```python
import torch

def _softmax(x, axis=-1):
    return torch.softmax(x, dim=axis)

def _gelu(x):
    return torch.nn.functional.gelu(x, approximate='tanh')

def _silu(x):
    return torch.nn.functional.silu(x)

def _sigmoid(x):
    return torch.sigmoid(x)

def _layernorm(x, axis=-1, eps=1e-05):
    m = x.mean(dim=axis, keepdim=True)
    v = x.var(dim=axis, keepdim=True, unbiased=False)
    return (x - m) / torch.sqrt(v + eps)

def _scatter_add(tgt, idx, src, axis=0):
    return tgt.clone().index_add_(axis, idx, src)

def _segment_sum(src, seg, n):
    out = torch.zeros((n,) + src.shape[1:], dtype=src.dtype)
    return out.index_add_(0, seg, src)

def _pad(x, pw):
    flat = tuple((v for pair in reversed(pw) for v in pair))
    return torch.nn.functional.pad(x, flat)
kernel_name = 'interleave_layers__memory_aug_recurrent_mem_tr__moe_arch_mod__prompt'

def setup_inputs():

    _w = lambda a: (lambda t: t.to(torch.bfloat16) if t.is_floating_point() else t)(torch.as_tensor(a))

    def _A_setup():
        B, S, Dm = (1, 2048, 512)
        H, Dh = (32, 128)
        M, seg = (8, 32)
        seg = min(seg, S)
        S = S // seg * seg
        return {'x': _w((lambda *s: torch.randn(*s, dtype=torch.bfloat16) * 0.05)(B, S, Dm)), 'mem0': _w((lambda *s: torch.randn(*s, dtype=torch.bfloat16) * 0.8)(B, M, Dm)), 'Wq': _w((lambda *s: torch.randn(*s, dtype=torch.bfloat16) * 0.8)(Dm, H, Dh) * Dm ** (-0.5)), 'Wk': _w((lambda *s: torch.randn(*s, dtype=torch.bfloat16) * 0.8)(Dm, H, Dh) * Dm ** (-0.5)), 'Wv': _w((lambda *s: torch.randn(*s, dtype=torch.bfloat16) * 0.8)(Dm, H, Dh) * Dm ** (-0.5)), 'Wo': _w((lambda *s: torch.randn(*s, dtype=torch.bfloat16) * 0.8)(H, Dh, Dm) * (H * Dh) ** (-0.5)), 'seg_len': seg}
    _A_in = _A_setup()

    def _B_setup():
        B, S, D, F, C = (1, 2048, 512, 1792, 1)
        return {'x': _w((lambda *s: torch.randn(*s, dtype=torch.bfloat16) * 0.05)(B, S, D)), 'w_r': _w((lambda *s: torch.randn(*s, dtype=torch.bfloat16) * 0.05)(D)), 'w_gate': _w((lambda *s: torch.randn(*s, dtype=torch.bfloat16) * 0.05)(D, F)), 'w_up': _w((lambda *s: torch.randn(*s, dtype=torch.bfloat16) * 0.05)(D, F)), 'w_down': _w((lambda *s: torch.randn(*s, dtype=torch.bfloat16) * 0.05)(F, D))}
    _B_in = _B_setup()
    return {'A_x': _A_in['x'], 'A_mem0': _A_in['mem0'], 'A_Wq': _A_in['Wq'], 'A_Wk': _A_in['Wk'], 'A_Wv': _A_in['Wv'], 'A_Wo': _A_in['Wo'], 'A_seg_len': _A_in['seg_len'], 'B_x': _B_in['x'], 'B_w_r': _B_in['w_r'], 'B_w_gate': _B_in['w_gate'], 'B_w_up': _B_in['w_up'], 'B_w_down': _B_in['w_down']}

def reference(A_x, A_mem0, A_Wq, A_Wk, A_Wv, A_Wo, A_seg_len, B_x, B_w_r, B_w_gate, B_w_up, B_w_down):

    def _A_ref(x, mem0, Wq, Wk, Wv, Wo, seg_len):
        B, S, Dm = x.shape
        H, Dh = (Wq.shape[1], Wq.shape[2])
        M = mem0.shape[1]
        scale = Dh ** (-0.5)
        n_seg = S // seg_len
        L = M + seg_len
        idx = torch.arange(L)
        mask = (idx[:, None] < M) | (idx[:, None] >= idx[None, :])
        mem = mem0
        outs = []
        for s in range(n_seg):
            xs = x[:, s * seg_len:(s + 1) * seg_len, :].clone()
            h = torch.concatenate([mem, xs], axis=1)
            q = torch.einsum('btd,dhe->bhte', h, Wq)
            k = torch.einsum('btd,dhe->bhte', h, Wk)
            v = torch.einsum('btd,dhe->bhte', h, Wv)
            scores = torch.einsum('bhqe,bhke->bhqk', q, k) * scale
            scores = torch.where(mask[None, None], scores, -1000000000.0)
            p = _softmax(scores, axis=-1)
            o = torch.einsum('bhqk,bhke->bhqe', p, v)
            o = torch.einsum('bhte,hed->btd', o, Wo)
            mem = o[:, :M, :].clone()
            outs.append(o[:, M:, :])
        return torch.concatenate(outs, axis=1)

    def _B_ref(x, w_r, w_gate, w_up, w_down):
        B, S, D = x.shape
        C = 1
        r = x @ w_r
        idx = torch.argsort(-r, axis=-1)[:, :C]
        idx_e = (lambda x, n, axis: torch.repeat_interleave(x, n, dim=axis))(idx.reshape(B, C, 1), D, axis=2)
        x_sel = (lambda x, i, axis: torch.take_along_dim(x, i, dim=axis))(x, idx_e, axis=1)
        g = _silu(x_sel @ w_gate)
        u = x_sel @ w_up
        y = g * u @ w_down
        r_sel = _sigmoid((lambda x, i, axis: torch.take_along_dim(x, i, dim=axis))(r, idx, axis=1))
        y = y * r_sel.reshape(B, C, 1)
        b_off = (torch.arange(B) * S).reshape(B, 1)
        flat_idx = (idx + b_off).reshape(B * C)
        zero = (x * 0.0).reshape(B * S, D)
        upd = _scatter_add(zero, flat_idx, y.reshape(B * C, D), axis=0)
        return x + upd.reshape(B, S, D)
    x = A_x
    x = x + _A_ref(_layernorm(x, axis=-1), A_mem0, A_Wq, A_Wk, A_Wv, A_Wo, A_seg_len)
    x = x + _B_ref(_layernorm(x, axis=-1), B_w_r, B_w_gate, B_w_up, B_w_down)
    x = x + _A_ref(_layernorm(x, axis=-1), A_mem0, A_Wq, A_Wk, A_Wv, A_Wo, A_seg_len)
    x = x + _B_ref(_layernorm(x, axis=-1), B_w_r, B_w_gate, B_w_up, B_w_down)
    return x
```

```asm
; @launch grid=(256,1,1) block=(256,1,1) lds=163840
.amdgcn_target "amdgcn-amd-amdhsa--gfx950"
.text
.globl interleave_layers__memory_aug_recurrent_mem_tr__moe_arch_mod__prompt_kernel
.p2align 8
.type interleave_layers__memory_aug_recurrent_mem_tr__moe_arch_mod__prompt_kernel,@function
interleave_layers__memory_aug_recurrent_mem_tr__moe_arch_mod__prompt_kernel:
  s_cmp_ge_u32 s2, 256
  s_cbranch_scc1 L_end
  s_load_dwordx2 s[4:5], s[0:1], 112
  s_load_dwordx2 s[12:13], s[0:1], 104
  s_mov_b32 s6, 268435456
  s_mov_b32 s7, 0x20000
  s_mov_b32 s11, 0x20000
  s_getreg_b32 s91, hwreg(HW_REG_XCC_ID)
  s_and_b32 s91, s91, 7
  v_lshrrev_b32 v1, 6, v0
  v_mov_b32 v2, 0
  v_readfirstlane_b32 s17, v1
  s_waitcnt lgkmcnt(0)
  s_cmp_lg_u32 s17, 0
  s_cbranch_scc1 L_got
  s_lshl_b32 s26, s91, 4
  v_mov_b32 v3, s26
  v_mov_b32 v4, 1
  s_mov_b64 exec, 1
  global_atomic_add v5, v3, v4, s[12:13] sc0
  s_mov_b64 exec, -1
  s_waitcnt vmcnt(0)
  v_readfirstlane_b32 s90, v5
  s_cmp_ge_u32 s90, 32
  s_cbranch_scc1 L_ovf
  s_lshl_b32 s26, s91, 5
  s_add_u32 s90, s90, s26
L_pub:
  v_mov_b32 v3, s90
  ds_write_b32 v2, v3
  s_waitcnt lgkmcnt(0)
L_got:
  s_barrier
  ds_read_b32 v3, v2
  s_waitcnt lgkmcnt(0)
  v_readfirstlane_b32 s90, v3
  s_barrier
  s_cmp_ge_u32 s90, 256
  s_cbranch_scc1 L_end
  s_lshr_b32 s91, s90, 5
  s_cmp_lt_u32 s91, 3
  s_cbranch_scc1 L_chain
  s_cmp_lt_u32 s91, 6
  s_cbranch_scc1 L_qkv
  s_branch L_o
L_ovf:
  v_mov_b32 v3, 128
  s_mov_b64 exec, 1
  global_atomic_add v5, v3, v4, s[12:13] sc0
  s_mov_b64 exec, -1
  s_waitcnt vmcnt(0)
  v_readfirstlane_b32 s37, v5
  v_lshlrev_b32 v6, 4, v0
  s_mov_b32 s26, 0
  s_mov_b32 s90, 256
L_ovw:
  v_and_b32 v7, 0x70, v6
  global_load_dword v8, v7, s[12:13] sc1
  s_waitcnt vmcnt(0)
  v_readlane_b32 s28, v8, 0
  v_readlane_b32 s29, v8, 1
  v_readlane_b32 s30, v8, 2
  v_readlane_b32 s31, v8, 3
  v_readlane_b32 s32, v8, 4
  v_readlane_b32 s33, v8, 5
  v_readlane_b32 s34, v8, 6
  v_readlane_b32 s35, v8, 7
  s_add_u32 s27, s28, s29
  s_add_u32 s27, s27, s30
  s_add_u32 s27, s27, s31
  s_add_u32 s27, s27, s32
  s_add_u32 s27, s27, s33
  s_add_u32 s27, s27, s34
  s_add_u32 s27, s27, s35
  s_add_u32 s26, s26, 1
  s_cmp_gt_u32 s26, 1048576
  s_cbranch_scc1 L_pub
  s_cmp_lt_u32 s27, 256
  s_cbranch_scc1 L_ovw
  s_min_u32 s28, s28, 32
  s_add_u32 s37, s37, s28
  s_add_u32 s90, s37, 0
  s_cmp_lt_u32 s37, 32
  s_cbranch_scc1 L_pub
  s_sub_u32 s37, s37, 32
  s_min_u32 s29, s29, 32
  s_add_u32 s37, s37, s29
  s_add_u32 s90, s37, 32
  s_cmp_lt_u32 s37, 32
  s_cbranch_scc1 L_pub
  s_sub_u32 s37, s37, 32
  s_min_u32 s30, s30, 32
  s_add_u32 s37, s37, s30
  s_add_u32 s90, s37, 64
  s_cmp_lt_u32 s37, 32
  s_cbranch_scc1 L_pub
  s_sub_u32 s37, s37, 32
  s_min_u32 s31, s31, 32
  s_add_u32 s37, s37, s31
  s_add_u32 s90, s37, 96
  s_cmp_lt_u32 s37, 32
  s_cbranch_scc1 L_pub
  s_sub_u32 s37, s37, 32
  s_min_u32 s32, s32, 32
  s_add_u32 s37, s37, s32
  s_add_u32 s90, s37, 128
  s_cmp_lt_u32 s37, 32
  s_cbranch_scc1 L_pub
  s_sub_u32 s37, s37, 32
  s_min_u32 s33, s33, 32
  s_add_u32 s37, s37, s33
  s_add_u32 s90, s37, 160
  s_cmp_lt_u32 s37, 32
  s_cbranch_scc1 L_pub
  s_sub_u32 s37, s37, 32
  s_min_u32 s34, s34, 32
  s_add_u32 s37, s37, s34
  s_add_u32 s90, s37, 192
  s_cmp_lt_u32 s37, 32
  s_cbranch_scc1 L_pub
  s_sub_u32 s37, s37, 32
  s_min_u32 s35, s35, 32
  s_add_u32 s37, s37, s35
  s_add_u32 s90, s37, 224
  s_cmp_lt_u32 s37, 32
  s_cbranch_scc1 L_pub
  s_sub_u32 s37, s37, 32
  s_mov_b32 s90, 256
  s_branch L_pub
L_end:
  s_endpgm
L_chain:
  s_cmp_eq_u32 s91, 1
  s_cbranch_scc1 L_end
  s_and_b32 s16, s90, 31
  s_mov_b32 s60, s91
  s_min_u32 s61, s91, 1
  v_lshrrev_b32 v18, 6, v0
  v_and_b32 v19, 63, v0
  v_readfirstlane_b32 s17, v18
  v_and_b32 v7, 15, v19
  v_lshrrev_b32 v17, 4, v19
  v_lshlrev_b32 v0, 4, v19
  s_mov_b32 s44, 0x05040100
  s_mov_b32 s45, 0x07060302
  s_mov_b32 s18, 0xcccccccc
  s_mov_b32 s19, 0xcccccccc
  s_mov_b32 s24, 0x3e0293ee
  s_lshl_b32 s26, s17, 10
  v_add_u32 v8, s26, v0
  v_xor_b32 v9, 1024, v8
  v_xor_b32 v10, 2048, v8
  v_xor_b32 v11, 3072, v8
  s_mov_b32 s14, 0x3f803f80
  s_mov_b32 s15, 0x3f803f80
  s_mul_i32 s27, s17, 36864
  s_add_u32 s27, s27, 16384
  s_add_u32 m0, s27, 32768
  v_add_u32 v1, s27, v0
  v_lshrrev_b32 v20, 2, v7
  v_xor_b32 v21, v17, v20
  v_lshlrev_b32 v22, 5, v7
  v_add_u32 v22, s26, v22
  v_lshl_add_u32 v2, v21, 3, v22
  v_and_b32 v21, 3, v7
  v_xor_b32 v21, v21, v17
  v_lshl_add_u32 v22, v17, 2, v20
  v_lshlrev_b32 v22, 5, v22
  v_lshl_add_u32 v3, v21, 3, v22
  v_add_u32 v12, s26, v3
  v_xor_b32 v13, 1024, v12
  v_xor_b32 v14, 2048, v12
  v_xor_b32 v15, 3072, v12
  v_lshlrev_b32 v21, 13, v20
  v_and_b32 v22, 3, v7
  v_lshl_add_u32 v22, v17, 2, v22
  v_lshl_add_u32 v21, v22, 4, v21
  s_lshl_b32 s27, s17, 16
  s_lshl_b32 s28, s16, 8
  s_add_u32 s27, s27, s28
  v_add_u32 v4, s27, v21
  v_and_b32 v21, 1, v7
  v_lshl_add_u32 v21, v17, 2, v21
  v_bfe_u32 v22, v7, 2, 1
  v_lshl_add_u32 v21, v22, 1, v21
  v_lshlrev_b32 v21, 4, v21
  v_bfe_u32 v22, v7, 1, 1
  v_lshl_add_u32 v21, v22, 3, v21
  v_add_u32 v5, s28, v21
  v_cmp_lt_u32 vcc, 7, v7
  v_mov_b32 v22, 0x7ff00000
  s_nop 0
  v_cndmask_b32 v5, v5, v22, vcc
  v_mov_b32 v21, 0x4444
  v_mov_b32 v22, 0xeeee
  v_cndmask_b32 v6, v21, v22, s[18:19]
  s_lshl_b32 s40, s60, 20
  s_add_u32 s40, s40, 0
  s_add_u32 s41, s40, 32768
  s_lshl_b32 s62, s60, 16
  s_add_u32 s62, s62, 4194304
  v_mov_b32 v24, -1
  v_mov_b32 v25, -1
  v_mov_b32 v26, -1
  v_mov_b32 v27, -1
  buffer_store_dwordx4 v[24:27], v4, s[4:7], s40 offen sc1
  buffer_store_dwordx4 v[24:27], v4, s[4:7], s41 offen sc1
  s_add_u32 s27, s62, 8192
  buffer_store_dwordx2 v[24:25], v5, s[4:7], s27 offen sc1
  s_add_u32 s27, s62, 16384
  buffer_store_dwordx2 v[24:25], v5, s[4:7], s27 offen sc1
  s_load_dwordx2 s[8:9], s[0:1], 8
  s_mov_b32 s10, 8192
  s_mov_b32 s11, 0x20000
  v_and_b32 v21, 1, v7
  v_lshl_add_u32 v21, v17, 1, v21
  v_lshlrev_b32 v21, 10, v21
  v_bfe_u32 v22, v7, 1, 2
  v_lshl_add_u32 v21, v22, 1, v21
  s_lshr_b32 s27, s16, 3
  s_lshl_b32 s27, s27, 8
  s_and_b32 s28, s16, 3
  s_lshl_b32 s28, s28, 6
  s_add_u32 s27, s27, s28
  s_and_b32 s28, s16, 4
  s_lshl_b32 s28, s28, 1
  s_add_u32 s27, s27, s28
  s_waitcnt lgkmcnt(0)
  buffer_load_ushort v28, v21, s[8:11], s27 offen
  buffer_load_ushort v29, v21, s[8:11], s27 offen offset:16
  buffer_load_ushort v30, v21, s[8:11], s27 offen offset:32
  buffer_load_ushort v31, v21, s[8:11], s27 offen offset:48
  s_waitcnt vmcnt(0)
  v_lshl_or_b32 v28, v29, 16, v28
  v_lshl_or_b32 v29, v31, 16, v30
  v_min_u32 v28, -2, v28
  v_min_u32 v29, -2, v29
  buffer_store_dwordx2 v[28:29], v5, s[4:7], s62 offen sc1
  s_waitcnt vmcnt(0)
  s_barrier
  s_lshl_b32 s38, s91, 2
  s_add_u32 s38, s38, 192
  s_cmp_lg_u32 s17, 0
  s_cbranch_scc1 g_ar_1
  v_mov_b32 v20, s38
  v_mov_b32 v21, 1
  s_mov_b64 exec, 1
  global_atomic_add v20, v21, s[12:13]
  s_mov_b64 exec, -1
g_ar_1:
  s_load_dwordx2 s[8:9], s[0:1], 40
  s_mov_b32 s10, 4194304
  s_mov_b32 s11, 0x20000
  v_and_b32 v20, 1, v17
  v_lshlrev_b32 v20, 5, v20
  v_lshrrev_b32 v21, 1, v17
  v_lshl_add_u32 v20, v21, 3, v20
  v_lshlrev_b32 v20, 10, v20
  v_lshl_add_u32 v20, v7, 4, v20
  s_lshl_b32 s26, s16, 17
  s_lshl_b32 s27, s17, 8
  s_add_u32 s26, s26, s27
  v_lshlrev_b32 v22, 5, v21
  v_and_b32 v21, 1, v17
  v_add_u32 v21, v21, v22
  v_lshlrev_b32 v21, 13, v21
  v_lshl_add_u32 v21, v7, 2, v21
  s_waitcnt lgkmcnt(0)
  s_add_u32 s27, s26, 0
  buffer_load_dwordx4 v[128:131], v20, s[8:11], s27 offen
  s_add_u32 s27, s26, 2048
  buffer_load_dwordx4 v[132:135], v20, s[8:11], s27 offen
  s_add_u32 s27, s26, 1024
  buffer_load_dwordx4 v[136:139], v20, s[8:11], s27 offen
  s_add_u32 s27, s26, 3072
  buffer_load_dwordx4 v[140:143], v20, s[8:11], s27 offen
  s_add_u32 s27, s26, 4096
  buffer_load_dwordx4 v[144:147], v20, s[8:11], s27 offen
  s_add_u32 s27, s26, 6144
  buffer_load_dwordx4 v[148:151], v20, s[8:11], s27 offen
  s_add_u32 s27, s26, 5120
  buffer_load_dwordx4 v[152:155], v20, s[8:11], s27 offen
  s_add_u32 s27, s26, 7168
  buffer_load_dwordx4 v[156:159], v20, s[8:11], s27 offen
  s_add_u32 s27, s26, 16384
  buffer_load_dwordx4 v[160:163], v20, s[8:11], s27 offen
  s_add_u32 s27, s26, 18432
  buffer_load_dwordx4 v[164:167], v20, s[8:11], s27 offen
  s_add_u32 s27, s26, 17408
  buffer_load_dwordx4 v[168:171], v20, s[8:11], s27 offen
  s_add_u32 s27, s26, 19456
  buffer_load_dwordx4 v[172:175], v20, s[8:11], s27 offen
  s_add_u32 s27, s26, 20480
  buffer_load_dwordx4 v[176:179], v20, s[8:11], s27 offen
  s_add_u32 s27, s26, 22528
  buffer_load_dwordx4 v[180:183], v20, s[8:11], s27 offen
  s_add_u32 s27, s26, 21504
  buffer_load_dwordx4 v[184:187], v20, s[8:11], s27 offen
  s_add_u32 s27, s26, 23552
  buffer_load_dwordx4 v[188:191], v20, s[8:11], s27 offen
  s_add_u32 s27, s26, 65536
  buffer_load_dwordx4 v[192:195], v20, s[8:11], s27 offen
  s_add_u32 s27, s26, 67584
  buffer_load_dwordx4 v[196:199], v20, s[8:11], s27 offen
  s_add_u32 s27, s26, 66560
  buffer_load_dwordx4 v[200:203], v20, s[8:11], s27 offen
  s_add_u32 s27, s26, 68608
  buffer_load_dwordx4 v[204:207], v20, s[8:11], s27 offen
  s_add_u32 s27, s26, 69632
  buffer_load_dwordx4 v[208:211], v20, s[8:11], s27 offen
  s_add_u32 s27, s26, 71680
  buffer_load_dwordx4 v[212:215], v20, s[8:11], s27 offen
  s_add_u32 s27, s26, 70656
  buffer_load_dwordx4 v[216:219], v20, s[8:11], s27 offen
  s_add_u32 s27, s26, 72704
  buffer_load_dwordx4 v[220:223], v20, s[8:11], s27 offen
  s_add_u32 s27, s26, 81920
  buffer_load_dwordx4 v[224:227], v20, s[8:11], s27 offen
  s_add_u32 s27, s26, 83968
  buffer_load_dwordx4 v[228:231], v20, s[8:11], s27 offen
  s_add_u32 s27, s26, 82944
  buffer_load_dwordx4 v[232:235], v20, s[8:11], s27 offen
  s_add_u32 s27, s26, 84992
  buffer_load_dwordx4 v[236:239], v20, s[8:11], s27 offen
  s_add_u32 s27, s26, 86016
  buffer_load_dwordx4 v[240:243], v20, s[8:11], s27 offen
  s_add_u32 s27, s26, 88064
  buffer_load_dwordx4 v[244:247], v20, s[8:11], s27 offen
  s_add_u32 s27, s26, 87040
  buffer_load_dwordx4 v[248:251], v20, s[8:11], s27 offen
  s_add_u32 s27, s26, 89088
  buffer_load_dwordx4 v[252:255], v20, s[8:11], s27 offen
  s_lshl_b32 s26, s16, 8
  s_lshl_b32 s27, s17, 6
  s_add_u32 s26, s26, s27
  s_xor_b32 s27, s17, 0
  s_lshr_b32 s28, s27, 1
  s_lshl_b32 s28, s28, 20
  s_and_b32 s27, s27, 1
  s_lshl_b32 s27, s27, 15
  s_add_u32 s30, s27, s28
  s_add_u32 s30, s30, s26
  s_xor_b32 s27, s17, 1
  s_lshr_b32 s28, s27, 1
  s_lshl_b32 s28, s28, 20
  s_and_b32 s27, s27, 1
  s_lshl_b32 s27, s27, 15
  s_add_u32 s31, s27, s28
  s_add_u32 s31, s31, s26
  s_xor_b32 s27, s17, 2
  s_lshr_b32 s28, s27, 1
  s_lshl_b32 s28, s28, 20
  s_and_b32 s27, s27, 1
  s_lshl_b32 s27, s27, 15
  s_add_u32 s32, s27, s28
  s_add_u32 s32, s32, s26
  s_xor_b32 s27, s17, 3
  s_lshr_b32 s28, s27, 1
  s_lshl_b32 s28, s28, 20
  s_and_b32 s27, s27, 1
  s_lshl_b32 s27, s27, 15
  s_add_u32 s33, s27, s28
  s_add_u32 s33, s33, s26
  s_load_dwordx2 s[8:9], s[0:1], 16
  s_waitcnt lgkmcnt(0)
  s_add_u32 s27, s30, 0
  buffer_load_dword v24, v21, s[8:11], s27 offen
  s_add_u32 s27, s30, 65536
  buffer_load_dword v25, v21, s[8:11], s27 offen
  s_add_u32 s27, s30, 16384
  buffer_load_dword v26, v21, s[8:11], s27 offen
  s_add_u32 s27, s30, 81920
  buffer_load_dword v27, v21, s[8:11], s27 offen
  s_add_u32 s27, s30, 131072
  buffer_load_dword v28, v21, s[8:11], s27 offen
  s_add_u32 s27, s30, 196608
  buffer_load_dword v29, v21, s[8:11], s27 offen
  s_add_u32 s27, s30, 147456
  buffer_load_dword v30, v21, s[8:11], s27 offen
  s_add_u32 s27, s30, 212992
  buffer_load_dword v31, v21, s[8:11], s27 offen
  s_add_u32 s27, s30, 524288
  buffer_load_dword v32, v21, s[8:11], s27 offen
  s_add_u32 s27, s30, 589824
  buffer_load_dword v33, v21, s[8:11], s27 offen
  s_add_u32 s27, s30, 540672
  buffer_load_dword v34, v21, s[8:11], s27 offen
  s_add_u32 s27, s30, 606208
  buffer_load_dword v35, v21, s[8:11], s27 offen
  s_add_u32 s27, s30, 655360
  buffer_load_dword v36, v21, s[8:11], s27 offen
  s_add_u32 s27, s30, 720896
  buffer_load_dword v37, v21, s[8:11], s27 offen
  s_add_u32 s27, s30, 671744
  buffer_load_dword v38, v21, s[8:11], s27 offen
  s_add_u32 s27, s30, 737280
  buffer_load_dword v39, v21, s[8:11], s27 offen
  s_waitcnt vmcnt(40)
  v_perm_b32 v120, v132, v128, s44
  v_perm_b32 v121, v140, v136, s44
  v_perm_b32 v122, v148, v144, s44
  v_perm_b32 v123, v156, v152, s44
  v_accvgpr_write_b32 a248, v120
  v_accvgpr_write_b32 a249, v121
  v_accvgpr_write_b32 a250, v122
  v_accvgpr_write_b32 a251, v123
  v_perm_b32 v124, v132, v128, s45
  v_perm_b32 v125, v140, v136, s45
  v_perm_b32 v126, v148, v144, s45
  v_perm_b32 v127, v156, v152, s45
  v_accvgpr_write_b32 a232, v124
  v_accvgpr_write_b32 a233, v125
  v_accvgpr_write_b32 a234, v126
  v_accvgpr_write_b32 a235, v127
  v_perm_b32 v120, v133, v129, s44
  v_perm_b32 v121, v141, v137, s44
  v_perm_b32 v122, v149, v145, s44
  v_perm_b32 v123, v157, v153, s44
  v_accvgpr_write_b32 a216, v120
  v_accvgpr_write_b32 a217, v121
  v_accvgpr_write_b32 a218, v122
  v_accvgpr_write_b32 a219, v123
  v_perm_b32 v124, v133, v129, s45
  v_perm_b32 v125, v141, v137, s45
  v_perm_b32 v126, v149, v145, s45
  v_perm_b32 v127, v157, v153, s45
  v_accvgpr_write_b32 a200, v124
  v_accvgpr_write_b32 a201, v125
  v_accvgpr_write_b32 a202, v126
  v_accvgpr_write_b32 a203, v127
  v_perm_b32 v120, v134, v130, s44
  v_perm_b32 v121, v142, v138, s44
  v_perm_b32 v122, v150, v146, s44
  v_perm_b32 v123, v158, v154, s44
  v_accvgpr_write_b32 a184, v120
  v_accvgpr_write_b32 a185, v121
  v_accvgpr_write_b32 a186, v122
  v_accvgpr_write_b32 a187, v123
  v_perm_b32 v124, v134, v130, s45
  v_perm_b32 v125, v142, v138, s45
  v_perm_b32 v126, v150, v146, s45
  v_perm_b32 v127, v158, v154, s45
  ds_write_b128 v1, v[124:127] offset:20480
  s_waitcnt lgkmcnt(0)
  v_perm_b32 v120, v135, v131, s44
  v_perm_b32 v121, v143, v139, s44
  v_perm_b32 v122, v151, v147, s44
  v_perm_b32 v123, v159, v155, s44
  ds_write_b128 v1, v[120:123] offset:24576
  s_waitcnt lgkmcnt(0)
  v_perm_b32 v124, v135, v131, s45
  v_perm_b32 v125, v143, v139, s45
  v_perm_b32 v126, v151, v147, s45
  v_perm_b32 v127, v159, v155, s45
  ds_write_b128 v1, v[124:127] offset:28672
  s_waitcnt lgkmcnt(0)
  s_waitcnt vmcnt(32)
  s_add_u32 s27, s31, 0
  buffer_load_dword v40, v21, s[8:11], s27 offen
  s_add_u32 s27, s31, 65536
  buffer_load_dword v41, v21, s[8:11], s27 offen
  s_add_u32 s27, s31, 16384
  buffer_load_dword v42, v21, s[8:11], s27 offen
  s_add_u32 s27, s31, 81920
  buffer_load_dword v43, v21, s[8:11], s27 offen
  s_add_u32 s27, s31, 131072
  buffer_load_dword v44, v21, s[8:11], s27 offen
  s_add_u32 s27, s31, 196608
  buffer_load_dword v45, v21, s[8:11], s27 offen
  s_add_u32 s27, s31, 147456
  buffer_load_dword v46, v21, s[8:11], s27 offen
  s_add_u32 s27, s31, 212992
  buffer_load_dword v47, v21, s[8:11], s27 offen
  s_add_u32 s27, s31, 524288
  buffer_load_dword v48, v21, s[8:11], s27 offen
  s_add_u32 s27, s31, 589824
  buffer_load_dword v49, v21, s[8:11], s27 offen
  s_add_u32 s27, s31, 540672
  buffer_load_dword v50, v21, s[8:11], s27 offen
  s_add_u32 s27, s31, 606208
  buffer_load_dword v51, v21, s[8:11], s27 offen
  s_add_u32 s27, s31, 655360
  buffer_load_dword v52, v21, s[8:11], s27 offen
  s_add_u32 s27, s31, 720896
  buffer_load_dword v53, v21, s[8:11], s27 offen
  s_add_u32 s27, s31, 671744
  buffer_load_dword v54, v21, s[8:11], s27 offen
  s_add_u32 s27, s31, 737280
  buffer_load_dword v55, v21, s[8:11], s27 offen
  v_perm_b32 v120, v164, v160, s44
  v_perm_b32 v121, v172, v168, s44
  v_perm_b32 v122, v180, v176, s44
  v_perm_b32 v123, v188, v184, s44
  v_accvgpr_write_b32 a252, v120
  v_accvgpr_write_b32 a253, v121
  v_accvgpr_write_b32 a254, v122
  v_accvgpr_write_b32 a255, v123
  v_perm_b32 v124, v164, v160, s45
  v_perm_b32 v125, v172, v168, s45
  v_perm_b32 v126, v180, v176, s45
  v_perm_b32 v127, v188, v184, s45
  v_accvgpr_write_b32 a236, v124
  v_accvgpr_write_b32 a237, v125
  v_accvgpr_write_b32 a238, v126
  v_accvgpr_write_b32 a239, v127
  v_perm_b32 v120, v165, v161, s44
  v_perm_b32 v121, v173, v169, s44
  v_perm_b32 v122, v181, v177, s44
  v_perm_b32 v123, v189, v185, s44
  v_accvgpr_write_b32 a220, v120
  v_accvgpr_write_b32 a221, v121
  v_accvgpr_write_b32 a222, v122
  v_accvgpr_write_b32 a223, v123
  v_perm_b32 v124, v165, v161, s45
  v_perm_b32 v125, v173, v169, s45
  v_perm_b32 v126, v181, v177, s45
  v_perm_b32 v127, v189, v185, s45
  v_accvgpr_write_b32 a204, v124
  v_accvgpr_write_b32 a205, v125
  v_accvgpr_write_b32 a206, v126
  v_accvgpr_write_b32 a207, v127
  v_perm_b32 v120, v166, v162, s44
  v_perm_b32 v121, v174, v170, s44
  v_perm_b32 v122, v182, v178, s44
  v_perm_b32 v123, v190, v186, s44
  v_accvgpr_write_b32 a188, v120
  v_accvgpr_write_b32 a189, v121
  v_accvgpr_write_b32 a190, v122
  v_accvgpr_write_b32 a191, v123
  v_perm_b32 v124, v166, v162, s45
  v_perm_b32 v125, v174, v170, s45
  v_perm_b32 v126, v182, v178, s45
  v_perm_b32 v127, v190, v186, s45
  ds_write_b128 v1, v[124:127] offset:21504
  s_waitcnt lgkmcnt(0)
  v_perm_b32 v120, v167, v163, s44
  v_perm_b32 v121, v175, v171, s44
  v_perm_b32 v122, v183, v179, s44
  v_perm_b32 v123, v191, v187, s44
  ds_write_b128 v1, v[120:123] offset:25600
  s_waitcnt lgkmcnt(0)
  v_perm_b32 v124, v167, v163, s45
  v_perm_b32 v125, v175, v171, s45
  v_perm_b32 v126, v183, v179, s45
  v_perm_b32 v127, v191, v187, s45
  ds_write_b128 v1, v[124:127] offset:29696
  s_waitcnt lgkmcnt(0)
  s_waitcnt vmcnt(40)
  v_perm_b32 v120, v196, v192, s44
  v_perm_b32 v121, v204, v200, s44
  v_perm_b32 v122, v212, v208, s44
  v_perm_b32 v123, v220, v216, s44
  v_accvgpr_write_b32 a240, v120
  v_accvgpr_write_b32 a241, v121
  v_accvgpr_write_b32 a242, v122
  v_accvgpr_write_b32 a243, v123
  v_perm_b32 v124, v196, v192, s45
  v_perm_b32 v125, v204, v200, s45
  v_perm_b32 v126, v212, v208, s45
  v_perm_b32 v127, v220, v216, s45
  v_accvgpr_write_b32 a224, v124
  v_accvgpr_write_b32 a225, v125
  v_accvgpr_write_b32 a226, v126
  v_accvgpr_write_b32 a227, v127
  v_perm_b32 v120, v197, v193, s44
  v_perm_b32 v121, v205, v201, s44
  v_perm_b32 v122, v213, v209, s44
  v_perm_b32 v123, v221, v217, s44
  v_accvgpr_write_b32 a208, v120
  v_accvgpr_write_b32 a209, v121
  v_accvgpr_write_b32 a210, v122
  v_accvgpr_write_b32 a211, v123
  v_perm_b32 v124, v197, v193, s45
  v_perm_b32 v125, v205, v201, s45
  v_perm_b32 v126, v213, v209, s45
  v_perm_b32 v127, v221, v217, s45
  v_accvgpr_write_b32 a192, v124
  v_accvgpr_write_b32 a193, v125
  v_accvgpr_write_b32 a194, v126
  v_accvgpr_write_b32 a195, v127
  v_perm_b32 v120, v198, v194, s44
  v_perm_b32 v121, v206, v202, s44
  v_perm_b32 v122, v214, v210, s44
  v_perm_b32 v123, v222, v218, s44
  v_accvgpr_write_b32 a176, v120
  v_accvgpr_write_b32 a177, v121
  v_accvgpr_write_b32 a178, v122
  v_accvgpr_write_b32 a179, v123
  v_perm_b32 v124, v198, v194, s45
  v_perm_b32 v125, v206, v202, s45
  v_perm_b32 v126, v214, v210, s45
  v_perm_b32 v127, v222, v218, s45
  ds_write_b128 v1, v[124:127] offset:22528
  s_waitcnt lgkmcnt(0)
  v_perm_b32 v120, v199, v195, s44
  v_perm_b32 v121, v207, v203, s44
  v_perm_b32 v122, v215, v211, s44
  v_perm_b32 v123, v223, v219, s44
  ds_write_b128 v1, v[120:123] offset:26624
  s_waitcnt lgkmcnt(0)
  v_perm_b32 v124, v199, v195, s45
  v_perm_b32 v125, v207, v203, s45
  v_perm_b32 v126, v215, v211, s45
  v_perm_b32 v127, v223, v219, s45
  ds_write_b128 v1, v[124:127] offset:30720
  s_waitcnt lgkmcnt(0)
  s_waitcnt vmcnt(32)
  s_add_u32 s27, s32, 0
  buffer_load_dword v56, v21, s[8:11], s27 offen
  s_add_u32 s27, s32, 65536
  buffer_load_dword v57, v21, s[8:11], s27 offen
  s_add_u32 s27, s32, 16384
  buffer_load_dword v58, v21, s[8:11], s27 offen
  s_add_u32 s27, s32, 81920
  buffer_load_dword v59, v21, s[8:11], s27 offen
  s_add_u32 s27, s32, 131072
  buffer_load_dword v60, v21, s[8:11], s27 offen
  s_add_u32 s27, s32, 196608
  buffer_load_dword v61, v21, s[8:11], s27 offen
  s_add_u32 s27, s32, 147456
  buffer_load_dword v62, v21, s[8:11], s27 offen
  s_add_u32 s27, s32, 212992
  buffer_load_dword v63, v21, s[8:11], s27 offen
  s_add_u32 s27, s32, 524288
  buffer_load_dword v64, v21, s[8:11], s27 offen
  s_add_u32 s27, s32, 589824
  buffer_load_dword v65, v21, s[8:11], s27 offen
  s_add_u32 s27, s32, 540672
  buffer_load_dword v66, v21, s[8:11], s27 offen
  s_add_u32 s27, s32, 606208
  buffer_load_dword v67, v21, s[8:11], s27 offen
  s_add_u32 s27, s32, 655360
  buffer_load_dword v68, v21, s[8:11], s27 offen
  s_add_u32 s27, s32, 720896
  buffer_load_dword v69, v21, s[8:11], s27 offen
  s_add_u32 s27, s32, 671744
  buffer_load_dword v70, v21, s[8:11], s27 offen
  s_add_u32 s27, s32, 737280
  buffer_load_dword v71, v21, s[8:11], s27 offen
  v_perm_b32 v120, v228, v224, s44
  v_perm_b32 v121, v236, v232, s44
  v_perm_b32 v122, v244, v240, s44
  v_perm_b32 v123, v252, v248, s44
  v_accvgpr_write_b32 a244, v120
  v_accvgpr_write_b32 a245, v121
  v_accvgpr_write_b32 a246, v122
  v_accvgpr_write_b32 a247, v123
  v_perm_b32 v124, v228, v224, s45
  v_perm_b32 v125, v236, v232, s45
  v_perm_b32 v126, v244, v240, s45
  v_perm_b32 v127, v252, v248, s45
  v_accvgpr_write_b32 a228, v124
  v_accvgpr_write_b32 a229, v125
  v_accvgpr_write_b32 a230, v126
  v_accvgpr_write_b32 a231, v127
  v_perm_b32 v120, v229, v225, s44
  v_perm_b32 v121, v237, v233, s44
  v_perm_b32 v122, v245, v241, s44
  v_perm_b32 v123, v253, v249, s44
  v_accvgpr_write_b32 a212, v120
  v_accvgpr_write_b32 a213, v121
  v_accvgpr_write_b32 a214, v122
  v_accvgpr_write_b32 a215, v123
  v_perm_b32 v124, v229, v225, s45
  v_perm_b32 v125, v237, v233, s45
  v_perm_b32 v126, v245, v241, s45
  v_perm_b32 v127, v253, v249, s45
  v_accvgpr_write_b32 a196, v124
  v_accvgpr_write_b32 a197, v125
  v_accvgpr_write_b32 a198, v126
  v_accvgpr_write_b32 a199, v127
  v_perm_b32 v120, v230, v226, s44
  v_perm_b32 v121, v238, v234, s44
  v_perm_b32 v122, v246, v242, s44
  v_perm_b32 v123, v254, v250, s44
  v_accvgpr_write_b32 a180, v120
  v_accvgpr_write_b32 a181, v121
  v_accvgpr_write_b32 a182, v122
  v_accvgpr_write_b32 a183, v123
  v_perm_b32 v124, v230, v226, s45
  v_perm_b32 v125, v238, v234, s45
  v_perm_b32 v126, v246, v242, s45
  v_perm_b32 v127, v254, v250, s45
  ds_write_b128 v1, v[124:127] offset:23552
  s_waitcnt lgkmcnt(0)
  v_perm_b32 v120, v231, v227, s44
  v_perm_b32 v121, v239, v235, s44
  v_perm_b32 v122, v247, v243, s44
  v_perm_b32 v123, v255, v251, s44
  ds_write_b128 v1, v[120:123] offset:27648
  s_waitcnt lgkmcnt(0)
  v_perm_b32 v124, v231, v227, s45
  v_perm_b32 v125, v239, v235, s45
  v_perm_b32 v126, v247, v243, s45
  v_perm_b32 v127, v255, v251, s45
  ds_write_b128 v1, v[124:127] offset:31744
  s_waitcnt lgkmcnt(0)
  s_add_u32 s27, s33, 0
  buffer_load_dword v72, v21, s[8:11], s27 offen
  s_add_u32 s27, s33, 65536
  buffer_load_dword v73, v21, s[8:11], s27 offen
  s_add_u32 s27, s33, 16384
  buffer_load_dword v74, v21, s[8:11], s27 offen
  s_add_u32 s27, s33, 81920
  buffer_load_dword v75, v21, s[8:11], s27 offen
  s_add_u32 s27, s33, 131072
  buffer_load_dword v76, v21, s[8:11], s27 offen
  s_add_u32 s27, s33, 196608
  buffer_load_dword v77, v21, s[8:11], s27 offen
  s_add_u32 s27, s33, 147456
  buffer_load_dword v78, v21, s[8:11], s27 offen
  s_add_u32 s27, s33, 212992
  buffer_load_dword v79, v21, s[8:11], s27 offen
  s_add_u32 s27, s33, 524288
  buffer_load_dword v80, v21, s[8:11], s27 offen
  s_add_u32 s27, s33, 589824
  buffer_load_dword v81, v21, s[8:11], s27 offen
  s_add_u32 s27, s33, 540672
  buffer_load_dword v82, v21, s[8:11], s27 offen
  s_add_u32 s27, s33, 606208
  buffer_load_dword v83, v21, s[8:11], s27 offen
  s_add_u32 s27, s33, 655360
  buffer_load_dword v84, v21, s[8:11], s27 offen
  s_add_u32 s27, s33, 720896
  buffer_load_dword v85, v21, s[8:11], s27 offen
  s_add_u32 s27, s33, 671744
  buffer_load_dword v86, v21, s[8:11], s27 offen
  s_add_u32 s27, s33, 737280
  buffer_load_dword v87, v21, s[8:11], s27 offen
  s_waitcnt vmcnt(48)
  v_perm_b32 v120, v25, v24, s44
  v_perm_b32 v121, v27, v26, s44
  v_perm_b32 v122, v29, v28, s44
  v_perm_b32 v123, v31, v30, s44
  ds_write_b128 v1, v[120:123] offset:0
  s_waitcnt lgkmcnt(0)
  v_perm_b32 v124, v25, v24, s45
  v_perm_b32 v125, v27, v26, s45
  v_perm_b32 v126, v29, v28, s45
  v_perm_b32 v127, v31, v30, s45
  ds_write_b128 v1, v[124:127] offset:2048
  s_waitcnt lgkmcnt(0)
  v_perm_b32 v120, v33, v32, s44
  v_perm_b32 v121, v35, v34, s44
  v_perm_b32 v122, v37, v36, s44
  v_perm_b32 v123, v39, v38, s44
  ds_write_b128 v1, v[120:123] offset:1024
  s_waitcnt lgkmcnt(0)
  v_perm_b32 v124, v33, v32, s45
  v_perm_b32 v125, v35, v34, s45
  v_perm_b32 v126, v37, v36, s45
  v_perm_b32 v127, v39, v38, s45
  ds_write_b128 v1, v[124:127] offset:3072
  s_waitcnt lgkmcnt(0)
  s_add_u32 s27, s30, 2097152
  buffer_load_dword v88, v21, s[8:11], s27 offen
  s_add_u32 s27, s30, 2162688
  buffer_load_dword v89, v21, s[8:11], s27 offen
  s_add_u32 s27, s30, 2113536
  buffer_load_dword v90, v21, s[8:11], s27 offen
  s_add_u32 s27, s30, 2179072
  buffer_load_dword v91, v21, s[8:11], s27 offen
  s_add_u32 s27, s30, 2228224
  buffer_load_dword v92, v21, s[8:11], s27 offen
  s_add_u32 s27, s30, 2293760
  buffer_load_dword v93, v21, s[8:11], s27 offen
  s_add_u32 s27, s30, 2244608
  buffer_load_dword v94, v21, s[8:11], s27 offen
  s_add_u32 s27, s30, 2310144
  buffer_load_dword v95, v21, s[8:11], s27 offen
  s_add_u32 s27, s30, 2621440
  buffer_load_dword v96, v21, s[8:11], s27 offen
  s_add_u32 s27, s30, 2686976
  buffer_load_dword v97, v21, s[8:11], s27 offen
  s_add_u32 s27, s30, 2637824
  buffer_load_dword v98, v21, s[8:11], s27 offen
  s_add_u32 s27, s30, 2703360
  buffer_load_dword v99, v21, s[8:11], s27 offen
  s_add_u32 s27, s30, 2752512
  buffer_load_dword v100, v21, s[8:11], s27 offen
  s_add_u32 s27, s30, 2818048
  buffer_load_dword v101, v21, s[8:11], s27 offen
  s_add_u32 s27, s30, 2768896
  buffer_load_dword v102, v21, s[8:11], s27 offen
  s_add_u32 s27, s30, 2834432
  buffer_load_dword v103, v21, s[8:11], s27 offen
  s_waitcnt vmcnt(48)
  v_perm_b32 v120, v41, v40, s44
  v_perm_b32 v121, v43, v42, s44
  v_perm_b32 v122, v45, v44, s44
  v_perm_b32 v123, v47, v46, s44
  v_accvgpr_write_b32 a168, v120
  v_accvgpr_write_b32 a169, v121
  v_accvgpr_write_b32 a170, v122
  v_accvgpr_write_b32 a171, v123
  v_perm_b32 v124, v41, v40, s45
  v_perm_b32 v125, v43, v42, s45
  v_perm_b32 v126, v45, v44, s45
  v_perm_b32 v127, v47, v46, s45
  v_accvgpr_write_b32 a120, v124
  v_accvgpr_write_b32 a121, v125
  v_accvgpr_write_b32 a122, v126
  v_accvgpr_write_b32 a123, v127
  v_perm_b32 v120, v49, v48, s44
  v_perm_b32 v121, v51, v50, s44
  v_perm_b32 v122, v53, v52, s44
  v_perm_b32 v123, v55, v54, s44
  v_accvgpr_write_b32 a172, v120
  v_accvgpr_write_b32 a173, v121
  v_accvgpr_write_b32 a174, v122
  v_accvgpr_write_b32 a175, v123
  v_perm_b32 v124, v49, v48, s45
  v_perm_b32 v125, v51, v50, s45
  v_perm_b32 v126, v53, v52, s45
  v_perm_b32 v127, v55, v54, s45
  v_accvgpr_write_b32 a124, v124
  v_accvgpr_write_b32 a125, v125
  v_accvgpr_write_b32 a126, v126
  v_accvgpr_write_b32 a127, v127
  s_add_u32 s27, s31, 2097152
  buffer_load_dword v104, v21, s[8:11], s27 offen
  s_add_u32 s27, s31, 2162688
  buffer_load_dword v105, v21, s[8:11], s27 offen
  s_add_u32 s27, s31, 2113536
  buffer_load_dword v106, v21, s[8:11], s27 offen
  s_add_u32 s27, s31, 2179072
  buffer_load_dword v107, v21, s[8:11], s27 offen
  s_add_u32 s27, s31, 2228224
  buffer_load_dword v108, v21, s[8:11], s27 offen
  s_add_u32 s27, s31, 2293760
  buffer_load_dword v109, v21, s[8:11], s27 offen
  s_add_u32 s27, s31, 2244608
  buffer_load_dword v110, v21, s[8:11], s27 offen
  s_add_u32 s27, s31, 2310144
  buffer_load_dword v111, v21, s[8:11], s27 offen
  s_add_u32 s27, s31, 2621440
  buffer_load_dword v112, v21, s[8:11], s27 offen
  s_add_u32 s27, s31, 2686976
  buffer_load_dword v113, v21, s[8:11], s27 offen
  s_add_u32 s27, s31, 2637824
  buffer_load_dword v114, v21, s[8:11], s27 offen
  s_add_u32 s27, s31, 2703360
  buffer_load_dword v115, v21, s[8:11], s27 offen
  s_add_u32 s27, s31, 2752512
  buffer_load_dword v116, v21, s[8:11], s27 offen
  s_add_u32 s27, s31, 2818048
  buffer_load_dword v117, v21, s[8:11], s27 offen
  s_add_u32 s27, s31, 2768896
  buffer_load_dword v118, v21, s[8:11], s27 offen
  s_add_u32 s27, s31, 2834432
  buffer_load_dword v119, v21, s[8:11], s27 offen
  s_waitcnt vmcnt(48)
  v_perm_b32 v120, v57, v56, s44
  v_perm_b32 v121, v59, v58, s44
  v_perm_b32 v122, v61, v60, s44
  v_perm_b32 v123, v63, v62, s44
  v_accvgpr_write_b32 a160, v120
  v_accvgpr_write_b32 a161, v121
  v_accvgpr_write_b32 a162, v122
  v_accvgpr_write_b32 a163, v123
  v_perm_b32 v124, v57, v56, s45
  v_perm_b32 v125, v59, v58, s45
  v_perm_b32 v126, v61, v60, s45
  v_perm_b32 v127, v63, v62, s45
  v_accvgpr_write_b32 a112, v124
  v_accvgpr_write_b32 a113, v125
  v_accvgpr_write_b32 a114, v126
  v_accvgpr_write_b32 a115, v127
  v_perm_b32 v120, v65, v64, s44
  v_perm_b32 v121, v67, v66, s44
  v_perm_b32 v122, v69, v68, s44
  v_perm_b32 v123, v71, v70, s44
  v_accvgpr_write_b32 a164, v120
  v_accvgpr_write_b32 a165, v121
  v_accvgpr_write_b32 a166, v122
  v_accvgpr_write_b32 a167, v123
  v_perm_b32 v124, v65, v64, s45
  v_perm_b32 v125, v67, v66, s45
  v_perm_b32 v126, v69, v68, s45
  v_perm_b32 v127, v71, v70, s45
  v_accvgpr_write_b32 a116, v124
  v_accvgpr_write_b32 a117, v125
  v_accvgpr_write_b32 a118, v126
  v_accvgpr_write_b32 a119, v127
  s_add_u32 s27, s32, 2097152
  buffer_load_dword v24, v21, s[8:11], s27 offen
  s_add_u32 s27, s32, 2162688
  buffer_load_dword v25, v21, s[8:11], s27 offen
  s_add_u32 s27, s32, 2113536
  buffer_load_dword v26, v21, s[8:11], s27 offen
  s_add_u32 s27, s32, 2179072
  buffer_load_dword v27, v21, s[8:11], s27 offen
  s_add_u32 s27, s32, 2228224
  buffer_load_dword v28, v21, s[8:11], s27 offen
  s_add_u32 s27, s32, 2293760
  buffer_load_dword v29, v21, s[8:11], s27 offen
  s_add_u32 s27, s32, 2244608
  buffer_load_dword v30, v21, s[8:11], s27 offen
  s_add_u32 s27, s32, 2310144
  buffer_load_dword v31, v21, s[8:11], s27 offen
  s_add_u32 s27, s32, 2621440
  buffer_load_dword v32, v21, s[8:11], s27 offen
  s_add_u32 s27, s32, 2686976
  buffer_load_dword v33, v21, s[8:11], s27 offen
  s_add_u32 s27, s32, 2637824
  buffer_load_dword v34, v21, s[8:11], s27 offen
  s_add_u32 s27, s32, 2703360
  buffer_load_dword v35, v21, s[8:11], s27 offen
  s_add_u32 s27, s32, 2752512
  buffer_load_dword v36, v21, s[8:11], s27 offen
  s_add_u32 s27, s32, 2818048
  buffer_load_dword v37, v21, s[8:11], s27 offen
  s_add_u32 s27, s32, 2768896
  buffer_load_dword v38, v21, s[8:11], s27 offen
  s_add_u32 s27, s32, 2834432
  buffer_load_dword v39, v21, s[8:11], s27 offen
  s_waitcnt vmcnt(48)
  v_perm_b32 v120, v73, v72, s44
  v_perm_b32 v121, v75, v74, s44
  v_perm_b32 v122, v77, v76, s44
  v_perm_b32 v123, v79, v78, s44
  v_accvgpr_write_b32 a152, v120
  v_accvgpr_write_b32 a153, v121
  v_accvgpr_write_b32 a154, v122
  v_accvgpr_write_b32 a155, v123
  v_perm_b32 v124, v73, v72, s45
  v_perm_b32 v125, v75, v74, s45
  v_perm_b32 v126, v77, v76, s45
  v_perm_b32 v127, v79, v78, s45
  v_accvgpr_write_b32 a104, v124
  v_accvgpr_write_b32 a105, v125
  v_accvgpr_write_b32 a106, v126
  v_accvgpr_write_b32 a107, v127
  v_perm_b32 v120, v81, v80, s44
  v_perm_b32 v121, v83, v82, s44
  v_perm_b32 v122, v85, v84, s44
  v_perm_b32 v123, v87, v86, s44
  v_accvgpr_write_b32 a156, v120
  v_accvgpr_write_b32 a157, v121
  v_accvgpr_write_b32 a158, v122
  v_accvgpr_write_b32 a159, v123
  v_perm_b32 v124, v81, v80, s45
  v_perm_b32 v125, v83, v82, s45
  v_perm_b32 v126, v85, v84, s45
  v_perm_b32 v127, v87, v86, s45
  v_accvgpr_write_b32 a108, v124
  v_accvgpr_write_b32 a109, v125
  v_accvgpr_write_b32 a110, v126
  v_accvgpr_write_b32 a111, v127
  s_add_u32 s27, s33, 2097152
  buffer_load_dword v40, v21, s[8:11], s27 offen
  s_add_u32 s27, s33, 2162688
  buffer_load_dword v41, v21, s[8:11], s27 offen
  s_add_u32 s27, s33, 2113536
  buffer_load_dword v42, v21, s[8:11], s27 offen
  s_add_u32 s27, s33, 2179072
  buffer_load_dword v43, v21, s[8:11], s27 offen
  s_add_u32 s27, s33, 2228224
  buffer_load_dword v44, v21, s[8:11], s27 offen
  s_add_u32 s27, s33, 2293760
  buffer_load_dword v45, v21, s[8:11], s27 offen
  s_add_u32 s27, s33, 2244608
  buffer_load_dword v46, v21, s[8:11], s27 offen
  s_add_u32 s27, s33, 2310144
  buffer_load_dword v47, v21, s[8:11], s27 offen
  s_add_u32 s27, s33, 2621440
  buffer_load_dword v48, v21, s[8:11], s27 offen
  s_add_u32 s27, s33, 2686976
  buffer_load_dword v49, v21, s[8:11], s27 offen
  s_add_u32 s27, s33, 2637824
  buffer_load_dword v50, v21, s[8:11], s27 offen
  s_add_u32 s27, s33, 2703360
  buffer_load_dword v51, v21, s[8:11], s27 offen
  s_add_u32 s27, s33, 2752512
  buffer_load_dword v52, v21, s[8:11], s27 offen
  s_add_u32 s27, s33, 2818048
  buffer_load_dword v53, v21, s[8:11], s27 offen
  s_add_u32 s27, s33, 2768896
  buffer_load_dword v54, v21, s[8:11], s27 offen
  s_add_u32 s27, s33, 2834432
  buffer_load_dword v55, v21, s[8:11], s27 offen
  s_waitcnt vmcnt(48)
  v_perm_b32 v120, v89, v88, s44
  v_perm_b32 v121, v91, v90, s44
  v_perm_b32 v122, v93, v92, s44
  v_perm_b32 v123, v95, v94, s44
  ds_write_b128 v1, v[120:123] offset:8192
  s_waitcnt lgkmcnt(0)
  v_perm_b32 v124, v89, v88, s45
  v_perm_b32 v125, v91, v90, s45
  v_perm_b32 v126, v93, v92, s45
  v_perm_b32 v127, v95, v94, s45
  ds_write_b128 v1, v[124:127] offset:10240
  s_waitcnt lgkmcnt(0)
  v_perm_b32 v120, v97, v96, s44
  v_perm_b32 v121, v99, v98, s44
  v_perm_b32 v122, v101, v100, s44
  v_perm_b32 v123, v103, v102, s44
  ds_write_b128 v1, v[120:123] offset:9216
  s_waitcnt lgkmcnt(0)
  v_perm_b32 v124, v97, v96, s45
  v_perm_b32 v125, v99, v98, s45
  v_perm_b32 v126, v101, v100, s45
  v_perm_b32 v127, v103, v102, s45
  ds_write_b128 v1, v[124:127] offset:11264
  s_waitcnt lgkmcnt(0)
  s_load_dwordx2 s[8:9], s[0:1], 24
  s_waitcnt lgkmcnt(0)
  s_add_u32 s27, s30, 0
  buffer_load_dword v56, v21, s[8:11], s27 offen
  s_add_u32 s27, s30, 65536
  buffer_load_dword v57, v21, s[8:11], s27 offen
  s_add_u32 s27, s30, 16384
  buffer_load_dword v58, v21, s[8:11], s27 offen
  s_add_u32 s27, s30, 81920
  buffer_load_dword v59, v21, s[8:11], s27 offen
  s_add_u32 s27, s30, 131072
  buffer_load_dword v60, v21, s[8:11], s27 offen
  s_add_u32 s27, s30, 196608
  buffer_load_dword v61, v21, s[8:11], s27 offen
  s_add_u32 s27, s30, 147456
  buffer_load_dword v62, v21, s[8:11], s27 offen
  s_add_u32 s27, s30, 212992
  buffer_load_dword v63, v21, s[8:11], s27 offen
  s_add_u32 s27, s30, 524288
  buffer_load_dword v64, v21, s[8:11], s27 offen
  s_add_u32 s27, s30, 589824
  buffer_load_dword v65, v21, s[8:11], s27 offen
  s_add_u32 s27, s30, 540672
  buffer_load_dword v66, v21, s[8:11], s27 offen
  s_add_u32 s27, s30, 606208
  buffer_load_dword v67, v21, s[8:11], s27 offen
  s_add_u32 s27, s30, 655360
  buffer_load_dword v68, v21, s[8:11], s27 offen
  s_add_u32 s27, s30, 720896
  buffer_load_dword v69, v21, s[8:11], s27 offen
  s_add_u32 s27, s30, 671744
  buffer_load_dword v70, v21, s[8:11], s27 offen
  s_add_u32 s27, s30, 737280
  buffer_load_dword v71, v21, s[8:11], s27 offen
  s_waitcnt vmcnt(48)
  v_perm_b32 v120, v105, v104, s44
  v_perm_b32 v121, v107, v106, s44
  v_perm_b32 v122, v109, v108, s44
  v_perm_b32 v123, v111, v110, s44
  v_accvgpr_write_b32 a144, v120
  v_accvgpr_write_b32 a145, v121
  v_accvgpr_write_b32 a146, v122
  v_accvgpr_write_b32 a147, v123
  v_perm_b32 v124, v105, v104, s45
  v_perm_b32 v125, v107, v106, s45
  v_perm_b32 v126, v109, v108, s45
  v_perm_b32 v127, v111, v110, s45
  v_accvgpr_write_b32 a96, v124
  v_accvgpr_write_b32 a97, v125
  v_accvgpr_write_b32 a98, v126
  v_accvgpr_write_b32 a99, v127
  v_perm_b32 v120, v113, v112, s44
  v_perm_b32 v121, v115, v114, s44
  v_perm_b32 v122, v117, v116, s44
  v_perm_b32 v123, v119, v118, s44
  v_accvgpr_write_b32 a148, v120
  v_accvgpr_write_b32 a149, v121
  v_accvgpr_write_b32 a150, v122
  v_accvgpr_write_b32 a151, v123
  v_perm_b32 v124, v113, v112, s45
  v_perm_b32 v125, v115, v114, s45
  v_perm_b32 v126, v117, v116, s45
  v_perm_b32 v127, v119, v118, s45
  v_accvgpr_write_b32 a100, v124
  v_accvgpr_write_b32 a101, v125
  v_accvgpr_write_b32 a102, v126
  v_accvgpr_write_b32 a103, v127
  s_add_u32 s27, s31, 0
  buffer_load_dword v72, v21, s[8:11], s27 offen
  s_add_u32 s27, s31, 65536
  buffer_load_dword v73, v21, s[8:11], s27 offen
  s_add_u32 s27, s31, 16384
  buffer_load_dword v74, v21, s[8:11], s27 offen
  s_add_u32 s27, s31, 81920
  buffer_load_dword v75, v21, s[8:11], s27 offen
  s_add_u32 s27, s31, 131072
  buffer_load_dword v76, v21, s[8:11], s27 offen
  s_add_u32 s27, s31, 196608
  buffer_load_dword v77, v21, s[8:11], s27 offen
  s_add_u32 s27, s31, 147456
  buffer_load_dword v78, v21, s[8:11], s27 offen
  s_add_u32 s27, s31, 212992
  buffer_load_dword v79, v21, s[8:11], s27 offen
  s_add_u32 s27, s31, 524288
  buffer_load_dword v80, v21, s[8:11], s27 offen
  s_add_u32 s27, s31, 589824
  buffer_load_dword v81, v21, s[8:11], s27 offen
  s_add_u32 s27, s31, 540672
  buffer_load_dword v82, v21, s[8:11], s27 offen
  s_add_u32 s27, s31, 606208
  buffer_load_dword v83, v21, s[8:11], s27 offen
  s_add_u32 s27, s31, 655360
  buffer_load_dword v84, v21, s[8:11], s27 offen
  s_add_u32 s27, s31, 720896
  buffer_load_dword v85, v21, s[8:11], s27 offen
  s_add_u32 s27, s31, 671744
  buffer_load_dword v86, v21, s[8:11], s27 offen
  s_add_u32 s27, s31, 737280
  buffer_load_dword v87, v21, s[8:11], s27 offen
  s_waitcnt vmcnt(48)
  v_perm_b32 v120, v25, v24, s44
  v_perm_b32 v121, v27, v26, s44
  v_perm_b32 v122, v29, v28, s44
  v_perm_b32 v123, v31, v30, s44
  v_accvgpr_write_b32 a136, v120
  v_accvgpr_write_b32 a137, v121
  v_accvgpr_write_b32 a138, v122
  v_accvgpr_write_b32 a139, v123
  v_perm_b32 v124, v25, v24, s45
  v_perm_b32 v125, v27, v26, s45
  v_perm_b32 v126, v29, v28, s45
  v_perm_b32 v127, v31, v30, s45
  v_accvgpr_write_b32 a88, v124
  v_accvgpr_write_b32 a89, v125
  v_accvgpr_write_b32 a90, v126
  v_accvgpr_write_b32 a91, v127
  v_perm_b32 v120, v33, v32, s44
  v_perm_b32 v121, v35, v34, s44
  v_perm_b32 v122, v37, v36, s44
  v_perm_b32 v123, v39, v38, s44
  v_accvgpr_write_b32 a140, v120
  v_accvgpr_write_b32 a141, v121
  v_accvgpr_write_b32 a142, v122
  v_accvgpr_write_b32 a143, v123
  v_perm_b32 v124, v33, v32, s45
  v_perm_b32 v125, v35, v34, s45
  v_perm_b32 v126, v37, v36, s45
  v_perm_b32 v127, v39, v38, s45
  v_accvgpr_write_b32 a92, v124
  v_accvgpr_write_b32 a93, v125
  v_accvgpr_write_b32 a94, v126
  v_accvgpr_write_b32 a95, v127
  s_add_u32 s27, s32, 0
  buffer_load_dword v88, v21, s[8:11], s27 offen
  s_add_u32 s27, s32, 65536
  buffer_load_dword v89, v21, s[8:11], s27 offen
  s_add_u32 s27, s32, 16384
  buffer_load_dword v90, v21, s[8:11], s27 offen
  s_add_u32 s27, s32, 81920
  buffer_load_dword v91, v21, s[8:11], s27 offen
  s_add_u32 s27, s32, 131072
  buffer_load_dword v92, v21, s[8:11], s27 offen
  s_add_u32 s27, s32, 196608
  buffer_load_dword v93, v21, s[8:11], s27 offen
  s_add_u32 s27, s32, 147456
  buffer_load_dword v94, v21, s[8:11], s27 offen
  s_add_u32 s27, s32, 212992
  buffer_load_dword v95, v21, s[8:11], s27 offen
  s_add_u32 s27, s32, 524288
  buffer_load_dword v96, v21, s[8:11], s27 offen
  s_add_u32 s27, s32, 589824
  buffer_load_dword v97, v21, s[8:11], s27 offen
  s_add_u32 s27, s32, 540672
  buffer_load_dword v98, v21, s[8:11], s27 offen
  s_add_u32 s27, s32, 606208
  buffer_load_dword v99, v21, s[8:11], s27 offen
  s_add_u32 s27, s32, 655360
  buffer_load_dword v100, v21, s[8:11], s27 offen
  s_add_u32 s27, s32, 720896
  buffer_load_dword v101, v21, s[8:11], s27 offen
  s_add_u32 s27, s32, 671744
  buffer_load_dword v102, v21, s[8:11], s27 offen
  s_add_u32 s27, s32, 737280
  buffer_load_dword v103, v21, s[8:11], s27 offen
  s_waitcnt vmcnt(48)
  v_perm_b32 v120, v41, v40, s44
  v_perm_b32 v121, v43, v42, s44
  v_perm_b32 v122, v45, v44, s44
  v_perm_b32 v123, v47, v46, s44
  v_accvgpr_write_b32 a128, v120
  v_accvgpr_write_b32 a129, v121
  v_accvgpr_write_b32 a130, v122
  v_accvgpr_write_b32 a131, v123
  v_perm_b32 v124, v41, v40, s45
  v_perm_b32 v125, v43, v42, s45
  v_perm_b32 v126, v45, v44, s45
  v_perm_b32 v127, v47, v46, s45
  v_accvgpr_write_b32 a80, v124
  v_accvgpr_write_b32 a81, v125
  v_accvgpr_write_b32 a82, v126
  v_accvgpr_write_b32 a83, v127
  v_perm_b32 v120, v49, v48, s44
  v_perm_b32 v121, v51, v50, s44
  v_perm_b32 v122, v53, v52, s44
  v_perm_b32 v123, v55, v54, s44
  v_accvgpr_write_b32 a132, v120
  v_accvgpr_write_b32 a133, v121
  v_accvgpr_write_b32 a134, v122
  v_accvgpr_write_b32 a135, v123
  v_perm_b32 v124, v49, v48, s45
  v_perm_b32 v125, v51, v50, s45
  v_perm_b32 v126, v53, v52, s45
  v_perm_b32 v127, v55, v54, s45
  v_accvgpr_write_b32 a84, v124
  v_accvgpr_write_b32 a85, v125
  v_accvgpr_write_b32 a86, v126
  v_accvgpr_write_b32 a87, v127
  s_add_u32 s27, s33, 0
  buffer_load_dword v104, v21, s[8:11], s27 offen
  s_add_u32 s27, s33, 65536
  buffer_load_dword v105, v21, s[8:11], s27 offen
  s_add_u32 s27, s33, 16384
  buffer_load_dword v106, v21, s[8:11], s27 offen
  s_add_u32 s27, s33, 81920
  buffer_load_dword v107, v21, s[8:11], s27 offen
  s_add_u32 s27, s33, 131072
  buffer_load_dword v108, v21, s[8:11], s27 offen
  s_add_u32 s27, s33, 196608
  buffer_load_dword v109, v21, s[8:11], s27 offen
  s_add_u32 s27, s33, 147456
  buffer_load_dword v110, v21, s[8:11], s27 offen
  s_add_u32 s27, s33, 212992
  buffer_load_dword v111, v21, s[8:11], s27 offen
  s_add_u32 s27, s33, 524288
  buffer_load_dword v112, v21, s[8:11], s27 offen
  s_add_u32 s27, s33, 589824
  buffer_load_dword v113, v21, s[8:11], s27 offen
  s_add_u32 s27, s33, 540672
  buffer_load_dword v114, v21, s[8:11], s27 offen
  s_add_u32 s27, s33, 606208
  buffer_load_dword v115, v21, s[8:11], s27 offen
  s_add_u32 s27, s33, 655360
  buffer_load_dword v116, v21, s[8:11], s27 offen
  s_add_u32 s27, s33, 720896
  buffer_load_dword v117, v21, s[8:11], s27 offen
  s_add_u32 s27, s33, 671744
  buffer_load_dword v118, v21, s[8:11], s27 offen
  s_add_u32 s27, s33, 737280
  buffer_load_dword v119, v21, s[8:11], s27 offen
  s_waitcnt vmcnt(48)
  v_perm_b32 v120, v57, v56, s44
  v_perm_b32 v121, v59, v58, s44
  v_perm_b32 v122, v61, v60, s44
  v_perm_b32 v123, v63, v62, s44
  ds_write_b128 v1, v[120:123] offset:4096
  s_waitcnt lgkmcnt(0)
  v_perm_b32 v124, v57, v56, s45
  v_perm_b32 v125, v59, v58, s45
  v_perm_b32 v126, v61, v60, s45
  v_perm_b32 v127, v63, v62, s45
  ds_write_b128 v1, v[124:127] offset:6144
  s_waitcnt lgkmcnt(0)
  v_perm_b32 v120, v65, v64, s44
  v_perm_b32 v121, v67, v66, s44
  v_perm_b32 v122, v69, v68, s44
  v_perm_b32 v123, v71, v70, s44
  ds_write_b128 v1, v[120:123] offset:5120
  s_waitcnt lgkmcnt(0)
  v_perm_b32 v124, v65, v64, s45
  v_perm_b32 v125, v67, v66, s45
  v_perm_b32 v126, v69, v68, s45
  v_perm_b32 v127, v71, v70, s45
  ds_write_b128 v1, v[124:127] offset:7168
  s_waitcnt lgkmcnt(0)
  s_add_u32 s27, s30, 2097152
  buffer_load_dword v24, v21, s[8:11], s27 offen
  s_add_u32 s27, s30, 2162688
  buffer_load_dword v25, v21, s[8:11], s27 offen
  s_add_u32 s27, s30, 2113536
  buffer_load_dword v26, v21, s[8:11], s27 offen
  s_add_u32 s27, s30, 2179072
  buffer_load_dword v27, v21, s[8:11], s27 offen
  s_add_u32 s27, s30, 2228224
  buffer_load_dword v28, v21, s[8:11], s27 offen
  s_add_u32 s27, s30, 2293760
  buffer_load_dword v29, v21, s[8:11], s27 offen
  s_add_u32 s27, s30, 2244608
  buffer_load_dword v30, v21, s[8:11], s27 offen
  s_add_u32 s27, s30, 2310144
  buffer_load_dword v31, v21, s[8:11], s27 offen
  s_add_u32 s27, s30, 2621440
  buffer_load_dword v32, v21, s[8:11], s27 offen
  s_add_u32 s27, s30, 2686976
  buffer_load_dword v33, v21, s[8:11], s27 offen
  s_add_u32 s27, s30, 2637824
  buffer_load_dword v34, v21, s[8:11], s27 offen
  s_add_u32 s27, s30, 2703360
  buffer_load_dword v35, v21, s[8:11], s27 offen
  s_add_u32 s27, s30, 2752512
  buffer_load_dword v36, v21, s[8:11], s27 offen
  s_add_u32 s27, s30, 2818048
  buffer_load_dword v37, v21, s[8:11], s27 offen
  s_add_u32 s27, s30, 2768896
  buffer_load_dword v38, v21, s[8:11], s27 offen
  s_add_u32 s27, s30, 2834432
  buffer_load_dword v39, v21, s[8:11], s27 offen
  s_waitcnt vmcnt(48)
  v_perm_b32 v120, v73, v72, s44
  v_perm_b32 v121, v75, v74, s44
  v_perm_b32 v122, v77, v76, s44
  v_perm_b32 v123, v79, v78, s44
  v_accvgpr_write_b32 a72, v120
  v_accvgpr_write_b32 a73, v121
  v_accvgpr_write_b32 a74, v122
  v_accvgpr_write_b32 a75, v123
  v_perm_b32 v124, v73, v72, s45
  v_perm_b32 v125, v75, v74, s45
  v_perm_b32 v126, v77, v76, s45
  v_perm_b32 v127, v79, v78, s45
  v_accvgpr_write_b32 a24, v124
  v_accvgpr_write_b32 a25, v125
  v_accvgpr_write_b32 a26, v126
  v_accvgpr_write_b32 a27, v127
  v_perm_b32 v120, v81, v80, s44
  v_perm_b32 v121, v83, v82, s44
  v_perm_b32 v122, v85, v84, s44
  v_perm_b32 v123, v87, v86, s44
  v_accvgpr_write_b32 a76, v120
  v_accvgpr_write_b32 a77, v121
  v_accvgpr_write_b32 a78, v122
  v_accvgpr_write_b32 a79, v123
  v_perm_b32 v124, v81, v80, s45
  v_perm_b32 v125, v83, v82, s45
  v_perm_b32 v126, v85, v84, s45
  v_perm_b32 v127, v87, v86, s45
  v_accvgpr_write_b32 a28, v124
  v_accvgpr_write_b32 a29, v125
  v_accvgpr_write_b32 a30, v126
  v_accvgpr_write_b32 a31, v127
  s_add_u32 s27, s31, 2097152
  buffer_load_dword v40, v21, s[8:11], s27 offen
  s_add_u32 s27, s31, 2162688
  buffer_load_dword v41, v21, s[8:11], s27 offen
  s_add_u32 s27, s31, 2113536
  buffer_load_dword v42, v21, s[8:11], s27 offen
  s_add_u32 s27, s31, 2179072
  buffer_load_dword v43, v21, s[8:11], s27 offen
  s_add_u32 s27, s31, 2228224
  buffer_load_dword v44, v21, s[8:11], s27 offen
  s_add_u32 s27, s31, 2293760
  buffer_load_dword v45, v21, s[8:11], s27 offen
  s_add_u32 s27, s31, 2244608
  buffer_load_dword v46, v21, s[8:11], s27 offen
  s_add_u32 s27, s31, 2310144
  buffer_load_dword v47, v21, s[8:11], s27 offen
  s_add_u32 s27, s31, 2621440
  buffer_load_dword v48, v21, s[8:11], s27 offen
  s_add_u32 s27, s31, 2686976
  buffer_load_dword v49, v21, s[8:11], s27 offen
  s_add_u32 s27, s31, 2637824
  buffer_load_dword v50, v21, s[8:11], s27 offen
  s_add_u32 s27, s31, 2703360
  buffer_load_dword v51, v21, s[8:11], s27 offen
  s_add_u32 s27, s31, 2752512
  buffer_load_dword v52, v21, s[8:11], s27 offen
  s_add_u32 s27, s31, 2818048
  buffer_load_dword v53, v21, s[8:11], s27 offen
  s_add_u32 s27, s31, 2768896
  buffer_load_dword v54, v21, s[8:11], s27 offen
  s_add_u32 s27, s31, 2834432
  buffer_load_dword v55, v21, s[8:11], s27 offen
  s_waitcnt vmcnt(48)
  v_perm_b32 v120, v89, v88, s44
  v_perm_b32 v121, v91, v90, s44
  v_perm_b32 v122, v93, v92, s44
  v_perm_b32 v123, v95, v94, s44
  v_accvgpr_write_b32 a64, v120
  v_accvgpr_write_b32 a65, v121
  v_accvgpr_write_b32 a66, v122
  v_accvgpr_write_b32 a67, v123
  v_perm_b32 v124, v89, v88, s45
  v_perm_b32 v125, v91, v90, s45
  v_perm_b32 v126, v93, v92, s45
  v_perm_b32 v127, v95, v94, s45
  v_accvgpr_write_b32 a16, v124
  v_accvgpr_write_b32 a17, v125
  v_accvgpr_write_b32 a18, v126
  v_accvgpr_write_b32 a19, v127
  v_perm_b32 v120, v97, v96, s44
  v_perm_b32 v121, v99, v98, s44
  v_perm_b32 v122, v101, v100, s44
  v_perm_b32 v123, v103, v102, s44
  v_accvgpr_write_b32 a68, v120
  v_accvgpr_write_b32 a69, v121
  v_accvgpr_write_b32 a70, v122
  v_accvgpr_write_b32 a71, v123
  v_perm_b32 v124, v97, v96, s45
  v_perm_b32 v125, v99, v98, s45
  v_perm_b32 v126, v101, v100, s45
  v_perm_b32 v127, v103, v102, s45
  v_accvgpr_write_b32 a20, v124
  v_accvgpr_write_b32 a21, v125
  v_accvgpr_write_b32 a22, v126
  v_accvgpr_write_b32 a23, v127
  s_add_u32 s27, s32, 2097152
  buffer_load_dword v56, v21, s[8:11], s27 offen
  s_add_u32 s27, s32, 2162688
  buffer_load_dword v57, v21, s[8:11], s27 offen
  s_add_u32 s27, s32, 2113536
  buffer_load_dword v58, v21, s[8:11], s27 offen
  s_add_u32 s27, s32, 2179072
  buffer_load_dword v59, v21, s[8:11], s27 offen
  s_add_u32 s27, s32, 2228224
  buffer_load_dword v60, v21, s[8:11], s27 offen
  s_add_u32 s27, s32, 2293760
  buffer_load_dword v61, v21, s[8:11], s27 offen
  s_add_u32 s27, s32, 2244608
  buffer_load_dword v62, v21, s[8:11], s27 offen
  s_add_u32 s27, s32, 2310144
  buffer_load_dword v63, v21, s[8:11], s27 offen
  s_add_u32 s27, s32, 2621440
  buffer_load_dword v64, v21, s[8:11], s27 offen
  s_add_u32 s27, s32, 2686976
  buffer_load_dword v65, v21, s[8:11], s27 offen
  s_add_u32 s27, s32, 2637824
  buffer_load_dword v66, v21, s[8:11], s27 offen
  s_add_u32 s27, s32, 2703360
  buffer_load_dword v67, v21, s[8:11], s27 offen
  s_add_u32 s27, s32, 2752512
  buffer_load_dword v68, v21, s[8:11], s27 offen
  s_add_u32 s27, s32, 2818048
  buffer_load_dword v69, v21, s[8:11], s27 offen
  s_add_u32 s27, s32, 2768896
  buffer_load_dword v70, v21, s[8:11], s27 offen
  s_add_u32 s27, s32, 2834432
  buffer_load_dword v71, v21, s[8:11], s27 offen
  s_waitcnt vmcnt(48)
  v_perm_b32 v120, v105, v104, s44
  v_perm_b32 v121, v107, v106, s44
  v_perm_b32 v122, v109, v108, s44
  v_perm_b32 v123, v111, v110, s44
  v_accvgpr_write_b32 a56, v120
  v_accvgpr_write_b32 a57, v121
  v_accvgpr_write_b32 a58, v122
  v_accvgpr_write_b32 a59, v123
  v_perm_b32 v124, v105, v104, s45
  v_perm_b32 v125, v107, v106, s45
  v_perm_b32 v126, v109, v108, s45
  v_perm_b32 v127, v111, v110, s45
  v_accvgpr_write_b32 a8, v124
  v_accvgpr_write_b32 a9, v125
  v_accvgpr_write_b32 a10, v126
  v_accvgpr_write_b32 a11, v127
  v_perm_b32 v120, v113, v112, s44
  v_perm_b32 v121, v115, v114, s44
  v_perm_b32 v122, v117, v116, s44
  v_perm_b32 v123, v119, v118, s44
  v_accvgpr_write_b32 a60, v120
  v_accvgpr_write_b32 a61, v121
  v_accvgpr_write_b32 a62, v122
  v_accvgpr_write_b32 a63, v123
  v_perm_b32 v124, v113, v112, s45
  v_perm_b32 v125, v115, v114, s45
  v_perm_b32 v126, v117, v116, s45
  v_perm_b32 v127, v119, v118, s45
  v_accvgpr_write_b32 a12, v124
  v_accvgpr_write_b32 a13, v125
  v_accvgpr_write_b32 a14, v126
  v_accvgpr_write_b32 a15, v127
  s_add_u32 s27, s33, 2097152
  buffer_load_dword v72, v21, s[8:11], s27 offen
  s_add_u32 s27, s33, 2162688
  buffer_load_dword v73, v21, s[8:11], s27 offen
  s_add_u32 s27, s33, 2113536
  buffer_load_dword v74, v21, s[8:11], s27 offen
  s_add_u32 s27, s33, 2179072
  buffer_load_dword v75, v21, s[8:11], s27 offen
  s_add_u32 s27, s33, 2228224
  buffer_load_dword v76, v21, s[8:11], s27 offen
  s_add_u32 s27, s33, 2293760
  buffer_load_dword v77, v21, s[8:11], s27 offen
  s_add_u32 s27, s33, 2244608
  buffer_load_dword v78, v21, s[8:11], s27 offen
  s_add_u32 s27, s33, 2310144
  buffer_load_dword v79, v21, s[8:11], s27 offen
  s_add_u32 s27, s33, 2621440
  buffer_load_dword v80, v21, s[8:11], s27 offen
  s_add_u32 s27, s33, 2686976
  buffer_load_dword v81, v21, s[8:11], s27 offen
  s_add_u32 s27, s33, 2637824
  buffer_load_dword v82, v21, s[8:11], s27 offen
  s_add_u32 s27, s33, 2703360
  buffer_load_dword v83, v21, s[8:11], s27 offen
  s_add_u32 s27, s33, 2752512
  buffer_load_dword v84, v21, s[8:11], s27 offen
  s_add_u32 s27, s33, 2818048
  buffer_load_dword v85, v21, s[8:11], s27 offen
  s_add_u32 s27, s33, 2768896
  buffer_load_dword v86, v21, s[8:11], s27 offen
  s_add_u32 s27, s33, 2834432
  buffer_load_dword v87, v21, s[8:11], s27 offen
  s_waitcnt vmcnt(48)
  v_perm_b32 v120, v25, v24, s44
  v_perm_b32 v121, v27, v26, s44
  v_perm_b32 v122, v29, v28, s44
  v_perm_b32 v123, v31, v30, s44
  ds_write_b128 v1, v[120:123] offset:12288
  s_waitcnt lgkmcnt(0)
  v_perm_b32 v124, v25, v24, s45
  v_perm_b32 v125, v27, v26, s45
  v_perm_b32 v126, v29, v28, s45
  v_perm_b32 v127, v31, v30, s45
  ds_write_b128 v1, v[124:127] offset:14336
  s_waitcnt lgkmcnt(0)
  v_perm_b32 v120, v33, v32, s44
  v_perm_b32 v121, v35, v34, s44
  v_perm_b32 v122, v37, v36, s44
  v_perm_b32 v123, v39, v38, s44
  ds_write_b128 v1, v[120:123] offset:13312
  s_waitcnt lgkmcnt(0)
  v_perm_b32 v124, v33, v32, s45
  v_perm_b32 v125, v35, v34, s45
  v_perm_b32 v126, v37, v36, s45
  v_perm_b32 v127, v39, v38, s45
  ds_write_b128 v1, v[124:127] offset:15360
  s_waitcnt lgkmcnt(0)
  s_load_dwordx2 s[8:9], s[0:1], 32
  s_waitcnt lgkmcnt(0)
  s_add_u32 s27, s30, 0
  buffer_load_dword v88, v21, s[8:11], s27 offen
  s_add_u32 s27, s30, 65536
  buffer_load_dword v89, v21, s[8:11], s27 offen
  s_add_u32 s27, s30, 16384
  buffer_load_dword v90, v21, s[8:11], s27 offen
  s_add_u32 s27, s30, 81920
  buffer_load_dword v91, v21, s[8:11], s27 offen
  s_add_u32 s27, s30, 131072
  buffer_load_dword v92, v21, s[8:11], s27 offen
  s_add_u32 s27, s30, 196608
  buffer_load_dword v93, v21, s[8:11], s27 offen
  s_add_u32 s27, s30, 147456
  buffer_load_dword v94, v21, s[8:11], s27 offen
  s_add_u32 s27, s30, 212992
  buffer_load_dword v95, v21, s[8:11], s27 offen
  s_add_u32 s27, s30, 524288
  buffer_load_dword v96, v21, s[8:11], s27 offen
  s_add_u32 s27, s30, 589824
  buffer_load_dword v97, v21, s[8:11], s27 offen
  s_add_u32 s27, s30, 540672
  buffer_load_dword v98, v21, s[8:11], s27 offen
  s_add_u32 s27, s30, 606208
  buffer_load_dword v99, v21, s[8:11], s27 offen
  s_add_u32 s27, s30, 655360
  buffer_load_dword v100, v21, s[8:11], s27 offen
  s_add_u32 s27, s30, 720896
  buffer_load_dword v101, v21, s[8:11], s27 offen
  s_add_u32 s27, s30, 671744
  buffer_load_dword v102, v21, s[8:11], s27 offen
  s_add_u32 s27, s30, 737280
  buffer_load_dword v103, v21, s[8:11], s27 offen
  s_waitcnt vmcnt(48)
  v_perm_b32 v120, v41, v40, s44
  v_perm_b32 v121, v43, v42, s44
  v_perm_b32 v122, v45, v44, s44
  v_perm_b32 v123, v47, v46, s44
  v_accvgpr_write_b32 a48, v120
  v_accvgpr_write_b32 a49, v121
  v_accvgpr_write_b32 a50, v122
  v_accvgpr_write_b32 a51, v123
  v_perm_b32 v124, v41, v40, s45
  v_perm_b32 v125, v43, v42, s45
  v_perm_b32 v126, v45, v44, s45
  v_perm_b32 v127, v47, v46, s45
  v_accvgpr_write_b32 a0, v124
  v_accvgpr_write_b32 a1, v125
  v_accvgpr_write_b32 a2, v126
  v_accvgpr_write_b32 a3, v127
  v_perm_b32 v120, v49, v48, s44
  v_perm_b32 v121, v51, v50, s44
  v_perm_b32 v122, v53, v52, s44
  v_perm_b32 v123, v55, v54, s44
  v_accvgpr_write_b32 a52, v120
  v_accvgpr_write_b32 a53, v121
  v_accvgpr_write_b32 a54, v122
  v_accvgpr_write_b32 a55, v123
  v_perm_b32 v124, v49, v48, s45
  v_perm_b32 v125, v51, v50, s45
  v_perm_b32 v126, v53, v52, s45
  v_perm_b32 v127, v55, v54, s45
  v_accvgpr_write_b32 a4, v124
  v_accvgpr_write_b32 a5, v125
  v_accvgpr_write_b32 a6, v126
  v_accvgpr_write_b32 a7, v127
  s_add_u32 s27, s31, 0
  buffer_load_dword v104, v21, s[8:11], s27 offen
  s_add_u32 s27, s31, 65536
  buffer_load_dword v105, v21, s[8:11], s27 offen
  s_add_u32 s27, s31, 16384
  buffer_load_dword v106, v21, s[8:11], s27 offen
  s_add_u32 s27, s31, 81920
  buffer_load_dword v107, v21, s[8:11], s27 offen
  s_add_u32 s27, s31, 131072
  buffer_load_dword v108, v21, s[8:11], s27 offen
  s_add_u32 s27, s31, 196608
  buffer_load_dword v109, v21, s[8:11], s27 offen
  s_add_u32 s27, s31, 147456
  buffer_load_dword v110, v21, s[8:11], s27 offen
  s_add_u32 s27, s31, 212992
  buffer_load_dword v111, v21, s[8:11], s27 offen
  s_add_u32 s27, s31, 524288
  buffer_load_dword v112, v21, s[8:11], s27 offen
  s_add_u32 s27, s31, 589824
  buffer_load_dword v113, v21, s[8:11], s27 offen
  s_add_u32 s27, s31, 540672
  buffer_load_dword v114, v21, s[8:11], s27 offen
  s_add_u32 s27, s31, 606208
  buffer_load_dword v115, v21, s[8:11], s27 offen
  s_add_u32 s27, s31, 655360
  buffer_load_dword v116, v21, s[8:11], s27 offen
  s_add_u32 s27, s31, 720896
  buffer_load_dword v117, v21, s[8:11], s27 offen
  s_add_u32 s27, s31, 671744
  buffer_load_dword v118, v21, s[8:11], s27 offen
  s_add_u32 s27, s31, 737280
  buffer_load_dword v119, v21, s[8:11], s27 offen
  s_waitcnt vmcnt(48)
  v_perm_b32 v120, v57, v56, s44
  v_perm_b32 v121, v59, v58, s44
  v_perm_b32 v122, v61, v60, s44
  v_perm_b32 v123, v63, v62, s44
  v_accvgpr_write_b32 a40, v120
  v_accvgpr_write_b32 a41, v121
  v_accvgpr_write_b32 a42, v122
  v_accvgpr_write_b32 a43, v123
  v_perm_b32 v248, v57, v56, s45
  v_perm_b32 v249, v59, v58, s45
  v_perm_b32 v250, v61, v60, s45
  v_perm_b32 v251, v63, v62, s45
  v_perm_b32 v120, v65, v64, s44
  v_perm_b32 v121, v67, v66, s44
  v_perm_b32 v122, v69, v68, s44
  v_perm_b32 v123, v71, v70, s44
  v_accvgpr_write_b32 a44, v120
  v_accvgpr_write_b32 a45, v121
  v_accvgpr_write_b32 a46, v122
  v_accvgpr_write_b32 a47, v123
  v_perm_b32 v252, v65, v64, s45
  v_perm_b32 v253, v67, v66, s45
  v_perm_b32 v254, v69, v68, s45
  v_perm_b32 v255, v71, v70, s45
  s_add_u32 s27, s32, 0
  buffer_load_dword v24, v21, s[8:11], s27 offen
  s_add_u32 s27, s32, 65536
  buffer_load_dword v25, v21, s[8:11], s27 offen
  s_add_u32 s27, s32, 16384
  buffer_load_dword v26, v21, s[8:11], s27 offen
  s_add_u32 s27, s32, 81920
  buffer_load_dword v27, v21, s[8:11], s27 offen
  s_add_u32 s27, s32, 131072
  buffer_load_dword v28, v21, s[8:11], s27 offen
  s_add_u32 s27, s32, 196608
  buffer_load_dword v29, v21, s[8:11], s27 offen
  s_add_u32 s27, s32, 147456
  buffer_load_dword v30, v21, s[8:11], s27 offen
  s_add_u32 s27, s32, 212992
  buffer_load_dword v31, v21, s[8:11], s27 offen
  s_add_u32 s27, s32, 524288
  buffer_load_dword v32, v21, s[8:11], s27 offen
  s_add_u32 s27, s32, 589824
  buffer_load_dword v33, v21, s[8:11], s27 offen
  s_add_u32 s27, s32, 540672
  buffer_load_dword v34, v21, s[8:11], s27 offen
  s_add_u32 s27, s32, 606208
  buffer_load_dword v35, v21, s[8:11], s27 offen
  s_add_u32 s27, s32, 655360
  buffer_load_dword v36, v21, s[8:11], s27 offen
  s_add_u32 s27, s32, 720896
  buffer_load_dword v37, v21, s[8:11], s27 offen
  s_add_u32 s27, s32, 671744
  buffer_load_dword v38, v21, s[8:11], s27 offen
  s_add_u32 s27, s32, 737280
  buffer_load_dword v39, v21, s[8:11], s27 offen
  s_waitcnt vmcnt(48)
  v_perm_b32 v120, v73, v72, s44
  v_perm_b32 v121, v75, v74, s44
  v_perm_b32 v122, v77, v76, s44
  v_perm_b32 v123, v79, v78, s44
  v_accvgpr_write_b32 a32, v120
  v_accvgpr_write_b32 a33, v121
  v_accvgpr_write_b32 a34, v122
  v_accvgpr_write_b32 a35, v123
  v_perm_b32 v240, v73, v72, s45
  v_perm_b32 v241, v75, v74, s45
  v_perm_b32 v242, v77, v76, s45
  v_perm_b32 v243, v79, v78, s45
  v_perm_b32 v120, v81, v80, s44
  v_perm_b32 v121, v83, v82, s44
  v_perm_b32 v122, v85, v84, s44
  v_perm_b32 v123, v87, v86, s44
  v_accvgpr_write_b32 a36, v120
  v_accvgpr_write_b32 a37, v121
  v_accvgpr_write_b32 a38, v122
  v_accvgpr_write_b32 a39, v123
  v_perm_b32 v244, v81, v80, s45
  v_perm_b32 v245, v83, v82, s45
  v_perm_b32 v246, v85, v84, s45
  v_perm_b32 v247, v87, v86, s45
  s_add_u32 s27, s33, 0
  buffer_load_dword v40, v21, s[8:11], s27 offen
  s_add_u32 s27, s33, 65536
  buffer_load_dword v41, v21, s[8:11], s27 offen
  s_add_u32 s27, s33, 16384
  buffer_load_dword v42, v21, s[8:11], s27 offen
  s_add_u32 s27, s33, 81920
  buffer_load_dword v43, v21, s[8:11], s27 offen
  s_add_u32 s27, s33, 131072
  buffer_load_dword v44, v21, s[8:11], s27 offen
  s_add_u32 s27, s33, 196608
  buffer_load_dword v45, v21, s[8:11], s27 offen
  s_add_u32 s27, s33, 147456
  buffer_load_dword v46, v21, s[8:11], s27 offen
  s_add_u32 s27, s33, 212992
  buffer_load_dword v47, v21, s[8:11], s27 offen
  s_add_u32 s27, s33, 524288
  buffer_load_dword v48, v21, s[8:11], s27 offen
  s_add_u32 s27, s33, 589824
  buffer_load_dword v49, v21, s[8:11], s27 offen
  s_add_u32 s27, s33, 540672
  buffer_load_dword v50, v21, s[8:11], s27 offen
  s_add_u32 s27, s33, 606208
  buffer_load_dword v51, v21, s[8:11], s27 offen
  s_add_u32 s27, s33, 655360
  buffer_load_dword v52, v21, s[8:11], s27 offen
  s_add_u32 s27, s33, 720896
  buffer_load_dword v53, v21, s[8:11], s27 offen
  s_add_u32 s27, s33, 671744
  buffer_load_dword v54, v21, s[8:11], s27 offen
  s_add_u32 s27, s33, 737280
  buffer_load_dword v55, v21, s[8:11], s27 offen
  s_waitcnt vmcnt(48)
  v_perm_b32 v120, v89, v88, s44
  v_perm_b32 v121, v91, v90, s44
  v_perm_b32 v122, v93, v92, s44
  v_perm_b32 v123, v95, v94, s44
  ds_write_b128 v1, v[120:123] offset:16384
  s_waitcnt lgkmcnt(0)
  v_perm_b32 v124, v89, v88, s45
  v_perm_b32 v125, v91, v90, s45
  v_perm_b32 v126, v93, v92, s45
  v_perm_b32 v127, v95, v94, s45
  ds_write_b128 v1, v[124:127] offset:18432
  s_waitcnt lgkmcnt(0)
  v_perm_b32 v120, v97, v96, s44
  v_perm_b32 v121, v99, v98, s44
  v_perm_b32 v122, v101, v100, s44
  v_perm_b32 v123, v103, v102, s44
  ds_write_b128 v1, v[120:123] offset:17408
  s_waitcnt lgkmcnt(0)
  v_perm_b32 v124, v97, v96, s45
  v_perm_b32 v125, v99, v98, s45
  v_perm_b32 v126, v101, v100, s45
  v_perm_b32 v127, v103, v102, s45
  ds_write_b128 v1, v[124:127] offset:19456
  s_waitcnt lgkmcnt(0)
  s_add_u32 s27, s30, 2097152
  buffer_load_dword v56, v21, s[8:11], s27 offen
  s_add_u32 s27, s30, 2162688
  buffer_load_dword v57, v21, s[8:11], s27 offen
  s_add_u32 s27, s30, 2113536
  buffer_load_dword v58, v21, s[8:11], s27 offen
  s_add_u32 s27, s30, 2179072
  buffer_load_dword v59, v21, s[8:11], s27 offen
  s_add_u32 s27, s30, 2228224
  buffer_load_dword v60, v21, s[8:11], s27 offen
  s_add_u32 s27, s30, 2293760
  buffer_load_dword v61, v21, s[8:11], s27 offen
  s_add_u32 s27, s30, 2244608
  buffer_load_dword v62, v21, s[8:11], s27 offen
  s_add_u32 s27, s30, 2310144
  buffer_load_dword v63, v21, s[8:11], s27 offen
  s_add_u32 s27, s30, 2621440
  buffer_load_dword v64, v21, s[8:11], s27 offen
  s_add_u32 s27, s30, 2686976
  buffer_load_dword v65, v21, s[8:11], s27 offen
  s_add_u32 s27, s30, 2637824
  buffer_load_dword v66, v21, s[8:11], s27 offen
  s_add_u32 s27, s30, 2703360
  buffer_load_dword v67, v21, s[8:11], s27 offen
  s_add_u32 s27, s30, 2752512
  buffer_load_dword v68, v21, s[8:11], s27 offen
  s_add_u32 s27, s30, 2818048
  buffer_load_dword v69, v21, s[8:11], s27 offen
  s_add_u32 s27, s30, 2768896
  buffer_load_dword v70, v21, s[8:11], s27 offen
  s_add_u32 s27, s30, 2834432
  buffer_load_dword v71, v21, s[8:11], s27 offen
  s_waitcnt vmcnt(48)
  v_perm_b32 v232, v105, v104, s44
  v_perm_b32 v233, v107, v106, s44
  v_perm_b32 v234, v109, v108, s44
  v_perm_b32 v235, v111, v110, s44
  v_perm_b32 v176, v105, v104, s45
  v_perm_b32 v177, v107, v106, s45
  v_perm_b32 v178, v109, v108, s45
  v_perm_b32 v179, v111, v110, s45
  v_perm_b32 v236, v113, v112, s44
  v_perm_b32 v237, v115, v114, s44
  v_perm_b32 v238, v117, v116, s44
  v_perm_b32 v239, v119, v118, s44
  v_perm_b32 v180, v113, v112, s45
  v_perm_b32 v181, v115, v114, s45
  v_perm_b32 v182, v117, v116, s45
  v_perm_b32 v183, v119, v118, s45
  s_add_u32 s27, s31, 2097152
  buffer_load_dword v72, v21, s[8:11], s27 offen
  s_add_u32 s27, s31, 2162688
  buffer_load_dword v73, v21, s[8:11], s27 offen
  s_add_u32 s27, s31, 2113536
  buffer_load_dword v74, v21, s[8:11], s27 offen
  s_add_u32 s27, s31, 2179072
  buffer_load_dword v75, v21, s[8:11], s27 offen
  s_add_u32 s27, s31, 2228224
  buffer_load_dword v76, v21, s[8:11], s27 offen
  s_add_u32 s27, s31, 2293760
  buffer_load_dword v77, v21, s[8:11], s27 offen
  s_add_u32 s27, s31, 2244608
  buffer_load_dword v78, v21, s[8:11], s27 offen
  s_add_u32 s27, s31, 2310144
  buffer_load_dword v79, v21, s[8:11], s27 offen
  s_add_u32 s27, s31, 2621440
  buffer_load_dword v80, v21, s[8:11], s27 offen
  s_add_u32 s27, s31, 2686976
  buffer_load_dword v81, v21, s[8:11], s27 offen
  s_add_u32 s27, s31, 2637824
  buffer_load_dword v82, v21, s[8:11], s27 offen
  s_add_u32 s27, s31, 2703360
  buffer_load_dword v83, v21, s[8:11], s27 offen
  s_add_u32 s27, s31, 2752512
  buffer_load_dword v84, v21, s[8:11], s27 offen
  s_add_u32 s27, s31, 2818048
  buffer_load_dword v85, v21, s[8:11], s27 offen
  s_add_u32 s27, s31, 2768896
  buffer_load_dword v86, v21, s[8:11], s27 offen
  s_add_u32 s27, s31, 2834432
  buffer_load_dword v87, v21, s[8:11], s27 offen
  s_waitcnt vmcnt(48)
  v_perm_b32 v224, v25, v24, s44
  v_perm_b32 v225, v27, v26, s44
  v_perm_b32 v226, v29, v28, s44
  v_perm_b32 v227, v31, v30, s44
  v_perm_b32 v168, v25, v24, s45
  v_perm_b32 v169, v27, v26, s45
  v_perm_b32 v170, v29, v28, s45
  v_perm_b32 v171, v31, v30, s45
  v_perm_b32 v228, v33, v32, s44
  v_perm_b32 v229, v35, v34, s44
  v_perm_b32 v230, v37, v36, s44
  v_perm_b32 v231, v39, v38, s44
  v_perm_b32 v172, v33, v32, s45
  v_perm_b32 v173, v35, v34, s45
  v_perm_b32 v174, v37, v36, s45
  v_perm_b32 v175, v39, v38, s45
  s_add_u32 s27, s32, 2097152
  buffer_load_dword v88, v21, s[8:11], s27 offen
  s_add_u32 s27, s32, 2162688
  buffer_load_dword v89, v21, s[8:11], s27 offen
  s_add_u32 s27, s32, 2113536
  buffer_load_dword v90, v21, s[8:11], s27 offen
  s_add_u32 s27, s32, 2179072
  buffer_load_dword v91, v21, s[8:11], s27 offen
  s_add_u32 s27, s32, 2228224
  buffer_load_dword v92, v21, s[8:11], s27 offen
  s_add_u32 s27, s32, 2293760
  buffer_load_dword v93, v21, s[8:11], s27 offen
  s_add_u32 s27, s32, 2244608
  buffer_load_dword v94, v21, s[8:11], s27 offen
  s_add_u32 s27, s32, 2310144
  buffer_load_dword v95, v21, s[8:11], s27 offen
  s_add_u32 s27, s32, 2621440
  buffer_load_dword v96, v21, s[8:11], s27 offen
  s_add_u32 s27, s32, 2686976
  buffer_load_dword v97, v21, s[8:11], s27 offen
  s_add_u32 s27, s32, 2637824
  buffer_load_dword v98, v21, s[8:11], s27 offen
  s_add_u32 s27, s32, 2703360
  buffer_load_dword v99, v21, s[8:11], s27 offen
  s_add_u32 s27, s32, 2752512
  buffer_load_dword v100, v21, s[8:11], s27 offen
  s_add_u32 s27, s32, 2818048
  buffer_load_dword v101, v21, s[8:11], s27 offen
  s_add_u32 s27, s32, 2768896
  buffer_load_dword v102, v21, s[8:11], s27 offen
  s_add_u32 s27, s32, 2834432
  buffer_load_dword v103, v21, s[8:11], s27 offen
  s_waitcnt vmcnt(48)
  v_perm_b32 v216, v41, v40, s44
  v_perm_b32 v217, v43, v42, s44
  v_perm_b32 v218, v45, v44, s44
  v_perm_b32 v219, v47, v46, s44
  v_perm_b32 v160, v41, v40, s45
  v_perm_b32 v161, v43, v42, s45
  v_perm_b32 v162, v45, v44, s45
  v_perm_b32 v163, v47, v46, s45
  v_perm_b32 v220, v49, v48, s44
  v_perm_b32 v221, v51, v50, s44
  v_perm_b32 v222, v53, v52, s44
  v_perm_b32 v223, v55, v54, s44
  v_perm_b32 v164, v49, v48, s45
  v_perm_b32 v165, v51, v50, s45
  v_perm_b32 v166, v53, v52, s45
  v_perm_b32 v167, v55, v54, s45
  s_add_u32 s27, s33, 2097152
  buffer_load_dword v104, v21, s[8:11], s27 offen
  s_add_u32 s27, s33, 2162688
  buffer_load_dword v105, v21, s[8:11], s27 offen
  s_add_u32 s27, s33, 2113536
  buffer_load_dword v106, v21, s[8:11], s27 offen
  s_add_u32 s27, s33, 2179072
  buffer_load_dword v107, v21, s[8:11], s27 offen
  s_add_u32 s27, s33, 2228224
  buffer_load_dword v108, v21, s[8:11], s27 offen
  s_add_u32 s27, s33, 2293760
  buffer_load_dword v109, v21, s[8:11], s27 offen
  s_add_u32 s27, s33, 2244608
  buffer_load_dword v110, v21, s[8:11], s27 offen
  s_add_u32 s27, s33, 2310144
  buffer_load_dword v111, v21, s[8:11], s27 offen
  s_add_u32 s27, s33, 2621440
  buffer_load_dword v112, v21, s[8:11], s27 offen
  s_add_u32 s27, s33, 2686976
  buffer_load_dword v113, v21, s[8:11], s27 offen
  s_add_u32 s27, s33, 2637824
  buffer_load_dword v114, v21, s[8:11], s27 offen
  s_add_u32 s27, s33, 2703360
  buffer_load_dword v115, v21, s[8:11], s27 offen
  s_add_u32 s27, s33, 2752512
  buffer_load_dword v116, v21, s[8:11], s27 offen
  s_add_u32 s27, s33, 2818048
  buffer_load_dword v117, v21, s[8:11], s27 offen
  s_add_u32 s27, s33, 2768896
  buffer_load_dword v118, v21, s[8:11], s27 offen
  s_add_u32 s27, s33, 2834432
  buffer_load_dword v119, v21, s[8:11], s27 offen
  s_waitcnt vmcnt(48)
  v_perm_b32 v208, v57, v56, s44
  v_perm_b32 v209, v59, v58, s44
  v_perm_b32 v210, v61, v60, s44
  v_perm_b32 v211, v63, v62, s44
  v_perm_b32 v152, v57, v56, s45
  v_perm_b32 v153, v59, v58, s45
  v_perm_b32 v154, v61, v60, s45
  v_perm_b32 v155, v63, v62, s45
  v_perm_b32 v212, v65, v64, s44
  v_perm_b32 v213, v67, v66, s44
  v_perm_b32 v214, v69, v68, s44
  v_perm_b32 v215, v71, v70, s44
  v_perm_b32 v156, v65, v64, s45
  v_perm_b32 v157, v67, v66, s45
  v_perm_b32 v158, v69, v68, s45
  v_perm_b32 v159, v71, v70, s45
  s_waitcnt vmcnt(32)
  v_perm_b32 v200, v73, v72, s44
  v_perm_b32 v201, v75, v74, s44
  v_perm_b32 v202, v77, v76, s44
  v_perm_b32 v203, v79, v78, s44
  v_perm_b32 v144, v73, v72, s45
  v_perm_b32 v145, v75, v74, s45
  v_perm_b32 v146, v77, v76, s45
  v_perm_b32 v147, v79, v78, s45
  v_perm_b32 v204, v81, v80, s44
  v_perm_b32 v205, v83, v82, s44
  v_perm_b32 v206, v85, v84, s44
  v_perm_b32 v207, v87, v86, s44
  v_perm_b32 v148, v81, v80, s45
  v_perm_b32 v149, v83, v82, s45
  v_perm_b32 v150, v85, v84, s45
  v_perm_b32 v151, v87, v86, s45
  s_waitcnt vmcnt(16)
  v_perm_b32 v192, v89, v88, s44
  v_perm_b32 v193, v91, v90, s44
  v_perm_b32 v194, v93, v92, s44
  v_perm_b32 v195, v95, v94, s44
  v_perm_b32 v136, v89, v88, s45
  v_perm_b32 v137, v91, v90, s45
  v_perm_b32 v138, v93, v92, s45
  v_perm_b32 v139, v95, v94, s45
  v_perm_b32 v196, v97, v96, s44
  v_perm_b32 v197, v99, v98, s44
  v_perm_b32 v198, v101, v100, s44
  v_perm_b32 v199, v103, v102, s44
  v_perm_b32 v140, v97, v96, s45
  v_perm_b32 v141, v99, v98, s45
  v_perm_b32 v142, v101, v100, s45
  v_perm_b32 v143, v103, v102, s45
  s_waitcnt vmcnt(0)
  v_perm_b32 v184, v105, v104, s44
  v_perm_b32 v185, v107, v106, s44
  v_perm_b32 v186, v109, v108, s44
  v_perm_b32 v187, v111, v110, s44
  v_perm_b32 v128, v105, v104, s45
  v_perm_b32 v129, v107, v106, s45
  v_perm_b32 v130, v109, v108, s45
  v_perm_b32 v131, v111, v110, s45
  v_perm_b32 v188, v113, v112, s44
  v_perm_b32 v189, v115, v114, s44
  v_perm_b32 v190, v117, v116, s44
  v_perm_b32 v191, v119, v118, s44
  v_perm_b32 v132, v113, v112, s45
  v_perm_b32 v133, v115, v114, s45
  v_perm_b32 v134, v117, v116, s45
  v_perm_b32 v135, v119, v118, s45
  s_mov_b32 s26, 0
  v_mov_b32 v20, s38
g_wc_2:
  global_load_dword v21, v20, s[12:13] sc1
  s_add_u32 s26, s26, 1
  s_cmp_gt_u32 s26, 1048576
  s_cbranch_scc1 L_end
  s_waitcnt vmcnt(0)
  v_readfirstlane_b32 s27, v21
  s_cmp_lt_u32 s27, 32
  s_cbranch_scc1 g_wc_2
  s_mov_b32 s26, 0
  v_mov_b32 v20, 160
g_wc_3:
  global_load_dword v21, v20, s[12:13] sc1
  s_add_u32 s26, s26, 1
  s_cmp_gt_u32 s26, 1048576
  s_cbranch_scc1 L_end
  s_waitcnt vmcnt(0)
  v_readfirstlane_b32 s27, v21
  s_cmp_lt_u32 s27, 64
  s_cbranch_scc1 g_wc_3
  s_mov_b32 s26, 0
g_pu_4:
  v_and_b32 v20, 0x70, v0
  global_load_dword v21, v20, s[12:13] sc1
  s_waitcnt vmcnt(0)
  v_readlane_b32 s28, v21, 0
  v_readlane_b32 s29, v21, 1
  v_readlane_b32 s30, v21, 2
  v_readlane_b32 s31, v21, 3
  v_readlane_b32 s32, v21, 4
  v_readlane_b32 s33, v21, 5
  v_readlane_b32 s34, v21, 6
  v_readlane_b32 s35, v21, 7
  s_add_u32 s27, s28, s29
  s_add_u32 s27, s27, s30
  s_add_u32 s27, s27, s31
  s_add_u32 s27, s27, s32
  s_add_u32 s27, s27, s33
  s_add_u32 s27, s27, s34
  s_add_u32 s27, s27, s35
  v_readlane_b32 s36, v21, s91
  s_cmp_ge_u32 s36, 32
  s_cbranch_scc1 g_pure_5
  s_cmp_ge_u32 s27, 256
  s_cbranch_scc1 L_chain_x
  s_add_u32 s26, s26, 1
  s_cmp_gt_u32 s26, 1048576
  s_cbranch_scc1 L_end
  s_branch g_pu_4
g_pure_5:
  s_mov_b32 s22, 0
  s_mov_b32 s42, s62
  s_add_u32 s43, s62, 4096
  s_mov_b32 s46, 0
  s_mov_b32 s47, 0
  s_lshl_b32 s26, s16, 2
  s_add_u32 s26, s26, s17
  s_lshl_b32 s27, s60, 13
  s_add_u32 s27, s27, s26
  s_lshl_b32 s25, s27, 11
  s_add_u32 s25, s25, 117440512
  s_lshl_b32 s64, s60, 14
  s_add_u32 s64, s64, s26
  s_lshl_b32 s64, s64, 2
  s_add_u32 s64, s64, 5447168
  s_lshl_b32 s27, s61, 13
  s_add_u32 s27, s27, s26
  s_lshl_b32 s23, s27, 12
  s_add_u32 s23, s23, 16777216
  s_lshl_b32 s63, s27, 2
  s_add_u32 s63, s63, 5308416
  s_mov_b32 s29, 0
c_kvw_14:
  s_buffer_load_dword s65, s[4:7], s63 glc
  s_add_u32 s29, s29, 1
  s_cmp_gt_u32 s29, 1048576
  s_cbranch_scc1 c_fail_12
  s_waitcnt lgkmcnt(0)
  s_cmp_eq_u32 s65, 0
  s_cbranch_scc1 c_kvw_14
  buffer_load_dwordx4 v0, s[4:7], s23 offen offset:0  lds
  buffer_load_dwordx4 v0, s[4:7], s23 offen offset:1024  lds
  buffer_load_dwordx4 v0, s[4:7], s23 offen offset:2048  lds
  buffer_load_dwordx4 v0, s[4:7], s23 offen offset:3072  lds
  s_add_u32 s23, s23, 524288
  s_add_u32 s63, s63, 512
  s_mov_b32 s65, 0
  ds_read_b128 v[72:75], v1 offset:6144
  ds_read_b128 v[76:79], v1 offset:7168
  ds_read_b128 v[80:83], v1 offset:8192
  ds_read_b128 v[84:87], v1 offset:9216
  ds_read_b128 v[88:91], v1 offset:10240
  ds_read_b128 v[92:95], v1 offset:11264
  ds_read_b128 v[96:99], v1 offset:12288
  ds_read_b128 v[100:103], v1 offset:13312
  ds_read_b128 v[104:107], v1 offset:14336
  ds_read_b128 v[108:111], v1 offset:15360
  ds_read_b128 v[112:115], v1 offset:16384
  ds_read_b128 v[116:119], v1 offset:17408
  ds_read_b128 v[120:123], v1 offset:18432
  ds_read_b128 v[124:127], v1 offset:19456
  v_mov_b64 v[48:49], 0
  v_mov_b64 v[50:51], 0
  v_mov_b64 v[52:53], 0
  v_mov_b64 v[54:55], 0
  v_mov_b64 v[56:57], 0
  v_mov_b64 v[58:59], 0
  v_mov_b64 v[60:61], 0
  v_mov_b64 v[62:63], 0
  v_mov_b64 v[64:65], 0
  v_mov_b64 v[66:67], 0
  v_mov_b64 v[68:69], 0
  v_mov_b64 v[70:71], 0
  s_lshl_b32 s38, s16, 13
  s_add_u32 s38, s38, s40
  s_add_u32 s39, s38, 4096
  ds_read_b128 v[24:27], v1 offset:0
  ds_read_b128 v[28:31], v1 offset:1024
  ds_read_b128 v[32:35], v1 offset:2048
  ds_read_b128 v[36:39], v1 offset:3072
  ds_read_b128 v[40:43], v1 offset:4096
  ds_read_b128 v[44:47], v1 offset:5120
  s_waitcnt lgkmcnt(0)
c_loop_6:
  buffer_load_dwordx4 v[16:19], v8, s[4:7], s42 offen sc1
  buffer_load_dwordx4 v[20:23], v8, s[4:7], s43 offen sc1
  s_mov_b32 s28, 0
  s_cmp_eq_u32 s17, 0
  s_cbranch_scc1 c_w0a_15
  s_nop 15
  s_nop 8
  buffer_load_dwordx4 v[16:19], v8, s[4:7], s42 offen sc1
  buffer_load_dwordx4 v[20:23], v8, s[4:7], s43 offen sc1
  s_nop 15
  s_nop 8
  buffer_load_dwordx4 v[16:19], v8, s[4:7], s42 offen sc1
  buffer_load_dwordx4 v[20:23], v8, s[4:7], s43 offen sc1
c_w0b_16:
  s_waitcnt lgkmcnt(0)
  s_waitcnt vmcnt(5)
  v_max3_u32 v7, v16, v17, v18
  v_max_u32 v7, v7, v19
  ds_write_b128 v8, v[16:19] offset:0
  v_smfmac_f32_16x16x64_bf16 v[48:51], v[16:19], v[24:31], v6
  s_waitcnt vmcnt(4)
c_got_8:
  v_max3_u32 v7, v20, v21, v7
  v_max3_u32 v7, v22, v23, v7
  ds_write_b128 v8, v[20:23] offset:4096
  v_smfmac_f32_16x16x64_bf16 v[52:55], v[16:19], v[32:39], v6
  v_cmp_eq_u32 vcc, -1, v7
  v_smfmac_f32_16x16x64_bf16 v[56:59], v[16:19], v[40:47], v6
  s_cbranch_vccnz c_retry_7
  v_smfmac_f32_16x16x64_bf16 v[60:63], v[16:19], v[72:79], v6
  s_cmp_eq_u32 s65, 0
  s_cbranch_scc1 c_kvs_17
c_kvr_18:
  v_smfmac_f32_16x16x64_bf16 v[48:51], v[20:23], v[80:87], v6
  v_mov_b32 v7, 1
  v_smfmac_f32_16x16x64_bf16 v[52:55], v[20:23], v[88:95], v6
  v_smfmac_f32_16x16x64_bf16 v[56:59], v[20:23], v[96:103], v6
  s_waitcnt lgkmcnt(0)
  s_barrier
  ds_read_b128 v[24:27], v9 offset:0
  ds_read_b128 v[28:31], v10 offset:0
  v_smfmac_f32_16x16x64_bf16 v[60:63], v[20:23], v[104:111], v6
  ds_read_b128 v[32:35], v11 offset:0
  v_smfmac_f32_16x16x64_bf16 v[64:67], v[16:19], v[112:119], v6
  ds_read_b128 v[36:39], v9 offset:4096
  v_smfmac_f32_16x16x64_bf16 v[68:71], v[16:19], v[120:127], v6
  ds_read_b128 v[40:43], v10 offset:4096
  v_smfmac_f32_16x16x64_bf16 v[64:67], v[20:23], v[208:215], v6
  ds_read_b128 v[44:47], v11 offset:4096
  s_waitcnt lgkmcnt(5)
  v_smfmac_f32_16x16x64_bf16 v[48:51], v[24:27], a[168:175], v6
  ds_read_b128 v[72:75], v1 offset:32768
  s_waitcnt lgkmcnt(5)
  v_smfmac_f32_16x16x64_bf16 v[48:51], v[28:31], a[160:167], v6
  ds_read_b128 v[76:79], v1 offset:33792
  s_waitcnt lgkmcnt(5)
  v_smfmac_f32_16x16x64_bf16 v[48:51], v[32:35], a[152:159], v6
  ds_read_b128 v[80:83], v1 offset:34816
  s_waitcnt lgkmcnt(5)
  v_smfmac_f32_16x16x64_bf16 v[48:51], v[36:39], a[144:151], v6
  ds_read_b128 v[84:87], v1 offset:35840
  s_waitcnt lgkmcnt(5)
  v_smfmac_f32_16x16x64_bf16 v[48:51], v[40:43], a[136:143], v6
  ds_read_b128 v[104:107], v1 offset:20480
  s_waitcnt lgkmcnt(5)
  v_smfmac_f32_16x16x64_bf16 v[48:51], v[44:47], a[128:135], v6
  ds_read_b128 v[108:111], v1 offset:21504
  v_smfmac_f32_16x16x64_bf16 v[52:55], v[24:27], a[120:127], v6
  s_waitcnt lgkmcnt(5)
  buffer_load_dwordx4 v0, s[4:7], s23 offen offset:0  lds
  s_mov_b64 exec, 1
  buffer_store_dword v7, off, s[4:7], s64 sc1
  s_mov_b64 exec, -1
  v_smfmac_f32_16x16x64_bf16 v[52:55], v[28:31], a[112:119], v6
  s_waitcnt lgkmcnt(2)
  s_nop 0
  v_smfmac_f32_16x16x64_bf16 v[52:55], v[32:35], a[104:111], v6
  v_add_f32 v48, v48, v50
  v_smfmac_f32_16x16x64_bf16 v[52:55], v[36:39], a[96:103], v6
  v_add_f32 v49, v49, v51
  v_smfmac_f32_16x16x64_bf16 v[52:55], v[40:43], a[88:95], v6
  v_cvt_pk_bf16_f32 v50, v48, v49
  v_smfmac_f32_16x16x64_bf16 v[52:55], v[44:47], a[80:87], v6
  v_cvt_pk_bf16_f32 v51, v48, v49
  v_smfmac_f32_16x16x64_bf16 v[56:59], v[24:27], a[72:79], v6
  ds_write_b64 v2, v[50:51] offset:8192
  v_smfmac_f32_16x16x64_bf16 v[56:59], v[28:31], a[64:71], v6
  ds_read_b64_tr_b16 v[88:89], v12 offset:8192
  s_nop 0
  v_smfmac_f32_16x16x64_bf16 v[56:59], v[32:35], a[56:63], v6
  s_nop 0
  v_add_f32 v52, v52, v54
  v_add_f32 v53, v53, v55
  v_cvt_pk_bf16_f32 v54, v52, v53
  v_cvt_pk_bf16_f32 v55, v52, v53
  ds_write_b64 v2, v[54:55] offset:8704
  v_smfmac_f32_16x16x64_bf16 v[56:59], v[36:39], a[48:55], v6
  ds_read_b64_tr_b16 v[90:91], v12 offset:8704
  v_smfmac_f32_16x16x64_bf16 v[56:59], v[40:43], a[40:47], v6
  buffer_load_dwordx4 v0, s[4:7], s23 offen offset:1024  lds
  v_smfmac_f32_16x16x64_bf16 v[56:59], v[44:47], a[32:39], v6
  ds_read_b128 v[112:115], v1 offset:22528
  v_smfmac_f32_16x16x64_bf16 v[60:63], v[24:27], a[24:31], v6
  buffer_load_dwordx4 v0, s[4:7], s23 offen offset:2048  lds
  v_smfmac_f32_16x16x64_bf16 v[60:63], v[28:31], a[16:23], v6
  s_waitcnt lgkmcnt(1)
  v_mfma_f32_16x16x32_bf16 v[92:95], v[72:75], v[88:91], 0
  buffer_load_dwordx4 v0, s[4:7], s23 offen offset:3072  lds
  v_mfma_f32_16x16x32_bf16 v[96:99], v[76:79], v[88:91], 0
  v_add_f32 v56, v56, v58
  v_add_f32 v57, v57, v59
  v_smfmac_f32_16x16x64_bf16 v[60:63], v[32:35], a[8:15], v6
  v_cvt_pk_bf16_f32 v58, v56, v57
  v_smfmac_f32_16x16x64_bf16 v[60:63], v[36:39], a[0:7], v6
  ds_write_b32 v2, v58 offset:8192
  v_smfmac_f32_16x16x64_bf16 v[60:63], v[40:43], v[248:255], v6
  s_nop 0
  v_cndmask_b32 v48, v92, v96, s[18:19]
  v_smfmac_f32_16x16x64_bf16 v[60:63], v[44:47], v[240:247], v6
  v_cndmask_b32 v49, v93, v97, s[18:19]
  v_cndmask_b32 v50, v94, v98, s[18:19]
  v_cndmask_b32 v51, v95, v99, s[18:19]
  ds_write_b128 v8, v[48:51] offset:12288
  v_smfmac_f32_16x16x64_bf16 v[68:71], v[20:23], v[152:159], v6
  s_nop 1
  s_nop 0
  v_add_f32 v60, v60, v62
  v_add_f32 v61, v61, v63
  v_cvt_pk_bf16_f32 v62, v60, v61
  ds_write_b32 v2, v62 offset:8704
  v_smfmac_f32_16x16x64_bf16 v[64:67], v[24:27], v[232:239], v6
  v_mov_b32 v76, 0
  v_smfmac_f32_16x16x64_bf16 v[64:67], v[28:31], v[224:231], v6
  v_mov_b32 v79, 0
  s_waitcnt vmcnt(5)
  v_smfmac_f32_16x16x64_bf16 v[64:67], v[32:35], v[216:223], v6
  ds_read_b128 v[116:119], v1 offset:23552
  v_smfmac_f32_16x16x64_bf16 v[64:67], v[36:39], v[200:207], v6
  s_waitcnt lgkmcnt(1)
  s_barrier
  ds_read_b128 v[52:55], v9 offset:12288
  ds_read_b128 v[56:59], v10 offset:12288
  v_smfmac_f32_16x16x64_bf16 v[64:67], v[40:43], v[192:199], v6
  ds_read_b128 v[60:63], v11 offset:12288
  v_smfmac_f32_16x16x64_bf16 v[64:67], v[44:47], v[184:191], v6
  ds_read_b64_tr_b16 v[88:89], v12 offset:8192
  ds_read_b64_tr_b16 v[90:91], v12 offset:8704
  v_smfmac_f32_16x16x64_bf16 v[68:71], v[24:27], v[176:183], v6
  ds_read_b64_tr_b16 v[92:93], v13 offset:8192
  ds_read_b64_tr_b16 v[94:95], v13 offset:8704
  v_smfmac_f32_16x16x64_bf16 v[68:71], v[28:31], v[168:175], v6
  ds_read_b64_tr_b16 v[96:97], v14 offset:8192
  ds_read_b64_tr_b16 v[98:99], v14 offset:8704
  v_smfmac_f32_16x16x64_bf16 v[68:71], v[32:35], v[160:167], v6
  ds_read_b64_tr_b16 v[100:101], v15 offset:8192
  ds_read_b64_tr_b16 v[102:103], v15 offset:8704
  s_waitcnt lgkmcnt(8)
  v_smfmac_f32_16x16x64_bf16 v[68:71], v[36:39], v[144:151], v6
  v_add_f32 v48, v48, v52
  v_smfmac_f32_16x16x64_bf16 v[68:71], v[40:43], v[136:143], v6
  v_add_f32 v49, v49, v53
  v_smfmac_f32_16x16x64_bf16 v[68:71], v[44:47], v[128:135], v6
  v_add_f32 v50, v50, v54
  s_waitcnt lgkmcnt(4)
  v_mfma_f32_16x16x32_bf16 v[16:19], v[88:91], v[88:91], 0
  v_add_f32 v51, v51, v55
  v_add_f32 v56, v56, v60
  v_mfma_f32_16x16x32_bf16 v[16:19], v[92:95], v[92:95], v[16:19]
  v_add_f32 v57, v57, v61
  s_waitcnt lgkmcnt(0)
  v_add_f32 v58, v58, v62
  v_mfma_f32_16x16x32_bf16 v[16:19], v[96:99], v[96:99], v[16:19]
  v_add_f32 v59, v59, v63
  v_add_f32 v48, v48, v56
  v_mfma_f32_16x16x32_bf16 v[16:19], v[100:103], v[100:103], v[16:19]
  v_add_f32 v49, v49, v57
  v_add_f32 v50, v50, v58
  v_add_f32 v51, v51, v59
  v_exp_f32 v24, v48
  v_exp_f32 v25, v49
  v_exp_f32 v26, v50
  v_exp_f32 v27, v51
  v_mov_b64 v[20:21], s[14:15]
  v_cvt_pk_bf16_f32 v24, v24, v25
  v_cvt_pk_bf16_f32 v25, v26, v27
  v_cndmask_b32 v72, v24, 0, s[18:19]
  v_cndmask_b32 v73, v25, 0, s[18:19]
  v_cndmask_b32 v74, 0, v24, s[18:19]
  v_cndmask_b32 v75, 0, v25, s[18:19]
  v_mul_f32 v16, s24, v16
  v_mul_f32 v17, s24, v17
  v_mfma_f32_16x16x32_bf16 v[52:55], v[72:75], v[80:83], 0
  buffer_store_dwordx4 v[88:91], v0, s[4:7], s25 offen sc1
  v_exp_f32 v28, v16
  v_mov_b64 v[22:23], s[14:15]
  v_mfma_f32_16x16x32_bf16 v[56:59], v[72:75], v[84:87], 0
  v_exp_f32 v29, v17
  v_mfma_f32_16x16x32_bf16 v[60:63], v[72:75], v[20:23], 0
  v_add_f32 v64, v64, v66
  v_add_f32 v65, v65, v67
  v_cvt_pk_bf16_f32 v28, v28, v29
  v_cvt_pk_bf16_f32 v66, v64, v65
  v_cndmask_b32 v77, 0, v28, s[18:19]
  v_cndmask_b32 v78, 0, v28, s[18:19]
  v_add_f32 v68, v68, v70
  v_add_f32 v69, v69, v71
  v_cvt_pk_bf16_f32 v67, v68, v69
  v_mfma_f32_16x16x16_bf16 v[60:63], v[76:77], v[20:21], v[60:63]
  v_max3_f32 v7, |v48|, |v49|, |v50|
  v_max_f32 v26, |v16|, |v17|
  v_mfma_f32_16x16x16_bf16 v[52:55], v[78:79], v[66:67], v[52:55]
  v_cndmask_b32 v26, 0, v26, s[18:19]
  v_max3_f32 v7, |v51|, v26, v7
  v_mfma_f32_16x16x16_bf16 v[56:59], v[76:77], v[66:67], v[56:59]
  v_cmp_lt_f32 vcc, 0x42700000, v7
  v_mov_b64 v[44:45], 0
  v_add_f32 v60, v60, v62
  v_add_f32 v61, v61, v63
  s_cbranch_vccnz c_fb_10
c_fbr_11:
  v_rcp_f32 v60, v60
  v_rcp_f32 v61, v61
  v_pk_add_f32 v[52:53], v[52:53], v[54:55]
  v_pk_add_f32 v[56:57], v[56:57], v[58:59]
  v_pk_mul_f32 v[52:53], v[52:53], v[60:61]
  v_pk_mul_f32 v[56:57], v[56:57], v[60:61]
  v_cvt_pk_bf16_f32 v54, v52, v53
  v_cvt_pk_bf16_f32 v55, v56, v57
  ds_write_b64 v2, v[54:55] offset:0
  v_mov_b64 v[46:47], 0
  v_mov_b64 v[40:41], 0
  v_mov_b64 v[42:43], 0
  v_mov_b64 v[36:37], 0
  v_mov_b64 v[38:39], 0
  v_mov_b64 v[32:33], 0
  v_mov_b64 v[34:35], 0
  v_mov_b64 v[28:29], 0
  v_mov_b64 v[30:31], 0
  v_mov_b64 v[24:25], 0
  v_mov_b64 v[26:27], 0
  v_mov_b64 v[80:81], 0
  v_lshrrev_b32 v7, 1, v0
  s_waitcnt lgkmcnt(0)
  s_barrier
  ds_read_b64_tr_b16 v[72:73], v3 offset:0
  ds_read_b64_tr_b16 v[74:75], v3 offset:1024
  ds_read_b64_tr_b16 v[76:77], v3 offset:2048
  ds_read_b64_tr_b16 v[78:79], v3 offset:3072
  s_waitcnt lgkmcnt(2)
  v_smfmac_f32_16x16x64_bf16 v[44:47], v[72:75], a[248:255], v6
  ds_read_b128 v[120:123], v1 offset:24576
  s_and_b32 s3, s22, 1
  s_add_u32 s22, s22, 1
  buffer_store_dwordx2 v[66:67], v7, s[4:7], s25 offen offset:1024 sc1
  s_waitcnt lgkmcnt(1)
  v_smfmac_f32_16x16x64_bf16 v[44:47], v[76:79], a[240:247], v6
  ds_read_b128 v[124:127], v1 offset:25600
  s_and_b32 s42, s22, 3
  s_lshl_b32 s42, s42, 13
  s_cmp_eq_u32 s22, 64
  s_cbranch_scc1 c_last_13
  v_smfmac_f32_16x16x64_bf16 v[40:43], v[72:75], a[232:239], v6
  ds_read_b128 v[16:19], v1 offset:26624
  v_smfmac_f32_16x16x64_bf16 v[40:43], v[76:79], a[224:231], v6
  ds_read_b128 v[20:23], v1 offset:27648
  v_smfmac_f32_16x16x64_bf16 v[36:39], v[72:75], a[216:223], v6
  v_mov_b64 v[82:83], 0
  v_mov_b64 v[84:85], 0
  v_mov_b64 v[86:87], 0
  v_smfmac_f32_16x16x64_bf16 v[36:39], v[76:79], a[208:215], v6
  ds_read_b128 v[88:91], v1 offset:28672
  v_smfmac_f32_16x16x64_bf16 v[32:35], v[72:75], a[200:207], v6
  v_add_f32 v44, v44, v46
  v_add_f32 v45, v45, v47
  v_cvt_pk_bf16_f32 v48, v44, v45
  v_smfmac_f32_16x16x64_bf16 v[32:35], v[76:79], a[192:199], v6
  ds_read_b128 v[92:95], v1 offset:29696
  v_smfmac_f32_16x16x64_bf16 v[28:31], v[72:75], a[184:191], v6
  v_and_or_b32 v48, v48, -2, s3
  v_add_f32 v40, v40, v42
  v_add_f32 v41, v41, v43
  v_smfmac_f32_16x16x64_bf16 v[28:31], v[76:79], a[176:183], v6
  ds_read_b128 v[96:99], v1 offset:30720
  v_smfmac_f32_16x16x64_bf16 v[24:27], v[72:75], v[104:111], v6
  v_cvt_pk_bf16_f32 v49, v40, v41
  v_add_f32 v36, v36, v38
  v_add_f32 v37, v37, v39
  v_smfmac_f32_16x16x64_bf16 v[24:27], v[76:79], v[112:119], v6
  ds_read_b128 v[100:103], v1 offset:31744
  s_waitcnt lgkmcnt(6)
  v_smfmac_f32_16x16x64_bf16 v[80:83], v[72:75], v[120:127], v6
  v_cvt_pk_bf16_f32 v50, v36, v37
  v_add_f32 v32, v32, v34
  v_add_f32 v33, v33, v35
  s_waitcnt lgkmcnt(4)
  v_smfmac_f32_16x16x64_bf16 v[80:83], v[76:79], v[16:23], v6
  v_cvt_pk_bf16_f32 v51, v32, v33
  v_add_f32 v28, v28, v30
  v_add_f32 v29, v29, v31
  buffer_store_dwordx4 v[48:51], v4, s[4:7], s40 offen
  s_waitcnt lgkmcnt(2)
  v_smfmac_f32_16x16x64_bf16 v[84:87], v[72:75], v[88:95], v6
  v_cvt_pk_bf16_f32 v52, v28, v29
  v_and_or_b32 v52, v52, -2, s3
  v_add_f32 v24, v24, v26
  s_waitcnt lgkmcnt(0)
  v_smfmac_f32_16x16x64_bf16 v[84:87], v[76:79], v[96:103], v6
  v_add_f32 v25, v25, v27
  v_cvt_pk_bf16_f32 v53, v24, v25
  v_add_f32 v80, v80, v82
  v_add_f32 v81, v81, v83
  v_cvt_pk_bf16_f32 v54, v80, v81
  s_nop 2
  v_pk_add_f32 v[84:85], v[84:85], v[86:87]
  v_cvt_pk_bf16_f32 v55, v84, v85
  buffer_store_dwordx4 v[52:55], v4, s[4:7], s41 offen
  s_add_u32 s42, s42, s62
  s_add_u32 s43, s42, 4096
  s_add_u32 s23, s23, 524288
  s_add_u32 s25, s25, 262144
  s_add_u32 s63, s63, 512
  s_add_u32 s64, s64, 512
  s_buffer_load_dword s65, s[4:7], s63 glc
  v_mov_b64 v[56:57], 0
  v_mov_b64 v[58:59], 0
  v_mov_b64 v[60:61], 0
  v_mov_b64 v[62:63], 0
  v_mov_b64 v[48:49], 0
  v_mov_b64 v[50:51], 0
  v_mov_b64 v[52:53], 0
  v_mov_b64 v[54:55], 0
  s_cmp_lg_u32 s17, 0
  s_cbranch_scc1 c_oth_19
  s_mov_b32 s28, 0
  s_add_u32 s46, s46, 1
  v_mov_b64 v[120:121], -1
  s_xor_b32 s34, s42, 16384
  buffer_store_dwordx2 v[120:121], v5, s[4:7], s34 offen
  s_mov_b32 vcc_lo, 0xaaaaaaaa
  s_mov_b32 vcc_hi, 0xaaaaaaaa
  v_mov_b32 v7, 0x3f80
  v_cndmask_b32 v7, v7, 1.0, vcc
  s_mov_b32 vcc_lo, 0x30003
  s_mov_b32 vcc_hi, 0x30003
  v_cndmask_b32 v68, 0, v7, vcc
  s_mov_b32 vcc_lo, 0xc000c
  s_mov_b32 vcc_hi, 0xc000c
  v_cndmask_b32 v69, 0, v7, vcc
  s_mov_b32 vcc_lo, 0x300030
  s_mov_b32 vcc_hi, 0x300030
  v_cndmask_b32 v70, 0, v7, vcc
  s_mov_b32 vcc_lo, 0xc000c0
  s_mov_b32 vcc_hi, 0xc000c0
  v_cndmask_b32 v71, 0, v7, vcc
  s_nop 15
  s_nop 15
  s_nop 15
  s_nop 15
  s_nop 5
  buffer_load_dwordx4 v[16:19], v0, s[4:7], s38 offen offset:0 sc1
  buffer_load_dwordx4 v[20:23], v0, s[4:7], s38 offen offset:1024 sc1
  buffer_load_dwordx4 v[24:27], v0, s[4:7], s38 offen offset:2048 sc1
  buffer_load_dwordx4 v[28:31], v0, s[4:7], s38 offen offset:3072 sc1
  buffer_load_dwordx4 v[32:35], v0, s[4:7], s39 offen offset:0 sc1
  buffer_load_dwordx4 v[36:39], v0, s[4:7], s39 offen offset:1024 sc1
  buffer_load_dwordx4 v[40:43], v0, s[4:7], s39 offen offset:2048 sc1
  buffer_load_dwordx4 v[44:47], v0, s[4:7], s39 offen offset:3072 sc1
  s_nop 14
  buffer_load_dwordx4 v[72:75], v0, s[4:7], s38 offen offset:0 sc1
  buffer_load_dwordx4 v[76:79], v0, s[4:7], s38 offen offset:1024 sc1
  buffer_load_dwordx4 v[80:83], v0, s[4:7], s38 offen offset:2048 sc1
  buffer_load_dwordx4 v[84:87], v0, s[4:7], s38 offen offset:3072 sc1
  buffer_load_dwordx4 v[88:91], v0, s[4:7], s39 offen offset:0 sc1
  buffer_load_dwordx4 v[92:95], v0, s[4:7], s39 offen offset:1024 sc1
  buffer_load_dwordx4 v[96:99], v0, s[4:7], s39 offen offset:2048 sc1
  buffer_load_dwordx4 v[100:103], v0, s[4:7], s39 offen offset:3072 sc1
  s_waitcnt vmcnt(15)
  v_mfma_f32_16x16x32_bf16 v[64:67], v[16:19], v[68:71], 0
  v_xor_b32 v7, s3, v16
  s_waitcnt vmcnt(14)
  v_mfma_f32_16x16x32_bf16 v[64:67], v[20:23], v[68:71], v[64:67]
  v_bitop3_b32 v7, v7, v20, s3 bitop3:0xf6
  s_waitcnt vmcnt(13)
  v_mfma_f32_16x16x32_bf16 v[64:67], v[24:27], v[68:71], v[64:67]
  v_bitop3_b32 v7, v7, v24, s3 bitop3:0xf6
  s_waitcnt vmcnt(12)
  v_mfma_f32_16x16x32_bf16 v[64:67], v[28:31], v[68:71], v[64:67]
  v_bitop3_b32 v7, v7, v28, s3 bitop3:0xf6
  s_waitcnt vmcnt(11)
  v_mfma_f32_16x16x32_bf16 v[64:67], v[32:35], v[68:71], v[64:67]
  v_bitop3_b32 v7, v7, v32, s3 bitop3:0xf6
  s_waitcnt vmcnt(10)
  v_mfma_f32_16x16x32_bf16 v[64:67], v[36:39], v[68:71], v[64:67]
  v_bitop3_b32 v7, v7, v36, s3 bitop3:0xf6
  s_waitcnt vmcnt(9)
  v_mfma_f32_16x16x32_bf16 v[64:67], v[40:43], v[68:71], v[64:67]
  v_bitop3_b32 v7, v7, v40, s3 bitop3:0xf6
  s_waitcnt vmcnt(8)
  v_mfma_f32_16x16x32_bf16 v[64:67], v[44:47], v[68:71], v[64:67]
  v_bitop3_b32 v7, v7, v44, s3 bitop3:0xf6
  v_and_b32 v7, 1, v7
  v_cmp_ne_u32 vcc, 0, v7
  v_mov_b32 v7, 0
  v_mov_b32 v7, 0
  s_cbranch_vccnz c_p1r_20
c_publ_21:
  s_nop 1
  v_cvt_pk_bf16_f32 v64, v64, v65
  v_cvt_pk_bf16_f32 v65, v66, v67
  v_min_u32 v64, -2, v64
  v_min_u32 v65, -2, v65
  buffer_store_dwordx2 v[64:65], v5, s[4:7], s42 offen
c_hop2_9:
  s_barrier
  s_nop 15
  s_nop 13
  s_branch c_loop_6
c_kvs_17:
  s_cmp_ge_u32 s22, 63
  s_cbranch_scc1 c_kvr_18
  s_mov_b32 s29, 0
c_kvw_22:
  s_buffer_load_dword s65, s[4:7], s63 glc
  s_add_u32 s29, s29, 1
  s_cmp_gt_u32 s29, 1048576
  s_cbranch_scc1 c_fail_12
  s_waitcnt lgkmcnt(0)
  s_cmp_eq_u32 s65, 0
  s_cbranch_scc1 c_kvw_22
  s_branch c_kvr_18
c_last_13:
  s_add_u32 s64, s64, 512
  v_mov_b32 v7, 1
  s_waitcnt vmcnt(0)
  s_mov_b64 exec, 1
  buffer_store_dword v7, off, s[4:7], s64 sc1
  s_mov_b64 exec, -1
  s_branch c_fail_12
c_oth_19:
  ds_read_b128 v[24:27], v1 offset:0
  ds_read_b128 v[28:31], v1 offset:1024
  ds_read_b128 v[32:35], v1 offset:2048
  ds_read_b128 v[36:39], v1 offset:3072
  ds_read_b128 v[40:43], v1 offset:4096
  ds_read_b128 v[44:47], v1 offset:5120
  ds_read_b128 v[72:75], v1 offset:6144
  ds_read_b128 v[76:79], v1 offset:7168
  ds_read_b128 v[80:83], v1 offset:8192
  ds_read_b128 v[84:87], v1 offset:9216
  ds_read_b128 v[88:91], v1 offset:10240
  ds_read_b128 v[92:95], v1 offset:11264
  ds_read_b128 v[96:99], v1 offset:12288
  ds_read_b128 v[100:103], v1 offset:13312
  ds_read_b128 v[104:107], v1 offset:14336
  ds_read_b128 v[108:111], v1 offset:15360
  ds_read_b128 v[112:115], v1 offset:16384
  ds_read_b128 v[116:119], v1 offset:17408
  ds_read_b128 v[120:123], v1 offset:18432
  ds_read_b128 v[124:127], v1 offset:19456
  v_mov_b64 v[64:65], 0
  v_mov_b64 v[66:67], 0
  v_mov_b64 v[68:69], 0
  v_mov_b64 v[70:71], 0
  s_branch c_hop2_9
c_w0a_15:
  s_waitcnt vmcnt(3)
  ds_read_b128 v[24:27], v1 offset:0
  ds_read_b128 v[28:31], v1 offset:1024
  ds_read_b128 v[32:35], v1 offset:2048
  ds_read_b128 v[36:39], v1 offset:3072
  ds_read_b128 v[40:43], v1 offset:4096
  ds_read_b128 v[44:47], v1 offset:5120
  ds_read_b128 v[72:75], v1 offset:6144
  ds_read_b128 v[76:79], v1 offset:7168
  ds_read_b128 v[80:83], v1 offset:8192
  ds_read_b128 v[84:87], v1 offset:9216
  buffer_load_dwordx4 v[16:19], v8, s[4:7], s42 offen sc1
  buffer_load_dwordx4 v[20:23], v8, s[4:7], s43 offen sc1
  ds_read_b128 v[88:91], v1 offset:10240
  ds_read_b128 v[92:95], v1 offset:11264
  ds_read_b128 v[96:99], v1 offset:12288
  ds_read_b128 v[100:103], v1 offset:13312
  ds_read_b128 v[104:107], v1 offset:14336
  ds_read_b128 v[108:111], v1 offset:15360
  ds_read_b128 v[112:115], v1 offset:16384
  ds_read_b128 v[116:119], v1 offset:17408
  ds_read_b128 v[120:123], v1 offset:18432
  ds_read_b128 v[124:127], v1 offset:19456
  buffer_load_dwordx4 v[16:19], v8, s[4:7], s42 offen sc1
  buffer_load_dwordx4 v[20:23], v8, s[4:7], s43 offen sc1
  v_mov_b64 v[64:65], 0
  v_mov_b64 v[66:67], 0
  v_mov_b64 v[68:69], 0
  v_mov_b64 v[70:71], 0
  s_branch c_w0b_16
c_p1r_20:
  buffer_load_dwordx4 v[16:19], v0, s[4:7], s38 offen offset:0 sc1
  buffer_load_dwordx4 v[20:23], v0, s[4:7], s38 offen offset:1024 sc1
  buffer_load_dwordx4 v[24:27], v0, s[4:7], s38 offen offset:2048 sc1
  buffer_load_dwordx4 v[28:31], v0, s[4:7], s38 offen offset:3072 sc1
  buffer_load_dwordx4 v[32:35], v0, s[4:7], s39 offen offset:0 sc1
  buffer_load_dwordx4 v[36:39], v0, s[4:7], s39 offen offset:1024 sc1
  buffer_load_dwordx4 v[40:43], v0, s[4:7], s39 offen offset:2048 sc1
  buffer_load_dwordx4 v[44:47], v0, s[4:7], s39 offen offset:3072 sc1
  s_add_u32 s46, s46, 1
  s_waitcnt vmcnt(15)
  v_mfma_f32_16x16x32_bf16 v[64:67], v[72:75], v[68:71], 0
  v_xor_b32 v7, s3, v72
  s_waitcnt vmcnt(14)
  v_mfma_f32_16x16x32_bf16 v[64:67], v[76:79], v[68:71], v[64:67]
  v_bitop3_b32 v7, v7, v76, s3 bitop3:0xf6
  s_waitcnt vmcnt(13)
  v_mfma_f32_16x16x32_bf16 v[64:67], v[80:83], v[68:71], v[64:67]
  v_bitop3_b32 v7, v7, v80, s3 bitop3:0xf6
  s_waitcnt vmcnt(12)
  v_mfma_f32_16x16x32_bf16 v[64:67], v[84:87], v[68:71], v[64:67]
  v_bitop3_b32 v7, v7, v84, s3 bitop3:0xf6
  s_waitcnt vmcnt(11)
  v_mfma_f32_16x16x32_bf16 v[64:67], v[88:91], v[68:71], v[64:67]
  v_bitop3_b32 v7, v7, v88, s3 bitop3:0xf6
  s_waitcnt vmcnt(10)
  v_mfma_f32_16x16x32_bf16 v[64:67], v[92:95], v[68:71], v[64:67]
  v_bitop3_b32 v7, v7, v92, s3 bitop3:0xf6
  s_waitcnt vmcnt(9)
  v_mfma_f32_16x16x32_bf16 v[64:67], v[96:99], v[68:71], v[64:67]
  v_bitop3_b32 v7, v7, v96, s3 bitop3:0xf6
  s_waitcnt vmcnt(8)
  v_mfma_f32_16x16x32_bf16 v[64:67], v[100:103], v[68:71], v[64:67]
  v_bitop3_b32 v7, v7, v100, s3 bitop3:0xf6
  v_and_b32 v7, 1, v7
  v_cmp_ne_u32 vcc, 0, v7
  v_mov_b32 v7, 0
  v_mov_b32 v7, 0
  s_cbranch_vccnz c_p1s_23
  s_branch c_publ_21
c_p1s_23:
  buffer_load_dwordx4 v[72:75], v0, s[4:7], s38 offen offset:0 sc1
  buffer_load_dwordx4 v[76:79], v0, s[4:7], s38 offen offset:1024 sc1
  buffer_load_dwordx4 v[80:83], v0, s[4:7], s38 offen offset:2048 sc1
  buffer_load_dwordx4 v[84:87], v0, s[4:7], s38 offen offset:3072 sc1
  buffer_load_dwordx4 v[88:91], v0, s[4:7], s39 offen offset:0 sc1
  buffer_load_dwordx4 v[92:95], v0, s[4:7], s39 offen offset:1024 sc1
  buffer_load_dwordx4 v[96:99], v0, s[4:7], s39 offen offset:2048 sc1
  buffer_load_dwordx4 v[100:103], v0, s[4:7], s39 offen offset:3072 sc1
  s_add_u32 s28, s28, 1
  s_add_u32 s46, s46, 1
  s_cmp_gt_u32 s28, 1048576
  s_cbranch_scc1 c_fail_12
  s_waitcnt vmcnt(15)
  v_mfma_f32_16x16x32_bf16 v[64:67], v[16:19], v[68:71], 0
  v_xor_b32 v7, s3, v16
  s_waitcnt vmcnt(14)
  v_mfma_f32_16x16x32_bf16 v[64:67], v[20:23], v[68:71], v[64:67]
  v_bitop3_b32 v7, v7, v20, s3 bitop3:0xf6
  s_waitcnt vmcnt(13)
  v_mfma_f32_16x16x32_bf16 v[64:67], v[24:27], v[68:71], v[64:67]
  v_bitop3_b32 v7, v7, v24, s3 bitop3:0xf6
  s_waitcnt vmcnt(12)
  v_mfma_f32_16x16x32_bf16 v[64:67], v[28:31], v[68:71], v[64:67]
  v_bitop3_b32 v7, v7, v28, s3 bitop3:0xf6
  s_waitcnt vmcnt(11)
  v_mfma_f32_16x16x32_bf16 v[64:67], v[32:35], v[68:71], v[64:67]
  v_bitop3_b32 v7, v7, v32, s3 bitop3:0xf6
  s_waitcnt vmcnt(10)
  v_mfma_f32_16x16x32_bf16 v[64:67], v[36:39], v[68:71], v[64:67]
  v_bitop3_b32 v7, v7, v36, s3 bitop3:0xf6
  s_waitcnt vmcnt(9)
  v_mfma_f32_16x16x32_bf16 v[64:67], v[40:43], v[68:71], v[64:67]
  v_bitop3_b32 v7, v7, v40, s3 bitop3:0xf6
  s_waitcnt vmcnt(8)
  v_mfma_f32_16x16x32_bf16 v[64:67], v[44:47], v[68:71], v[64:67]
  v_bitop3_b32 v7, v7, v44, s3 bitop3:0xf6
  v_and_b32 v7, 1, v7
  v_cmp_ne_u32 vcc, 0, v7
  v_mov_b32 v7, 0
  v_mov_b32 v7, 0
  s_cbranch_vccnz c_p1r_20
  s_branch c_publ_21
c_retry_7:
  buffer_load_dwordx4 v[16:19], v8, s[4:7], s42 offen sc1
  buffer_load_dwordx4 v[20:23], v8, s[4:7], s43 offen sc1
  s_add_u32 s28, s28, 1
  s_add_u32 s47, s47, 1
  s_cmp_gt_u32 s28, 1048576
  s_cbranch_scc1 c_fail_12
  v_mov_b64 v[48:49], 0
  v_mov_b64 v[50:51], 0
  v_mov_b64 v[52:53], 0
  v_mov_b64 v[54:55], 0
  v_mov_b64 v[56:57], 0
  v_mov_b64 v[58:59], 0
  s_waitcnt vmcnt(4)
  v_max3_u32 v7, v16, v17, v18
  v_max_u32 v7, v7, v19
  ds_write_b128 v8, v[16:19] offset:0
  v_smfmac_f32_16x16x64_bf16 v[48:51], v[16:19], v[24:31], v6
  s_branch c_got_8
c_fb_10:
  v_max3_f32 v7, v48, v49, v50
  v_max_f32 v7, v51, v7
  s_mov_b64 exec, s[18:19]
  v_max3_f32 v7, v16, v17, v7
  s_mov_b64 exec, -1
  s_nop 0
  v_max_f32_dpp v7, v7, v7 quad_perm:[2,3,0,1] row_mask:0xf bank_mask:0xf
  v_mov_b32 v24, v7
  s_nop 0
  s_nop 0
  v_permlane16_swap_b32 v7, v24
  v_max_f32 v7, v7, v24
  v_mov_b32 v24, v7
  s_nop 0
  s_nop 0
  v_permlane32_swap_b32 v7, v24
  v_max_f32 v7, v7, v24
  v_sub_f32 v24, v48, v7
  v_sub_f32 v25, v49, v7
  v_sub_f32 v26, v50, v7
  v_sub_f32 v27, v51, v7
  v_sub_f32 v28, v16, v7
  v_sub_f32 v29, v17, v7
  v_exp_f32 v24, v24
  v_exp_f32 v25, v25
  v_exp_f32 v26, v26
  v_exp_f32 v27, v27
  v_exp_f32 v28, v28
  v_exp_f32 v29, v29
  v_cvt_pk_bf16_f32 v24, v24, v25
  v_cvt_pk_bf16_f32 v25, v26, v27
  v_cvt_pk_bf16_f32 v28, v28, v29
  v_cndmask_b32 v72, v24, 0, s[18:19]
  v_cndmask_b32 v73, v25, 0, s[18:19]
  v_cndmask_b32 v74, 0, v24, s[18:19]
  v_cndmask_b32 v75, 0, v25, s[18:19]
  v_cndmask_b32 v77, 0, v28, s[18:19]
  v_cndmask_b32 v78, 0, v28, s[18:19]
  v_mfma_f32_16x16x32_bf16 v[60:63], v[72:75], v[20:23], 0
  v_mfma_f32_16x16x32_bf16 v[52:55], v[72:75], v[80:83], 0
  v_mfma_f32_16x16x32_bf16 v[56:59], v[72:75], v[84:87], 0
  s_nop 5
  v_mfma_f32_16x16x16_bf16 v[60:63], v[76:77], v[20:21], v[60:63]
  v_mfma_f32_16x16x16_bf16 v[52:55], v[78:79], v[66:67], v[52:55]
  v_mfma_f32_16x16x16_bf16 v[56:59], v[76:77], v[66:67], v[56:59]
  s_nop 7
  v_add_f32 v60, v60, v62
  v_add_f32 v61, v61, v63
  s_branch c_fbr_11
c_fail_12:
  s_endpgm
L_chain_x:
  s_mov_b32 s22, 0
  s_mov_b32 s42, s62
  s_add_u32 s43, s62, 4096
  s_mov_b32 s46, 0
  s_mov_b32 s47, 0
  s_lshl_b32 s26, s16, 2
  s_add_u32 s26, s26, s17
  s_lshl_b32 s27, s60, 13
  s_add_u32 s27, s27, s26
  s_lshl_b32 s25, s27, 11
  s_add_u32 s25, s25, 117440512
  s_lshl_b32 s64, s60, 14
  s_add_u32 s64, s64, s26
  s_lshl_b32 s64, s64, 2
  s_add_u32 s64, s64, 5447168
  s_lshl_b32 s27, s61, 13
  s_add_u32 s27, s27, s26
  s_lshl_b32 s23, s27, 12
  s_add_u32 s23, s23, 16777216
  s_lshl_b32 s63, s27, 2
  s_add_u32 s63, s63, 5308416
  s_mov_b32 s29, 0
c_kvw_32:
  s_buffer_load_dword s65, s[4:7], s63 glc
  s_add_u32 s29, s29, 1
  s_cmp_gt_u32 s29, 1048576
  s_cbranch_scc1 c_fail_30
  s_waitcnt lgkmcnt(0)
  s_cmp_eq_u32 s65, 0
  s_cbranch_scc1 c_kvw_32
  buffer_load_dwordx4 v0, s[4:7], s23 offen offset:0  lds
  buffer_load_dwordx4 v0, s[4:7], s23 offen offset:1024  lds
  buffer_load_dwordx4 v0, s[4:7], s23 offen offset:2048  lds
  buffer_load_dwordx4 v0, s[4:7], s23 offen offset:3072  lds
  s_add_u32 s23, s23, 524288
  s_add_u32 s63, s63, 512
  s_mov_b32 s65, 0
  ds_read_b128 v[72:75], v1 offset:6144
  ds_read_b128 v[76:79], v1 offset:7168
  ds_read_b128 v[80:83], v1 offset:8192
  ds_read_b128 v[84:87], v1 offset:9216
  ds_read_b128 v[88:91], v1 offset:10240
  ds_read_b128 v[92:95], v1 offset:11264
  ds_read_b128 v[96:99], v1 offset:12288
  ds_read_b128 v[100:103], v1 offset:13312
  ds_read_b128 v[104:107], v1 offset:14336
  ds_read_b128 v[108:111], v1 offset:15360
  ds_read_b128 v[112:115], v1 offset:16384
  ds_read_b128 v[116:119], v1 offset:17408
  ds_read_b128 v[120:123], v1 offset:18432
  ds_read_b128 v[124:127], v1 offset:19456
  v_mov_b64 v[48:49], 0
  v_mov_b64 v[50:51], 0
  v_mov_b64 v[52:53], 0
  v_mov_b64 v[54:55], 0
  v_mov_b64 v[56:57], 0
  v_mov_b64 v[58:59], 0
  v_mov_b64 v[60:61], 0
  v_mov_b64 v[62:63], 0
  v_mov_b64 v[64:65], 0
  v_mov_b64 v[66:67], 0
  v_mov_b64 v[68:69], 0
  v_mov_b64 v[70:71], 0
  s_lshl_b32 s38, s16, 13
  s_add_u32 s38, s38, s40
  s_add_u32 s39, s38, 4096
  ds_read_b128 v[24:27], v1 offset:0
  ds_read_b128 v[28:31], v1 offset:1024
  ds_read_b128 v[32:35], v1 offset:2048
  ds_read_b128 v[36:39], v1 offset:3072
  ds_read_b128 v[40:43], v1 offset:4096
  ds_read_b128 v[44:47], v1 offset:5120
  s_waitcnt lgkmcnt(0)
c_loop_24:
  buffer_load_dwordx4 v[16:19], v8, s[4:7], s42 offen sc1
  buffer_load_dwordx4 v[20:23], v8, s[4:7], s43 offen sc1
  s_mov_b32 s28, 0
  s_cmp_eq_u32 s17, 0
  s_cbranch_scc1 c_w0a_33
  s_nop 15
  s_nop 8
  buffer_load_dwordx4 v[16:19], v8, s[4:7], s42 offen sc1
  buffer_load_dwordx4 v[20:23], v8, s[4:7], s43 offen sc1
  s_nop 15
  s_nop 8
  buffer_load_dwordx4 v[16:19], v8, s[4:7], s42 offen sc1
  buffer_load_dwordx4 v[20:23], v8, s[4:7], s43 offen sc1
c_w0b_34:
  s_waitcnt lgkmcnt(0)
  s_waitcnt vmcnt(5)
  v_max3_u32 v7, v16, v17, v18
  v_max_u32 v7, v7, v19
  ds_write_b128 v8, v[16:19] offset:0
  v_smfmac_f32_16x16x64_bf16 v[48:51], v[16:19], v[24:31], v6
  s_waitcnt vmcnt(4)
c_got_26:
  v_max3_u32 v7, v20, v21, v7
  v_max3_u32 v7, v22, v23, v7
  ds_write_b128 v8, v[20:23] offset:4096
  v_smfmac_f32_16x16x64_bf16 v[52:55], v[16:19], v[32:39], v6
  v_cmp_eq_u32 vcc, -1, v7
  v_smfmac_f32_16x16x64_bf16 v[56:59], v[16:19], v[40:47], v6
  s_cbranch_vccnz c_retry_25
  v_smfmac_f32_16x16x64_bf16 v[60:63], v[16:19], v[72:79], v6
  s_cmp_eq_u32 s65, 0
  s_cbranch_scc1 c_kvs_35
c_kvr_36:
  v_smfmac_f32_16x16x64_bf16 v[48:51], v[20:23], v[80:87], v6
  v_mov_b32 v7, 1
  v_smfmac_f32_16x16x64_bf16 v[52:55], v[20:23], v[88:95], v6
  v_smfmac_f32_16x16x64_bf16 v[56:59], v[20:23], v[96:103], v6
  s_waitcnt lgkmcnt(0)
  s_barrier
  ds_read_b128 v[24:27], v9 offset:0
  ds_read_b128 v[28:31], v10 offset:0
  v_smfmac_f32_16x16x64_bf16 v[60:63], v[20:23], v[104:111], v6
  ds_read_b128 v[32:35], v11 offset:0
  v_smfmac_f32_16x16x64_bf16 v[64:67], v[16:19], v[112:119], v6
  ds_read_b128 v[36:39], v9 offset:4096
  v_smfmac_f32_16x16x64_bf16 v[68:71], v[16:19], v[120:127], v6
  ds_read_b128 v[40:43], v10 offset:4096
  v_smfmac_f32_16x16x64_bf16 v[64:67], v[20:23], v[208:215], v6
  ds_read_b128 v[44:47], v11 offset:4096
  s_waitcnt lgkmcnt(5)
  v_smfmac_f32_16x16x64_bf16 v[48:51], v[24:27], a[168:175], v6
  ds_read_b128 v[72:75], v1 offset:32768
  s_waitcnt lgkmcnt(5)
  v_smfmac_f32_16x16x64_bf16 v[48:51], v[28:31], a[160:167], v6
  ds_read_b128 v[76:79], v1 offset:33792
  s_waitcnt lgkmcnt(5)
  v_smfmac_f32_16x16x64_bf16 v[48:51], v[32:35], a[152:159], v6
  ds_read_b128 v[80:83], v1 offset:34816
  s_waitcnt lgkmcnt(5)
  v_smfmac_f32_16x16x64_bf16 v[48:51], v[36:39], a[144:151], v6
  ds_read_b128 v[84:87], v1 offset:35840
  s_waitcnt lgkmcnt(5)
  v_smfmac_f32_16x16x64_bf16 v[48:51], v[40:43], a[136:143], v6
  ds_read_b128 v[104:107], v1 offset:20480
  s_waitcnt lgkmcnt(5)
  v_smfmac_f32_16x16x64_bf16 v[48:51], v[44:47], a[128:135], v6
  ds_read_b128 v[108:111], v1 offset:21504
  v_smfmac_f32_16x16x64_bf16 v[52:55], v[24:27], a[120:127], v6
  s_waitcnt lgkmcnt(5)
  buffer_load_dwordx4 v0, s[4:7], s23 offen offset:0  lds
  s_mov_b64 exec, 1
  buffer_store_dword v7, off, s[4:7], s64 sc1
  s_mov_b64 exec, -1
  v_smfmac_f32_16x16x64_bf16 v[52:55], v[28:31], a[112:119], v6
  s_waitcnt lgkmcnt(2)
  s_nop 0
  v_smfmac_f32_16x16x64_bf16 v[52:55], v[32:35], a[104:111], v6
  v_add_f32 v48, v48, v50
  v_smfmac_f32_16x16x64_bf16 v[52:55], v[36:39], a[96:103], v6
  v_add_f32 v49, v49, v51
  v_smfmac_f32_16x16x64_bf16 v[52:55], v[40:43], a[88:95], v6
  v_cvt_pk_bf16_f32 v50, v48, v49
  v_smfmac_f32_16x16x64_bf16 v[52:55], v[44:47], a[80:87], v6
  v_cvt_pk_bf16_f32 v51, v48, v49
  v_smfmac_f32_16x16x64_bf16 v[56:59], v[24:27], a[72:79], v6
  ds_write_b64 v2, v[50:51] offset:8192
  v_smfmac_f32_16x16x64_bf16 v[56:59], v[28:31], a[64:71], v6
  ds_read_b64_tr_b16 v[88:89], v12 offset:8192
  s_nop 0
  v_smfmac_f32_16x16x64_bf16 v[56:59], v[32:35], a[56:63], v6
  s_nop 0
  v_add_f32 v52, v52, v54
  v_add_f32 v53, v53, v55
  v_cvt_pk_bf16_f32 v54, v52, v53
  v_cvt_pk_bf16_f32 v55, v52, v53
  ds_write_b64 v2, v[54:55] offset:8704
  v_smfmac_f32_16x16x64_bf16 v[56:59], v[36:39], a[48:55], v6
  ds_read_b64_tr_b16 v[90:91], v12 offset:8704
  v_smfmac_f32_16x16x64_bf16 v[56:59], v[40:43], a[40:47], v6
  buffer_load_dwordx4 v0, s[4:7], s23 offen offset:1024  lds
  v_smfmac_f32_16x16x64_bf16 v[56:59], v[44:47], a[32:39], v6
  ds_read_b128 v[112:115], v1 offset:22528
  v_smfmac_f32_16x16x64_bf16 v[60:63], v[24:27], a[24:31], v6
  buffer_load_dwordx4 v0, s[4:7], s23 offen offset:2048  lds
  v_smfmac_f32_16x16x64_bf16 v[60:63], v[28:31], a[16:23], v6
  s_waitcnt lgkmcnt(1)
  v_mfma_f32_16x16x32_bf16 v[92:95], v[72:75], v[88:91], 0
  buffer_load_dwordx4 v0, s[4:7], s23 offen offset:3072  lds
  v_mfma_f32_16x16x32_bf16 v[96:99], v[76:79], v[88:91], 0
  v_add_f32 v56, v56, v58
  v_add_f32 v57, v57, v59
  v_smfmac_f32_16x16x64_bf16 v[60:63], v[32:35], a[8:15], v6
  v_cvt_pk_bf16_f32 v58, v56, v57
  v_smfmac_f32_16x16x64_bf16 v[60:63], v[36:39], a[0:7], v6
  ds_write_b32 v2, v58 offset:8192
  v_smfmac_f32_16x16x64_bf16 v[60:63], v[40:43], v[248:255], v6
  s_nop 0
  v_cndmask_b32 v48, v92, v96, s[18:19]
  v_smfmac_f32_16x16x64_bf16 v[60:63], v[44:47], v[240:247], v6
  v_cndmask_b32 v49, v93, v97, s[18:19]
  v_cndmask_b32 v50, v94, v98, s[18:19]
  v_cndmask_b32 v51, v95, v99, s[18:19]
  ds_write_b128 v8, v[48:51] offset:12288
  v_smfmac_f32_16x16x64_bf16 v[68:71], v[20:23], v[152:159], v6
  s_nop 1
  s_nop 0
  v_add_f32 v60, v60, v62
  v_add_f32 v61, v61, v63
  v_cvt_pk_bf16_f32 v62, v60, v61
  ds_write_b32 v2, v62 offset:8704
  v_smfmac_f32_16x16x64_bf16 v[64:67], v[24:27], v[232:239], v6
  v_mov_b32 v76, 0
  v_smfmac_f32_16x16x64_bf16 v[64:67], v[28:31], v[224:231], v6
  v_mov_b32 v79, 0
  s_waitcnt vmcnt(5)
  v_smfmac_f32_16x16x64_bf16 v[64:67], v[32:35], v[216:223], v6
  ds_read_b128 v[116:119], v1 offset:23552
  v_smfmac_f32_16x16x64_bf16 v[64:67], v[36:39], v[200:207], v6
  s_waitcnt lgkmcnt(1)
  s_barrier
  ds_read_b128 v[52:55], v9 offset:12288
  ds_read_b128 v[56:59], v10 offset:12288
  v_smfmac_f32_16x16x64_bf16 v[64:67], v[40:43], v[192:199], v6
  ds_read_b128 v[60:63], v11 offset:12288
  v_smfmac_f32_16x16x64_bf16 v[64:67], v[44:47], v[184:191], v6
  ds_read_b64_tr_b16 v[88:89], v12 offset:8192
  ds_read_b64_tr_b16 v[90:91], v12 offset:8704
  v_smfmac_f32_16x16x64_bf16 v[68:71], v[24:27], v[176:183], v6
  ds_read_b64_tr_b16 v[92:93], v13 offset:8192
  ds_read_b64_tr_b16 v[94:95], v13 offset:8704
  v_smfmac_f32_16x16x64_bf16 v[68:71], v[28:31], v[168:175], v6
  ds_read_b64_tr_b16 v[96:97], v14 offset:8192
  ds_read_b64_tr_b16 v[98:99], v14 offset:8704
  v_smfmac_f32_16x16x64_bf16 v[68:71], v[32:35], v[160:167], v6
  ds_read_b64_tr_b16 v[100:101], v15 offset:8192
  ds_read_b64_tr_b16 v[102:103], v15 offset:8704
  s_waitcnt lgkmcnt(8)
  v_smfmac_f32_16x16x64_bf16 v[68:71], v[36:39], v[144:151], v6
  v_add_f32 v48, v48, v52
  v_smfmac_f32_16x16x64_bf16 v[68:71], v[40:43], v[136:143], v6
  v_add_f32 v49, v49, v53
  v_smfmac_f32_16x16x64_bf16 v[68:71], v[44:47], v[128:135], v6
  v_add_f32 v50, v50, v54
  s_waitcnt lgkmcnt(4)
  v_mfma_f32_16x16x32_bf16 v[16:19], v[88:91], v[88:91], 0
  v_add_f32 v51, v51, v55
  v_add_f32 v56, v56, v60
  v_mfma_f32_16x16x32_bf16 v[16:19], v[92:95], v[92:95], v[16:19]
  v_add_f32 v57, v57, v61
  s_waitcnt lgkmcnt(0)
  v_add_f32 v58, v58, v62
  v_mfma_f32_16x16x32_bf16 v[16:19], v[96:99], v[96:99], v[16:19]
  v_add_f32 v59, v59, v63
  v_add_f32 v48, v48, v56
  v_mfma_f32_16x16x32_bf16 v[16:19], v[100:103], v[100:103], v[16:19]
  v_add_f32 v49, v49, v57
  v_add_f32 v50, v50, v58
  v_add_f32 v51, v51, v59
  v_exp_f32 v24, v48
  v_exp_f32 v25, v49
  v_exp_f32 v26, v50
  v_exp_f32 v27, v51
  v_mov_b64 v[20:21], s[14:15]
  v_cvt_pk_bf16_f32 v24, v24, v25
  v_cvt_pk_bf16_f32 v25, v26, v27
  v_cndmask_b32 v72, v24, 0, s[18:19]
  v_cndmask_b32 v73, v25, 0, s[18:19]
  v_cndmask_b32 v74, 0, v24, s[18:19]
  v_cndmask_b32 v75, 0, v25, s[18:19]
  v_mul_f32 v16, s24, v16
  v_mul_f32 v17, s24, v17
  v_mfma_f32_16x16x32_bf16 v[52:55], v[72:75], v[80:83], 0
  buffer_store_dwordx4 v[88:91], v0, s[4:7], s25 offen sc1
  v_exp_f32 v28, v16
  v_mov_b64 v[22:23], s[14:15]
  v_mfma_f32_16x16x32_bf16 v[56:59], v[72:75], v[84:87], 0
  v_exp_f32 v29, v17
  v_mfma_f32_16x16x32_bf16 v[60:63], v[72:75], v[20:23], 0
  v_add_f32 v64, v64, v66
  v_add_f32 v65, v65, v67
  v_cvt_pk_bf16_f32 v28, v28, v29
  v_cvt_pk_bf16_f32 v66, v64, v65
  v_cndmask_b32 v77, 0, v28, s[18:19]
  v_cndmask_b32 v78, 0, v28, s[18:19]
  v_add_f32 v68, v68, v70
  v_add_f32 v69, v69, v71
  v_cvt_pk_bf16_f32 v67, v68, v69
  v_mfma_f32_16x16x16_bf16 v[60:63], v[76:77], v[20:21], v[60:63]
  v_max3_f32 v7, |v48|, |v49|, |v50|
  v_max_f32 v26, |v16|, |v17|
  v_mfma_f32_16x16x16_bf16 v[52:55], v[78:79], v[66:67], v[52:55]
  v_cndmask_b32 v26, 0, v26, s[18:19]
  v_max3_f32 v7, |v51|, v26, v7
  v_mfma_f32_16x16x16_bf16 v[56:59], v[76:77], v[66:67], v[56:59]
  v_cmp_lt_f32 vcc, 0x42700000, v7
  v_mov_b64 v[44:45], 0
  v_add_f32 v60, v60, v62
  v_add_f32 v61, v61, v63
  s_cbranch_vccnz c_fb_28
c_fbr_29:
  v_rcp_f32 v60, v60
  v_rcp_f32 v61, v61
  v_pk_add_f32 v[52:53], v[52:53], v[54:55]
  v_pk_add_f32 v[56:57], v[56:57], v[58:59]
  v_pk_mul_f32 v[52:53], v[52:53], v[60:61]
  v_pk_mul_f32 v[56:57], v[56:57], v[60:61]
  v_cvt_pk_bf16_f32 v54, v52, v53
  v_cvt_pk_bf16_f32 v55, v56, v57
  ds_write_b64 v2, v[54:55] offset:0
  v_mov_b64 v[46:47], 0
  v_mov_b64 v[40:41], 0
  v_mov_b64 v[42:43], 0
  v_mov_b64 v[36:37], 0
  v_mov_b64 v[38:39], 0
  v_mov_b64 v[32:33], 0
  v_mov_b64 v[34:35], 0
  v_mov_b64 v[28:29], 0
  v_mov_b64 v[30:31], 0
  v_mov_b64 v[24:25], 0
  v_mov_b64 v[26:27], 0
  v_mov_b64 v[80:81], 0
  v_lshrrev_b32 v7, 1, v0
  s_waitcnt lgkmcnt(0)
  s_barrier
  ds_read_b64_tr_b16 v[72:73], v3 offset:0
  ds_read_b64_tr_b16 v[74:75], v3 offset:1024
  ds_read_b64_tr_b16 v[76:77], v3 offset:2048
  ds_read_b64_tr_b16 v[78:79], v3 offset:3072
  s_waitcnt lgkmcnt(2)
  v_smfmac_f32_16x16x64_bf16 v[44:47], v[72:75], a[248:255], v6
  ds_read_b128 v[120:123], v1 offset:24576
  s_and_b32 s3, s22, 1
  s_add_u32 s22, s22, 1
  buffer_store_dwordx2 v[66:67], v7, s[4:7], s25 offen offset:1024 sc1
  s_waitcnt lgkmcnt(1)
  v_smfmac_f32_16x16x64_bf16 v[44:47], v[76:79], a[240:247], v6
  ds_read_b128 v[124:127], v1 offset:25600
  s_and_b32 s42, s22, 3
  s_lshl_b32 s42, s42, 13
  s_cmp_eq_u32 s22, 64
  s_cbranch_scc1 c_last_31
  v_smfmac_f32_16x16x64_bf16 v[40:43], v[72:75], a[232:239], v6
  ds_read_b128 v[16:19], v1 offset:26624
  v_smfmac_f32_16x16x64_bf16 v[40:43], v[76:79], a[224:231], v6
  ds_read_b128 v[20:23], v1 offset:27648
  v_smfmac_f32_16x16x64_bf16 v[36:39], v[72:75], a[216:223], v6
  v_mov_b64 v[82:83], 0
  v_mov_b64 v[84:85], 0
  v_mov_b64 v[86:87], 0
  v_smfmac_f32_16x16x64_bf16 v[36:39], v[76:79], a[208:215], v6
  ds_read_b128 v[88:91], v1 offset:28672
  v_smfmac_f32_16x16x64_bf16 v[32:35], v[72:75], a[200:207], v6
  v_add_f32 v44, v44, v46
  v_add_f32 v45, v45, v47
  v_cvt_pk_bf16_f32 v48, v44, v45
  v_smfmac_f32_16x16x64_bf16 v[32:35], v[76:79], a[192:199], v6
  ds_read_b128 v[92:95], v1 offset:29696
  v_smfmac_f32_16x16x64_bf16 v[28:31], v[72:75], a[184:191], v6
  v_and_or_b32 v48, v48, -2, s3
  v_add_f32 v40, v40, v42
  v_add_f32 v41, v41, v43
  v_smfmac_f32_16x16x64_bf16 v[28:31], v[76:79], a[176:183], v6
  ds_read_b128 v[96:99], v1 offset:30720
  v_smfmac_f32_16x16x64_bf16 v[24:27], v[72:75], v[104:111], v6
  v_cvt_pk_bf16_f32 v49, v40, v41
  v_add_f32 v36, v36, v38
  v_add_f32 v37, v37, v39
  v_smfmac_f32_16x16x64_bf16 v[24:27], v[76:79], v[112:119], v6
  ds_read_b128 v[100:103], v1 offset:31744
  s_waitcnt lgkmcnt(6)
  v_smfmac_f32_16x16x64_bf16 v[80:83], v[72:75], v[120:127], v6
  v_cvt_pk_bf16_f32 v50, v36, v37
  v_add_f32 v32, v32, v34
  v_add_f32 v33, v33, v35
  s_waitcnt lgkmcnt(4)
  v_smfmac_f32_16x16x64_bf16 v[80:83], v[76:79], v[16:23], v6
  v_cvt_pk_bf16_f32 v51, v32, v33
  v_add_f32 v28, v28, v30
  v_add_f32 v29, v29, v31
  buffer_store_dwordx4 v[48:51], v4, s[4:7], s40 offen sc1
  s_waitcnt lgkmcnt(2)
  v_smfmac_f32_16x16x64_bf16 v[84:87], v[72:75], v[88:95], v6
  v_cvt_pk_bf16_f32 v52, v28, v29
  v_and_or_b32 v52, v52, -2, s3
  v_add_f32 v24, v24, v26
  s_waitcnt lgkmcnt(0)
  v_smfmac_f32_16x16x64_bf16 v[84:87], v[76:79], v[96:103], v6
  v_add_f32 v25, v25, v27
  v_cvt_pk_bf16_f32 v53, v24, v25
  v_add_f32 v80, v80, v82
  v_add_f32 v81, v81, v83
  v_cvt_pk_bf16_f32 v54, v80, v81
  s_nop 2
  v_pk_add_f32 v[84:85], v[84:85], v[86:87]
  v_cvt_pk_bf16_f32 v55, v84, v85
  buffer_store_dwordx4 v[52:55], v4, s[4:7], s41 offen sc1
  s_add_u32 s42, s42, s62
  s_add_u32 s43, s42, 4096
  s_add_u32 s23, s23, 524288
  s_add_u32 s25, s25, 262144
  s_add_u32 s63, s63, 512
  s_add_u32 s64, s64, 512
  s_buffer_load_dword s65, s[4:7], s63 glc
  v_mov_b64 v[56:57], 0
  v_mov_b64 v[58:59], 0
  v_mov_b64 v[60:61], 0
  v_mov_b64 v[62:63], 0
  v_mov_b64 v[48:49], 0
  v_mov_b64 v[50:51], 0
  v_mov_b64 v[52:53], 0
  v_mov_b64 v[54:55], 0
  s_cmp_lg_u32 s17, 0
  s_cbranch_scc1 c_oth_37
  s_mov_b32 s28, 0
  s_add_u32 s46, s46, 1
  v_mov_b64 v[120:121], -1
  s_xor_b32 s34, s42, 16384
  buffer_store_dwordx2 v[120:121], v5, s[4:7], s34 offen sc1
  s_mov_b32 vcc_lo, 0xaaaaaaaa
  s_mov_b32 vcc_hi, 0xaaaaaaaa
  v_mov_b32 v7, 0x3f80
  v_cndmask_b32 v7, v7, 1.0, vcc
  s_mov_b32 vcc_lo, 0x30003
  s_mov_b32 vcc_hi, 0x30003
  v_cndmask_b32 v68, 0, v7, vcc
  s_mov_b32 vcc_lo, 0xc000c
  s_mov_b32 vcc_hi, 0xc000c
  v_cndmask_b32 v69, 0, v7, vcc
  s_mov_b32 vcc_lo, 0x300030
  s_mov_b32 vcc_hi, 0x300030
  v_cndmask_b32 v70, 0, v7, vcc
  s_mov_b32 vcc_lo, 0xc000c0
  s_mov_b32 vcc_hi, 0xc000c0
  v_cndmask_b32 v71, 0, v7, vcc
  s_nop 15
  s_nop 15
  s_nop 15
  s_nop 15
  s_nop 5
  buffer_load_dwordx4 v[16:19], v0, s[4:7], s38 offen offset:0 sc1
  buffer_load_dwordx4 v[20:23], v0, s[4:7], s38 offen offset:1024 sc1
  buffer_load_dwordx4 v[24:27], v0, s[4:7], s38 offen offset:2048 sc1
  buffer_load_dwordx4 v[28:31], v0, s[4:7], s38 offen offset:3072 sc1
  buffer_load_dwordx4 v[32:35], v0, s[4:7], s39 offen offset:0 sc1
  buffer_load_dwordx4 v[36:39], v0, s[4:7], s39 offen offset:1024 sc1
  buffer_load_dwordx4 v[40:43], v0, s[4:7], s39 offen offset:2048 sc1
  buffer_load_dwordx4 v[44:47], v0, s[4:7], s39 offen offset:3072 sc1
  s_nop 14
  buffer_load_dwordx4 v[72:75], v0, s[4:7], s38 offen offset:0 sc1
  buffer_load_dwordx4 v[76:79], v0, s[4:7], s38 offen offset:1024 sc1
  buffer_load_dwordx4 v[80:83], v0, s[4:7], s38 offen offset:2048 sc1
  buffer_load_dwordx4 v[84:87], v0, s[4:7], s38 offen offset:3072 sc1
  buffer_load_dwordx4 v[88:91], v0, s[4:7], s39 offen offset:0 sc1
  buffer_load_dwordx4 v[92:95], v0, s[4:7], s39 offen offset:1024 sc1
  buffer_load_dwordx4 v[96:99], v0, s[4:7], s39 offen offset:2048 sc1
  buffer_load_dwordx4 v[100:103], v0, s[4:7], s39 offen offset:3072 sc1
  s_waitcnt vmcnt(15)
  v_mfma_f32_16x16x32_bf16 v[64:67], v[16:19], v[68:71], 0
  v_xor_b32 v7, s3, v16
  s_waitcnt vmcnt(14)
  v_mfma_f32_16x16x32_bf16 v[64:67], v[20:23], v[68:71], v[64:67]
  v_bitop3_b32 v7, v7, v20, s3 bitop3:0xf6
  s_waitcnt vmcnt(13)
  v_mfma_f32_16x16x32_bf16 v[64:67], v[24:27], v[68:71], v[64:67]
  v_bitop3_b32 v7, v7, v24, s3 bitop3:0xf6
  s_waitcnt vmcnt(12)
  v_mfma_f32_16x16x32_bf16 v[64:67], v[28:31], v[68:71], v[64:67]
  v_bitop3_b32 v7, v7, v28, s3 bitop3:0xf6
  s_waitcnt vmcnt(11)
  v_mfma_f32_16x16x32_bf16 v[64:67], v[32:35], v[68:71], v[64:67]
  v_bitop3_b32 v7, v7, v32, s3 bitop3:0xf6
  s_waitcnt vmcnt(10)
  v_mfma_f32_16x16x32_bf16 v[64:67], v[36:39], v[68:71], v[64:67]
  v_bitop3_b32 v7, v7, v36, s3 bitop3:0xf6
  s_waitcnt vmcnt(9)
  v_mfma_f32_16x16x32_bf16 v[64:67], v[40:43], v[68:71], v[64:67]
  v_bitop3_b32 v7, v7, v40, s3 bitop3:0xf6
  s_waitcnt vmcnt(8)
  v_mfma_f32_16x16x32_bf16 v[64:67], v[44:47], v[68:71], v[64:67]
  v_bitop3_b32 v7, v7, v44, s3 bitop3:0xf6
  v_and_b32 v7, 1, v7
  v_cmp_ne_u32 vcc, 0, v7
  v_mov_b32 v7, 0
  v_mov_b32 v7, 0
  s_cbranch_vccnz c_p1r_38
c_publ_39:
  s_nop 1
  v_cvt_pk_bf16_f32 v64, v64, v65
  v_cvt_pk_bf16_f32 v65, v66, v67
  v_min_u32 v64, -2, v64
  v_min_u32 v65, -2, v65
  buffer_store_dwordx2 v[64:65], v5, s[4:7], s42 offen sc1
c_hop2_27:
  s_barrier
  s_nop 15
  s_nop 13
  s_branch c_loop_24
c_kvs_35:
  s_cmp_ge_u32 s22, 63
  s_cbranch_scc1 c_kvr_36
  s_mov_b32 s29, 0
c_kvw_40:
  s_buffer_load_dword s65, s[4:7], s63 glc
  s_add_u32 s29, s29, 1
  s_cmp_gt_u32 s29, 1048576
  s_cbranch_scc1 c_fail_30
  s_waitcnt lgkmcnt(0)
  s_cmp_eq_u32 s65, 0
  s_cbranch_scc1 c_kvw_40
  s_branch c_kvr_36
c_last_31:
  s_add_u32 s64, s64, 512
  v_mov_b32 v7, 1
  s_waitcnt vmcnt(0)
  s_mov_b64 exec, 1
  buffer_store_dword v7, off, s[4:7], s64 sc1
  s_mov_b64 exec, -1
  s_branch c_fail_30
c_oth_37:
  ds_read_b128 v[24:27], v1 offset:0
  ds_read_b128 v[28:31], v1 offset:1024
  ds_read_b128 v[32:35], v1 offset:2048
  ds_read_b128 v[36:39], v1 offset:3072
  ds_read_b128 v[40:43], v1 offset:4096
  ds_read_b128 v[44:47], v1 offset:5120
  ds_read_b128 v[72:75], v1 offset:6144
  ds_read_b128 v[76:79], v1 offset:7168
  ds_read_b128 v[80:83], v1 offset:8192
  ds_read_b128 v[84:87], v1 offset:9216
  ds_read_b128 v[88:91], v1 offset:10240
  ds_read_b128 v[92:95], v1 offset:11264
  ds_read_b128 v[96:99], v1 offset:12288
  ds_read_b128 v[100:103], v1 offset:13312
  ds_read_b128 v[104:107], v1 offset:14336
  ds_read_b128 v[108:111], v1 offset:15360
  ds_read_b128 v[112:115], v1 offset:16384
  ds_read_b128 v[116:119], v1 offset:17408
  ds_read_b128 v[120:123], v1 offset:18432
  ds_read_b128 v[124:127], v1 offset:19456
  v_mov_b64 v[64:65], 0
  v_mov_b64 v[66:67], 0
  v_mov_b64 v[68:69], 0
  v_mov_b64 v[70:71], 0
  s_branch c_hop2_27
c_w0a_33:
  s_waitcnt vmcnt(3)
  ds_read_b128 v[24:27], v1 offset:0
  ds_read_b128 v[28:31], v1 offset:1024
  ds_read_b128 v[32:35], v1 offset:2048
  ds_read_b128 v[36:39], v1 offset:3072
  ds_read_b128 v[40:43], v1 offset:4096
  ds_read_b128 v[44:47], v1 offset:5120
  ds_read_b128 v[72:75], v1 offset:6144
  ds_read_b128 v[76:79], v1 offset:7168
  ds_read_b128 v[80:83], v1 offset:8192
  ds_read_b128 v[84:87], v1 offset:9216
  buffer_load_dwordx4 v[16:19], v8, s[4:7], s42 offen sc1
  buffer_load_dwordx4 v[20:23], v8, s[4:7], s43 offen sc1
  ds_read_b128 v[88:91], v1 offset:10240
  ds_read_b128 v[92:95], v1 offset:11264
  ds_read_b128 v[96:99], v1 offset:12288
  ds_read_b128 v[100:103], v1 offset:13312
  ds_read_b128 v[104:107], v1 offset:14336
  ds_read_b128 v[108:111], v1 offset:15360
  ds_read_b128 v[112:115], v1 offset:16384
  ds_read_b128 v[116:119], v1 offset:17408
  ds_read_b128 v[120:123], v1 offset:18432
  ds_read_b128 v[124:127], v1 offset:19456
  buffer_load_dwordx4 v[16:19], v8, s[4:7], s42 offen sc1
  buffer_load_dwordx4 v[20:23], v8, s[4:7], s43 offen sc1
  v_mov_b64 v[64:65], 0
  v_mov_b64 v[66:67], 0
  v_mov_b64 v[68:69], 0
  v_mov_b64 v[70:71], 0
  s_branch c_w0b_34
c_p1r_38:
  buffer_load_dwordx4 v[16:19], v0, s[4:7], s38 offen offset:0 sc1
  buffer_load_dwordx4 v[20:23], v0, s[4:7], s38 offen offset:1024 sc1
  buffer_load_dwordx4 v[24:27], v0, s[4:7], s38 offen offset:2048 sc1
  buffer_load_dwordx4 v[28:31], v0, s[4:7], s38 offen offset:3072 sc1
  buffer_load_dwordx4 v[32:35], v0, s[4:7], s39 offen offset:0 sc1
  buffer_load_dwordx4 v[36:39], v0, s[4:7], s39 offen offset:1024 sc1
  buffer_load_dwordx4 v[40:43], v0, s[4:7], s39 offen offset:2048 sc1
  buffer_load_dwordx4 v[44:47], v0, s[4:7], s39 offen offset:3072 sc1
  s_add_u32 s46, s46, 1
  s_waitcnt vmcnt(15)
  v_mfma_f32_16x16x32_bf16 v[64:67], v[72:75], v[68:71], 0
  v_xor_b32 v7, s3, v72
  s_waitcnt vmcnt(14)
  v_mfma_f32_16x16x32_bf16 v[64:67], v[76:79], v[68:71], v[64:67]
  v_bitop3_b32 v7, v7, v76, s3 bitop3:0xf6
  s_waitcnt vmcnt(13)
  v_mfma_f32_16x16x32_bf16 v[64:67], v[80:83], v[68:71], v[64:67]
  v_bitop3_b32 v7, v7, v80, s3 bitop3:0xf6
  s_waitcnt vmcnt(12)
  v_mfma_f32_16x16x32_bf16 v[64:67], v[84:87], v[68:71], v[64:67]
  v_bitop3_b32 v7, v7, v84, s3 bitop3:0xf6
  s_waitcnt vmcnt(11)
  v_mfma_f32_16x16x32_bf16 v[64:67], v[88:91], v[68:71], v[64:67]
  v_bitop3_b32 v7, v7, v88, s3 bitop3:0xf6
  s_waitcnt vmcnt(10)
  v_mfma_f32_16x16x32_bf16 v[64:67], v[92:95], v[68:71], v[64:67]
  v_bitop3_b32 v7, v7, v92, s3 bitop3:0xf6
  s_waitcnt vmcnt(9)
  v_mfma_f32_16x16x32_bf16 v[64:67], v[96:99], v[68:71], v[64:67]
  v_bitop3_b32 v7, v7, v96, s3 bitop3:0xf6
  s_waitcnt vmcnt(8)
  v_mfma_f32_16x16x32_bf16 v[64:67], v[100:103], v[68:71], v[64:67]
  v_bitop3_b32 v7, v7, v100, s3 bitop3:0xf6
  v_and_b32 v7, 1, v7
  v_cmp_ne_u32 vcc, 0, v7
  v_mov_b32 v7, 0
  v_mov_b32 v7, 0
  s_cbranch_vccnz c_p1s_41
  s_branch c_publ_39
c_p1s_41:
  buffer_load_dwordx4 v[72:75], v0, s[4:7], s38 offen offset:0 sc1
  buffer_load_dwordx4 v[76:79], v0, s[4:7], s38 offen offset:1024 sc1
  buffer_load_dwordx4 v[80:83], v0, s[4:7], s38 offen offset:2048 sc1
  buffer_load_dwordx4 v[84:87], v0, s[4:7], s38 offen offset:3072 sc1
  buffer_load_dwordx4 v[88:91], v0, s[4:7], s39 offen offset:0 sc1
  buffer_load_dwordx4 v[92:95], v0, s[4:7], s39 offen offset:1024 sc1
  buffer_load_dwordx4 v[96:99], v0, s[4:7], s39 offen offset:2048 sc1
  buffer_load_dwordx4 v[100:103], v0, s[4:7], s39 offen offset:3072 sc1
  s_add_u32 s28, s28, 1
  s_add_u32 s46, s46, 1
  s_cmp_gt_u32 s28, 1048576
  s_cbranch_scc1 c_fail_30
  s_waitcnt vmcnt(15)
  v_mfma_f32_16x16x32_bf16 v[64:67], v[16:19], v[68:71], 0
  v_xor_b32 v7, s3, v16
  s_waitcnt vmcnt(14)
  v_mfma_f32_16x16x32_bf16 v[64:67], v[20:23], v[68:71], v[64:67]
  v_bitop3_b32 v7, v7, v20, s3 bitop3:0xf6
  s_waitcnt vmcnt(13)
  v_mfma_f32_16x16x32_bf16 v[64:67], v[24:27], v[68:71], v[64:67]
  v_bitop3_b32 v7, v7, v24, s3 bitop3:0xf6
  s_waitcnt vmcnt(12)
  v_mfma_f32_16x16x32_bf16 v[64:67], v[28:31], v[68:71], v[64:67]
  v_bitop3_b32 v7, v7, v28, s3 bitop3:0xf6
  s_waitcnt vmcnt(11)
  v_mfma_f32_16x16x32_bf16 v[64:67], v[32:35], v[68:71], v[64:67]
  v_bitop3_b32 v7, v7, v32, s3 bitop3:0xf6
  s_waitcnt vmcnt(10)
  v_mfma_f32_16x16x32_bf16 v[64:67], v[36:39], v[68:71], v[64:67]
  v_bitop3_b32 v7, v7, v36, s3 bitop3:0xf6
  s_waitcnt vmcnt(9)
  v_mfma_f32_16x16x32_bf16 v[64:67], v[40:43], v[68:71], v[64:67]
  v_bitop3_b32 v7, v7, v40, s3 bitop3:0xf6
  s_waitcnt vmcnt(8)
  v_mfma_f32_16x16x32_bf16 v[64:67], v[44:47], v[68:71], v[64:67]
  v_bitop3_b32 v7, v7, v44, s3 bitop3:0xf6
  v_and_b32 v7, 1, v7
  v_cmp_ne_u32 vcc, 0, v7
  v_mov_b32 v7, 0
  v_mov_b32 v7, 0
  s_cbranch_vccnz c_p1r_38
  s_branch c_publ_39
c_retry_25:
  buffer_load_dwordx4 v[16:19], v8, s[4:7], s42 offen sc1
  buffer_load_dwordx4 v[20:23], v8, s[4:7], s43 offen sc1
  s_add_u32 s28, s28, 1
  s_add_u32 s47, s47, 1
  s_cmp_gt_u32 s28, 1048576
  s_cbranch_scc1 c_fail_30
  v_mov_b64 v[48:49], 0
  v_mov_b64 v[50:51], 0
  v_mov_b64 v[52:53], 0
  v_mov_b64 v[54:55], 0
  v_mov_b64 v[56:57], 0
  v_mov_b64 v[58:59], 0
  s_waitcnt vmcnt(4)
  v_max3_u32 v7, v16, v17, v18
  v_max_u32 v7, v7, v19
  ds_write_b128 v8, v[16:19] offset:0
  v_smfmac_f32_16x16x64_bf16 v[48:51], v[16:19], v[24:31], v6
  s_branch c_got_26
c_fb_28:
  v_max3_f32 v7, v48, v49, v50
  v_max_f32 v7, v51, v7
  s_mov_b64 exec, s[18:19]
  v_max3_f32 v7, v16, v17, v7
  s_mov_b64 exec, -1
  s_nop 0
  v_max_f32_dpp v7, v7, v7 quad_perm:[2,3,0,1] row_mask:0xf bank_mask:0xf
  v_mov_b32 v24, v7
  s_nop 0
  s_nop 0
  v_permlane16_swap_b32 v7, v24
  v_max_f32 v7, v7, v24
  v_mov_b32 v24, v7
  s_nop 0
  s_nop 0
  v_permlane32_swap_b32 v7, v24
  v_max_f32 v7, v7, v24
  v_sub_f32 v24, v48, v7
  v_sub_f32 v25, v49, v7
  v_sub_f32 v26, v50, v7
  v_sub_f32 v27, v51, v7
  v_sub_f32 v28, v16, v7
  v_sub_f32 v29, v17, v7
  v_exp_f32 v24, v24
  v_exp_f32 v25, v25
  v_exp_f32 v26, v26
  v_exp_f32 v27, v27
  v_exp_f32 v28, v28
  v_exp_f32 v29, v29
  v_cvt_pk_bf16_f32 v24, v24, v25
  v_cvt_pk_bf16_f32 v25, v26, v27
  v_cvt_pk_bf16_f32 v28, v28, v29
  v_cndmask_b32 v72, v24, 0, s[18:19]
  v_cndmask_b32 v73, v25, 0, s[18:19]
  v_cndmask_b32 v74, 0, v24, s[18:19]
  v_cndmask_b32 v75, 0, v25, s[18:19]
  v_cndmask_b32 v77, 0, v28, s[18:19]
  v_cndmask_b32 v78, 0, v28, s[18:19]
  v_mfma_f32_16x16x32_bf16 v[60:63], v[72:75], v[20:23], 0
  v_mfma_f32_16x16x32_bf16 v[52:55], v[72:75], v[80:83], 0
  v_mfma_f32_16x16x32_bf16 v[56:59], v[72:75], v[84:87], 0
  s_nop 5
  v_mfma_f32_16x16x16_bf16 v[60:63], v[76:77], v[20:21], v[60:63]
  v_mfma_f32_16x16x16_bf16 v[52:55], v[78:79], v[66:67], v[52:55]
  v_mfma_f32_16x16x16_bf16 v[56:59], v[76:77], v[66:67], v[56:59]
  s_nop 7
  v_add_f32 v60, v60, v62
  v_add_f32 v61, v61, v63
  s_branch c_fbr_29
c_fail_30:
  s_endpgm
L_qkv:
  s_sub_u32 s26, s90, 96
  s_mul_i32 s16, s26, 171
  s_lshr_b32 s16, s16, 9
  s_mul_i32 s27, s16, 3
  s_sub_u32 s60, s26, s27
  v_and_b32 v19, 63, v0
  v_and_b32 v17, 15, v19
  v_lshrrev_b32 v18, 4, v19
  v_lshlrev_b32 v1, 2, v19
  v_and_b32 v1, 127, v1
  v_lshlrev_b32 v0, 4, v19
  v_mov_b32 v4, 1
  v_mov_b32 v5, 0
  s_mov_b32 s24, 0x3e0293ee
  s_mov_b32 s44, 0x05040100
  s_mov_b32 s45, 0x07060302
  s_mov_b32 s10, 4194304
  s_mov_b32 s11, 0x20000
  v_lshlrev_b32 v21, 16, v18
  v_lshl_add_u32 v21, v17, 2, v21
  s_lshl_b32 s26, s16, 8
  s_lshl_b32 s27, s17, 6
  s_add_u32 s26, s26, s27
  s_load_dwordx2 s[8:9], s[0:1], 24
  s_waitcnt lgkmcnt(0)
  s_add_u32 s27, s26, 0
  buffer_load_dword v24, v21, s[8:11], s27 offen
  s_add_u32 s27, s26, 8192
  buffer_load_dword v25, v21, s[8:11], s27 offen
  s_add_u32 s27, s26, 16384
  buffer_load_dword v26, v21, s[8:11], s27 offen
  s_add_u32 s27, s26, 24576
  buffer_load_dword v27, v21, s[8:11], s27 offen
  s_add_u32 s27, s26, 32768
  buffer_load_dword v28, v21, s[8:11], s27 offen
  s_add_u32 s27, s26, 40960
  buffer_load_dword v29, v21, s[8:11], s27 offen
  s_add_u32 s27, s26, 49152
  buffer_load_dword v30, v21, s[8:11], s27 offen
  s_add_u32 s27, s26, 57344
  buffer_load_dword v31, v21, s[8:11], s27 offen
  s_add_u32 s27, s26, 262144
  buffer_load_dword v32, v21, s[8:11], s27 offen
  s_add_u32 s27, s26, 270336
  buffer_load_dword v33, v21, s[8:11], s27 offen
  s_add_u32 s27, s26, 278528
  buffer_load_dword v34, v21, s[8:11], s27 offen
  s_add_u32 s27, s26, 286720
  buffer_load_dword v35, v21, s[8:11], s27 offen
  s_add_u32 s27, s26, 294912
  buffer_load_dword v36, v21, s[8:11], s27 offen
  s_add_u32 s27, s26, 303104
  buffer_load_dword v37, v21, s[8:11], s27 offen
  s_add_u32 s27, s26, 311296
  buffer_load_dword v38, v21, s[8:11], s27 offen
  s_add_u32 s27, s26, 319488
  buffer_load_dword v39, v21, s[8:11], s27 offen
  s_add_u32 s27, s26, 524288
  buffer_load_dword v40, v21, s[8:11], s27 offen
  s_add_u32 s27, s26, 532480
  buffer_load_dword v41, v21, s[8:11], s27 offen
  s_add_u32 s27, s26, 540672
  buffer_load_dword v42, v21, s[8:11], s27 offen
  s_add_u32 s27, s26, 548864
  buffer_load_dword v43, v21, s[8:11], s27 offen
  s_add_u32 s27, s26, 557056
  buffer_load_dword v44, v21, s[8:11], s27 offen
  s_add_u32 s27, s26, 565248
  buffer_load_dword v45, v21, s[8:11], s27 offen
  s_add_u32 s27, s26, 573440
  buffer_load_dword v46, v21, s[8:11], s27 offen
  s_add_u32 s27, s26, 581632
  buffer_load_dword v47, v21, s[8:11], s27 offen
  s_add_u32 s27, s26, 786432
  buffer_load_dword v48, v21, s[8:11], s27 offen
  s_add_u32 s27, s26, 794624
  buffer_load_dword v49, v21, s[8:11], s27 offen
  s_add_u32 s27, s26, 802816
  buffer_load_dword v50, v21, s[8:11], s27 offen
  s_add_u32 s27, s26, 811008
  buffer_load_dword v51, v21, s[8:11], s27 offen
  s_add_u32 s27, s26, 819200
  buffer_load_dword v52, v21, s[8:11], s27 offen
  s_add_u32 s27, s26, 827392
  buffer_load_dword v53, v21, s[8:11], s27 offen
  s_add_u32 s27, s26, 835584
  buffer_load_dword v54, v21, s[8:11], s27 offen
  s_add_u32 s27, s26, 843776
  buffer_load_dword v55, v21, s[8:11], s27 offen
  s_add_u32 s27, s26, 1048576
  buffer_load_dword v56, v21, s[8:11], s27 offen
  s_add_u32 s27, s26, 1056768
  buffer_load_dword v57, v21, s[8:11], s27 offen
  s_add_u32 s27, s26, 1064960
  buffer_load_dword v58, v21, s[8:11], s27 offen
  s_add_u32 s27, s26, 1073152
  buffer_load_dword v59, v21, s[8:11], s27 offen
  s_add_u32 s27, s26, 1081344
  buffer_load_dword v60, v21, s[8:11], s27 offen
  s_add_u32 s27, s26, 1089536
  buffer_load_dword v61, v21, s[8:11], s27 offen
  s_add_u32 s27, s26, 1097728
  buffer_load_dword v62, v21, s[8:11], s27 offen
  s_add_u32 s27, s26, 1105920
  buffer_load_dword v63, v21, s[8:11], s27 offen
  s_add_u32 s27, s26, 1310720
  buffer_load_dword v64, v21, s[8:11], s27 offen
  s_add_u32 s27, s26, 1318912
  buffer_load_dword v65, v21, s[8:11], s27 offen
  s_add_u32 s27, s26, 1327104
  buffer_load_dword v66, v21, s[8:11], s27 offen
  s_add_u32 s27, s26, 1335296
  buffer_load_dword v67, v21, s[8:11], s27 offen
  s_add_u32 s27, s26, 1343488
  buffer_load_dword v68, v21, s[8:11], s27 offen
  s_add_u32 s27, s26, 1351680
  buffer_load_dword v69, v21, s[8:11], s27 offen
  s_add_u32 s27, s26, 1359872
  buffer_load_dword v70, v21, s[8:11], s27 offen
  s_add_u32 s27, s26, 1368064
  buffer_load_dword v71, v21, s[8:11], s27 offen
  s_add_u32 s27, s26, 1572864
  buffer_load_dword v72, v21, s[8:11], s27 offen
  s_add_u32 s27, s26, 1581056
  buffer_load_dword v73, v21, s[8:11], s27 offen
  s_add_u32 s27, s26, 1589248
  buffer_load_dword v74, v21, s[8:11], s27 offen
  s_add_u32 s27, s26, 1597440
  buffer_load_dword v75, v21, s[8:11], s27 offen
  s_add_u32 s27, s26, 1605632
  buffer_load_dword v76, v21, s[8:11], s27 offen
  s_add_u32 s27, s26, 1613824
  buffer_load_dword v77, v21, s[8:11], s27 offen
  s_add_u32 s27, s26, 1622016
  buffer_load_dword v78, v21, s[8:11], s27 offen
  s_add_u32 s27, s26, 1630208
  buffer_load_dword v79, v21, s[8:11], s27 offen
  s_add_u32 s27, s26, 1835008
  buffer_load_dword v80, v21, s[8:11], s27 offen
  s_add_u32 s27, s26, 1843200
  buffer_load_dword v81, v21, s[8:11], s27 offen
  s_add_u32 s27, s26, 1851392
  buffer_load_dword v82, v21, s[8:11], s27 offen
  s_add_u32 s27, s26, 1859584
  buffer_load_dword v83, v21, s[8:11], s27 offen
  s_add_u32 s27, s26, 1867776
  buffer_load_dword v84, v21, s[8:11], s27 offen
  s_add_u32 s27, s26, 1875968
  buffer_load_dword v85, v21, s[8:11], s27 offen
  s_add_u32 s27, s26, 1884160
  buffer_load_dword v86, v21, s[8:11], s27 offen
  s_add_u32 s27, s26, 1892352
  buffer_load_dword v87, v21, s[8:11], s27 offen
  s_waitcnt vmcnt(48)
  v_perm_b32 v128, v25, v24, s44
  v_perm_b32 v129, v27, v26, s44
  v_perm_b32 v130, v29, v28, s44
  v_perm_b32 v131, v31, v30, s44
  v_perm_b32 v192, v25, v24, s45
  v_perm_b32 v193, v27, v26, s45
  v_perm_b32 v194, v29, v28, s45
  v_perm_b32 v195, v31, v30, s45
  v_perm_b32 v132, v33, v32, s44
  v_perm_b32 v133, v35, v34, s44
  v_perm_b32 v134, v37, v36, s44
  v_perm_b32 v135, v39, v38, s44
  v_perm_b32 v196, v33, v32, s45
  v_perm_b32 v197, v35, v34, s45
  v_perm_b32 v198, v37, v36, s45
  v_perm_b32 v199, v39, v38, s45
  s_add_u32 s27, s26, 2097152
  buffer_load_dword v88, v21, s[8:11], s27 offen
  s_add_u32 s27, s26, 2105344
  buffer_load_dword v89, v21, s[8:11], s27 offen
  s_add_u32 s27, s26, 2113536
  buffer_load_dword v90, v21, s[8:11], s27 offen
  s_add_u32 s27, s26, 2121728
  buffer_load_dword v91, v21, s[8:11], s27 offen
  s_add_u32 s27, s26, 2129920
  buffer_load_dword v92, v21, s[8:11], s27 offen
  s_add_u32 s27, s26, 2138112
  buffer_load_dword v93, v21, s[8:11], s27 offen
  s_add_u32 s27, s26, 2146304
  buffer_load_dword v94, v21, s[8:11], s27 offen
  s_add_u32 s27, s26, 2154496
  buffer_load_dword v95, v21, s[8:11], s27 offen
  s_add_u32 s27, s26, 2359296
  buffer_load_dword v96, v21, s[8:11], s27 offen
  s_add_u32 s27, s26, 2367488
  buffer_load_dword v97, v21, s[8:11], s27 offen
  s_add_u32 s27, s26, 2375680
  buffer_load_dword v98, v21, s[8:11], s27 offen
  s_add_u32 s27, s26, 2383872
  buffer_load_dword v99, v21, s[8:11], s27 offen
  s_add_u32 s27, s26, 2392064
  buffer_load_dword v100, v21, s[8:11], s27 offen
  s_add_u32 s27, s26, 2400256
  buffer_load_dword v101, v21, s[8:11], s27 offen
  s_add_u32 s27, s26, 2408448
  buffer_load_dword v102, v21, s[8:11], s27 offen
  s_add_u32 s27, s26, 2416640
  buffer_load_dword v103, v21, s[8:11], s27 offen
  s_waitcnt vmcnt(48)
  v_perm_b32 v136, v41, v40, s44
  v_perm_b32 v137, v43, v42, s44
  v_perm_b32 v138, v45, v44, s44
  v_perm_b32 v139, v47, v46, s44
  v_perm_b32 v200, v41, v40, s45
  v_perm_b32 v201, v43, v42, s45
  v_perm_b32 v202, v45, v44, s45
  v_perm_b32 v203, v47, v46, s45
  v_perm_b32 v140, v49, v48, s44
  v_perm_b32 v141, v51, v50, s44
  v_perm_b32 v142, v53, v52, s44
  v_perm_b32 v143, v55, v54, s44
  v_perm_b32 v204, v49, v48, s45
  v_perm_b32 v205, v51, v50, s45
  v_perm_b32 v206, v53, v52, s45
  v_perm_b32 v207, v55, v54, s45
  s_add_u32 s27, s26, 2621440
  buffer_load_dword v104, v21, s[8:11], s27 offen
  s_add_u32 s27, s26, 2629632
  buffer_load_dword v105, v21, s[8:11], s27 offen
  s_add_u32 s27, s26, 2637824
  buffer_load_dword v106, v21, s[8:11], s27 offen
  s_add_u32 s27, s26, 2646016
  buffer_load_dword v107, v21, s[8:11], s27 offen
  s_add_u32 s27, s26, 2654208
  buffer_load_dword v108, v21, s[8:11], s27 offen
  s_add_u32 s27, s26, 2662400
  buffer_load_dword v109, v21, s[8:11], s27 offen
  s_add_u32 s27, s26, 2670592
  buffer_load_dword v110, v21, s[8:11], s27 offen
  s_add_u32 s27, s26, 2678784
  buffer_load_dword v111, v21, s[8:11], s27 offen
  s_add_u32 s27, s26, 2883584
  buffer_load_dword v112, v21, s[8:11], s27 offen
  s_add_u32 s27, s26, 2891776
  buffer_load_dword v113, v21, s[8:11], s27 offen
  s_add_u32 s27, s26, 2899968
  buffer_load_dword v114, v21, s[8:11], s27 offen
  s_add_u32 s27, s26, 2908160
  buffer_load_dword v115, v21, s[8:11], s27 offen
  s_add_u32 s27, s26, 2916352
  buffer_load_dword v116, v21, s[8:11], s27 offen
  s_add_u32 s27, s26, 2924544
  buffer_load_dword v117, v21, s[8:11], s27 offen
  s_add_u32 s27, s26, 2932736
  buffer_load_dword v118, v21, s[8:11], s27 offen
  s_add_u32 s27, s26, 2940928
  buffer_load_dword v119, v21, s[8:11], s27 offen
  s_waitcnt vmcnt(48)
  v_perm_b32 v144, v57, v56, s44
  v_perm_b32 v145, v59, v58, s44
  v_perm_b32 v146, v61, v60, s44
  v_perm_b32 v147, v63, v62, s44
  v_perm_b32 v208, v57, v56, s45
  v_perm_b32 v209, v59, v58, s45
  v_perm_b32 v210, v61, v60, s45
  v_perm_b32 v211, v63, v62, s45
  v_perm_b32 v148, v65, v64, s44
  v_perm_b32 v149, v67, v66, s44
  v_perm_b32 v150, v69, v68, s44
  v_perm_b32 v151, v71, v70, s44
  v_perm_b32 v212, v65, v64, s45
  v_perm_b32 v213, v67, v66, s45
  v_perm_b32 v214, v69, v68, s45
  v_perm_b32 v215, v71, v70, s45
  s_add_u32 s27, s26, 3145728
  buffer_load_dword v24, v21, s[8:11], s27 offen
  s_add_u32 s27, s26, 3153920
  buffer_load_dword v25, v21, s[8:11], s27 offen
  s_add_u32 s27, s26, 3162112
  buffer_load_dword v26, v21, s[8:11], s27 offen
  s_add_u32 s27, s26, 3170304
  buffer_load_dword v27, v21, s[8:11], s27 offen
  s_add_u32 s27, s26, 3178496
  buffer_load_dword v28, v21, s[8:11], s27 offen
  s_add_u32 s27, s26, 3186688
  buffer_load_dword v29, v21, s[8:11], s27 offen
  s_add_u32 s27, s26, 3194880
  buffer_load_dword v30, v21, s[8:11], s27 offen
  s_add_u32 s27, s26, 3203072
  buffer_load_dword v31, v21, s[8:11], s27 offen
  s_add_u32 s27, s26, 3407872
  buffer_load_dword v32, v21, s[8:11], s27 offen
  s_add_u32 s27, s26, 3416064
  buffer_load_dword v33, v21, s[8:11], s27 offen
  s_add_u32 s27, s26, 3424256
  buffer_load_dword v34, v21, s[8:11], s27 offen
  s_add_u32 s27, s26, 3432448
  buffer_load_dword v35, v21, s[8:11], s27 offen
  s_add_u32 s27, s26, 3440640
  buffer_load_dword v36, v21, s[8:11], s27 offen
  s_add_u32 s27, s26, 3448832
  buffer_load_dword v37, v21, s[8:11], s27 offen
  s_add_u32 s27, s26, 3457024
  buffer_load_dword v38, v21, s[8:11], s27 offen
  s_add_u32 s27, s26, 3465216
  buffer_load_dword v39, v21, s[8:11], s27 offen
  s_waitcnt vmcnt(48)
  v_perm_b32 v152, v73, v72, s44
  v_perm_b32 v153, v75, v74, s44
  v_perm_b32 v154, v77, v76, s44
  v_perm_b32 v155, v79, v78, s44
  v_perm_b32 v216, v73, v72, s45
  v_perm_b32 v217, v75, v74, s45
  v_perm_b32 v218, v77, v76, s45
  v_perm_b32 v219, v79, v78, s45
  v_perm_b32 v156, v81, v80, s44
  v_perm_b32 v157, v83, v82, s44
  v_perm_b32 v158, v85, v84, s44
  v_perm_b32 v159, v87, v86, s44
  v_perm_b32 v220, v81, v80, s45
  v_perm_b32 v221, v83, v82, s45
  v_perm_b32 v222, v85, v84, s45
  v_perm_b32 v223, v87, v86, s45
  s_add_u32 s27, s26, 3670016
  buffer_load_dword v40, v21, s[8:11], s27 offen
  s_add_u32 s27, s26, 3678208
  buffer_load_dword v41, v21, s[8:11], s27 offen
  s_add_u32 s27, s26, 3686400
  buffer_load_dword v42, v21, s[8:11], s27 offen
  s_add_u32 s27, s26, 3694592
  buffer_load_dword v43, v21, s[8:11], s27 offen
  s_add_u32 s27, s26, 3702784
  buffer_load_dword v44, v21, s[8:11], s27 offen
  s_add_u32 s27, s26, 3710976
  buffer_load_dword v45, v21, s[8:11], s27 offen
  s_add_u32 s27, s26, 3719168
  buffer_load_dword v46, v21, s[8:11], s27 offen
  s_add_u32 s27, s26, 3727360
  buffer_load_dword v47, v21, s[8:11], s27 offen
  s_add_u32 s27, s26, 3932160
  buffer_load_dword v48, v21, s[8:11], s27 offen
  s_add_u32 s27, s26, 3940352
  buffer_load_dword v49, v21, s[8:11], s27 offen
  s_add_u32 s27, s26, 3948544
  buffer_load_dword v50, v21, s[8:11], s27 offen
  s_add_u32 s27, s26, 3956736
  buffer_load_dword v51, v21, s[8:11], s27 offen
  s_add_u32 s27, s26, 3964928
  buffer_load_dword v52, v21, s[8:11], s27 offen
  s_add_u32 s27, s26, 3973120
  buffer_load_dword v53, v21, s[8:11], s27 offen
  s_add_u32 s27, s26, 3981312
  buffer_load_dword v54, v21, s[8:11], s27 offen
  s_add_u32 s27, s26, 3989504
  buffer_load_dword v55, v21, s[8:11], s27 offen
  s_waitcnt vmcnt(48)
  v_perm_b32 v160, v89, v88, s44
  v_perm_b32 v161, v91, v90, s44
  v_perm_b32 v162, v93, v92, s44
  v_perm_b32 v163, v95, v94, s44
  v_perm_b32 v224, v89, v88, s45
  v_perm_b32 v225, v91, v90, s45
  v_perm_b32 v226, v93, v92, s45
  v_perm_b32 v227, v95, v94, s45
  v_perm_b32 v164, v97, v96, s44
  v_perm_b32 v165, v99, v98, s44
  v_perm_b32 v166, v101, v100, s44
  v_perm_b32 v167, v103, v102, s44
  v_perm_b32 v228, v97, v96, s45
  v_perm_b32 v229, v99, v98, s45
  v_perm_b32 v230, v101, v100, s45
  v_perm_b32 v231, v103, v102, s45
  s_load_dwordx2 s[8:9], s[0:1], 32
  s_waitcnt lgkmcnt(0)
  s_add_u32 s27, s26, 0
  buffer_load_dword v56, v21, s[8:11], s27 offen
  s_add_u32 s27, s26, 8192
  buffer_load_dword v57, v21, s[8:11], s27 offen
  s_add_u32 s27, s26, 16384
  buffer_load_dword v58, v21, s[8:11], s27 offen
  s_add_u32 s27, s26, 24576
  buffer_load_dword v59, v21, s[8:11], s27 offen
  s_add_u32 s27, s26, 32768
  buffer_load_dword v60, v21, s[8:11], s27 offen
  s_add_u32 s27, s26, 40960
  buffer_load_dword v61, v21, s[8:11], s27 offen
  s_add_u32 s27, s26, 49152
  buffer_load_dword v62, v21, s[8:11], s27 offen
  s_add_u32 s27, s26, 57344
  buffer_load_dword v63, v21, s[8:11], s27 offen
  s_add_u32 s27, s26, 262144
  buffer_load_dword v64, v21, s[8:11], s27 offen
  s_add_u32 s27, s26, 270336
  buffer_load_dword v65, v21, s[8:11], s27 offen
  s_add_u32 s27, s26, 278528
  buffer_load_dword v66, v21, s[8:11], s27 offen
  s_add_u32 s27, s26, 286720
  buffer_load_dword v67, v21, s[8:11], s27 offen
  s_add_u32 s27, s26, 294912
  buffer_load_dword v68, v21, s[8:11], s27 offen
  s_add_u32 s27, s26, 303104
  buffer_load_dword v69, v21, s[8:11], s27 offen
  s_add_u32 s27, s26, 311296
  buffer_load_dword v70, v21, s[8:11], s27 offen
  s_add_u32 s27, s26, 319488
  buffer_load_dword v71, v21, s[8:11], s27 offen
  s_waitcnt vmcnt(48)
  v_perm_b32 v168, v105, v104, s44
  v_perm_b32 v169, v107, v106, s44
  v_perm_b32 v170, v109, v108, s44
  v_perm_b32 v171, v111, v110, s44
  v_perm_b32 v232, v105, v104, s45
  v_perm_b32 v233, v107, v106, s45
  v_perm_b32 v234, v109, v108, s45
  v_perm_b32 v235, v111, v110, s45
  v_perm_b32 v172, v113, v112, s44
  v_perm_b32 v173, v115, v114, s44
  v_perm_b32 v174, v117, v116, s44
  v_perm_b32 v175, v119, v118, s44
  v_perm_b32 v236, v113, v112, s45
  v_perm_b32 v237, v115, v114, s45
  v_perm_b32 v238, v117, v116, s45
  v_perm_b32 v239, v119, v118, s45
  s_add_u32 s27, s26, 524288
  buffer_load_dword v72, v21, s[8:11], s27 offen
  s_add_u32 s27, s26, 532480
  buffer_load_dword v73, v21, s[8:11], s27 offen
  s_add_u32 s27, s26, 540672
  buffer_load_dword v74, v21, s[8:11], s27 offen
  s_add_u32 s27, s26, 548864
  buffer_load_dword v75, v21, s[8:11], s27 offen
  s_add_u32 s27, s26, 557056
  buffer_load_dword v76, v21, s[8:11], s27 offen
  s_add_u32 s27, s26, 565248
  buffer_load_dword v77, v21, s[8:11], s27 offen
  s_add_u32 s27, s26, 573440
  buffer_load_dword v78, v21, s[8:11], s27 offen
  s_add_u32 s27, s26, 581632
  buffer_load_dword v79, v21, s[8:11], s27 offen
  s_add_u32 s27, s26, 786432
  buffer_load_dword v80, v21, s[8:11], s27 offen
  s_add_u32 s27, s26, 794624
  buffer_load_dword v81, v21, s[8:11], s27 offen
  s_add_u32 s27, s26, 802816
  buffer_load_dword v82, v21, s[8:11], s27 offen
  s_add_u32 s27, s26, 811008
  buffer_load_dword v83, v21, s[8:11], s27 offen
  s_add_u32 s27, s26, 819200
  buffer_load_dword v84, v21, s[8:11], s27 offen
  s_add_u32 s27, s26, 827392
  buffer_load_dword v85, v21, s[8:11], s27 offen
  s_add_u32 s27, s26, 835584
  buffer_load_dword v86, v21, s[8:11], s27 offen
  s_add_u32 s27, s26, 843776
  buffer_load_dword v87, v21, s[8:11], s27 offen
  s_waitcnt vmcnt(48)
  v_perm_b32 v176, v25, v24, s44
  v_perm_b32 v177, v27, v26, s44
  v_perm_b32 v178, v29, v28, s44
  v_perm_b32 v179, v31, v30, s44
  v_perm_b32 v240, v25, v24, s45
  v_perm_b32 v241, v27, v26, s45
  v_perm_b32 v242, v29, v28, s45
  v_perm_b32 v243, v31, v30, s45
  v_perm_b32 v180, v33, v32, s44
  v_perm_b32 v181, v35, v34, s44
  v_perm_b32 v182, v37, v36, s44
  v_perm_b32 v183, v39, v38, s44
  v_perm_b32 v244, v33, v32, s45
  v_perm_b32 v245, v35, v34, s45
  v_perm_b32 v246, v37, v36, s45
  v_perm_b32 v247, v39, v38, s45
  s_add_u32 s27, s26, 1048576
  buffer_load_dword v88, v21, s[8:11], s27 offen
  s_add_u32 s27, s26, 1056768
  buffer_load_dword v89, v21, s[8:11], s27 offen
  s_add_u32 s27, s26, 1064960
  buffer_load_dword v90, v21, s[8:11], s27 offen
  s_add_u32 s27, s26, 1073152
  buffer_load_dword v91, v21, s[8:11], s27 offen
  s_add_u32 s27, s26, 1081344
  buffer_load_dword v92, v21, s[8:11], s27 offen
  s_add_u32 s27, s26, 1089536
  buffer_load_dword v93, v21, s[8:11], s27 offen
  s_add_u32 s27, s26, 1097728
  buffer_load_dword v94, v21, s[8:11], s27 offen
  s_add_u32 s27, s26, 1105920
  buffer_load_dword v95, v21, s[8:11], s27 offen
  s_add_u32 s27, s26, 1310720
  buffer_load_dword v96, v21, s[8:11], s27 offen
  s_add_u32 s27, s26, 1318912
  buffer_load_dword v97, v21, s[8:11], s27 offen
  s_add_u32 s27, s26, 1327104
  buffer_load_dword v98, v21, s[8:11], s27 offen
  s_add_u32 s27, s26, 1335296
  buffer_load_dword v99, v21, s[8:11], s27 offen
  s_add_u32 s27, s26, 1343488
  buffer_load_dword v100, v21, s[8:11], s27 offen
  s_add_u32 s27, s26, 1351680
  buffer_load_dword v101, v21, s[8:11], s27 offen
  s_add_u32 s27, s26, 1359872
  buffer_load_dword v102, v21, s[8:11], s27 offen
  s_add_u32 s27, s26, 1368064
  buffer_load_dword v103, v21, s[8:11], s27 offen
  s_waitcnt vmcnt(48)
  v_perm_b32 v184, v41, v40, s44
  v_perm_b32 v185, v43, v42, s44
  v_perm_b32 v186, v45, v44, s44
  v_perm_b32 v187, v47, v46, s44
  v_perm_b32 v248, v41, v40, s45
  v_perm_b32 v249, v43, v42, s45
  v_perm_b32 v250, v45, v44, s45
  v_perm_b32 v251, v47, v46, s45
  v_perm_b32 v188, v49, v48, s44
  v_perm_b32 v189, v51, v50, s44
  v_perm_b32 v190, v53, v52, s44
  v_perm_b32 v191, v55, v54, s44
  v_perm_b32 v252, v49, v48, s45
  v_perm_b32 v253, v51, v50, s45
  v_perm_b32 v254, v53, v52, s45
  v_perm_b32 v255, v55, v54, s45
  s_add_u32 s27, s26, 1572864
  buffer_load_dword v104, v21, s[8:11], s27 offen
  s_add_u32 s27, s26, 1581056
  buffer_load_dword v105, v21, s[8:11], s27 offen
  s_add_u32 s27, s26, 1589248
  buffer_load_dword v106, v21, s[8:11], s27 offen
  s_add_u32 s27, s26, 1597440
  buffer_load_dword v107, v21, s[8:11], s27 offen
  s_add_u32 s27, s26, 1605632
  buffer_load_dword v108, v21, s[8:11], s27 offen
  s_add_u32 s27, s26, 1613824
  buffer_load_dword v109, v21, s[8:11], s27 offen
  s_add_u32 s27, s26, 1622016
  buffer_load_dword v110, v21, s[8:11], s27 offen
  s_add_u32 s27, s26, 1630208
  buffer_load_dword v111, v21, s[8:11], s27 offen
  s_add_u32 s27, s26, 1835008
  buffer_load_dword v112, v21, s[8:11], s27 offen
  s_add_u32 s27, s26, 1843200
  buffer_load_dword v113, v21, s[8:11], s27 offen
  s_add_u32 s27, s26, 1851392
  buffer_load_dword v114, v21, s[8:11], s27 offen
  s_add_u32 s27, s26, 1859584
  buffer_load_dword v115, v21, s[8:11], s27 offen
  s_add_u32 s27, s26, 1867776
  buffer_load_dword v116, v21, s[8:11], s27 offen
  s_add_u32 s27, s26, 1875968
  buffer_load_dword v117, v21, s[8:11], s27 offen
  s_add_u32 s27, s26, 1884160
  buffer_load_dword v118, v21, s[8:11], s27 offen
  s_add_u32 s27, s26, 1892352
  buffer_load_dword v119, v21, s[8:11], s27 offen
  s_waitcnt vmcnt(48)
  v_perm_b32 v120, v57, v56, s44
  v_perm_b32 v121, v59, v58, s44
  v_perm_b32 v122, v61, v60, s44
  v_perm_b32 v123, v63, v62, s44
  v_accvgpr_write_b32 a0, v120
  v_accvgpr_write_b32 a1, v121
  v_accvgpr_write_b32 a2, v122
  v_accvgpr_write_b32 a3, v123
  v_perm_b32 v124, v57, v56, s45
  v_perm_b32 v125, v59, v58, s45
  v_perm_b32 v126, v61, v60, s45
  v_perm_b32 v127, v63, v62, s45
  v_accvgpr_write_b32 a64, v124
  v_accvgpr_write_b32 a65, v125
  v_accvgpr_write_b32 a66, v126
  v_accvgpr_write_b32 a67, v127
  v_perm_b32 v120, v65, v64, s44
  v_perm_b32 v121, v67, v66, s44
  v_perm_b32 v122, v69, v68, s44
  v_perm_b32 v123, v71, v70, s44
  v_accvgpr_write_b32 a4, v120
  v_accvgpr_write_b32 a5, v121
  v_accvgpr_write_b32 a6, v122
  v_accvgpr_write_b32 a7, v123
  v_perm_b32 v124, v65, v64, s45
  v_perm_b32 v125, v67, v66, s45
  v_perm_b32 v126, v69, v68, s45
  v_perm_b32 v127, v71, v70, s45
  v_accvgpr_write_b32 a68, v124
  v_accvgpr_write_b32 a69, v125
  v_accvgpr_write_b32 a70, v126
  v_accvgpr_write_b32 a71, v127
  s_add_u32 s27, s26, 2097152
  buffer_load_dword v24, v21, s[8:11], s27 offen
  s_add_u32 s27, s26, 2105344
  buffer_load_dword v25, v21, s[8:11], s27 offen
  s_add_u32 s27, s26, 2113536
  buffer_load_dword v26, v21, s[8:11], s27 offen
  s_add_u32 s27, s26, 2121728
  buffer_load_dword v27, v21, s[8:11], s27 offen
  s_add_u32 s27, s26, 2129920
  buffer_load_dword v28, v21, s[8:11], s27 offen
  s_add_u32 s27, s26, 2138112
  buffer_load_dword v29, v21, s[8:11], s27 offen
  s_add_u32 s27, s26, 2146304
  buffer_load_dword v30, v21, s[8:11], s27 offen
  s_add_u32 s27, s26, 2154496
  buffer_load_dword v31, v21, s[8:11], s27 offen
  s_add_u32 s27, s26, 2359296
  buffer_load_dword v32, v21, s[8:11], s27 offen
  s_add_u32 s27, s26, 2367488
  buffer_load_dword v33, v21, s[8:11], s27 offen
  s_add_u32 s27, s26, 2375680
  buffer_load_dword v34, v21, s[8:11], s27 offen
  s_add_u32 s27, s26, 2383872
  buffer_load_dword v35, v21, s[8:11], s27 offen
  s_add_u32 s27, s26, 2392064
  buffer_load_dword v36, v21, s[8:11], s27 offen
  s_add_u32 s27, s26, 2400256
  buffer_load_dword v37, v21, s[8:11], s27 offen
  s_add_u32 s27, s26, 2408448
  buffer_load_dword v38, v21, s[8:11], s27 offen
  s_add_u32 s27, s26, 2416640
  buffer_load_dword v39, v21, s[8:11], s27 offen
  s_waitcnt vmcnt(48)
  v_perm_b32 v120, v73, v72, s44
  v_perm_b32 v121, v75, v74, s44
  v_perm_b32 v122, v77, v76, s44
  v_perm_b32 v123, v79, v78, s44
  v_accvgpr_write_b32 a8, v120
  v_accvgpr_write_b32 a9, v121
  v_accvgpr_write_b32 a10, v122
  v_accvgpr_write_b32 a11, v123
  v_perm_b32 v124, v73, v72, s45
  v_perm_b32 v125, v75, v74, s45
  v_perm_b32 v126, v77, v76, s45
  v_perm_b32 v127, v79, v78, s45
  v_accvgpr_write_b32 a72, v124
  v_accvgpr_write_b32 a73, v125
  v_accvgpr_write_b32 a74, v126
  v_accvgpr_write_b32 a75, v127
  v_perm_b32 v120, v81, v80, s44
  v_perm_b32 v121, v83, v82, s44
  v_perm_b32 v122, v85, v84, s44
  v_perm_b32 v123, v87, v86, s44
  v_accvgpr_write_b32 a12, v120
  v_accvgpr_write_b32 a13, v121
  v_accvgpr_write_b32 a14, v122
  v_accvgpr_write_b32 a15, v123
  v_perm_b32 v124, v81, v80, s45
  v_perm_b32 v125, v83, v82, s45
  v_perm_b32 v126, v85, v84, s45
  v_perm_b32 v127, v87, v86, s45
  v_accvgpr_write_b32 a76, v124
  v_accvgpr_write_b32 a77, v125
  v_accvgpr_write_b32 a78, v126
  v_accvgpr_write_b32 a79, v127
  s_add_u32 s27, s26, 2621440
  buffer_load_dword v40, v21, s[8:11], s27 offen
  s_add_u32 s27, s26, 2629632
  buffer_load_dword v41, v21, s[8:11], s27 offen
  s_add_u32 s27, s26, 2637824
  buffer_load_dword v42, v21, s[8:11], s27 offen
  s_add_u32 s27, s26, 2646016
  buffer_load_dword v43, v21, s[8:11], s27 offen
  s_add_u32 s27, s26, 2654208
  buffer_load_dword v44, v21, s[8:11], s27 offen
  s_add_u32 s27, s26, 2662400
  buffer_load_dword v45, v21, s[8:11], s27 offen
  s_add_u32 s27, s26, 2670592
  buffer_load_dword v46, v21, s[8:11], s27 offen
  s_add_u32 s27, s26, 2678784
  buffer_load_dword v47, v21, s[8:11], s27 offen
  s_add_u32 s27, s26, 2883584
  buffer_load_dword v48, v21, s[8:11], s27 offen
  s_add_u32 s27, s26, 2891776
  buffer_load_dword v49, v21, s[8:11], s27 offen
  s_add_u32 s27, s26, 2899968
  buffer_load_dword v50, v21, s[8:11], s27 offen
  s_add_u32 s27, s26, 2908160
  buffer_load_dword v51, v21, s[8:11], s27 offen
  s_add_u32 s27, s26, 2916352
  buffer_load_dword v52, v21, s[8:11], s27 offen
  s_add_u32 s27, s26, 2924544
  buffer_load_dword v53, v21, s[8:11], s27 offen
  s_add_u32 s27, s26, 2932736
  buffer_load_dword v54, v21, s[8:11], s27 offen
  s_add_u32 s27, s26, 2940928
  buffer_load_dword v55, v21, s[8:11], s27 offen
  s_waitcnt vmcnt(48)
  v_perm_b32 v120, v89, v88, s44
  v_perm_b32 v121, v91, v90, s44
  v_perm_b32 v122, v93, v92, s44
  v_perm_b32 v123, v95, v94, s44
  v_accvgpr_write_b32 a16, v120
  v_accvgpr_write_b32 a17, v121
  v_accvgpr_write_b32 a18, v122
  v_accvgpr_write_b32 a19, v123
  v_perm_b32 v124, v89, v88, s45
  v_perm_b32 v125, v91, v90, s45
  v_perm_b32 v126, v93, v92, s45
  v_perm_b32 v127, v95, v94, s45
  v_accvgpr_write_b32 a80, v124
  v_accvgpr_write_b32 a81, v125
  v_accvgpr_write_b32 a82, v126
  v_accvgpr_write_b32 a83, v127
  v_perm_b32 v120, v97, v96, s44
  v_perm_b32 v121, v99, v98, s44
  v_perm_b32 v122, v101, v100, s44
  v_perm_b32 v123, v103, v102, s44
  v_accvgpr_write_b32 a20, v120
  v_accvgpr_write_b32 a21, v121
  v_accvgpr_write_b32 a22, v122
  v_accvgpr_write_b32 a23, v123
  v_perm_b32 v124, v97, v96, s45
  v_perm_b32 v125, v99, v98, s45
  v_perm_b32 v126, v101, v100, s45
  v_perm_b32 v127, v103, v102, s45
  v_accvgpr_write_b32 a84, v124
  v_accvgpr_write_b32 a85, v125
  v_accvgpr_write_b32 a86, v126
  v_accvgpr_write_b32 a87, v127
  s_add_u32 s27, s26, 3145728
  buffer_load_dword v56, v21, s[8:11], s27 offen
  s_add_u32 s27, s26, 3153920
  buffer_load_dword v57, v21, s[8:11], s27 offen
  s_add_u32 s27, s26, 3162112
  buffer_load_dword v58, v21, s[8:11], s27 offen
  s_add_u32 s27, s26, 3170304
  buffer_load_dword v59, v21, s[8:11], s27 offen
  s_add_u32 s27, s26, 3178496
  buffer_load_dword v60, v21, s[8:11], s27 offen
  s_add_u32 s27, s26, 3186688
  buffer_load_dword v61, v21, s[8:11], s27 offen
  s_add_u32 s27, s26, 3194880
  buffer_load_dword v62, v21, s[8:11], s27 offen
  s_add_u32 s27, s26, 3203072
  buffer_load_dword v63, v21, s[8:11], s27 offen
  s_add_u32 s27, s26, 3407872
  buffer_load_dword v64, v21, s[8:11], s27 offen
  s_add_u32 s27, s26, 3416064
  buffer_load_dword v65, v21, s[8:11], s27 offen
  s_add_u32 s27, s26, 3424256
  buffer_load_dword v66, v21, s[8:11], s27 offen
  s_add_u32 s27, s26, 3432448
  buffer_load_dword v67, v21, s[8:11], s27 offen
  s_add_u32 s27, s26, 3440640
  buffer_load_dword v68, v21, s[8:11], s27 offen
  s_add_u32 s27, s26, 3448832
  buffer_load_dword v69, v21, s[8:11], s27 offen
  s_add_u32 s27, s26, 3457024
  buffer_load_dword v70, v21, s[8:11], s27 offen
  s_add_u32 s27, s26, 3465216
  buffer_load_dword v71, v21, s[8:11], s27 offen
  s_waitcnt vmcnt(48)
  v_perm_b32 v120, v105, v104, s44
  v_perm_b32 v121, v107, v106, s44
  v_perm_b32 v122, v109, v108, s44
  v_perm_b32 v123, v111, v110, s44
  v_accvgpr_write_b32 a24, v120
  v_accvgpr_write_b32 a25, v121
  v_accvgpr_write_b32 a26, v122
  v_accvgpr_write_b32 a27, v123
  v_perm_b32 v124, v105, v104, s45
  v_perm_b32 v125, v107, v106, s45
  v_perm_b32 v126, v109, v108, s45
  v_perm_b32 v127, v111, v110, s45
  v_accvgpr_write_b32 a88, v124
  v_accvgpr_write_b32 a89, v125
  v_accvgpr_write_b32 a90, v126
  v_accvgpr_write_b32 a91, v127
  v_perm_b32 v120, v113, v112, s44
  v_perm_b32 v121, v115, v114, s44
  v_perm_b32 v122, v117, v116, s44
  v_perm_b32 v123, v119, v118, s44
  v_accvgpr_write_b32 a28, v120
  v_accvgpr_write_b32 a29, v121
  v_accvgpr_write_b32 a30, v122
  v_accvgpr_write_b32 a31, v123
  v_perm_b32 v124, v113, v112, s45
  v_perm_b32 v125, v115, v114, s45
  v_perm_b32 v126, v117, v116, s45
  v_perm_b32 v127, v119, v118, s45
  v_accvgpr_write_b32 a92, v124
  v_accvgpr_write_b32 a93, v125
  v_accvgpr_write_b32 a94, v126
  v_accvgpr_write_b32 a95, v127
  s_add_u32 s27, s26, 3670016
  buffer_load_dword v72, v21, s[8:11], s27 offen
  s_add_u32 s27, s26, 3678208
  buffer_load_dword v73, v21, s[8:11], s27 offen
  s_add_u32 s27, s26, 3686400
  buffer_load_dword v74, v21, s[8:11], s27 offen
  s_add_u32 s27, s26, 3694592
  buffer_load_dword v75, v21, s[8:11], s27 offen
  s_add_u32 s27, s26, 3702784
  buffer_load_dword v76, v21, s[8:11], s27 offen
  s_add_u32 s27, s26, 3710976
  buffer_load_dword v77, v21, s[8:11], s27 offen
  s_add_u32 s27, s26, 3719168
  buffer_load_dword v78, v21, s[8:11], s27 offen
  s_add_u32 s27, s26, 3727360
  buffer_load_dword v79, v21, s[8:11], s27 offen
  s_add_u32 s27, s26, 3932160
  buffer_load_dword v80, v21, s[8:11], s27 offen
  s_add_u32 s27, s26, 3940352
  buffer_load_dword v81, v21, s[8:11], s27 offen
  s_add_u32 s27, s26, 3948544
  buffer_load_dword v82, v21, s[8:11], s27 offen
  s_add_u32 s27, s26, 3956736
  buffer_load_dword v83, v21, s[8:11], s27 offen
  s_add_u32 s27, s26, 3964928
  buffer_load_dword v84, v21, s[8:11], s27 offen
  s_add_u32 s27, s26, 3973120
  buffer_load_dword v85, v21, s[8:11], s27 offen
  s_add_u32 s27, s26, 3981312
  buffer_load_dword v86, v21, s[8:11], s27 offen
  s_add_u32 s27, s26, 3989504
  buffer_load_dword v87, v21, s[8:11], s27 offen
  s_waitcnt vmcnt(48)
  v_perm_b32 v120, v25, v24, s44
  v_perm_b32 v121, v27, v26, s44
  v_perm_b32 v122, v29, v28, s44
  v_perm_b32 v123, v31, v30, s44
  v_accvgpr_write_b32 a32, v120
  v_accvgpr_write_b32 a33, v121
  v_accvgpr_write_b32 a34, v122
  v_accvgpr_write_b32 a35, v123
  v_perm_b32 v124, v25, v24, s45
  v_perm_b32 v125, v27, v26, s45
  v_perm_b32 v126, v29, v28, s45
  v_perm_b32 v127, v31, v30, s45
  v_accvgpr_write_b32 a96, v124
  v_accvgpr_write_b32 a97, v125
  v_accvgpr_write_b32 a98, v126
  v_accvgpr_write_b32 a99, v127
  v_perm_b32 v120, v33, v32, s44
  v_perm_b32 v121, v35, v34, s44
  v_perm_b32 v122, v37, v36, s44
  v_perm_b32 v123, v39, v38, s44
  v_accvgpr_write_b32 a36, v120
  v_accvgpr_write_b32 a37, v121
  v_accvgpr_write_b32 a38, v122
  v_accvgpr_write_b32 a39, v123
  v_perm_b32 v124, v33, v32, s45
  v_perm_b32 v125, v35, v34, s45
  v_perm_b32 v126, v37, v36, s45
  v_perm_b32 v127, v39, v38, s45
  v_accvgpr_write_b32 a100, v124
  v_accvgpr_write_b32 a101, v125
  v_accvgpr_write_b32 a102, v126
  v_accvgpr_write_b32 a103, v127
  s_load_dwordx2 s[8:9], s[0:1], 16
  s_waitcnt lgkmcnt(0)
  s_add_u32 s27, s26, 0
  buffer_load_dword v88, v21, s[8:11], s27 offen
  s_add_u32 s27, s26, 8192
  buffer_load_dword v89, v21, s[8:11], s27 offen
  s_add_u32 s27, s26, 16384
  buffer_load_dword v90, v21, s[8:11], s27 offen
  s_add_u32 s27, s26, 24576
  buffer_load_dword v91, v21, s[8:11], s27 offen
  s_add_u32 s27, s26, 32768
  buffer_load_dword v92, v21, s[8:11], s27 offen
  s_add_u32 s27, s26, 40960
  buffer_load_dword v93, v21, s[8:11], s27 offen
  s_add_u32 s27, s26, 49152
  buffer_load_dword v94, v21, s[8:11], s27 offen
  s_add_u32 s27, s26, 57344
  buffer_load_dword v95, v21, s[8:11], s27 offen
  s_add_u32 s27, s26, 262144
  buffer_load_dword v96, v21, s[8:11], s27 offen
  s_add_u32 s27, s26, 270336
  buffer_load_dword v97, v21, s[8:11], s27 offen
  s_add_u32 s27, s26, 278528
  buffer_load_dword v98, v21, s[8:11], s27 offen
  s_add_u32 s27, s26, 286720
  buffer_load_dword v99, v21, s[8:11], s27 offen
  s_add_u32 s27, s26, 294912
  buffer_load_dword v100, v21, s[8:11], s27 offen
  s_add_u32 s27, s26, 303104
  buffer_load_dword v101, v21, s[8:11], s27 offen
  s_add_u32 s27, s26, 311296
  buffer_load_dword v102, v21, s[8:11], s27 offen
  s_add_u32 s27, s26, 319488
  buffer_load_dword v103, v21, s[8:11], s27 offen
  s_waitcnt vmcnt(48)
  v_perm_b32 v120, v41, v40, s44
  v_perm_b32 v121, v43, v42, s44
  v_perm_b32 v122, v45, v44, s44
  v_perm_b32 v123, v47, v46, s44
  v_accvgpr_write_b32 a40, v120
  v_accvgpr_write_b32 a41, v121
  v_accvgpr_write_b32 a42, v122
  v_accvgpr_write_b32 a43, v123
  v_perm_b32 v124, v41, v40, s45
  v_perm_b32 v125, v43, v42, s45
  v_perm_b32 v126, v45, v44, s45
  v_perm_b32 v127, v47, v46, s45
  v_accvgpr_write_b32 a104, v124
  v_accvgpr_write_b32 a105, v125
  v_accvgpr_write_b32 a106, v126
  v_accvgpr_write_b32 a107, v127
  v_perm_b32 v120, v49, v48, s44
  v_perm_b32 v121, v51, v50, s44
  v_perm_b32 v122, v53, v52, s44
  v_perm_b32 v123, v55, v54, s44
  v_accvgpr_write_b32 a44, v120
  v_accvgpr_write_b32 a45, v121
  v_accvgpr_write_b32 a46, v122
  v_accvgpr_write_b32 a47, v123
  v_perm_b32 v124, v49, v48, s45
  v_perm_b32 v125, v51, v50, s45
  v_perm_b32 v126, v53, v52, s45
  v_perm_b32 v127, v55, v54, s45
  v_accvgpr_write_b32 a108, v124
  v_accvgpr_write_b32 a109, v125
  v_accvgpr_write_b32 a110, v126
  v_accvgpr_write_b32 a111, v127
  s_add_u32 s27, s26, 524288
  buffer_load_dword v104, v21, s[8:11], s27 offen
  s_add_u32 s27, s26, 532480
  buffer_load_dword v105, v21, s[8:11], s27 offen
  s_add_u32 s27, s26, 540672
  buffer_load_dword v106, v21, s[8:11], s27 offen
  s_add_u32 s27, s26, 548864
  buffer_load_dword v107, v21, s[8:11], s27 offen
  s_add_u32 s27, s26, 557056
  buffer_load_dword v108, v21, s[8:11], s27 offen
  s_add_u32 s27, s26, 565248
  buffer_load_dword v109, v21, s[8:11], s27 offen
  s_add_u32 s27, s26, 573440
  buffer_load_dword v110, v21, s[8:11], s27 offen
  s_add_u32 s27, s26, 581632
  buffer_load_dword v111, v21, s[8:11], s27 offen
  s_add_u32 s27, s26, 786432
  buffer_load_dword v112, v21, s[8:11], s27 offen
  s_add_u32 s27, s26, 794624
  buffer_load_dword v113, v21, s[8:11], s27 offen
  s_add_u32 s27, s26, 802816
  buffer_load_dword v114, v21, s[8:11], s27 offen
  s_add_u32 s27, s26, 811008
  buffer_load_dword v115, v21, s[8:11], s27 offen
  s_add_u32 s27, s26, 819200
  buffer_load_dword v116, v21, s[8:11], s27 offen
  s_add_u32 s27, s26, 827392
  buffer_load_dword v117, v21, s[8:11], s27 offen
  s_add_u32 s27, s26, 835584
  buffer_load_dword v118, v21, s[8:11], s27 offen
  s_add_u32 s27, s26, 843776
  buffer_load_dword v119, v21, s[8:11], s27 offen
  s_waitcnt vmcnt(48)
  v_perm_b32 v120, v57, v56, s44
  v_perm_b32 v121, v59, v58, s44
  v_perm_b32 v122, v61, v60, s44
  v_perm_b32 v123, v63, v62, s44
  v_accvgpr_write_b32 a48, v120
  v_accvgpr_write_b32 a49, v121
  v_accvgpr_write_b32 a50, v122
  v_accvgpr_write_b32 a51, v123
  v_perm_b32 v124, v57, v56, s45
  v_perm_b32 v125, v59, v58, s45
  v_perm_b32 v126, v61, v60, s45
  v_perm_b32 v127, v63, v62, s45
  v_accvgpr_write_b32 a112, v124
  v_accvgpr_write_b32 a113, v125
  v_accvgpr_write_b32 a114, v126
  v_accvgpr_write_b32 a115, v127
  v_perm_b32 v120, v65, v64, s44
  v_perm_b32 v121, v67, v66, s44
  v_perm_b32 v122, v69, v68, s44
  v_perm_b32 v123, v71, v70, s44
  v_accvgpr_write_b32 a52, v120
  v_accvgpr_write_b32 a53, v121
  v_accvgpr_write_b32 a54, v122
  v_accvgpr_write_b32 a55, v123
  v_perm_b32 v124, v65, v64, s45
  v_perm_b32 v125, v67, v66, s45
  v_perm_b32 v126, v69, v68, s45
  v_perm_b32 v127, v71, v70, s45
  v_accvgpr_write_b32 a116, v124
  v_accvgpr_write_b32 a117, v125
  v_accvgpr_write_b32 a118, v126
  v_accvgpr_write_b32 a119, v127
  s_add_u32 s27, s26, 1048576
  buffer_load_dword v24, v21, s[8:11], s27 offen
  s_add_u32 s27, s26, 1056768
  buffer_load_dword v25, v21, s[8:11], s27 offen
  s_add_u32 s27, s26, 1064960
  buffer_load_dword v26, v21, s[8:11], s27 offen
  s_add_u32 s27, s26, 1073152
  buffer_load_dword v27, v21, s[8:11], s27 offen
  s_add_u32 s27, s26, 1081344
  buffer_load_dword v28, v21, s[8:11], s27 offen
  s_add_u32 s27, s26, 1089536
  buffer_load_dword v29, v21, s[8:11], s27 offen
  s_add_u32 s27, s26, 1097728
  buffer_load_dword v30, v21, s[8:11], s27 offen
  s_add_u32 s27, s26, 1105920
  buffer_load_dword v31, v21, s[8:11], s27 offen
  s_add_u32 s27, s26, 1310720
  buffer_load_dword v32, v21, s[8:11], s27 offen
  s_add_u32 s27, s26, 1318912
  buffer_load_dword v33, v21, s[8:11], s27 offen
  s_add_u32 s27, s26, 1327104
  buffer_load_dword v34, v21, s[8:11], s27 offen
  s_add_u32 s27, s26, 1335296
  buffer_load_dword v35, v21, s[8:11], s27 offen
  s_add_u32 s27, s26, 1343488
  buffer_load_dword v36, v21, s[8:11], s27 offen
  s_add_u32 s27, s26, 1351680
  buffer_load_dword v37, v21, s[8:11], s27 offen
  s_add_u32 s27, s26, 1359872
  buffer_load_dword v38, v21, s[8:11], s27 offen
  s_add_u32 s27, s26, 1368064
  buffer_load_dword v39, v21, s[8:11], s27 offen
  s_waitcnt vmcnt(48)
  v_perm_b32 v120, v73, v72, s44
  v_perm_b32 v121, v75, v74, s44
  v_perm_b32 v122, v77, v76, s44
  v_perm_b32 v123, v79, v78, s44
  v_accvgpr_write_b32 a56, v120
  v_accvgpr_write_b32 a57, v121
  v_accvgpr_write_b32 a58, v122
  v_accvgpr_write_b32 a59, v123
  v_perm_b32 v124, v73, v72, s45
  v_perm_b32 v125, v75, v74, s45
  v_perm_b32 v126, v77, v76, s45
  v_perm_b32 v127, v79, v78, s45
  v_accvgpr_write_b32 a120, v124
  v_accvgpr_write_b32 a121, v125
  v_accvgpr_write_b32 a122, v126
  v_accvgpr_write_b32 a123, v127
  v_perm_b32 v120, v81, v80, s44
  v_perm_b32 v121, v83, v82, s44
  v_perm_b32 v122, v85, v84, s44
  v_perm_b32 v123, v87, v86, s44
  v_accvgpr_write_b32 a60, v120
  v_accvgpr_write_b32 a61, v121
  v_accvgpr_write_b32 a62, v122
  v_accvgpr_write_b32 a63, v123
  v_perm_b32 v124, v81, v80, s45
  v_perm_b32 v125, v83, v82, s45
  v_perm_b32 v126, v85, v84, s45
  v_perm_b32 v127, v87, v86, s45
  v_accvgpr_write_b32 a124, v124
  v_accvgpr_write_b32 a125, v125
  v_accvgpr_write_b32 a126, v126
  v_accvgpr_write_b32 a127, v127
  s_add_u32 s27, s26, 1572864
  buffer_load_dword v40, v21, s[8:11], s27 offen
  s_add_u32 s27, s26, 1581056
  buffer_load_dword v41, v21, s[8:11], s27 offen
  s_add_u32 s27, s26, 1589248
  buffer_load_dword v42, v21, s[8:11], s27 offen
  s_add_u32 s27, s26, 1597440
  buffer_load_dword v43, v21, s[8:11], s27 offen
  s_add_u32 s27, s26, 1605632
  buffer_load_dword v44, v21, s[8:11], s27 offen
  s_add_u32 s27, s26, 1613824
  buffer_load_dword v45, v21, s[8:11], s27 offen
  s_add_u32 s27, s26, 1622016
  buffer_load_dword v46, v21, s[8:11], s27 offen
  s_add_u32 s27, s26, 1630208
  buffer_load_dword v47, v21, s[8:11], s27 offen
  s_add_u32 s27, s26, 1835008
  buffer_load_dword v48, v21, s[8:11], s27 offen
  s_add_u32 s27, s26, 1843200
  buffer_load_dword v49, v21, s[8:11], s27 offen
  s_add_u32 s27, s26, 1851392
  buffer_load_dword v50, v21, s[8:11], s27 offen
  s_add_u32 s27, s26, 1859584
  buffer_load_dword v51, v21, s[8:11], s27 offen
  s_add_u32 s27, s26, 1867776
  buffer_load_dword v52, v21, s[8:11], s27 offen
  s_add_u32 s27, s26, 1875968
  buffer_load_dword v53, v21, s[8:11], s27 offen
  s_add_u32 s27, s26, 1884160
  buffer_load_dword v54, v21, s[8:11], s27 offen
  s_add_u32 s27, s26, 1892352
  buffer_load_dword v55, v21, s[8:11], s27 offen
  s_waitcnt vmcnt(48)
  v_perm_b32 v120, v89, v88, s44
  v_perm_b32 v121, v91, v90, s44
  v_perm_b32 v122, v93, v92, s44
  v_perm_b32 v123, v95, v94, s44
  v_accvgpr_write_b32 a128, v120
  v_accvgpr_write_b32 a129, v121
  v_accvgpr_write_b32 a130, v122
  v_accvgpr_write_b32 a131, v123
  v_perm_b32 v124, v89, v88, s45
  v_perm_b32 v125, v91, v90, s45
  v_perm_b32 v126, v93, v92, s45
  v_perm_b32 v127, v95, v94, s45
  v_accvgpr_write_b32 a192, v124
  v_accvgpr_write_b32 a193, v125
  v_accvgpr_write_b32 a194, v126
  v_accvgpr_write_b32 a195, v127
  v_perm_b32 v120, v97, v96, s44
  v_perm_b32 v121, v99, v98, s44
  v_perm_b32 v122, v101, v100, s44
  v_perm_b32 v123, v103, v102, s44
  v_accvgpr_write_b32 a132, v120
  v_accvgpr_write_b32 a133, v121
  v_accvgpr_write_b32 a134, v122
  v_accvgpr_write_b32 a135, v123
  v_perm_b32 v124, v97, v96, s45
  v_perm_b32 v125, v99, v98, s45
  v_perm_b32 v126, v101, v100, s45
  v_perm_b32 v127, v103, v102, s45
  v_accvgpr_write_b32 a196, v124
  v_accvgpr_write_b32 a197, v125
  v_accvgpr_write_b32 a198, v126
  v_accvgpr_write_b32 a199, v127
  s_add_u32 s27, s26, 2097152
  buffer_load_dword v56, v21, s[8:11], s27 offen
  s_add_u32 s27, s26, 2105344
  buffer_load_dword v57, v21, s[8:11], s27 offen
  s_add_u32 s27, s26, 2113536
  buffer_load_dword v58, v21, s[8:11], s27 offen
  s_add_u32 s27, s26, 2121728
  buffer_load_dword v59, v21, s[8:11], s27 offen
  s_add_u32 s27, s26, 2129920
  buffer_load_dword v60, v21, s[8:11], s27 offen
  s_add_u32 s27, s26, 2138112
  buffer_load_dword v61, v21, s[8:11], s27 offen
  s_add_u32 s27, s26, 2146304
  buffer_load_dword v62, v21, s[8:11], s27 offen
  s_add_u32 s27, s26, 2154496
  buffer_load_dword v63, v21, s[8:11], s27 offen
  s_add_u32 s27, s26, 2359296
  buffer_load_dword v64, v21, s[8:11], s27 offen
  s_add_u32 s27, s26, 2367488
  buffer_load_dword v65, v21, s[8:11], s27 offen
  s_add_u32 s27, s26, 2375680
  buffer_load_dword v66, v21, s[8:11], s27 offen
  s_add_u32 s27, s26, 2383872
  buffer_load_dword v67, v21, s[8:11], s27 offen
  s_add_u32 s27, s26, 2392064
  buffer_load_dword v68, v21, s[8:11], s27 offen
  s_add_u32 s27, s26, 2400256
  buffer_load_dword v69, v21, s[8:11], s27 offen
  s_add_u32 s27, s26, 2408448
  buffer_load_dword v70, v21, s[8:11], s27 offen
  s_add_u32 s27, s26, 2416640
  buffer_load_dword v71, v21, s[8:11], s27 offen
  s_waitcnt vmcnt(48)
  v_perm_b32 v120, v105, v104, s44
  v_perm_b32 v121, v107, v106, s44
  v_perm_b32 v122, v109, v108, s44
  v_perm_b32 v123, v111, v110, s44
  v_accvgpr_write_b32 a136, v120
  v_accvgpr_write_b32 a137, v121
  v_accvgpr_write_b32 a138, v122
  v_accvgpr_write_b32 a139, v123
  v_perm_b32 v124, v105, v104, s45
  v_perm_b32 v125, v107, v106, s45
  v_perm_b32 v126, v109, v108, s45
  v_perm_b32 v127, v111, v110, s45
  v_accvgpr_write_b32 a200, v124
  v_accvgpr_write_b32 a201, v125
  v_accvgpr_write_b32 a202, v126
  v_accvgpr_write_b32 a203, v127
  v_perm_b32 v120, v113, v112, s44
  v_perm_b32 v121, v115, v114, s44
  v_perm_b32 v122, v117, v116, s44
  v_perm_b32 v123, v119, v118, s44
  v_accvgpr_write_b32 a140, v120
  v_accvgpr_write_b32 a141, v121
  v_accvgpr_write_b32 a142, v122
  v_accvgpr_write_b32 a143, v123
  v_perm_b32 v124, v113, v112, s45
  v_perm_b32 v125, v115, v114, s45
  v_perm_b32 v126, v117, v116, s45
  v_perm_b32 v127, v119, v118, s45
  v_accvgpr_write_b32 a204, v124
  v_accvgpr_write_b32 a205, v125
  v_accvgpr_write_b32 a206, v126
  v_accvgpr_write_b32 a207, v127
  s_add_u32 s27, s26, 2621440
  buffer_load_dword v72, v21, s[8:11], s27 offen
  s_add_u32 s27, s26, 2629632
  buffer_load_dword v73, v21, s[8:11], s27 offen
  s_add_u32 s27, s26, 2637824
  buffer_load_dword v74, v21, s[8:11], s27 offen
  s_add_u32 s27, s26, 2646016
  buffer_load_dword v75, v21, s[8:11], s27 offen
  s_add_u32 s27, s26, 2654208
  buffer_load_dword v76, v21, s[8:11], s27 offen
  s_add_u32 s27, s26, 2662400
  buffer_load_dword v77, v21, s[8:11], s27 offen
  s_add_u32 s27, s26, 2670592
  buffer_load_dword v78, v21, s[8:11], s27 offen
  s_add_u32 s27, s26, 2678784
  buffer_load_dword v79, v21, s[8:11], s27 offen
  s_add_u32 s27, s26, 2883584
  buffer_load_dword v80, v21, s[8:11], s27 offen
  s_add_u32 s27, s26, 2891776
  buffer_load_dword v81, v21, s[8:11], s27 offen
  s_add_u32 s27, s26, 2899968
  buffer_load_dword v82, v21, s[8:11], s27 offen
  s_add_u32 s27, s26, 2908160
  buffer_load_dword v83, v21, s[8:11], s27 offen
  s_add_u32 s27, s26, 2916352
  buffer_load_dword v84, v21, s[8:11], s27 offen
  s_add_u32 s27, s26, 2924544
  buffer_load_dword v85, v21, s[8:11], s27 offen
  s_add_u32 s27, s26, 2932736
  buffer_load_dword v86, v21, s[8:11], s27 offen
  s_add_u32 s27, s26, 2940928
  buffer_load_dword v87, v21, s[8:11], s27 offen
  s_waitcnt vmcnt(48)
  v_perm_b32 v120, v25, v24, s44
  v_perm_b32 v121, v27, v26, s44
  v_perm_b32 v122, v29, v28, s44
  v_perm_b32 v123, v31, v30, s44
  v_accvgpr_write_b32 a144, v120
  v_accvgpr_write_b32 a145, v121
  v_accvgpr_write_b32 a146, v122
  v_accvgpr_write_b32 a147, v123
  v_perm_b32 v124, v25, v24, s45
  v_perm_b32 v125, v27, v26, s45
  v_perm_b32 v126, v29, v28, s45
  v_perm_b32 v127, v31, v30, s45
  v_accvgpr_write_b32 a208, v124
  v_accvgpr_write_b32 a209, v125
  v_accvgpr_write_b32 a210, v126
  v_accvgpr_write_b32 a211, v127
  v_perm_b32 v120, v33, v32, s44
  v_perm_b32 v121, v35, v34, s44
  v_perm_b32 v122, v37, v36, s44
  v_perm_b32 v123, v39, v38, s44
  v_accvgpr_write_b32 a148, v120
  v_accvgpr_write_b32 a149, v121
  v_accvgpr_write_b32 a150, v122
  v_accvgpr_write_b32 a151, v123
  v_perm_b32 v124, v33, v32, s45
  v_perm_b32 v125, v35, v34, s45
  v_perm_b32 v126, v37, v36, s45
  v_perm_b32 v127, v39, v38, s45
  v_accvgpr_write_b32 a212, v124
  v_accvgpr_write_b32 a213, v125
  v_accvgpr_write_b32 a214, v126
  v_accvgpr_write_b32 a215, v127
  s_add_u32 s27, s26, 3145728
  buffer_load_dword v88, v21, s[8:11], s27 offen
  s_add_u32 s27, s26, 3153920
  buffer_load_dword v89, v21, s[8:11], s27 offen
  s_add_u32 s27, s26, 3162112
  buffer_load_dword v90, v21, s[8:11], s27 offen
  s_add_u32 s27, s26, 3170304
  buffer_load_dword v91, v21, s[8:11], s27 offen
  s_add_u32 s27, s26, 3178496
  buffer_load_dword v92, v21, s[8:11], s27 offen
  s_add_u32 s27, s26, 3186688
  buffer_load_dword v93, v21, s[8:11], s27 offen
  s_add_u32 s27, s26, 3194880
  buffer_load_dword v94, v21, s[8:11], s27 offen
  s_add_u32 s27, s26, 3203072
  buffer_load_dword v95, v21, s[8:11], s27 offen
  s_add_u32 s27, s26, 3407872
  buffer_load_dword v96, v21, s[8:11], s27 offen
  s_add_u32 s27, s26, 3416064
  buffer_load_dword v97, v21, s[8:11], s27 offen
  s_add_u32 s27, s26, 3424256
  buffer_load_dword v98, v21, s[8:11], s27 offen
  s_add_u32 s27, s26, 3432448
  buffer_load_dword v99, v21, s[8:11], s27 offen
  s_add_u32 s27, s26, 3440640
  buffer_load_dword v100, v21, s[8:11], s27 offen
  s_add_u32 s27, s26, 3448832
  buffer_load_dword v101, v21, s[8:11], s27 offen
  s_add_u32 s27, s26, 3457024
  buffer_load_dword v102, v21, s[8:11], s27 offen
  s_add_u32 s27, s26, 3465216
  buffer_load_dword v103, v21, s[8:11], s27 offen
  s_waitcnt vmcnt(48)
  v_perm_b32 v120, v41, v40, s44
  v_perm_b32 v121, v43, v42, s44
  v_perm_b32 v122, v45, v44, s44
  v_perm_b32 v123, v47, v46, s44
  v_accvgpr_write_b32 a152, v120
  v_accvgpr_write_b32 a153, v121
  v_accvgpr_write_b32 a154, v122
  v_accvgpr_write_b32 a155, v123
  v_perm_b32 v124, v41, v40, s45
  v_perm_b32 v125, v43, v42, s45
  v_perm_b32 v126, v45, v44, s45
  v_perm_b32 v127, v47, v46, s45
  v_accvgpr_write_b32 a216, v124
  v_accvgpr_write_b32 a217, v125
  v_accvgpr_write_b32 a218, v126
  v_accvgpr_write_b32 a219, v127
  v_perm_b32 v120, v49, v48, s44
  v_perm_b32 v121, v51, v50, s44
  v_perm_b32 v122, v53, v52, s44
  v_perm_b32 v123, v55, v54, s44
  v_accvgpr_write_b32 a156, v120
  v_accvgpr_write_b32 a157, v121
  v_accvgpr_write_b32 a158, v122
  v_accvgpr_write_b32 a159, v123
  v_perm_b32 v124, v49, v48, s45
  v_perm_b32 v125, v51, v50, s45
  v_perm_b32 v126, v53, v52, s45
  v_perm_b32 v127, v55, v54, s45
  v_accvgpr_write_b32 a220, v124
  v_accvgpr_write_b32 a221, v125
  v_accvgpr_write_b32 a222, v126
  v_accvgpr_write_b32 a223, v127
  s_add_u32 s27, s26, 3670016
  buffer_load_dword v104, v21, s[8:11], s27 offen
  s_add_u32 s27, s26, 3678208
  buffer_load_dword v105, v21, s[8:11], s27 offen
  s_add_u32 s27, s26, 3686400
  buffer_load_dword v106, v21, s[8:11], s27 offen
  s_add_u32 s27, s26, 3694592
  buffer_load_dword v107, v21, s[8:11], s27 offen
  s_add_u32 s27, s26, 3702784
  buffer_load_dword v108, v21, s[8:11], s27 offen
  s_add_u32 s27, s26, 3710976
  buffer_load_dword v109, v21, s[8:11], s27 offen
  s_add_u32 s27, s26, 3719168
  buffer_load_dword v110, v21, s[8:11], s27 offen
  s_add_u32 s27, s26, 3727360
  buffer_load_dword v111, v21, s[8:11], s27 offen
  s_add_u32 s27, s26, 3932160
  buffer_load_dword v112, v21, s[8:11], s27 offen
  s_add_u32 s27, s26, 3940352
  buffer_load_dword v113, v21, s[8:11], s27 offen
  s_add_u32 s27, s26, 3948544
  buffer_load_dword v114, v21, s[8:11], s27 offen
  s_add_u32 s27, s26, 3956736
  buffer_load_dword v115, v21, s[8:11], s27 offen
  s_add_u32 s27, s26, 3964928
  buffer_load_dword v116, v21, s[8:11], s27 offen
  s_add_u32 s27, s26, 3973120
  buffer_load_dword v117, v21, s[8:11], s27 offen
  s_add_u32 s27, s26, 3981312
  buffer_load_dword v118, v21, s[8:11], s27 offen
  s_add_u32 s27, s26, 3989504
  buffer_load_dword v119, v21, s[8:11], s27 offen
  s_waitcnt vmcnt(48)
  v_perm_b32 v120, v57, v56, s44
  v_perm_b32 v121, v59, v58, s44
  v_perm_b32 v122, v61, v60, s44
  v_perm_b32 v123, v63, v62, s44
  v_accvgpr_write_b32 a160, v120
  v_accvgpr_write_b32 a161, v121
  v_accvgpr_write_b32 a162, v122
  v_accvgpr_write_b32 a163, v123
  v_perm_b32 v124, v57, v56, s45
  v_perm_b32 v125, v59, v58, s45
  v_perm_b32 v126, v61, v60, s45
  v_perm_b32 v127, v63, v62, s45
  v_accvgpr_write_b32 a224, v124
  v_accvgpr_write_b32 a225, v125
  v_accvgpr_write_b32 a226, v126
  v_accvgpr_write_b32 a227, v127
  v_perm_b32 v120, v65, v64, s44
  v_perm_b32 v121, v67, v66, s44
  v_perm_b32 v122, v69, v68, s44
  v_perm_b32 v123, v71, v70, s44
  v_accvgpr_write_b32 a164, v120
  v_accvgpr_write_b32 a165, v121
  v_accvgpr_write_b32 a166, v122
  v_accvgpr_write_b32 a167, v123
  v_perm_b32 v124, v65, v64, s45
  v_perm_b32 v125, v67, v66, s45
  v_perm_b32 v126, v69, v68, s45
  v_perm_b32 v127, v71, v70, s45
  v_accvgpr_write_b32 a228, v124
  v_accvgpr_write_b32 a229, v125
  v_accvgpr_write_b32 a230, v126
  v_accvgpr_write_b32 a231, v127
  s_waitcnt vmcnt(32)
  v_perm_b32 v120, v73, v72, s44
  v_perm_b32 v121, v75, v74, s44
  v_perm_b32 v122, v77, v76, s44
  v_perm_b32 v123, v79, v78, s44
  v_accvgpr_write_b32 a168, v120
  v_accvgpr_write_b32 a169, v121
  v_accvgpr_write_b32 a170, v122
  v_accvgpr_write_b32 a171, v123
  v_perm_b32 v124, v73, v72, s45
  v_perm_b32 v125, v75, v74, s45
  v_perm_b32 v126, v77, v76, s45
  v_perm_b32 v127, v79, v78, s45
  v_accvgpr_write_b32 a232, v124
  v_accvgpr_write_b32 a233, v125
  v_accvgpr_write_b32 a234, v126
  v_accvgpr_write_b32 a235, v127
  v_perm_b32 v120, v81, v80, s44
  v_perm_b32 v121, v83, v82, s44
  v_perm_b32 v122, v85, v84, s44
  v_perm_b32 v123, v87, v86, s44
  v_accvgpr_write_b32 a172, v120
  v_accvgpr_write_b32 a173, v121
  v_accvgpr_write_b32 a174, v122
  v_accvgpr_write_b32 a175, v123
  v_perm_b32 v124, v81, v80, s45
  v_perm_b32 v125, v83, v82, s45
  v_perm_b32 v126, v85, v84, s45
  v_perm_b32 v127, v87, v86, s45
  v_accvgpr_write_b32 a236, v124
  v_accvgpr_write_b32 a237, v125
  v_accvgpr_write_b32 a238, v126
  v_accvgpr_write_b32 a239, v127
  s_waitcnt vmcnt(16)
  v_perm_b32 v120, v89, v88, s44
  v_perm_b32 v121, v91, v90, s44
  v_perm_b32 v122, v93, v92, s44
  v_perm_b32 v123, v95, v94, s44
  v_accvgpr_write_b32 a176, v120
  v_accvgpr_write_b32 a177, v121
  v_accvgpr_write_b32 a178, v122
  v_accvgpr_write_b32 a179, v123
  v_perm_b32 v124, v89, v88, s45
  v_perm_b32 v125, v91, v90, s45
  v_perm_b32 v126, v93, v92, s45
  v_perm_b32 v127, v95, v94, s45
  v_accvgpr_write_b32 a240, v124
  v_accvgpr_write_b32 a241, v125
  v_accvgpr_write_b32 a242, v126
  v_accvgpr_write_b32 a243, v127
  v_perm_b32 v120, v97, v96, s44
  v_perm_b32 v121, v99, v98, s44
  v_perm_b32 v122, v101, v100, s44
  v_perm_b32 v123, v103, v102, s44
  v_accvgpr_write_b32 a180, v120
  v_accvgpr_write_b32 a181, v121
  v_accvgpr_write_b32 a182, v122
  v_accvgpr_write_b32 a183, v123
  v_perm_b32 v124, v97, v96, s45
  v_perm_b32 v125, v99, v98, s45
  v_perm_b32 v126, v101, v100, s45
  v_perm_b32 v127, v103, v102, s45
  v_accvgpr_write_b32 a244, v124
  v_accvgpr_write_b32 a245, v125
  v_accvgpr_write_b32 a246, v126
  v_accvgpr_write_b32 a247, v127
  s_waitcnt vmcnt(0)
  v_perm_b32 v120, v105, v104, s44
  v_perm_b32 v121, v107, v106, s44
  v_perm_b32 v122, v109, v108, s44
  v_perm_b32 v123, v111, v110, s44
  v_accvgpr_write_b32 a184, v120
  v_accvgpr_write_b32 a185, v121
  v_accvgpr_write_b32 a186, v122
  v_accvgpr_write_b32 a187, v123
  v_perm_b32 v124, v105, v104, s45
  v_perm_b32 v125, v107, v106, s45
  v_perm_b32 v126, v109, v108, s45
  v_perm_b32 v127, v111, v110, s45
  v_accvgpr_write_b32 a248, v124
  v_accvgpr_write_b32 a249, v125
  v_accvgpr_write_b32 a250, v126
  v_accvgpr_write_b32 a251, v127
  v_perm_b32 v120, v113, v112, s44
  v_perm_b32 v121, v115, v114, s44
  v_perm_b32 v122, v117, v116, s44
  v_perm_b32 v123, v119, v118, s44
  v_accvgpr_write_b32 a188, v120
  v_accvgpr_write_b32 a189, v121
  v_accvgpr_write_b32 a190, v122
  v_accvgpr_write_b32 a191, v123
  v_perm_b32 v124, v113, v112, s45
  v_perm_b32 v125, v115, v114, s45
  v_perm_b32 v126, v117, v116, s45
  v_perm_b32 v127, v119, v118, s45
  v_accvgpr_write_b32 a252, v124
  v_accvgpr_write_b32 a253, v125
  v_accvgpr_write_b32 a254, v126
  v_accvgpr_write_b32 a255, v127
  s_mov_b32 s26, 0
  v_mov_b32 v20, 160
g_wc_42:
  global_load_dword v21, v20, s[12:13] sc1
  s_add_u32 s26, s26, 1
  s_cmp_gt_u32 s26, 1048576
  s_cbranch_scc1 L_end
  s_waitcnt vmcnt(0)
  v_readfirstlane_b32 s27, v21
  s_cmp_lt_u32 s27, 64
  s_cbranch_scc1 g_wc_42
  v_xor_b32 v20, v18, v17
  v_lshlrev_b32 v20, 4, v20
  v_lshl_add_u32 v20, v17, 10, v20
  v_add_u32 v20, 32768, v20
  v_xor_b32 v88, 0, v20
  v_xor_b32 v89, 64, v20
  v_xor_b32 v90, 128, v20
  v_xor_b32 v91, 192, v20
  s_and_b32 s26, s17, 1
  s_lshl_b32 s26, s26, 7
  v_xor_b32 v20, s26, v0
  v_xor_b32 v92, 0, v20
  v_xor_b32 v93, 16, v20
  v_xor_b32 v94, 32, v20
  v_xor_b32 v95, 48, v20
  v_xor_b32 v96, 64, v20
  v_xor_b32 v97, 80, v20
  v_xor_b32 v98, 96, v20
  v_xor_b32 v99, 112, v20
  s_getpc_b64 s[40:41]
q_pc_43:
  s_mul_i32 s26, s60, 360
  s_add_u32 s26, s26, qkv_tab-q_pc_43
  s_add_u32 s40, s40, s26
  s_addc_u32 s41, s41, 0
  s_load_dword s47, s[40:41], 0
  s_mov_b32 s48, 0
  s_mov_b64 s[80:81], 0
  s_mov_b64 s[82:83], 0
  s_mov_b32 s49, 0
  s_mov_b32 s50, 32768
  s_lshl_b32 s54, s17, 13
  s_waitcnt lgkmcnt(0)
q_top_44:
  s_mov_b32 s46, s47
  s_bitcmp1_b32 s46, 9
  s_cbranch_scc0 q_end_45
  s_add_u32 s40, s40, 4
  s_addc_u32 s41, s41, 0
  s_load_dword s47, s[40:41], 0
  s_bitcmp1_b32 s46, 8
  s_cbranch_scc0 q_have_46x
  s_cmp_lg_u32 s48, 0
  s_cbranch_scc1 q_have_46
  s_mov_b32 s53, 0
  s_add_u32 s83, s83, 1
q_poll_48:
  s_and_b32 s26, s46, 127
  s_lshl_b32 s26, s26, 7
  s_add_u32 s26, s26, 5242880
  s_bitcmp1_b32 s46, 6
  s_cselect_b32 s26, 5283840, s26
  buffer_load_dword v2, v1, s[4:7], s26 offen sc1
  s_add_u32 s53, s53, 1
  s_cmp_gt_u32 s53, 1048576
  s_cbranch_scc1 q_fail_49
  s_waitcnt vmcnt(0)
  s_cmp_eq_u32 s49, 0
  s_cbranch_scc1 q_np_50
  s_mov_b64 exec, 1
  buffer_store_dword v4, v5, s[4:7], s49 offen sc1
  s_mov_b64 exec, -1
  s_mov_b32 s49, 0
q_np_50:
  v_cmp_eq_u32 vcc, 0, v2
  s_cbranch_vccnz q_poll_48
  s_and_b32 s26, s46, 127
  s_lshl_b32 s26, s26, 15
  s_xor_b32 s27, s50, 32768
  s_add_u32 m0, s27, s54
  s_add_u32 s26, s26, s54
  s_add_u32 s26, s26, 6291456
  buffer_load_dwordx4 v92, s[4:7], s26 offen offset:0 sc1 lds
  buffer_load_dwordx4 v93, s[4:7], s26 offen offset:1024 sc1 lds
  buffer_load_dwordx4 v94, s[4:7], s26 offen offset:2048 sc1 lds
  buffer_load_dwordx4 v95, s[4:7], s26 offen offset:3072 sc1 lds
  s_add_u32 m0, m0, 4096
  s_add_u32 s26, s26, 4096
  buffer_load_dwordx4 v96, s[4:7], s26 offen offset:0 sc1 lds
  buffer_load_dwordx4 v97, s[4:7], s26 offen offset:1024 sc1 lds
  buffer_load_dwordx4 v98, s[4:7], s26 offen offset:2048 sc1 lds
  buffer_load_dwordx4 v99, s[4:7], s26 offen offset:3072 sc1 lds
  s_waitcnt vmcnt(0)
q_have_46:
  s_mov_b32 s48, 0
  s_xor_b32 s50, s50, 32768
  v_xor_b32 v88, 32768, v88
  v_xor_b32 v89, 32768, v89
  v_xor_b32 v90, 32768, v90
  v_xor_b32 v91, 32768, v91
  s_barrier
q_have_46x:
  s_and_b32 s52, s46, 127
  s_lshl_b32 s52, s52, 5
  s_add_u32 s52, s52, s16
  s_lshl_b32 s52, s52, 2
  s_add_u32 s52, s52, s17
  s_lshr_b32 s51, s46, 16
  s_waitcnt lgkmcnt(0)
  s_and_b32 s26, s51, 127
  s_lshl_b32 s26, s26, 7
  s_add_u32 s26, s26, 5242880
  s_bitcmp1_b32 s51, 6
  s_cselect_b32 s26, 5283840, s26
  buffer_load_dword v2, v1, s[4:7], s26 offen sc1
  s_bitcmp1_b32 s46, 7
  s_cbranch_scc1 q_qblk_47
  ds_read_b128 v[40:43], v88 offset:0
  ds_read_b128 v[44:47], v88 offset:16384
  ds_read_b128 v[48:51], v89 offset:0
  ds_read_b128 v[52:55], v89 offset:16384
  ds_read_b128 v[56:59], v90 offset:0
  ds_read_b128 v[60:63], v90 offset:16384
  s_waitcnt lgkmcnt(5)
  v_mfma_f32_16x16x32_bf16 v[8:11], v[128:131], v[40:43], 0
  ds_read_b128 v[64:67], v91 offset:0
  v_mfma_f32_16x16x32_bf16 v[12:15], v[192:195], v[40:43], 0
  v_mfma_f32_16x16x32_bf16 v[24:27], v[40:43], a[0:3], 0
  v_mfma_f32_16x16x32_bf16 v[28:31], v[40:43], a[64:67], 0
  s_waitcnt lgkmcnt(5)
  v_mfma_f32_16x16x32_bf16 v[16:19], v[128:131], v[44:47], 0
  ds_read_b128 v[68:71], v91 offset:16384
  v_mfma_f32_16x16x32_bf16 v[20:23], v[192:195], v[44:47], 0
  v_mfma_f32_16x16x32_bf16 v[32:35], v[44:47], a[0:3], 0
  v_mfma_f32_16x16x32_bf16 v[36:39], v[44:47], a[64:67], 0
  s_waitcnt lgkmcnt(5)
  v_mfma_f32_16x16x32_bf16 v[8:11], v[132:135], v[48:51], v[8:11]
  ds_read_b128 v[40:43], v88 offset:256
  v_mfma_f32_16x16x32_bf16 v[12:15], v[196:199], v[48:51], v[12:15]
  v_mfma_f32_16x16x32_bf16 v[24:27], v[48:51], a[4:7], v[24:27]
  v_mfma_f32_16x16x32_bf16 v[28:31], v[48:51], a[68:71], v[28:31]
  s_waitcnt lgkmcnt(5)
  v_mfma_f32_16x16x32_bf16 v[16:19], v[132:135], v[52:55], v[16:19]
  ds_read_b128 v[44:47], v88 offset:16640
  v_mfma_f32_16x16x32_bf16 v[20:23], v[196:199], v[52:55], v[20:23]
  v_mfma_f32_16x16x32_bf16 v[32:35], v[52:55], a[4:7], v[32:35]
  v_mfma_f32_16x16x32_bf16 v[36:39], v[52:55], a[68:71], v[36:39]
  s_waitcnt lgkmcnt(5)
  v_mfma_f32_16x16x32_bf16 v[8:11], v[136:139], v[56:59], v[8:11]
  ds_read_b128 v[48:51], v89 offset:256
  v_mfma_f32_16x16x32_bf16 v[12:15], v[200:203], v[56:59], v[12:15]
  v_mfma_f32_16x16x32_bf16 v[24:27], v[56:59], a[8:11], v[24:27]
  v_mfma_f32_16x16x32_bf16 v[28:31], v[56:59], a[72:75], v[28:31]
  s_waitcnt lgkmcnt(5)
  v_mfma_f32_16x16x32_bf16 v[16:19], v[136:139], v[60:63], v[16:19]
  ds_read_b128 v[52:55], v89 offset:16640
  v_mfma_f32_16x16x32_bf16 v[20:23], v[200:203], v[60:63], v[20:23]
  v_mfma_f32_16x16x32_bf16 v[32:35], v[60:63], a[8:11], v[32:35]
  v_mfma_f32_16x16x32_bf16 v[36:39], v[60:63], a[72:75], v[36:39]
  s_waitcnt lgkmcnt(5)
  v_mfma_f32_16x16x32_bf16 v[8:11], v[140:143], v[64:67], v[8:11]
  ds_read_b128 v[56:59], v90 offset:256
  v_mfma_f32_16x16x32_bf16 v[12:15], v[204:207], v[64:67], v[12:15]
  v_mfma_f32_16x16x32_bf16 v[24:27], v[64:67], a[12:15], v[24:27]
  v_mfma_f32_16x16x32_bf16 v[28:31], v[64:67], a[76:79], v[28:31]
  s_waitcnt lgkmcnt(5)
  v_mfma_f32_16x16x32_bf16 v[16:19], v[140:143], v[68:71], v[16:19]
  ds_read_b128 v[60:63], v90 offset:16640
  v_mfma_f32_16x16x32_bf16 v[20:23], v[204:207], v[68:71], v[20:23]
  v_mfma_f32_16x16x32_bf16 v[32:35], v[68:71], a[12:15], v[32:35]
  v_mfma_f32_16x16x32_bf16 v[36:39], v[68:71], a[76:79], v[36:39]
  s_waitcnt lgkmcnt(5)
  v_mfma_f32_16x16x32_bf16 v[8:11], v[144:147], v[40:43], v[8:11]
  ds_read_b128 v[64:67], v91 offset:256
  v_mfma_f32_16x16x32_bf16 v[12:15], v[208:211], v[40:43], v[12:15]
  v_mfma_f32_16x16x32_bf16 v[24:27], v[40:43], a[16:19], v[24:27]
  v_mfma_f32_16x16x32_bf16 v[28:31], v[40:43], a[80:83], v[28:31]
  s_waitcnt lgkmcnt(5)
  v_mfma_f32_16x16x32_bf16 v[16:19], v[144:147], v[44:47], v[16:19]
  ds_read_b128 v[68:71], v91 offset:16640
  v_mfma_f32_16x16x32_bf16 v[20:23], v[208:211], v[44:47], v[20:23]
  v_mfma_f32_16x16x32_bf16 v[32:35], v[44:47], a[16:19], v[32:35]
  v_mfma_f32_16x16x32_bf16 v[36:39], v[44:47], a[80:83], v[36:39]
  s_waitcnt vmcnt(0)
  s_cmp_eq_u32 s49, 0
  s_cbranch_scc1 q_np_52
  s_mov_b64 exec, 1
  buffer_store_dword v4, v5, s[4:7], s49 offen sc1
  s_mov_b64 exec, -1
  s_mov_b32 s49, 0
q_np_52:
  v_cmp_eq_u32 vcc, 0, v2
  s_bitcmp1_b32 s51, 7
  s_cbranch_scc0 q_mid_51
  s_cmp_lg_u32 s48, 0
  s_cbranch_scc1 q_mid_51
  s_cbranch_vccnz q_mid_51
  s_and_b32 s26, s51, 127
  s_lshl_b32 s26, s26, 15
  s_xor_b32 s27, s50, 32768
  s_add_u32 m0, s27, s54
  s_add_u32 s26, s26, s54
  s_add_u32 s26, s26, 6291456
  buffer_load_dwordx4 v92, s[4:7], s26 offen offset:0 sc1 lds
  buffer_load_dwordx4 v93, s[4:7], s26 offen offset:1024 sc1 lds
  buffer_load_dwordx4 v94, s[4:7], s26 offen offset:2048 sc1 lds
  buffer_load_dwordx4 v95, s[4:7], s26 offen offset:3072 sc1 lds
  s_add_u32 m0, m0, 4096
  s_add_u32 s26, s26, 4096
  buffer_load_dwordx4 v96, s[4:7], s26 offen offset:0 sc1 lds
  buffer_load_dwordx4 v97, s[4:7], s26 offen offset:1024 sc1 lds
  buffer_load_dwordx4 v98, s[4:7], s26 offen offset:2048 sc1 lds
  buffer_load_dwordx4 v99, s[4:7], s26 offen offset:3072 sc1 lds
  s_mov_b32 s48, 1
q_mid_51:
  s_waitcnt lgkmcnt(5)
  v_mfma_f32_16x16x32_bf16 v[8:11], v[148:151], v[48:51], v[8:11]
  ds_read_b128 v[40:43], v88 offset:512
  v_mfma_f32_16x16x32_bf16 v[12:15], v[212:215], v[48:51], v[12:15]
  v_mfma_f32_16x16x32_bf16 v[24:27], v[48:51], a[20:23], v[24:27]
  v_mfma_f32_16x16x32_bf16 v[28:31], v[48:51], a[84:87], v[28:31]
  s_waitcnt lgkmcnt(5)
  v_mfma_f32_16x16x32_bf16 v[16:19], v[148:151], v[52:55], v[16:19]
  ds_read_b128 v[44:47], v88 offset:16896
  v_mfma_f32_16x16x32_bf16 v[20:23], v[212:215], v[52:55], v[20:23]
  v_mfma_f32_16x16x32_bf16 v[32:35], v[52:55], a[20:23], v[32:35]
  v_mfma_f32_16x16x32_bf16 v[36:39], v[52:55], a[84:87], v[36:39]
  s_waitcnt lgkmcnt(5)
  v_mfma_f32_16x16x32_bf16 v[8:11], v[152:155], v[56:59], v[8:11]
  ds_read_b128 v[48:51], v89 offset:512
  v_mfma_f32_16x16x32_bf16 v[12:15], v[216:219], v[56:59], v[12:15]
  v_mfma_f32_16x16x32_bf16 v[24:27], v[56:59], a[24:27], v[24:27]
  v_mfma_f32_16x16x32_bf16 v[28:31], v[56:59], a[88:91], v[28:31]
  s_waitcnt lgkmcnt(5)
  v_mfma_f32_16x16x32_bf16 v[16:19], v[152:155], v[60:63], v[16:19]
  ds_read_b128 v[52:55], v89 offset:16896
  v_mfma_f32_16x16x32_bf16 v[20:23], v[216:219], v[60:63], v[20:23]
  v_mfma_f32_16x16x32_bf16 v[32:35], v[60:63], a[24:27], v[32:35]
  v_mfma_f32_16x16x32_bf16 v[36:39], v[60:63], a[88:91], v[36:39]
  s_waitcnt lgkmcnt(5)
  v_mfma_f32_16x16x32_bf16 v[8:11], v[156:159], v[64:67], v[8:11]
  ds_read_b128 v[56:59], v90 offset:512
  v_mfma_f32_16x16x32_bf16 v[12:15], v[220:223], v[64:67], v[12:15]
  v_mfma_f32_16x16x32_bf16 v[24:27], v[64:67], a[28:31], v[24:27]
  v_mfma_f32_16x16x32_bf16 v[28:31], v[64:67], a[92:95], v[28:31]
  s_waitcnt lgkmcnt(5)
  v_mfma_f32_16x16x32_bf16 v[16:19], v[156:159], v[68:71], v[16:19]
  ds_read_b128 v[60:63], v90 offset:16896
  v_mfma_f32_16x16x32_bf16 v[20:23], v[220:223], v[68:71], v[20:23]
  v_mfma_f32_16x16x32_bf16 v[32:35], v[68:71], a[28:31], v[32:35]
  v_mfma_f32_16x16x32_bf16 v[36:39], v[68:71], a[92:95], v[36:39]
  s_waitcnt lgkmcnt(5)
  v_mfma_f32_16x16x32_bf16 v[8:11], v[160:163], v[40:43], v[8:11]
  ds_read_b128 v[64:67], v91 offset:512
  v_mfma_f32_16x16x32_bf16 v[12:15], v[224:227], v[40:43], v[12:15]
  v_mfma_f32_16x16x32_bf16 v[24:27], v[40:43], a[32:35], v[24:27]
  v_mfma_f32_16x16x32_bf16 v[28:31], v[40:43], a[96:99], v[28:31]
  s_waitcnt lgkmcnt(5)
  v_mfma_f32_16x16x32_bf16 v[16:19], v[160:163], v[44:47], v[16:19]
  ds_read_b128 v[68:71], v91 offset:16896
  v_mfma_f32_16x16x32_bf16 v[20:23], v[224:227], v[44:47], v[20:23]
  v_mfma_f32_16x16x32_bf16 v[32:35], v[44:47], a[32:35], v[32:35]
  v_mfma_f32_16x16x32_bf16 v[36:39], v[44:47], a[96:99], v[36:39]
  s_waitcnt lgkmcnt(5)
  v_mfma_f32_16x16x32_bf16 v[8:11], v[164:167], v[48:51], v[8:11]
  ds_read_b128 v[40:43], v88 offset:768
  v_mfma_f32_16x16x32_bf16 v[12:15], v[228:231], v[48:51], v[12:15]
  v_mfma_f32_16x16x32_bf16 v[24:27], v[48:51], a[36:39], v[24:27]
  v_mfma_f32_16x16x32_bf16 v[28:31], v[48:51], a[100:103], v[28:31]
  s_waitcnt lgkmcnt(5)
  v_mfma_f32_16x16x32_bf16 v[16:19], v[164:167], v[52:55], v[16:19]
  ds_read_b128 v[44:47], v88 offset:17152
  v_mfma_f32_16x16x32_bf16 v[20:23], v[228:231], v[52:55], v[20:23]
  v_mfma_f32_16x16x32_bf16 v[32:35], v[52:55], a[36:39], v[32:35]
  v_mfma_f32_16x16x32_bf16 v[36:39], v[52:55], a[100:103], v[36:39]
  s_waitcnt lgkmcnt(5)
  v_mfma_f32_16x16x32_bf16 v[8:11], v[168:171], v[56:59], v[8:11]
  ds_read_b128 v[48:51], v89 offset:768
  v_mfma_f32_16x16x32_bf16 v[12:15], v[232:235], v[56:59], v[12:15]
  v_mfma_f32_16x16x32_bf16 v[24:27], v[56:59], a[40:43], v[24:27]
  v_mfma_f32_16x16x32_bf16 v[28:31], v[56:59], a[104:107], v[28:31]
  s_waitcnt lgkmcnt(5)
  v_mfma_f32_16x16x32_bf16 v[16:19], v[168:171], v[60:63], v[16:19]
  ds_read_b128 v[52:55], v89 offset:17152
  v_mfma_f32_16x16x32_bf16 v[20:23], v[232:235], v[60:63], v[20:23]
  v_mfma_f32_16x16x32_bf16 v[32:35], v[60:63], a[40:43], v[32:35]
  v_mfma_f32_16x16x32_bf16 v[36:39], v[60:63], a[104:107], v[36:39]
  s_waitcnt lgkmcnt(5)
  v_mfma_f32_16x16x32_bf16 v[8:11], v[172:175], v[64:67], v[8:11]
  ds_read_b128 v[56:59], v90 offset:768
  v_mfma_f32_16x16x32_bf16 v[12:15], v[236:239], v[64:67], v[12:15]
  v_mfma_f32_16x16x32_bf16 v[24:27], v[64:67], a[44:47], v[24:27]
  v_mfma_f32_16x16x32_bf16 v[28:31], v[64:67], a[108:111], v[28:31]
  s_waitcnt lgkmcnt(5)
  v_mfma_f32_16x16x32_bf16 v[16:19], v[172:175], v[68:71], v[16:19]
  ds_read_b128 v[60:63], v90 offset:17152
  v_mfma_f32_16x16x32_bf16 v[20:23], v[236:239], v[68:71], v[20:23]
  v_mfma_f32_16x16x32_bf16 v[32:35], v[68:71], a[44:47], v[32:35]
  v_mfma_f32_16x16x32_bf16 v[36:39], v[68:71], a[108:111], v[36:39]
  s_waitcnt lgkmcnt(5)
  v_mfma_f32_16x16x32_bf16 v[8:11], v[176:179], v[40:43], v[8:11]
  ds_read_b128 v[64:67], v91 offset:768
  v_mfma_f32_16x16x32_bf16 v[12:15], v[240:243], v[40:43], v[12:15]
  v_mfma_f32_16x16x32_bf16 v[24:27], v[40:43], a[48:51], v[24:27]
  v_mfma_f32_16x16x32_bf16 v[28:31], v[40:43], a[112:115], v[28:31]
  s_waitcnt lgkmcnt(5)
  v_mfma_f32_16x16x32_bf16 v[16:19], v[176:179], v[44:47], v[16:19]
  ds_read_b128 v[68:71], v91 offset:17152
  v_mfma_f32_16x16x32_bf16 v[20:23], v[240:243], v[44:47], v[20:23]
  v_mfma_f32_16x16x32_bf16 v[32:35], v[44:47], a[48:51], v[32:35]
  v_mfma_f32_16x16x32_bf16 v[36:39], v[44:47], a[112:115], v[36:39]
  s_waitcnt lgkmcnt(5)
  v_mfma_f32_16x16x32_bf16 v[8:11], v[180:183], v[48:51], v[8:11]
  v_mfma_f32_16x16x32_bf16 v[12:15], v[244:247], v[48:51], v[12:15]
  v_mfma_f32_16x16x32_bf16 v[24:27], v[48:51], a[52:55], v[24:27]
  v_mfma_f32_16x16x32_bf16 v[28:31], v[48:51], a[116:119], v[28:31]
  s_waitcnt lgkmcnt(4)
  v_mfma_f32_16x16x32_bf16 v[16:19], v[180:183], v[52:55], v[16:19]
  v_mfma_f32_16x16x32_bf16 v[20:23], v[244:247], v[52:55], v[20:23]
  v_mfma_f32_16x16x32_bf16 v[32:35], v[52:55], a[52:55], v[32:35]
  v_mfma_f32_16x16x32_bf16 v[36:39], v[52:55], a[116:119], v[36:39]
  s_waitcnt lgkmcnt(3)
  v_mfma_f32_16x16x32_bf16 v[8:11], v[184:187], v[56:59], v[8:11]
  v_mfma_f32_16x16x32_bf16 v[12:15], v[248:251], v[56:59], v[12:15]
  v_mfma_f32_16x16x32_bf16 v[24:27], v[56:59], a[56:59], v[24:27]
  v_mfma_f32_16x16x32_bf16 v[28:31], v[56:59], a[120:123], v[28:31]
  s_waitcnt lgkmcnt(2)
  v_mfma_f32_16x16x32_bf16 v[16:19], v[184:187], v[60:63], v[16:19]
  v_mfma_f32_16x16x32_bf16 v[20:23], v[248:251], v[60:63], v[20:23]
  v_mfma_f32_16x16x32_bf16 v[32:35], v[60:63], a[56:59], v[32:35]
  v_mfma_f32_16x16x32_bf16 v[36:39], v[60:63], a[120:123], v[36:39]
  s_waitcnt lgkmcnt(1)
  v_mfma_f32_16x16x32_bf16 v[8:11], v[188:191], v[64:67], v[8:11]
  v_mfma_f32_16x16x32_bf16 v[12:15], v[252:255], v[64:67], v[12:15]
  v_mfma_f32_16x16x32_bf16 v[24:27], v[64:67], a[60:63], v[24:27]
  v_mfma_f32_16x16x32_bf16 v[28:31], v[64:67], a[124:127], v[28:31]
  s_waitcnt lgkmcnt(0)
  v_mfma_f32_16x16x32_bf16 v[16:19], v[188:191], v[68:71], v[16:19]
  v_mfma_f32_16x16x32_bf16 v[20:23], v[252:255], v[68:71], v[20:23]
  v_mfma_f32_16x16x32_bf16 v[32:35], v[68:71], a[60:63], v[32:35]
  v_mfma_f32_16x16x32_bf16 v[36:39], v[68:71], a[124:127], v[36:39]
  s_lshl_b32 s26, s52, 12
  s_add_u32 s26, s26, 16777216
  v_pk_mul_f32 v[8:9], v[8:9], s[24:25] op_sel_hi:[1,0]
  v_pk_mul_f32 v[10:11], v[10:11], s[24:25] op_sel_hi:[1,0]
  v_pk_mul_f32 v[12:13], v[12:13], s[24:25] op_sel_hi:[1,0]
  v_pk_mul_f32 v[14:15], v[14:15], s[24:25] op_sel_hi:[1,0]
  v_cvt_pk_bf16_f32 v72, v8, v9
  v_cvt_pk_bf16_f32 v73, v10, v11
  v_cvt_pk_bf16_f32 v74, v12, v13
  v_cvt_pk_bf16_f32 v75, v14, v15
  buffer_store_dwordx4 v[72:75], v0, s[4:7], s26 offen offset:0 sc1
  v_pk_mul_f32 v[16:17], v[16:17], s[24:25] op_sel_hi:[1,0]
  v_pk_mul_f32 v[18:19], v[18:19], s[24:25] op_sel_hi:[1,0]
  v_pk_mul_f32 v[20:21], v[20:21], s[24:25] op_sel_hi:[1,0]
  v_pk_mul_f32 v[22:23], v[22:23], s[24:25] op_sel_hi:[1,0]
  v_cvt_pk_bf16_f32 v76, v16, v17
  v_cvt_pk_bf16_f32 v77, v18, v19
  v_cvt_pk_bf16_f32 v78, v20, v21
  v_cvt_pk_bf16_f32 v79, v22, v23
  buffer_store_dwordx4 v[76:79], v0, s[4:7], s26 offen offset:1024 sc1
  v_cvt_pk_bf16_f32 v80, v24, v25
  v_cvt_pk_bf16_f32 v81, v26, v27
  v_cvt_pk_bf16_f32 v82, v32, v33
  v_cvt_pk_bf16_f32 v83, v34, v35
  buffer_store_dwordx4 v[80:83], v0, s[4:7], s26 offen offset:2048 sc1
  v_cvt_pk_bf16_f32 v84, v28, v29
  v_cvt_pk_bf16_f32 v85, v30, v31
  v_cvt_pk_bf16_f32 v86, v36, v37
  v_cvt_pk_bf16_f32 v87, v38, v39
  buffer_store_dwordx4 v[84:87], v0, s[4:7], s26 offen offset:3072 sc1
  s_lshl_b32 s49, s52, 2
  s_add_u32 s49, s49, 5308416
  s_waitcnt vmcnt(4)
  s_branch q_top_44
q_qblk_47:
  ds_read_b128 v[40:43], v88 offset:0
  ds_read_b128 v[44:47], v88 offset:16384
  ds_read_b128 v[48:51], v89 offset:0
  ds_read_b128 v[52:55], v89 offset:16384
  ds_read_b128 v[56:59], v90 offset:0
  ds_read_b128 v[60:63], v90 offset:16384
  s_waitcnt lgkmcnt(5)
  v_mfma_f32_16x16x32_bf16 v[8:11], a[128:131], v[40:43], 0
  ds_read_b128 v[64:67], v91 offset:0
  v_mfma_f32_16x16x32_bf16 v[12:15], a[192:195], v[40:43], 0
  s_waitcnt lgkmcnt(5)
  v_mfma_f32_16x16x32_bf16 v[16:19], a[128:131], v[44:47], 0
  ds_read_b128 v[68:71], v91 offset:16384
  v_mfma_f32_16x16x32_bf16 v[20:23], a[192:195], v[44:47], 0
  s_waitcnt lgkmcnt(5)
  v_mfma_f32_16x16x32_bf16 v[8:11], a[132:135], v[48:51], v[8:11]
  ds_read_b128 v[40:43], v88 offset:256
  v_mfma_f32_16x16x32_bf16 v[12:15], a[196:199], v[48:51], v[12:15]
  s_waitcnt lgkmcnt(5)
  v_mfma_f32_16x16x32_bf16 v[16:19], a[132:135], v[52:55], v[16:19]
  ds_read_b128 v[44:47], v88 offset:16640
  v_mfma_f32_16x16x32_bf16 v[20:23], a[196:199], v[52:55], v[20:23]
  s_waitcnt lgkmcnt(5)
  v_mfma_f32_16x16x32_bf16 v[8:11], a[136:139], v[56:59], v[8:11]
  ds_read_b128 v[48:51], v89 offset:256
  v_mfma_f32_16x16x32_bf16 v[12:15], a[200:203], v[56:59], v[12:15]
  s_waitcnt lgkmcnt(5)
  v_mfma_f32_16x16x32_bf16 v[16:19], a[136:139], v[60:63], v[16:19]
  ds_read_b128 v[52:55], v89 offset:16640
  v_mfma_f32_16x16x32_bf16 v[20:23], a[200:203], v[60:63], v[20:23]
  s_waitcnt lgkmcnt(5)
  v_mfma_f32_16x16x32_bf16 v[8:11], a[140:143], v[64:67], v[8:11]
  ds_read_b128 v[56:59], v90 offset:256
  v_mfma_f32_16x16x32_bf16 v[12:15], a[204:207], v[64:67], v[12:15]
  s_waitcnt lgkmcnt(5)
  v_mfma_f32_16x16x32_bf16 v[16:19], a[140:143], v[68:71], v[16:19]
  ds_read_b128 v[60:63], v90 offset:16640
  v_mfma_f32_16x16x32_bf16 v[20:23], a[204:207], v[68:71], v[20:23]
  s_waitcnt lgkmcnt(5)
  v_mfma_f32_16x16x32_bf16 v[8:11], a[144:147], v[40:43], v[8:11]
  ds_read_b128 v[64:67], v91 offset:256
  v_mfma_f32_16x16x32_bf16 v[12:15], a[208:211], v[40:43], v[12:15]
  s_waitcnt lgkmcnt(5)
  v_mfma_f32_16x16x32_bf16 v[16:19], a[144:147], v[44:47], v[16:19]
  ds_read_b128 v[68:71], v91 offset:16640
  v_mfma_f32_16x16x32_bf16 v[20:23], a[208:211], v[44:47], v[20:23]
  s_waitcnt lgkmcnt(5)
  v_mfma_f32_16x16x32_bf16 v[8:11], a[148:151], v[48:51], v[8:11]
  ds_read_b128 v[40:43], v88 offset:512
  v_mfma_f32_16x16x32_bf16 v[12:15], a[212:215], v[48:51], v[12:15]
  s_waitcnt lgkmcnt(5)
  v_mfma_f32_16x16x32_bf16 v[16:19], a[148:151], v[52:55], v[16:19]
  ds_read_b128 v[44:47], v88 offset:16896
  v_mfma_f32_16x16x32_bf16 v[20:23], a[212:215], v[52:55], v[20:23]
  s_waitcnt lgkmcnt(5)
  v_mfma_f32_16x16x32_bf16 v[8:11], a[152:155], v[56:59], v[8:11]
  ds_read_b128 v[48:51], v89 offset:512
  v_mfma_f32_16x16x32_bf16 v[12:15], a[216:219], v[56:59], v[12:15]
  s_waitcnt lgkmcnt(5)
  v_mfma_f32_16x16x32_bf16 v[16:19], a[152:155], v[60:63], v[16:19]
  ds_read_b128 v[52:55], v89 offset:16896
  v_mfma_f32_16x16x32_bf16 v[20:23], a[216:219], v[60:63], v[20:23]
  s_waitcnt lgkmcnt(5)
  v_mfma_f32_16x16x32_bf16 v[8:11], a[156:159], v[64:67], v[8:11]
  ds_read_b128 v[56:59], v90 offset:512
  v_mfma_f32_16x16x32_bf16 v[12:15], a[220:223], v[64:67], v[12:15]
  s_waitcnt lgkmcnt(5)
  v_mfma_f32_16x16x32_bf16 v[16:19], a[156:159], v[68:71], v[16:19]
  ds_read_b128 v[60:63], v90 offset:16896
  v_mfma_f32_16x16x32_bf16 v[20:23], a[220:223], v[68:71], v[20:23]
  s_waitcnt vmcnt(0)
  s_cmp_eq_u32 s49, 0
  s_cbranch_scc1 q_np_54
  s_mov_b64 exec, 1
  buffer_store_dword v4, v5, s[4:7], s49 offen sc1
  s_mov_b64 exec, -1
  s_mov_b32 s49, 0
q_np_54:
  v_cmp_eq_u32 vcc, 0, v2
  s_bitcmp1_b32 s51, 7
  s_cbranch_scc0 q_mid_53
  s_cmp_lg_u32 s48, 0
  s_cbranch_scc1 q_mid_53
  s_cbranch_vccnz q_mid_53
  s_and_b32 s26, s51, 127
  s_lshl_b32 s26, s26, 15
  s_xor_b32 s27, s50, 32768
  s_add_u32 m0, s27, s54
  s_add_u32 s26, s26, s54
  s_add_u32 s26, s26, 6291456
  buffer_load_dwordx4 v92, s[4:7], s26 offen offset:0 sc1 lds
  buffer_load_dwordx4 v93, s[4:7], s26 offen offset:1024 sc1 lds
  buffer_load_dwordx4 v94, s[4:7], s26 offen offset:2048 sc1 lds
  buffer_load_dwordx4 v95, s[4:7], s26 offen offset:3072 sc1 lds
  s_add_u32 m0, m0, 4096
  s_add_u32 s26, s26, 4096
  buffer_load_dwordx4 v96, s[4:7], s26 offen offset:0 sc1 lds
  buffer_load_dwordx4 v97, s[4:7], s26 offen offset:1024 sc1 lds
  buffer_load_dwordx4 v98, s[4:7], s26 offen offset:2048 sc1 lds
  buffer_load_dwordx4 v99, s[4:7], s26 offen offset:3072 sc1 lds
  s_mov_b32 s48, 1
q_mid_53:
  s_waitcnt lgkmcnt(5)
  v_mfma_f32_16x16x32_bf16 v[8:11], a[160:163], v[40:43], v[8:11]
  ds_read_b128 v[64:67], v91 offset:512
  v_mfma_f32_16x16x32_bf16 v[12:15], a[224:227], v[40:43], v[12:15]
  s_waitcnt lgkmcnt(5)
  v_mfma_f32_16x16x32_bf16 v[16:19], a[160:163], v[44:47], v[16:19]
  ds_read_b128 v[68:71], v91 offset:16896
  v_mfma_f32_16x16x32_bf16 v[20:23], a[224:227], v[44:47], v[20:23]
  s_waitcnt lgkmcnt(5)
  v_mfma_f32_16x16x32_bf16 v[8:11], a[164:167], v[48:51], v[8:11]
  ds_read_b128 v[40:43], v88 offset:768
  v_mfma_f32_16x16x32_bf16 v[12:15], a[228:231], v[48:51], v[12:15]
  s_waitcnt lgkmcnt(5)
  v_mfma_f32_16x16x32_bf16 v[16:19], a[164:167], v[52:55], v[16:19]
  ds_read_b128 v[44:47], v88 offset:17152
  v_mfma_f32_16x16x32_bf16 v[20:23], a[228:231], v[52:55], v[20:23]
  s_waitcnt lgkmcnt(5)
  v_mfma_f32_16x16x32_bf16 v[8:11], a[168:171], v[56:59], v[8:11]
  ds_read_b128 v[48:51], v89 offset:768
  v_mfma_f32_16x16x32_bf16 v[12:15], a[232:235], v[56:59], v[12:15]
  s_waitcnt lgkmcnt(5)
  v_mfma_f32_16x16x32_bf16 v[16:19], a[168:171], v[60:63], v[16:19]
  ds_read_b128 v[52:55], v89 offset:17152
  v_mfma_f32_16x16x32_bf16 v[20:23], a[232:235], v[60:63], v[20:23]
  s_waitcnt lgkmcnt(5)
  v_mfma_f32_16x16x32_bf16 v[8:11], a[172:175], v[64:67], v[8:11]
  ds_read_b128 v[56:59], v90 offset:768
  v_mfma_f32_16x16x32_bf16 v[12:15], a[236:239], v[64:67], v[12:15]
  s_waitcnt lgkmcnt(5)
  v_mfma_f32_16x16x32_bf16 v[16:19], a[172:175], v[68:71], v[16:19]
  ds_read_b128 v[60:63], v90 offset:17152
  v_mfma_f32_16x16x32_bf16 v[20:23], a[236:239], v[68:71], v[20:23]
  s_waitcnt lgkmcnt(5)
  v_mfma_f32_16x16x32_bf16 v[8:11], a[176:179], v[40:43], v[8:11]
  ds_read_b128 v[64:67], v91 offset:768
  v_mfma_f32_16x16x32_bf16 v[12:15], a[240:243], v[40:43], v[12:15]
  s_waitcnt lgkmcnt(5)
  v_mfma_f32_16x16x32_bf16 v[16:19], a[176:179], v[44:47], v[16:19]
  ds_read_b128 v[68:71], v91 offset:17152
  v_mfma_f32_16x16x32_bf16 v[20:23], a[240:243], v[44:47], v[20:23]
  s_waitcnt lgkmcnt(5)
  v_mfma_f32_16x16x32_bf16 v[8:11], a[180:183], v[48:51], v[8:11]
  v_mfma_f32_16x16x32_bf16 v[12:15], a[244:247], v[48:51], v[12:15]
  s_waitcnt lgkmcnt(4)
  v_mfma_f32_16x16x32_bf16 v[16:19], a[180:183], v[52:55], v[16:19]
  v_mfma_f32_16x16x32_bf16 v[20:23], a[244:247], v[52:55], v[20:23]
  s_waitcnt lgkmcnt(3)
  v_mfma_f32_16x16x32_bf16 v[8:11], a[184:187], v[56:59], v[8:11]
  v_mfma_f32_16x16x32_bf16 v[12:15], a[248:251], v[56:59], v[12:15]
  s_waitcnt lgkmcnt(2)
  v_mfma_f32_16x16x32_bf16 v[16:19], a[184:187], v[60:63], v[16:19]
  v_mfma_f32_16x16x32_bf16 v[20:23], a[248:251], v[60:63], v[20:23]
  s_waitcnt lgkmcnt(1)
  v_mfma_f32_16x16x32_bf16 v[8:11], a[188:191], v[64:67], v[8:11]
  v_mfma_f32_16x16x32_bf16 v[12:15], a[252:255], v[64:67], v[12:15]
  s_waitcnt lgkmcnt(0)
  v_mfma_f32_16x16x32_bf16 v[16:19], a[188:191], v[68:71], v[16:19]
  v_mfma_f32_16x16x32_bf16 v[20:23], a[252:255], v[68:71], v[20:23]
  s_lshl_b32 s26, s52, 11
  s_add_u32 s26, s26, 83886080
  s_nop 1
  v_cvt_pk_bf16_f32 v72, v8, v9
  v_cvt_pk_bf16_f32 v73, v10, v11
  v_cvt_pk_bf16_f32 v74, v12, v13
  v_cvt_pk_bf16_f32 v75, v14, v15
  buffer_store_dwordx4 v[72:75], v0, s[4:7], s26 offen offset:0 sc1
  v_cvt_pk_bf16_f32 v76, v16, v17
  v_cvt_pk_bf16_f32 v77, v18, v19
  v_cvt_pk_bf16_f32 v78, v20, v21
  v_cvt_pk_bf16_f32 v79, v22, v23
  buffer_store_dwordx4 v[76:79], v0, s[4:7], s26 offen offset:1024 sc1
  s_lshl_b32 s49, s52, 2
  s_add_u32 s49, s49, 5373952
  s_waitcnt vmcnt(2)
  s_branch q_top_44
q_end_45:
  s_waitcnt vmcnt(0)
  s_cmp_eq_u32 s49, 0
  s_cbranch_scc1 q_np_55
  s_mov_b64 exec, 1
  buffer_store_dword v4, v5, s[4:7], s49 offen sc1
  s_mov_b64 exec, -1
  s_mov_b32 s49, 0
q_np_55:
q_fail_49:
  s_endpgm
L_o:
  s_sub_u32 s26, s90, 192
  s_lshr_b32 s60, s26, 4
  s_and_b32 s61, s26, 15
  s_lshl_b32 s26, s26, 13
  s_add_u32 s26, s26, 5242880
  v_lshlrev_b32 v1, 4, v0
  v_mov_b64 v[4:5], 0
  v_mov_b64 v[6:7], 0
  buffer_store_dwordx4 v[4:7], v1, s[4:7], s26 offen sc1
  s_add_u32 s26, s26, 4096
  buffer_store_dwordx4 v[4:7], v1, s[4:7], s26 offen sc1
  v_and_b32 v26, 63, v0
  v_and_b32 v24, 15, v26
  v_lshrrev_b32 v25, 4, v26
  v_lshlrev_b32 v1, 3, v26
  v_lshlrev_b32 v2, 2, v26
  v_lshlrev_b32 v0, 4, v26
  s_mov_b32 s24, 0x3e0293ee
  s_mov_b32 s44, 0x05040100
  s_mov_b32 s45, 0x07060302
  s_and_b32 s26, s17, 1
  s_lshl_b32 s26, s26, 4
  v_lshlrev_b32 v27, 2, v25
  v_sub_u32 v3, v24, v27
  v_add_u32 v3, s26, v3
  v_lshlrev_b32 v27, 16, v25
  v_lshl_add_u32 v27, v24, 4, v27
  s_lshl_b32 s26, s61, 10
  s_lshl_b32 s27, s17, 8
  s_add_u32 s26, s26, s27
  v_add_u32 v4, s26, v27
  v_lshlrev_b32 v27, 10, v25
  v_lshl_add_u32 v5, v24, 4, v27
  s_lshl_b32 s26, s17, 12
  v_add_u32 v6, s26, v0
  s_mov_b32 vcc_lo, 0xaaaaaaaa
  s_mov_b32 vcc_hi, 0xaaaaaaaa
  v_mov_b32 v27, 0x3f80
  v_cndmask_b32 v27, v27, 1.0, vcc
  s_mov_b32 vcc_lo, 0x30003
  s_mov_b32 vcc_hi, 0x30003
  v_cndmask_b32 v16, 0, v27, vcc
  s_mov_b32 vcc_lo, 0xc000c
  s_mov_b32 vcc_hi, 0xc000c
  v_cndmask_b32 v17, 0, v27, vcc
  s_mov_b32 vcc_lo, 0x300030
  s_mov_b32 vcc_hi, 0x300030
  v_cndmask_b32 v18, 0, v27, vcc
  s_mov_b32 vcc_lo, 0xc000c0
  s_mov_b32 vcc_hi, 0xc000c0
  v_cndmask_b32 v19, 0, v27, vcc
  s_mov_b32 vcc_lo, 0x3000300
  s_mov_b32 vcc_hi, 0x3000300
  v_cndmask_b32 v20, 0, v27, vcc
  s_mov_b32 vcc_lo, 0xc000c00
  s_mov_b32 vcc_hi, 0xc000c00
  v_cndmask_b32 v21, 0, v27, vcc
  s_mov_b32 vcc_lo, 0x30003000
  s_mov_b32 vcc_hi, 0x30003000
  v_cndmask_b32 v22, 0, v27, vcc
  s_mov_b32 vcc_lo, 0xc000c000
  s_mov_b32 vcc_hi, 0xc000c000
  v_cndmask_b32 v23, 0, v27, vcc
  s_load_dwordx2 s[68:69], s[0:1], 96
  s_load_dwordx2 s[72:73], s[0:1], 0
  s_load_dwordx2 s[8:9], s[0:1], 64
  s_mov_b32 s70, 2097152
  s_mov_b32 s71, 0x20000
  s_mov_b32 s74, 2097152
  s_mov_b32 s75, 0x20000
  s_mov_b32 s10, 1024
  s_mov_b32 s11, 0x20000
  s_waitcnt lgkmcnt(0)
  buffer_load_dwordx4 v[28:31], v0, s[8:11], 0 offen
  s_waitcnt vmcnt(0)
  v_lshlrev_b32 v8, 16, v28
  v_and_b32 v9, 0xffff0000, v28
  v_lshlrev_b32 v10, 16, v29
  v_and_b32 v11, 0xffff0000, v29
  v_lshlrev_b32 v12, 16, v30
  v_and_b32 v13, 0xffff0000, v30
  v_lshlrev_b32 v14, 16, v31
  v_and_b32 v15, 0xffff0000, v31
  s_barrier
  s_cmp_lg_u32 s17, 0
  s_cbranch_scc1 g_ar_56
  v_mov_b32 v60, 160
  v_mov_b32 v61, 1
  s_mov_b64 exec, 1
  global_atomic_add v60, v61, s[12:13]
  s_mov_b64 exec, -1
g_ar_56:
  s_lshl_b32 s77, s60, 4
  s_add_u32 s77, s77, s61
  s_lshl_b32 s77, s77, 2
  s_add_u32 s77, s77, s17
  s_lshl_b32 s26, s77, 10
  buffer_load_dwordx4 v[64:67], v0, s[72:75], s26 offen
  s_add_u32 s26, s26, 262144
  buffer_load_dwordx4 v[68:71], v0, s[72:75], s26 offen
  s_add_u32 s26, s26, 262144
  buffer_load_dwordx4 v[72:75], v0, s[72:75], s26 offen
  s_add_u32 s26, s26, 262144
  buffer_load_dwordx4 v[76:79], v0, s[72:75], s26 offen
  s_add_u32 s26, s26, 262144
  buffer_load_dwordx4 v[80:83], v0, s[72:75], s26 offen
  s_add_u32 s26, s26, 262144
  buffer_load_dwordx4 v[84:87], v0, s[72:75], s26 offen
  s_add_u32 s26, s26, 262144
  buffer_load_dwordx4 v[88:91], v0, s[72:75], s26 offen
  s_add_u32 s26, s26, 262144
  buffer_load_dwordx4 v[92:95], v0, s[72:75], s26 offen
  s_add_u32 s26, s26, 262144
  s_mov_b32 s26, 0
  v_mov_b32 v60, 160
g_wc_57:
  global_load_dword v61, v60, s[12:13] sc1
  s_add_u32 s26, s26, 1
  s_cmp_gt_u32 s26, 1048576
  s_cbranch_scc1 L_end
  s_waitcnt vmcnt(0)
  v_readfirstlane_b32 s27, v61
  s_cmp_lt_u32 s27, 64
  s_cbranch_scc1 g_wc_57
  s_lshl_b32 s26, s77, 10
  s_add_u32 s26, s26, 6291456
  s_lshl_b32 s27, s77, 2
  s_add_u32 s27, s27, 5242880
  v_mov_b32 v60, 1
  v_mov_b32 v61, 0
  s_waitcnt vmcnt(0)
  v_lshlrev_b32 v32, 16, v64
  v_and_b32 v33, 0xffff0000, v64
  v_lshlrev_b32 v34, 16, v65
  v_and_b32 v35, 0xffff0000, v65
  v_lshlrev_b32 v36, 16, v66
  v_and_b32 v37, 0xffff0000, v66
  v_lshlrev_b32 v38, 16, v67
  v_and_b32 v39, 0xffff0000, v67
  v_add_f32 v40, v32, v33
  v_add_f32 v41, v34, v35
  v_add_f32 v42, v36, v37
  v_add_f32 v43, v38, v39
  v_add_f32 v40, v40, v41
  v_add_f32 v42, v42, v43
  v_add_f32 v40, v40, v42
  s_nop 1
  v_add_f32_dpp v40, v40, v40 row_ror:8 row_mask:0xf bank_mask:0xf
  s_nop 1
  v_add_f32_dpp v40, v40, v40 row_ror:4 row_mask:0xf bank_mask:0xf
  s_nop 1
  v_add_f32_dpp v40, v40, v40 row_ror:2 row_mask:0xf bank_mask:0xf
  s_nop 1
  v_add_f32_dpp v40, v40, v40 row_ror:1 row_mask:0xf bank_mask:0xf
  v_mov_b32 v42, v40
  s_nop 0
  s_nop 0
  v_permlane16_swap_b32 v40, v42
  v_add_f32 v40, v40, v42
  v_mov_b32 v42, v40
  s_nop 0
  s_nop 0
  v_permlane32_swap_b32 v40, v42
  v_add_f32 v40, v40, v42
  v_mul_f32 v40, 0x3b000000, v40
  v_sub_f32 v44, v32, v40
  v_sub_f32 v45, v33, v40
  v_sub_f32 v46, v34, v40
  v_sub_f32 v47, v35, v40
  v_sub_f32 v48, v36, v40
  v_sub_f32 v49, v37, v40
  v_sub_f32 v50, v38, v40
  v_sub_f32 v51, v39, v40
  v_mul_f32 v41, v44, v44
  v_mul_f32 v42, v45, v45
  v_fmac_f32 v41, v46, v46
  v_fmac_f32 v42, v47, v47
  v_fmac_f32 v41, v48, v48
  v_fmac_f32 v42, v49, v49
  v_fmac_f32 v41, v50, v50
  v_fmac_f32 v42, v51, v51
  v_add_f32 v41, v41, v42
  v_cvt_pk_bf16_f32 v40, v40, v40
  v_and_b32 v40, 0xffff0000, v40
  v_add_f32_dpp v41, v41, v41 row_ror:8 row_mask:0xf bank_mask:0xf
  s_nop 1
  v_add_f32_dpp v41, v41, v41 row_ror:4 row_mask:0xf bank_mask:0xf
  s_nop 1
  v_add_f32_dpp v41, v41, v41 row_ror:2 row_mask:0xf bank_mask:0xf
  s_nop 1
  v_add_f32_dpp v41, v41, v41 row_ror:1 row_mask:0xf bank_mask:0xf
  v_mov_b32 v42, v41
  s_nop 0
  s_nop 0
  v_permlane16_swap_b32 v41, v42
  v_add_f32 v41, v41, v42
  v_mov_b32 v42, v41
  s_nop 0
  s_nop 0
  v_permlane32_swap_b32 v41, v42
  v_add_f32 v41, v41, v42
  v_sub_f32 v44, v32, v40
  v_sub_f32 v45, v33, v40
  v_sub_f32 v46, v34, v40
  v_sub_f32 v47, v35, v40
  v_sub_f32 v48, v36, v40
  v_sub_f32 v49, v37, v40
  v_sub_f32 v50, v38, v40
  v_sub_f32 v51, v39, v40
  v_mul_f32 v41, 0x3b000000, v41
  v_cvt_pk_bf16_f32 v41, v41, v41
  v_and_b32 v41, 0xffff0000, v41
  v_add_f32 v41, 0x3727c5ac, v41
  v_cvt_pk_bf16_f32 v41, v41, v41
  v_and_b32 v41, 0xffff0000, v41
  v_sqrt_f32 v41, v41
  v_cvt_pk_bf16_f32 v64, v44, v45
  v_cvt_pk_bf16_f32 v65, v46, v47
  v_cvt_pk_bf16_f32 v66, v48, v49
  v_cvt_pk_bf16_f32 v67, v50, v51
  v_cvt_pk_bf16_f32 v41, v41, v41
  v_and_b32 v41, 0xffff0000, v41
  v_rcp_f32 v41, v41
  v_lshlrev_b32 v44, 16, v64
  v_and_b32 v45, 0xffff0000, v64
  v_lshlrev_b32 v46, 16, v65
  v_and_b32 v47, 0xffff0000, v65
  v_lshlrev_b32 v48, 16, v66
  v_and_b32 v49, 0xffff0000, v66
  v_lshlrev_b32 v50, 16, v67
  v_and_b32 v51, 0xffff0000, v67
  v_mul_f32 v44, v44, v41
  v_mul_f32 v45, v45, v41
  v_mul_f32 v46, v46, v41
  v_mul_f32 v47, v47, v41
  v_mul_f32 v48, v48, v41
  v_mul_f32 v49, v49, v41
  v_mul_f32 v50, v50, v41
  v_mul_f32 v51, v51, v41
  v_cvt_pk_bf16_f32 v64, v44, v45
  v_cvt_pk_bf16_f32 v65, v46, v47
  v_cvt_pk_bf16_f32 v66, v48, v49
  v_cvt_pk_bf16_f32 v67, v50, v51
  buffer_store_dwordx4 v[64:67], v0, s[4:7], s26 offen sc1
  s_add_u32 s26, s26, 262144
  v_lshlrev_b32 v32, 16, v68
  v_and_b32 v33, 0xffff0000, v68
  v_lshlrev_b32 v34, 16, v69
  v_and_b32 v35, 0xffff0000, v69
  v_lshlrev_b32 v36, 16, v70
  v_and_b32 v37, 0xffff0000, v70
  v_lshlrev_b32 v38, 16, v71
  v_and_b32 v39, 0xffff0000, v71
  v_add_f32 v40, v32, v33
  v_add_f32 v41, v34, v35
  v_add_f32 v42, v36, v37
  v_add_f32 v43, v38, v39
  v_add_f32 v40, v40, v41
  v_add_f32 v42, v42, v43
  v_add_f32 v40, v40, v42
  s_nop 1
  v_add_f32_dpp v40, v40, v40 row_ror:8 row_mask:0xf bank_mask:0xf
  s_nop 1
  v_add_f32_dpp v40, v40, v40 row_ror:4 row_mask:0xf bank_mask:0xf
  s_nop 1
  v_add_f32_dpp v40, v40, v40 row_ror:2 row_mask:0xf bank_mask:0xf
  s_nop 1
  v_add_f32_dpp v40, v40, v40 row_ror:1 row_mask:0xf bank_mask:0xf
  v_mov_b32 v42, v40
  s_nop 0
  s_nop 0
  v_permlane16_swap_b32 v40, v42
  v_add_f32 v40, v40, v42
  v_mov_b32 v42, v40
  s_nop 0
  s_nop 0
  v_permlane32_swap_b32 v40, v42
  v_add_f32 v40, v40, v42
  v_mul_f32 v40, 0x3b000000, v40
  v_sub_f32 v44, v32, v40
  v_sub_f32 v45, v33, v40
  v_sub_f32 v46, v34, v40
  v_sub_f32 v47, v35, v40
  v_sub_f32 v48, v36, v40
  v_sub_f32 v49, v37, v40
  v_sub_f32 v50, v38, v40
  v_sub_f32 v51, v39, v40
  v_mul_f32 v41, v44, v44
  v_mul_f32 v42, v45, v45
  v_fmac_f32 v41, v46, v46
  v_fmac_f32 v42, v47, v47
  v_fmac_f32 v41, v48, v48
  v_fmac_f32 v42, v49, v49
  v_fmac_f32 v41, v50, v50
  v_fmac_f32 v42, v51, v51
  v_add_f32 v41, v41, v42
  v_cvt_pk_bf16_f32 v40, v40, v40
  v_and_b32 v40, 0xffff0000, v40
  v_add_f32_dpp v41, v41, v41 row_ror:8 row_mask:0xf bank_mask:0xf
  s_nop 1
  v_add_f32_dpp v41, v41, v41 row_ror:4 row_mask:0xf bank_mask:0xf
  s_nop 1
  v_add_f32_dpp v41, v41, v41 row_ror:2 row_mask:0xf bank_mask:0xf
  s_nop 1
  v_add_f32_dpp v41, v41, v41 row_ror:1 row_mask:0xf bank_mask:0xf
  v_mov_b32 v42, v41
  s_nop 0
  s_nop 0
  v_permlane16_swap_b32 v41, v42
  v_add_f32 v41, v41, v42
  v_mov_b32 v42, v41
  s_nop 0
  s_nop 0
  v_permlane32_swap_b32 v41, v42
  v_add_f32 v41, v41, v42
  v_sub_f32 v44, v32, v40
  v_sub_f32 v45, v33, v40
  v_sub_f32 v46, v34, v40
  v_sub_f32 v47, v35, v40
  v_sub_f32 v48, v36, v40
  v_sub_f32 v49, v37, v40
  v_sub_f32 v50, v38, v40
  v_sub_f32 v51, v39, v40
  v_mul_f32 v41, 0x3b000000, v41
  v_cvt_pk_bf16_f32 v41, v41, v41
  v_and_b32 v41, 0xffff0000, v41
  v_add_f32 v41, 0x3727c5ac, v41
  v_cvt_pk_bf16_f32 v41, v41, v41
  v_and_b32 v41, 0xffff0000, v41
  v_sqrt_f32 v41, v41
  v_cvt_pk_bf16_f32 v68, v44, v45
  v_cvt_pk_bf16_f32 v69, v46, v47
  v_cvt_pk_bf16_f32 v70, v48, v49
  v_cvt_pk_bf16_f32 v71, v50, v51
  v_cvt_pk_bf16_f32 v41, v41, v41
  v_and_b32 v41, 0xffff0000, v41
  v_rcp_f32 v41, v41
  v_lshlrev_b32 v44, 16, v68
  v_and_b32 v45, 0xffff0000, v68
  v_lshlrev_b32 v46, 16, v69
  v_and_b32 v47, 0xffff0000, v69
  v_lshlrev_b32 v48, 16, v70
  v_and_b32 v49, 0xffff0000, v70
  v_lshlrev_b32 v50, 16, v71
  v_and_b32 v51, 0xffff0000, v71
  v_mul_f32 v44, v44, v41
  v_mul_f32 v45, v45, v41
  v_mul_f32 v46, v46, v41
  v_mul_f32 v47, v47, v41
  v_mul_f32 v48, v48, v41
  v_mul_f32 v49, v49, v41
  v_mul_f32 v50, v50, v41
  v_mul_f32 v51, v51, v41
  v_cvt_pk_bf16_f32 v68, v44, v45
  v_cvt_pk_bf16_f32 v69, v46, v47
  v_cvt_pk_bf16_f32 v70, v48, v49
  v_cvt_pk_bf16_f32 v71, v50, v51
  s_waitcnt vmcnt(0)
  s_mov_b64 exec, 1
  buffer_store_dword v60, v61, s[4:7], s27 offen sc1
  s_mov_b64 exec, -1
  s_add_u32 s27, s27, 1024
  buffer_store_dwordx4 v[68:71], v0, s[4:7], s26 offen sc1
  s_add_u32 s26, s26, 262144
  v_lshlrev_b32 v32, 16, v72
  v_and_b32 v33, 0xffff0000, v72
  v_lshlrev_b32 v34, 16, v73
  v_and_b32 v35, 0xffff0000, v73
  v_lshlrev_b32 v36, 16, v74
  v_and_b32 v37, 0xffff0000, v74
  v_lshlrev_b32 v38, 16, v75
  v_and_b32 v39, 0xffff0000, v75
  v_add_f32 v40, v32, v33
  v_add_f32 v41, v34, v35
  v_add_f32 v42, v36, v37
  v_add_f32 v43, v38, v39
  v_add_f32 v40, v40, v41
  v_add_f32 v42, v42, v43
  v_add_f32 v40, v40, v42
  s_nop 1
  v_add_f32_dpp v40, v40, v40 row_ror:8 row_mask:0xf bank_mask:0xf
  s_nop 1
  v_add_f32_dpp v40, v40, v40 row_ror:4 row_mask:0xf bank_mask:0xf
  s_nop 1
  v_add_f32_dpp v40, v40, v40 row_ror:2 row_mask:0xf bank_mask:0xf
  s_nop 1
  v_add_f32_dpp v40, v40, v40 row_ror:1 row_mask:0xf bank_mask:0xf
  v_mov_b32 v42, v40
  s_nop 0
  s_nop 0
  v_permlane16_swap_b32 v40, v42
  v_add_f32 v40, v40, v42
  v_mov_b32 v42, v40
  s_nop 0
  s_nop 0
  v_permlane32_swap_b32 v40, v42
  v_add_f32 v40, v40, v42
  v_mul_f32 v40, 0x3b000000, v40
  v_sub_f32 v44, v32, v40
  v_sub_f32 v45, v33, v40
  v_sub_f32 v46, v34, v40
  v_sub_f32 v47, v35, v40
  v_sub_f32 v48, v36, v40
  v_sub_f32 v49, v37, v40
  v_sub_f32 v50, v38, v40
  v_sub_f32 v51, v39, v40
  v_mul_f32 v41, v44, v44
  v_mul_f32 v42, v45, v45
  v_fmac_f32 v41, v46, v46
  v_fmac_f32 v42, v47, v47
  v_fmac_f32 v41, v48, v48
  v_fmac_f32 v42, v49, v49
  v_fmac_f32 v41, v50, v50
  v_fmac_f32 v42, v51, v51
  v_add_f32 v41, v41, v42
  v_cvt_pk_bf16_f32 v40, v40, v40
  v_and_b32 v40, 0xffff0000, v40
  v_add_f32_dpp v41, v41, v41 row_ror:8 row_mask:0xf bank_mask:0xf
  s_nop 1
  v_add_f32_dpp v41, v41, v41 row_ror:4 row_mask:0xf bank_mask:0xf
  s_nop 1
  v_add_f32_dpp v41, v41, v41 row_ror:2 row_mask:0xf bank_mask:0xf
  s_nop 1
  v_add_f32_dpp v41, v41, v41 row_ror:1 row_mask:0xf bank_mask:0xf
  v_mov_b32 v42, v41
  s_nop 0
  s_nop 0
  v_permlane16_swap_b32 v41, v42
  v_add_f32 v41, v41, v42
  v_mov_b32 v42, v41
  s_nop 0
  s_nop 0
  v_permlane32_swap_b32 v41, v42
  v_add_f32 v41, v41, v42
  v_sub_f32 v44, v32, v40
  v_sub_f32 v45, v33, v40
  v_sub_f32 v46, v34, v40
  v_sub_f32 v47, v35, v40
  v_sub_f32 v48, v36, v40
  v_sub_f32 v49, v37, v40
  v_sub_f32 v50, v38, v40
  v_sub_f32 v51, v39, v40
  v_mul_f32 v41, 0x3b000000, v41
  v_cvt_pk_bf16_f32 v41, v41, v41
  v_and_b32 v41, 0xffff0000, v41
  v_add_f32 v41, 0x3727c5ac, v41
  v_cvt_pk_bf16_f32 v41, v41, v41
  v_and_b32 v41, 0xffff0000, v41
  v_sqrt_f32 v41, v41
  v_cvt_pk_bf16_f32 v72, v44, v45
  v_cvt_pk_bf16_f32 v73, v46, v47
  v_cvt_pk_bf16_f32 v74, v48, v49
  v_cvt_pk_bf16_f32 v75, v50, v51
  v_cvt_pk_bf16_f32 v41, v41, v41
  v_and_b32 v41, 0xffff0000, v41
  v_rcp_f32 v41, v41
  v_lshlrev_b32 v44, 16, v72
  v_and_b32 v45, 0xffff0000, v72
  v_lshlrev_b32 v46, 16, v73
  v_and_b32 v47, 0xffff0000, v73
  v_lshlrev_b32 v48, 16, v74
  v_and_b32 v49, 0xffff0000, v74
  v_lshlrev_b32 v50, 16, v75
  v_and_b32 v51, 0xffff0000, v75
  v_mul_f32 v44, v44, v41
  v_mul_f32 v45, v45, v41
  v_mul_f32 v46, v46, v41
  v_mul_f32 v47, v47, v41
  v_mul_f32 v48, v48, v41
  v_mul_f32 v49, v49, v41
  v_mul_f32 v50, v50, v41
  v_mul_f32 v51, v51, v41
  v_cvt_pk_bf16_f32 v72, v44, v45
  v_cvt_pk_bf16_f32 v73, v46, v47
  v_cvt_pk_bf16_f32 v74, v48, v49
  v_cvt_pk_bf16_f32 v75, v50, v51
  s_waitcnt vmcnt(0)
  s_mov_b64 exec, 1
  buffer_store_dword v60, v61, s[4:7], s27 offen sc1
  s_mov_b64 exec, -1
  s_add_u32 s27, s27, 1024
  buffer_store_dwordx4 v[72:75], v0, s[4:7], s26 offen sc1
  s_add_u32 s26, s26, 262144
  v_lshlrev_b32 v32, 16, v76
  v_and_b32 v33, 0xffff0000, v76
  v_lshlrev_b32 v34, 16, v77
  v_and_b32 v35, 0xffff0000, v77
  v_lshlrev_b32 v36, 16, v78
  v_and_b32 v37, 0xffff0000, v78
  v_lshlrev_b32 v38, 16, v79
  v_and_b32 v39, 0xffff0000, v79
  v_add_f32 v40, v32, v33
  v_add_f32 v41, v34, v35
  v_add_f32 v42, v36, v37
  v_add_f32 v43, v38, v39
  v_add_f32 v40, v40, v41
  v_add_f32 v42, v42, v43
  v_add_f32 v40, v40, v42
  s_nop 1
  v_add_f32_dpp v40, v40, v40 row_ror:8 row_mask:0xf bank_mask:0xf
  s_nop 1
  v_add_f32_dpp v40, v40, v40 row_ror:4 row_mask:0xf bank_mask:0xf
  s_nop 1
  v_add_f32_dpp v40, v40, v40 row_ror:2 row_mask:0xf bank_mask:0xf
  s_nop 1
  v_add_f32_dpp v40, v40, v40 row_ror:1 row_mask:0xf bank_mask:0xf
  v_mov_b32 v42, v40
  s_nop 0
  s_nop 0
  v_permlane16_swap_b32 v40, v42
  v_add_f32 v40, v40, v42
  v_mov_b32 v42, v40
  s_nop 0
  s_nop 0
  v_permlane32_swap_b32 v40, v42
  v_add_f32 v40, v40, v42
  v_mul_f32 v40, 0x3b000000, v40
  v_sub_f32 v44, v32, v40
  v_sub_f32 v45, v33, v40
  v_sub_f32 v46, v34, v40
  v_sub_f32 v47, v35, v40
  v_sub_f32 v48, v36, v40
  v_sub_f32 v49, v37, v40
  v_sub_f32 v50, v38, v40
  v_sub_f32 v51, v39, v40
  v_mul_f32 v41, v44, v44
  v_mul_f32 v42, v45, v45
  v_fmac_f32 v41, v46, v46
  v_fmac_f32 v42, v47, v47
  v_fmac_f32 v41, v48, v48
  v_fmac_f32 v42, v49, v49
  v_fmac_f32 v41, v50, v50
  v_fmac_f32 v42, v51, v51
  v_add_f32 v41, v41, v42
  v_cvt_pk_bf16_f32 v40, v40, v40
  v_and_b32 v40, 0xffff0000, v40
  v_add_f32_dpp v41, v41, v41 row_ror:8 row_mask:0xf bank_mask:0xf
  s_nop 1
  v_add_f32_dpp v41, v41, v41 row_ror:4 row_mask:0xf bank_mask:0xf
  s_nop 1
  v_add_f32_dpp v41, v41, v41 row_ror:2 row_mask:0xf bank_mask:0xf
  s_nop 1
  v_add_f32_dpp v41, v41, v41 row_ror:1 row_mask:0xf bank_mask:0xf
  v_mov_b32 v42, v41
  s_nop 0
  s_nop 0
  v_permlane16_swap_b32 v41, v42
  v_add_f32 v41, v41, v42
  v_mov_b32 v42, v41
  s_nop 0
  s_nop 0
  v_permlane32_swap_b32 v41, v42
  v_add_f32 v41, v41, v42
  v_sub_f32 v44, v32, v40
  v_sub_f32 v45, v33, v40
  v_sub_f32 v46, v34, v40
  v_sub_f32 v47, v35, v40
  v_sub_f32 v48, v36, v40
  v_sub_f32 v49, v37, v40
  v_sub_f32 v50, v38, v40
  v_sub_f32 v51, v39, v40
  v_mul_f32 v41, 0x3b000000, v41
  v_cvt_pk_bf16_f32 v41, v41, v41
  v_and_b32 v41, 0xffff0000, v41
  v_add_f32 v41, 0x3727c5ac, v41
  v_cvt_pk_bf16_f32 v41, v41, v41
  v_and_b32 v41, 0xffff0000, v41
  v_sqrt_f32 v41, v41
  v_cvt_pk_bf16_f32 v76, v44, v45
  v_cvt_pk_bf16_f32 v77, v46, v47
  v_cvt_pk_bf16_f32 v78, v48, v49
  v_cvt_pk_bf16_f32 v79, v50, v51
  v_cvt_pk_bf16_f32 v41, v41, v41
  v_and_b32 v41, 0xffff0000, v41
  v_rcp_f32 v41, v41
  v_lshlrev_b32 v44, 16, v76
  v_and_b32 v45, 0xffff0000, v76
  v_lshlrev_b32 v46, 16, v77
  v_and_b32 v47, 0xffff0000, v77
  v_lshlrev_b32 v48, 16, v78
  v_and_b32 v49, 0xffff0000, v78
  v_lshlrev_b32 v50, 16, v79
  v_and_b32 v51, 0xffff0000, v79
  v_mul_f32 v44, v44, v41
  v_mul_f32 v45, v45, v41
  v_mul_f32 v46, v46, v41
  v_mul_f32 v47, v47, v41
  v_mul_f32 v48, v48, v41
  v_mul_f32 v49, v49, v41
  v_mul_f32 v50, v50, v41
  v_mul_f32 v51, v51, v41
  v_cvt_pk_bf16_f32 v76, v44, v45
  v_cvt_pk_bf16_f32 v77, v46, v47
  v_cvt_pk_bf16_f32 v78, v48, v49
  v_cvt_pk_bf16_f32 v79, v50, v51
  s_waitcnt vmcnt(0)
  s_mov_b64 exec, 1
  buffer_store_dword v60, v61, s[4:7], s27 offen sc1
  s_mov_b64 exec, -1
  s_add_u32 s27, s27, 1024
  buffer_store_dwordx4 v[76:79], v0, s[4:7], s26 offen sc1
  s_add_u32 s26, s26, 262144
  v_lshlrev_b32 v32, 16, v80
  v_and_b32 v33, 0xffff0000, v80
  v_lshlrev_b32 v34, 16, v81
  v_and_b32 v35, 0xffff0000, v81
  v_lshlrev_b32 v36, 16, v82
  v_and_b32 v37, 0xffff0000, v82
  v_lshlrev_b32 v38, 16, v83
  v_and_b32 v39, 0xffff0000, v83
  v_add_f32 v40, v32, v33
  v_add_f32 v41, v34, v35
  v_add_f32 v42, v36, v37
  v_add_f32 v43, v38, v39
  v_add_f32 v40, v40, v41
  v_add_f32 v42, v42, v43
  v_add_f32 v40, v40, v42
  s_nop 1
  v_add_f32_dpp v40, v40, v40 row_ror:8 row_mask:0xf bank_mask:0xf
  s_nop 1
  v_add_f32_dpp v40, v40, v40 row_ror:4 row_mask:0xf bank_mask:0xf
  s_nop 1
  v_add_f32_dpp v40, v40, v40 row_ror:2 row_mask:0xf bank_mask:0xf
  s_nop 1
  v_add_f32_dpp v40, v40, v40 row_ror:1 row_mask:0xf bank_mask:0xf
  v_mov_b32 v42, v40
  s_nop 0
  s_nop 0
  v_permlane16_swap_b32 v40, v42
  v_add_f32 v40, v40, v42
  v_mov_b32 v42, v40
  s_nop 0
  s_nop 0
  v_permlane32_swap_b32 v40, v42
  v_add_f32 v40, v40, v42
  v_mul_f32 v40, 0x3b000000, v40
  v_sub_f32 v44, v32, v40
  v_sub_f32 v45, v33, v40
  v_sub_f32 v46, v34, v40
  v_sub_f32 v47, v35, v40
  v_sub_f32 v48, v36, v40
  v_sub_f32 v49, v37, v40
  v_sub_f32 v50, v38, v40
  v_sub_f32 v51, v39, v40
  v_mul_f32 v41, v44, v44
  v_mul_f32 v42, v45, v45
  v_fmac_f32 v41, v46, v46
  v_fmac_f32 v42, v47, v47
  v_fmac_f32 v41, v48, v48
  v_fmac_f32 v42, v49, v49
  v_fmac_f32 v41, v50, v50
  v_fmac_f32 v42, v51, v51
  v_add_f32 v41, v41, v42
  v_cvt_pk_bf16_f32 v40, v40, v40
  v_and_b32 v40, 0xffff0000, v40
  v_add_f32_dpp v41, v41, v41 row_ror:8 row_mask:0xf bank_mask:0xf
  s_nop 1
  v_add_f32_dpp v41, v41, v41 row_ror:4 row_mask:0xf bank_mask:0xf
  s_nop 1
  v_add_f32_dpp v41, v41, v41 row_ror:2 row_mask:0xf bank_mask:0xf
  s_nop 1
  v_add_f32_dpp v41, v41, v41 row_ror:1 row_mask:0xf bank_mask:0xf
  v_mov_b32 v42, v41
  s_nop 0
  s_nop 0
  v_permlane16_swap_b32 v41, v42
  v_add_f32 v41, v41, v42
  v_mov_b32 v42, v41
  s_nop 0
  s_nop 0
  v_permlane32_swap_b32 v41, v42
  v_add_f32 v41, v41, v42
  v_sub_f32 v44, v32, v40
  v_sub_f32 v45, v33, v40
  v_sub_f32 v46, v34, v40
  v_sub_f32 v47, v35, v40
  v_sub_f32 v48, v36, v40
  v_sub_f32 v49, v37, v40
  v_sub_f32 v50, v38, v40
  v_sub_f32 v51, v39, v40
  v_mul_f32 v41, 0x3b000000, v41
  v_cvt_pk_bf16_f32 v41, v41, v41
  v_and_b32 v41, 0xffff0000, v41
  v_add_f32 v41, 0x3727c5ac, v41
  v_cvt_pk_bf16_f32 v41, v41, v41
  v_and_b32 v41, 0xffff0000, v41
  v_sqrt_f32 v41, v41
  v_cvt_pk_bf16_f32 v80, v44, v45
  v_cvt_pk_bf16_f32 v81, v46, v47
  v_cvt_pk_bf16_f32 v82, v48, v49
  v_cvt_pk_bf16_f32 v83, v50, v51
  v_cvt_pk_bf16_f32 v41, v41, v41
  v_and_b32 v41, 0xffff0000, v41
  v_rcp_f32 v41, v41
  v_lshlrev_b32 v44, 16, v80
  v_and_b32 v45, 0xffff0000, v80
  v_lshlrev_b32 v46, 16, v81
  v_and_b32 v47, 0xffff0000, v81
  v_lshlrev_b32 v48, 16, v82
  v_and_b32 v49, 0xffff0000, v82
  v_lshlrev_b32 v50, 16, v83
  v_and_b32 v51, 0xffff0000, v83
  v_mul_f32 v44, v44, v41
  v_mul_f32 v45, v45, v41
  v_mul_f32 v46, v46, v41
  v_mul_f32 v47, v47, v41
  v_mul_f32 v48, v48, v41
  v_mul_f32 v49, v49, v41
  v_mul_f32 v50, v50, v41
  v_mul_f32 v51, v51, v41
  v_cvt_pk_bf16_f32 v80, v44, v45
  v_cvt_pk_bf16_f32 v81, v46, v47
  v_cvt_pk_bf16_f32 v82, v48, v49
  v_cvt_pk_bf16_f32 v83, v50, v51
  s_waitcnt vmcnt(0)
  s_mov_b64 exec, 1
  buffer_store_dword v60, v61, s[4:7], s27 offen sc1
  s_mov_b64 exec, -1
  s_add_u32 s27, s27, 1024
  buffer_store_dwordx4 v[80:83], v0, s[4:7], s26 offen sc1
  s_add_u32 s26, s26, 262144
  v_lshlrev_b32 v32, 16, v84
  v_and_b32 v33, 0xffff0000, v84
  v_lshlrev_b32 v34, 16, v85
  v_and_b32 v35, 0xffff0000, v85
  v_lshlrev_b32 v36, 16, v86
  v_and_b32 v37, 0xffff0000, v86
  v_lshlrev_b32 v38, 16, v87
  v_and_b32 v39, 0xffff0000, v87
  v_add_f32 v40, v32, v33
  v_add_f32 v41, v34, v35
  v_add_f32 v42, v36, v37
  v_add_f32 v43, v38, v39
  v_add_f32 v40, v40, v41
  v_add_f32 v42, v42, v43
  v_add_f32 v40, v40, v42
  s_nop 1
  v_add_f32_dpp v40, v40, v40 row_ror:8 row_mask:0xf bank_mask:0xf
  s_nop 1
  v_add_f32_dpp v40, v40, v40 row_ror:4 row_mask:0xf bank_mask:0xf
  s_nop 1
  v_add_f32_dpp v40, v40, v40 row_ror:2 row_mask:0xf bank_mask:0xf
  s_nop 1
  v_add_f32_dpp v40, v40, v40 row_ror:1 row_mask:0xf bank_mask:0xf
  v_mov_b32 v42, v40
  s_nop 0
  s_nop 0
  v_permlane16_swap_b32 v40, v42
  v_add_f32 v40, v40, v42
  v_mov_b32 v42, v40
  s_nop 0
  s_nop 0
  v_permlane32_swap_b32 v40, v42
  v_add_f32 v40, v40, v42
  v_mul_f32 v40, 0x3b000000, v40
  v_sub_f32 v44, v32, v40
  v_sub_f32 v45, v33, v40
  v_sub_f32 v46, v34, v40
  v_sub_f32 v47, v35, v40
  v_sub_f32 v48, v36, v40
  v_sub_f32 v49, v37, v40
  v_sub_f32 v50, v38, v40
  v_sub_f32 v51, v39, v40
  v_mul_f32 v41, v44, v44
  v_mul_f32 v42, v45, v45
  v_fmac_f32 v41, v46, v46
  v_fmac_f32 v42, v47, v47
  v_fmac_f32 v41, v48, v48
  v_fmac_f32 v42, v49, v49
  v_fmac_f32 v41, v50, v50
  v_fmac_f32 v42, v51, v51
  v_add_f32 v41, v41, v42
  v_cvt_pk_bf16_f32 v40, v40, v40
  v_and_b32 v40, 0xffff0000, v40
  v_add_f32_dpp v41, v41, v41 row_ror:8 row_mask:0xf bank_mask:0xf
  s_nop 1
  v_add_f32_dpp v41, v41, v41 row_ror:4 row_mask:0xf bank_mask:0xf
  s_nop 1
  v_add_f32_dpp v41, v41, v41 row_ror:2 row_mask:0xf bank_mask:0xf
  s_nop 1
  v_add_f32_dpp v41, v41, v41 row_ror:1 row_mask:0xf bank_mask:0xf
  v_mov_b32 v42, v41
  s_nop 0
  s_nop 0
  v_permlane16_swap_b32 v41, v42
  v_add_f32 v41, v41, v42
  v_mov_b32 v42, v41
  s_nop 0
  s_nop 0
  v_permlane32_swap_b32 v41, v42
  v_add_f32 v41, v41, v42
  v_sub_f32 v44, v32, v40
  v_sub_f32 v45, v33, v40
  v_sub_f32 v46, v34, v40
  v_sub_f32 v47, v35, v40
  v_sub_f32 v48, v36, v40
  v_sub_f32 v49, v37, v40
  v_sub_f32 v50, v38, v40
  v_sub_f32 v51, v39, v40
  v_mul_f32 v41, 0x3b000000, v41
  v_cvt_pk_bf16_f32 v41, v41, v41
  v_and_b32 v41, 0xffff0000, v41
  v_add_f32 v41, 0x3727c5ac, v41
  v_cvt_pk_bf16_f32 v41, v41, v41
  v_and_b32 v41, 0xffff0000, v41
  v_sqrt_f32 v41, v41
  v_cvt_pk_bf16_f32 v84, v44, v45
  v_cvt_pk_bf16_f32 v85, v46, v47
  v_cvt_pk_bf16_f32 v86, v48, v49
  v_cvt_pk_bf16_f32 v87, v50, v51
  v_cvt_pk_bf16_f32 v41, v41, v41
  v_and_b32 v41, 0xffff0000, v41
  v_rcp_f32 v41, v41
  v_lshlrev_b32 v44, 16, v84
  v_and_b32 v45, 0xffff0000, v84
  v_lshlrev_b32 v46, 16, v85
  v_and_b32 v47, 0xffff0000, v85
  v_lshlrev_b32 v48, 16, v86
  v_and_b32 v49, 0xffff0000, v86
  v_lshlrev_b32 v50, 16, v87
  v_and_b32 v51, 0xffff0000, v87
  v_mul_f32 v44, v44, v41
  v_mul_f32 v45, v45, v41
  v_mul_f32 v46, v46, v41
  v_mul_f32 v47, v47, v41
  v_mul_f32 v48, v48, v41
  v_mul_f32 v49, v49, v41
  v_mul_f32 v50, v50, v41
  v_mul_f32 v51, v51, v41
  v_cvt_pk_bf16_f32 v84, v44, v45
  v_cvt_pk_bf16_f32 v85, v46, v47
  v_cvt_pk_bf16_f32 v86, v48, v49
  v_cvt_pk_bf16_f32 v87, v50, v51
  s_waitcnt vmcnt(0)
  s_mov_b64 exec, 1
  buffer_store_dword v60, v61, s[4:7], s27 offen sc1
  s_mov_b64 exec, -1
  s_add_u32 s27, s27, 1024
  buffer_store_dwordx4 v[84:87], v0, s[4:7], s26 offen sc1
  s_add_u32 s26, s26, 262144
  v_lshlrev_b32 v32, 16, v88
  v_and_b32 v33, 0xffff0000, v88
  v_lshlrev_b32 v34, 16, v89
  v_and_b32 v35, 0xffff0000, v89
  v_lshlrev_b32 v36, 16, v90
  v_and_b32 v37, 0xffff0000, v90
  v_lshlrev_b32 v38, 16, v91
  v_and_b32 v39, 0xffff0000, v91
  v_add_f32 v40, v32, v33
  v_add_f32 v41, v34, v35
  v_add_f32 v42, v36, v37
  v_add_f32 v43, v38, v39
  v_add_f32 v40, v40, v41
  v_add_f32 v42, v42, v43
  v_add_f32 v40, v40, v42
  s_nop 1
  v_add_f32_dpp v40, v40, v40 row_ror:8 row_mask:0xf bank_mask:0xf
  s_nop 1
  v_add_f32_dpp v40, v40, v40 row_ror:4 row_mask:0xf bank_mask:0xf
  s_nop 1
  v_add_f32_dpp v40, v40, v40 row_ror:2 row_mask:0xf bank_mask:0xf
  s_nop 1
  v_add_f32_dpp v40, v40, v40 row_ror:1 row_mask:0xf bank_mask:0xf
  v_mov_b32 v42, v40
  s_nop 0
  s_nop 0
  v_permlane16_swap_b32 v40, v42
  v_add_f32 v40, v40, v42
  v_mov_b32 v42, v40
  s_nop 0
  s_nop 0
  v_permlane32_swap_b32 v40, v42
  v_add_f32 v40, v40, v42
  v_mul_f32 v40, 0x3b000000, v40
  v_sub_f32 v44, v32, v40
  v_sub_f32 v45, v33, v40
  v_sub_f32 v46, v34, v40
  v_sub_f32 v47, v35, v40
  v_sub_f32 v48, v36, v40
  v_sub_f32 v49, v37, v40
  v_sub_f32 v50, v38, v40
  v_sub_f32 v51, v39, v40
  v_mul_f32 v41, v44, v44
  v_mul_f32 v42, v45, v45
  v_fmac_f32 v41, v46, v46
  v_fmac_f32 v42, v47, v47
  v_fmac_f32 v41, v48, v48
  v_fmac_f32 v42, v49, v49
  v_fmac_f32 v41, v50, v50
  v_fmac_f32 v42, v51, v51
  v_add_f32 v41, v41, v42
  v_cvt_pk_bf16_f32 v40, v40, v40
  v_and_b32 v40, 0xffff0000, v40
  v_add_f32_dpp v41, v41, v41 row_ror:8 row_mask:0xf bank_mask:0xf
  s_nop 1
  v_add_f32_dpp v41, v41, v41 row_ror:4 row_mask:0xf bank_mask:0xf
  s_nop 1
  v_add_f32_dpp v41, v41, v41 row_ror:2 row_mask:0xf bank_mask:0xf
  s_nop 1
  v_add_f32_dpp v41, v41, v41 row_ror:1 row_mask:0xf bank_mask:0xf
  v_mov_b32 v42, v41
  s_nop 0
  s_nop 0
  v_permlane16_swap_b32 v41, v42
  v_add_f32 v41, v41, v42
  v_mov_b32 v42, v41
  s_nop 0
  s_nop 0
  v_permlane32_swap_b32 v41, v42
  v_add_f32 v41, v41, v42
  v_sub_f32 v44, v32, v40
  v_sub_f32 v45, v33, v40
  v_sub_f32 v46, v34, v40
  v_sub_f32 v47, v35, v40
  v_sub_f32 v48, v36, v40
  v_sub_f32 v49, v37, v40
  v_sub_f32 v50, v38, v40
  v_sub_f32 v51, v39, v40
  v_mul_f32 v41, 0x3b000000, v41
  v_cvt_pk_bf16_f32 v41, v41, v41
  v_and_b32 v41, 0xffff0000, v41
  v_add_f32 v41, 0x3727c5ac, v41
  v_cvt_pk_bf16_f32 v41, v41, v41
  v_and_b32 v41, 0xffff0000, v41
  v_sqrt_f32 v41, v41
  v_cvt_pk_bf16_f32 v88, v44, v45
  v_cvt_pk_bf16_f32 v89, v46, v47
  v_cvt_pk_bf16_f32 v90, v48, v49
  v_cvt_pk_bf16_f32 v91, v50, v51
  v_cvt_pk_bf16_f32 v41, v41, v41
  v_and_b32 v41, 0xffff0000, v41
  v_rcp_f32 v41, v41
  v_lshlrev_b32 v44, 16, v88
  v_and_b32 v45, 0xffff0000, v88
  v_lshlrev_b32 v46, 16, v89
  v_and_b32 v47, 0xffff0000, v89
  v_lshlrev_b32 v48, 16, v90
  v_and_b32 v49, 0xffff0000, v90
  v_lshlrev_b32 v50, 16, v91
  v_and_b32 v51, 0xffff0000, v91
  v_mul_f32 v44, v44, v41
  v_mul_f32 v45, v45, v41
  v_mul_f32 v46, v46, v41
  v_mul_f32 v47, v47, v41
  v_mul_f32 v48, v48, v41
  v_mul_f32 v49, v49, v41
  v_mul_f32 v50, v50, v41
  v_mul_f32 v51, v51, v41
  v_cvt_pk_bf16_f32 v88, v44, v45
  v_cvt_pk_bf16_f32 v89, v46, v47
  v_cvt_pk_bf16_f32 v90, v48, v49
  v_cvt_pk_bf16_f32 v91, v50, v51
  s_waitcnt vmcnt(0)
  s_mov_b64 exec, 1
  buffer_store_dword v60, v61, s[4:7], s27 offen sc1
  s_mov_b64 exec, -1
  s_add_u32 s27, s27, 1024
  buffer_store_dwordx4 v[88:91], v0, s[4:7], s26 offen sc1
  s_add_u32 s26, s26, 262144
  v_lshlrev_b32 v32, 16, v92
  v_and_b32 v33, 0xffff0000, v92
  v_lshlrev_b32 v34, 16, v93
  v_and_b32 v35, 0xffff0000, v93
  v_lshlrev_b32 v36, 16, v94
  v_and_b32 v37, 0xffff0000, v94
  v_lshlrev_b32 v38, 16, v95
  v_and_b32 v39, 0xffff0000, v95
  v_add_f32 v40, v32, v33
  v_add_f32 v41, v34, v35
  v_add_f32 v42, v36, v37
  v_add_f32 v43, v38, v39
  v_add_f32 v40, v40, v41
  v_add_f32 v42, v42, v43
  v_add_f32 v40, v40, v42
  s_nop 1
  v_add_f32_dpp v40, v40, v40 row_ror:8 row_mask:0xf bank_mask:0xf
  s_nop 1
  v_add_f32_dpp v40, v40, v40 row_ror:4 row_mask:0xf bank_mask:0xf
  s_nop 1
  v_add_f32_dpp v40, v40, v40 row_ror:2 row_mask:0xf bank_mask:0xf
  s_nop 1
  v_add_f32_dpp v40, v40, v40 row_ror:1 row_mask:0xf bank_mask:0xf
  v_mov_b32 v42, v40
  s_nop 0
  s_nop 0
  v_permlane16_swap_b32 v40, v42
  v_add_f32 v40, v40, v42
  v_mov_b32 v42, v40
  s_nop 0
  s_nop 0
  v_permlane32_swap_b32 v40, v42
  v_add_f32 v40, v40, v42
  v_mul_f32 v40, 0x3b000000, v40
  v_sub_f32 v44, v32, v40
  v_sub_f32 v45, v33, v40
  v_sub_f32 v46, v34, v40
  v_sub_f32 v47, v35, v40
  v_sub_f32 v48, v36, v40
  v_sub_f32 v49, v37, v40
  v_sub_f32 v50, v38, v40
  v_sub_f32 v51, v39, v40
  v_mul_f32 v41, v44, v44
  v_mul_f32 v42, v45, v45
  v_fmac_f32 v41, v46, v46
  v_fmac_f32 v42, v47, v47
  v_fmac_f32 v41, v48, v48
  v_fmac_f32 v42, v49, v49
  v_fmac_f32 v41, v50, v50
  v_fmac_f32 v42, v51, v51
  v_add_f32 v41, v41, v42
  v_cvt_pk_bf16_f32 v40, v40, v40
  v_and_b32 v40, 0xffff0000, v40
  v_add_f32_dpp v41, v41, v41 row_ror:8 row_mask:0xf bank_mask:0xf
  s_nop 1
  v_add_f32_dpp v41, v41, v41 row_ror:4 row_mask:0xf bank_mask:0xf
  s_nop 1
  v_add_f32_dpp v41, v41, v41 row_ror:2 row_mask:0xf bank_mask:0xf
  s_nop 1
  v_add_f32_dpp v41, v41, v41 row_ror:1 row_mask:0xf bank_mask:0xf
  v_mov_b32 v42, v41
  s_nop 0
  s_nop 0
  v_permlane16_swap_b32 v41, v42
  v_add_f32 v41, v41, v42
  v_mov_b32 v42, v41
  s_nop 0
  s_nop 0
  v_permlane32_swap_b32 v41, v42
  v_add_f32 v41, v41, v42
  v_sub_f32 v44, v32, v40
  v_sub_f32 v45, v33, v40
  v_sub_f32 v46, v34, v40
  v_sub_f32 v47, v35, v40
  v_sub_f32 v48, v36, v40
  v_sub_f32 v49, v37, v40
  v_sub_f32 v50, v38, v40
  v_sub_f32 v51, v39, v40
  v_mul_f32 v41, 0x3b000000, v41
  v_cvt_pk_bf16_f32 v41, v41, v41
  v_and_b32 v41, 0xffff0000, v41
  v_add_f32 v41, 0x3727c5ac, v41
  v_cvt_pk_bf16_f32 v41, v41, v41
  v_and_b32 v41, 0xffff0000, v41
  v_sqrt_f32 v41, v41
  v_cvt_pk_bf16_f32 v92, v44, v45
  v_cvt_pk_bf16_f32 v93, v46, v47
  v_cvt_pk_bf16_f32 v94, v48, v49
  v_cvt_pk_bf16_f32 v95, v50, v51
  v_cvt_pk_bf16_f32 v41, v41, v41
  v_and_b32 v41, 0xffff0000, v41
  v_rcp_f32 v41, v41
  v_lshlrev_b32 v44, 16, v92
  v_and_b32 v45, 0xffff0000, v92
  v_lshlrev_b32 v46, 16, v93
  v_and_b32 v47, 0xffff0000, v93
  v_lshlrev_b32 v48, 16, v94
  v_and_b32 v49, 0xffff0000, v94
  v_lshlrev_b32 v50, 16, v95
  v_and_b32 v51, 0xffff0000, v95
  v_mul_f32 v44, v44, v41
  v_mul_f32 v45, v45, v41
  v_mul_f32 v46, v46, v41
  v_mul_f32 v47, v47, v41
  v_mul_f32 v48, v48, v41
  v_mul_f32 v49, v49, v41
  v_mul_f32 v50, v50, v41
  v_mul_f32 v51, v51, v41
  v_cvt_pk_bf16_f32 v92, v44, v45
  v_cvt_pk_bf16_f32 v93, v46, v47
  v_cvt_pk_bf16_f32 v94, v48, v49
  v_cvt_pk_bf16_f32 v95, v50, v51
  s_waitcnt vmcnt(0)
  s_mov_b64 exec, 1
  buffer_store_dword v60, v61, s[4:7], s27 offen sc1
  s_mov_b64 exec, -1
  s_add_u32 s27, s27, 1024
  buffer_store_dwordx4 v[92:95], v0, s[4:7], s26 offen sc1
  s_add_u32 s26, s26, 262144
  s_waitcnt vmcnt(0)
  s_mov_b64 exec, 1
  buffer_store_dword v60, v61, s[4:7], s27 offen sc1
  s_mov_b64 exec, -1
  s_load_dwordx2 s[8:9], s[0:1], 40
  s_mov_b32 s10, 4194304
  v_lshlrev_b32 v26, 13, v25
  v_lshl_add_u32 v26, v24, 4, v26
  s_lshl_b32 s26, s61, 18
  s_lshl_b32 s27, s17, 8
  s_add_u32 s26, s26, s27
  s_waitcnt lgkmcnt(0)
  s_add_u32 s27, s26, 0
  buffer_load_dwordx4 v[64:67], v26, s[8:11], s27 offen
  s_add_u32 s27, s26, 2048
  buffer_load_dwordx4 v[68:71], v26, s[8:11], s27 offen
  s_add_u32 s27, s26, 4096
  buffer_load_dwordx4 v[72:75], v26, s[8:11], s27 offen
  s_add_u32 s27, s26, 6144
  buffer_load_dwordx4 v[76:79], v26, s[8:11], s27 offen
  s_add_u32 s27, s26, 1024
  buffer_load_dwordx4 v[80:83], v26, s[8:11], s27 offen
  s_add_u32 s27, s26, 3072
  buffer_load_dwordx4 v[84:87], v26, s[8:11], s27 offen
  s_add_u32 s27, s26, 5120
  buffer_load_dwordx4 v[88:91], v26, s[8:11], s27 offen
  s_add_u32 s27, s26, 7168
  buffer_load_dwordx4 v[92:95], v26, s[8:11], s27 offen
  s_add_u32 s27, s26, 32768
  buffer_load_dwordx4 v[96:99], v26, s[8:11], s27 offen
  s_add_u32 s27, s26, 34816
  buffer_load_dwordx4 v[100:103], v26, s[8:11], s27 offen
  s_add_u32 s27, s26, 36864
  buffer_load_dwordx4 v[104:107], v26, s[8:11], s27 offen
  s_add_u32 s27, s26, 38912
  buffer_load_dwordx4 v[108:111], v26, s[8:11], s27 offen
  s_add_u32 s27, s26, 33792
  buffer_load_dwordx4 v[112:115], v26, s[8:11], s27 offen
  s_add_u32 s27, s26, 35840
  buffer_load_dwordx4 v[116:119], v26, s[8:11], s27 offen
  s_add_u32 s27, s26, 37888
  buffer_load_dwordx4 v[120:123], v26, s[8:11], s27 offen
  s_add_u32 s27, s26, 39936
  buffer_load_dwordx4 v[124:127], v26, s[8:11], s27 offen
  s_add_u32 s27, s26, 65536
  buffer_load_dwordx4 v[128:131], v26, s[8:11], s27 offen
  s_add_u32 s27, s26, 67584
  buffer_load_dwordx4 v[132:135], v26, s[8:11], s27 offen
  s_add_u32 s27, s26, 69632
  buffer_load_dwordx4 v[136:139], v26, s[8:11], s27 offen
  s_add_u32 s27, s26, 71680
  buffer_load_dwordx4 v[140:143], v26, s[8:11], s27 offen
  s_add_u32 s27, s26, 66560
  buffer_load_dwordx4 v[144:147], v26, s[8:11], s27 offen
  s_add_u32 s27, s26, 68608
  buffer_load_dwordx4 v[148:151], v26, s[8:11], s27 offen
  s_add_u32 s27, s26, 70656
  buffer_load_dwordx4 v[152:155], v26, s[8:11], s27 offen
  s_add_u32 s27, s26, 72704
  buffer_load_dwordx4 v[156:159], v26, s[8:11], s27 offen
  s_add_u32 s27, s26, 98304
  buffer_load_dwordx4 v[160:163], v26, s[8:11], s27 offen
  s_add_u32 s27, s26, 100352
  buffer_load_dwordx4 v[164:167], v26, s[8:11], s27 offen
  s_add_u32 s27, s26, 102400
  buffer_load_dwordx4 v[168:171], v26, s[8:11], s27 offen
  s_add_u32 s27, s26, 104448
  buffer_load_dwordx4 v[172:175], v26, s[8:11], s27 offen
  s_add_u32 s27, s26, 99328
  buffer_load_dwordx4 v[176:179], v26, s[8:11], s27 offen
  s_add_u32 s27, s26, 101376
  buffer_load_dwordx4 v[180:183], v26, s[8:11], s27 offen
  s_add_u32 s27, s26, 103424
  buffer_load_dwordx4 v[184:187], v26, s[8:11], s27 offen
  s_add_u32 s27, s26, 105472
  buffer_load_dwordx4 v[188:191], v26, s[8:11], s27 offen
  s_add_u32 s27, s26, 131072
  buffer_load_dwordx4 v[192:195], v26, s[8:11], s27 offen
  s_add_u32 s27, s26, 133120
  buffer_load_dwordx4 v[196:199], v26, s[8:11], s27 offen
  s_add_u32 s27, s26, 135168
  buffer_load_dwordx4 v[200:203], v26, s[8:11], s27 offen
  s_add_u32 s27, s26, 137216
  buffer_load_dwordx4 v[204:207], v26, s[8:11], s27 offen
  s_add_u32 s27, s26, 132096
  buffer_load_dwordx4 v[208:211], v26, s[8:11], s27 offen
  s_add_u32 s27, s26, 134144
  buffer_load_dwordx4 v[212:215], v26, s[8:11], s27 offen
  s_add_u32 s27, s26, 136192
  buffer_load_dwordx4 v[216:219], v26, s[8:11], s27 offen
  s_add_u32 s27, s26, 138240
  buffer_load_dwordx4 v[220:223], v26, s[8:11], s27 offen
  s_add_u32 s27, s26, 163840
  buffer_load_dwordx4 v[224:227], v26, s[8:11], s27 offen
  s_add_u32 s27, s26, 165888
  buffer_load_dwordx4 v[228:231], v26, s[8:11], s27 offen
  s_add_u32 s27, s26, 167936
  buffer_load_dwordx4 v[232:235], v26, s[8:11], s27 offen
  s_add_u32 s27, s26, 169984
  buffer_load_dwordx4 v[236:239], v26, s[8:11], s27 offen
  s_add_u32 s27, s26, 164864
  buffer_load_dwordx4 v[240:243], v26, s[8:11], s27 offen
  s_add_u32 s27, s26, 166912
  buffer_load_dwordx4 v[244:247], v26, s[8:11], s27 offen
  s_add_u32 s27, s26, 168960
  buffer_load_dwordx4 v[248:251], v26, s[8:11], s27 offen
  s_add_u32 s27, s26, 171008
  buffer_load_dwordx4 v[252:255], v26, s[8:11], s27 offen
  s_waitcnt vmcnt(40)
  v_perm_b32 v32, v68, v64, s44
  v_perm_b32 v33, v76, v72, s44
  v_perm_b32 v34, v84, v80, s44
  v_perm_b32 v35, v92, v88, s44
  v_accvgpr_write_b32 a0, v32
  v_accvgpr_write_b32 a1, v33
  v_accvgpr_write_b32 a2, v34
  v_accvgpr_write_b32 a3, v35
  v_perm_b32 v36, v68, v64, s45
  v_perm_b32 v37, v76, v72, s45
  v_perm_b32 v38, v84, v80, s45
  v_perm_b32 v39, v92, v88, s45
  v_accvgpr_write_b32 a4, v36
  v_accvgpr_write_b32 a5, v37
  v_accvgpr_write_b32 a6, v38
  v_accvgpr_write_b32 a7, v39
  v_perm_b32 v32, v69, v65, s44
  v_perm_b32 v33, v77, v73, s44
  v_perm_b32 v34, v85, v81, s44
  v_perm_b32 v35, v93, v89, s44
  v_accvgpr_write_b32 a8, v32
  v_accvgpr_write_b32 a9, v33
  v_accvgpr_write_b32 a10, v34
  v_accvgpr_write_b32 a11, v35
  v_perm_b32 v36, v69, v65, s45
  v_perm_b32 v37, v77, v73, s45
  v_perm_b32 v38, v85, v81, s45
  v_perm_b32 v39, v93, v89, s45
  v_accvgpr_write_b32 a12, v36
  v_accvgpr_write_b32 a13, v37
  v_accvgpr_write_b32 a14, v38
  v_accvgpr_write_b32 a15, v39
  v_perm_b32 v32, v70, v66, s44
  v_perm_b32 v33, v78, v74, s44
  v_perm_b32 v34, v86, v82, s44
  v_perm_b32 v35, v94, v90, s44
  v_accvgpr_write_b32 a16, v32
  v_accvgpr_write_b32 a17, v33
  v_accvgpr_write_b32 a18, v34
  v_accvgpr_write_b32 a19, v35
  v_perm_b32 v36, v70, v66, s45
  v_perm_b32 v37, v78, v74, s45
  v_perm_b32 v38, v86, v82, s45
  v_perm_b32 v39, v94, v90, s45
  v_accvgpr_write_b32 a20, v36
  v_accvgpr_write_b32 a21, v37
  v_accvgpr_write_b32 a22, v38
  v_accvgpr_write_b32 a23, v39
  v_perm_b32 v32, v71, v67, s44
  v_perm_b32 v33, v79, v75, s44
  v_perm_b32 v34, v87, v83, s44
  v_perm_b32 v35, v95, v91, s44
  v_accvgpr_write_b32 a24, v32
  v_accvgpr_write_b32 a25, v33
  v_accvgpr_write_b32 a26, v34
  v_accvgpr_write_b32 a27, v35
  v_perm_b32 v36, v71, v67, s45
  v_perm_b32 v37, v79, v75, s45
  v_perm_b32 v38, v87, v83, s45
  v_perm_b32 v39, v95, v91, s45
  v_accvgpr_write_b32 a28, v36
  v_accvgpr_write_b32 a29, v37
  v_accvgpr_write_b32 a30, v38
  v_accvgpr_write_b32 a31, v39
  s_add_u32 s27, s26, 196608
  buffer_load_dwordx4 v[64:67], v26, s[8:11], s27 offen
  s_add_u32 s27, s26, 198656
  buffer_load_dwordx4 v[68:71], v26, s[8:11], s27 offen
  s_add_u32 s27, s26, 200704
  buffer_load_dwordx4 v[72:75], v26, s[8:11], s27 offen
  s_add_u32 s27, s26, 202752
  buffer_load_dwordx4 v[76:79], v26, s[8:11], s27 offen
  s_add_u32 s27, s26, 197632
  buffer_load_dwordx4 v[80:83], v26, s[8:11], s27 offen
  s_add_u32 s27, s26, 199680
  buffer_load_dwordx4 v[84:87], v26, s[8:11], s27 offen
  s_add_u32 s27, s26, 201728
  buffer_load_dwordx4 v[88:91], v26, s[8:11], s27 offen
  s_add_u32 s27, s26, 203776
  buffer_load_dwordx4 v[92:95], v26, s[8:11], s27 offen
  s_waitcnt vmcnt(40)
  v_perm_b32 v32, v100, v96, s44
  v_perm_b32 v33, v108, v104, s44
  v_perm_b32 v34, v116, v112, s44
  v_perm_b32 v35, v124, v120, s44
  v_accvgpr_write_b32 a32, v32
  v_accvgpr_write_b32 a33, v33
  v_accvgpr_write_b32 a34, v34
  v_accvgpr_write_b32 a35, v35
  v_perm_b32 v36, v100, v96, s45
  v_perm_b32 v37, v108, v104, s45
  v_perm_b32 v38, v116, v112, s45
  v_perm_b32 v39, v124, v120, s45
  v_accvgpr_write_b32 a36, v36
  v_accvgpr_write_b32 a37, v37
  v_accvgpr_write_b32 a38, v38
  v_accvgpr_write_b32 a39, v39
  v_perm_b32 v32, v101, v97, s44
  v_perm_b32 v33, v109, v105, s44
  v_perm_b32 v34, v117, v113, s44
  v_perm_b32 v35, v125, v121, s44
  v_accvgpr_write_b32 a40, v32
  v_accvgpr_write_b32 a41, v33
  v_accvgpr_write_b32 a42, v34
  v_accvgpr_write_b32 a43, v35
  v_perm_b32 v36, v101, v97, s45
  v_perm_b32 v37, v109, v105, s45
  v_perm_b32 v38, v117, v113, s45
  v_perm_b32 v39, v125, v121, s45
  v_accvgpr_write_b32 a44, v36
  v_accvgpr_write_b32 a45, v37
  v_accvgpr_write_b32 a46, v38
  v_accvgpr_write_b32 a47, v39
  v_perm_b32 v32, v102, v98, s44
  v_perm_b32 v33, v110, v106, s44
  v_perm_b32 v34, v118, v114, s44
  v_perm_b32 v35, v126, v122, s44
  v_accvgpr_write_b32 a48, v32
  v_accvgpr_write_b32 a49, v33
  v_accvgpr_write_b32 a50, v34
  v_accvgpr_write_b32 a51, v35
  v_perm_b32 v36, v102, v98, s45
  v_perm_b32 v37, v110, v106, s45
  v_perm_b32 v38, v118, v114, s45
  v_perm_b32 v39, v126, v122, s45
  v_accvgpr_write_b32 a52, v36
  v_accvgpr_write_b32 a53, v37
  v_accvgpr_write_b32 a54, v38
  v_accvgpr_write_b32 a55, v39
  v_perm_b32 v32, v103, v99, s44
  v_perm_b32 v33, v111, v107, s44
  v_perm_b32 v34, v119, v115, s44
  v_perm_b32 v35, v127, v123, s44
  v_accvgpr_write_b32 a56, v32
  v_accvgpr_write_b32 a57, v33
  v_accvgpr_write_b32 a58, v34
  v_accvgpr_write_b32 a59, v35
  v_perm_b32 v36, v103, v99, s45
  v_perm_b32 v37, v111, v107, s45
  v_perm_b32 v38, v119, v115, s45
  v_perm_b32 v39, v127, v123, s45
  v_accvgpr_write_b32 a60, v36
  v_accvgpr_write_b32 a61, v37
  v_accvgpr_write_b32 a62, v38
  v_accvgpr_write_b32 a63, v39
  s_add_u32 s27, s26, 229376
  buffer_load_dwordx4 v[96:99], v26, s[8:11], s27 offen
  s_add_u32 s27, s26, 231424
  buffer_load_dwordx4 v[100:103], v26, s[8:11], s27 offen
  s_add_u32 s27, s26, 233472
  buffer_load_dwordx4 v[104:107], v26, s[8:11], s27 offen
  s_add_u32 s27, s26, 235520
  buffer_load_dwordx4 v[108:111], v26, s[8:11], s27 offen
  s_add_u32 s27, s26, 230400
  buffer_load_dwordx4 v[112:115], v26, s[8:11], s27 offen
  s_add_u32 s27, s26, 232448
  buffer_load_dwordx4 v[116:119], v26, s[8:11], s27 offen
  s_add_u32 s27, s26, 234496
  buffer_load_dwordx4 v[120:123], v26, s[8:11], s27 offen
  s_add_u32 s27, s26, 236544
  buffer_load_dwordx4 v[124:127], v26, s[8:11], s27 offen
  s_waitcnt vmcnt(40)
  v_perm_b32 v32, v132, v128, s44
  v_perm_b32 v33, v140, v136, s44
  v_perm_b32 v34, v148, v144, s44
  v_perm_b32 v35, v156, v152, s44
  v_accvgpr_write_b32 a64, v32
  v_accvgpr_write_b32 a65, v33
  v_accvgpr_write_b32 a66, v34
  v_accvgpr_write_b32 a67, v35
  v_perm_b32 v36, v132, v128, s45
  v_perm_b32 v37, v140, v136, s45
  v_perm_b32 v38, v148, v144, s45
  v_perm_b32 v39, v156, v152, s45
  v_accvgpr_write_b32 a68, v36
  v_accvgpr_write_b32 a69, v37
  v_accvgpr_write_b32 a70, v38
  v_accvgpr_write_b32 a71, v39
  v_perm_b32 v32, v133, v129, s44
  v_perm_b32 v33, v141, v137, s44
  v_perm_b32 v34, v149, v145, s44
  v_perm_b32 v35, v157, v153, s44
  v_accvgpr_write_b32 a72, v32
  v_accvgpr_write_b32 a73, v33
  v_accvgpr_write_b32 a74, v34
  v_accvgpr_write_b32 a75, v35
  v_perm_b32 v36, v133, v129, s45
  v_perm_b32 v37, v141, v137, s45
  v_perm_b32 v38, v149, v145, s45
  v_perm_b32 v39, v157, v153, s45
  v_accvgpr_write_b32 a76, v36
  v_accvgpr_write_b32 a77, v37
  v_accvgpr_write_b32 a78, v38
  v_accvgpr_write_b32 a79, v39
  v_perm_b32 v32, v134, v130, s44
  v_perm_b32 v33, v142, v138, s44
  v_perm_b32 v34, v150, v146, s44
  v_perm_b32 v35, v158, v154, s44
  v_accvgpr_write_b32 a80, v32
  v_accvgpr_write_b32 a81, v33
  v_accvgpr_write_b32 a82, v34
  v_accvgpr_write_b32 a83, v35
  v_perm_b32 v36, v134, v130, s45
  v_perm_b32 v37, v142, v138, s45
  v_perm_b32 v38, v150, v146, s45
  v_perm_b32 v39, v158, v154, s45
  v_accvgpr_write_b32 a84, v36
  v_accvgpr_write_b32 a85, v37
  v_accvgpr_write_b32 a86, v38
  v_accvgpr_write_b32 a87, v39
  v_perm_b32 v32, v135, v131, s44
  v_perm_b32 v33, v143, v139, s44
  v_perm_b32 v34, v151, v147, s44
  v_perm_b32 v35, v159, v155, s44
  v_accvgpr_write_b32 a88, v32
  v_accvgpr_write_b32 a89, v33
  v_accvgpr_write_b32 a90, v34
  v_accvgpr_write_b32 a91, v35
  v_perm_b32 v36, v135, v131, s45
  v_perm_b32 v37, v143, v139, s45
  v_perm_b32 v38, v151, v147, s45
  v_perm_b32 v39, v159, v155, s45
  v_accvgpr_write_b32 a92, v36
  v_accvgpr_write_b32 a93, v37
  v_accvgpr_write_b32 a94, v38
  v_accvgpr_write_b32 a95, v39
  s_waitcnt vmcnt(32)
  v_perm_b32 v32, v164, v160, s44
  v_perm_b32 v33, v172, v168, s44
  v_perm_b32 v34, v180, v176, s44
  v_perm_b32 v35, v188, v184, s44
  v_accvgpr_write_b32 a96, v32
  v_accvgpr_write_b32 a97, v33
  v_accvgpr_write_b32 a98, v34
  v_accvgpr_write_b32 a99, v35
  v_perm_b32 v36, v164, v160, s45
  v_perm_b32 v37, v172, v168, s45
  v_perm_b32 v38, v180, v176, s45
  v_perm_b32 v39, v188, v184, s45
  v_accvgpr_write_b32 a100, v36
  v_accvgpr_write_b32 a101, v37
  v_accvgpr_write_b32 a102, v38
  v_accvgpr_write_b32 a103, v39
  v_perm_b32 v32, v165, v161, s44
  v_perm_b32 v33, v173, v169, s44
  v_perm_b32 v34, v181, v177, s44
  v_perm_b32 v35, v189, v185, s44
  v_accvgpr_write_b32 a104, v32
  v_accvgpr_write_b32 a105, v33
  v_accvgpr_write_b32 a106, v34
  v_accvgpr_write_b32 a107, v35
  v_perm_b32 v36, v165, v161, s45
  v_perm_b32 v37, v173, v169, s45
  v_perm_b32 v38, v181, v177, s45
  v_perm_b32 v39, v189, v185, s45
  v_accvgpr_write_b32 a108, v36
  v_accvgpr_write_b32 a109, v37
  v_accvgpr_write_b32 a110, v38
  v_accvgpr_write_b32 a111, v39
  v_perm_b32 v32, v166, v162, s44
  v_perm_b32 v33, v174, v170, s44
  v_perm_b32 v34, v182, v178, s44
  v_perm_b32 v35, v190, v186, s44
  v_accvgpr_write_b32 a112, v32
  v_accvgpr_write_b32 a113, v33
  v_accvgpr_write_b32 a114, v34
  v_accvgpr_write_b32 a115, v35
  v_perm_b32 v36, v166, v162, s45
  v_perm_b32 v37, v174, v170, s45
  v_perm_b32 v38, v182, v178, s45
  v_perm_b32 v39, v190, v186, s45
  v_accvgpr_write_b32 a116, v36
  v_accvgpr_write_b32 a117, v37
  v_accvgpr_write_b32 a118, v38
  v_accvgpr_write_b32 a119, v39
  v_perm_b32 v32, v167, v163, s44
  v_perm_b32 v33, v175, v171, s44
  v_perm_b32 v34, v183, v179, s44
  v_perm_b32 v35, v191, v187, s44
  v_accvgpr_write_b32 a120, v32
  v_accvgpr_write_b32 a121, v33
  v_accvgpr_write_b32 a122, v34
  v_accvgpr_write_b32 a123, v35
  v_perm_b32 v36, v167, v163, s45
  v_perm_b32 v37, v175, v171, s45
  v_perm_b32 v38, v183, v179, s45
  v_perm_b32 v39, v191, v187, s45
  v_accvgpr_write_b32 a124, v36
  v_accvgpr_write_b32 a125, v37
  v_accvgpr_write_b32 a126, v38
  v_accvgpr_write_b32 a127, v39
  s_waitcnt vmcnt(24)
  v_perm_b32 v32, v196, v192, s44
  v_perm_b32 v33, v204, v200, s44
  v_perm_b32 v34, v212, v208, s44
  v_perm_b32 v35, v220, v216, s44
  v_accvgpr_write_b32 a128, v32
  v_accvgpr_write_b32 a129, v33
  v_accvgpr_write_b32 a130, v34
  v_accvgpr_write_b32 a131, v35
  v_perm_b32 v36, v196, v192, s45
  v_perm_b32 v37, v204, v200, s45
  v_perm_b32 v38, v212, v208, s45
  v_perm_b32 v39, v220, v216, s45
  v_accvgpr_write_b32 a132, v36
  v_accvgpr_write_b32 a133, v37
  v_accvgpr_write_b32 a134, v38
  v_accvgpr_write_b32 a135, v39
  v_perm_b32 v32, v197, v193, s44
  v_perm_b32 v33, v205, v201, s44
  v_perm_b32 v34, v213, v209, s44
  v_perm_b32 v35, v221, v217, s44
  v_accvgpr_write_b32 a136, v32
  v_accvgpr_write_b32 a137, v33
  v_accvgpr_write_b32 a138, v34
  v_accvgpr_write_b32 a139, v35
  v_perm_b32 v36, v197, v193, s45
  v_perm_b32 v37, v205, v201, s45
  v_perm_b32 v38, v213, v209, s45
  v_perm_b32 v39, v221, v217, s45
  v_accvgpr_write_b32 a140, v36
  v_accvgpr_write_b32 a141, v37
  v_accvgpr_write_b32 a142, v38
  v_accvgpr_write_b32 a143, v39
  v_perm_b32 v32, v198, v194, s44
  v_perm_b32 v33, v206, v202, s44
  v_perm_b32 v34, v214, v210, s44
  v_perm_b32 v35, v222, v218, s44
  v_accvgpr_write_b32 a144, v32
  v_accvgpr_write_b32 a145, v33
  v_accvgpr_write_b32 a146, v34
  v_accvgpr_write_b32 a147, v35
  v_perm_b32 v36, v198, v194, s45
  v_perm_b32 v37, v206, v202, s45
  v_perm_b32 v38, v214, v210, s45
  v_perm_b32 v39, v222, v218, s45
  v_accvgpr_write_b32 a148, v36
  v_accvgpr_write_b32 a149, v37
  v_accvgpr_write_b32 a150, v38
  v_accvgpr_write_b32 a151, v39
  v_perm_b32 v32, v199, v195, s44
  v_perm_b32 v33, v207, v203, s44
  v_perm_b32 v34, v215, v211, s44
  v_perm_b32 v35, v223, v219, s44
  v_accvgpr_write_b32 a152, v32
  v_accvgpr_write_b32 a153, v33
  v_accvgpr_write_b32 a154, v34
  v_accvgpr_write_b32 a155, v35
  v_perm_b32 v36, v199, v195, s45
  v_perm_b32 v37, v207, v203, s45
  v_perm_b32 v38, v215, v211, s45
  v_perm_b32 v39, v223, v219, s45
  v_accvgpr_write_b32 a156, v36
  v_accvgpr_write_b32 a157, v37
  v_accvgpr_write_b32 a158, v38
  v_accvgpr_write_b32 a159, v39
  s_waitcnt vmcnt(16)
  v_perm_b32 v32, v228, v224, s44
  v_perm_b32 v33, v236, v232, s44
  v_perm_b32 v34, v244, v240, s44
  v_perm_b32 v35, v252, v248, s44
  v_accvgpr_write_b32 a160, v32
  v_accvgpr_write_b32 a161, v33
  v_accvgpr_write_b32 a162, v34
  v_accvgpr_write_b32 a163, v35
  v_perm_b32 v36, v228, v224, s45
  v_perm_b32 v37, v236, v232, s45
  v_perm_b32 v38, v244, v240, s45
  v_perm_b32 v39, v252, v248, s45
  v_accvgpr_write_b32 a164, v36
  v_accvgpr_write_b32 a165, v37
  v_accvgpr_write_b32 a166, v38
  v_accvgpr_write_b32 a167, v39
  v_perm_b32 v32, v229, v225, s44
  v_perm_b32 v33, v237, v233, s44
  v_perm_b32 v34, v245, v241, s44
  v_perm_b32 v35, v253, v249, s44
  v_accvgpr_write_b32 a168, v32
  v_accvgpr_write_b32 a169, v33
  v_accvgpr_write_b32 a170, v34
  v_accvgpr_write_b32 a171, v35
  v_perm_b32 v36, v229, v225, s45
  v_perm_b32 v37, v237, v233, s45
  v_perm_b32 v38, v245, v241, s45
  v_perm_b32 v39, v253, v249, s45
  v_accvgpr_write_b32 a172, v36
  v_accvgpr_write_b32 a173, v37
  v_accvgpr_write_b32 a174, v38
  v_accvgpr_write_b32 a175, v39
  v_perm_b32 v32, v230, v226, s44
  v_perm_b32 v33, v238, v234, s44
  v_perm_b32 v34, v246, v242, s44
  v_perm_b32 v35, v254, v250, s44
  v_accvgpr_write_b32 a176, v32
  v_accvgpr_write_b32 a177, v33
  v_accvgpr_write_b32 a178, v34
  v_accvgpr_write_b32 a179, v35
  v_perm_b32 v36, v230, v226, s45
  v_perm_b32 v37, v238, v234, s45
  v_perm_b32 v38, v246, v242, s45
  v_perm_b32 v39, v254, v250, s45
  v_accvgpr_write_b32 a180, v36
  v_accvgpr_write_b32 a181, v37
  v_accvgpr_write_b32 a182, v38
  v_accvgpr_write_b32 a183, v39
  v_perm_b32 v32, v231, v227, s44
  v_perm_b32 v33, v239, v235, s44
  v_perm_b32 v34, v247, v243, s44
  v_perm_b32 v35, v255, v251, s44
  v_accvgpr_write_b32 a184, v32
  v_accvgpr_write_b32 a185, v33
  v_accvgpr_write_b32 a186, v34
  v_accvgpr_write_b32 a187, v35
  v_perm_b32 v36, v231, v227, s45
  v_perm_b32 v37, v239, v235, s45
  v_perm_b32 v38, v247, v243, s45
  v_perm_b32 v39, v255, v251, s45
  v_accvgpr_write_b32 a188, v36
  v_accvgpr_write_b32 a189, v37
  v_accvgpr_write_b32 a190, v38
  v_accvgpr_write_b32 a191, v39
  s_waitcnt vmcnt(8)
  v_perm_b32 v32, v68, v64, s44
  v_perm_b32 v33, v76, v72, s44
  v_perm_b32 v34, v84, v80, s44
  v_perm_b32 v35, v92, v88, s44
  v_accvgpr_write_b32 a192, v32
  v_accvgpr_write_b32 a193, v33
  v_accvgpr_write_b32 a194, v34
  v_accvgpr_write_b32 a195, v35
  v_perm_b32 v36, v68, v64, s45
  v_perm_b32 v37, v76, v72, s45
  v_perm_b32 v38, v84, v80, s45
  v_perm_b32 v39, v92, v88, s45
  v_accvgpr_write_b32 a196, v36
  v_accvgpr_write_b32 a197, v37
  v_accvgpr_write_b32 a198, v38
  v_accvgpr_write_b32 a199, v39
  v_perm_b32 v32, v69, v65, s44
  v_perm_b32 v33, v77, v73, s44
  v_perm_b32 v34, v85, v81, s44
  v_perm_b32 v35, v93, v89, s44
  v_accvgpr_write_b32 a200, v32
  v_accvgpr_write_b32 a201, v33
  v_accvgpr_write_b32 a202, v34
  v_accvgpr_write_b32 a203, v35
  v_perm_b32 v36, v69, v65, s45
  v_perm_b32 v37, v77, v73, s45
  v_perm_b32 v38, v85, v81, s45
  v_perm_b32 v39, v93, v89, s45
  v_accvgpr_write_b32 a204, v36
  v_accvgpr_write_b32 a205, v37
  v_accvgpr_write_b32 a206, v38
  v_accvgpr_write_b32 a207, v39
  v_perm_b32 v32, v70, v66, s44
  v_perm_b32 v33, v78, v74, s44
  v_perm_b32 v34, v86, v82, s44
  v_perm_b32 v35, v94, v90, s44
  v_accvgpr_write_b32 a208, v32
  v_accvgpr_write_b32 a209, v33
  v_accvgpr_write_b32 a210, v34
  v_accvgpr_write_b32 a211, v35
  v_perm_b32 v36, v70, v66, s45
  v_perm_b32 v37, v78, v74, s45
  v_perm_b32 v38, v86, v82, s45
  v_perm_b32 v39, v94, v90, s45
  v_accvgpr_write_b32 a212, v36
  v_accvgpr_write_b32 a213, v37
  v_accvgpr_write_b32 a214, v38
  v_accvgpr_write_b32 a215, v39
  v_perm_b32 v32, v71, v67, s44
  v_perm_b32 v33, v79, v75, s44
  v_perm_b32 v34, v87, v83, s44
  v_perm_b32 v35, v95, v91, s44
  v_accvgpr_write_b32 a216, v32
  v_accvgpr_write_b32 a217, v33
  v_accvgpr_write_b32 a218, v34
  v_accvgpr_write_b32 a219, v35
  v_perm_b32 v36, v71, v67, s45
  v_perm_b32 v37, v79, v75, s45
  v_perm_b32 v38, v87, v83, s45
  v_perm_b32 v39, v95, v91, s45
  v_accvgpr_write_b32 a220, v36
  v_accvgpr_write_b32 a221, v37
  v_accvgpr_write_b32 a222, v38
  v_accvgpr_write_b32 a223, v39
  s_waitcnt vmcnt(0)
  v_perm_b32 v32, v100, v96, s44
  v_perm_b32 v33, v108, v104, s44
  v_perm_b32 v34, v116, v112, s44
  v_perm_b32 v35, v124, v120, s44
  v_accvgpr_write_b32 a224, v32
  v_accvgpr_write_b32 a225, v33
  v_accvgpr_write_b32 a226, v34
  v_accvgpr_write_b32 a227, v35
  v_perm_b32 v36, v100, v96, s45
  v_perm_b32 v37, v108, v104, s45
  v_perm_b32 v38, v116, v112, s45
  v_perm_b32 v39, v124, v120, s45
  v_accvgpr_write_b32 a228, v36
  v_accvgpr_write_b32 a229, v37
  v_accvgpr_write_b32 a230, v38
  v_accvgpr_write_b32 a231, v39
  v_perm_b32 v32, v101, v97, s44
  v_perm_b32 v33, v109, v105, s44
  v_perm_b32 v34, v117, v113, s44
  v_perm_b32 v35, v125, v121, s44
  v_accvgpr_write_b32 a232, v32
  v_accvgpr_write_b32 a233, v33
  v_accvgpr_write_b32 a234, v34
  v_accvgpr_write_b32 a235, v35
  v_perm_b32 v36, v101, v97, s45
  v_perm_b32 v37, v109, v105, s45
  v_perm_b32 v38, v117, v113, s45
  v_perm_b32 v39, v125, v121, s45
  v_accvgpr_write_b32 a236, v36
  v_accvgpr_write_b32 a237, v37
  v_accvgpr_write_b32 a238, v38
  v_accvgpr_write_b32 a239, v39
  v_perm_b32 v32, v102, v98, s44
  v_perm_b32 v33, v110, v106, s44
  v_perm_b32 v34, v118, v114, s44
  v_perm_b32 v35, v126, v122, s44
  v_accvgpr_write_b32 a240, v32
  v_accvgpr_write_b32 a241, v33
  v_accvgpr_write_b32 a242, v34
  v_accvgpr_write_b32 a243, v35
  v_perm_b32 v36, v102, v98, s45
  v_perm_b32 v37, v110, v106, s45
  v_perm_b32 v38, v118, v114, s45
  v_perm_b32 v39, v126, v122, s45
  v_accvgpr_write_b32 a244, v36
  v_accvgpr_write_b32 a245, v37
  v_accvgpr_write_b32 a246, v38
  v_accvgpr_write_b32 a247, v39
  v_perm_b32 v32, v103, v99, s44
  v_perm_b32 v33, v111, v107, s44
  v_perm_b32 v34, v119, v115, s44
  v_perm_b32 v35, v127, v123, s44
  v_accvgpr_write_b32 a248, v32
  v_accvgpr_write_b32 a249, v33
  v_accvgpr_write_b32 a250, v34
  v_accvgpr_write_b32 a251, v35
  v_perm_b32 v36, v103, v99, s45
  v_perm_b32 v37, v111, v107, s45
  v_perm_b32 v38, v119, v115, s45
  v_perm_b32 v39, v127, v123, s45
  v_accvgpr_write_b32 a252, v36
  v_accvgpr_write_b32 a253, v37
  v_accvgpr_write_b32 a254, v38
  v_accvgpr_write_b32 a255, v39
  s_mov_b32 s26, 0
g_pu_58:
  v_and_b32 v60, 0x70, v0
  global_load_dword v61, v60, s[12:13] sc1
  s_waitcnt vmcnt(0)
  v_readlane_b32 s28, v61, 0
  v_readlane_b32 s29, v61, 1
  v_readlane_b32 s30, v61, 2
  v_readlane_b32 s31, v61, 3
  v_readlane_b32 s32, v61, 4
  v_readlane_b32 s33, v61, 5
  v_readlane_b32 s34, v61, 6
  v_readlane_b32 s35, v61, 7
  s_add_u32 s27, s28, s29
  s_add_u32 s27, s27, s30
  s_add_u32 s27, s27, s31
  s_add_u32 s27, s27, s32
  s_add_u32 s27, s27, s33
  s_add_u32 s27, s27, s34
  s_add_u32 s27, s27, s35
  v_readlane_b32 s36, v61, s91
  s_cmp_ge_u32 s36, 32
  s_cbranch_scc1 g_pure_59
  s_cmp_ge_u32 s27, 256
  s_cbranch_scc1 L_o_x
  s_add_u32 s26, s26, 1
  s_cmp_gt_u32 s26, 1048576
  s_cbranch_scc1 L_end
  s_branch g_pu_58
g_pure_59:
  s_mov_b32 s62, 0
  s_mov_b32 s79, 0
  s_mov_b32 s64, 0
  s_mov_b32 s65, 0
  s_mov_b32 s66, 0
  s_mov_b32 s63, s60
o_loop_60:
  s_add_u32 s62, s62, 1
  s_lshr_b32 s26, s17, 1
  s_lshl_b32 s27, s61, 1
  s_add_u32 s26, s26, s27
  s_lshl_b32 s27, s63, 5
  s_add_u32 s26, s26, s27
  s_lshl_b32 s34, s64, 11
  s_add_u32 s34, s34, s26
  s_lshl_b32 s35, s65, 11
  s_add_u32 s35, s35, s26
  s_lshl_b32 s26, s34, 4
  s_add_u32 s27, s26, 5373952
  s_add_u32 s26, s26, 5308416
  s_mov_b32 s67, 0
  v_mov_b32 v7, 0
  v_xor_b32 v6, 16384, v6
  v_and_b32 v200, 16384, v6
  v_add_u32 v200, v200, v0
o_w1_63:
  buffer_load_dwordx4 v[128:131], v7, s[4:7], s26 offen sc1
  buffer_load_dwordx4 v[132:135], v7, s[4:7], s27 offen sc1
  s_add_u32 s67, s67, 1
  s_cmp_gt_u32 s67, 1048576
  s_cbranch_scc1 L_end
  s_waitcnt vmcnt(0)
  v_min3_u32 v128, v128, v129, v130
  v_min3_u32 v128, v128, v131, v132
  v_min3_u32 v128, v128, v133, v134
  v_min_u32 v128, v128, v135
  v_cmp_eq_u32 vcc, 0, v128
  s_cbranch_vccnz o_w1_63
  s_lshl_b32 s26, s34, 13
  s_and_b32 s27, s17, 1
  s_lshl_b32 s27, s27, 10
  s_add_u32 s26, s26, s27
  s_add_u32 s26, s26, 83886080
  s_lshl_b32 s27, s34, 14
  s_add_u32 s27, s27, 16777216
  buffer_load_dwordx4 v[24:27], v0, s[4:7], s26 offen offset:0 sc1
  buffer_load_dwordx4 v[40:43], v0, s[4:7], s27 offen offset:0 sc1
  buffer_load_dwordx4 v[56:59], v0, s[4:7], s27 offen offset:1024 sc1
  buffer_load_dwordx4 v[88:91], v0, s[4:7], s27 offen offset:2048 sc1
  buffer_load_dwordx4 v[92:95], v0, s[4:7], s27 offen offset:3072 sc1
  s_add_u32 s27, s27, 4096
  buffer_load_dwordx4 v[28:31], v0, s[4:7], s26 offen offset:2048 sc1
  s_add_u32 s26, s26, 4096
  buffer_load_dwordx4 v[44:47], v0, s[4:7], s27 offen offset:0 sc1
  buffer_load_dwordx4 v[60:63], v0, s[4:7], s27 offen offset:1024 sc1
  buffer_load_dwordx4 v[96:99], v0, s[4:7], s27 offen offset:2048 sc1
  buffer_load_dwordx4 v[100:103], v0, s[4:7], s27 offen offset:3072 sc1
  s_add_u32 s27, s27, 4096
  buffer_load_dwordx4 v[32:35], v0, s[4:7], s26 offen offset:0 sc1
  buffer_load_dwordx4 v[48:51], v0, s[4:7], s27 offen offset:0 sc1
  buffer_load_dwordx4 v[64:67], v0, s[4:7], s27 offen offset:1024 sc1
  buffer_load_dwordx4 v[104:107], v0, s[4:7], s27 offen offset:2048 sc1
  buffer_load_dwordx4 v[108:111], v0, s[4:7], s27 offen offset:3072 sc1
  s_add_u32 s27, s27, 4096
  buffer_load_dwordx4 v[36:39], v0, s[4:7], s26 offen offset:2048 sc1
  buffer_load_dwordx4 v[52:55], v0, s[4:7], s27 offen offset:0 sc1
  buffer_load_dwordx4 v[68:71], v0, s[4:7], s27 offen offset:1024 sc1
  buffer_load_dwordx4 v[112:115], v0, s[4:7], s27 offen offset:2048 sc1
  buffer_load_dwordx4 v[116:119], v0, s[4:7], s27 offen offset:3072 sc1
  s_add_u32 s27, s27, 4096
  s_lshl_b32 s26, s35, 4
  s_lshl_b32 s27, s65, 15
  s_add_u32 s26, s26, s27
  s_add_u32 s26, s26, 5447680
o_w2_64:
  buffer_load_dwordx4 v[128:131], v7, s[4:7], s26 offen sc1
  s_add_u32 s67, s67, 1
  s_cmp_gt_u32 s67, 1048576
  s_cbranch_scc1 L_end
  s_waitcnt vmcnt(0)
  v_min3_u32 v128, v128, v129, v130
  v_min_u32 v128, v128, v131
  v_cmp_eq_u32 vcc, 0, v128
  s_cbranch_vccnz o_w2_64
  s_lshl_b32 s26, s35, 13
  s_add_u32 s26, s26, 117440512
  s_add_u32 s27, s26, 4096
  buffer_load_dwordx4 v[72:75], v0, s[4:7], s26 offen offset:0 sc1
  buffer_load_dwordx4 v[76:79], v0, s[4:7], s26 offen offset:2048 sc1
  buffer_load_dwordx4 v[80:83], v0, s[4:7], s27 offen offset:0 sc1
  buffer_load_dwordx4 v[84:87], v0, s[4:7], s27 offen offset:2048 sc1
  buffer_load_dwordx2 v[120:121], v1, s[4:7], s26 offen offset:1024 sc1
  buffer_load_dwordx2 v[122:123], v1, s[4:7], s26 offen offset:3072 sc1
  buffer_load_dwordx2 v[124:125], v1, s[4:7], s27 offen offset:1024 sc1
  buffer_load_dwordx2 v[126:127], v1, s[4:7], s27 offen offset:3072 sc1
  v_mfma_f32_16x16x32_bf16 v[128:131], v[40:43], v[24:27], 0
  v_mfma_f32_16x16x32_bf16 v[132:135], v[56:59], v[24:27], 0
  v_mfma_f32_16x16x32_bf16 v[128:131], v[44:47], v[28:31], v[128:131]
  v_mfma_f32_16x16x32_bf16 v[132:135], v[60:63], v[28:31], v[132:135]
  v_mfma_f32_16x16x32_bf16 v[128:131], v[48:51], v[32:35], v[128:131]
  v_mfma_f32_16x16x32_bf16 v[132:135], v[64:67], v[32:35], v[132:135]
  v_mfma_f32_16x16x32_bf16 v[128:131], v[52:55], v[36:39], v[128:131]
  v_mfma_f32_16x16x32_bf16 v[132:135], v[68:71], v[36:39], v[132:135]
  v_mov_b32 v144, 0
  v_mov_b32 v147, 0
  v_mov_b32 v7, 0xff000000
  v_cmp_le_i32 s[28:29], 0, v3
  s_nop 0
  s_nop 1
  v_cndmask_b32 v128, v7, v128, s[28:29]
  v_cmp_le_i32 s[30:31], 1, v3
  s_nop 1
  v_cndmask_b32 v129, v7, v129, s[30:31]
  v_cmp_le_i32 s[28:29], 2, v3
  s_nop 1
  v_cndmask_b32 v130, v7, v130, s[28:29]
  v_cmp_le_i32 s[30:31], 3, v3
  s_nop 1
  v_cndmask_b32 v131, v7, v131, s[30:31]
  v_cmp_le_i32 s[28:29], 16, v3
  s_nop 1
  v_cndmask_b32 v132, v7, v132, s[28:29]
  v_cmp_le_i32 s[30:31], 17, v3
  s_nop 1
  v_cndmask_b32 v133, v7, v133, s[30:31]
  v_cmp_le_i32 s[28:29], 18, v3
  s_nop 1
  v_cndmask_b32 v134, v7, v134, s[28:29]
  v_cmp_le_i32 s[30:31], 19, v3
  s_nop 1
  v_cndmask_b32 v135, v7, v135, s[30:31]
  v_max3_f32 v140, v128, v129, v130
  v_max3_f32 v140, v131, v132, v140
  v_max3_f32 v140, v133, v134, v140
  s_waitcnt vmcnt(7)
  v_mfma_f32_16x16x32_bf16 v[136:139], v[72:75], v[24:27], 0
  s_waitcnt vmcnt(6)
  v_mfma_f32_16x16x32_bf16 v[136:139], v[76:79], v[28:31], v[136:139]
  s_waitcnt vmcnt(5)
  v_mfma_f32_16x16x32_bf16 v[136:139], v[80:83], v[32:35], v[136:139]
  s_waitcnt vmcnt(4)
  v_mfma_f32_16x16x32_bf16 v[136:139], v[84:87], v[36:39], v[136:139]
  s_nop 1
  s_nop 1
  s_nop 1
  s_nop 1
  v_mul_f32 v136, s24, v136
  v_mul_f32 v137, s24, v137
  v_max_f32 v140, v135, v140
  v_max3_f32 v140, v136, v137, v140
  v_mov_b32 v141, v140
  s_nop 0
  s_nop 0
  v_permlane16_swap_b32 v140, v141
  v_max_f32 v140, v140, v141
  v_mov_b32 v141, v140
  s_nop 0
  s_nop 0
  v_permlane32_swap_b32 v140, v141
  v_max_f32 v140, v140, v141
  v_sub_f32 v128, v128, v140
  v_sub_f32 v129, v129, v140
  v_sub_f32 v130, v130, v140
  v_sub_f32 v131, v131, v140
  v_sub_f32 v132, v132, v140
  v_sub_f32 v133, v133, v140
  v_sub_f32 v134, v134, v140
  v_sub_f32 v135, v135, v140
  v_sub_f32 v136, v136, v140
  v_sub_f32 v137, v137, v140
  v_exp_f32 v128, v128
  v_exp_f32 v129, v129
  v_exp_f32 v130, v130
  v_exp_f32 v131, v131
  v_exp_f32 v132, v132
  v_exp_f32 v133, v133
  v_exp_f32 v134, v134
  v_exp_f32 v135, v135
  v_exp_f32 v136, v136
  v_exp_f32 v137, v137
  v_add_f32 v140, v128, v129
  v_add_f32 v141, v130, v131
  v_add_f32 v140, v140, v132
  v_add_f32 v141, v141, v133
  v_add_f32 v140, v140, v134
  v_add_f32 v141, v141, v135
  v_add_f32 v140, v140, v136
  v_add_f32 v141, v141, v137
  v_add_f32 v140, v140, v141
  v_mov_b32 v141, v140
  s_nop 0
  s_nop 0
  v_permlane16_swap_b32 v140, v141
  v_add_f32 v140, v140, v141
  v_mov_b32 v141, v140
  s_nop 0
  s_nop 0
  v_permlane32_swap_b32 v140, v141
  v_add_f32 v140, v140, v141
  v_rcp_f32 v140, v140
  s_nop 0
  v_mul_f32 v128, v128, v140
  v_mul_f32 v129, v129, v140
  v_mul_f32 v130, v130, v140
  v_mul_f32 v131, v131, v140
  v_mul_f32 v132, v132, v140
  v_mul_f32 v133, v133, v140
  v_mul_f32 v134, v134, v140
  v_mul_f32 v135, v135, v140
  v_mul_f32 v136, v136, v140
  v_mul_f32 v137, v137, v140
  v_cvt_pk_bf16_f32 v140, v128, v129
  v_cvt_pk_bf16_f32 v141, v130, v131
  v_cvt_pk_bf16_f32 v142, v132, v133
  v_cvt_pk_bf16_f32 v143, v134, v135
  v_cvt_pk_bf16_f32 v145, v136, v137
  v_cvt_pk_bf16_f32 v146, v136, v137
  v_mfma_f32_16x16x32_bf16 v[148:151], v[88:91], v[140:143], 0
  v_mfma_f32_16x16x32_bf16 v[152:155], v[92:95], v[140:143], 0
  v_mfma_f32_16x16x32_bf16 v[156:159], v[96:99], v[140:143], 0
  v_mfma_f32_16x16x32_bf16 v[160:163], v[100:103], v[140:143], 0
  v_mfma_f32_16x16x32_bf16 v[164:167], v[104:107], v[140:143], 0
  v_mfma_f32_16x16x32_bf16 v[168:171], v[108:111], v[140:143], 0
  v_mfma_f32_16x16x32_bf16 v[172:175], v[112:115], v[140:143], 0
  v_mfma_f32_16x16x32_bf16 v[176:179], v[116:119], v[140:143], 0
  s_waitcnt vmcnt(0)
  v_mfma_f32_16x16x16_bf16 v[148:151], v[120:121], v[146:147], v[148:151]
  v_mfma_f32_16x16x16_bf16 v[152:155], v[120:121], v[144:145], v[152:155]
  v_mfma_f32_16x16x16_bf16 v[156:159], v[122:123], v[146:147], v[156:159]
  v_mfma_f32_16x16x16_bf16 v[160:163], v[122:123], v[144:145], v[160:163]
  v_mfma_f32_16x16x16_bf16 v[164:167], v[124:125], v[146:147], v[164:167]
  v_mfma_f32_16x16x16_bf16 v[168:171], v[124:125], v[144:145], v[168:171]
  v_mfma_f32_16x16x16_bf16 v[172:175], v[126:127], v[146:147], v[172:175]
  v_mfma_f32_16x16x16_bf16 v[176:179], v[126:127], v[144:145], v[176:179]
  s_nop 0
  v_cvt_pk_bf16_f32 v180, v148, v149
  v_cvt_pk_bf16_f32 v181, v150, v151
  v_cvt_pk_bf16_f32 v182, v152, v153
  v_cvt_pk_bf16_f32 v183, v154, v155
  ds_write_b128 v6, v[180:183] offset:0
  v_cvt_pk_bf16_f32 v184, v156, v157
  v_cvt_pk_bf16_f32 v185, v158, v159
  v_cvt_pk_bf16_f32 v186, v160, v161
  v_cvt_pk_bf16_f32 v187, v162, v163
  ds_write_b128 v6, v[184:187] offset:1024
  v_cvt_pk_bf16_f32 v188, v164, v165
  v_cvt_pk_bf16_f32 v189, v166, v167
  v_cvt_pk_bf16_f32 v190, v168, v169
  v_cvt_pk_bf16_f32 v191, v170, v171
  ds_write_b128 v6, v[188:191] offset:2048
  v_cvt_pk_bf16_f32 v192, v172, v173
  v_cvt_pk_bf16_f32 v193, v174, v175
  v_cvt_pk_bf16_f32 v194, v176, v177
  v_cvt_pk_bf16_f32 v195, v178, v179
  ds_write_b128 v6, v[192:195] offset:3072
  s_waitcnt lgkmcnt(0)
  s_barrier
  ds_read_b128 v[88:91], v200 offset:0
  ds_read_b128 v[92:95], v200 offset:1024
  ds_read_b128 v[96:99], v200 offset:2048
  ds_read_b128 v[100:103], v200 offset:3072
  s_and_b32 s76, s62, 1
  s_lshl_b32 s76, s76, 19
  s_lshl_b32 s26, s60, 20
  s_add_u32 s76, s76, s26
  s_add_u32 s76, s76, 12582912
  s_waitcnt lgkmcnt(3)
  v_mfma_f32_16x16x32_bf16 v[24:27], v[88:91], a[0:3], 0
  ds_read_b128 v[104:107], v200 offset:8192
  v_mfma_f32_16x16x32_bf16 v[28:31], v[88:91], a[4:7], 0
  v_mfma_f32_16x16x32_bf16 v[32:35], v[88:91], a[8:11], 0
  v_mfma_f32_16x16x32_bf16 v[36:39], v[88:91], a[12:15], 0
  v_mfma_f32_16x16x32_bf16 v[40:43], v[88:91], a[16:19], 0
  v_mfma_f32_16x16x32_bf16 v[44:47], v[88:91], a[20:23], 0
  v_mfma_f32_16x16x32_bf16 v[48:51], v[88:91], a[24:27], 0
  v_mfma_f32_16x16x32_bf16 v[52:55], v[88:91], a[28:31], 0
  s_waitcnt lgkmcnt(3)
  v_mfma_f32_16x16x32_bf16 v[24:27], v[92:95], a[32:35], v[24:27]
  ds_read_b128 v[108:111], v200 offset:9216
  v_mfma_f32_16x16x32_bf16 v[28:31], v[92:95], a[36:39], v[28:31]
  v_mfma_f32_16x16x32_bf16 v[32:35], v[92:95], a[40:43], v[32:35]
  v_mfma_f32_16x16x32_bf16 v[36:39], v[92:95], a[44:47], v[36:39]
  v_mfma_f32_16x16x32_bf16 v[40:43], v[92:95], a[48:51], v[40:43]
  v_mfma_f32_16x16x32_bf16 v[44:47], v[92:95], a[52:55], v[44:47]
  v_mfma_f32_16x16x32_bf16 v[48:51], v[92:95], a[56:59], v[48:51]
  v_mfma_f32_16x16x32_bf16 v[52:55], v[92:95], a[60:63], v[52:55]
  s_waitcnt lgkmcnt(3)
  v_mfma_f32_16x16x32_bf16 v[24:27], v[96:99], a[64:67], v[24:27]
  ds_read_b128 v[112:115], v200 offset:10240
  v_mfma_f32_16x16x32_bf16 v[28:31], v[96:99], a[68:71], v[28:31]
  v_mfma_f32_16x16x32_bf16 v[32:35], v[96:99], a[72:75], v[32:35]
  v_mfma_f32_16x16x32_bf16 v[36:39], v[96:99], a[76:79], v[36:39]
  v_mfma_f32_16x16x32_bf16 v[40:43], v[96:99], a[80:83], v[40:43]
  v_mfma_f32_16x16x32_bf16 v[44:47], v[96:99], a[84:87], v[44:47]
  v_mfma_f32_16x16x32_bf16 v[48:51], v[96:99], a[88:91], v[48:51]
  v_mfma_f32_16x16x32_bf16 v[52:55], v[96:99], a[92:95], v[52:55]
  s_waitcnt lgkmcnt(3)
  v_mfma_f32_16x16x32_bf16 v[24:27], v[100:103], a[96:99], v[24:27]
  ds_read_b128 v[116:119], v200 offset:11264
  v_mfma_f32_16x16x32_bf16 v[28:31], v[100:103], a[100:103], v[28:31]
  v_mfma_f32_16x16x32_bf16 v[32:35], v[100:103], a[104:107], v[32:35]
  v_mfma_f32_16x16x32_bf16 v[36:39], v[100:103], a[108:111], v[36:39]
  v_mfma_f32_16x16x32_bf16 v[40:43], v[100:103], a[112:115], v[40:43]
  v_mfma_f32_16x16x32_bf16 v[44:47], v[100:103], a[116:119], v[44:47]
  v_mfma_f32_16x16x32_bf16 v[48:51], v[100:103], a[120:123], v[48:51]
  v_mfma_f32_16x16x32_bf16 v[52:55], v[100:103], a[124:127], v[52:55]
  s_waitcnt lgkmcnt(3)
  v_mfma_f32_16x16x32_bf16 v[24:27], v[104:107], a[128:131], v[24:27]
  ds_read_b128 v[88:91], v200 offset:4096
  v_mfma_f32_16x16x32_bf16 v[28:31], v[104:107], a[132:135], v[28:31]
  v_mfma_f32_16x16x32_bf16 v[32:35], v[104:107], a[136:139], v[32:35]
  v_mfma_f32_16x16x32_bf16 v[36:39], v[104:107], a[140:143], v[36:39]
  v_mfma_f32_16x16x32_bf16 v[40:43], v[104:107], a[144:147], v[40:43]
  v_mfma_f32_16x16x32_bf16 v[44:47], v[104:107], a[148:151], v[44:47]
  v_mfma_f32_16x16x32_bf16 v[48:51], v[104:107], a[152:155], v[48:51]
  v_mfma_f32_16x16x32_bf16 v[52:55], v[104:107], a[156:159], v[52:55]
  s_waitcnt lgkmcnt(3)
  v_mfma_f32_16x16x32_bf16 v[24:27], v[108:111], a[160:163], v[24:27]
  ds_read_b128 v[92:95], v200 offset:5120
  v_mfma_f32_16x16x32_bf16 v[28:31], v[108:111], a[164:167], v[28:31]
  v_mfma_f32_16x16x32_bf16 v[32:35], v[108:111], a[168:171], v[32:35]
  v_mfma_f32_16x16x32_bf16 v[36:39], v[108:111], a[172:175], v[36:39]
  v_mfma_f32_16x16x32_bf16 v[40:43], v[108:111], a[176:179], v[40:43]
  v_mfma_f32_16x16x32_bf16 v[44:47], v[108:111], a[180:183], v[44:47]
  v_mfma_f32_16x16x32_bf16 v[48:51], v[108:111], a[184:187], v[48:51]
  v_mfma_f32_16x16x32_bf16 v[52:55], v[108:111], a[188:191], v[52:55]
  s_waitcnt lgkmcnt(3)
  v_mfma_f32_16x16x32_bf16 v[24:27], v[112:115], a[192:195], v[24:27]
  ds_read_b128 v[96:99], v200 offset:6144
  v_mfma_f32_16x16x32_bf16 v[28:31], v[112:115], a[196:199], v[28:31]
  v_mfma_f32_16x16x32_bf16 v[32:35], v[112:115], a[200:203], v[32:35]
  v_mfma_f32_16x16x32_bf16 v[36:39], v[112:115], a[204:207], v[36:39]
  v_mfma_f32_16x16x32_bf16 v[40:43], v[112:115], a[208:211], v[40:43]
  v_mfma_f32_16x16x32_bf16 v[44:47], v[112:115], a[212:215], v[44:47]
  v_mfma_f32_16x16x32_bf16 v[48:51], v[112:115], a[216:219], v[48:51]
  v_mfma_f32_16x16x32_bf16 v[52:55], v[112:115], a[220:223], v[52:55]
  s_waitcnt lgkmcnt(3)
  v_mfma_f32_16x16x32_bf16 v[24:27], v[116:119], a[224:227], v[24:27]
  ds_read_b128 v[100:103], v200 offset:7168
  v_mfma_f32_16x16x32_bf16 v[28:31], v[116:119], a[228:231], v[28:31]
  v_mfma_f32_16x16x32_bf16 v[32:35], v[116:119], a[232:235], v[32:35]
  v_mfma_f32_16x16x32_bf16 v[36:39], v[116:119], a[236:239], v[36:39]
  v_mfma_f32_16x16x32_bf16 v[40:43], v[116:119], a[240:243], v[40:43]
  v_mfma_f32_16x16x32_bf16 v[44:47], v[116:119], a[244:247], v[44:47]
  v_mfma_f32_16x16x32_bf16 v[48:51], v[116:119], a[248:251], v[48:51]
  v_mfma_f32_16x16x32_bf16 v[52:55], v[116:119], a[252:255], v[52:55]
  s_waitcnt lgkmcnt(3)
  v_mfma_f32_16x16x32_bf16 v[56:59], v[88:91], a[0:3], 0
  ds_read_b128 v[104:107], v200 offset:12288
  v_mfma_f32_16x16x32_bf16 v[60:63], v[88:91], a[4:7], 0
  v_mfma_f32_16x16x32_bf16 v[64:67], v[88:91], a[8:11], 0
  v_mfma_f32_16x16x32_bf16 v[68:71], v[88:91], a[12:15], 0
  v_mfma_f32_16x16x32_bf16 v[72:75], v[88:91], a[16:19], 0
  v_mfma_f32_16x16x32_bf16 v[76:79], v[88:91], a[20:23], 0
  v_mfma_f32_16x16x32_bf16 v[80:83], v[88:91], a[24:27], 0
  v_mfma_f32_16x16x32_bf16 v[84:87], v[88:91], a[28:31], 0
  s_waitcnt lgkmcnt(3)
  v_mfma_f32_16x16x32_bf16 v[56:59], v[92:95], a[32:35], v[56:59]
  ds_read_b128 v[108:111], v200 offset:13312
  v_mfma_f32_16x16x32_bf16 v[60:63], v[92:95], a[36:39], v[60:63]
  v_cvt_pk_bf16_f32 v120, v24, v28
  v_mfma_f32_16x16x32_bf16 v[64:67], v[92:95], a[40:43], v[64:67]
  v_mfma_f32_16x16x32_bf16 v[68:71], v[92:95], a[44:47], v[68:71]
  v_cvt_pk_bf16_f32 v121, v32, v36
  v_mfma_f32_16x16x32_bf16 v[72:75], v[92:95], a[48:51], v[72:75]
  v_mfma_f32_16x16x32_bf16 v[76:79], v[92:95], a[52:55], v[76:79]
  v_cvt_pk_bf16_f32 v122, v40, v44
  v_mfma_f32_16x16x32_bf16 v[80:83], v[92:95], a[56:59], v[80:83]
  v_mfma_f32_16x16x32_bf16 v[84:87], v[92:95], a[60:63], v[84:87]
  v_cvt_pk_bf16_f32 v123, v48, v52
  s_waitcnt lgkmcnt(3)
  v_mfma_f32_16x16x32_bf16 v[56:59], v[96:99], a[64:67], v[56:59]
  ds_read_b128 v[112:115], v200 offset:14336
  v_mfma_f32_16x16x32_bf16 v[60:63], v[96:99], a[68:71], v[60:63]
  s_add_u32 s26, s76, 0
  buffer_store_dwordx4 v[120:123], v4, s[4:7], s26 offen
  v_mfma_f32_16x16x32_bf16 v[64:67], v[96:99], a[72:75], v[64:67]
  v_mfma_f32_16x16x32_bf16 v[68:71], v[96:99], a[76:79], v[68:71]
  v_cvt_pk_bf16_f32 v124, v25, v29
  v_mfma_f32_16x16x32_bf16 v[72:75], v[96:99], a[80:83], v[72:75]
  v_mfma_f32_16x16x32_bf16 v[76:79], v[96:99], a[84:87], v[76:79]
  v_cvt_pk_bf16_f32 v125, v33, v37
  v_mfma_f32_16x16x32_bf16 v[80:83], v[96:99], a[88:91], v[80:83]
  v_mfma_f32_16x16x32_bf16 v[84:87], v[96:99], a[92:95], v[84:87]
  v_cvt_pk_bf16_f32 v126, v41, v45
  s_waitcnt lgkmcnt(3)
  v_mfma_f32_16x16x32_bf16 v[56:59], v[100:103], a[96:99], v[56:59]
  ds_read_b128 v[116:119], v200 offset:15360
  v_mfma_f32_16x16x32_bf16 v[60:63], v[100:103], a[100:103], v[60:63]
  v_cvt_pk_bf16_f32 v127, v49, v53
  v_mfma_f32_16x16x32_bf16 v[64:67], v[100:103], a[104:107], v[64:67]
  v_mfma_f32_16x16x32_bf16 v[68:71], v[100:103], a[108:111], v[68:71]
  s_add_u32 s26, s76, 16384
  buffer_store_dwordx4 v[124:127], v4, s[4:7], s26 offen
  v_mfma_f32_16x16x32_bf16 v[72:75], v[100:103], a[112:115], v[72:75]
  v_mfma_f32_16x16x32_bf16 v[76:79], v[100:103], a[116:119], v[76:79]
  v_cvt_pk_bf16_f32 v128, v26, v30
  v_mfma_f32_16x16x32_bf16 v[80:83], v[100:103], a[120:123], v[80:83]
  v_mfma_f32_16x16x32_bf16 v[84:87], v[100:103], a[124:127], v[84:87]
  v_cvt_pk_bf16_f32 v129, v34, v38
  s_waitcnt lgkmcnt(3)
  v_mfma_f32_16x16x32_bf16 v[56:59], v[104:107], a[128:131], v[56:59]
  v_mfma_f32_16x16x32_bf16 v[60:63], v[104:107], a[132:135], v[60:63]
  v_cvt_pk_bf16_f32 v130, v42, v46
  v_mfma_f32_16x16x32_bf16 v[64:67], v[104:107], a[136:139], v[64:67]
  v_mfma_f32_16x16x32_bf16 v[68:71], v[104:107], a[140:143], v[68:71]
  v_cvt_pk_bf16_f32 v131, v50, v54
  v_mfma_f32_16x16x32_bf16 v[72:75], v[104:107], a[144:147], v[72:75]
  v_mfma_f32_16x16x32_bf16 v[76:79], v[104:107], a[148:151], v[76:79]
  s_add_u32 s26, s76, 32768
  buffer_store_dwordx4 v[128:131], v4, s[4:7], s26 offen
  v_mfma_f32_16x16x32_bf16 v[80:83], v[104:107], a[152:155], v[80:83]
  v_mfma_f32_16x16x32_bf16 v[84:87], v[104:107], a[156:159], v[84:87]
  v_cvt_pk_bf16_f32 v132, v27, v31
  s_waitcnt lgkmcnt(2)
  v_mfma_f32_16x16x32_bf16 v[56:59], v[108:111], a[160:163], v[56:59]
  v_mfma_f32_16x16x32_bf16 v[60:63], v[108:111], a[164:167], v[60:63]
  v_cvt_pk_bf16_f32 v133, v35, v39
  v_mfma_f32_16x16x32_bf16 v[64:67], v[108:111], a[168:171], v[64:67]
  v_mfma_f32_16x16x32_bf16 v[68:71], v[108:111], a[172:175], v[68:71]
  v_cvt_pk_bf16_f32 v134, v43, v47
  v_mfma_f32_16x16x32_bf16 v[72:75], v[108:111], a[176:179], v[72:75]
  v_mfma_f32_16x16x32_bf16 v[76:79], v[108:111], a[180:183], v[76:79]
  v_cvt_pk_bf16_f32 v135, v51, v55
  v_mfma_f32_16x16x32_bf16 v[80:83], v[108:111], a[184:187], v[80:83]
  v_mfma_f32_16x16x32_bf16 v[84:87], v[108:111], a[188:191], v[84:87]
  s_add_u32 s26, s76, 49152
  buffer_store_dwordx4 v[132:135], v4, s[4:7], s26 offen
  s_waitcnt lgkmcnt(1)
  v_mfma_f32_16x16x32_bf16 v[56:59], v[112:115], a[192:195], v[56:59]
  v_mfma_f32_16x16x32_bf16 v[60:63], v[112:115], a[196:199], v[60:63]
  v_mfma_f32_16x16x32_bf16 v[64:67], v[112:115], a[200:203], v[64:67]
  v_mfma_f32_16x16x32_bf16 v[68:71], v[112:115], a[204:207], v[68:71]
  v_mfma_f32_16x16x32_bf16 v[72:75], v[112:115], a[208:211], v[72:75]
  v_mfma_f32_16x16x32_bf16 v[76:79], v[112:115], a[212:215], v[76:79]
  v_mfma_f32_16x16x32_bf16 v[80:83], v[112:115], a[216:219], v[80:83]
  v_mfma_f32_16x16x32_bf16 v[84:87], v[112:115], a[220:223], v[84:87]
  s_waitcnt lgkmcnt(0)
  v_mfma_f32_16x16x32_bf16 v[56:59], v[116:119], a[224:227], v[56:59]
  v_mfma_f32_16x16x32_bf16 v[60:63], v[116:119], a[228:231], v[60:63]
  v_mfma_f32_16x16x32_bf16 v[64:67], v[116:119], a[232:235], v[64:67]
  v_mfma_f32_16x16x32_bf16 v[68:71], v[116:119], a[236:239], v[68:71]
  v_mfma_f32_16x16x32_bf16 v[72:75], v[116:119], a[240:243], v[72:75]
  v_mfma_f32_16x16x32_bf16 v[76:79], v[116:119], a[244:247], v[76:79]
  v_mfma_f32_16x16x32_bf16 v[80:83], v[116:119], a[248:251], v[80:83]
  v_mfma_f32_16x16x32_bf16 v[84:87], v[116:119], a[252:255], v[84:87]
  s_nop 0
  s_nop 0
  v_cvt_pk_bf16_f32 v136, v56, v60
  s_nop 0
  v_cvt_pk_bf16_f32 v137, v64, v68
  s_nop 0
  v_cvt_pk_bf16_f32 v138, v72, v76
  s_nop 0
  v_cvt_pk_bf16_f32 v139, v80, v84
  s_add_u32 s26, s76, 262144
  buffer_store_dwordx4 v[136:139], v4, s[4:7], s26 offen
  v_cvt_pk_bf16_f32 v140, v57, v61
  v_cvt_pk_bf16_f32 v141, v65, v69
  v_cvt_pk_bf16_f32 v142, v73, v77
  v_cvt_pk_bf16_f32 v143, v81, v85
  s_add_u32 s26, s76, 278528
  buffer_store_dwordx4 v[140:143], v4, s[4:7], s26 offen
  v_cvt_pk_bf16_f32 v144, v58, v62
  v_cvt_pk_bf16_f32 v145, v66, v70
  v_cvt_pk_bf16_f32 v146, v74, v78
  v_cvt_pk_bf16_f32 v147, v82, v86
  s_add_u32 s26, s76, 294912
  buffer_store_dwordx4 v[144:147], v4, s[4:7], s26 offen
  v_cvt_pk_bf16_f32 v148, v59, v63
  v_cvt_pk_bf16_f32 v149, v67, v71
  v_cvt_pk_bf16_f32 v150, v75, v79
  v_cvt_pk_bf16_f32 v151, v83, v87
  s_add_u32 s26, s76, 311296
  buffer_store_dwordx4 v[148:151], v4, s[4:7], s26 offen
  s_lshl_b32 s26, s60, 10
  s_add_u32 s26, s26, 5275648
  s_lshl_b32 s27, s61, 4
  s_lshl_b32 s28, s17, 2
  s_add_u32 s27, s27, s28
  v_mov_b32 v24, s62
  v_mov_b32 v25, s27
  s_waitcnt vmcnt(0)
  s_mov_b64 exec, 1
  buffer_store_dword v24, v25, s[4:7], s26 offen
  s_mov_b64 exec, -1
  s_cmp_ge_u32 s17, 2
  s_cbranch_scc1 o_done_65
  s_lshl_b32 s77, s61, 1
  s_add_u32 s77, s77, s17
  s_lshl_b32 s29, s77, 14
  s_add_u32 s76, s76, s29
  s_lshl_b32 s29, s63, 5
  s_add_u32 s77, s77, s29
  s_lshl_b32 s29, s77, 10
  s_cmp_lg_u32 s64, 0
  s_cbranch_scc1 o_l2_67
  buffer_load_dwordx4 v[96:99], v0, s[72:75], s29 offen
  s_branch o_join_68
o_l2_67:
  s_add_u32 s30, s29, 10485760
  buffer_load_dwordx4 v[96:99], v0, s[4:7], s30 offen sc1
o_join_68:
  s_mov_b32 s67, 0
o_w3_66:
  buffer_load_dword v24, v2, s[4:7], s26 offen sc1
  s_add_u32 s67, s67, 1
  s_cmp_gt_u32 s67, 1048576
  s_cbranch_scc1 L_end
  s_waitcnt vmcnt(0)
  v_cmp_gt_u32 vcc, s62, v24
  s_cbranch_vccnz o_w3_66
  buffer_load_dwordx4 v[24:27], v5, s[4:7], s76 offen offset:0 sc1
  buffer_load_dwordx4 v[28:31], v5, s[4:7], s76 offen offset:256 sc1
  buffer_load_dwordx4 v[32:35], v5, s[4:7], s76 offen offset:512 sc1
  buffer_load_dwordx4 v[36:39], v5, s[4:7], s76 offen offset:768 sc1
  s_add_u32 s76, s76, 4096
  buffer_load_dwordx4 v[40:43], v5, s[4:7], s76 offen offset:0 sc1
  buffer_load_dwordx4 v[44:47], v5, s[4:7], s76 offen offset:256 sc1
  buffer_load_dwordx4 v[48:51], v5, s[4:7], s76 offen offset:512 sc1
  buffer_load_dwordx4 v[52:55], v5, s[4:7], s76 offen offset:768 sc1
  s_add_u32 s76, s76, 4096
  buffer_load_dwordx4 v[56:59], v5, s[4:7], s76 offen offset:0 sc1
  buffer_load_dwordx4 v[60:63], v5, s[4:7], s76 offen offset:256 sc1
  buffer_load_dwordx4 v[64:67], v5, s[4:7], s76 offen offset:512 sc1
  buffer_load_dwordx4 v[68:71], v5, s[4:7], s76 offen offset:768 sc1
  s_add_u32 s76, s76, 4096
  buffer_load_dwordx4 v[72:75], v5, s[4:7], s76 offen offset:0 sc1
  buffer_load_dwordx4 v[76:79], v5, s[4:7], s76 offen offset:256 sc1
  buffer_load_dwordx4 v[80:83], v5, s[4:7], s76 offen offset:512 sc1
  buffer_load_dwordx4 v[84:87], v5, s[4:7], s76 offen offset:768 sc1
  s_add_u32 s76, s76, 4096
  v_lshlrev_b32 v108, 16, v96
  v_and_b32 v109, 0xffff0000, v96
  v_lshlrev_b32 v110, 16, v97
  v_and_b32 v111, 0xffff0000, v97
  v_lshlrev_b32 v112, 16, v98
  v_and_b32 v113, 0xffff0000, v98
  v_lshlrev_b32 v114, 16, v99
  v_and_b32 v115, 0xffff0000, v99
  s_waitcnt vmcnt(15)
  v_mfma_f32_16x16x32_bf16 v[100:103], v[16:19], v[24:27], 0
  s_waitcnt vmcnt(14)
  v_mfma_f32_16x16x32_bf16 v[104:107], v[16:19], v[28:31], 0
  s_waitcnt vmcnt(13)
  v_mfma_f32_16x16x32_bf16 v[100:103], v[20:23], v[32:35], v[100:103]
  s_waitcnt vmcnt(12)
  v_mfma_f32_16x16x32_bf16 v[104:107], v[20:23], v[36:39], v[104:107]
  s_waitcnt vmcnt(11)
  v_mfma_f32_16x16x32_bf16 v[100:103], v[16:19], v[40:43], v[100:103]
  s_waitcnt vmcnt(10)
  v_mfma_f32_16x16x32_bf16 v[104:107], v[16:19], v[44:47], v[104:107]
  s_waitcnt vmcnt(9)
  v_mfma_f32_16x16x32_bf16 v[100:103], v[20:23], v[48:51], v[100:103]
  s_waitcnt vmcnt(8)
  v_mfma_f32_16x16x32_bf16 v[104:107], v[20:23], v[52:55], v[104:107]
  s_waitcnt vmcnt(7)
  v_mfma_f32_16x16x32_bf16 v[100:103], v[16:19], v[56:59], v[100:103]
  s_waitcnt vmcnt(6)
  v_mfma_f32_16x16x32_bf16 v[104:107], v[16:19], v[60:63], v[104:107]
  s_waitcnt vmcnt(5)
  v_mfma_f32_16x16x32_bf16 v[100:103], v[20:23], v[64:67], v[100:103]
  s_waitcnt vmcnt(4)
  v_mfma_f32_16x16x32_bf16 v[104:107], v[20:23], v[68:71], v[104:107]
  s_waitcnt vmcnt(3)
  v_mfma_f32_16x16x32_bf16 v[100:103], v[16:19], v[72:75], v[100:103]
  s_waitcnt vmcnt(2)
  v_mfma_f32_16x16x32_bf16 v[104:107], v[16:19], v[76:79], v[104:107]
  s_waitcnt vmcnt(1)
  v_mfma_f32_16x16x32_bf16 v[100:103], v[20:23], v[80:83], v[100:103]
  s_waitcnt vmcnt(0)
  v_mfma_f32_16x16x32_bf16 v[104:107], v[20:23], v[84:87], v[104:107]
  s_nop 1
  s_nop 1
  s_nop 1
  s_nop 1
  v_permlane16_swap_b32 v100, v104
  v_permlane16_swap_b32 v101, v105
  v_permlane16_swap_b32 v102, v106
  v_permlane16_swap_b32 v103, v107
  v_cvt_pk_bf16_f32 v124, v100, v101
  v_cvt_pk_bf16_f32 v125, v102, v103
  v_cvt_pk_bf16_f32 v126, v104, v105
  v_cvt_pk_bf16_f32 v127, v106, v107
  v_lshlrev_b32 v100, 16, v124
  v_and_b32 v101, 0xffff0000, v124
  v_lshlrev_b32 v102, 16, v125
  v_and_b32 v103, 0xffff0000, v125
  v_lshlrev_b32 v104, 16, v126
  v_and_b32 v105, 0xffff0000, v126
  v_lshlrev_b32 v106, 16, v127
  v_and_b32 v107, 0xffff0000, v127
  v_add_f32 v108, v108, v100
  v_add_f32 v109, v109, v101
  v_add_f32 v110, v110, v102
  v_add_f32 v111, v111, v103
  v_add_f32 v112, v112, v104
  v_add_f32 v113, v113, v105
  v_add_f32 v114, v114, v106
  v_add_f32 v115, v115, v107
  v_cvt_pk_bf16_f32 v124, v108, v109
  v_cvt_pk_bf16_f32 v125, v110, v111
  v_cvt_pk_bf16_f32 v126, v112, v113
  v_cvt_pk_bf16_f32 v127, v114, v115
  v_lshlrev_b32 v108, 16, v124
  v_and_b32 v109, 0xffff0000, v124
  v_lshlrev_b32 v110, 16, v125
  v_and_b32 v111, 0xffff0000, v125
  v_lshlrev_b32 v112, 16, v126
  v_and_b32 v113, 0xffff0000, v126
  v_lshlrev_b32 v114, 16, v127
  v_and_b32 v115, 0xffff0000, v127
  s_lshl_b32 s30, s66, 21
  s_add_u32 s30, s30, s29
  s_add_u32 s31, s30, 167772160
  s_add_u32 s30, s30, 176160768
  buffer_store_dwordx4 v[124:127], v0, s[4:7], s31 offen sc1
  v_add_f32 v132, v108, v109
  v_add_f32 v133, v110, v111
  v_add_f32 v134, v112, v113
  v_add_f32 v135, v114, v115
  v_add_f32 v132, v132, v133
  v_add_f32 v134, v134, v135
  v_add_f32 v132, v132, v134
  s_nop 1
  v_add_f32_dpp v132, v132, v132 row_ror:8 row_mask:0xf bank_mask:0xf
  s_nop 1
  v_add_f32_dpp v132, v132, v132 row_ror:4 row_mask:0xf bank_mask:0xf
  s_nop 1
  v_add_f32_dpp v132, v132, v132 row_ror:2 row_mask:0xf bank_mask:0xf
  s_nop 1
  v_add_f32_dpp v132, v132, v132 row_ror:1 row_mask:0xf bank_mask:0xf
  v_mov_b32 v134, v132
  s_nop 0
  s_nop 0
  v_permlane16_swap_b32 v132, v134
  v_add_f32 v132, v132, v134
  v_mov_b32 v134, v132
  s_nop 0
  s_nop 0
  v_permlane32_swap_b32 v132, v134
  v_add_f32 v132, v132, v134
  v_mul_f32 v132, 0x3b000000, v132
  v_sub_f32 v136, v108, v132
  v_sub_f32 v137, v109, v132
  v_sub_f32 v138, v110, v132
  v_sub_f32 v139, v111, v132
  v_sub_f32 v140, v112, v132
  v_sub_f32 v141, v113, v132
  v_sub_f32 v142, v114, v132
  v_sub_f32 v143, v115, v132
  v_mul_f32 v133, v136, v136
  v_mul_f32 v134, v137, v137
  v_fmac_f32 v133, v138, v138
  v_fmac_f32 v134, v139, v139
  v_fmac_f32 v133, v140, v140
  v_fmac_f32 v134, v141, v141
  v_fmac_f32 v133, v142, v142
  v_fmac_f32 v134, v143, v143
  v_add_f32 v133, v133, v134
  v_cvt_pk_bf16_f32 v132, v132, v132
  v_and_b32 v132, 0xffff0000, v132
  v_add_f32_dpp v133, v133, v133 row_ror:8 row_mask:0xf bank_mask:0xf
  s_nop 1
  v_add_f32_dpp v133, v133, v133 row_ror:4 row_mask:0xf bank_mask:0xf
  s_nop 1
  v_add_f32_dpp v133, v133, v133 row_ror:2 row_mask:0xf bank_mask:0xf
  s_nop 1
  v_add_f32_dpp v133, v133, v133 row_ror:1 row_mask:0xf bank_mask:0xf
  v_mov_b32 v134, v133
  s_nop 0
  s_nop 0
  v_permlane16_swap_b32 v133, v134
  v_add_f32 v133, v133, v134
  v_mov_b32 v134, v133
  s_nop 0
  s_nop 0
  v_permlane32_swap_b32 v133, v134
  v_add_f32 v133, v133, v134
  v_sub_f32 v136, v108, v132
  v_sub_f32 v137, v109, v132
  v_sub_f32 v138, v110, v132
  v_sub_f32 v139, v111, v132
  v_sub_f32 v140, v112, v132
  v_sub_f32 v141, v113, v132
  v_sub_f32 v142, v114, v132
  v_sub_f32 v143, v115, v132
  v_mul_f32 v133, 0x3b000000, v133
  v_cvt_pk_bf16_f32 v133, v133, v133
  v_and_b32 v133, 0xffff0000, v133
  v_add_f32 v133, 0x3727c5ac, v133
  v_cvt_pk_bf16_f32 v133, v133, v133
  v_and_b32 v133, 0xffff0000, v133
  v_sqrt_f32 v133, v133
  v_cvt_pk_bf16_f32 v128, v136, v137
  v_cvt_pk_bf16_f32 v129, v138, v139
  v_cvt_pk_bf16_f32 v130, v140, v141
  v_cvt_pk_bf16_f32 v131, v142, v143
  v_cvt_pk_bf16_f32 v133, v133, v133
  v_and_b32 v133, 0xffff0000, v133
  v_rcp_f32 v133, v133
  v_lshlrev_b32 v136, 16, v128
  v_and_b32 v137, 0xffff0000, v128
  v_lshlrev_b32 v138, 16, v129
  v_and_b32 v139, 0xffff0000, v129
  v_lshlrev_b32 v140, 16, v130
  v_and_b32 v141, 0xffff0000, v130
  v_lshlrev_b32 v142, 16, v131
  v_and_b32 v143, 0xffff0000, v131
  v_mul_f32 v136, v136, v133
  v_mul_f32 v137, v137, v133
  v_mul_f32 v138, v138, v133
  v_mul_f32 v139, v139, v133
  v_mul_f32 v140, v140, v133
  v_mul_f32 v141, v141, v133
  v_mul_f32 v142, v142, v133
  v_mul_f32 v143, v143, v133
  v_cvt_pk_bf16_f32 v128, v136, v137
  v_cvt_pk_bf16_f32 v129, v138, v139
  v_cvt_pk_bf16_f32 v130, v140, v141
  v_cvt_pk_bf16_f32 v131, v142, v143
  v_lshlrev_b32 v116, 16, v128
  v_and_b32 v117, 0xffff0000, v128
  v_lshlrev_b32 v118, 16, v129
  v_and_b32 v119, 0xffff0000, v129
  v_lshlrev_b32 v120, 16, v130
  v_and_b32 v121, 0xffff0000, v130
  v_lshlrev_b32 v122, 16, v131
  v_and_b32 v123, 0xffff0000, v131
  buffer_store_dwordx4 v[128:131], v0, s[4:7], s30 offen sc1
  v_mul_f32 v100, v116, v8
  v_mul_f32 v101, v117, v9
  v_fmac_f32 v100, v118, v10
  v_fmac_f32 v101, v119, v11
  v_fmac_f32 v100, v120, v12
  v_fmac_f32 v101, v121, v13
  v_fmac_f32 v100, v122, v14
  v_fmac_f32 v101, v123, v15
  v_add_f32 v100, v100, v101
  v_add_f32 v108, v108, v116
  v_add_f32 v109, v109, v117
  v_add_f32 v110, v110, v118
  v_add_f32 v111, v111, v119
  v_add_f32 v112, v112, v120
  v_add_f32 v113, v113, v121
  v_add_f32 v114, v114, v122
  v_add_f32 v115, v115, v123
  v_cvt_pk_bf16_f32 v96, v108, v109
  v_cvt_pk_bf16_f32 v97, v110, v111
  v_cvt_pk_bf16_f32 v98, v112, v113
  v_cvt_pk_bf16_f32 v99, v114, v115
  s_cmp_lg_u32 s66, 0
  s_cbranch_scc1 o_k1_69
  s_add_u32 s30, s29, 10485760
  buffer_store_dwordx4 v[96:99], v0, s[4:7], s30 offen sc1
  v_lshlrev_b32 v108, 16, v96
  v_and_b32 v109, 0xffff0000, v96
  v_lshlrev_b32 v110, 16, v97
  v_and_b32 v111, 0xffff0000, v97
  v_lshlrev_b32 v112, 16, v98
  v_and_b32 v113, 0xffff0000, v98
  v_lshlrev_b32 v114, 16, v99
  v_and_b32 v115, 0xffff0000, v99
  v_add_f32 v132, v108, v109
  v_add_f32 v133, v110, v111
  v_add_f32 v134, v112, v113
  v_add_f32 v135, v114, v115
  v_add_f32 v132, v132, v133
  v_add_f32 v134, v134, v135
  v_add_f32 v132, v132, v134
  s_nop 1
  v_add_f32_dpp v132, v132, v132 row_ror:8 row_mask:0xf bank_mask:0xf
  v_add_f32_dpp v100, v100, v100 row_ror:8 row_mask:0xf bank_mask:0xf
  s_nop 0
  v_add_f32_dpp v132, v132, v132 row_ror:4 row_mask:0xf bank_mask:0xf
  v_add_f32_dpp v100, v100, v100 row_ror:4 row_mask:0xf bank_mask:0xf
  s_nop 0
  v_add_f32_dpp v132, v132, v132 row_ror:2 row_mask:0xf bank_mask:0xf
  v_add_f32_dpp v100, v100, v100 row_ror:2 row_mask:0xf bank_mask:0xf
  s_nop 0
  v_add_f32_dpp v132, v132, v132 row_ror:1 row_mask:0xf bank_mask:0xf
  v_add_f32_dpp v100, v100, v100 row_ror:1 row_mask:0xf bank_mask:0xf
  v_mov_b32 v134, v132
  v_mov_b32 v135, v100
  s_nop 0
  v_permlane16_swap_b32 v132, v134
  v_permlane16_swap_b32 v100, v135
  v_add_f32 v132, v132, v134
  v_add_f32 v100, v100, v135
  v_mov_b32 v134, v132
  v_mov_b32 v135, v100
  s_nop 0
  v_permlane32_swap_b32 v132, v134
  v_permlane32_swap_b32 v100, v135
  v_add_f32 v132, v132, v134
  v_add_f32 v100, v100, v135
  v_mul_f32 v132, 0x3b000000, v132
  v_sub_f32 v136, v108, v132
  v_sub_f32 v137, v109, v132
  v_sub_f32 v138, v110, v132
  v_sub_f32 v139, v111, v132
  v_sub_f32 v140, v112, v132
  v_sub_f32 v141, v113, v132
  v_sub_f32 v142, v114, v132
  v_sub_f32 v143, v115, v132
  v_mul_f32 v133, v136, v136
  v_mul_f32 v134, v137, v137
  v_fmac_f32 v133, v138, v138
  v_fmac_f32 v134, v139, v139
  v_fmac_f32 v133, v140, v140
  v_fmac_f32 v134, v141, v141
  v_fmac_f32 v133, v142, v142
  v_fmac_f32 v134, v143, v143
  v_add_f32 v133, v133, v134
  v_cvt_pk_bf16_f32 v132, v132, v132
  v_and_b32 v132, 0xffff0000, v132
  v_add_f32_dpp v133, v133, v133 row_ror:8 row_mask:0xf bank_mask:0xf
  s_nop 1
  v_add_f32_dpp v133, v133, v133 row_ror:4 row_mask:0xf bank_mask:0xf
  s_nop 1
  v_add_f32_dpp v133, v133, v133 row_ror:2 row_mask:0xf bank_mask:0xf
  s_nop 1
  v_add_f32_dpp v133, v133, v133 row_ror:1 row_mask:0xf bank_mask:0xf
  v_mov_b32 v134, v133
  s_nop 0
  s_nop 0
  v_permlane16_swap_b32 v133, v134
  v_add_f32 v133, v133, v134
  v_mov_b32 v134, v133
  s_nop 0
  s_nop 0
  v_permlane32_swap_b32 v133, v134
  v_add_f32 v133, v133, v134
  v_sub_f32 v136, v108, v132
  v_sub_f32 v137, v109, v132
  v_sub_f32 v138, v110, v132
  v_sub_f32 v139, v111, v132
  v_sub_f32 v140, v112, v132
  v_sub_f32 v141, v113, v132
  v_sub_f32 v142, v114, v132
  v_sub_f32 v143, v115, v132
  v_mul_f32 v133, 0x3b000000, v133
  v_cvt_pk_bf16_f32 v133, v133, v133
  v_and_b32 v133, 0xffff0000, v133
  v_add_f32 v133, 0x3727c5ac, v133
  v_cvt_pk_bf16_f32 v133, v133, v133
  v_and_b32 v133, 0xffff0000, v133
  v_sqrt_f32 v133, v133
  v_cvt_pk_bf16_f32 v124, v136, v137
  v_cvt_pk_bf16_f32 v125, v138, v139
  v_cvt_pk_bf16_f32 v126, v140, v141
  v_cvt_pk_bf16_f32 v127, v142, v143
  v_cvt_pk_bf16_f32 v133, v133, v133
  v_and_b32 v133, 0xffff0000, v133
  v_rcp_f32 v133, v133
  v_lshlrev_b32 v136, 16, v124
  v_and_b32 v137, 0xffff0000, v124
  v_lshlrev_b32 v138, 16, v125
  v_and_b32 v139, 0xffff0000, v125
  v_lshlrev_b32 v140, 16, v126
  v_and_b32 v141, 0xffff0000, v126
  v_lshlrev_b32 v142, 16, v127
  v_and_b32 v143, 0xffff0000, v127
  v_mul_f32 v136, v136, v133
  v_mul_f32 v137, v137, v133
  v_mul_f32 v138, v138, v133
  v_mul_f32 v139, v139, v133
  v_mul_f32 v140, v140, v133
  v_mul_f32 v141, v141, v133
  v_mul_f32 v142, v142, v133
  v_mul_f32 v143, v143, v133
  v_cvt_pk_bf16_f32 v124, v136, v137
  v_cvt_pk_bf16_f32 v125, v138, v139
  v_cvt_pk_bf16_f32 v126, v140, v141
  v_cvt_pk_bf16_f32 v127, v142, v143
  s_add_u32 s30, s29, 8388608
  buffer_store_dwordx4 v[124:127], v0, s[4:7], s30 offen sc1
  s_branch o_key_71
o_k1_69:
  v_add_f32_dpp v100, v100, v100 row_ror:8 row_mask:0xf bank_mask:0xf
  s_nop 1
  v_add_f32_dpp v100, v100, v100 row_ror:4 row_mask:0xf bank_mask:0xf
  s_nop 1
  v_add_f32_dpp v100, v100, v100 row_ror:2 row_mask:0xf bank_mask:0xf
  s_nop 1
  v_add_f32_dpp v100, v100, v100 row_ror:1 row_mask:0xf bank_mask:0xf
  v_mov_b32 v101, v100
  s_nop 0
  s_nop 0
  v_permlane16_swap_b32 v100, v101
  v_add_f32 v100, v100, v101
  v_mov_b32 v101, v100
  s_nop 0
  s_nop 0
  v_permlane32_swap_b32 v100, v101
  v_add_f32 v100, v100, v101
  s_cmp_eq_u32 s66, 2
  s_cbranch_scc1 o_k2_70
  s_add_u32 s30, s29, 184549376
  buffer_store_dwordx4 v[96:99], v0, s[4:7], s30 offen sc1
  s_branch o_key_71
o_k2_70:
  buffer_store_dwordx4 v[96:99], v0, s[68:71], s29 offen sc1
o_key_71:
  v_cvt_pk_bf16_f32 v100, v100, v100
  v_and_b32 v100, 0xffff0000, v100
  v_ashrrev_i32 v101, 31, v100
  v_or_b32 v101, 0x80000000, v101
  v_xor_b32 v100, v100, v101
  v_and_b32 v100, 0xffff0000, v100
  s_sub_u32 s30, 4095, s77
  v_or_b32 v100, s30, v100
  s_add_u32 s30, s66, 1
  s_lshl_b32 s30, s30, 13
  s_lshl_b32 s31, s77, 2
  s_add_u32 s30, s30, s31
  s_add_u32 s30, s30, 5242880
  v_mov_b32 v101, 0
  s_waitcnt vmcnt(0)
  s_mov_b64 exec, 1
  buffer_store_dword v100, v101, s[4:7], s30 offen sc1
  s_mov_b64 exec, -1
o_done_65:
  s_add_u32 s63, s63, 4
  s_cmp_lt_u32 s63, 64
  s_cbranch_scc1 o_loop_60
  s_cmp_lg_u32 s60, 0
  s_cbranch_scc1 o_nomlp_61
  s_cmp_lg_u32 s64, 0
  s_cbranch_scc1 o_k2_72
  s_mov_b32 s67, 0
  s_mov_b32 s26, 5251072
  s_mov_b32 s27, 5255168
k_w_74:
  buffer_load_dwordx4 v[24:27], v0, s[4:7], s26 offen offset:0 sc1
  buffer_load_dwordx4 v[28:31], v0, s[4:7], s26 offen offset:1024 sc1
  buffer_load_dwordx4 v[32:35], v0, s[4:7], s26 offen offset:2048 sc1
  buffer_load_dwordx4 v[36:39], v0, s[4:7], s26 offen offset:3072 sc1
  buffer_load_dwordx4 v[40:43], v0, s[4:7], s27 offen offset:0 sc1
  buffer_load_dwordx4 v[44:47], v0, s[4:7], s27 offen offset:1024 sc1
  buffer_load_dwordx4 v[48:51], v0, s[4:7], s27 offen offset:2048 sc1
  buffer_load_dwordx4 v[52:55], v0, s[4:7], s27 offen offset:3072 sc1
  s_add_u32 s67, s67, 1
  s_cmp_gt_u32 s67, 1048576
  s_cbranch_scc1 L_end
  s_sleep 2
  s_waitcnt vmcnt(0)
  v_min_u32 v56, v24, v25
  v_max_u32 v57, v24, v25
  v_min3_u32 v56, v26, v27, v56
  v_max3_u32 v57, v26, v27, v57
  v_min3_u32 v56, v28, v29, v56
  v_max3_u32 v57, v28, v29, v57
  v_min3_u32 v56, v30, v31, v56
  v_max3_u32 v57, v30, v31, v57
  v_min3_u32 v56, v32, v33, v56
  v_max3_u32 v57, v32, v33, v57
  v_min3_u32 v56, v34, v35, v56
  v_max3_u32 v57, v34, v35, v57
  v_min3_u32 v56, v36, v37, v56
  v_max3_u32 v57, v36, v37, v57
  v_min3_u32 v56, v38, v39, v56
  v_max3_u32 v57, v38, v39, v57
  v_min3_u32 v56, v40, v41, v56
  v_max3_u32 v57, v40, v41, v57
  v_min3_u32 v56, v42, v43, v56
  v_max3_u32 v57, v42, v43, v57
  v_min3_u32 v56, v44, v45, v56
  v_max3_u32 v57, v44, v45, v57
  v_min3_u32 v56, v46, v47, v56
  v_max3_u32 v57, v46, v47, v57
  v_min3_u32 v56, v48, v49, v56
  v_max3_u32 v57, v48, v49, v57
  v_min3_u32 v56, v50, v51, v56
  v_max3_u32 v57, v50, v51, v57
  v_min3_u32 v56, v52, v53, v56
  v_max3_u32 v57, v52, v53, v57
  v_min3_u32 v56, v54, v55, v56
  v_max3_u32 v57, v54, v55, v57
  v_cmp_eq_u32 vcc, 0, v56
  s_cbranch_vccnz k_w_74
  v_max_u32_dpp v57, v57, v57 row_ror:8 row_mask:0xf bank_mask:0xf
  s_nop 1
  v_max_u32_dpp v57, v57, v57 row_ror:4 row_mask:0xf bank_mask:0xf
  s_nop 1
  v_max_u32_dpp v57, v57, v57 row_ror:2 row_mask:0xf bank_mask:0xf
  s_nop 1
  v_max_u32_dpp v57, v57, v57 row_ror:1 row_mask:0xf bank_mask:0xf
  v_mov_b32 v56, v57
  s_nop 0
  s_nop 0
  v_permlane16_swap_b32 v57, v56
  v_max_u32 v57, v57, v56
  v_mov_b32 v56, v57
  s_nop 0
  s_nop 0
  v_permlane32_swap_b32 v57, v56
  v_max_u32 v57, v57, v56
  s_nop 0
  v_readfirstlane_b32 s78, v57
  s_branch o_k3_73
o_k2_72:
  s_mov_b32 s67, 0
  s_mov_b32 s26, 5267456
  s_mov_b32 s27, 5271552
k_w_75:
  buffer_load_dwordx4 v[24:27], v0, s[4:7], s26 offen offset:0 sc1
  buffer_load_dwordx4 v[28:31], v0, s[4:7], s26 offen offset:1024 sc1
  buffer_load_dwordx4 v[32:35], v0, s[4:7], s26 offen offset:2048 sc1
  buffer_load_dwordx4 v[36:39], v0, s[4:7], s26 offen offset:3072 sc1
  buffer_load_dwordx4 v[40:43], v0, s[4:7], s27 offen offset:0 sc1
  buffer_load_dwordx4 v[44:47], v0, s[4:7], s27 offen offset:1024 sc1
  buffer_load_dwordx4 v[48:51], v0, s[4:7], s27 offen offset:2048 sc1
  buffer_load_dwordx4 v[52:55], v0, s[4:7], s27 offen offset:3072 sc1
  s_add_u32 s67, s67, 1
  s_cmp_gt_u32 s67, 1048576
  s_cbranch_scc1 L_end
  s_sleep 2
  s_waitcnt vmcnt(0)
  v_min_u32 v56, v24, v25
  v_max_u32 v57, v24, v25
  v_min3_u32 v56, v26, v27, v56
  v_max3_u32 v57, v26, v27, v57
  v_min3_u32 v56, v28, v29, v56
  v_max3_u32 v57, v28, v29, v57
  v_min3_u32 v56, v30, v31, v56
  v_max3_u32 v57, v30, v31, v57
  v_min3_u32 v56, v32, v33, v56
  v_max3_u32 v57, v32, v33, v57
  v_min3_u32 v56, v34, v35, v56
  v_max3_u32 v57, v34, v35, v57
  v_min3_u32 v56, v36, v37, v56
  v_max3_u32 v57, v36, v37, v57
  v_min3_u32 v56, v38, v39, v56
  v_max3_u32 v57, v38, v39, v57
  v_min3_u32 v56, v40, v41, v56
  v_max3_u32 v57, v40, v41, v57
  v_min3_u32 v56, v42, v43, v56
  v_max3_u32 v57, v42, v43, v57
  v_min3_u32 v56, v44, v45, v56
  v_max3_u32 v57, v44, v45, v57
  v_min3_u32 v56, v46, v47, v56
  v_max3_u32 v57, v46, v47, v57
  v_min3_u32 v56, v48, v49, v56
  v_max3_u32 v57, v48, v49, v57
  v_min3_u32 v56, v50, v51, v56
  v_max3_u32 v57, v50, v51, v57
  v_min3_u32 v56, v52, v53, v56
  v_max3_u32 v57, v52, v53, v57
  v_min3_u32 v56, v54, v55, v56
  v_max3_u32 v57, v54, v55, v57
  v_cmp_eq_u32 vcc, 0, v56
  s_cbranch_vccnz k_w_75
  v_max_u32_dpp v57, v57, v57 row_ror:8 row_mask:0xf bank_mask:0xf
  s_nop 1
  v_max_u32_dpp v57, v57, v57 row_ror:4 row_mask:0xf bank_mask:0xf
  s_nop 1
  v_max_u32_dpp v57, v57, v57 row_ror:2 row_mask:0xf bank_mask:0xf
  s_nop 1
  v_max_u32_dpp v57, v57, v57 row_ror:1 row_mask:0xf bank_mask:0xf
  v_mov_b32 v56, v57
  s_nop 0
  s_nop 0
  v_permlane16_swap_b32 v57, v56
  v_max_u32 v57, v57, v56
  v_mov_b32 v56, v57
  s_nop 0
  s_nop 0
  v_permlane32_swap_b32 v57, v56
  v_max_u32 v57, v57, v56
  s_nop 0
  v_readfirstlane_b32 s78, v57
o_k3_73:
  s_add_u32 s79, s79, 1
  s_load_dwordx2 s[80:81], s[0:1], 72
  s_load_dwordx2 s[84:85], s[0:1], 80
  s_load_dwordx2 s[8:9], s[0:1], 88
  s_mov_b32 s82, 1835008
  s_mov_b32 s83, 0x20000
  s_mov_b32 s86, 1835008
  s_mov_b32 s87, 0x20000
  s_mov_b32 s10, 1835008
  s_and_b32 s77, s78, 0xfff
  s_sub_u32 s77, 4095, s77
  v_lshrrev_b32 v25, 8, v0
  v_and_b32 v24, 0xf0, v0
  s_mov_b32 s26, 114688
  v_mul_lo_u32 v26, v25, s26
  v_add_u32 v26, v26, v24
  v_mul_u32_u24 v27, 28672, v25
  v_add_u32 v27, v27, v24
  v_lshlrev_b32 v7, 6, v25
  s_lshl_b32 s26, s66, 21
  s_lshl_b32 s27, s77, 10
  s_add_u32 s32, s26, s27
  s_lshl_b32 s27, s17, 8
  s_add_u32 s26, s32, s27
  s_add_u32 s26, s26, 176160768
  buffer_load_dwordx4 v[28:31], v7, s[4:7], s26 offen offset:0 sc1
  buffer_load_dwordx4 v[32:35], v7, s[4:7], s26 offen offset:16 sc1
  buffer_load_dwordx4 v[36:39], v7, s[4:7], s26 offen offset:32 sc1
  buffer_load_dwordx4 v[40:43], v7, s[4:7], s26 offen offset:48 sc1
  s_mul_i32 s26, s17, 458752
  s_mul_i32 s27, s61, 224
  s_add_u32 s26, s26, s27
  s_mul_i32 s28, s61, 114688
  s_lshl_b32 s27, s17, 8
  s_add_u32 s28, s28, s27
  s_mov_b32 s30, 0x01000100
  s_mov_b32 s31, 0x03020302
  s_waitcnt lgkmcnt(0)
  buffer_load_dwordx4 v[72:75], v26, s[80:83], s26 offen
  buffer_load_dwordx4 v[76:79], v26, s[84:87], s26 offen
  s_add_u32 s26, s26, 3584
  buffer_load_dwordx4 v[80:83], v26, s[80:83], s26 offen
  buffer_load_dwordx4 v[84:87], v26, s[84:87], s26 offen
  s_add_u32 s26, s26, 3584
  buffer_load_dwordx4 v[88:91], v26, s[80:83], s26 offen
  buffer_load_dwordx4 v[92:95], v26, s[84:87], s26 offen
  s_add_u32 s26, s26, 3584
  buffer_load_dwordx4 v[96:99], v26, s[80:83], s26 offen
  buffer_load_dwordx4 v[100:103], v26, s[84:87], s26 offen
  s_add_u32 s26, s26, 3584
  buffer_load_dwordx4 v[104:107], v26, s[80:83], s26 offen
  buffer_load_dwordx4 v[108:111], v26, s[84:87], s26 offen
  s_add_u32 s26, s26, 3584
  buffer_load_dwordx4 v[112:115], v26, s[80:83], s26 offen
  buffer_load_dwordx4 v[116:119], v26, s[84:87], s26 offen
  s_add_u32 s26, s26, 3584
  buffer_load_dwordx4 v[120:123], v26, s[80:83], s26 offen
  buffer_load_dwordx4 v[124:127], v26, s[84:87], s26 offen
  s_add_u32 s26, s26, 3584
  buffer_load_dwordx4 v[128:131], v26, s[80:83], s26 offen
  buffer_load_dwordx4 v[132:135], v26, s[84:87], s26 offen
  s_add_u32 s26, s26, 3584
  buffer_load_dwordx4 v[136:139], v26, s[80:83], s26 offen
  buffer_load_dwordx4 v[140:143], v26, s[84:87], s26 offen
  s_add_u32 s26, s26, 3584
  buffer_load_dwordx4 v[144:147], v26, s[80:83], s26 offen
  buffer_load_dwordx4 v[148:151], v26, s[84:87], s26 offen
  s_add_u32 s26, s26, 3584
  buffer_load_dwordx4 v[152:155], v26, s[80:83], s26 offen
  buffer_load_dwordx4 v[156:159], v26, s[84:87], s26 offen
  s_add_u32 s26, s26, 3584
  buffer_load_dwordx4 v[160:163], v26, s[80:83], s26 offen
  buffer_load_dwordx4 v[164:167], v26, s[84:87], s26 offen
  s_add_u32 s26, s26, 3584
  buffer_load_dwordx4 v[168:171], v26, s[80:83], s26 offen
  buffer_load_dwordx4 v[172:175], v26, s[84:87], s26 offen
  s_add_u32 s26, s26, 3584
  buffer_load_dwordx4 v[176:179], v26, s[80:83], s26 offen
  buffer_load_dwordx4 v[180:183], v26, s[84:87], s26 offen
  s_add_u32 s26, s26, 3584
  buffer_load_dwordx4 v[184:187], v26, s[80:83], s26 offen
  buffer_load_dwordx4 v[188:191], v26, s[84:87], s26 offen
  s_add_u32 s26, s26, 3584
  buffer_load_dwordx4 v[192:195], v26, s[80:83], s26 offen
  buffer_load_dwordx4 v[196:199], v26, s[84:87], s26 offen
  s_add_u32 s26, s26, 3584
  buffer_load_dwordx4 v[200:203], v26, s[80:83], s26 offen
  buffer_load_dwordx4 v[204:207], v26, s[84:87], s26 offen
  s_add_u32 s26, s26, 3584
  buffer_load_dwordx4 v[208:211], v26, s[80:83], s26 offen
  buffer_load_dwordx4 v[212:215], v26, s[84:87], s26 offen
  s_add_u32 s26, s26, 3584
  buffer_load_dwordx4 v[216:219], v26, s[80:83], s26 offen
  buffer_load_dwordx4 v[220:223], v26, s[84:87], s26 offen
  s_add_u32 s26, s26, 3584
  buffer_load_dwordx4 v[224:227], v26, s[80:83], s26 offen
  buffer_load_dwordx4 v[228:231], v26, s[84:87], s26 offen
  s_add_u32 s26, s26, 3584
  buffer_load_dwordx4 v[232:235], v26, s[80:83], s26 offen
  buffer_load_dwordx4 v[236:239], v26, s[84:87], s26 offen
  s_add_u32 s26, s26, 3584
  buffer_load_dwordx4 v[240:243], v26, s[80:83], s26 offen
  buffer_load_dwordx4 v[244:247], v26, s[84:87], s26 offen
  s_add_u32 s26, s26, 3584
  buffer_load_dwordx4 v[248:251], v26, s[80:83], s26 offen
  buffer_load_dwordx4 v[252:255], v26, s[84:87], s26 offen
  s_add_u32 s26, s26, 3584
  s_mov_b32 vcc_lo, 0xaaaaaaaa
  s_mov_b32 vcc_hi, 0xaaaaaaaa
  v_mov_b32 v7, 0xffff
  v_mov_b32 v52, 0xffff0000
  v_cndmask_b32 v7, v7, v52, vcc
  s_mov_b32 vcc_lo, 0x30003
  s_mov_b32 vcc_hi, 0x30003
  v_cndmask_b32 v52, 0, v7, vcc
  s_mov_b32 vcc_lo, 0xc000c
  s_mov_b32 vcc_hi, 0xc000c
  v_cndmask_b32 v53, 0, v7, vcc
  s_mov_b32 vcc_lo, 0x300030
  s_mov_b32 vcc_hi, 0x300030
  v_cndmask_b32 v54, 0, v7, vcc
  s_mov_b32 vcc_lo, 0xc000c0
  s_mov_b32 vcc_hi, 0xc000c0
  v_cndmask_b32 v55, 0, v7, vcc
  s_waitcnt vmcnt(46)
  v_perm_b32 v7, v28, v28, s30
  v_and_b32 v44, v52, v7
  v_and_b32 v45, v53, v7
  v_and_b32 v46, v54, v7
  v_and_b32 v47, v55, v7
  s_waitcnt vmcnt(45)
  s_nop 0
  v_mfma_f32_16x16x32_bf16 v[56:59], v[44:47], v[72:75], 0
  buffer_load_dwordx4 v[72:75], v26, s[80:83], s26 offen
  s_waitcnt vmcnt(45)
  v_mfma_f32_16x16x32_bf16 v[60:63], v[44:47], v[76:79], 0
  buffer_load_dwordx4 v[76:79], v26, s[84:87], s26 offen
  s_add_u32 s26, s26, 3584
  v_perm_b32 v7, v28, v28, s31
  v_and_b32 v48, v52, v7
  v_and_b32 v49, v53, v7
  v_and_b32 v50, v54, v7
  v_and_b32 v51, v55, v7
  s_waitcnt vmcnt(45)
  s_nop 0
  v_mfma_f32_16x16x32_bf16 v[56:59], v[48:51], v[80:83], v[56:59]
  buffer_load_dwordx4 v[80:83], v26, s[80:83], s26 offen
  s_waitcnt vmcnt(45)
  v_mfma_f32_16x16x32_bf16 v[60:63], v[48:51], v[84:87], v[60:63]
  buffer_load_dwordx4 v[84:87], v26, s[84:87], s26 offen
  s_add_u32 s26, s26, 3584
  v_perm_b32 v7, v29, v29, s30
  v_and_b32 v44, v52, v7
  v_and_b32 v45, v53, v7
  v_and_b32 v46, v54, v7
  v_and_b32 v47, v55, v7
  s_waitcnt vmcnt(45)
  s_nop 0
  v_mfma_f32_16x16x32_bf16 v[56:59], v[44:47], v[88:91], v[56:59]
  buffer_load_dwordx4 v[88:91], v26, s[80:83], s26 offen
  s_waitcnt vmcnt(45)
  v_mfma_f32_16x16x32_bf16 v[60:63], v[44:47], v[92:95], v[60:63]
  buffer_load_dwordx4 v[92:95], v26, s[84:87], s26 offen
  s_add_u32 s26, s26, 3584
  v_perm_b32 v7, v29, v29, s31
  v_and_b32 v48, v52, v7
  v_and_b32 v49, v53, v7
  v_and_b32 v50, v54, v7
  v_and_b32 v51, v55, v7
  s_waitcnt vmcnt(45)
  s_nop 0
  v_mfma_f32_16x16x32_bf16 v[56:59], v[48:51], v[96:99], v[56:59]
  buffer_load_dwordx4 v[96:99], v26, s[80:83], s26 offen
  s_waitcnt vmcnt(45)
  v_mfma_f32_16x16x32_bf16 v[60:63], v[48:51], v[100:103], v[60:63]
  buffer_load_dwordx4 v[100:103], v26, s[84:87], s26 offen
  s_add_u32 s26, s26, 3584
  v_perm_b32 v7, v30, v30, s30
  v_and_b32 v44, v52, v7
  v_and_b32 v45, v53, v7
  v_and_b32 v46, v54, v7
  v_and_b32 v47, v55, v7
  s_waitcnt vmcnt(45)
  s_nop 0
  v_mfma_f32_16x16x32_bf16 v[56:59], v[44:47], v[104:107], v[56:59]
  buffer_load_dwordx4 v[104:107], v26, s[80:83], s26 offen
  s_waitcnt vmcnt(45)
  v_mfma_f32_16x16x32_bf16 v[60:63], v[44:47], v[108:111], v[60:63]
  buffer_load_dwordx4 v[108:111], v26, s[84:87], s26 offen
  s_add_u32 s26, s26, 3584
  v_perm_b32 v7, v30, v30, s31
  v_and_b32 v48, v52, v7
  v_and_b32 v49, v53, v7
  v_and_b32 v50, v54, v7
  v_and_b32 v51, v55, v7
  s_waitcnt vmcnt(45)
  s_nop 0
  v_mfma_f32_16x16x32_bf16 v[56:59], v[48:51], v[112:115], v[56:59]
  buffer_load_dwordx4 v[112:115], v26, s[80:83], s26 offen
  s_waitcnt vmcnt(45)
  v_mfma_f32_16x16x32_bf16 v[60:63], v[48:51], v[116:119], v[60:63]
  buffer_load_dwordx4 v[116:119], v26, s[84:87], s26 offen
  s_add_u32 s26, s26, 3584
  v_perm_b32 v7, v31, v31, s30
  v_and_b32 v44, v52, v7
  v_and_b32 v45, v53, v7
  v_and_b32 v46, v54, v7
  v_and_b32 v47, v55, v7
  s_waitcnt vmcnt(45)
  s_nop 0
  v_mfma_f32_16x16x32_bf16 v[56:59], v[44:47], v[120:123], v[56:59]
  buffer_load_dwordx4 v[120:123], v26, s[80:83], s26 offen
  s_waitcnt vmcnt(45)
  v_mfma_f32_16x16x32_bf16 v[60:63], v[44:47], v[124:127], v[60:63]
  buffer_load_dwordx4 v[124:127], v26, s[84:87], s26 offen
  s_add_u32 s26, s26, 3584
  v_perm_b32 v7, v31, v31, s31
  v_and_b32 v48, v52, v7
  v_and_b32 v49, v53, v7
  v_and_b32 v50, v54, v7
  v_and_b32 v51, v55, v7
  s_waitcnt vmcnt(45)
  s_nop 0
  v_mfma_f32_16x16x32_bf16 v[56:59], v[48:51], v[128:131], v[56:59]
  buffer_load_dwordx4 v[128:131], v26, s[80:83], s26 offen
  s_waitcnt vmcnt(45)
  v_mfma_f32_16x16x32_bf16 v[60:63], v[48:51], v[132:135], v[60:63]
  buffer_load_dwordx4 v[132:135], v26, s[84:87], s26 offen
  s_add_u32 s26, s26, 3584
  v_perm_b32 v7, v32, v32, s30
  v_and_b32 v44, v52, v7
  v_and_b32 v45, v53, v7
  v_and_b32 v46, v54, v7
  v_and_b32 v47, v55, v7
  s_waitcnt vmcnt(45)
  s_nop 0
  v_mfma_f32_16x16x32_bf16 v[56:59], v[44:47], v[136:139], v[56:59]
  buffer_load_dwordx4 v[136:139], v26, s[80:83], s26 offen
  s_waitcnt vmcnt(45)
  v_mfma_f32_16x16x32_bf16 v[60:63], v[44:47], v[140:143], v[60:63]
  buffer_load_dwordx4 v[140:143], v26, s[84:87], s26 offen
  s_add_u32 s26, s26, 3584
  v_perm_b32 v7, v32, v32, s31
  v_and_b32 v48, v52, v7
  v_and_b32 v49, v53, v7
  v_and_b32 v50, v54, v7
  v_and_b32 v51, v55, v7
  s_waitcnt vmcnt(45)
  s_nop 0
  v_mfma_f32_16x16x32_bf16 v[56:59], v[48:51], v[144:147], v[56:59]
  buffer_load_dwordx4 v[144:147], v27, s[8:11], s28 offen offset:0
  s_waitcnt vmcnt(45)
  v_mfma_f32_16x16x32_bf16 v[60:63], v[48:51], v[148:151], v[60:63]
  buffer_load_dwordx4 v[148:151], v27, s[8:11], s28 offen offset:1024
  v_perm_b32 v7, v33, v33, s30
  v_and_b32 v44, v52, v7
  v_and_b32 v45, v53, v7
  v_and_b32 v46, v54, v7
  v_and_b32 v47, v55, v7
  s_waitcnt vmcnt(45)
  s_nop 0
  v_mfma_f32_16x16x32_bf16 v[56:59], v[44:47], v[152:155], v[56:59]
  buffer_load_dwordx4 v[152:155], v27, s[8:11], s28 offen offset:2048
  s_waitcnt vmcnt(45)
  v_mfma_f32_16x16x32_bf16 v[60:63], v[44:47], v[156:159], v[60:63]
  buffer_load_dwordx4 v[156:159], v27, s[8:11], s28 offen offset:3072
  s_add_u32 s28, s28, 4096
  v_perm_b32 v7, v33, v33, s31
  v_and_b32 v48, v52, v7
  v_and_b32 v49, v53, v7
  v_and_b32 v50, v54, v7
  v_and_b32 v51, v55, v7
  s_waitcnt vmcnt(45)
  s_nop 0
  v_mfma_f32_16x16x32_bf16 v[56:59], v[48:51], v[160:163], v[56:59]
  buffer_load_dwordx4 v[160:163], v27, s[8:11], s28 offen offset:0
  s_waitcnt vmcnt(45)
  v_mfma_f32_16x16x32_bf16 v[60:63], v[48:51], v[164:167], v[60:63]
  buffer_load_dwordx4 v[164:167], v27, s[8:11], s28 offen offset:1024
  v_perm_b32 v7, v34, v34, s30
  v_and_b32 v44, v52, v7
  v_and_b32 v45, v53, v7
  v_and_b32 v46, v54, v7
  v_and_b32 v47, v55, v7
  s_waitcnt vmcnt(45)
  s_nop 0
  v_mfma_f32_16x16x32_bf16 v[56:59], v[44:47], v[168:171], v[56:59]
  buffer_load_dwordx4 v[168:171], v27, s[8:11], s28 offen offset:2048
  s_waitcnt vmcnt(45)
  v_mfma_f32_16x16x32_bf16 v[60:63], v[44:47], v[172:175], v[60:63]
  buffer_load_dwordx4 v[172:175], v27, s[8:11], s28 offen offset:3072
  s_add_u32 s28, s28, 4096
  v_perm_b32 v7, v34, v34, s31
  v_and_b32 v48, v52, v7
  v_and_b32 v49, v53, v7
  v_and_b32 v50, v54, v7
  v_and_b32 v51, v55, v7
  s_waitcnt vmcnt(45)
  s_nop 0
  v_mfma_f32_16x16x32_bf16 v[56:59], v[48:51], v[176:179], v[56:59]
  buffer_load_dwordx4 v[176:179], v27, s[8:11], s28 offen offset:0
  s_waitcnt vmcnt(45)
  v_mfma_f32_16x16x32_bf16 v[60:63], v[48:51], v[180:183], v[60:63]
  buffer_load_dwordx4 v[180:183], v27, s[8:11], s28 offen offset:1024
  v_perm_b32 v7, v35, v35, s30
  v_and_b32 v44, v52, v7
  v_and_b32 v45, v53, v7
  v_and_b32 v46, v54, v7
  v_and_b32 v47, v55, v7
  s_waitcnt vmcnt(45)
  s_nop 0
  v_mfma_f32_16x16x32_bf16 v[56:59], v[44:47], v[184:187], v[56:59]
  buffer_load_dwordx4 v[184:187], v27, s[8:11], s28 offen offset:2048
  s_waitcnt vmcnt(45)
  v_mfma_f32_16x16x32_bf16 v[60:63], v[44:47], v[188:191], v[60:63]
  buffer_load_dwordx4 v[188:191], v27, s[8:11], s28 offen offset:3072
  s_add_u32 s28, s28, 4096
  v_perm_b32 v7, v35, v35, s31
  v_and_b32 v48, v52, v7
  v_and_b32 v49, v53, v7
  v_and_b32 v50, v54, v7
  v_and_b32 v51, v55, v7
  s_waitcnt vmcnt(45)
  s_nop 0
  v_mfma_f32_16x16x32_bf16 v[56:59], v[48:51], v[192:195], v[56:59]
  buffer_load_dwordx4 v[192:195], v27, s[8:11], s28 offen offset:0
  s_waitcnt vmcnt(45)
  v_mfma_f32_16x16x32_bf16 v[60:63], v[48:51], v[196:199], v[60:63]
  buffer_load_dwordx4 v[196:199], v27, s[8:11], s28 offen offset:1024
  v_perm_b32 v7, v36, v36, s30
  v_and_b32 v44, v52, v7
  v_and_b32 v45, v53, v7
  v_and_b32 v46, v54, v7
  v_and_b32 v47, v55, v7
  s_waitcnt vmcnt(45)
  s_nop 0
  v_mfma_f32_16x16x32_bf16 v[56:59], v[44:47], v[200:203], v[56:59]
  buffer_load_dwordx4 v[200:203], v27, s[8:11], s28 offen offset:2048
  s_waitcnt vmcnt(45)
  v_mfma_f32_16x16x32_bf16 v[60:63], v[44:47], v[204:207], v[60:63]
  buffer_load_dwordx4 v[204:207], v27, s[8:11], s28 offen offset:3072
  s_add_u32 s28, s28, 4096
  v_perm_b32 v7, v36, v36, s31
  v_and_b32 v48, v52, v7
  v_and_b32 v49, v53, v7
  v_and_b32 v50, v54, v7
  v_and_b32 v51, v55, v7
  s_waitcnt vmcnt(45)
  s_nop 0
  v_mfma_f32_16x16x32_bf16 v[56:59], v[48:51], v[208:211], v[56:59]
  buffer_load_dwordx4 v[208:211], v27, s[8:11], s28 offen offset:0
  s_waitcnt vmcnt(45)
  v_mfma_f32_16x16x32_bf16 v[60:63], v[48:51], v[212:215], v[60:63]
  buffer_load_dwordx4 v[212:215], v27, s[8:11], s28 offen offset:1024
  v_perm_b32 v7, v37, v37, s30
  v_and_b32 v44, v52, v7
  v_and_b32 v45, v53, v7
  v_and_b32 v46, v54, v7
  v_and_b32 v47, v55, v7
  s_waitcnt vmcnt(45)
  s_nop 0
  v_mfma_f32_16x16x32_bf16 v[56:59], v[44:47], v[216:219], v[56:59]
  buffer_load_dwordx4 v[216:219], v27, s[8:11], s28 offen offset:2048
  s_waitcnt vmcnt(45)
  v_mfma_f32_16x16x32_bf16 v[60:63], v[44:47], v[220:223], v[60:63]
  buffer_load_dwordx4 v[220:223], v27, s[8:11], s28 offen offset:3072
  s_add_u32 s28, s28, 4096
  v_perm_b32 v7, v37, v37, s31
  v_and_b32 v48, v52, v7
  v_and_b32 v49, v53, v7
  v_and_b32 v50, v54, v7
  v_and_b32 v51, v55, v7
  s_waitcnt vmcnt(45)
  s_nop 0
  v_mfma_f32_16x16x32_bf16 v[56:59], v[48:51], v[224:227], v[56:59]
  buffer_load_dwordx4 v[224:227], v27, s[8:11], s28 offen offset:0
  s_waitcnt vmcnt(45)
  v_mfma_f32_16x16x32_bf16 v[60:63], v[48:51], v[228:231], v[60:63]
  buffer_load_dwordx4 v[228:231], v27, s[8:11], s28 offen offset:1024
  v_perm_b32 v7, v38, v38, s30
  v_and_b32 v44, v52, v7
  v_and_b32 v45, v53, v7
  v_and_b32 v46, v54, v7
  v_and_b32 v47, v55, v7
  s_waitcnt vmcnt(45)
  s_nop 0
  v_mfma_f32_16x16x32_bf16 v[56:59], v[44:47], v[232:235], v[56:59]
  buffer_load_dwordx4 v[232:235], v27, s[8:11], s28 offen offset:2048
  s_waitcnt vmcnt(45)
  v_mfma_f32_16x16x32_bf16 v[60:63], v[44:47], v[236:239], v[60:63]
  buffer_load_dwordx4 v[236:239], v27, s[8:11], s28 offen offset:3072
  s_add_u32 s28, s28, 4096
  v_perm_b32 v7, v38, v38, s31
  v_and_b32 v48, v52, v7
  v_and_b32 v49, v53, v7
  v_and_b32 v50, v54, v7
  v_and_b32 v51, v55, v7
  s_waitcnt vmcnt(45)
  s_nop 0
  v_mfma_f32_16x16x32_bf16 v[56:59], v[48:51], v[240:243], v[56:59]
  buffer_load_dwordx4 v[240:243], v27, s[8:11], s28 offen offset:0
  s_waitcnt vmcnt(45)
  v_mfma_f32_16x16x32_bf16 v[60:63], v[48:51], v[244:247], v[60:63]
  buffer_load_dwordx4 v[244:247], v27, s[8:11], s28 offen offset:1024
  v_perm_b32 v7, v39, v39, s30
  v_and_b32 v44, v52, v7
  v_and_b32 v45, v53, v7
  v_and_b32 v46, v54, v7
  v_and_b32 v47, v55, v7
  s_waitcnt vmcnt(45)
  s_nop 0
  v_mfma_f32_16x16x32_bf16 v[56:59], v[44:47], v[248:251], v[56:59]
  buffer_load_dwordx4 v[248:251], v27, s[8:11], s28 offen offset:2048
  s_waitcnt vmcnt(45)
  v_mfma_f32_16x16x32_bf16 v[60:63], v[44:47], v[252:255], v[60:63]
  buffer_load_dwordx4 v[252:255], v27, s[8:11], s28 offen offset:3072
  s_add_u32 s28, s28, 4096
  v_perm_b32 v7, v39, v39, s31
  v_and_b32 v48, v52, v7
  v_and_b32 v49, v53, v7
  v_and_b32 v50, v54, v7
  v_and_b32 v51, v55, v7
  s_waitcnt vmcnt(45)
  s_nop 0
  v_mfma_f32_16x16x32_bf16 v[56:59], v[48:51], v[72:75], v[56:59]
  s_waitcnt vmcnt(44)
  v_mfma_f32_16x16x32_bf16 v[60:63], v[48:51], v[76:79], v[60:63]
  v_perm_b32 v7, v40, v40, s30
  v_and_b32 v44, v52, v7
  v_and_b32 v45, v53, v7
  v_and_b32 v46, v54, v7
  v_and_b32 v47, v55, v7
  s_waitcnt vmcnt(43)
  s_nop 0
  v_mfma_f32_16x16x32_bf16 v[56:59], v[44:47], v[80:83], v[56:59]
  s_waitcnt vmcnt(42)
  v_mfma_f32_16x16x32_bf16 v[60:63], v[44:47], v[84:87], v[60:63]
  v_perm_b32 v7, v40, v40, s31
  v_and_b32 v48, v52, v7
  v_and_b32 v49, v53, v7
  v_and_b32 v50, v54, v7
  v_and_b32 v51, v55, v7
  s_waitcnt vmcnt(41)
  s_nop 0
  v_mfma_f32_16x16x32_bf16 v[56:59], v[48:51], v[88:91], v[56:59]
  s_waitcnt vmcnt(40)
  v_mfma_f32_16x16x32_bf16 v[60:63], v[48:51], v[92:95], v[60:63]
  v_perm_b32 v7, v41, v41, s30
  v_and_b32 v44, v52, v7
  v_and_b32 v45, v53, v7
  v_and_b32 v46, v54, v7
  v_and_b32 v47, v55, v7
  s_waitcnt vmcnt(39)
  s_nop 0
  v_mfma_f32_16x16x32_bf16 v[56:59], v[44:47], v[96:99], v[56:59]
  s_waitcnt vmcnt(38)
  v_mfma_f32_16x16x32_bf16 v[60:63], v[44:47], v[100:103], v[60:63]
  v_perm_b32 v7, v41, v41, s31
  v_and_b32 v48, v52, v7
  v_and_b32 v49, v53, v7
  v_and_b32 v50, v54, v7
  v_and_b32 v51, v55, v7
  s_waitcnt vmcnt(37)
  s_nop 0
  v_mfma_f32_16x16x32_bf16 v[56:59], v[48:51], v[104:107], v[56:59]
  s_waitcnt vmcnt(36)
  v_mfma_f32_16x16x32_bf16 v[60:63], v[48:51], v[108:111], v[60:63]
  v_perm_b32 v7, v42, v42, s30
  v_and_b32 v44, v52, v7
  v_and_b32 v45, v53, v7
  v_and_b32 v46, v54, v7
  v_and_b32 v47, v55, v7
  s_waitcnt vmcnt(35)
  s_nop 0
  v_mfma_f32_16x16x32_bf16 v[56:59], v[44:47], v[112:115], v[56:59]
  s_waitcnt vmcnt(34)
  v_mfma_f32_16x16x32_bf16 v[60:63], v[44:47], v[116:119], v[60:63]
  v_perm_b32 v7, v42, v42, s31
  v_and_b32 v48, v52, v7
  v_and_b32 v49, v53, v7
  v_and_b32 v50, v54, v7
  v_and_b32 v51, v55, v7
  s_waitcnt vmcnt(33)
  s_nop 0
  v_mfma_f32_16x16x32_bf16 v[56:59], v[48:51], v[120:123], v[56:59]
  s_waitcnt vmcnt(32)
  v_mfma_f32_16x16x32_bf16 v[60:63], v[48:51], v[124:127], v[60:63]
  v_perm_b32 v7, v43, v43, s30
  v_and_b32 v44, v52, v7
  v_and_b32 v45, v53, v7
  v_and_b32 v46, v54, v7
  v_and_b32 v47, v55, v7
  s_waitcnt vmcnt(31)
  s_nop 0
  v_mfma_f32_16x16x32_bf16 v[56:59], v[44:47], v[128:131], v[56:59]
  s_waitcnt vmcnt(30)
  v_mfma_f32_16x16x32_bf16 v[60:63], v[44:47], v[132:135], v[60:63]
  v_perm_b32 v7, v43, v43, s31
  v_and_b32 v48, v52, v7
  v_and_b32 v49, v53, v7
  v_and_b32 v50, v54, v7
  v_and_b32 v51, v55, v7
  s_waitcnt vmcnt(29)
  s_nop 0
  v_mfma_f32_16x16x32_bf16 v[56:59], v[48:51], v[136:139], v[56:59]
  s_waitcnt vmcnt(28)
  v_mfma_f32_16x16x32_bf16 v[60:63], v[48:51], v[140:143], v[60:63]
  s_lshl_b32 s26, s17, 11
  v_lshlrev_b32 v7, 1, v24
  v_lshl_add_u32 v7, v25, 4, v7
  v_cmp_gt_u32 vcc, 2, v25
  v_mov_b32 v28, 512
  s_nop 0
  v_cndmask_b32 v7, v28, v7, vcc
  v_add_u32 v7, s26, v7
  ds_write_b128 v7, v[56:59] offset:32768
  ds_write_b128 v7, v[60:63] offset:33792
  s_waitcnt lgkmcnt(0)
  s_barrier
  ds_read_b64 v[28:29], v1 offset:32768
  ds_read_b64 v[30:31], v1 offset:33792
  ds_read_b64 v[32:33], v1 offset:34816
  ds_read_b64 v[34:35], v1 offset:35840
  ds_read_b64 v[36:37], v1 offset:36864
  ds_read_b64 v[38:39], v1 offset:37888
  ds_read_b64 v[40:41], v1 offset:38912
  ds_read_b64 v[42:43], v1 offset:39936
  s_waitcnt lgkmcnt(0)
  v_add_f32 v28, v28, v32
  v_add_f32 v36, v36, v40
  v_add_f32 v28, v28, v36
  v_cvt_pk_bf16_f32 v28, v28, v28
  v_and_b32 v28, 0xffff0000, v28
  v_add_f32 v29, v29, v33
  v_add_f32 v37, v37, v41
  v_add_f32 v29, v29, v37
  v_cvt_pk_bf16_f32 v29, v29, v29
  v_and_b32 v29, 0xffff0000, v29
  v_add_f32 v30, v30, v34
  v_add_f32 v38, v38, v42
  v_add_f32 v30, v30, v38
  v_cvt_pk_bf16_f32 v30, v30, v30
  v_and_b32 v30, 0xffff0000, v30
  v_add_f32 v31, v31, v35
  v_add_f32 v39, v39, v43
  v_add_f32 v31, v31, v39
  v_cvt_pk_bf16_f32 v31, v31, v31
  v_and_b32 v31, 0xffff0000, v31
  v_mul_f32 v32, 0xbfb8aa3b, v28
  v_exp_f32 v32, v32
  s_nop 0
  v_add_f32 v32, 1.0, v32
  v_rcp_f32 v32, v32
  s_nop 0
  v_mul_f32 v28, v28, v32
  v_cvt_pk_bf16_f32 v28, v28, v28
  v_and_b32 v28, 0xffff0000, v28
  v_mul_f32 v28, v28, v30
  v_cvt_pk_bf16_f32 v28, v28, v28
  v_mul_f32 v33, 0xbfb8aa3b, v29
  v_exp_f32 v33, v33
  s_nop 0
  v_add_f32 v33, 1.0, v33
  v_rcp_f32 v33, v33
  s_nop 0
  v_mul_f32 v29, v29, v33
  v_cvt_pk_bf16_f32 v29, v29, v29
  v_and_b32 v29, 0xffff0000, v29
  v_mul_f32 v29, v29, v31
  v_cvt_pk_bf16_f32 v29, v29, v29
  s_lshl_b32 s26, s17, 9
  v_add_u32 v7, s26, v1
  ds_write_b64 v7, v[28:29] offset:40960
  v_mul_u32_u24 v7, 112, v25
  v_add_u32 v7, s26, v7
  ds_read_b128 v[28:31], v7 offset:40960
  ds_read_b128 v[32:35], v7 offset:40976
  ds_read_b128 v[36:39], v7 offset:40992
  ds_read_b128 v[40:43], v7 offset:41008
  ds_read_b128 v[56:59], v7 offset:41024
  ds_read_b128 v[60:63], v7 offset:41040
  ds_read_b128 v[68:71], v7 offset:41056
  s_waitcnt lgkmcnt(0)
  v_and_b32 v44, v52, v28
  v_and_b32 v45, v53, v28
  v_and_b32 v46, v54, v28
  v_and_b32 v47, v55, v28
  s_waitcnt vmcnt(27)
  s_nop 0
  v_mfma_f32_16x16x32_bf16 v[64:67], v[44:47], v[144:147], 0
  v_and_b32 v48, v52, v29
  v_and_b32 v49, v53, v29
  v_and_b32 v50, v54, v29
  v_and_b32 v51, v55, v29
  s_waitcnt vmcnt(26)
  s_nop 0
  v_mfma_f32_16x16x32_bf16 v[64:67], v[48:51], v[148:151], v[64:67]
  v_and_b32 v44, v52, v30
  v_and_b32 v45, v53, v30
  v_and_b32 v46, v54, v30
  v_and_b32 v47, v55, v30
  s_waitcnt vmcnt(25)
  s_nop 0
  v_mfma_f32_16x16x32_bf16 v[64:67], v[44:47], v[152:155], v[64:67]
  v_and_b32 v48, v52, v31
  v_and_b32 v49, v53, v31
  v_and_b32 v50, v54, v31
  v_and_b32 v51, v55, v31
  s_waitcnt vmcnt(24)
  s_nop 0
  v_mfma_f32_16x16x32_bf16 v[64:67], v[48:51], v[156:159], v[64:67]
  v_and_b32 v44, v52, v32
  v_and_b32 v45, v53, v32
  v_and_b32 v46, v54, v32
  v_and_b32 v47, v55, v32
  s_waitcnt vmcnt(23)
  s_nop 0
  v_mfma_f32_16x16x32_bf16 v[64:67], v[44:47], v[160:163], v[64:67]
  v_and_b32 v48, v52, v33
  v_and_b32 v49, v53, v33
  v_and_b32 v50, v54, v33
  v_and_b32 v51, v55, v33
  s_waitcnt vmcnt(22)
  s_nop 0
  v_mfma_f32_16x16x32_bf16 v[64:67], v[48:51], v[164:167], v[64:67]
  v_and_b32 v44, v52, v34
  v_and_b32 v45, v53, v34
  v_and_b32 v46, v54, v34
  v_and_b32 v47, v55, v34
  s_waitcnt vmcnt(21)
  s_nop 0
  v_mfma_f32_16x16x32_bf16 v[64:67], v[44:47], v[168:171], v[64:67]
  v_and_b32 v48, v52, v35
  v_and_b32 v49, v53, v35
  v_and_b32 v50, v54, v35
  v_and_b32 v51, v55, v35
  s_waitcnt vmcnt(20)
  s_nop 0
  v_mfma_f32_16x16x32_bf16 v[64:67], v[48:51], v[172:175], v[64:67]
  v_and_b32 v44, v52, v36
  v_and_b32 v45, v53, v36
  v_and_b32 v46, v54, v36
  v_and_b32 v47, v55, v36
  s_waitcnt vmcnt(19)
  s_nop 0
  v_mfma_f32_16x16x32_bf16 v[64:67], v[44:47], v[176:179], v[64:67]
  v_and_b32 v48, v52, v37
  v_and_b32 v49, v53, v37
  v_and_b32 v50, v54, v37
  v_and_b32 v51, v55, v37
  s_waitcnt vmcnt(18)
  s_nop 0
  v_mfma_f32_16x16x32_bf16 v[64:67], v[48:51], v[180:183], v[64:67]
  v_and_b32 v44, v52, v38
  v_and_b32 v45, v53, v38
  v_and_b32 v46, v54, v38
  v_and_b32 v47, v55, v38
  s_waitcnt vmcnt(17)
  s_nop 0
  v_mfma_f32_16x16x32_bf16 v[64:67], v[44:47], v[184:187], v[64:67]
  v_and_b32 v48, v52, v39
  v_and_b32 v49, v53, v39
  v_and_b32 v50, v54, v39
  v_and_b32 v51, v55, v39
  s_waitcnt vmcnt(16)
  s_nop 0
  v_mfma_f32_16x16x32_bf16 v[64:67], v[48:51], v[188:191], v[64:67]
  v_and_b32 v44, v52, v40
  v_and_b32 v45, v53, v40
  v_and_b32 v46, v54, v40
  v_and_b32 v47, v55, v40
  s_waitcnt vmcnt(15)
  s_nop 0
  v_mfma_f32_16x16x32_bf16 v[64:67], v[44:47], v[192:195], v[64:67]
  v_and_b32 v48, v52, v41
  v_and_b32 v49, v53, v41
  v_and_b32 v50, v54, v41
  v_and_b32 v51, v55, v41
  s_waitcnt vmcnt(14)
  s_nop 0
  v_mfma_f32_16x16x32_bf16 v[64:67], v[48:51], v[196:199], v[64:67]
  v_and_b32 v44, v52, v42
  v_and_b32 v45, v53, v42
  v_and_b32 v46, v54, v42
  v_and_b32 v47, v55, v42
  s_waitcnt vmcnt(13)
  s_nop 0
  v_mfma_f32_16x16x32_bf16 v[64:67], v[44:47], v[200:203], v[64:67]
  v_and_b32 v48, v52, v43
  v_and_b32 v49, v53, v43
  v_and_b32 v50, v54, v43
  v_and_b32 v51, v55, v43
  s_waitcnt vmcnt(12)
  s_nop 0
  v_mfma_f32_16x16x32_bf16 v[64:67], v[48:51], v[204:207], v[64:67]
  v_and_b32 v44, v52, v56
  v_and_b32 v45, v53, v56
  v_and_b32 v46, v54, v56
  v_and_b32 v47, v55, v56
  s_waitcnt vmcnt(11)
  s_nop 0
  v_mfma_f32_16x16x32_bf16 v[64:67], v[44:47], v[208:211], v[64:67]
  v_and_b32 v48, v52, v57
  v_and_b32 v49, v53, v57
  v_and_b32 v50, v54, v57
  v_and_b32 v51, v55, v57
  s_waitcnt vmcnt(10)
  s_nop 0
  v_mfma_f32_16x16x32_bf16 v[64:67], v[48:51], v[212:215], v[64:67]
  v_and_b32 v44, v52, v58
  v_and_b32 v45, v53, v58
  v_and_b32 v46, v54, v58
  v_and_b32 v47, v55, v58
  s_waitcnt vmcnt(9)
  s_nop 0
  v_mfma_f32_16x16x32_bf16 v[64:67], v[44:47], v[216:219], v[64:67]
  v_and_b32 v48, v52, v59
  v_and_b32 v49, v53, v59
  v_and_b32 v50, v54, v59
  v_and_b32 v51, v55, v59
  s_waitcnt vmcnt(8)
  s_nop 0
  v_mfma_f32_16x16x32_bf16 v[64:67], v[48:51], v[220:223], v[64:67]
  v_and_b32 v44, v52, v60
  v_and_b32 v45, v53, v60
  v_and_b32 v46, v54, v60
  v_and_b32 v47, v55, v60
  s_waitcnt vmcnt(7)
  s_nop 0
  v_mfma_f32_16x16x32_bf16 v[64:67], v[44:47], v[224:227], v[64:67]
  v_and_b32 v48, v52, v61
  v_and_b32 v49, v53, v61
  v_and_b32 v50, v54, v61
  v_and_b32 v51, v55, v61
  s_waitcnt vmcnt(6)
  s_nop 0
  v_mfma_f32_16x16x32_bf16 v[64:67], v[48:51], v[228:231], v[64:67]
  v_and_b32 v44, v52, v62
  v_and_b32 v45, v53, v62
  v_and_b32 v46, v54, v62
  v_and_b32 v47, v55, v62
  s_waitcnt vmcnt(5)
  s_nop 0
  v_mfma_f32_16x16x32_bf16 v[64:67], v[44:47], v[232:235], v[64:67]
  v_and_b32 v48, v52, v63
  v_and_b32 v49, v53, v63
  v_and_b32 v50, v54, v63
  v_and_b32 v51, v55, v63
  s_waitcnt vmcnt(4)
  s_nop 0
  v_mfma_f32_16x16x32_bf16 v[64:67], v[48:51], v[236:239], v[64:67]
  v_and_b32 v44, v52, v68
  v_and_b32 v45, v53, v68
  v_and_b32 v46, v54, v68
  v_and_b32 v47, v55, v68
  s_waitcnt vmcnt(3)
  s_nop 0
  v_mfma_f32_16x16x32_bf16 v[64:67], v[44:47], v[240:243], v[64:67]
  v_and_b32 v48, v52, v69
  v_and_b32 v49, v53, v69
  v_and_b32 v50, v54, v69
  v_and_b32 v51, v55, v69
  s_waitcnt vmcnt(2)
  s_nop 0
  v_mfma_f32_16x16x32_bf16 v[64:67], v[48:51], v[244:247], v[64:67]
  v_and_b32 v44, v52, v70
  v_and_b32 v45, v53, v70
  v_and_b32 v46, v54, v70
  v_and_b32 v47, v55, v70
  s_waitcnt vmcnt(1)
  s_nop 0
  v_mfma_f32_16x16x32_bf16 v[64:67], v[44:47], v[248:251], v[64:67]
  v_and_b32 v48, v52, v71
  v_and_b32 v49, v53, v71
  v_and_b32 v50, v54, v71
  v_and_b32 v51, v55, v71
  s_waitcnt vmcnt(0)
  s_nop 0
  v_mfma_f32_16x16x32_bf16 v[64:67], v[48:51], v[252:255], v[64:67]
  v_lshlrev_b32 v7, 1, v24
  v_lshl_add_u32 v7, v25, 4, v7
  s_lshl_b32 s26, s60, 4
  s_add_u32 s26, s26, s61
  s_lshl_b32 s26, s26, 11
  s_lshl_b32 s27, s17, 9
  s_add_u32 s26, s26, s27
  s_add_u32 s26, s26, 188743680
  s_mov_b32 exec_hi, 0
  buffer_store_dwordx4 v[64:67], v7, s[4:7], s26 offen
  s_mov_b64 exec, -1
  s_lshl_b32 s26, s60, 10
  s_add_u32 s26, s26, 5279744
  s_lshl_b32 s27, s61, 4
  s_lshl_b32 s28, s17, 2
  s_add_u32 s27, s27, s28
  v_mov_b32 v28, s79
  v_mov_b32 v29, s27
  s_waitcnt vmcnt(0)
  s_mov_b64 exec, 1
  buffer_store_dword v28, v29, s[4:7], s26 offen
  s_mov_b64 exec, -1
  s_cmp_lg_u32 s27, 0
  s_cbranch_scc1 m_done_76
  s_add_u32 s27, s32, 167772160
  s_add_u32 s28, s32, 176160768
  buffer_load_dwordx4 v[24:27], v0, s[4:7], s27 offen sc1
  buffer_load_dwordx4 v[28:31], v0, s[4:7], s28 offen sc1
  s_mov_b32 s67, 0
m_w_77:
  buffer_load_dword v32, v2, s[4:7], s26 offen sc1
  s_add_u32 s67, s67, 1
  s_cmp_gt_u32 s67, 1048576
  s_cbranch_scc1 L_end
  s_waitcnt vmcnt(0)
  v_cmp_gt_u32 vcc, s79, v32
  s_cbranch_vccnz m_w_77
  s_lshl_b32 s26, s60, 15
  s_add_u32 s26, s26, 188743680
  v_lshlrev_b32 v7, 1, v0
  buffer_load_dwordx4 v[72:75], v7, s[4:7], s26 offen offset:0 sc1
  buffer_load_dwordx4 v[76:79], v7, s[4:7], s26 offen offset:16 sc1
  buffer_load_dwordx4 v[80:83], v7, s[4:7], s26 offen offset:2048 sc1
  buffer_load_dwordx4 v[84:87], v7, s[4:7], s26 offen offset:2064 sc1
  s_add_u32 s26, s26, 4096
  buffer_load_dwordx4 v[88:91], v7, s[4:7], s26 offen offset:0 sc1
  buffer_load_dwordx4 v[92:95], v7, s[4:7], s26 offen offset:16 sc1
  buffer_load_dwordx4 v[96:99], v7, s[4:7], s26 offen offset:2048 sc1
  buffer_load_dwordx4 v[100:103], v7, s[4:7], s26 offen offset:2064 sc1
  s_add_u32 s26, s26, 4096
  buffer_load_dwordx4 v[104:107], v7, s[4:7], s26 offen offset:0 sc1
  buffer_load_dwordx4 v[108:111], v7, s[4:7], s26 offen offset:16 sc1
  buffer_load_dwordx4 v[112:115], v7, s[4:7], s26 offen offset:2048 sc1
  buffer_load_dwordx4 v[116:119], v7, s[4:7], s26 offen offset:2064 sc1
  s_add_u32 s26, s26, 4096
  buffer_load_dwordx4 v[120:123], v7, s[4:7], s26 offen offset:0 sc1
  buffer_load_dwordx4 v[124:127], v7, s[4:7], s26 offen offset:16 sc1
  buffer_load_dwordx4 v[128:131], v7, s[4:7], s26 offen offset:2048 sc1
  buffer_load_dwordx4 v[132:135], v7, s[4:7], s26 offen offset:2064 sc1
  s_add_u32 s26, s26, 4096
  buffer_load_dwordx4 v[136:139], v7, s[4:7], s26 offen offset:0 sc1
  buffer_load_dwordx4 v[140:143], v7, s[4:7], s26 offen offset:16 sc1
  buffer_load_dwordx4 v[144:147], v7, s[4:7], s26 offen offset:2048 sc1
  buffer_load_dwordx4 v[148:151], v7, s[4:7], s26 offen offset:2064 sc1
  s_add_u32 s26, s26, 4096
  buffer_load_dwordx4 v[152:155], v7, s[4:7], s26 offen offset:0 sc1
  buffer_load_dwordx4 v[156:159], v7, s[4:7], s26 offen offset:16 sc1
  buffer_load_dwordx4 v[160:163], v7, s[4:7], s26 offen offset:2048 sc1
  buffer_load_dwordx4 v[164:167], v7, s[4:7], s26 offen offset:2064 sc1
  s_add_u32 s26, s26, 4096
  buffer_load_dwordx4 v[168:171], v7, s[4:7], s26 offen offset:0 sc1
  buffer_load_dwordx4 v[172:175], v7, s[4:7], s26 offen offset:16 sc1
  buffer_load_dwordx4 v[176:179], v7, s[4:7], s26 offen offset:2048 sc1
  buffer_load_dwordx4 v[180:183], v7, s[4:7], s26 offen offset:2064 sc1
  s_add_u32 s26, s26, 4096
  buffer_load_dwordx4 v[184:187], v7, s[4:7], s26 offen offset:0 sc1
  buffer_load_dwordx4 v[188:191], v7, s[4:7], s26 offen offset:16 sc1
  buffer_load_dwordx4 v[192:195], v7, s[4:7], s26 offen offset:2048 sc1
  buffer_load_dwordx4 v[196:199], v7, s[4:7], s26 offen offset:2064 sc1
  s_add_u32 s26, s26, 4096
  v_lshlrev_b32 v32, 16, v24
  v_and_b32 v33, 0xffff0000, v24
  v_lshlrev_b32 v34, 16, v25
  v_and_b32 v35, 0xffff0000, v25
  v_lshlrev_b32 v36, 16, v26
  v_and_b32 v37, 0xffff0000, v26
  v_lshlrev_b32 v38, 16, v27
  v_and_b32 v39, 0xffff0000, v27
  v_lshlrev_b32 v40, 16, v28
  v_and_b32 v41, 0xffff0000, v28
  v_lshlrev_b32 v42, 16, v29
  v_and_b32 v43, 0xffff0000, v29
  v_lshlrev_b32 v44, 16, v30
  v_and_b32 v45, 0xffff0000, v30
  v_lshlrev_b32 v46, 16, v31
  v_and_b32 v47, 0xffff0000, v31
  s_and_b32 s26, s78, 0xffff0000
  s_xor_b32 s27, s26, 0x80000000
  s_xor_b32 s28, s26, 0xffff0000
  s_bitcmp1_b32 s26, 31
  s_cselect_b32 s26, s27, s28
  v_mov_b32 v52, s26
  v_mul_f32 v52, 0xbfb8aa3b, v52
  v_exp_f32 v52, v52
  s_nop 0
  v_add_f32 v52, 1.0, v52
  v_rcp_f32 v52, v52
  s_nop 0
  v_cvt_pk_bf16_f32 v52, v52, v52
  v_and_b32 v52, 0xffff0000, v52
  s_waitcnt vmcnt(28)
  v_pk_add_f32 v[72:73], v[72:73], v[80:81]
  v_pk_add_f32 v[74:75], v[74:75], v[82:83]
  v_pk_add_f32 v[76:77], v[76:77], v[84:85]
  v_pk_add_f32 v[78:79], v[78:79], v[86:87]
  s_waitcnt vmcnt(26)
  v_pk_add_f32 v[72:73], v[72:73], v[88:89]
  v_pk_add_f32 v[74:75], v[74:75], v[90:91]
  v_pk_add_f32 v[76:77], v[76:77], v[92:93]
  v_pk_add_f32 v[78:79], v[78:79], v[94:95]
  s_waitcnt vmcnt(24)
  v_pk_add_f32 v[72:73], v[72:73], v[96:97]
  v_pk_add_f32 v[74:75], v[74:75], v[98:99]
  v_pk_add_f32 v[76:77], v[76:77], v[100:101]
  v_pk_add_f32 v[78:79], v[78:79], v[102:103]
  s_waitcnt vmcnt(22)
  v_pk_add_f32 v[72:73], v[72:73], v[104:105]
  v_pk_add_f32 v[74:75], v[74:75], v[106:107]
  v_pk_add_f32 v[76:77], v[76:77], v[108:109]
  v_pk_add_f32 v[78:79], v[78:79], v[110:111]
  s_waitcnt vmcnt(20)
  v_pk_add_f32 v[72:73], v[72:73], v[112:113]
  v_pk_add_f32 v[74:75], v[74:75], v[114:115]
  v_pk_add_f32 v[76:77], v[76:77], v[116:117]
  v_pk_add_f32 v[78:79], v[78:79], v[118:119]
  s_waitcnt vmcnt(18)
  v_pk_add_f32 v[72:73], v[72:73], v[120:121]
  v_pk_add_f32 v[74:75], v[74:75], v[122:123]
  v_pk_add_f32 v[76:77], v[76:77], v[124:125]
  v_pk_add_f32 v[78:79], v[78:79], v[126:127]
  s_waitcnt vmcnt(16)
  v_pk_add_f32 v[72:73], v[72:73], v[128:129]
  v_pk_add_f32 v[74:75], v[74:75], v[130:131]
  v_pk_add_f32 v[76:77], v[76:77], v[132:133]
  v_pk_add_f32 v[78:79], v[78:79], v[134:135]
  s_waitcnt vmcnt(14)
  v_pk_add_f32 v[72:73], v[72:73], v[136:137]
  v_pk_add_f32 v[74:75], v[74:75], v[138:139]
  v_pk_add_f32 v[76:77], v[76:77], v[140:141]
  v_pk_add_f32 v[78:79], v[78:79], v[142:143]
  s_waitcnt vmcnt(12)
  v_pk_add_f32 v[72:73], v[72:73], v[144:145]
  v_pk_add_f32 v[74:75], v[74:75], v[146:147]
  v_pk_add_f32 v[76:77], v[76:77], v[148:149]
  v_pk_add_f32 v[78:79], v[78:79], v[150:151]
  s_waitcnt vmcnt(10)
  v_pk_add_f32 v[72:73], v[72:73], v[152:153]
  v_pk_add_f32 v[74:75], v[74:75], v[154:155]
  v_pk_add_f32 v[76:77], v[76:77], v[156:157]
  v_pk_add_f32 v[78:79], v[78:79], v[158:159]
  s_waitcnt vmcnt(8)
  v_pk_add_f32 v[72:73], v[72:73], v[160:161]
  v_pk_add_f32 v[74:75], v[74:75], v[162:163]
  v_pk_add_f32 v[76:77], v[76:77], v[164:165]
  v_pk_add_f32 v[78:79], v[78:79], v[166:167]
  s_waitcnt vmcnt(6)
  v_pk_add_f32 v[72:73], v[72:73], v[168:169]
  v_pk_add_f32 v[74:75], v[74:75], v[170:171]
  v_pk_add_f32 v[76:77], v[76:77], v[172:173]
  v_pk_add_f32 v[78:79], v[78:79], v[174:175]
  s_waitcnt vmcnt(4)
  v_pk_add_f32 v[72:73], v[72:73], v[176:177]
  v_pk_add_f32 v[74:75], v[74:75], v[178:179]
  v_pk_add_f32 v[76:77], v[76:77], v[180:181]
  v_pk_add_f32 v[78:79], v[78:79], v[182:183]
  s_waitcnt vmcnt(2)
  v_pk_add_f32 v[72:73], v[72:73], v[184:185]
  v_pk_add_f32 v[74:75], v[74:75], v[186:187]
  v_pk_add_f32 v[76:77], v[76:77], v[188:189]
  v_pk_add_f32 v[78:79], v[78:79], v[190:191]
  s_waitcnt vmcnt(0)
  v_pk_add_f32 v[72:73], v[72:73], v[192:193]
  v_pk_add_f32 v[74:75], v[74:75], v[194:195]
  v_pk_add_f32 v[76:77], v[76:77], v[196:197]
  v_pk_add_f32 v[78:79], v[78:79], v[198:199]
  v_cvt_pk_bf16_f32 v48, v72, v73
  v_cvt_pk_bf16_f32 v49, v74, v75
  v_cvt_pk_bf16_f32 v50, v76, v77
  v_cvt_pk_bf16_f32 v51, v78, v79
  v_lshlrev_b32 v72, 16, v48
  v_and_b32 v73, 0xffff0000, v48
  v_lshlrev_b32 v74, 16, v49
  v_and_b32 v75, 0xffff0000, v49
  v_lshlrev_b32 v76, 16, v50
  v_and_b32 v77, 0xffff0000, v50
  v_lshlrev_b32 v78, 16, v51
  v_and_b32 v79, 0xffff0000, v51
  v_mul_f32 v72, v72, v52
  v_mul_f32 v73, v73, v52
  v_mul_f32 v74, v74, v52
  v_mul_f32 v75, v75, v52
  v_mul_f32 v76, v76, v52
  v_mul_f32 v77, v77, v52
  v_mul_f32 v78, v78, v52
  v_mul_f32 v79, v79, v52
  v_cvt_pk_bf16_f32 v48, v72, v73
  v_cvt_pk_bf16_f32 v49, v74, v75
  v_cvt_pk_bf16_f32 v50, v76, v77
  v_cvt_pk_bf16_f32 v51, v78, v79
  v_lshlrev_b32 v72, 16, v48
  v_and_b32 v73, 0xffff0000, v48
  v_lshlrev_b32 v74, 16, v49
  v_and_b32 v75, 0xffff0000, v49
  v_lshlrev_b32 v76, 16, v50
  v_and_b32 v77, 0xffff0000, v50
  v_lshlrev_b32 v78, 16, v51
  v_and_b32 v79, 0xffff0000, v51
  v_add_f32 v72, v72, v40
  v_add_f32 v73, v73, v41
  v_add_f32 v74, v74, v42
  v_add_f32 v75, v75, v43
  v_add_f32 v76, v76, v44
  v_add_f32 v77, v77, v45
  v_add_f32 v78, v78, v46
  v_add_f32 v79, v79, v47
  v_cvt_pk_bf16_f32 v48, v72, v73
  v_cvt_pk_bf16_f32 v49, v74, v75
  v_cvt_pk_bf16_f32 v50, v76, v77
  v_cvt_pk_bf16_f32 v51, v78, v79
  v_lshlrev_b32 v72, 16, v48
  v_and_b32 v73, 0xffff0000, v48
  v_lshlrev_b32 v74, 16, v49
  v_and_b32 v75, 0xffff0000, v49
  v_lshlrev_b32 v76, 16, v50
  v_and_b32 v77, 0xffff0000, v50
  v_lshlrev_b32 v78, 16, v51
  v_and_b32 v79, 0xffff0000, v51
  v_add_f32 v32, v32, v72
  v_add_f32 v33, v33, v73
  v_add_f32 v34, v34, v74
  v_add_f32 v35, v35, v75
  v_add_f32 v36, v36, v76
  v_add_f32 v37, v37, v77
  v_add_f32 v38, v38, v78
  v_add_f32 v39, v39, v79
  v_cvt_pk_bf16_f32 v48, v32, v33
  v_cvt_pk_bf16_f32 v49, v34, v35
  v_cvt_pk_bf16_f32 v50, v36, v37
  v_cvt_pk_bf16_f32 v51, v38, v39
  v_lshlrev_b32 v32, 16, v48
  v_and_b32 v33, 0xffff0000, v48
  v_lshlrev_b32 v34, 16, v49
  v_and_b32 v35, 0xffff0000, v49
  v_lshlrev_b32 v36, 16, v50
  v_and_b32 v37, 0xffff0000, v50
  v_lshlrev_b32 v38, 16, v51
  v_and_b32 v39, 0xffff0000, v51
  s_lshl_b32 s26, s77, 10
  s_cmp_lg_u32 s64, 0
  s_cbranch_scc1 m_f2_78
  s_add_u32 s27, s26, 10485760
  buffer_store_dwordx4 v[48:51], v0, s[4:7], s27 offen sc1
  v_add_f32 v52, v32, v33
  v_add_f32 v53, v34, v35
  v_add_f32 v54, v36, v37
  v_add_f32 v55, v38, v39
  v_add_f32 v52, v52, v53
  v_add_f32 v54, v54, v55
  v_add_f32 v52, v52, v54
  s_nop 1
  v_add_f32_dpp v52, v52, v52 row_ror:8 row_mask:0xf bank_mask:0xf
  s_nop 1
  v_add_f32_dpp v52, v52, v52 row_ror:4 row_mask:0xf bank_mask:0xf
  s_nop 1
  v_add_f32_dpp v52, v52, v52 row_ror:2 row_mask:0xf bank_mask:0xf
  s_nop 1
  v_add_f32_dpp v52, v52, v52 row_ror:1 row_mask:0xf bank_mask:0xf
  v_mov_b32 v54, v52
  s_nop 0
  s_nop 0
  v_permlane16_swap_b32 v52, v54
  v_add_f32 v52, v52, v54
  v_mov_b32 v54, v52
  s_nop 0
  s_nop 0
  v_permlane32_swap_b32 v52, v54
  v_add_f32 v52, v52, v54
  v_mul_f32 v52, 0x3b000000, v52
  v_sub_f32 v56, v32, v52
  v_sub_f32 v57, v33, v52
  v_sub_f32 v58, v34, v52
  v_sub_f32 v59, v35, v52
  v_sub_f32 v60, v36, v52
  v_sub_f32 v61, v37, v52
  v_sub_f32 v62, v38, v52
  v_sub_f32 v63, v39, v52
  v_mul_f32 v53, v56, v56
  v_mul_f32 v54, v57, v57
  v_fmac_f32 v53, v58, v58
  v_fmac_f32 v54, v59, v59
  v_fmac_f32 v53, v60, v60
  v_fmac_f32 v54, v61, v61
  v_fmac_f32 v53, v62, v62
  v_fmac_f32 v54, v63, v63
  v_add_f32 v53, v53, v54
  v_cvt_pk_bf16_f32 v52, v52, v52
  v_and_b32 v52, 0xffff0000, v52
  v_add_f32_dpp v53, v53, v53 row_ror:8 row_mask:0xf bank_mask:0xf
  s_nop 1
  v_add_f32_dpp v53, v53, v53 row_ror:4 row_mask:0xf bank_mask:0xf
  s_nop 1
  v_add_f32_dpp v53, v53, v53 row_ror:2 row_mask:0xf bank_mask:0xf
  s_nop 1
  v_add_f32_dpp v53, v53, v53 row_ror:1 row_mask:0xf bank_mask:0xf
  v_mov_b32 v54, v53
  s_nop 0
  s_nop 0
  v_permlane16_swap_b32 v53, v54
  v_add_f32 v53, v53, v54
  v_mov_b32 v54, v53
  s_nop 0
  s_nop 0
  v_permlane32_swap_b32 v53, v54
  v_add_f32 v53, v53, v54
  v_sub_f32 v56, v32, v52
  v_sub_f32 v57, v33, v52
  v_sub_f32 v58, v34, v52
  v_sub_f32 v59, v35, v52
  v_sub_f32 v60, v36, v52
  v_sub_f32 v61, v37, v52
  v_sub_f32 v62, v38, v52
  v_sub_f32 v63, v39, v52
  v_mul_f32 v53, 0x3b000000, v53
  v_cvt_pk_bf16_f32 v53, v53, v53
  v_and_b32 v53, 0xffff0000, v53
  v_add_f32 v53, 0x3727c5ac, v53
  v_cvt_pk_bf16_f32 v53, v53, v53
  v_and_b32 v53, 0xffff0000, v53
  v_sqrt_f32 v53, v53
  v_cvt_pk_bf16_f32 v72, v56, v57
  v_cvt_pk_bf16_f32 v73, v58, v59
  v_cvt_pk_bf16_f32 v74, v60, v61
  v_cvt_pk_bf16_f32 v75, v62, v63
  v_cvt_pk_bf16_f32 v53, v53, v53
  v_and_b32 v53, 0xffff0000, v53
  v_rcp_f32 v53, v53
  v_lshlrev_b32 v56, 16, v72
  v_and_b32 v57, 0xffff0000, v72
  v_lshlrev_b32 v58, 16, v73
  v_and_b32 v59, 0xffff0000, v73
  v_lshlrev_b32 v60, 16, v74
  v_and_b32 v61, 0xffff0000, v74
  v_lshlrev_b32 v62, 16, v75
  v_and_b32 v63, 0xffff0000, v75
  v_mul_f32 v56, v56, v53
  v_mul_f32 v57, v57, v53
  v_mul_f32 v58, v58, v53
  v_mul_f32 v59, v59, v53
  v_mul_f32 v60, v60, v53
  v_mul_f32 v61, v61, v53
  v_mul_f32 v62, v62, v53
  v_mul_f32 v63, v63, v53
  v_cvt_pk_bf16_f32 v72, v56, v57
  v_cvt_pk_bf16_f32 v73, v58, v59
  v_cvt_pk_bf16_f32 v74, v60, v61
  v_cvt_pk_bf16_f32 v75, v62, v63
  s_add_u32 s27, s26, 8388608
  buffer_store_dwordx4 v[72:75], v0, s[4:7], s27 offen sc1
  v_mov_b32 v76, 1
  s_mov_b32 s27, 5283840
  s_waitcnt vmcnt(0)
  buffer_store_dword v76, v2, s[4:7], s27 offen sc1
  s_branch m_f3_79
m_f2_78:
  buffer_store_dwordx4 v[48:51], v0, s[68:71], s26 offen sc1
m_f3_79:
m_done_76:
o_nomlp_61:
  s_cmp_lg_u32 s64, 0
  s_cbranch_scc1 o_fin_62
  s_mov_b32 s64, 1
  s_mov_b32 s65, 2
  s_mov_b32 s66, 2
  s_mov_b32 s63, s60
  s_branch o_loop_60
o_fin_62:
  s_endpgm
L_o_x:
  s_mov_b32 s62, 0
  s_mov_b32 s79, 0
  s_mov_b32 s64, 0
  s_mov_b32 s65, 0
  s_mov_b32 s66, 0
  s_mov_b32 s63, s60
o_loop_80:
  s_add_u32 s62, s62, 1
  s_lshr_b32 s26, s17, 1
  s_lshl_b32 s27, s61, 1
  s_add_u32 s26, s26, s27
  s_lshl_b32 s27, s63, 5
  s_add_u32 s26, s26, s27
  s_lshl_b32 s34, s64, 11
  s_add_u32 s34, s34, s26
  s_lshl_b32 s35, s65, 11
  s_add_u32 s35, s35, s26
  s_lshl_b32 s26, s34, 4
  s_add_u32 s27, s26, 5373952
  s_add_u32 s26, s26, 5308416
  s_mov_b32 s67, 0
  v_mov_b32 v7, 0
  v_xor_b32 v6, 16384, v6
  v_and_b32 v200, 16384, v6
  v_add_u32 v200, v200, v0
o_w1_83:
  buffer_load_dwordx4 v[128:131], v7, s[4:7], s26 offen sc1
  buffer_load_dwordx4 v[132:135], v7, s[4:7], s27 offen sc1
  s_add_u32 s67, s67, 1
  s_cmp_gt_u32 s67, 1048576
  s_cbranch_scc1 L_end
  s_waitcnt vmcnt(0)
  v_min3_u32 v128, v128, v129, v130
  v_min3_u32 v128, v128, v131, v132
  v_min3_u32 v128, v128, v133, v134
  v_min_u32 v128, v128, v135
  v_cmp_eq_u32 vcc, 0, v128
  s_cbranch_vccnz o_w1_83
  s_lshl_b32 s26, s34, 13
  s_and_b32 s27, s17, 1
  s_lshl_b32 s27, s27, 10
  s_add_u32 s26, s26, s27
  s_add_u32 s26, s26, 83886080
  s_lshl_b32 s27, s34, 14
  s_add_u32 s27, s27, 16777216
  buffer_load_dwordx4 v[24:27], v0, s[4:7], s26 offen offset:0 sc1
  buffer_load_dwordx4 v[40:43], v0, s[4:7], s27 offen offset:0 sc1
  buffer_load_dwordx4 v[56:59], v0, s[4:7], s27 offen offset:1024 sc1
  buffer_load_dwordx4 v[88:91], v0, s[4:7], s27 offen offset:2048 sc1
  buffer_load_dwordx4 v[92:95], v0, s[4:7], s27 offen offset:3072 sc1
  s_add_u32 s27, s27, 4096
  buffer_load_dwordx4 v[28:31], v0, s[4:7], s26 offen offset:2048 sc1
  s_add_u32 s26, s26, 4096
  buffer_load_dwordx4 v[44:47], v0, s[4:7], s27 offen offset:0 sc1
  buffer_load_dwordx4 v[60:63], v0, s[4:7], s27 offen offset:1024 sc1
  buffer_load_dwordx4 v[96:99], v0, s[4:7], s27 offen offset:2048 sc1
  buffer_load_dwordx4 v[100:103], v0, s[4:7], s27 offen offset:3072 sc1
  s_add_u32 s27, s27, 4096
  buffer_load_dwordx4 v[32:35], v0, s[4:7], s26 offen offset:0 sc1
  buffer_load_dwordx4 v[48:51], v0, s[4:7], s27 offen offset:0 sc1
  buffer_load_dwordx4 v[64:67], v0, s[4:7], s27 offen offset:1024 sc1
  buffer_load_dwordx4 v[104:107], v0, s[4:7], s27 offen offset:2048 sc1
  buffer_load_dwordx4 v[108:111], v0, s[4:7], s27 offen offset:3072 sc1
  s_add_u32 s27, s27, 4096
  buffer_load_dwordx4 v[36:39], v0, s[4:7], s26 offen offset:2048 sc1
  buffer_load_dwordx4 v[52:55], v0, s[4:7], s27 offen offset:0 sc1
  buffer_load_dwordx4 v[68:71], v0, s[4:7], s27 offen offset:1024 sc1
  buffer_load_dwordx4 v[112:115], v0, s[4:7], s27 offen offset:2048 sc1
  buffer_load_dwordx4 v[116:119], v0, s[4:7], s27 offen offset:3072 sc1
  s_add_u32 s27, s27, 4096
  s_lshl_b32 s26, s35, 4
  s_lshl_b32 s27, s65, 15
  s_add_u32 s26, s26, s27
  s_add_u32 s26, s26, 5447680
o_w2_84:
  buffer_load_dwordx4 v[128:131], v7, s[4:7], s26 offen sc1
  s_add_u32 s67, s67, 1
  s_cmp_gt_u32 s67, 1048576
  s_cbranch_scc1 L_end
  s_waitcnt vmcnt(0)
  v_min3_u32 v128, v128, v129, v130
  v_min_u32 v128, v128, v131
  v_cmp_eq_u32 vcc, 0, v128
  s_cbranch_vccnz o_w2_84
  s_lshl_b32 s26, s35, 13
  s_add_u32 s26, s26, 117440512
  s_add_u32 s27, s26, 4096
  buffer_load_dwordx4 v[72:75], v0, s[4:7], s26 offen offset:0 sc1
  buffer_load_dwordx4 v[76:79], v0, s[4:7], s26 offen offset:2048 sc1
  buffer_load_dwordx4 v[80:83], v0, s[4:7], s27 offen offset:0 sc1
  buffer_load_dwordx4 v[84:87], v0, s[4:7], s27 offen offset:2048 sc1
  buffer_load_dwordx2 v[120:121], v1, s[4:7], s26 offen offset:1024 sc1
  buffer_load_dwordx2 v[122:123], v1, s[4:7], s26 offen offset:3072 sc1
  buffer_load_dwordx2 v[124:125], v1, s[4:7], s27 offen offset:1024 sc1
  buffer_load_dwordx2 v[126:127], v1, s[4:7], s27 offen offset:3072 sc1
  v_mfma_f32_16x16x32_bf16 v[128:131], v[40:43], v[24:27], 0
  v_mfma_f32_16x16x32_bf16 v[132:135], v[56:59], v[24:27], 0
  v_mfma_f32_16x16x32_bf16 v[128:131], v[44:47], v[28:31], v[128:131]
  v_mfma_f32_16x16x32_bf16 v[132:135], v[60:63], v[28:31], v[132:135]
  v_mfma_f32_16x16x32_bf16 v[128:131], v[48:51], v[32:35], v[128:131]
  v_mfma_f32_16x16x32_bf16 v[132:135], v[64:67], v[32:35], v[132:135]
  v_mfma_f32_16x16x32_bf16 v[128:131], v[52:55], v[36:39], v[128:131]
  v_mfma_f32_16x16x32_bf16 v[132:135], v[68:71], v[36:39], v[132:135]
  v_mov_b32 v144, 0
  v_mov_b32 v147, 0
  v_mov_b32 v7, 0xff000000
  v_cmp_le_i32 s[28:29], 0, v3
  s_nop 0
  s_nop 1
  v_cndmask_b32 v128, v7, v128, s[28:29]
  v_cmp_le_i32 s[30:31], 1, v3
  s_nop 1
  v_cndmask_b32 v129, v7, v129, s[30:31]
  v_cmp_le_i32 s[28:29], 2, v3
  s_nop 1
  v_cndmask_b32 v130, v7, v130, s[28:29]
  v_cmp_le_i32 s[30:31], 3, v3
  s_nop 1
  v_cndmask_b32 v131, v7, v131, s[30:31]
  v_cmp_le_i32 s[28:29], 16, v3
  s_nop 1
  v_cndmask_b32 v132, v7, v132, s[28:29]
  v_cmp_le_i32 s[30:31], 17, v3
  s_nop 1
  v_cndmask_b32 v133, v7, v133, s[30:31]
  v_cmp_le_i32 s[28:29], 18, v3
  s_nop 1
  v_cndmask_b32 v134, v7, v134, s[28:29]
  v_cmp_le_i32 s[30:31], 19, v3
  s_nop 1
  v_cndmask_b32 v135, v7, v135, s[30:31]
  v_max3_f32 v140, v128, v129, v130
  v_max3_f32 v140, v131, v132, v140
  v_max3_f32 v140, v133, v134, v140
  s_waitcnt vmcnt(7)
  v_mfma_f32_16x16x32_bf16 v[136:139], v[72:75], v[24:27], 0
  s_waitcnt vmcnt(6)
  v_mfma_f32_16x16x32_bf16 v[136:139], v[76:79], v[28:31], v[136:139]
  s_waitcnt vmcnt(5)
  v_mfma_f32_16x16x32_bf16 v[136:139], v[80:83], v[32:35], v[136:139]
  s_waitcnt vmcnt(4)
  v_mfma_f32_16x16x32_bf16 v[136:139], v[84:87], v[36:39], v[136:139]
  s_nop 1
  s_nop 1
  s_nop 1
  s_nop 1
  v_mul_f32 v136, s24, v136
  v_mul_f32 v137, s24, v137
  v_max_f32 v140, v135, v140
  v_max3_f32 v140, v136, v137, v140
  v_mov_b32 v141, v140
  s_nop 0
  s_nop 0
  v_permlane16_swap_b32 v140, v141
  v_max_f32 v140, v140, v141
  v_mov_b32 v141, v140
  s_nop 0
  s_nop 0
  v_permlane32_swap_b32 v140, v141
  v_max_f32 v140, v140, v141
  v_sub_f32 v128, v128, v140
  v_sub_f32 v129, v129, v140
  v_sub_f32 v130, v130, v140
  v_sub_f32 v131, v131, v140
  v_sub_f32 v132, v132, v140
  v_sub_f32 v133, v133, v140
  v_sub_f32 v134, v134, v140
  v_sub_f32 v135, v135, v140
  v_sub_f32 v136, v136, v140
  v_sub_f32 v137, v137, v140
  v_exp_f32 v128, v128
  v_exp_f32 v129, v129
  v_exp_f32 v130, v130
  v_exp_f32 v131, v131
  v_exp_f32 v132, v132
  v_exp_f32 v133, v133
  v_exp_f32 v134, v134
  v_exp_f32 v135, v135
  v_exp_f32 v136, v136
  v_exp_f32 v137, v137
  v_add_f32 v140, v128, v129
  v_add_f32 v141, v130, v131
  v_add_f32 v140, v140, v132
  v_add_f32 v141, v141, v133
  v_add_f32 v140, v140, v134
  v_add_f32 v141, v141, v135
  v_add_f32 v140, v140, v136
  v_add_f32 v141, v141, v137
  v_add_f32 v140, v140, v141
  v_mov_b32 v141, v140
  s_nop 0
  s_nop 0
  v_permlane16_swap_b32 v140, v141
  v_add_f32 v140, v140, v141
  v_mov_b32 v141, v140
  s_nop 0
  s_nop 0
  v_permlane32_swap_b32 v140, v141
  v_add_f32 v140, v140, v141
  v_rcp_f32 v140, v140
  s_nop 0
  v_mul_f32 v128, v128, v140
  v_mul_f32 v129, v129, v140
  v_mul_f32 v130, v130, v140
  v_mul_f32 v131, v131, v140
  v_mul_f32 v132, v132, v140
  v_mul_f32 v133, v133, v140
  v_mul_f32 v134, v134, v140
  v_mul_f32 v135, v135, v140
  v_mul_f32 v136, v136, v140
  v_mul_f32 v137, v137, v140
  v_cvt_pk_bf16_f32 v140, v128, v129
  v_cvt_pk_bf16_f32 v141, v130, v131
  v_cvt_pk_bf16_f32 v142, v132, v133
  v_cvt_pk_bf16_f32 v143, v134, v135
  v_cvt_pk_bf16_f32 v145, v136, v137
  v_cvt_pk_bf16_f32 v146, v136, v137
  v_mfma_f32_16x16x32_bf16 v[148:151], v[88:91], v[140:143], 0
  v_mfma_f32_16x16x32_bf16 v[152:155], v[92:95], v[140:143], 0
  v_mfma_f32_16x16x32_bf16 v[156:159], v[96:99], v[140:143], 0
  v_mfma_f32_16x16x32_bf16 v[160:163], v[100:103], v[140:143], 0
  v_mfma_f32_16x16x32_bf16 v[164:167], v[104:107], v[140:143], 0
  v_mfma_f32_16x16x32_bf16 v[168:171], v[108:111], v[140:143], 0
  v_mfma_f32_16x16x32_bf16 v[172:175], v[112:115], v[140:143], 0
  v_mfma_f32_16x16x32_bf16 v[176:179], v[116:119], v[140:143], 0
  s_waitcnt vmcnt(0)
  v_mfma_f32_16x16x16_bf16 v[148:151], v[120:121], v[146:147], v[148:151]
  v_mfma_f32_16x16x16_bf16 v[152:155], v[120:121], v[144:145], v[152:155]
  v_mfma_f32_16x16x16_bf16 v[156:159], v[122:123], v[146:147], v[156:159]
  v_mfma_f32_16x16x16_bf16 v[160:163], v[122:123], v[144:145], v[160:163]
  v_mfma_f32_16x16x16_bf16 v[164:167], v[124:125], v[146:147], v[164:167]
  v_mfma_f32_16x16x16_bf16 v[168:171], v[124:125], v[144:145], v[168:171]
  v_mfma_f32_16x16x16_bf16 v[172:175], v[126:127], v[146:147], v[172:175]
  v_mfma_f32_16x16x16_bf16 v[176:179], v[126:127], v[144:145], v[176:179]
  s_nop 0
  v_cvt_pk_bf16_f32 v180, v148, v149
  v_cvt_pk_bf16_f32 v181, v150, v151
  v_cvt_pk_bf16_f32 v182, v152, v153
  v_cvt_pk_bf16_f32 v183, v154, v155
  ds_write_b128 v6, v[180:183] offset:0
  v_cvt_pk_bf16_f32 v184, v156, v157
  v_cvt_pk_bf16_f32 v185, v158, v159
  v_cvt_pk_bf16_f32 v186, v160, v161
  v_cvt_pk_bf16_f32 v187, v162, v163
  ds_write_b128 v6, v[184:187] offset:1024
  v_cvt_pk_bf16_f32 v188, v164, v165
  v_cvt_pk_bf16_f32 v189, v166, v167
  v_cvt_pk_bf16_f32 v190, v168, v169
  v_cvt_pk_bf16_f32 v191, v170, v171
  ds_write_b128 v6, v[188:191] offset:2048
  v_cvt_pk_bf16_f32 v192, v172, v173
  v_cvt_pk_bf16_f32 v193, v174, v175
  v_cvt_pk_bf16_f32 v194, v176, v177
  v_cvt_pk_bf16_f32 v195, v178, v179
  ds_write_b128 v6, v[192:195] offset:3072
  s_waitcnt lgkmcnt(0)
  s_barrier
  ds_read_b128 v[88:91], v200 offset:0
  ds_read_b128 v[92:95], v200 offset:1024
  ds_read_b128 v[96:99], v200 offset:2048
  ds_read_b128 v[100:103], v200 offset:3072
  s_and_b32 s76, s62, 1
  s_lshl_b32 s76, s76, 19
  s_lshl_b32 s26, s60, 20
  s_add_u32 s76, s76, s26
  s_add_u32 s76, s76, 12582912
  s_waitcnt lgkmcnt(3)
  v_mfma_f32_16x16x32_bf16 v[24:27], v[88:91], a[0:3], 0
  ds_read_b128 v[104:107], v200 offset:8192
  v_mfma_f32_16x16x32_bf16 v[28:31], v[88:91], a[4:7], 0
  v_mfma_f32_16x16x32_bf16 v[32:35], v[88:91], a[8:11], 0
  v_mfma_f32_16x16x32_bf16 v[36:39], v[88:91], a[12:15], 0
  v_mfma_f32_16x16x32_bf16 v[40:43], v[88:91], a[16:19], 0
  v_mfma_f32_16x16x32_bf16 v[44:47], v[88:91], a[20:23], 0
  v_mfma_f32_16x16x32_bf16 v[48:51], v[88:91], a[24:27], 0
  v_mfma_f32_16x16x32_bf16 v[52:55], v[88:91], a[28:31], 0
  s_waitcnt lgkmcnt(3)
  v_mfma_f32_16x16x32_bf16 v[24:27], v[92:95], a[32:35], v[24:27]
  ds_read_b128 v[108:111], v200 offset:9216
  v_mfma_f32_16x16x32_bf16 v[28:31], v[92:95], a[36:39], v[28:31]
  v_mfma_f32_16x16x32_bf16 v[32:35], v[92:95], a[40:43], v[32:35]
  v_mfma_f32_16x16x32_bf16 v[36:39], v[92:95], a[44:47], v[36:39]
  v_mfma_f32_16x16x32_bf16 v[40:43], v[92:95], a[48:51], v[40:43]
  v_mfma_f32_16x16x32_bf16 v[44:47], v[92:95], a[52:55], v[44:47]
  v_mfma_f32_16x16x32_bf16 v[48:51], v[92:95], a[56:59], v[48:51]
  v_mfma_f32_16x16x32_bf16 v[52:55], v[92:95], a[60:63], v[52:55]
  s_waitcnt lgkmcnt(3)
  v_mfma_f32_16x16x32_bf16 v[24:27], v[96:99], a[64:67], v[24:27]
  ds_read_b128 v[112:115], v200 offset:10240
  v_mfma_f32_16x16x32_bf16 v[28:31], v[96:99], a[68:71], v[28:31]
  v_mfma_f32_16x16x32_bf16 v[32:35], v[96:99], a[72:75], v[32:35]
  v_mfma_f32_16x16x32_bf16 v[36:39], v[96:99], a[76:79], v[36:39]
  v_mfma_f32_16x16x32_bf16 v[40:43], v[96:99], a[80:83], v[40:43]
  v_mfma_f32_16x16x32_bf16 v[44:47], v[96:99], a[84:87], v[44:47]
  v_mfma_f32_16x16x32_bf16 v[48:51], v[96:99], a[88:91], v[48:51]
  v_mfma_f32_16x16x32_bf16 v[52:55], v[96:99], a[92:95], v[52:55]
  s_waitcnt lgkmcnt(3)
  v_mfma_f32_16x16x32_bf16 v[24:27], v[100:103], a[96:99], v[24:27]
  ds_read_b128 v[116:119], v200 offset:11264
  v_mfma_f32_16x16x32_bf16 v[28:31], v[100:103], a[100:103], v[28:31]
  v_mfma_f32_16x16x32_bf16 v[32:35], v[100:103], a[104:107], v[32:35]
  v_mfma_f32_16x16x32_bf16 v[36:39], v[100:103], a[108:111], v[36:39]
  v_mfma_f32_16x16x32_bf16 v[40:43], v[100:103], a[112:115], v[40:43]
  v_mfma_f32_16x16x32_bf16 v[44:47], v[100:103], a[116:119], v[44:47]
  v_mfma_f32_16x16x32_bf16 v[48:51], v[100:103], a[120:123], v[48:51]
  v_mfma_f32_16x16x32_bf16 v[52:55], v[100:103], a[124:127], v[52:55]
  s_waitcnt lgkmcnt(3)
  v_mfma_f32_16x16x32_bf16 v[24:27], v[104:107], a[128:131], v[24:27]
  ds_read_b128 v[88:91], v200 offset:4096
  v_mfma_f32_16x16x32_bf16 v[28:31], v[104:107], a[132:135], v[28:31]
  v_mfma_f32_16x16x32_bf16 v[32:35], v[104:107], a[136:139], v[32:35]
  v_mfma_f32_16x16x32_bf16 v[36:39], v[104:107], a[140:143], v[36:39]
  v_mfma_f32_16x16x32_bf16 v[40:43], v[104:107], a[144:147], v[40:43]
  v_mfma_f32_16x16x32_bf16 v[44:47], v[104:107], a[148:151], v[44:47]
  v_mfma_f32_16x16x32_bf16 v[48:51], v[104:107], a[152:155], v[48:51]
  v_mfma_f32_16x16x32_bf16 v[52:55], v[104:107], a[156:159], v[52:55]
  s_waitcnt lgkmcnt(3)
  v_mfma_f32_16x16x32_bf16 v[24:27], v[108:111], a[160:163], v[24:27]
  ds_read_b128 v[92:95], v200 offset:5120
  v_mfma_f32_16x16x32_bf16 v[28:31], v[108:111], a[164:167], v[28:31]
  v_mfma_f32_16x16x32_bf16 v[32:35], v[108:111], a[168:171], v[32:35]
  v_mfma_f32_16x16x32_bf16 v[36:39], v[108:111], a[172:175], v[36:39]
  v_mfma_f32_16x16x32_bf16 v[40:43], v[108:111], a[176:179], v[40:43]
  v_mfma_f32_16x16x32_bf16 v[44:47], v[108:111], a[180:183], v[44:47]
  v_mfma_f32_16x16x32_bf16 v[48:51], v[108:111], a[184:187], v[48:51]
  v_mfma_f32_16x16x32_bf16 v[52:55], v[108:111], a[188:191], v[52:55]
  s_waitcnt lgkmcnt(3)
  v_mfma_f32_16x16x32_bf16 v[24:27], v[112:115], a[192:195], v[24:27]
  ds_read_b128 v[96:99], v200 offset:6144
  v_mfma_f32_16x16x32_bf16 v[28:31], v[112:115], a[196:199], v[28:31]
  v_mfma_f32_16x16x32_bf16 v[32:35], v[112:115], a[200:203], v[32:35]
  v_mfma_f32_16x16x32_bf16 v[36:39], v[112:115], a[204:207], v[36:39]
  v_mfma_f32_16x16x32_bf16 v[40:43], v[112:115], a[208:211], v[40:43]
  v_mfma_f32_16x16x32_bf16 v[44:47], v[112:115], a[212:215], v[44:47]
  v_mfma_f32_16x16x32_bf16 v[48:51], v[112:115], a[216:219], v[48:51]
  v_mfma_f32_16x16x32_bf16 v[52:55], v[112:115], a[220:223], v[52:55]
  s_waitcnt lgkmcnt(3)
  v_mfma_f32_16x16x32_bf16 v[24:27], v[116:119], a[224:227], v[24:27]
  ds_read_b128 v[100:103], v200 offset:7168
  v_mfma_f32_16x16x32_bf16 v[28:31], v[116:119], a[228:231], v[28:31]
  v_mfma_f32_16x16x32_bf16 v[32:35], v[116:119], a[232:235], v[32:35]
  v_mfma_f32_16x16x32_bf16 v[36:39], v[116:119], a[236:239], v[36:39]
  v_mfma_f32_16x16x32_bf16 v[40:43], v[116:119], a[240:243], v[40:43]
  v_mfma_f32_16x16x32_bf16 v[44:47], v[116:119], a[244:247], v[44:47]
  v_mfma_f32_16x16x32_bf16 v[48:51], v[116:119], a[248:251], v[48:51]
  v_mfma_f32_16x16x32_bf16 v[52:55], v[116:119], a[252:255], v[52:55]
  s_waitcnt lgkmcnt(3)
  v_mfma_f32_16x16x32_bf16 v[56:59], v[88:91], a[0:3], 0
  ds_read_b128 v[104:107], v200 offset:12288
  v_mfma_f32_16x16x32_bf16 v[60:63], v[88:91], a[4:7], 0
  v_mfma_f32_16x16x32_bf16 v[64:67], v[88:91], a[8:11], 0
  v_mfma_f32_16x16x32_bf16 v[68:71], v[88:91], a[12:15], 0
  v_mfma_f32_16x16x32_bf16 v[72:75], v[88:91], a[16:19], 0
  v_mfma_f32_16x16x32_bf16 v[76:79], v[88:91], a[20:23], 0
  v_mfma_f32_16x16x32_bf16 v[80:83], v[88:91], a[24:27], 0
  v_mfma_f32_16x16x32_bf16 v[84:87], v[88:91], a[28:31], 0
  s_waitcnt lgkmcnt(3)
  v_mfma_f32_16x16x32_bf16 v[56:59], v[92:95], a[32:35], v[56:59]
  ds_read_b128 v[108:111], v200 offset:13312
  v_mfma_f32_16x16x32_bf16 v[60:63], v[92:95], a[36:39], v[60:63]
  v_cvt_pk_bf16_f32 v120, v24, v28
  v_mfma_f32_16x16x32_bf16 v[64:67], v[92:95], a[40:43], v[64:67]
  v_mfma_f32_16x16x32_bf16 v[68:71], v[92:95], a[44:47], v[68:71]
  v_cvt_pk_bf16_f32 v121, v32, v36
  v_mfma_f32_16x16x32_bf16 v[72:75], v[92:95], a[48:51], v[72:75]
  v_mfma_f32_16x16x32_bf16 v[76:79], v[92:95], a[52:55], v[76:79]
  v_cvt_pk_bf16_f32 v122, v40, v44
  v_mfma_f32_16x16x32_bf16 v[80:83], v[92:95], a[56:59], v[80:83]
  v_mfma_f32_16x16x32_bf16 v[84:87], v[92:95], a[60:63], v[84:87]
  v_cvt_pk_bf16_f32 v123, v48, v52
  s_waitcnt lgkmcnt(3)
  v_mfma_f32_16x16x32_bf16 v[56:59], v[96:99], a[64:67], v[56:59]
  ds_read_b128 v[112:115], v200 offset:14336
  v_mfma_f32_16x16x32_bf16 v[60:63], v[96:99], a[68:71], v[60:63]
  s_add_u32 s26, s76, 0
  buffer_store_dwordx4 v[120:123], v4, s[4:7], s26 offen sc1
  v_mfma_f32_16x16x32_bf16 v[64:67], v[96:99], a[72:75], v[64:67]
  v_mfma_f32_16x16x32_bf16 v[68:71], v[96:99], a[76:79], v[68:71]
  v_cvt_pk_bf16_f32 v124, v25, v29
  v_mfma_f32_16x16x32_bf16 v[72:75], v[96:99], a[80:83], v[72:75]
  v_mfma_f32_16x16x32_bf16 v[76:79], v[96:99], a[84:87], v[76:79]
  v_cvt_pk_bf16_f32 v125, v33, v37
  v_mfma_f32_16x16x32_bf16 v[80:83], v[96:99], a[88:91], v[80:83]
  v_mfma_f32_16x16x32_bf16 v[84:87], v[96:99], a[92:95], v[84:87]
  v_cvt_pk_bf16_f32 v126, v41, v45
  s_waitcnt lgkmcnt(3)
  v_mfma_f32_16x16x32_bf16 v[56:59], v[100:103], a[96:99], v[56:59]
  ds_read_b128 v[116:119], v200 offset:15360
  v_mfma_f32_16x16x32_bf16 v[60:63], v[100:103], a[100:103], v[60:63]
  v_cvt_pk_bf16_f32 v127, v49, v53
  v_mfma_f32_16x16x32_bf16 v[64:67], v[100:103], a[104:107], v[64:67]
  v_mfma_f32_16x16x32_bf16 v[68:71], v[100:103], a[108:111], v[68:71]
  s_add_u32 s26, s76, 16384
  buffer_store_dwordx4 v[124:127], v4, s[4:7], s26 offen sc1
  v_mfma_f32_16x16x32_bf16 v[72:75], v[100:103], a[112:115], v[72:75]
  v_mfma_f32_16x16x32_bf16 v[76:79], v[100:103], a[116:119], v[76:79]
  v_cvt_pk_bf16_f32 v128, v26, v30
  v_mfma_f32_16x16x32_bf16 v[80:83], v[100:103], a[120:123], v[80:83]
  v_mfma_f32_16x16x32_bf16 v[84:87], v[100:103], a[124:127], v[84:87]
  v_cvt_pk_bf16_f32 v129, v34, v38
  s_waitcnt lgkmcnt(3)
  v_mfma_f32_16x16x32_bf16 v[56:59], v[104:107], a[128:131], v[56:59]
  v_mfma_f32_16x16x32_bf16 v[60:63], v[104:107], a[132:135], v[60:63]
  v_cvt_pk_bf16_f32 v130, v42, v46
  v_mfma_f32_16x16x32_bf16 v[64:67], v[104:107], a[136:139], v[64:67]
  v_mfma_f32_16x16x32_bf16 v[68:71], v[104:107], a[140:143], v[68:71]
  v_cvt_pk_bf16_f32 v131, v50, v54
  v_mfma_f32_16x16x32_bf16 v[72:75], v[104:107], a[144:147], v[72:75]
  v_mfma_f32_16x16x32_bf16 v[76:79], v[104:107], a[148:151], v[76:79]
  s_add_u32 s26, s76, 32768
  buffer_store_dwordx4 v[128:131], v4, s[4:7], s26 offen sc1
  v_mfma_f32_16x16x32_bf16 v[80:83], v[104:107], a[152:155], v[80:83]
  v_mfma_f32_16x16x32_bf16 v[84:87], v[104:107], a[156:159], v[84:87]
  v_cvt_pk_bf16_f32 v132, v27, v31
  s_waitcnt lgkmcnt(2)
  v_mfma_f32_16x16x32_bf16 v[56:59], v[108:111], a[160:163], v[56:59]
  v_mfma_f32_16x16x32_bf16 v[60:63], v[108:111], a[164:167], v[60:63]
  v_cvt_pk_bf16_f32 v133, v35, v39
  v_mfma_f32_16x16x32_bf16 v[64:67], v[108:111], a[168:171], v[64:67]
  v_mfma_f32_16x16x32_bf16 v[68:71], v[108:111], a[172:175], v[68:71]
  v_cvt_pk_bf16_f32 v134, v43, v47
  v_mfma_f32_16x16x32_bf16 v[72:75], v[108:111], a[176:179], v[72:75]
  v_mfma_f32_16x16x32_bf16 v[76:79], v[108:111], a[180:183], v[76:79]
  v_cvt_pk_bf16_f32 v135, v51, v55
  v_mfma_f32_16x16x32_bf16 v[80:83], v[108:111], a[184:187], v[80:83]
  v_mfma_f32_16x16x32_bf16 v[84:87], v[108:111], a[188:191], v[84:87]
  s_add_u32 s26, s76, 49152
  buffer_store_dwordx4 v[132:135], v4, s[4:7], s26 offen sc1
  s_waitcnt lgkmcnt(1)
  v_mfma_f32_16x16x32_bf16 v[56:59], v[112:115], a[192:195], v[56:59]
  v_mfma_f32_16x16x32_bf16 v[60:63], v[112:115], a[196:199], v[60:63]
  v_mfma_f32_16x16x32_bf16 v[64:67], v[112:115], a[200:203], v[64:67]
  v_mfma_f32_16x16x32_bf16 v[68:71], v[112:115], a[204:207], v[68:71]
  v_mfma_f32_16x16x32_bf16 v[72:75], v[112:115], a[208:211], v[72:75]
  v_mfma_f32_16x16x32_bf16 v[76:79], v[112:115], a[212:215], v[76:79]
  v_mfma_f32_16x16x32_bf16 v[80:83], v[112:115], a[216:219], v[80:83]
  v_mfma_f32_16x16x32_bf16 v[84:87], v[112:115], a[220:223], v[84:87]
  s_waitcnt lgkmcnt(0)
  v_mfma_f32_16x16x32_bf16 v[56:59], v[116:119], a[224:227], v[56:59]
  v_mfma_f32_16x16x32_bf16 v[60:63], v[116:119], a[228:231], v[60:63]
  v_mfma_f32_16x16x32_bf16 v[64:67], v[116:119], a[232:235], v[64:67]
  v_mfma_f32_16x16x32_bf16 v[68:71], v[116:119], a[236:239], v[68:71]
  v_mfma_f32_16x16x32_bf16 v[72:75], v[116:119], a[240:243], v[72:75]
  v_mfma_f32_16x16x32_bf16 v[76:79], v[116:119], a[244:247], v[76:79]
  v_mfma_f32_16x16x32_bf16 v[80:83], v[116:119], a[248:251], v[80:83]
  v_mfma_f32_16x16x32_bf16 v[84:87], v[116:119], a[252:255], v[84:87]
  s_nop 0
  s_nop 0
  v_cvt_pk_bf16_f32 v136, v56, v60
  s_nop 0
  v_cvt_pk_bf16_f32 v137, v64, v68
  s_nop 0
  v_cvt_pk_bf16_f32 v138, v72, v76
  s_nop 0
  v_cvt_pk_bf16_f32 v139, v80, v84
  s_add_u32 s26, s76, 262144
  buffer_store_dwordx4 v[136:139], v4, s[4:7], s26 offen sc1
  v_cvt_pk_bf16_f32 v140, v57, v61
  v_cvt_pk_bf16_f32 v141, v65, v69
  v_cvt_pk_bf16_f32 v142, v73, v77
  v_cvt_pk_bf16_f32 v143, v81, v85
  s_add_u32 s26, s76, 278528
  buffer_store_dwordx4 v[140:143], v4, s[4:7], s26 offen sc1
  v_cvt_pk_bf16_f32 v144, v58, v62
  v_cvt_pk_bf16_f32 v145, v66, v70
  v_cvt_pk_bf16_f32 v146, v74, v78
  v_cvt_pk_bf16_f32 v147, v82, v86
  s_add_u32 s26, s76, 294912
  buffer_store_dwordx4 v[144:147], v4, s[4:7], s26 offen sc1
  v_cvt_pk_bf16_f32 v148, v59, v63
  v_cvt_pk_bf16_f32 v149, v67, v71
  v_cvt_pk_bf16_f32 v150, v75, v79
  v_cvt_pk_bf16_f32 v151, v83, v87
  s_add_u32 s26, s76, 311296
  buffer_store_dwordx4 v[148:151], v4, s[4:7], s26 offen sc1
  s_lshl_b32 s26, s60, 10
  s_add_u32 s26, s26, 5275648
  s_lshl_b32 s27, s61, 4
  s_lshl_b32 s28, s17, 2
  s_add_u32 s27, s27, s28
  v_mov_b32 v24, s62
  v_mov_b32 v25, s27
  s_waitcnt vmcnt(0)
  s_mov_b64 exec, 1
  buffer_store_dword v24, v25, s[4:7], s26 offen sc1
  s_mov_b64 exec, -1
  s_cmp_ge_u32 s17, 2
  s_cbranch_scc1 o_done_85
  s_lshl_b32 s77, s61, 1
  s_add_u32 s77, s77, s17
  s_lshl_b32 s29, s77, 14
  s_add_u32 s76, s76, s29
  s_lshl_b32 s29, s63, 5
  s_add_u32 s77, s77, s29
  s_lshl_b32 s29, s77, 10
  s_cmp_lg_u32 s64, 0
  s_cbranch_scc1 o_l2_87
  buffer_load_dwordx4 v[96:99], v0, s[72:75], s29 offen
  s_branch o_join_88
o_l2_87:
  s_add_u32 s30, s29, 10485760
  buffer_load_dwordx4 v[96:99], v0, s[4:7], s30 offen sc1
o_join_88:
  s_mov_b32 s67, 0
o_w3_86:
  buffer_load_dword v24, v2, s[4:7], s26 offen sc1
  s_add_u32 s67, s67, 1
  s_cmp_gt_u32 s67, 1048576
  s_cbranch_scc1 L_end
  s_waitcnt vmcnt(0)
  v_cmp_gt_u32 vcc, s62, v24
  s_cbranch_vccnz o_w3_86
  buffer_load_dwordx4 v[24:27], v5, s[4:7], s76 offen offset:0 sc1
  buffer_load_dwordx4 v[28:31], v5, s[4:7], s76 offen offset:256 sc1
  buffer_load_dwordx4 v[32:35], v5, s[4:7], s76 offen offset:512 sc1
  buffer_load_dwordx4 v[36:39], v5, s[4:7], s76 offen offset:768 sc1
  s_add_u32 s76, s76, 4096
  buffer_load_dwordx4 v[40:43], v5, s[4:7], s76 offen offset:0 sc1
  buffer_load_dwordx4 v[44:47], v5, s[4:7], s76 offen offset:256 sc1
  buffer_load_dwordx4 v[48:51], v5, s[4:7], s76 offen offset:512 sc1
  buffer_load_dwordx4 v[52:55], v5, s[4:7], s76 offen offset:768 sc1
  s_add_u32 s76, s76, 4096
  buffer_load_dwordx4 v[56:59], v5, s[4:7], s76 offen offset:0 sc1
  buffer_load_dwordx4 v[60:63], v5, s[4:7], s76 offen offset:256 sc1
  buffer_load_dwordx4 v[64:67], v5, s[4:7], s76 offen offset:512 sc1
  buffer_load_dwordx4 v[68:71], v5, s[4:7], s76 offen offset:768 sc1
  s_add_u32 s76, s76, 4096
  buffer_load_dwordx4 v[72:75], v5, s[4:7], s76 offen offset:0 sc1
  buffer_load_dwordx4 v[76:79], v5, s[4:7], s76 offen offset:256 sc1
  buffer_load_dwordx4 v[80:83], v5, s[4:7], s76 offen offset:512 sc1
  buffer_load_dwordx4 v[84:87], v5, s[4:7], s76 offen offset:768 sc1
  s_add_u32 s76, s76, 4096
  v_lshlrev_b32 v108, 16, v96
  v_and_b32 v109, 0xffff0000, v96
  v_lshlrev_b32 v110, 16, v97
  v_and_b32 v111, 0xffff0000, v97
  v_lshlrev_b32 v112, 16, v98
  v_and_b32 v113, 0xffff0000, v98
  v_lshlrev_b32 v114, 16, v99
  v_and_b32 v115, 0xffff0000, v99
  s_waitcnt vmcnt(15)
  v_mfma_f32_16x16x32_bf16 v[100:103], v[16:19], v[24:27], 0
  s_waitcnt vmcnt(14)
  v_mfma_f32_16x16x32_bf16 v[104:107], v[16:19], v[28:31], 0
  s_waitcnt vmcnt(13)
  v_mfma_f32_16x16x32_bf16 v[100:103], v[20:23], v[32:35], v[100:103]
  s_waitcnt vmcnt(12)
  v_mfma_f32_16x16x32_bf16 v[104:107], v[20:23], v[36:39], v[104:107]
  s_waitcnt vmcnt(11)
  v_mfma_f32_16x16x32_bf16 v[100:103], v[16:19], v[40:43], v[100:103]
  s_waitcnt vmcnt(10)
  v_mfma_f32_16x16x32_bf16 v[104:107], v[16:19], v[44:47], v[104:107]
  s_waitcnt vmcnt(9)
  v_mfma_f32_16x16x32_bf16 v[100:103], v[20:23], v[48:51], v[100:103]
  s_waitcnt vmcnt(8)
  v_mfma_f32_16x16x32_bf16 v[104:107], v[20:23], v[52:55], v[104:107]
  s_waitcnt vmcnt(7)
  v_mfma_f32_16x16x32_bf16 v[100:103], v[16:19], v[56:59], v[100:103]
  s_waitcnt vmcnt(6)
  v_mfma_f32_16x16x32_bf16 v[104:107], v[16:19], v[60:63], v[104:107]
  s_waitcnt vmcnt(5)
  v_mfma_f32_16x16x32_bf16 v[100:103], v[20:23], v[64:67], v[100:103]
  s_waitcnt vmcnt(4)
  v_mfma_f32_16x16x32_bf16 v[104:107], v[20:23], v[68:71], v[104:107]
  s_waitcnt vmcnt(3)
  v_mfma_f32_16x16x32_bf16 v[100:103], v[16:19], v[72:75], v[100:103]
  s_waitcnt vmcnt(2)
  v_mfma_f32_16x16x32_bf16 v[104:107], v[16:19], v[76:79], v[104:107]
  s_waitcnt vmcnt(1)
  v_mfma_f32_16x16x32_bf16 v[100:103], v[20:23], v[80:83], v[100:103]
  s_waitcnt vmcnt(0)
  v_mfma_f32_16x16x32_bf16 v[104:107], v[20:23], v[84:87], v[104:107]
  s_nop 1
  s_nop 1
  s_nop 1
  s_nop 1
  v_permlane16_swap_b32 v100, v104
  v_permlane16_swap_b32 v101, v105
  v_permlane16_swap_b32 v102, v106
  v_permlane16_swap_b32 v103, v107
  v_cvt_pk_bf16_f32 v124, v100, v101
  v_cvt_pk_bf16_f32 v125, v102, v103
  v_cvt_pk_bf16_f32 v126, v104, v105
  v_cvt_pk_bf16_f32 v127, v106, v107
  v_lshlrev_b32 v100, 16, v124
  v_and_b32 v101, 0xffff0000, v124
  v_lshlrev_b32 v102, 16, v125
  v_and_b32 v103, 0xffff0000, v125
  v_lshlrev_b32 v104, 16, v126
  v_and_b32 v105, 0xffff0000, v126
  v_lshlrev_b32 v106, 16, v127
  v_and_b32 v107, 0xffff0000, v127
  v_add_f32 v108, v108, v100
  v_add_f32 v109, v109, v101
  v_add_f32 v110, v110, v102
  v_add_f32 v111, v111, v103
  v_add_f32 v112, v112, v104
  v_add_f32 v113, v113, v105
  v_add_f32 v114, v114, v106
  v_add_f32 v115, v115, v107
  v_cvt_pk_bf16_f32 v124, v108, v109
  v_cvt_pk_bf16_f32 v125, v110, v111
  v_cvt_pk_bf16_f32 v126, v112, v113
  v_cvt_pk_bf16_f32 v127, v114, v115
  v_lshlrev_b32 v108, 16, v124
  v_and_b32 v109, 0xffff0000, v124
  v_lshlrev_b32 v110, 16, v125
  v_and_b32 v111, 0xffff0000, v125
  v_lshlrev_b32 v112, 16, v126
  v_and_b32 v113, 0xffff0000, v126
  v_lshlrev_b32 v114, 16, v127
  v_and_b32 v115, 0xffff0000, v127
  s_lshl_b32 s30, s66, 21
  s_add_u32 s30, s30, s29
  s_add_u32 s31, s30, 167772160
  s_add_u32 s30, s30, 176160768
  buffer_store_dwordx4 v[124:127], v0, s[4:7], s31 offen sc1
  v_add_f32 v132, v108, v109
  v_add_f32 v133, v110, v111
  v_add_f32 v134, v112, v113
  v_add_f32 v135, v114, v115
  v_add_f32 v132, v132, v133
  v_add_f32 v134, v134, v135
  v_add_f32 v132, v132, v134
  s_nop 1
  v_add_f32_dpp v132, v132, v132 row_ror:8 row_mask:0xf bank_mask:0xf
  s_nop 1
  v_add_f32_dpp v132, v132, v132 row_ror:4 row_mask:0xf bank_mask:0xf
  s_nop 1
  v_add_f32_dpp v132, v132, v132 row_ror:2 row_mask:0xf bank_mask:0xf
  s_nop 1
  v_add_f32_dpp v132, v132, v132 row_ror:1 row_mask:0xf bank_mask:0xf
  v_mov_b32 v134, v132
  s_nop 0
  s_nop 0
  v_permlane16_swap_b32 v132, v134
  v_add_f32 v132, v132, v134
  v_mov_b32 v134, v132
  s_nop 0
  s_nop 0
  v_permlane32_swap_b32 v132, v134
  v_add_f32 v132, v132, v134
  v_mul_f32 v132, 0x3b000000, v132
  v_sub_f32 v136, v108, v132
  v_sub_f32 v137, v109, v132
  v_sub_f32 v138, v110, v132
  v_sub_f32 v139, v111, v132
  v_sub_f32 v140, v112, v132
  v_sub_f32 v141, v113, v132
  v_sub_f32 v142, v114, v132
  v_sub_f32 v143, v115, v132
  v_mul_f32 v133, v136, v136
  v_mul_f32 v134, v137, v137
  v_fmac_f32 v133, v138, v138
  v_fmac_f32 v134, v139, v139
  v_fmac_f32 v133, v140, v140
  v_fmac_f32 v134, v141, v141
  v_fmac_f32 v133, v142, v142
  v_fmac_f32 v134, v143, v143
  v_add_f32 v133, v133, v134
  v_cvt_pk_bf16_f32 v132, v132, v132
  v_and_b32 v132, 0xffff0000, v132
  v_add_f32_dpp v133, v133, v133 row_ror:8 row_mask:0xf bank_mask:0xf
  s_nop 1
  v_add_f32_dpp v133, v133, v133 row_ror:4 row_mask:0xf bank_mask:0xf
  s_nop 1
  v_add_f32_dpp v133, v133, v133 row_ror:2 row_mask:0xf bank_mask:0xf
  s_nop 1
  v_add_f32_dpp v133, v133, v133 row_ror:1 row_mask:0xf bank_mask:0xf
  v_mov_b32 v134, v133
  s_nop 0
  s_nop 0
  v_permlane16_swap_b32 v133, v134
  v_add_f32 v133, v133, v134
  v_mov_b32 v134, v133
  s_nop 0
  s_nop 0
  v_permlane32_swap_b32 v133, v134
  v_add_f32 v133, v133, v134
  v_sub_f32 v136, v108, v132
  v_sub_f32 v137, v109, v132
  v_sub_f32 v138, v110, v132
  v_sub_f32 v139, v111, v132
  v_sub_f32 v140, v112, v132
  v_sub_f32 v141, v113, v132
  v_sub_f32 v142, v114, v132
  v_sub_f32 v143, v115, v132
  v_mul_f32 v133, 0x3b000000, v133
  v_cvt_pk_bf16_f32 v133, v133, v133
  v_and_b32 v133, 0xffff0000, v133
  v_add_f32 v133, 0x3727c5ac, v133
  v_cvt_pk_bf16_f32 v133, v133, v133
  v_and_b32 v133, 0xffff0000, v133
  v_sqrt_f32 v133, v133
  v_cvt_pk_bf16_f32 v128, v136, v137
  v_cvt_pk_bf16_f32 v129, v138, v139
  v_cvt_pk_bf16_f32 v130, v140, v141
  v_cvt_pk_bf16_f32 v131, v142, v143
  v_cvt_pk_bf16_f32 v133, v133, v133
  v_and_b32 v133, 0xffff0000, v133
  v_rcp_f32 v133, v133
  v_lshlrev_b32 v136, 16, v128
  v_and_b32 v137, 0xffff0000, v128
  v_lshlrev_b32 v138, 16, v129
  v_and_b32 v139, 0xffff0000, v129
  v_lshlrev_b32 v140, 16, v130
  v_and_b32 v141, 0xffff0000, v130
  v_lshlrev_b32 v142, 16, v131
  v_and_b32 v143, 0xffff0000, v131
  v_mul_f32 v136, v136, v133
  v_mul_f32 v137, v137, v133
  v_mul_f32 v138, v138, v133
  v_mul_f32 v139, v139, v133
  v_mul_f32 v140, v140, v133
  v_mul_f32 v141, v141, v133
  v_mul_f32 v142, v142, v133
  v_mul_f32 v143, v143, v133
  v_cvt_pk_bf16_f32 v128, v136, v137
  v_cvt_pk_bf16_f32 v129, v138, v139
  v_cvt_pk_bf16_f32 v130, v140, v141
  v_cvt_pk_bf16_f32 v131, v142, v143
  v_lshlrev_b32 v116, 16, v128
  v_and_b32 v117, 0xffff0000, v128
  v_lshlrev_b32 v118, 16, v129
  v_and_b32 v119, 0xffff0000, v129
  v_lshlrev_b32 v120, 16, v130
  v_and_b32 v121, 0xffff0000, v130
  v_lshlrev_b32 v122, 16, v131
  v_and_b32 v123, 0xffff0000, v131
  buffer_store_dwordx4 v[128:131], v0, s[4:7], s30 offen sc1
  v_mul_f32 v100, v116, v8
  v_mul_f32 v101, v117, v9
  v_fmac_f32 v100, v118, v10
  v_fmac_f32 v101, v119, v11
  v_fmac_f32 v100, v120, v12
  v_fmac_f32 v101, v121, v13
  v_fmac_f32 v100, v122, v14
  v_fmac_f32 v101, v123, v15
  v_add_f32 v100, v100, v101
  v_add_f32 v108, v108, v116
  v_add_f32 v109, v109, v117
  v_add_f32 v110, v110, v118
  v_add_f32 v111, v111, v119
  v_add_f32 v112, v112, v120
  v_add_f32 v113, v113, v121
  v_add_f32 v114, v114, v122
  v_add_f32 v115, v115, v123
  v_cvt_pk_bf16_f32 v96, v108, v109
  v_cvt_pk_bf16_f32 v97, v110, v111
  v_cvt_pk_bf16_f32 v98, v112, v113
  v_cvt_pk_bf16_f32 v99, v114, v115
  s_cmp_lg_u32 s66, 0
  s_cbranch_scc1 o_k1_89
  s_add_u32 s30, s29, 10485760
  buffer_store_dwordx4 v[96:99], v0, s[4:7], s30 offen sc1
  v_lshlrev_b32 v108, 16, v96
  v_and_b32 v109, 0xffff0000, v96
  v_lshlrev_b32 v110, 16, v97
  v_and_b32 v111, 0xffff0000, v97
  v_lshlrev_b32 v112, 16, v98
  v_and_b32 v113, 0xffff0000, v98
  v_lshlrev_b32 v114, 16, v99
  v_and_b32 v115, 0xffff0000, v99
  v_add_f32 v132, v108, v109
  v_add_f32 v133, v110, v111
  v_add_f32 v134, v112, v113
  v_add_f32 v135, v114, v115
  v_add_f32 v132, v132, v133
  v_add_f32 v134, v134, v135
  v_add_f32 v132, v132, v134
  s_nop 1
  v_add_f32_dpp v132, v132, v132 row_ror:8 row_mask:0xf bank_mask:0xf
  v_add_f32_dpp v100, v100, v100 row_ror:8 row_mask:0xf bank_mask:0xf
  s_nop 0
  v_add_f32_dpp v132, v132, v132 row_ror:4 row_mask:0xf bank_mask:0xf
  v_add_f32_dpp v100, v100, v100 row_ror:4 row_mask:0xf bank_mask:0xf
  s_nop 0
  v_add_f32_dpp v132, v132, v132 row_ror:2 row_mask:0xf bank_mask:0xf
  v_add_f32_dpp v100, v100, v100 row_ror:2 row_mask:0xf bank_mask:0xf
  s_nop 0
  v_add_f32_dpp v132, v132, v132 row_ror:1 row_mask:0xf bank_mask:0xf
  v_add_f32_dpp v100, v100, v100 row_ror:1 row_mask:0xf bank_mask:0xf
  v_mov_b32 v134, v132
  v_mov_b32 v135, v100
  s_nop 0
  v_permlane16_swap_b32 v132, v134
  v_permlane16_swap_b32 v100, v135
  v_add_f32 v132, v132, v134
  v_add_f32 v100, v100, v135
  v_mov_b32 v134, v132
  v_mov_b32 v135, v100
  s_nop 0
  v_permlane32_swap_b32 v132, v134
  v_permlane32_swap_b32 v100, v135
  v_add_f32 v132, v132, v134
  v_add_f32 v100, v100, v135
  v_mul_f32 v132, 0x3b000000, v132
  v_sub_f32 v136, v108, v132
  v_sub_f32 v137, v109, v132
  v_sub_f32 v138, v110, v132
  v_sub_f32 v139, v111, v132
  v_sub_f32 v140, v112, v132
  v_sub_f32 v141, v113, v132
  v_sub_f32 v142, v114, v132
  v_sub_f32 v143, v115, v132
  v_mul_f32 v133, v136, v136
  v_mul_f32 v134, v137, v137
  v_fmac_f32 v133, v138, v138
  v_fmac_f32 v134, v139, v139
  v_fmac_f32 v133, v140, v140
  v_fmac_f32 v134, v141, v141
  v_fmac_f32 v133, v142, v142
  v_fmac_f32 v134, v143, v143
  v_add_f32 v133, v133, v134
  v_cvt_pk_bf16_f32 v132, v132, v132
  v_and_b32 v132, 0xffff0000, v132
  v_add_f32_dpp v133, v133, v133 row_ror:8 row_mask:0xf bank_mask:0xf
  s_nop 1
  v_add_f32_dpp v133, v133, v133 row_ror:4 row_mask:0xf bank_mask:0xf
  s_nop 1
  v_add_f32_dpp v133, v133, v133 row_ror:2 row_mask:0xf bank_mask:0xf
  s_nop 1
  v_add_f32_dpp v133, v133, v133 row_ror:1 row_mask:0xf bank_mask:0xf
  v_mov_b32 v134, v133
  s_nop 0
  s_nop 0
  v_permlane16_swap_b32 v133, v134
  v_add_f32 v133, v133, v134
  v_mov_b32 v134, v133
  s_nop 0
  s_nop 0
  v_permlane32_swap_b32 v133, v134
  v_add_f32 v133, v133, v134
  v_sub_f32 v136, v108, v132
  v_sub_f32 v137, v109, v132
  v_sub_f32 v138, v110, v132
  v_sub_f32 v139, v111, v132
  v_sub_f32 v140, v112, v132
  v_sub_f32 v141, v113, v132
  v_sub_f32 v142, v114, v132
  v_sub_f32 v143, v115, v132
  v_mul_f32 v133, 0x3b000000, v133
  v_cvt_pk_bf16_f32 v133, v133, v133
  v_and_b32 v133, 0xffff0000, v133
  v_add_f32 v133, 0x3727c5ac, v133
  v_cvt_pk_bf16_f32 v133, v133, v133
  v_and_b32 v133, 0xffff0000, v133
  v_sqrt_f32 v133, v133
  v_cvt_pk_bf16_f32 v124, v136, v137
  v_cvt_pk_bf16_f32 v125, v138, v139
  v_cvt_pk_bf16_f32 v126, v140, v141
  v_cvt_pk_bf16_f32 v127, v142, v143
  v_cvt_pk_bf16_f32 v133, v133, v133
  v_and_b32 v133, 0xffff0000, v133
  v_rcp_f32 v133, v133
  v_lshlrev_b32 v136, 16, v124
  v_and_b32 v137, 0xffff0000, v124
  v_lshlrev_b32 v138, 16, v125
  v_and_b32 v139, 0xffff0000, v125
  v_lshlrev_b32 v140, 16, v126
  v_and_b32 v141, 0xffff0000, v126
  v_lshlrev_b32 v142, 16, v127
  v_and_b32 v143, 0xffff0000, v127
  v_mul_f32 v136, v136, v133
  v_mul_f32 v137, v137, v133
  v_mul_f32 v138, v138, v133
  v_mul_f32 v139, v139, v133
  v_mul_f32 v140, v140, v133
  v_mul_f32 v141, v141, v133
  v_mul_f32 v142, v142, v133
  v_mul_f32 v143, v143, v133
  v_cvt_pk_bf16_f32 v124, v136, v137
  v_cvt_pk_bf16_f32 v125, v138, v139
  v_cvt_pk_bf16_f32 v126, v140, v141
  v_cvt_pk_bf16_f32 v127, v142, v143
  s_add_u32 s30, s29, 8388608
  buffer_store_dwordx4 v[124:127], v0, s[4:7], s30 offen sc1
  s_branch o_key_91
o_k1_89:
  v_add_f32_dpp v100, v100, v100 row_ror:8 row_mask:0xf bank_mask:0xf
  s_nop 1
  v_add_f32_dpp v100, v100, v100 row_ror:4 row_mask:0xf bank_mask:0xf
  s_nop 1
  v_add_f32_dpp v100, v100, v100 row_ror:2 row_mask:0xf bank_mask:0xf
  s_nop 1
  v_add_f32_dpp v100, v100, v100 row_ror:1 row_mask:0xf bank_mask:0xf
  v_mov_b32 v101, v100
  s_nop 0
  s_nop 0
  v_permlane16_swap_b32 v100, v101
  v_add_f32 v100, v100, v101
  v_mov_b32 v101, v100
  s_nop 0
  s_nop 0
  v_permlane32_swap_b32 v100, v101
  v_add_f32 v100, v100, v101
  s_cmp_eq_u32 s66, 2
  s_cbranch_scc1 o_k2_90
  s_add_u32 s30, s29, 184549376
  buffer_store_dwordx4 v[96:99], v0, s[4:7], s30 offen sc1
  s_branch o_key_91
o_k2_90:
  buffer_store_dwordx4 v[96:99], v0, s[68:71], s29 offen sc1
o_key_91:
  v_cvt_pk_bf16_f32 v100, v100, v100
  v_and_b32 v100, 0xffff0000, v100
  v_ashrrev_i32 v101, 31, v100
  v_or_b32 v101, 0x80000000, v101
  v_xor_b32 v100, v100, v101
  v_and_b32 v100, 0xffff0000, v100
  s_sub_u32 s30, 4095, s77
  v_or_b32 v100, s30, v100
  s_add_u32 s30, s66, 1
  s_lshl_b32 s30, s30, 13
  s_lshl_b32 s31, s77, 2
  s_add_u32 s30, s30, s31
  s_add_u32 s30, s30, 5242880
  v_mov_b32 v101, 0
  s_waitcnt vmcnt(0)
  s_mov_b64 exec, 1
  buffer_store_dword v100, v101, s[4:7], s30 offen sc1
  s_mov_b64 exec, -1
o_done_85:
  s_add_u32 s63, s63, 4
  s_cmp_lt_u32 s63, 64
  s_cbranch_scc1 o_loop_80
  s_cmp_lg_u32 s60, 0
  s_cbranch_scc1 o_nomlp_81
  s_cmp_lg_u32 s64, 0
  s_cbranch_scc1 o_k2_92
  s_mov_b32 s67, 0
  s_mov_b32 s26, 5251072
  s_mov_b32 s27, 5255168
k_w_94:
  buffer_load_dwordx4 v[24:27], v0, s[4:7], s26 offen offset:0 sc1
  buffer_load_dwordx4 v[28:31], v0, s[4:7], s26 offen offset:1024 sc1
  buffer_load_dwordx4 v[32:35], v0, s[4:7], s26 offen offset:2048 sc1
  buffer_load_dwordx4 v[36:39], v0, s[4:7], s26 offen offset:3072 sc1
  buffer_load_dwordx4 v[40:43], v0, s[4:7], s27 offen offset:0 sc1
  buffer_load_dwordx4 v[44:47], v0, s[4:7], s27 offen offset:1024 sc1
  buffer_load_dwordx4 v[48:51], v0, s[4:7], s27 offen offset:2048 sc1
  buffer_load_dwordx4 v[52:55], v0, s[4:7], s27 offen offset:3072 sc1
  s_add_u32 s67, s67, 1
  s_cmp_gt_u32 s67, 1048576
  s_cbranch_scc1 L_end
  s_sleep 2
  s_waitcnt vmcnt(0)
  v_min_u32 v56, v24, v25
  v_max_u32 v57, v24, v25
  v_min3_u32 v56, v26, v27, v56
  v_max3_u32 v57, v26, v27, v57
  v_min3_u32 v56, v28, v29, v56
  v_max3_u32 v57, v28, v29, v57
  v_min3_u32 v56, v30, v31, v56
  v_max3_u32 v57, v30, v31, v57
  v_min3_u32 v56, v32, v33, v56
  v_max3_u32 v57, v32, v33, v57
  v_min3_u32 v56, v34, v35, v56
  v_max3_u32 v57, v34, v35, v57
  v_min3_u32 v56, v36, v37, v56
  v_max3_u32 v57, v36, v37, v57
  v_min3_u32 v56, v38, v39, v56
  v_max3_u32 v57, v38, v39, v57
  v_min3_u32 v56, v40, v41, v56
  v_max3_u32 v57, v40, v41, v57
  v_min3_u32 v56, v42, v43, v56
  v_max3_u32 v57, v42, v43, v57
  v_min3_u32 v56, v44, v45, v56
  v_max3_u32 v57, v44, v45, v57
  v_min3_u32 v56, v46, v47, v56
  v_max3_u32 v57, v46, v47, v57
  v_min3_u32 v56, v48, v49, v56
  v_max3_u32 v57, v48, v49, v57
  v_min3_u32 v56, v50, v51, v56
  v_max3_u32 v57, v50, v51, v57
  v_min3_u32 v56, v52, v53, v56
  v_max3_u32 v57, v52, v53, v57
  v_min3_u32 v56, v54, v55, v56
  v_max3_u32 v57, v54, v55, v57
  v_cmp_eq_u32 vcc, 0, v56
  s_cbranch_vccnz k_w_94
  v_max_u32_dpp v57, v57, v57 row_ror:8 row_mask:0xf bank_mask:0xf
  s_nop 1
  v_max_u32_dpp v57, v57, v57 row_ror:4 row_mask:0xf bank_mask:0xf
  s_nop 1
  v_max_u32_dpp v57, v57, v57 row_ror:2 row_mask:0xf bank_mask:0xf
  s_nop 1
  v_max_u32_dpp v57, v57, v57 row_ror:1 row_mask:0xf bank_mask:0xf
  v_mov_b32 v56, v57
  s_nop 0
  s_nop 0
  v_permlane16_swap_b32 v57, v56
  v_max_u32 v57, v57, v56
  v_mov_b32 v56, v57
  s_nop 0
  s_nop 0
  v_permlane32_swap_b32 v57, v56
  v_max_u32 v57, v57, v56
  s_nop 0
  v_readfirstlane_b32 s78, v57
  s_branch o_k3_93
o_k2_92:
  s_mov_b32 s67, 0
  s_mov_b32 s26, 5267456
  s_mov_b32 s27, 5271552
k_w_95:
  buffer_load_dwordx4 v[24:27], v0, s[4:7], s26 offen offset:0 sc1
  buffer_load_dwordx4 v[28:31], v0, s[4:7], s26 offen offset:1024 sc1
  buffer_load_dwordx4 v[32:35], v0, s[4:7], s26 offen offset:2048 sc1
  buffer_load_dwordx4 v[36:39], v0, s[4:7], s26 offen offset:3072 sc1
  buffer_load_dwordx4 v[40:43], v0, s[4:7], s27 offen offset:0 sc1
  buffer_load_dwordx4 v[44:47], v0, s[4:7], s27 offen offset:1024 sc1
  buffer_load_dwordx4 v[48:51], v0, s[4:7], s27 offen offset:2048 sc1
  buffer_load_dwordx4 v[52:55], v0, s[4:7], s27 offen offset:3072 sc1
  s_add_u32 s67, s67, 1
  s_cmp_gt_u32 s67, 1048576
  s_cbranch_scc1 L_end
  s_sleep 2
  s_waitcnt vmcnt(0)
  v_min_u32 v56, v24, v25
  v_max_u32 v57, v24, v25
  v_min3_u32 v56, v26, v27, v56
  v_max3_u32 v57, v26, v27, v57
  v_min3_u32 v56, v28, v29, v56
  v_max3_u32 v57, v28, v29, v57
  v_min3_u32 v56, v30, v31, v56
  v_max3_u32 v57, v30, v31, v57
  v_min3_u32 v56, v32, v33, v56
  v_max3_u32 v57, v32, v33, v57
  v_min3_u32 v56, v34, v35, v56
  v_max3_u32 v57, v34, v35, v57
  v_min3_u32 v56, v36, v37, v56
  v_max3_u32 v57, v36, v37, v57
  v_min3_u32 v56, v38, v39, v56
  v_max3_u32 v57, v38, v39, v57
  v_min3_u32 v56, v40, v41, v56
  v_max3_u32 v57, v40, v41, v57
  v_min3_u32 v56, v42, v43, v56
  v_max3_u32 v57, v42, v43, v57
  v_min3_u32 v56, v44, v45, v56
  v_max3_u32 v57, v44, v45, v57
  v_min3_u32 v56, v46, v47, v56
  v_max3_u32 v57, v46, v47, v57
  v_min3_u32 v56, v48, v49, v56
  v_max3_u32 v57, v48, v49, v57
  v_min3_u32 v56, v50, v51, v56
  v_max3_u32 v57, v50, v51, v57
  v_min3_u32 v56, v52, v53, v56
  v_max3_u32 v57, v52, v53, v57
  v_min3_u32 v56, v54, v55, v56
  v_max3_u32 v57, v54, v55, v57
  v_cmp_eq_u32 vcc, 0, v56
  s_cbranch_vccnz k_w_95
  v_max_u32_dpp v57, v57, v57 row_ror:8 row_mask:0xf bank_mask:0xf
  s_nop 1
  v_max_u32_dpp v57, v57, v57 row_ror:4 row_mask:0xf bank_mask:0xf
  s_nop 1
  v_max_u32_dpp v57, v57, v57 row_ror:2 row_mask:0xf bank_mask:0xf
  s_nop 1
  v_max_u32_dpp v57, v57, v57 row_ror:1 row_mask:0xf bank_mask:0xf
  v_mov_b32 v56, v57
  s_nop 0
  s_nop 0
  v_permlane16_swap_b32 v57, v56
  v_max_u32 v57, v57, v56
  v_mov_b32 v56, v57
  s_nop 0
  s_nop 0
  v_permlane32_swap_b32 v57, v56
  v_max_u32 v57, v57, v56
  s_nop 0
  v_readfirstlane_b32 s78, v57
o_k3_93:
  s_add_u32 s79, s79, 1
  s_load_dwordx2 s[80:81], s[0:1], 72
  s_load_dwordx2 s[84:85], s[0:1], 80
  s_load_dwordx2 s[8:9], s[0:1], 88
  s_mov_b32 s82, 1835008
  s_mov_b32 s83, 0x20000
  s_mov_b32 s86, 1835008
  s_mov_b32 s87, 0x20000
  s_mov_b32 s10, 1835008
  s_and_b32 s77, s78, 0xfff
  s_sub_u32 s77, 4095, s77
  v_lshrrev_b32 v25, 8, v0
  v_and_b32 v24, 0xf0, v0
  s_mov_b32 s26, 114688
  v_mul_lo_u32 v26, v25, s26
  v_add_u32 v26, v26, v24
  v_mul_u32_u24 v27, 28672, v25
  v_add_u32 v27, v27, v24
  v_lshlrev_b32 v7, 6, v25
  s_lshl_b32 s26, s66, 21
  s_lshl_b32 s27, s77, 10
  s_add_u32 s32, s26, s27
  s_lshl_b32 s27, s17, 8
  s_add_u32 s26, s32, s27
  s_add_u32 s26, s26, 176160768
  buffer_load_dwordx4 v[28:31], v7, s[4:7], s26 offen offset:0 sc1
  buffer_load_dwordx4 v[32:35], v7, s[4:7], s26 offen offset:16 sc1
  buffer_load_dwordx4 v[36:39], v7, s[4:7], s26 offen offset:32 sc1
  buffer_load_dwordx4 v[40:43], v7, s[4:7], s26 offen offset:48 sc1
  s_mul_i32 s26, s17, 458752
  s_mul_i32 s27, s61, 224
  s_add_u32 s26, s26, s27
  s_mul_i32 s28, s61, 114688
  s_lshl_b32 s27, s17, 8
  s_add_u32 s28, s28, s27
  s_mov_b32 s30, 0x01000100
  s_mov_b32 s31, 0x03020302
  s_waitcnt lgkmcnt(0)
  buffer_load_dwordx4 v[72:75], v26, s[80:83], s26 offen
  buffer_load_dwordx4 v[76:79], v26, s[84:87], s26 offen
  s_add_u32 s26, s26, 3584
  buffer_load_dwordx4 v[80:83], v26, s[80:83], s26 offen
  buffer_load_dwordx4 v[84:87], v26, s[84:87], s26 offen
  s_add_u32 s26, s26, 3584
  buffer_load_dwordx4 v[88:91], v26, s[80:83], s26 offen
  buffer_load_dwordx4 v[92:95], v26, s[84:87], s26 offen
  s_add_u32 s26, s26, 3584
  buffer_load_dwordx4 v[96:99], v26, s[80:83], s26 offen
  buffer_load_dwordx4 v[100:103], v26, s[84:87], s26 offen
  s_add_u32 s26, s26, 3584
  buffer_load_dwordx4 v[104:107], v26, s[80:83], s26 offen
  buffer_load_dwordx4 v[108:111], v26, s[84:87], s26 offen
  s_add_u32 s26, s26, 3584
  buffer_load_dwordx4 v[112:115], v26, s[80:83], s26 offen
  buffer_load_dwordx4 v[116:119], v26, s[84:87], s26 offen
  s_add_u32 s26, s26, 3584
  buffer_load_dwordx4 v[120:123], v26, s[80:83], s26 offen
  buffer_load_dwordx4 v[124:127], v26, s[84:87], s26 offen
  s_add_u32 s26, s26, 3584
  buffer_load_dwordx4 v[128:131], v26, s[80:83], s26 offen
  buffer_load_dwordx4 v[132:135], v26, s[84:87], s26 offen
  s_add_u32 s26, s26, 3584
  buffer_load_dwordx4 v[136:139], v26, s[80:83], s26 offen
  buffer_load_dwordx4 v[140:143], v26, s[84:87], s26 offen
  s_add_u32 s26, s26, 3584
  buffer_load_dwordx4 v[144:147], v26, s[80:83], s26 offen
  buffer_load_dwordx4 v[148:151], v26, s[84:87], s26 offen
  s_add_u32 s26, s26, 3584
  buffer_load_dwordx4 v[152:155], v26, s[80:83], s26 offen
  buffer_load_dwordx4 v[156:159], v26, s[84:87], s26 offen
  s_add_u32 s26, s26, 3584
  buffer_load_dwordx4 v[160:163], v26, s[80:83], s26 offen
  buffer_load_dwordx4 v[164:167], v26, s[84:87], s26 offen
  s_add_u32 s26, s26, 3584
  buffer_load_dwordx4 v[168:171], v26, s[80:83], s26 offen
  buffer_load_dwordx4 v[172:175], v26, s[84:87], s26 offen
  s_add_u32 s26, s26, 3584
  buffer_load_dwordx4 v[176:179], v26, s[80:83], s26 offen
  buffer_load_dwordx4 v[180:183], v26, s[84:87], s26 offen
  s_add_u32 s26, s26, 3584
  buffer_load_dwordx4 v[184:187], v26, s[80:83], s26 offen
  buffer_load_dwordx4 v[188:191], v26, s[84:87], s26 offen
  s_add_u32 s26, s26, 3584
  buffer_load_dwordx4 v[192:195], v26, s[80:83], s26 offen
  buffer_load_dwordx4 v[196:199], v26, s[84:87], s26 offen
  s_add_u32 s26, s26, 3584
  buffer_load_dwordx4 v[200:203], v26, s[80:83], s26 offen
  buffer_load_dwordx4 v[204:207], v26, s[84:87], s26 offen
  s_add_u32 s26, s26, 3584
  buffer_load_dwordx4 v[208:211], v26, s[80:83], s26 offen
  buffer_load_dwordx4 v[212:215], v26, s[84:87], s26 offen
  s_add_u32 s26, s26, 3584
  buffer_load_dwordx4 v[216:219], v26, s[80:83], s26 offen
  buffer_load_dwordx4 v[220:223], v26, s[84:87], s26 offen
  s_add_u32 s26, s26, 3584
  buffer_load_dwordx4 v[224:227], v26, s[80:83], s26 offen
  buffer_load_dwordx4 v[228:231], v26, s[84:87], s26 offen
  s_add_u32 s26, s26, 3584
  buffer_load_dwordx4 v[232:235], v26, s[80:83], s26 offen
  buffer_load_dwordx4 v[236:239], v26, s[84:87], s26 offen
  s_add_u32 s26, s26, 3584
  buffer_load_dwordx4 v[240:243], v26, s[80:83], s26 offen
  buffer_load_dwordx4 v[244:247], v26, s[84:87], s26 offen
  s_add_u32 s26, s26, 3584
  buffer_load_dwordx4 v[248:251], v26, s[80:83], s26 offen
  buffer_load_dwordx4 v[252:255], v26, s[84:87], s26 offen
  s_add_u32 s26, s26, 3584
  s_mov_b32 vcc_lo, 0xaaaaaaaa
  s_mov_b32 vcc_hi, 0xaaaaaaaa
  v_mov_b32 v7, 0xffff
  v_mov_b32 v52, 0xffff0000
  v_cndmask_b32 v7, v7, v52, vcc
  s_mov_b32 vcc_lo, 0x30003
  s_mov_b32 vcc_hi, 0x30003
  v_cndmask_b32 v52, 0, v7, vcc
  s_mov_b32 vcc_lo, 0xc000c
  s_mov_b32 vcc_hi, 0xc000c
  v_cndmask_b32 v53, 0, v7, vcc
  s_mov_b32 vcc_lo, 0x300030
  s_mov_b32 vcc_hi, 0x300030
  v_cndmask_b32 v54, 0, v7, vcc
  s_mov_b32 vcc_lo, 0xc000c0
  s_mov_b32 vcc_hi, 0xc000c0
  v_cndmask_b32 v55, 0, v7, vcc
  s_waitcnt vmcnt(46)
  v_perm_b32 v7, v28, v28, s30
  v_and_b32 v44, v52, v7
  v_and_b32 v45, v53, v7
  v_and_b32 v46, v54, v7
  v_and_b32 v47, v55, v7
  s_waitcnt vmcnt(45)
  s_nop 0
  v_mfma_f32_16x16x32_bf16 v[56:59], v[44:47], v[72:75], 0
  buffer_load_dwordx4 v[72:75], v26, s[80:83], s26 offen
  s_waitcnt vmcnt(45)
  v_mfma_f32_16x16x32_bf16 v[60:63], v[44:47], v[76:79], 0
  buffer_load_dwordx4 v[76:79], v26, s[84:87], s26 offen
  s_add_u32 s26, s26, 3584
  v_perm_b32 v7, v28, v28, s31
  v_and_b32 v48, v52, v7
  v_and_b32 v49, v53, v7
  v_and_b32 v50, v54, v7
  v_and_b32 v51, v55, v7
  s_waitcnt vmcnt(45)
  s_nop 0
  v_mfma_f32_16x16x32_bf16 v[56:59], v[48:51], v[80:83], v[56:59]
  buffer_load_dwordx4 v[80:83], v26, s[80:83], s26 offen
  s_waitcnt vmcnt(45)
  v_mfma_f32_16x16x32_bf16 v[60:63], v[48:51], v[84:87], v[60:63]
  buffer_load_dwordx4 v[84:87], v26, s[84:87], s26 offen
  s_add_u32 s26, s26, 3584
  v_perm_b32 v7, v29, v29, s30
  v_and_b32 v44, v52, v7
  v_and_b32 v45, v53, v7
  v_and_b32 v46, v54, v7
  v_and_b32 v47, v55, v7
  s_waitcnt vmcnt(45)
  s_nop 0
  v_mfma_f32_16x16x32_bf16 v[56:59], v[44:47], v[88:91], v[56:59]
  buffer_load_dwordx4 v[88:91], v26, s[80:83], s26 offen
  s_waitcnt vmcnt(45)
  v_mfma_f32_16x16x32_bf16 v[60:63], v[44:47], v[92:95], v[60:63]
  buffer_load_dwordx4 v[92:95], v26, s[84:87], s26 offen
  s_add_u32 s26, s26, 3584
  v_perm_b32 v7, v29, v29, s31
  v_and_b32 v48, v52, v7
  v_and_b32 v49, v53, v7
  v_and_b32 v50, v54, v7
  v_and_b32 v51, v55, v7
  s_waitcnt vmcnt(45)
  s_nop 0
  v_mfma_f32_16x16x32_bf16 v[56:59], v[48:51], v[96:99], v[56:59]
  buffer_load_dwordx4 v[96:99], v26, s[80:83], s26 offen
  s_waitcnt vmcnt(45)
  v_mfma_f32_16x16x32_bf16 v[60:63], v[48:51], v[100:103], v[60:63]
  buffer_load_dwordx4 v[100:103], v26, s[84:87], s26 offen
  s_add_u32 s26, s26, 3584
  v_perm_b32 v7, v30, v30, s30
  v_and_b32 v44, v52, v7
  v_and_b32 v45, v53, v7
  v_and_b32 v46, v54, v7
  v_and_b32 v47, v55, v7
  s_waitcnt vmcnt(45)
  s_nop 0
  v_mfma_f32_16x16x32_bf16 v[56:59], v[44:47], v[104:107], v[56:59]
  buffer_load_dwordx4 v[104:107], v26, s[80:83], s26 offen
  s_waitcnt vmcnt(45)
  v_mfma_f32_16x16x32_bf16 v[60:63], v[44:47], v[108:111], v[60:63]
  buffer_load_dwordx4 v[108:111], v26, s[84:87], s26 offen
  s_add_u32 s26, s26, 3584
  v_perm_b32 v7, v30, v30, s31
  v_and_b32 v48, v52, v7
  v_and_b32 v49, v53, v7
  v_and_b32 v50, v54, v7
  v_and_b32 v51, v55, v7
  s_waitcnt vmcnt(45)
  s_nop 0
  v_mfma_f32_16x16x32_bf16 v[56:59], v[48:51], v[112:115], v[56:59]
  buffer_load_dwordx4 v[112:115], v26, s[80:83], s26 offen
  s_waitcnt vmcnt(45)
  v_mfma_f32_16x16x32_bf16 v[60:63], v[48:51], v[116:119], v[60:63]
  buffer_load_dwordx4 v[116:119], v26, s[84:87], s26 offen
  s_add_u32 s26, s26, 3584
  v_perm_b32 v7, v31, v31, s30
  v_and_b32 v44, v52, v7
  v_and_b32 v45, v53, v7
  v_and_b32 v46, v54, v7
  v_and_b32 v47, v55, v7
  s_waitcnt vmcnt(45)
  s_nop 0
  v_mfma_f32_16x16x32_bf16 v[56:59], v[44:47], v[120:123], v[56:59]
  buffer_load_dwordx4 v[120:123], v26, s[80:83], s26 offen
  s_waitcnt vmcnt(45)
  v_mfma_f32_16x16x32_bf16 v[60:63], v[44:47], v[124:127], v[60:63]
  buffer_load_dwordx4 v[124:127], v26, s[84:87], s26 offen
  s_add_u32 s26, s26, 3584
  v_perm_b32 v7, v31, v31, s31
  v_and_b32 v48, v52, v7
  v_and_b32 v49, v53, v7
  v_and_b32 v50, v54, v7
  v_and_b32 v51, v55, v7
  s_waitcnt vmcnt(45)
  s_nop 0
  v_mfma_f32_16x16x32_bf16 v[56:59], v[48:51], v[128:131], v[56:59]
  buffer_load_dwordx4 v[128:131], v26, s[80:83], s26 offen
  s_waitcnt vmcnt(45)
  v_mfma_f32_16x16x32_bf16 v[60:63], v[48:51], v[132:135], v[60:63]
  buffer_load_dwordx4 v[132:135], v26, s[84:87], s26 offen
  s_add_u32 s26, s26, 3584
  v_perm_b32 v7, v32, v32, s30
  v_and_b32 v44, v52, v7
  v_and_b32 v45, v53, v7
  v_and_b32 v46, v54, v7
  v_and_b32 v47, v55, v7
  s_waitcnt vmcnt(45)
  s_nop 0
  v_mfma_f32_16x16x32_bf16 v[56:59], v[44:47], v[136:139], v[56:59]
  buffer_load_dwordx4 v[136:139], v26, s[80:83], s26 offen
  s_waitcnt vmcnt(45)
  v_mfma_f32_16x16x32_bf16 v[60:63], v[44:47], v[140:143], v[60:63]
  buffer_load_dwordx4 v[140:143], v26, s[84:87], s26 offen
  s_add_u32 s26, s26, 3584
  v_perm_b32 v7, v32, v32, s31
  v_and_b32 v48, v52, v7
  v_and_b32 v49, v53, v7
  v_and_b32 v50, v54, v7
  v_and_b32 v51, v55, v7
  s_waitcnt vmcnt(45)
  s_nop 0
  v_mfma_f32_16x16x32_bf16 v[56:59], v[48:51], v[144:147], v[56:59]
  buffer_load_dwordx4 v[144:147], v27, s[8:11], s28 offen offset:0
  s_waitcnt vmcnt(45)
  v_mfma_f32_16x16x32_bf16 v[60:63], v[48:51], v[148:151], v[60:63]
  buffer_load_dwordx4 v[148:151], v27, s[8:11], s28 offen offset:1024
  v_perm_b32 v7, v33, v33, s30
  v_and_b32 v44, v52, v7
  v_and_b32 v45, v53, v7
  v_and_b32 v46, v54, v7
  v_and_b32 v47, v55, v7
  s_waitcnt vmcnt(45)
  s_nop 0
  v_mfma_f32_16x16x32_bf16 v[56:59], v[44:47], v[152:155], v[56:59]
  buffer_load_dwordx4 v[152:155], v27, s[8:11], s28 offen offset:2048
  s_waitcnt vmcnt(45)
  v_mfma_f32_16x16x32_bf16 v[60:63], v[44:47], v[156:159], v[60:63]
  buffer_load_dwordx4 v[156:159], v27, s[8:11], s28 offen offset:3072
  s_add_u32 s28, s28, 4096
  v_perm_b32 v7, v33, v33, s31
  v_and_b32 v48, v52, v7
  v_and_b32 v49, v53, v7
  v_and_b32 v50, v54, v7
  v_and_b32 v51, v55, v7
  s_waitcnt vmcnt(45)
  s_nop 0
  v_mfma_f32_16x16x32_bf16 v[56:59], v[48:51], v[160:163], v[56:59]
  buffer_load_dwordx4 v[160:163], v27, s[8:11], s28 offen offset:0
  s_waitcnt vmcnt(45)
  v_mfma_f32_16x16x32_bf16 v[60:63], v[48:51], v[164:167], v[60:63]
  buffer_load_dwordx4 v[164:167], v27, s[8:11], s28 offen offset:1024
  v_perm_b32 v7, v34, v34, s30
  v_and_b32 v44, v52, v7
  v_and_b32 v45, v53, v7
  v_and_b32 v46, v54, v7
  v_and_b32 v47, v55, v7
  s_waitcnt vmcnt(45)
  s_nop 0
  v_mfma_f32_16x16x32_bf16 v[56:59], v[44:47], v[168:171], v[56:59]
  buffer_load_dwordx4 v[168:171], v27, s[8:11], s28 offen offset:2048
  s_waitcnt vmcnt(45)
  v_mfma_f32_16x16x32_bf16 v[60:63], v[44:47], v[172:175], v[60:63]
  buffer_load_dwordx4 v[172:175], v27, s[8:11], s28 offen offset:3072
  s_add_u32 s28, s28, 4096
  v_perm_b32 v7, v34, v34, s31
  v_and_b32 v48, v52, v7
  v_and_b32 v49, v53, v7
  v_and_b32 v50, v54, v7
  v_and_b32 v51, v55, v7
  s_waitcnt vmcnt(45)
  s_nop 0
  v_mfma_f32_16x16x32_bf16 v[56:59], v[48:51], v[176:179], v[56:59]
  buffer_load_dwordx4 v[176:179], v27, s[8:11], s28 offen offset:0
  s_waitcnt vmcnt(45)
  v_mfma_f32_16x16x32_bf16 v[60:63], v[48:51], v[180:183], v[60:63]
  buffer_load_dwordx4 v[180:183], v27, s[8:11], s28 offen offset:1024
  v_perm_b32 v7, v35, v35, s30
  v_and_b32 v44, v52, v7
  v_and_b32 v45, v53, v7
  v_and_b32 v46, v54, v7
  v_and_b32 v47, v55, v7
  s_waitcnt vmcnt(45)
  s_nop 0
  v_mfma_f32_16x16x32_bf16 v[56:59], v[44:47], v[184:187], v[56:59]
  buffer_load_dwordx4 v[184:187], v27, s[8:11], s28 offen offset:2048
  s_waitcnt vmcnt(45)
  v_mfma_f32_16x16x32_bf16 v[60:63], v[44:47], v[188:191], v[60:63]
  buffer_load_dwordx4 v[188:191], v27, s[8:11], s28 offen offset:3072
  s_add_u32 s28, s28, 4096
  v_perm_b32 v7, v35, v35, s31
  v_and_b32 v48, v52, v7
  v_and_b32 v49, v53, v7
  v_and_b32 v50, v54, v7
  v_and_b32 v51, v55, v7
  s_waitcnt vmcnt(45)
  s_nop 0
  v_mfma_f32_16x16x32_bf16 v[56:59], v[48:51], v[192:195], v[56:59]
  buffer_load_dwordx4 v[192:195], v27, s[8:11], s28 offen offset:0
  s_waitcnt vmcnt(45)
  v_mfma_f32_16x16x32_bf16 v[60:63], v[48:51], v[196:199], v[60:63]
  buffer_load_dwordx4 v[196:199], v27, s[8:11], s28 offen offset:1024
  v_perm_b32 v7, v36, v36, s30
  v_and_b32 v44, v52, v7
  v_and_b32 v45, v53, v7
  v_and_b32 v46, v54, v7
  v_and_b32 v47, v55, v7
  s_waitcnt vmcnt(45)
  s_nop 0
  v_mfma_f32_16x16x32_bf16 v[56:59], v[44:47], v[200:203], v[56:59]
  buffer_load_dwordx4 v[200:203], v27, s[8:11], s28 offen offset:2048
  s_waitcnt vmcnt(45)
  v_mfma_f32_16x16x32_bf16 v[60:63], v[44:47], v[204:207], v[60:63]
  buffer_load_dwordx4 v[204:207], v27, s[8:11], s28 offen offset:3072
  s_add_u32 s28, s28, 4096
  v_perm_b32 v7, v36, v36, s31
  v_and_b32 v48, v52, v7
  v_and_b32 v49, v53, v7
  v_and_b32 v50, v54, v7
  v_and_b32 v51, v55, v7
  s_waitcnt vmcnt(45)
  s_nop 0
  v_mfma_f32_16x16x32_bf16 v[56:59], v[48:51], v[208:211], v[56:59]
  buffer_load_dwordx4 v[208:211], v27, s[8:11], s28 offen offset:0
  s_waitcnt vmcnt(45)
  v_mfma_f32_16x16x32_bf16 v[60:63], v[48:51], v[212:215], v[60:63]
  buffer_load_dwordx4 v[212:215], v27, s[8:11], s28 offen offset:1024
  v_perm_b32 v7, v37, v37, s30
  v_and_b32 v44, v52, v7
  v_and_b32 v45, v53, v7
  v_and_b32 v46, v54, v7
  v_and_b32 v47, v55, v7
  s_waitcnt vmcnt(45)
  s_nop 0
  v_mfma_f32_16x16x32_bf16 v[56:59], v[44:47], v[216:219], v[56:59]
  buffer_load_dwordx4 v[216:219], v27, s[8:11], s28 offen offset:2048
  s_waitcnt vmcnt(45)
  v_mfma_f32_16x16x32_bf16 v[60:63], v[44:47], v[220:223], v[60:63]
  buffer_load_dwordx4 v[220:223], v27, s[8:11], s28 offen offset:3072
  s_add_u32 s28, s28, 4096
  v_perm_b32 v7, v37, v37, s31
  v_and_b32 v48, v52, v7
  v_and_b32 v49, v53, v7
  v_and_b32 v50, v54, v7
  v_and_b32 v51, v55, v7
  s_waitcnt vmcnt(45)
  s_nop 0
  v_mfma_f32_16x16x32_bf16 v[56:59], v[48:51], v[224:227], v[56:59]
  buffer_load_dwordx4 v[224:227], v27, s[8:11], s28 offen offset:0
  s_waitcnt vmcnt(45)
  v_mfma_f32_16x16x32_bf16 v[60:63], v[48:51], v[228:231], v[60:63]
  buffer_load_dwordx4 v[228:231], v27, s[8:11], s28 offen offset:1024
  v_perm_b32 v7, v38, v38, s30
  v_and_b32 v44, v52, v7
  v_and_b32 v45, v53, v7
  v_and_b32 v46, v54, v7
  v_and_b32 v47, v55, v7
  s_waitcnt vmcnt(45)
  s_nop 0
  v_mfma_f32_16x16x32_bf16 v[56:59], v[44:47], v[232:235], v[56:59]
  buffer_load_dwordx4 v[232:235], v27, s[8:11], s28 offen offset:2048
  s_waitcnt vmcnt(45)
  v_mfma_f32_16x16x32_bf16 v[60:63], v[44:47], v[236:239], v[60:63]
  buffer_load_dwordx4 v[236:239], v27, s[8:11], s28 offen offset:3072
  s_add_u32 s28, s28, 4096
  v_perm_b32 v7, v38, v38, s31
  v_and_b32 v48, v52, v7
  v_and_b32 v49, v53, v7
  v_and_b32 v50, v54, v7
  v_and_b32 v51, v55, v7
  s_waitcnt vmcnt(45)
  s_nop 0
  v_mfma_f32_16x16x32_bf16 v[56:59], v[48:51], v[240:243], v[56:59]
  buffer_load_dwordx4 v[240:243], v27, s[8:11], s28 offen offset:0
  s_waitcnt vmcnt(45)
  v_mfma_f32_16x16x32_bf16 v[60:63], v[48:51], v[244:247], v[60:63]
  buffer_load_dwordx4 v[244:247], v27, s[8:11], s28 offen offset:1024
  v_perm_b32 v7, v39, v39, s30
  v_and_b32 v44, v52, v7
  v_and_b32 v45, v53, v7
  v_and_b32 v46, v54, v7
  v_and_b32 v47, v55, v7
  s_waitcnt vmcnt(45)
  s_nop 0
  v_mfma_f32_16x16x32_bf16 v[56:59], v[44:47], v[248:251], v[56:59]
  buffer_load_dwordx4 v[248:251], v27, s[8:11], s28 offen offset:2048
  s_waitcnt vmcnt(45)
  v_mfma_f32_16x16x32_bf16 v[60:63], v[44:47], v[252:255], v[60:63]
  buffer_load_dwordx4 v[252:255], v27, s[8:11], s28 offen offset:3072
  s_add_u32 s28, s28, 4096
  v_perm_b32 v7, v39, v39, s31
  v_and_b32 v48, v52, v7
  v_and_b32 v49, v53, v7
  v_and_b32 v50, v54, v7
  v_and_b32 v51, v55, v7
  s_waitcnt vmcnt(45)
  s_nop 0
  v_mfma_f32_16x16x32_bf16 v[56:59], v[48:51], v[72:75], v[56:59]
  s_waitcnt vmcnt(44)
  v_mfma_f32_16x16x32_bf16 v[60:63], v[48:51], v[76:79], v[60:63]
  v_perm_b32 v7, v40, v40, s30
  v_and_b32 v44, v52, v7
  v_and_b32 v45, v53, v7
  v_and_b32 v46, v54, v7
  v_and_b32 v47, v55, v7
  s_waitcnt vmcnt(43)
  s_nop 0
  v_mfma_f32_16x16x32_bf16 v[56:59], v[44:47], v[80:83], v[56:59]
  s_waitcnt vmcnt(42)
  v_mfma_f32_16x16x32_bf16 v[60:63], v[44:47], v[84:87], v[60:63]
  v_perm_b32 v7, v40, v40, s31
  v_and_b32 v48, v52, v7
  v_and_b32 v49, v53, v7
  v_and_b32 v50, v54, v7
  v_and_b32 v51, v55, v7
  s_waitcnt vmcnt(41)
  s_nop 0
  v_mfma_f32_16x16x32_bf16 v[56:59], v[48:51], v[88:91], v[56:59]
  s_waitcnt vmcnt(40)
  v_mfma_f32_16x16x32_bf16 v[60:63], v[48:51], v[92:95], v[60:63]
  v_perm_b32 v7, v41, v41, s30
  v_and_b32 v44, v52, v7
  v_and_b32 v45, v53, v7
  v_and_b32 v46, v54, v7
  v_and_b32 v47, v55, v7
  s_waitcnt vmcnt(39)
  s_nop 0
  v_mfma_f32_16x16x32_bf16 v[56:59], v[44:47], v[96:99], v[56:59]
  s_waitcnt vmcnt(38)
  v_mfma_f32_16x16x32_bf16 v[60:63], v[44:47], v[100:103], v[60:63]
  v_perm_b32 v7, v41, v41, s31
  v_and_b32 v48, v52, v7
  v_and_b32 v49, v53, v7
  v_and_b32 v50, v54, v7
  v_and_b32 v51, v55, v7
  s_waitcnt vmcnt(37)
  s_nop 0
  v_mfma_f32_16x16x32_bf16 v[56:59], v[48:51], v[104:107], v[56:59]
  s_waitcnt vmcnt(36)
  v_mfma_f32_16x16x32_bf16 v[60:63], v[48:51], v[108:111], v[60:63]
  v_perm_b32 v7, v42, v42, s30
  v_and_b32 v44, v52, v7
  v_and_b32 v45, v53, v7
  v_and_b32 v46, v54, v7
  v_and_b32 v47, v55, v7
  s_waitcnt vmcnt(35)
  s_nop 0
  v_mfma_f32_16x16x32_bf16 v[56:59], v[44:47], v[112:115], v[56:59]
  s_waitcnt vmcnt(34)
  v_mfma_f32_16x16x32_bf16 v[60:63], v[44:47], v[116:119], v[60:63]
  v_perm_b32 v7, v42, v42, s31
  v_and_b32 v48, v52, v7
  v_and_b32 v49, v53, v7
  v_and_b32 v50, v54, v7
  v_and_b32 v51, v55, v7
  s_waitcnt vmcnt(33)
  s_nop 0
  v_mfma_f32_16x16x32_bf16 v[56:59], v[48:51], v[120:123], v[56:59]
  s_waitcnt vmcnt(32)
  v_mfma_f32_16x16x32_bf16 v[60:63], v[48:51], v[124:127], v[60:63]
  v_perm_b32 v7, v43, v43, s30
  v_and_b32 v44, v52, v7
  v_and_b32 v45, v53, v7
  v_and_b32 v46, v54, v7
  v_and_b32 v47, v55, v7
  s_waitcnt vmcnt(31)
  s_nop 0
  v_mfma_f32_16x16x32_bf16 v[56:59], v[44:47], v[128:131], v[56:59]
  s_waitcnt vmcnt(30)
  v_mfma_f32_16x16x32_bf16 v[60:63], v[44:47], v[132:135], v[60:63]
  v_perm_b32 v7, v43, v43, s31
  v_and_b32 v48, v52, v7
  v_and_b32 v49, v53, v7
  v_and_b32 v50, v54, v7
  v_and_b32 v51, v55, v7
  s_waitcnt vmcnt(29)
  s_nop 0
  v_mfma_f32_16x16x32_bf16 v[56:59], v[48:51], v[136:139], v[56:59]
  s_waitcnt vmcnt(28)
  v_mfma_f32_16x16x32_bf16 v[60:63], v[48:51], v[140:143], v[60:63]
  s_lshl_b32 s26, s17, 11
  v_lshlrev_b32 v7, 1, v24
  v_lshl_add_u32 v7, v25, 4, v7
  v_cmp_gt_u32 vcc, 2, v25
  v_mov_b32 v28, 512
  s_nop 0
  v_cndmask_b32 v7, v28, v7, vcc
  v_add_u32 v7, s26, v7
  ds_write_b128 v7, v[56:59] offset:32768
  ds_write_b128 v7, v[60:63] offset:33792
  s_waitcnt lgkmcnt(0)
  s_barrier
  ds_read_b64 v[28:29], v1 offset:32768
  ds_read_b64 v[30:31], v1 offset:33792
  ds_read_b64 v[32:33], v1 offset:34816
  ds_read_b64 v[34:35], v1 offset:35840
  ds_read_b64 v[36:37], v1 offset:36864
  ds_read_b64 v[38:39], v1 offset:37888
  ds_read_b64 v[40:41], v1 offset:38912
  ds_read_b64 v[42:43], v1 offset:39936
  s_waitcnt lgkmcnt(0)
  v_add_f32 v28, v28, v32
  v_add_f32 v36, v36, v40
  v_add_f32 v28, v28, v36
  v_cvt_pk_bf16_f32 v28, v28, v28
  v_and_b32 v28, 0xffff0000, v28
  v_add_f32 v29, v29, v33
  v_add_f32 v37, v37, v41
  v_add_f32 v29, v29, v37
  v_cvt_pk_bf16_f32 v29, v29, v29
  v_and_b32 v29, 0xffff0000, v29
  v_add_f32 v30, v30, v34
  v_add_f32 v38, v38, v42
  v_add_f32 v30, v30, v38
  v_cvt_pk_bf16_f32 v30, v30, v30
  v_and_b32 v30, 0xffff0000, v30
  v_add_f32 v31, v31, v35
  v_add_f32 v39, v39, v43
  v_add_f32 v31, v31, v39
  v_cvt_pk_bf16_f32 v31, v31, v31
  v_and_b32 v31, 0xffff0000, v31
  v_mul_f32 v32, 0xbfb8aa3b, v28
  v_exp_f32 v32, v32
  s_nop 0
  v_add_f32 v32, 1.0, v32
  v_rcp_f32 v32, v32
  s_nop 0
  v_mul_f32 v28, v28, v32
  v_cvt_pk_bf16_f32 v28, v28, v28
  v_and_b32 v28, 0xffff0000, v28
  v_mul_f32 v28, v28, v30
  v_cvt_pk_bf16_f32 v28, v28, v28
  v_mul_f32 v33, 0xbfb8aa3b, v29
  v_exp_f32 v33, v33
  s_nop 0
  v_add_f32 v33, 1.0, v33
  v_rcp_f32 v33, v33
  s_nop 0
  v_mul_f32 v29, v29, v33
  v_cvt_pk_bf16_f32 v29, v29, v29
  v_and_b32 v29, 0xffff0000, v29
  v_mul_f32 v29, v29, v31
  v_cvt_pk_bf16_f32 v29, v29, v29
  s_lshl_b32 s26, s17, 9
  v_add_u32 v7, s26, v1
  ds_write_b64 v7, v[28:29] offset:40960
  v_mul_u32_u24 v7, 112, v25
  v_add_u32 v7, s26, v7
  ds_read_b128 v[28:31], v7 offset:40960
  ds_read_b128 v[32:35], v7 offset:40976
  ds_read_b128 v[36:39], v7 offset:40992
  ds_read_b128 v[40:43], v7 offset:41008
  ds_read_b128 v[56:59], v7 offset:41024
  ds_read_b128 v[60:63], v7 offset:41040
  ds_read_b128 v[68:71], v7 offset:41056
  s_waitcnt lgkmcnt(0)
  v_and_b32 v44, v52, v28
  v_and_b32 v45, v53, v28
  v_and_b32 v46, v54, v28
  v_and_b32 v47, v55, v28
  s_waitcnt vmcnt(27)
  s_nop 0
  v_mfma_f32_16x16x32_bf16 v[64:67], v[44:47], v[144:147], 0
  v_and_b32 v48, v52, v29
  v_and_b32 v49, v53, v29
  v_and_b32 v50, v54, v29
  v_and_b32 v51, v55, v29
  s_waitcnt vmcnt(26)
  s_nop 0
  v_mfma_f32_16x16x32_bf16 v[64:67], v[48:51], v[148:151], v[64:67]
  v_and_b32 v44, v52, v30
  v_and_b32 v45, v53, v30
  v_and_b32 v46, v54, v30
  v_and_b32 v47, v55, v30
  s_waitcnt vmcnt(25)
  s_nop 0
  v_mfma_f32_16x16x32_bf16 v[64:67], v[44:47], v[152:155], v[64:67]
  v_and_b32 v48, v52, v31
  v_and_b32 v49, v53, v31
  v_and_b32 v50, v54, v31
  v_and_b32 v51, v55, v31
  s_waitcnt vmcnt(24)
  s_nop 0
  v_mfma_f32_16x16x32_bf16 v[64:67], v[48:51], v[156:159], v[64:67]
  v_and_b32 v44, v52, v32
  v_and_b32 v45, v53, v32
  v_and_b32 v46, v54, v32
  v_and_b32 v47, v55, v32
  s_waitcnt vmcnt(23)
  s_nop 0
  v_mfma_f32_16x16x32_bf16 v[64:67], v[44:47], v[160:163], v[64:67]
  v_and_b32 v48, v52, v33
  v_and_b32 v49, v53, v33
  v_and_b32 v50, v54, v33
  v_and_b32 v51, v55, v33
  s_waitcnt vmcnt(22)
  s_nop 0
  v_mfma_f32_16x16x32_bf16 v[64:67], v[48:51], v[164:167], v[64:67]
  v_and_b32 v44, v52, v34
  v_and_b32 v45, v53, v34
  v_and_b32 v46, v54, v34
  v_and_b32 v47, v55, v34
  s_waitcnt vmcnt(21)
  s_nop 0
  v_mfma_f32_16x16x32_bf16 v[64:67], v[44:47], v[168:171], v[64:67]
  v_and_b32 v48, v52, v35
  v_and_b32 v49, v53, v35
  v_and_b32 v50, v54, v35
  v_and_b32 v51, v55, v35
  s_waitcnt vmcnt(20)
  s_nop 0
  v_mfma_f32_16x16x32_bf16 v[64:67], v[48:51], v[172:175], v[64:67]
  v_and_b32 v44, v52, v36
  v_and_b32 v45, v53, v36
  v_and_b32 v46, v54, v36
  v_and_b32 v47, v55, v36
  s_waitcnt vmcnt(19)
  s_nop 0
  v_mfma_f32_16x16x32_bf16 v[64:67], v[44:47], v[176:179], v[64:67]
  v_and_b32 v48, v52, v37
  v_and_b32 v49, v53, v37
  v_and_b32 v50, v54, v37
  v_and_b32 v51, v55, v37
  s_waitcnt vmcnt(18)
  s_nop 0
  v_mfma_f32_16x16x32_bf16 v[64:67], v[48:51], v[180:183], v[64:67]
  v_and_b32 v44, v52, v38
  v_and_b32 v45, v53, v38
  v_and_b32 v46, v54, v38
  v_and_b32 v47, v55, v38
  s_waitcnt vmcnt(17)
  s_nop 0
  v_mfma_f32_16x16x32_bf16 v[64:67], v[44:47], v[184:187], v[64:67]
  v_and_b32 v48, v52, v39
  v_and_b32 v49, v53, v39
  v_and_b32 v50, v54, v39
  v_and_b32 v51, v55, v39
  s_waitcnt vmcnt(16)
  s_nop 0
  v_mfma_f32_16x16x32_bf16 v[64:67], v[48:51], v[188:191], v[64:67]
  v_and_b32 v44, v52, v40
  v_and_b32 v45, v53, v40
  v_and_b32 v46, v54, v40
  v_and_b32 v47, v55, v40
  s_waitcnt vmcnt(15)
  s_nop 0
  v_mfma_f32_16x16x32_bf16 v[64:67], v[44:47], v[192:195], v[64:67]
  v_and_b32 v48, v52, v41
  v_and_b32 v49, v53, v41
  v_and_b32 v50, v54, v41
  v_and_b32 v51, v55, v41
  s_waitcnt vmcnt(14)
  s_nop 0
  v_mfma_f32_16x16x32_bf16 v[64:67], v[48:51], v[196:199], v[64:67]
  v_and_b32 v44, v52, v42
  v_and_b32 v45, v53, v42
  v_and_b32 v46, v54, v42
  v_and_b32 v47, v55, v42
  s_waitcnt vmcnt(13)
  s_nop 0
  v_mfma_f32_16x16x32_bf16 v[64:67], v[44:47], v[200:203], v[64:67]
  v_and_b32 v48, v52, v43
  v_and_b32 v49, v53, v43
  v_and_b32 v50, v54, v43
  v_and_b32 v51, v55, v43
  s_waitcnt vmcnt(12)
  s_nop 0
  v_mfma_f32_16x16x32_bf16 v[64:67], v[48:51], v[204:207], v[64:67]
  v_and_b32 v44, v52, v56
  v_and_b32 v45, v53, v56
  v_and_b32 v46, v54, v56
  v_and_b32 v47, v55, v56
  s_waitcnt vmcnt(11)
  s_nop 0
  v_mfma_f32_16x16x32_bf16 v[64:67], v[44:47], v[208:211], v[64:67]
  v_and_b32 v48, v52, v57
  v_and_b32 v49, v53, v57
  v_and_b32 v50, v54, v57
  v_and_b32 v51, v55, v57
  s_waitcnt vmcnt(10)
  s_nop 0
  v_mfma_f32_16x16x32_bf16 v[64:67], v[48:51], v[212:215], v[64:67]
  v_and_b32 v44, v52, v58
  v_and_b32 v45, v53, v58
  v_and_b32 v46, v54, v58
  v_and_b32 v47, v55, v58
  s_waitcnt vmcnt(9)
  s_nop 0
  v_mfma_f32_16x16x32_bf16 v[64:67], v[44:47], v[216:219], v[64:67]
  v_and_b32 v48, v52, v59
  v_and_b32 v49, v53, v59
  v_and_b32 v50, v54, v59
  v_and_b32 v51, v55, v59
  s_waitcnt vmcnt(8)
  s_nop 0
  v_mfma_f32_16x16x32_bf16 v[64:67], v[48:51], v[220:223], v[64:67]
  v_and_b32 v44, v52, v60
  v_and_b32 v45, v53, v60
  v_and_b32 v46, v54, v60
  v_and_b32 v47, v55, v60
  s_waitcnt vmcnt(7)
  s_nop 0
  v_mfma_f32_16x16x32_bf16 v[64:67], v[44:47], v[224:227], v[64:67]
  v_and_b32 v48, v52, v61
  v_and_b32 v49, v53, v61
  v_and_b32 v50, v54, v61
  v_and_b32 v51, v55, v61
  s_waitcnt vmcnt(6)
  s_nop 0
  v_mfma_f32_16x16x32_bf16 v[64:67], v[48:51], v[228:231], v[64:67]
  v_and_b32 v44, v52, v62
  v_and_b32 v45, v53, v62
  v_and_b32 v46, v54, v62
  v_and_b32 v47, v55, v62
  s_waitcnt vmcnt(5)
  s_nop 0
  v_mfma_f32_16x16x32_bf16 v[64:67], v[44:47], v[232:235], v[64:67]
  v_and_b32 v48, v52, v63
  v_and_b32 v49, v53, v63
  v_and_b32 v50, v54, v63
  v_and_b32 v51, v55, v63
  s_waitcnt vmcnt(4)
  s_nop 0
  v_mfma_f32_16x16x32_bf16 v[64:67], v[48:51], v[236:239], v[64:67]
  v_and_b32 v44, v52, v68
  v_and_b32 v45, v53, v68
  v_and_b32 v46, v54, v68
  v_and_b32 v47, v55, v68
  s_waitcnt vmcnt(3)
  s_nop 0
  v_mfma_f32_16x16x32_bf16 v[64:67], v[44:47], v[240:243], v[64:67]
  v_and_b32 v48, v52, v69
  v_and_b32 v49, v53, v69
  v_and_b32 v50, v54, v69
  v_and_b32 v51, v55, v69
  s_waitcnt vmcnt(2)
  s_nop 0
  v_mfma_f32_16x16x32_bf16 v[64:67], v[48:51], v[244:247], v[64:67]
  v_and_b32 v44, v52, v70
  v_and_b32 v45, v53, v70
  v_and_b32 v46, v54, v70
  v_and_b32 v47, v55, v70
  s_waitcnt vmcnt(1)
  s_nop 0
  v_mfma_f32_16x16x32_bf16 v[64:67], v[44:47], v[248:251], v[64:67]
  v_and_b32 v48, v52, v71
  v_and_b32 v49, v53, v71
  v_and_b32 v50, v54, v71
  v_and_b32 v51, v55, v71
  s_waitcnt vmcnt(0)
  s_nop 0
  v_mfma_f32_16x16x32_bf16 v[64:67], v[48:51], v[252:255], v[64:67]
  v_lshlrev_b32 v7, 1, v24
  v_lshl_add_u32 v7, v25, 4, v7
  s_lshl_b32 s26, s60, 4
  s_add_u32 s26, s26, s61
  s_lshl_b32 s26, s26, 11
  s_lshl_b32 s27, s17, 9
  s_add_u32 s26, s26, s27
  s_add_u32 s26, s26, 188743680
  s_mov_b32 exec_hi, 0
  buffer_store_dwordx4 v[64:67], v7, s[4:7], s26 offen sc1
  s_mov_b64 exec, -1
  s_lshl_b32 s26, s60, 10
  s_add_u32 s26, s26, 5279744
  s_lshl_b32 s27, s61, 4
  s_lshl_b32 s28, s17, 2
  s_add_u32 s27, s27, s28
  v_mov_b32 v28, s79
  v_mov_b32 v29, s27
  s_waitcnt vmcnt(0)
  s_mov_b64 exec, 1
  buffer_store_dword v28, v29, s[4:7], s26 offen sc1
  s_mov_b64 exec, -1
  s_cmp_lg_u32 s27, 0
  s_cbranch_scc1 m_done_96
  s_add_u32 s27, s32, 167772160
  s_add_u32 s28, s32, 176160768
  buffer_load_dwordx4 v[24:27], v0, s[4:7], s27 offen sc1
  buffer_load_dwordx4 v[28:31], v0, s[4:7], s28 offen sc1
  s_mov_b32 s67, 0
m_w_97:
  buffer_load_dword v32, v2, s[4:7], s26 offen sc1
  s_add_u32 s67, s67, 1
  s_cmp_gt_u32 s67, 1048576
  s_cbranch_scc1 L_end
  s_waitcnt vmcnt(0)
  v_cmp_gt_u32 vcc, s79, v32
  s_cbranch_vccnz m_w_97
  s_lshl_b32 s26, s60, 15
  s_add_u32 s26, s26, 188743680
  v_lshlrev_b32 v7, 1, v0
  buffer_load_dwordx4 v[72:75], v7, s[4:7], s26 offen offset:0 sc1
  buffer_load_dwordx4 v[76:79], v7, s[4:7], s26 offen offset:16 sc1
  buffer_load_dwordx4 v[80:83], v7, s[4:7], s26 offen offset:2048 sc1
  buffer_load_dwordx4 v[84:87], v7, s[4:7], s26 offen offset:2064 sc1
  s_add_u32 s26, s26, 4096
  buffer_load_dwordx4 v[88:91], v7, s[4:7], s26 offen offset:0 sc1
  buffer_load_dwordx4 v[92:95], v7, s[4:7], s26 offen offset:16 sc1
  buffer_load_dwordx4 v[96:99], v7, s[4:7], s26 offen offset:2048 sc1
  buffer_load_dwordx4 v[100:103], v7, s[4:7], s26 offen offset:2064 sc1
  s_add_u32 s26, s26, 4096
  buffer_load_dwordx4 v[104:107], v7, s[4:7], s26 offen offset:0 sc1
  buffer_load_dwordx4 v[108:111], v7, s[4:7], s26 offen offset:16 sc1
  buffer_load_dwordx4 v[112:115], v7, s[4:7], s26 offen offset:2048 sc1
  buffer_load_dwordx4 v[116:119], v7, s[4:7], s26 offen offset:2064 sc1
  s_add_u32 s26, s26, 4096
  buffer_load_dwordx4 v[120:123], v7, s[4:7], s26 offen offset:0 sc1
  buffer_load_dwordx4 v[124:127], v7, s[4:7], s26 offen offset:16 sc1
  buffer_load_dwordx4 v[128:131], v7, s[4:7], s26 offen offset:2048 sc1
  buffer_load_dwordx4 v[132:135], v7, s[4:7], s26 offen offset:2064 sc1
  s_add_u32 s26, s26, 4096
  buffer_load_dwordx4 v[136:139], v7, s[4:7], s26 offen offset:0 sc1
  buffer_load_dwordx4 v[140:143], v7, s[4:7], s26 offen offset:16 sc1
  buffer_load_dwordx4 v[144:147], v7, s[4:7], s26 offen offset:2048 sc1
  buffer_load_dwordx4 v[148:151], v7, s[4:7], s26 offen offset:2064 sc1
  s_add_u32 s26, s26, 4096
  buffer_load_dwordx4 v[152:155], v7, s[4:7], s26 offen offset:0 sc1
  buffer_load_dwordx4 v[156:159], v7, s[4:7], s26 offen offset:16 sc1
  buffer_load_dwordx4 v[160:163], v7, s[4:7], s26 offen offset:2048 sc1
  buffer_load_dwordx4 v[164:167], v7, s[4:7], s26 offen offset:2064 sc1
  s_add_u32 s26, s26, 4096
  buffer_load_dwordx4 v[168:171], v7, s[4:7], s26 offen offset:0 sc1
  buffer_load_dwordx4 v[172:175], v7, s[4:7], s26 offen offset:16 sc1
  buffer_load_dwordx4 v[176:179], v7, s[4:7], s26 offen offset:2048 sc1
  buffer_load_dwordx4 v[180:183], v7, s[4:7], s26 offen offset:2064 sc1
  s_add_u32 s26, s26, 4096
  buffer_load_dwordx4 v[184:187], v7, s[4:7], s26 offen offset:0 sc1
  buffer_load_dwordx4 v[188:191], v7, s[4:7], s26 offen offset:16 sc1
  buffer_load_dwordx4 v[192:195], v7, s[4:7], s26 offen offset:2048 sc1
  buffer_load_dwordx4 v[196:199], v7, s[4:7], s26 offen offset:2064 sc1
  s_add_u32 s26, s26, 4096
  v_lshlrev_b32 v32, 16, v24
  v_and_b32 v33, 0xffff0000, v24
  v_lshlrev_b32 v34, 16, v25
  v_and_b32 v35, 0xffff0000, v25
  v_lshlrev_b32 v36, 16, v26
  v_and_b32 v37, 0xffff0000, v26
  v_lshlrev_b32 v38, 16, v27
  v_and_b32 v39, 0xffff0000, v27
  v_lshlrev_b32 v40, 16, v28
  v_and_b32 v41, 0xffff0000, v28
  v_lshlrev_b32 v42, 16, v29
  v_and_b32 v43, 0xffff0000, v29
  v_lshlrev_b32 v44, 16, v30
  v_and_b32 v45, 0xffff0000, v30
  v_lshlrev_b32 v46, 16, v31
  v_and_b32 v47, 0xffff0000, v31
  s_and_b32 s26, s78, 0xffff0000
  s_xor_b32 s27, s26, 0x80000000
  s_xor_b32 s28, s26, 0xffff0000
  s_bitcmp1_b32 s26, 31
  s_cselect_b32 s26, s27, s28
  v_mov_b32 v52, s26
  v_mul_f32 v52, 0xbfb8aa3b, v52
  v_exp_f32 v52, v52
  s_nop 0
  v_add_f32 v52, 1.0, v52
  v_rcp_f32 v52, v52
  s_nop 0
  v_cvt_pk_bf16_f32 v52, v52, v52
  v_and_b32 v52, 0xffff0000, v52
  s_waitcnt vmcnt(28)
  v_pk_add_f32 v[72:73], v[72:73], v[80:81]
  v_pk_add_f32 v[74:75], v[74:75], v[82:83]
  v_pk_add_f32 v[76:77], v[76:77], v[84:85]
  v_pk_add_f32 v[78:79], v[78:79], v[86:87]
  s_waitcnt vmcnt(26)
  v_pk_add_f32 v[72:73], v[72:73], v[88:89]
  v_pk_add_f32 v[74:75], v[74:75], v[90:91]
  v_pk_add_f32 v[76:77], v[76:77], v[92:93]
  v_pk_add_f32 v[78:79], v[78:79], v[94:95]
  s_waitcnt vmcnt(24)
  v_pk_add_f32 v[72:73], v[72:73], v[96:97]
  v_pk_add_f32 v[74:75], v[74:75], v[98:99]
  v_pk_add_f32 v[76:77], v[76:77], v[100:101]
  v_pk_add_f32 v[78:79], v[78:79], v[102:103]
  s_waitcnt vmcnt(22)
  v_pk_add_f32 v[72:73], v[72:73], v[104:105]
  v_pk_add_f32 v[74:75], v[74:75], v[106:107]
  v_pk_add_f32 v[76:77], v[76:77], v[108:109]
  v_pk_add_f32 v[78:79], v[78:79], v[110:111]
  s_waitcnt vmcnt(20)
  v_pk_add_f32 v[72:73], v[72:73], v[112:113]
  v_pk_add_f32 v[74:75], v[74:75], v[114:115]
  v_pk_add_f32 v[76:77], v[76:77], v[116:117]
  v_pk_add_f32 v[78:79], v[78:79], v[118:119]
  s_waitcnt vmcnt(18)
  v_pk_add_f32 v[72:73], v[72:73], v[120:121]
  v_pk_add_f32 v[74:75], v[74:75], v[122:123]
  v_pk_add_f32 v[76:77], v[76:77], v[124:125]
  v_pk_add_f32 v[78:79], v[78:79], v[126:127]
  s_waitcnt vmcnt(16)
  v_pk_add_f32 v[72:73], v[72:73], v[128:129]
  v_pk_add_f32 v[74:75], v[74:75], v[130:131]
  v_pk_add_f32 v[76:77], v[76:77], v[132:133]
  v_pk_add_f32 v[78:79], v[78:79], v[134:135]
  s_waitcnt vmcnt(14)
  v_pk_add_f32 v[72:73], v[72:73], v[136:137]
  v_pk_add_f32 v[74:75], v[74:75], v[138:139]
  v_pk_add_f32 v[76:77], v[76:77], v[140:141]
  v_pk_add_f32 v[78:79], v[78:79], v[142:143]
  s_waitcnt vmcnt(12)
  v_pk_add_f32 v[72:73], v[72:73], v[144:145]
  v_pk_add_f32 v[74:75], v[74:75], v[146:147]
  v_pk_add_f32 v[76:77], v[76:77], v[148:149]
  v_pk_add_f32 v[78:79], v[78:79], v[150:151]
  s_waitcnt vmcnt(10)
  v_pk_add_f32 v[72:73], v[72:73], v[152:153]
  v_pk_add_f32 v[74:75], v[74:75], v[154:155]
  v_pk_add_f32 v[76:77], v[76:77], v[156:157]
  v_pk_add_f32 v[78:79], v[78:79], v[158:159]
  s_waitcnt vmcnt(8)
  v_pk_add_f32 v[72:73], v[72:73], v[160:161]
  v_pk_add_f32 v[74:75], v[74:75], v[162:163]
  v_pk_add_f32 v[76:77], v[76:77], v[164:165]
  v_pk_add_f32 v[78:79], v[78:79], v[166:167]
  s_waitcnt vmcnt(6)
  v_pk_add_f32 v[72:73], v[72:73], v[168:169]
  v_pk_add_f32 v[74:75], v[74:75], v[170:171]
  v_pk_add_f32 v[76:77], v[76:77], v[172:173]
  v_pk_add_f32 v[78:79], v[78:79], v[174:175]
  s_waitcnt vmcnt(4)
  v_pk_add_f32 v[72:73], v[72:73], v[176:177]
  v_pk_add_f32 v[74:75], v[74:75], v[178:179]
  v_pk_add_f32 v[76:77], v[76:77], v[180:181]
  v_pk_add_f32 v[78:79], v[78:79], v[182:183]
  s_waitcnt vmcnt(2)
  v_pk_add_f32 v[72:73], v[72:73], v[184:185]
  v_pk_add_f32 v[74:75], v[74:75], v[186:187]
  v_pk_add_f32 v[76:77], v[76:77], v[188:189]
  v_pk_add_f32 v[78:79], v[78:79], v[190:191]
  s_waitcnt vmcnt(0)
  v_pk_add_f32 v[72:73], v[72:73], v[192:193]
  v_pk_add_f32 v[74:75], v[74:75], v[194:195]
  v_pk_add_f32 v[76:77], v[76:77], v[196:197]
  v_pk_add_f32 v[78:79], v[78:79], v[198:199]
  v_cvt_pk_bf16_f32 v48, v72, v73
  v_cvt_pk_bf16_f32 v49, v74, v75
  v_cvt_pk_bf16_f32 v50, v76, v77
  v_cvt_pk_bf16_f32 v51, v78, v79
  v_lshlrev_b32 v72, 16, v48
  v_and_b32 v73, 0xffff0000, v48
  v_lshlrev_b32 v74, 16, v49
  v_and_b32 v75, 0xffff0000, v49
  v_lshlrev_b32 v76, 16, v50
  v_and_b32 v77, 0xffff0000, v50
  v_lshlrev_b32 v78, 16, v51
  v_and_b32 v79, 0xffff0000, v51
  v_mul_f32 v72, v72, v52
  v_mul_f32 v73, v73, v52
  v_mul_f32 v74, v74, v52
  v_mul_f32 v75, v75, v52
  v_mul_f32 v76, v76, v52
  v_mul_f32 v77, v77, v52
  v_mul_f32 v78, v78, v52
  v_mul_f32 v79, v79, v52
  v_cvt_pk_bf16_f32 v48, v72, v73
  v_cvt_pk_bf16_f32 v49, v74, v75
  v_cvt_pk_bf16_f32 v50, v76, v77
  v_cvt_pk_bf16_f32 v51, v78, v79
  v_lshlrev_b32 v72, 16, v48
  v_and_b32 v73, 0xffff0000, v48
  v_lshlrev_b32 v74, 16, v49
  v_and_b32 v75, 0xffff0000, v49
  v_lshlrev_b32 v76, 16, v50
  v_and_b32 v77, 0xffff0000, v50
  v_lshlrev_b32 v78, 16, v51
  v_and_b32 v79, 0xffff0000, v51
  v_add_f32 v72, v72, v40
  v_add_f32 v73, v73, v41
  v_add_f32 v74, v74, v42
  v_add_f32 v75, v75, v43
  v_add_f32 v76, v76, v44
  v_add_f32 v77, v77, v45
  v_add_f32 v78, v78, v46
  v_add_f32 v79, v79, v47
  v_cvt_pk_bf16_f32 v48, v72, v73
  v_cvt_pk_bf16_f32 v49, v74, v75
  v_cvt_pk_bf16_f32 v50, v76, v77
  v_cvt_pk_bf16_f32 v51, v78, v79
  v_lshlrev_b32 v72, 16, v48
  v_and_b32 v73, 0xffff0000, v48
  v_lshlrev_b32 v74, 16, v49
  v_and_b32 v75, 0xffff0000, v49
  v_lshlrev_b32 v76, 16, v50
  v_and_b32 v77, 0xffff0000, v50
  v_lshlrev_b32 v78, 16, v51
  v_and_b32 v79, 0xffff0000, v51
  v_add_f32 v32, v32, v72
  v_add_f32 v33, v33, v73
  v_add_f32 v34, v34, v74
  v_add_f32 v35, v35, v75
  v_add_f32 v36, v36, v76
  v_add_f32 v37, v37, v77
  v_add_f32 v38, v38, v78
  v_add_f32 v39, v39, v79
  v_cvt_pk_bf16_f32 v48, v32, v33
  v_cvt_pk_bf16_f32 v49, v34, v35
  v_cvt_pk_bf16_f32 v50, v36, v37
  v_cvt_pk_bf16_f32 v51, v38, v39
  v_lshlrev_b32 v32, 16, v48
  v_and_b32 v33, 0xffff0000, v48
  v_lshlrev_b32 v34, 16, v49
  v_and_b32 v35, 0xffff0000, v49
  v_lshlrev_b32 v36, 16, v50
  v_and_b32 v37, 0xffff0000, v50
  v_lshlrev_b32 v38, 16, v51
  v_and_b32 v39, 0xffff0000, v51
  s_lshl_b32 s26, s77, 10
  s_cmp_lg_u32 s64, 0
  s_cbranch_scc1 m_f2_98
  s_add_u32 s27, s26, 10485760
  buffer_store_dwordx4 v[48:51], v0, s[4:7], s27 offen sc1
  v_add_f32 v52, v32, v33
  v_add_f32 v53, v34, v35
  v_add_f32 v54, v36, v37
  v_add_f32 v55, v38, v39
  v_add_f32 v52, v52, v53
  v_add_f32 v54, v54, v55
  v_add_f32 v52, v52, v54
  s_nop 1
  v_add_f32_dpp v52, v52, v52 row_ror:8 row_mask:0xf bank_mask:0xf
  s_nop 1
  v_add_f32_dpp v52, v52, v52 row_ror:4 row_mask:0xf bank_mask:0xf
  s_nop 1
  v_add_f32_dpp v52, v52, v52 row_ror:2 row_mask:0xf bank_mask:0xf
  s_nop 1
  v_add_f32_dpp v52, v52, v52 row_ror:1 row_mask:0xf bank_mask:0xf
  v_mov_b32 v54, v52
  s_nop 0
  s_nop 0
  v_permlane16_swap_b32 v52, v54
  v_add_f32 v52, v52, v54
  v_mov_b32 v54, v52
  s_nop 0
  s_nop 0
  v_permlane32_swap_b32 v52, v54
  v_add_f32 v52, v52, v54
  v_mul_f32 v52, 0x3b000000, v52
  v_sub_f32 v56, v32, v52
  v_sub_f32 v57, v33, v52
  v_sub_f32 v58, v34, v52
  v_sub_f32 v59, v35, v52
  v_sub_f32 v60, v36, v52
  v_sub_f32 v61, v37, v52
  v_sub_f32 v62, v38, v52
  v_sub_f32 v63, v39, v52
  v_mul_f32 v53, v56, v56
  v_mul_f32 v54, v57, v57
  v_fmac_f32 v53, v58, v58
  v_fmac_f32 v54, v59, v59
  v_fmac_f32 v53, v60, v60
  v_fmac_f32 v54, v61, v61
  v_fmac_f32 v53, v62, v62
  v_fmac_f32 v54, v63, v63
  v_add_f32 v53, v53, v54
  v_cvt_pk_bf16_f32 v52, v52, v52
  v_and_b32 v52, 0xffff0000, v52
  v_add_f32_dpp v53, v53, v53 row_ror:8 row_mask:0xf bank_mask:0xf
  s_nop 1
  v_add_f32_dpp v53, v53, v53 row_ror:4 row_mask:0xf bank_mask:0xf
  s_nop 1
  v_add_f32_dpp v53, v53, v53 row_ror:2 row_mask:0xf bank_mask:0xf
  s_nop 1
  v_add_f32_dpp v53, v53, v53 row_ror:1 row_mask:0xf bank_mask:0xf
  v_mov_b32 v54, v53
  s_nop 0
  s_nop 0
  v_permlane16_swap_b32 v53, v54
  v_add_f32 v53, v53, v54
  v_mov_b32 v54, v53
  s_nop 0
  s_nop 0
  v_permlane32_swap_b32 v53, v54
  v_add_f32 v53, v53, v54
  v_sub_f32 v56, v32, v52
  v_sub_f32 v57, v33, v52
  v_sub_f32 v58, v34, v52
  v_sub_f32 v59, v35, v52
  v_sub_f32 v60, v36, v52
  v_sub_f32 v61, v37, v52
  v_sub_f32 v62, v38, v52
  v_sub_f32 v63, v39, v52
  v_mul_f32 v53, 0x3b000000, v53
  v_cvt_pk_bf16_f32 v53, v53, v53
  v_and_b32 v53, 0xffff0000, v53
  v_add_f32 v53, 0x3727c5ac, v53
  v_cvt_pk_bf16_f32 v53, v53, v53
  v_and_b32 v53, 0xffff0000, v53
  v_sqrt_f32 v53, v53
  v_cvt_pk_bf16_f32 v72, v56, v57
  v_cvt_pk_bf16_f32 v73, v58, v59
  v_cvt_pk_bf16_f32 v74, v60, v61
  v_cvt_pk_bf16_f32 v75, v62, v63
  v_cvt_pk_bf16_f32 v53, v53, v53
  v_and_b32 v53, 0xffff0000, v53
  v_rcp_f32 v53, v53
  v_lshlrev_b32 v56, 16, v72
  v_and_b32 v57, 0xffff0000, v72
  v_lshlrev_b32 v58, 16, v73
  v_and_b32 v59, 0xffff0000, v73
  v_lshlrev_b32 v60, 16, v74
  v_and_b32 v61, 0xffff0000, v74
  v_lshlrev_b32 v62, 16, v75
  v_and_b32 v63, 0xffff0000, v75
  v_mul_f32 v56, v56, v53
  v_mul_f32 v57, v57, v53
  v_mul_f32 v58, v58, v53
  v_mul_f32 v59, v59, v53
  v_mul_f32 v60, v60, v53
  v_mul_f32 v61, v61, v53
  v_mul_f32 v62, v62, v53
  v_mul_f32 v63, v63, v53
  v_cvt_pk_bf16_f32 v72, v56, v57
  v_cvt_pk_bf16_f32 v73, v58, v59
  v_cvt_pk_bf16_f32 v74, v60, v61
  v_cvt_pk_bf16_f32 v75, v62, v63
  s_add_u32 s27, s26, 8388608
  buffer_store_dwordx4 v[72:75], v0, s[4:7], s27 offen sc1
  v_mov_b32 v76, 1
  s_mov_b32 s27, 5283840
  s_waitcnt vmcnt(0)
  buffer_store_dword v76, v2, s[4:7], s27 offen sc1
  s_branch m_f3_99
m_f2_98:
  buffer_store_dwordx4 v[48:51], v0, s[68:71], s26 offen sc1
m_f3_99:
m_done_96:
o_nomlp_81:
  s_cmp_lg_u32 s64, 0
  s_cbranch_scc1 o_fin_82
  s_mov_b32 s64, 1
  s_mov_b32 s65, 2
  s_mov_b32 s66, 2
  s_mov_b32 s63, s60
  s_branch o_loop_80
o_fin_82:
  s_endpgm
.p2align 2
qkv_tab:
.long 0x830300, 0x830280, 0x860303, 0x860283, 0x890306, 0x890286, 0x8c0309, 0x8c0289, 0x8f030c, 0x8f028c, 0x92030f, 0x92028f, 0x950312, 0x950292, 0x980315, 0x980295, 0x9b0318, 0x9b0298, 0x9e031b, 0x9e029b, 0xa1031e, 0xa1029e, 0xa40321, 0xa402a1, 0xa70324, 0xa702a4, 0xaa0327, 0xaa02a7, 0xad032a, 0xad02aa, 0xb0032d, 0xb002ad, 0xb30330, 0xb302b0, 0xb60333, 0xb602b3, 0xb90336, 0xb902b6, 0xbc0339, 0xbc02b9, 0xbf033c, 0xbf02bc, 0xc0033f, 0xc002bf, 0xc30340, 0xc302c0, 0xc60343, 0xc602c3, 0xc90346, 0xc902c6, 0xcc0349, 0xcc02c9, 0xcf034c, 0xcf02cc, 0xd2034f, 0xd202cf, 0xd50352, 0xd502d2, 0xd80355, 0xd802d5, 0xdb0358, 0xdb02d8, 0xde035b, 0xde02db, 0xe1035e, 0xe102de, 0xe40361, 0xe402e1, 0xe70364, 0xe702e4, 0xea0367, 0xea02e7, 0xed036a, 0xed02ea, 0xf0036d, 0xf002ed, 0xf30370, 0xf302f0, 0xf60373, 0xf602f3, 0xf90376, 0xf902f6, 0xfc0379, 0xfc02f9, 0xff037c, 0xff02fc, 0x37f, 0x2ff, 0x0, 0x0
.long 0x840301, 0x840281, 0x870304, 0x870284, 0x8a0307, 0x8a0287, 0x8d030a, 0x8d028a, 0x90030d, 0x90028d, 0x930310, 0x930290, 0x960313, 0x960293, 0x990316, 0x990296, 0x9c0319, 0x9c0299, 0x9f031c, 0x9f029c, 0xa2031f, 0xa2029f, 0xa50322, 0xa502a2, 0xa80325, 0xa802a5, 0xab0328, 0xab02a8, 0xae032b, 0xae02ab, 0xb1032e, 0xb102ae, 0xb40331, 0xb402b1, 0xb70334, 0xb702b4, 0xba0337, 0xba02b7, 0xbd033a, 0xbd02ba, 0xc1033d, 0xc102bd, 0xc40341, 0xc402c1, 0xc70344, 0xc702c4, 0xca0347, 0xca02c7, 0xcd034a, 0xcd02ca, 0xd0034d, 0xd002cd, 0xd30350, 0xd302d0, 0xd60353, 0xd602d3, 0xd90356, 0xd902d6, 0xdc0359, 0xdc02d9, 0xdf035c, 0xdf02dc, 0xe2035f, 0xe202df, 0xe50362, 0xe502e2, 0xe80365, 0xe802e5, 0xeb0368, 0xeb02e8, 0xee036b, 0xee02eb, 0xf1036e, 0xf102ee, 0xf40371, 0xf402f1, 0xf70374, 0xf702f4, 0xfa0377, 0xfa02f7, 0xfd037a, 0xfd02fa, 0x37d, 0x2fd, 0x0, 0x0, 0x0, 0x0, 0x0, 0x0
.long 0x850302, 0x850282, 0x880305, 0x880285, 0x8b0308, 0x8b0288, 0x8e030b, 0x8e028b, 0x91030e, 0x91028e, 0x940311, 0x940291, 0x970314, 0x970294, 0x9a0317, 0x9a0297, 0x9d031a, 0x9d029a, 0xa0031d, 0xa0029d, 0xa30320, 0xa302a0, 0xa60323, 0xa602a3, 0xa90326, 0xa902a6, 0xac0329, 0xac02a9, 0xaf032c, 0xaf02ac, 0xb2032f, 0xb202af, 0xb50332, 0xb502b2, 0xb80335, 0xb802b5, 0xbb0338, 0xbb02b8, 0xbe033b, 0xbe02bb, 0xc2033e, 0xc202be, 0xc50342, 0xc502c2, 0xc80345, 0xc802c5, 0xcb0348, 0xcb02c8, 0xce034b, 0xce02cb, 0xd1034e, 0xd102ce, 0xd40351, 0xd402d1, 0xd70354, 0xd702d4, 0xda0357, 0xda02d7, 0xdd035a, 0xdd02da, 0xe0035d, 0xe002dd, 0xe30360, 0xe302e0, 0xe60363, 0xe602e3, 0xe90366, 0xe902e6, 0xec0369, 0xec02e9, 0xef036c, 0xef02ec, 0xf2036f, 0xf202ef, 0xf50372, 0xf502f2, 0xf80375, 0xf802f5, 0xfb0378, 0xfb02f8, 0xfe037b, 0xfe02fb, 0x37e, 0x2fe, 0x0, 0x0, 0x0, 0x0, 0x0, 0x0

.section .rodata,"a"
.p2align 6
.amdhsa_kernel interleave_layers__memory_aug_recurrent_mem_tr__moe_arch_mod__prompt_kernel
  .amdhsa_next_free_vgpr 512
  .amdhsa_next_free_sgpr 102
  .amdhsa_accum_offset 256
  .amdhsa_group_segment_fixed_size 0
  .amdhsa_kernarg_size 120
  .amdhsa_user_sgpr_count 2
  .amdhsa_user_sgpr_kernarg_segment_ptr 1
  .amdhsa_system_sgpr_workgroup_id_x 1
  .amdhsa_float_denorm_mode_32 3
.end_amdhsa_kernel
```

```asm
; @launch grid=(256,1,1) block=(256,1,1) lds=163840
.amdgcn_target "amdgcn-amd-amdhsa--gfx950"
.text
.globl interleave_layers__memory_aug_recurrent_mem_tr__moe_arch_mod__prompt_kernel
.p2align 8
.type interleave_layers__memory_aug_recurrent_mem_tr__moe_arch_mod__prompt_kernel,@function
interleave_layers__memory_aug_recurrent_mem_tr__moe_arch_mod__prompt_kernel:
  s_cmp_ge_u32 s2, 256
  s_cbranch_scc1 L_end
  s_load_dwordx2 s[4:5], s[0:1], 112
  s_load_dwordx2 s[12:13], s[0:1], 104
  s_mov_b32 s6, 268435456
  s_mov_b32 s7, 0x20000
  s_mov_b32 s11, 0x20000
  s_getreg_b32 s91, hwreg(HW_REG_XCC_ID)
  s_and_b32 s91, s91, 7
  v_lshrrev_b32 v1, 6, v0
  v_mov_b32 v2, 0
  v_readfirstlane_b32 s17, v1
  s_waitcnt lgkmcnt(0)
  s_cmp_lg_u32 s17, 0
  s_cbranch_scc1 L_got
  s_lshl_b32 s26, s91, 4
  v_mov_b32 v3, s26
  v_mov_b32 v4, 1
  s_mov_b64 exec, 1
  global_atomic_add v5, v3, v4, s[12:13] sc0
  s_mov_b64 exec, -1
  s_waitcnt vmcnt(0)
  v_readfirstlane_b32 s90, v5
  s_cmp_ge_u32 s90, 32
  s_cbranch_scc1 L_ovf
  s_lshl_b32 s26, s91, 5
  s_add_u32 s90, s90, s26
L_pub:
  v_mov_b32 v3, s90
  ds_write_b32 v2, v3
  s_waitcnt lgkmcnt(0)
L_got:
  s_barrier
  ds_read_b32 v3, v2
  s_waitcnt lgkmcnt(0)
  v_readfirstlane_b32 s90, v3
  s_barrier
  s_cmp_ge_u32 s90, 256
  s_cbranch_scc1 L_end
  s_lshl_b32 s100, s90, 2
  s_add_u32 s100, s100, s17
  s_lshl_b32 s100, s100, 12
  s_add_u32 s100, s100, 37748736
  s_lshr_b32 s91, s90, 5
  s_cmp_lt_u32 s91, 3
  s_cbranch_scc1 L_chain
  s_cmp_lt_u32 s91, 6
  s_cbranch_scc1 L_qkv
  s_branch L_o
L_ovf:
  v_mov_b32 v3, 128
  s_mov_b64 exec, 1
  global_atomic_add v5, v3, v4, s[12:13] sc0
  s_mov_b64 exec, -1
  s_waitcnt vmcnt(0)
  v_readfirstlane_b32 s37, v5
  v_lshlrev_b32 v6, 4, v0
  s_mov_b32 s26, 0
  s_mov_b32 s90, 256
L_ovw:
  v_and_b32 v7, 0x70, v6
  global_load_dword v8, v7, s[12:13] sc1
  s_waitcnt vmcnt(0)
  v_readlane_b32 s28, v8, 0
  v_readlane_b32 s29, v8, 1
  v_readlane_b32 s30, v8, 2
  v_readlane_b32 s31, v8, 3
  v_readlane_b32 s32, v8, 4
  v_readlane_b32 s33, v8, 5
  v_readlane_b32 s34, v8, 6
  v_readlane_b32 s35, v8, 7
  s_add_u32 s27, s28, s29
  s_add_u32 s27, s27, s30
  s_add_u32 s27, s27, s31
  s_add_u32 s27, s27, s32
  s_add_u32 s27, s27, s33
  s_add_u32 s27, s27, s34
  s_add_u32 s27, s27, s35
  s_add_u32 s26, s26, 1
  s_cmp_gt_u32 s26, 1048576
  s_cbranch_scc1 L_pub
  s_cmp_lt_u32 s27, 256
  s_cbranch_scc1 L_ovw
  s_min_u32 s28, s28, 32
  s_add_u32 s37, s37, s28
  s_add_u32 s90, s37, 0
  s_cmp_lt_u32 s37, 32
  s_cbranch_scc1 L_pub
  s_sub_u32 s37, s37, 32
  s_min_u32 s29, s29, 32
  s_add_u32 s37, s37, s29
  s_add_u32 s90, s37, 32
  s_cmp_lt_u32 s37, 32
  s_cbranch_scc1 L_pub
  s_sub_u32 s37, s37, 32
  s_min_u32 s30, s30, 32
  s_add_u32 s37, s37, s30
  s_add_u32 s90, s37, 64
  s_cmp_lt_u32 s37, 32
  s_cbranch_scc1 L_pub
  s_sub_u32 s37, s37, 32
  s_min_u32 s31, s31, 32
  s_add_u32 s37, s37, s31
  s_add_u32 s90, s37, 96
  s_cmp_lt_u32 s37, 32
  s_cbranch_scc1 L_pub
  s_sub_u32 s37, s37, 32
  s_min_u32 s32, s32, 32
  s_add_u32 s37, s37, s32
  s_add_u32 s90, s37, 128
  s_cmp_lt_u32 s37, 32
  s_cbranch_scc1 L_pub
  s_sub_u32 s37, s37, 32
  s_min_u32 s33, s33, 32
  s_add_u32 s37, s37, s33
  s_add_u32 s90, s37, 160
  s_cmp_lt_u32 s37, 32
  s_cbranch_scc1 L_pub
  s_sub_u32 s37, s37, 32
  s_min_u32 s34, s34, 32
  s_add_u32 s37, s37, s34
  s_add_u32 s90, s37, 192
  s_cmp_lt_u32 s37, 32
  s_cbranch_scc1 L_pub
  s_sub_u32 s37, s37, 32
  s_min_u32 s35, s35, 32
  s_add_u32 s37, s37, s35
  s_add_u32 s90, s37, 224
  s_cmp_lt_u32 s37, 32
  s_cbranch_scc1 L_pub
  s_sub_u32 s37, s37, 32
  s_mov_b32 s90, 256
  s_branch L_pub
L_end:
  s_endpgm
L_chain:
  s_and_b32 s16, s90, 31
  s_mov_b32 s60, s91
  s_min_u32 s61, s91, 1
  v_lshrrev_b32 v18, 6, v0
  v_and_b32 v19, 63, v0
  v_readfirstlane_b32 s17, v18
  v_and_b32 v7, 15, v19
  v_lshrrev_b32 v17, 4, v19
  v_lshlrev_b32 v0, 4, v19
  s_mov_b32 s44, 0x05040100
  s_mov_b32 s45, 0x07060302
  s_mov_b32 s18, 0xcccccccc
  s_mov_b32 s19, 0xcccccccc
  s_mov_b32 s24, 0x3e0293ee
  s_lshl_b32 s26, s17, 10
  v_add_u32 v8, s26, v0
  v_xor_b32 v9, 1024, v8
  v_xor_b32 v10, 2048, v8
  v_xor_b32 v11, 3072, v8
  s_mov_b32 s14, 0x3f803f80
  s_mov_b32 s15, 0x3f803f80
  s_mul_i32 s27, s17, 36864
  s_add_u32 s27, s27, 16384
  s_add_u32 m0, s27, 32768
  v_add_u32 v1, s27, v0
  v_lshrrev_b32 v20, 2, v7
  v_xor_b32 v21, v17, v20
  v_lshlrev_b32 v22, 5, v7
  v_add_u32 v22, s26, v22
  v_lshl_add_u32 v2, v21, 3, v22
  v_and_b32 v21, 3, v7
  v_xor_b32 v21, v21, v17
  v_lshl_add_u32 v22, v17, 2, v20
  v_lshlrev_b32 v22, 5, v22
  v_lshl_add_u32 v3, v21, 3, v22
  v_add_u32 v12, s26, v3
  v_xor_b32 v13, 1024, v12
  v_xor_b32 v14, 2048, v12
  v_xor_b32 v15, 3072, v12
  v_lshlrev_b32 v21, 13, v20
  v_and_b32 v22, 3, v7
  v_lshl_add_u32 v22, v17, 2, v22
  v_lshl_add_u32 v21, v22, 4, v21
  s_lshl_b32 s27, s17, 16
  s_lshl_b32 s28, s16, 8
  s_add_u32 s27, s27, s28
  v_add_u32 v4, s27, v21
  v_and_b32 v21, 1, v7
  v_lshl_add_u32 v21, v17, 2, v21
  v_bfe_u32 v22, v7, 2, 1
  v_lshl_add_u32 v21, v22, 1, v21
  v_lshlrev_b32 v21, 4, v21
  v_bfe_u32 v22, v7, 1, 1
  v_lshl_add_u32 v21, v22, 3, v21
  v_add_u32 v5, s28, v21
  v_cmp_lt_u32 vcc, 7, v7
  v_mov_b32 v22, 0x7ff00000
  s_nop 0
  v_cndmask_b32 v5, v5, v22, vcc
  v_mov_b32 v21, 0x4444
  v_mov_b32 v22, 0xeeee
  v_cndmask_b32 v6, v21, v22, s[18:19]
  s_lshl_b32 s40, s60, 20
  s_add_u32 s40, s40, 0
  s_add_u32 s41, s40, 32768
  s_lshl_b32 s62, s60, 16
  s_add_u32 s62, s62, 4194304
  v_mov_b32 v24, -1
  v_mov_b32 v25, -1
  v_mov_b32 v26, -1
  v_mov_b32 v27, -1
  buffer_store_dwordx4 v[24:27], v4, s[4:7], s40 offen sc1
  buffer_store_dwordx4 v[24:27], v4, s[4:7], s41 offen sc1
  s_add_u32 s27, s62, 8192
  buffer_store_dwordx2 v[24:25], v5, s[4:7], s27 offen sc1
  s_add_u32 s27, s62, 16384
  buffer_store_dwordx2 v[24:25], v5, s[4:7], s27 offen sc1
  s_load_dwordx2 s[8:9], s[0:1], 8
  s_mov_b32 s10, 8192
  s_mov_b32 s11, 0x20000
  v_and_b32 v21, 1, v7
  v_lshl_add_u32 v21, v17, 1, v21
  v_lshlrev_b32 v21, 10, v21
  v_bfe_u32 v22, v7, 1, 2
  v_lshl_add_u32 v21, v22, 1, v21
  s_lshr_b32 s27, s16, 3
  s_lshl_b32 s27, s27, 8
  s_and_b32 s28, s16, 3
  s_lshl_b32 s28, s28, 6
  s_add_u32 s27, s27, s28
  s_and_b32 s28, s16, 4
  s_lshl_b32 s28, s28, 1
  s_add_u32 s27, s27, s28
  s_waitcnt lgkmcnt(0)
  buffer_load_ushort v28, v21, s[8:11], s27 offen
  buffer_load_ushort v29, v21, s[8:11], s27 offen offset:16
  buffer_load_ushort v30, v21, s[8:11], s27 offen offset:32
  buffer_load_ushort v31, v21, s[8:11], s27 offen offset:48
  s_waitcnt vmcnt(0)
  v_lshl_or_b32 v28, v29, 16, v28
  v_lshl_or_b32 v29, v31, 16, v30
  v_min_u32 v28, -2, v28
  v_min_u32 v29, -2, v29
  buffer_store_dwordx2 v[28:29], v5, s[4:7], s62 offen sc1
  s_waitcnt vmcnt(0)
  s_barrier
  s_lshl_b32 s38, s91, 2
  s_add_u32 s38, s38, 192
  s_cmp_lg_u32 s17, 0
  s_cbranch_scc1 g_ar_1
  v_mov_b32 v20, s38
  v_mov_b32 v21, 1
  s_mov_b64 exec, 1
  global_atomic_add v20, v21, s[12:13]
  s_mov_b64 exec, -1
g_ar_1:
  s_load_dwordx2 s[8:9], s[0:1], 40
  s_mov_b32 s10, 4194304
  s_mov_b32 s11, 0x20000
  v_and_b32 v20, 1, v17
  v_lshlrev_b32 v20, 5, v20
  v_lshrrev_b32 v21, 1, v17
  v_lshl_add_u32 v20, v21, 3, v20
  v_lshlrev_b32 v20, 10, v20
  v_lshl_add_u32 v20, v7, 4, v20
  s_lshl_b32 s26, s16, 17
  s_lshl_b32 s27, s17, 8
  s_add_u32 s26, s26, s27
  v_lshlrev_b32 v22, 5, v21
  v_and_b32 v21, 1, v17
  v_add_u32 v21, v21, v22
  v_lshlrev_b32 v21, 13, v21
  v_lshl_add_u32 v21, v7, 2, v21
  s_waitcnt lgkmcnt(0)
  s_add_u32 s27, s26, 0
  buffer_load_dwordx4 v[128:131], v20, s[8:11], s27 offen
  s_add_u32 s27, s26, 2048
  buffer_load_dwordx4 v[132:135], v20, s[8:11], s27 offen
  s_add_u32 s27, s26, 1024
  buffer_load_dwordx4 v[136:139], v20, s[8:11], s27 offen
  s_add_u32 s27, s26, 3072
  buffer_load_dwordx4 v[140:143], v20, s[8:11], s27 offen
  s_add_u32 s27, s26, 4096
  buffer_load_dwordx4 v[144:147], v20, s[8:11], s27 offen
  s_add_u32 s27, s26, 6144
  buffer_load_dwordx4 v[148:151], v20, s[8:11], s27 offen
  s_add_u32 s27, s26, 5120
  buffer_load_dwordx4 v[152:155], v20, s[8:11], s27 offen
  s_add_u32 s27, s26, 7168
  buffer_load_dwordx4 v[156:159], v20, s[8:11], s27 offen
  s_add_u32 s27, s26, 16384
  buffer_load_dwordx4 v[160:163], v20, s[8:11], s27 offen
  s_add_u32 s27, s26, 18432
  buffer_load_dwordx4 v[164:167], v20, s[8:11], s27 offen
  s_add_u32 s27, s26, 17408
  buffer_load_dwordx4 v[168:171], v20, s[8:11], s27 offen
  s_add_u32 s27, s26, 19456
  buffer_load_dwordx4 v[172:175], v20, s[8:11], s27 offen
  s_add_u32 s27, s26, 20480
  buffer_load_dwordx4 v[176:179], v20, s[8:11], s27 offen
  s_add_u32 s27, s26, 22528
  buffer_load_dwordx4 v[180:183], v20, s[8:11], s27 offen
  s_add_u32 s27, s26, 21504
  buffer_load_dwordx4 v[184:187], v20, s[8:11], s27 offen
  s_add_u32 s27, s26, 23552
  buffer_load_dwordx4 v[188:191], v20, s[8:11], s27 offen
  s_add_u32 s27, s26, 65536
  buffer_load_dwordx4 v[192:195], v20, s[8:11], s27 offen
  s_add_u32 s27, s26, 67584
  buffer_load_dwordx4 v[196:199], v20, s[8:11], s27 offen
  s_add_u32 s27, s26, 66560
  buffer_load_dwordx4 v[200:203], v20, s[8:11], s27 offen
  s_add_u32 s27, s26, 68608
  buffer_load_dwordx4 v[204:207], v20, s[8:11], s27 offen
  s_add_u32 s27, s26, 69632
  buffer_load_dwordx4 v[208:211], v20, s[8:11], s27 offen
  s_add_u32 s27, s26, 71680
  buffer_load_dwordx4 v[212:215], v20, s[8:11], s27 offen
  s_add_u32 s27, s26, 70656
  buffer_load_dwordx4 v[216:219], v20, s[8:11], s27 offen
  s_add_u32 s27, s26, 72704
  buffer_load_dwordx4 v[220:223], v20, s[8:11], s27 offen
  s_add_u32 s27, s26, 81920
  buffer_load_dwordx4 v[224:227], v20, s[8:11], s27 offen
  s_add_u32 s27, s26, 83968
  buffer_load_dwordx4 v[228:231], v20, s[8:11], s27 offen
  s_add_u32 s27, s26, 82944
  buffer_load_dwordx4 v[232:235], v20, s[8:11], s27 offen
  s_add_u32 s27, s26, 84992
  buffer_load_dwordx4 v[236:239], v20, s[8:11], s27 offen
  s_add_u32 s27, s26, 86016
  buffer_load_dwordx4 v[240:243], v20, s[8:11], s27 offen
  s_add_u32 s27, s26, 88064
  buffer_load_dwordx4 v[244:247], v20, s[8:11], s27 offen
  s_add_u32 s27, s26, 87040
  buffer_load_dwordx4 v[248:251], v20, s[8:11], s27 offen
  s_add_u32 s27, s26, 89088
  buffer_load_dwordx4 v[252:255], v20, s[8:11], s27 offen
  s_lshl_b32 s26, s16, 8
  s_lshl_b32 s27, s17, 6
  s_add_u32 s26, s26, s27
  s_xor_b32 s27, s17, 0
  s_lshr_b32 s28, s27, 1
  s_lshl_b32 s28, s28, 20
  s_and_b32 s27, s27, 1
  s_lshl_b32 s27, s27, 15
  s_add_u32 s30, s27, s28
  s_add_u32 s30, s30, s26
  s_xor_b32 s27, s17, 1
  s_lshr_b32 s28, s27, 1
  s_lshl_b32 s28, s28, 20
  s_and_b32 s27, s27, 1
  s_lshl_b32 s27, s27, 15
  s_add_u32 s31, s27, s28
  s_add_u32 s31, s31, s26
  s_xor_b32 s27, s17, 2
  s_lshr_b32 s28, s27, 1
  s_lshl_b32 s28, s28, 20
  s_and_b32 s27, s27, 1
  s_lshl_b32 s27, s27, 15
  s_add_u32 s32, s27, s28
  s_add_u32 s32, s32, s26
  s_xor_b32 s27, s17, 3
  s_lshr_b32 s28, s27, 1
  s_lshl_b32 s28, s28, 20
  s_and_b32 s27, s27, 1
  s_lshl_b32 s27, s27, 15
  s_add_u32 s33, s27, s28
  s_add_u32 s33, s33, s26
  s_load_dwordx2 s[8:9], s[0:1], 16
  s_waitcnt lgkmcnt(0)
  s_add_u32 s27, s30, 0
  buffer_load_dword v24, v21, s[8:11], s27 offen
  s_add_u32 s27, s30, 65536
  buffer_load_dword v25, v21, s[8:11], s27 offen
  s_add_u32 s27, s30, 16384
  buffer_load_dword v26, v21, s[8:11], s27 offen
  s_add_u32 s27, s30, 81920
  buffer_load_dword v27, v21, s[8:11], s27 offen
  s_add_u32 s27, s30, 131072
  buffer_load_dword v28, v21, s[8:11], s27 offen
  s_add_u32 s27, s30, 196608
  buffer_load_dword v29, v21, s[8:11], s27 offen
  s_add_u32 s27, s30, 147456
  buffer_load_dword v30, v21, s[8:11], s27 offen
  s_add_u32 s27, s30, 212992
  buffer_load_dword v31, v21, s[8:11], s27 offen
  s_add_u32 s27, s30, 524288
  buffer_load_dword v32, v21, s[8:11], s27 offen
  s_add_u32 s27, s30, 589824
  buffer_load_dword v33, v21, s[8:11], s27 offen
  s_add_u32 s27, s30, 540672
  buffer_load_dword v34, v21, s[8:11], s27 offen
  s_add_u32 s27, s30, 606208
  buffer_load_dword v35, v21, s[8:11], s27 offen
  s_add_u32 s27, s30, 655360
  buffer_load_dword v36, v21, s[8:11], s27 offen
  s_add_u32 s27, s30, 720896
  buffer_load_dword v37, v21, s[8:11], s27 offen
  s_add_u32 s27, s30, 671744
  buffer_load_dword v38, v21, s[8:11], s27 offen
  s_add_u32 s27, s30, 737280
  buffer_load_dword v39, v21, s[8:11], s27 offen
  s_waitcnt vmcnt(40)
  v_perm_b32 v120, v132, v128, s44
  v_perm_b32 v121, v140, v136, s44
  v_perm_b32 v122, v148, v144, s44
  v_perm_b32 v123, v156, v152, s44
  v_accvgpr_write_b32 a248, v120
  v_accvgpr_write_b32 a249, v121
  v_accvgpr_write_b32 a250, v122
  v_accvgpr_write_b32 a251, v123
  v_perm_b32 v124, v132, v128, s45
  v_perm_b32 v125, v140, v136, s45
  v_perm_b32 v126, v148, v144, s45
  v_perm_b32 v127, v156, v152, s45
  v_accvgpr_write_b32 a232, v124
  v_accvgpr_write_b32 a233, v125
  v_accvgpr_write_b32 a234, v126
  v_accvgpr_write_b32 a235, v127
  v_perm_b32 v120, v133, v129, s44
  v_perm_b32 v121, v141, v137, s44
  v_perm_b32 v122, v149, v145, s44
  v_perm_b32 v123, v157, v153, s44
  v_accvgpr_write_b32 a216, v120
  v_accvgpr_write_b32 a217, v121
  v_accvgpr_write_b32 a218, v122
  v_accvgpr_write_b32 a219, v123
  v_perm_b32 v124, v133, v129, s45
  v_perm_b32 v125, v141, v137, s45
  v_perm_b32 v126, v149, v145, s45
  v_perm_b32 v127, v157, v153, s45
  v_accvgpr_write_b32 a200, v124
  v_accvgpr_write_b32 a201, v125
  v_accvgpr_write_b32 a202, v126
  v_accvgpr_write_b32 a203, v127
  v_perm_b32 v120, v134, v130, s44
  v_perm_b32 v121, v142, v138, s44
  v_perm_b32 v122, v150, v146, s44
  v_perm_b32 v123, v158, v154, s44
  v_accvgpr_write_b32 a184, v120
  v_accvgpr_write_b32 a185, v121
  v_accvgpr_write_b32 a186, v122
  v_accvgpr_write_b32 a187, v123
  v_perm_b32 v124, v134, v130, s45
  v_perm_b32 v125, v142, v138, s45
  v_perm_b32 v126, v150, v146, s45
  v_perm_b32 v127, v158, v154, s45
  ds_write_b128 v1, v[124:127] offset:20480
  s_waitcnt lgkmcnt(0)
  v_perm_b32 v120, v135, v131, s44
  v_perm_b32 v121, v143, v139, s44
  v_perm_b32 v122, v151, v147, s44
  v_perm_b32 v123, v159, v155, s44
  ds_write_b128 v1, v[120:123] offset:24576
  s_waitcnt lgkmcnt(0)
  v_perm_b32 v124, v135, v131, s45
  v_perm_b32 v125, v143, v139, s45
  v_perm_b32 v126, v151, v147, s45
  v_perm_b32 v127, v159, v155, s45
  ds_write_b128 v1, v[124:127] offset:28672
  s_waitcnt lgkmcnt(0)
  s_waitcnt vmcnt(32)
  s_add_u32 s27, s31, 0
  buffer_load_dword v40, v21, s[8:11], s27 offen
  s_add_u32 s27, s31, 65536
  buffer_load_dword v41, v21, s[8:11], s27 offen
  s_add_u32 s27, s31, 16384
  buffer_load_dword v42, v21, s[8:11], s27 offen
  s_add_u32 s27, s31, 81920
  buffer_load_dword v43, v21, s[8:11], s27 offen
  s_add_u32 s27, s31, 131072
  buffer_load_dword v44, v21, s[8:11], s27 offen
  s_add_u32 s27, s31, 196608
  buffer_load_dword v45, v21, s[8:11], s27 offen
  s_add_u32 s27, s31, 147456
  buffer_load_dword v46, v21, s[8:11], s27 offen
  s_add_u32 s27, s31, 212992
  buffer_load_dword v47, v21, s[8:11], s27 offen
  s_add_u32 s27, s31, 524288
  buffer_load_dword v48, v21, s[8:11], s27 offen
  s_add_u32 s27, s31, 589824
  buffer_load_dword v49, v21, s[8:11], s27 offen
  s_add_u32 s27, s31, 540672
  buffer_load_dword v50, v21, s[8:11], s27 offen
  s_add_u32 s27, s31, 606208
  buffer_load_dword v51, v21, s[8:11], s27 offen
  s_add_u32 s27, s31, 655360
  buffer_load_dword v52, v21, s[8:11], s27 offen
  s_add_u32 s27, s31, 720896
  buffer_load_dword v53, v21, s[8:11], s27 offen
  s_add_u32 s27, s31, 671744
  buffer_load_dword v54, v21, s[8:11], s27 offen
  s_add_u32 s27, s31, 737280
  buffer_load_dword v55, v21, s[8:11], s27 offen
  v_perm_b32 v120, v164, v160, s44
  v_perm_b32 v121, v172, v168, s44
  v_perm_b32 v122, v180, v176, s44
  v_perm_b32 v123, v188, v184, s44
  v_accvgpr_write_b32 a252, v120
  v_accvgpr_write_b32 a253, v121
  v_accvgpr_write_b32 a254, v122
  v_accvgpr_write_b32 a255, v123
  v_perm_b32 v124, v164, v160, s45
  v_perm_b32 v125, v172, v168, s45
  v_perm_b32 v126, v180, v176, s45
  v_perm_b32 v127, v188, v184, s45
  v_accvgpr_write_b32 a236, v124
  v_accvgpr_write_b32 a237, v125
  v_accvgpr_write_b32 a238, v126
  v_accvgpr_write_b32 a239, v127
  v_perm_b32 v120, v165, v161, s44
  v_perm_b32 v121, v173, v169, s44
  v_perm_b32 v122, v181, v177, s44
  v_perm_b32 v123, v189, v185, s44
  v_accvgpr_write_b32 a220, v120
  v_accvgpr_write_b32 a221, v121
  v_accvgpr_write_b32 a222, v122
  v_accvgpr_write_b32 a223, v123
  v_perm_b32 v124, v165, v161, s45
  v_perm_b32 v125, v173, v169, s45
  v_perm_b32 v126, v181, v177, s45
  v_perm_b32 v127, v189, v185, s45
  v_accvgpr_write_b32 a204, v124
  v_accvgpr_write_b32 a205, v125
  v_accvgpr_write_b32 a206, v126
  v_accvgpr_write_b32 a207, v127
  v_perm_b32 v120, v166, v162, s44
  v_perm_b32 v121, v174, v170, s44
  v_perm_b32 v122, v182, v178, s44
  v_perm_b32 v123, v190, v186, s44
  v_accvgpr_write_b32 a188, v120
  v_accvgpr_write_b32 a189, v121
  v_accvgpr_write_b32 a190, v122
  v_accvgpr_write_b32 a191, v123
  v_perm_b32 v124, v166, v162, s45
  v_perm_b32 v125, v174, v170, s45
  v_perm_b32 v126, v182, v178, s45
  v_perm_b32 v127, v190, v186, s45
  ds_write_b128 v1, v[124:127] offset:21504
  s_waitcnt lgkmcnt(0)
  v_perm_b32 v120, v167, v163, s44
  v_perm_b32 v121, v175, v171, s44
  v_perm_b32 v122, v183, v179, s44
  v_perm_b32 v123, v191, v187, s44
  ds_write_b128 v1, v[120:123] offset:25600
  s_waitcnt lgkmcnt(0)
  v_perm_b32 v124, v167, v163, s45
  v_perm_b32 v125, v175, v171, s45
  v_perm_b32 v126, v183, v179, s45
  v_perm_b32 v127, v191, v187, s45
  ds_write_b128 v1, v[124:127] offset:29696
  s_waitcnt lgkmcnt(0)
  s_waitcnt vmcnt(40)
  v_perm_b32 v120, v196, v192, s44
  v_perm_b32 v121, v204, v200, s44
  v_perm_b32 v122, v212, v208, s44
  v_perm_b32 v123, v220, v216, s44
  v_accvgpr_write_b32 a240, v120
  v_accvgpr_write_b32 a241, v121
  v_accvgpr_write_b32 a242, v122
  v_accvgpr_write_b32 a243, v123
  v_perm_b32 v124, v196, v192, s45
  v_perm_b32 v125, v204, v200, s45
  v_perm_b32 v126, v212, v208, s45
  v_perm_b32 v127, v220, v216, s45
  v_accvgpr_write_b32 a224, v124
  v_accvgpr_write_b32 a225, v125
  v_accvgpr_write_b32 a226, v126
  v_accvgpr_write_b32 a227, v127
  v_perm_b32 v120, v197, v193, s44
  v_perm_b32 v121, v205, v201, s44
  v_perm_b32 v122, v213, v209, s44
  v_perm_b32 v123, v221, v217, s44
  v_accvgpr_write_b32 a208, v120
  v_accvgpr_write_b32 a209, v121
  v_accvgpr_write_b32 a210, v122
  v_accvgpr_write_b32 a211, v123
  v_perm_b32 v124, v197, v193, s45
  v_perm_b32 v125, v205, v201, s45
  v_perm_b32 v126, v213, v209, s45
  v_perm_b32 v127, v221, v217, s45
  v_accvgpr_write_b32 a192, v124
  v_accvgpr_write_b32 a193, v125
  v_accvgpr_write_b32 a194, v126
  v_accvgpr_write_b32 a195, v127
  v_perm_b32 v120, v198, v194, s44
  v_perm_b32 v121, v206, v202, s44
  v_perm_b32 v122, v214, v210, s44
  v_perm_b32 v123, v222, v218, s44
  v_accvgpr_write_b32 a176, v120
  v_accvgpr_write_b32 a177, v121
  v_accvgpr_write_b32 a178, v122
  v_accvgpr_write_b32 a179, v123
  v_perm_b32 v124, v198, v194, s45
  v_perm_b32 v125, v206, v202, s45
  v_perm_b32 v126, v214, v210, s45
  v_perm_b32 v127, v222, v218, s45
  ds_write_b128 v1, v[124:127] offset:22528
  s_waitcnt lgkmcnt(0)
  v_perm_b32 v120, v199, v195, s44
  v_perm_b32 v121, v207, v203, s44
  v_perm_b32 v122, v215, v211, s44
  v_perm_b32 v123, v223, v219, s44
  ds_write_b128 v1, v[120:123] offset:26624
  s_waitcnt lgkmcnt(0)
  v_perm_b32 v124, v199, v195, s45
  v_perm_b32 v125, v207, v203, s45
  v_perm_b32 v126, v215, v211, s45
  v_perm_b32 v127, v223, v219, s45
  ds_write_b128 v1, v[124:127] offset:30720
  s_waitcnt lgkmcnt(0)
  s_waitcnt vmcnt(32)
  s_add_u32 s27, s32, 0
  buffer_load_dword v56, v21, s[8:11], s27 offen
  s_add_u32 s27, s32, 65536
  buffer_load_dword v57, v21, s[8:11], s27 offen
  s_add_u32 s27, s32, 16384
  buffer_load_dword v58, v21, s[8:11], s27 offen
  s_add_u32 s27, s32, 81920
  buffer_load_dword v59, v21, s[8:11], s27 offen
  s_add_u32 s27, s32, 131072
  buffer_load_dword v60, v21, s[8:11], s27 offen
  s_add_u32 s27, s32, 196608
  buffer_load_dword v61, v21, s[8:11], s27 offen
  s_add_u32 s27, s32, 147456
  buffer_load_dword v62, v21, s[8:11], s27 offen
  s_add_u32 s27, s32, 212992
  buffer_load_dword v63, v21, s[8:11], s27 offen
  s_add_u32 s27, s32, 524288
  buffer_load_dword v64, v21, s[8:11], s27 offen
  s_add_u32 s27, s32, 589824
  buffer_load_dword v65, v21, s[8:11], s27 offen
  s_add_u32 s27, s32, 540672
  buffer_load_dword v66, v21, s[8:11], s27 offen
  s_add_u32 s27, s32, 606208
  buffer_load_dword v67, v21, s[8:11], s27 offen
  s_add_u32 s27, s32, 655360
  buffer_load_dword v68, v21, s[8:11], s27 offen
  s_add_u32 s27, s32, 720896
  buffer_load_dword v69, v21, s[8:11], s27 offen
  s_add_u32 s27, s32, 671744
  buffer_load_dword v70, v21, s[8:11], s27 offen
  s_add_u32 s27, s32, 737280
  buffer_load_dword v71, v21, s[8:11], s27 offen
  v_perm_b32 v120, v228, v224, s44
  v_perm_b32 v121, v236, v232, s44
  v_perm_b32 v122, v244, v240, s44
  v_perm_b32 v123, v252, v248, s44
  v_accvgpr_write_b32 a244, v120
  v_accvgpr_write_b32 a245, v121
  v_accvgpr_write_b32 a246, v122
  v_accvgpr_write_b32 a247, v123
  v_perm_b32 v124, v228, v224, s45
  v_perm_b32 v125, v236, v232, s45
  v_perm_b32 v126, v244, v240, s45
  v_perm_b32 v127, v252, v248, s45
  v_accvgpr_write_b32 a228, v124
  v_accvgpr_write_b32 a229, v125
  v_accvgpr_write_b32 a230, v126
  v_accvgpr_write_b32 a231, v127
  v_perm_b32 v120, v229, v225, s44
  v_perm_b32 v121, v237, v233, s44
  v_perm_b32 v122, v245, v241, s44
  v_perm_b32 v123, v253, v249, s44
  v_accvgpr_write_b32 a212, v120
  v_accvgpr_write_b32 a213, v121
  v_accvgpr_write_b32 a214, v122
  v_accvgpr_write_b32 a215, v123
  v_perm_b32 v124, v229, v225, s45
  v_perm_b32 v125, v237, v233, s45
  v_perm_b32 v126, v245, v241, s45
  v_perm_b32 v127, v253, v249, s45
  v_accvgpr_write_b32 a196, v124
  v_accvgpr_write_b32 a197, v125
  v_accvgpr_write_b32 a198, v126
  v_accvgpr_write_b32 a199, v127
  v_perm_b32 v120, v230, v226, s44
  v_perm_b32 v121, v238, v234, s44
  v_perm_b32 v122, v246, v242, s44
  v_perm_b32 v123, v254, v250, s44
  v_accvgpr_write_b32 a180, v120
  v_accvgpr_write_b32 a181, v121
  v_accvgpr_write_b32 a182, v122
  v_accvgpr_write_b32 a183, v123
  v_perm_b32 v124, v230, v226, s45
  v_perm_b32 v125, v238, v234, s45
  v_perm_b32 v126, v246, v242, s45
  v_perm_b32 v127, v254, v250, s45
  ds_write_b128 v1, v[124:127] offset:23552
  s_waitcnt lgkmcnt(0)
  v_perm_b32 v120, v231, v227, s44
  v_perm_b32 v121, v239, v235, s44
  v_perm_b32 v122, v247, v243, s44
  v_perm_b32 v123, v255, v251, s44
  ds_write_b128 v1, v[120:123] offset:27648
  s_waitcnt lgkmcnt(0)
  v_perm_b32 v124, v231, v227, s45
  v_perm_b32 v125, v239, v235, s45
  v_perm_b32 v126, v247, v243, s45
  v_perm_b32 v127, v255, v251, s45
  ds_write_b128 v1, v[124:127] offset:31744
  s_waitcnt lgkmcnt(0)
  s_add_u32 s27, s33, 0
  buffer_load_dword v72, v21, s[8:11], s27 offen
  s_add_u32 s27, s33, 65536
  buffer_load_dword v73, v21, s[8:11], s27 offen
  s_add_u32 s27, s33, 16384
  buffer_load_dword v74, v21, s[8:11], s27 offen
  s_add_u32 s27, s33, 81920
  buffer_load_dword v75, v21, s[8:11], s27 offen
  s_add_u32 s27, s33, 131072
  buffer_load_dword v76, v21, s[8:11], s27 offen
  s_add_u32 s27, s33, 196608
  buffer_load_dword v77, v21, s[8:11], s27 offen
  s_add_u32 s27, s33, 147456
  buffer_load_dword v78, v21, s[8:11], s27 offen
  s_add_u32 s27, s33, 212992
  buffer_load_dword v79, v21, s[8:11], s27 offen
  s_add_u32 s27, s33, 524288
  buffer_load_dword v80, v21, s[8:11], s27 offen
  s_add_u32 s27, s33, 589824
  buffer_load_dword v81, v21, s[8:11], s27 offen
  s_add_u32 s27, s33, 540672
  buffer_load_dword v82, v21, s[8:11], s27 offen
  s_add_u32 s27, s33, 606208
  buffer_load_dword v83, v21, s[8:11], s27 offen
  s_add_u32 s27, s33, 655360
  buffer_load_dword v84, v21, s[8:11], s27 offen
  s_add_u32 s27, s33, 720896
  buffer_load_dword v85, v21, s[8:11], s27 offen
  s_add_u32 s27, s33, 671744
  buffer_load_dword v86, v21, s[8:11], s27 offen
  s_add_u32 s27, s33, 737280
  buffer_load_dword v87, v21, s[8:11], s27 offen
  s_waitcnt vmcnt(48)
  v_perm_b32 v120, v25, v24, s44
  v_perm_b32 v121, v27, v26, s44
  v_perm_b32 v122, v29, v28, s44
  v_perm_b32 v123, v31, v30, s44
  ds_write_b128 v1, v[120:123] offset:0
  s_waitcnt lgkmcnt(0)
  v_perm_b32 v124, v25, v24, s45
  v_perm_b32 v125, v27, v26, s45
  v_perm_b32 v126, v29, v28, s45
  v_perm_b32 v127, v31, v30, s45
  ds_write_b128 v1, v[124:127] offset:2048
  s_waitcnt lgkmcnt(0)
  v_perm_b32 v120, v33, v32, s44
  v_perm_b32 v121, v35, v34, s44
  v_perm_b32 v122, v37, v36, s44
  v_perm_b32 v123, v39, v38, s44
  ds_write_b128 v1, v[120:123] offset:1024
  s_waitcnt lgkmcnt(0)
  v_perm_b32 v124, v33, v32, s45
  v_perm_b32 v125, v35, v34, s45
  v_perm_b32 v126, v37, v36, s45
  v_perm_b32 v127, v39, v38, s45
  ds_write_b128 v1, v[124:127] offset:3072
  s_waitcnt lgkmcnt(0)
  s_add_u32 s27, s30, 2097152
  buffer_load_dword v88, v21, s[8:11], s27 offen
  s_add_u32 s27, s30, 2162688
  buffer_load_dword v89, v21, s[8:11], s27 offen
  s_add_u32 s27, s30, 2113536
  buffer_load_dword v90, v21, s[8:11], s27 offen
  s_add_u32 s27, s30, 2179072
  buffer_load_dword v91, v21, s[8:11], s27 offen
  s_add_u32 s27, s30, 2228224
  buffer_load_dword v92, v21, s[8:11], s27 offen
  s_add_u32 s27, s30, 2293760
  buffer_load_dword v93, v21, s[8:11], s27 offen
  s_add_u32 s27, s30, 2244608
  buffer_load_dword v94, v21, s[8:11], s27 offen
  s_add_u32 s27, s30, 2310144
  buffer_load_dword v95, v21, s[8:11], s27 offen
  s_add_u32 s27, s30, 2621440
  buffer_load_dword v96, v21, s[8:11], s27 offen
  s_add_u32 s27, s30, 2686976
  buffer_load_dword v97, v21, s[8:11], s27 offen
  s_add_u32 s27, s30, 2637824
  buffer_load_dword v98, v21, s[8:11], s27 offen
  s_add_u32 s27, s30, 2703360
  buffer_load_dword v99, v21, s[8:11], s27 offen
  s_add_u32 s27, s30, 2752512
  buffer_load_dword v100, v21, s[8:11], s27 offen
  s_add_u32 s27, s30, 2818048
  buffer_load_dword v101, v21, s[8:11], s27 offen
  s_add_u32 s27, s30, 2768896
  buffer_load_dword v102, v21, s[8:11], s27 offen
  s_add_u32 s27, s30, 2834432
  buffer_load_dword v103, v21, s[8:11], s27 offen
  s_waitcnt vmcnt(48)
  v_perm_b32 v120, v41, v40, s44
  v_perm_b32 v121, v43, v42, s44
  v_perm_b32 v122, v45, v44, s44
  v_perm_b32 v123, v47, v46, s44
  v_accvgpr_write_b32 a168, v120
  v_accvgpr_write_b32 a169, v121
  v_accvgpr_write_b32 a170, v122
  v_accvgpr_write_b32 a171, v123
  v_perm_b32 v124, v41, v40, s45
  v_perm_b32 v125, v43, v42, s45
  v_perm_b32 v126, v45, v44, s45
  v_perm_b32 v127, v47, v46, s45
  v_accvgpr_write_b32 a120, v124
  v_accvgpr_write_b32 a121, v125
  v_accvgpr_write_b32 a122, v126
  v_accvgpr_write_b32 a123, v127
  v_perm_b32 v120, v49, v48, s44
  v_perm_b32 v121, v51, v50, s44
  v_perm_b32 v122, v53, v52, s44
  v_perm_b32 v123, v55, v54, s44
  v_accvgpr_write_b32 a172, v120
  v_accvgpr_write_b32 a173, v121
  v_accvgpr_write_b32 a174, v122
  v_accvgpr_write_b32 a175, v123
  v_perm_b32 v124, v49, v48, s45
  v_perm_b32 v125, v51, v50, s45
  v_perm_b32 v126, v53, v52, s45
  v_perm_b32 v127, v55, v54, s45
  v_accvgpr_write_b32 a124, v124
  v_accvgpr_write_b32 a125, v125
  v_accvgpr_write_b32 a126, v126
  v_accvgpr_write_b32 a127, v127
  s_add_u32 s27, s31, 2097152
  buffer_load_dword v104, v21, s[8:11], s27 offen
  s_add_u32 s27, s31, 2162688
  buffer_load_dword v105, v21, s[8:11], s27 offen
  s_add_u32 s27, s31, 2113536
  buffer_load_dword v106, v21, s[8:11], s27 offen
  s_add_u32 s27, s31, 2179072
  buffer_load_dword v107, v21, s[8:11], s27 offen
  s_add_u32 s27, s31, 2228224
  buffer_load_dword v108, v21, s[8:11], s27 offen
  s_add_u32 s27, s31, 2293760
  buffer_load_dword v109, v21, s[8:11], s27 offen
  s_add_u32 s27, s31, 2244608
  buffer_load_dword v110, v21, s[8:11], s27 offen
  s_add_u32 s27, s31, 2310144
  buffer_load_dword v111, v21, s[8:11], s27 offen
  s_add_u32 s27, s31, 2621440
  buffer_load_dword v112, v21, s[8:11], s27 offen
  s_add_u32 s27, s31, 2686976
  buffer_load_dword v113, v21, s[8:11], s27 offen
  s_add_u32 s27, s31, 2637824
  buffer_load_dword v114, v21, s[8:11], s27 offen
  s_add_u32 s27, s31, 2703360
  buffer_load_dword v115, v21, s[8:11], s27 offen
  s_add_u32 s27, s31, 2752512
  buffer_load_dword v116, v21, s[8:11], s27 offen
  s_add_u32 s27, s31, 2818048
  buffer_load_dword v117, v21, s[8:11], s27 offen
  s_add_u32 s27, s31, 2768896
  buffer_load_dword v118, v21, s[8:11], s27 offen
  s_add_u32 s27, s31, 2834432
  buffer_load_dword v119, v21, s[8:11], s27 offen
  s_waitcnt vmcnt(48)
  v_perm_b32 v120, v57, v56, s44
  v_perm_b32 v121, v59, v58, s44
  v_perm_b32 v122, v61, v60, s44
  v_perm_b32 v123, v63, v62, s44
  v_accvgpr_write_b32 a160, v120
  v_accvgpr_write_b32 a161, v121
  v_accvgpr_write_b32 a162, v122
  v_accvgpr_write_b32 a163, v123
  v_perm_b32 v124, v57, v56, s45
  v_perm_b32 v125, v59, v58, s45
  v_perm_b32 v126, v61, v60, s45
  v_perm_b32 v127, v63, v62, s45
  v_accvgpr_write_b32 a112, v124
  v_accvgpr_write_b32 a113, v125
  v_accvgpr_write_b32 a114, v126
  v_accvgpr_write_b32 a115, v127
  v_perm_b32 v120, v65, v64, s44
  v_perm_b32 v121, v67, v66, s44
  v_perm_b32 v122, v69, v68, s44
  v_perm_b32 v123, v71, v70, s44
  v_accvgpr_write_b32 a164, v120
  v_accvgpr_write_b32 a165, v121
  v_accvgpr_write_b32 a166, v122
  v_accvgpr_write_b32 a167, v123
  v_perm_b32 v124, v65, v64, s45
  v_perm_b32 v125, v67, v66, s45
  v_perm_b32 v126, v69, v68, s45
  v_perm_b32 v127, v71, v70, s45
  v_accvgpr_write_b32 a116, v124
  v_accvgpr_write_b32 a117, v125
  v_accvgpr_write_b32 a118, v126
  v_accvgpr_write_b32 a119, v127
  s_add_u32 s27, s32, 2097152
  buffer_load_dword v24, v21, s[8:11], s27 offen
  s_add_u32 s27, s32, 2162688
  buffer_load_dword v25, v21, s[8:11], s27 offen
  s_add_u32 s27, s32, 2113536
  buffer_load_dword v26, v21, s[8:11], s27 offen
  s_add_u32 s27, s32, 2179072
  buffer_load_dword v27, v21, s[8:11], s27 offen
  s_add_u32 s27, s32, 2228224
  buffer_load_dword v28, v21, s[8:11], s27 offen
  s_add_u32 s27, s32, 2293760
  buffer_load_dword v29, v21, s[8:11], s27 offen
  s_add_u32 s27, s32, 2244608
  buffer_load_dword v30, v21, s[8:11], s27 offen
  s_add_u32 s27, s32, 2310144
  buffer_load_dword v31, v21, s[8:11], s27 offen
  s_add_u32 s27, s32, 2621440
  buffer_load_dword v32, v21, s[8:11], s27 offen
  s_add_u32 s27, s32, 2686976
  buffer_load_dword v33, v21, s[8:11], s27 offen
  s_add_u32 s27, s32, 2637824
  buffer_load_dword v34, v21, s[8:11], s27 offen
  s_add_u32 s27, s32, 2703360
  buffer_load_dword v35, v21, s[8:11], s27 offen
  s_add_u32 s27, s32, 2752512
  buffer_load_dword v36, v21, s[8:11], s27 offen
  s_add_u32 s27, s32, 2818048
  buffer_load_dword v37, v21, s[8:11], s27 offen
  s_add_u32 s27, s32, 2768896
  buffer_load_dword v38, v21, s[8:11], s27 offen
  s_add_u32 s27, s32, 2834432
  buffer_load_dword v39, v21, s[8:11], s27 offen
  s_waitcnt vmcnt(48)
  v_perm_b32 v120, v73, v72, s44
  v_perm_b32 v121, v75, v74, s44
  v_perm_b32 v122, v77, v76, s44
  v_perm_b32 v123, v79, v78, s44
  v_accvgpr_write_b32 a152, v120
  v_accvgpr_write_b32 a153, v121
  v_accvgpr_write_b32 a154, v122
  v_accvgpr_write_b32 a155, v123
  v_perm_b32 v124, v73, v72, s45
  v_perm_b32 v125, v75, v74, s45
  v_perm_b32 v126, v77, v76, s45
  v_perm_b32 v127, v79, v78, s45
  v_accvgpr_write_b32 a104, v124
  v_accvgpr_write_b32 a105, v125
  v_accvgpr_write_b32 a106, v126
  v_accvgpr_write_b32 a107, v127
  v_perm_b32 v120, v81, v80, s44
  v_perm_b32 v121, v83, v82, s44
  v_perm_b32 v122, v85, v84, s44
  v_perm_b32 v123, v87, v86, s44
  v_accvgpr_write_b32 a156, v120
  v_accvgpr_write_b32 a157, v121
  v_accvgpr_write_b32 a158, v122
  v_accvgpr_write_b32 a159, v123
  v_perm_b32 v124, v81, v80, s45
  v_perm_b32 v125, v83, v82, s45
  v_perm_b32 v126, v85, v84, s45
  v_perm_b32 v127, v87, v86, s45
  v_accvgpr_write_b32 a108, v124
  v_accvgpr_write_b32 a109, v125
  v_accvgpr_write_b32 a110, v126
  v_accvgpr_write_b32 a111, v127
  s_add_u32 s27, s33, 2097152
  buffer_load_dword v40, v21, s[8:11], s27 offen
  s_add_u32 s27, s33, 2162688
  buffer_load_dword v41, v21, s[8:11], s27 offen
  s_add_u32 s27, s33, 2113536
  buffer_load_dword v42, v21, s[8:11], s27 offen
  s_add_u32 s27, s33, 2179072
  buffer_load_dword v43, v21, s[8:11], s27 offen
  s_add_u32 s27, s33, 2228224
  buffer_load_dword v44, v21, s[8:11], s27 offen
  s_add_u32 s27, s33, 2293760
  buffer_load_dword v45, v21, s[8:11], s27 offen
  s_add_u32 s27, s33, 2244608
  buffer_load_dword v46, v21, s[8:11], s27 offen
  s_add_u32 s27, s33, 2310144
  buffer_load_dword v47, v21, s[8:11], s27 offen
  s_add_u32 s27, s33, 2621440
  buffer_load_dword v48, v21, s[8:11], s27 offen
  s_add_u32 s27, s33, 2686976
  buffer_load_dword v49, v21, s[8:11], s27 offen
  s_add_u32 s27, s33, 2637824
  buffer_load_dword v50, v21, s[8:11], s27 offen
  s_add_u32 s27, s33, 2703360
  buffer_load_dword v51, v21, s[8:11], s27 offen
  s_add_u32 s27, s33, 2752512
  buffer_load_dword v52, v21, s[8:11], s27 offen
  s_add_u32 s27, s33, 2818048
  buffer_load_dword v53, v21, s[8:11], s27 offen
  s_add_u32 s27, s33, 2768896
  buffer_load_dword v54, v21, s[8:11], s27 offen
  s_add_u32 s27, s33, 2834432
  buffer_load_dword v55, v21, s[8:11], s27 offen
  s_waitcnt vmcnt(48)
  v_perm_b32 v120, v89, v88, s44
  v_perm_b32 v121, v91, v90, s44
  v_perm_b32 v122, v93, v92, s44
  v_perm_b32 v123, v95, v94, s44
  ds_write_b128 v1, v[120:123] offset:8192
  s_waitcnt lgkmcnt(0)
  v_perm_b32 v124, v89, v88, s45
  v_perm_b32 v125, v91, v90, s45
  v_perm_b32 v126, v93, v92, s45
  v_perm_b32 v127, v95, v94, s45
  ds_write_b128 v1, v[124:127] offset:10240
  s_waitcnt lgkmcnt(0)
  v_perm_b32 v120, v97, v96, s44
  v_perm_b32 v121, v99, v98, s44
  v_perm_b32 v122, v101, v100, s44
  v_perm_b32 v123, v103, v102, s44
  ds_write_b128 v1, v[120:123] offset:9216
  s_waitcnt lgkmcnt(0)
  v_perm_b32 v124, v97, v96, s45
  v_perm_b32 v125, v99, v98, s45
  v_perm_b32 v126, v101, v100, s45
  v_perm_b32 v127, v103, v102, s45
  ds_write_b128 v1, v[124:127] offset:11264
  s_waitcnt lgkmcnt(0)
  s_load_dwordx2 s[8:9], s[0:1], 24
  s_waitcnt lgkmcnt(0)
  s_add_u32 s27, s30, 0
  buffer_load_dword v56, v21, s[8:11], s27 offen
  s_add_u32 s27, s30, 65536
  buffer_load_dword v57, v21, s[8:11], s27 offen
  s_add_u32 s27, s30, 16384
  buffer_load_dword v58, v21, s[8:11], s27 offen
  s_add_u32 s27, s30, 81920
  buffer_load_dword v59, v21, s[8:11], s27 offen
  s_add_u32 s27, s30, 131072
  buffer_load_dword v60, v21, s[8:11], s27 offen
  s_add_u32 s27, s30, 196608
  buffer_load_dword v61, v21, s[8:11], s27 offen
  s_add_u32 s27, s30, 147456
  buffer_load_dword v62, v21, s[8:11], s27 offen
  s_add_u32 s27, s30, 212992
  buffer_load_dword v63, v21, s[8:11], s27 offen
  s_add_u32 s27, s30, 524288
  buffer_load_dword v64, v21, s[8:11], s27 offen
  s_add_u32 s27, s30, 589824
  buffer_load_dword v65, v21, s[8:11], s27 offen
  s_add_u32 s27, s30, 540672
  buffer_load_dword v66, v21, s[8:11], s27 offen
  s_add_u32 s27, s30, 606208
  buffer_load_dword v67, v21, s[8:11], s27 offen
  s_add_u32 s27, s30, 655360
  buffer_load_dword v68, v21, s[8:11], s27 offen
  s_add_u32 s27, s30, 720896
  buffer_load_dword v69, v21, s[8:11], s27 offen
  s_add_u32 s27, s30, 671744
  buffer_load_dword v70, v21, s[8:11], s27 offen
  s_add_u32 s27, s30, 737280
  buffer_load_dword v71, v21, s[8:11], s27 offen
  s_waitcnt vmcnt(48)
  v_perm_b32 v120, v105, v104, s44
  v_perm_b32 v121, v107, v106, s44
  v_perm_b32 v122, v109, v108, s44
  v_perm_b32 v123, v111, v110, s44
  v_accvgpr_write_b32 a144, v120
  v_accvgpr_write_b32 a145, v121
  v_accvgpr_write_b32 a146, v122
  v_accvgpr_write_b32 a147, v123
  v_perm_b32 v124, v105, v104, s45
  v_perm_b32 v125, v107, v106, s45
  v_perm_b32 v126, v109, v108, s45
  v_perm_b32 v127, v111, v110, s45
  v_accvgpr_write_b32 a96, v124
  v_accvgpr_write_b32 a97, v125
  v_accvgpr_write_b32 a98, v126
  v_accvgpr_write_b32 a99, v127
  v_perm_b32 v120, v113, v112, s44
  v_perm_b32 v121, v115, v114, s44
  v_perm_b32 v122, v117, v116, s44
  v_perm_b32 v123, v119, v118, s44
  v_accvgpr_write_b32 a148, v120
  v_accvgpr_write_b32 a149, v121
  v_accvgpr_write_b32 a150, v122
  v_accvgpr_write_b32 a151, v123
  v_perm_b32 v124, v113, v112, s45
  v_perm_b32 v125, v115, v114, s45
  v_perm_b32 v126, v117, v116, s45
  v_perm_b32 v127, v119, v118, s45
  v_accvgpr_write_b32 a100, v124
  v_accvgpr_write_b32 a101, v125
  v_accvgpr_write_b32 a102, v126
  v_accvgpr_write_b32 a103, v127
  s_add_u32 s27, s31, 0
  buffer_load_dword v72, v21, s[8:11], s27 offen
  s_add_u32 s27, s31, 65536
  buffer_load_dword v73, v21, s[8:11], s27 offen
  s_add_u32 s27, s31, 16384
  buffer_load_dword v74, v21, s[8:11], s27 offen
  s_add_u32 s27, s31, 81920
  buffer_load_dword v75, v21, s[8:11], s27 offen
  s_add_u32 s27, s31, 131072
  buffer_load_dword v76, v21, s[8:11], s27 offen
  s_add_u32 s27, s31, 196608
  buffer_load_dword v77, v21, s[8:11], s27 offen
  s_add_u32 s27, s31, 147456
  buffer_load_dword v78, v21, s[8:11], s27 offen
  s_add_u32 s27, s31, 212992
  buffer_load_dword v79, v21, s[8:11], s27 offen
  s_add_u32 s27, s31, 524288
  buffer_load_dword v80, v21, s[8:11], s27 offen
  s_add_u32 s27, s31, 589824
  buffer_load_dword v81, v21, s[8:11], s27 offen
  s_add_u32 s27, s31, 540672
  buffer_load_dword v82, v21, s[8:11], s27 offen
  s_add_u32 s27, s31, 606208
  buffer_load_dword v83, v21, s[8:11], s27 offen
  s_add_u32 s27, s31, 655360
  buffer_load_dword v84, v21, s[8:11], s27 offen
  s_add_u32 s27, s31, 720896
  buffer_load_dword v85, v21, s[8:11], s27 offen
  s_add_u32 s27, s31, 671744
  buffer_load_dword v86, v21, s[8:11], s27 offen
  s_add_u32 s27, s31, 737280
  buffer_load_dword v87, v21, s[8:11], s27 offen
  s_waitcnt vmcnt(48)
  v_perm_b32 v120, v25, v24, s44
  v_perm_b32 v121, v27, v26, s44
  v_perm_b32 v122, v29, v28, s44
  v_perm_b32 v123, v31, v30, s44
  v_accvgpr_write_b32 a136, v120
  v_accvgpr_write_b32 a137, v121
  v_accvgpr_write_b32 a138, v122
  v_accvgpr_write_b32 a139, v123
  v_perm_b32 v124, v25, v24, s45
  v_perm_b32 v125, v27, v26, s45
  v_perm_b32 v126, v29, v28, s45
  v_perm_b32 v127, v31, v30, s45
  v_accvgpr_write_b32 a88, v124
  v_accvgpr_write_b32 a89, v125
  v_accvgpr_write_b32 a90, v126
  v_accvgpr_write_b32 a91, v127
  v_perm_b32 v120, v33, v32, s44
  v_perm_b32 v121, v35, v34, s44
  v_perm_b32 v122, v37, v36, s44
  v_perm_b32 v123, v39, v38, s44
  v_accvgpr_write_b32 a140, v120
  v_accvgpr_write_b32 a141, v121
  v_accvgpr_write_b32 a142, v122
  v_accvgpr_write_b32 a143, v123
  v_perm_b32 v124, v33, v32, s45
  v_perm_b32 v125, v35, v34, s45
  v_perm_b32 v126, v37, v36, s45
  v_perm_b32 v127, v39, v38, s45
  v_accvgpr_write_b32 a92, v124
  v_accvgpr_write_b32 a93, v125
  v_accvgpr_write_b32 a94, v126
  v_accvgpr_write_b32 a95, v127
  s_add_u32 s27, s32, 0
  buffer_load_dword v88, v21, s[8:11], s27 offen
  s_add_u32 s27, s32, 65536
  buffer_load_dword v89, v21, s[8:11], s27 offen
  s_add_u32 s27, s32, 16384
  buffer_load_dword v90, v21, s[8:11], s27 offen
  s_add_u32 s27, s32, 81920
  buffer_load_dword v91, v21, s[8:11], s27 offen
  s_add_u32 s27, s32, 131072
  buffer_load_dword v92, v21, s[8:11], s27 offen
  s_add_u32 s27, s32, 196608
  buffer_load_dword v93, v21, s[8:11], s27 offen
  s_add_u32 s27, s32, 147456
  buffer_load_dword v94, v21, s[8:11], s27 offen
  s_add_u32 s27, s32, 212992
  buffer_load_dword v95, v21, s[8:11], s27 offen
  s_add_u32 s27, s32, 524288
  buffer_load_dword v96, v21, s[8:11], s27 offen
  s_add_u32 s27, s32, 589824
  buffer_load_dword v97, v21, s[8:11], s27 offen
  s_add_u32 s27, s32, 540672
  buffer_load_dword v98, v21, s[8:11], s27 offen
  s_add_u32 s27, s32, 606208
  buffer_load_dword v99, v21, s[8:11], s27 offen
  s_add_u32 s27, s32, 655360
  buffer_load_dword v100, v21, s[8:11], s27 offen
  s_add_u32 s27, s32, 720896
  buffer_load_dword v101, v21, s[8:11], s27 offen
  s_add_u32 s27, s32, 671744
  buffer_load_dword v102, v21, s[8:11], s27 offen
  s_add_u32 s27, s32, 737280
  buffer_load_dword v103, v21, s[8:11], s27 offen
  s_waitcnt vmcnt(48)
  v_perm_b32 v120, v41, v40, s44
  v_perm_b32 v121, v43, v42, s44
  v_perm_b32 v122, v45, v44, s44
  v_perm_b32 v123, v47, v46, s44
  v_accvgpr_write_b32 a128, v120
  v_accvgpr_write_b32 a129, v121
  v_accvgpr_write_b32 a130, v122
  v_accvgpr_write_b32 a131, v123
  v_perm_b32 v124, v41, v40, s45
  v_perm_b32 v125, v43, v42, s45
  v_perm_b32 v126, v45, v44, s45
  v_perm_b32 v127, v47, v46, s45
  v_accvgpr_write_b32 a80, v124
  v_accvgpr_write_b32 a81, v125
  v_accvgpr_write_b32 a82, v126
  v_accvgpr_write_b32 a83, v127
  v_perm_b32 v120, v49, v48, s44
  v_perm_b32 v121, v51, v50, s44
  v_perm_b32 v122, v53, v52, s44
  v_perm_b32 v123, v55, v54, s44
  v_accvgpr_write_b32 a132, v120
  v_accvgpr_write_b32 a133, v121
  v_accvgpr_write_b32 a134, v122
  v_accvgpr_write_b32 a135, v123
  v_perm_b32 v124, v49, v48, s45
  v_perm_b32 v125, v51, v50, s45
  v_perm_b32 v126, v53, v52, s45
  v_perm_b32 v127, v55, v54, s45
  v_accvgpr_write_b32 a84, v124
  v_accvgpr_write_b32 a85, v125
  v_accvgpr_write_b32 a86, v126
  v_accvgpr_write_b32 a87, v127
  s_add_u32 s27, s33, 0
  buffer_load_dword v104, v21, s[8:11], s27 offen
  s_add_u32 s27, s33, 65536
  buffer_load_dword v105, v21, s[8:11], s27 offen
  s_add_u32 s27, s33, 16384
  buffer_load_dword v106, v21, s[8:11], s27 offen
  s_add_u32 s27, s33, 81920
  buffer_load_dword v107, v21, s[8:11], s27 offen
  s_add_u32 s27, s33, 131072
  buffer_load_dword v108, v21, s[8:11], s27 offen
  s_add_u32 s27, s33, 196608
  buffer_load_dword v109, v21, s[8:11], s27 offen
  s_add_u32 s27, s33, 147456
  buffer_load_dword v110, v21, s[8:11], s27 offen
  s_add_u32 s27, s33, 212992
  buffer_load_dword v111, v21, s[8:11], s27 offen
  s_add_u32 s27, s33, 524288
  buffer_load_dword v112, v21, s[8:11], s27 offen
  s_add_u32 s27, s33, 589824
  buffer_load_dword v113, v21, s[8:11], s27 offen
  s_add_u32 s27, s33, 540672
  buffer_load_dword v114, v21, s[8:11], s27 offen
  s_add_u32 s27, s33, 606208
  buffer_load_dword v115, v21, s[8:11], s27 offen
  s_add_u32 s27, s33, 655360
  buffer_load_dword v116, v21, s[8:11], s27 offen
  s_add_u32 s27, s33, 720896
  buffer_load_dword v117, v21, s[8:11], s27 offen
  s_add_u32 s27, s33, 671744
  buffer_load_dword v118, v21, s[8:11], s27 offen
  s_add_u32 s27, s33, 737280
  buffer_load_dword v119, v21, s[8:11], s27 offen
  s_waitcnt vmcnt(48)
  v_perm_b32 v120, v57, v56, s44
  v_perm_b32 v121, v59, v58, s44
  v_perm_b32 v122, v61, v60, s44
  v_perm_b32 v123, v63, v62, s44
  ds_write_b128 v1, v[120:123] offset:4096
  s_waitcnt lgkmcnt(0)
  v_perm_b32 v124, v57, v56, s45
  v_perm_b32 v125, v59, v58, s45
  v_perm_b32 v126, v61, v60, s45
  v_perm_b32 v127, v63, v62, s45
  ds_write_b128 v1, v[124:127] offset:6144
  s_waitcnt lgkmcnt(0)
  v_perm_b32 v120, v65, v64, s44
  v_perm_b32 v121, v67, v66, s44
  v_perm_b32 v122, v69, v68, s44
  v_perm_b32 v123, v71, v70, s44
  ds_write_b128 v1, v[120:123] offset:5120
  s_waitcnt lgkmcnt(0)
  v_perm_b32 v124, v65, v64, s45
  v_perm_b32 v125, v67, v66, s45
  v_perm_b32 v126, v69, v68, s45
  v_perm_b32 v127, v71, v70, s45
  ds_write_b128 v1, v[124:127] offset:7168
  s_waitcnt lgkmcnt(0)
  s_add_u32 s27, s30, 2097152
  buffer_load_dword v24, v21, s[8:11], s27 offen
  s_add_u32 s27, s30, 2162688
  buffer_load_dword v25, v21, s[8:11], s27 offen
  s_add_u32 s27, s30, 2113536
  buffer_load_dword v26, v21, s[8:11], s27 offen
  s_add_u32 s27, s30, 2179072
  buffer_load_dword v27, v21, s[8:11], s27 offen
  s_add_u32 s27, s30, 2228224
  buffer_load_dword v28, v21, s[8:11], s27 offen
  s_add_u32 s27, s30, 2293760
  buffer_load_dword v29, v21, s[8:11], s27 offen
  s_add_u32 s27, s30, 2244608
  buffer_load_dword v30, v21, s[8:11], s27 offen
  s_add_u32 s27, s30, 2310144
  buffer_load_dword v31, v21, s[8:11], s27 offen
  s_add_u32 s27, s30, 2621440
  buffer_load_dword v32, v21, s[8:11], s27 offen
  s_add_u32 s27, s30, 2686976
  buffer_load_dword v33, v21, s[8:11], s27 offen
  s_add_u32 s27, s30, 2637824
  buffer_load_dword v34, v21, s[8:11], s27 offen
  s_add_u32 s27, s30, 2703360
  buffer_load_dword v35, v21, s[8:11], s27 offen
  s_add_u32 s27, s30, 2752512
  buffer_load_dword v36, v21, s[8:11], s27 offen
  s_add_u32 s27, s30, 2818048
  buffer_load_dword v37, v21, s[8:11], s27 offen
  s_add_u32 s27, s30, 2768896
  buffer_load_dword v38, v21, s[8:11], s27 offen
  s_add_u32 s27, s30, 2834432
  buffer_load_dword v39, v21, s[8:11], s27 offen
  s_waitcnt vmcnt(48)
  v_perm_b32 v120, v73, v72, s44
  v_perm_b32 v121, v75, v74, s44
  v_perm_b32 v122, v77, v76, s44
  v_perm_b32 v123, v79, v78, s44
  v_accvgpr_write_b32 a72, v120
  v_accvgpr_write_b32 a73, v121
  v_accvgpr_write_b32 a74, v122
  v_accvgpr_write_b32 a75, v123
  v_perm_b32 v124, v73, v72, s45
  v_perm_b32 v125, v75, v74, s45
  v_perm_b32 v126, v77, v76, s45
  v_perm_b32 v127, v79, v78, s45
  v_accvgpr_write_b32 a24, v124
  v_accvgpr_write_b32 a25, v125
  v_accvgpr_write_b32 a26, v126
  v_accvgpr_write_b32 a27, v127
  v_perm_b32 v120, v81, v80, s44
  v_perm_b32 v121, v83, v82, s44
  v_perm_b32 v122, v85, v84, s44
  v_perm_b32 v123, v87, v86, s44
  v_accvgpr_write_b32 a76, v120
  v_accvgpr_write_b32 a77, v121
  v_accvgpr_write_b32 a78, v122
  v_accvgpr_write_b32 a79, v123
  v_perm_b32 v124, v81, v80, s45
  v_perm_b32 v125, v83, v82, s45
  v_perm_b32 v126, v85, v84, s45
  v_perm_b32 v127, v87, v86, s45
  v_accvgpr_write_b32 a28, v124
  v_accvgpr_write_b32 a29, v125
  v_accvgpr_write_b32 a30, v126
  v_accvgpr_write_b32 a31, v127
  s_add_u32 s27, s31, 2097152
  buffer_load_dword v40, v21, s[8:11], s27 offen
  s_add_u32 s27, s31, 2162688
  buffer_load_dword v41, v21, s[8:11], s27 offen
  s_add_u32 s27, s31, 2113536
  buffer_load_dword v42, v21, s[8:11], s27 offen
  s_add_u32 s27, s31, 2179072
  buffer_load_dword v43, v21, s[8:11], s27 offen
  s_add_u32 s27, s31, 2228224
  buffer_load_dword v44, v21, s[8:11], s27 offen
  s_add_u32 s27, s31, 2293760
  buffer_load_dword v45, v21, s[8:11], s27 offen
  s_add_u32 s27, s31, 2244608
  buffer_load_dword v46, v21, s[8:11], s27 offen
  s_add_u32 s27, s31, 2310144
  buffer_load_dword v47, v21, s[8:11], s27 offen
  s_add_u32 s27, s31, 2621440
  buffer_load_dword v48, v21, s[8:11], s27 offen
  s_add_u32 s27, s31, 2686976
  buffer_load_dword v49, v21, s[8:11], s27 offen
  s_add_u32 s27, s31, 2637824
  buffer_load_dword v50, v21, s[8:11], s27 offen
  s_add_u32 s27, s31, 2703360
  buffer_load_dword v51, v21, s[8:11], s27 offen
  s_add_u32 s27, s31, 2752512
  buffer_load_dword v52, v21, s[8:11], s27 offen
  s_add_u32 s27, s31, 2818048
  buffer_load_dword v53, v21, s[8:11], s27 offen
  s_add_u32 s27, s31, 2768896
  buffer_load_dword v54, v21, s[8:11], s27 offen
  s_add_u32 s27, s31, 2834432
  buffer_load_dword v55, v21, s[8:11], s27 offen
  s_waitcnt vmcnt(48)
  v_perm_b32 v120, v89, v88, s44
  v_perm_b32 v121, v91, v90, s44
  v_perm_b32 v122, v93, v92, s44
  v_perm_b32 v123, v95, v94, s44
  v_accvgpr_write_b32 a64, v120
  v_accvgpr_write_b32 a65, v121
  v_accvgpr_write_b32 a66, v122
  v_accvgpr_write_b32 a67, v123
  v_perm_b32 v124, v89, v88, s45
  v_perm_b32 v125, v91, v90, s45
  v_perm_b32 v126, v93, v92, s45
  v_perm_b32 v127, v95, v94, s45
  v_accvgpr_write_b32 a16, v124
  v_accvgpr_write_b32 a17, v125
  v_accvgpr_write_b32 a18, v126
  v_accvgpr_write_b32 a19, v127
  v_perm_b32 v120, v97, v96, s44
  v_perm_b32 v121, v99, v98, s44
  v_perm_b32 v122, v101, v100, s44
  v_perm_b32 v123, v103, v102, s44
  v_accvgpr_write_b32 a68, v120
  v_accvgpr_write_b32 a69, v121
  v_accvgpr_write_b32 a70, v122
  v_accvgpr_write_b32 a71, v123
  v_perm_b32 v124, v97, v96, s45
  v_perm_b32 v125, v99, v98, s45
  v_perm_b32 v126, v101, v100, s45
  v_perm_b32 v127, v103, v102, s45
  v_accvgpr_write_b32 a20, v124
  v_accvgpr_write_b32 a21, v125
  v_accvgpr_write_b32 a22, v126
  v_accvgpr_write_b32 a23, v127
  s_add_u32 s27, s32, 2097152
  buffer_load_dword v56, v21, s[8:11], s27 offen
  s_add_u32 s27, s32, 2162688
  buffer_load_dword v57, v21, s[8:11], s27 offen
  s_add_u32 s27, s32, 2113536
  buffer_load_dword v58, v21, s[8:11], s27 offen
  s_add_u32 s27, s32, 2179072
  buffer_load_dword v59, v21, s[8:11], s27 offen
  s_add_u32 s27, s32, 2228224
  buffer_load_dword v60, v21, s[8:11], s27 offen
  s_add_u32 s27, s32, 2293760
  buffer_load_dword v61, v21, s[8:11], s27 offen
  s_add_u32 s27, s32, 2244608
  buffer_load_dword v62, v21, s[8:11], s27 offen
  s_add_u32 s27, s32, 2310144
  buffer_load_dword v63, v21, s[8:11], s27 offen
  s_add_u32 s27, s32, 2621440
  buffer_load_dword v64, v21, s[8:11], s27 offen
  s_add_u32 s27, s32, 2686976
  buffer_load_dword v65, v21, s[8:11], s27 offen
  s_add_u32 s27, s32, 2637824
  buffer_load_dword v66, v21, s[8:11], s27 offen
  s_add_u32 s27, s32, 2703360
  buffer_load_dword v67, v21, s[8:11], s27 offen
  s_add_u32 s27, s32, 2752512
  buffer_load_dword v68, v21, s[8:11], s27 offen
  s_add_u32 s27, s32, 2818048
  buffer_load_dword v69, v21, s[8:11], s27 offen
  s_add_u32 s27, s32, 2768896
  buffer_load_dword v70, v21, s[8:11], s27 offen
  s_add_u32 s27, s32, 2834432
  buffer_load_dword v71, v21, s[8:11], s27 offen
  s_waitcnt vmcnt(48)
  v_perm_b32 v120, v105, v104, s44
  v_perm_b32 v121, v107, v106, s44
  v_perm_b32 v122, v109, v108, s44
  v_perm_b32 v123, v111, v110, s44
  v_accvgpr_write_b32 a56, v120
  v_accvgpr_write_b32 a57, v121
  v_accvgpr_write_b32 a58, v122
  v_accvgpr_write_b32 a59, v123
  v_perm_b32 v124, v105, v104, s45
  v_perm_b32 v125, v107, v106, s45
  v_perm_b32 v126, v109, v108, s45
  v_perm_b32 v127, v111, v110, s45
  v_accvgpr_write_b32 a8, v124
  v_accvgpr_write_b32 a9, v125
  v_accvgpr_write_b32 a10, v126
  v_accvgpr_write_b32 a11, v127
  v_perm_b32 v120, v113, v112, s44
  v_perm_b32 v121, v115, v114, s44
  v_perm_b32 v122, v117, v116, s44
  v_perm_b32 v123, v119, v118, s44
  v_accvgpr_write_b32 a60, v120
  v_accvgpr_write_b32 a61, v121
  v_accvgpr_write_b32 a62, v122
  v_accvgpr_write_b32 a63, v123
  v_perm_b32 v124, v113, v112, s45
  v_perm_b32 v125, v115, v114, s45
  v_perm_b32 v126, v117, v116, s45
  v_perm_b32 v127, v119, v118, s45
  v_accvgpr_write_b32 a12, v124
  v_accvgpr_write_b32 a13, v125
  v_accvgpr_write_b32 a14, v126
  v_accvgpr_write_b32 a15, v127
  s_add_u32 s27, s33, 2097152
  buffer_load_dword v72, v21, s[8:11], s27 offen
  s_add_u32 s27, s33, 2162688
  buffer_load_dword v73, v21, s[8:11], s27 offen
  s_add_u32 s27, s33, 2113536
  buffer_load_dword v74, v21, s[8:11], s27 offen
  s_add_u32 s27, s33, 2179072
  buffer_load_dword v75, v21, s[8:11], s27 offen
  s_add_u32 s27, s33, 2228224
  buffer_load_dword v76, v21, s[8:11], s27 offen
  s_add_u32 s27, s33, 2293760
  buffer_load_dword v77, v21, s[8:11], s27 offen
  s_add_u32 s27, s33, 2244608
  buffer_load_dword v78, v21, s[8:11], s27 offen
  s_add_u32 s27, s33, 2310144
  buffer_load_dword v79, v21, s[8:11], s27 offen
  s_add_u32 s27, s33, 2621440
  buffer_load_dword v80, v21, s[8:11], s27 offen
  s_add_u32 s27, s33, 2686976
  buffer_load_dword v81, v21, s[8:11], s27 offen
  s_add_u32 s27, s33, 2637824
  buffer_load_dword v82, v21, s[8:11], s27 offen
  s_add_u32 s27, s33, 2703360
  buffer_load_dword v83, v21, s[8:11], s27 offen
  s_add_u32 s27, s33, 2752512
  buffer_load_dword v84, v21, s[8:11], s27 offen
  s_add_u32 s27, s33, 2818048
  buffer_load_dword v85, v21, s[8:11], s27 offen
  s_add_u32 s27, s33, 2768896
  buffer_load_dword v86, v21, s[8:11], s27 offen
  s_add_u32 s27, s33, 2834432
  buffer_load_dword v87, v21, s[8:11], s27 offen
  s_waitcnt vmcnt(48)
  v_perm_b32 v120, v25, v24, s44
  v_perm_b32 v121, v27, v26, s44
  v_perm_b32 v122, v29, v28, s44
  v_perm_b32 v123, v31, v30, s44
  ds_write_b128 v1, v[120:123] offset:12288
  s_waitcnt lgkmcnt(0)
  v_perm_b32 v124, v25, v24, s45
  v_perm_b32 v125, v27, v26, s45
  v_perm_b32 v126, v29, v28, s45
  v_perm_b32 v127, v31, v30, s45
  ds_write_b128 v1, v[124:127] offset:14336
  s_waitcnt lgkmcnt(0)
  v_perm_b32 v120, v33, v32, s44
  v_perm_b32 v121, v35, v34, s44
  v_perm_b32 v122, v37, v36, s44
  v_perm_b32 v123, v39, v38, s44
  ds_write_b128 v1, v[120:123] offset:13312
  s_waitcnt lgkmcnt(0)
  v_perm_b32 v124, v33, v32, s45
  v_perm_b32 v125, v35, v34, s45
  v_perm_b32 v126, v37, v36, s45
  v_perm_b32 v127, v39, v38, s45
  ds_write_b128 v1, v[124:127] offset:15360
  s_waitcnt lgkmcnt(0)
  s_load_dwordx2 s[8:9], s[0:1], 32
  s_waitcnt lgkmcnt(0)
  s_add_u32 s27, s30, 0
  buffer_load_dword v88, v21, s[8:11], s27 offen
  s_add_u32 s27, s30, 65536
  buffer_load_dword v89, v21, s[8:11], s27 offen
  s_add_u32 s27, s30, 16384
  buffer_load_dword v90, v21, s[8:11], s27 offen
  s_add_u32 s27, s30, 81920
  buffer_load_dword v91, v21, s[8:11], s27 offen
  s_add_u32 s27, s30, 131072
  buffer_load_dword v92, v21, s[8:11], s27 offen
  s_add_u32 s27, s30, 196608
  buffer_load_dword v93, v21, s[8:11], s27 offen
  s_add_u32 s27, s30, 147456
  buffer_load_dword v94, v21, s[8:11], s27 offen
  s_add_u32 s27, s30, 212992
  buffer_load_dword v95, v21, s[8:11], s27 offen
  s_add_u32 s27, s30, 524288
  buffer_load_dword v96, v21, s[8:11], s27 offen
  s_add_u32 s27, s30, 589824
  buffer_load_dword v97, v21, s[8:11], s27 offen
  s_add_u32 s27, s30, 540672
  buffer_load_dword v98, v21, s[8:11], s27 offen
  s_add_u32 s27, s30, 606208
  buffer_load_dword v99, v21, s[8:11], s27 offen
  s_add_u32 s27, s30, 655360
  buffer_load_dword v100, v21, s[8:11], s27 offen
  s_add_u32 s27, s30, 720896
  buffer_load_dword v101, v21, s[8:11], s27 offen
  s_add_u32 s27, s30, 671744
  buffer_load_dword v102, v21, s[8:11], s27 offen
  s_add_u32 s27, s30, 737280
  buffer_load_dword v103, v21, s[8:11], s27 offen
  s_waitcnt vmcnt(48)
  v_perm_b32 v120, v41, v40, s44
  v_perm_b32 v121, v43, v42, s44
  v_perm_b32 v122, v45, v44, s44
  v_perm_b32 v123, v47, v46, s44
  v_accvgpr_write_b32 a48, v120
  v_accvgpr_write_b32 a49, v121
  v_accvgpr_write_b32 a50, v122
  v_accvgpr_write_b32 a51, v123
  v_perm_b32 v124, v41, v40, s45
  v_perm_b32 v125, v43, v42, s45
  v_perm_b32 v126, v45, v44, s45
  v_perm_b32 v127, v47, v46, s45
  v_accvgpr_write_b32 a0, v124
  v_accvgpr_write_b32 a1, v125
  v_accvgpr_write_b32 a2, v126
  v_accvgpr_write_b32 a3, v127
  v_perm_b32 v120, v49, v48, s44
  v_perm_b32 v121, v51, v50, s44
  v_perm_b32 v122, v53, v52, s44
  v_perm_b32 v123, v55, v54, s44
  v_accvgpr_write_b32 a52, v120
  v_accvgpr_write_b32 a53, v121
  v_accvgpr_write_b32 a54, v122
  v_accvgpr_write_b32 a55, v123
  v_perm_b32 v124, v49, v48, s45
  v_perm_b32 v125, v51, v50, s45
  v_perm_b32 v126, v53, v52, s45
  v_perm_b32 v127, v55, v54, s45
  v_accvgpr_write_b32 a4, v124
  v_accvgpr_write_b32 a5, v125
  v_accvgpr_write_b32 a6, v126
  v_accvgpr_write_b32 a7, v127
  s_add_u32 s27, s31, 0
  buffer_load_dword v104, v21, s[8:11], s27 offen
  s_add_u32 s27, s31, 65536
  buffer_load_dword v105, v21, s[8:11], s27 offen
  s_add_u32 s27, s31, 16384
  buffer_load_dword v106, v21, s[8:11], s27 offen
  s_add_u32 s27, s31, 81920
  buffer_load_dword v107, v21, s[8:11], s27 offen
  s_add_u32 s27, s31, 131072
  buffer_load_dword v108, v21, s[8:11], s27 offen
  s_add_u32 s27, s31, 196608
  buffer_load_dword v109, v21, s[8:11], s27 offen
  s_add_u32 s27, s31, 147456
  buffer_load_dword v110, v21, s[8:11], s27 offen
  s_add_u32 s27, s31, 212992
  buffer_load_dword v111, v21, s[8:11], s27 offen
  s_add_u32 s27, s31, 524288
  buffer_load_dword v112, v21, s[8:11], s27 offen
  s_add_u32 s27, s31, 589824
  buffer_load_dword v113, v21, s[8:11], s27 offen
  s_add_u32 s27, s31, 540672
  buffer_load_dword v114, v21, s[8:11], s27 offen
  s_add_u32 s27, s31, 606208
  buffer_load_dword v115, v21, s[8:11], s27 offen
  s_add_u32 s27, s31, 655360
  buffer_load_dword v116, v21, s[8:11], s27 offen
  s_add_u32 s27, s31, 720896
  buffer_load_dword v117, v21, s[8:11], s27 offen
  s_add_u32 s27, s31, 671744
  buffer_load_dword v118, v21, s[8:11], s27 offen
  s_add_u32 s27, s31, 737280
  buffer_load_dword v119, v21, s[8:11], s27 offen
  s_waitcnt vmcnt(48)
  v_perm_b32 v120, v57, v56, s44
  v_perm_b32 v121, v59, v58, s44
  v_perm_b32 v122, v61, v60, s44
  v_perm_b32 v123, v63, v62, s44
  v_accvgpr_write_b32 a40, v120
  v_accvgpr_write_b32 a41, v121
  v_accvgpr_write_b32 a42, v122
  v_accvgpr_write_b32 a43, v123
  v_perm_b32 v248, v57, v56, s45
  v_perm_b32 v249, v59, v58, s45
  v_perm_b32 v250, v61, v60, s45
  v_perm_b32 v251, v63, v62, s45
  v_perm_b32 v120, v65, v64, s44
  v_perm_b32 v121, v67, v66, s44
  v_perm_b32 v122, v69, v68, s44
  v_perm_b32 v123, v71, v70, s44
  v_accvgpr_write_b32 a44, v120
  v_accvgpr_write_b32 a45, v121
  v_accvgpr_write_b32 a46, v122
  v_accvgpr_write_b32 a47, v123
  v_perm_b32 v252, v65, v64, s45
  v_perm_b32 v253, v67, v66, s45
  v_perm_b32 v254, v69, v68, s45
  v_perm_b32 v255, v71, v70, s45
  s_add_u32 s27, s32, 0
  buffer_load_dword v24, v21, s[8:11], s27 offen
  s_add_u32 s27, s32, 65536
  buffer_load_dword v25, v21, s[8:11], s27 offen
  s_add_u32 s27, s32, 16384
  buffer_load_dword v26, v21, s[8:11], s27 offen
  s_add_u32 s27, s32, 81920
  buffer_load_dword v27, v21, s[8:11], s27 offen
  s_add_u32 s27, s32, 131072
  buffer_load_dword v28, v21, s[8:11], s27 offen
  s_add_u32 s27, s32, 196608
  buffer_load_dword v29, v21, s[8:11], s27 offen
  s_add_u32 s27, s32, 147456
  buffer_load_dword v30, v21, s[8:11], s27 offen
  s_add_u32 s27, s32, 212992
  buffer_load_dword v31, v21, s[8:11], s27 offen
  s_add_u32 s27, s32, 524288
  buffer_load_dword v32, v21, s[8:11], s27 offen
  s_add_u32 s27, s32, 589824
  buffer_load_dword v33, v21, s[8:11], s27 offen
  s_add_u32 s27, s32, 540672
  buffer_load_dword v34, v21, s[8:11], s27 offen
  s_add_u32 s27, s32, 606208
  buffer_load_dword v35, v21, s[8:11], s27 offen
  s_add_u32 s27, s32, 655360
  buffer_load_dword v36, v21, s[8:11], s27 offen
  s_add_u32 s27, s32, 720896
  buffer_load_dword v37, v21, s[8:11], s27 offen
  s_add_u32 s27, s32, 671744
  buffer_load_dword v38, v21, s[8:11], s27 offen
  s_add_u32 s27, s32, 737280
  buffer_load_dword v39, v21, s[8:11], s27 offen
  s_waitcnt vmcnt(48)
  v_perm_b32 v120, v73, v72, s44
  v_perm_b32 v121, v75, v74, s44
  v_perm_b32 v122, v77, v76, s44
  v_perm_b32 v123, v79, v78, s44
  v_accvgpr_write_b32 a32, v120
  v_accvgpr_write_b32 a33, v121
  v_accvgpr_write_b32 a34, v122
  v_accvgpr_write_b32 a35, v123
  v_perm_b32 v240, v73, v72, s45
  v_perm_b32 v241, v75, v74, s45
  v_perm_b32 v242, v77, v76, s45
  v_perm_b32 v243, v79, v78, s45
  v_perm_b32 v120, v81, v80, s44
  v_perm_b32 v121, v83, v82, s44
  v_perm_b32 v122, v85, v84, s44
  v_perm_b32 v123, v87, v86, s44
  v_accvgpr_write_b32 a36, v120
  v_accvgpr_write_b32 a37, v121
  v_accvgpr_write_b32 a38, v122
  v_accvgpr_write_b32 a39, v123
  v_perm_b32 v244, v81, v80, s45
  v_perm_b32 v245, v83, v82, s45
  v_perm_b32 v246, v85, v84, s45
  v_perm_b32 v247, v87, v86, s45
  s_add_u32 s27, s33, 0
  buffer_load_dword v40, v21, s[8:11], s27 offen
  s_add_u32 s27, s33, 65536
  buffer_load_dword v41, v21, s[8:11], s27 offen
  s_add_u32 s27, s33, 16384
  buffer_load_dword v42, v21, s[8:11], s27 offen
  s_add_u32 s27, s33, 81920
  buffer_load_dword v43, v21, s[8:11], s27 offen
  s_add_u32 s27, s33, 131072
  buffer_load_dword v44, v21, s[8:11], s27 offen
  s_add_u32 s27, s33, 196608
  buffer_load_dword v45, v21, s[8:11], s27 offen
  s_add_u32 s27, s33, 147456
  buffer_load_dword v46, v21, s[8:11], s27 offen
  s_add_u32 s27, s33, 212992
  buffer_load_dword v47, v21, s[8:11], s27 offen
  s_add_u32 s27, s33, 524288
  buffer_load_dword v48, v21, s[8:11], s27 offen
  s_add_u32 s27, s33, 589824
  buffer_load_dword v49, v21, s[8:11], s27 offen
  s_add_u32 s27, s33, 540672
  buffer_load_dword v50, v21, s[8:11], s27 offen
  s_add_u32 s27, s33, 606208
  buffer_load_dword v51, v21, s[8:11], s27 offen
  s_add_u32 s27, s33, 655360
  buffer_load_dword v52, v21, s[8:11], s27 offen
  s_add_u32 s27, s33, 720896
  buffer_load_dword v53, v21, s[8:11], s27 offen
  s_add_u32 s27, s33, 671744
  buffer_load_dword v54, v21, s[8:11], s27 offen
  s_add_u32 s27, s33, 737280
  buffer_load_dword v55, v21, s[8:11], s27 offen
  s_waitcnt vmcnt(48)
  v_perm_b32 v120, v89, v88, s44
  v_perm_b32 v121, v91, v90, s44
  v_perm_b32 v122, v93, v92, s44
  v_perm_b32 v123, v95, v94, s44
  ds_write_b128 v1, v[120:123] offset:16384
  s_waitcnt lgkmcnt(0)
  v_perm_b32 v124, v89, v88, s45
  v_perm_b32 v125, v91, v90, s45
  v_perm_b32 v126, v93, v92, s45
  v_perm_b32 v127, v95, v94, s45
  ds_write_b128 v1, v[124:127] offset:18432
  s_waitcnt lgkmcnt(0)
  v_perm_b32 v120, v97, v96, s44
  v_perm_b32 v121, v99, v98, s44
  v_perm_b32 v122, v101, v100, s44
  v_perm_b32 v123, v103, v102, s44
  ds_write_b128 v1, v[120:123] offset:17408
  s_waitcnt lgkmcnt(0)
  v_perm_b32 v124, v97, v96, s45
  v_perm_b32 v125, v99, v98, s45
  v_perm_b32 v126, v101, v100, s45
  v_perm_b32 v127, v103, v102, s45
  ds_write_b128 v1, v[124:127] offset:19456
  s_waitcnt lgkmcnt(0)
  s_add_u32 s27, s30, 2097152
  buffer_load_dword v56, v21, s[8:11], s27 offen
  s_add_u32 s27, s30, 2162688
  buffer_load_dword v57, v21, s[8:11], s27 offen
  s_add_u32 s27, s30, 2113536
  buffer_load_dword v58, v21, s[8:11], s27 offen
  s_add_u32 s27, s30, 2179072
  buffer_load_dword v59, v21, s[8:11], s27 offen
  s_add_u32 s27, s30, 2228224
  buffer_load_dword v60, v21, s[8:11], s27 offen
  s_add_u32 s27, s30, 2293760
  buffer_load_dword v61, v21, s[8:11], s27 offen
  s_add_u32 s27, s30, 2244608
  buffer_load_dword v62, v21, s[8:11], s27 offen
  s_add_u32 s27, s30, 2310144
  buffer_load_dword v63, v21, s[8:11], s27 offen
  s_add_u32 s27, s30, 2621440
  buffer_load_dword v64, v21, s[8:11], s27 offen
  s_add_u32 s27, s30, 2686976
  buffer_load_dword v65, v21, s[8:11], s27 offen
  s_add_u32 s27, s30, 2637824
  buffer_load_dword v66, v21, s[8:11], s27 offen
  s_add_u32 s27, s30, 2703360
  buffer_load_dword v67, v21, s[8:11], s27 offen
  s_add_u32 s27, s30, 2752512
  buffer_load_dword v68, v21, s[8:11], s27 offen
  s_add_u32 s27, s30, 2818048
  buffer_load_dword v69, v21, s[8:11], s27 offen
  s_add_u32 s27, s30, 2768896
  buffer_load_dword v70, v21, s[8:11], s27 offen
  s_add_u32 s27, s30, 2834432
  buffer_load_dword v71, v21, s[8:11], s27 offen
  s_waitcnt vmcnt(48)
  v_perm_b32 v232, v105, v104, s44
  v_perm_b32 v233, v107, v106, s44
  v_perm_b32 v234, v109, v108, s44
  v_perm_b32 v235, v111, v110, s44
  v_perm_b32 v176, v105, v104, s45
  v_perm_b32 v177, v107, v106, s45
  v_perm_b32 v178, v109, v108, s45
  v_perm_b32 v179, v111, v110, s45
  v_perm_b32 v236, v113, v112, s44
  v_perm_b32 v237, v115, v114, s44
  v_perm_b32 v238, v117, v116, s44
  v_perm_b32 v239, v119, v118, s44
  v_perm_b32 v180, v113, v112, s45
  v_perm_b32 v181, v115, v114, s45
  v_perm_b32 v182, v117, v116, s45
  v_perm_b32 v183, v119, v118, s45
  s_add_u32 s27, s31, 2097152
  buffer_load_dword v72, v21, s[8:11], s27 offen
  s_add_u32 s27, s31, 2162688
  buffer_load_dword v73, v21, s[8:11], s27 offen
  s_add_u32 s27, s31, 2113536
  buffer_load_dword v74, v21, s[8:11], s27 offen
  s_add_u32 s27, s31, 2179072
  buffer_load_dword v75, v21, s[8:11], s27 offen
  s_add_u32 s27, s31, 2228224
  buffer_load_dword v76, v21, s[8:11], s27 offen
  s_add_u32 s27, s31, 2293760
  buffer_load_dword v77, v21, s[8:11], s27 offen
  s_add_u32 s27, s31, 2244608
  buffer_load_dword v78, v21, s[8:11], s27 offen
  s_add_u32 s27, s31, 2310144
  buffer_load_dword v79, v21, s[8:11], s27 offen
  s_add_u32 s27, s31, 2621440
  buffer_load_dword v80, v21, s[8:11], s27 offen
  s_add_u32 s27, s31, 2686976
  buffer_load_dword v81, v21, s[8:11], s27 offen
  s_add_u32 s27, s31, 2637824
  buffer_load_dword v82, v21, s[8:11], s27 offen
  s_add_u32 s27, s31, 2703360
  buffer_load_dword v83, v21, s[8:11], s27 offen
  s_add_u32 s27, s31, 2752512
  buffer_load_dword v84, v21, s[8:11], s27 offen
  s_add_u32 s27, s31, 2818048
  buffer_load_dword v85, v21, s[8:11], s27 offen
  s_add_u32 s27, s31, 2768896
  buffer_load_dword v86, v21, s[8:11], s27 offen
  s_add_u32 s27, s31, 2834432
  buffer_load_dword v87, v21, s[8:11], s27 offen
  s_waitcnt vmcnt(48)
  v_perm_b32 v224, v25, v24, s44
  v_perm_b32 v225, v27, v26, s44
  v_perm_b32 v226, v29, v28, s44
  v_perm_b32 v227, v31, v30, s44
  v_perm_b32 v168, v25, v24, s45
  v_perm_b32 v169, v27, v26, s45
  v_perm_b32 v170, v29, v28, s45
  v_perm_b32 v171, v31, v30, s45
  v_perm_b32 v228, v33, v32, s44
  v_perm_b32 v229, v35, v34, s44
  v_perm_b32 v230, v37, v36, s44
  v_perm_b32 v231, v39, v38, s44
  v_perm_b32 v172, v33, v32, s45
  v_perm_b32 v173, v35, v34, s45
  v_perm_b32 v174, v37, v36, s45
  v_perm_b32 v175, v39, v38, s45
  s_add_u32 s27, s32, 2097152
  buffer_load_dword v88, v21, s[8:11], s27 offen
  s_add_u32 s27, s32, 2162688
  buffer_load_dword v89, v21, s[8:11], s27 offen
  s_add_u32 s27, s32, 2113536
  buffer_load_dword v90, v21, s[8:11], s27 offen
  s_add_u32 s27, s32, 2179072
  buffer_load_dword v91, v21, s[8:11], s27 offen
  s_add_u32 s27, s32, 2228224
  buffer_load_dword v92, v21, s[8:11], s27 offen
  s_add_u32 s27, s32, 2293760
  buffer_load_dword v93, v21, s[8:11], s27 offen
  s_add_u32 s27, s32, 2244608
  buffer_load_dword v94, v21, s[8:11], s27 offen
  s_add_u32 s27, s32, 2310144
  buffer_load_dword v95, v21, s[8:11], s27 offen
  s_add_u32 s27, s32, 2621440
  buffer_load_dword v96, v21, s[8:11], s27 offen
  s_add_u32 s27, s32, 2686976
  buffer_load_dword v97, v21, s[8:11], s27 offen
  s_add_u32 s27, s32, 2637824
  buffer_load_dword v98, v21, s[8:11], s27 offen
  s_add_u32 s27, s32, 2703360
  buffer_load_dword v99, v21, s[8:11], s27 offen
  s_add_u32 s27, s32, 2752512
  buffer_load_dword v100, v21, s[8:11], s27 offen
  s_add_u32 s27, s32, 2818048
  buffer_load_dword v101, v21, s[8:11], s27 offen
  s_add_u32 s27, s32, 2768896
  buffer_load_dword v102, v21, s[8:11], s27 offen
  s_add_u32 s27, s32, 2834432
  buffer_load_dword v103, v21, s[8:11], s27 offen
  s_waitcnt vmcnt(48)
  v_perm_b32 v216, v41, v40, s44
  v_perm_b32 v217, v43, v42, s44
  v_perm_b32 v218, v45, v44, s44
  v_perm_b32 v219, v47, v46, s44
  v_perm_b32 v160, v41, v40, s45
  v_perm_b32 v161, v43, v42, s45
  v_perm_b32 v162, v45, v44, s45
  v_perm_b32 v163, v47, v46, s45
  v_perm_b32 v220, v49, v48, s44
  v_perm_b32 v221, v51, v50, s44
  v_perm_b32 v222, v53, v52, s44
  v_perm_b32 v223, v55, v54, s44
  v_perm_b32 v164, v49, v48, s45
  v_perm_b32 v165, v51, v50, s45
  v_perm_b32 v166, v53, v52, s45
  v_perm_b32 v167, v55, v54, s45
  s_add_u32 s27, s33, 2097152
  buffer_load_dword v104, v21, s[8:11], s27 offen
  s_add_u32 s27, s33, 2162688
  buffer_load_dword v105, v21, s[8:11], s27 offen
  s_add_u32 s27, s33, 2113536
  buffer_load_dword v106, v21, s[8:11], s27 offen
  s_add_u32 s27, s33, 2179072
  buffer_load_dword v107, v21, s[8:11], s27 offen
  s_add_u32 s27, s33, 2228224
  buffer_load_dword v108, v21, s[8:11], s27 offen
  s_add_u32 s27, s33, 2293760
  buffer_load_dword v109, v21, s[8:11], s27 offen
  s_add_u32 s27, s33, 2244608
  buffer_load_dword v110, v21, s[8:11], s27 offen
  s_add_u32 s27, s33, 2310144
  buffer_load_dword v111, v21, s[8:11], s27 offen
  s_add_u32 s27, s33, 2621440
  buffer_load_dword v112, v21, s[8:11], s27 offen
  s_add_u32 s27, s33, 2686976
  buffer_load_dword v113, v21, s[8:11], s27 offen
  s_add_u32 s27, s33, 2637824
  buffer_load_dword v114, v21, s[8:11], s27 offen
  s_add_u32 s27, s33, 2703360
  buffer_load_dword v115, v21, s[8:11], s27 offen
  s_add_u32 s27, s33, 2752512
  buffer_load_dword v116, v21, s[8:11], s27 offen
  s_add_u32 s27, s33, 2818048
  buffer_load_dword v117, v21, s[8:11], s27 offen
  s_add_u32 s27, s33, 2768896
  buffer_load_dword v118, v21, s[8:11], s27 offen
  s_add_u32 s27, s33, 2834432
  buffer_load_dword v119, v21, s[8:11], s27 offen
  s_waitcnt vmcnt(48)
  v_perm_b32 v208, v57, v56, s44
  v_perm_b32 v209, v59, v58, s44
  v_perm_b32 v210, v61, v60, s44
  v_perm_b32 v211, v63, v62, s44
  v_perm_b32 v152, v57, v56, s45
  v_perm_b32 v153, v59, v58, s45
  v_perm_b32 v154, v61, v60, s45
  v_perm_b32 v155, v63, v62, s45
  v_perm_b32 v212, v65, v64, s44
  v_perm_b32 v213, v67, v66, s44
  v_perm_b32 v214, v69, v68, s44
  v_perm_b32 v215, v71, v70, s44
  v_perm_b32 v156, v65, v64, s45
  v_perm_b32 v157, v67, v66, s45
  v_perm_b32 v158, v69, v68, s45
  v_perm_b32 v159, v71, v70, s45
  s_waitcnt vmcnt(32)
  v_perm_b32 v200, v73, v72, s44
  v_perm_b32 v201, v75, v74, s44
  v_perm_b32 v202, v77, v76, s44
  v_perm_b32 v203, v79, v78, s44
  v_perm_b32 v144, v73, v72, s45
  v_perm_b32 v145, v75, v74, s45
  v_perm_b32 v146, v77, v76, s45
  v_perm_b32 v147, v79, v78, s45
  v_perm_b32 v204, v81, v80, s44
  v_perm_b32 v205, v83, v82, s44
  v_perm_b32 v206, v85, v84, s44
  v_perm_b32 v207, v87, v86, s44
  v_perm_b32 v148, v81, v80, s45
  v_perm_b32 v149, v83, v82, s45
  v_perm_b32 v150, v85, v84, s45
  v_perm_b32 v151, v87, v86, s45
  s_waitcnt vmcnt(16)
  v_perm_b32 v192, v89, v88, s44
  v_perm_b32 v193, v91, v90, s44
  v_perm_b32 v194, v93, v92, s44
  v_perm_b32 v195, v95, v94, s44
  v_perm_b32 v136, v89, v88, s45
  v_perm_b32 v137, v91, v90, s45
  v_perm_b32 v138, v93, v92, s45
  v_perm_b32 v139, v95, v94, s45
  v_perm_b32 v196, v97, v96, s44
  v_perm_b32 v197, v99, v98, s44
  v_perm_b32 v198, v101, v100, s44
  v_perm_b32 v199, v103, v102, s44
  v_perm_b32 v140, v97, v96, s45
  v_perm_b32 v141, v99, v98, s45
  v_perm_b32 v142, v101, v100, s45
  v_perm_b32 v143, v103, v102, s45
  s_waitcnt vmcnt(0)
  v_perm_b32 v184, v105, v104, s44
  v_perm_b32 v185, v107, v106, s44
  v_perm_b32 v186, v109, v108, s44
  v_perm_b32 v187, v111, v110, s44
  v_perm_b32 v128, v105, v104, s45
  v_perm_b32 v129, v107, v106, s45
  v_perm_b32 v130, v109, v108, s45
  v_perm_b32 v131, v111, v110, s45
  v_perm_b32 v188, v113, v112, s44
  v_perm_b32 v189, v115, v114, s44
  v_perm_b32 v190, v117, v116, s44
  v_perm_b32 v191, v119, v118, s44
  v_perm_b32 v132, v113, v112, s45
  v_perm_b32 v133, v115, v114, s45
  v_perm_b32 v134, v117, v116, s45
  v_perm_b32 v135, v119, v118, s45
  s_mov_b32 s26, 0
  v_mov_b32 v20, s38
g_wc_2:
  global_load_dword v21, v20, s[12:13] sc1
  s_add_u32 s26, s26, 1
  s_cmp_gt_u32 s26, 1048576
  s_cbranch_scc1 L_end
  s_waitcnt vmcnt(0)
  v_readfirstlane_b32 s27, v21
  s_cmp_lt_u32 s27, 32
  s_cbranch_scc1 g_wc_2
  s_mov_b32 s26, 0
  v_mov_b32 v20, 160
g_wc_3:
  global_load_dword v21, v20, s[12:13] sc1
  s_add_u32 s26, s26, 1
  s_cmp_gt_u32 s26, 1048576
  s_cbranch_scc1 L_end
  s_waitcnt vmcnt(0)
  v_readfirstlane_b32 s27, v21
  s_cmp_lt_u32 s27, 64
  s_cbranch_scc1 g_wc_3
  s_mov_b32 s26, 0
g_pu_4:
  v_and_b32 v20, 0x70, v0
  global_load_dword v21, v20, s[12:13] sc1
  s_waitcnt vmcnt(0)
  v_readlane_b32 s28, v21, 0
  v_readlane_b32 s29, v21, 1
  v_readlane_b32 s30, v21, 2
  v_readlane_b32 s31, v21, 3
  v_readlane_b32 s32, v21, 4
  v_readlane_b32 s33, v21, 5
  v_readlane_b32 s34, v21, 6
  v_readlane_b32 s35, v21, 7
  s_add_u32 s27, s28, s29
  s_add_u32 s27, s27, s30
  s_add_u32 s27, s27, s31
  s_add_u32 s27, s27, s32
  s_add_u32 s27, s27, s33
  s_add_u32 s27, s27, s34
  s_add_u32 s27, s27, s35
  v_readlane_b32 s36, v21, s91
  s_cmp_ge_u32 s36, 32
  s_cbranch_scc1 g_pure_5
  s_cmp_ge_u32 s27, 256
  s_cbranch_scc1 L_chain_x
  s_add_u32 s26, s26, 1
  s_cmp_gt_u32 s26, 1048576
  s_cbranch_scc1 L_end
  s_branch g_pu_4
g_pure_5:
  s_mov_b32 s22, 0
  s_mov_b32 s42, s62
  s_add_u32 s43, s62, 4096
  s_mov_b32 s46, 0
  s_mov_b32 s47, 0
  s_lshl_b32 s26, s16, 2
  s_add_u32 s26, s26, s17
  s_lshl_b32 s27, s60, 13
  s_add_u32 s27, s27, s26
  s_lshl_b32 s25, s27, 11
  s_add_u32 s25, s25, 192937984
  s_lshl_b32 s64, s60, 14
  s_add_u32 s64, s64, s26
  s_lshl_b32 s64, s64, 2
  s_add_u32 s64, s64, 5512704
  s_lshl_b32 s27, s61, 13
  s_add_u32 s27, s27, s26
  s_lshl_b32 s23, s27, 12
  s_add_u32 s23, s23, 41943040
  s_lshl_b32 s63, s27, 2
  s_add_u32 s63, s63, 5308416
  s_mov_b32 s97, 268435456
  s_cmp_eq_u32 s60, 2
  s_cselect_b32 s92, 32768, 0
  s_cselect_b32 s93, 2, 1
  s_add_u32 s92, s92, s63
  s_lshl_b32 s26, s17, 2
  s_add_u32 s26, s26, s60
  s_cmp_eq_u32 s26, 1
  s_cselect_b32 s97, 5767168, s97
  s_mov_b32 s95, 0
  s_mov_b32 s96, s23
  s_mov_b32 s29, 0
c_gw_14:
  buffer_load_dword v7, off, s[4:7], s92 sc1
  s_add_u32 s29, s29, 1
  s_cmp_gt_u32 s29, 1048576
  s_cbranch_scc1 c_fail_12
  s_waitcnt vmcnt(0)
  v_readfirstlane_b32 s94, v7
  s_cmp_eq_u32 s94, 0
  s_cbranch_scc1 c_gw_14
  s_cmp_lg_u32 s94, s93
  s_cselect_b32 s95, 1, 0
  s_lshl_b32 s30, s95, 25
  s_add_u32 s96, s23, s30
  s_cmp_lg_u32 s95, 0
  s_cbranch_scc1 c_kvx_16
c_kvw_15:
  buffer_load_dword v7, off, s[4:7], s63 sc1
  s_add_u32 s29, s29, 1
  s_cmp_gt_u32 s29, 1048576
  s_cbranch_scc1 c_fail_12
  s_waitcnt vmcnt(0)
  v_readfirstlane_b32 s65, v7
  s_cmp_eq_u32 s65, 0
  s_cbranch_scc1 c_kvw_15
c_kvx_16:
  buffer_load_dwordx4 v0, s[4:7], s96 offen offset:0  lds
  buffer_load_dwordx4 v0, s[4:7], s96 offen offset:1024  lds
  buffer_load_dwordx4 v0, s[4:7], s96 offen offset:2048  lds
  buffer_load_dwordx4 v0, s[4:7], s96 offen offset:3072  lds
  s_add_u32 s23, s23, 524288
  s_add_u32 s63, s63, 512
  s_mov_b32 s65, 0
  s_add_u32 s92, s92, 512
  s_mov_b32 s94, 0
  s_mov_b32 s95, 0
  s_mov_b32 s96, s23
  ds_read_b128 v[72:75], v1 offset:6144
  ds_read_b128 v[76:79], v1 offset:7168
  ds_read_b128 v[80:83], v1 offset:8192
  ds_read_b128 v[84:87], v1 offset:9216
  ds_read_b128 v[88:91], v1 offset:10240
  ds_read_b128 v[92:95], v1 offset:11264
  ds_read_b128 v[96:99], v1 offset:12288
  ds_read_b128 v[100:103], v1 offset:13312
  ds_read_b128 v[104:107], v1 offset:14336
  ds_read_b128 v[108:111], v1 offset:15360
  ds_read_b128 v[112:115], v1 offset:16384
  ds_read_b128 v[116:119], v1 offset:17408
  ds_read_b128 v[120:123], v1 offset:18432
  ds_read_b128 v[124:127], v1 offset:19456
  v_mov_b64 v[48:49], 0
  v_mov_b64 v[50:51], 0
  v_mov_b64 v[52:53], 0
  v_mov_b64 v[54:55], 0
  v_mov_b64 v[56:57], 0
  v_mov_b64 v[58:59], 0
  v_mov_b64 v[60:61], 0
  v_mov_b64 v[62:63], 0
  v_mov_b64 v[64:65], 0
  v_mov_b64 v[66:67], 0
  v_mov_b64 v[68:69], 0
  v_mov_b64 v[70:71], 0
  s_lshl_b32 s38, s16, 13
  s_add_u32 s38, s38, s40
  s_add_u32 s39, s38, 4096
  ds_read_b128 v[24:27], v1 offset:0
  ds_read_b128 v[28:31], v1 offset:1024
  ds_read_b128 v[32:35], v1 offset:2048
  ds_read_b128 v[36:39], v1 offset:3072
  ds_read_b128 v[40:43], v1 offset:4096
  ds_read_b128 v[44:47], v1 offset:5120
  s_waitcnt lgkmcnt(0)
c_loop_6:
  buffer_load_dwordx4 v[16:19], v8, s[4:7], s42 offen sc1
  buffer_load_dwordx4 v[20:23], v8, s[4:7], s43 offen sc1
  s_mov_b32 s28, 0
  s_cmp_eq_u32 s17, 0
  s_cbranch_scc1 c_w0a_17
  s_nop 15
  s_nop 8
  buffer_load_dwordx4 v[16:19], v8, s[4:7], s42 offen sc1
  buffer_load_dwordx4 v[20:23], v8, s[4:7], s43 offen sc1
  s_nop 15
  s_nop 8
  buffer_load_dwordx4 v[16:19], v8, s[4:7], s42 offen sc1
  buffer_load_dwordx4 v[20:23], v8, s[4:7], s43 offen sc1
c_w0b_18:
  s_waitcnt lgkmcnt(0)
  s_waitcnt vmcnt(5)
  v_max3_u32 v7, v16, v17, v18
  v_max_u32 v7, v7, v19
  ds_write_b128 v8, v[16:19] offset:0
  v_smfmac_f32_16x16x64_bf16 v[48:51], v[16:19], v[24:31], v6
  s_waitcnt vmcnt(4)
c_got_8:
  v_max3_u32 v7, v20, v21, v7
  v_max3_u32 v7, v22, v23, v7
  ds_write_b128 v8, v[20:23] offset:4096
  v_smfmac_f32_16x16x64_bf16 v[52:55], v[16:19], v[32:39], v6
  v_cmp_eq_u32 vcc, -1, v7
  v_smfmac_f32_16x16x64_bf16 v[56:59], v[16:19], v[40:47], v6
  s_cbranch_vccnz c_retry_7
  v_smfmac_f32_16x16x64_bf16 v[60:63], v[16:19], v[72:79], v6
  s_mul_i32 s65, s65, s94
  s_cmp_lg_u32 s65, s93
  s_cbranch_scc1 c_kvs_19
c_kvr_20:
  v_smfmac_f32_16x16x64_bf16 v[48:51], v[20:23], v[80:87], v6
  v_mov_b32 v7, 1
  v_smfmac_f32_16x16x64_bf16 v[52:55], v[20:23], v[88:95], v6
  v_smfmac_f32_16x16x64_bf16 v[56:59], v[20:23], v[96:103], v6
  s_waitcnt lgkmcnt(0)
  s_barrier
  ds_read_b128 v[24:27], v9 offset:0
  ds_read_b128 v[28:31], v10 offset:0
  v_smfmac_f32_16x16x64_bf16 v[60:63], v[20:23], v[104:111], v6
  ds_read_b128 v[32:35], v11 offset:0
  v_smfmac_f32_16x16x64_bf16 v[64:67], v[16:19], v[112:119], v6
  ds_read_b128 v[36:39], v9 offset:4096
  v_smfmac_f32_16x16x64_bf16 v[68:71], v[16:19], v[120:127], v6
  ds_read_b128 v[40:43], v10 offset:4096
  v_smfmac_f32_16x16x64_bf16 v[64:67], v[20:23], v[208:215], v6
  ds_read_b128 v[44:47], v11 offset:4096
  s_waitcnt lgkmcnt(5)
  v_smfmac_f32_16x16x64_bf16 v[48:51], v[24:27], a[168:175], v6
  ds_read_b128 v[72:75], v1 offset:32768
  s_waitcnt lgkmcnt(5)
  v_smfmac_f32_16x16x64_bf16 v[48:51], v[28:31], a[160:167], v6
  ds_read_b128 v[76:79], v1 offset:33792
  s_waitcnt lgkmcnt(5)
  v_smfmac_f32_16x16x64_bf16 v[48:51], v[32:35], a[152:159], v6
  ds_read_b128 v[80:83], v1 offset:34816
  s_waitcnt lgkmcnt(5)
  v_smfmac_f32_16x16x64_bf16 v[48:51], v[36:39], a[144:151], v6
  ds_read_b128 v[84:87], v1 offset:35840
  s_waitcnt lgkmcnt(5)
  v_smfmac_f32_16x16x64_bf16 v[48:51], v[40:43], a[136:143], v6
  ds_read_b128 v[104:107], v1 offset:20480
  s_waitcnt lgkmcnt(5)
  v_smfmac_f32_16x16x64_bf16 v[48:51], v[44:47], a[128:135], v6
  ds_read_b128 v[108:111], v1 offset:21504
  v_smfmac_f32_16x16x64_bf16 v[52:55], v[24:27], a[120:127], v6
  s_waitcnt lgkmcnt(5)
  buffer_load_dwordx4 v0, s[4:7], s96 offen offset:0  lds
  s_mov_b64 exec, 1
  buffer_store_dword v7, off, s[4:7], s64 sc1
  s_mov_b64 exec, -1
  v_smfmac_f32_16x16x64_bf16 v[52:55], v[28:31], a[112:119], v6
  s_waitcnt lgkmcnt(2)
  ds_read_b64 v[100:101], v5 offset:0
  v_smfmac_f32_16x16x64_bf16 v[52:55], v[32:35], a[104:111], v6
  v_add_f32 v48, v48, v50
  v_smfmac_f32_16x16x64_bf16 v[52:55], v[36:39], a[96:103], v6
  v_add_f32 v49, v49, v51
  v_smfmac_f32_16x16x64_bf16 v[52:55], v[40:43], a[88:95], v6
  v_cvt_pk_bf16_f32 v50, v48, v49
  v_smfmac_f32_16x16x64_bf16 v[52:55], v[44:47], a[80:87], v6
  v_cvt_pk_bf16_f32 v51, v48, v49
  v_smfmac_f32_16x16x64_bf16 v[56:59], v[24:27], a[72:79], v6
  ds_write_b64 v2, v[50:51] offset:8192
  v_smfmac_f32_16x16x64_bf16 v[56:59], v[28:31], a[64:71], v6
  ds_read_b64_tr_b16 v[88:89], v12 offset:8192
  s_nop 0
  v_smfmac_f32_16x16x64_bf16 v[56:59], v[32:35], a[56:63], v6
  s_nop 0
  v_add_f32 v52, v52, v54
  v_add_f32 v53, v53, v55
  v_cvt_pk_bf16_f32 v54, v52, v53
  v_cvt_pk_bf16_f32 v55, v52, v53
  ds_write_b64 v2, v[54:55] offset:8704
  v_smfmac_f32_16x16x64_bf16 v[56:59], v[36:39], a[48:55], v6
  ds_read_b64_tr_b16 v[90:91], v12 offset:8704
  v_smfmac_f32_16x16x64_bf16 v[56:59], v[40:43], a[40:47], v6
  buffer_load_dwordx4 v0, s[4:7], s96 offen offset:1024  lds
  v_smfmac_f32_16x16x64_bf16 v[56:59], v[44:47], a[32:39], v6
  ds_read_b128 v[112:115], v1 offset:22528
  v_smfmac_f32_16x16x64_bf16 v[60:63], v[24:27], a[24:31], v6
  buffer_load_dwordx4 v0, s[4:7], s96 offen offset:2048  lds
  v_smfmac_f32_16x16x64_bf16 v[60:63], v[28:31], a[16:23], v6
  s_waitcnt lgkmcnt(1)
  v_mfma_f32_16x16x32_bf16 v[92:95], v[72:75], v[88:91], 0
  buffer_load_dwordx4 v0, s[4:7], s96 offen offset:3072  lds
  v_mfma_f32_16x16x32_bf16 v[96:99], v[76:79], v[88:91], 0
  v_add_f32 v56, v56, v58
  v_add_f32 v57, v57, v59
  v_smfmac_f32_16x16x64_bf16 v[60:63], v[32:35], a[8:15], v6
  v_cvt_pk_bf16_f32 v58, v56, v57
  v_smfmac_f32_16x16x64_bf16 v[60:63], v[36:39], a[0:7], v6
  ds_write_b32 v2, v58 offset:8192
  v_smfmac_f32_16x16x64_bf16 v[60:63], v[40:43], v[248:255], v6
  s_nop 0
  v_cndmask_b32 v48, v92, v96, s[18:19]
  v_smfmac_f32_16x16x64_bf16 v[60:63], v[44:47], v[240:247], v6
  v_cndmask_b32 v49, v93, v97, s[18:19]
  v_cndmask_b32 v50, v94, v98, s[18:19]
  v_cndmask_b32 v51, v95, v99, s[18:19]
  ds_write_b128 v8, v[48:51] offset:12288
  v_smfmac_f32_16x16x64_bf16 v[68:71], v[20:23], v[152:159], v6
  s_nop 1
  s_nop 0
  v_add_f32 v60, v60, v62
  v_add_f32 v61, v61, v63
  v_cvt_pk_bf16_f32 v62, v60, v61
  ds_write_b32 v2, v62 offset:8704
  v_smfmac_f32_16x16x64_bf16 v[64:67], v[24:27], v[232:239], v6
  v_mov_b32 v76, 0
  buffer_store_dwordx2 v[100:101], v5, s[4:7], s97 offen sc1
  v_smfmac_f32_16x16x64_bf16 v[64:67], v[28:31], v[224:231], v6
  v_mov_b32 v79, 0
  s_waitcnt vmcnt(6)
  v_smfmac_f32_16x16x64_bf16 v[64:67], v[32:35], v[216:223], v6
  ds_read_b128 v[116:119], v1 offset:23552
  v_smfmac_f32_16x16x64_bf16 v[64:67], v[36:39], v[200:207], v6
  s_waitcnt lgkmcnt(1)
  s_barrier
  ds_read_b128 v[52:55], v9 offset:12288
  ds_read_b128 v[56:59], v10 offset:12288
  v_smfmac_f32_16x16x64_bf16 v[64:67], v[40:43], v[192:199], v6
  ds_read_b128 v[60:63], v11 offset:12288
  v_smfmac_f32_16x16x64_bf16 v[64:67], v[44:47], v[184:191], v6
  ds_read_b64_tr_b16 v[88:89], v12 offset:8192
  ds_read_b64_tr_b16 v[90:91], v12 offset:8704
  v_smfmac_f32_16x16x64_bf16 v[68:71], v[24:27], v[176:183], v6
  ds_read_b64_tr_b16 v[92:93], v13 offset:8192
  ds_read_b64_tr_b16 v[94:95], v13 offset:8704
  v_smfmac_f32_16x16x64_bf16 v[68:71], v[28:31], v[168:175], v6
  ds_read_b64_tr_b16 v[96:97], v14 offset:8192
  ds_read_b64_tr_b16 v[98:99], v14 offset:8704
  v_smfmac_f32_16x16x64_bf16 v[68:71], v[32:35], v[160:167], v6
  ds_read_b64_tr_b16 v[100:101], v15 offset:8192
  ds_read_b64_tr_b16 v[102:103], v15 offset:8704
  s_waitcnt lgkmcnt(8)
  v_smfmac_f32_16x16x64_bf16 v[68:71], v[36:39], v[144:151], v6
  v_add_f32 v48, v48, v52
  v_smfmac_f32_16x16x64_bf16 v[68:71], v[40:43], v[136:143], v6
  v_add_f32 v49, v49, v53
  v_smfmac_f32_16x16x64_bf16 v[68:71], v[44:47], v[128:135], v6
  v_add_f32 v50, v50, v54
  s_waitcnt lgkmcnt(4)
  v_mfma_f32_16x16x32_bf16 v[16:19], v[88:91], v[88:91], 0
  v_add_f32 v51, v51, v55
  v_add_f32 v56, v56, v60
  v_mfma_f32_16x16x32_bf16 v[16:19], v[92:95], v[92:95], v[16:19]
  v_add_f32 v57, v57, v61
  s_waitcnt lgkmcnt(0)
  v_add_f32 v58, v58, v62
  v_mfma_f32_16x16x32_bf16 v[16:19], v[96:99], v[96:99], v[16:19]
  v_add_f32 v59, v59, v63
  v_add_f32 v48, v48, v56
  v_mfma_f32_16x16x32_bf16 v[16:19], v[100:103], v[100:103], v[16:19]
  v_add_f32 v49, v49, v57
  v_add_f32 v50, v50, v58
  v_add_f32 v51, v51, v59
  v_exp_f32 v24, v48
  v_exp_f32 v25, v49
  v_exp_f32 v26, v50
  v_exp_f32 v27, v51
  v_mov_b64 v[20:21], s[14:15]
  v_cvt_pk_bf16_f32 v24, v24, v25
  v_cvt_pk_bf16_f32 v25, v26, v27
  v_cndmask_b32 v72, v24, 0, s[18:19]
  v_cndmask_b32 v73, v25, 0, s[18:19]
  v_cndmask_b32 v74, 0, v24, s[18:19]
  v_cndmask_b32 v75, 0, v25, s[18:19]
  v_mul_f32 v16, s24, v16
  v_mul_f32 v17, s24, v17
  v_mfma_f32_16x16x32_bf16 v[52:55], v[72:75], v[80:83], 0
  buffer_store_dwordx4 v[88:91], v0, s[4:7], s25 offen sc1
  v_exp_f32 v28, v16
  v_mov_b64 v[22:23], s[14:15]
  v_mfma_f32_16x16x32_bf16 v[56:59], v[72:75], v[84:87], 0
  v_exp_f32 v29, v17
  v_mfma_f32_16x16x32_bf16 v[60:63], v[72:75], v[20:23], 0
  v_add_f32 v64, v64, v66
  v_add_f32 v65, v65, v67
  v_cvt_pk_bf16_f32 v28, v28, v29
  v_cvt_pk_bf16_f32 v66, v64, v65
  v_cndmask_b32 v77, 0, v28, s[18:19]
  v_cndmask_b32 v78, 0, v28, s[18:19]
  v_add_f32 v68, v68, v70
  v_add_f32 v69, v69, v71
  v_cvt_pk_bf16_f32 v67, v68, v69
  v_mfma_f32_16x16x16_bf16 v[60:63], v[76:77], v[20:21], v[60:63]
  v_max3_f32 v7, |v48|, |v49|, |v50|
  v_max_f32 v26, |v16|, |v17|
  v_mfma_f32_16x16x16_bf16 v[52:55], v[78:79], v[66:67], v[52:55]
  v_cndmask_b32 v26, 0, v26, s[18:19]
  v_max3_f32 v7, |v51|, v26, v7
  v_mfma_f32_16x16x16_bf16 v[56:59], v[76:77], v[66:67], v[56:59]
  v_cmp_lt_f32 vcc, 0x42700000, v7
  v_mov_b64 v[44:45], 0
  v_add_f32 v60, v60, v62
  v_add_f32 v61, v61, v63
  s_cbranch_vccnz c_fb_10
c_fbr_11:
  v_rcp_f32 v60, v60
  v_rcp_f32 v61, v61
  v_pk_add_f32 v[52:53], v[52:53], v[54:55]
  v_pk_add_f32 v[56:57], v[56:57], v[58:59]
  v_pk_mul_f32 v[52:53], v[52:53], v[60:61]
  v_pk_mul_f32 v[56:57], v[56:57], v[60:61]
  v_cvt_pk_bf16_f32 v54, v52, v53
  v_cvt_pk_bf16_f32 v55, v56, v57
  ds_write_b64 v2, v[54:55] offset:0
  v_mov_b64 v[46:47], 0
  v_mov_b64 v[40:41], 0
  v_mov_b64 v[42:43], 0
  v_mov_b64 v[36:37], 0
  v_mov_b64 v[38:39], 0
  v_mov_b64 v[32:33], 0
  v_mov_b64 v[34:35], 0
  v_mov_b64 v[28:29], 0
  v_mov_b64 v[30:31], 0
  v_mov_b64 v[24:25], 0
  v_mov_b64 v[26:27], 0
  v_mov_b64 v[80:81], 0
  v_lshrrev_b32 v7, 1, v0
  s_waitcnt lgkmcnt(0)
  s_barrier
  ds_read_b64_tr_b16 v[72:73], v3 offset:0
  ds_read_b64_tr_b16 v[74:75], v3 offset:1024
  ds_read_b64_tr_b16 v[76:77], v3 offset:2048
  ds_read_b64_tr_b16 v[78:79], v3 offset:3072
  s_waitcnt lgkmcnt(2)
  v_smfmac_f32_16x16x64_bf16 v[44:47], v[72:75], a[248:255], v6
  ds_read_b128 v[120:123], v1 offset:24576
  s_and_b32 s3, s22, 1
  s_add_u32 s22, s22, 1
  buffer_store_dwordx2 v[66:67], v7, s[4:7], s25 offen offset:1024 sc1
  s_waitcnt lgkmcnt(1)
  v_smfmac_f32_16x16x64_bf16 v[44:47], v[76:79], a[240:247], v6
  ds_read_b128 v[124:127], v1 offset:25600
  s_and_b32 s42, s22, 3
  s_lshl_b32 s42, s42, 13
  s_cmp_eq_u32 s22, 64
  s_cbranch_scc1 c_last_13
  v_smfmac_f32_16x16x64_bf16 v[40:43], v[72:75], a[232:239], v6
  ds_read_b128 v[16:19], v1 offset:26624
  v_smfmac_f32_16x16x64_bf16 v[40:43], v[76:79], a[224:231], v6
  ds_read_b128 v[20:23], v1 offset:27648
  v_smfmac_f32_16x16x64_bf16 v[36:39], v[72:75], a[216:223], v6
  v_mov_b64 v[82:83], 0
  v_mov_b64 v[84:85], 0
  v_mov_b64 v[86:87], 0
  v_smfmac_f32_16x16x64_bf16 v[36:39], v[76:79], a[208:215], v6
  ds_read_b128 v[88:91], v1 offset:28672
  v_smfmac_f32_16x16x64_bf16 v[32:35], v[72:75], a[200:207], v6
  v_add_f32 v44, v44, v46
  v_add_f32 v45, v45, v47
  v_cvt_pk_bf16_f32 v48, v44, v45
  v_smfmac_f32_16x16x64_bf16 v[32:35], v[76:79], a[192:199], v6
  ds_read_b128 v[92:95], v1 offset:29696
  v_smfmac_f32_16x16x64_bf16 v[28:31], v[72:75], a[184:191], v6
  v_and_or_b32 v48, v48, -2, s3
  v_add_f32 v40, v40, v42
  v_add_f32 v41, v41, v43
  v_smfmac_f32_16x16x64_bf16 v[28:31], v[76:79], a[176:183], v6
  ds_read_b128 v[96:99], v1 offset:30720
  v_smfmac_f32_16x16x64_bf16 v[24:27], v[72:75], v[104:111], v6
  v_cvt_pk_bf16_f32 v49, v40, v41
  v_add_f32 v36, v36, v38
  v_add_f32 v37, v37, v39
  v_smfmac_f32_16x16x64_bf16 v[24:27], v[76:79], v[112:119], v6
  ds_read_b128 v[100:103], v1 offset:31744
  s_waitcnt lgkmcnt(6)
  v_smfmac_f32_16x16x64_bf16 v[80:83], v[72:75], v[120:127], v6
  v_cvt_pk_bf16_f32 v50, v36, v37
  v_add_f32 v32, v32, v34
  v_add_f32 v33, v33, v35
  s_waitcnt lgkmcnt(4)
  v_smfmac_f32_16x16x64_bf16 v[80:83], v[76:79], v[16:23], v6
  v_cvt_pk_bf16_f32 v51, v32, v33
  v_add_f32 v28, v28, v30
  v_add_f32 v29, v29, v31
  buffer_store_dwordx4 v[48:51], v4, s[4:7], s40 offen
  s_waitcnt lgkmcnt(2)
  v_smfmac_f32_16x16x64_bf16 v[84:87], v[72:75], v[88:95], v6
  v_cvt_pk_bf16_f32 v52, v28, v29
  v_and_or_b32 v52, v52, -2, s3
  v_add_f32 v24, v24, v26
  s_waitcnt lgkmcnt(0)
  v_smfmac_f32_16x16x64_bf16 v[84:87], v[76:79], v[96:103], v6
  v_add_f32 v25, v25, v27
  v_cvt_pk_bf16_f32 v53, v24, v25
  v_add_f32 v80, v80, v82
  v_add_f32 v81, v81, v83
  v_cvt_pk_bf16_f32 v54, v80, v81
  s_nop 2
  v_pk_add_f32 v[84:85], v[84:85], v[86:87]
  v_cvt_pk_bf16_f32 v55, v84, v85
  buffer_store_dwordx4 v[52:55], v4, s[4:7], s41 offen
  s_add_u32 s42, s42, s62
  s_add_u32 s43, s42, 4096
  s_add_u32 s23, s23, 524288
  s_add_u32 s25, s25, 262144
  s_add_u32 s63, s63, 512
  s_add_u32 s64, s64, 512
  s_add_u32 s92, s92, 512
  s_mov_b32 s96, s23
  s_add_u32 s97, s97, 8192
  s_buffer_load_dword s65, s[4:7], s63
  s_buffer_load_dword s94, s[4:7], s92
  v_mov_b64 v[56:57], 0
  v_mov_b64 v[58:59], 0
  v_mov_b64 v[60:61], 0
  v_mov_b64 v[62:63], 0
  v_mov_b64 v[48:49], 0
  v_mov_b64 v[50:51], 0
  v_mov_b64 v[52:53], 0
  v_mov_b64 v[54:55], 0
  s_cmp_lg_u32 s17, 0
  s_cbranch_scc1 c_oth_21
  s_mov_b32 s28, 0
  s_add_u32 s46, s46, 1
  v_mov_b64 v[120:121], -1
  s_xor_b32 s34, s42, 16384
  buffer_store_dwordx2 v[120:121], v5, s[4:7], s34 offen
  s_mov_b32 vcc_lo, 0xaaaaaaaa
  s_mov_b32 vcc_hi, 0xaaaaaaaa
  v_mov_b32 v7, 0x3f80
  v_cndmask_b32 v7, v7, 1.0, vcc
  s_mov_b32 vcc_lo, 0x30003
  s_mov_b32 vcc_hi, 0x30003
  v_cndmask_b32 v68, 0, v7, vcc
  s_mov_b32 vcc_lo, 0xc000c
  s_mov_b32 vcc_hi, 0xc000c
  v_cndmask_b32 v69, 0, v7, vcc
  s_mov_b32 vcc_lo, 0x300030
  s_mov_b32 vcc_hi, 0x300030
  v_cndmask_b32 v70, 0, v7, vcc
  s_mov_b32 vcc_lo, 0xc000c0
  s_mov_b32 vcc_hi, 0xc000c0
  v_cndmask_b32 v71, 0, v7, vcc
  s_nop 15
  s_nop 15
  s_nop 15
  s_nop 15
  s_nop 5
  buffer_load_dwordx4 v[16:19], v0, s[4:7], s38 offen offset:0 sc1
  buffer_load_dwordx4 v[20:23], v0, s[4:7], s38 offen offset:1024 sc1
  buffer_load_dwordx4 v[24:27], v0, s[4:7], s38 offen offset:2048 sc1
  buffer_load_dwordx4 v[28:31], v0, s[4:7], s38 offen offset:3072 sc1
  buffer_load_dwordx4 v[32:35], v0, s[4:7], s39 offen offset:0 sc1
  buffer_load_dwordx4 v[36:39], v0, s[4:7], s39 offen offset:1024 sc1
  buffer_load_dwordx4 v[40:43], v0, s[4:7], s39 offen offset:2048 sc1
  buffer_load_dwordx4 v[44:47], v0, s[4:7], s39 offen offset:3072 sc1
  s_nop 14
  buffer_load_dwordx4 v[72:75], v0, s[4:7], s38 offen offset:0 sc1
  buffer_load_dwordx4 v[76:79], v0, s[4:7], s38 offen offset:1024 sc1
  buffer_load_dwordx4 v[80:83], v0, s[4:7], s38 offen offset:2048 sc1
  buffer_load_dwordx4 v[84:87], v0, s[4:7], s38 offen offset:3072 sc1
  buffer_load_dwordx4 v[88:91], v0, s[4:7], s39 offen offset:0 sc1
  buffer_load_dwordx4 v[92:95], v0, s[4:7], s39 offen offset:1024 sc1
  buffer_load_dwordx4 v[96:99], v0, s[4:7], s39 offen offset:2048 sc1
  buffer_load_dwordx4 v[100:103], v0, s[4:7], s39 offen offset:3072 sc1
  s_waitcnt vmcnt(15)
  v_mfma_f32_16x16x32_bf16 v[64:67], v[16:19], v[68:71], 0
  v_xor_b32 v7, s3, v16
  s_waitcnt vmcnt(14)
  v_mfma_f32_16x16x32_bf16 v[64:67], v[20:23], v[68:71], v[64:67]
  v_bitop3_b32 v7, v7, v20, s3 bitop3:0xf6
  s_waitcnt vmcnt(13)
  v_mfma_f32_16x16x32_bf16 v[64:67], v[24:27], v[68:71], v[64:67]
  v_bitop3_b32 v7, v7, v24, s3 bitop3:0xf6
  s_waitcnt vmcnt(12)
  v_mfma_f32_16x16x32_bf16 v[64:67], v[28:31], v[68:71], v[64:67]
  v_bitop3_b32 v7, v7, v28, s3 bitop3:0xf6
  s_waitcnt vmcnt(11)
  v_mfma_f32_16x16x32_bf16 v[64:67], v[32:35], v[68:71], v[64:67]
  v_bitop3_b32 v7, v7, v32, s3 bitop3:0xf6
  s_waitcnt vmcnt(10)
  v_mfma_f32_16x16x32_bf16 v[64:67], v[36:39], v[68:71], v[64:67]
  v_bitop3_b32 v7, v7, v36, s3 bitop3:0xf6
  s_waitcnt vmcnt(9)
  v_mfma_f32_16x16x32_bf16 v[64:67], v[40:43], v[68:71], v[64:67]
  v_bitop3_b32 v7, v7, v40, s3 bitop3:0xf6
  s_waitcnt vmcnt(8)
  v_mfma_f32_16x16x32_bf16 v[64:67], v[44:47], v[68:71], v[64:67]
  v_bitop3_b32 v7, v7, v44, s3 bitop3:0xf6
  v_and_b32 v7, 1, v7
  v_cmp_ne_u32 vcc, 0, v7
  v_mov_b32 v7, 0
  v_mov_b32 v7, 0
  s_cbranch_vccnz c_p1r_22
c_publ_23:
  s_nop 1
  v_cvt_pk_bf16_f32 v64, v64, v65
  v_cvt_pk_bf16_f32 v65, v66, v67
  v_min_u32 v64, -2, v64
  v_min_u32 v65, -2, v65
  buffer_store_dwordx2 v[64:65], v5, s[4:7], s42 offen
c_hop2_9:
  s_barrier
  s_nop 15
  s_nop 13
  s_cmp_eq_u32 s95, 0
  s_cbranch_scc1 c_loop_6
  s_mov_b32 s29, 0
c_fk_24:
  buffer_load_dwordx4 v[16:19], v8, s[4:7], s42 offen sc1
  buffer_load_dwordx4 v[20:23], v8, s[4:7], s43 offen sc1
  s_add_u32 s29, s29, 1
  s_cmp_gt_u32 s29, 1048576
  s_cbranch_scc1 c_fail_12
  s_waitcnt vmcnt(0)
  v_max3_u32 v7, v16, v17, v18
  v_max3_u32 v7, v19, v20, v7
  v_max3_u32 v7, v21, v22, v7
  v_max_u32 v7, v7, v23
  v_cmp_eq_u32 vcc, -1, v7
  s_cbranch_vccnz c_fk_24
  s_lshl_b32 s42, s22, 13
  s_add_u32 s42, s42, 5767168
  s_add_u32 s43, s42, 4096
  s_mov_b32 s95, 0
  s_branch c_loop_6
c_kvs_19:
  s_cmp_ge_u32 s22, 63
  s_cbranch_scc1 c_kvr_20
  s_mov_b32 s29, 0
c_gw_25:
  buffer_load_dword v7, off, s[4:7], s92 sc1
  s_add_u32 s29, s29, 1
  s_cmp_gt_u32 s29, 1048576
  s_cbranch_scc1 c_fail_12
  s_waitcnt vmcnt(0)
  v_readfirstlane_b32 s94, v7
  s_cmp_eq_u32 s94, 0
  s_cbranch_scc1 c_gw_25
  s_cmp_lg_u32 s94, s93
  s_cselect_b32 s95, 1, 0
  s_lshl_b32 s30, s95, 25
  s_add_u32 s96, s23, s30
  s_cmp_lg_u32 s95, 0
  s_cbranch_scc1 c_kvx_27
c_kvw_26:
  buffer_load_dword v7, off, s[4:7], s63 sc1
  s_add_u32 s29, s29, 1
  s_cmp_gt_u32 s29, 1048576
  s_cbranch_scc1 c_fail_12
  s_waitcnt vmcnt(0)
  v_readfirstlane_b32 s65, v7
  s_cmp_eq_u32 s65, 0
  s_cbranch_scc1 c_kvw_26
c_kvx_27:
  s_branch c_kvr_20
c_last_13:
  s_add_u32 s64, s64, 512
  v_mov_b32 v7, 1
  s_waitcnt vmcnt(0)
  s_mov_b64 exec, 1
  buffer_store_dword v7, off, s[4:7], s64 sc1
  s_mov_b64 exec, -1
  s_branch c_fail_12
c_oth_21:
  ds_read_b128 v[24:27], v1 offset:0
  ds_read_b128 v[28:31], v1 offset:1024
  ds_read_b128 v[32:35], v1 offset:2048
  ds_read_b128 v[36:39], v1 offset:3072
  ds_read_b128 v[40:43], v1 offset:4096
  ds_read_b128 v[44:47], v1 offset:5120
  ds_read_b128 v[72:75], v1 offset:6144
  ds_read_b128 v[76:79], v1 offset:7168
  ds_read_b128 v[80:83], v1 offset:8192
  ds_read_b128 v[84:87], v1 offset:9216
  ds_read_b128 v[88:91], v1 offset:10240
  ds_read_b128 v[92:95], v1 offset:11264
  ds_read_b128 v[96:99], v1 offset:12288
  ds_read_b128 v[100:103], v1 offset:13312
  ds_read_b128 v[104:107], v1 offset:14336
  ds_read_b128 v[108:111], v1 offset:15360
  ds_read_b128 v[112:115], v1 offset:16384
  ds_read_b128 v[116:119], v1 offset:17408
  ds_read_b128 v[120:123], v1 offset:18432
  ds_read_b128 v[124:127], v1 offset:19456
  v_mov_b64 v[64:65], 0
  v_mov_b64 v[66:67], 0
  v_mov_b64 v[68:69], 0
  v_mov_b64 v[70:71], 0
  s_branch c_hop2_9
c_w0a_17:
  s_waitcnt vmcnt(3)
  ds_read_b128 v[24:27], v1 offset:0
  ds_read_b128 v[28:31], v1 offset:1024
  ds_read_b128 v[32:35], v1 offset:2048
  ds_read_b128 v[36:39], v1 offset:3072
  ds_read_b128 v[40:43], v1 offset:4096
  ds_read_b128 v[44:47], v1 offset:5120
  ds_read_b128 v[72:75], v1 offset:6144
  ds_read_b128 v[76:79], v1 offset:7168
  ds_read_b128 v[80:83], v1 offset:8192
  ds_read_b128 v[84:87], v1 offset:9216
  buffer_load_dwordx4 v[16:19], v8, s[4:7], s42 offen sc1
  buffer_load_dwordx4 v[20:23], v8, s[4:7], s43 offen sc1
  ds_read_b128 v[88:91], v1 offset:10240
  ds_read_b128 v[92:95], v1 offset:11264
  ds_read_b128 v[96:99], v1 offset:12288
  ds_read_b128 v[100:103], v1 offset:13312
  ds_read_b128 v[104:107], v1 offset:14336
  ds_read_b128 v[108:111], v1 offset:15360
  ds_read_b128 v[112:115], v1 offset:16384
  ds_read_b128 v[116:119], v1 offset:17408
  ds_read_b128 v[120:123], v1 offset:18432
  ds_read_b128 v[124:127], v1 offset:19456
  buffer_load_dwordx4 v[16:19], v8, s[4:7], s42 offen sc1
  buffer_load_dwordx4 v[20:23], v8, s[4:7], s43 offen sc1
  v_mov_b64 v[64:65], 0
  v_mov_b64 v[66:67], 0
  v_mov_b64 v[68:69], 0
  v_mov_b64 v[70:71], 0
  s_branch c_w0b_18
c_p1r_22:
  buffer_load_dwordx4 v[16:19], v0, s[4:7], s38 offen offset:0 sc1
  buffer_load_dwordx4 v[20:23], v0, s[4:7], s38 offen offset:1024 sc1
  buffer_load_dwordx4 v[24:27], v0, s[4:7], s38 offen offset:2048 sc1
  buffer_load_dwordx4 v[28:31], v0, s[4:7], s38 offen offset:3072 sc1
  buffer_load_dwordx4 v[32:35], v0, s[4:7], s39 offen offset:0 sc1
  buffer_load_dwordx4 v[36:39], v0, s[4:7], s39 offen offset:1024 sc1
  buffer_load_dwordx4 v[40:43], v0, s[4:7], s39 offen offset:2048 sc1
  buffer_load_dwordx4 v[44:47], v0, s[4:7], s39 offen offset:3072 sc1
  s_add_u32 s46, s46, 1
  s_waitcnt vmcnt(15)
  v_mfma_f32_16x16x32_bf16 v[64:67], v[72:75], v[68:71], 0
  v_xor_b32 v7, s3, v72
  s_waitcnt vmcnt(14)
  v_mfma_f32_16x16x32_bf16 v[64:67], v[76:79], v[68:71], v[64:67]
  v_bitop3_b32 v7, v7, v76, s3 bitop3:0xf6
  s_waitcnt vmcnt(13)
  v_mfma_f32_16x16x32_bf16 v[64:67], v[80:83], v[68:71], v[64:67]
  v_bitop3_b32 v7, v7, v80, s3 bitop3:0xf6
  s_waitcnt vmcnt(12)
  v_mfma_f32_16x16x32_bf16 v[64:67], v[84:87], v[68:71], v[64:67]
  v_bitop3_b32 v7, v7, v84, s3 bitop3:0xf6
  s_waitcnt vmcnt(11)
  v_mfma_f32_16x16x32_bf16 v[64:67], v[88:91], v[68:71], v[64:67]
  v_bitop3_b32 v7, v7, v88, s3 bitop3:0xf6
  s_waitcnt vmcnt(10)
  v_mfma_f32_16x16x32_bf16 v[64:67], v[92:95], v[68:71], v[64:67]
  v_bitop3_b32 v7, v7, v92, s3 bitop3:0xf6
  s_waitcnt vmcnt(9)
  v_mfma_f32_16x16x32_bf16 v[64:67], v[96:99], v[68:71], v[64:67]
  v_bitop3_b32 v7, v7, v96, s3 bitop3:0xf6
  s_waitcnt vmcnt(8)
  v_mfma_f32_16x16x32_bf16 v[64:67], v[100:103], v[68:71], v[64:67]
  v_bitop3_b32 v7, v7, v100, s3 bitop3:0xf6
  v_and_b32 v7, 1, v7
  v_cmp_ne_u32 vcc, 0, v7
  v_mov_b32 v7, 0
  v_mov_b32 v7, 0
  s_cbranch_vccnz c_p1s_28
  s_branch c_publ_23
c_p1s_28:
  buffer_load_dwordx4 v[72:75], v0, s[4:7], s38 offen offset:0 sc1
  buffer_load_dwordx4 v[76:79], v0, s[4:7], s38 offen offset:1024 sc1
  buffer_load_dwordx4 v[80:83], v0, s[4:7], s38 offen offset:2048 sc1
  buffer_load_dwordx4 v[84:87], v0, s[4:7], s38 offen offset:3072 sc1
  buffer_load_dwordx4 v[88:91], v0, s[4:7], s39 offen offset:0 sc1
  buffer_load_dwordx4 v[92:95], v0, s[4:7], s39 offen offset:1024 sc1
  buffer_load_dwordx4 v[96:99], v0, s[4:7], s39 offen offset:2048 sc1
  buffer_load_dwordx4 v[100:103], v0, s[4:7], s39 offen offset:3072 sc1
  s_add_u32 s28, s28, 1
  s_add_u32 s46, s46, 1
  s_cmp_gt_u32 s28, 1048576
  s_cbranch_scc1 c_fail_12
  s_waitcnt vmcnt(15)
  v_mfma_f32_16x16x32_bf16 v[64:67], v[16:19], v[68:71], 0
  v_xor_b32 v7, s3, v16
  s_waitcnt vmcnt(14)
  v_mfma_f32_16x16x32_bf16 v[64:67], v[20:23], v[68:71], v[64:67]
  v_bitop3_b32 v7, v7, v20, s3 bitop3:0xf6
  s_waitcnt vmcnt(13)
  v_mfma_f32_16x16x32_bf16 v[64:67], v[24:27], v[68:71], v[64:67]
  v_bitop3_b32 v7, v7, v24, s3 bitop3:0xf6
  s_waitcnt vmcnt(12)
  v_mfma_f32_16x16x32_bf16 v[64:67], v[28:31], v[68:71], v[64:67]
  v_bitop3_b32 v7, v7, v28, s3 bitop3:0xf6
  s_waitcnt vmcnt(11)
  v_mfma_f32_16x16x32_bf16 v[64:67], v[32:35], v[68:71], v[64:67]
  v_bitop3_b32 v7, v7, v32, s3 bitop3:0xf6
  s_waitcnt vmcnt(10)
  v_mfma_f32_16x16x32_bf16 v[64:67], v[36:39], v[68:71], v[64:67]
  v_bitop3_b32 v7, v7, v36, s3 bitop3:0xf6
  s_waitcnt vmcnt(9)
  v_mfma_f32_16x16x32_bf16 v[64:67], v[40:43], v[68:71], v[64:67]
  v_bitop3_b32 v7, v7, v40, s3 bitop3:0xf6
  s_waitcnt vmcnt(8)
  v_mfma_f32_16x16x32_bf16 v[64:67], v[44:47], v[68:71], v[64:67]
  v_bitop3_b32 v7, v7, v44, s3 bitop3:0xf6
  v_and_b32 v7, 1, v7
  v_cmp_ne_u32 vcc, 0, v7
  v_mov_b32 v7, 0
  v_mov_b32 v7, 0
  s_cbranch_vccnz c_p1r_22
  s_branch c_publ_23
c_retry_7:
  buffer_load_dwordx4 v[16:19], v8, s[4:7], s42 offen sc1
  buffer_load_dwordx4 v[20:23], v8, s[4:7], s43 offen sc1
  s_add_u32 s28, s28, 1
  s_add_u32 s47, s47, 1
  s_cmp_gt_u32 s28, 1048576
  s_cbranch_scc1 c_fail_12
  v_mov_b64 v[48:49], 0
  v_mov_b64 v[50:51], 0
  v_mov_b64 v[52:53], 0
  v_mov_b64 v[54:55], 0
  v_mov_b64 v[56:57], 0
  v_mov_b64 v[58:59], 0
  s_waitcnt vmcnt(4)
  v_max3_u32 v7, v16, v17, v18
  v_max_u32 v7, v7, v19
  ds_write_b128 v8, v[16:19] offset:0
  v_smfmac_f32_16x16x64_bf16 v[48:51], v[16:19], v[24:31], v6
  s_branch c_got_8
c_fb_10:
  v_max3_f32 v7, v48, v49, v50
  v_max_f32 v7, v51, v7
  s_mov_b64 exec, s[18:19]
  v_max3_f32 v7, v16, v17, v7
  s_mov_b64 exec, -1
  s_nop 0
  v_max_f32_dpp v7, v7, v7 quad_perm:[2,3,0,1] row_mask:0xf bank_mask:0xf
  v_mov_b32 v24, v7
  s_nop 0
  s_nop 0
  v_permlane16_swap_b32 v7, v24
  v_max_f32 v7, v7, v24
  v_mov_b32 v24, v7
  s_nop 0
  s_nop 0
  v_permlane32_swap_b32 v7, v24
  v_max_f32 v7, v7, v24
  v_sub_f32 v24, v48, v7
  v_sub_f32 v25, v49, v7
  v_sub_f32 v26, v50, v7
  v_sub_f32 v27, v51, v7
  v_sub_f32 v28, v16, v7
  v_sub_f32 v29, v17, v7
  v_exp_f32 v24, v24
  v_exp_f32 v25, v25
  v_exp_f32 v26, v26
  v_exp_f32 v27, v27
  v_exp_f32 v28, v28
  v_exp_f32 v29, v29
  v_cvt_pk_bf16_f32 v24, v24, v25
  v_cvt_pk_bf16_f32 v25, v26, v27
  v_cvt_pk_bf16_f32 v28, v28, v29
  v_cndmask_b32 v72, v24, 0, s[18:19]
  v_cndmask_b32 v73, v25, 0, s[18:19]
  v_cndmask_b32 v74, 0, v24, s[18:19]
  v_cndmask_b32 v75, 0, v25, s[18:19]
  v_cndmask_b32 v77, 0, v28, s[18:19]
  v_cndmask_b32 v78, 0, v28, s[18:19]
  v_mfma_f32_16x16x32_bf16 v[60:63], v[72:75], v[20:23], 0
  v_mfma_f32_16x16x32_bf16 v[52:55], v[72:75], v[80:83], 0
  v_mfma_f32_16x16x32_bf16 v[56:59], v[72:75], v[84:87], 0
  s_nop 5
  v_mfma_f32_16x16x16_bf16 v[60:63], v[76:77], v[20:21], v[60:63]
  v_mfma_f32_16x16x16_bf16 v[52:55], v[78:79], v[66:67], v[52:55]
  v_mfma_f32_16x16x16_bf16 v[56:59], v[76:77], v[66:67], v[56:59]
  s_nop 7
  v_add_f32 v60, v60, v62
  v_add_f32 v61, v61, v63
  s_branch c_fbr_11
c_fail_12:
  s_endpgm
L_chain_x:
  s_mov_b32 s22, 0
  s_mov_b32 s42, s62
  s_add_u32 s43, s62, 4096
  s_mov_b32 s46, 0
  s_mov_b32 s47, 0
  s_lshl_b32 s26, s16, 2
  s_add_u32 s26, s26, s17
  s_lshl_b32 s27, s60, 13
  s_add_u32 s27, s27, s26
  s_lshl_b32 s25, s27, 11
  s_add_u32 s25, s25, 192937984
  s_lshl_b32 s64, s60, 14
  s_add_u32 s64, s64, s26
  s_lshl_b32 s64, s64, 2
  s_add_u32 s64, s64, 5512704
  s_lshl_b32 s27, s61, 13
  s_add_u32 s27, s27, s26
  s_lshl_b32 s23, s27, 12
  s_add_u32 s23, s23, 41943040
  s_lshl_b32 s63, s27, 2
  s_add_u32 s63, s63, 5308416
  s_mov_b32 s97, 268435456
  s_cmp_eq_u32 s60, 2
  s_cselect_b32 s92, 32768, 0
  s_cselect_b32 s93, 2, 1
  s_add_u32 s92, s92, s63
  s_lshl_b32 s26, s17, 2
  s_add_u32 s26, s26, s60
  s_cmp_eq_u32 s26, 1
  s_cselect_b32 s97, 5767168, s97
  s_mov_b32 s95, 0
  s_mov_b32 s96, s23
  s_mov_b32 s29, 0
c_gw_37:
  buffer_load_dword v7, off, s[4:7], s92 sc1
  s_add_u32 s29, s29, 1
  s_cmp_gt_u32 s29, 1048576
  s_cbranch_scc1 c_fail_35
  s_waitcnt vmcnt(0)
  v_readfirstlane_b32 s94, v7
  s_cmp_eq_u32 s94, 0
  s_cbranch_scc1 c_gw_37
  s_cmp_lg_u32 s94, s93
  s_cselect_b32 s95, 1, 0
  s_lshl_b32 s30, s95, 25
  s_add_u32 s96, s23, s30
  s_cmp_lg_u32 s95, 0
  s_cbranch_scc1 c_kvx_39
c_kvw_38:
  buffer_load_dword v7, off, s[4:7], s63 sc1
  s_add_u32 s29, s29, 1
  s_cmp_gt_u32 s29, 1048576
  s_cbranch_scc1 c_fail_35
  s_waitcnt vmcnt(0)
  v_readfirstlane_b32 s65, v7
  s_cmp_eq_u32 s65, 0
  s_cbranch_scc1 c_kvw_38
c_kvx_39:
  buffer_load_dwordx4 v0, s[4:7], s96 offen offset:0  lds
  buffer_load_dwordx4 v0, s[4:7], s96 offen offset:1024  lds
  buffer_load_dwordx4 v0, s[4:7], s96 offen offset:2048  lds
  buffer_load_dwordx4 v0, s[4:7], s96 offen offset:3072  lds
  s_add_u32 s23, s23, 524288
  s_add_u32 s63, s63, 512
  s_mov_b32 s65, 0
  s_add_u32 s92, s92, 512
  s_mov_b32 s94, 0
  s_mov_b32 s95, 0
  s_mov_b32 s96, s23
  ds_read_b128 v[72:75], v1 offset:6144
  ds_read_b128 v[76:79], v1 offset:7168
  ds_read_b128 v[80:83], v1 offset:8192
  ds_read_b128 v[84:87], v1 offset:9216
  ds_read_b128 v[88:91], v1 offset:10240
  ds_read_b128 v[92:95], v1 offset:11264
  ds_read_b128 v[96:99], v1 offset:12288
  ds_read_b128 v[100:103], v1 offset:13312
  ds_read_b128 v[104:107], v1 offset:14336
  ds_read_b128 v[108:111], v1 offset:15360
  ds_read_b128 v[112:115], v1 offset:16384
  ds_read_b128 v[116:119], v1 offset:17408
  ds_read_b128 v[120:123], v1 offset:18432
  ds_read_b128 v[124:127], v1 offset:19456
  v_mov_b64 v[48:49], 0
  v_mov_b64 v[50:51], 0
  v_mov_b64 v[52:53], 0
  v_mov_b64 v[54:55], 0
  v_mov_b64 v[56:57], 0
  v_mov_b64 v[58:59], 0
  v_mov_b64 v[60:61], 0
  v_mov_b64 v[62:63], 0
  v_mov_b64 v[64:65], 0
  v_mov_b64 v[66:67], 0
  v_mov_b64 v[68:69], 0
  v_mov_b64 v[70:71], 0
  s_lshl_b32 s38, s16, 13
  s_add_u32 s38, s38, s40
  s_add_u32 s39, s38, 4096
  ds_read_b128 v[24:27], v1 offset:0
  ds_read_b128 v[28:31], v1 offset:1024
  ds_read_b128 v[32:35], v1 offset:2048
  ds_read_b128 v[36:39], v1 offset:3072
  ds_read_b128 v[40:43], v1 offset:4096
  ds_read_b128 v[44:47], v1 offset:5120
  s_waitcnt lgkmcnt(0)
c_loop_29:
  buffer_load_dwordx4 v[16:19], v8, s[4:7], s42 offen sc1
  buffer_load_dwordx4 v[20:23], v8, s[4:7], s43 offen sc1
  s_mov_b32 s28, 0
  s_cmp_eq_u32 s17, 0
  s_cbranch_scc1 c_w0a_40
  s_nop 15
  s_nop 8
  buffer_load_dwordx4 v[16:19], v8, s[4:7], s42 offen sc1
  buffer_load_dwordx4 v[20:23], v8, s[4:7], s43 offen sc1
  s_nop 15
  s_nop 8
  buffer_load_dwordx4 v[16:19], v8, s[4:7], s42 offen sc1
  buffer_load_dwordx4 v[20:23], v8, s[4:7], s43 offen sc1
c_w0b_41:
  s_waitcnt lgkmcnt(0)
  s_waitcnt vmcnt(5)
  v_max3_u32 v7, v16, v17, v18
  v_max_u32 v7, v7, v19
  ds_write_b128 v8, v[16:19] offset:0
  v_smfmac_f32_16x16x64_bf16 v[48:51], v[16:19], v[24:31], v6
  s_waitcnt vmcnt(4)
c_got_31:
  v_max3_u32 v7, v20, v21, v7
  v_max3_u32 v7, v22, v23, v7
  ds_write_b128 v8, v[20:23] offset:4096
  v_smfmac_f32_16x16x64_bf16 v[52:55], v[16:19], v[32:39], v6
  v_cmp_eq_u32 vcc, -1, v7
  v_smfmac_f32_16x16x64_bf16 v[56:59], v[16:19], v[40:47], v6
  s_cbranch_vccnz c_retry_30
  v_smfmac_f32_16x16x64_bf16 v[60:63], v[16:19], v[72:79], v6
  s_mul_i32 s65, s65, s94
  s_cmp_lg_u32 s65, s93
  s_cbranch_scc1 c_kvs_42
c_kvr_43:
  v_smfmac_f32_16x16x64_bf16 v[48:51], v[20:23], v[80:87], v6
  v_mov_b32 v7, 1
  v_smfmac_f32_16x16x64_bf16 v[52:55], v[20:23], v[88:95], v6
  v_smfmac_f32_16x16x64_bf16 v[56:59], v[20:23], v[96:103], v6
  s_waitcnt lgkmcnt(0)
  s_barrier
  ds_read_b128 v[24:27], v9 offset:0
  ds_read_b128 v[28:31], v10 offset:0
  v_smfmac_f32_16x16x64_bf16 v[60:63], v[20:23], v[104:111], v6
  ds_read_b128 v[32:35], v11 offset:0
  v_smfmac_f32_16x16x64_bf16 v[64:67], v[16:19], v[112:119], v6
  ds_read_b128 v[36:39], v9 offset:4096
  v_smfmac_f32_16x16x64_bf16 v[68:71], v[16:19], v[120:127], v6
  ds_read_b128 v[40:43], v10 offset:4096
  v_smfmac_f32_16x16x64_bf16 v[64:67], v[20:23], v[208:215], v6
  ds_read_b128 v[44:47], v11 offset:4096
  s_waitcnt lgkmcnt(5)
  v_smfmac_f32_16x16x64_bf16 v[48:51], v[24:27], a[168:175], v6
  ds_read_b128 v[72:75], v1 offset:32768
  s_waitcnt lgkmcnt(5)
  v_smfmac_f32_16x16x64_bf16 v[48:51], v[28:31], a[160:167], v6
  ds_read_b128 v[76:79], v1 offset:33792
  s_waitcnt lgkmcnt(5)
  v_smfmac_f32_16x16x64_bf16 v[48:51], v[32:35], a[152:159], v6
  ds_read_b128 v[80:83], v1 offset:34816
  s_waitcnt lgkmcnt(5)
  v_smfmac_f32_16x16x64_bf16 v[48:51], v[36:39], a[144:151], v6
  ds_read_b128 v[84:87], v1 offset:35840
  s_waitcnt lgkmcnt(5)
  v_smfmac_f32_16x16x64_bf16 v[48:51], v[40:43], a[136:143], v6
  ds_read_b128 v[104:107], v1 offset:20480
  s_waitcnt lgkmcnt(5)
  v_smfmac_f32_16x16x64_bf16 v[48:51], v[44:47], a[128:135], v6
  ds_read_b128 v[108:111], v1 offset:21504
  v_smfmac_f32_16x16x64_bf16 v[52:55], v[24:27], a[120:127], v6
  s_waitcnt lgkmcnt(5)
  buffer_load_dwordx4 v0, s[4:7], s96 offen offset:0  lds
  s_mov_b64 exec, 1
  buffer_store_dword v7, off, s[4:7], s64 sc1
  s_mov_b64 exec, -1
  v_smfmac_f32_16x16x64_bf16 v[52:55], v[28:31], a[112:119], v6
  s_waitcnt lgkmcnt(2)
  ds_read_b64 v[100:101], v5 offset:0
  v_smfmac_f32_16x16x64_bf16 v[52:55], v[32:35], a[104:111], v6
  v_add_f32 v48, v48, v50
  v_smfmac_f32_16x16x64_bf16 v[52:55], v[36:39], a[96:103], v6
  v_add_f32 v49, v49, v51
  v_smfmac_f32_16x16x64_bf16 v[52:55], v[40:43], a[88:95], v6
  v_cvt_pk_bf16_f32 v50, v48, v49
  v_smfmac_f32_16x16x64_bf16 v[52:55], v[44:47], a[80:87], v6
  v_cvt_pk_bf16_f32 v51, v48, v49
  v_smfmac_f32_16x16x64_bf16 v[56:59], v[24:27], a[72:79], v6
  ds_write_b64 v2, v[50:51] offset:8192
  v_smfmac_f32_16x16x64_bf16 v[56:59], v[28:31], a[64:71], v6
  ds_read_b64_tr_b16 v[88:89], v12 offset:8192
  s_nop 0
  v_smfmac_f32_16x16x64_bf16 v[56:59], v[32:35], a[56:63], v6
  s_nop 0
  v_add_f32 v52, v52, v54
  v_add_f32 v53, v53, v55
  v_cvt_pk_bf16_f32 v54, v52, v53
  v_cvt_pk_bf16_f32 v55, v52, v53
  ds_write_b64 v2, v[54:55] offset:8704
  v_smfmac_f32_16x16x64_bf16 v[56:59], v[36:39], a[48:55], v6
  ds_read_b64_tr_b16 v[90:91], v12 offset:8704
  v_smfmac_f32_16x16x64_bf16 v[56:59], v[40:43], a[40:47], v6
  buffer_load_dwordx4 v0, s[4:7], s96 offen offset:1024  lds
  v_smfmac_f32_16x16x64_bf16 v[56:59], v[44:47], a[32:39], v6
  ds_read_b128 v[112:115], v1 offset:22528
  v_smfmac_f32_16x16x64_bf16 v[60:63], v[24:27], a[24:31], v6
  buffer_load_dwordx4 v0, s[4:7], s96 offen offset:2048  lds
  v_smfmac_f32_16x16x64_bf16 v[60:63], v[28:31], a[16:23], v6
  s_waitcnt lgkmcnt(1)
  v_mfma_f32_16x16x32_bf16 v[92:95], v[72:75], v[88:91], 0
  buffer_load_dwordx4 v0, s[4:7], s96 offen offset:3072  lds
  v_mfma_f32_16x16x32_bf16 v[96:99], v[76:79], v[88:91], 0
  v_add_f32 v56, v56, v58
  v_add_f32 v57, v57, v59
  v_smfmac_f32_16x16x64_bf16 v[60:63], v[32:35], a[8:15], v6
  v_cvt_pk_bf16_f32 v58, v56, v57
  v_smfmac_f32_16x16x64_bf16 v[60:63], v[36:39], a[0:7], v6
  ds_write_b32 v2, v58 offset:8192
  v_smfmac_f32_16x16x64_bf16 v[60:63], v[40:43], v[248:255], v6
  s_nop 0
  v_cndmask_b32 v48, v92, v96, s[18:19]
  v_smfmac_f32_16x16x64_bf16 v[60:63], v[44:47], v[240:247], v6
  v_cndmask_b32 v49, v93, v97, s[18:19]
  v_cndmask_b32 v50, v94, v98, s[18:19]
  v_cndmask_b32 v51, v95, v99, s[18:19]
  ds_write_b128 v8, v[48:51] offset:12288
  v_smfmac_f32_16x16x64_bf16 v[68:71], v[20:23], v[152:159], v6
  s_nop 1
  s_nop 0
  v_add_f32 v60, v60, v62
  v_add_f32 v61, v61, v63
  v_cvt_pk_bf16_f32 v62, v60, v61
  ds_write_b32 v2, v62 offset:8704
  v_smfmac_f32_16x16x64_bf16 v[64:67], v[24:27], v[232:239], v6
  v_mov_b32 v76, 0
  buffer_store_dwordx2 v[100:101], v5, s[4:7], s97 offen sc1
  v_smfmac_f32_16x16x64_bf16 v[64:67], v[28:31], v[224:231], v6
  v_mov_b32 v79, 0
  s_waitcnt vmcnt(6)
  v_smfmac_f32_16x16x64_bf16 v[64:67], v[32:35], v[216:223], v6
  ds_read_b128 v[116:119], v1 offset:23552
  v_smfmac_f32_16x16x64_bf16 v[64:67], v[36:39], v[200:207], v6
  s_waitcnt lgkmcnt(1)
  s_barrier
  ds_read_b128 v[52:55], v9 offset:12288
  ds_read_b128 v[56:59], v10 offset:12288
  v_smfmac_f32_16x16x64_bf16 v[64:67], v[40:43], v[192:199], v6
  ds_read_b128 v[60:63], v11 offset:12288
  v_smfmac_f32_16x16x64_bf16 v[64:67], v[44:47], v[184:191], v6
  ds_read_b64_tr_b16 v[88:89], v12 offset:8192
  ds_read_b64_tr_b16 v[90:91], v12 offset:8704
  v_smfmac_f32_16x16x64_bf16 v[68:71], v[24:27], v[176:183], v6
  ds_read_b64_tr_b16 v[92:93], v13 offset:8192
  ds_read_b64_tr_b16 v[94:95], v13 offset:8704
  v_smfmac_f32_16x16x64_bf16 v[68:71], v[28:31], v[168:175], v6
  ds_read_b64_tr_b16 v[96:97], v14 offset:8192
  ds_read_b64_tr_b16 v[98:99], v14 offset:8704
  v_smfmac_f32_16x16x64_bf16 v[68:71], v[32:35], v[160:167], v6
  ds_read_b64_tr_b16 v[100:101], v15 offset:8192
  ds_read_b64_tr_b16 v[102:103], v15 offset:8704
  s_waitcnt lgkmcnt(8)
  v_smfmac_f32_16x16x64_bf16 v[68:71], v[36:39], v[144:151], v6
  v_add_f32 v48, v48, v52
  v_smfmac_f32_16x16x64_bf16 v[68:71], v[40:43], v[136:143], v6
  v_add_f32 v49, v49, v53
  v_smfmac_f32_16x16x64_bf16 v[68:71], v[44:47], v[128:135], v6
  v_add_f32 v50, v50, v54
  s_waitcnt lgkmcnt(4)
  v_mfma_f32_16x16x32_bf16 v[16:19], v[88:91], v[88:91], 0
  v_add_f32 v51, v51, v55
  v_add_f32 v56, v56, v60
  v_mfma_f32_16x16x32_bf16 v[16:19], v[92:95], v[92:95], v[16:19]
  v_add_f32 v57, v57, v61
  s_waitcnt lgkmcnt(0)
  v_add_f32 v58, v58, v62
  v_mfma_f32_16x16x32_bf16 v[16:19], v[96:99], v[96:99], v[16:19]
  v_add_f32 v59, v59, v63
  v_add_f32 v48, v48, v56
  v_mfma_f32_16x16x32_bf16 v[16:19], v[100:103], v[100:103], v[16:19]
  v_add_f32 v49, v49, v57
  v_add_f32 v50, v50, v58
  v_add_f32 v51, v51, v59
  v_exp_f32 v24, v48
  v_exp_f32 v25, v49
  v_exp_f32 v26, v50
  v_exp_f32 v27, v51
  v_mov_b64 v[20:21], s[14:15]
  v_cvt_pk_bf16_f32 v24, v24, v25
  v_cvt_pk_bf16_f32 v25, v26, v27
  v_cndmask_b32 v72, v24, 0, s[18:19]
  v_cndmask_b32 v73, v25, 0, s[18:19]
  v_cndmask_b32 v74, 0, v24, s[18:19]
  v_cndmask_b32 v75, 0, v25, s[18:19]
  v_mul_f32 v16, s24, v16
  v_mul_f32 v17, s24, v17
  v_mfma_f32_16x16x32_bf16 v[52:55], v[72:75], v[80:83], 0
  buffer_store_dwordx4 v[88:91], v0, s[4:7], s25 offen sc1
  v_exp_f32 v28, v16
  v_mov_b64 v[22:23], s[14:15]
  v_mfma_f32_16x16x32_bf16 v[56:59], v[72:75], v[84:87], 0
  v_exp_f32 v29, v17
  v_mfma_f32_16x16x32_bf16 v[60:63], v[72:75], v[20:23], 0
  v_add_f32 v64, v64, v66
  v_add_f32 v65, v65, v67
  v_cvt_pk_bf16_f32 v28, v28, v29
  v_cvt_pk_bf16_f32 v66, v64, v65
  v_cndmask_b32 v77, 0, v28, s[18:19]
  v_cndmask_b32 v78, 0, v28, s[18:19]
  v_add_f32 v68, v68, v70
  v_add_f32 v69, v69, v71
  v_cvt_pk_bf16_f32 v67, v68, v69
  v_mfma_f32_16x16x16_bf16 v[60:63], v[76:77], v[20:21], v[60:63]
  v_max3_f32 v7, |v48|, |v49|, |v50|
  v_max_f32 v26, |v16|, |v17|
  v_mfma_f32_16x16x16_bf16 v[52:55], v[78:79], v[66:67], v[52:55]
  v_cndmask_b32 v26, 0, v26, s[18:19]
  v_max3_f32 v7, |v51|, v26, v7
  v_mfma_f32_16x16x16_bf16 v[56:59], v[76:77], v[66:67], v[56:59]
  v_cmp_lt_f32 vcc, 0x42700000, v7
  v_mov_b64 v[44:45], 0
  v_add_f32 v60, v60, v62
  v_add_f32 v61, v61, v63
  s_cbranch_vccnz c_fb_33
c_fbr_34:
  v_rcp_f32 v60, v60
  v_rcp_f32 v61, v61
  v_pk_add_f32 v[52:53], v[52:53], v[54:55]
  v_pk_add_f32 v[56:57], v[56:57], v[58:59]
  v_pk_mul_f32 v[52:53], v[52:53], v[60:61]
  v_pk_mul_f32 v[56:57], v[56:57], v[60:61]
  v_cvt_pk_bf16_f32 v54, v52, v53
  v_cvt_pk_bf16_f32 v55, v56, v57
  ds_write_b64 v2, v[54:55] offset:0
  v_mov_b64 v[46:47], 0
  v_mov_b64 v[40:41], 0
  v_mov_b64 v[42:43], 0
  v_mov_b64 v[36:37], 0
  v_mov_b64 v[38:39], 0
  v_mov_b64 v[32:33], 0
  v_mov_b64 v[34:35], 0
  v_mov_b64 v[28:29], 0
  v_mov_b64 v[30:31], 0
  v_mov_b64 v[24:25], 0
  v_mov_b64 v[26:27], 0
  v_mov_b64 v[80:81], 0
  v_lshrrev_b32 v7, 1, v0
  s_waitcnt lgkmcnt(0)
  s_barrier
  ds_read_b64_tr_b16 v[72:73], v3 offset:0
  ds_read_b64_tr_b16 v[74:75], v3 offset:1024
  ds_read_b64_tr_b16 v[76:77], v3 offset:2048
  ds_read_b64_tr_b16 v[78:79], v3 offset:3072
  s_waitcnt lgkmcnt(2)
  v_smfmac_f32_16x16x64_bf16 v[44:47], v[72:75], a[248:255], v6
  ds_read_b128 v[120:123], v1 offset:24576
  s_and_b32 s3, s22, 1
  s_add_u32 s22, s22, 1
  buffer_store_dwordx2 v[66:67], v7, s[4:7], s25 offen offset:1024 sc1
  s_waitcnt lgkmcnt(1)
  v_smfmac_f32_16x16x64_bf16 v[44:47], v[76:79], a[240:247], v6
  ds_read_b128 v[124:127], v1 offset:25600
  s_and_b32 s42, s22, 3
  s_lshl_b32 s42, s42, 13
  s_cmp_eq_u32 s22, 64
  s_cbranch_scc1 c_last_36
  v_smfmac_f32_16x16x64_bf16 v[40:43], v[72:75], a[232:239], v6
  ds_read_b128 v[16:19], v1 offset:26624
  v_smfmac_f32_16x16x64_bf16 v[40:43], v[76:79], a[224:231], v6
  ds_read_b128 v[20:23], v1 offset:27648
  v_smfmac_f32_16x16x64_bf16 v[36:39], v[72:75], a[216:223], v6
  v_mov_b64 v[82:83], 0
  v_mov_b64 v[84:85], 0
  v_mov_b64 v[86:87], 0
  v_smfmac_f32_16x16x64_bf16 v[36:39], v[76:79], a[208:215], v6
  ds_read_b128 v[88:91], v1 offset:28672
  v_smfmac_f32_16x16x64_bf16 v[32:35], v[72:75], a[200:207], v6
  v_add_f32 v44, v44, v46
  v_add_f32 v45, v45, v47
  v_cvt_pk_bf16_f32 v48, v44, v45
  v_smfmac_f32_16x16x64_bf16 v[32:35], v[76:79], a[192:199], v6
  ds_read_b128 v[92:95], v1 offset:29696
  v_smfmac_f32_16x16x64_bf16 v[28:31], v[72:75], a[184:191], v6
  v_and_or_b32 v48, v48, -2, s3
  v_add_f32 v40, v40, v42
  v_add_f32 v41, v41, v43
  v_smfmac_f32_16x16x64_bf16 v[28:31], v[76:79], a[176:183], v6
  ds_read_b128 v[96:99], v1 offset:30720
  v_smfmac_f32_16x16x64_bf16 v[24:27], v[72:75], v[104:111], v6
  v_cvt_pk_bf16_f32 v49, v40, v41
  v_add_f32 v36, v36, v38
  v_add_f32 v37, v37, v39
  v_smfmac_f32_16x16x64_bf16 v[24:27], v[76:79], v[112:119], v6
  ds_read_b128 v[100:103], v1 offset:31744
  s_waitcnt lgkmcnt(6)
  v_smfmac_f32_16x16x64_bf16 v[80:83], v[72:75], v[120:127], v6
  v_cvt_pk_bf16_f32 v50, v36, v37
  v_add_f32 v32, v32, v34
  v_add_f32 v33, v33, v35
  s_waitcnt lgkmcnt(4)
  v_smfmac_f32_16x16x64_bf16 v[80:83], v[76:79], v[16:23], v6
  v_cvt_pk_bf16_f32 v51, v32, v33
  v_add_f32 v28, v28, v30
  v_add_f32 v29, v29, v31
  buffer_store_dwordx4 v[48:51], v4, s[4:7], s40 offen sc1
  s_waitcnt lgkmcnt(2)
  v_smfmac_f32_16x16x64_bf16 v[84:87], v[72:75], v[88:95], v6
  v_cvt_pk_bf16_f32 v52, v28, v29
  v_and_or_b32 v52, v52, -2, s3
  v_add_f32 v24, v24, v26
  s_waitcnt lgkmcnt(0)
  v_smfmac_f32_16x16x64_bf16 v[84:87], v[76:79], v[96:103], v6
  v_add_f32 v25, v25, v27
  v_cvt_pk_bf16_f32 v53, v24, v25
  v_add_f32 v80, v80, v82
  v_add_f32 v81, v81, v83
  v_cvt_pk_bf16_f32 v54, v80, v81
  s_nop 2
  v_pk_add_f32 v[84:85], v[84:85], v[86:87]
  v_cvt_pk_bf16_f32 v55, v84, v85
  buffer_store_dwordx4 v[52:55], v4, s[4:7], s41 offen sc1
  s_add_u32 s42, s42, s62
  s_add_u32 s43, s42, 4096
  s_add_u32 s23, s23, 524288
  s_add_u32 s25, s25, 262144
  s_add_u32 s63, s63, 512
  s_add_u32 s64, s64, 512
  s_add_u32 s92, s92, 512
  s_mov_b32 s96, s23
  s_add_u32 s97, s97, 8192
  s_buffer_load_dword s65, s[4:7], s63
  s_buffer_load_dword s94, s[4:7], s92
  v_mov_b64 v[56:57], 0
  v_mov_b64 v[58:59], 0
  v_mov_b64 v[60:61], 0
  v_mov_b64 v[62:63], 0
  v_mov_b64 v[48:49], 0
  v_mov_b64 v[50:51], 0
  v_mov_b64 v[52:53], 0
  v_mov_b64 v[54:55], 0
  s_cmp_lg_u32 s17, 0
  s_cbranch_scc1 c_oth_44
  s_mov_b32 s28, 0
  s_add_u32 s46, s46, 1
  v_mov_b64 v[120:121], -1
  s_xor_b32 s34, s42, 16384
  buffer_store_dwordx2 v[120:121], v5, s[4:7], s34 offen sc1
  s_mov_b32 vcc_lo, 0xaaaaaaaa
  s_mov_b32 vcc_hi, 0xaaaaaaaa
  v_mov_b32 v7, 0x3f80
  v_cndmask_b32 v7, v7, 1.0, vcc
  s_mov_b32 vcc_lo, 0x30003
  s_mov_b32 vcc_hi, 0x30003
  v_cndmask_b32 v68, 0, v7, vcc
  s_mov_b32 vcc_lo, 0xc000c
  s_mov_b32 vcc_hi, 0xc000c
  v_cndmask_b32 v69, 0, v7, vcc
  s_mov_b32 vcc_lo, 0x300030
  s_mov_b32 vcc_hi, 0x300030
  v_cndmask_b32 v70, 0, v7, vcc
  s_mov_b32 vcc_lo, 0xc000c0
  s_mov_b32 vcc_hi, 0xc000c0
  v_cndmask_b32 v71, 0, v7, vcc
  s_nop 15
  s_nop 15
  s_nop 15
  s_nop 15
  s_nop 5
  buffer_load_dwordx4 v[16:19], v0, s[4:7], s38 offen offset:0 sc1
  buffer_load_dwordx4 v[20:23], v0, s[4:7], s38 offen offset:1024 sc1
  buffer_load_dwordx4 v[24:27], v0, s[4:7], s38 offen offset:2048 sc1
  buffer_load_dwordx4 v[28:31], v0, s[4:7], s38 offen offset:3072 sc1
  buffer_load_dwordx4 v[32:35], v0, s[4:7], s39 offen offset:0 sc1
  buffer_load_dwordx4 v[36:39], v0, s[4:7], s39 offen offset:1024 sc1
  buffer_load_dwordx4 v[40:43], v0, s[4:7], s39 offen offset:2048 sc1
  buffer_load_dwordx4 v[44:47], v0, s[4:7], s39 offen offset:3072 sc1
  s_nop 14
  buffer_load_dwordx4 v[72:75], v0, s[4:7], s38 offen offset:0 sc1
  buffer_load_dwordx4 v[76:79], v0, s[4:7], s38 offen offset:1024 sc1
  buffer_load_dwordx4 v[80:83], v0, s[4:7], s38 offen offset:2048 sc1
  buffer_load_dwordx4 v[84:87], v0, s[4:7], s38 offen offset:3072 sc1
  buffer_load_dwordx4 v[88:91], v0, s[4:7], s39 offen offset:0 sc1
  buffer_load_dwordx4 v[92:95], v0, s[4:7], s39 offen offset:1024 sc1
  buffer_load_dwordx4 v[96:99], v0, s[4:7], s39 offen offset:2048 sc1
  buffer_load_dwordx4 v[100:103], v0, s[4:7], s39 offen offset:3072 sc1
  s_waitcnt vmcnt(15)
  v_mfma_f32_16x16x32_bf16 v[64:67], v[16:19], v[68:71], 0
  v_xor_b32 v7, s3, v16
  s_waitcnt vmcnt(14)
  v_mfma_f32_16x16x32_bf16 v[64:67], v[20:23], v[68:71], v[64:67]
  v_bitop3_b32 v7, v7, v20, s3 bitop3:0xf6
  s_waitcnt vmcnt(13)
  v_mfma_f32_16x16x32_bf16 v[64:67], v[24:27], v[68:71], v[64:67]
  v_bitop3_b32 v7, v7, v24, s3 bitop3:0xf6
  s_waitcnt vmcnt(12)
  v_mfma_f32_16x16x32_bf16 v[64:67], v[28:31], v[68:71], v[64:67]
  v_bitop3_b32 v7, v7, v28, s3 bitop3:0xf6
  s_waitcnt vmcnt(11)
  v_mfma_f32_16x16x32_bf16 v[64:67], v[32:35], v[68:71], v[64:67]
  v_bitop3_b32 v7, v7, v32, s3 bitop3:0xf6
  s_waitcnt vmcnt(10)
  v_mfma_f32_16x16x32_bf16 v[64:67], v[36:39], v[68:71], v[64:67]
  v_bitop3_b32 v7, v7, v36, s3 bitop3:0xf6
  s_waitcnt vmcnt(9)
  v_mfma_f32_16x16x32_bf16 v[64:67], v[40:43], v[68:71], v[64:67]
  v_bitop3_b32 v7, v7, v40, s3 bitop3:0xf6
  s_waitcnt vmcnt(8)
  v_mfma_f32_16x16x32_bf16 v[64:67], v[44:47], v[68:71], v[64:67]
  v_bitop3_b32 v7, v7, v44, s3 bitop3:0xf6
  v_and_b32 v7, 1, v7
  v_cmp_ne_u32 vcc, 0, v7
  v_mov_b32 v7, 0
  v_mov_b32 v7, 0
  s_cbranch_vccnz c_p1r_45
c_publ_46:
  s_nop 1
  v_cvt_pk_bf16_f32 v64, v64, v65
  v_cvt_pk_bf16_f32 v65, v66, v67
  v_min_u32 v64, -2, v64
  v_min_u32 v65, -2, v65
  buffer_store_dwordx2 v[64:65], v5, s[4:7], s42 offen sc1
c_hop2_32:
  s_barrier
  s_nop 15
  s_nop 13
  s_cmp_eq_u32 s95, 0
  s_cbranch_scc1 c_loop_29
  s_mov_b32 s29, 0
c_fk_47:
  buffer_load_dwordx4 v[16:19], v8, s[4:7], s42 offen sc1
  buffer_load_dwordx4 v[20:23], v8, s[4:7], s43 offen sc1
  s_add_u32 s29, s29, 1
  s_cmp_gt_u32 s29, 1048576
  s_cbranch_scc1 c_fail_35
  s_waitcnt vmcnt(0)
  v_max3_u32 v7, v16, v17, v18
  v_max3_u32 v7, v19, v20, v7
  v_max3_u32 v7, v21, v22, v7
  v_max_u32 v7, v7, v23
  v_cmp_eq_u32 vcc, -1, v7
  s_cbranch_vccnz c_fk_47
  s_lshl_b32 s42, s22, 13
  s_add_u32 s42, s42, 5767168
  s_add_u32 s43, s42, 4096
  s_mov_b32 s95, 0
  s_branch c_loop_29
c_kvs_42:
  s_cmp_ge_u32 s22, 63
  s_cbranch_scc1 c_kvr_43
  s_mov_b32 s29, 0
c_gw_48:
  buffer_load_dword v7, off, s[4:7], s92 sc1
  s_add_u32 s29, s29, 1
  s_cmp_gt_u32 s29, 1048576
  s_cbranch_scc1 c_fail_35
  s_waitcnt vmcnt(0)
  v_readfirstlane_b32 s94, v7
  s_cmp_eq_u32 s94, 0
  s_cbranch_scc1 c_gw_48
  s_cmp_lg_u32 s94, s93
  s_cselect_b32 s95, 1, 0
  s_lshl_b32 s30, s95, 25
  s_add_u32 s96, s23, s30
  s_cmp_lg_u32 s95, 0
  s_cbranch_scc1 c_kvx_50
c_kvw_49:
  buffer_load_dword v7, off, s[4:7], s63 sc1
  s_add_u32 s29, s29, 1
  s_cmp_gt_u32 s29, 1048576
  s_cbranch_scc1 c_fail_35
  s_waitcnt vmcnt(0)
  v_readfirstlane_b32 s65, v7
  s_cmp_eq_u32 s65, 0
  s_cbranch_scc1 c_kvw_49
c_kvx_50:
  s_branch c_kvr_43
c_last_36:
  s_add_u32 s64, s64, 512
  v_mov_b32 v7, 1
  s_waitcnt vmcnt(0)
  s_mov_b64 exec, 1
  buffer_store_dword v7, off, s[4:7], s64 sc1
  s_mov_b64 exec, -1
  s_branch c_fail_35
c_oth_44:
  ds_read_b128 v[24:27], v1 offset:0
  ds_read_b128 v[28:31], v1 offset:1024
  ds_read_b128 v[32:35], v1 offset:2048
  ds_read_b128 v[36:39], v1 offset:3072
  ds_read_b128 v[40:43], v1 offset:4096
  ds_read_b128 v[44:47], v1 offset:5120
  ds_read_b128 v[72:75], v1 offset:6144
  ds_read_b128 v[76:79], v1 offset:7168
  ds_read_b128 v[80:83], v1 offset:8192
  ds_read_b128 v[84:87], v1 offset:9216
  ds_read_b128 v[88:91], v1 offset:10240
  ds_read_b128 v[92:95], v1 offset:11264
  ds_read_b128 v[96:99], v1 offset:12288
  ds_read_b128 v[100:103], v1 offset:13312
  ds_read_b128 v[104:107], v1 offset:14336
  ds_read_b128 v[108:111], v1 offset:15360
  ds_read_b128 v[112:115], v1 offset:16384
  ds_read_b128 v[116:119], v1 offset:17408
  ds_read_b128 v[120:123], v1 offset:18432
  ds_read_b128 v[124:127], v1 offset:19456
  v_mov_b64 v[64:65], 0
  v_mov_b64 v[66:67], 0
  v_mov_b64 v[68:69], 0
  v_mov_b64 v[70:71], 0
  s_branch c_hop2_32
c_w0a_40:
  s_waitcnt vmcnt(3)
  ds_read_b128 v[24:27], v1 offset:0
  ds_read_b128 v[28:31], v1 offset:1024
  ds_read_b128 v[32:35], v1 offset:2048
  ds_read_b128 v[36:39], v1 offset:3072
  ds_read_b128 v[40:43], v1 offset:4096
  ds_read_b128 v[44:47], v1 offset:5120
  ds_read_b128 v[72:75], v1 offset:6144
  ds_read_b128 v[76:79], v1 offset:7168
  ds_read_b128 v[80:83], v1 offset:8192
  ds_read_b128 v[84:87], v1 offset:9216
  buffer_load_dwordx4 v[16:19], v8, s[4:7], s42 offen sc1
  buffer_load_dwordx4 v[20:23], v8, s[4:7], s43 offen sc1
  ds_read_b128 v[88:91], v1 offset:10240
  ds_read_b128 v[92:95], v1 offset:11264
  ds_read_b128 v[96:99], v1 offset:12288
  ds_read_b128 v[100:103], v1 offset:13312
  ds_read_b128 v[104:107], v1 offset:14336
  ds_read_b128 v[108:111], v1 offset:15360
  ds_read_b128 v[112:115], v1 offset:16384
  ds_read_b128 v[116:119], v1 offset:17408
  ds_read_b128 v[120:123], v1 offset:18432
  ds_read_b128 v[124:127], v1 offset:19456
  buffer_load_dwordx4 v[16:19], v8, s[4:7], s42 offen sc1
  buffer_load_dwordx4 v[20:23], v8, s[4:7], s43 offen sc1
  v_mov_b64 v[64:65], 0
  v_mov_b64 v[66:67], 0
  v_mov_b64 v[68:69], 0
  v_mov_b64 v[70:71], 0
  s_branch c_w0b_41
c_p1r_45:
  buffer_load_dwordx4 v[16:19], v0, s[4:7], s38 offen offset:0 sc1
  buffer_load_dwordx4 v[20:23], v0, s[4:7], s38 offen offset:1024 sc1
  buffer_load_dwordx4 v[24:27], v0, s[4:7], s38 offen offset:2048 sc1
  buffer_load_dwordx4 v[28:31], v0, s[4:7], s38 offen offset:3072 sc1
  buffer_load_dwordx4 v[32:35], v0, s[4:7], s39 offen offset:0 sc1
  buffer_load_dwordx4 v[36:39], v0, s[4:7], s39 offen offset:1024 sc1
  buffer_load_dwordx4 v[40:43], v0, s[4:7], s39 offen offset:2048 sc1
  buffer_load_dwordx4 v[44:47], v0, s[4:7], s39 offen offset:3072 sc1
  s_add_u32 s46, s46, 1
  s_waitcnt vmcnt(15)
  v_mfma_f32_16x16x32_bf16 v[64:67], v[72:75], v[68:71], 0
  v_xor_b32 v7, s3, v72
  s_waitcnt vmcnt(14)
  v_mfma_f32_16x16x32_bf16 v[64:67], v[76:79], v[68:71], v[64:67]
  v_bitop3_b32 v7, v7, v76, s3 bitop3:0xf6
  s_waitcnt vmcnt(13)
  v_mfma_f32_16x16x32_bf16 v[64:67], v[80:83], v[68:71], v[64:67]
  v_bitop3_b32 v7, v7, v80, s3 bitop3:0xf6
  s_waitcnt vmcnt(12)
  v_mfma_f32_16x16x32_bf16 v[64:67], v[84:87], v[68:71], v[64:67]
  v_bitop3_b32 v7, v7, v84, s3 bitop3:0xf6
  s_waitcnt vmcnt(11)
  v_mfma_f32_16x16x32_bf16 v[64:67], v[88:91], v[68:71], v[64:67]
  v_bitop3_b32 v7, v7, v88, s3 bitop3:0xf6
  s_waitcnt vmcnt(10)
  v_mfma_f32_16x16x32_bf16 v[64:67], v[92:95], v[68:71], v[64:67]
  v_bitop3_b32 v7, v7, v92, s3 bitop3:0xf6
  s_waitcnt vmcnt(9)
  v_mfma_f32_16x16x32_bf16 v[64:67], v[96:99], v[68:71], v[64:67]
  v_bitop3_b32 v7, v7, v96, s3 bitop3:0xf6
  s_waitcnt vmcnt(8)
  v_mfma_f32_16x16x32_bf16 v[64:67], v[100:103], v[68:71], v[64:67]
  v_bitop3_b32 v7, v7, v100, s3 bitop3:0xf6
  v_and_b32 v7, 1, v7
  v_cmp_ne_u32 vcc, 0, v7
  v_mov_b32 v7, 0
  v_mov_b32 v7, 0
  s_cbranch_vccnz c_p1s_51
  s_branch c_publ_46
c_p1s_51:
  buffer_load_dwordx4 v[72:75], v0, s[4:7], s38 offen offset:0 sc1
  buffer_load_dwordx4 v[76:79], v0, s[4:7], s38 offen offset:1024 sc1
  buffer_load_dwordx4 v[80:83], v0, s[4:7], s38 offen offset:2048 sc1
  buffer_load_dwordx4 v[84:87], v0, s[4:7], s38 offen offset:3072 sc1
  buffer_load_dwordx4 v[88:91], v0, s[4:7], s39 offen offset:0 sc1
  buffer_load_dwordx4 v[92:95], v0, s[4:7], s39 offen offset:1024 sc1
  buffer_load_dwordx4 v[96:99], v0, s[4:7], s39 offen offset:2048 sc1
  buffer_load_dwordx4 v[100:103], v0, s[4:7], s39 offen offset:3072 sc1
  s_add_u32 s28, s28, 1
  s_add_u32 s46, s46, 1
  s_cmp_gt_u32 s28, 1048576
  s_cbranch_scc1 c_fail_35
  s_waitcnt vmcnt(15)
  v_mfma_f32_16x16x32_bf16 v[64:67], v[16:19], v[68:71], 0
  v_xor_b32 v7, s3, v16
  s_waitcnt vmcnt(14)
  v_mfma_f32_16x16x32_bf16 v[64:67], v[20:23], v[68:71], v[64:67]
  v_bitop3_b32 v7, v7, v20, s3 bitop3:0xf6
  s_waitcnt vmcnt(13)
  v_mfma_f32_16x16x32_bf16 v[64:67], v[24:27], v[68:71], v[64:67]
  v_bitop3_b32 v7, v7, v24, s3 bitop3:0xf6
  s_waitcnt vmcnt(12)
  v_mfma_f32_16x16x32_bf16 v[64:67], v[28:31], v[68:71], v[64:67]
  v_bitop3_b32 v7, v7, v28, s3 bitop3:0xf6
  s_waitcnt vmcnt(11)
  v_mfma_f32_16x16x32_bf16 v[64:67], v[32:35], v[68:71], v[64:67]
  v_bitop3_b32 v7, v7, v32, s3 bitop3:0xf6
  s_waitcnt vmcnt(10)
  v_mfma_f32_16x16x32_bf16 v[64:67], v[36:39], v[68:71], v[64:67]
  v_bitop3_b32 v7, v7, v36, s3 bitop3:0xf6
  s_waitcnt vmcnt(9)
  v_mfma_f32_16x16x32_bf16 v[64:67], v[40:43], v[68:71], v[64:67]
  v_bitop3_b32 v7, v7, v40, s3 bitop3:0xf6
  s_waitcnt vmcnt(8)
  v_mfma_f32_16x16x32_bf16 v[64:67], v[44:47], v[68:71], v[64:67]
  v_bitop3_b32 v7, v7, v44, s3 bitop3:0xf6
  v_and_b32 v7, 1, v7
  v_cmp_ne_u32 vcc, 0, v7
  v_mov_b32 v7, 0
  v_mov_b32 v7, 0
  s_cbranch_vccnz c_p1r_45
  s_branch c_publ_46
c_retry_30:
  buffer_load_dwordx4 v[16:19], v8, s[4:7], s42 offen sc1
  buffer_load_dwordx4 v[20:23], v8, s[4:7], s43 offen sc1
  s_add_u32 s28, s28, 1
  s_add_u32 s47, s47, 1
  s_cmp_gt_u32 s28, 1048576
  s_cbranch_scc1 c_fail_35
  v_mov_b64 v[48:49], 0
  v_mov_b64 v[50:51], 0
  v_mov_b64 v[52:53], 0
  v_mov_b64 v[54:55], 0
  v_mov_b64 v[56:57], 0
  v_mov_b64 v[58:59], 0
  s_waitcnt vmcnt(4)
  v_max3_u32 v7, v16, v17, v18
  v_max_u32 v7, v7, v19
  ds_write_b128 v8, v[16:19] offset:0
  v_smfmac_f32_16x16x64_bf16 v[48:51], v[16:19], v[24:31], v6
  s_branch c_got_31
c_fb_33:
  v_max3_f32 v7, v48, v49, v50
  v_max_f32 v7, v51, v7
  s_mov_b64 exec, s[18:19]
  v_max3_f32 v7, v16, v17, v7
  s_mov_b64 exec, -1
  s_nop 0
  v_max_f32_dpp v7, v7, v7 quad_perm:[2,3,0,1] row_mask:0xf bank_mask:0xf
  v_mov_b32 v24, v7
  s_nop 0
  s_nop 0
  v_permlane16_swap_b32 v7, v24
  v_max_f32 v7, v7, v24
  v_mov_b32 v24, v7
  s_nop 0
  s_nop 0
  v_permlane32_swap_b32 v7, v24
  v_max_f32 v7, v7, v24
  v_sub_f32 v24, v48, v7
  v_sub_f32 v25, v49, v7
  v_sub_f32 v26, v50, v7
  v_sub_f32 v27, v51, v7
  v_sub_f32 v28, v16, v7
  v_sub_f32 v29, v17, v7
  v_exp_f32 v24, v24
  v_exp_f32 v25, v25
  v_exp_f32 v26, v26
  v_exp_f32 v27, v27
  v_exp_f32 v28, v28
  v_exp_f32 v29, v29
  v_cvt_pk_bf16_f32 v24, v24, v25
  v_cvt_pk_bf16_f32 v25, v26, v27
  v_cvt_pk_bf16_f32 v28, v28, v29
  v_cndmask_b32 v72, v24, 0, s[18:19]
  v_cndmask_b32 v73, v25, 0, s[18:19]
  v_cndmask_b32 v74, 0, v24, s[18:19]
  v_cndmask_b32 v75, 0, v25, s[18:19]
  v_cndmask_b32 v77, 0, v28, s[18:19]
  v_cndmask_b32 v78, 0, v28, s[18:19]
  v_mfma_f32_16x16x32_bf16 v[60:63], v[72:75], v[20:23], 0
  v_mfma_f32_16x16x32_bf16 v[52:55], v[72:75], v[80:83], 0
  v_mfma_f32_16x16x32_bf16 v[56:59], v[72:75], v[84:87], 0
  s_nop 5
  v_mfma_f32_16x16x16_bf16 v[60:63], v[76:77], v[20:21], v[60:63]
  v_mfma_f32_16x16x16_bf16 v[52:55], v[78:79], v[66:67], v[52:55]
  v_mfma_f32_16x16x16_bf16 v[56:59], v[76:77], v[66:67], v[56:59]
  s_nop 7
  v_add_f32 v60, v60, v62
  v_add_f32 v61, v61, v63
  s_branch c_fbr_34
c_fail_35:
  s_endpgm
L_qkv:
  s_sub_u32 s26, s90, 96
  s_mul_i32 s16, s26, 171
  s_lshr_b32 s16, s16, 9
  s_mul_i32 s27, s16, 3
  s_sub_u32 s60, s26, s27
  v_and_b32 v19, 63, v0
  v_and_b32 v6, 15, v19
  v_lshrrev_b32 v7, 4, v19
  v_lshlrev_b32 v1, 2, v19
  v_lshlrev_b32 v0, 4, v19
  v_mov_b32 v4, 1
  s_mov_b32 s24, 0x3e0293ee
  v_xor_b32 v20, v7, v6
  v_lshlrev_b32 v20, 4, v20
  v_lshl_add_u32 v20, v6, 10, v20
  v_add_u32 v20, 32768, v20
  v_xor_b32 v8, 0, v20
  v_xor_b32 v9, 64, v20
  v_xor_b32 v10, 128, v20
  v_xor_b32 v11, 192, v20
  s_and_b32 s26, s17, 1
  s_lshl_b32 s26, s26, 7
  v_xor_b32 v20, s26, v0
  v_xor_b32 v12, 0, v20
  v_xor_b32 v13, 16, v20
  v_xor_b32 v14, 32, v20
  v_xor_b32 v15, 48, v20
  v_xor_b32 v16, 64, v20
  v_xor_b32 v17, 80, v20
  v_xor_b32 v18, 96, v20
  v_xor_b32 v19, 112, v20
  s_mov_b32 s44, 0x05040100
  s_mov_b32 s45, 0x07060302
  s_mov_b32 s10, 4194304
  s_mov_b32 s11, 0x20000
  v_lshlrev_b32 v21, 16, v7
  v_lshl_add_u32 v21, v6, 2, v21
  s_lshl_b32 s26, s16, 8
  s_lshl_b32 s27, s17, 6
  s_add_u32 s26, s26, s27
  s_load_dwordx2 s[8:9], s[0:1], 24
  s_waitcnt lgkmcnt(0)
  s_add_u32 s27, s26, 0
  buffer_load_dword v24, v21, s[8:11], s27 offen
  s_add_u32 s27, s26, 8192
  buffer_load_dword v25, v21, s[8:11], s27 offen
  s_add_u32 s27, s26, 16384
  buffer_load_dword v26, v21, s[8:11], s27 offen
  s_add_u32 s27, s26, 24576
  buffer_load_dword v27, v21, s[8:11], s27 offen
  s_add_u32 s27, s26, 32768
  buffer_load_dword v28, v21, s[8:11], s27 offen
  s_add_u32 s27, s26, 40960
  buffer_load_dword v29, v21, s[8:11], s27 offen
  s_add_u32 s27, s26, 49152
  buffer_load_dword v30, v21, s[8:11], s27 offen
  s_add_u32 s27, s26, 57344
  buffer_load_dword v31, v21, s[8:11], s27 offen
  s_add_u32 s27, s26, 262144
  buffer_load_dword v32, v21, s[8:11], s27 offen
  s_add_u32 s27, s26, 270336
  buffer_load_dword v33, v21, s[8:11], s27 offen
  s_add_u32 s27, s26, 278528
  buffer_load_dword v34, v21, s[8:11], s27 offen
  s_add_u32 s27, s26, 286720
  buffer_load_dword v35, v21, s[8:11], s27 offen
  s_add_u32 s27, s26, 294912
  buffer_load_dword v36, v21, s[8:11], s27 offen
  s_add_u32 s27, s26, 303104
  buffer_load_dword v37, v21, s[8:11], s27 offen
  s_add_u32 s27, s26, 311296
  buffer_load_dword v38, v21, s[8:11], s27 offen
  s_add_u32 s27, s26, 319488
  buffer_load_dword v39, v21, s[8:11], s27 offen
  s_add_u32 s27, s26, 524288
  buffer_load_dword v40, v21, s[8:11], s27 offen
  s_add_u32 s27, s26, 532480
  buffer_load_dword v41, v21, s[8:11], s27 offen
  s_add_u32 s27, s26, 540672
  buffer_load_dword v42, v21, s[8:11], s27 offen
  s_add_u32 s27, s26, 548864
  buffer_load_dword v43, v21, s[8:11], s27 offen
  s_add_u32 s27, s26, 557056
  buffer_load_dword v44, v21, s[8:11], s27 offen
  s_add_u32 s27, s26, 565248
  buffer_load_dword v45, v21, s[8:11], s27 offen
  s_add_u32 s27, s26, 573440
  buffer_load_dword v46, v21, s[8:11], s27 offen
  s_add_u32 s27, s26, 581632
  buffer_load_dword v47, v21, s[8:11], s27 offen
  s_add_u32 s27, s26, 786432
  buffer_load_dword v48, v21, s[8:11], s27 offen
  s_add_u32 s27, s26, 794624
  buffer_load_dword v49, v21, s[8:11], s27 offen
  s_add_u32 s27, s26, 802816
  buffer_load_dword v50, v21, s[8:11], s27 offen
  s_add_u32 s27, s26, 811008
  buffer_load_dword v51, v21, s[8:11], s27 offen
  s_add_u32 s27, s26, 819200
  buffer_load_dword v52, v21, s[8:11], s27 offen
  s_add_u32 s27, s26, 827392
  buffer_load_dword v53, v21, s[8:11], s27 offen
  s_add_u32 s27, s26, 835584
  buffer_load_dword v54, v21, s[8:11], s27 offen
  s_add_u32 s27, s26, 843776
  buffer_load_dword v55, v21, s[8:11], s27 offen
  s_add_u32 s27, s26, 1048576
  buffer_load_dword v56, v21, s[8:11], s27 offen
  s_add_u32 s27, s26, 1056768
  buffer_load_dword v57, v21, s[8:11], s27 offen
  s_add_u32 s27, s26, 1064960
  buffer_load_dword v58, v21, s[8:11], s27 offen
  s_add_u32 s27, s26, 1073152
  buffer_load_dword v59, v21, s[8:11], s27 offen
  s_add_u32 s27, s26, 1081344
  buffer_load_dword v60, v21, s[8:11], s27 offen
  s_add_u32 s27, s26, 1089536
  buffer_load_dword v61, v21, s[8:11], s27 offen
  s_add_u32 s27, s26, 1097728
  buffer_load_dword v62, v21, s[8:11], s27 offen
  s_add_u32 s27, s26, 1105920
  buffer_load_dword v63, v21, s[8:11], s27 offen
  s_add_u32 s27, s26, 1310720
  buffer_load_dword v64, v21, s[8:11], s27 offen
  s_add_u32 s27, s26, 1318912
  buffer_load_dword v65, v21, s[8:11], s27 offen
  s_add_u32 s27, s26, 1327104
  buffer_load_dword v66, v21, s[8:11], s27 offen
  s_add_u32 s27, s26, 1335296
  buffer_load_dword v67, v21, s[8:11], s27 offen
  s_add_u32 s27, s26, 1343488
  buffer_load_dword v68, v21, s[8:11], s27 offen
  s_add_u32 s27, s26, 1351680
  buffer_load_dword v69, v21, s[8:11], s27 offen
  s_add_u32 s27, s26, 1359872
  buffer_load_dword v70, v21, s[8:11], s27 offen
  s_add_u32 s27, s26, 1368064
  buffer_load_dword v71, v21, s[8:11], s27 offen
  s_add_u32 s27, s26, 1572864
  buffer_load_dword v72, v21, s[8:11], s27 offen
  s_add_u32 s27, s26, 1581056
  buffer_load_dword v73, v21, s[8:11], s27 offen
  s_add_u32 s27, s26, 1589248
  buffer_load_dword v74, v21, s[8:11], s27 offen
  s_add_u32 s27, s26, 1597440
  buffer_load_dword v75, v21, s[8:11], s27 offen
  s_add_u32 s27, s26, 1605632
  buffer_load_dword v76, v21, s[8:11], s27 offen
  s_add_u32 s27, s26, 1613824
  buffer_load_dword v77, v21, s[8:11], s27 offen
  s_add_u32 s27, s26, 1622016
  buffer_load_dword v78, v21, s[8:11], s27 offen
  s_add_u32 s27, s26, 1630208
  buffer_load_dword v79, v21, s[8:11], s27 offen
  s_add_u32 s27, s26, 1835008
  buffer_load_dword v80, v21, s[8:11], s27 offen
  s_add_u32 s27, s26, 1843200
  buffer_load_dword v81, v21, s[8:11], s27 offen
  s_add_u32 s27, s26, 1851392
  buffer_load_dword v82, v21, s[8:11], s27 offen
  s_add_u32 s27, s26, 1859584
  buffer_load_dword v83, v21, s[8:11], s27 offen
  s_add_u32 s27, s26, 1867776
  buffer_load_dword v84, v21, s[8:11], s27 offen
  s_add_u32 s27, s26, 1875968
  buffer_load_dword v85, v21, s[8:11], s27 offen
  s_add_u32 s27, s26, 1884160
  buffer_load_dword v86, v21, s[8:11], s27 offen
  s_add_u32 s27, s26, 1892352
  buffer_load_dword v87, v21, s[8:11], s27 offen
  s_waitcnt vmcnt(48)
  v_perm_b32 v128, v25, v24, s44
  v_perm_b32 v129, v27, v26, s44
  v_perm_b32 v130, v29, v28, s44
  v_perm_b32 v131, v31, v30, s44
  v_perm_b32 v192, v25, v24, s45
  v_perm_b32 v193, v27, v26, s45
  v_perm_b32 v194, v29, v28, s45
  v_perm_b32 v195, v31, v30, s45
  v_perm_b32 v132, v33, v32, s44
  v_perm_b32 v133, v35, v34, s44
  v_perm_b32 v134, v37, v36, s44
  v_perm_b32 v135, v39, v38, s44
  v_perm_b32 v196, v33, v32, s45
  v_perm_b32 v197, v35, v34, s45
  v_perm_b32 v198, v37, v36, s45
  v_perm_b32 v199, v39, v38, s45
  s_add_u32 s27, s26, 2097152
  buffer_load_dword v88, v21, s[8:11], s27 offen
  s_add_u32 s27, s26, 2105344
  buffer_load_dword v89, v21, s[8:11], s27 offen
  s_add_u32 s27, s26, 2113536
  buffer_load_dword v90, v21, s[8:11], s27 offen
  s_add_u32 s27, s26, 2121728
  buffer_load_dword v91, v21, s[8:11], s27 offen
  s_add_u32 s27, s26, 2129920
  buffer_load_dword v92, v21, s[8:11], s27 offen
  s_add_u32 s27, s26, 2138112
  buffer_load_dword v93, v21, s[8:11], s27 offen
  s_add_u32 s27, s26, 2146304
  buffer_load_dword v94, v21, s[8:11], s27 offen
  s_add_u32 s27, s26, 2154496
  buffer_load_dword v95, v21, s[8:11], s27 offen
  s_add_u32 s27, s26, 2359296
  buffer_load_dword v96, v21, s[8:11], s27 offen
  s_add_u32 s27, s26, 2367488
  buffer_load_dword v97, v21, s[8:11], s27 offen
  s_add_u32 s27, s26, 2375680
  buffer_load_dword v98, v21, s[8:11], s27 offen
  s_add_u32 s27, s26, 2383872
  buffer_load_dword v99, v21, s[8:11], s27 offen
  s_add_u32 s27, s26, 2392064
  buffer_load_dword v100, v21, s[8:11], s27 offen
  s_add_u32 s27, s26, 2400256
  buffer_load_dword v101, v21, s[8:11], s27 offen
  s_add_u32 s27, s26, 2408448
  buffer_load_dword v102, v21, s[8:11], s27 offen
  s_add_u32 s27, s26, 2416640
  buffer_load_dword v103, v21, s[8:11], s27 offen
  s_waitcnt vmcnt(48)
  v_perm_b32 v136, v41, v40, s44
  v_perm_b32 v137, v43, v42, s44
  v_perm_b32 v138, v45, v44, s44
  v_perm_b32 v139, v47, v46, s44
  v_perm_b32 v200, v41, v40, s45
  v_perm_b32 v201, v43, v42, s45
  v_perm_b32 v202, v45, v44, s45
  v_perm_b32 v203, v47, v46, s45
  v_perm_b32 v140, v49, v48, s44
  v_perm_b32 v141, v51, v50, s44
  v_perm_b32 v142, v53, v52, s44
  v_perm_b32 v143, v55, v54, s44
  v_perm_b32 v204, v49, v48, s45
  v_perm_b32 v205, v51, v50, s45
  v_perm_b32 v206, v53, v52, s45
  v_perm_b32 v207, v55, v54, s45
  s_add_u32 s27, s26, 2621440
  buffer_load_dword v104, v21, s[8:11], s27 offen
  s_add_u32 s27, s26, 2629632
  buffer_load_dword v105, v21, s[8:11], s27 offen
  s_add_u32 s27, s26, 2637824
  buffer_load_dword v106, v21, s[8:11], s27 offen
  s_add_u32 s27, s26, 2646016
  buffer_load_dword v107, v21, s[8:11], s27 offen
  s_add_u32 s27, s26, 2654208
  buffer_load_dword v108, v21, s[8:11], s27 offen
  s_add_u32 s27, s26, 2662400
  buffer_load_dword v109, v21, s[8:11], s27 offen
  s_add_u32 s27, s26, 2670592
  buffer_load_dword v110, v21, s[8:11], s27 offen
  s_add_u32 s27, s26, 2678784
  buffer_load_dword v111, v21, s[8:11], s27 offen
  s_add_u32 s27, s26, 2883584
  buffer_load_dword v112, v21, s[8:11], s27 offen
  s_add_u32 s27, s26, 2891776
  buffer_load_dword v113, v21, s[8:11], s27 offen
  s_add_u32 s27, s26, 2899968
  buffer_load_dword v114, v21, s[8:11], s27 offen
  s_add_u32 s27, s26, 2908160
  buffer_load_dword v115, v21, s[8:11], s27 offen
  s_add_u32 s27, s26, 2916352
  buffer_load_dword v116, v21, s[8:11], s27 offen
  s_add_u32 s27, s26, 2924544
  buffer_load_dword v117, v21, s[8:11], s27 offen
  s_add_u32 s27, s26, 2932736
  buffer_load_dword v118, v21, s[8:11], s27 offen
  s_add_u32 s27, s26, 2940928
  buffer_load_dword v119, v21, s[8:11], s27 offen
  s_waitcnt vmcnt(48)
  v_perm_b32 v144, v57, v56, s44
  v_perm_b32 v145, v59, v58, s44
  v_perm_b32 v146, v61, v60, s44
  v_perm_b32 v147, v63, v62, s44
  v_perm_b32 v208, v57, v56, s45
  v_perm_b32 v209, v59, v58, s45
  v_perm_b32 v210, v61, v60, s45
  v_perm_b32 v211, v63, v62, s45
  v_perm_b32 v148, v65, v64, s44
  v_perm_b32 v149, v67, v66, s44
  v_perm_b32 v150, v69, v68, s44
  v_perm_b32 v151, v71, v70, s44
  v_perm_b32 v212, v65, v64, s45
  v_perm_b32 v213, v67, v66, s45
  v_perm_b32 v214, v69, v68, s45
  v_perm_b32 v215, v71, v70, s45
  s_add_u32 s27, s26, 3145728
  buffer_load_dword v24, v21, s[8:11], s27 offen
  s_add_u32 s27, s26, 3153920
  buffer_load_dword v25, v21, s[8:11], s27 offen
  s_add_u32 s27, s26, 3162112
  buffer_load_dword v26, v21, s[8:11], s27 offen
  s_add_u32 s27, s26, 3170304
  buffer_load_dword v27, v21, s[8:11], s27 offen
  s_add_u32 s27, s26, 3178496
  buffer_load_dword v28, v21, s[8:11], s27 offen
  s_add_u32 s27, s26, 3186688
  buffer_load_dword v29, v21, s[8:11], s27 offen
  s_add_u32 s27, s26, 3194880
  buffer_load_dword v30, v21, s[8:11], s27 offen
  s_add_u32 s27, s26, 3203072
  buffer_load_dword v31, v21, s[8:11], s27 offen
  s_add_u32 s27, s26, 3407872
  buffer_load_dword v32, v21, s[8:11], s27 offen
  s_add_u32 s27, s26, 3416064
  buffer_load_dword v33, v21, s[8:11], s27 offen
  s_add_u32 s27, s26, 3424256
  buffer_load_dword v34, v21, s[8:11], s27 offen
  s_add_u32 s27, s26, 3432448
  buffer_load_dword v35, v21, s[8:11], s27 offen
  s_add_u32 s27, s26, 3440640
  buffer_load_dword v36, v21, s[8:11], s27 offen
  s_add_u32 s27, s26, 3448832
  buffer_load_dword v37, v21, s[8:11], s27 offen
  s_add_u32 s27, s26, 3457024
  buffer_load_dword v38, v21, s[8:11], s27 offen
  s_add_u32 s27, s26, 3465216
  buffer_load_dword v39, v21, s[8:11], s27 offen
  s_waitcnt vmcnt(48)
  v_perm_b32 v152, v73, v72, s44
  v_perm_b32 v153, v75, v74, s44
  v_perm_b32 v154, v77, v76, s44
  v_perm_b32 v155, v79, v78, s44
  v_perm_b32 v216, v73, v72, s45
  v_perm_b32 v217, v75, v74, s45
  v_perm_b32 v218, v77, v76, s45
  v_perm_b32 v219, v79, v78, s45
  v_perm_b32 v156, v81, v80, s44
  v_perm_b32 v157, v83, v82, s44
  v_perm_b32 v158, v85, v84, s44
  v_perm_b32 v159, v87, v86, s44
  v_perm_b32 v220, v81, v80, s45
  v_perm_b32 v221, v83, v82, s45
  v_perm_b32 v222, v85, v84, s45
  v_perm_b32 v223, v87, v86, s45
  s_add_u32 s27, s26, 3670016
  buffer_load_dword v40, v21, s[8:11], s27 offen
  s_add_u32 s27, s26, 3678208
  buffer_load_dword v41, v21, s[8:11], s27 offen
  s_add_u32 s27, s26, 3686400
  buffer_load_dword v42, v21, s[8:11], s27 offen
  s_add_u32 s27, s26, 3694592
  buffer_load_dword v43, v21, s[8:11], s27 offen
  s_add_u32 s27, s26, 3702784
  buffer_load_dword v44, v21, s[8:11], s27 offen
  s_add_u32 s27, s26, 3710976
  buffer_load_dword v45, v21, s[8:11], s27 offen
  s_add_u32 s27, s26, 3719168
  buffer_load_dword v46, v21, s[8:11], s27 offen
  s_add_u32 s27, s26, 3727360
  buffer_load_dword v47, v21, s[8:11], s27 offen
  s_add_u32 s27, s26, 3932160
  buffer_load_dword v48, v21, s[8:11], s27 offen
  s_add_u32 s27, s26, 3940352
  buffer_load_dword v49, v21, s[8:11], s27 offen
  s_add_u32 s27, s26, 3948544
  buffer_load_dword v50, v21, s[8:11], s27 offen
  s_add_u32 s27, s26, 3956736
  buffer_load_dword v51, v21, s[8:11], s27 offen
  s_add_u32 s27, s26, 3964928
  buffer_load_dword v52, v21, s[8:11], s27 offen
  s_add_u32 s27, s26, 3973120
  buffer_load_dword v53, v21, s[8:11], s27 offen
  s_add_u32 s27, s26, 3981312
  buffer_load_dword v54, v21, s[8:11], s27 offen
  s_add_u32 s27, s26, 3989504
  buffer_load_dword v55, v21, s[8:11], s27 offen
  s_waitcnt vmcnt(48)
  v_perm_b32 v160, v89, v88, s44
  v_perm_b32 v161, v91, v90, s44
  v_perm_b32 v162, v93, v92, s44
  v_perm_b32 v163, v95, v94, s44
  v_perm_b32 v224, v89, v88, s45
  v_perm_b32 v225, v91, v90, s45
  v_perm_b32 v226, v93, v92, s45
  v_perm_b32 v227, v95, v94, s45
  v_perm_b32 v164, v97, v96, s44
  v_perm_b32 v165, v99, v98, s44
  v_perm_b32 v166, v101, v100, s44
  v_perm_b32 v167, v103, v102, s44
  v_perm_b32 v228, v97, v96, s45
  v_perm_b32 v229, v99, v98, s45
  v_perm_b32 v230, v101, v100, s45
  v_perm_b32 v231, v103, v102, s45
  s_load_dwordx2 s[8:9], s[0:1], 32
  s_waitcnt lgkmcnt(0)
  s_add_u32 s27, s26, 0
  buffer_load_dword v56, v21, s[8:11], s27 offen
  s_add_u32 s27, s26, 8192
  buffer_load_dword v57, v21, s[8:11], s27 offen
  s_add_u32 s27, s26, 16384
  buffer_load_dword v58, v21, s[8:11], s27 offen
  s_add_u32 s27, s26, 24576
  buffer_load_dword v59, v21, s[8:11], s27 offen
  s_add_u32 s27, s26, 32768
  buffer_load_dword v60, v21, s[8:11], s27 offen
  s_add_u32 s27, s26, 40960
  buffer_load_dword v61, v21, s[8:11], s27 offen
  s_add_u32 s27, s26, 49152
  buffer_load_dword v62, v21, s[8:11], s27 offen
  s_add_u32 s27, s26, 57344
  buffer_load_dword v63, v21, s[8:11], s27 offen
  s_add_u32 s27, s26, 262144
  buffer_load_dword v64, v21, s[8:11], s27 offen
  s_add_u32 s27, s26, 270336
  buffer_load_dword v65, v21, s[8:11], s27 offen
  s_add_u32 s27, s26, 278528
  buffer_load_dword v66, v21, s[8:11], s27 offen
  s_add_u32 s27, s26, 286720
  buffer_load_dword v67, v21, s[8:11], s27 offen
  s_add_u32 s27, s26, 294912
  buffer_load_dword v68, v21, s[8:11], s27 offen
  s_add_u32 s27, s26, 303104
  buffer_load_dword v69, v21, s[8:11], s27 offen
  s_add_u32 s27, s26, 311296
  buffer_load_dword v70, v21, s[8:11], s27 offen
  s_add_u32 s27, s26, 319488
  buffer_load_dword v71, v21, s[8:11], s27 offen
  s_waitcnt vmcnt(48)
  v_perm_b32 v168, v105, v104, s44
  v_perm_b32 v169, v107, v106, s44
  v_perm_b32 v170, v109, v108, s44
  v_perm_b32 v171, v111, v110, s44
  v_perm_b32 v232, v105, v104, s45
  v_perm_b32 v233, v107, v106, s45
  v_perm_b32 v234, v109, v108, s45
  v_perm_b32 v235, v111, v110, s45
  v_perm_b32 v172, v113, v112, s44
  v_perm_b32 v173, v115, v114, s44
  v_perm_b32 v174, v117, v116, s44
  v_perm_b32 v175, v119, v118, s44
  v_perm_b32 v236, v113, v112, s45
  v_perm_b32 v237, v115, v114, s45
  v_perm_b32 v238, v117, v116, s45
  v_perm_b32 v239, v119, v118, s45
  s_add_u32 s27, s26, 524288
  buffer_load_dword v72, v21, s[8:11], s27 offen
  s_add_u32 s27, s26, 532480
  buffer_load_dword v73, v21, s[8:11], s27 offen
  s_add_u32 s27, s26, 540672
  buffer_load_dword v74, v21, s[8:11], s27 offen
  s_add_u32 s27, s26, 548864
  buffer_load_dword v75, v21, s[8:11], s27 offen
  s_add_u32 s27, s26, 557056
  buffer_load_dword v76, v21, s[8:11], s27 offen
  s_add_u32 s27, s26, 565248
  buffer_load_dword v77, v21, s[8:11], s27 offen
  s_add_u32 s27, s26, 573440
  buffer_load_dword v78, v21, s[8:11], s27 offen
  s_add_u32 s27, s26, 581632
  buffer_load_dword v79, v21, s[8:11], s27 offen
  s_add_u32 s27, s26, 786432
  buffer_load_dword v80, v21, s[8:11], s27 offen
  s_add_u32 s27, s26, 794624
  buffer_load_dword v81, v21, s[8:11], s27 offen
  s_add_u32 s27, s26, 802816
  buffer_load_dword v82, v21, s[8:11], s27 offen
  s_add_u32 s27, s26, 811008
  buffer_load_dword v83, v21, s[8:11], s27 offen
  s_add_u32 s27, s26, 819200
  buffer_load_dword v84, v21, s[8:11], s27 offen
  s_add_u32 s27, s26, 827392
  buffer_load_dword v85, v21, s[8:11], s27 offen
  s_add_u32 s27, s26, 835584
  buffer_load_dword v86, v21, s[8:11], s27 offen
  s_add_u32 s27, s26, 843776
  buffer_load_dword v87, v21, s[8:11], s27 offen
  s_waitcnt vmcnt(48)
  v_perm_b32 v176, v25, v24, s44
  v_perm_b32 v177, v27, v26, s44
  v_perm_b32 v178, v29, v28, s44
  v_perm_b32 v179, v31, v30, s44
  v_perm_b32 v240, v25, v24, s45
  v_perm_b32 v241, v27, v26, s45
  v_perm_b32 v242, v29, v28, s45
  v_perm_b32 v243, v31, v30, s45
  v_perm_b32 v180, v33, v32, s44
  v_perm_b32 v181, v35, v34, s44
  v_perm_b32 v182, v37, v36, s44
  v_perm_b32 v183, v39, v38, s44
  v_perm_b32 v244, v33, v32, s45
  v_perm_b32 v245, v35, v34, s45
  v_perm_b32 v246, v37, v36, s45
  v_perm_b32 v247, v39, v38, s45
  s_add_u32 s27, s26, 1048576
  buffer_load_dword v88, v21, s[8:11], s27 offen
  s_add_u32 s27, s26, 1056768
  buffer_load_dword v89, v21, s[8:11], s27 offen
  s_add_u32 s27, s26, 1064960
  buffer_load_dword v90, v21, s[8:11], s27 offen
  s_add_u32 s27, s26, 1073152
  buffer_load_dword v91, v21, s[8:11], s27 offen
  s_add_u32 s27, s26, 1081344
  buffer_load_dword v92, v21, s[8:11], s27 offen
  s_add_u32 s27, s26, 1089536
  buffer_load_dword v93, v21, s[8:11], s27 offen
  s_add_u32 s27, s26, 1097728
  buffer_load_dword v94, v21, s[8:11], s27 offen
  s_add_u32 s27, s26, 1105920
  buffer_load_dword v95, v21, s[8:11], s27 offen
  s_add_u32 s27, s26, 1310720
  buffer_load_dword v96, v21, s[8:11], s27 offen
  s_add_u32 s27, s26, 1318912
  buffer_load_dword v97, v21, s[8:11], s27 offen
  s_add_u32 s27, s26, 1327104
  buffer_load_dword v98, v21, s[8:11], s27 offen
  s_add_u32 s27, s26, 1335296
  buffer_load_dword v99, v21, s[8:11], s27 offen
  s_add_u32 s27, s26, 1343488
  buffer_load_dword v100, v21, s[8:11], s27 offen
  s_add_u32 s27, s26, 1351680
  buffer_load_dword v101, v21, s[8:11], s27 offen
  s_add_u32 s27, s26, 1359872
  buffer_load_dword v102, v21, s[8:11], s27 offen
  s_add_u32 s27, s26, 1368064
  buffer_load_dword v103, v21, s[8:11], s27 offen
  s_waitcnt vmcnt(48)
  v_perm_b32 v184, v41, v40, s44
  v_perm_b32 v185, v43, v42, s44
  v_perm_b32 v186, v45, v44, s44
  v_perm_b32 v187, v47, v46, s44
  v_perm_b32 v248, v41, v40, s45
  v_perm_b32 v249, v43, v42, s45
  v_perm_b32 v250, v45, v44, s45
  v_perm_b32 v251, v47, v46, s45
  v_perm_b32 v188, v49, v48, s44
  v_perm_b32 v189, v51, v50, s44
  v_perm_b32 v190, v53, v52, s44
  v_perm_b32 v191, v55, v54, s44
  v_perm_b32 v252, v49, v48, s45
  v_perm_b32 v253, v51, v50, s45
  v_perm_b32 v254, v53, v52, s45
  v_perm_b32 v255, v55, v54, s45
  s_add_u32 s27, s26, 1572864
  buffer_load_dword v104, v21, s[8:11], s27 offen
  s_add_u32 s27, s26, 1581056
  buffer_load_dword v105, v21, s[8:11], s27 offen
  s_add_u32 s27, s26, 1589248
  buffer_load_dword v106, v21, s[8:11], s27 offen
  s_add_u32 s27, s26, 1597440
  buffer_load_dword v107, v21, s[8:11], s27 offen
  s_add_u32 s27, s26, 1605632
  buffer_load_dword v108, v21, s[8:11], s27 offen
  s_add_u32 s27, s26, 1613824
  buffer_load_dword v109, v21, s[8:11], s27 offen
  s_add_u32 s27, s26, 1622016
  buffer_load_dword v110, v21, s[8:11], s27 offen
  s_add_u32 s27, s26, 1630208
  buffer_load_dword v111, v21, s[8:11], s27 offen
  s_add_u32 s27, s26, 1835008
  buffer_load_dword v112, v21, s[8:11], s27 offen
  s_add_u32 s27, s26, 1843200
  buffer_load_dword v113, v21, s[8:11], s27 offen
  s_add_u32 s27, s26, 1851392
  buffer_load_dword v114, v21, s[8:11], s27 offen
  s_add_u32 s27, s26, 1859584
  buffer_load_dword v115, v21, s[8:11], s27 offen
  s_add_u32 s27, s26, 1867776
  buffer_load_dword v116, v21, s[8:11], s27 offen
  s_add_u32 s27, s26, 1875968
  buffer_load_dword v117, v21, s[8:11], s27 offen
  s_add_u32 s27, s26, 1884160
  buffer_load_dword v118, v21, s[8:11], s27 offen
  s_add_u32 s27, s26, 1892352
  buffer_load_dword v119, v21, s[8:11], s27 offen
  s_waitcnt vmcnt(48)
  v_perm_b32 v120, v57, v56, s44
  v_perm_b32 v121, v59, v58, s44
  v_perm_b32 v122, v61, v60, s44
  v_perm_b32 v123, v63, v62, s44
  v_accvgpr_write_b32 a0, v120
  v_accvgpr_write_b32 a1, v121
  v_accvgpr_write_b32 a2, v122
  v_accvgpr_write_b32 a3, v123
  v_perm_b32 v124, v57, v56, s45
  v_perm_b32 v125, v59, v58, s45
  v_perm_b32 v126, v61, v60, s45
  v_perm_b32 v127, v63, v62, s45
  v_accvgpr_write_b32 a64, v124
  v_accvgpr_write_b32 a65, v125
  v_accvgpr_write_b32 a66, v126
  v_accvgpr_write_b32 a67, v127
  v_perm_b32 v120, v65, v64, s44
  v_perm_b32 v121, v67, v66, s44
  v_perm_b32 v122, v69, v68, s44
  v_perm_b32 v123, v71, v70, s44
  v_accvgpr_write_b32 a4, v120
  v_accvgpr_write_b32 a5, v121
  v_accvgpr_write_b32 a6, v122
  v_accvgpr_write_b32 a7, v123
  v_perm_b32 v124, v65, v64, s45
  v_perm_b32 v125, v67, v66, s45
  v_perm_b32 v126, v69, v68, s45
  v_perm_b32 v127, v71, v70, s45
  v_accvgpr_write_b32 a68, v124
  v_accvgpr_write_b32 a69, v125
  v_accvgpr_write_b32 a70, v126
  v_accvgpr_write_b32 a71, v127
  s_add_u32 s27, s26, 2097152
  buffer_load_dword v24, v21, s[8:11], s27 offen
  s_add_u32 s27, s26, 2105344
  buffer_load_dword v25, v21, s[8:11], s27 offen
  s_add_u32 s27, s26, 2113536
  buffer_load_dword v26, v21, s[8:11], s27 offen
  s_add_u32 s27, s26, 2121728
  buffer_load_dword v27, v21, s[8:11], s27 offen
  s_add_u32 s27, s26, 2129920
  buffer_load_dword v28, v21, s[8:11], s27 offen
  s_add_u32 s27, s26, 2138112
  buffer_load_dword v29, v21, s[8:11], s27 offen
  s_add_u32 s27, s26, 2146304
  buffer_load_dword v30, v21, s[8:11], s27 offen
  s_add_u32 s27, s26, 2154496
  buffer_load_dword v31, v21, s[8:11], s27 offen
  s_add_u32 s27, s26, 2359296
  buffer_load_dword v32, v21, s[8:11], s27 offen
  s_add_u32 s27, s26, 2367488
  buffer_load_dword v33, v21, s[8:11], s27 offen
  s_add_u32 s27, s26, 2375680
  buffer_load_dword v34, v21, s[8:11], s27 offen
  s_add_u32 s27, s26, 2383872
  buffer_load_dword v35, v21, s[8:11], s27 offen
  s_add_u32 s27, s26, 2392064
  buffer_load_dword v36, v21, s[8:11], s27 offen
  s_add_u32 s27, s26, 2400256
  buffer_load_dword v37, v21, s[8:11], s27 offen
  s_add_u32 s27, s26, 2408448
  buffer_load_dword v38, v21, s[8:11], s27 offen
  s_add_u32 s27, s26, 2416640
  buffer_load_dword v39, v21, s[8:11], s27 offen
  s_waitcnt vmcnt(48)
  v_perm_b32 v120, v73, v72, s44
  v_perm_b32 v121, v75, v74, s44
  v_perm_b32 v122, v77, v76, s44
  v_perm_b32 v123, v79, v78, s44
  v_accvgpr_write_b32 a8, v120
  v_accvgpr_write_b32 a9, v121
  v_accvgpr_write_b32 a10, v122
  v_accvgpr_write_b32 a11, v123
  v_perm_b32 v124, v73, v72, s45
  v_perm_b32 v125, v75, v74, s45
  v_perm_b32 v126, v77, v76, s45
  v_perm_b32 v127, v79, v78, s45
  v_accvgpr_write_b32 a72, v124
  v_accvgpr_write_b32 a73, v125
  v_accvgpr_write_b32 a74, v126
  v_accvgpr_write_b32 a75, v127
  v_perm_b32 v120, v81, v80, s44
  v_perm_b32 v121, v83, v82, s44
  v_perm_b32 v122, v85, v84, s44
  v_perm_b32 v123, v87, v86, s44
  v_accvgpr_write_b32 a12, v120
  v_accvgpr_write_b32 a13, v121
  v_accvgpr_write_b32 a14, v122
  v_accvgpr_write_b32 a15, v123
  v_perm_b32 v124, v81, v80, s45
  v_perm_b32 v125, v83, v82, s45
  v_perm_b32 v126, v85, v84, s45
  v_perm_b32 v127, v87, v86, s45
  v_accvgpr_write_b32 a76, v124
  v_accvgpr_write_b32 a77, v125
  v_accvgpr_write_b32 a78, v126
  v_accvgpr_write_b32 a79, v127
  s_add_u32 s27, s26, 2621440
  buffer_load_dword v40, v21, s[8:11], s27 offen
  s_add_u32 s27, s26, 2629632
  buffer_load_dword v41, v21, s[8:11], s27 offen
  s_add_u32 s27, s26, 2637824
  buffer_load_dword v42, v21, s[8:11], s27 offen
  s_add_u32 s27, s26, 2646016
  buffer_load_dword v43, v21, s[8:11], s27 offen
  s_add_u32 s27, s26, 2654208
  buffer_load_dword v44, v21, s[8:11], s27 offen
  s_add_u32 s27, s26, 2662400
  buffer_load_dword v45, v21, s[8:11], s27 offen
  s_add_u32 s27, s26, 2670592
  buffer_load_dword v46, v21, s[8:11], s27 offen
  s_add_u32 s27, s26, 2678784
  buffer_load_dword v47, v21, s[8:11], s27 offen
  s_add_u32 s27, s26, 2883584
  buffer_load_dword v48, v21, s[8:11], s27 offen
  s_add_u32 s27, s26, 2891776
  buffer_load_dword v49, v21, s[8:11], s27 offen
  s_add_u32 s27, s26, 2899968
  buffer_load_dword v50, v21, s[8:11], s27 offen
  s_add_u32 s27, s26, 2908160
  buffer_load_dword v51, v21, s[8:11], s27 offen
  s_add_u32 s27, s26, 2916352
  buffer_load_dword v52, v21, s[8:11], s27 offen
  s_add_u32 s27, s26, 2924544
  buffer_load_dword v53, v21, s[8:11], s27 offen
  s_add_u32 s27, s26, 2932736
  buffer_load_dword v54, v21, s[8:11], s27 offen
  s_add_u32 s27, s26, 2940928
  buffer_load_dword v55, v21, s[8:11], s27 offen
  s_waitcnt vmcnt(48)
  v_perm_b32 v120, v89, v88, s44
  v_perm_b32 v121, v91, v90, s44
  v_perm_b32 v122, v93, v92, s44
  v_perm_b32 v123, v95, v94, s44
  v_accvgpr_write_b32 a16, v120
  v_accvgpr_write_b32 a17, v121
  v_accvgpr_write_b32 a18, v122
  v_accvgpr_write_b32 a19, v123
  v_perm_b32 v124, v89, v88, s45
  v_perm_b32 v125, v91, v90, s45
  v_perm_b32 v126, v93, v92, s45
  v_perm_b32 v127, v95, v94, s45
  v_accvgpr_write_b32 a80, v124
  v_accvgpr_write_b32 a81, v125
  v_accvgpr_write_b32 a82, v126
  v_accvgpr_write_b32 a83, v127
  v_perm_b32 v120, v97, v96, s44
  v_perm_b32 v121, v99, v98, s44
  v_perm_b32 v122, v101, v100, s44
  v_perm_b32 v123, v103, v102, s44
  v_accvgpr_write_b32 a20, v120
  v_accvgpr_write_b32 a21, v121
  v_accvgpr_write_b32 a22, v122
  v_accvgpr_write_b32 a23, v123
  v_perm_b32 v124, v97, v96, s45
  v_perm_b32 v125, v99, v98, s45
  v_perm_b32 v126, v101, v100, s45
  v_perm_b32 v127, v103, v102, s45
  v_accvgpr_write_b32 a84, v124
  v_accvgpr_write_b32 a85, v125
  v_accvgpr_write_b32 a86, v126
  v_accvgpr_write_b32 a87, v127
  s_add_u32 s27, s26, 3145728
  buffer_load_dword v56, v21, s[8:11], s27 offen
  s_add_u32 s27, s26, 3153920
  buffer_load_dword v57, v21, s[8:11], s27 offen
  s_add_u32 s27, s26, 3162112
  buffer_load_dword v58, v21, s[8:11], s27 offen
  s_add_u32 s27, s26, 3170304
  buffer_load_dword v59, v21, s[8:11], s27 offen
  s_add_u32 s27, s26, 3178496
  buffer_load_dword v60, v21, s[8:11], s27 offen
  s_add_u32 s27, s26, 3186688
  buffer_load_dword v61, v21, s[8:11], s27 offen
  s_add_u32 s27, s26, 3194880
  buffer_load_dword v62, v21, s[8:11], s27 offen
  s_add_u32 s27, s26, 3203072
  buffer_load_dword v63, v21, s[8:11], s27 offen
  s_add_u32 s27, s26, 3407872
  buffer_load_dword v64, v21, s[8:11], s27 offen
  s_add_u32 s27, s26, 3416064
  buffer_load_dword v65, v21, s[8:11], s27 offen
  s_add_u32 s27, s26, 3424256
  buffer_load_dword v66, v21, s[8:11], s27 offen
  s_add_u32 s27, s26, 3432448
  buffer_load_dword v67, v21, s[8:11], s27 offen
  s_add_u32 s27, s26, 3440640
  buffer_load_dword v68, v21, s[8:11], s27 offen
  s_add_u32 s27, s26, 3448832
  buffer_load_dword v69, v21, s[8:11], s27 offen
  s_add_u32 s27, s26, 3457024
  buffer_load_dword v70, v21, s[8:11], s27 offen
  s_add_u32 s27, s26, 3465216
  buffer_load_dword v71, v21, s[8:11], s27 offen
  s_waitcnt vmcnt(48)
  v_perm_b32 v120, v105, v104, s44
  v_perm_b32 v121, v107, v106, s44
  v_perm_b32 v122, v109, v108, s44
  v_perm_b32 v123, v111, v110, s44
  v_accvgpr_write_b32 a24, v120
  v_accvgpr_write_b32 a25, v121
  v_accvgpr_write_b32 a26, v122
  v_accvgpr_write_b32 a27, v123
  v_perm_b32 v124, v105, v104, s45
  v_perm_b32 v125, v107, v106, s45
  v_perm_b32 v126, v109, v108, s45
  v_perm_b32 v127, v111, v110, s45
  v_accvgpr_write_b32 a88, v124
  v_accvgpr_write_b32 a89, v125
  v_accvgpr_write_b32 a90, v126
  v_accvgpr_write_b32 a91, v127
  v_perm_b32 v120, v113, v112, s44
  v_perm_b32 v121, v115, v114, s44
  v_perm_b32 v122, v117, v116, s44
  v_perm_b32 v123, v119, v118, s44
  v_accvgpr_write_b32 a28, v120
  v_accvgpr_write_b32 a29, v121
  v_accvgpr_write_b32 a30, v122
  v_accvgpr_write_b32 a31, v123
  v_perm_b32 v124, v113, v112, s45
  v_perm_b32 v125, v115, v114, s45
  v_perm_b32 v126, v117, v116, s45
  v_perm_b32 v127, v119, v118, s45
  v_accvgpr_write_b32 a92, v124
  v_accvgpr_write_b32 a93, v125
  v_accvgpr_write_b32 a94, v126
  v_accvgpr_write_b32 a95, v127
  s_add_u32 s27, s26, 3670016
  buffer_load_dword v72, v21, s[8:11], s27 offen
  s_add_u32 s27, s26, 3678208
  buffer_load_dword v73, v21, s[8:11], s27 offen
  s_add_u32 s27, s26, 3686400
  buffer_load_dword v74, v21, s[8:11], s27 offen
  s_add_u32 s27, s26, 3694592
  buffer_load_dword v75, v21, s[8:11], s27 offen
  s_add_u32 s27, s26, 3702784
  buffer_load_dword v76, v21, s[8:11], s27 offen
  s_add_u32 s27, s26, 3710976
  buffer_load_dword v77, v21, s[8:11], s27 offen
  s_add_u32 s27, s26, 3719168
  buffer_load_dword v78, v21, s[8:11], s27 offen
  s_add_u32 s27, s26, 3727360
  buffer_load_dword v79, v21, s[8:11], s27 offen
  s_add_u32 s27, s26, 3932160
  buffer_load_dword v80, v21, s[8:11], s27 offen
  s_add_u32 s27, s26, 3940352
  buffer_load_dword v81, v21, s[8:11], s27 offen
  s_add_u32 s27, s26, 3948544
  buffer_load_dword v82, v21, s[8:11], s27 offen
  s_add_u32 s27, s26, 3956736
  buffer_load_dword v83, v21, s[8:11], s27 offen
  s_add_u32 s27, s26, 3964928
  buffer_load_dword v84, v21, s[8:11], s27 offen
  s_add_u32 s27, s26, 3973120
  buffer_load_dword v85, v21, s[8:11], s27 offen
  s_add_u32 s27, s26, 3981312
  buffer_load_dword v86, v21, s[8:11], s27 offen
  s_add_u32 s27, s26, 3989504
  buffer_load_dword v87, v21, s[8:11], s27 offen
  s_waitcnt vmcnt(48)
  v_perm_b32 v120, v25, v24, s44
  v_perm_b32 v121, v27, v26, s44
  v_perm_b32 v122, v29, v28, s44
  v_perm_b32 v123, v31, v30, s44
  v_accvgpr_write_b32 a32, v120
  v_accvgpr_write_b32 a33, v121
  v_accvgpr_write_b32 a34, v122
  v_accvgpr_write_b32 a35, v123
  v_perm_b32 v124, v25, v24, s45
  v_perm_b32 v125, v27, v26, s45
  v_perm_b32 v126, v29, v28, s45
  v_perm_b32 v127, v31, v30, s45
  v_accvgpr_write_b32 a96, v124
  v_accvgpr_write_b32 a97, v125
  v_accvgpr_write_b32 a98, v126
  v_accvgpr_write_b32 a99, v127
  v_perm_b32 v120, v33, v32, s44
  v_perm_b32 v121, v35, v34, s44
  v_perm_b32 v122, v37, v36, s44
  v_perm_b32 v123, v39, v38, s44
  v_accvgpr_write_b32 a36, v120
  v_accvgpr_write_b32 a37, v121
  v_accvgpr_write_b32 a38, v122
  v_accvgpr_write_b32 a39, v123
  v_perm_b32 v124, v33, v32, s45
  v_perm_b32 v125, v35, v34, s45
  v_perm_b32 v126, v37, v36, s45
  v_perm_b32 v127, v39, v38, s45
  v_accvgpr_write_b32 a100, v124
  v_accvgpr_write_b32 a101, v125
  v_accvgpr_write_b32 a102, v126
  v_accvgpr_write_b32 a103, v127
  s_load_dwordx2 s[8:9], s[0:1], 16
  s_waitcnt lgkmcnt(0)
  s_add_u32 s27, s26, 0
  buffer_load_dword v88, v21, s[8:11], s27 offen
  s_add_u32 s27, s26, 8192
  buffer_load_dword v89, v21, s[8:11], s27 offen
  s_add_u32 s27, s26, 16384
  buffer_load_dword v90, v21, s[8:11], s27 offen
  s_add_u32 s27, s26, 24576
  buffer_load_dword v91, v21, s[8:11], s27 offen
  s_add_u32 s27, s26, 32768
  buffer_load_dword v92, v21, s[8:11], s27 offen
  s_add_u32 s27, s26, 40960
  buffer_load_dword v93, v21, s[8:11], s27 offen
  s_add_u32 s27, s26, 49152
  buffer_load_dword v94, v21, s[8:11], s27 offen
  s_add_u32 s27, s26, 57344
  buffer_load_dword v95, v21, s[8:11], s27 offen
  s_add_u32 s27, s26, 262144
  buffer_load_dword v96, v21, s[8:11], s27 offen
  s_add_u32 s27, s26, 270336
  buffer_load_dword v97, v21, s[8:11], s27 offen
  s_add_u32 s27, s26, 278528
  buffer_load_dword v98, v21, s[8:11], s27 offen
  s_add_u32 s27, s26, 286720
  buffer_load_dword v99, v21, s[8:11], s27 offen
  s_add_u32 s27, s26, 294912
  buffer_load_dword v100, v21, s[8:11], s27 offen
  s_add_u32 s27, s26, 303104
  buffer_load_dword v101, v21, s[8:11], s27 offen
  s_add_u32 s27, s26, 311296
  buffer_load_dword v102, v21, s[8:11], s27 offen
  s_add_u32 s27, s26, 319488
  buffer_load_dword v103, v21, s[8:11], s27 offen
  s_waitcnt vmcnt(48)
  v_perm_b32 v120, v41, v40, s44
  v_perm_b32 v121, v43, v42, s44
  v_perm_b32 v122, v45, v44, s44
  v_perm_b32 v123, v47, v46, s44
  v_accvgpr_write_b32 a40, v120
  v_accvgpr_write_b32 a41, v121
  v_accvgpr_write_b32 a42, v122
  v_accvgpr_write_b32 a43, v123
  v_perm_b32 v124, v41, v40, s45
  v_perm_b32 v125, v43, v42, s45
  v_perm_b32 v126, v45, v44, s45
  v_perm_b32 v127, v47, v46, s45
  v_accvgpr_write_b32 a104, v124
  v_accvgpr_write_b32 a105, v125
  v_accvgpr_write_b32 a106, v126
  v_accvgpr_write_b32 a107, v127
  v_perm_b32 v120, v49, v48, s44
  v_perm_b32 v121, v51, v50, s44
  v_perm_b32 v122, v53, v52, s44
  v_perm_b32 v123, v55, v54, s44
  v_accvgpr_write_b32 a44, v120
  v_accvgpr_write_b32 a45, v121
  v_accvgpr_write_b32 a46, v122
  v_accvgpr_write_b32 a47, v123
  v_perm_b32 v124, v49, v48, s45
  v_perm_b32 v125, v51, v50, s45
  v_perm_b32 v126, v53, v52, s45
  v_perm_b32 v127, v55, v54, s45
  v_accvgpr_write_b32 a108, v124
  v_accvgpr_write_b32 a109, v125
  v_accvgpr_write_b32 a110, v126
  v_accvgpr_write_b32 a111, v127
  s_add_u32 s27, s26, 524288
  buffer_load_dword v104, v21, s[8:11], s27 offen
  s_add_u32 s27, s26, 532480
  buffer_load_dword v105, v21, s[8:11], s27 offen
  s_add_u32 s27, s26, 540672
  buffer_load_dword v106, v21, s[8:11], s27 offen
  s_add_u32 s27, s26, 548864
  buffer_load_dword v107, v21, s[8:11], s27 offen
  s_add_u32 s27, s26, 557056
  buffer_load_dword v108, v21, s[8:11], s27 offen
  s_add_u32 s27, s26, 565248
  buffer_load_dword v109, v21, s[8:11], s27 offen
  s_add_u32 s27, s26, 573440
  buffer_load_dword v110, v21, s[8:11], s27 offen
  s_add_u32 s27, s26, 581632
  buffer_load_dword v111, v21, s[8:11], s27 offen
  s_add_u32 s27, s26, 786432
  buffer_load_dword v112, v21, s[8:11], s27 offen
  s_add_u32 s27, s26, 794624
  buffer_load_dword v113, v21, s[8:11], s27 offen
  s_add_u32 s27, s26, 802816
  buffer_load_dword v114, v21, s[8:11], s27 offen
  s_add_u32 s27, s26, 811008
  buffer_load_dword v115, v21, s[8:11], s27 offen
  s_add_u32 s27, s26, 819200
  buffer_load_dword v116, v21, s[8:11], s27 offen
  s_add_u32 s27, s26, 827392
  buffer_load_dword v117, v21, s[8:11], s27 offen
  s_add_u32 s27, s26, 835584
  buffer_load_dword v118, v21, s[8:11], s27 offen
  s_add_u32 s27, s26, 843776
  buffer_load_dword v119, v21, s[8:11], s27 offen
  s_waitcnt vmcnt(48)
  v_perm_b32 v120, v57, v56, s44
  v_perm_b32 v121, v59, v58, s44
  v_perm_b32 v122, v61, v60, s44
  v_perm_b32 v123, v63, v62, s44
  v_accvgpr_write_b32 a48, v120
  v_accvgpr_write_b32 a49, v121
  v_accvgpr_write_b32 a50, v122
  v_accvgpr_write_b32 a51, v123
  v_perm_b32 v124, v57, v56, s45
  v_perm_b32 v125, v59, v58, s45
  v_perm_b32 v126, v61, v60, s45
  v_perm_b32 v127, v63, v62, s45
  v_accvgpr_write_b32 a112, v124
  v_accvgpr_write_b32 a113, v125
  v_accvgpr_write_b32 a114, v126
  v_accvgpr_write_b32 a115, v127
  v_perm_b32 v120, v65, v64, s44
  v_perm_b32 v121, v67, v66, s44
  v_perm_b32 v122, v69, v68, s44
  v_perm_b32 v123, v71, v70, s44
  v_accvgpr_write_b32 a52, v120
  v_accvgpr_write_b32 a53, v121
  v_accvgpr_write_b32 a54, v122
  v_accvgpr_write_b32 a55, v123
  v_perm_b32 v124, v65, v64, s45
  v_perm_b32 v125, v67, v66, s45
  v_perm_b32 v126, v69, v68, s45
  v_perm_b32 v127, v71, v70, s45
  v_accvgpr_write_b32 a116, v124
  v_accvgpr_write_b32 a117, v125
  v_accvgpr_write_b32 a118, v126
  v_accvgpr_write_b32 a119, v127
  s_add_u32 s27, s26, 1048576
  buffer_load_dword v24, v21, s[8:11], s27 offen
  s_add_u32 s27, s26, 1056768
  buffer_load_dword v25, v21, s[8:11], s27 offen
  s_add_u32 s27, s26, 1064960
  buffer_load_dword v26, v21, s[8:11], s27 offen
  s_add_u32 s27, s26, 1073152
  buffer_load_dword v27, v21, s[8:11], s27 offen
  s_add_u32 s27, s26, 1081344
  buffer_load_dword v28, v21, s[8:11], s27 offen
  s_add_u32 s27, s26, 1089536
  buffer_load_dword v29, v21, s[8:11], s27 offen
  s_add_u32 s27, s26, 1097728
  buffer_load_dword v30, v21, s[8:11], s27 offen
  s_add_u32 s27, s26, 1105920
  buffer_load_dword v31, v21, s[8:11], s27 offen
  s_add_u32 s27, s26, 1310720
  buffer_load_dword v32, v21, s[8:11], s27 offen
  s_add_u32 s27, s26, 1318912
  buffer_load_dword v33, v21, s[8:11], s27 offen
  s_add_u32 s27, s26, 1327104
  buffer_load_dword v34, v21, s[8:11], s27 offen
  s_add_u32 s27, s26, 1335296
  buffer_load_dword v35, v21, s[8:11], s27 offen
  s_add_u32 s27, s26, 1343488
  buffer_load_dword v36, v21, s[8:11], s27 offen
  s_add_u32 s27, s26, 1351680
  buffer_load_dword v37, v21, s[8:11], s27 offen
  s_add_u32 s27, s26, 1359872
  buffer_load_dword v38, v21, s[8:11], s27 offen
  s_add_u32 s27, s26, 1368064
  buffer_load_dword v39, v21, s[8:11], s27 offen
  s_waitcnt vmcnt(48)
  v_perm_b32 v120, v73, v72, s44
  v_perm_b32 v121, v75, v74, s44
  v_perm_b32 v122, v77, v76, s44
  v_perm_b32 v123, v79, v78, s44
  v_accvgpr_write_b32 a56, v120
  v_accvgpr_write_b32 a57, v121
  v_accvgpr_write_b32 a58, v122
  v_accvgpr_write_b32 a59, v123
  v_perm_b32 v124, v73, v72, s45
  v_perm_b32 v125, v75, v74, s45
  v_perm_b32 v126, v77, v76, s45
  v_perm_b32 v127, v79, v78, s45
  v_accvgpr_write_b32 a120, v124
  v_accvgpr_write_b32 a121, v125
  v_accvgpr_write_b32 a122, v126
  v_accvgpr_write_b32 a123, v127
  v_perm_b32 v120, v81, v80, s44
  v_perm_b32 v121, v83, v82, s44
  v_perm_b32 v122, v85, v84, s44
  v_perm_b32 v123, v87, v86, s44
  v_accvgpr_write_b32 a60, v120
  v_accvgpr_write_b32 a61, v121
  v_accvgpr_write_b32 a62, v122
  v_accvgpr_write_b32 a63, v123
  v_perm_b32 v124, v81, v80, s45
  v_perm_b32 v125, v83, v82, s45
  v_perm_b32 v126, v85, v84, s45
  v_perm_b32 v127, v87, v86, s45
  v_accvgpr_write_b32 a124, v124
  v_accvgpr_write_b32 a125, v125
  v_accvgpr_write_b32 a126, v126
  v_accvgpr_write_b32 a127, v127
  s_add_u32 s27, s26, 1572864
  buffer_load_dword v40, v21, s[8:11], s27 offen
  s_add_u32 s27, s26, 1581056
  buffer_load_dword v41, v21, s[8:11], s27 offen
  s_add_u32 s27, s26, 1589248
  buffer_load_dword v42, v21, s[8:11], s27 offen
  s_add_u32 s27, s26, 1597440
  buffer_load_dword v43, v21, s[8:11], s27 offen
  s_add_u32 s27, s26, 1605632
  buffer_load_dword v44, v21, s[8:11], s27 offen
  s_add_u32 s27, s26, 1613824
  buffer_load_dword v45, v21, s[8:11], s27 offen
  s_add_u32 s27, s26, 1622016
  buffer_load_dword v46, v21, s[8:11], s27 offen
  s_add_u32 s27, s26, 1630208
  buffer_load_dword v47, v21, s[8:11], s27 offen
  s_add_u32 s27, s26, 1835008
  buffer_load_dword v48, v21, s[8:11], s27 offen
  s_add_u32 s27, s26, 1843200
  buffer_load_dword v49, v21, s[8:11], s27 offen
  s_add_u32 s27, s26, 1851392
  buffer_load_dword v50, v21, s[8:11], s27 offen
  s_add_u32 s27, s26, 1859584
  buffer_load_dword v51, v21, s[8:11], s27 offen
  s_add_u32 s27, s26, 1867776
  buffer_load_dword v52, v21, s[8:11], s27 offen
  s_add_u32 s27, s26, 1875968
  buffer_load_dword v53, v21, s[8:11], s27 offen
  s_add_u32 s27, s26, 1884160
  buffer_load_dword v54, v21, s[8:11], s27 offen
  s_add_u32 s27, s26, 1892352
  buffer_load_dword v55, v21, s[8:11], s27 offen
  s_waitcnt vmcnt(48)
  v_perm_b32 v120, v89, v88, s44
  v_perm_b32 v121, v91, v90, s44
  v_perm_b32 v122, v93, v92, s44
  v_perm_b32 v123, v95, v94, s44
  v_accvgpr_write_b32 a128, v120
  v_accvgpr_write_b32 a129, v121
  v_accvgpr_write_b32 a130, v122
  v_accvgpr_write_b32 a131, v123
  v_perm_b32 v124, v89, v88, s45
  v_perm_b32 v125, v91, v90, s45
  v_perm_b32 v126, v93, v92, s45
  v_perm_b32 v127, v95, v94, s45
  v_accvgpr_write_b32 a192, v124
  v_accvgpr_write_b32 a193, v125
  v_accvgpr_write_b32 a194, v126
  v_accvgpr_write_b32 a195, v127
  v_perm_b32 v120, v97, v96, s44
  v_perm_b32 v121, v99, v98, s44
  v_perm_b32 v122, v101, v100, s44
  v_perm_b32 v123, v103, v102, s44
  v_accvgpr_write_b32 a132, v120
  v_accvgpr_write_b32 a133, v121
  v_accvgpr_write_b32 a134, v122
  v_accvgpr_write_b32 a135, v123
  v_perm_b32 v124, v97, v96, s45
  v_perm_b32 v125, v99, v98, s45
  v_perm_b32 v126, v101, v100, s45
  v_perm_b32 v127, v103, v102, s45
  v_accvgpr_write_b32 a196, v124
  v_accvgpr_write_b32 a197, v125
  v_accvgpr_write_b32 a198, v126
  v_accvgpr_write_b32 a199, v127
  s_add_u32 s27, s26, 2097152
  buffer_load_dword v56, v21, s[8:11], s27 offen
  s_add_u32 s27, s26, 2105344
  buffer_load_dword v57, v21, s[8:11], s27 offen
  s_add_u32 s27, s26, 2113536
  buffer_load_dword v58, v21, s[8:11], s27 offen
  s_add_u32 s27, s26, 2121728
  buffer_load_dword v59, v21, s[8:11], s27 offen
  s_add_u32 s27, s26, 2129920
  buffer_load_dword v60, v21, s[8:11], s27 offen
  s_add_u32 s27, s26, 2138112
  buffer_load_dword v61, v21, s[8:11], s27 offen
  s_add_u32 s27, s26, 2146304
  buffer_load_dword v62, v21, s[8:11], s27 offen
  s_add_u32 s27, s26, 2154496
  buffer_load_dword v63, v21, s[8:11], s27 offen
  s_add_u32 s27, s26, 2359296
  buffer_load_dword v64, v21, s[8:11], s27 offen
  s_add_u32 s27, s26, 2367488
  buffer_load_dword v65, v21, s[8:11], s27 offen
  s_add_u32 s27, s26, 2375680
  buffer_load_dword v66, v21, s[8:11], s27 offen
  s_add_u32 s27, s26, 2383872
  buffer_load_dword v67, v21, s[8:11], s27 offen
  s_add_u32 s27, s26, 2392064
  buffer_load_dword v68, v21, s[8:11], s27 offen
  s_add_u32 s27, s26, 2400256
  buffer_load_dword v69, v21, s[8:11], s27 offen
  s_add_u32 s27, s26, 2408448
  buffer_load_dword v70, v21, s[8:11], s27 offen
  s_add_u32 s27, s26, 2416640
  buffer_load_dword v71, v21, s[8:11], s27 offen
  s_waitcnt vmcnt(48)
  v_perm_b32 v120, v105, v104, s44
  v_perm_b32 v121, v107, v106, s44
  v_perm_b32 v122, v109, v108, s44
  v_perm_b32 v123, v111, v110, s44
  v_accvgpr_write_b32 a136, v120
  v_accvgpr_write_b32 a137, v121
  v_accvgpr_write_b32 a138, v122
  v_accvgpr_write_b32 a139, v123
  v_perm_b32 v124, v105, v104, s45
  v_perm_b32 v125, v107, v106, s45
  v_perm_b32 v126, v109, v108, s45
  v_perm_b32 v127, v111, v110, s45
  v_accvgpr_write_b32 a200, v124
  v_accvgpr_write_b32 a201, v125
  v_accvgpr_write_b32 a202, v126
  v_accvgpr_write_b32 a203, v127
  v_perm_b32 v120, v113, v112, s44
  v_perm_b32 v121, v115, v114, s44
  v_perm_b32 v122, v117, v116, s44
  v_perm_b32 v123, v119, v118, s44
  v_accvgpr_write_b32 a140, v120
  v_accvgpr_write_b32 a141, v121
  v_accvgpr_write_b32 a142, v122
  v_accvgpr_write_b32 a143, v123
  v_perm_b32 v124, v113, v112, s45
  v_perm_b32 v125, v115, v114, s45
  v_perm_b32 v126, v117, v116, s45
  v_perm_b32 v127, v119, v118, s45
  v_accvgpr_write_b32 a204, v124
  v_accvgpr_write_b32 a205, v125
  v_accvgpr_write_b32 a206, v126
  v_accvgpr_write_b32 a207, v127
  s_add_u32 s27, s26, 2621440
  buffer_load_dword v72, v21, s[8:11], s27 offen
  s_add_u32 s27, s26, 2629632
  buffer_load_dword v73, v21, s[8:11], s27 offen
  s_add_u32 s27, s26, 2637824
  buffer_load_dword v74, v21, s[8:11], s27 offen
  s_add_u32 s27, s26, 2646016
  buffer_load_dword v75, v21, s[8:11], s27 offen
  s_add_u32 s27, s26, 2654208
  buffer_load_dword v76, v21, s[8:11], s27 offen
  s_add_u32 s27, s26, 2662400
  buffer_load_dword v77, v21, s[8:11], s27 offen
  s_add_u32 s27, s26, 2670592
  buffer_load_dword v78, v21, s[8:11], s27 offen
  s_add_u32 s27, s26, 2678784
  buffer_load_dword v79, v21, s[8:11], s27 offen
  s_add_u32 s27, s26, 2883584
  buffer_load_dword v80, v21, s[8:11], s27 offen
  s_add_u32 s27, s26, 2891776
  buffer_load_dword v81, v21, s[8:11], s27 offen
  s_add_u32 s27, s26, 2899968
  buffer_load_dword v82, v21, s[8:11], s27 offen
  s_add_u32 s27, s26, 2908160
  buffer_load_dword v83, v21, s[8:11], s27 offen
  s_add_u32 s27, s26, 2916352
  buffer_load_dword v84, v21, s[8:11], s27 offen
  s_add_u32 s27, s26, 2924544
  buffer_load_dword v85, v21, s[8:11], s27 offen
  s_add_u32 s27, s26, 2932736
  buffer_load_dword v86, v21, s[8:11], s27 offen
  s_add_u32 s27, s26, 2940928
  buffer_load_dword v87, v21, s[8:11], s27 offen
  s_waitcnt vmcnt(48)
  v_perm_b32 v120, v25, v24, s44
  v_perm_b32 v121, v27, v26, s44
  v_perm_b32 v122, v29, v28, s44
  v_perm_b32 v123, v31, v30, s44
  v_accvgpr_write_b32 a144, v120
  v_accvgpr_write_b32 a145, v121
  v_accvgpr_write_b32 a146, v122
  v_accvgpr_write_b32 a147, v123
  v_perm_b32 v124, v25, v24, s45
  v_perm_b32 v125, v27, v26, s45
  v_perm_b32 v126, v29, v28, s45
  v_perm_b32 v127, v31, v30, s45
  v_accvgpr_write_b32 a208, v124
  v_accvgpr_write_b32 a209, v125
  v_accvgpr_write_b32 a210, v126
  v_accvgpr_write_b32 a211, v127
  v_perm_b32 v120, v33, v32, s44
  v_perm_b32 v121, v35, v34, s44
  v_perm_b32 v122, v37, v36, s44
  v_perm_b32 v123, v39, v38, s44
  v_accvgpr_write_b32 a148, v120
  v_accvgpr_write_b32 a149, v121
  v_accvgpr_write_b32 a150, v122
  v_accvgpr_write_b32 a151, v123
  v_perm_b32 v124, v33, v32, s45
  v_perm_b32 v125, v35, v34, s45
  v_perm_b32 v126, v37, v36, s45
  v_perm_b32 v127, v39, v38, s45
  v_accvgpr_write_b32 a212, v124
  v_accvgpr_write_b32 a213, v125
  v_accvgpr_write_b32 a214, v126
  v_accvgpr_write_b32 a215, v127
  s_add_u32 s27, s26, 3145728
  buffer_load_dword v88, v21, s[8:11], s27 offen
  s_add_u32 s27, s26, 3153920
  buffer_load_dword v89, v21, s[8:11], s27 offen
  s_add_u32 s27, s26, 3162112
  buffer_load_dword v90, v21, s[8:11], s27 offen
  s_add_u32 s27, s26, 3170304
  buffer_load_dword v91, v21, s[8:11], s27 offen
  s_add_u32 s27, s26, 3178496
  buffer_load_dword v92, v21, s[8:11], s27 offen
  s_add_u32 s27, s26, 3186688
  buffer_load_dword v93, v21, s[8:11], s27 offen
  s_add_u32 s27, s26, 3194880
  buffer_load_dword v94, v21, s[8:11], s27 offen
  s_add_u32 s27, s26, 3203072
  buffer_load_dword v95, v21, s[8:11], s27 offen
  s_add_u32 s27, s26, 3407872
  buffer_load_dword v96, v21, s[8:11], s27 offen
  s_add_u32 s27, s26, 3416064
  buffer_load_dword v97, v21, s[8:11], s27 offen
  s_add_u32 s27, s26, 3424256
  buffer_load_dword v98, v21, s[8:11], s27 offen
  s_add_u32 s27, s26, 3432448
  buffer_load_dword v99, v21, s[8:11], s27 offen
  s_add_u32 s27, s26, 3440640
  buffer_load_dword v100, v21, s[8:11], s27 offen
  s_add_u32 s27, s26, 3448832
  buffer_load_dword v101, v21, s[8:11], s27 offen
  s_add_u32 s27, s26, 3457024
  buffer_load_dword v102, v21, s[8:11], s27 offen
  s_add_u32 s27, s26, 3465216
  buffer_load_dword v103, v21, s[8:11], s27 offen
  s_waitcnt vmcnt(48)
  v_perm_b32 v120, v41, v40, s44
  v_perm_b32 v121, v43, v42, s44
  v_perm_b32 v122, v45, v44, s44
  v_perm_b32 v123, v47, v46, s44
  v_accvgpr_write_b32 a152, v120
  v_accvgpr_write_b32 a153, v121
  v_accvgpr_write_b32 a154, v122
  v_accvgpr_write_b32 a155, v123
  v_perm_b32 v124, v41, v40, s45
  v_perm_b32 v125, v43, v42, s45
  v_perm_b32 v126, v45, v44, s45
  v_perm_b32 v127, v47, v46, s45
  v_accvgpr_write_b32 a216, v124
  v_accvgpr_write_b32 a217, v125
  v_accvgpr_write_b32 a218, v126
  v_accvgpr_write_b32 a219, v127
  v_perm_b32 v120, v49, v48, s44
  v_perm_b32 v121, v51, v50, s44
  v_perm_b32 v122, v53, v52, s44
  v_perm_b32 v123, v55, v54, s44
  v_accvgpr_write_b32 a156, v120
  v_accvgpr_write_b32 a157, v121
  v_accvgpr_write_b32 a158, v122
  v_accvgpr_write_b32 a159, v123
  v_perm_b32 v124, v49, v48, s45
  v_perm_b32 v125, v51, v50, s45
  v_perm_b32 v126, v53, v52, s45
  v_perm_b32 v127, v55, v54, s45
  v_accvgpr_write_b32 a220, v124
  v_accvgpr_write_b32 a221, v125
  v_accvgpr_write_b32 a222, v126
  v_accvgpr_write_b32 a223, v127
  s_add_u32 s27, s26, 3670016
  buffer_load_dword v104, v21, s[8:11], s27 offen
  s_add_u32 s27, s26, 3678208
  buffer_load_dword v105, v21, s[8:11], s27 offen
  s_add_u32 s27, s26, 3686400
  buffer_load_dword v106, v21, s[8:11], s27 offen
  s_add_u32 s27, s26, 3694592
  buffer_load_dword v107, v21, s[8:11], s27 offen
  s_add_u32 s27, s26, 3702784
  buffer_load_dword v108, v21, s[8:11], s27 offen
  s_add_u32 s27, s26, 3710976
  buffer_load_dword v109, v21, s[8:11], s27 offen
  s_add_u32 s27, s26, 3719168
  buffer_load_dword v110, v21, s[8:11], s27 offen
  s_add_u32 s27, s26, 3727360
  buffer_load_dword v111, v21, s[8:11], s27 offen
  s_add_u32 s27, s26, 3932160
  buffer_load_dword v112, v21, s[8:11], s27 offen
  s_add_u32 s27, s26, 3940352
  buffer_load_dword v113, v21, s[8:11], s27 offen
  s_add_u32 s27, s26, 3948544
  buffer_load_dword v114, v21, s[8:11], s27 offen
  s_add_u32 s27, s26, 3956736
  buffer_load_dword v115, v21, s[8:11], s27 offen
  s_add_u32 s27, s26, 3964928
  buffer_load_dword v116, v21, s[8:11], s27 offen
  s_add_u32 s27, s26, 3973120
  buffer_load_dword v117, v21, s[8:11], s27 offen
  s_add_u32 s27, s26, 3981312
  buffer_load_dword v118, v21, s[8:11], s27 offen
  s_add_u32 s27, s26, 3989504
  buffer_load_dword v119, v21, s[8:11], s27 offen
  s_waitcnt vmcnt(48)
  v_perm_b32 v120, v57, v56, s44
  v_perm_b32 v121, v59, v58, s44
  v_perm_b32 v122, v61, v60, s44
  v_perm_b32 v123, v63, v62, s44
  v_accvgpr_write_b32 a160, v120
  v_accvgpr_write_b32 a161, v121
  v_accvgpr_write_b32 a162, v122
  v_accvgpr_write_b32 a163, v123
  v_perm_b32 v124, v57, v56, s45
  v_perm_b32 v125, v59, v58, s45
  v_perm_b32 v126, v61, v60, s45
  v_perm_b32 v127, v63, v62, s45
  v_accvgpr_write_b32 a224, v124
  v_accvgpr_write_b32 a225, v125
  v_accvgpr_write_b32 a226, v126
  v_accvgpr_write_b32 a227, v127
  v_perm_b32 v120, v65, v64, s44
  v_perm_b32 v121, v67, v66, s44
  v_perm_b32 v122, v69, v68, s44
  v_perm_b32 v123, v71, v70, s44
  v_accvgpr_write_b32 a164, v120
  v_accvgpr_write_b32 a165, v121
  v_accvgpr_write_b32 a166, v122
  v_accvgpr_write_b32 a167, v123
  v_perm_b32 v124, v65, v64, s45
  v_perm_b32 v125, v67, v66, s45
  v_perm_b32 v126, v69, v68, s45
  v_perm_b32 v127, v71, v70, s45
  v_accvgpr_write_b32 a228, v124
  v_accvgpr_write_b32 a229, v125
  v_accvgpr_write_b32 a230, v126
  v_accvgpr_write_b32 a231, v127
  s_waitcnt vmcnt(32)
  v_perm_b32 v120, v73, v72, s44
  v_perm_b32 v121, v75, v74, s44
  v_perm_b32 v122, v77, v76, s44
  v_perm_b32 v123, v79, v78, s44
  v_accvgpr_write_b32 a168, v120
  v_accvgpr_write_b32 a169, v121
  v_accvgpr_write_b32 a170, v122
  v_accvgpr_write_b32 a171, v123
  v_perm_b32 v124, v73, v72, s45
  v_perm_b32 v125, v75, v74, s45
  v_perm_b32 v126, v77, v76, s45
  v_perm_b32 v127, v79, v78, s45
  v_accvgpr_write_b32 a232, v124
  v_accvgpr_write_b32 a233, v125
  v_accvgpr_write_b32 a234, v126
  v_accvgpr_write_b32 a235, v127
  v_perm_b32 v120, v81, v80, s44
  v_perm_b32 v121, v83, v82, s44
  v_perm_b32 v122, v85, v84, s44
  v_perm_b32 v123, v87, v86, s44
  v_accvgpr_write_b32 a172, v120
  v_accvgpr_write_b32 a173, v121
  v_accvgpr_write_b32 a174, v122
  v_accvgpr_write_b32 a175, v123
  v_perm_b32 v124, v81, v80, s45
  v_perm_b32 v125, v83, v82, s45
  v_perm_b32 v126, v85, v84, s45
  v_perm_b32 v127, v87, v86, s45
  v_accvgpr_write_b32 a236, v124
  v_accvgpr_write_b32 a237, v125
  v_accvgpr_write_b32 a238, v126
  v_accvgpr_write_b32 a239, v127
  s_waitcnt vmcnt(16)
  v_perm_b32 v120, v89, v88, s44
  v_perm_b32 v121, v91, v90, s44
  v_perm_b32 v122, v93, v92, s44
  v_perm_b32 v123, v95, v94, s44
  v_accvgpr_write_b32 a176, v120
  v_accvgpr_write_b32 a177, v121
  v_accvgpr_write_b32 a178, v122
  v_accvgpr_write_b32 a179, v123
  v_perm_b32 v124, v89, v88, s45
  v_perm_b32 v125, v91, v90, s45
  v_perm_b32 v126, v93, v92, s45
  v_perm_b32 v127, v95, v94, s45
  v_accvgpr_write_b32 a240, v124
  v_accvgpr_write_b32 a241, v125
  v_accvgpr_write_b32 a242, v126
  v_accvgpr_write_b32 a243, v127
  v_perm_b32 v120, v97, v96, s44
  v_perm_b32 v121, v99, v98, s44
  v_perm_b32 v122, v101, v100, s44
  v_perm_b32 v123, v103, v102, s44
  v_accvgpr_write_b32 a180, v120
  v_accvgpr_write_b32 a181, v121
  v_accvgpr_write_b32 a182, v122
  v_accvgpr_write_b32 a183, v123
  v_perm_b32 v124, v97, v96, s45
  v_perm_b32 v125, v99, v98, s45
  v_perm_b32 v126, v101, v100, s45
  v_perm_b32 v127, v103, v102, s45
  v_accvgpr_write_b32 a244, v124
  v_accvgpr_write_b32 a245, v125
  v_accvgpr_write_b32 a246, v126
  v_accvgpr_write_b32 a247, v127
  s_waitcnt vmcnt(0)
  v_perm_b32 v120, v105, v104, s44
  v_perm_b32 v121, v107, v106, s44
  v_perm_b32 v122, v109, v108, s44
  v_perm_b32 v123, v111, v110, s44
  v_accvgpr_write_b32 a184, v120
  v_accvgpr_write_b32 a185, v121
  v_accvgpr_write_b32 a186, v122
  v_accvgpr_write_b32 a187, v123
  v_perm_b32 v124, v105, v104, s45
  v_perm_b32 v125, v107, v106, s45
  v_perm_b32 v126, v109, v108, s45
  v_perm_b32 v127, v111, v110, s45
  v_accvgpr_write_b32 a248, v124
  v_accvgpr_write_b32 a249, v125
  v_accvgpr_write_b32 a250, v126
  v_accvgpr_write_b32 a251, v127
  v_perm_b32 v120, v113, v112, s44
  v_perm_b32 v121, v115, v114, s44
  v_perm_b32 v122, v117, v116, s44
  v_perm_b32 v123, v119, v118, s44
  v_accvgpr_write_b32 a188, v120
  v_accvgpr_write_b32 a189, v121
  v_accvgpr_write_b32 a190, v122
  v_accvgpr_write_b32 a191, v123
  v_perm_b32 v124, v113, v112, s45
  v_perm_b32 v125, v115, v114, s45
  v_perm_b32 v126, v117, v116, s45
  v_perm_b32 v127, v119, v118, s45
  v_accvgpr_write_b32 a252, v124
  v_accvgpr_write_b32 a253, v125
  v_accvgpr_write_b32 a254, v126
  v_accvgpr_write_b32 a255, v127
  s_mov_b32 s26, 0
  v_mov_b32 v20, 160
g_wc_52:
  global_load_dword v21, v20, s[12:13] sc1
  s_add_u32 s26, s26, 1
  s_cmp_gt_u32 s26, 1048576
  s_cbranch_scc1 L_end
  s_waitcnt vmcnt(0)
  v_readfirstlane_b32 s27, v21
  s_cmp_lt_u32 s27, 64
  s_cbranch_scc1 g_wc_52
  s_getpc_b64 s[40:41]
q_pc_53:
  s_mul_i32 s26, s60, 616
  s_add_u32 s26, s26, qkv_tab-q_pc_53
  s_add_u32 s40, s40, s26
  s_addc_u32 s41, s41, 0
  s_load_dword s47, s[40:41], 0
  s_mov_b32 s48, 0
  s_mov_b32 s49, 268435456
  s_mov_b32 s50, 32768
  s_mov_b32 s56, 0
  s_mov_b32 s57, 0
  s_mov_b32 s61, 0
  s_lshl_b32 s54, s17, 13
q_top_54:
  s_waitcnt lgkmcnt(0)
  s_mov_b32 s46, s47
  s_bitcmp1_b32 s46, 9
  s_cbranch_scc0 q_end_55
  s_add_u32 s40, s40, 4
  s_addc_u32 s41, s41, 0
  s_and_b32 s26, s46, 7168
  s_cbranch_scc1 q_cond_61
q_decr_67:
  s_bitcmp1_b32 s46, 8
  s_cbranch_scc0 q_havex_57
  s_cmp_lg_u32 s48, 0
  s_cbranch_scc1 q_have_56
  s_mov_b32 s53, 0
q_poll_59:
  s_and_b32 s26, s46, 127
  s_lshl_b32 s26, s26, 7
  s_add_u32 s26, s26, 5242752
  buffer_load_dword v2, v1, s[4:7], s26 offen sc1
  s_add_u32 s53, s53, 1
  s_cmp_gt_u32 s53, 1048576
  s_cbranch_scc1 q_fail_60
  s_waitcnt vmcnt(0)
  s_mov_b64 exec, 1
  buffer_store_dword v4, off, s[4:7], s49 sc1
  s_mov_b64 exec, -1
  s_mov_b32 s49, 268435456
  v_cmp_eq_u32 vcc, 0, v2
  s_cmp_lg_u32 vcc_hi, 0
  s_cbranch_scc1 q_poll_59
  s_and_b32 s63, s46, 127
  s_lshl_b32 s63, s63, 15
  s_xor_b32 s27, s50, 32768
  s_add_u32 m0, s27, s54
  s_add_u32 s63, s63, s54
  s_add_u32 s63, s63, 6291456
  buffer_load_dwordx4 v12, s[4:7], s63 offen offset:0 sc1 lds
  buffer_load_dwordx4 v13, s[4:7], s63 offen offset:1024 sc1 lds
  buffer_load_dwordx4 v14, s[4:7], s63 offen offset:2048 sc1 lds
  buffer_load_dwordx4 v15, s[4:7], s63 offen offset:3072 sc1 lds
  s_add_u32 m0, m0, 4096
  s_add_u32 s63, s63, 4096
  buffer_load_dwordx4 v16, s[4:7], s63 offen offset:0 sc1 lds
  buffer_load_dwordx4 v17, s[4:7], s63 offen offset:1024 sc1 lds
  buffer_load_dwordx4 v18, s[4:7], s63 offen offset:2048 sc1 lds
  buffer_load_dwordx4 v19, s[4:7], s63 offen offset:3072 sc1 lds
  s_waitcnt vmcnt(0)
q_have_56:
  s_mov_b32 s48, 0
  s_xor_b32 s50, s50, 32768
  v_xor_b32 v8, 32768, v8
  v_xor_b32 v9, 32768, v9
  v_xor_b32 v10, 32768, v10
  v_xor_b32 v11, 32768, v11
  s_barrier
q_havex_57:
  s_and_b32 s52, s46, 127
q_cgo_64:
  s_bitcmp1_b32 s46, 7
  s_cbranch_scc1 q_qblk_58
  ds_read_b128 v[52:55], v8 offset:0
  ds_read_b128 v[56:59], v9 offset:0
  ds_read_b128 v[60:63], v10 offset:0
  ds_read_b128 v[64:67], v11 offset:0
  ds_read_b128 v[68:71], v8 offset:256
  ds_read_b128 v[72:75], v9 offset:256
  s_waitcnt lgkmcnt(5)
  v_mfma_f32_16x16x32_bf16 v[20:23], v[128:131], v[52:55], 0
  ds_read_b128 v[76:79], v10 offset:256
  v_mfma_f32_16x16x32_bf16 v[24:27], v[192:195], v[52:55], 0
  s_lshr_b32 s51, s46, 16
  s_and_b32 s26, s51, 127
  s_lshl_b32 s26, s26, 7
  s_add_u32 s26, s26, 5242752
  buffer_load_dword v2, v1, s[4:7], s26 offen sc1
  s_waitcnt lgkmcnt(5)
  v_mfma_f32_16x16x32_bf16 v[20:23], v[132:135], v[56:59], v[20:23]
  ds_read_b128 v[80:83], v11 offset:256
  v_mfma_f32_16x16x32_bf16 v[24:27], v[196:199], v[56:59], v[24:27]
  s_lshl_b32 s52, s52, 5
  s_add_u32 s52, s52, s16
  s_lshl_b32 s52, s52, 2
  s_add_u32 s52, s52, s17
  s_lshl_b32 s29, s52, 12
  s_add_u32 s29, s29, 41943040
  s_waitcnt lgkmcnt(5)
  v_mfma_f32_16x16x32_bf16 v[20:23], v[136:139], v[60:63], v[20:23]
  ds_read_b128 v[52:55], v8 offset:512
  v_mfma_f32_16x16x32_bf16 v[24:27], v[200:203], v[60:63], v[24:27]
  s_waitcnt lgkmcnt(5)
  v_mfma_f32_16x16x32_bf16 v[20:23], v[140:143], v[64:67], v[20:23]
  ds_read_b128 v[56:59], v9 offset:512
  v_mfma_f32_16x16x32_bf16 v[24:27], v[204:207], v[64:67], v[24:27]
  s_waitcnt lgkmcnt(5)
  v_mfma_f32_16x16x32_bf16 v[20:23], v[144:147], v[68:71], v[20:23]
  ds_read_b128 v[60:63], v10 offset:512
  v_mfma_f32_16x16x32_bf16 v[24:27], v[208:211], v[68:71], v[24:27]
  s_waitcnt lgkmcnt(5)
  v_mfma_f32_16x16x32_bf16 v[20:23], v[148:151], v[72:75], v[20:23]
  ds_read_b128 v[64:67], v11 offset:512
  v_mfma_f32_16x16x32_bf16 v[24:27], v[212:215], v[72:75], v[24:27]
  s_waitcnt lgkmcnt(5)
  v_mfma_f32_16x16x32_bf16 v[20:23], v[152:155], v[76:79], v[20:23]
  ds_read_b128 v[68:71], v8 offset:768
  v_mfma_f32_16x16x32_bf16 v[24:27], v[216:219], v[76:79], v[24:27]
  s_waitcnt lgkmcnt(5)
  v_mfma_f32_16x16x32_bf16 v[20:23], v[156:159], v[80:83], v[20:23]
  ds_read_b128 v[72:75], v9 offset:768
  v_mfma_f32_16x16x32_bf16 v[24:27], v[220:223], v[80:83], v[24:27]
  s_waitcnt lgkmcnt(5)
  v_mfma_f32_16x16x32_bf16 v[20:23], v[160:163], v[52:55], v[20:23]
  ds_read_b128 v[76:79], v10 offset:768
  v_mfma_f32_16x16x32_bf16 v[24:27], v[224:227], v[52:55], v[24:27]
  s_waitcnt lgkmcnt(5)
  v_mfma_f32_16x16x32_bf16 v[20:23], v[164:167], v[56:59], v[20:23]
  ds_read_b128 v[80:83], v11 offset:768
  v_mfma_f32_16x16x32_bf16 v[24:27], v[228:231], v[56:59], v[24:27]
  s_waitcnt lgkmcnt(5)
  v_mfma_f32_16x16x32_bf16 v[20:23], v[168:171], v[60:63], v[20:23]
  ds_read_b128 v[52:55], v8 offset:16384
  v_mfma_f32_16x16x32_bf16 v[24:27], v[232:235], v[60:63], v[24:27]
  s_waitcnt lgkmcnt(5)
  v_mfma_f32_16x16x32_bf16 v[20:23], v[172:175], v[64:67], v[20:23]
  ds_read_b128 v[56:59], v9 offset:16384
  v_mfma_f32_16x16x32_bf16 v[24:27], v[236:239], v[64:67], v[24:27]
  s_waitcnt lgkmcnt(5)
  v_mfma_f32_16x16x32_bf16 v[20:23], v[176:179], v[68:71], v[20:23]
  ds_read_b128 v[60:63], v10 offset:16384
  v_mfma_f32_16x16x32_bf16 v[24:27], v[240:243], v[68:71], v[24:27]
  s_waitcnt vmcnt(0)
  v_cmp_eq_u32 vcc, 0, v2
  s_bfe_u32 s28, s51, 0x10007
  s_cmp_eq_u32 vcc_hi, 0
  s_waitcnt lgkmcnt(5)
  v_mfma_f32_16x16x32_bf16 v[20:23], v[180:183], v[72:75], v[20:23]
  ds_read_b128 v[64:67], v11 offset:16384
  v_mfma_f32_16x16x32_bf16 v[24:27], v[244:247], v[72:75], v[24:27]
  s_cselect_b32 s28, s28, 0
  s_or_b32 s48, s48, s28
  s_cselect_b32 s28, s51, s46
  s_and_b32 s63, s28, 127
  s_lshl_b32 s63, s63, 15
  s_xor_b32 s27, s50, 32768
  s_waitcnt lgkmcnt(5)
  v_mfma_f32_16x16x32_bf16 v[20:23], v[184:187], v[76:79], v[20:23]
  ds_read_b128 v[68:71], v8 offset:16640
  v_mfma_f32_16x16x32_bf16 v[24:27], v[248:251], v[76:79], v[24:27]
  s_add_u32 m0, s27, s54
  s_add_u32 s63, s63, s54
  s_add_u32 s63, s63, 6291456
  buffer_load_dwordx4 v12, s[4:7], s63 offen offset:0 sc1 lds
  s_waitcnt lgkmcnt(5)
  v_mfma_f32_16x16x32_bf16 v[20:23], v[188:191], v[80:83], v[20:23]
  ds_read_b128 v[72:75], v9 offset:16640
  v_mfma_f32_16x16x32_bf16 v[24:27], v[252:255], v[80:83], v[24:27]
  buffer_load_dwordx4 v13, s[4:7], s63 offen offset:1024 sc1 lds
  s_waitcnt lgkmcnt(5)
  v_mfma_f32_16x16x32_bf16 v[28:31], v[128:131], v[52:55], 0
  ds_read_b128 v[76:79], v10 offset:16640
  v_mfma_f32_16x16x32_bf16 v[32:35], v[192:195], v[52:55], 0
  buffer_load_dwordx4 v14, s[4:7], s63 offen offset:2048 sc1 lds
  s_waitcnt lgkmcnt(5)
  v_mfma_f32_16x16x32_bf16 v[28:31], v[132:135], v[56:59], v[28:31]
  ds_read_b128 v[80:83], v11 offset:16640
  v_mfma_f32_16x16x32_bf16 v[32:35], v[196:199], v[56:59], v[32:35]
  buffer_load_dwordx4 v15, s[4:7], s63 offen offset:3072 sc1 lds
  s_waitcnt lgkmcnt(5)
  v_mfma_f32_16x16x32_bf16 v[28:31], v[136:139], v[60:63], v[28:31]
  ds_read_b128 v[52:55], v8 offset:16896
  v_mfma_f32_16x16x32_bf16 v[32:35], v[200:203], v[60:63], v[32:35]
  s_add_u32 m0, m0, 4096
  s_add_u32 s63, s63, 4096
  buffer_load_dwordx4 v16, s[4:7], s63 offen offset:0 sc1 lds
  s_waitcnt lgkmcnt(5)
  v_mfma_f32_16x16x32_bf16 v[28:31], v[140:143], v[64:67], v[28:31]
  ds_read_b128 v[56:59], v9 offset:16896
  v_mfma_f32_16x16x32_bf16 v[32:35], v[204:207], v[64:67], v[32:35]
  buffer_load_dwordx4 v17, s[4:7], s63 offen offset:1024 sc1 lds
  s_waitcnt lgkmcnt(5)
  v_mfma_f32_16x16x32_bf16 v[28:31], v[144:147], v[68:71], v[28:31]
  ds_read_b128 v[60:63], v10 offset:16896
  v_mfma_f32_16x16x32_bf16 v[32:35], v[208:211], v[68:71], v[32:35]
  buffer_load_dwordx4 v18, s[4:7], s63 offen offset:2048 sc1 lds
  s_waitcnt lgkmcnt(5)
  v_mfma_f32_16x16x32_bf16 v[28:31], v[148:151], v[72:75], v[28:31]
  ds_read_b128 v[64:67], v11 offset:16896
  v_mfma_f32_16x16x32_bf16 v[32:35], v[212:215], v[72:75], v[32:35]
  buffer_load_dwordx4 v19, s[4:7], s63 offen offset:3072 sc1 lds
  s_waitcnt lgkmcnt(5)
  v_mfma_f32_16x16x32_bf16 v[28:31], v[152:155], v[76:79], v[28:31]
  ds_read_b128 v[68:71], v8 offset:17152
  v_mfma_f32_16x16x32_bf16 v[32:35], v[216:219], v[76:79], v[32:35]
  s_mov_b64 exec, 1
  buffer_store_dword v4, off, s[4:7], s49 sc1
  s_mov_b64 exec, -1
  s_mov_b32 s49, 268435456
  s_waitcnt lgkmcnt(5)
  v_mfma_f32_16x16x32_bf16 v[28:31], v[156:159], v[80:83], v[28:31]
  ds_read_b128 v[72:75], v9 offset:17152
  v_mfma_f32_16x16x32_bf16 v[32:35], v[220:223], v[80:83], v[32:35]
  s_waitcnt lgkmcnt(5)
  v_mfma_f32_16x16x32_bf16 v[28:31], v[160:163], v[52:55], v[28:31]
  ds_read_b128 v[76:79], v10 offset:17152
  v_mfma_f32_16x16x32_bf16 v[32:35], v[224:227], v[52:55], v[32:35]
  s_waitcnt lgkmcnt(5)
  v_mfma_f32_16x16x32_bf16 v[28:31], v[164:167], v[56:59], v[28:31]
  ds_read_b128 v[80:83], v11 offset:17152
  v_mfma_f32_16x16x32_bf16 v[32:35], v[228:231], v[56:59], v[32:35]
  s_waitcnt lgkmcnt(5)
  v_mfma_f32_16x16x32_bf16 v[28:31], v[168:171], v[60:63], v[28:31]
  ds_read_b128 v[52:55], v8 offset:0
  v_mfma_f32_16x16x32_bf16 v[32:35], v[232:235], v[60:63], v[32:35]
  s_waitcnt lgkmcnt(5)
  v_mfma_f32_16x16x32_bf16 v[28:31], v[172:175], v[64:67], v[28:31]
  ds_read_b128 v[56:59], v9 offset:0
  v_mfma_f32_16x16x32_bf16 v[32:35], v[236:239], v[64:67], v[32:35]
  s_waitcnt lgkmcnt(5)
  v_mfma_f32_16x16x32_bf16 v[28:31], v[176:179], v[68:71], v[28:31]
  ds_read_b128 v[60:63], v10 offset:0
  v_mfma_f32_16x16x32_bf16 v[32:35], v[240:243], v[68:71], v[32:35]
  s_waitcnt lgkmcnt(5)
  v_mfma_f32_16x16x32_bf16 v[28:31], v[180:183], v[72:75], v[28:31]
  ds_read_b128 v[64:67], v11 offset:0
  v_mfma_f32_16x16x32_bf16 v[32:35], v[244:247], v[72:75], v[32:35]
  s_waitcnt lgkmcnt(5)
  v_mfma_f32_16x16x32_bf16 v[28:31], v[184:187], v[76:79], v[28:31]
  ds_read_b128 v[68:71], v8 offset:256
  v_mfma_f32_16x16x32_bf16 v[32:35], v[248:251], v[76:79], v[32:35]
  s_waitcnt lgkmcnt(5)
  v_mfma_f32_16x16x32_bf16 v[28:31], v[188:191], v[80:83], v[28:31]
  ds_read_b128 v[72:75], v9 offset:256
  v_mfma_f32_16x16x32_bf16 v[32:35], v[252:255], v[80:83], v[32:35]
  s_waitcnt lgkmcnt(5)
  v_mfma_f32_16x16x32_bf16 v[36:39], v[52:55], a[0:3], 0
  ds_read_b128 v[76:79], v10 offset:256
  v_mfma_f32_16x16x32_bf16 v[40:43], v[52:55], a[64:67], 0
  s_waitcnt lgkmcnt(5)
  v_mfma_f32_16x16x32_bf16 v[36:39], v[56:59], a[4:7], v[36:39]
  ds_read_b128 v[80:83], v11 offset:256
  v_mfma_f32_16x16x32_bf16 v[40:43], v[56:59], a[68:71], v[40:43]
  s_waitcnt lgkmcnt(5)
  v_mfma_f32_16x16x32_bf16 v[36:39], v[60:63], a[8:11], v[36:39]
  ds_read_b128 v[52:55], v8 offset:512
  v_mfma_f32_16x16x32_bf16 v[40:43], v[60:63], a[72:75], v[40:43]
  s_waitcnt lgkmcnt(5)
  v_mfma_f32_16x16x32_bf16 v[36:39], v[64:67], a[12:15], v[36:39]
  ds_read_b128 v[56:59], v9 offset:512
  v_mfma_f32_16x16x32_bf16 v[40:43], v[64:67], a[76:79], v[40:43]
  s_waitcnt lgkmcnt(5)
  v_mfma_f32_16x16x32_bf16 v[36:39], v[68:71], a[16:19], v[36:39]
  ds_read_b128 v[60:63], v10 offset:512
  v_mfma_f32_16x16x32_bf16 v[40:43], v[68:71], a[80:83], v[40:43]
  v_mul_f32 v20, s24, v20
  v_mul_f32 v21, s24, v21
  s_waitcnt lgkmcnt(5)
  v_mfma_f32_16x16x32_bf16 v[36:39], v[72:75], a[20:23], v[36:39]
  ds_read_b128 v[64:67], v11 offset:512
  v_mfma_f32_16x16x32_bf16 v[40:43], v[72:75], a[84:87], v[40:43]
  v_mul_f32 v22, s24, v22
  v_mul_f32 v23, s24, v23
  s_waitcnt lgkmcnt(5)
  v_mfma_f32_16x16x32_bf16 v[36:39], v[76:79], a[24:27], v[36:39]
  ds_read_b128 v[68:71], v8 offset:768
  v_mfma_f32_16x16x32_bf16 v[40:43], v[76:79], a[88:91], v[40:43]
  v_mul_f32 v24, s24, v24
  v_mul_f32 v25, s24, v25
  s_waitcnt lgkmcnt(5)
  v_mfma_f32_16x16x32_bf16 v[36:39], v[80:83], a[28:31], v[36:39]
  ds_read_b128 v[72:75], v9 offset:768
  v_mfma_f32_16x16x32_bf16 v[40:43], v[80:83], a[92:95], v[40:43]
  v_mul_f32 v26, s24, v26
  v_mul_f32 v27, s24, v27
  s_waitcnt lgkmcnt(5)
  v_mfma_f32_16x16x32_bf16 v[36:39], v[52:55], a[32:35], v[36:39]
  ds_read_b128 v[76:79], v10 offset:768
  v_mfma_f32_16x16x32_bf16 v[40:43], v[52:55], a[96:99], v[40:43]
  v_cvt_pk_bf16_f32 v84, v20, v21
  v_cvt_pk_bf16_f32 v85, v22, v23
  s_waitcnt lgkmcnt(5)
  v_mfma_f32_16x16x32_bf16 v[36:39], v[56:59], a[36:39], v[36:39]
  ds_read_b128 v[80:83], v11 offset:768
  v_mfma_f32_16x16x32_bf16 v[40:43], v[56:59], a[100:103], v[40:43]
  v_cvt_pk_bf16_f32 v86, v24, v25
  v_cvt_pk_bf16_f32 v87, v26, v27
  s_waitcnt lgkmcnt(5)
  v_mfma_f32_16x16x32_bf16 v[36:39], v[60:63], a[40:43], v[36:39]
  ds_read_b128 v[52:55], v8 offset:16384
  v_mfma_f32_16x16x32_bf16 v[40:43], v[60:63], a[104:107], v[40:43]
  buffer_store_dwordx4 v[84:87], v0, s[4:7], s29 offen offset:0 sc1
  s_waitcnt lgkmcnt(5)
  v_mfma_f32_16x16x32_bf16 v[36:39], v[64:67], a[44:47], v[36:39]
  ds_read_b128 v[56:59], v9 offset:16384
  v_mfma_f32_16x16x32_bf16 v[40:43], v[64:67], a[108:111], v[40:43]
  s_waitcnt lgkmcnt(5)
  v_mfma_f32_16x16x32_bf16 v[36:39], v[68:71], a[48:51], v[36:39]
  ds_read_b128 v[60:63], v10 offset:16384
  v_mfma_f32_16x16x32_bf16 v[40:43], v[68:71], a[112:115], v[40:43]
  v_mul_f32 v28, s24, v28
  v_mul_f32 v29, s24, v29
  s_waitcnt lgkmcnt(5)
  v_mfma_f32_16x16x32_bf16 v[36:39], v[72:75], a[52:55], v[36:39]
  ds_read_b128 v[64:67], v11 offset:16384
  v_mfma_f32_16x16x32_bf16 v[40:43], v[72:75], a[116:119], v[40:43]
  v_mul_f32 v30, s24, v30
  v_mul_f32 v31, s24, v31
  s_waitcnt lgkmcnt(5)
  v_mfma_f32_16x16x32_bf16 v[36:39], v[76:79], a[56:59], v[36:39]
  ds_read_b128 v[68:71], v8 offset:16640
  v_mfma_f32_16x16x32_bf16 v[40:43], v[76:79], a[120:123], v[40:43]
  v_mul_f32 v32, s24, v32
  v_mul_f32 v33, s24, v33
  s_waitcnt lgkmcnt(5)
  v_mfma_f32_16x16x32_bf16 v[36:39], v[80:83], a[60:63], v[36:39]
  ds_read_b128 v[72:75], v9 offset:16640
  v_mfma_f32_16x16x32_bf16 v[40:43], v[80:83], a[124:127], v[40:43]
  v_mul_f32 v34, s24, v34
  v_mul_f32 v35, s24, v35
  s_waitcnt lgkmcnt(5)
  v_mfma_f32_16x16x32_bf16 v[44:47], v[52:55], a[0:3], 0
  ds_read_b128 v[76:79], v10 offset:16640
  v_mfma_f32_16x16x32_bf16 v[48:51], v[52:55], a[64:67], 0
  v_cvt_pk_bf16_f32 v88, v28, v29
  v_cvt_pk_bf16_f32 v89, v30, v31
  s_waitcnt lgkmcnt(5)
  v_mfma_f32_16x16x32_bf16 v[44:47], v[56:59], a[4:7], v[44:47]
  ds_read_b128 v[80:83], v11 offset:16640
  v_mfma_f32_16x16x32_bf16 v[48:51], v[56:59], a[68:71], v[48:51]
  v_cvt_pk_bf16_f32 v90, v32, v33
  v_cvt_pk_bf16_f32 v91, v34, v35
  s_waitcnt lgkmcnt(5)
  v_mfma_f32_16x16x32_bf16 v[44:47], v[60:63], a[8:11], v[44:47]
  ds_read_b128 v[52:55], v8 offset:16896
  v_mfma_f32_16x16x32_bf16 v[48:51], v[60:63], a[72:75], v[48:51]
  buffer_store_dwordx4 v[88:91], v0, s[4:7], s29 offen offset:1024 sc1
  s_waitcnt lgkmcnt(5)
  v_mfma_f32_16x16x32_bf16 v[44:47], v[64:67], a[12:15], v[44:47]
  ds_read_b128 v[56:59], v9 offset:16896
  v_mfma_f32_16x16x32_bf16 v[48:51], v[64:67], a[76:79], v[48:51]
  s_waitcnt lgkmcnt(5)
  v_mfma_f32_16x16x32_bf16 v[44:47], v[68:71], a[16:19], v[44:47]
  ds_read_b128 v[60:63], v10 offset:16896
  v_mfma_f32_16x16x32_bf16 v[48:51], v[68:71], a[80:83], v[48:51]
  v_cvt_pk_bf16_f32 v92, v36, v37
  v_cvt_pk_bf16_f32 v93, v38, v39
  s_waitcnt lgkmcnt(5)
  v_mfma_f32_16x16x32_bf16 v[44:47], v[72:75], a[20:23], v[44:47]
  ds_read_b128 v[64:67], v11 offset:16896
  v_mfma_f32_16x16x32_bf16 v[48:51], v[72:75], a[84:87], v[48:51]
  v_cvt_pk_bf16_f32 v96, v40, v41
  v_cvt_pk_bf16_f32 v97, v42, v43
  s_waitcnt lgkmcnt(5)
  v_mfma_f32_16x16x32_bf16 v[44:47], v[76:79], a[24:27], v[44:47]
  ds_read_b128 v[68:71], v8 offset:17152
  v_mfma_f32_16x16x32_bf16 v[48:51], v[76:79], a[88:91], v[48:51]
  s_waitcnt lgkmcnt(5)
  v_mfma_f32_16x16x32_bf16 v[44:47], v[80:83], a[28:31], v[44:47]
  ds_read_b128 v[72:75], v9 offset:17152
  v_mfma_f32_16x16x32_bf16 v[48:51], v[80:83], a[92:95], v[48:51]
  s_waitcnt lgkmcnt(5)
  v_mfma_f32_16x16x32_bf16 v[44:47], v[52:55], a[32:35], v[44:47]
  ds_read_b128 v[76:79], v10 offset:17152
  v_mfma_f32_16x16x32_bf16 v[48:51], v[52:55], a[96:99], v[48:51]
  s_waitcnt lgkmcnt(5)
  v_mfma_f32_16x16x32_bf16 v[44:47], v[56:59], a[36:39], v[44:47]
  ds_read_b128 v[80:83], v11 offset:17152
  v_mfma_f32_16x16x32_bf16 v[48:51], v[56:59], a[100:103], v[48:51]
  s_waitcnt lgkmcnt(5)
  v_mfma_f32_16x16x32_bf16 v[44:47], v[60:63], a[40:43], v[44:47]
  v_mfma_f32_16x16x32_bf16 v[48:51], v[60:63], a[104:107], v[48:51]
  s_waitcnt lgkmcnt(4)
  v_mfma_f32_16x16x32_bf16 v[44:47], v[64:67], a[44:47], v[44:47]
  v_mfma_f32_16x16x32_bf16 v[48:51], v[64:67], a[108:111], v[48:51]
  s_waitcnt lgkmcnt(3)
  v_mfma_f32_16x16x32_bf16 v[44:47], v[68:71], a[48:51], v[44:47]
  v_mfma_f32_16x16x32_bf16 v[48:51], v[68:71], a[112:115], v[48:51]
  s_waitcnt lgkmcnt(2)
  v_mfma_f32_16x16x32_bf16 v[44:47], v[72:75], a[52:55], v[44:47]
  v_mfma_f32_16x16x32_bf16 v[48:51], v[72:75], a[116:119], v[48:51]
  s_waitcnt lgkmcnt(1)
  v_mfma_f32_16x16x32_bf16 v[44:47], v[76:79], a[56:59], v[44:47]
  v_mfma_f32_16x16x32_bf16 v[48:51], v[76:79], a[120:123], v[48:51]
  s_waitcnt lgkmcnt(0)
  v_mfma_f32_16x16x32_bf16 v[44:47], v[80:83], a[60:63], v[44:47]
  v_mfma_f32_16x16x32_bf16 v[48:51], v[80:83], a[124:127], v[48:51]
  s_load_dword s47, s[40:41], 0
  s_nop 2
  s_nop 2
  v_cvt_pk_bf16_f32 v94, v44, v45
  v_cvt_pk_bf16_f32 v95, v46, v47
  v_cvt_pk_bf16_f32 v98, v48, v49
  v_cvt_pk_bf16_f32 v99, v50, v51
  buffer_store_dwordx4 v[92:95], v0, s[4:7], s29 offen offset:2048 sc1
  buffer_store_dwordx4 v[96:99], v0, s[4:7], s29 offen offset:3072 sc1
  s_lshl_b32 s49, s52, 2
  s_add_u32 s49, s49, 5308416
  s_waitcnt vmcnt(5)
  s_branch q_top_54
q_qblk_58:
  ds_read_b128 v[52:55], v8 offset:0
  ds_read_b128 v[56:59], v9 offset:0
  ds_read_b128 v[60:63], v10 offset:0
  ds_read_b128 v[64:67], v11 offset:0
  ds_read_b128 v[68:71], v8 offset:256
  ds_read_b128 v[72:75], v9 offset:256
  s_waitcnt lgkmcnt(5)
  v_mfma_f32_16x16x32_bf16 v[20:23], a[128:131], v[52:55], 0
  ds_read_b128 v[76:79], v10 offset:256
  v_mfma_f32_16x16x32_bf16 v[24:27], a[192:195], v[52:55], 0
  s_lshr_b32 s51, s46, 16
  s_and_b32 s26, s51, 127
  s_lshl_b32 s26, s26, 7
  s_add_u32 s26, s26, 5242752
  buffer_load_dword v2, v1, s[4:7], s26 offen sc1
  s_waitcnt lgkmcnt(5)
  v_mfma_f32_16x16x32_bf16 v[20:23], a[132:135], v[56:59], v[20:23]
  ds_read_b128 v[80:83], v11 offset:256
  v_mfma_f32_16x16x32_bf16 v[24:27], a[196:199], v[56:59], v[24:27]
  s_lshl_b32 s52, s52, 5
  s_add_u32 s52, s52, s16
  s_lshl_b32 s52, s52, 2
  s_add_u32 s52, s52, s17
  s_lshl_b32 s29, s52, 11
  s_add_u32 s29, s29, 142606336
  s_waitcnt lgkmcnt(5)
  v_mfma_f32_16x16x32_bf16 v[20:23], a[136:139], v[60:63], v[20:23]
  ds_read_b128 v[52:55], v8 offset:512
  v_mfma_f32_16x16x32_bf16 v[24:27], a[200:203], v[60:63], v[24:27]
  s_waitcnt lgkmcnt(5)
  v_mfma_f32_16x16x32_bf16 v[20:23], a[140:143], v[64:67], v[20:23]
  ds_read_b128 v[56:59], v9 offset:512
  v_mfma_f32_16x16x32_bf16 v[24:27], a[204:207], v[64:67], v[24:27]
  s_waitcnt lgkmcnt(5)
  v_mfma_f32_16x16x32_bf16 v[20:23], a[144:147], v[68:71], v[20:23]
  ds_read_b128 v[60:63], v10 offset:512
  v_mfma_f32_16x16x32_bf16 v[24:27], a[208:211], v[68:71], v[24:27]
  s_waitcnt lgkmcnt(5)
  v_mfma_f32_16x16x32_bf16 v[20:23], a[148:151], v[72:75], v[20:23]
  ds_read_b128 v[64:67], v11 offset:512
  v_mfma_f32_16x16x32_bf16 v[24:27], a[212:215], v[72:75], v[24:27]
  s_waitcnt lgkmcnt(5)
  v_mfma_f32_16x16x32_bf16 v[20:23], a[152:155], v[76:79], v[20:23]
  ds_read_b128 v[68:71], v8 offset:768
  v_mfma_f32_16x16x32_bf16 v[24:27], a[216:219], v[76:79], v[24:27]
  s_waitcnt lgkmcnt(5)
  v_mfma_f32_16x16x32_bf16 v[20:23], a[156:159], v[80:83], v[20:23]
  ds_read_b128 v[72:75], v9 offset:768
  v_mfma_f32_16x16x32_bf16 v[24:27], a[220:223], v[80:83], v[24:27]
  s_waitcnt lgkmcnt(5)
  v_mfma_f32_16x16x32_bf16 v[20:23], a[160:163], v[52:55], v[20:23]
  ds_read_b128 v[76:79], v10 offset:768
  v_mfma_f32_16x16x32_bf16 v[24:27], a[224:227], v[52:55], v[24:27]
  s_waitcnt vmcnt(0)
  v_cmp_eq_u32 vcc, 0, v2
  s_bfe_u32 s28, s51, 0x10007
  s_cmp_eq_u32 vcc_hi, 0
  s_waitcnt lgkmcnt(5)
  v_mfma_f32_16x16x32_bf16 v[20:23], a[164:167], v[56:59], v[20:23]
  ds_read_b128 v[80:83], v11 offset:768
  v_mfma_f32_16x16x32_bf16 v[24:27], a[228:231], v[56:59], v[24:27]
  s_cselect_b32 s28, s28, 0
  s_or_b32 s48, s48, s28
  s_cselect_b32 s28, s51, s46
  s_and_b32 s63, s28, 127
  s_lshl_b32 s63, s63, 15
  s_xor_b32 s27, s50, 32768
  s_waitcnt lgkmcnt(5)
  v_mfma_f32_16x16x32_bf16 v[20:23], a[168:171], v[60:63], v[20:23]
  ds_read_b128 v[52:55], v8 offset:16384
  v_mfma_f32_16x16x32_bf16 v[24:27], a[232:235], v[60:63], v[24:27]
  s_add_u32 m0, s27, s54
  s_add_u32 s63, s63, s54
  s_add_u32 s63, s63, 6291456
  buffer_load_dwordx4 v12, s[4:7], s63 offen offset:0 sc1 lds
  s_waitcnt lgkmcnt(5)
  v_mfma_f32_16x16x32_bf16 v[20:23], a[172:175], v[64:67], v[20:23]
  ds_read_b128 v[56:59], v9 offset:16384
  v_mfma_f32_16x16x32_bf16 v[24:27], a[236:239], v[64:67], v[24:27]
  buffer_load_dwordx4 v13, s[4:7], s63 offen offset:1024 sc1 lds
  s_waitcnt lgkmcnt(5)
  v_mfma_f32_16x16x32_bf16 v[20:23], a[176:179], v[68:71], v[20:23]
  ds_read_b128 v[60:63], v10 offset:16384
  v_mfma_f32_16x16x32_bf16 v[24:27], a[240:243], v[68:71], v[24:27]
  buffer_load_dwordx4 v14, s[4:7], s63 offen offset:2048 sc1 lds
  s_waitcnt lgkmcnt(5)
  v_mfma_f32_16x16x32_bf16 v[20:23], a[180:183], v[72:75], v[20:23]
  ds_read_b128 v[64:67], v11 offset:16384
  v_mfma_f32_16x16x32_bf16 v[24:27], a[244:247], v[72:75], v[24:27]
  buffer_load_dwordx4 v15, s[4:7], s63 offen offset:3072 sc1 lds
  s_waitcnt lgkmcnt(5)
  v_mfma_f32_16x16x32_bf16 v[20:23], a[184:187], v[76:79], v[20:23]
  ds_read_b128 v[68:71], v8 offset:16640
  v_mfma_f32_16x16x32_bf16 v[24:27], a[248:251], v[76:79], v[24:27]
  s_add_u32 m0, m0, 4096
  s_add_u32 s63, s63, 4096
  buffer_load_dwordx4 v16, s[4:7], s63 offen offset:0 sc1 lds
  s_waitcnt lgkmcnt(5)
  v_mfma_f32_16x16x32_bf16 v[20:23], a[188:191], v[80:83], v[20:23]
  ds_read_b128 v[72:75], v9 offset:16640
  v_mfma_f32_16x16x32_bf16 v[24:27], a[252:255], v[80:83], v[24:27]
  buffer_load_dwordx4 v17, s[4:7], s63 offen offset:1024 sc1 lds
  s_waitcnt lgkmcnt(5)
  v_mfma_f32_16x16x32_bf16 v[28:31], a[128:131], v[52:55], 0
  ds_read_b128 v[76:79], v10 offset:16640
  v_mfma_f32_16x16x32_bf16 v[32:35], a[192:195], v[52:55], 0
  buffer_load_dwordx4 v18, s[4:7], s63 offen offset:2048 sc1 lds
  s_waitcnt lgkmcnt(5)
  v_mfma_f32_16x16x32_bf16 v[28:31], a[132:135], v[56:59], v[28:31]
  ds_read_b128 v[80:83], v11 offset:16640
  v_mfma_f32_16x16x32_bf16 v[32:35], a[196:199], v[56:59], v[32:35]
  buffer_load_dwordx4 v19, s[4:7], s63 offen offset:3072 sc1 lds
  s_waitcnt lgkmcnt(5)
  v_mfma_f32_16x16x32_bf16 v[28:31], a[136:139], v[60:63], v[28:31]
  ds_read_b128 v[52:55], v8 offset:16896
  v_mfma_f32_16x16x32_bf16 v[32:35], a[200:203], v[60:63], v[32:35]
  s_mov_b64 exec, 1
  buffer_store_dword v4, off, s[4:7], s49 sc1
  s_mov_b64 exec, -1
  s_mov_b32 s49, 268435456
  s_waitcnt lgkmcnt(5)
  v_mfma_f32_16x16x32_bf16 v[28:31], a[140:143], v[64:67], v[28:31]
  ds_read_b128 v[56:59], v9 offset:16896
  v_mfma_f32_16x16x32_bf16 v[32:35], a[204:207], v[64:67], v[32:35]
  s_waitcnt lgkmcnt(5)
  v_mfma_f32_16x16x32_bf16 v[28:31], a[144:147], v[68:71], v[28:31]
  ds_read_b128 v[60:63], v10 offset:16896
  v_mfma_f32_16x16x32_bf16 v[32:35], a[208:211], v[68:71], v[32:35]
  s_waitcnt lgkmcnt(5)
  v_mfma_f32_16x16x32_bf16 v[28:31], a[148:151], v[72:75], v[28:31]
  ds_read_b128 v[64:67], v11 offset:16896
  v_mfma_f32_16x16x32_bf16 v[32:35], a[212:215], v[72:75], v[32:35]
  s_waitcnt lgkmcnt(5)
  v_mfma_f32_16x16x32_bf16 v[28:31], a[152:155], v[76:79], v[28:31]
  ds_read_b128 v[68:71], v8 offset:17152
  v_mfma_f32_16x16x32_bf16 v[32:35], a[216:219], v[76:79], v[32:35]
  s_waitcnt lgkmcnt(5)
  v_mfma_f32_16x16x32_bf16 v[28:31], a[156:159], v[80:83], v[28:31]
  ds_read_b128 v[72:75], v9 offset:17152
  v_mfma_f32_16x16x32_bf16 v[32:35], a[220:223], v[80:83], v[32:35]
  s_waitcnt lgkmcnt(5)
  v_mfma_f32_16x16x32_bf16 v[28:31], a[160:163], v[52:55], v[28:31]
  ds_read_b128 v[76:79], v10 offset:17152
  v_mfma_f32_16x16x32_bf16 v[32:35], a[224:227], v[52:55], v[32:35]
  s_waitcnt lgkmcnt(5)
  v_mfma_f32_16x16x32_bf16 v[28:31], a[164:167], v[56:59], v[28:31]
  ds_read_b128 v[80:83], v11 offset:17152
  v_mfma_f32_16x16x32_bf16 v[32:35], a[228:231], v[56:59], v[32:35]
  s_waitcnt lgkmcnt(5)
  v_mfma_f32_16x16x32_bf16 v[28:31], a[168:171], v[60:63], v[28:31]
  v_mfma_f32_16x16x32_bf16 v[32:35], a[232:235], v[60:63], v[32:35]
  s_waitcnt lgkmcnt(4)
  v_mfma_f32_16x16x32_bf16 v[28:31], a[172:175], v[64:67], v[28:31]
  v_cvt_pk_bf16_f32 v84, v20, v21
  v_cvt_pk_bf16_f32 v85, v22, v23
  v_mfma_f32_16x16x32_bf16 v[32:35], a[236:239], v[64:67], v[32:35]
  v_cvt_pk_bf16_f32 v86, v24, v25
  v_cvt_pk_bf16_f32 v87, v26, v27
  s_waitcnt lgkmcnt(3)
  v_mfma_f32_16x16x32_bf16 v[28:31], a[176:179], v[68:71], v[28:31]
  buffer_store_dwordx4 v[84:87], v0, s[4:7], s29 offen offset:0 sc1
  v_mfma_f32_16x16x32_bf16 v[32:35], a[240:243], v[68:71], v[32:35]
  s_waitcnt lgkmcnt(2)
  v_mfma_f32_16x16x32_bf16 v[28:31], a[180:183], v[72:75], v[28:31]
  v_mfma_f32_16x16x32_bf16 v[32:35], a[244:247], v[72:75], v[32:35]
  s_waitcnt lgkmcnt(1)
  v_mfma_f32_16x16x32_bf16 v[28:31], a[184:187], v[76:79], v[28:31]
  v_mfma_f32_16x16x32_bf16 v[32:35], a[248:251], v[76:79], v[32:35]
  s_waitcnt lgkmcnt(0)
  v_mfma_f32_16x16x32_bf16 v[28:31], a[188:191], v[80:83], v[28:31]
  v_mfma_f32_16x16x32_bf16 v[32:35], a[252:255], v[80:83], v[32:35]
  s_load_dword s47, s[40:41], 0
  s_nop 2
  s_nop 2
  v_cvt_pk_bf16_f32 v88, v28, v29
  v_cvt_pk_bf16_f32 v89, v30, v31
  v_cvt_pk_bf16_f32 v90, v32, v33
  v_cvt_pk_bf16_f32 v91, v34, v35
  buffer_store_dwordx4 v[88:91], v0, s[4:7], s29 offen offset:1024 sc1
  s_lshl_b32 s49, s52, 2
  s_add_u32 s49, s49, 5406720
  s_waitcnt vmcnt(3)
  s_branch q_top_54
q_cond_61:
  s_bitcmp1_b32 s46, 12
  s_cbranch_scc1 q_dec_66
  s_cmp_eq_u32 s55, 0
  s_cbranch_scc1 q_csk_70
  s_bitcmp1_b32 s46, 11
  s_cbranch_scc1 q_cond2_62
  s_mov_b32 s53, 0
  s_and_b32 s28, s46, 63
  s_lshl_b32 s28, s28, 7
  s_add_u32 s28, s28, 5292032
q_cpoll_63:
  buffer_load_dword v2, off, s[4:7], s28 sc1
  s_add_u32 s53, s53, 1
  s_cmp_gt_u32 s53, 1048576
  s_cbranch_scc1 q_fail_60
  s_waitcnt vmcnt(0)
  s_mov_b64 exec, 1
  buffer_store_dword v4, off, s[4:7], s49 sc1
  s_mov_b64 exec, -1
  s_mov_b32 s49, 268435456
  v_cmp_eq_u32 vcc, 0, v2
  s_cbranch_vccnz q_cpoll_63
  s_barrier
  s_cmp_lg_u32 s17, 0
  s_cbranch_scc1 q_cnp_65
  s_andn2_b32 s26, 31, s56
  s_lshl_b32 s27, s26, 10
  s_add_u32 m0, s27, s50
  s_and_b32 s26, s26, 15
  s_lshl_b32 s26, s26, 4
  v_xor_b32 v3, s26, v0
  s_and_b32 s26, s46, 63
  s_lshl_b32 s26, s26, 11
  s_add_u32 s26, s26, 36701184
  buffer_load_dwordx4 v3, s[4:7], s26 offen sc1 lds
  s_waitcnt vmcnt(0)
q_cnp_65:
  s_barrier
q_cond2_62:
  s_and_b32 s52, s46, 63
  s_add_u32 s52, s52, 128
  s_branch q_cgo_64
q_csk_70:
  s_load_dword s47, s[40:41], 0
  s_branch q_top_54
q_dec_66:
  s_mov_b32 s53, 0
q_dpoll_68:
  s_and_b32 s26, s46, 127
  s_lshl_b32 s26, s26, 7
  s_add_u32 s26, s26, 5242752
  buffer_load_dword v2, v1, s[4:7], s26 offen sc1
  s_add_u32 s53, s53, 1
  s_cmp_gt_u32 s53, 1048576
  s_cbranch_scc1 q_fail_60
  s_waitcnt vmcnt(0)
  s_mov_b64 exec, 1
  buffer_store_dword v4, off, s[4:7], s49 sc1
  s_mov_b64 exec, -1
  s_mov_b32 s49, 268435456
  v_cmp_eq_u32 vcc, 0, v2
  s_cbranch_vccnz q_dpoll_68
  v_max_u32_dpp v2, v2, v2 row_ror:8 row_mask:0xf bank_mask:0xf
  s_nop 1
  v_max_u32_dpp v2, v2, v2 row_ror:4 row_mask:0xf bank_mask:0xf
  s_nop 1
  v_max_u32_dpp v2, v2, v2 row_ror:2 row_mask:0xf bank_mask:0xf
  s_nop 1
  v_max_u32_dpp v2, v2, v2 row_ror:1 row_mask:0xf bank_mask:0xf
  s_nop 0
  v_readlane_b32 s28, v2, 0
  v_readlane_b32 s29, v2, 16
  v_readlane_b32 s30, v2, 32
  v_readlane_b32 s31, v2, 48
  s_max_u32 s28, s28, s29
  s_max_u32 s56, s56, s28
  s_max_u32 s30, s30, s31
  s_cmp_gt_u32 s30, s56
  s_cselect_b32 s55, 1, 0
  s_cbranch_scc0 q_nof_69
  s_mov_b32 s56, s30
  s_mov_b32 s58, s30
  s_add_u32 s57, s57, 1
  s_load_dwordx2 s[64:65], s[0:1], 72
  s_load_dwordx2 s[68:69], s[0:1], 80
  s_load_dwordx2 s[8:9], s[0:1], 88
  s_mov_b32 s66, 1835008
  s_mov_b32 s67, 0x20000
  s_mov_b32 s70, 1835008
  s_mov_b32 s71, 0x20000
  s_mov_b32 s10, 1835008
  v_lshrrev_b32 v2, 8, v0
  v_and_b32 v3, 0x70, v0
  s_mov_b32 s26, 114688
  v_mul_lo_u32 v6, v2, s26
  v_add_u32 v6, v6, v3
  v_cmp_eq_u32 vcc, 0x70, v3
  v_mov_b32 v3, 0x7ff00000
  s_nop 0
  v_cndmask_b32 v6, v6, v3, vcc
  v_mul_u32_u24 v7, 14336, v2
  v_and_b32 v3, 0xf0, v0
  v_add_u32 v7, v7, v3
  s_mul_i32 s34, s17, 458752
  s_mul_i32 s27, s16, 112
  s_add_u32 s34, s34, s27
  s_mul_i32 s35, s16, 57344
  s_lshl_b32 s27, s17, 8
  s_add_u32 s35, s35, s27
  s_mov_b32 s36, 0x00ff00ff
  s_mov_b32 s37, 0x00ff00ff
  s_waitcnt lgkmcnt(0)
  s_andn2_b32 s59, 0xfff, s58
  s_lshl_b32 s26, s61, 21
  s_lshl_b32 s27, s59, 10
  s_add_u32 s32, s26, s27
  s_lshl_b32 s27, s17, 8
  s_add_u32 s26, s32, s27
  s_add_u32 s26, s26, 27262976
  v_lshrrev_b32 v3, 8, v0
  v_lshlrev_b32 v3, 6, v3
  buffer_load_dwordx4 v[36:39], v3, s[4:7], s26 offen offset:0 sc1
  buffer_load_dwordx4 v[40:43], v3, s[4:7], s26 offen offset:16 sc1
  buffer_load_dwordx4 v[44:47], v3, s[4:7], s26 offen offset:32 sc1
  buffer_load_dwordx4 v[48:51], v3, s[4:7], s26 offen offset:48 sc1
  s_mov_b64 exec, s[36:37]
  buffer_load_dwordx4 v[52:55], v6, s[64:67], s34 offen
  s_not_b64 exec, exec
  buffer_load_dwordx4 v[52:55], v6, s[68:71], s34 offen
  s_mov_b64 exec, -1
  s_add_u32 s34, s34, 3584
  s_mov_b64 exec, s[36:37]
  buffer_load_dwordx4 v[56:59], v6, s[64:67], s34 offen
  s_not_b64 exec, exec
  buffer_load_dwordx4 v[56:59], v6, s[68:71], s34 offen
  s_mov_b64 exec, -1
  s_add_u32 s34, s34, 3584
  s_mov_b64 exec, s[36:37]
  buffer_load_dwordx4 v[60:63], v6, s[64:67], s34 offen
  s_not_b64 exec, exec
  buffer_load_dwordx4 v[60:63], v6, s[68:71], s34 offen
  s_mov_b64 exec, -1
  s_add_u32 s34, s34, 3584
  s_mov_b64 exec, s[36:37]
  buffer_load_dwordx4 v[64:67], v6, s[64:67], s34 offen
  s_not_b64 exec, exec
  buffer_load_dwordx4 v[64:67], v6, s[68:71], s34 offen
  s_mov_b64 exec, -1
  s_add_u32 s34, s34, 3584
  s_mov_b64 exec, s[36:37]
  buffer_load_dwordx4 v[68:71], v6, s[64:67], s34 offen
  s_not_b64 exec, exec
  buffer_load_dwordx4 v[68:71], v6, s[68:71], s34 offen
  s_mov_b64 exec, -1
  s_add_u32 s34, s34, 3584
  s_mov_b64 exec, s[36:37]
  buffer_load_dwordx4 v[72:75], v6, s[64:67], s34 offen
  s_not_b64 exec, exec
  buffer_load_dwordx4 v[72:75], v6, s[68:71], s34 offen
  s_mov_b64 exec, -1
  s_add_u32 s34, s34, 3584
  s_mov_b64 exec, s[36:37]
  buffer_load_dwordx4 v[76:79], v6, s[64:67], s34 offen
  s_not_b64 exec, exec
  buffer_load_dwordx4 v[76:79], v6, s[68:71], s34 offen
  s_mov_b64 exec, -1
  s_add_u32 s34, s34, 3584
  s_mov_b64 exec, s[36:37]
  buffer_load_dwordx4 v[80:83], v6, s[64:67], s34 offen
  s_not_b64 exec, exec
  buffer_load_dwordx4 v[80:83], v6, s[68:71], s34 offen
  s_mov_b64 exec, -1
  s_add_u32 s34, s34, 3584
  s_mov_b64 exec, s[36:37]
  buffer_load_dwordx4 v[84:87], v6, s[64:67], s34 offen
  s_not_b64 exec, exec
  buffer_load_dwordx4 v[84:87], v6, s[68:71], s34 offen
  s_mov_b64 exec, -1
  s_add_u32 s34, s34, 3584
  s_mov_b64 exec, s[36:37]
  buffer_load_dwordx4 v[88:91], v6, s[64:67], s34 offen
  s_not_b64 exec, exec
  buffer_load_dwordx4 v[88:91], v6, s[68:71], s34 offen
  s_mov_b64 exec, -1
  s_add_u32 s34, s34, 3584
  s_mov_b64 exec, s[36:37]
  buffer_load_dwordx4 v[92:95], v6, s[64:67], s34 offen
  s_not_b64 exec, exec
  buffer_load_dwordx4 v[92:95], v6, s[68:71], s34 offen
  s_mov_b64 exec, -1
  s_add_u32 s34, s34, 3584
  s_mov_b64 exec, s[36:37]
  buffer_load_dwordx4 v[96:99], v6, s[64:67], s34 offen
  s_not_b64 exec, exec
  buffer_load_dwordx4 v[96:99], v6, s[68:71], s34 offen
  s_mov_b64 exec, -1
  s_add_u32 s34, s34, 3584
  s_mov_b64 exec, s[36:37]
  buffer_load_dwordx4 v[100:103], v6, s[64:67], s34 offen
  s_not_b64 exec, exec
  buffer_load_dwordx4 v[100:103], v6, s[68:71], s34 offen
  s_mov_b64 exec, -1
  s_add_u32 s34, s34, 3584
  s_mov_b64 exec, s[36:37]
  buffer_load_dwordx4 v[104:107], v6, s[64:67], s34 offen
  s_not_b64 exec, exec
  buffer_load_dwordx4 v[104:107], v6, s[68:71], s34 offen
  s_mov_b64 exec, -1
  s_add_u32 s34, s34, 3584
  s_mov_b64 exec, s[36:37]
  buffer_load_dwordx4 v[108:111], v6, s[64:67], s34 offen
  s_not_b64 exec, exec
  buffer_load_dwordx4 v[108:111], v6, s[68:71], s34 offen
  s_mov_b64 exec, -1
  s_add_u32 s34, s34, 3584
  s_mov_b64 exec, s[36:37]
  buffer_load_dwordx4 v[112:115], v6, s[64:67], s34 offen
  s_not_b64 exec, exec
  buffer_load_dwordx4 v[112:115], v6, s[68:71], s34 offen
  s_mov_b64 exec, -1
  s_add_u32 s34, s34, 3584
  s_mov_b64 exec, s[36:37]
  buffer_load_dwordx4 v[116:119], v6, s[64:67], s34 offen
  s_not_b64 exec, exec
  buffer_load_dwordx4 v[116:119], v6, s[68:71], s34 offen
  s_mov_b64 exec, -1
  s_add_u32 s34, s34, 3584
  s_mov_b64 exec, s[36:37]
  buffer_load_dwordx4 v[120:123], v6, s[64:67], s34 offen
  s_not_b64 exec, exec
  buffer_load_dwordx4 v[120:123], v6, s[68:71], s34 offen
  s_mov_b64 exec, -1
  s_add_u32 s34, s34, 3584
  s_mov_b64 exec, s[36:37]
  buffer_load_dwordx4 v[124:127], v6, s[64:67], s34 offen
  s_not_b64 exec, exec
  buffer_load_dwordx4 v[124:127], v6, s[68:71], s34 offen
  s_mov_b64 exec, -1
  s_add_u32 s34, s34, 3584
  s_mov_b32 vcc_lo, 0xaaaaaaaa
  s_mov_b32 vcc_hi, 0xaaaaaaaa
  v_mov_b32 v3, 0xffff
  v_mov_b32 v28, 0xffff0000
  v_cndmask_b32 v3, v3, v28, vcc
  s_mov_b32 vcc_lo, 0x30003
  s_mov_b32 vcc_hi, 0x30003
  v_cndmask_b32 v28, 0, v3, vcc
  s_mov_b32 vcc_lo, 0xc000c
  s_mov_b32 vcc_hi, 0xc000c
  v_cndmask_b32 v29, 0, v3, vcc
  s_mov_b32 vcc_lo, 0x300030
  s_mov_b32 vcc_hi, 0x300030
  v_cndmask_b32 v30, 0, v3, vcc
  s_mov_b32 vcc_lo, 0xc000c0
  s_mov_b32 vcc_hi, 0xc000c0
  v_cndmask_b32 v31, 0, v3, vcc
  s_mov_b32 s30, 0x01000100
  s_mov_b32 s31, 0x03020302
  s_waitcnt vmcnt(38)
  v_perm_b32 v3, v36, v36, s30
  v_and_b32 v20, v28, v3
  v_and_b32 v21, v29, v3
  v_and_b32 v22, v30, v3
  v_and_b32 v23, v31, v3
  s_waitcnt vmcnt(36)
  s_nop 0
  v_mfma_f32_16x16x32_bf16 v[32:35], v[20:23], v[52:55], 0
  s_mov_b64 exec, s[36:37]
  buffer_load_dwordx4 v[52:55], v6, s[64:67], s34 offen
  s_not_b64 exec, exec
  buffer_load_dwordx4 v[52:55], v6, s[68:71], s34 offen
  s_mov_b64 exec, -1
  s_add_u32 s34, s34, 3584
  v_perm_b32 v3, v36, v36, s31
  v_and_b32 v24, v28, v3
  v_and_b32 v25, v29, v3
  v_and_b32 v26, v30, v3
  v_and_b32 v27, v31, v3
  s_waitcnt vmcnt(36)
  s_nop 0
  v_mfma_f32_16x16x32_bf16 v[32:35], v[24:27], v[56:59], v[32:35]
  s_mov_b64 exec, s[36:37]
  buffer_load_dwordx4 v[56:59], v6, s[64:67], s34 offen
  s_not_b64 exec, exec
  buffer_load_dwordx4 v[56:59], v6, s[68:71], s34 offen
  s_mov_b64 exec, -1
  s_add_u32 s34, s34, 3584
  v_perm_b32 v3, v37, v37, s30
  v_and_b32 v20, v28, v3
  v_and_b32 v21, v29, v3
  v_and_b32 v22, v30, v3
  v_and_b32 v23, v31, v3
  s_waitcnt vmcnt(36)
  s_nop 0
  v_mfma_f32_16x16x32_bf16 v[32:35], v[20:23], v[60:63], v[32:35]
  s_mov_b64 exec, s[36:37]
  buffer_load_dwordx4 v[60:63], v6, s[64:67], s34 offen
  s_not_b64 exec, exec
  buffer_load_dwordx4 v[60:63], v6, s[68:71], s34 offen
  s_mov_b64 exec, -1
  s_add_u32 s34, s34, 3584
  v_perm_b32 v3, v37, v37, s31
  v_and_b32 v24, v28, v3
  v_and_b32 v25, v29, v3
  v_and_b32 v26, v30, v3
  v_and_b32 v27, v31, v3
  s_waitcnt vmcnt(36)
  s_nop 0
  v_mfma_f32_16x16x32_bf16 v[32:35], v[24:27], v[64:67], v[32:35]
  s_mov_b64 exec, s[36:37]
  buffer_load_dwordx4 v[64:67], v6, s[64:67], s34 offen
  s_not_b64 exec, exec
  buffer_load_dwordx4 v[64:67], v6, s[68:71], s34 offen
  s_mov_b64 exec, -1
  s_add_u32 s34, s34, 3584
  v_perm_b32 v3, v38, v38, s30
  v_and_b32 v20, v28, v3
  v_and_b32 v21, v29, v3
  v_and_b32 v22, v30, v3
  v_and_b32 v23, v31, v3
  s_waitcnt vmcnt(36)
  s_nop 0
  v_mfma_f32_16x16x32_bf16 v[32:35], v[20:23], v[68:71], v[32:35]
  s_mov_b64 exec, s[36:37]
  buffer_load_dwordx4 v[68:71], v6, s[64:67], s34 offen
  s_not_b64 exec, exec
  buffer_load_dwordx4 v[68:71], v6, s[68:71], s34 offen
  s_mov_b64 exec, -1
  s_add_u32 s34, s34, 3584
  v_perm_b32 v3, v38, v38, s31
  v_and_b32 v24, v28, v3
  v_and_b32 v25, v29, v3
  v_and_b32 v26, v30, v3
  v_and_b32 v27, v31, v3
  s_waitcnt vmcnt(36)
  s_nop 0
  v_mfma_f32_16x16x32_bf16 v[32:35], v[24:27], v[72:75], v[32:35]
  s_mov_b64 exec, s[36:37]
  buffer_load_dwordx4 v[72:75], v6, s[64:67], s34 offen
  s_not_b64 exec, exec
  buffer_load_dwordx4 v[72:75], v6, s[68:71], s34 offen
  s_mov_b64 exec, -1
  s_add_u32 s34, s34, 3584
  v_perm_b32 v3, v39, v39, s30
  v_and_b32 v20, v28, v3
  v_and_b32 v21, v29, v3
  v_and_b32 v22, v30, v3
  v_and_b32 v23, v31, v3
  s_waitcnt vmcnt(36)
  s_nop 0
  v_mfma_f32_16x16x32_bf16 v[32:35], v[20:23], v[76:79], v[32:35]
  s_mov_b64 exec, s[36:37]
  buffer_load_dwordx4 v[76:79], v6, s[64:67], s34 offen
  s_not_b64 exec, exec
  buffer_load_dwordx4 v[76:79], v6, s[68:71], s34 offen
  s_mov_b64 exec, -1
  s_add_u32 s34, s34, 3584
  v_perm_b32 v3, v39, v39, s31
  v_and_b32 v24, v28, v3
  v_and_b32 v25, v29, v3
  v_and_b32 v26, v30, v3
  v_and_b32 v27, v31, v3
  s_waitcnt vmcnt(36)
  s_nop 0
  v_mfma_f32_16x16x32_bf16 v[32:35], v[24:27], v[80:83], v[32:35]
  s_mov_b64 exec, s[36:37]
  buffer_load_dwordx4 v[80:83], v6, s[64:67], s34 offen
  s_not_b64 exec, exec
  buffer_load_dwordx4 v[80:83], v6, s[68:71], s34 offen
  s_mov_b64 exec, -1
  s_add_u32 s34, s34, 3584
  v_perm_b32 v3, v40, v40, s30
  v_and_b32 v20, v28, v3
  v_and_b32 v21, v29, v3
  v_and_b32 v22, v30, v3
  v_and_b32 v23, v31, v3
  s_waitcnt vmcnt(36)
  s_nop 0
  v_mfma_f32_16x16x32_bf16 v[32:35], v[20:23], v[84:87], v[32:35]
  s_mov_b64 exec, s[36:37]
  buffer_load_dwordx4 v[84:87], v6, s[64:67], s34 offen
  s_not_b64 exec, exec
  buffer_load_dwordx4 v[84:87], v6, s[68:71], s34 offen
  s_mov_b64 exec, -1
  s_add_u32 s34, s34, 3584
  v_perm_b32 v3, v40, v40, s31
  v_and_b32 v24, v28, v3
  v_and_b32 v25, v29, v3
  v_and_b32 v26, v30, v3
  v_and_b32 v27, v31, v3
  s_waitcnt vmcnt(36)
  s_nop 0
  v_mfma_f32_16x16x32_bf16 v[32:35], v[24:27], v[88:91], v[32:35]
  s_mov_b64 exec, s[36:37]
  buffer_load_dwordx4 v[88:91], v6, s[64:67], s34 offen
  s_not_b64 exec, exec
  buffer_load_dwordx4 v[88:91], v6, s[68:71], s34 offen
  s_mov_b64 exec, -1
  s_add_u32 s34, s34, 3584
  v_perm_b32 v3, v41, v41, s30
  v_and_b32 v20, v28, v3
  v_and_b32 v21, v29, v3
  v_and_b32 v22, v30, v3
  v_and_b32 v23, v31, v3
  s_waitcnt vmcnt(36)
  s_nop 0
  v_mfma_f32_16x16x32_bf16 v[32:35], v[20:23], v[92:95], v[32:35]
  s_mov_b64 exec, s[36:37]
  buffer_load_dwordx4 v[92:95], v6, s[64:67], s34 offen
  s_not_b64 exec, exec
  buffer_load_dwordx4 v[92:95], v6, s[68:71], s34 offen
  s_mov_b64 exec, -1
  s_add_u32 s34, s34, 3584
  v_perm_b32 v3, v41, v41, s31
  v_and_b32 v24, v28, v3
  v_and_b32 v25, v29, v3
  v_and_b32 v26, v30, v3
  v_and_b32 v27, v31, v3
  s_waitcnt vmcnt(36)
  s_nop 0
  v_mfma_f32_16x16x32_bf16 v[32:35], v[24:27], v[96:99], v[32:35]
  s_mov_b64 exec, s[36:37]
  buffer_load_dwordx4 v[96:99], v6, s[64:67], s34 offen
  s_not_b64 exec, exec
  buffer_load_dwordx4 v[96:99], v6, s[68:71], s34 offen
  s_mov_b64 exec, -1
  s_add_u32 s34, s34, 3584
  v_perm_b32 v3, v42, v42, s30
  v_and_b32 v20, v28, v3
  v_and_b32 v21, v29, v3
  v_and_b32 v22, v30, v3
  v_and_b32 v23, v31, v3
  s_waitcnt vmcnt(36)
  s_nop 0
  v_mfma_f32_16x16x32_bf16 v[32:35], v[20:23], v[100:103], v[32:35]
  s_mov_b64 exec, s[36:37]
  buffer_load_dwordx4 v[100:103], v6, s[64:67], s34 offen
  s_not_b64 exec, exec
  buffer_load_dwordx4 v[100:103], v6, s[68:71], s34 offen
  s_mov_b64 exec, -1
  s_add_u32 s34, s34, 3584
  v_perm_b32 v3, v42, v42, s31
  v_and_b32 v24, v28, v3
  v_and_b32 v25, v29, v3
  v_and_b32 v26, v30, v3
  v_and_b32 v27, v31, v3
  s_waitcnt vmcnt(36)
  s_nop 0
  v_mfma_f32_16x16x32_bf16 v[32:35], v[24:27], v[104:107], v[32:35]
  buffer_load_dwordx4 v[104:107], v7, s[8:11], s35 offen offset:0
  v_perm_b32 v3, v43, v43, s30
  v_and_b32 v20, v28, v3
  v_and_b32 v21, v29, v3
  v_and_b32 v22, v30, v3
  v_and_b32 v23, v31, v3
  s_waitcnt vmcnt(35)
  s_nop 0
  v_mfma_f32_16x16x32_bf16 v[32:35], v[20:23], v[108:111], v[32:35]
  buffer_load_dwordx4 v[108:111], v7, s[8:11], s35 offen offset:1024
  v_perm_b32 v3, v43, v43, s31
  v_and_b32 v24, v28, v3
  v_and_b32 v25, v29, v3
  v_and_b32 v26, v30, v3
  v_and_b32 v27, v31, v3
  s_waitcnt vmcnt(34)
  s_nop 0
  v_mfma_f32_16x16x32_bf16 v[32:35], v[24:27], v[112:115], v[32:35]
  buffer_load_dwordx4 v[112:115], v7, s[8:11], s35 offen offset:2048
  v_perm_b32 v3, v44, v44, s30
  v_and_b32 v20, v28, v3
  v_and_b32 v21, v29, v3
  v_and_b32 v22, v30, v3
  v_and_b32 v23, v31, v3
  s_waitcnt vmcnt(33)
  s_nop 0
  v_mfma_f32_16x16x32_bf16 v[32:35], v[20:23], v[116:119], v[32:35]
  buffer_load_dwordx4 v[116:119], v7, s[8:11], s35 offen offset:3072
  s_add_u32 s35, s35, 4096
  v_perm_b32 v3, v44, v44, s31
  v_and_b32 v24, v28, v3
  v_and_b32 v25, v29, v3
  v_and_b32 v26, v30, v3
  v_and_b32 v27, v31, v3
  s_waitcnt vmcnt(32)
  s_nop 0
  v_mfma_f32_16x16x32_bf16 v[32:35], v[24:27], v[120:123], v[32:35]
  buffer_load_dwordx4 v[120:123], v7, s[8:11], s35 offen offset:0
  v_perm_b32 v3, v45, v45, s30
  v_and_b32 v20, v28, v3
  v_and_b32 v21, v29, v3
  v_and_b32 v22, v30, v3
  v_and_b32 v23, v31, v3
  s_waitcnt vmcnt(31)
  s_nop 0
  v_mfma_f32_16x16x32_bf16 v[32:35], v[20:23], v[124:127], v[32:35]
  buffer_load_dwordx4 v[124:127], v7, s[8:11], s35 offen offset:1024
  v_perm_b32 v3, v45, v45, s31
  v_and_b32 v24, v28, v3
  v_and_b32 v25, v29, v3
  v_and_b32 v26, v30, v3
  v_and_b32 v27, v31, v3
  s_waitcnt vmcnt(30)
  s_nop 0
  v_mfma_f32_16x16x32_bf16 v[32:35], v[24:27], v[52:55], v[32:35]
  buffer_load_dwordx4 v[52:55], v7, s[8:11], s35 offen offset:2048
  v_perm_b32 v3, v46, v46, s30
  v_and_b32 v20, v28, v3
  v_and_b32 v21, v29, v3
  v_and_b32 v22, v30, v3
  v_and_b32 v23, v31, v3
  s_waitcnt vmcnt(29)
  s_nop 0
  v_mfma_f32_16x16x32_bf16 v[32:35], v[20:23], v[56:59], v[32:35]
  buffer_load_dwordx4 v[56:59], v7, s[8:11], s35 offen offset:3072
  s_add_u32 s35, s35, 4096
  v_perm_b32 v3, v46, v46, s31
  v_and_b32 v24, v28, v3
  v_and_b32 v25, v29, v3
  v_and_b32 v26, v30, v3
  v_and_b32 v27, v31, v3
  s_waitcnt vmcnt(28)
  s_nop 0
  v_mfma_f32_16x16x32_bf16 v[32:35], v[24:27], v[60:63], v[32:35]
  buffer_load_dwordx4 v[60:63], v7, s[8:11], s35 offen offset:0
  v_perm_b32 v3, v47, v47, s30
  v_and_b32 v20, v28, v3
  v_and_b32 v21, v29, v3
  v_and_b32 v22, v30, v3
  v_and_b32 v23, v31, v3
  s_waitcnt vmcnt(27)
  s_nop 0
  v_mfma_f32_16x16x32_bf16 v[32:35], v[20:23], v[64:67], v[32:35]
  buffer_load_dwordx4 v[64:67], v7, s[8:11], s35 offen offset:1024
  v_perm_b32 v3, v47, v47, s31
  v_and_b32 v24, v28, v3
  v_and_b32 v25, v29, v3
  v_and_b32 v26, v30, v3
  v_and_b32 v27, v31, v3
  s_waitcnt vmcnt(26)
  s_nop 0
  v_mfma_f32_16x16x32_bf16 v[32:35], v[24:27], v[68:71], v[32:35]
  buffer_load_dwordx4 v[68:71], v7, s[8:11], s35 offen offset:2048
  v_perm_b32 v3, v48, v48, s30
  v_and_b32 v20, v28, v3
  v_and_b32 v21, v29, v3
  v_and_b32 v22, v30, v3
  v_and_b32 v23, v31, v3
  s_waitcnt vmcnt(25)
  s_nop 0
  v_mfma_f32_16x16x32_bf16 v[32:35], v[20:23], v[72:75], v[32:35]
  buffer_load_dwordx4 v[72:75], v7, s[8:11], s35 offen offset:3072
  s_add_u32 s35, s35, 4096
  v_perm_b32 v3, v48, v48, s31
  v_and_b32 v24, v28, v3
  v_and_b32 v25, v29, v3
  v_and_b32 v26, v30, v3
  v_and_b32 v27, v31, v3
  s_waitcnt vmcnt(24)
  s_nop 0
  v_mfma_f32_16x16x32_bf16 v[32:35], v[24:27], v[76:79], v[32:35]
  buffer_load_dwordx4 v[76:79], v7, s[8:11], s35 offen offset:0
  v_perm_b32 v3, v49, v49, s30
  v_and_b32 v20, v28, v3
  v_and_b32 v21, v29, v3
  v_and_b32 v22, v30, v3
  v_and_b32 v23, v31, v3
  s_waitcnt vmcnt(23)
  s_nop 0
  v_mfma_f32_16x16x32_bf16 v[32:35], v[20:23], v[80:83], v[32:35]
  buffer_load_dwordx4 v[80:83], v7, s[8:11], s35 offen offset:1024
  v_perm_b32 v3, v49, v49, s31
  v_and_b32 v24, v28, v3
  v_and_b32 v25, v29, v3
  v_and_b32 v26, v30, v3
  v_and_b32 v27, v31, v3
  s_waitcnt vmcnt(22)
  s_nop 0
  v_mfma_f32_16x16x32_bf16 v[32:35], v[24:27], v[84:87], v[32:35]
  v_perm_b32 v3, v50, v50, s30
  v_and_b32 v20, v28, v3
  v_and_b32 v21, v29, v3
  v_and_b32 v22, v30, v3
  v_and_b32 v23, v31, v3
  s_waitcnt vmcnt(20)
  s_nop 0
  v_mfma_f32_16x16x32_bf16 v[32:35], v[20:23], v[88:91], v[32:35]
  v_perm_b32 v3, v50, v50, s31
  v_and_b32 v24, v28, v3
  v_and_b32 v25, v29, v3
  v_and_b32 v26, v30, v3
  v_and_b32 v27, v31, v3
  s_waitcnt vmcnt(18)
  s_nop 0
  v_mfma_f32_16x16x32_bf16 v[32:35], v[24:27], v[92:95], v[32:35]
  v_perm_b32 v3, v51, v51, s30
  v_and_b32 v20, v28, v3
  v_and_b32 v21, v29, v3
  v_and_b32 v22, v30, v3
  v_and_b32 v23, v31, v3
  s_waitcnt vmcnt(16)
  s_nop 0
  v_mfma_f32_16x16x32_bf16 v[32:35], v[20:23], v[96:99], v[32:35]
  v_perm_b32 v3, v51, v51, s31
  v_and_b32 v24, v28, v3
  v_and_b32 v25, v29, v3
  v_and_b32 v26, v30, v3
  v_and_b32 v27, v31, v3
  s_waitcnt vmcnt(14)
  s_nop 0
  v_mfma_f32_16x16x32_bf16 v[32:35], v[24:27], v[100:103], v[32:35]
  v_lshrrev_b32 v2, 8, v0
  v_and_b32 v3, 0xf0, v0
  v_lshlrev_b32 v3, 1, v3
  v_lshl_add_u32 v3, v2, 4, v3
  s_lshl_b32 s26, s17, 9
  s_add_u32 s26, s26, 65536
  v_add_u32 v5, s26, v3
  s_mov_b32 exec_hi, 0
  ds_write_b128 v5, v[32:35]
  s_mov_b32 exec_hi, -1
  v_add_u32 v5, 65536, v1
  s_waitcnt lgkmcnt(0)
  s_barrier
  ds_read_b32 v36, v5 offset:0
  ds_read_b32 v37, v5 offset:256
  ds_read_b32 v38, v5 offset:512
  ds_read_b32 v39, v5 offset:768
  ds_read_b32 v40, v5 offset:1024
  ds_read_b32 v41, v5 offset:1280
  ds_read_b32 v42, v5 offset:1536
  ds_read_b32 v43, v5 offset:1792
  s_waitcnt lgkmcnt(0)
  v_add_f32 v36, v36, v38
  v_add_f32 v40, v40, v42
  v_add_f32 v36, v36, v40
  v_cvt_pk_bf16_f32 v36, 0, v36
  v_add_f32 v37, v37, v39
  v_add_f32 v41, v41, v43
  v_add_f32 v37, v37, v41
  v_cvt_pk_bf16_f32 v37, 0, v37
  v_mul_f32 v40, 0xbfb8aa3b, v36
  v_exp_f32 v40, v40
  s_nop 0
  v_add_f32 v40, 1.0, v40
  v_rcp_f32 v40, v40
  s_nop 0
  v_mul_f32 v36, v36, v40
  v_cvt_pk_bf16_f32 v36, 0, v36
  v_mul_f32 v36, v36, v37
  v_cvt_pk_bf16_f32 v36, v36, v36
  s_lshl_b32 s26, s17, 8
  s_add_u32 s26, s26, 73728
  v_add_u32 v5, s26, v1
  ds_write_b32 v5, v36
  v_mul_u32_u24 v5, 56, v2
  v_add_u32 v5, s26, v5
  ds_read_b64 v[36:37], v5 offset:0
  ds_read_b64 v[38:39], v5 offset:8
  ds_read_b64 v[40:41], v5 offset:16
  ds_read_b64 v[42:43], v5 offset:24
  ds_read_b64 v[44:45], v5 offset:32
  ds_read_b64 v[46:47], v5 offset:40
  ds_read_b64 v[48:49], v5 offset:48
  s_waitcnt lgkmcnt(0)
  v_and_b32 v20, v28, v36
  v_and_b32 v21, v29, v36
  v_and_b32 v22, v30, v36
  v_and_b32 v23, v31, v36
  s_waitcnt vmcnt(13)
  s_nop 0
  v_mfma_f32_16x16x32_bf16 v[32:35], v[20:23], v[104:107], 0
  v_and_b32 v24, v28, v37
  v_and_b32 v25, v29, v37
  v_and_b32 v26, v30, v37
  v_and_b32 v27, v31, v37
  s_waitcnt vmcnt(12)
  s_nop 0
  v_mfma_f32_16x16x32_bf16 v[32:35], v[24:27], v[108:111], v[32:35]
  v_and_b32 v20, v28, v38
  v_and_b32 v21, v29, v38
  v_and_b32 v22, v30, v38
  v_and_b32 v23, v31, v38
  s_waitcnt vmcnt(11)
  s_nop 0
  v_mfma_f32_16x16x32_bf16 v[32:35], v[20:23], v[112:115], v[32:35]
  v_and_b32 v24, v28, v39
  v_and_b32 v25, v29, v39
  v_and_b32 v26, v30, v39
  v_and_b32 v27, v31, v39
  s_waitcnt vmcnt(10)
  s_nop 0
  v_mfma_f32_16x16x32_bf16 v[32:35], v[24:27], v[116:119], v[32:35]
  v_and_b32 v20, v28, v40
  v_and_b32 v21, v29, v40
  v_and_b32 v22, v30, v40
  v_and_b32 v23, v31, v40
  s_waitcnt vmcnt(9)
  s_nop 0
  v_mfma_f32_16x16x32_bf16 v[32:35], v[20:23], v[120:123], v[32:35]
  v_and_b32 v24, v28, v41
  v_and_b32 v25, v29, v41
  v_and_b32 v26, v30, v41
  v_and_b32 v27, v31, v41
  s_waitcnt vmcnt(8)
  s_nop 0
  v_mfma_f32_16x16x32_bf16 v[32:35], v[24:27], v[124:127], v[32:35]
  v_and_b32 v20, v28, v42
  v_and_b32 v21, v29, v42
  v_and_b32 v22, v30, v42
  v_and_b32 v23, v31, v42
  s_waitcnt vmcnt(7)
  s_nop 0
  v_mfma_f32_16x16x32_bf16 v[32:35], v[20:23], v[52:55], v[32:35]
  v_and_b32 v24, v28, v43
  v_and_b32 v25, v29, v43
  v_and_b32 v26, v30, v43
  v_and_b32 v27, v31, v43
  s_waitcnt vmcnt(6)
  s_nop 0
  v_mfma_f32_16x16x32_bf16 v[32:35], v[24:27], v[56:59], v[32:35]
  v_and_b32 v20, v28, v44
  v_and_b32 v21, v29, v44
  v_and_b32 v22, v30, v44
  v_and_b32 v23, v31, v44
  s_waitcnt vmcnt(5)
  s_nop 0
  v_mfma_f32_16x16x32_bf16 v[32:35], v[20:23], v[60:63], v[32:35]
  v_and_b32 v24, v28, v45
  v_and_b32 v25, v29, v45
  v_and_b32 v26, v30, v45
  v_and_b32 v27, v31, v45
  s_waitcnt vmcnt(4)
  s_nop 0
  v_mfma_f32_16x16x32_bf16 v[32:35], v[24:27], v[64:67], v[32:35]
  v_and_b32 v20, v28, v46
  v_and_b32 v21, v29, v46
  v_and_b32 v22, v30, v46
  v_and_b32 v23, v31, v46
  s_waitcnt vmcnt(3)
  s_nop 0
  v_mfma_f32_16x16x32_bf16 v[32:35], v[20:23], v[68:71], v[32:35]
  v_and_b32 v24, v28, v47
  v_and_b32 v25, v29, v47
  v_and_b32 v26, v30, v47
  v_and_b32 v27, v31, v47
  s_waitcnt vmcnt(2)
  s_nop 0
  v_mfma_f32_16x16x32_bf16 v[32:35], v[24:27], v[72:75], v[32:35]
  v_and_b32 v20, v28, v48
  v_and_b32 v21, v29, v48
  v_and_b32 v22, v30, v48
  v_and_b32 v23, v31, v48
  s_waitcnt vmcnt(1)
  s_nop 0
  v_mfma_f32_16x16x32_bf16 v[32:35], v[20:23], v[76:79], v[32:35]
  v_and_b32 v24, v28, v49
  v_and_b32 v25, v29, v49
  v_and_b32 v26, v30, v49
  v_and_b32 v27, v31, v49
  s_waitcnt vmcnt(0)
  s_nop 0
  v_mfma_f32_16x16x32_bf16 v[32:35], v[24:27], v[80:83], v[32:35]
  v_lshrrev_b32 v3, 1, v3
  s_lshl_b32 s26, s60, 5
  s_add_u32 s26, s26, s16
  s_lshl_b32 s26, s26, 2
  s_add_u32 s26, s26, s17
  s_lshl_b32 s27, s26, 2
  s_add_u32 s27, s27, 5287936
  s_lshl_b32 s26, s26, 8
  s_add_u32 s26, s26, 35651584
  v_cvt_pk_bf16_f32 v32, v32, v33
  v_cvt_pk_bf16_f32 v33, v34, v35
  s_mov_b32 exec_hi, 0
  buffer_store_dwordx2 v[32:33], v3, s[4:7], s26 offen sc1
  s_mov_b32 exec_hi, -1
  v_mov_b32 v5, s57
  s_waitcnt vmcnt(0)
  s_mov_b64 exec, 1
  buffer_store_dword v5, off, s[4:7], s27 sc1
  s_mov_b64 exec, -1
  s_or_b32 s26, s16, s17
  s_cbranch_scc1 m_done_71
  s_add_u32 s27, s32, 20971520
  s_add_u32 s28, s32, 27262976
  buffer_load_dwordx4 v[36:39], v0, s[4:7], s27 offen sc1
  buffer_load_dwordx4 v[40:43], v0, s[4:7], s28 offen sc1
  s_mov_b32 vcc_lo, 0xaaaaaaaa
  s_mov_b32 vcc_hi, 0xaaaaaaaa
  v_mov_b32 v3, 0x3f80
  v_mov_b32 v20, 1.0
  v_cndmask_b32 v3, v3, v20, vcc
  s_mov_b32 vcc_lo, 0x30003
  s_mov_b32 vcc_hi, 0x30003
  v_cndmask_b32 v20, 0, v3, vcc
  s_mov_b32 vcc_lo, 0xc000c
  s_mov_b32 vcc_hi, 0xc000c
  v_cndmask_b32 v21, 0, v3, vcc
  s_mov_b32 vcc_lo, 0x300030
  s_mov_b32 vcc_hi, 0x300030
  v_cndmask_b32 v22, 0, v3, vcc
  s_mov_b32 vcc_lo, 0xc000c0
  s_mov_b32 vcc_hi, 0xc000c0
  v_cndmask_b32 v23, 0, v3, vcc
  s_mov_b32 vcc_lo, 0x3000300
  s_mov_b32 vcc_hi, 0x3000300
  v_cndmask_b32 v24, 0, v3, vcc
  s_mov_b32 vcc_lo, 0xc000c00
  s_mov_b32 vcc_hi, 0xc000c00
  v_cndmask_b32 v25, 0, v3, vcc
  s_mov_b32 vcc_lo, 0x30003000
  s_mov_b32 vcc_hi, 0x30003000
  v_cndmask_b32 v26, 0, v3, vcc
  s_mov_b32 vcc_lo, 0xc000c000
  s_mov_b32 vcc_hi, 0xc000c000
  v_cndmask_b32 v27, 0, v3, vcc
  v_lshrrev_b32 v5, 1, v0
  s_lshl_b32 s26, s60, 9
  s_add_u32 s26, s26, 5287936
  s_mov_b32 s53, 0
m_w_72:
  buffer_load_dwordx2 v[44:45], v5, s[4:7], s26 offen sc1
  s_add_u32 s53, s53, 1
  s_cmp_gt_u32 s53, 1048576
  s_cbranch_scc1 q_fail_60
  s_waitcnt vmcnt(0)
  v_min_u32 v44, v44, v45
  v_cmp_gt_u32 vcc, s57, v44
  s_cbranch_vccnz m_w_72
  s_lshl_b32 s26, s60, 15
  s_add_u32 s26, s26, 35651584
  v_lshrrev_b32 v2, 8, v0
  v_and_b32 v3, 0xf0, v0
  v_lshl_add_u32 v3, v2, 10, v3
  buffer_load_dwordx4 v[60:63], v3, s[4:7], s26 offen offset:0 sc1
  buffer_load_dwordx4 v[64:67], v3, s[4:7], s26 offen offset:256 sc1
  buffer_load_dwordx4 v[68:71], v3, s[4:7], s26 offen offset:512 sc1
  buffer_load_dwordx4 v[72:75], v3, s[4:7], s26 offen offset:768 sc1
  s_add_u32 s26, s26, 4096
  buffer_load_dwordx4 v[76:79], v3, s[4:7], s26 offen offset:0 sc1
  buffer_load_dwordx4 v[80:83], v3, s[4:7], s26 offen offset:256 sc1
  buffer_load_dwordx4 v[84:87], v3, s[4:7], s26 offen offset:512 sc1
  buffer_load_dwordx4 v[88:91], v3, s[4:7], s26 offen offset:768 sc1
  s_add_u32 s26, s26, 4096
  buffer_load_dwordx4 v[92:95], v3, s[4:7], s26 offen offset:0 sc1
  buffer_load_dwordx4 v[96:99], v3, s[4:7], s26 offen offset:256 sc1
  buffer_load_dwordx4 v[100:103], v3, s[4:7], s26 offen offset:512 sc1
  buffer_load_dwordx4 v[104:107], v3, s[4:7], s26 offen offset:768 sc1
  s_add_u32 s26, s26, 4096
  buffer_load_dwordx4 v[108:111], v3, s[4:7], s26 offen offset:0 sc1
  buffer_load_dwordx4 v[112:115], v3, s[4:7], s26 offen offset:256 sc1
  buffer_load_dwordx4 v[116:119], v3, s[4:7], s26 offen offset:512 sc1
  buffer_load_dwordx4 v[120:123], v3, s[4:7], s26 offen offset:768 sc1
  s_add_u32 s26, s26, 4096
  v_lshlrev_b32 v44, 16, v36
  v_and_b32 v45, 0xffff0000, v36
  v_lshlrev_b32 v46, 16, v37
  v_and_b32 v47, 0xffff0000, v37
  v_lshlrev_b32 v48, 16, v38
  v_and_b32 v49, 0xffff0000, v38
  v_lshlrev_b32 v50, 16, v39
  v_and_b32 v51, 0xffff0000, v39
  v_lshlrev_b32 v52, 16, v40
  v_and_b32 v53, 0xffff0000, v40
  v_lshlrev_b32 v54, 16, v41
  v_and_b32 v55, 0xffff0000, v41
  v_lshlrev_b32 v56, 16, v42
  v_and_b32 v57, 0xffff0000, v42
  v_lshlrev_b32 v58, 16, v43
  v_and_b32 v59, 0xffff0000, v43
  s_and_b32 s29, s58, 0xffff0000
  s_xor_b32 s27, s29, 0x80000000
  s_xor_b32 s28, s29, 0xffff0000
  s_bitcmp1_b32 s29, 31
  s_cselect_b32 s29, s27, s28
  v_mov_b32 v36, s29
  v_mul_f32 v36, 0xbfb8aa3b, v36
  v_exp_f32 v36, v36
  s_nop 0
  v_add_f32 v36, 1.0, v36
  v_rcp_f32 v36, v36
  s_nop 0
  v_cvt_pk_bf16_f32 v36, 0, v36
  s_waitcnt vmcnt(15)
  v_mfma_f32_16x16x32_bf16 v[28:31], v[20:23], v[60:63], 0
  buffer_load_dwordx4 v[60:63], v3, s[4:7], s26 offen offset:0 sc1
  s_waitcnt vmcnt(15)
  v_mfma_f32_16x16x32_bf16 v[32:35], v[20:23], v[64:67], 0
  buffer_load_dwordx4 v[64:67], v3, s[4:7], s26 offen offset:256 sc1
  s_waitcnt vmcnt(15)
  v_mfma_f32_16x16x32_bf16 v[28:31], v[24:27], v[68:71], v[28:31]
  buffer_load_dwordx4 v[68:71], v3, s[4:7], s26 offen offset:512 sc1
  s_waitcnt vmcnt(15)
  v_mfma_f32_16x16x32_bf16 v[32:35], v[24:27], v[72:75], v[32:35]
  buffer_load_dwordx4 v[72:75], v3, s[4:7], s26 offen offset:768 sc1
  s_add_u32 s26, s26, 4096
  s_waitcnt vmcnt(15)
  v_mfma_f32_16x16x32_bf16 v[28:31], v[20:23], v[76:79], v[28:31]
  buffer_load_dwordx4 v[76:79], v3, s[4:7], s26 offen offset:0 sc1
  s_waitcnt vmcnt(15)
  v_mfma_f32_16x16x32_bf16 v[32:35], v[20:23], v[80:83], v[32:35]
  buffer_load_dwordx4 v[80:83], v3, s[4:7], s26 offen offset:256 sc1
  s_waitcnt vmcnt(15)
  v_mfma_f32_16x16x32_bf16 v[28:31], v[24:27], v[84:87], v[28:31]
  buffer_load_dwordx4 v[84:87], v3, s[4:7], s26 offen offset:512 sc1
  s_waitcnt vmcnt(15)
  v_mfma_f32_16x16x32_bf16 v[32:35], v[24:27], v[88:91], v[32:35]
  buffer_load_dwordx4 v[88:91], v3, s[4:7], s26 offen offset:768 sc1
  s_add_u32 s26, s26, 4096
  s_waitcnt vmcnt(15)
  v_mfma_f32_16x16x32_bf16 v[28:31], v[20:23], v[92:95], v[28:31]
  buffer_load_dwordx4 v[92:95], v3, s[4:7], s26 offen offset:0 sc1
  s_waitcnt vmcnt(15)
  v_mfma_f32_16x16x32_bf16 v[32:35], v[20:23], v[96:99], v[32:35]
  buffer_load_dwordx4 v[96:99], v3, s[4:7], s26 offen offset:256 sc1
  s_waitcnt vmcnt(15)
  v_mfma_f32_16x16x32_bf16 v[28:31], v[24:27], v[100:103], v[28:31]
  buffer_load_dwordx4 v[100:103], v3, s[4:7], s26 offen offset:512 sc1
  s_waitcnt vmcnt(15)
  v_mfma_f32_16x16x32_bf16 v[32:35], v[24:27], v[104:107], v[32:35]
  buffer_load_dwordx4 v[104:107], v3, s[4:7], s26 offen offset:768 sc1
  s_add_u32 s26, s26, 4096
  s_waitcnt vmcnt(15)
  v_mfma_f32_16x16x32_bf16 v[28:31], v[20:23], v[108:111], v[28:31]
  buffer_load_dwordx4 v[108:111], v3, s[4:7], s26 offen offset:0 sc1
  s_waitcnt vmcnt(15)
  v_mfma_f32_16x16x32_bf16 v[32:35], v[20:23], v[112:115], v[32:35]
  buffer_load_dwordx4 v[112:115], v3, s[4:7], s26 offen offset:256 sc1
  s_waitcnt vmcnt(15)
  v_mfma_f32_16x16x32_bf16 v[28:31], v[24:27], v[116:119], v[28:31]
  buffer_load_dwordx4 v[116:119], v3, s[4:7], s26 offen offset:512 sc1
  s_waitcnt vmcnt(15)
  v_mfma_f32_16x16x32_bf16 v[32:35], v[24:27], v[120:123], v[32:35]
  buffer_load_dwordx4 v[120:123], v3, s[4:7], s26 offen offset:768 sc1
  s_add_u32 s26, s26, 4096
  s_waitcnt vmcnt(15)
  v_mfma_f32_16x16x32_bf16 v[28:31], v[20:23], v[60:63], v[28:31]
  s_waitcnt vmcnt(14)
  v_mfma_f32_16x16x32_bf16 v[32:35], v[20:23], v[64:67], v[32:35]
  s_waitcnt vmcnt(13)
  v_mfma_f32_16x16x32_bf16 v[28:31], v[24:27], v[68:71], v[28:31]
  s_waitcnt vmcnt(12)
  v_mfma_f32_16x16x32_bf16 v[32:35], v[24:27], v[72:75], v[32:35]
  s_waitcnt vmcnt(11)
  v_mfma_f32_16x16x32_bf16 v[28:31], v[20:23], v[76:79], v[28:31]
  s_waitcnt vmcnt(10)
  v_mfma_f32_16x16x32_bf16 v[32:35], v[20:23], v[80:83], v[32:35]
  s_waitcnt vmcnt(9)
  v_mfma_f32_16x16x32_bf16 v[28:31], v[24:27], v[84:87], v[28:31]
  s_waitcnt vmcnt(8)
  v_mfma_f32_16x16x32_bf16 v[32:35], v[24:27], v[88:91], v[32:35]
  s_waitcnt vmcnt(7)
  v_mfma_f32_16x16x32_bf16 v[28:31], v[20:23], v[92:95], v[28:31]
  s_waitcnt vmcnt(6)
  v_mfma_f32_16x16x32_bf16 v[32:35], v[20:23], v[96:99], v[32:35]
  s_waitcnt vmcnt(5)
  v_mfma_f32_16x16x32_bf16 v[28:31], v[24:27], v[100:103], v[28:31]
  s_waitcnt vmcnt(4)
  v_mfma_f32_16x16x32_bf16 v[32:35], v[24:27], v[104:107], v[32:35]
  s_waitcnt vmcnt(3)
  v_mfma_f32_16x16x32_bf16 v[28:31], v[20:23], v[108:111], v[28:31]
  s_waitcnt vmcnt(2)
  v_mfma_f32_16x16x32_bf16 v[32:35], v[20:23], v[112:115], v[32:35]
  s_waitcnt vmcnt(1)
  v_mfma_f32_16x16x32_bf16 v[28:31], v[24:27], v[116:119], v[28:31]
  s_waitcnt vmcnt(0)
  v_mfma_f32_16x16x32_bf16 v[32:35], v[24:27], v[120:123], v[32:35]
  s_nop 1
  s_nop 1
  s_nop 1
  s_nop 1
  v_permlane16_swap_b32 v28, v32
  v_permlane16_swap_b32 v29, v33
  v_permlane16_swap_b32 v30, v34
  v_permlane16_swap_b32 v31, v35
  v_cvt_pk_bf16_f32 v28, 0, v28
  v_cvt_pk_bf16_f32 v29, 0, v29
  v_cvt_pk_bf16_f32 v30, 0, v30
  v_cvt_pk_bf16_f32 v31, 0, v31
  v_cvt_pk_bf16_f32 v32, 0, v32
  v_cvt_pk_bf16_f32 v33, 0, v33
  v_cvt_pk_bf16_f32 v34, 0, v34
  v_cvt_pk_bf16_f32 v35, 0, v35
  v_mul_f32 v28, v28, v36
  v_mul_f32 v29, v29, v36
  v_mul_f32 v30, v30, v36
  v_mul_f32 v31, v31, v36
  v_mul_f32 v32, v32, v36
  v_mul_f32 v33, v33, v36
  v_mul_f32 v34, v34, v36
  v_mul_f32 v35, v35, v36
  v_cvt_pk_bf16_f32 v28, 0, v28
  v_cvt_pk_bf16_f32 v29, 0, v29
  v_cvt_pk_bf16_f32 v30, 0, v30
  v_cvt_pk_bf16_f32 v31, 0, v31
  v_cvt_pk_bf16_f32 v32, 0, v32
  v_cvt_pk_bf16_f32 v33, 0, v33
  v_cvt_pk_bf16_f32 v34, 0, v34
  v_cvt_pk_bf16_f32 v35, 0, v35
  v_add_f32 v28, v28, v52
  v_add_f32 v29, v29, v53
  v_add_f32 v30, v30, v54
  v_add_f32 v31, v31, v55
  v_add_f32 v32, v32, v56
  v_add_f32 v33, v33, v57
  v_add_f32 v34, v34, v58
  v_add_f32 v35, v35, v59
  v_cvt_pk_bf16_f32 v28, 0, v28
  v_cvt_pk_bf16_f32 v29, 0, v29
  v_cvt_pk_bf16_f32 v30, 0, v30
  v_cvt_pk_bf16_f32 v31, 0, v31
  v_cvt_pk_bf16_f32 v32, 0, v32
  v_cvt_pk_bf16_f32 v33, 0, v33
  v_cvt_pk_bf16_f32 v34, 0, v34
  v_cvt_pk_bf16_f32 v35, 0, v35
  v_add_f32 v44, v44, v28
  v_add_f32 v45, v45, v29
  v_add_f32 v46, v46, v30
  v_add_f32 v47, v47, v31
  v_add_f32 v48, v48, v32
  v_add_f32 v49, v49, v33
  v_add_f32 v50, v50, v34
  v_add_f32 v51, v51, v35
  v_cvt_pk_bf16_f32 v40, v44, v45
  v_cvt_pk_bf16_f32 v41, v46, v47
  v_cvt_pk_bf16_f32 v42, v48, v49
  v_cvt_pk_bf16_f32 v43, v50, v51
  v_lshlrev_b32 v44, 16, v40
  v_and_b32 v45, 0xffff0000, v40
  v_lshlrev_b32 v46, 16, v41
  v_and_b32 v47, 0xffff0000, v41
  v_lshlrev_b32 v48, 16, v42
  v_and_b32 v49, 0xffff0000, v42
  v_lshlrev_b32 v50, 16, v43
  v_and_b32 v51, 0xffff0000, v43
  s_and_b32 s28, s46, 63
  s_lshl_b32 s27, s28, 11
  s_add_u32 s27, s27, 36700160
  buffer_store_dwordx4 v[40:43], v0, s[4:7], s27 offen sc1
  v_add_f32 v60, v44, v45
  v_add_f32 v61, v46, v47
  v_add_f32 v62, v48, v49
  v_add_f32 v63, v50, v51
  v_add_f32 v60, v60, v61
  v_add_f32 v62, v62, v63
  v_add_f32 v60, v60, v62
  s_nop 1
  v_add_f32_dpp v60, v60, v60 row_ror:8 row_mask:0xf bank_mask:0xf
  s_nop 1
  v_add_f32_dpp v60, v60, v60 row_ror:4 row_mask:0xf bank_mask:0xf
  s_nop 1
  v_add_f32_dpp v60, v60, v60 row_ror:2 row_mask:0xf bank_mask:0xf
  s_nop 1
  v_add_f32_dpp v60, v60, v60 row_ror:1 row_mask:0xf bank_mask:0xf
  v_mov_b32 v62, v60
  s_nop 0
  s_nop 0
  v_permlane16_swap_b32 v60, v62
  v_add_f32 v60, v60, v62
  v_mov_b32 v62, v60
  s_nop 0
  s_nop 0
  v_permlane32_swap_b32 v60, v62
  v_add_f32 v60, v60, v62
  v_mul_f32 v60, 0x3b000000, v60
  v_sub_f32 v64, v44, v60
  v_sub_f32 v65, v45, v60
  v_sub_f32 v66, v46, v60
  v_sub_f32 v67, v47, v60
  v_sub_f32 v68, v48, v60
  v_sub_f32 v69, v49, v60
  v_sub_f32 v70, v50, v60
  v_sub_f32 v71, v51, v60
  v_mul_f32 v61, v64, v64
  v_mul_f32 v62, v65, v65
  v_fmac_f32 v61, v66, v66
  v_fmac_f32 v62, v67, v67
  v_fmac_f32 v61, v68, v68
  v_fmac_f32 v62, v69, v69
  v_fmac_f32 v61, v70, v70
  v_fmac_f32 v62, v71, v71
  v_add_f32 v61, v61, v62
  v_cvt_pk_bf16_f32 v60, 0, v60
  s_nop 0
  v_add_f32_dpp v61, v61, v61 row_ror:8 row_mask:0xf bank_mask:0xf
  v_sub_f32 v64, v44, v60
  v_sub_f32 v65, v45, v60
  v_add_f32_dpp v61, v61, v61 row_ror:4 row_mask:0xf bank_mask:0xf
  v_sub_f32 v66, v46, v60
  v_sub_f32 v67, v47, v60
  v_add_f32_dpp v61, v61, v61 row_ror:2 row_mask:0xf bank_mask:0xf
  v_sub_f32 v68, v48, v60
  v_sub_f32 v69, v49, v60
  v_add_f32_dpp v61, v61, v61 row_ror:1 row_mask:0xf bank_mask:0xf
  v_sub_f32 v70, v50, v60
  v_sub_f32 v71, v51, v60
  v_mov_b32 v62, v61
  v_cvt_pk_bf16_f32 v64, 0, v64
  v_cvt_pk_bf16_f32 v65, 0, v65
  v_permlane16_swap_b32 v61, v62
  v_cvt_pk_bf16_f32 v66, 0, v66
  v_cvt_pk_bf16_f32 v67, 0, v67
  v_add_f32 v61, v61, v62
  v_cvt_pk_bf16_f32 v68, 0, v68
  v_cvt_pk_bf16_f32 v69, 0, v69
  v_mov_b32 v62, v61
  v_cvt_pk_bf16_f32 v70, 0, v70
  v_cvt_pk_bf16_f32 v71, 0, v71
  v_permlane32_swap_b32 v61, v62
  v_add_f32 v61, v61, v62
  v_mul_f32 v61, 0x3b000000, v61
  v_cvt_pk_bf16_f32 v61, 0, v61
  v_add_f32 v61, 0x3727c5ac, v61
  v_cvt_pk_bf16_f32 v61, 0, v61
  v_sqrt_f32 v61, v61
  s_nop 0
  v_cvt_pk_bf16_f32 v61, 0, v61
  v_rcp_f32 v61, v61
  s_nop 0
  v_mul_f32 v64, v64, v61
  v_mul_f32 v65, v65, v61
  v_mul_f32 v66, v66, v61
  v_mul_f32 v67, v67, v61
  v_mul_f32 v68, v68, v61
  v_mul_f32 v69, v69, v61
  v_mul_f32 v70, v70, v61
  v_mul_f32 v71, v71, v61
  v_cvt_pk_bf16_f32 v72, v64, v65
  v_cvt_pk_bf16_f32 v73, v66, v67
  v_cvt_pk_bf16_f32 v74, v68, v69
  v_cvt_pk_bf16_f32 v75, v70, v71
  buffer_store_dwordx4 v[72:75], v0, s[4:7], s27 offen offset:1024 sc1
  v_mov_b32 v5, s58
  s_lshl_b32 s27, s28, 7
  s_add_u32 s27, s27, 5292032
  s_waitcnt vmcnt(0)
  s_mov_b64 exec, 1
  buffer_store_dword v5, off, s[4:7], s27 sc1
  s_mov_b64 exec, -1
m_done_71:
  s_branch q_decr_67
q_nof_69:
  s_and_b32 s26, s46, 63
  s_lshl_b32 s26, s26, 5
  s_add_u32 s26, s26, s16
  s_lshl_b32 s26, s26, 2
  s_add_u32 s26, s26, s17
  s_lshl_b32 s26, s26, 2
  s_add_u32 s26, s26, 5373952
  v_mov_b32 v3, 2
  s_mov_b64 exec, 1
  buffer_store_dword v3, off, s[4:7], s26 sc1
  s_mov_b64 exec, -1
  s_branch q_decr_67
q_end_55:
  s_waitcnt vmcnt(0)
  s_mov_b64 exec, 1
  buffer_store_dword v4, off, s[4:7], s49 sc1
  s_mov_b64 exec, -1
  s_mov_b32 s49, 268435456
  s_cmp_lg_u32 s60, 1
  s_cbranch_scc1 q_fail_60
  s_load_dwordx2 s[72:73], s[0:1], 96
  s_mov_b32 s74, 2097152
  s_mov_b32 s75, 0x20000
  s_add_u32 s57, s57, 1
  s_load_dwordx2 s[64:65], s[0:1], 72
  s_load_dwordx2 s[68:69], s[0:1], 80
  s_load_dwordx2 s[8:9], s[0:1], 88
  s_mov_b32 s66, 1835008
  s_mov_b32 s67, 0x20000
  s_mov_b32 s70, 1835008
  s_mov_b32 s71, 0x20000
  s_mov_b32 s10, 1835008
  v_lshrrev_b32 v2, 8, v0
  v_and_b32 v3, 0x70, v0
  s_mov_b32 s26, 114688
  v_mul_lo_u32 v6, v2, s26
  v_add_u32 v6, v6, v3
  v_cmp_eq_u32 vcc, 0x70, v3
  v_mov_b32 v3, 0x7ff00000
  s_nop 0
  v_cndmask_b32 v6, v6, v3, vcc
  v_mul_u32_u24 v7, 14336, v2
  v_and_b32 v3, 0xf0, v0
  v_add_u32 v7, v7, v3
  s_mul_i32 s34, s17, 458752
  s_mul_i32 s27, s16, 112
  s_add_u32 s34, s34, s27
  s_mul_i32 s35, s16, 57344
  s_lshl_b32 s27, s17, 8
  s_add_u32 s35, s35, s27
  s_mov_b32 s36, 0x00ff00ff
  s_mov_b32 s37, 0x00ff00ff
  s_waitcnt lgkmcnt(0)
  s_mov_b64 exec, s[36:37]
  buffer_load_dwordx4 a[0:3], v6, s[64:67], s34 offen
  s_not_b64 exec, exec
  buffer_load_dwordx4 a[0:3], v6, s[68:71], s34 offen
  s_mov_b64 exec, -1
  s_add_u32 s34, s34, 3584
  s_mov_b64 exec, s[36:37]
  buffer_load_dwordx4 a[4:7], v6, s[64:67], s34 offen
  s_not_b64 exec, exec
  buffer_load_dwordx4 a[4:7], v6, s[68:71], s34 offen
  s_mov_b64 exec, -1
  s_add_u32 s34, s34, 3584
  s_mov_b64 exec, s[36:37]
  buffer_load_dwordx4 a[8:11], v6, s[64:67], s34 offen
  s_not_b64 exec, exec
  buffer_load_dwordx4 a[8:11], v6, s[68:71], s34 offen
  s_mov_b64 exec, -1
  s_add_u32 s34, s34, 3584
  s_mov_b64 exec, s[36:37]
  buffer_load_dwordx4 a[12:15], v6, s[64:67], s34 offen
  s_not_b64 exec, exec
  buffer_load_dwordx4 a[12:15], v6, s[68:71], s34 offen
  s_mov_b64 exec, -1
  s_add_u32 s34, s34, 3584
  s_mov_b64 exec, s[36:37]
  buffer_load_dwordx4 a[16:19], v6, s[64:67], s34 offen
  s_not_b64 exec, exec
  buffer_load_dwordx4 a[16:19], v6, s[68:71], s34 offen
  s_mov_b64 exec, -1
  s_add_u32 s34, s34, 3584
  s_mov_b64 exec, s[36:37]
  buffer_load_dwordx4 a[20:23], v6, s[64:67], s34 offen
  s_not_b64 exec, exec
  buffer_load_dwordx4 a[20:23], v6, s[68:71], s34 offen
  s_mov_b64 exec, -1
  s_add_u32 s34, s34, 3584
  s_mov_b64 exec, s[36:37]
  buffer_load_dwordx4 a[24:27], v6, s[64:67], s34 offen
  s_not_b64 exec, exec
  buffer_load_dwordx4 a[24:27], v6, s[68:71], s34 offen
  s_mov_b64 exec, -1
  s_add_u32 s34, s34, 3584
  s_mov_b64 exec, s[36:37]
  buffer_load_dwordx4 a[28:31], v6, s[64:67], s34 offen
  s_not_b64 exec, exec
  buffer_load_dwordx4 a[28:31], v6, s[68:71], s34 offen
  s_mov_b64 exec, -1
  s_add_u32 s34, s34, 3584
  s_mov_b64 exec, s[36:37]
  buffer_load_dwordx4 a[32:35], v6, s[64:67], s34 offen
  s_not_b64 exec, exec
  buffer_load_dwordx4 a[32:35], v6, s[68:71], s34 offen
  s_mov_b64 exec, -1
  s_add_u32 s34, s34, 3584
  s_mov_b64 exec, s[36:37]
  buffer_load_dwordx4 a[36:39], v6, s[64:67], s34 offen
  s_not_b64 exec, exec
  buffer_load_dwordx4 a[36:39], v6, s[68:71], s34 offen
  s_mov_b64 exec, -1
  s_add_u32 s34, s34, 3584
  s_mov_b64 exec, s[36:37]
  buffer_load_dwordx4 a[40:43], v6, s[64:67], s34 offen
  s_not_b64 exec, exec
  buffer_load_dwordx4 a[40:43], v6, s[68:71], s34 offen
  s_mov_b64 exec, -1
  s_add_u32 s34, s34, 3584
  s_mov_b64 exec, s[36:37]
  buffer_load_dwordx4 a[44:47], v6, s[64:67], s34 offen
  s_not_b64 exec, exec
  buffer_load_dwordx4 a[44:47], v6, s[68:71], s34 offen
  s_mov_b64 exec, -1
  s_add_u32 s34, s34, 3584
  s_mov_b64 exec, s[36:37]
  buffer_load_dwordx4 a[48:51], v6, s[64:67], s34 offen
  s_not_b64 exec, exec
  buffer_load_dwordx4 a[48:51], v6, s[68:71], s34 offen
  s_mov_b64 exec, -1
  s_add_u32 s34, s34, 3584
  s_mov_b64 exec, s[36:37]
  buffer_load_dwordx4 a[52:55], v6, s[64:67], s34 offen
  s_not_b64 exec, exec
  buffer_load_dwordx4 a[52:55], v6, s[68:71], s34 offen
  s_mov_b64 exec, -1
  s_add_u32 s34, s34, 3584
  s_mov_b64 exec, s[36:37]
  buffer_load_dwordx4 a[56:59], v6, s[64:67], s34 offen
  s_not_b64 exec, exec
  buffer_load_dwordx4 a[56:59], v6, s[68:71], s34 offen
  s_mov_b64 exec, -1
  s_add_u32 s34, s34, 3584
  s_mov_b64 exec, s[36:37]
  buffer_load_dwordx4 a[60:63], v6, s[64:67], s34 offen
  s_not_b64 exec, exec
  buffer_load_dwordx4 a[60:63], v6, s[68:71], s34 offen
  s_mov_b64 exec, -1
  s_add_u32 s34, s34, 3584
  s_mov_b64 exec, s[36:37]
  buffer_load_dwordx4 a[64:67], v6, s[64:67], s34 offen
  s_not_b64 exec, exec
  buffer_load_dwordx4 a[64:67], v6, s[68:71], s34 offen
  s_mov_b64 exec, -1
  s_add_u32 s34, s34, 3584
  s_mov_b64 exec, s[36:37]
  buffer_load_dwordx4 a[68:71], v6, s[64:67], s34 offen
  s_not_b64 exec, exec
  buffer_load_dwordx4 a[68:71], v6, s[68:71], s34 offen
  s_mov_b64 exec, -1
  s_add_u32 s34, s34, 3584
  s_mov_b64 exec, s[36:37]
  buffer_load_dwordx4 a[72:75], v6, s[64:67], s34 offen
  s_not_b64 exec, exec
  buffer_load_dwordx4 a[72:75], v6, s[68:71], s34 offen
  s_mov_b64 exec, -1
  s_add_u32 s34, s34, 3584
  s_mov_b64 exec, s[36:37]
  buffer_load_dwordx4 a[76:79], v6, s[64:67], s34 offen
  s_not_b64 exec, exec
  buffer_load_dwordx4 a[76:79], v6, s[68:71], s34 offen
  s_mov_b64 exec, -1
  s_add_u32 s34, s34, 3584
  s_mov_b64 exec, s[36:37]
  buffer_load_dwordx4 a[80:83], v6, s[64:67], s34 offen
  s_not_b64 exec, exec
  buffer_load_dwordx4 a[80:83], v6, s[68:71], s34 offen
  s_mov_b64 exec, -1
  s_add_u32 s34, s34, 3584
  s_mov_b64 exec, s[36:37]
  buffer_load_dwordx4 a[84:87], v6, s[64:67], s34 offen
  s_not_b64 exec, exec
  buffer_load_dwordx4 a[84:87], v6, s[68:71], s34 offen
  s_mov_b64 exec, -1
  s_add_u32 s34, s34, 3584
  s_mov_b64 exec, s[36:37]
  buffer_load_dwordx4 a[88:91], v6, s[64:67], s34 offen
  s_not_b64 exec, exec
  buffer_load_dwordx4 a[88:91], v6, s[68:71], s34 offen
  s_mov_b64 exec, -1
  s_add_u32 s34, s34, 3584
  s_mov_b64 exec, s[36:37]
  buffer_load_dwordx4 a[92:95], v6, s[64:67], s34 offen
  s_not_b64 exec, exec
  buffer_load_dwordx4 a[92:95], v6, s[68:71], s34 offen
  s_mov_b64 exec, -1
  s_add_u32 s34, s34, 3584
  s_mov_b64 exec, s[36:37]
  buffer_load_dwordx4 a[96:99], v6, s[64:67], s34 offen
  s_not_b64 exec, exec
  buffer_load_dwordx4 a[96:99], v6, s[68:71], s34 offen
  s_mov_b64 exec, -1
  s_add_u32 s34, s34, 3584
  s_mov_b64 exec, s[36:37]
  buffer_load_dwordx4 a[100:103], v6, s[64:67], s34 offen
  s_not_b64 exec, exec
  buffer_load_dwordx4 a[100:103], v6, s[68:71], s34 offen
  s_mov_b64 exec, -1
  s_add_u32 s34, s34, 3584
  s_mov_b64 exec, s[36:37]
  buffer_load_dwordx4 a[104:107], v6, s[64:67], s34 offen
  s_not_b64 exec, exec
  buffer_load_dwordx4 a[104:107], v6, s[68:71], s34 offen
  s_mov_b64 exec, -1
  s_add_u32 s34, s34, 3584
  s_mov_b64 exec, s[36:37]
  buffer_load_dwordx4 a[108:111], v6, s[64:67], s34 offen
  s_not_b64 exec, exec
  buffer_load_dwordx4 a[108:111], v6, s[68:71], s34 offen
  s_mov_b64 exec, -1
  s_add_u32 s34, s34, 3584
  s_mov_b64 exec, s[36:37]
  buffer_load_dwordx4 a[112:115], v6, s[64:67], s34 offen
  s_not_b64 exec, exec
  buffer_load_dwordx4 a[112:115], v6, s[68:71], s34 offen
  s_mov_b64 exec, -1
  s_add_u32 s34, s34, 3584
  s_waitcnt vmcnt(49)
  s_mov_b64 exec, s[36:37]
  buffer_load_dwordx4 a[116:119], v6, s[64:67], s34 offen
  s_not_b64 exec, exec
  buffer_load_dwordx4 a[116:119], v6, s[68:71], s34 offen
  s_mov_b64 exec, -1
  s_add_u32 s34, s34, 3584
  s_mov_b64 exec, s[36:37]
  buffer_load_dwordx4 a[120:123], v6, s[64:67], s34 offen
  s_not_b64 exec, exec
  buffer_load_dwordx4 a[120:123], v6, s[68:71], s34 offen
  s_mov_b64 exec, -1
  s_add_u32 s34, s34, 3584
  s_mov_b64 exec, s[36:37]
  buffer_load_dwordx4 a[124:127], v6, s[64:67], s34 offen
  s_not_b64 exec, exec
  buffer_load_dwordx4 a[124:127], v6, s[68:71], s34 offen
  s_mov_b64 exec, -1
  s_add_u32 s34, s34, 3584
  buffer_load_dwordx4 a[128:131], v7, s[8:11], s35 offen offset:0
  buffer_load_dwordx4 a[132:135], v7, s[8:11], s35 offen offset:1024
  s_waitcnt vmcnt(48)
  buffer_load_dwordx4 a[136:139], v7, s[8:11], s35 offen offset:2048
  buffer_load_dwordx4 a[140:143], v7, s[8:11], s35 offen offset:3072
  s_add_u32 s35, s35, 4096
  buffer_load_dwordx4 a[144:147], v7, s[8:11], s35 offen offset:0
  buffer_load_dwordx4 a[148:151], v7, s[8:11], s35 offen offset:1024
  buffer_load_dwordx4 a[152:155], v7, s[8:11], s35 offen offset:2048
  buffer_load_dwordx4 a[156:159], v7, s[8:11], s35 offen offset:3072
  s_add_u32 s35, s35, 4096
  buffer_load_dwordx4 a[160:163], v7, s[8:11], s35 offen offset:0
  buffer_load_dwordx4 a[164:167], v7, s[8:11], s35 offen offset:1024
  buffer_load_dwordx4 a[168:171], v7, s[8:11], s35 offen offset:2048
  s_waitcnt vmcnt(48)
  buffer_load_dwordx4 a[172:175], v7, s[8:11], s35 offen offset:3072
  s_add_u32 s35, s35, 4096
  buffer_load_dwordx4 a[176:179], v7, s[8:11], s35 offen offset:0
  buffer_load_dwordx4 a[180:183], v7, s[8:11], s35 offen offset:1024
  s_mov_b32 s53, 0
  s_mov_b32 s26, 5275648
  s_mov_b32 s27, 5279744
k_w_73:
  buffer_load_dwordx4 v[20:23], v0, s[4:7], s26 offen offset:0 sc1
  buffer_load_dwordx4 v[24:27], v0, s[4:7], s26 offen offset:1024 sc1
  buffer_load_dwordx4 v[28:31], v0, s[4:7], s26 offen offset:2048 sc1
  buffer_load_dwordx4 v[32:35], v0, s[4:7], s26 offen offset:3072 sc1
  buffer_load_dwordx4 v[36:39], v0, s[4:7], s27 offen offset:0 sc1
  buffer_load_dwordx4 v[40:43], v0, s[4:7], s27 offen offset:1024 sc1
  buffer_load_dwordx4 v[44:47], v0, s[4:7], s27 offen offset:2048 sc1
  buffer_load_dwordx4 v[48:51], v0, s[4:7], s27 offen offset:3072 sc1
  s_add_u32 s53, s53, 1
  s_cmp_gt_u32 s53, 1048576
  s_cbranch_scc1 q_fail_60
  s_waitcnt vmcnt(0)
  v_min_u32 v52, v20, v21
  v_max_u32 v53, v20, v21
  v_min3_u32 v52, v22, v23, v52
  v_max3_u32 v53, v22, v23, v53
  v_min3_u32 v52, v24, v25, v52
  v_max3_u32 v53, v24, v25, v53
  v_min3_u32 v52, v26, v27, v52
  v_max3_u32 v53, v26, v27, v53
  v_min3_u32 v52, v28, v29, v52
  v_max3_u32 v53, v28, v29, v53
  v_min3_u32 v52, v30, v31, v52
  v_max3_u32 v53, v30, v31, v53
  v_min3_u32 v52, v32, v33, v52
  v_max3_u32 v53, v32, v33, v53
  v_min3_u32 v52, v34, v35, v52
  v_max3_u32 v53, v34, v35, v53
  v_min3_u32 v52, v36, v37, v52
  v_max3_u32 v53, v36, v37, v53
  v_min3_u32 v52, v38, v39, v52
  v_max3_u32 v53, v38, v39, v53
  v_min3_u32 v52, v40, v41, v52
  v_max3_u32 v53, v40, v41, v53
  v_min3_u32 v52, v42, v43, v52
  v_max3_u32 v53, v42, v43, v53
  v_min3_u32 v52, v44, v45, v52
  v_max3_u32 v53, v44, v45, v53
  v_min3_u32 v52, v46, v47, v52
  v_max3_u32 v53, v46, v47, v53
  v_min3_u32 v52, v48, v49, v52
  v_max3_u32 v53, v48, v49, v53
  v_min3_u32 v52, v50, v51, v52
  v_max3_u32 v53, v50, v51, v53
  v_cmp_eq_u32 vcc, 0, v52
  s_cbranch_vccnz k_w_73
  v_max_u32_dpp v53, v53, v53 row_ror:8 row_mask:0xf bank_mask:0xf
  s_nop 1
  v_max_u32_dpp v53, v53, v53 row_ror:4 row_mask:0xf bank_mask:0xf
  s_nop 1
  v_max_u32_dpp v53, v53, v53 row_ror:2 row_mask:0xf bank_mask:0xf
  s_nop 1
  v_max_u32_dpp v53, v53, v53 row_ror:1 row_mask:0xf bank_mask:0xf
  v_mov_b32 v52, v53
  s_nop 0
  s_nop 0
  v_permlane16_swap_b32 v53, v52
  v_max_u32 v53, v53, v52
  v_mov_b32 v52, v53
  s_nop 0
  s_nop 0
  v_permlane32_swap_b32 v53, v52
  v_max_u32 v53, v53, v52
  s_nop 0
  v_readfirstlane_b32 s58, v53
  s_andn2_b32 s26, 0xfe0, s56
  s_andn2_b32 s27, 0xfe0, s58
  s_cmp_lt_u32 s27, s26
  s_cselect_b32 s61, 1, 2
  s_andn2_b32 s59, 0xfff, s58
  s_lshl_b32 s26, s61, 21
  s_lshl_b32 s27, s59, 10
  s_add_u32 s32, s26, s27
  s_lshl_b32 s27, s17, 8
  s_add_u32 s26, s32, s27
  s_add_u32 s26, s26, 27262976
  v_lshrrev_b32 v3, 8, v0
  v_lshlrev_b32 v3, 6, v3
  buffer_load_dwordx4 v[36:39], v3, s[4:7], s26 offen offset:0 sc1
  buffer_load_dwordx4 v[40:43], v3, s[4:7], s26 offen offset:16 sc1
  buffer_load_dwordx4 v[44:47], v3, s[4:7], s26 offen offset:32 sc1
  buffer_load_dwordx4 v[48:51], v3, s[4:7], s26 offen offset:48 sc1
  s_mov_b32 vcc_lo, 0xaaaaaaaa
  s_mov_b32 vcc_hi, 0xaaaaaaaa
  v_mov_b32 v3, 0xffff
  v_mov_b32 v28, 0xffff0000
  v_cndmask_b32 v3, v3, v28, vcc
  s_mov_b32 vcc_lo, 0x30003
  s_mov_b32 vcc_hi, 0x30003
  v_cndmask_b32 v28, 0, v3, vcc
  s_mov_b32 vcc_lo, 0xc000c
  s_mov_b32 vcc_hi, 0xc000c
  v_cndmask_b32 v29, 0, v3, vcc
  s_mov_b32 vcc_lo, 0x300030
  s_mov_b32 vcc_hi, 0x300030
  v_cndmask_b32 v30, 0, v3, vcc
  s_mov_b32 vcc_lo, 0xc000c0
  s_mov_b32 vcc_hi, 0xc000c0
  v_cndmask_b32 v31, 0, v3, vcc
  s_mov_b32 s30, 0x01000100
  s_mov_b32 s31, 0x03020302
  s_waitcnt vmcnt(0)
  v_perm_b32 v3, v36, v36, s30
  v_and_b32 v20, v28, v3
  v_and_b32 v21, v29, v3
  v_and_b32 v22, v30, v3
  v_and_b32 v23, v31, v3
  s_nop 0
  s_nop 0
  v_mfma_f32_16x16x32_bf16 v[32:35], v[20:23], a[0:3], 0
  v_perm_b32 v3, v36, v36, s31
  v_and_b32 v24, v28, v3
  v_and_b32 v25, v29, v3
  v_and_b32 v26, v30, v3
  v_and_b32 v27, v31, v3
  s_nop 0
  s_nop 0
  v_mfma_f32_16x16x32_bf16 v[32:35], v[24:27], a[4:7], v[32:35]
  v_perm_b32 v3, v37, v37, s30
  v_and_b32 v20, v28, v3
  v_and_b32 v21, v29, v3
  v_and_b32 v22, v30, v3
  v_and_b32 v23, v31, v3
  s_nop 0
  s_nop 0
  v_mfma_f32_16x16x32_bf16 v[32:35], v[20:23], a[8:11], v[32:35]
  v_perm_b32 v3, v37, v37, s31
  v_and_b32 v24, v28, v3
  v_and_b32 v25, v29, v3
  v_and_b32 v26, v30, v3
  v_and_b32 v27, v31, v3
  s_nop 0
  s_nop 0
  v_mfma_f32_16x16x32_bf16 v[32:35], v[24:27], a[12:15], v[32:35]
  v_perm_b32 v3, v38, v38, s30
  v_and_b32 v20, v28, v3
  v_and_b32 v21, v29, v3
  v_and_b32 v22, v30, v3
  v_and_b32 v23, v31, v3
  s_nop 0
  s_nop 0
  v_mfma_f32_16x16x32_bf16 v[32:35], v[20:23], a[16:19], v[32:35]
  v_perm_b32 v3, v38, v38, s31
  v_and_b32 v24, v28, v3
  v_and_b32 v25, v29, v3
  v_and_b32 v26, v30, v3
  v_and_b32 v27, v31, v3
  s_nop 0
  s_nop 0
  v_mfma_f32_16x16x32_bf16 v[32:35], v[24:27], a[20:23], v[32:35]
  v_perm_b32 v3, v39, v39, s30
  v_and_b32 v20, v28, v3
  v_and_b32 v21, v29, v3
  v_and_b32 v22, v30, v3
  v_and_b32 v23, v31, v3
  s_nop 0
  s_nop 0
  v_mfma_f32_16x16x32_bf16 v[32:35], v[20:23], a[24:27], v[32:35]
  v_perm_b32 v3, v39, v39, s31
  v_and_b32 v24, v28, v3
  v_and_b32 v25, v29, v3
  v_and_b32 v26, v30, v3
  v_and_b32 v27, v31, v3
  s_nop 0
  s_nop 0
  v_mfma_f32_16x16x32_bf16 v[32:35], v[24:27], a[28:31], v[32:35]
  v_perm_b32 v3, v40, v40, s30
  v_and_b32 v20, v28, v3
  v_and_b32 v21, v29, v3
  v_and_b32 v22, v30, v3
  v_and_b32 v23, v31, v3
  s_nop 0
  s_nop 0
  v_mfma_f32_16x16x32_bf16 v[32:35], v[20:23], a[32:35], v[32:35]
  v_perm_b32 v3, v40, v40, s31
  v_and_b32 v24, v28, v3
  v_and_b32 v25, v29, v3
  v_and_b32 v26, v30, v3
  v_and_b32 v27, v31, v3
  s_nop 0
  s_nop 0
  v_mfma_f32_16x16x32_bf16 v[32:35], v[24:27], a[36:39], v[32:35]
  v_perm_b32 v3, v41, v41, s30
  v_and_b32 v20, v28, v3
  v_and_b32 v21, v29, v3
  v_and_b32 v22, v30, v3
  v_and_b32 v23, v31, v3
  s_nop 0
  s_nop 0
  v_mfma_f32_16x16x32_bf16 v[32:35], v[20:23], a[40:43], v[32:35]
  v_perm_b32 v3, v41, v41, s31
  v_and_b32 v24, v28, v3
  v_and_b32 v25, v29, v3
  v_and_b32 v26, v30, v3
  v_and_b32 v27, v31, v3
  s_nop 0
  s_nop 0
  v_mfma_f32_16x16x32_bf16 v[32:35], v[24:27], a[44:47], v[32:35]
  v_perm_b32 v3, v42, v42, s30
  v_and_b32 v20, v28, v3
  v_and_b32 v21, v29, v3
  v_and_b32 v22, v30, v3
  v_and_b32 v23, v31, v3
  s_nop 0
  s_nop 0
  v_mfma_f32_16x16x32_bf16 v[32:35], v[20:23], a[48:51], v[32:35]
  v_perm_b32 v3, v42, v42, s31
  v_and_b32 v24, v28, v3
  v_and_b32 v25, v29, v3
  v_and_b32 v26, v30, v3
  v_and_b32 v27, v31, v3
  s_nop 0
  s_nop 0
  v_mfma_f32_16x16x32_bf16 v[32:35], v[24:27], a[52:55], v[32:35]
  v_perm_b32 v3, v43, v43, s30
  v_and_b32 v20, v28, v3
  v_and_b32 v21, v29, v3
  v_and_b32 v22, v30, v3
  v_and_b32 v23, v31, v3
  s_nop 0
  s_nop 0
  v_mfma_f32_16x16x32_bf16 v[32:35], v[20:23], a[56:59], v[32:35]
  v_perm_b32 v3, v43, v43, s31
  v_and_b32 v24, v28, v3
  v_and_b32 v25, v29, v3
  v_and_b32 v26, v30, v3
  v_and_b32 v27, v31, v3
  s_nop 0
  s_nop 0
  v_mfma_f32_16x16x32_bf16 v[32:35], v[24:27], a[60:63], v[32:35]
  v_perm_b32 v3, v44, v44, s30
  v_and_b32 v20, v28, v3
  v_and_b32 v21, v29, v3
  v_and_b32 v22, v30, v3
  v_and_b32 v23, v31, v3
  s_nop 0
  s_nop 0
  v_mfma_f32_16x16x32_bf16 v[32:35], v[20:23], a[64:67], v[32:35]
  v_perm_b32 v3, v44, v44, s31
  v_and_b32 v24, v28, v3
  v_and_b32 v25, v29, v3
  v_and_b32 v26, v30, v3
  v_and_b32 v27, v31, v3
  s_nop 0
  s_nop 0
  v_mfma_f32_16x16x32_bf16 v[32:35], v[24:27], a[68:71], v[32:35]
  v_perm_b32 v3, v45, v45, s30
  v_and_b32 v20, v28, v3
  v_and_b32 v21, v29, v3
  v_and_b32 v22, v30, v3
  v_and_b32 v23, v31, v3
  s_nop 0
  s_nop 0
  v_mfma_f32_16x16x32_bf16 v[32:35], v[20:23], a[72:75], v[32:35]
  v_perm_b32 v3, v45, v45, s31
  v_and_b32 v24, v28, v3
  v_and_b32 v25, v29, v3
  v_and_b32 v26, v30, v3
  v_and_b32 v27, v31, v3
  s_nop 0
  s_nop 0
  v_mfma_f32_16x16x32_bf16 v[32:35], v[24:27], a[76:79], v[32:35]
  v_perm_b32 v3, v46, v46, s30
  v_and_b32 v20, v28, v3
  v_and_b32 v21, v29, v3
  v_and_b32 v22, v30, v3
  v_and_b32 v23, v31, v3
  s_nop 0
  s_nop 0
  v_mfma_f32_16x16x32_bf16 v[32:35], v[20:23], a[80:83], v[32:35]
  v_perm_b32 v3, v46, v46, s31
  v_and_b32 v24, v28, v3
  v_and_b32 v25, v29, v3
  v_and_b32 v26, v30, v3
  v_and_b32 v27, v31, v3
  s_nop 0
  s_nop 0
  v_mfma_f32_16x16x32_bf16 v[32:35], v[24:27], a[84:87], v[32:35]
  v_perm_b32 v3, v47, v47, s30
  v_and_b32 v20, v28, v3
  v_and_b32 v21, v29, v3
  v_and_b32 v22, v30, v3
  v_and_b32 v23, v31, v3
  s_nop 0
  s_nop 0
  v_mfma_f32_16x16x32_bf16 v[32:35], v[20:23], a[88:91], v[32:35]
  v_perm_b32 v3, v47, v47, s31
  v_and_b32 v24, v28, v3
  v_and_b32 v25, v29, v3
  v_and_b32 v26, v30, v3
  v_and_b32 v27, v31, v3
  s_nop 0
  s_nop 0
  v_mfma_f32_16x16x32_bf16 v[32:35], v[24:27], a[92:95], v[32:35]
  v_perm_b32 v3, v48, v48, s30
  v_and_b32 v20, v28, v3
  v_and_b32 v21, v29, v3
  v_and_b32 v22, v30, v3
  v_and_b32 v23, v31, v3
  s_nop 0
  s_nop 0
  v_mfma_f32_16x16x32_bf16 v[32:35], v[20:23], a[96:99], v[32:35]
  v_perm_b32 v3, v48, v48, s31
  v_and_b32 v24, v28, v3
  v_and_b32 v25, v29, v3
  v_and_b32 v26, v30, v3
  v_and_b32 v27, v31, v3
  s_nop 0
  s_nop 0
  v_mfma_f32_16x16x32_bf16 v[32:35], v[24:27], a[100:103], v[32:35]
  v_perm_b32 v3, v49, v49, s30
  v_and_b32 v20, v28, v3
  v_and_b32 v21, v29, v3
  v_and_b32 v22, v30, v3
  v_and_b32 v23, v31, v3
  s_nop 0
  s_nop 0
  v_mfma_f32_16x16x32_bf16 v[32:35], v[20:23], a[104:107], v[32:35]
  v_perm_b32 v3, v49, v49, s31
  v_and_b32 v24, v28, v3
  v_and_b32 v25, v29, v3
  v_and_b32 v26, v30, v3
  v_and_b32 v27, v31, v3
  s_nop 0
  s_nop 0
  v_mfma_f32_16x16x32_bf16 v[32:35], v[24:27], a[108:111], v[32:35]
  v_perm_b32 v3, v50, v50, s30
  v_and_b32 v20, v28, v3
  v_and_b32 v21, v29, v3
  v_and_b32 v22, v30, v3
  v_and_b32 v23, v31, v3
  s_nop 0
  s_nop 0
  v_mfma_f32_16x16x32_bf16 v[32:35], v[20:23], a[112:115], v[32:35]
  v_perm_b32 v3, v50, v50, s31
  v_and_b32 v24, v28, v3
  v_and_b32 v25, v29, v3
  v_and_b32 v26, v30, v3
  v_and_b32 v27, v31, v3
  s_nop 0
  s_nop 0
  v_mfma_f32_16x16x32_bf16 v[32:35], v[24:27], a[116:119], v[32:35]
  v_perm_b32 v3, v51, v51, s30
  v_and_b32 v20, v28, v3
  v_and_b32 v21, v29, v3
  v_and_b32 v22, v30, v3
  v_and_b32 v23, v31, v3
  s_nop 0
  s_nop 0
  v_mfma_f32_16x16x32_bf16 v[32:35], v[20:23], a[120:123], v[32:35]
  v_perm_b32 v3, v51, v51, s31
  v_and_b32 v24, v28, v3
  v_and_b32 v25, v29, v3
  v_and_b32 v26, v30, v3
  v_and_b32 v27, v31, v3
  s_nop 0
  s_nop 0
  v_mfma_f32_16x16x32_bf16 v[32:35], v[24:27], a[124:127], v[32:35]
  v_lshrrev_b32 v2, 8, v0
  v_and_b32 v3, 0xf0, v0
  v_lshlrev_b32 v3, 1, v3
  v_lshl_add_u32 v3, v2, 4, v3
  s_lshl_b32 s26, s17, 9
  s_add_u32 s26, s26, 65536
  v_add_u32 v5, s26, v3
  s_mov_b32 exec_hi, 0
  ds_write_b128 v5, v[32:35]
  s_mov_b32 exec_hi, -1
  v_add_u32 v5, 65536, v1
  s_waitcnt lgkmcnt(0)
  s_barrier
  ds_read_b32 v36, v5 offset:0
  ds_read_b32 v37, v5 offset:256
  ds_read_b32 v38, v5 offset:512
  ds_read_b32 v39, v5 offset:768
  ds_read_b32 v40, v5 offset:1024
  ds_read_b32 v41, v5 offset:1280
  ds_read_b32 v42, v5 offset:1536
  ds_read_b32 v43, v5 offset:1792
  s_waitcnt lgkmcnt(0)
  v_add_f32 v36, v36, v38
  v_add_f32 v40, v40, v42
  v_add_f32 v36, v36, v40
  v_cvt_pk_bf16_f32 v36, 0, v36
  v_add_f32 v37, v37, v39
  v_add_f32 v41, v41, v43
  v_add_f32 v37, v37, v41
  v_cvt_pk_bf16_f32 v37, 0, v37
  v_mul_f32 v40, 0xbfb8aa3b, v36
  v_exp_f32 v40, v40
  s_nop 0
  v_add_f32 v40, 1.0, v40
  v_rcp_f32 v40, v40
  s_nop 0
  v_mul_f32 v36, v36, v40
  v_cvt_pk_bf16_f32 v36, 0, v36
  v_mul_f32 v36, v36, v37
  v_cvt_pk_bf16_f32 v36, v36, v36
  s_lshl_b32 s26, s17, 8
  s_add_u32 s26, s26, 73728
  v_add_u32 v5, s26, v1
  ds_write_b32 v5, v36
  v_mul_u32_u24 v5, 56, v2
  v_add_u32 v5, s26, v5
  ds_read_b64 v[36:37], v5 offset:0
  ds_read_b64 v[38:39], v5 offset:8
  ds_read_b64 v[40:41], v5 offset:16
  ds_read_b64 v[42:43], v5 offset:24
  ds_read_b64 v[44:45], v5 offset:32
  ds_read_b64 v[46:47], v5 offset:40
  ds_read_b64 v[48:49], v5 offset:48
  s_waitcnt lgkmcnt(0)
  v_and_b32 v20, v28, v36
  v_and_b32 v21, v29, v36
  v_and_b32 v22, v30, v36
  v_and_b32 v23, v31, v36
  s_nop 0
  s_nop 0
  v_mfma_f32_16x16x32_bf16 v[32:35], v[20:23], a[128:131], 0
  v_and_b32 v24, v28, v37
  v_and_b32 v25, v29, v37
  v_and_b32 v26, v30, v37
  v_and_b32 v27, v31, v37
  s_nop 0
  s_nop 0
  v_mfma_f32_16x16x32_bf16 v[32:35], v[24:27], a[132:135], v[32:35]
  v_and_b32 v20, v28, v38
  v_and_b32 v21, v29, v38
  v_and_b32 v22, v30, v38
  v_and_b32 v23, v31, v38
  s_nop 0
  s_nop 0
  v_mfma_f32_16x16x32_bf16 v[32:35], v[20:23], a[136:139], v[32:35]
  v_and_b32 v24, v28, v39
  v_and_b32 v25, v29, v39
  v_and_b32 v26, v30, v39
  v_and_b32 v27, v31, v39
  s_nop 0
  s_nop 0
  v_mfma_f32_16x16x32_bf16 v[32:35], v[24:27], a[140:143], v[32:35]
  v_and_b32 v20, v28, v40
  v_and_b32 v21, v29, v40
  v_and_b32 v22, v30, v40
  v_and_b32 v23, v31, v40
  s_nop 0
  s_nop 0
  v_mfma_f32_16x16x32_bf16 v[32:35], v[20:23], a[144:147], v[32:35]
  v_and_b32 v24, v28, v41
  v_and_b32 v25, v29, v41
  v_and_b32 v26, v30, v41
  v_and_b32 v27, v31, v41
  s_nop 0
  s_nop 0
  v_mfma_f32_16x16x32_bf16 v[32:35], v[24:27], a[148:151], v[32:35]
  v_and_b32 v20, v28, v42
  v_and_b32 v21, v29, v42
  v_and_b32 v22, v30, v42
  v_and_b32 v23, v31, v42
  s_nop 0
  s_nop 0
  v_mfma_f32_16x16x32_bf16 v[32:35], v[20:23], a[152:155], v[32:35]
  v_and_b32 v24, v28, v43
  v_and_b32 v25, v29, v43
  v_and_b32 v26, v30, v43
  v_and_b32 v27, v31, v43
  s_nop 0
  s_nop 0
  v_mfma_f32_16x16x32_bf16 v[32:35], v[24:27], a[156:159], v[32:35]
  v_and_b32 v20, v28, v44
  v_and_b32 v21, v29, v44
  v_and_b32 v22, v30, v44
  v_and_b32 v23, v31, v44
  s_nop 0
  s_nop 0
  v_mfma_f32_16x16x32_bf16 v[32:35], v[20:23], a[160:163], v[32:35]
  v_and_b32 v24, v28, v45
  v_and_b32 v25, v29, v45
  v_and_b32 v26, v30, v45
  v_and_b32 v27, v31, v45
  s_nop 0
  s_nop 0
  v_mfma_f32_16x16x32_bf16 v[32:35], v[24:27], a[164:167], v[32:35]
  v_and_b32 v20, v28, v46
  v_and_b32 v21, v29, v46
  v_and_b32 v22, v30, v46
  v_and_b32 v23, v31, v46
  s_nop 0
  s_nop 0
  v_mfma_f32_16x16x32_bf16 v[32:35], v[20:23], a[168:171], v[32:35]
  v_and_b32 v24, v28, v47
  v_and_b32 v25, v29, v47
  v_and_b32 v26, v30, v47
  v_and_b32 v27, v31, v47
  s_nop 0
  s_nop 0
  v_mfma_f32_16x16x32_bf16 v[32:35], v[24:27], a[172:175], v[32:35]
  v_and_b32 v20, v28, v48
  v_and_b32 v21, v29, v48
  v_and_b32 v22, v30, v48
  v_and_b32 v23, v31, v48
  s_nop 0
  s_nop 0
  v_mfma_f32_16x16x32_bf16 v[32:35], v[20:23], a[176:179], v[32:35]
  v_and_b32 v24, v28, v49
  v_and_b32 v25, v29, v49
  v_and_b32 v26, v30, v49
  v_and_b32 v27, v31, v49
  s_nop 0
  s_nop 0
  v_mfma_f32_16x16x32_bf16 v[32:35], v[24:27], a[180:183], v[32:35]
  v_lshrrev_b32 v3, 1, v3
  s_lshl_b32 s26, s60, 5
  s_add_u32 s26, s26, s16
  s_lshl_b32 s26, s26, 2
  s_add_u32 s26, s26, s17
  s_lshl_b32 s27, s26, 2
  s_add_u32 s27, s27, 5287936
  s_lshl_b32 s26, s26, 8
  s_add_u32 s26, s26, 35651584
  v_cvt_pk_bf16_f32 v32, v32, v33
  v_cvt_pk_bf16_f32 v33, v34, v35
  s_mov_b32 exec_hi, 0
  buffer_store_dwordx2 v[32:33], v3, s[4:7], s26 offen sc1
  s_mov_b32 exec_hi, -1
  v_mov_b32 v5, s57
  s_waitcnt vmcnt(0)
  s_mov_b64 exec, 1
  buffer_store_dword v5, off, s[4:7], s27 sc1
  s_mov_b64 exec, -1
  s_or_b32 s26, s16, s17
  s_cbranch_scc1 m_done_74
  s_add_u32 s27, s32, 20971520
  s_add_u32 s28, s32, 27262976
  buffer_load_dwordx4 v[36:39], v0, s[4:7], s27 offen sc1
  buffer_load_dwordx4 v[40:43], v0, s[4:7], s28 offen sc1
  s_mov_b32 vcc_lo, 0xaaaaaaaa
  s_mov_b32 vcc_hi, 0xaaaaaaaa
  v_mov_b32 v3, 0x3f80
  v_mov_b32 v20, 1.0
  v_cndmask_b32 v3, v3, v20, vcc
  s_mov_b32 vcc_lo, 0x30003
  s_mov_b32 vcc_hi, 0x30003
  v_cndmask_b32 v20, 0, v3, vcc
  s_mov_b32 vcc_lo, 0xc000c
  s_mov_b32 vcc_hi, 0xc000c
  v_cndmask_b32 v21, 0, v3, vcc
  s_mov_b32 vcc_lo, 0x300030
  s_mov_b32 vcc_hi, 0x300030
  v_cndmask_b32 v22, 0, v3, vcc
  s_mov_b32 vcc_lo, 0xc000c0
  s_mov_b32 vcc_hi, 0xc000c0
  v_cndmask_b32 v23, 0, v3, vcc
  s_mov_b32 vcc_lo, 0x3000300
  s_mov_b32 vcc_hi, 0x3000300
  v_cndmask_b32 v24, 0, v3, vcc
  s_mov_b32 vcc_lo, 0xc000c00
  s_mov_b32 vcc_hi, 0xc000c00
  v_cndmask_b32 v25, 0, v3, vcc
  s_mov_b32 vcc_lo, 0x30003000
  s_mov_b32 vcc_hi, 0x30003000
  v_cndmask_b32 v26, 0, v3, vcc
  s_mov_b32 vcc_lo, 0xc000c000
  s_mov_b32 vcc_hi, 0xc000c000
  v_cndmask_b32 v27, 0, v3, vcc
  v_lshrrev_b32 v5, 1, v0
  s_lshl_b32 s26, s60, 9
  s_add_u32 s26, s26, 5287936
  s_mov_b32 s53, 0
m_w_75:
  buffer_load_dwordx2 v[44:45], v5, s[4:7], s26 offen sc1
  s_add_u32 s53, s53, 1
  s_cmp_gt_u32 s53, 1048576
  s_cbranch_scc1 q_fail_60
  s_waitcnt vmcnt(0)
  v_min_u32 v44, v44, v45
  v_cmp_gt_u32 vcc, s57, v44
  s_cbranch_vccnz m_w_75
  s_lshl_b32 s26, s60, 15
  s_add_u32 s26, s26, 35651584
  v_lshrrev_b32 v2, 8, v0
  v_and_b32 v3, 0xf0, v0
  v_lshl_add_u32 v3, v2, 10, v3
  buffer_load_dwordx4 v[60:63], v3, s[4:7], s26 offen offset:0 sc1
  buffer_load_dwordx4 v[64:67], v3, s[4:7], s26 offen offset:256 sc1
  buffer_load_dwordx4 v[68:71], v3, s[4:7], s26 offen offset:512 sc1
  buffer_load_dwordx4 v[72:75], v3, s[4:7], s26 offen offset:768 sc1
  s_add_u32 s26, s26, 4096
  buffer_load_dwordx4 v[76:79], v3, s[4:7], s26 offen offset:0 sc1
  buffer_load_dwordx4 v[80:83], v3, s[4:7], s26 offen offset:256 sc1
  buffer_load_dwordx4 v[84:87], v3, s[4:7], s26 offen offset:512 sc1
  buffer_load_dwordx4 v[88:91], v3, s[4:7], s26 offen offset:768 sc1
  s_add_u32 s26, s26, 4096
  buffer_load_dwordx4 v[92:95], v3, s[4:7], s26 offen offset:0 sc1
  buffer_load_dwordx4 v[96:99], v3, s[4:7], s26 offen offset:256 sc1
  buffer_load_dwordx4 v[100:103], v3, s[4:7], s26 offen offset:512 sc1
  buffer_load_dwordx4 v[104:107], v3, s[4:7], s26 offen offset:768 sc1
  s_add_u32 s26, s26, 4096
  buffer_load_dwordx4 v[108:111], v3, s[4:7], s26 offen offset:0 sc1
  buffer_load_dwordx4 v[112:115], v3, s[4:7], s26 offen offset:256 sc1
  buffer_load_dwordx4 v[116:119], v3, s[4:7], s26 offen offset:512 sc1
  buffer_load_dwordx4 v[120:123], v3, s[4:7], s26 offen offset:768 sc1
  s_add_u32 s26, s26, 4096
  v_lshlrev_b32 v44, 16, v36
  v_and_b32 v45, 0xffff0000, v36
  v_lshlrev_b32 v46, 16, v37
  v_and_b32 v47, 0xffff0000, v37
  v_lshlrev_b32 v48, 16, v38
  v_and_b32 v49, 0xffff0000, v38
  v_lshlrev_b32 v50, 16, v39
  v_and_b32 v51, 0xffff0000, v39
  v_lshlrev_b32 v52, 16, v40
  v_and_b32 v53, 0xffff0000, v40
  v_lshlrev_b32 v54, 16, v41
  v_and_b32 v55, 0xffff0000, v41
  v_lshlrev_b32 v56, 16, v42
  v_and_b32 v57, 0xffff0000, v42
  v_lshlrev_b32 v58, 16, v43
  v_and_b32 v59, 0xffff0000, v43
  s_and_b32 s29, s58, 0xffff0000
  s_xor_b32 s27, s29, 0x80000000
  s_xor_b32 s28, s29, 0xffff0000
  s_bitcmp1_b32 s29, 31
  s_cselect_b32 s29, s27, s28
  v_mov_b32 v36, s29
  v_mul_f32 v36, 0xbfb8aa3b, v36
  v_exp_f32 v36, v36
  s_nop 0
  v_add_f32 v36, 1.0, v36
  v_rcp_f32 v36, v36
  s_nop 0
  v_cvt_pk_bf16_f32 v36, 0, v36
  s_waitcnt vmcnt(15)
  v_mfma_f32_16x16x32_bf16 v[28:31], v[20:23], v[60:63], 0
  buffer_load_dwordx4 v[60:63], v3, s[4:7], s26 offen offset:0 sc1
  s_waitcnt vmcnt(15)
  v_mfma_f32_16x16x32_bf16 v[32:35], v[20:23], v[64:67], 0
  buffer_load_dwordx4 v[64:67], v3, s[4:7], s26 offen offset:256 sc1
  s_waitcnt vmcnt(15)
  v_mfma_f32_16x16x32_bf16 v[28:31], v[24:27], v[68:71], v[28:31]
  buffer_load_dwordx4 v[68:71], v3, s[4:7], s26 offen offset:512 sc1
  s_waitcnt vmcnt(15)
  v_mfma_f32_16x16x32_bf16 v[32:35], v[24:27], v[72:75], v[32:35]
  buffer_load_dwordx4 v[72:75], v3, s[4:7], s26 offen offset:768 sc1
  s_add_u32 s26, s26, 4096
  s_waitcnt vmcnt(15)
  v_mfma_f32_16x16x32_bf16 v[28:31], v[20:23], v[76:79], v[28:31]
  buffer_load_dwordx4 v[76:79], v3, s[4:7], s26 offen offset:0 sc1
  s_waitcnt vmcnt(15)
  v_mfma_f32_16x16x32_bf16 v[32:35], v[20:23], v[80:83], v[32:35]
  buffer_load_dwordx4 v[80:83], v3, s[4:7], s26 offen offset:256 sc1
  s_waitcnt vmcnt(15)
  v_mfma_f32_16x16x32_bf16 v[28:31], v[24:27], v[84:87], v[28:31]
  buffer_load_dwordx4 v[84:87], v3, s[4:7], s26 offen offset:512 sc1
  s_waitcnt vmcnt(15)
  v_mfma_f32_16x16x32_bf16 v[32:35], v[24:27], v[88:91], v[32:35]
  buffer_load_dwordx4 v[88:91], v3, s[4:7], s26 offen offset:768 sc1
  s_add_u32 s26, s26, 4096
  s_waitcnt vmcnt(15)
  v_mfma_f32_16x16x32_bf16 v[28:31], v[20:23], v[92:95], v[28:31]
  buffer_load_dwordx4 v[92:95], v3, s[4:7], s26 offen offset:0 sc1
  s_waitcnt vmcnt(15)
  v_mfma_f32_16x16x32_bf16 v[32:35], v[20:23], v[96:99], v[32:35]
  buffer_load_dwordx4 v[96:99], v3, s[4:7], s26 offen offset:256 sc1
  s_waitcnt vmcnt(15)
  v_mfma_f32_16x16x32_bf16 v[28:31], v[24:27], v[100:103], v[28:31]
  buffer_load_dwordx4 v[100:103], v3, s[4:7], s26 offen offset:512 sc1
  s_waitcnt vmcnt(15)
  v_mfma_f32_16x16x32_bf16 v[32:35], v[24:27], v[104:107], v[32:35]
  buffer_load_dwordx4 v[104:107], v3, s[4:7], s26 offen offset:768 sc1
  s_add_u32 s26, s26, 4096
  s_waitcnt vmcnt(15)
  v_mfma_f32_16x16x32_bf16 v[28:31], v[20:23], v[108:111], v[28:31]
  buffer_load_dwordx4 v[108:111], v3, s[4:7], s26 offen offset:0 sc1
  s_waitcnt vmcnt(15)
  v_mfma_f32_16x16x32_bf16 v[32:35], v[20:23], v[112:115], v[32:35]
  buffer_load_dwordx4 v[112:115], v3, s[4:7], s26 offen offset:256 sc1
  s_waitcnt vmcnt(15)
  v_mfma_f32_16x16x32_bf16 v[28:31], v[24:27], v[116:119], v[28:31]
  buffer_load_dwordx4 v[116:119], v3, s[4:7], s26 offen offset:512 sc1
  s_waitcnt vmcnt(15)
  v_mfma_f32_16x16x32_bf16 v[32:35], v[24:27], v[120:123], v[32:35]
  buffer_load_dwordx4 v[120:123], v3, s[4:7], s26 offen offset:768 sc1
  s_add_u32 s26, s26, 4096
  s_waitcnt vmcnt(15)
  v_mfma_f32_16x16x32_bf16 v[28:31], v[20:23], v[60:63], v[28:31]
  s_waitcnt vmcnt(14)
  v_mfma_f32_16x16x32_bf16 v[32:35], v[20:23], v[64:67], v[32:35]
  s_waitcnt vmcnt(13)
  v_mfma_f32_16x16x32_bf16 v[28:31], v[24:27], v[68:71], v[28:31]
  s_waitcnt vmcnt(12)
  v_mfma_f32_16x16x32_bf16 v[32:35], v[24:27], v[72:75], v[32:35]
  s_waitcnt vmcnt(11)
  v_mfma_f32_16x16x32_bf16 v[28:31], v[20:23], v[76:79], v[28:31]
  s_waitcnt vmcnt(10)
  v_mfma_f32_16x16x32_bf16 v[32:35], v[20:23], v[80:83], v[32:35]
  s_waitcnt vmcnt(9)
  v_mfma_f32_16x16x32_bf16 v[28:31], v[24:27], v[84:87], v[28:31]
  s_waitcnt vmcnt(8)
  v_mfma_f32_16x16x32_bf16 v[32:35], v[24:27], v[88:91], v[32:35]
  s_waitcnt vmcnt(7)
  v_mfma_f32_16x16x32_bf16 v[28:31], v[20:23], v[92:95], v[28:31]
  s_waitcnt vmcnt(6)
  v_mfma_f32_16x16x32_bf16 v[32:35], v[20:23], v[96:99], v[32:35]
  s_waitcnt vmcnt(5)
  v_mfma_f32_16x16x32_bf16 v[28:31], v[24:27], v[100:103], v[28:31]
  s_waitcnt vmcnt(4)
  v_mfma_f32_16x16x32_bf16 v[32:35], v[24:27], v[104:107], v[32:35]
  s_waitcnt vmcnt(3)
  v_mfma_f32_16x16x32_bf16 v[28:31], v[20:23], v[108:111], v[28:31]
  s_waitcnt vmcnt(2)
  v_mfma_f32_16x16x32_bf16 v[32:35], v[20:23], v[112:115], v[32:35]
  s_waitcnt vmcnt(1)
  v_mfma_f32_16x16x32_bf16 v[28:31], v[24:27], v[116:119], v[28:31]
  s_waitcnt vmcnt(0)
  v_mfma_f32_16x16x32_bf16 v[32:35], v[24:27], v[120:123], v[32:35]
  s_nop 1
  s_nop 1
  s_nop 1
  s_nop 1
  v_permlane16_swap_b32 v28, v32
  v_permlane16_swap_b32 v29, v33
  v_permlane16_swap_b32 v30, v34
  v_permlane16_swap_b32 v31, v35
  v_cvt_pk_bf16_f32 v28, 0, v28
  v_cvt_pk_bf16_f32 v29, 0, v29
  v_cvt_pk_bf16_f32 v30, 0, v30
  v_cvt_pk_bf16_f32 v31, 0, v31
  v_cvt_pk_bf16_f32 v32, 0, v32
  v_cvt_pk_bf16_f32 v33, 0, v33
  v_cvt_pk_bf16_f32 v34, 0, v34
  v_cvt_pk_bf16_f32 v35, 0, v35
  v_mul_f32 v28, v28, v36
  v_mul_f32 v29, v29, v36
  v_mul_f32 v30, v30, v36
  v_mul_f32 v31, v31, v36
  v_mul_f32 v32, v32, v36
  v_mul_f32 v33, v33, v36
  v_mul_f32 v34, v34, v36
  v_mul_f32 v35, v35, v36
  v_cvt_pk_bf16_f32 v28, 0, v28
  v_cvt_pk_bf16_f32 v29, 0, v29
  v_cvt_pk_bf16_f32 v30, 0, v30
  v_cvt_pk_bf16_f32 v31, 0, v31
  v_cvt_pk_bf16_f32 v32, 0, v32
  v_cvt_pk_bf16_f32 v33, 0, v33
  v_cvt_pk_bf16_f32 v34, 0, v34
  v_cvt_pk_bf16_f32 v35, 0, v35
  v_add_f32 v28, v28, v52
  v_add_f32 v29, v29, v53
  v_add_f32 v30, v30, v54
  v_add_f32 v31, v31, v55
  v_add_f32 v32, v32, v56
  v_add_f32 v33, v33, v57
  v_add_f32 v34, v34, v58
  v_add_f32 v35, v35, v59
  v_cvt_pk_bf16_f32 v28, 0, v28
  v_cvt_pk_bf16_f32 v29, 0, v29
  v_cvt_pk_bf16_f32 v30, 0, v30
  v_cvt_pk_bf16_f32 v31, 0, v31
  v_cvt_pk_bf16_f32 v32, 0, v32
  v_cvt_pk_bf16_f32 v33, 0, v33
  v_cvt_pk_bf16_f32 v34, 0, v34
  v_cvt_pk_bf16_f32 v35, 0, v35
  v_add_f32 v44, v44, v28
  v_add_f32 v45, v45, v29
  v_add_f32 v46, v46, v30
  v_add_f32 v47, v47, v31
  v_add_f32 v48, v48, v32
  v_add_f32 v49, v49, v33
  v_add_f32 v50, v50, v34
  v_add_f32 v51, v51, v35
  v_cvt_pk_bf16_f32 v40, v44, v45
  v_cvt_pk_bf16_f32 v41, v46, v47
  v_cvt_pk_bf16_f32 v42, v48, v49
  v_cvt_pk_bf16_f32 v43, v50, v51
  v_lshlrev_b32 v44, 16, v40
  v_and_b32 v45, 0xffff0000, v40
  v_lshlrev_b32 v46, 16, v41
  v_and_b32 v47, 0xffff0000, v41
  v_lshlrev_b32 v48, 16, v42
  v_and_b32 v49, 0xffff0000, v42
  v_lshlrev_b32 v50, 16, v43
  v_and_b32 v51, 0xffff0000, v43
  s_lshl_b32 s26, s59, 10
  buffer_store_dwordx4 v[40:43], v0, s[72:75], s26 offen sc1
m_done_74:
q_fail_60:
  s_endpgm
L_o:
  s_sub_u32 s26, s90, 192
  s_lshr_b32 s60, s26, 4
  s_and_b32 s61, s26, 15
  s_lshl_b32 s26, s26, 13
  s_add_u32 s26, s26, 5242880
  v_lshlrev_b32 v1, 4, v0
  v_mov_b64 v[4:5], 0
  v_mov_b64 v[6:7], 0
  buffer_store_dwordx4 v[4:7], v1, s[4:7], s26 offen sc1
  s_add_u32 s26, s26, 4096
  buffer_store_dwordx4 v[4:7], v1, s[4:7], s26 offen sc1
  v_mov_b64 v[8:9], -1
  v_mov_b64 v[10:11], -1
  s_add_u32 s26, s26, 520192
  buffer_store_dwordx4 v[8:11], v1, s[4:7], s26 offen sc1
  s_add_u32 s26, s26, 4096
  buffer_store_dwordx4 v[8:11], v1, s[4:7], s26 offen sc1
  v_and_b32 v26, 63, v0
  v_and_b32 v24, 15, v26
  v_lshrrev_b32 v25, 4, v26
  v_lshlrev_b32 v1, 3, v26
  v_lshlrev_b32 v2, 2, v26
  v_lshlrev_b32 v0, 4, v26
  s_mov_b32 s24, 0x3e0293ee
  s_mov_b32 s44, 0x05040100
  s_mov_b32 s45, 0x07060302
  s_and_b32 s26, s17, 1
  s_lshl_b32 s26, s26, 4
  v_lshlrev_b32 v27, 2, v25
  v_sub_u32 v3, v24, v27
  v_add_u32 v3, s26, v3
  v_lshlrev_b32 v27, 16, v25
  v_lshl_add_u32 v27, v24, 4, v27
  s_lshl_b32 s26, s61, 10
  s_lshl_b32 s27, s17, 8
  s_add_u32 s26, s26, s27
  v_add_u32 v4, s26, v27
  v_lshlrev_b32 v27, 10, v25
  v_lshl_add_u32 v5, v24, 4, v27
  s_lshl_b32 s26, s17, 12
  v_add_u32 v6, s26, v0
  s_mov_b32 vcc_lo, 0xaaaaaaaa
  s_mov_b32 vcc_hi, 0xaaaaaaaa
  v_mov_b32 v27, 0x3f80
  v_mov_b32 v16, 1.0
  v_cndmask_b32 v27, v27, v16, vcc
  s_mov_b32 vcc_lo, 0x30003
  s_mov_b32 vcc_hi, 0x30003
  v_cndmask_b32 v16, 0, v27, vcc
  s_mov_b32 vcc_lo, 0xc000c
  s_mov_b32 vcc_hi, 0xc000c
  v_cndmask_b32 v17, 0, v27, vcc
  s_mov_b32 vcc_lo, 0x300030
  s_mov_b32 vcc_hi, 0x300030
  v_cndmask_b32 v18, 0, v27, vcc
  s_mov_b32 vcc_lo, 0xc000c0
  s_mov_b32 vcc_hi, 0xc000c0
  v_cndmask_b32 v19, 0, v27, vcc
  s_mov_b32 vcc_lo, 0x3000300
  s_mov_b32 vcc_hi, 0x3000300
  v_cndmask_b32 v20, 0, v27, vcc
  s_mov_b32 vcc_lo, 0xc000c00
  s_mov_b32 vcc_hi, 0xc000c00
  v_cndmask_b32 v21, 0, v27, vcc
  s_mov_b32 vcc_lo, 0x30003000
  s_mov_b32 vcc_hi, 0x30003000
  v_cndmask_b32 v22, 0, v27, vcc
  s_mov_b32 vcc_lo, 0xc000c000
  s_mov_b32 vcc_hi, 0xc000c000
  v_cndmask_b32 v23, 0, v27, vcc
  s_load_dwordx2 s[68:69], s[0:1], 96
  s_load_dwordx2 s[72:73], s[0:1], 0
  s_load_dwordx2 s[8:9], s[0:1], 64
  s_mov_b32 s70, 2097152
  s_mov_b32 s71, 0x20000
  s_mov_b32 s74, 2097152
  s_mov_b32 s75, 0x20000
  s_mov_b32 s10, 1024
  s_mov_b32 s83, 0x20000
  s_lshr_b32 s85, s17, 1
  s_lshl_b32 s26, s61, 1
  s_add_u32 s85, s85, s26
  s_mov_b32 s11, 0x20000
  s_waitcnt lgkmcnt(0)
  buffer_load_dwordx4 v[28:31], v0, s[8:11], 0 offen
  s_waitcnt vmcnt(0)
  v_lshlrev_b32 v8, 16, v28
  v_and_b32 v9, 0xffff0000, v28
  v_lshlrev_b32 v10, 16, v29
  v_and_b32 v11, 0xffff0000, v29
  v_lshlrev_b32 v12, 16, v30
  v_and_b32 v13, 0xffff0000, v30
  v_lshlrev_b32 v14, 16, v31
  v_and_b32 v15, 0xffff0000, v31
  s_barrier
  s_cmp_lg_u32 s17, 0
  s_cbranch_scc1 g_ar_76
  v_mov_b32 v60, 160
  v_mov_b32 v61, 1
  s_mov_b64 exec, 1
  global_atomic_add v60, v61, s[12:13]
  s_mov_b64 exec, -1
g_ar_76:
  s_lshl_b32 s77, s60, 4
  s_add_u32 s77, s77, s61
  s_lshl_b32 s77, s77, 2
  s_add_u32 s77, s77, s17
  s_lshl_b32 s26, s77, 10
  buffer_load_dwordx4 v[64:67], v0, s[72:75], s26 offen
  s_add_u32 s26, s26, 262144
  buffer_load_dwordx4 v[68:71], v0, s[72:75], s26 offen
  s_add_u32 s26, s26, 262144
  buffer_load_dwordx4 v[72:75], v0, s[72:75], s26 offen
  s_add_u32 s26, s26, 262144
  buffer_load_dwordx4 v[76:79], v0, s[72:75], s26 offen
  s_add_u32 s26, s26, 262144
  buffer_load_dwordx4 v[80:83], v0, s[72:75], s26 offen
  s_add_u32 s26, s26, 262144
  buffer_load_dwordx4 v[84:87], v0, s[72:75], s26 offen
  s_add_u32 s26, s26, 262144
  buffer_load_dwordx4 v[88:91], v0, s[72:75], s26 offen
  s_add_u32 s26, s26, 262144
  buffer_load_dwordx4 v[92:95], v0, s[72:75], s26 offen
  s_add_u32 s26, s26, 262144
  s_mov_b32 s26, 0
  v_mov_b32 v60, 160
g_wc_77:
  global_load_dword v61, v60, s[12:13] sc1
  s_add_u32 s26, s26, 1
  s_cmp_gt_u32 s26, 1048576
  s_cbranch_scc1 L_end
  s_waitcnt vmcnt(0)
  v_readfirstlane_b32 s27, v61
  s_cmp_lt_u32 s27, 64
  s_cbranch_scc1 g_wc_77
  s_lshl_b32 s26, s77, 10
  s_add_u32 s26, s26, 6291456
  s_lshl_b32 s27, s77, 2
  s_add_u32 s27, s27, 5242880
  v_mov_b32 v60, 1
  v_mov_b32 v61, 0
  s_waitcnt vmcnt(0)
  v_lshlrev_b32 v32, 16, v64
  v_and_b32 v33, 0xffff0000, v64
  v_lshlrev_b32 v34, 16, v65
  v_and_b32 v35, 0xffff0000, v65
  v_lshlrev_b32 v36, 16, v66
  v_and_b32 v37, 0xffff0000, v66
  v_lshlrev_b32 v38, 16, v67
  v_and_b32 v39, 0xffff0000, v67
  v_add_f32 v40, v32, v33
  v_add_f32 v41, v34, v35
  v_add_f32 v42, v36, v37
  v_add_f32 v43, v38, v39
  v_add_f32 v40, v40, v41
  v_add_f32 v42, v42, v43
  v_add_f32 v40, v40, v42
  s_nop 1
  v_add_f32_dpp v40, v40, v40 row_ror:8 row_mask:0xf bank_mask:0xf
  s_nop 1
  v_add_f32_dpp v40, v40, v40 row_ror:4 row_mask:0xf bank_mask:0xf
  s_nop 1
  v_add_f32_dpp v40, v40, v40 row_ror:2 row_mask:0xf bank_mask:0xf
  s_nop 1
  v_add_f32_dpp v40, v40, v40 row_ror:1 row_mask:0xf bank_mask:0xf
  v_mov_b32 v42, v40
  s_nop 0
  s_nop 0
  v_permlane16_swap_b32 v40, v42
  v_add_f32 v40, v40, v42
  v_mov_b32 v42, v40
  s_nop 0
  s_nop 0
  v_permlane32_swap_b32 v40, v42
  v_add_f32 v40, v40, v42
  v_mul_f32 v40, 0x3b000000, v40
  v_sub_f32 v44, v32, v40
  v_sub_f32 v45, v33, v40
  v_sub_f32 v46, v34, v40
  v_sub_f32 v47, v35, v40
  v_sub_f32 v48, v36, v40
  v_sub_f32 v49, v37, v40
  v_sub_f32 v50, v38, v40
  v_sub_f32 v51, v39, v40
  v_mul_f32 v41, v44, v44
  v_mul_f32 v42, v45, v45
  v_fmac_f32 v41, v46, v46
  v_fmac_f32 v42, v47, v47
  v_fmac_f32 v41, v48, v48
  v_fmac_f32 v42, v49, v49
  v_fmac_f32 v41, v50, v50
  v_fmac_f32 v42, v51, v51
  v_add_f32 v41, v41, v42
  v_cvt_pk_bf16_f32 v40, 0, v40
  s_nop 0
  v_add_f32_dpp v41, v41, v41 row_ror:8 row_mask:0xf bank_mask:0xf
  v_sub_f32 v44, v32, v40
  v_sub_f32 v45, v33, v40
  v_add_f32_dpp v41, v41, v41 row_ror:4 row_mask:0xf bank_mask:0xf
  v_sub_f32 v46, v34, v40
  v_sub_f32 v47, v35, v40
  v_add_f32_dpp v41, v41, v41 row_ror:2 row_mask:0xf bank_mask:0xf
  v_sub_f32 v48, v36, v40
  v_sub_f32 v49, v37, v40
  v_add_f32_dpp v41, v41, v41 row_ror:1 row_mask:0xf bank_mask:0xf
  v_sub_f32 v50, v38, v40
  v_sub_f32 v51, v39, v40
  v_mov_b32 v42, v41
  v_cvt_pk_bf16_f32 v44, 0, v44
  v_cvt_pk_bf16_f32 v45, 0, v45
  v_permlane16_swap_b32 v41, v42
  v_cvt_pk_bf16_f32 v46, 0, v46
  v_cvt_pk_bf16_f32 v47, 0, v47
  v_add_f32 v41, v41, v42
  v_cvt_pk_bf16_f32 v48, 0, v48
  v_cvt_pk_bf16_f32 v49, 0, v49
  v_mov_b32 v42, v41
  v_cvt_pk_bf16_f32 v50, 0, v50
  v_cvt_pk_bf16_f32 v51, 0, v51
  v_permlane32_swap_b32 v41, v42
  v_add_f32 v41, v41, v42
  v_mul_f32 v41, 0x3b000000, v41
  v_cvt_pk_bf16_f32 v41, 0, v41
  v_add_f32 v41, 0x3727c5ac, v41
  v_cvt_pk_bf16_f32 v41, 0, v41
  v_sqrt_f32 v41, v41
  s_nop 0
  v_cvt_pk_bf16_f32 v41, 0, v41
  v_rcp_f32 v41, v41
  s_nop 0
  v_mul_f32 v44, v44, v41
  v_mul_f32 v45, v45, v41
  v_mul_f32 v46, v46, v41
  v_mul_f32 v47, v47, v41
  v_mul_f32 v48, v48, v41
  v_mul_f32 v49, v49, v41
  v_mul_f32 v50, v50, v41
  v_mul_f32 v51, v51, v41
  v_cvt_pk_bf16_f32 v64, v44, v45
  v_cvt_pk_bf16_f32 v65, v46, v47
  v_cvt_pk_bf16_f32 v66, v48, v49
  v_cvt_pk_bf16_f32 v67, v50, v51
  buffer_store_dwordx4 v[64:67], v0, s[4:7], s26 offen sc1
  s_add_u32 s26, s26, 262144
  v_lshlrev_b32 v32, 16, v68
  v_and_b32 v33, 0xffff0000, v68
  v_lshlrev_b32 v34, 16, v69
  v_and_b32 v35, 0xffff0000, v69
  v_lshlrev_b32 v36, 16, v70
  v_and_b32 v37, 0xffff0000, v70
  v_lshlrev_b32 v38, 16, v71
  v_and_b32 v39, 0xffff0000, v71
  v_add_f32 v40, v32, v33
  v_add_f32 v41, v34, v35
  v_add_f32 v42, v36, v37
  v_add_f32 v43, v38, v39
  v_add_f32 v40, v40, v41
  v_add_f32 v42, v42, v43
  v_add_f32 v40, v40, v42
  s_nop 1
  v_add_f32_dpp v40, v40, v40 row_ror:8 row_mask:0xf bank_mask:0xf
  s_nop 1
  v_add_f32_dpp v40, v40, v40 row_ror:4 row_mask:0xf bank_mask:0xf
  s_nop 1
  v_add_f32_dpp v40, v40, v40 row_ror:2 row_mask:0xf bank_mask:0xf
  s_nop 1
  v_add_f32_dpp v40, v40, v40 row_ror:1 row_mask:0xf bank_mask:0xf
  v_mov_b32 v42, v40
  s_nop 0
  s_nop 0
  v_permlane16_swap_b32 v40, v42
  v_add_f32 v40, v40, v42
  v_mov_b32 v42, v40
  s_nop 0
  s_nop 0
  v_permlane32_swap_b32 v40, v42
  v_add_f32 v40, v40, v42
  v_mul_f32 v40, 0x3b000000, v40
  v_sub_f32 v44, v32, v40
  v_sub_f32 v45, v33, v40
  v_sub_f32 v46, v34, v40
  v_sub_f32 v47, v35, v40
  v_sub_f32 v48, v36, v40
  v_sub_f32 v49, v37, v40
  v_sub_f32 v50, v38, v40
  v_sub_f32 v51, v39, v40
  v_mul_f32 v41, v44, v44
  v_mul_f32 v42, v45, v45
  v_fmac_f32 v41, v46, v46
  v_fmac_f32 v42, v47, v47
  v_fmac_f32 v41, v48, v48
  v_fmac_f32 v42, v49, v49
  v_fmac_f32 v41, v50, v50
  v_fmac_f32 v42, v51, v51
  v_add_f32 v41, v41, v42
  v_cvt_pk_bf16_f32 v40, 0, v40
  s_nop 0
  v_add_f32_dpp v41, v41, v41 row_ror:8 row_mask:0xf bank_mask:0xf
  v_sub_f32 v44, v32, v40
  v_sub_f32 v45, v33, v40
  v_add_f32_dpp v41, v41, v41 row_ror:4 row_mask:0xf bank_mask:0xf
  v_sub_f32 v46, v34, v40
  v_sub_f32 v47, v35, v40
  v_add_f32_dpp v41, v41, v41 row_ror:2 row_mask:0xf bank_mask:0xf
  v_sub_f32 v48, v36, v40
  v_sub_f32 v49, v37, v40
  v_add_f32_dpp v41, v41, v41 row_ror:1 row_mask:0xf bank_mask:0xf
  v_sub_f32 v50, v38, v40
  v_sub_f32 v51, v39, v40
  v_mov_b32 v42, v41
  v_cvt_pk_bf16_f32 v44, 0, v44
  v_cvt_pk_bf16_f32 v45, 0, v45
  v_permlane16_swap_b32 v41, v42
  v_cvt_pk_bf16_f32 v46, 0, v46
  v_cvt_pk_bf16_f32 v47, 0, v47
  v_add_f32 v41, v41, v42
  v_cvt_pk_bf16_f32 v48, 0, v48
  v_cvt_pk_bf16_f32 v49, 0, v49
  v_mov_b32 v42, v41
  v_cvt_pk_bf16_f32 v50, 0, v50
  v_cvt_pk_bf16_f32 v51, 0, v51
  v_permlane32_swap_b32 v41, v42
  v_add_f32 v41, v41, v42
  v_mul_f32 v41, 0x3b000000, v41
  v_cvt_pk_bf16_f32 v41, 0, v41
  v_add_f32 v41, 0x3727c5ac, v41
  v_cvt_pk_bf16_f32 v41, 0, v41
  v_sqrt_f32 v41, v41
  s_nop 0
  v_cvt_pk_bf16_f32 v41, 0, v41
  v_rcp_f32 v41, v41
  s_nop 0
  v_mul_f32 v44, v44, v41
  v_mul_f32 v45, v45, v41
  v_mul_f32 v46, v46, v41
  v_mul_f32 v47, v47, v41
  v_mul_f32 v48, v48, v41
  v_mul_f32 v49, v49, v41
  v_mul_f32 v50, v50, v41
  v_mul_f32 v51, v51, v41
  v_cvt_pk_bf16_f32 v68, v44, v45
  v_cvt_pk_bf16_f32 v69, v46, v47
  v_cvt_pk_bf16_f32 v70, v48, v49
  v_cvt_pk_bf16_f32 v71, v50, v51
  s_waitcnt vmcnt(0)
  s_mov_b64 exec, 1
  buffer_store_dword v60, v61, s[4:7], s27 offen sc1
  s_mov_b64 exec, -1
  s_add_u32 s27, s27, 1024
  buffer_store_dwordx4 v[68:71], v0, s[4:7], s26 offen sc1
  s_add_u32 s26, s26, 262144
  v_lshlrev_b32 v32, 16, v72
  v_and_b32 v33, 0xffff0000, v72
  v_lshlrev_b32 v34, 16, v73
  v_and_b32 v35, 0xffff0000, v73
  v_lshlrev_b32 v36, 16, v74
  v_and_b32 v37, 0xffff0000, v74
  v_lshlrev_b32 v38, 16, v75
  v_and_b32 v39, 0xffff0000, v75
  v_add_f32 v40, v32, v33
  v_add_f32 v41, v34, v35
  v_add_f32 v42, v36, v37
  v_add_f32 v43, v38, v39
  v_add_f32 v40, v40, v41
  v_add_f32 v42, v42, v43
  v_add_f32 v40, v40, v42
  s_nop 1
  v_add_f32_dpp v40, v40, v40 row_ror:8 row_mask:0xf bank_mask:0xf
  s_nop 1
  v_add_f32_dpp v40, v40, v40 row_ror:4 row_mask:0xf bank_mask:0xf
  s_nop 1
  v_add_f32_dpp v40, v40, v40 row_ror:2 row_mask:0xf bank_mask:0xf
  s_nop 1
  v_add_f32_dpp v40, v40, v40 row_ror:1 row_mask:0xf bank_mask:0xf
  v_mov_b32 v42, v40
  s_nop 0
  s_nop 0
  v_permlane16_swap_b32 v40, v42
  v_add_f32 v40, v40, v42
  v_mov_b32 v42, v40
  s_nop 0
  s_nop 0
  v_permlane32_swap_b32 v40, v42
  v_add_f32 v40, v40, v42
  v_mul_f32 v40, 0x3b000000, v40
  v_sub_f32 v44, v32, v40
  v_sub_f32 v45, v33, v40
  v_sub_f32 v46, v34, v40
  v_sub_f32 v47, v35, v40
  v_sub_f32 v48, v36, v40
  v_sub_f32 v49, v37, v40
  v_sub_f32 v50, v38, v40
  v_sub_f32 v51, v39, v40
  v_mul_f32 v41, v44, v44
  v_mul_f32 v42, v45, v45
  v_fmac_f32 v41, v46, v46
  v_fmac_f32 v42, v47, v47
  v_fmac_f32 v41, v48, v48
  v_fmac_f32 v42, v49, v49
  v_fmac_f32 v41, v50, v50
  v_fmac_f32 v42, v51, v51
  v_add_f32 v41, v41, v42
  v_cvt_pk_bf16_f32 v40, 0, v40
  s_nop 0
  v_add_f32_dpp v41, v41, v41 row_ror:8 row_mask:0xf bank_mask:0xf
  v_sub_f32 v44, v32, v40
  v_sub_f32 v45, v33, v40
  v_add_f32_dpp v41, v41, v41 row_ror:4 row_mask:0xf bank_mask:0xf
  v_sub_f32 v46, v34, v40
  v_sub_f32 v47, v35, v40
  v_add_f32_dpp v41, v41, v41 row_ror:2 row_mask:0xf bank_mask:0xf
  v_sub_f32 v48, v36, v40
  v_sub_f32 v49, v37, v40
  v_add_f32_dpp v41, v41, v41 row_ror:1 row_mask:0xf bank_mask:0xf
  v_sub_f32 v50, v38, v40
  v_sub_f32 v51, v39, v40
  v_mov_b32 v42, v41
  v_cvt_pk_bf16_f32 v44, 0, v44
  v_cvt_pk_bf16_f32 v45, 0, v45
  v_permlane16_swap_b32 v41, v42
  v_cvt_pk_bf16_f32 v46, 0, v46
  v_cvt_pk_bf16_f32 v47, 0, v47
  v_add_f32 v41, v41, v42
  v_cvt_pk_bf16_f32 v48, 0, v48
  v_cvt_pk_bf16_f32 v49, 0, v49
  v_mov_b32 v42, v41
  v_cvt_pk_bf16_f32 v50, 0, v50
  v_cvt_pk_bf16_f32 v51, 0, v51
  v_permlane32_swap_b32 v41, v42
  v_add_f32 v41, v41, v42
  v_mul_f32 v41, 0x3b000000, v41
  v_cvt_pk_bf16_f32 v41, 0, v41
  v_add_f32 v41, 0x3727c5ac, v41
  v_cvt_pk_bf16_f32 v41, 0, v41
  v_sqrt_f32 v41, v41
  s_nop 0
  v_cvt_pk_bf16_f32 v41, 0, v41
  v_rcp_f32 v41, v41
  s_nop 0
  v_mul_f32 v44, v44, v41
  v_mul_f32 v45, v45, v41
  v_mul_f32 v46, v46, v41
  v_mul_f32 v47, v47, v41
  v_mul_f32 v48, v48, v41
  v_mul_f32 v49, v49, v41
  v_mul_f32 v50, v50, v41
  v_mul_f32 v51, v51, v41
  v_cvt_pk_bf16_f32 v72, v44, v45
  v_cvt_pk_bf16_f32 v73, v46, v47
  v_cvt_pk_bf16_f32 v74, v48, v49
  v_cvt_pk_bf16_f32 v75, v50, v51
  s_waitcnt vmcnt(0)
  s_mov_b64 exec, 1
  buffer_store_dword v60, v61, s[4:7], s27 offen sc1
  s_mov_b64 exec, -1
  s_add_u32 s27, s27, 1024
  buffer_store_dwordx4 v[72:75], v0, s[4:7], s26 offen sc1
  s_add_u32 s26, s26, 262144
  v_lshlrev_b32 v32, 16, v76
  v_and_b32 v33, 0xffff0000, v76
  v_lshlrev_b32 v34, 16, v77
  v_and_b32 v35, 0xffff0000, v77
  v_lshlrev_b32 v36, 16, v78
  v_and_b32 v37, 0xffff0000, v78
  v_lshlrev_b32 v38, 16, v79
  v_and_b32 v39, 0xffff0000, v79
  v_add_f32 v40, v32, v33
  v_add_f32 v41, v34, v35
  v_add_f32 v42, v36, v37
  v_add_f32 v43, v38, v39
  v_add_f32 v40, v40, v41
  v_add_f32 v42, v42, v43
  v_add_f32 v40, v40, v42
  s_nop 1
  v_add_f32_dpp v40, v40, v40 row_ror:8 row_mask:0xf bank_mask:0xf
  s_nop 1
  v_add_f32_dpp v40, v40, v40 row_ror:4 row_mask:0xf bank_mask:0xf
  s_nop 1
  v_add_f32_dpp v40, v40, v40 row_ror:2 row_mask:0xf bank_mask:0xf
  s_nop 1
  v_add_f32_dpp v40, v40, v40 row_ror:1 row_mask:0xf bank_mask:0xf
  v_mov_b32 v42, v40
  s_nop 0
  s_nop 0
  v_permlane16_swap_b32 v40, v42
  v_add_f32 v40, v40, v42
  v_mov_b32 v42, v40
  s_nop 0
  s_nop 0
  v_permlane32_swap_b32 v40, v42
  v_add_f32 v40, v40, v42
  v_mul_f32 v40, 0x3b000000, v40
  v_sub_f32 v44, v32, v40
  v_sub_f32 v45, v33, v40
  v_sub_f32 v46, v34, v40
  v_sub_f32 v47, v35, v40
  v_sub_f32 v48, v36, v40
  v_sub_f32 v49, v37, v40
  v_sub_f32 v50, v38, v40
  v_sub_f32 v51, v39, v40
  v_mul_f32 v41, v44, v44
  v_mul_f32 v42, v45, v45
  v_fmac_f32 v41, v46, v46
  v_fmac_f32 v42, v47, v47
  v_fmac_f32 v41, v48, v48
  v_fmac_f32 v42, v49, v49
  v_fmac_f32 v41, v50, v50
  v_fmac_f32 v42, v51, v51
  v_add_f32 v41, v41, v42
  v_cvt_pk_bf16_f32 v40, 0, v40
  s_nop 0
  v_add_f32_dpp v41, v41, v41 row_ror:8 row_mask:0xf bank_mask:0xf
  v_sub_f32 v44, v32, v40
  v_sub_f32 v45, v33, v40
  v_add_f32_dpp v41, v41, v41 row_ror:4 row_mask:0xf bank_mask:0xf
  v_sub_f32 v46, v34, v40
  v_sub_f32 v47, v35, v40
  v_add_f32_dpp v41, v41, v41 row_ror:2 row_mask:0xf bank_mask:0xf
  v_sub_f32 v48, v36, v40
  v_sub_f32 v49, v37, v40
  v_add_f32_dpp v41, v41, v41 row_ror:1 row_mask:0xf bank_mask:0xf
  v_sub_f32 v50, v38, v40
  v_sub_f32 v51, v39, v40
  v_mov_b32 v42, v41
  v_cvt_pk_bf16_f32 v44, 0, v44
  v_cvt_pk_bf16_f32 v45, 0, v45
  v_permlane16_swap_b32 v41, v42
  v_cvt_pk_bf16_f32 v46, 0, v46
  v_cvt_pk_bf16_f32 v47, 0, v47
  v_add_f32 v41, v41, v42
  v_cvt_pk_bf16_f32 v48, 0, v48
  v_cvt_pk_bf16_f32 v49, 0, v49
  v_mov_b32 v42, v41
  v_cvt_pk_bf16_f32 v50, 0, v50
  v_cvt_pk_bf16_f32 v51, 0, v51
  v_permlane32_swap_b32 v41, v42
  v_add_f32 v41, v41, v42
  v_mul_f32 v41, 0x3b000000, v41
  v_cvt_pk_bf16_f32 v41, 0, v41
  v_add_f32 v41, 0x3727c5ac, v41
  v_cvt_pk_bf16_f32 v41, 0, v41
  v_sqrt_f32 v41, v41
  s_nop 0
  v_cvt_pk_bf16_f32 v41, 0, v41
  v_rcp_f32 v41, v41
  s_nop 0
  v_mul_f32 v44, v44, v41
  v_mul_f32 v45, v45, v41
  v_mul_f32 v46, v46, v41
  v_mul_f32 v47, v47, v41
  v_mul_f32 v48, v48, v41
  v_mul_f32 v49, v49, v41
  v_mul_f32 v50, v50, v41
  v_mul_f32 v51, v51, v41
  v_cvt_pk_bf16_f32 v76, v44, v45
  v_cvt_pk_bf16_f32 v77, v46, v47
  v_cvt_pk_bf16_f32 v78, v48, v49
  v_cvt_pk_bf16_f32 v79, v50, v51
  s_waitcnt vmcnt(0)
  s_mov_b64 exec, 1
  buffer_store_dword v60, v61, s[4:7], s27 offen sc1
  s_mov_b64 exec, -1
  s_add_u32 s27, s27, 1024
  buffer_store_dwordx4 v[76:79], v0, s[4:7], s26 offen sc1
  s_add_u32 s26, s26, 262144
  v_lshlrev_b32 v32, 16, v80
  v_and_b32 v33, 0xffff0000, v80
  v_lshlrev_b32 v34, 16, v81
  v_and_b32 v35, 0xffff0000, v81
  v_lshlrev_b32 v36, 16, v82
  v_and_b32 v37, 0xffff0000, v82
  v_lshlrev_b32 v38, 16, v83
  v_and_b32 v39, 0xffff0000, v83
  v_add_f32 v40, v32, v33
  v_add_f32 v41, v34, v35
  v_add_f32 v42, v36, v37
  v_add_f32 v43, v38, v39
  v_add_f32 v40, v40, v41
  v_add_f32 v42, v42, v43
  v_add_f32 v40, v40, v42
  s_nop 1
  v_add_f32_dpp v40, v40, v40 row_ror:8 row_mask:0xf bank_mask:0xf
  s_nop 1
  v_add_f32_dpp v40, v40, v40 row_ror:4 row_mask:0xf bank_mask:0xf
  s_nop 1
  v_add_f32_dpp v40, v40, v40 row_ror:2 row_mask:0xf bank_mask:0xf
  s_nop 1
  v_add_f32_dpp v40, v40, v40 row_ror:1 row_mask:0xf bank_mask:0xf
  v_mov_b32 v42, v40
  s_nop 0
  s_nop 0
  v_permlane16_swap_b32 v40, v42
  v_add_f32 v40, v40, v42
  v_mov_b32 v42, v40
  s_nop 0
  s_nop 0
  v_permlane32_swap_b32 v40, v42
  v_add_f32 v40, v40, v42
  v_mul_f32 v40, 0x3b000000, v40
  v_sub_f32 v44, v32, v40
  v_sub_f32 v45, v33, v40
  v_sub_f32 v46, v34, v40
  v_sub_f32 v47, v35, v40
  v_sub_f32 v48, v36, v40
  v_sub_f32 v49, v37, v40
  v_sub_f32 v50, v38, v40
  v_sub_f32 v51, v39, v40
  v_mul_f32 v41, v44, v44
  v_mul_f32 v42, v45, v45
  v_fmac_f32 v41, v46, v46
  v_fmac_f32 v42, v47, v47
  v_fmac_f32 v41, v48, v48
  v_fmac_f32 v42, v49, v49
  v_fmac_f32 v41, v50, v50
  v_fmac_f32 v42, v51, v51
  v_add_f32 v41, v41, v42
  v_cvt_pk_bf16_f32 v40, 0, v40
  s_nop 0
  v_add_f32_dpp v41, v41, v41 row_ror:8 row_mask:0xf bank_mask:0xf
  v_sub_f32 v44, v32, v40
  v_sub_f32 v45, v33, v40
  v_add_f32_dpp v41, v41, v41 row_ror:4 row_mask:0xf bank_mask:0xf
  v_sub_f32 v46, v34, v40
  v_sub_f32 v47, v35, v40
  v_add_f32_dpp v41, v41, v41 row_ror:2 row_mask:0xf bank_mask:0xf
  v_sub_f32 v48, v36, v40
  v_sub_f32 v49, v37, v40
  v_add_f32_dpp v41, v41, v41 row_ror:1 row_mask:0xf bank_mask:0xf
  v_sub_f32 v50, v38, v40
  v_sub_f32 v51, v39, v40
  v_mov_b32 v42, v41
  v_cvt_pk_bf16_f32 v44, 0, v44
  v_cvt_pk_bf16_f32 v45, 0, v45
  v_permlane16_swap_b32 v41, v42
  v_cvt_pk_bf16_f32 v46, 0, v46
  v_cvt_pk_bf16_f32 v47, 0, v47
  v_add_f32 v41, v41, v42
  v_cvt_pk_bf16_f32 v48, 0, v48
  v_cvt_pk_bf16_f32 v49, 0, v49
  v_mov_b32 v42, v41
  v_cvt_pk_bf16_f32 v50, 0, v50
  v_cvt_pk_bf16_f32 v51, 0, v51
  v_permlane32_swap_b32 v41, v42
  v_add_f32 v41, v41, v42
  v_mul_f32 v41, 0x3b000000, v41
  v_cvt_pk_bf16_f32 v41, 0, v41
  v_add_f32 v41, 0x3727c5ac, v41
  v_cvt_pk_bf16_f32 v41, 0, v41
  v_sqrt_f32 v41, v41
  s_nop 0
  v_cvt_pk_bf16_f32 v41, 0, v41
  v_rcp_f32 v41, v41
  s_nop 0
  v_mul_f32 v44, v44, v41
  v_mul_f32 v45, v45, v41
  v_mul_f32 v46, v46, v41
  v_mul_f32 v47, v47, v41
  v_mul_f32 v48, v48, v41
  v_mul_f32 v49, v49, v41
  v_mul_f32 v50, v50, v41
  v_mul_f32 v51, v51, v41
  v_cvt_pk_bf16_f32 v80, v44, v45
  v_cvt_pk_bf16_f32 v81, v46, v47
  v_cvt_pk_bf16_f32 v82, v48, v49
  v_cvt_pk_bf16_f32 v83, v50, v51
  s_waitcnt vmcnt(0)
  s_mov_b64 exec, 1
  buffer_store_dword v60, v61, s[4:7], s27 offen sc1
  s_mov_b64 exec, -1
  s_add_u32 s27, s27, 1024
  buffer_store_dwordx4 v[80:83], v0, s[4:7], s26 offen sc1
  s_add_u32 s26, s26, 262144
  v_lshlrev_b32 v32, 16, v84
  v_and_b32 v33, 0xffff0000, v84
  v_lshlrev_b32 v34, 16, v85
  v_and_b32 v35, 0xffff0000, v85
  v_lshlrev_b32 v36, 16, v86
  v_and_b32 v37, 0xffff0000, v86
  v_lshlrev_b32 v38, 16, v87
  v_and_b32 v39, 0xffff0000, v87
  v_add_f32 v40, v32, v33
  v_add_f32 v41, v34, v35
  v_add_f32 v42, v36, v37
  v_add_f32 v43, v38, v39
  v_add_f32 v40, v40, v41
  v_add_f32 v42, v42, v43
  v_add_f32 v40, v40, v42
  s_nop 1
  v_add_f32_dpp v40, v40, v40 row_ror:8 row_mask:0xf bank_mask:0xf
  s_nop 1
  v_add_f32_dpp v40, v40, v40 row_ror:4 row_mask:0xf bank_mask:0xf
  s_nop 1
  v_add_f32_dpp v40, v40, v40 row_ror:2 row_mask:0xf bank_mask:0xf
  s_nop 1
  v_add_f32_dpp v40, v40, v40 row_ror:1 row_mask:0xf bank_mask:0xf
  v_mov_b32 v42, v40
  s_nop 0
  s_nop 0
  v_permlane16_swap_b32 v40, v42
  v_add_f32 v40, v40, v42
  v_mov_b32 v42, v40
  s_nop 0
  s_nop 0
  v_permlane32_swap_b32 v40, v42
  v_add_f32 v40, v40, v42
  v_mul_f32 v40, 0x3b000000, v40
  v_sub_f32 v44, v32, v40
  v_sub_f32 v45, v33, v40
  v_sub_f32 v46, v34, v40
  v_sub_f32 v47, v35, v40
  v_sub_f32 v48, v36, v40
  v_sub_f32 v49, v37, v40
  v_sub_f32 v50, v38, v40
  v_sub_f32 v51, v39, v40
  v_mul_f32 v41, v44, v44
  v_mul_f32 v42, v45, v45
  v_fmac_f32 v41, v46, v46
  v_fmac_f32 v42, v47, v47
  v_fmac_f32 v41, v48, v48
  v_fmac_f32 v42, v49, v49
  v_fmac_f32 v41, v50, v50
  v_fmac_f32 v42, v51, v51
  v_add_f32 v41, v41, v42
  v_cvt_pk_bf16_f32 v40, 0, v40
  s_nop 0
  v_add_f32_dpp v41, v41, v41 row_ror:8 row_mask:0xf bank_mask:0xf
  v_sub_f32 v44, v32, v40
  v_sub_f32 v45, v33, v40
  v_add_f32_dpp v41, v41, v41 row_ror:4 row_mask:0xf bank_mask:0xf
  v_sub_f32 v46, v34, v40
  v_sub_f32 v47, v35, v40
  v_add_f32_dpp v41, v41, v41 row_ror:2 row_mask:0xf bank_mask:0xf
  v_sub_f32 v48, v36, v40
  v_sub_f32 v49, v37, v40
  v_add_f32_dpp v41, v41, v41 row_ror:1 row_mask:0xf bank_mask:0xf
  v_sub_f32 v50, v38, v40
  v_sub_f32 v51, v39, v40
  v_mov_b32 v42, v41
  v_cvt_pk_bf16_f32 v44, 0, v44
  v_cvt_pk_bf16_f32 v45, 0, v45
  v_permlane16_swap_b32 v41, v42
  v_cvt_pk_bf16_f32 v46, 0, v46
  v_cvt_pk_bf16_f32 v47, 0, v47
  v_add_f32 v41, v41, v42
  v_cvt_pk_bf16_f32 v48, 0, v48
  v_cvt_pk_bf16_f32 v49, 0, v49
  v_mov_b32 v42, v41
  v_cvt_pk_bf16_f32 v50, 0, v50
  v_cvt_pk_bf16_f32 v51, 0, v51
  v_permlane32_swap_b32 v41, v42
  v_add_f32 v41, v41, v42
  v_mul_f32 v41, 0x3b000000, v41
  v_cvt_pk_bf16_f32 v41, 0, v41
  v_add_f32 v41, 0x3727c5ac, v41
  v_cvt_pk_bf16_f32 v41, 0, v41
  v_sqrt_f32 v41, v41
  s_nop 0
  v_cvt_pk_bf16_f32 v41, 0, v41
  v_rcp_f32 v41, v41
  s_nop 0
  v_mul_f32 v44, v44, v41
  v_mul_f32 v45, v45, v41
  v_mul_f32 v46, v46, v41
  v_mul_f32 v47, v47, v41
  v_mul_f32 v48, v48, v41
  v_mul_f32 v49, v49, v41
  v_mul_f32 v50, v50, v41
  v_mul_f32 v51, v51, v41
  v_cvt_pk_bf16_f32 v84, v44, v45
  v_cvt_pk_bf16_f32 v85, v46, v47
  v_cvt_pk_bf16_f32 v86, v48, v49
  v_cvt_pk_bf16_f32 v87, v50, v51
  s_waitcnt vmcnt(0)
  s_mov_b64 exec, 1
  buffer_store_dword v60, v61, s[4:7], s27 offen sc1
  s_mov_b64 exec, -1
  s_add_u32 s27, s27, 1024
  buffer_store_dwordx4 v[84:87], v0, s[4:7], s26 offen sc1
  s_add_u32 s26, s26, 262144
  v_lshlrev_b32 v32, 16, v88
  v_and_b32 v33, 0xffff0000, v88
  v_lshlrev_b32 v34, 16, v89
  v_and_b32 v35, 0xffff0000, v89
  v_lshlrev_b32 v36, 16, v90
  v_and_b32 v37, 0xffff0000, v90
  v_lshlrev_b32 v38, 16, v91
  v_and_b32 v39, 0xffff0000, v91
  v_add_f32 v40, v32, v33
  v_add_f32 v41, v34, v35
  v_add_f32 v42, v36, v37
  v_add_f32 v43, v38, v39
  v_add_f32 v40, v40, v41
  v_add_f32 v42, v42, v43
  v_add_f32 v40, v40, v42
  s_nop 1
  v_add_f32_dpp v40, v40, v40 row_ror:8 row_mask:0xf bank_mask:0xf
  s_nop 1
  v_add_f32_dpp v40, v40, v40 row_ror:4 row_mask:0xf bank_mask:0xf
  s_nop 1
  v_add_f32_dpp v40, v40, v40 row_ror:2 row_mask:0xf bank_mask:0xf
  s_nop 1
  v_add_f32_dpp v40, v40, v40 row_ror:1 row_mask:0xf bank_mask:0xf
  v_mov_b32 v42, v40
  s_nop 0
  s_nop 0
  v_permlane16_swap_b32 v40, v42
  v_add_f32 v40, v40, v42
  v_mov_b32 v42, v40
  s_nop 0
  s_nop 0
  v_permlane32_swap_b32 v40, v42
  v_add_f32 v40, v40, v42
  v_mul_f32 v40, 0x3b000000, v40
  v_sub_f32 v44, v32, v40
  v_sub_f32 v45, v33, v40
  v_sub_f32 v46, v34, v40
  v_sub_f32 v47, v35, v40
  v_sub_f32 v48, v36, v40
  v_sub_f32 v49, v37, v40
  v_sub_f32 v50, v38, v40
  v_sub_f32 v51, v39, v40
  v_mul_f32 v41, v44, v44
  v_mul_f32 v42, v45, v45
  v_fmac_f32 v41, v46, v46
  v_fmac_f32 v42, v47, v47
  v_fmac_f32 v41, v48, v48
  v_fmac_f32 v42, v49, v49
  v_fmac_f32 v41, v50, v50
  v_fmac_f32 v42, v51, v51
  v_add_f32 v41, v41, v42
  v_cvt_pk_bf16_f32 v40, 0, v40
  s_nop 0
  v_add_f32_dpp v41, v41, v41 row_ror:8 row_mask:0xf bank_mask:0xf
  v_sub_f32 v44, v32, v40
  v_sub_f32 v45, v33, v40
  v_add_f32_dpp v41, v41, v41 row_ror:4 row_mask:0xf bank_mask:0xf
  v_sub_f32 v46, v34, v40
  v_sub_f32 v47, v35, v40
  v_add_f32_dpp v41, v41, v41 row_ror:2 row_mask:0xf bank_mask:0xf
  v_sub_f32 v48, v36, v40
  v_sub_f32 v49, v37, v40
  v_add_f32_dpp v41, v41, v41 row_ror:1 row_mask:0xf bank_mask:0xf
  v_sub_f32 v50, v38, v40
  v_sub_f32 v51, v39, v40
  v_mov_b32 v42, v41
  v_cvt_pk_bf16_f32 v44, 0, v44
  v_cvt_pk_bf16_f32 v45, 0, v45
  v_permlane16_swap_b32 v41, v42
  v_cvt_pk_bf16_f32 v46, 0, v46
  v_cvt_pk_bf16_f32 v47, 0, v47
  v_add_f32 v41, v41, v42
  v_cvt_pk_bf16_f32 v48, 0, v48
  v_cvt_pk_bf16_f32 v49, 0, v49
  v_mov_b32 v42, v41
  v_cvt_pk_bf16_f32 v50, 0, v50
  v_cvt_pk_bf16_f32 v51, 0, v51
  v_permlane32_swap_b32 v41, v42
  v_add_f32 v41, v41, v42
  v_mul_f32 v41, 0x3b000000, v41
  v_cvt_pk_bf16_f32 v41, 0, v41
  v_add_f32 v41, 0x3727c5ac, v41
  v_cvt_pk_bf16_f32 v41, 0, v41
  v_sqrt_f32 v41, v41
  s_nop 0
  v_cvt_pk_bf16_f32 v41, 0, v41
  v_rcp_f32 v41, v41
  s_nop 0
  v_mul_f32 v44, v44, v41
  v_mul_f32 v45, v45, v41
  v_mul_f32 v46, v46, v41
  v_mul_f32 v47, v47, v41
  v_mul_f32 v48, v48, v41
  v_mul_f32 v49, v49, v41
  v_mul_f32 v50, v50, v41
  v_mul_f32 v51, v51, v41
  v_cvt_pk_bf16_f32 v88, v44, v45
  v_cvt_pk_bf16_f32 v89, v46, v47
  v_cvt_pk_bf16_f32 v90, v48, v49
  v_cvt_pk_bf16_f32 v91, v50, v51
  s_waitcnt vmcnt(0)
  s_mov_b64 exec, 1
  buffer_store_dword v60, v61, s[4:7], s27 offen sc1
  s_mov_b64 exec, -1
  s_add_u32 s27, s27, 1024
  buffer_store_dwordx4 v[88:91], v0, s[4:7], s26 offen sc1
  s_add_u32 s26, s26, 262144
  v_lshlrev_b32 v32, 16, v92
  v_and_b32 v33, 0xffff0000, v92
  v_lshlrev_b32 v34, 16, v93
  v_and_b32 v35, 0xffff0000, v93
  v_lshlrev_b32 v36, 16, v94
  v_and_b32 v37, 0xffff0000, v94
  v_lshlrev_b32 v38, 16, v95
  v_and_b32 v39, 0xffff0000, v95
  v_add_f32 v40, v32, v33
  v_add_f32 v41, v34, v35
  v_add_f32 v42, v36, v37
  v_add_f32 v43, v38, v39
  v_add_f32 v40, v40, v41
  v_add_f32 v42, v42, v43
  v_add_f32 v40, v40, v42
  s_nop 1
  v_add_f32_dpp v40, v40, v40 row_ror:8 row_mask:0xf bank_mask:0xf
  s_nop 1
  v_add_f32_dpp v40, v40, v40 row_ror:4 row_mask:0xf bank_mask:0xf
  s_nop 1
  v_add_f32_dpp v40, v40, v40 row_ror:2 row_mask:0xf bank_mask:0xf
  s_nop 1
  v_add_f32_dpp v40, v40, v40 row_ror:1 row_mask:0xf bank_mask:0xf
  v_mov_b32 v42, v40
  s_nop 0
  s_nop 0
  v_permlane16_swap_b32 v40, v42
  v_add_f32 v40, v40, v42
  v_mov_b32 v42, v40
  s_nop 0
  s_nop 0
  v_permlane32_swap_b32 v40, v42
  v_add_f32 v40, v40, v42
  v_mul_f32 v40, 0x3b000000, v40
  v_sub_f32 v44, v32, v40
  v_sub_f32 v45, v33, v40
  v_sub_f32 v46, v34, v40
  v_sub_f32 v47, v35, v40
  v_sub_f32 v48, v36, v40
  v_sub_f32 v49, v37, v40
  v_sub_f32 v50, v38, v40
  v_sub_f32 v51, v39, v40
  v_mul_f32 v41, v44, v44
  v_mul_f32 v42, v45, v45
  v_fmac_f32 v41, v46, v46
  v_fmac_f32 v42, v47, v47
  v_fmac_f32 v41, v48, v48
  v_fmac_f32 v42, v49, v49
  v_fmac_f32 v41, v50, v50
  v_fmac_f32 v42, v51, v51
  v_add_f32 v41, v41, v42
  v_cvt_pk_bf16_f32 v40, 0, v40
  s_nop 0
  v_add_f32_dpp v41, v41, v41 row_ror:8 row_mask:0xf bank_mask:0xf
  v_sub_f32 v44, v32, v40
  v_sub_f32 v45, v33, v40
  v_add_f32_dpp v41, v41, v41 row_ror:4 row_mask:0xf bank_mask:0xf
  v_sub_f32 v46, v34, v40
  v_sub_f32 v47, v35, v40
  v_add_f32_dpp v41, v41, v41 row_ror:2 row_mask:0xf bank_mask:0xf
  v_sub_f32 v48, v36, v40
  v_sub_f32 v49, v37, v40
  v_add_f32_dpp v41, v41, v41 row_ror:1 row_mask:0xf bank_mask:0xf
  v_sub_f32 v50, v38, v40
  v_sub_f32 v51, v39, v40
  v_mov_b32 v42, v41
  v_cvt_pk_bf16_f32 v44, 0, v44
  v_cvt_pk_bf16_f32 v45, 0, v45
  v_permlane16_swap_b32 v41, v42
  v_cvt_pk_bf16_f32 v46, 0, v46
  v_cvt_pk_bf16_f32 v47, 0, v47
  v_add_f32 v41, v41, v42
  v_cvt_pk_bf16_f32 v48, 0, v48
  v_cvt_pk_bf16_f32 v49, 0, v49
  v_mov_b32 v42, v41
  v_cvt_pk_bf16_f32 v50, 0, v50
  v_cvt_pk_bf16_f32 v51, 0, v51
  v_permlane32_swap_b32 v41, v42
  v_add_f32 v41, v41, v42
  v_mul_f32 v41, 0x3b000000, v41
  v_cvt_pk_bf16_f32 v41, 0, v41
  v_add_f32 v41, 0x3727c5ac, v41
  v_cvt_pk_bf16_f32 v41, 0, v41
  v_sqrt_f32 v41, v41
  s_nop 0
  v_cvt_pk_bf16_f32 v41, 0, v41
  v_rcp_f32 v41, v41
  s_nop 0
  v_mul_f32 v44, v44, v41
  v_mul_f32 v45, v45, v41
  v_mul_f32 v46, v46, v41
  v_mul_f32 v47, v47, v41
  v_mul_f32 v48, v48, v41
  v_mul_f32 v49, v49, v41
  v_mul_f32 v50, v50, v41
  v_mul_f32 v51, v51, v41
  v_cvt_pk_bf16_f32 v92, v44, v45
  v_cvt_pk_bf16_f32 v93, v46, v47
  v_cvt_pk_bf16_f32 v94, v48, v49
  v_cvt_pk_bf16_f32 v95, v50, v51
  s_waitcnt vmcnt(0)
  s_mov_b64 exec, 1
  buffer_store_dword v60, v61, s[4:7], s27 offen sc1
  s_mov_b64 exec, -1
  s_add_u32 s27, s27, 1024
  buffer_store_dwordx4 v[92:95], v0, s[4:7], s26 offen sc1
  s_add_u32 s26, s26, 262144
  s_waitcnt vmcnt(0)
  s_mov_b64 exec, 1
  buffer_store_dword v60, v61, s[4:7], s27 offen sc1
  s_mov_b64 exec, -1
  s_load_dwordx2 s[8:9], s[0:1], 40
  s_mov_b32 s10, 4194304
  v_lshlrev_b32 v26, 13, v25
  v_lshl_add_u32 v26, v24, 4, v26
  s_lshl_b32 s26, s61, 18
  s_lshl_b32 s27, s17, 8
  s_add_u32 s26, s26, s27
  s_waitcnt lgkmcnt(0)
  s_add_u32 s27, s26, 0
  buffer_load_dwordx4 v[64:67], v26, s[8:11], s27 offen
  s_add_u32 s27, s26, 2048
  buffer_load_dwordx4 v[68:71], v26, s[8:11], s27 offen
  s_add_u32 s27, s26, 4096
  buffer_load_dwordx4 v[72:75], v26, s[8:11], s27 offen
  s_add_u32 s27, s26, 6144
  buffer_load_dwordx4 v[76:79], v26, s[8:11], s27 offen
  s_add_u32 s27, s26, 1024
  buffer_load_dwordx4 v[80:83], v26, s[8:11], s27 offen
  s_add_u32 s27, s26, 3072
  buffer_load_dwordx4 v[84:87], v26, s[8:11], s27 offen
  s_add_u32 s27, s26, 5120
  buffer_load_dwordx4 v[88:91], v26, s[8:11], s27 offen
  s_add_u32 s27, s26, 7168
  buffer_load_dwordx4 v[92:95], v26, s[8:11], s27 offen
  s_add_u32 s27, s26, 32768
  buffer_load_dwordx4 v[96:99], v26, s[8:11], s27 offen
  s_add_u32 s27, s26, 34816
  buffer_load_dwordx4 v[100:103], v26, s[8:11], s27 offen
  s_add_u32 s27, s26, 36864
  buffer_load_dwordx4 v[104:107], v26, s[8:11], s27 offen
  s_add_u32 s27, s26, 38912
  buffer_load_dwordx4 v[108:111], v26, s[8:11], s27 offen
  s_add_u32 s27, s26, 33792
  buffer_load_dwordx4 v[112:115], v26, s[8:11], s27 offen
  s_add_u32 s27, s26, 35840
  buffer_load_dwordx4 v[116:119], v26, s[8:11], s27 offen
  s_add_u32 s27, s26, 37888
  buffer_load_dwordx4 v[120:123], v26, s[8:11], s27 offen
  s_add_u32 s27, s26, 39936
  buffer_load_dwordx4 v[124:127], v26, s[8:11], s27 offen
  s_add_u32 s27, s26, 65536
  buffer_load_dwordx4 v[128:131], v26, s[8:11], s27 offen
  s_add_u32 s27, s26, 67584
  buffer_load_dwordx4 v[132:135], v26, s[8:11], s27 offen
  s_add_u32 s27, s26, 69632
  buffer_load_dwordx4 v[136:139], v26, s[8:11], s27 offen
  s_add_u32 s27, s26, 71680
  buffer_load_dwordx4 v[140:143], v26, s[8:11], s27 offen
  s_add_u32 s27, s26, 66560
  buffer_load_dwordx4 v[144:147], v26, s[8:11], s27 offen
  s_add_u32 s27, s26, 68608
  buffer_load_dwordx4 v[148:151], v26, s[8:11], s27 offen
  s_add_u32 s27, s26, 70656
  buffer_load_dwordx4 v[152:155], v26, s[8:11], s27 offen
  s_add_u32 s27, s26, 72704
  buffer_load_dwordx4 v[156:159], v26, s[8:11], s27 offen
  s_add_u32 s27, s26, 98304
  buffer_load_dwordx4 v[160:163], v26, s[8:11], s27 offen
  s_add_u32 s27, s26, 100352
  buffer_load_dwordx4 v[164:167], v26, s[8:11], s27 offen
  s_add_u32 s27, s26, 102400
  buffer_load_dwordx4 v[168:171], v26, s[8:11], s27 offen
  s_add_u32 s27, s26, 104448
  buffer_load_dwordx4 v[172:175], v26, s[8:11], s27 offen
  s_add_u32 s27, s26, 99328
  buffer_load_dwordx4 v[176:179], v26, s[8:11], s27 offen
  s_add_u32 s27, s26, 101376
  buffer_load_dwordx4 v[180:183], v26, s[8:11], s27 offen
  s_add_u32 s27, s26, 103424
  buffer_load_dwordx4 v[184:187], v26, s[8:11], s27 offen
  s_add_u32 s27, s26, 105472
  buffer_load_dwordx4 v[188:191], v26, s[8:11], s27 offen
  s_add_u32 s27, s26, 131072
  buffer_load_dwordx4 v[192:195], v26, s[8:11], s27 offen
  s_add_u32 s27, s26, 133120
  buffer_load_dwordx4 v[196:199], v26, s[8:11], s27 offen
  s_add_u32 s27, s26, 135168
  buffer_load_dwordx4 v[200:203], v26, s[8:11], s27 offen
  s_add_u32 s27, s26, 137216
  buffer_load_dwordx4 v[204:207], v26, s[8:11], s27 offen
  s_add_u32 s27, s26, 132096
  buffer_load_dwordx4 v[208:211], v26, s[8:11], s27 offen
  s_add_u32 s27, s26, 134144
  buffer_load_dwordx4 v[212:215], v26, s[8:11], s27 offen
  s_add_u32 s27, s26, 136192
  buffer_load_dwordx4 v[216:219], v26, s[8:11], s27 offen
  s_add_u32 s27, s26, 138240
  buffer_load_dwordx4 v[220:223], v26, s[8:11], s27 offen
  s_add_u32 s27, s26, 163840
  buffer_load_dwordx4 v[224:227], v26, s[8:11], s27 offen
  s_add_u32 s27, s26, 165888
  buffer_load_dwordx4 v[228:231], v26, s[8:11], s27 offen
  s_add_u32 s27, s26, 167936
  buffer_load_dwordx4 v[232:235], v26, s[8:11], s27 offen
  s_add_u32 s27, s26, 169984
  buffer_load_dwordx4 v[236:239], v26, s[8:11], s27 offen
  s_add_u32 s27, s26, 164864
  buffer_load_dwordx4 v[240:243], v26, s[8:11], s27 offen
  s_add_u32 s27, s26, 166912
  buffer_load_dwordx4 v[244:247], v26, s[8:11], s27 offen
  s_add_u32 s27, s26, 168960
  buffer_load_dwordx4 v[248:251], v26, s[8:11], s27 offen
  s_add_u32 s27, s26, 171008
  buffer_load_dwordx4 v[252:255], v26, s[8:11], s27 offen
  s_waitcnt vmcnt(40)
  v_perm_b32 v32, v68, v64, s44
  v_perm_b32 v33, v76, v72, s44
  v_perm_b32 v34, v84, v80, s44
  v_perm_b32 v35, v92, v88, s44
  v_accvgpr_write_b32 a0, v32
  v_accvgpr_write_b32 a1, v33
  v_accvgpr_write_b32 a2, v34
  v_accvgpr_write_b32 a3, v35
  v_perm_b32 v36, v68, v64, s45
  v_perm_b32 v37, v76, v72, s45
  v_perm_b32 v38, v84, v80, s45
  v_perm_b32 v39, v92, v88, s45
  v_accvgpr_write_b32 a4, v36
  v_accvgpr_write_b32 a5, v37
  v_accvgpr_write_b32 a6, v38
  v_accvgpr_write_b32 a7, v39
  v_perm_b32 v32, v69, v65, s44
  v_perm_b32 v33, v77, v73, s44
  v_perm_b32 v34, v85, v81, s44
  v_perm_b32 v35, v93, v89, s44
  v_accvgpr_write_b32 a8, v32
  v_accvgpr_write_b32 a9, v33
  v_accvgpr_write_b32 a10, v34
  v_accvgpr_write_b32 a11, v35
  v_perm_b32 v36, v69, v65, s45
  v_perm_b32 v37, v77, v73, s45
  v_perm_b32 v38, v85, v81, s45
  v_perm_b32 v39, v93, v89, s45
  v_accvgpr_write_b32 a12, v36
  v_accvgpr_write_b32 a13, v37
  v_accvgpr_write_b32 a14, v38
  v_accvgpr_write_b32 a15, v39
  v_perm_b32 v32, v70, v66, s44
  v_perm_b32 v33, v78, v74, s44
  v_perm_b32 v34, v86, v82, s44
  v_perm_b32 v35, v94, v90, s44
  v_accvgpr_write_b32 a16, v32
  v_accvgpr_write_b32 a17, v33
  v_accvgpr_write_b32 a18, v34
  v_accvgpr_write_b32 a19, v35
  v_perm_b32 v36, v70, v66, s45
  v_perm_b32 v37, v78, v74, s45
  v_perm_b32 v38, v86, v82, s45
  v_perm_b32 v39, v94, v90, s45
  v_accvgpr_write_b32 a20, v36
  v_accvgpr_write_b32 a21, v37
  v_accvgpr_write_b32 a22, v38
  v_accvgpr_write_b32 a23, v39
  v_perm_b32 v32, v71, v67, s44
  v_perm_b32 v33, v79, v75, s44
  v_perm_b32 v34, v87, v83, s44
  v_perm_b32 v35, v95, v91, s44
  v_accvgpr_write_b32 a24, v32
  v_accvgpr_write_b32 a25, v33
  v_accvgpr_write_b32 a26, v34
  v_accvgpr_write_b32 a27, v35
  v_perm_b32 v36, v71, v67, s45
  v_perm_b32 v37, v79, v75, s45
  v_perm_b32 v38, v87, v83, s45
  v_perm_b32 v39, v95, v91, s45
  v_accvgpr_write_b32 a28, v36
  v_accvgpr_write_b32 a29, v37
  v_accvgpr_write_b32 a30, v38
  v_accvgpr_write_b32 a31, v39
  s_add_u32 s27, s26, 196608
  buffer_load_dwordx4 v[64:67], v26, s[8:11], s27 offen
  s_add_u32 s27, s26, 198656
  buffer_load_dwordx4 v[68:71], v26, s[8:11], s27 offen
  s_add_u32 s27, s26, 200704
  buffer_load_dwordx4 v[72:75], v26, s[8:11], s27 offen
  s_add_u32 s27, s26, 202752
  buffer_load_dwordx4 v[76:79], v26, s[8:11], s27 offen
  s_add_u32 s27, s26, 197632
  buffer_load_dwordx4 v[80:83], v26, s[8:11], s27 offen
  s_add_u32 s27, s26, 199680
  buffer_load_dwordx4 v[84:87], v26, s[8:11], s27 offen
  s_add_u32 s27, s26, 201728
  buffer_load_dwordx4 v[88:91], v26, s[8:11], s27 offen
  s_add_u32 s27, s26, 203776
  buffer_load_dwordx4 v[92:95], v26, s[8:11], s27 offen
  s_waitcnt vmcnt(40)
  v_perm_b32 v32, v100, v96, s44
  v_perm_b32 v33, v108, v104, s44
  v_perm_b32 v34, v116, v112, s44
  v_perm_b32 v35, v124, v120, s44
  v_accvgpr_write_b32 a32, v32
  v_accvgpr_write_b32 a33, v33
  v_accvgpr_write_b32 a34, v34
  v_accvgpr_write_b32 a35, v35
  v_perm_b32 v36, v100, v96, s45
  v_perm_b32 v37, v108, v104, s45
  v_perm_b32 v38, v116, v112, s45
  v_perm_b32 v39, v124, v120, s45
  v_accvgpr_write_b32 a36, v36
  v_accvgpr_write_b32 a37, v37
  v_accvgpr_write_b32 a38, v38
  v_accvgpr_write_b32 a39, v39
  v_perm_b32 v32, v101, v97, s44
  v_perm_b32 v33, v109, v105, s44
  v_perm_b32 v34, v117, v113, s44
  v_perm_b32 v35, v125, v121, s44
  v_accvgpr_write_b32 a40, v32
  v_accvgpr_write_b32 a41, v33
  v_accvgpr_write_b32 a42, v34
  v_accvgpr_write_b32 a43, v35
  v_perm_b32 v36, v101, v97, s45
  v_perm_b32 v37, v109, v105, s45
  v_perm_b32 v38, v117, v113, s45
  v_perm_b32 v39, v125, v121, s45
  v_accvgpr_write_b32 a44, v36
  v_accvgpr_write_b32 a45, v37
  v_accvgpr_write_b32 a46, v38
  v_accvgpr_write_b32 a47, v39
  v_perm_b32 v32, v102, v98, s44
  v_perm_b32 v33, v110, v106, s44
  v_perm_b32 v34, v118, v114, s44
  v_perm_b32 v35, v126, v122, s44
  v_accvgpr_write_b32 a48, v32
  v_accvgpr_write_b32 a49, v33
  v_accvgpr_write_b32 a50, v34
  v_accvgpr_write_b32 a51, v35
  v_perm_b32 v36, v102, v98, s45
  v_perm_b32 v37, v110, v106, s45
  v_perm_b32 v38, v118, v114, s45
  v_perm_b32 v39, v126, v122, s45
  v_accvgpr_write_b32 a52, v36
  v_accvgpr_write_b32 a53, v37
  v_accvgpr_write_b32 a54, v38
  v_accvgpr_write_b32 a55, v39
  v_perm_b32 v32, v103, v99, s44
  v_perm_b32 v33, v111, v107, s44
  v_perm_b32 v34, v119, v115, s44
  v_perm_b32 v35, v127, v123, s44
  v_accvgpr_write_b32 a56, v32
  v_accvgpr_write_b32 a57, v33
  v_accvgpr_write_b32 a58, v34
  v_accvgpr_write_b32 a59, v35
  v_perm_b32 v36, v103, v99, s45
  v_perm_b32 v37, v111, v107, s45
  v_perm_b32 v38, v119, v115, s45
  v_perm_b32 v39, v127, v123, s45
  v_accvgpr_write_b32 a60, v36
  v_accvgpr_write_b32 a61, v37
  v_accvgpr_write_b32 a62, v38
  v_accvgpr_write_b32 a63, v39
  s_add_u32 s27, s26, 229376
  buffer_load_dwordx4 v[96:99], v26, s[8:11], s27 offen
  s_add_u32 s27, s26, 231424
  buffer_load_dwordx4 v[100:103], v26, s[8:11], s27 offen
  s_add_u32 s27, s26, 233472
  buffer_load_dwordx4 v[104:107], v26, s[8:11], s27 offen
  s_add_u32 s27, s26, 235520
  buffer_load_dwordx4 v[108:111], v26, s[8:11], s27 offen
  s_add_u32 s27, s26, 230400
  buffer_load_dwordx4 v[112:115], v26, s[8:11], s27 offen
  s_add_u32 s27, s26, 232448
  buffer_load_dwordx4 v[116:119], v26, s[8:11], s27 offen
  s_add_u32 s27, s26, 234496
  buffer_load_dwordx4 v[120:123], v26, s[8:11], s27 offen
  s_add_u32 s27, s26, 236544
  buffer_load_dwordx4 v[124:127], v26, s[8:11], s27 offen
  s_waitcnt vmcnt(40)
  v_perm_b32 v32, v132, v128, s44
  v_perm_b32 v33, v140, v136, s44
  v_perm_b32 v34, v148, v144, s44
  v_perm_b32 v35, v156, v152, s44
  v_accvgpr_write_b32 a64, v32
  v_accvgpr_write_b32 a65, v33
  v_accvgpr_write_b32 a66, v34
  v_accvgpr_write_b32 a67, v35
  v_perm_b32 v36, v132, v128, s45
  v_perm_b32 v37, v140, v136, s45
  v_perm_b32 v38, v148, v144, s45
  v_perm_b32 v39, v156, v152, s45
  v_accvgpr_write_b32 a68, v36
  v_accvgpr_write_b32 a69, v37
  v_accvgpr_write_b32 a70, v38
  v_accvgpr_write_b32 a71, v39
  v_perm_b32 v32, v133, v129, s44
  v_perm_b32 v33, v141, v137, s44
  v_perm_b32 v34, v149, v145, s44
  v_perm_b32 v35, v157, v153, s44
  v_accvgpr_write_b32 a72, v32
  v_accvgpr_write_b32 a73, v33
  v_accvgpr_write_b32 a74, v34
  v_accvgpr_write_b32 a75, v35
  v_perm_b32 v36, v133, v129, s45
  v_perm_b32 v37, v141, v137, s45
  v_perm_b32 v38, v149, v145, s45
  v_perm_b32 v39, v157, v153, s45
  v_accvgpr_write_b32 a76, v36
  v_accvgpr_write_b32 a77, v37
  v_accvgpr_write_b32 a78, v38
  v_accvgpr_write_b32 a79, v39
  v_perm_b32 v32, v134, v130, s44
  v_perm_b32 v33, v142, v138, s44
  v_perm_b32 v34, v150, v146, s44
  v_perm_b32 v35, v158, v154, s44
  v_accvgpr_write_b32 a80, v32
  v_accvgpr_write_b32 a81, v33
  v_accvgpr_write_b32 a82, v34
  v_accvgpr_write_b32 a83, v35
  v_perm_b32 v36, v134, v130, s45
  v_perm_b32 v37, v142, v138, s45
  v_perm_b32 v38, v150, v146, s45
  v_perm_b32 v39, v158, v154, s45
  v_accvgpr_write_b32 a84, v36
  v_accvgpr_write_b32 a85, v37
  v_accvgpr_write_b32 a86, v38
  v_accvgpr_write_b32 a87, v39
  v_perm_b32 v32, v135, v131, s44
  v_perm_b32 v33, v143, v139, s44
  v_perm_b32 v34, v151, v147, s44
  v_perm_b32 v35, v159, v155, s44
  v_accvgpr_write_b32 a88, v32
  v_accvgpr_write_b32 a89, v33
  v_accvgpr_write_b32 a90, v34
  v_accvgpr_write_b32 a91, v35
  v_perm_b32 v36, v135, v131, s45
  v_perm_b32 v37, v143, v139, s45
  v_perm_b32 v38, v151, v147, s45
  v_perm_b32 v39, v159, v155, s45
  v_accvgpr_write_b32 a92, v36
  v_accvgpr_write_b32 a93, v37
  v_accvgpr_write_b32 a94, v38
  v_accvgpr_write_b32 a95, v39
  s_waitcnt vmcnt(32)
  v_perm_b32 v32, v164, v160, s44
  v_perm_b32 v33, v172, v168, s44
  v_perm_b32 v34, v180, v176, s44
  v_perm_b32 v35, v188, v184, s44
  v_accvgpr_write_b32 a96, v32
  v_accvgpr_write_b32 a97, v33
  v_accvgpr_write_b32 a98, v34
  v_accvgpr_write_b32 a99, v35
  v_perm_b32 v36, v164, v160, s45
  v_perm_b32 v37, v172, v168, s45
  v_perm_b32 v38, v180, v176, s45
  v_perm_b32 v39, v188, v184, s45
  v_accvgpr_write_b32 a100, v36
  v_accvgpr_write_b32 a101, v37
  v_accvgpr_write_b32 a102, v38
  v_accvgpr_write_b32 a103, v39
  v_perm_b32 v32, v165, v161, s44
  v_perm_b32 v33, v173, v169, s44
  v_perm_b32 v34, v181, v177, s44
  v_perm_b32 v35, v189, v185, s44
  v_accvgpr_write_b32 a104, v32
  v_accvgpr_write_b32 a105, v33
  v_accvgpr_write_b32 a106, v34
  v_accvgpr_write_b32 a107, v35
  v_perm_b32 v36, v165, v161, s45
  v_perm_b32 v37, v173, v169, s45
  v_perm_b32 v38, v181, v177, s45
  v_perm_b32 v39, v189, v185, s45
  v_accvgpr_write_b32 a108, v36
  v_accvgpr_write_b32 a109, v37
  v_accvgpr_write_b32 a110, v38
  v_accvgpr_write_b32 a111, v39
  v_perm_b32 v32, v166, v162, s44
  v_perm_b32 v33, v174, v170, s44
  v_perm_b32 v34, v182, v178, s44
  v_perm_b32 v35, v190, v186, s44
  v_accvgpr_write_b32 a112, v32
  v_accvgpr_write_b32 a113, v33
  v_accvgpr_write_b32 a114, v34
  v_accvgpr_write_b32 a115, v35
  v_perm_b32 v36, v166, v162, s45
  v_perm_b32 v37, v174, v170, s45
  v_perm_b32 v38, v182, v178, s45
  v_perm_b32 v39, v190, v186, s45
  v_accvgpr_write_b32 a116, v36
  v_accvgpr_write_b32 a117, v37
  v_accvgpr_write_b32 a118, v38
  v_accvgpr_write_b32 a119, v39
  v_perm_b32 v32, v167, v163, s44
  v_perm_b32 v33, v175, v171, s44
  v_perm_b32 v34, v183, v179, s44
  v_perm_b32 v35, v191, v187, s44
  v_accvgpr_write_b32 a120, v32
  v_accvgpr_write_b32 a121, v33
  v_accvgpr_write_b32 a122, v34
  v_accvgpr_write_b32 a123, v35
  v_perm_b32 v36, v167, v163, s45
  v_perm_b32 v37, v175, v171, s45
  v_perm_b32 v38, v183, v179, s45
  v_perm_b32 v39, v191, v187, s45
  v_accvgpr_write_b32 a124, v36
  v_accvgpr_write_b32 a125, v37
  v_accvgpr_write_b32 a126, v38
  v_accvgpr_write_b32 a127, v39
  s_waitcnt vmcnt(24)
  v_perm_b32 v32, v196, v192, s44
  v_perm_b32 v33, v204, v200, s44
  v_perm_b32 v34, v212, v208, s44
  v_perm_b32 v35, v220, v216, s44
  v_accvgpr_write_b32 a128, v32
  v_accvgpr_write_b32 a129, v33
  v_accvgpr_write_b32 a130, v34
  v_accvgpr_write_b32 a131, v35
  v_perm_b32 v36, v196, v192, s45
  v_perm_b32 v37, v204, v200, s45
  v_perm_b32 v38, v212, v208, s45
  v_perm_b32 v39, v220, v216, s45
  v_accvgpr_write_b32 a132, v36
  v_accvgpr_write_b32 a133, v37
  v_accvgpr_write_b32 a134, v38
  v_accvgpr_write_b32 a135, v39
  v_perm_b32 v32, v197, v193, s44
  v_perm_b32 v33, v205, v201, s44
  v_perm_b32 v34, v213, v209, s44
  v_perm_b32 v35, v221, v217, s44
  v_accvgpr_write_b32 a136, v32
  v_accvgpr_write_b32 a137, v33
  v_accvgpr_write_b32 a138, v34
  v_accvgpr_write_b32 a139, v35
  v_perm_b32 v36, v197, v193, s45
  v_perm_b32 v37, v205, v201, s45
  v_perm_b32 v38, v213, v209, s45
  v_perm_b32 v39, v221, v217, s45
  v_accvgpr_write_b32 a140, v36
  v_accvgpr_write_b32 a141, v37
  v_accvgpr_write_b32 a142, v38
  v_accvgpr_write_b32 a143, v39
  v_perm_b32 v32, v198, v194, s44
  v_perm_b32 v33, v206, v202, s44
  v_perm_b32 v34, v214, v210, s44
  v_perm_b32 v35, v222, v218, s44
  v_accvgpr_write_b32 a144, v32
  v_accvgpr_write_b32 a145, v33
  v_accvgpr_write_b32 a146, v34
  v_accvgpr_write_b32 a147, v35
  v_perm_b32 v36, v198, v194, s45
  v_perm_b32 v37, v206, v202, s45
  v_perm_b32 v38, v214, v210, s45
  v_perm_b32 v39, v222, v218, s45
  v_accvgpr_write_b32 a148, v36
  v_accvgpr_write_b32 a149, v37
  v_accvgpr_write_b32 a150, v38
  v_accvgpr_write_b32 a151, v39
  v_perm_b32 v32, v199, v195, s44
  v_perm_b32 v33, v207, v203, s44
  v_perm_b32 v34, v215, v211, s44
  v_perm_b32 v35, v223, v219, s44
  v_accvgpr_write_b32 a152, v32
  v_accvgpr_write_b32 a153, v33
  v_accvgpr_write_b32 a154, v34
  v_accvgpr_write_b32 a155, v35
  v_perm_b32 v36, v199, v195, s45
  v_perm_b32 v37, v207, v203, s45
  v_perm_b32 v38, v215, v211, s45
  v_perm_b32 v39, v223, v219, s45
  v_accvgpr_write_b32 a156, v36
  v_accvgpr_write_b32 a157, v37
  v_accvgpr_write_b32 a158, v38
  v_accvgpr_write_b32 a159, v39
  s_waitcnt vmcnt(16)
  v_perm_b32 v32, v228, v224, s44
  v_perm_b32 v33, v236, v232, s44
  v_perm_b32 v34, v244, v240, s44
  v_perm_b32 v35, v252, v248, s44
  v_accvgpr_write_b32 a160, v32
  v_accvgpr_write_b32 a161, v33
  v_accvgpr_write_b32 a162, v34
  v_accvgpr_write_b32 a163, v35
  v_perm_b32 v36, v228, v224, s45
  v_perm_b32 v37, v236, v232, s45
  v_perm_b32 v38, v244, v240, s45
  v_perm_b32 v39, v252, v248, s45
  v_accvgpr_write_b32 a164, v36
  v_accvgpr_write_b32 a165, v37
  v_accvgpr_write_b32 a166, v38
  v_accvgpr_write_b32 a167, v39
  v_perm_b32 v32, v229, v225, s44
  v_perm_b32 v33, v237, v233, s44
  v_perm_b32 v34, v245, v241, s44
  v_perm_b32 v35, v253, v249, s44
  v_accvgpr_write_b32 a168, v32
  v_accvgpr_write_b32 a169, v33
  v_accvgpr_write_b32 a170, v34
  v_accvgpr_write_b32 a171, v35
  v_perm_b32 v36, v229, v225, s45
  v_perm_b32 v37, v237, v233, s45
  v_perm_b32 v38, v245, v241, s45
  v_perm_b32 v39, v253, v249, s45
  v_accvgpr_write_b32 a172, v36
  v_accvgpr_write_b32 a173, v37
  v_accvgpr_write_b32 a174, v38
  v_accvgpr_write_b32 a175, v39
  v_perm_b32 v32, v230, v226, s44
  v_perm_b32 v33, v238, v234, s44
  v_perm_b32 v34, v246, v242, s44
  v_perm_b32 v35, v254, v250, s44
  v_accvgpr_write_b32 a176, v32
  v_accvgpr_write_b32 a177, v33
  v_accvgpr_write_b32 a178, v34
  v_accvgpr_write_b32 a179, v35
  v_perm_b32 v36, v230, v226, s45
  v_perm_b32 v37, v238, v234, s45
  v_perm_b32 v38, v246, v242, s45
  v_perm_b32 v39, v254, v250, s45
  v_accvgpr_write_b32 a180, v36
  v_accvgpr_write_b32 a181, v37
  v_accvgpr_write_b32 a182, v38
  v_accvgpr_write_b32 a183, v39
  v_perm_b32 v32, v231, v227, s44
  v_perm_b32 v33, v239, v235, s44
  v_perm_b32 v34, v247, v243, s44
  v_perm_b32 v35, v255, v251, s44
  v_accvgpr_write_b32 a184, v32
  v_accvgpr_write_b32 a185, v33
  v_accvgpr_write_b32 a186, v34
  v_accvgpr_write_b32 a187, v35
  v_perm_b32 v36, v231, v227, s45
  v_perm_b32 v37, v239, v235, s45
  v_perm_b32 v38, v247, v243, s45
  v_perm_b32 v39, v255, v251, s45
  v_accvgpr_write_b32 a188, v36
  v_accvgpr_write_b32 a189, v37
  v_accvgpr_write_b32 a190, v38
  v_accvgpr_write_b32 a191, v39
  s_waitcnt vmcnt(8)
  v_perm_b32 v32, v68, v64, s44
  v_perm_b32 v33, v76, v72, s44
  v_perm_b32 v34, v84, v80, s44
  v_perm_b32 v35, v92, v88, s44
  v_accvgpr_write_b32 a192, v32
  v_accvgpr_write_b32 a193, v33
  v_accvgpr_write_b32 a194, v34
  v_accvgpr_write_b32 a195, v35
  v_perm_b32 v36, v68, v64, s45
  v_perm_b32 v37, v76, v72, s45
  v_perm_b32 v38, v84, v80, s45
  v_perm_b32 v39, v92, v88, s45
  v_accvgpr_write_b32 a196, v36
  v_accvgpr_write_b32 a197, v37
  v_accvgpr_write_b32 a198, v38
  v_accvgpr_write_b32 a199, v39
  v_perm_b32 v32, v69, v65, s44
  v_perm_b32 v33, v77, v73, s44
  v_perm_b32 v34, v85, v81, s44
  v_perm_b32 v35, v93, v89, s44
  v_accvgpr_write_b32 a200, v32
  v_accvgpr_write_b32 a201, v33
  v_accvgpr_write_b32 a202, v34
  v_accvgpr_write_b32 a203, v35
  v_perm_b32 v36, v69, v65, s45
  v_perm_b32 v37, v77, v73, s45
  v_perm_b32 v38, v85, v81, s45
  v_perm_b32 v39, v93, v89, s45
  v_accvgpr_write_b32 a204, v36
  v_accvgpr_write_b32 a205, v37
  v_accvgpr_write_b32 a206, v38
  v_accvgpr_write_b32 a207, v39
  v_perm_b32 v32, v70, v66, s44
  v_perm_b32 v33, v78, v74, s44
  v_perm_b32 v34, v86, v82, s44
  v_perm_b32 v35, v94, v90, s44
  v_accvgpr_write_b32 a208, v32
  v_accvgpr_write_b32 a209, v33
  v_accvgpr_write_b32 a210, v34
  v_accvgpr_write_b32 a211, v35
  v_perm_b32 v36, v70, v66, s45
  v_perm_b32 v37, v78, v74, s45
  v_perm_b32 v38, v86, v82, s45
  v_perm_b32 v39, v94, v90, s45
  v_accvgpr_write_b32 a212, v36
  v_accvgpr_write_b32 a213, v37
  v_accvgpr_write_b32 a214, v38
  v_accvgpr_write_b32 a215, v39
  v_perm_b32 v32, v71, v67, s44
  v_perm_b32 v33, v79, v75, s44
  v_perm_b32 v34, v87, v83, s44
  v_perm_b32 v35, v95, v91, s44
  v_accvgpr_write_b32 a216, v32
  v_accvgpr_write_b32 a217, v33
  v_accvgpr_write_b32 a218, v34
  v_accvgpr_write_b32 a219, v35
  v_perm_b32 v36, v71, v67, s45
  v_perm_b32 v37, v79, v75, s45
  v_perm_b32 v38, v87, v83, s45
  v_perm_b32 v39, v95, v91, s45
  v_accvgpr_write_b32 a220, v36
  v_accvgpr_write_b32 a221, v37
  v_accvgpr_write_b32 a222, v38
  v_accvgpr_write_b32 a223, v39
  s_waitcnt vmcnt(0)
  v_perm_b32 v32, v100, v96, s44
  v_perm_b32 v33, v108, v104, s44
  v_perm_b32 v34, v116, v112, s44
  v_perm_b32 v35, v124, v120, s44
  v_accvgpr_write_b32 a224, v32
  v_accvgpr_write_b32 a225, v33
  v_accvgpr_write_b32 a226, v34
  v_accvgpr_write_b32 a227, v35
  v_perm_b32 v36, v100, v96, s45
  v_perm_b32 v37, v108, v104, s45
  v_perm_b32 v38, v116, v112, s45
  v_perm_b32 v39, v124, v120, s45
  v_accvgpr_write_b32 a228, v36
  v_accvgpr_write_b32 a229, v37
  v_accvgpr_write_b32 a230, v38
  v_accvgpr_write_b32 a231, v39
  v_perm_b32 v32, v101, v97, s44
  v_perm_b32 v33, v109, v105, s44
  v_perm_b32 v34, v117, v113, s44
  v_perm_b32 v35, v125, v121, s44
  v_accvgpr_write_b32 a232, v32
  v_accvgpr_write_b32 a233, v33
  v_accvgpr_write_b32 a234, v34
  v_accvgpr_write_b32 a235, v35
  v_perm_b32 v36, v101, v97, s45
  v_perm_b32 v37, v109, v105, s45
  v_perm_b32 v38, v117, v113, s45
  v_perm_b32 v39, v125, v121, s45
  v_accvgpr_write_b32 a236, v36
  v_accvgpr_write_b32 a237, v37
  v_accvgpr_write_b32 a238, v38
  v_accvgpr_write_b32 a239, v39
  v_perm_b32 v32, v102, v98, s44
  v_perm_b32 v33, v110, v106, s44
  v_perm_b32 v34, v118, v114, s44
  v_perm_b32 v35, v126, v122, s44
  v_accvgpr_write_b32 a240, v32
  v_accvgpr_write_b32 a241, v33
  v_accvgpr_write_b32 a242, v34
  v_accvgpr_write_b32 a243, v35
  v_perm_b32 v36, v102, v98, s45
  v_perm_b32 v37, v110, v106, s45
  v_perm_b32 v38, v118, v114, s45
  v_perm_b32 v39, v126, v122, s45
  v_accvgpr_write_b32 a244, v36
  v_accvgpr_write_b32 a245, v37
  v_accvgpr_write_b32 a246, v38
  v_accvgpr_write_b32 a247, v39
  v_perm_b32 v32, v103, v99, s44
  v_perm_b32 v33, v111, v107, s44
  v_perm_b32 v34, v119, v115, s44
  v_perm_b32 v35, v127, v123, s44
  v_accvgpr_write_b32 a248, v32
  v_accvgpr_write_b32 a249, v33
  v_accvgpr_write_b32 a250, v34
  v_accvgpr_write_b32 a251, v35
  v_perm_b32 v36, v103, v99, s45
  v_perm_b32 v37, v111, v107, s45
  v_perm_b32 v38, v119, v115, s45
  v_perm_b32 v39, v127, v123, s45
  v_accvgpr_write_b32 a252, v36
  v_accvgpr_write_b32 a253, v37
  v_accvgpr_write_b32 a254, v38
  v_accvgpr_write_b32 a255, v39
  s_mov_b32 s26, 0
g_pu_78:
  v_and_b32 v60, 0x70, v0
  global_load_dword v61, v60, s[12:13] sc1
  s_waitcnt vmcnt(0)
  v_readlane_b32 s28, v61, 0
  v_readlane_b32 s29, v61, 1
  v_readlane_b32 s30, v61, 2
  v_readlane_b32 s31, v61, 3
  v_readlane_b32 s32, v61, 4
  v_readlane_b32 s33, v61, 5
  v_readlane_b32 s34, v61, 6
  v_readlane_b32 s35, v61, 7
  s_add_u32 s27, s28, s29
  s_add_u32 s27, s27, s30
  s_add_u32 s27, s27, s31
  s_add_u32 s27, s27, s32
  s_add_u32 s27, s27, s33
  s_add_u32 s27, s27, s34
  s_add_u32 s27, s27, s35
  v_readlane_b32 s36, v61, s91
  s_cmp_ge_u32 s36, 32
  s_cbranch_scc1 g_pure_79
  s_cmp_ge_u32 s27, 256
  s_cbranch_scc1 L_o_x
  s_add_u32 s26, s26, 1
  s_cmp_gt_u32 s26, 1048576
  s_cbranch_scc1 L_end
  s_branch g_pu_78
g_pure_79:
  s_mov_b32 s62, 0
  s_mov_b32 s46, 0
  s_mov_b32 s48, 0
  s_mov_b32 s65, 0
  s_mov_b32 s66, 0
  s_mov_b32 s76, 0
  s_mov_b32 s79, 268435456
  s_mov_b32 s84, 32768
  s_mov_b32 s47, s60
  s_mov_b32 s49, s60
o_round_80:
  s_mov_b32 s67, 0
  s_lshl_b32 s26, s49, 7
  s_add_u32 s26, s26, 5249664
d_w_90:
  buffer_load_dwordx2 v[160:161], v1, s[4:7], s26 offen sc1
  s_add_u32 s67, s67, 1
  s_cmp_gt_u32 s67, 1048576
  s_cbranch_scc1 L_end
  s_waitcnt vmcnt(0)
  v_min_u32 v162, v160, v161
  v_max_u32 v163, v160, v161
  v_cmp_eq_u32 vcc, 0, v162
  s_cbranch_vccnz d_w_90
  v_max_u32_dpp v163, v163, v163 row_ror:8 row_mask:0xf bank_mask:0xf
  s_nop 1
  v_max_u32_dpp v163, v163, v163 row_ror:4 row_mask:0xf bank_mask:0xf
  s_nop 1
  v_max_u32_dpp v163, v163, v163 row_ror:2 row_mask:0xf bank_mask:0xf
  s_nop 1
  v_max_u32_dpp v163, v163, v163 row_ror:1 row_mask:0xf bank_mask:0xf
  s_nop 0
  v_readlane_b32 s28, v163, 0
  v_readlane_b32 s29, v163, 16
  v_readlane_b32 s30, v163, 32
  v_readlane_b32 s31, v163, 48
  s_max_u32 s28, s28, s29
  s_max_u32 s30, s30, s31
  s_max_u32 s46, s46, s28
  s_max_u32 s46, s46, s30
  s_andn2_b32 s52, 0xfff, s46
  s_lshr_b32 s52, s52, 5
  s_or_b32 s63, s49, 18432
  s_add_u32 s53, s63, 4
  s_cmp_lt_u32 s49, 60
  s_cselect_b32 s53, s53, 0
  s_or_b32 s26, s47, 25920
  s_or_b32 s27, s47, 20800
  s_cmp_lt_u32 s47, s52
  s_cselect_b32 s64, s26, s27
  s_add_u32 s26, s47, 16
  s_cmp_le_u32 s26, s49
  s_cselect_b32 s64, s64, s53
  s_cselect_b32 s51, 1, 0
o_task_81:
  s_bitcmp1_b32 s63, 15
  s_cbranch_scc1 o_same_93
  s_cmp_lg_u32 s66, 0
  s_cbranch_scc1 o_have_92
  s_mov_b32 s67, 0
o_w1_91:
  s_and_b32 s26, s63, 0xff
  s_lshl_b32 s26, s26, 5
  s_add_u32 s26, s26, s85
  s_lshl_b32 s26, s26, 4
  s_and_b32 s27, s17, 1
  s_lshl_b32 s27, s27, 3
  s_add_u32 s26, s26, s27
  s_add_u32 s27, s26, 5406720
  s_add_u32 s26, s26, 5308416
  buffer_load_dwordx2 v[52:53], off, s[4:7], s26 sc1
  buffer_load_dwordx2 v[54:55], off, s[4:7], s27 sc1
  s_add_u32 s67, s67, 1
  s_cmp_gt_u32 s67, 1048576
  s_cbranch_scc1 L_end
  s_waitcnt vmcnt(0)
  v_mov_b32 v7, s62
  s_mov_b64 exec, 1
  buffer_store_dword v7, off, s[4:7], s79
  s_mov_b64 exec, -1
  s_mov_b32 s79, 268435456
  v_min3_u32 v52, v52, v53, v54
  v_min_u32 v52, v52, v55
  v_cmp_ne_u32 vcc, 0, v52
  s_cbranch_vccz o_w1_91
  s_and_b32 s32, s63, 0xff
  s_lshl_b32 s32, s32, 4
  s_add_u32 s32, s32, s61
  s_lshl_b32 s32, s32, 2
  s_add_u32 s32, s32, s17
  s_lshl_b32 s33, s32, 12
  s_add_u32 s33, s33, 142606336
  s_lshl_b32 s32, s32, 13
  s_add_u32 s32, s32, 41943040
  s_xor_b32 s34, s84, 114688
  s_lshl_b32 s35, s17, 12
  s_add_u32 s34, s34, s35
  s_add_u32 m0, s34, 32768
  s_add_u32 s34, s34, s35
  buffer_load_dwordx4 v0, s[4:7], s33 offen offset:0 sc1 lds
  buffer_load_dwordx4 v0, s[4:7], s33 offen offset:1024 sc1 lds
  buffer_load_dwordx4 v0, s[4:7], s33 offen offset:2048 sc1 lds
  buffer_load_dwordx4 v0, s[4:7], s33 offen offset:3072 sc1 lds
  s_add_u32 m0, s34, 0
  s_nop 0
  buffer_load_dwordx4 v0, s[4:7], s32 offen offset:0 sc1 lds
  buffer_load_dwordx4 v0, s[4:7], s32 offen offset:1024 sc1 lds
  buffer_load_dwordx4 v0, s[4:7], s32 offen offset:2048 sc1 lds
  buffer_load_dwordx4 v0, s[4:7], s32 offen offset:3072 sc1 lds
  s_add_u32 m0, s34, 4096
  s_add_u32 s32, s32, 4096
  buffer_load_dwordx4 v0, s[4:7], s32 offen offset:0 sc1 lds
  buffer_load_dwordx4 v0, s[4:7], s32 offen offset:1024 sc1 lds
  buffer_load_dwordx4 v0, s[4:7], s32 offen offset:2048 sc1 lds
  buffer_load_dwordx4 v0, s[4:7], s32 offen offset:3072 sc1 lds
  s_waitcnt vmcnt(0)
o_have_92:
  s_xor_b32 s84, s84, 114688
  s_mov_b32 s66, 0
  s_lshr_b32 s26, s17, 1
  s_lshl_b32 s27, s26, 14
  s_add_u32 s27, s27, s84
  v_add_u32 v49, s27, v0
  s_lshl_b32 s26, s26, 13
  s_and_b32 s27, s17, 1
  s_lshl_b32 s27, s27, 10
  s_add_u32 s26, s26, s27
  s_add_u32 s26, s26, s84
  v_add_u32 v50, s26, v0
  s_barrier
o_same_93:
  ds_read_b128 v[60:63], v50 offset:32768
  ds_read_b128 v[76:79], v49 offset:0
  ds_read_b128 v[92:95], v49 offset:1024
  ds_read_b128 v[64:67], v50 offset:34816
  ds_read_b128 v[80:83], v49 offset:4096
  ds_read_b128 v[96:99], v49 offset:5120
  ds_read_b128 v[68:71], v50 offset:36864
  ds_read_b128 v[84:87], v49 offset:8192
  ds_read_b128 v[100:103], v49 offset:9216
  ds_read_b128 v[72:75], v50 offset:38912
  ds_read_b128 v[88:91], v49 offset:12288
  ds_read_b128 v[104:107], v49 offset:13312
  s_and_b32 s26, s64, 0xff
  s_lshl_b32 s26, s26, 5
  s_add_u32 s26, s26, s85
  s_lshl_b32 s26, s26, 4
  s_and_b32 s27, s17, 1
  s_lshl_b32 s27, s27, 3
  s_add_u32 s26, s26, s27
  s_add_u32 s27, s26, 5406720
  s_add_u32 s26, s26, 5308416
  buffer_load_dwordx2 v[52:53], off, s[4:7], s26 sc1
  buffer_load_dwordx2 v[54:55], off, s[4:7], s27 sc1
  s_and_b32 s26, s64, 63
  s_lshl_b32 s26, s26, 5
  s_add_u32 s26, s26, s85
  s_bfe_u32 s27, s64, 131080
  s_lshl_b32 s26, s26, 4
  s_lshl_b32 s27, s27, 16
  s_add_u32 s26, s26, s27
  s_add_u32 s26, s26, 5513216
  buffer_load_dwordx4 v[56:59], off, s[4:7], s26 sc1
  v_xor_b32 v6, 16384, v6
  v_and_b32 v48, 16384, v6
  v_add_u32 v48, v48, v0
  s_waitcnt lgkmcnt(9)
  v_mfma_f32_16x16x32_bf16 v[140:143], v[76:79], v[60:63], 0
  ds_read_b128 v[108:111], v49 offset:2048
  v_mfma_f32_16x16x32_bf16 v[144:147], v[92:95], v[60:63], 0
  ds_read_b128 v[112:115], v49 offset:3072
  s_waitcnt lgkmcnt(8)
  v_mfma_f32_16x16x32_bf16 v[140:143], v[80:83], v[64:67], v[140:143]
  ds_read_b128 v[116:119], v49 offset:6144
  v_mfma_f32_16x16x32_bf16 v[144:147], v[96:99], v[64:67], v[144:147]
  ds_read_b128 v[120:123], v49 offset:7168
  s_waitcnt lgkmcnt(7)
  v_mfma_f32_16x16x32_bf16 v[140:143], v[84:87], v[68:71], v[140:143]
  ds_read_b128 v[124:127], v49 offset:10240
  v_mfma_f32_16x16x32_bf16 v[144:147], v[100:103], v[68:71], v[144:147]
  ds_read_b128 v[128:131], v49 offset:11264
  s_waitcnt lgkmcnt(6)
  v_mfma_f32_16x16x32_bf16 v[140:143], v[88:91], v[72:75], v[140:143]
  ds_read_b128 v[132:135], v49 offset:14336
  v_mfma_f32_16x16x32_bf16 v[144:147], v[104:107], v[72:75], v[144:147]
  ds_read_b128 v[136:139], v49 offset:15360
  v_mov_b32 v156, 0
  v_mov_b32 v159, 0
  v_mov_b32 v157, 0xff000000
  v_cmp_le_i32 s[90:91], 0, v3
  v_cmp_le_i32 s[92:93], 1, v3
  v_cmp_le_i32 s[94:95], 2, v3
  v_cmp_le_i32 s[96:97], 3, v3
  v_cndmask_b32 v140, v157, v140, s[90:91]
  v_cndmask_b32 v141, v157, v141, s[92:93]
  v_cndmask_b32 v142, v157, v142, s[94:95]
  v_cndmask_b32 v143, v157, v143, s[96:97]
  v_cmp_le_i32 s[90:91], 16, v3
  v_cmp_le_i32 s[92:93], 17, v3
  v_cmp_le_i32 s[94:95], 18, v3
  v_cmp_le_i32 s[96:97], 19, v3
  v_cndmask_b32 v144, v157, v144, s[90:91]
  v_cndmask_b32 v145, v157, v145, s[92:93]
  v_cndmask_b32 v146, v157, v146, s[94:95]
  v_cndmask_b32 v147, v157, v147, s[96:97]
  v_max3_f32 v152, v140, v141, v142
  v_max3_f32 v152, v143, v144, v152
  v_max3_f32 v152, v145, v146, v152
  s_waitcnt vmcnt(3)
  v_mov_b32 v7, s62
  s_mov_b64 exec, 1
  buffer_store_dword v7, off, s[4:7], s79
  s_mov_b64 exec, -1
  s_mov_b32 s79, 268435456
  s_cmp_lg_u32 s76, 0
  s_cbranch_scc1 o_havek_95
  s_mov_b32 s67, 0
  s_and_b32 s26, s63, 63
  s_lshl_b32 s26, s26, 5
  s_add_u32 s26, s26, s85
  s_bfe_u32 s27, s63, 131080
  s_lshl_b32 s26, s26, 4
  s_lshl_b32 s27, s27, 16
  s_add_u32 s26, s26, s27
  s_add_u32 s26, s26, 5513216
o_w2_94:
  buffer_load_dwordx4 v[160:163], off, s[4:7], s26 sc1
  s_add_u32 s67, s67, 1
  s_cmp_gt_u32 s67, 1048576
  s_cbranch_scc1 L_end
  s_waitcnt vmcnt(0)
  v_min3_u32 v160, v160, v161, v162
  v_min_u32 v160, v160, v163
  v_cmp_ne_u32 vcc, 0, v160
  s_cbranch_vccz o_w2_94
  s_and_b32 s32, s63, 63
  s_lshl_b32 s32, s32, 5
  s_add_u32 s32, s32, s85
  s_bfe_u32 s33, s63, 131080
  s_lshl_b32 s33, s33, 11
  s_add_u32 s32, s32, s33
  s_lshl_b32 s32, s32, 13
  s_add_u32 s32, s32, 192937984
  s_add_u32 s33, s32, 4096
  buffer_load_dwordx4 v[24:27], v0, s[4:7], s32 offen offset:0 sc1
  buffer_load_dwordx4 v[28:31], v0, s[4:7], s32 offen offset:2048 sc1
  buffer_load_dwordx4 v[32:35], v0, s[4:7], s33 offen offset:0 sc1
  buffer_load_dwordx4 v[36:39], v0, s[4:7], s33 offen offset:2048 sc1
  buffer_load_dwordx2 v[40:41], v1, s[4:7], s32 offen offset:1024 sc1
  buffer_load_dwordx2 v[42:43], v1, s[4:7], s32 offen offset:3072 sc1
  buffer_load_dwordx2 v[44:45], v1, s[4:7], s33 offen offset:1024 sc1
  buffer_load_dwordx2 v[46:47], v1, s[4:7], s33 offen offset:3072 sc1
  s_waitcnt vmcnt(4)
o_havek_95:
  v_mfma_f32_16x16x32_bf16 v[148:151], v[24:27], v[60:63], 0
  v_mfma_f32_16x16x32_bf16 v[148:151], v[28:31], v[64:67], v[148:151]
  v_mfma_f32_16x16x32_bf16 v[148:151], v[32:35], v[68:71], v[148:151]
  v_mfma_f32_16x16x32_bf16 v[148:151], v[36:39], v[72:75], v[148:151]
  v_max_f32 v152, v147, v152
  s_nop 3
  s_nop 0
  s_nop 0
  s_nop 0
  v_mul_f32 v148, s24, v148
  v_mul_f32 v149, s24, v149
  v_max3_f32 v152, v148, v149, v152
  v_mov_b32 v153, v152
  s_nop 0
  s_nop 0
  v_permlane16_swap_b32 v152, v153
  v_max_f32 v152, v152, v153
  v_mov_b32 v153, v152
  s_nop 0
  s_nop 0
  v_permlane32_swap_b32 v152, v153
  v_max_f32 v152, v152, v153
  v_sub_f32 v140, v140, v152
  v_sub_f32 v141, v141, v152
  v_sub_f32 v142, v142, v152
  v_sub_f32 v143, v143, v152
  v_sub_f32 v144, v144, v152
  v_sub_f32 v145, v145, v152
  v_sub_f32 v146, v146, v152
  v_sub_f32 v147, v147, v152
  v_sub_f32 v148, v148, v152
  v_sub_f32 v149, v149, v152
  v_exp_f32 v140, v140
  v_exp_f32 v141, v141
  v_exp_f32 v142, v142
  v_exp_f32 v143, v143
  v_exp_f32 v144, v144
  v_exp_f32 v145, v145
  v_exp_f32 v146, v146
  v_exp_f32 v147, v147
  v_exp_f32 v148, v148
  v_exp_f32 v149, v149
  v_add_f32 v152, v140, v141
  v_add_f32 v153, v142, v143
  v_add_f32 v152, v152, v144
  v_add_f32 v153, v153, v145
  v_add_f32 v152, v152, v146
  v_add_f32 v153, v153, v147
  v_add_f32 v152, v152, v148
  v_add_f32 v153, v153, v149
  v_add_f32 v152, v152, v153
  v_mov_b32 v153, v152
  s_nop 0
  s_nop 0
  v_permlane16_swap_b32 v152, v153
  v_add_f32 v152, v152, v153
  v_mov_b32 v153, v152
  s_nop 0
  s_nop 0
  v_permlane32_swap_b32 v152, v153
  v_add_f32 v152, v152, v153
  v_rcp_f32 v152, v152
  s_nop 0
  v_mul_f32 v140, v140, v152
  v_mul_f32 v141, v141, v152
  v_mul_f32 v142, v142, v152
  v_mul_f32 v143, v143, v152
  v_mul_f32 v144, v144, v152
  v_mul_f32 v145, v145, v152
  v_mul_f32 v146, v146, v152
  v_mul_f32 v147, v147, v152
  v_mul_f32 v148, v148, v152
  v_mul_f32 v149, v149, v152
  v_cvt_pk_bf16_f32 v152, v140, v141
  v_cvt_pk_bf16_f32 v153, v142, v143
  v_cvt_pk_bf16_f32 v154, v144, v145
  v_cvt_pk_bf16_f32 v155, v146, v147
  v_cvt_pk_bf16_f32 v157, v148, v149
  v_cvt_pk_bf16_f32 v158, v148, v149
  s_waitcnt lgkmcnt(0) vmcnt(0)
  v_mfma_f32_16x16x32_bf16 v[160:163], v[108:111], v[152:155], 0
  v_mfma_f32_16x16x32_bf16 v[164:167], v[112:115], v[152:155], 0
  v_mfma_f32_16x16x32_bf16 v[168:171], v[116:119], v[152:155], 0
  v_mfma_f32_16x16x32_bf16 v[172:175], v[120:123], v[152:155], 0
  v_mfma_f32_16x16x32_bf16 v[176:179], v[124:127], v[152:155], 0
  v_mfma_f32_16x16x32_bf16 v[180:183], v[128:131], v[152:155], 0
  v_mfma_f32_16x16x32_bf16 v[184:187], v[132:135], v[152:155], 0
  v_mfma_f32_16x16x32_bf16 v[188:191], v[136:139], v[152:155], 0
  v_min3_u32 v52, v52, v53, v54
  v_min3_u32 v56, v56, v57, v58
  v_min_u32 v52, v52, v55
  v_min_u32 v56, v56, v59
  v_lshl_or_b32 v52, v56, 1, v52
  s_and_b32 s27, s62, 1
  s_lshl_b32 s27, s27, 4
  s_add_u32 s27, s27, 131072
  v_mov_b32 v54, s27
  s_lshl_b32 s26, s17, 2
  v_add_u32 v53, s26, v54
  ds_write_b32 v53, v52
  v_mfma_f32_16x16x16_bf16 v[160:163], v[40:41], v[158:159], v[160:163]
  v_mfma_f32_16x16x16_bf16 v[164:167], v[40:41], v[156:157], v[164:167]
  v_mfma_f32_16x16x16_bf16 v[168:171], v[42:43], v[158:159], v[168:171]
  v_mfma_f32_16x16x16_bf16 v[172:175], v[42:43], v[156:157], v[172:175]
  v_mfma_f32_16x16x16_bf16 v[176:179], v[44:45], v[158:159], v[176:179]
  v_mfma_f32_16x16x16_bf16 v[180:183], v[44:45], v[156:157], v[180:183]
  v_mfma_f32_16x16x16_bf16 v[184:187], v[46:47], v[158:159], v[184:187]
  v_mfma_f32_16x16x16_bf16 v[188:191], v[46:47], v[156:157], v[188:191]
  s_nop 0
  v_cvt_pk_bf16_f32 v192, v160, v161
  v_cvt_pk_bf16_f32 v193, v162, v163
  v_cvt_pk_bf16_f32 v194, v164, v165
  v_cvt_pk_bf16_f32 v195, v166, v167
  ds_write_b128 v6, v[192:195] offset:0
  v_cvt_pk_bf16_f32 v196, v168, v169
  v_cvt_pk_bf16_f32 v197, v170, v171
  v_cvt_pk_bf16_f32 v198, v172, v173
  v_cvt_pk_bf16_f32 v199, v174, v175
  ds_write_b128 v6, v[196:199] offset:1024
  v_cvt_pk_bf16_f32 v200, v176, v177
  v_cvt_pk_bf16_f32 v201, v178, v179
  v_cvt_pk_bf16_f32 v202, v180, v181
  v_cvt_pk_bf16_f32 v203, v182, v183
  ds_write_b128 v6, v[200:203] offset:2048
  v_cvt_pk_bf16_f32 v204, v184, v185
  v_cvt_pk_bf16_f32 v205, v186, v187
  v_cvt_pk_bf16_f32 v206, v188, v189
  v_cvt_pk_bf16_f32 v207, v190, v191
  ds_write_b128 v6, v[204:207] offset:3072
  s_cmp_ge_u32 s17, 2
  s_cselect_b32 s65, 0, s65
  s_cmp_eq_u32 s65, 0
  s_cbranch_scc1 o_noob_96
  s_lshl_b32 s26, s60, 10
  s_add_u32 s26, s26, 5283840
  s_mov_b32 s67, 0
o_wob_97:
  buffer_load_dword v7, v2, s[4:7], s26 offen sc1
  s_add_u32 s67, s67, 1
  s_cmp_gt_u32 s67, 1048576
  s_cbranch_scc1 L_end
  s_waitcnt vmcnt(0)
  v_cmp_gt_u32 vcc, s62, v7
  s_cbranch_vccnz o_wob_97
o_noob_96:
  s_mov_b32 s95, s62
  s_add_u32 s62, s62, 1
  s_and_b32 s86, s62, 1
  s_lshl_b32 s86, s86, 19
  s_lshl_b32 s26, s60, 21
  s_add_u32 s86, s86, s26
  s_add_u32 s86, s86, 12582912
  s_waitcnt lgkmcnt(0)
  s_barrier
  s_cmp_lg_u32 s65, 0
  s_cbranch_scc1 o_wr1_98
  ds_read_b128 v[56:59], v54
  ds_read_b128 v[124:127], v48 offset:0
  ds_read_b128 v[128:131], v48 offset:1024
  ds_read_b128 v[132:135], v48 offset:2048
  s_waitcnt lgkmcnt(2)
  v_mfma_f32_16x16x32_bf16 v[60:63], v[124:127], a[0:3], 0
  v_mfma_f32_16x16x32_bf16 v[64:67], v[124:127], a[4:7], 0
  ds_read_b128 v[136:139], v48 offset:3072
  v_mfma_f32_16x16x32_bf16 v[68:71], v[124:127], a[8:11], 0
  v_mfma_f32_16x16x32_bf16 v[72:75], v[124:127], a[12:15], 0
  v_and_b32 v56, v56, v57
  v_and_b32 v58, v58, v59
  v_mfma_f32_16x16x32_bf16 v[76:79], v[124:127], a[16:19], 0
  v_mfma_f32_16x16x32_bf16 v[80:83], v[124:127], a[20:23], 0
  v_and_b32 v56, v56, v58
  s_bfe_u32 s26, s64, 131086
  v_readfirstlane_b32 s27, v56
  v_mfma_f32_16x16x32_bf16 v[84:87], v[124:127], a[24:27], 0
  v_mfma_f32_16x16x32_bf16 v[88:91], v[124:127], a[28:31], 0
  s_cmp_eq_u32 s26, 1
  s_cselect_b32 s66, s27, 0
  s_and_b32 s66, s66, 1
  s_cselect_b32 s87, 0, 268435456
  s_cmp_lg_u32 s26, 0
  s_cselect_b32 s76, s27, 0
  s_and_b32 s76, s76, 2
  s_cselect_b32 s88, 0, 268435456
  s_waitcnt lgkmcnt(2)
  v_mfma_f32_16x16x32_bf16 v[60:63], v[128:131], a[32:35], v[60:63]
  v_mfma_f32_16x16x32_bf16 v[64:67], v[128:131], a[36:39], v[64:67]
  ds_read_b128 v[124:127], v48 offset:8192
  v_mfma_f32_16x16x32_bf16 v[68:71], v[128:131], a[40:43], v[68:71]
  v_mfma_f32_16x16x32_bf16 v[72:75], v[128:131], a[44:47], v[72:75]
  v_mfma_f32_16x16x32_bf16 v[76:79], v[128:131], a[48:51], v[76:79]
  v_mfma_f32_16x16x32_bf16 v[80:83], v[128:131], a[52:55], v[80:83]
  v_mfma_f32_16x16x32_bf16 v[84:87], v[128:131], a[56:59], v[84:87]
  v_mfma_f32_16x16x32_bf16 v[88:91], v[128:131], a[60:63], v[88:91]
  s_waitcnt lgkmcnt(2)
  v_mfma_f32_16x16x32_bf16 v[60:63], v[132:135], a[64:67], v[60:63]
  v_mfma_f32_16x16x32_bf16 v[64:67], v[132:135], a[68:71], v[64:67]
  ds_read_b128 v[128:131], v48 offset:9216
  v_mfma_f32_16x16x32_bf16 v[68:71], v[132:135], a[72:75], v[68:71]
  v_mfma_f32_16x16x32_bf16 v[72:75], v[132:135], a[76:79], v[72:75]
  v_mfma_f32_16x16x32_bf16 v[76:79], v[132:135], a[80:83], v[76:79]
  v_mfma_f32_16x16x32_bf16 v[80:83], v[132:135], a[84:87], v[80:83]
  v_mfma_f32_16x16x32_bf16 v[84:87], v[132:135], a[88:91], v[84:87]
  v_mfma_f32_16x16x32_bf16 v[88:91], v[132:135], a[92:95], v[88:91]
  s_waitcnt lgkmcnt(2)
  v_mfma_f32_16x16x32_bf16 v[60:63], v[136:139], a[96:99], v[60:63]
  v_mfma_f32_16x16x32_bf16 v[64:67], v[136:139], a[100:103], v[64:67]
  ds_read_b128 v[132:135], v48 offset:10240
  v_mfma_f32_16x16x32_bf16 v[68:71], v[136:139], a[104:107], v[68:71]
  v_mfma_f32_16x16x32_bf16 v[72:75], v[136:139], a[108:111], v[72:75]
  s_and_b32 s32, s64, 0xff
  s_lshl_b32 s32, s32, 4
  s_add_u32 s32, s32, s61
  s_lshl_b32 s32, s32, 2
  s_add_u32 s32, s32, s17
  s_lshl_b32 s33, s32, 12
  v_mfma_f32_16x16x32_bf16 v[76:79], v[136:139], a[112:115], v[76:79]
  v_mfma_f32_16x16x32_bf16 v[80:83], v[136:139], a[116:119], v[80:83]
  s_add_u32 s33, s33, 142606336
  s_lshl_b32 s32, s32, 13
  s_add_u32 s32, s32, 41943040
  s_add_u32 s32, s32, s87
  s_add_u32 s33, s33, s87
  s_xor_b32 s34, s84, 114688
  v_mfma_f32_16x16x32_bf16 v[84:87], v[136:139], a[120:123], v[84:87]
  v_mfma_f32_16x16x32_bf16 v[88:91], v[136:139], a[124:127], v[88:91]
  s_lshl_b32 s35, s17, 12
  s_add_u32 s34, s34, s35
  s_add_u32 m0, s34, 32768
  s_add_u32 s34, s34, s35
  buffer_load_dwordx4 v0, s[4:7], s33 offen offset:0 sc1 lds
  s_waitcnt lgkmcnt(2)
  v_mfma_f32_16x16x32_bf16 v[60:63], v[124:127], a[128:131], v[60:63]
  v_mfma_f32_16x16x32_bf16 v[64:67], v[124:127], a[132:135], v[64:67]
  ds_read_b128 v[136:139], v48 offset:11264
  v_mfma_f32_16x16x32_bf16 v[68:71], v[124:127], a[136:139], v[68:71]
  v_mfma_f32_16x16x32_bf16 v[72:75], v[124:127], a[140:143], v[72:75]
  buffer_load_dwordx4 v0, s[4:7], s33 offen offset:1024 sc1 lds
  v_mfma_f32_16x16x32_bf16 v[76:79], v[124:127], a[144:147], v[76:79]
  v_mfma_f32_16x16x32_bf16 v[80:83], v[124:127], a[148:151], v[80:83]
  buffer_load_dwordx4 v0, s[4:7], s33 offen offset:2048 sc1 lds
  v_mfma_f32_16x16x32_bf16 v[84:87], v[124:127], a[152:155], v[84:87]
  v_mfma_f32_16x16x32_bf16 v[88:91], v[124:127], a[156:159], v[88:91]
  buffer_load_dwordx4 v0, s[4:7], s33 offen offset:3072 sc1 lds
  s_waitcnt lgkmcnt(2)
  v_mfma_f32_16x16x32_bf16 v[60:63], v[128:131], a[160:163], v[60:63]
  v_mfma_f32_16x16x32_bf16 v[64:67], v[128:131], a[164:167], v[64:67]
  ds_read_b128 v[124:127], v48 offset:4096
  v_mfma_f32_16x16x32_bf16 v[68:71], v[128:131], a[168:171], v[68:71]
  v_mfma_f32_16x16x32_bf16 v[72:75], v[128:131], a[172:175], v[72:75]
  s_add_u32 m0, s34, 0
  s_nop 0
  buffer_load_dwordx4 v0, s[4:7], s32 offen offset:0 sc1 lds
  v_mfma_f32_16x16x32_bf16 v[76:79], v[128:131], a[176:179], v[76:79]
  v_mfma_f32_16x16x32_bf16 v[80:83], v[128:131], a[180:183], v[80:83]
  buffer_load_dwordx4 v0, s[4:7], s32 offen offset:1024 sc1 lds
  v_mfma_f32_16x16x32_bf16 v[84:87], v[128:131], a[184:187], v[84:87]
  v_mfma_f32_16x16x32_bf16 v[88:91], v[128:131], a[188:191], v[88:91]
  buffer_load_dwordx4 v0, s[4:7], s32 offen offset:2048 sc1 lds
  s_waitcnt lgkmcnt(2)
  v_mfma_f32_16x16x32_bf16 v[60:63], v[132:135], a[192:195], v[60:63]
  v_mfma_f32_16x16x32_bf16 v[64:67], v[132:135], a[196:199], v[64:67]
  ds_read_b128 v[128:131], v48 offset:5120
  v_mfma_f32_16x16x32_bf16 v[68:71], v[132:135], a[200:203], v[68:71]
  v_mfma_f32_16x16x32_bf16 v[72:75], v[132:135], a[204:207], v[72:75]
  buffer_load_dwordx4 v0, s[4:7], s32 offen offset:3072 sc1 lds
  v_mfma_f32_16x16x32_bf16 v[76:79], v[132:135], a[208:211], v[76:79]
  v_mfma_f32_16x16x32_bf16 v[80:83], v[132:135], a[212:215], v[80:83]
  s_add_u32 m0, s34, 4096
  s_add_u32 s32, s32, 4096
  buffer_load_dwordx4 v0, s[4:7], s32 offen offset:0 sc1 lds
  v_mfma_f32_16x16x32_bf16 v[84:87], v[132:135], a[216:219], v[84:87]
  v_mfma_f32_16x16x32_bf16 v[88:91], v[132:135], a[220:223], v[88:91]
  buffer_load_dwordx4 v0, s[4:7], s32 offen offset:1024 sc1 lds
  s_waitcnt lgkmcnt(2)
  v_mfma_f32_16x16x32_bf16 v[60:63], v[136:139], a[224:227], v[60:63]
  v_mfma_f32_16x16x32_bf16 v[64:67], v[136:139], a[228:231], v[64:67]
  ds_read_b128 v[132:135], v48 offset:6144
  v_mfma_f32_16x16x32_bf16 v[68:71], v[136:139], a[232:235], v[68:71]
  v_mfma_f32_16x16x32_bf16 v[72:75], v[136:139], a[236:239], v[72:75]
  buffer_load_dwordx4 v0, s[4:7], s32 offen offset:2048 sc1 lds
  v_mfma_f32_16x16x32_bf16 v[76:79], v[136:139], a[240:243], v[76:79]
  v_mfma_f32_16x16x32_bf16 v[80:83], v[136:139], a[244:247], v[80:83]
  buffer_load_dwordx4 v0, s[4:7], s32 offen offset:3072 sc1 lds
  v_mfma_f32_16x16x32_bf16 v[84:87], v[136:139], a[248:251], v[84:87]
  v_mfma_f32_16x16x32_bf16 v[88:91], v[136:139], a[252:255], v[88:91]
  s_and_b32 s32, s64, 63
  s_lshl_b32 s32, s32, 5
  s_add_u32 s32, s32, s85
  s_bfe_u32 s33, s64, 131080
  s_lshl_b32 s33, s33, 11
  s_add_u32 s32, s32, s33
  s_waitcnt lgkmcnt(2)
  v_mfma_f32_16x16x32_bf16 v[92:95], v[124:127], a[0:3], 0
  v_mfma_f32_16x16x32_bf16 v[96:99], v[124:127], a[4:7], 0
  ds_read_b128 v[136:139], v48 offset:7168
  v_mfma_f32_16x16x32_bf16 v[100:103], v[124:127], a[8:11], 0
  v_mfma_f32_16x16x32_bf16 v[104:107], v[124:127], a[12:15], 0
  s_lshl_b32 s32, s32, 13
  s_add_u32 s32, s32, 192937984
  s_add_u32 s32, s32, s88
  s_add_u32 s33, s32, 4096
  buffer_load_dwordx4 v[24:27], v0, s[4:7], s32 offen offset:0 sc1
  v_mfma_f32_16x16x32_bf16 v[108:111], v[124:127], a[16:19], 0
  v_mfma_f32_16x16x32_bf16 v[112:115], v[124:127], a[20:23], 0
  buffer_load_dwordx4 v[28:31], v0, s[4:7], s32 offen offset:2048 sc1
  v_mfma_f32_16x16x32_bf16 v[116:119], v[124:127], a[24:27], 0
  v_mfma_f32_16x16x32_bf16 v[120:123], v[124:127], a[28:31], 0
  buffer_load_dwordx4 v[32:35], v0, s[4:7], s33 offen offset:0 sc1
  s_waitcnt lgkmcnt(2)
  v_mfma_f32_16x16x32_bf16 v[92:95], v[128:131], a[32:35], v[92:95]
  v_mfma_f32_16x16x32_bf16 v[96:99], v[128:131], a[36:39], v[96:99]
  ds_read_b128 v[124:127], v48 offset:12288
  v_mfma_f32_16x16x32_bf16 v[100:103], v[128:131], a[40:43], v[100:103]
  v_mfma_f32_16x16x32_bf16 v[104:107], v[128:131], a[44:47], v[104:107]
  buffer_load_dwordx4 v[36:39], v0, s[4:7], s33 offen offset:2048 sc1
  v_mfma_f32_16x16x32_bf16 v[108:111], v[128:131], a[48:51], v[108:111]
  v_mfma_f32_16x16x32_bf16 v[112:115], v[128:131], a[52:55], v[112:115]
  buffer_load_dwordx2 v[40:41], v1, s[4:7], s32 offen offset:1024 sc1
  v_mfma_f32_16x16x32_bf16 v[116:119], v[128:131], a[56:59], v[116:119]
  v_mfma_f32_16x16x32_bf16 v[120:123], v[128:131], a[60:63], v[120:123]
  buffer_load_dwordx2 v[42:43], v1, s[4:7], s32 offen offset:3072 sc1
  s_waitcnt lgkmcnt(2)
  v_mfma_f32_16x16x32_bf16 v[92:95], v[132:135], a[64:67], v[92:95]
  v_mfma_f32_16x16x32_bf16 v[96:99], v[132:135], a[68:71], v[96:99]
  ds_read_b128 v[128:131], v48 offset:13312
  v_mfma_f32_16x16x32_bf16 v[100:103], v[132:135], a[72:75], v[100:103]
  v_mfma_f32_16x16x32_bf16 v[104:107], v[132:135], a[76:79], v[104:107]
  buffer_load_dwordx2 v[44:45], v1, s[4:7], s33 offen offset:1024 sc1
  v_mfma_f32_16x16x32_bf16 v[108:111], v[132:135], a[80:83], v[108:111]
  v_mfma_f32_16x16x32_bf16 v[112:115], v[132:135], a[84:87], v[112:115]
  buffer_load_dwordx2 v[46:47], v1, s[4:7], s33 offen offset:3072 sc1
  v_mfma_f32_16x16x32_bf16 v[116:119], v[132:135], a[88:91], v[116:119]
  v_mfma_f32_16x16x32_bf16 v[120:123], v[132:135], a[92:95], v[120:123]
  v_cvt_pk_bf16_f32 v140, v60, v64
  v_cvt_pk_bf16_f32 v141, v68, v72
  s_waitcnt lgkmcnt(2)
  v_mfma_f32_16x16x32_bf16 v[92:95], v[136:139], a[96:99], v[92:95]
  v_mfma_f32_16x16x32_bf16 v[96:99], v[136:139], a[100:103], v[96:99]
  ds_read_b128 v[132:135], v48 offset:14336
  v_mfma_f32_16x16x32_bf16 v[100:103], v[136:139], a[104:107], v[100:103]
  v_mfma_f32_16x16x32_bf16 v[104:107], v[136:139], a[108:111], v[104:107]
  v_cvt_pk_bf16_f32 v142, v76, v80
  v_cvt_pk_bf16_f32 v143, v84, v88
  v_mfma_f32_16x16x32_bf16 v[108:111], v[136:139], a[112:115], v[108:111]
  v_mfma_f32_16x16x32_bf16 v[112:115], v[136:139], a[116:119], v[112:115]
  s_add_u32 s26, s86, 0
  buffer_store_dwordx4 v[140:143], v4, s[4:7], s26 offen
  v_mfma_f32_16x16x32_bf16 v[116:119], v[136:139], a[120:123], v[116:119]
  v_mfma_f32_16x16x32_bf16 v[120:123], v[136:139], a[124:127], v[120:123]
  v_cvt_pk_bf16_f32 v144, v61, v65
  v_cvt_pk_bf16_f32 v145, v69, v73
  s_waitcnt lgkmcnt(2)
  v_mfma_f32_16x16x32_bf16 v[92:95], v[124:127], a[128:131], v[92:95]
  v_mfma_f32_16x16x32_bf16 v[96:99], v[124:127], a[132:135], v[96:99]
  ds_read_b128 v[136:139], v48 offset:15360
  v_mfma_f32_16x16x32_bf16 v[100:103], v[124:127], a[136:139], v[100:103]
  v_mfma_f32_16x16x32_bf16 v[104:107], v[124:127], a[140:143], v[104:107]
  v_cvt_pk_bf16_f32 v146, v77, v81
  v_cvt_pk_bf16_f32 v147, v85, v89
  v_mfma_f32_16x16x32_bf16 v[108:111], v[124:127], a[144:147], v[108:111]
  v_mfma_f32_16x16x32_bf16 v[112:115], v[124:127], a[148:151], v[112:115]
  s_add_u32 s26, s86, 16384
  buffer_store_dwordx4 v[144:147], v4, s[4:7], s26 offen
  v_mfma_f32_16x16x32_bf16 v[116:119], v[124:127], a[152:155], v[116:119]
  v_mfma_f32_16x16x32_bf16 v[120:123], v[124:127], a[156:159], v[120:123]
  v_cvt_pk_bf16_f32 v148, v62, v66
  v_cvt_pk_bf16_f32 v149, v70, v74
  s_waitcnt lgkmcnt(2)
  v_mfma_f32_16x16x32_bf16 v[92:95], v[128:131], a[160:163], v[92:95]
  v_mfma_f32_16x16x32_bf16 v[96:99], v[128:131], a[164:167], v[96:99]
  v_cvt_pk_bf16_f32 v150, v78, v82
  v_cvt_pk_bf16_f32 v151, v86, v90
  v_mfma_f32_16x16x32_bf16 v[100:103], v[128:131], a[168:171], v[100:103]
  v_mfma_f32_16x16x32_bf16 v[104:107], v[128:131], a[172:175], v[104:107]
  s_add_u32 s26, s86, 32768
  buffer_store_dwordx4 v[148:151], v4, s[4:7], s26 offen
  v_mfma_f32_16x16x32_bf16 v[108:111], v[128:131], a[176:179], v[108:111]
  v_mfma_f32_16x16x32_bf16 v[112:115], v[128:131], a[180:183], v[112:115]
  v_cvt_pk_bf16_f32 v152, v63, v67
  v_cvt_pk_bf16_f32 v153, v71, v75
  v_mfma_f32_16x16x32_bf16 v[116:119], v[128:131], a[184:187], v[116:119]
  v_mfma_f32_16x16x32_bf16 v[120:123], v[128:131], a[188:191], v[120:123]
  v_cvt_pk_bf16_f32 v154, v79, v83
  v_cvt_pk_bf16_f32 v155, v87, v91
  s_waitcnt lgkmcnt(1)
  v_mfma_f32_16x16x32_bf16 v[92:95], v[132:135], a[192:195], v[92:95]
  v_mfma_f32_16x16x32_bf16 v[96:99], v[132:135], a[196:199], v[96:99]
  s_add_u32 s26, s86, 49152
  buffer_store_dwordx4 v[152:155], v4, s[4:7], s26 offen
  v_mfma_f32_16x16x32_bf16 v[100:103], v[132:135], a[200:203], v[100:103]
  v_mfma_f32_16x16x32_bf16 v[104:107], v[132:135], a[204:207], v[104:107]
  v_mfma_f32_16x16x32_bf16 v[108:111], v[132:135], a[208:211], v[108:111]
  v_mfma_f32_16x16x32_bf16 v[112:115], v[132:135], a[212:215], v[112:115]
  v_mfma_f32_16x16x32_bf16 v[116:119], v[132:135], a[216:219], v[116:119]
  v_mfma_f32_16x16x32_bf16 v[120:123], v[132:135], a[220:223], v[120:123]
  s_waitcnt lgkmcnt(0)
  v_mfma_f32_16x16x32_bf16 v[92:95], v[136:139], a[224:227], v[92:95]
  v_mfma_f32_16x16x32_bf16 v[96:99], v[136:139], a[228:231], v[96:99]
  v_mfma_f32_16x16x32_bf16 v[100:103], v[136:139], a[232:235], v[100:103]
  v_mfma_f32_16x16x32_bf16 v[104:107], v[136:139], a[236:239], v[104:107]
  v_mfma_f32_16x16x32_bf16 v[108:111], v[136:139], a[240:243], v[108:111]
  v_mfma_f32_16x16x32_bf16 v[112:115], v[136:139], a[244:247], v[112:115]
  v_mfma_f32_16x16x32_bf16 v[116:119], v[136:139], a[248:251], v[116:119]
  v_mfma_f32_16x16x32_bf16 v[120:123], v[136:139], a[252:255], v[120:123]
  s_nop 0
  s_nop 0
  v_cvt_pk_bf16_f32 v140, v92, v96
  s_nop 0
  v_cvt_pk_bf16_f32 v141, v100, v104
  s_nop 0
  v_cvt_pk_bf16_f32 v142, v108, v112
  s_nop 0
  v_cvt_pk_bf16_f32 v143, v116, v120
  s_add_u32 s26, s86, 262144
  buffer_store_dwordx4 v[140:143], v4, s[4:7], s26 offen
  v_cvt_pk_bf16_f32 v144, v93, v97
  v_cvt_pk_bf16_f32 v145, v101, v105
  v_cvt_pk_bf16_f32 v146, v109, v113
  v_cvt_pk_bf16_f32 v147, v117, v121
  s_add_u32 s26, s86, 278528
  buffer_store_dwordx4 v[144:147], v4, s[4:7], s26 offen
  v_cvt_pk_bf16_f32 v148, v94, v98
  v_cvt_pk_bf16_f32 v149, v102, v106
  v_cvt_pk_bf16_f32 v150, v110, v114
  v_cvt_pk_bf16_f32 v151, v118, v122
  s_add_u32 s26, s86, 294912
  buffer_store_dwordx4 v[148:151], v4, s[4:7], s26 offen
  v_cvt_pk_bf16_f32 v152, v95, v99
  v_cvt_pk_bf16_f32 v153, v103, v107
  v_cvt_pk_bf16_f32 v154, v111, v115
  v_cvt_pk_bf16_f32 v155, v119, v123
  s_add_u32 s26, s86, 311296
  buffer_store_dwordx4 v[152:155], v4, s[4:7], s26 offen
  s_waitcnt vmcnt(8)
  s_branch o_we_100
o_wr1_98:
  s_and_b32 s26, s65, 768
  s_cbranch_scc1 o_wr2_99
  ds_read_b128 v[56:59], v54
  ds_read_b128 v[124:127], v48 offset:0
  ds_read_b128 v[128:131], v48 offset:1024
  ds_read_b128 v[132:135], v48 offset:2048
  s_lshl_b32 s90, s61, 1
  s_add_u32 s90, s90, s17
  s_and_b32 s94, s95, 1
  s_lshl_b32 s94, s94, 5
  s_add_u32 s94, s94, s90
  s_lshl_b32 s94, s94, 14
  s_lshl_b32 s92, s60, 21
  s_add_u32 s94, s94, s92
  s_add_u32 s94, s94, 12582912
  buffer_load_dwordx4 v[156:159], v5, s[4:7], s94 offen offset:0 sc1
  buffer_load_dwordx4 v[160:163], v5, s[4:7], s94 offen offset:256 sc1
  buffer_load_dwordx4 v[164:167], v5, s[4:7], s94 offen offset:512 sc1
  buffer_load_dwordx4 v[168:171], v5, s[4:7], s94 offen offset:768 sc1
  s_add_u32 s94, s94, 4096
  buffer_load_dwordx4 v[172:175], v5, s[4:7], s94 offen offset:0 sc1
  buffer_load_dwordx4 v[176:179], v5, s[4:7], s94 offen offset:256 sc1
  buffer_load_dwordx4 v[180:183], v5, s[4:7], s94 offen offset:512 sc1
  buffer_load_dwordx4 v[184:187], v5, s[4:7], s94 offen offset:768 sc1
  s_add_u32 s94, s94, 4096
  buffer_load_dwordx4 v[188:191], v5, s[4:7], s94 offen offset:0 sc1
  buffer_load_dwordx4 v[192:195], v5, s[4:7], s94 offen offset:256 sc1
  buffer_load_dwordx4 v[196:199], v5, s[4:7], s94 offen offset:512 sc1
  buffer_load_dwordx4 v[200:203], v5, s[4:7], s94 offen offset:768 sc1
  s_add_u32 s94, s94, 4096
  buffer_load_dwordx4 v[204:207], v5, s[4:7], s94 offen offset:0 sc1
  buffer_load_dwordx4 v[208:211], v5, s[4:7], s94 offen offset:256 sc1
  buffer_load_dwordx4 v[212:215], v5, s[4:7], s94 offen offset:512 sc1
  buffer_load_dwordx4 v[216:219], v5, s[4:7], s94 offen offset:768 sc1
  s_and_b32 s91, s65, 63
  s_lshl_b32 s94, s91, 11
  s_lshl_b32 s91, s91, 5
  s_add_u32 s90, s90, s91
  s_lshl_b32 s91, s90, 10
  buffer_load_dwordx4 v[220:223], v0, s[72:75], s91 offen
  s_waitcnt lgkmcnt(2)
  v_mfma_f32_16x16x32_bf16 v[60:63], v[124:127], a[0:3], 0
  v_mfma_f32_16x16x32_bf16 v[64:67], v[124:127], a[4:7], 0
  ds_read_b128 v[136:139], v48 offset:3072
  v_mfma_f32_16x16x32_bf16 v[68:71], v[124:127], a[8:11], 0
  v_mfma_f32_16x16x32_bf16 v[72:75], v[124:127], a[12:15], 0
  v_and_b32 v56, v56, v57
  v_and_b32 v58, v58, v59
  v_mfma_f32_16x16x32_bf16 v[76:79], v[124:127], a[16:19], 0
  v_mfma_f32_16x16x32_bf16 v[80:83], v[124:127], a[20:23], 0
  v_and_b32 v56, v56, v58
  s_bfe_u32 s26, s64, 131086
  v_readfirstlane_b32 s27, v56
  v_mfma_f32_16x16x32_bf16 v[84:87], v[124:127], a[24:27], 0
  v_mfma_f32_16x16x32_bf16 v[88:91], v[124:127], a[28:31], 0
  s_cmp_eq_u32 s26, 1
  s_cselect_b32 s66, s27, 0
  s_and_b32 s66, s66, 1
  s_cselect_b32 s87, 0, 268435456
  s_cmp_lg_u32 s26, 0
  s_cselect_b32 s76, s27, 0
  s_and_b32 s76, s76, 2
  s_cselect_b32 s88, 0, 268435456
  s_waitcnt lgkmcnt(2)
  v_mfma_f32_16x16x32_bf16 v[60:63], v[128:131], a[32:35], v[60:63]
  v_mfma_f32_16x16x32_bf16 v[64:67], v[128:131], a[36:39], v[64:67]
  ds_read_b128 v[124:127], v48 offset:8192
  v_mfma_f32_16x16x32_bf16 v[68:71], v[128:131], a[40:43], v[68:71]
  v_mfma_f32_16x16x32_bf16 v[72:75], v[128:131], a[44:47], v[72:75]
  s_waitcnt vmcnt(16)
  v_mfma_f32_16x16x32_bf16 v[224:227], v[16:19], v[156:159], 0
  s_waitcnt vmcnt(15)
  v_mfma_f32_16x16x32_bf16 v[228:231], v[16:19], v[160:163], 0
  v_mfma_f32_16x16x32_bf16 v[76:79], v[128:131], a[48:51], v[76:79]
  s_waitcnt vmcnt(14)
  v_mfma_f32_16x16x32_bf16 v[224:227], v[20:23], v[164:167], v[224:227]
  s_waitcnt vmcnt(13)
  v_mfma_f32_16x16x32_bf16 v[228:231], v[20:23], v[168:171], v[228:231]
  v_mfma_f32_16x16x32_bf16 v[80:83], v[128:131], a[52:55], v[80:83]
  s_waitcnt vmcnt(12)
  v_mfma_f32_16x16x32_bf16 v[224:227], v[16:19], v[172:175], v[224:227]
  s_waitcnt vmcnt(11)
  v_mfma_f32_16x16x32_bf16 v[228:231], v[16:19], v[176:179], v[228:231]
  v_mfma_f32_16x16x32_bf16 v[84:87], v[128:131], a[56:59], v[84:87]
  s_waitcnt vmcnt(10)
  v_mfma_f32_16x16x32_bf16 v[224:227], v[20:23], v[180:183], v[224:227]
  s_waitcnt vmcnt(9)
  v_mfma_f32_16x16x32_bf16 v[228:231], v[20:23], v[184:187], v[228:231]
  v_mfma_f32_16x16x32_bf16 v[88:91], v[128:131], a[60:63], v[88:91]
  s_waitcnt vmcnt(8)
  v_mfma_f32_16x16x32_bf16 v[224:227], v[16:19], v[188:191], v[224:227]
  s_waitcnt vmcnt(7)
  v_mfma_f32_16x16x32_bf16 v[228:231], v[16:19], v[192:195], v[228:231]
  s_waitcnt lgkmcnt(2)
  v_mfma_f32_16x16x32_bf16 v[60:63], v[132:135], a[64:67], v[60:63]
  s_waitcnt vmcnt(6)
  v_mfma_f32_16x16x32_bf16 v[224:227], v[20:23], v[196:199], v[224:227]
  s_waitcnt vmcnt(5)
  v_mfma_f32_16x16x32_bf16 v[228:231], v[20:23], v[200:203], v[228:231]
  v_mfma_f32_16x16x32_bf16 v[64:67], v[132:135], a[68:71], v[64:67]
  ds_read_b128 v[128:131], v48 offset:9216
  v_mfma_f32_16x16x32_bf16 v[68:71], v[132:135], a[72:75], v[68:71]
  s_waitcnt vmcnt(4)
  v_mfma_f32_16x16x32_bf16 v[224:227], v[16:19], v[204:207], v[224:227]
  s_waitcnt vmcnt(3)
  v_mfma_f32_16x16x32_bf16 v[228:231], v[16:19], v[208:211], v[228:231]
  v_mfma_f32_16x16x32_bf16 v[72:75], v[132:135], a[76:79], v[72:75]
  s_waitcnt vmcnt(2)
  v_mfma_f32_16x16x32_bf16 v[224:227], v[20:23], v[212:215], v[224:227]
  s_waitcnt vmcnt(1)
  v_mfma_f32_16x16x32_bf16 v[228:231], v[20:23], v[216:219], v[228:231]
  v_mfma_f32_16x16x32_bf16 v[76:79], v[132:135], a[80:83], v[76:79]
  s_bfe_u32 s92, s65, 131080
  s_lshl_b32 s92, s92, 21
  s_add_u32 s92, s92, s91
  s_add_u32 s93, s92, 27262976
  s_add_u32 s92, s92, 20971520
  s_waitcnt vmcnt(0)
  v_lshlrev_b32 v232, 16, v220
  v_mfma_f32_16x16x32_bf16 v[80:83], v[132:135], a[84:87], v[80:83]
  v_and_b32 v233, 0xffff0000, v220
  v_lshlrev_b32 v234, 16, v221
  v_and_b32 v235, 0xffff0000, v221
  v_mfma_f32_16x16x32_bf16 v[84:87], v[132:135], a[88:91], v[84:87]
  v_lshlrev_b32 v236, 16, v222
  v_and_b32 v237, 0xffff0000, v222
  v_lshlrev_b32 v238, 16, v223
  v_mfma_f32_16x16x32_bf16 v[88:91], v[132:135], a[92:95], v[88:91]
  v_and_b32 v239, 0xffff0000, v223
  v_permlane16_swap_b32 v224, v228
  v_permlane16_swap_b32 v225, v229
  s_waitcnt lgkmcnt(2)
  v_mfma_f32_16x16x32_bf16 v[60:63], v[136:139], a[96:99], v[60:63]
  v_permlane16_swap_b32 v226, v230
  v_permlane16_swap_b32 v227, v231
  v_cvt_pk_bf16_f32 v224, 0, v224
  v_mfma_f32_16x16x32_bf16 v[64:67], v[136:139], a[100:103], v[64:67]
  ds_read_b128 v[132:135], v48 offset:10240
  v_mfma_f32_16x16x32_bf16 v[68:71], v[136:139], a[104:107], v[68:71]
  v_cvt_pk_bf16_f32 v225, 0, v225
  v_cvt_pk_bf16_f32 v226, 0, v226
  v_cvt_pk_bf16_f32 v227, 0, v227
  v_mfma_f32_16x16x32_bf16 v[72:75], v[136:139], a[108:111], v[72:75]
  s_and_b32 s32, s64, 0xff
  s_lshl_b32 s32, s32, 4
  s_add_u32 s32, s32, s61
  s_lshl_b32 s32, s32, 2
  s_add_u32 s32, s32, s17
  s_lshl_b32 s33, s32, 12
  v_cvt_pk_bf16_f32 v228, 0, v228
  v_mfma_f32_16x16x32_bf16 v[76:79], v[136:139], a[112:115], v[76:79]
  v_cvt_pk_bf16_f32 v229, 0, v229
  v_cvt_pk_bf16_f32 v230, 0, v230
  v_cvt_pk_bf16_f32 v231, 0, v231
  v_mfma_f32_16x16x32_bf16 v[80:83], v[136:139], a[116:119], v[80:83]
  s_add_u32 s33, s33, 142606336
  s_lshl_b32 s32, s32, 13
  s_add_u32 s32, s32, 41943040
  s_add_u32 s32, s32, s87
  s_add_u32 s33, s33, s87
  s_xor_b32 s34, s84, 114688
  v_add_f32 v232, v232, v224
  v_mfma_f32_16x16x32_bf16 v[84:87], v[136:139], a[120:123], v[84:87]
  v_add_f32 v233, v233, v225
  v_add_f32 v234, v234, v226
  v_add_f32 v235, v235, v227
  v_mfma_f32_16x16x32_bf16 v[88:91], v[136:139], a[124:127], v[88:91]
  s_lshl_b32 s35, s17, 12
  s_add_u32 s34, s34, s35
  s_add_u32 m0, s34, 32768
  s_add_u32 s34, s34, s35
  buffer_load_dwordx4 v0, s[4:7], s33 offen offset:0 sc1 lds
  s_waitcnt lgkmcnt(2)
  v_mfma_f32_16x16x32_bf16 v[60:63], v[124:127], a[128:131], v[60:63]
  v_add_f32 v236, v236, v228
  v_add_f32 v237, v237, v229
  v_add_f32 v238, v238, v230
  v_mfma_f32_16x16x32_bf16 v[64:67], v[124:127], a[132:135], v[64:67]
  ds_read_b128 v[136:139], v48 offset:11264
  v_mfma_f32_16x16x32_bf16 v[68:71], v[124:127], a[136:139], v[68:71]
  v_add_f32 v239, v239, v231
  v_cvt_pk_bf16_f32 v156, v232, v233
  v_cvt_pk_bf16_f32 v157, v234, v235
  v_mfma_f32_16x16x32_bf16 v[72:75], v[124:127], a[140:143], v[72:75]
  buffer_load_dwordx4 v0, s[4:7], s33 offen offset:1024 sc1 lds
  v_cvt_pk_bf16_f32 v158, v236, v237
  v_mfma_f32_16x16x32_bf16 v[76:79], v[124:127], a[144:147], v[76:79]
  v_cvt_pk_bf16_f32 v159, v238, v239
  v_lshlrev_b32 v232, 16, v156
  v_and_b32 v233, 0xffff0000, v156
  v_mfma_f32_16x16x32_bf16 v[80:83], v[124:127], a[148:151], v[80:83]
  buffer_load_dwordx4 v0, s[4:7], s33 offen offset:2048 sc1 lds
  v_lshlrev_b32 v234, 16, v157
  v_mfma_f32_16x16x32_bf16 v[84:87], v[124:127], a[152:155], v[84:87]
  v_and_b32 v235, 0xffff0000, v157
  v_lshlrev_b32 v236, 16, v158
  v_and_b32 v237, 0xffff0000, v158
  v_mfma_f32_16x16x32_bf16 v[88:91], v[124:127], a[156:159], v[88:91]
  buffer_load_dwordx4 v0, s[4:7], s33 offen offset:3072 sc1 lds
  v_lshlrev_b32 v238, 16, v159
  s_waitcnt lgkmcnt(2)
  v_mfma_f32_16x16x32_bf16 v[60:63], v[128:131], a[160:163], v[60:63]
  v_and_b32 v239, 0xffff0000, v159
  buffer_store_dwordx4 v[156:159], v0, s[4:7], s92 offen sc1
  v_mfma_f32_16x16x32_bf16 v[64:67], v[128:131], a[164:167], v[64:67]
  ds_read_b128 v[124:127], v48 offset:4096
  v_mfma_f32_16x16x32_bf16 v[68:71], v[128:131], a[168:171], v[68:71]
  v_add_f32 v172, v232, v233
  v_add_f32 v173, v234, v235
  v_add_f32 v174, v236, v237
  v_mfma_f32_16x16x32_bf16 v[72:75], v[128:131], a[172:175], v[72:75]
  s_add_u32 m0, s34, 0
  s_nop 0
  buffer_load_dwordx4 v0, s[4:7], s32 offen offset:0 sc1 lds
  v_add_f32 v175, v238, v239
  v_mfma_f32_16x16x32_bf16 v[76:79], v[128:131], a[176:179], v[76:79]
  v_add_f32 v172, v172, v173
  v_add_f32 v174, v174, v175
  v_add_f32 v172, v172, v174
  v_mfma_f32_16x16x32_bf16 v[80:83], v[128:131], a[180:183], v[80:83]
  buffer_load_dwordx4 v0, s[4:7], s32 offen offset:1024 sc1 lds
  v_add_f32_dpp v172, v172, v172 row_ror:8 row_mask:0xf bank_mask:0xf
  v_mfma_f32_16x16x32_bf16 v[84:87], v[128:131], a[184:187], v[84:87]
  s_nop 0
  v_add_f32_dpp v172, v172, v172 row_ror:4 row_mask:0xf bank_mask:0xf
  s_nop 1
  v_add_f32_dpp v172, v172, v172 row_ror:2 row_mask:0xf bank_mask:0xf
  s_nop 1
  v_add_f32_dpp v172, v172, v172 row_ror:1 row_mask:0xf bank_mask:0xf
  v_mfma_f32_16x16x32_bf16 v[88:91], v[128:131], a[188:191], v[88:91]
  buffer_load_dwordx4 v0, s[4:7], s32 offen offset:2048 sc1 lds
  v_mov_b32 v174, v172
  s_waitcnt lgkmcnt(2)
  v_mfma_f32_16x16x32_bf16 v[60:63], v[132:135], a[192:195], v[60:63]
  v_permlane16_swap_b32 v172, v174
  v_add_f32 v172, v172, v174
  v_mov_b32 v174, v172
  v_mfma_f32_16x16x32_bf16 v[64:67], v[132:135], a[196:199], v[64:67]
  ds_read_b128 v[128:131], v48 offset:5120
  v_mfma_f32_16x16x32_bf16 v[68:71], v[132:135], a[200:203], v[68:71]
  v_permlane32_swap_b32 v172, v174
  v_add_f32 v172, v172, v174
  v_mul_f32 v172, 0x3b000000, v172
  v_mfma_f32_16x16x32_bf16 v[72:75], v[132:135], a[204:207], v[72:75]
  buffer_load_dwordx4 v0, s[4:7], s32 offen offset:3072 sc1 lds
  v_sub_f32 v176, v232, v172
  v_mfma_f32_16x16x32_bf16 v[76:79], v[132:135], a[208:211], v[76:79]
  v_sub_f32 v177, v233, v172
  v_sub_f32 v178, v234, v172
  v_sub_f32 v179, v235, v172
  v_mfma_f32_16x16x32_bf16 v[80:83], v[132:135], a[212:215], v[80:83]
  s_add_u32 m0, s34, 4096
  s_add_u32 s32, s32, 4096
  buffer_load_dwordx4 v0, s[4:7], s32 offen offset:0 sc1 lds
  v_sub_f32 v180, v236, v172
  v_mfma_f32_16x16x32_bf16 v[84:87], v[132:135], a[216:219], v[84:87]
  v_sub_f32 v181, v237, v172
  v_sub_f32 v182, v238, v172
  v_sub_f32 v183, v239, v172
  v_mfma_f32_16x16x32_bf16 v[88:91], v[132:135], a[220:223], v[88:91]
  buffer_load_dwordx4 v0, s[4:7], s32 offen offset:1024 sc1 lds
  v_mul_f32 v173, v176, v176
  s_waitcnt lgkmcnt(2)
  v_mfma_f32_16x16x32_bf16 v[60:63], v[136:139], a[224:227], v[60:63]
  v_mul_f32 v174, v177, v177
  v_fmac_f32 v173, v178, v178
  v_fmac_f32 v174, v179, v179
  v_mfma_f32_16x16x32_bf16 v[64:67], v[136:139], a[228:231], v[64:67]
  ds_read_b128 v[132:135], v48 offset:6144
  v_mfma_f32_16x16x32_bf16 v[68:71], v[136:139], a[232:235], v[68:71]
  v_fmac_f32 v173, v180, v180
  v_fmac_f32 v174, v181, v181
  v_fmac_f32 v173, v182, v182
  v_mfma_f32_16x16x32_bf16 v[72:75], v[136:139], a[236:239], v[72:75]
  buffer_load_dwordx4 v0, s[4:7], s32 offen offset:2048 sc1 lds
  v_fmac_f32 v174, v183, v183
  v_mfma_f32_16x16x32_bf16 v[76:79], v[136:139], a[240:243], v[76:79]
  v_add_f32 v173, v173, v174
  v_cvt_pk_bf16_f32 v172, 0, v172
  s_nop 0
  v_add_f32_dpp v173, v173, v173 row_ror:8 row_mask:0xf bank_mask:0xf
  v_mfma_f32_16x16x32_bf16 v[80:83], v[136:139], a[244:247], v[80:83]
  buffer_load_dwordx4 v0, s[4:7], s32 offen offset:3072 sc1 lds
  v_sub_f32 v176, v232, v172
  v_mfma_f32_16x16x32_bf16 v[84:87], v[136:139], a[248:251], v[84:87]
  v_sub_f32 v177, v233, v172
  v_add_f32_dpp v173, v173, v173 row_ror:4 row_mask:0xf bank_mask:0xf
  v_sub_f32 v178, v234, v172
  v_mfma_f32_16x16x32_bf16 v[88:91], v[136:139], a[252:255], v[88:91]
  s_and_b32 s32, s64, 63
  s_lshl_b32 s32, s32, 5
  s_add_u32 s32, s32, s85
  s_bfe_u32 s33, s64, 131080
  s_lshl_b32 s33, s33, 11
  s_add_u32 s32, s32, s33
  v_sub_f32 v179, v235, v172
  s_waitcnt lgkmcnt(2)
  v_mfma_f32_16x16x32_bf16 v[92:95], v[124:127], a[0:3], 0
  v_add_f32_dpp v173, v173, v173 row_ror:2 row_mask:0xf bank_mask:0xf
  v_sub_f32 v180, v236, v172
  v_sub_f32 v181, v237, v172
  v_mfma_f32_16x16x32_bf16 v[96:99], v[124:127], a[4:7], 0
  ds_read_b128 v[136:139], v48 offset:7168
  v_mfma_f32_16x16x32_bf16 v[100:103], v[124:127], a[8:11], 0
  v_add_f32_dpp v173, v173, v173 row_ror:1 row_mask:0xf bank_mask:0xf
  v_sub_f32 v182, v238, v172
  v_sub_f32 v183, v239, v172
  v_mfma_f32_16x16x32_bf16 v[104:107], v[124:127], a[12:15], 0
  s_lshl_b32 s32, s32, 13
  s_add_u32 s32, s32, 192937984
  s_add_u32 s32, s32, s88
  s_add_u32 s33, s32, 4096
  buffer_load_dwordx4 v[24:27], v0, s[4:7], s32 offen offset:0 sc1
  v_mfma_f32_16x16x32_bf16 v[108:111], v[124:127], a[16:19], 0
  v_mov_b32 v174, v173
  v_cvt_pk_bf16_f32 v176, 0, v176
  v_cvt_pk_bf16_f32 v177, 0, v177
  v_mfma_f32_16x16x32_bf16 v[112:115], v[124:127], a[20:23], 0
  buffer_load_dwordx4 v[28:31], v0, s[4:7], s32 offen offset:2048 sc1
  v_permlane16_swap_b32 v173, v174
  v_mfma_f32_16x16x32_bf16 v[116:119], v[124:127], a[24:27], 0
  v_cvt_pk_bf16_f32 v178, 0, v178
  v_cvt_pk_bf16_f32 v179, 0, v179
  v_add_f32 v173, v173, v174
  v_mfma_f32_16x16x32_bf16 v[120:123], v[124:127], a[28:31], 0
  buffer_load_dwordx4 v[32:35], v0, s[4:7], s33 offen offset:0 sc1
  v_cvt_pk_bf16_f32 v180, 0, v180
  s_waitcnt lgkmcnt(2)
  v_mfma_f32_16x16x32_bf16 v[92:95], v[128:131], a[32:35], v[92:95]
  v_cvt_pk_bf16_f32 v181, 0, v181
  v_mov_b32 v174, v173
  v_cvt_pk_bf16_f32 v182, 0, v182
  v_mfma_f32_16x16x32_bf16 v[96:99], v[128:131], a[36:39], v[96:99]
  ds_read_b128 v[124:127], v48 offset:12288
  v_mfma_f32_16x16x32_bf16 v[100:103], v[128:131], a[40:43], v[100:103]
  v_cvt_pk_bf16_f32 v183, 0, v183
  v_permlane32_swap_b32 v173, v174
  v_add_f32 v173, v173, v174
  v_mfma_f32_16x16x32_bf16 v[104:107], v[128:131], a[44:47], v[104:107]
  buffer_load_dwordx4 v[36:39], v0, s[4:7], s33 offen offset:2048 sc1
  v_mul_f32 v173, 0x3b000000, v173
  v_mfma_f32_16x16x32_bf16 v[108:111], v[128:131], a[48:51], v[108:111]
  v_cvt_pk_bf16_f32 v173, 0, v173
  v_add_f32 v173, 0x3727c5ac, v173
  v_cvt_pk_bf16_f32 v173, 0, v173
  v_mfma_f32_16x16x32_bf16 v[112:115], v[128:131], a[52:55], v[112:115]
  buffer_load_dwordx2 v[40:41], v1, s[4:7], s32 offen offset:1024 sc1
  v_sqrt_f32 v173, v173
  v_mfma_f32_16x16x32_bf16 v[116:119], v[128:131], a[56:59], v[116:119]
  v_cvt_pk_bf16_f32 v173, 0, v173
  v_rcp_f32 v173, v173
  s_nop 0
  v_mul_f32 v176, v176, v173
  v_mfma_f32_16x16x32_bf16 v[120:123], v[128:131], a[60:63], v[120:123]
  buffer_load_dwordx2 v[42:43], v1, s[4:7], s32 offen offset:3072 sc1
  v_mul_f32 v177, v177, v173
  s_waitcnt lgkmcnt(2)
  v_mfma_f32_16x16x32_bf16 v[92:95], v[132:135], a[64:67], v[92:95]
  v_mul_f32 v178, v178, v173
  v_mul_f32 v179, v179, v173
  v_mul_f32 v180, v180, v173
  v_mfma_f32_16x16x32_bf16 v[96:99], v[132:135], a[68:71], v[96:99]
  ds_read_b128 v[128:131], v48 offset:13312
  v_mfma_f32_16x16x32_bf16 v[100:103], v[132:135], a[72:75], v[100:103]
  v_mul_f32 v181, v181, v173
  v_mul_f32 v182, v182, v173
  v_mul_f32 v183, v183, v173
  v_mfma_f32_16x16x32_bf16 v[104:107], v[132:135], a[76:79], v[104:107]
  buffer_load_dwordx2 v[44:45], v1, s[4:7], s33 offen offset:1024 sc1
  v_cvt_pk_bf16_f32 v160, v176, v177
  v_mfma_f32_16x16x32_bf16 v[108:111], v[132:135], a[80:83], v[108:111]
  v_cvt_pk_bf16_f32 v161, v178, v179
  v_cvt_pk_bf16_f32 v162, v180, v181
  v_cvt_pk_bf16_f32 v163, v182, v183
  v_mfma_f32_16x16x32_bf16 v[112:115], v[132:135], a[84:87], v[112:115]
  buffer_load_dwordx2 v[46:47], v1, s[4:7], s33 offen offset:3072 sc1
  v_lshlrev_b32 v240, 16, v160
  v_mfma_f32_16x16x32_bf16 v[116:119], v[132:135], a[88:91], v[116:119]
  v_and_b32 v241, 0xffff0000, v160
  v_lshlrev_b32 v242, 16, v161
  v_and_b32 v243, 0xffff0000, v161
  v_mfma_f32_16x16x32_bf16 v[120:123], v[132:135], a[92:95], v[120:123]
  v_cvt_pk_bf16_f32 v140, v60, v64
  v_cvt_pk_bf16_f32 v141, v68, v72
  v_lshlrev_b32 v244, 16, v162
  s_waitcnt lgkmcnt(2)
  v_mfma_f32_16x16x32_bf16 v[92:95], v[136:139], a[96:99], v[92:95]
  v_and_b32 v245, 0xffff0000, v162
  v_lshlrev_b32 v246, 16, v163
  v_and_b32 v247, 0xffff0000, v163
  v_mfma_f32_16x16x32_bf16 v[96:99], v[136:139], a[100:103], v[96:99]
  ds_read_b128 v[132:135], v48 offset:14336
  v_mfma_f32_16x16x32_bf16 v[100:103], v[136:139], a[104:107], v[100:103]
  buffer_store_dwordx4 v[160:163], v0, s[4:7], s93 offen sc1
  v_add_f32 v232, v232, v240
  v_mfma_f32_16x16x32_bf16 v[104:107], v[136:139], a[108:111], v[104:107]
  v_cvt_pk_bf16_f32 v142, v76, v80
  v_cvt_pk_bf16_f32 v143, v84, v88
  v_add_f32 v233, v233, v241
  v_mfma_f32_16x16x32_bf16 v[108:111], v[136:139], a[112:115], v[108:111]
  v_add_f32 v234, v234, v242
  v_add_f32 v235, v235, v243
  v_add_f32 v236, v236, v244
  v_mfma_f32_16x16x32_bf16 v[112:115], v[136:139], a[116:119], v[112:115]
  s_add_u32 s26, s86, 0
  buffer_store_dwordx4 v[140:143], v4, s[4:7], s26 offen
  v_add_f32 v237, v237, v245
  v_mfma_f32_16x16x32_bf16 v[116:119], v[136:139], a[120:123], v[116:119]
  v_add_f32 v238, v238, v246
  v_add_f32 v239, v239, v247
  v_cvt_pk_bf16_f32 v164, v232, v233
  v_mfma_f32_16x16x32_bf16 v[120:123], v[136:139], a[124:127], v[120:123]
  v_cvt_pk_bf16_f32 v144, v61, v65
  v_cvt_pk_bf16_f32 v145, v69, v73
  v_cvt_pk_bf16_f32 v165, v234, v235
  s_waitcnt lgkmcnt(2)
  v_mfma_f32_16x16x32_bf16 v[92:95], v[124:127], a[128:131], v[92:95]
  v_cvt_pk_bf16_f32 v166, v236, v237
  v_cvt_pk_bf16_f32 v167, v238, v239
  v_mul_f32 v224, v240, v8
  v_mfma_f32_16x16x32_bf16 v[96:99], v[124:127], a[132:135], v[96:99]
  ds_read_b128 v[136:139], v48 offset:15360
  v_mfma_f32_16x16x32_bf16 v[100:103], v[124:127], a[136:139], v[100:103]
  v_mul_f32 v225, v241, v9
  v_fmac_f32 v224, v242, v10
  v_fmac_f32 v225, v243, v11
  v_mfma_f32_16x16x32_bf16 v[104:107], v[124:127], a[140:143], v[104:107]
  v_cvt_pk_bf16_f32 v146, v77, v81
  v_cvt_pk_bf16_f32 v147, v85, v89
  v_fmac_f32 v224, v244, v12
  v_mfma_f32_16x16x32_bf16 v[108:111], v[124:127], a[144:147], v[108:111]
  v_fmac_f32 v225, v245, v13
  v_fmac_f32 v224, v246, v14
  v_fmac_f32 v225, v247, v15
  v_mfma_f32_16x16x32_bf16 v[112:115], v[124:127], a[148:151], v[112:115]
  s_add_u32 s26, s86, 16384
  buffer_store_dwordx4 v[144:147], v4, s[4:7], s26 offen
  v_add_f32 v224, v224, v225
  v_mfma_f32_16x16x32_bf16 v[116:119], v[124:127], a[152:155], v[116:119]
  s_add_u32 s92, s91, 10485760
  s_add_u32 s93, s91, 8388608
  buffer_store_dwordx4 v[164:167], v0, s[4:7], s92 offen sc1
  v_lshlrev_b32 v232, 16, v164
  v_mfma_f32_16x16x32_bf16 v[120:123], v[124:127], a[156:159], v[120:123]
  v_cvt_pk_bf16_f32 v148, v62, v66
  v_cvt_pk_bf16_f32 v149, v70, v74
  v_and_b32 v233, 0xffff0000, v164
  s_waitcnt lgkmcnt(2)
  v_mfma_f32_16x16x32_bf16 v[92:95], v[128:131], a[160:163], v[92:95]
  v_lshlrev_b32 v234, 16, v165
  v_and_b32 v235, 0xffff0000, v165
  v_lshlrev_b32 v236, 16, v166
  v_mfma_f32_16x16x32_bf16 v[96:99], v[128:131], a[164:167], v[96:99]
  v_cvt_pk_bf16_f32 v150, v78, v82
  v_cvt_pk_bf16_f32 v151, v86, v90
  v_and_b32 v237, 0xffff0000, v166
  v_mfma_f32_16x16x32_bf16 v[100:103], v[128:131], a[168:171], v[100:103]
  v_lshlrev_b32 v238, 16, v167
  v_and_b32 v239, 0xffff0000, v167
  v_add_f32 v172, v232, v233
  v_mfma_f32_16x16x32_bf16 v[104:107], v[128:131], a[172:175], v[104:107]
  s_add_u32 s26, s86, 32768
  buffer_store_dwordx4 v[148:151], v4, s[4:7], s26 offen
  v_add_f32 v173, v234, v235
  v_mfma_f32_16x16x32_bf16 v[108:111], v[128:131], a[176:179], v[108:111]
  v_add_f32 v174, v236, v237
  v_add_f32 v175, v238, v239
  v_add_f32 v172, v172, v173
  v_mfma_f32_16x16x32_bf16 v[112:115], v[128:131], a[180:183], v[112:115]
  v_cvt_pk_bf16_f32 v152, v63, v67
  v_cvt_pk_bf16_f32 v153, v71, v75
  v_add_f32 v174, v174, v175
  v_mfma_f32_16x16x32_bf16 v[116:119], v[128:131], a[184:187], v[116:119]
  v_add_f32 v172, v172, v174
  s_nop 1
  v_add_f32_dpp v172, v172, v172 row_ror:8 row_mask:0xf bank_mask:0xf
  v_add_f32_dpp v224, v224, v224 row_ror:8 row_mask:0xf bank_mask:0xf
  v_mfma_f32_16x16x32_bf16 v[120:123], v[128:131], a[188:191], v[120:123]
  v_cvt_pk_bf16_f32 v154, v79, v83
  v_cvt_pk_bf16_f32 v155, v87, v91
  v_add_f32_dpp v172, v172, v172 row_ror:4 row_mask:0xf bank_mask:0xf
  s_waitcnt lgkmcnt(1)
  v_mfma_f32_16x16x32_bf16 v[92:95], v[132:135], a[192:195], v[92:95]
  v_add_f32_dpp v224, v224, v224 row_ror:4 row_mask:0xf bank_mask:0xf
  v_add_f32_dpp v172, v172, v172 row_ror:2 row_mask:0xf bank_mask:0xf
  s_nop 0
  v_add_f32_dpp v224, v224, v224 row_ror:2 row_mask:0xf bank_mask:0xf
  v_mfma_f32_16x16x32_bf16 v[96:99], v[132:135], a[196:199], v[96:99]
  s_add_u32 s26, s86, 49152
  buffer_store_dwordx4 v[152:155], v4, s[4:7], s26 offen
  v_add_f32_dpp v172, v172, v172 row_ror:1 row_mask:0xf bank_mask:0xf
  v_mfma_f32_16x16x32_bf16 v[100:103], v[132:135], a[200:203], v[100:103]
  v_add_f32_dpp v224, v224, v224 row_ror:1 row_mask:0xf bank_mask:0xf
  v_mov_b32 v174, v172
  v_mov_b32 v175, v224
  v_mfma_f32_16x16x32_bf16 v[104:107], v[132:135], a[204:207], v[104:107]
  v_permlane16_swap_b32 v172, v174
  v_permlane16_swap_b32 v224, v175
  v_add_f32 v172, v172, v174
  v_mfma_f32_16x16x32_bf16 v[108:111], v[132:135], a[208:211], v[108:111]
  v_add_f32 v224, v224, v175
  v_mov_b32 v174, v172
  v_mov_b32 v175, v224
  v_mfma_f32_16x16x32_bf16 v[112:115], v[132:135], a[212:215], v[112:115]
  v_permlane32_swap_b32 v172, v174
  v_permlane32_swap_b32 v224, v175
  v_add_f32 v172, v172, v174
  v_mfma_f32_16x16x32_bf16 v[116:119], v[132:135], a[216:219], v[116:119]
  v_add_f32 v224, v224, v175
  v_mul_f32 v172, 0x3b000000, v172
  v_sub_f32 v176, v232, v172
  v_mfma_f32_16x16x32_bf16 v[120:123], v[132:135], a[220:223], v[120:123]
  v_sub_f32 v177, v233, v172
  v_sub_f32 v178, v234, v172
  v_sub_f32 v179, v235, v172
  s_waitcnt lgkmcnt(0)
  v_mfma_f32_16x16x32_bf16 v[92:95], v[136:139], a[224:227], v[92:95]
  v_sub_f32 v180, v236, v172
  v_sub_f32 v181, v237, v172
  v_sub_f32 v182, v238, v172
  v_mfma_f32_16x16x32_bf16 v[96:99], v[136:139], a[228:231], v[96:99]
  v_sub_f32 v183, v239, v172
  v_mul_f32 v173, v176, v176
  v_mul_f32 v174, v177, v177
  v_mfma_f32_16x16x32_bf16 v[100:103], v[136:139], a[232:235], v[100:103]
  v_fmac_f32 v173, v178, v178
  v_fmac_f32 v174, v179, v179
  v_fmac_f32 v173, v180, v180
  v_mfma_f32_16x16x32_bf16 v[104:107], v[136:139], a[236:239], v[104:107]
  v_fmac_f32 v174, v181, v181
  v_fmac_f32 v173, v182, v182
  v_fmac_f32 v174, v183, v183
  v_mfma_f32_16x16x32_bf16 v[108:111], v[136:139], a[240:243], v[108:111]
  v_add_f32 v173, v173, v174
  v_cvt_pk_bf16_f32 v172, 0, v172
  s_nop 0
  v_add_f32_dpp v173, v173, v173 row_ror:8 row_mask:0xf bank_mask:0xf
  v_mfma_f32_16x16x32_bf16 v[112:115], v[136:139], a[244:247], v[112:115]
  v_sub_f32 v176, v232, v172
  v_sub_f32 v177, v233, v172
  v_add_f32_dpp v173, v173, v173 row_ror:4 row_mask:0xf bank_mask:0xf
  v_mfma_f32_16x16x32_bf16 v[116:119], v[136:139], a[248:251], v[116:119]
  v_sub_f32 v178, v234, v172
  v_sub_f32 v179, v235, v172
  v_add_f32_dpp v173, v173, v173 row_ror:2 row_mask:0xf bank_mask:0xf
  v_mfma_f32_16x16x32_bf16 v[120:123], v[136:139], a[252:255], v[120:123]
  v_sub_f32 v180, v236, v172
  v_sub_f32 v181, v237, v172
  v_add_f32_dpp v173, v173, v173 row_ror:1 row_mask:0xf bank_mask:0xf
  v_sub_f32 v182, v238, v172
  v_sub_f32 v183, v239, v172
  v_mov_b32 v174, v173
  v_cvt_pk_bf16_f32 v176, 0, v176
  v_cvt_pk_bf16_f32 v177, 0, v177
  v_permlane16_swap_b32 v173, v174
  v_cvt_pk_bf16_f32 v178, 0, v178
  v_cvt_pk_bf16_f32 v179, 0, v179
  v_add_f32 v173, v173, v174
  v_cvt_pk_bf16_f32 v180, 0, v180
  v_cvt_pk_bf16_f32 v181, 0, v181
  v_mov_b32 v174, v173
  v_cvt_pk_bf16_f32 v182, 0, v182
  v_cvt_pk_bf16_f32 v183, 0, v183
  v_permlane32_swap_b32 v173, v174
  v_add_f32 v173, v173, v174
  v_mul_f32 v173, 0x3b000000, v173
  v_cvt_pk_bf16_f32 v173, 0, v173
  v_add_f32 v173, 0x3727c5ac, v173
  v_cvt_pk_bf16_f32 v173, 0, v173
  v_sqrt_f32 v173, v173
  s_nop 0
  v_cvt_pk_bf16_f32 v173, 0, v173
  v_rcp_f32 v173, v173
  s_nop 0
  v_mul_f32 v176, v176, v173
  v_mul_f32 v177, v177, v173
  v_mul_f32 v178, v178, v173
  v_mul_f32 v179, v179, v173
  v_mul_f32 v180, v180, v173
  v_mul_f32 v181, v181, v173
  v_mul_f32 v182, v182, v173
  v_mul_f32 v183, v183, v173
  v_cvt_pk_bf16_f32 v168, v176, v177
  v_cvt_pk_bf16_f32 v169, v178, v179
  v_cvt_pk_bf16_f32 v170, v180, v181
  v_cvt_pk_bf16_f32 v171, v182, v183
  buffer_store_dwordx4 v[168:171], v0, s[4:7], s93 offen sc1
  v_cvt_pk_bf16_f32 v224, 0, v224
  v_ashrrev_i32 v225, 31, v224
  v_or_b32 v225, 0x80000000, v225
  v_xor_b32 v224, v224, v225
  s_sub_u32 s92, 4095, s90
  v_and_b32 v224, 0xffff0000, v224
  v_or_b32 v224, s92, v224
  s_bfe_u32 s92, s65, 196619
  s_lshl_b32 s92, s92, 13
  s_lshl_b32 s93, s90, 2
  s_add_u32 s92, s92, s93
  s_add_u32 s92, s92, 5242880
  v_cvt_pk_bf16_f32 v140, v92, v96
  v_cvt_pk_bf16_f32 v141, v100, v104
  v_cvt_pk_bf16_f32 v142, v108, v112
  v_cvt_pk_bf16_f32 v143, v116, v120
  s_add_u32 s26, s86, 262144
  buffer_store_dwordx4 v[140:143], v4, s[4:7], s26 offen
  v_cvt_pk_bf16_f32 v144, v93, v97
  v_cvt_pk_bf16_f32 v145, v101, v105
  v_cvt_pk_bf16_f32 v146, v109, v113
  v_cvt_pk_bf16_f32 v147, v117, v121
  s_add_u32 s26, s86, 278528
  buffer_store_dwordx4 v[144:147], v4, s[4:7], s26 offen
  v_cvt_pk_bf16_f32 v148, v94, v98
  v_cvt_pk_bf16_f32 v149, v102, v106
  v_cvt_pk_bf16_f32 v150, v110, v114
  v_cvt_pk_bf16_f32 v151, v118, v122
  s_add_u32 s26, s86, 294912
  buffer_store_dwordx4 v[148:151], v4, s[4:7], s26 offen
  v_cvt_pk_bf16_f32 v152, v95, v99
  v_cvt_pk_bf16_f32 v153, v103, v107
  v_cvt_pk_bf16_f32 v154, v111, v115
  v_cvt_pk_bf16_f32 v155, v119, v123
  s_add_u32 s26, s86, 311296
  buffer_store_dwordx4 v[152:155], v4, s[4:7], s26 offen
  s_waitcnt vmcnt(4)
  s_mov_b64 exec, 1
  buffer_store_dword v224, off, s[4:7], s92 sc1
  s_mov_b64 exec, -1
  s_branch o_we_100
o_wr2_99:
  ds_read_b128 v[56:59], v54
  ds_read_b128 v[124:127], v48 offset:0
  ds_read_b128 v[128:131], v48 offset:1024
  ds_read_b128 v[132:135], v48 offset:2048
  s_lshl_b32 s90, s61, 1
  s_add_u32 s90, s90, s17
  s_and_b32 s94, s95, 1
  s_lshl_b32 s94, s94, 5
  s_add_u32 s94, s94, s90
  s_lshl_b32 s94, s94, 14
  s_lshl_b32 s92, s60, 21
  s_add_u32 s94, s94, s92
  s_add_u32 s94, s94, 12582912
  buffer_load_dwordx4 v[156:159], v5, s[4:7], s94 offen offset:0 sc1
  buffer_load_dwordx4 v[160:163], v5, s[4:7], s94 offen offset:256 sc1
  buffer_load_dwordx4 v[164:167], v5, s[4:7], s94 offen offset:512 sc1
  buffer_load_dwordx4 v[168:171], v5, s[4:7], s94 offen offset:768 sc1
  s_add_u32 s94, s94, 4096
  buffer_load_dwordx4 v[172:175], v5, s[4:7], s94 offen offset:0 sc1
  buffer_load_dwordx4 v[176:179], v5, s[4:7], s94 offen offset:256 sc1
  buffer_load_dwordx4 v[180:183], v5, s[4:7], s94 offen offset:512 sc1
  buffer_load_dwordx4 v[184:187], v5, s[4:7], s94 offen offset:768 sc1
  s_add_u32 s94, s94, 4096
  buffer_load_dwordx4 v[188:191], v5, s[4:7], s94 offen offset:0 sc1
  buffer_load_dwordx4 v[192:195], v5, s[4:7], s94 offen offset:256 sc1
  buffer_load_dwordx4 v[196:199], v5, s[4:7], s94 offen offset:512 sc1
  buffer_load_dwordx4 v[200:203], v5, s[4:7], s94 offen offset:768 sc1
  s_add_u32 s94, s94, 4096
  buffer_load_dwordx4 v[204:207], v5, s[4:7], s94 offen offset:0 sc1
  buffer_load_dwordx4 v[208:211], v5, s[4:7], s94 offen offset:256 sc1
  buffer_load_dwordx4 v[212:215], v5, s[4:7], s94 offen offset:512 sc1
  buffer_load_dwordx4 v[216:219], v5, s[4:7], s94 offen offset:768 sc1
  s_lshr_b32 s92, s65, 16
  s_xor_b32 s93, s90, 32
  s_and_b32 s91, s65, 63
  s_lshl_b32 s94, s91, 11
  s_lshl_b32 s91, s91, 5
  s_add_u32 s90, s90, s91
  s_lshl_b32 s91, s90, 10
  s_add_u32 s94, s94, 26214400
  s_cmp_eq_u32 s92, s93
  s_cselect_b32 s92, s94, s91
  s_add_u32 s92, s92, 10485760
  buffer_load_dwordx4 v[220:223], v0, s[4:7], s92 offen sc1
  s_waitcnt lgkmcnt(2)
  v_mfma_f32_16x16x32_bf16 v[60:63], v[124:127], a[0:3], 0
  v_mfma_f32_16x16x32_bf16 v[64:67], v[124:127], a[4:7], 0
  ds_read_b128 v[136:139], v48 offset:3072
  v_mfma_f32_16x16x32_bf16 v[68:71], v[124:127], a[8:11], 0
  v_mfma_f32_16x16x32_bf16 v[72:75], v[124:127], a[12:15], 0
  v_and_b32 v56, v56, v57
  v_and_b32 v58, v58, v59
  v_mfma_f32_16x16x32_bf16 v[76:79], v[124:127], a[16:19], 0
  v_mfma_f32_16x16x32_bf16 v[80:83], v[124:127], a[20:23], 0
  v_and_b32 v56, v56, v58
  s_bfe_u32 s26, s64, 131086
  v_readfirstlane_b32 s27, v56
  v_mfma_f32_16x16x32_bf16 v[84:87], v[124:127], a[24:27], 0
  v_mfma_f32_16x16x32_bf16 v[88:91], v[124:127], a[28:31], 0
  s_cmp_eq_u32 s26, 1
  s_cselect_b32 s66, s27, 0
  s_and_b32 s66, s66, 1
  s_cselect_b32 s87, 0, 268435456
  s_cmp_lg_u32 s26, 0
  s_cselect_b32 s76, s27, 0
  s_and_b32 s76, s76, 2
  s_cselect_b32 s88, 0, 268435456
  s_waitcnt lgkmcnt(2)
  v_mfma_f32_16x16x32_bf16 v[60:63], v[128:131], a[32:35], v[60:63]
  v_mfma_f32_16x16x32_bf16 v[64:67], v[128:131], a[36:39], v[64:67]
  ds_read_b128 v[124:127], v48 offset:8192
  v_mfma_f32_16x16x32_bf16 v[68:71], v[128:131], a[40:43], v[68:71]
  v_mfma_f32_16x16x32_bf16 v[72:75], v[128:131], a[44:47], v[72:75]
  s_waitcnt vmcnt(16)
  v_mfma_f32_16x16x32_bf16 v[224:227], v[16:19], v[156:159], 0
  v_mfma_f32_16x16x32_bf16 v[76:79], v[128:131], a[48:51], v[76:79]
  s_waitcnt vmcnt(15)
  v_mfma_f32_16x16x32_bf16 v[228:231], v[16:19], v[160:163], 0
  v_mfma_f32_16x16x32_bf16 v[80:83], v[128:131], a[52:55], v[80:83]
  s_waitcnt vmcnt(14)
  v_mfma_f32_16x16x32_bf16 v[224:227], v[20:23], v[164:167], v[224:227]
  v_mfma_f32_16x16x32_bf16 v[84:87], v[128:131], a[56:59], v[84:87]
  s_waitcnt vmcnt(13)
  v_mfma_f32_16x16x32_bf16 v[228:231], v[20:23], v[168:171], v[228:231]
  v_mfma_f32_16x16x32_bf16 v[88:91], v[128:131], a[60:63], v[88:91]
  s_waitcnt vmcnt(12)
  v_mfma_f32_16x16x32_bf16 v[224:227], v[16:19], v[172:175], v[224:227]
  s_waitcnt lgkmcnt(2)
  v_mfma_f32_16x16x32_bf16 v[60:63], v[132:135], a[64:67], v[60:63]
  s_waitcnt vmcnt(11)
  v_mfma_f32_16x16x32_bf16 v[228:231], v[16:19], v[176:179], v[228:231]
  v_mfma_f32_16x16x32_bf16 v[64:67], v[132:135], a[68:71], v[64:67]
  ds_read_b128 v[128:131], v48 offset:9216
  v_mfma_f32_16x16x32_bf16 v[68:71], v[132:135], a[72:75], v[68:71]
  s_waitcnt vmcnt(10)
  v_mfma_f32_16x16x32_bf16 v[224:227], v[20:23], v[180:183], v[224:227]
  v_mfma_f32_16x16x32_bf16 v[72:75], v[132:135], a[76:79], v[72:75]
  s_waitcnt vmcnt(9)
  v_mfma_f32_16x16x32_bf16 v[228:231], v[20:23], v[184:187], v[228:231]
  v_mfma_f32_16x16x32_bf16 v[76:79], v[132:135], a[80:83], v[76:79]
  s_waitcnt vmcnt(8)
  v_mfma_f32_16x16x32_bf16 v[224:227], v[16:19], v[188:191], v[224:227]
  v_mfma_f32_16x16x32_bf16 v[80:83], v[132:135], a[84:87], v[80:83]
  s_waitcnt vmcnt(7)
  v_mfma_f32_16x16x32_bf16 v[228:231], v[16:19], v[192:195], v[228:231]
  v_mfma_f32_16x16x32_bf16 v[84:87], v[132:135], a[88:91], v[84:87]
  s_waitcnt vmcnt(6)
  v_mfma_f32_16x16x32_bf16 v[224:227], v[20:23], v[196:199], v[224:227]
  v_mfma_f32_16x16x32_bf16 v[88:91], v[132:135], a[92:95], v[88:91]
  s_waitcnt vmcnt(5)
  v_mfma_f32_16x16x32_bf16 v[228:231], v[20:23], v[200:203], v[228:231]
  s_waitcnt lgkmcnt(2)
  v_mfma_f32_16x16x32_bf16 v[60:63], v[136:139], a[96:99], v[60:63]
  s_waitcnt vmcnt(4)
  v_mfma_f32_16x16x32_bf16 v[224:227], v[16:19], v[204:207], v[224:227]
  v_mfma_f32_16x16x32_bf16 v[64:67], v[136:139], a[100:103], v[64:67]
  ds_read_b128 v[132:135], v48 offset:10240
  v_mfma_f32_16x16x32_bf16 v[68:71], v[136:139], a[104:107], v[68:71]
  s_waitcnt vmcnt(3)
  v_mfma_f32_16x16x32_bf16 v[228:231], v[16:19], v[208:211], v[228:231]
  v_mfma_f32_16x16x32_bf16 v[72:75], v[136:139], a[108:111], v[72:75]
  s_and_b32 s32, s64, 0xff
  s_lshl_b32 s32, s32, 4
  s_add_u32 s32, s32, s61
  s_lshl_b32 s32, s32, 2
  s_add_u32 s32, s32, s17
  s_lshl_b32 s33, s32, 12
  v_mfma_f32_16x16x32_bf16 v[76:79], v[136:139], a[112:115], v[76:79]
  s_waitcnt vmcnt(2)
  v_mfma_f32_16x16x32_bf16 v[224:227], v[20:23], v[212:215], v[224:227]
  v_mfma_f32_16x16x32_bf16 v[80:83], v[136:139], a[116:119], v[80:83]
  s_add_u32 s33, s33, 142606336
  s_lshl_b32 s32, s32, 13
  s_add_u32 s32, s32, 41943040
  s_add_u32 s32, s32, s87
  s_add_u32 s33, s33, s87
  s_xor_b32 s34, s84, 114688
  v_mfma_f32_16x16x32_bf16 v[84:87], v[136:139], a[120:123], v[84:87]
  s_waitcnt vmcnt(1)
  v_mfma_f32_16x16x32_bf16 v[228:231], v[20:23], v[216:219], v[228:231]
  v_mfma_f32_16x16x32_bf16 v[88:91], v[136:139], a[124:127], v[88:91]
  s_lshl_b32 s35, s17, 12
  s_add_u32 s34, s34, s35
  s_add_u32 m0, s34, 32768
  s_add_u32 s34, s34, s35
  buffer_load_dwordx4 v0, s[4:7], s33 offen offset:0 sc1 lds
  s_waitcnt lgkmcnt(2)
  v_mfma_f32_16x16x32_bf16 v[60:63], v[124:127], a[128:131], v[60:63]
  s_bfe_u32 s92, s65, 131080
  s_lshl_b32 s92, s92, 21
  s_add_u32 s92, s92, s91
  s_add_u32 s93, s92, 27262976
  s_add_u32 s92, s92, 20971520
  s_waitcnt vmcnt(1)
  v_mfma_f32_16x16x32_bf16 v[64:67], v[124:127], a[132:135], v[64:67]
  ds_read_b128 v[136:139], v48 offset:11264
  v_mfma_f32_16x16x32_bf16 v[68:71], v[124:127], a[136:139], v[68:71]
  v_lshlrev_b32 v232, 16, v220
  v_and_b32 v233, 0xffff0000, v220
  v_mfma_f32_16x16x32_bf16 v[72:75], v[124:127], a[140:143], v[72:75]
  buffer_load_dwordx4 v0, s[4:7], s33 offen offset:1024 sc1 lds
  v_mfma_f32_16x16x32_bf16 v[76:79], v[124:127], a[144:147], v[76:79]
  v_lshlrev_b32 v234, 16, v221
  v_and_b32 v235, 0xffff0000, v221
  v_mfma_f32_16x16x32_bf16 v[80:83], v[124:127], a[148:151], v[80:83]
  buffer_load_dwordx4 v0, s[4:7], s33 offen offset:2048 sc1 lds
  v_mfma_f32_16x16x32_bf16 v[84:87], v[124:127], a[152:155], v[84:87]
  v_lshlrev_b32 v236, 16, v222
  v_and_b32 v237, 0xffff0000, v222
  v_mfma_f32_16x16x32_bf16 v[88:91], v[124:127], a[156:159], v[88:91]
  buffer_load_dwordx4 v0, s[4:7], s33 offen offset:3072 sc1 lds
  s_waitcnt lgkmcnt(2)
  v_mfma_f32_16x16x32_bf16 v[60:63], v[128:131], a[160:163], v[60:63]
  v_lshlrev_b32 v238, 16, v223
  v_and_b32 v239, 0xffff0000, v223
  v_mfma_f32_16x16x32_bf16 v[64:67], v[128:131], a[164:167], v[64:67]
  ds_read_b128 v[124:127], v48 offset:4096
  v_mfma_f32_16x16x32_bf16 v[68:71], v[128:131], a[168:171], v[68:71]
  v_permlane16_swap_b32 v224, v228
  v_permlane16_swap_b32 v225, v229
  v_mfma_f32_16x16x32_bf16 v[72:75], v[128:131], a[172:175], v[72:75]
  s_add_u32 m0, s34, 0
  s_nop 0
  buffer_load_dwordx4 v0, s[4:7], s32 offen offset:0 sc1 lds
  v_mfma_f32_16x16x32_bf16 v[76:79], v[128:131], a[176:179], v[76:79]
  v_permlane16_swap_b32 v226, v230
  v_permlane16_swap_b32 v227, v231
  v_mfma_f32_16x16x32_bf16 v[80:83], v[128:131], a[180:183], v[80:83]
  buffer_load_dwordx4 v0, s[4:7], s32 offen offset:1024 sc1 lds
  v_mfma_f32_16x16x32_bf16 v[84:87], v[128:131], a[184:187], v[84:87]
  v_cvt_pk_bf16_f32 v224, 0, v224
  v_cvt_pk_bf16_f32 v225, 0, v225
  v_mfma_f32_16x16x32_bf16 v[88:91], v[128:131], a[188:191], v[88:91]
  buffer_load_dwordx4 v0, s[4:7], s32 offen offset:2048 sc1 lds
  s_waitcnt lgkmcnt(2)
  v_mfma_f32_16x16x32_bf16 v[60:63], v[132:135], a[192:195], v[60:63]
  v_cvt_pk_bf16_f32 v226, 0, v226
  v_cvt_pk_bf16_f32 v227, 0, v227
  v_mfma_f32_16x16x32_bf16 v[64:67], v[132:135], a[196:199], v[64:67]
  ds_read_b128 v[128:131], v48 offset:5120
  v_mfma_f32_16x16x32_bf16 v[68:71], v[132:135], a[200:203], v[68:71]
  v_cvt_pk_bf16_f32 v228, 0, v228
  v_cvt_pk_bf16_f32 v229, 0, v229
  v_mfma_f32_16x16x32_bf16 v[72:75], v[132:135], a[204:207], v[72:75]
  buffer_load_dwordx4 v0, s[4:7], s32 offen offset:3072 sc1 lds
  v_mfma_f32_16x16x32_bf16 v[76:79], v[132:135], a[208:211], v[76:79]
  v_cvt_pk_bf16_f32 v230, 0, v230
  v_cvt_pk_bf16_f32 v231, 0, v231
  v_mfma_f32_16x16x32_bf16 v[80:83], v[132:135], a[212:215], v[80:83]
  s_add_u32 m0, s34, 4096
  s_add_u32 s32, s32, 4096
  buffer_load_dwordx4 v0, s[4:7], s32 offen offset:0 sc1 lds
  v_mfma_f32_16x16x32_bf16 v[84:87], v[132:135], a[216:219], v[84:87]
  v_add_f32 v232, v232, v224
  v_add_f32 v233, v233, v225
  v_mfma_f32_16x16x32_bf16 v[88:91], v[132:135], a[220:223], v[88:91]
  buffer_load_dwordx4 v0, s[4:7], s32 offen offset:1024 sc1 lds
  s_waitcnt lgkmcnt(2)
  v_mfma_f32_16x16x32_bf16 v[60:63], v[136:139], a[224:227], v[60:63]
  v_add_f32 v234, v234, v226
  v_add_f32 v235, v235, v227
  v_mfma_f32_16x16x32_bf16 v[64:67], v[136:139], a[228:231], v[64:67]
  ds_read_b128 v[132:135], v48 offset:6144
  v_mfma_f32_16x16x32_bf16 v[68:71], v[136:139], a[232:235], v[68:71]
  v_add_f32 v236, v236, v228
  v_add_f32 v237, v237, v229
  v_mfma_f32_16x16x32_bf16 v[72:75], v[136:139], a[236:239], v[72:75]
  buffer_load_dwordx4 v0, s[4:7], s32 offen offset:2048 sc1 lds
  v_mfma_f32_16x16x32_bf16 v[76:79], v[136:139], a[240:243], v[76:79]
  v_add_f32 v238, v238, v230
  v_add_f32 v239, v239, v231
  v_mfma_f32_16x16x32_bf16 v[80:83], v[136:139], a[244:247], v[80:83]
  buffer_load_dwordx4 v0, s[4:7], s32 offen offset:3072 sc1 lds
  v_mfma_f32_16x16x32_bf16 v[84:87], v[136:139], a[248:251], v[84:87]
  v_cvt_pk_bf16_f32 v156, v232, v233
  v_cvt_pk_bf16_f32 v157, v234, v235
  v_mfma_f32_16x16x32_bf16 v[88:91], v[136:139], a[252:255], v[88:91]
  s_and_b32 s32, s64, 63
  s_lshl_b32 s32, s32, 5
  s_add_u32 s32, s32, s85
  s_bfe_u32 s33, s64, 131080
  s_lshl_b32 s33, s33, 11
  s_add_u32 s32, s32, s33
  s_waitcnt lgkmcnt(2)
  v_mfma_f32_16x16x32_bf16 v[92:95], v[124:127], a[0:3], 0
  v_cvt_pk_bf16_f32 v158, v236, v237
  v_cvt_pk_bf16_f32 v159, v238, v239
  v_mfma_f32_16x16x32_bf16 v[96:99], v[124:127], a[4:7], 0
  ds_read_b128 v[136:139], v48 offset:7168
  v_mfma_f32_16x16x32_bf16 v[100:103], v[124:127], a[8:11], 0
  v_lshlrev_b32 v232, 16, v156
  v_and_b32 v233, 0xffff0000, v156
  v_mfma_f32_16x16x32_bf16 v[104:107], v[124:127], a[12:15], 0
  s_lshl_b32 s32, s32, 13
  s_add_u32 s32, s32, 192937984
  s_add_u32 s32, s32, s88
  s_add_u32 s33, s32, 4096
  buffer_load_dwordx4 v[24:27], v0, s[4:7], s32 offen offset:0 sc1
  v_mfma_f32_16x16x32_bf16 v[108:111], v[124:127], a[16:19], 0
  v_lshlrev_b32 v234, 16, v157
  v_and_b32 v235, 0xffff0000, v157
  v_mfma_f32_16x16x32_bf16 v[112:115], v[124:127], a[20:23], 0
  buffer_load_dwordx4 v[28:31], v0, s[4:7], s32 offen offset:2048 sc1
  v_mfma_f32_16x16x32_bf16 v[116:119], v[124:127], a[24:27], 0
  v_lshlrev_b32 v236, 16, v158
  v_and_b32 v237, 0xffff0000, v158
  v_mfma_f32_16x16x32_bf16 v[120:123], v[124:127], a[28:31], 0
  buffer_load_dwordx4 v[32:35], v0, s[4:7], s33 offen offset:0 sc1
  s_waitcnt lgkmcnt(2)
  v_mfma_f32_16x16x32_bf16 v[92:95], v[128:131], a[32:35], v[92:95]
  v_lshlrev_b32 v238, 16, v159
  v_and_b32 v239, 0xffff0000, v159
  v_mfma_f32_16x16x32_bf16 v[96:99], v[128:131], a[36:39], v[96:99]
  ds_read_b128 v[124:127], v48 offset:12288
  v_mfma_f32_16x16x32_bf16 v[100:103], v[128:131], a[40:43], v[100:103]
  buffer_store_dwordx4 v[156:159], v0, s[4:7], s92 offen sc1
  v_mfma_f32_16x16x32_bf16 v[104:107], v[128:131], a[44:47], v[104:107]
  buffer_load_dwordx4 v[36:39], v0, s[4:7], s33 offen offset:2048 sc1
  v_mfma_f32_16x16x32_bf16 v[108:111], v[128:131], a[48:51], v[108:111]
  v_add_f32 v172, v232, v233
  v_add_f32 v173, v234, v235
  v_mfma_f32_16x16x32_bf16 v[112:115], v[128:131], a[52:55], v[112:115]
  buffer_load_dwordx2 v[40:41], v1, s[4:7], s32 offen offset:1024 sc1
  v_mfma_f32_16x16x32_bf16 v[116:119], v[128:131], a[56:59], v[116:119]
  v_add_f32 v174, v236, v237
  v_add_f32 v175, v238, v239
  v_mfma_f32_16x16x32_bf16 v[120:123], v[128:131], a[60:63], v[120:123]
  buffer_load_dwordx2 v[42:43], v1, s[4:7], s32 offen offset:3072 sc1
  s_waitcnt lgkmcnt(2)
  v_mfma_f32_16x16x32_bf16 v[92:95], v[132:135], a[64:67], v[92:95]
  v_add_f32 v172, v172, v173
  v_add_f32 v174, v174, v175
  v_mfma_f32_16x16x32_bf16 v[96:99], v[132:135], a[68:71], v[96:99]
  ds_read_b128 v[128:131], v48 offset:13312
  v_mfma_f32_16x16x32_bf16 v[100:103], v[132:135], a[72:75], v[100:103]
  v_add_f32 v172, v172, v174
  s_nop 1
  v_add_f32_dpp v172, v172, v172 row_ror:8 row_mask:0xf bank_mask:0xf
  v_mfma_f32_16x16x32_bf16 v[104:107], v[132:135], a[76:79], v[104:107]
  buffer_load_dwordx2 v[44:45], v1, s[4:7], s33 offen offset:1024 sc1
  v_mfma_f32_16x16x32_bf16 v[108:111], v[132:135], a[80:83], v[108:111]
  v_add_f32_dpp v172, v172, v172 row_ror:4 row_mask:0xf bank_mask:0xf
  s_nop 1
  v_add_f32_dpp v172, v172, v172 row_ror:2 row_mask:0xf bank_mask:0xf
  v_mfma_f32_16x16x32_bf16 v[112:115], v[132:135], a[84:87], v[112:115]
  buffer_load_dwordx2 v[46:47], v1, s[4:7], s33 offen offset:3072 sc1
  v_mfma_f32_16x16x32_bf16 v[116:119], v[132:135], a[88:91], v[116:119]
  v_add_f32_dpp v172, v172, v172 row_ror:1 row_mask:0xf bank_mask:0xf
  v_mov_b32 v174, v172
  v_mfma_f32_16x16x32_bf16 v[120:123], v[132:135], a[92:95], v[120:123]
  v_cvt_pk_bf16_f32 v140, v60, v64
  v_cvt_pk_bf16_f32 v141, v68, v72
  s_waitcnt lgkmcnt(2)
  v_mfma_f32_16x16x32_bf16 v[92:95], v[136:139], a[96:99], v[92:95]
  v_permlane16_swap_b32 v172, v174
  v_add_f32 v172, v172, v174
  v_mfma_f32_16x16x32_bf16 v[96:99], v[136:139], a[100:103], v[96:99]
  ds_read_b128 v[132:135], v48 offset:14336
  v_mfma_f32_16x16x32_bf16 v[100:103], v[136:139], a[104:107], v[100:103]
  v_mov_b32 v174, v172
  s_nop 1
  v_permlane32_swap_b32 v172, v174
  v_mfma_f32_16x16x32_bf16 v[104:107], v[136:139], a[108:111], v[104:107]
  v_cvt_pk_bf16_f32 v142, v76, v80
  v_cvt_pk_bf16_f32 v143, v84, v88
  v_mfma_f32_16x16x32_bf16 v[108:111], v[136:139], a[112:115], v[108:111]
  v_add_f32 v172, v172, v174
  v_mul_f32 v172, 0x3b000000, v172
  v_mfma_f32_16x16x32_bf16 v[112:115], v[136:139], a[116:119], v[112:115]
  s_add_u32 s26, s86, 0
  buffer_store_dwordx4 v[140:143], v4, s[4:7], s26 offen
  v_mfma_f32_16x16x32_bf16 v[116:119], v[136:139], a[120:123], v[116:119]
  v_sub_f32 v176, v232, v172
  v_sub_f32 v177, v233, v172
  v_mfma_f32_16x16x32_bf16 v[120:123], v[136:139], a[124:127], v[120:123]
  v_cvt_pk_bf16_f32 v144, v61, v65
  v_cvt_pk_bf16_f32 v145, v69, v73
  s_waitcnt lgkmcnt(2)
  v_mfma_f32_16x16x32_bf16 v[92:95], v[124:127], a[128:131], v[92:95]
  v_sub_f32 v178, v234, v172
  v_sub_f32 v179, v235, v172
  v_mfma_f32_16x16x32_bf16 v[96:99], v[124:127], a[132:135], v[96:99]
  ds_read_b128 v[136:139], v48 offset:15360
  v_mfma_f32_16x16x32_bf16 v[100:103], v[124:127], a[136:139], v[100:103]
  v_sub_f32 v180, v236, v172
  v_sub_f32 v181, v237, v172
  v_mfma_f32_16x16x32_bf16 v[104:107], v[124:127], a[140:143], v[104:107]
  v_cvt_pk_bf16_f32 v146, v77, v81
  v_cvt_pk_bf16_f32 v147, v85, v89
  v_mfma_f32_16x16x32_bf16 v[108:111], v[124:127], a[144:147], v[108:111]
  v_sub_f32 v182, v238, v172
  v_sub_f32 v183, v239, v172
  v_mfma_f32_16x16x32_bf16 v[112:115], v[124:127], a[148:151], v[112:115]
  s_add_u32 s26, s86, 16384
  buffer_store_dwordx4 v[144:147], v4, s[4:7], s26 offen
  v_mfma_f32_16x16x32_bf16 v[116:119], v[124:127], a[152:155], v[116:119]
  v_mul_f32 v173, v176, v176
  v_mul_f32 v174, v177, v177
  v_mfma_f32_16x16x32_bf16 v[120:123], v[124:127], a[156:159], v[120:123]
  v_cvt_pk_bf16_f32 v148, v62, v66
  v_cvt_pk_bf16_f32 v149, v70, v74
  s_waitcnt lgkmcnt(2)
  v_mfma_f32_16x16x32_bf16 v[92:95], v[128:131], a[160:163], v[92:95]
  v_fmac_f32 v173, v178, v178
  v_fmac_f32 v174, v179, v179
  v_mfma_f32_16x16x32_bf16 v[96:99], v[128:131], a[164:167], v[96:99]
  v_cvt_pk_bf16_f32 v150, v78, v82
  v_cvt_pk_bf16_f32 v151, v86, v90
  v_mfma_f32_16x16x32_bf16 v[100:103], v[128:131], a[168:171], v[100:103]
  v_fmac_f32 v173, v180, v180
  v_fmac_f32 v174, v181, v181
  v_mfma_f32_16x16x32_bf16 v[104:107], v[128:131], a[172:175], v[104:107]
  s_add_u32 s26, s86, 32768
  buffer_store_dwordx4 v[148:151], v4, s[4:7], s26 offen
  v_mfma_f32_16x16x32_bf16 v[108:111], v[128:131], a[176:179], v[108:111]
  v_fmac_f32 v173, v182, v182
  v_fmac_f32 v174, v183, v183
  v_mfma_f32_16x16x32_bf16 v[112:115], v[128:131], a[180:183], v[112:115]
  v_cvt_pk_bf16_f32 v152, v63, v67
  v_cvt_pk_bf16_f32 v153, v71, v75
  v_mfma_f32_16x16x32_bf16 v[116:119], v[128:131], a[184:187], v[116:119]
  v_add_f32 v173, v173, v174
  v_cvt_pk_bf16_f32 v172, 0, v172
  v_mfma_f32_16x16x32_bf16 v[120:123], v[128:131], a[188:191], v[120:123]
  v_cvt_pk_bf16_f32 v154, v79, v83
  v_cvt_pk_bf16_f32 v155, v87, v91
  s_waitcnt lgkmcnt(1)
  v_mfma_f32_16x16x32_bf16 v[92:95], v[132:135], a[192:195], v[92:95]
  v_add_f32_dpp v173, v173, v173 row_ror:8 row_mask:0xf bank_mask:0xf
  v_sub_f32 v176, v232, v172
  v_mfma_f32_16x16x32_bf16 v[96:99], v[132:135], a[196:199], v[96:99]
  s_add_u32 s26, s86, 49152
  buffer_store_dwordx4 v[152:155], v4, s[4:7], s26 offen
  v_mfma_f32_16x16x32_bf16 v[100:103], v[132:135], a[200:203], v[100:103]
  v_sub_f32 v177, v233, v172
  v_add_f32_dpp v173, v173, v173 row_ror:4 row_mask:0xf bank_mask:0xf
  v_mfma_f32_16x16x32_bf16 v[104:107], v[132:135], a[204:207], v[104:107]
  v_sub_f32 v178, v234, v172
  v_sub_f32 v179, v235, v172
  v_mfma_f32_16x16x32_bf16 v[108:111], v[132:135], a[208:211], v[108:111]
  v_add_f32_dpp v173, v173, v173 row_ror:2 row_mask:0xf bank_mask:0xf
  v_sub_f32 v180, v236, v172
  v_mfma_f32_16x16x32_bf16 v[112:115], v[132:135], a[212:215], v[112:115]
  v_sub_f32 v181, v237, v172
  v_add_f32_dpp v173, v173, v173 row_ror:1 row_mask:0xf bank_mask:0xf
  v_mfma_f32_16x16x32_bf16 v[116:119], v[132:135], a[216:219], v[116:119]
  v_sub_f32 v182, v238, v172
  v_sub_f32 v183, v239, v172
  v_mfma_f32_16x16x32_bf16 v[120:123], v[132:135], a[220:223], v[120:123]
  v_mov_b32 v174, v173
  v_cvt_pk_bf16_f32 v176, 0, v176
  s_waitcnt lgkmcnt(0)
  v_mfma_f32_16x16x32_bf16 v[92:95], v[136:139], a[224:227], v[92:95]
  v_cvt_pk_bf16_f32 v177, 0, v177
  v_permlane16_swap_b32 v173, v174
  v_mfma_f32_16x16x32_bf16 v[96:99], v[136:139], a[228:231], v[96:99]
  v_cvt_pk_bf16_f32 v178, 0, v178
  v_cvt_pk_bf16_f32 v179, 0, v179
  v_mfma_f32_16x16x32_bf16 v[100:103], v[136:139], a[232:235], v[100:103]
  v_add_f32 v173, v173, v174
  v_cvt_pk_bf16_f32 v180, 0, v180
  v_mfma_f32_16x16x32_bf16 v[104:107], v[136:139], a[236:239], v[104:107]
  v_cvt_pk_bf16_f32 v181, 0, v181
  v_mov_b32 v174, v173
  v_mfma_f32_16x16x32_bf16 v[108:111], v[136:139], a[240:243], v[108:111]
  v_cvt_pk_bf16_f32 v182, 0, v182
  v_cvt_pk_bf16_f32 v183, 0, v183
  v_mfma_f32_16x16x32_bf16 v[112:115], v[136:139], a[244:247], v[112:115]
  v_permlane32_swap_b32 v173, v174
  v_add_f32 v173, v173, v174
  v_mfma_f32_16x16x32_bf16 v[116:119], v[136:139], a[248:251], v[116:119]
  v_mul_f32 v173, 0x3b000000, v173
  v_cvt_pk_bf16_f32 v173, 0, v173
  v_mfma_f32_16x16x32_bf16 v[120:123], v[136:139], a[252:255], v[120:123]
  v_add_f32 v173, 0x3727c5ac, v173
  v_cvt_pk_bf16_f32 v173, 0, v173
  v_sqrt_f32 v173, v173
  s_nop 0
  v_cvt_pk_bf16_f32 v173, 0, v173
  v_rcp_f32 v173, v173
  s_nop 0
  v_mul_f32 v176, v176, v173
  v_mul_f32 v177, v177, v173
  v_mul_f32 v178, v178, v173
  v_mul_f32 v179, v179, v173
  v_mul_f32 v180, v180, v173
  v_mul_f32 v181, v181, v173
  v_mul_f32 v182, v182, v173
  v_mul_f32 v183, v183, v173
  v_cvt_pk_bf16_f32 v160, v176, v177
  v_cvt_pk_bf16_f32 v161, v178, v179
  v_cvt_pk_bf16_f32 v162, v180, v181
  v_cvt_pk_bf16_f32 v163, v182, v183
  v_lshlrev_b32 v240, 16, v160
  v_and_b32 v241, 0xffff0000, v160
  v_lshlrev_b32 v242, 16, v161
  v_and_b32 v243, 0xffff0000, v161
  v_lshlrev_b32 v244, 16, v162
  v_and_b32 v245, 0xffff0000, v162
  v_lshlrev_b32 v246, 16, v163
  v_and_b32 v247, 0xffff0000, v163
  buffer_store_dwordx4 v[160:163], v0, s[4:7], s93 offen sc1
  v_add_f32 v232, v232, v240
  v_add_f32 v233, v233, v241
  v_add_f32 v234, v234, v242
  v_add_f32 v235, v235, v243
  v_add_f32 v236, v236, v244
  v_add_f32 v237, v237, v245
  v_add_f32 v238, v238, v246
  v_add_f32 v239, v239, v247
  v_cvt_pk_bf16_f32 v164, v232, v233
  v_cvt_pk_bf16_f32 v165, v234, v235
  v_cvt_pk_bf16_f32 v166, v236, v237
  v_cvt_pk_bf16_f32 v167, v238, v239
  v_mul_f32 v224, v240, v8
  v_mul_f32 v225, v241, v9
  v_fmac_f32 v224, v242, v10
  v_fmac_f32 v225, v243, v11
  v_fmac_f32 v224, v244, v12
  v_fmac_f32 v225, v245, v13
  v_fmac_f32 v224, v246, v14
  v_fmac_f32 v225, v247, v15
  v_add_f32 v224, v224, v225
  s_add_u32 s92, s91, 33554432
  s_bitcmp1_b32 s65, 10
  s_cselect_b64 s[80:81], s[68:69], s[4:5]
  s_cselect_b32 s82, s70, s6
  s_cselect_b32 s92, s91, s92
  buffer_store_dwordx4 v[164:167], v0, s[80:83], s92 offen sc1
  v_add_f32_dpp v224, v224, v224 row_ror:8 row_mask:0xf bank_mask:0xf
  s_nop 1
  v_add_f32_dpp v224, v224, v224 row_ror:4 row_mask:0xf bank_mask:0xf
  s_nop 1
  v_add_f32_dpp v224, v224, v224 row_ror:2 row_mask:0xf bank_mask:0xf
  s_nop 1
  v_add_f32_dpp v224, v224, v224 row_ror:1 row_mask:0xf bank_mask:0xf
  v_mov_b32 v225, v224
  s_nop 0
  s_nop 0
  v_permlane16_swap_b32 v224, v225
  v_add_f32 v224, v224, v225
  v_mov_b32 v225, v224
  s_nop 0
  s_nop 0
  v_permlane32_swap_b32 v224, v225
  v_add_f32 v224, v224, v225
  v_cvt_pk_bf16_f32 v224, 0, v224
  v_ashrrev_i32 v225, 31, v224
  v_or_b32 v225, 0x80000000, v225
  v_xor_b32 v224, v224, v225
  s_sub_u32 s92, 4095, s90
  v_and_b32 v224, 0xffff0000, v224
  v_or_b32 v224, s92, v224
  s_bfe_u32 s92, s65, 196619
  s_lshl_b32 s92, s92, 13
  s_lshl_b32 s93, s90, 2
  s_add_u32 s92, s92, s93
  s_add_u32 s92, s92, 5242880
  v_cvt_pk_bf16_f32 v140, v92, v96
  v_cvt_pk_bf16_f32 v141, v100, v104
  v_cvt_pk_bf16_f32 v142, v108, v112
  v_cvt_pk_bf16_f32 v143, v116, v120
  s_add_u32 s26, s86, 262144
  buffer_store_dwordx4 v[140:143], v4, s[4:7], s26 offen
  v_cvt_pk_bf16_f32 v144, v93, v97
  v_cvt_pk_bf16_f32 v145, v101, v105
  v_cvt_pk_bf16_f32 v146, v109, v113
  v_cvt_pk_bf16_f32 v147, v117, v121
  s_add_u32 s26, s86, 278528
  buffer_store_dwordx4 v[144:147], v4, s[4:7], s26 offen
  v_cvt_pk_bf16_f32 v148, v94, v98
  v_cvt_pk_bf16_f32 v149, v102, v106
  v_cvt_pk_bf16_f32 v150, v110, v114
  v_cvt_pk_bf16_f32 v151, v118, v122
  s_add_u32 s26, s86, 294912
  buffer_store_dwordx4 v[148:151], v4, s[4:7], s26 offen
  v_cvt_pk_bf16_f32 v152, v95, v99
  v_cvt_pk_bf16_f32 v153, v103, v107
  v_cvt_pk_bf16_f32 v154, v111, v115
  v_cvt_pk_bf16_f32 v155, v119, v123
  s_add_u32 s26, s86, 311296
  buffer_store_dwordx4 v[152:155], v4, s[4:7], s26 offen
  s_waitcnt vmcnt(4)
  s_mov_b64 exec, 1
  buffer_store_dword v224, off, s[4:7], s92 sc1
  s_mov_b64 exec, -1
o_we_100:
  s_mov_b32 s65, s63
  s_lshl_b32 s79, s60, 6
  s_add_u32 s79, s79, s61
  s_lshl_b32 s79, s79, 2
  s_add_u32 s79, s79, s17
  s_lshl_b32 s79, s79, 2
  s_add_u32 s79, s79, 5283840
  s_cmp_eq_u32 s51, 0
  s_cbranch_scc1 o_fl_88
  s_cmp_lg_u32 s76, 0
  s_cbranch_scc1 o_nofl_87
o_fl_88:
  s_waitcnt vmcnt(0)
  v_mov_b32 v7, s62
  s_mov_b64 exec, 1
  buffer_store_dword v7, off, s[4:7], s79
  s_mov_b64 exec, -1
  s_mov_b32 s79, 268435456
  s_cmp_ge_u32 s17, 2
  s_cbranch_scc1 o_fd_101
  s_cmp_eq_u32 s65, 0
  s_cbranch_scc1 o_fd_101
  s_lshl_b32 s26, s60, 10
  s_add_u32 s26, s26, 5283840
  s_mov_b32 s67, 0
o_wob_103:
  buffer_load_dword v7, v2, s[4:7], s26 offen sc1
  s_add_u32 s67, s67, 1
  s_cmp_gt_u32 s67, 1048576
  s_cbranch_scc1 L_end
  s_waitcnt vmcnt(0)
  v_cmp_gt_u32 vcc, s62, v7
  s_cbranch_vccnz o_wob_103
  s_and_b32 s26, s65, 768
  s_cbranch_scc1 o_f2_102
  s_lshl_b32 s90, s61, 1
  s_add_u32 s90, s90, s17
  s_and_b32 s94, s62, 1
  s_lshl_b32 s94, s94, 5
  s_add_u32 s94, s94, s90
  s_lshl_b32 s94, s94, 14
  s_lshl_b32 s92, s60, 21
  s_add_u32 s94, s94, s92
  s_add_u32 s94, s94, 12582912
  buffer_load_dwordx4 v[156:159], v5, s[4:7], s94 offen offset:0 sc1
  buffer_load_dwordx4 v[160:163], v5, s[4:7], s94 offen offset:256 sc1
  buffer_load_dwordx4 v[164:167], v5, s[4:7], s94 offen offset:512 sc1
  buffer_load_dwordx4 v[168:171], v5, s[4:7], s94 offen offset:768 sc1
  s_add_u32 s94, s94, 4096
  buffer_load_dwordx4 v[172:175], v5, s[4:7], s94 offen offset:0 sc1
  buffer_load_dwordx4 v[176:179], v5, s[4:7], s94 offen offset:256 sc1
  buffer_load_dwordx4 v[180:183], v5, s[4:7], s94 offen offset:512 sc1
  buffer_load_dwordx4 v[184:187], v5, s[4:7], s94 offen offset:768 sc1
  s_add_u32 s94, s94, 4096
  buffer_load_dwordx4 v[188:191], v5, s[4:7], s94 offen offset:0 sc1
  buffer_load_dwordx4 v[192:195], v5, s[4:7], s94 offen offset:256 sc1
  buffer_load_dwordx4 v[196:199], v5, s[4:7], s94 offen offset:512 sc1
  buffer_load_dwordx4 v[200:203], v5, s[4:7], s94 offen offset:768 sc1
  s_add_u32 s94, s94, 4096
  buffer_load_dwordx4 v[204:207], v5, s[4:7], s94 offen offset:0 sc1
  buffer_load_dwordx4 v[208:211], v5, s[4:7], s94 offen offset:256 sc1
  buffer_load_dwordx4 v[212:215], v5, s[4:7], s94 offen offset:512 sc1
  buffer_load_dwordx4 v[216:219], v5, s[4:7], s94 offen offset:768 sc1
  s_and_b32 s91, s65, 63
  s_lshl_b32 s94, s91, 11
  s_lshl_b32 s91, s91, 5
  s_add_u32 s90, s90, s91
  s_lshl_b32 s91, s90, 10
  buffer_load_dwordx4 v[220:223], v0, s[72:75], s91 offen
  s_waitcnt vmcnt(16)
  v_mfma_f32_16x16x32_bf16 v[224:227], v[16:19], v[156:159], 0
  s_waitcnt vmcnt(15)
  v_mfma_f32_16x16x32_bf16 v[228:231], v[16:19], v[160:163], 0
  s_waitcnt vmcnt(14)
  v_mfma_f32_16x16x32_bf16 v[224:227], v[20:23], v[164:167], v[224:227]
  s_waitcnt vmcnt(13)
  v_mfma_f32_16x16x32_bf16 v[228:231], v[20:23], v[168:171], v[228:231]
  s_waitcnt vmcnt(12)
  v_mfma_f32_16x16x32_bf16 v[224:227], v[16:19], v[172:175], v[224:227]
  s_waitcnt vmcnt(11)
  v_mfma_f32_16x16x32_bf16 v[228:231], v[16:19], v[176:179], v[228:231]
  s_waitcnt vmcnt(10)
  v_mfma_f32_16x16x32_bf16 v[224:227], v[20:23], v[180:183], v[224:227]
  s_waitcnt vmcnt(9)
  v_mfma_f32_16x16x32_bf16 v[228:231], v[20:23], v[184:187], v[228:231]
  s_waitcnt vmcnt(8)
  v_mfma_f32_16x16x32_bf16 v[224:227], v[16:19], v[188:191], v[224:227]
  s_waitcnt vmcnt(7)
  v_mfma_f32_16x16x32_bf16 v[228:231], v[16:19], v[192:195], v[228:231]
  s_waitcnt vmcnt(6)
  v_mfma_f32_16x16x32_bf16 v[224:227], v[20:23], v[196:199], v[224:227]
  s_waitcnt vmcnt(5)
  v_mfma_f32_16x16x32_bf16 v[228:231], v[20:23], v[200:203], v[228:231]
  s_waitcnt vmcnt(4)
  v_mfma_f32_16x16x32_bf16 v[224:227], v[16:19], v[204:207], v[224:227]
  s_waitcnt vmcnt(3)
  v_mfma_f32_16x16x32_bf16 v[228:231], v[16:19], v[208:211], v[228:231]
  s_waitcnt vmcnt(2)
  v_mfma_f32_16x16x32_bf16 v[224:227], v[20:23], v[212:215], v[224:227]
  s_waitcnt vmcnt(1)
  v_mfma_f32_16x16x32_bf16 v[228:231], v[20:23], v[216:219], v[228:231]
  s_bfe_u32 s92, s65, 131080
  s_lshl_b32 s92, s92, 21
  s_add_u32 s92, s92, s91
  s_add_u32 s93, s92, 27262976
  s_add_u32 s92, s92, 20971520
  s_waitcnt vmcnt(0)
  v_lshlrev_b32 v232, 16, v220
  v_and_b32 v233, 0xffff0000, v220
  v_lshlrev_b32 v234, 16, v221
  v_and_b32 v235, 0xffff0000, v221
  v_lshlrev_b32 v236, 16, v222
  v_and_b32 v237, 0xffff0000, v222
  v_lshlrev_b32 v238, 16, v223
  v_and_b32 v239, 0xffff0000, v223
  v_permlane16_swap_b32 v224, v228
  v_permlane16_swap_b32 v225, v229
  v_permlane16_swap_b32 v226, v230
  v_permlane16_swap_b32 v227, v231
  v_cvt_pk_bf16_f32 v224, 0, v224
  v_cvt_pk_bf16_f32 v225, 0, v225
  v_cvt_pk_bf16_f32 v226, 0, v226
  v_cvt_pk_bf16_f32 v227, 0, v227
  v_cvt_pk_bf16_f32 v228, 0, v228
  v_cvt_pk_bf16_f32 v229, 0, v229
  v_cvt_pk_bf16_f32 v230, 0, v230
  v_cvt_pk_bf16_f32 v231, 0, v231
  v_add_f32 v232, v232, v224
  v_add_f32 v233, v233, v225
  v_add_f32 v234, v234, v226
  v_add_f32 v235, v235, v227
  v_add_f32 v236, v236, v228
  v_add_f32 v237, v237, v229
  v_add_f32 v238, v238, v230
  v_add_f32 v239, v239, v231
  v_cvt_pk_bf16_f32 v156, v232, v233
  v_cvt_pk_bf16_f32 v157, v234, v235
  v_cvt_pk_bf16_f32 v158, v236, v237
  v_cvt_pk_bf16_f32 v159, v238, v239
  v_lshlrev_b32 v232, 16, v156
  v_and_b32 v233, 0xffff0000, v156
  v_lshlrev_b32 v234, 16, v157
  v_and_b32 v235, 0xffff0000, v157
  v_lshlrev_b32 v236, 16, v158
  v_and_b32 v237, 0xffff0000, v158
  v_lshlrev_b32 v238, 16, v159
  v_and_b32 v239, 0xffff0000, v159
  buffer_store_dwordx4 v[156:159], v0, s[4:7], s92 offen sc1
  v_add_f32 v172, v232, v233
  v_add_f32 v173, v234, v235
  v_add_f32 v174, v236, v237
  v_add_f32 v175, v238, v239
  v_add_f32 v172, v172, v173
  v_add_f32 v174, v174, v175
  v_add_f32 v172, v172, v174
  s_nop 1
  v_add_f32_dpp v172, v172, v172 row_ror:8 row_mask:0xf bank_mask:0xf
  s_nop 1
  v_add_f32_dpp v172, v172, v172 row_ror:4 row_mask:0xf bank_mask:0xf
  s_nop 1
  v_add_f32_dpp v172, v172, v172 row_ror:2 row_mask:0xf bank_mask:0xf
  s_nop 1
  v_add_f32_dpp v172, v172, v172 row_ror:1 row_mask:0xf bank_mask:0xf
  v_mov_b32 v174, v172
  s_nop 0
  s_nop 0
  v_permlane16_swap_b32 v172, v174
  v_add_f32 v172, v172, v174
  v_mov_b32 v174, v172
  s_nop 0
  s_nop 0
  v_permlane32_swap_b32 v172, v174
  v_add_f32 v172, v172, v174
  v_mul_f32 v172, 0x3b000000, v172
  v_sub_f32 v176, v232, v172
  v_sub_f32 v177, v233, v172
  v_sub_f32 v178, v234, v172
  v_sub_f32 v179, v235, v172
  v_sub_f32 v180, v236, v172
  v_sub_f32 v181, v237, v172
  v_sub_f32 v182, v238, v172
  v_sub_f32 v183, v239, v172
  v_mul_f32 v173, v176, v176
  v_mul_f32 v174, v177, v177
  v_fmac_f32 v173, v178, v178
  v_fmac_f32 v174, v179, v179
  v_fmac_f32 v173, v180, v180
  v_fmac_f32 v174, v181, v181
  v_fmac_f32 v173, v182, v182
  v_fmac_f32 v174, v183, v183
  v_add_f32 v173, v173, v174
  v_cvt_pk_bf16_f32 v172, 0, v172
  s_nop 0
  v_add_f32_dpp v173, v173, v173 row_ror:8 row_mask:0xf bank_mask:0xf
  v_sub_f32 v176, v232, v172
  v_sub_f32 v177, v233, v172
  v_add_f32_dpp v173, v173, v173 row_ror:4 row_mask:0xf bank_mask:0xf
  v_sub_f32 v178, v234, v172
  v_sub_f32 v179, v235, v172
  v_add_f32_dpp v173, v173, v173 row_ror:2 row_mask:0xf bank_mask:0xf
  v_sub_f32 v180, v236, v172
  v_sub_f32 v181, v237, v172
  v_add_f32_dpp v173, v173, v173 row_ror:1 row_mask:0xf bank_mask:0xf
  v_sub_f32 v182, v238, v172
  v_sub_f32 v183, v239, v172
  v_mov_b32 v174, v173
  v_cvt_pk_bf16_f32 v176, 0, v176
  v_cvt_pk_bf16_f32 v177, 0, v177
  v_permlane16_swap_b32 v173, v174
  v_cvt_pk_bf16_f32 v178, 0, v178
  v_cvt_pk_bf16_f32 v179, 0, v179
  v_add_f32 v173, v173, v174
  v_cvt_pk_bf16_f32 v180, 0, v180
  v_cvt_pk_bf16_f32 v181, 0, v181
  v_mov_b32 v174, v173
  v_cvt_pk_bf16_f32 v182, 0, v182
  v_cvt_pk_bf16_f32 v183, 0, v183
  v_permlane32_swap_b32 v173, v174
  v_add_f32 v173, v173, v174
  v_mul_f32 v173, 0x3b000000, v173
  v_cvt_pk_bf16_f32 v173, 0, v173
  v_add_f32 v173, 0x3727c5ac, v173
  v_cvt_pk_bf16_f32 v173, 0, v173
  v_sqrt_f32 v173, v173
  s_nop 0
  v_cvt_pk_bf16_f32 v173, 0, v173
  v_rcp_f32 v173, v173
  s_nop 0
  v_mul_f32 v176, v176, v173
  v_mul_f32 v177, v177, v173
  v_mul_f32 v178, v178, v173
  v_mul_f32 v179, v179, v173
  v_mul_f32 v180, v180, v173
  v_mul_f32 v181, v181, v173
  v_mul_f32 v182, v182, v173
  v_mul_f32 v183, v183, v173
  v_cvt_pk_bf16_f32 v160, v176, v177
  v_cvt_pk_bf16_f32 v161, v178, v179
  v_cvt_pk_bf16_f32 v162, v180, v181
  v_cvt_pk_bf16_f32 v163, v182, v183
  v_lshlrev_b32 v240, 16, v160
  v_and_b32 v241, 0xffff0000, v160
  v_lshlrev_b32 v242, 16, v161
  v_and_b32 v243, 0xffff0000, v161
  v_lshlrev_b32 v244, 16, v162
  v_and_b32 v245, 0xffff0000, v162
  v_lshlrev_b32 v246, 16, v163
  v_and_b32 v247, 0xffff0000, v163
  buffer_store_dwordx4 v[160:163], v0, s[4:7], s93 offen sc1
  v_add_f32 v232, v232, v240
  v_add_f32 v233, v233, v241
  v_add_f32 v234, v234, v242
  v_add_f32 v235, v235, v243
  v_add_f32 v236, v236, v244
  v_add_f32 v237, v237, v245
  v_add_f32 v238, v238, v246
  v_add_f32 v239, v239, v247
  v_cvt_pk_bf16_f32 v164, v232, v233
  v_cvt_pk_bf16_f32 v165, v234, v235
  v_cvt_pk_bf16_f32 v166, v236, v237
  v_cvt_pk_bf16_f32 v167, v238, v239
  v_mul_f32 v224, v240, v8
  v_mul_f32 v225, v241, v9
  v_fmac_f32 v224, v242, v10
  v_fmac_f32 v225, v243, v11
  v_fmac_f32 v224, v244, v12
  v_fmac_f32 v225, v245, v13
  v_fmac_f32 v224, v246, v14
  v_fmac_f32 v225, v247, v15
  v_add_f32 v224, v224, v225
  s_add_u32 s92, s91, 10485760
  s_add_u32 s93, s91, 8388608
  buffer_store_dwordx4 v[164:167], v0, s[4:7], s92 offen sc1
  v_lshlrev_b32 v232, 16, v164
  v_and_b32 v233, 0xffff0000, v164
  v_lshlrev_b32 v234, 16, v165
  v_and_b32 v235, 0xffff0000, v165
  v_lshlrev_b32 v236, 16, v166
  v_and_b32 v237, 0xffff0000, v166
  v_lshlrev_b32 v238, 16, v167
  v_and_b32 v239, 0xffff0000, v167
  v_add_f32 v172, v232, v233
  v_add_f32 v173, v234, v235
  v_add_f32 v174, v236, v237
  v_add_f32 v175, v238, v239
  v_add_f32 v172, v172, v173
  v_add_f32 v174, v174, v175
  v_add_f32 v172, v172, v174
  s_nop 1
  v_add_f32_dpp v172, v172, v172 row_ror:8 row_mask:0xf bank_mask:0xf
  v_add_f32_dpp v224, v224, v224 row_ror:8 row_mask:0xf bank_mask:0xf
  s_nop 0
  v_add_f32_dpp v172, v172, v172 row_ror:4 row_mask:0xf bank_mask:0xf
  v_add_f32_dpp v224, v224, v224 row_ror:4 row_mask:0xf bank_mask:0xf
  s_nop 0
  v_add_f32_dpp v172, v172, v172 row_ror:2 row_mask:0xf bank_mask:0xf
  v_add_f32_dpp v224, v224, v224 row_ror:2 row_mask:0xf bank_mask:0xf
  s_nop 0
  v_add_f32_dpp v172, v172, v172 row_ror:1 row_mask:0xf bank_mask:0xf
  v_add_f32_dpp v224, v224, v224 row_ror:1 row_mask:0xf bank_mask:0xf
  v_mov_b32 v174, v172
  v_mov_b32 v175, v224
  s_nop 0
  v_permlane16_swap_b32 v172, v174
  v_permlane16_swap_b32 v224, v175
  v_add_f32 v172, v172, v174
  v_add_f32 v224, v224, v175
  v_mov_b32 v174, v172
  v_mov_b32 v175, v224
  s_nop 0
  v_permlane32_swap_b32 v172, v174
  v_permlane32_swap_b32 v224, v175
  v_add_f32 v172, v172, v174
  v_add_f32 v224, v224, v175
  v_mul_f32 v172, 0x3b000000, v172
  v_sub_f32 v176, v232, v172
  v_sub_f32 v177, v233, v172
  v_sub_f32 v178, v234, v172
  v_sub_f32 v179, v235, v172
  v_sub_f32 v180, v236, v172
  v_sub_f32 v181, v237, v172
  v_sub_f32 v182, v238, v172
  v_sub_f32 v183, v239, v172
  v_mul_f32 v173, v176, v176
  v_mul_f32 v174, v177, v177
  v_fmac_f32 v173, v178, v178
  v_fmac_f32 v174, v179, v179
  v_fmac_f32 v173, v180, v180
  v_fmac_f32 v174, v181, v181
  v_fmac_f32 v173, v182, v182
  v_fmac_f32 v174, v183, v183
  v_add_f32 v173, v173, v174
  v_cvt_pk_bf16_f32 v172, 0, v172
  s_nop 0
  v_add_f32_dpp v173, v173, v173 row_ror:8 row_mask:0xf bank_mask:0xf
  v_sub_f32 v176, v232, v172
  v_sub_f32 v177, v233, v172
  v_add_f32_dpp v173, v173, v173 row_ror:4 row_mask:0xf bank_mask:0xf
  v_sub_f32 v178, v234, v172
  v_sub_f32 v179, v235, v172
  v_add_f32_dpp v173, v173, v173 row_ror:2 row_mask:0xf bank_mask:0xf
  v_sub_f32 v180, v236, v172
  v_sub_f32 v181, v237, v172
  v_add_f32_dpp v173, v173, v173 row_ror:1 row_mask:0xf bank_mask:0xf
  v_sub_f32 v182, v238, v172
  v_sub_f32 v183, v239, v172
  v_mov_b32 v174, v173
  v_cvt_pk_bf16_f32 v176, 0, v176
  v_cvt_pk_bf16_f32 v177, 0, v177
  v_permlane16_swap_b32 v173, v174
  v_cvt_pk_bf16_f32 v178, 0, v178
  v_cvt_pk_bf16_f32 v179, 0, v179
  v_add_f32 v173, v173, v174
  v_cvt_pk_bf16_f32 v180, 0, v180
  v_cvt_pk_bf16_f32 v181, 0, v181
  v_mov_b32 v174, v173
  v_cvt_pk_bf16_f32 v182, 0, v182
  v_cvt_pk_bf16_f32 v183, 0, v183
  v_permlane32_swap_b32 v173, v174
  v_add_f32 v173, v173, v174
  v_mul_f32 v173, 0x3b000000, v173
  v_cvt_pk_bf16_f32 v173, 0, v173
  v_add_f32 v173, 0x3727c5ac, v173
  v_cvt_pk_bf16_f32 v173, 0, v173
  v_sqrt_f32 v173, v173
  s_nop 0
  v_cvt_pk_bf16_f32 v173, 0, v173
  v_rcp_f32 v173, v173
  s_nop 0
  v_mul_f32 v176, v176, v173
  v_mul_f32 v177, v177, v173
  v_mul_f32 v178, v178, v173
  v_mul_f32 v179, v179, v173
  v_mul_f32 v180, v180, v173
  v_mul_f32 v181, v181, v173
  v_mul_f32 v182, v182, v173
  v_mul_f32 v183, v183, v173
  v_cvt_pk_bf16_f32 v168, v176, v177
  v_cvt_pk_bf16_f32 v169, v178, v179
  v_cvt_pk_bf16_f32 v170, v180, v181
  v_cvt_pk_bf16_f32 v171, v182, v183
  buffer_store_dwordx4 v[168:171], v0, s[4:7], s93 offen sc1
  v_cvt_pk_bf16_f32 v224, 0, v224
  v_ashrrev_i32 v225, 31, v224
  v_or_b32 v225, 0x80000000, v225
  v_xor_b32 v224, v224, v225
  s_sub_u32 s92, 4095, s90
  v_and_b32 v224, 0xffff0000, v224
  v_or_b32 v224, s92, v224
  s_bfe_u32 s92, s65, 196619
  s_lshl_b32 s92, s92, 13
  s_lshl_b32 s93, s90, 2
  s_add_u32 s92, s92, s93
  s_add_u32 s92, s92, 5242880
  s_waitcnt vmcnt(0)
  s_mov_b64 exec, 1
  buffer_store_dword v224, off, s[4:7], s92 sc1
  s_mov_b64 exec, -1
  s_branch o_fd_101
o_f2_102:
  s_lshl_b32 s90, s61, 1
  s_add_u32 s90, s90, s17
  s_and_b32 s94, s62, 1
  s_lshl_b32 s94, s94, 5
  s_add_u32 s94, s94, s90
  s_lshl_b32 s94, s94, 14
  s_lshl_b32 s92, s60, 21
  s_add_u32 s94, s94, s92
  s_add_u32 s94, s94, 12582912
  buffer_load_dwordx4 v[156:159], v5, s[4:7], s94 offen offset:0 sc1
  buffer_load_dwordx4 v[160:163], v5, s[4:7], s94 offen offset:256 sc1
  buffer_load_dwordx4 v[164:167], v5, s[4:7], s94 offen offset:512 sc1
  buffer_load_dwordx4 v[168:171], v5, s[4:7], s94 offen offset:768 sc1
  s_add_u32 s94, s94, 4096
  buffer_load_dwordx4 v[172:175], v5, s[4:7], s94 offen offset:0 sc1
  buffer_load_dwordx4 v[176:179], v5, s[4:7], s94 offen offset:256 sc1
  buffer_load_dwordx4 v[180:183], v5, s[4:7], s94 offen offset:512 sc1
  buffer_load_dwordx4 v[184:187], v5, s[4:7], s94 offen offset:768 sc1
  s_add_u32 s94, s94, 4096
  buffer_load_dwordx4 v[188:191], v5, s[4:7], s94 offen offset:0 sc1
  buffer_load_dwordx4 v[192:195], v5, s[4:7], s94 offen offset:256 sc1
  buffer_load_dwordx4 v[196:199], v5, s[4:7], s94 offen offset:512 sc1
  buffer_load_dwordx4 v[200:203], v5, s[4:7], s94 offen offset:768 sc1
  s_add_u32 s94, s94, 4096
  buffer_load_dwordx4 v[204:207], v5, s[4:7], s94 offen offset:0 sc1
  buffer_load_dwordx4 v[208:211], v5, s[4:7], s94 offen offset:256 sc1
  buffer_load_dwordx4 v[212:215], v5, s[4:7], s94 offen offset:512 sc1
  buffer_load_dwordx4 v[216:219], v5, s[4:7], s94 offen offset:768 sc1
  s_lshr_b32 s92, s65, 16
  s_xor_b32 s93, s90, 32
  s_and_b32 s91, s65, 63
  s_lshl_b32 s94, s91, 11
  s_lshl_b32 s91, s91, 5
  s_add_u32 s90, s90, s91
  s_lshl_b32 s91, s90, 10
  s_add_u32 s94, s94, 26214400
  s_cmp_eq_u32 s92, s93
  s_cselect_b32 s92, s94, s91
  s_add_u32 s92, s92, 10485760
  buffer_load_dwordx4 v[220:223], v0, s[4:7], s92 offen sc1
  s_waitcnt vmcnt(16)
  v_mfma_f32_16x16x32_bf16 v[224:227], v[16:19], v[156:159], 0
  s_waitcnt vmcnt(15)
  v_mfma_f32_16x16x32_bf16 v[228:231], v[16:19], v[160:163], 0
  s_waitcnt vmcnt(14)
  v_mfma_f32_16x16x32_bf16 v[224:227], v[20:23], v[164:167], v[224:227]
  s_waitcnt vmcnt(13)
  v_mfma_f32_16x16x32_bf16 v[228:231], v[20:23], v[168:171], v[228:231]
  s_waitcnt vmcnt(12)
  v_mfma_f32_16x16x32_bf16 v[224:227], v[16:19], v[172:175], v[224:227]
  s_waitcnt vmcnt(11)
  v_mfma_f32_16x16x32_bf16 v[228:231], v[16:19], v[176:179], v[228:231]
  s_waitcnt vmcnt(10)
  v_mfma_f32_16x16x32_bf16 v[224:227], v[20:23], v[180:183], v[224:227]
  s_waitcnt vmcnt(9)
  v_mfma_f32_16x16x32_bf16 v[228:231], v[20:23], v[184:187], v[228:231]
  s_waitcnt vmcnt(8)
  v_mfma_f32_16x16x32_bf16 v[224:227], v[16:19], v[188:191], v[224:227]
  s_waitcnt vmcnt(7)
  v_mfma_f32_16x16x32_bf16 v[228:231], v[16:19], v[192:195], v[228:231]
  s_waitcnt vmcnt(6)
  v_mfma_f32_16x16x32_bf16 v[224:227], v[20:23], v[196:199], v[224:227]
  s_waitcnt vmcnt(5)
  v_mfma_f32_16x16x32_bf16 v[228:231], v[20:23], v[200:203], v[228:231]
  s_waitcnt vmcnt(4)
  v_mfma_f32_16x16x32_bf16 v[224:227], v[16:19], v[204:207], v[224:227]
  s_waitcnt vmcnt(3)
  v_mfma_f32_16x16x32_bf16 v[228:231], v[16:19], v[208:211], v[228:231]
  s_waitcnt vmcnt(2)
  v_mfma_f32_16x16x32_bf16 v[224:227], v[20:23], v[212:215], v[224:227]
  s_waitcnt vmcnt(1)
  v_mfma_f32_16x16x32_bf16 v[228:231], v[20:23], v[216:219], v[228:231]
  s_bfe_u32 s92, s65, 131080
  s_lshl_b32 s92, s92, 21
  s_add_u32 s92, s92, s91
  s_add_u32 s93, s92, 27262976
  s_add_u32 s92, s92, 20971520
  s_waitcnt vmcnt(0)
  v_lshlrev_b32 v232, 16, v220
  v_and_b32 v233, 0xffff0000, v220
  v_lshlrev_b32 v234, 16, v221
  v_and_b32 v235, 0xffff0000, v221
  v_lshlrev_b32 v236, 16, v222
  v_and_b32 v237, 0xffff0000, v222
  v_lshlrev_b32 v238, 16, v223
  v_and_b32 v239, 0xffff0000, v223
  v_permlane16_swap_b32 v224, v228
  v_permlane16_swap_b32 v225, v229
  v_permlane16_swap_b32 v226, v230
  v_permlane16_swap_b32 v227, v231
  v_cvt_pk_bf16_f32 v224, 0, v224
  v_cvt_pk_bf16_f32 v225, 0, v225
  v_cvt_pk_bf16_f32 v226, 0, v226
  v_cvt_pk_bf16_f32 v227, 0, v227
  v_cvt_pk_bf16_f32 v228, 0, v228
  v_cvt_pk_bf16_f32 v229, 0, v229
  v_cvt_pk_bf16_f32 v230, 0, v230
  v_cvt_pk_bf16_f32 v231, 0, v231
  v_add_f32 v232, v232, v224
  v_add_f32 v233, v233, v225
  v_add_f32 v234, v234, v226
  v_add_f32 v235, v235, v227
  v_add_f32 v236, v236, v228
  v_add_f32 v237, v237, v229
  v_add_f32 v238, v238, v230
  v_add_f32 v239, v239, v231
  v_cvt_pk_bf16_f32 v156, v232, v233
  v_cvt_pk_bf16_f32 v157, v234, v235
  v_cvt_pk_bf16_f32 v158, v236, v237
  v_cvt_pk_bf16_f32 v159, v238, v239
  v_lshlrev_b32 v232, 16, v156
  v_and_b32 v233, 0xffff0000, v156
  v_lshlrev_b32 v234, 16, v157
  v_and_b32 v235, 0xffff0000, v157
  v_lshlrev_b32 v236, 16, v158
  v_and_b32 v237, 0xffff0000, v158
  v_lshlrev_b32 v238, 16, v159
  v_and_b32 v239, 0xffff0000, v159
  buffer_store_dwordx4 v[156:159], v0, s[4:7], s92 offen sc1
  v_add_f32 v172, v232, v233
  v_add_f32 v173, v234, v235
  v_add_f32 v174, v236, v237
  v_add_f32 v175, v238, v239
  v_add_f32 v172, v172, v173
  v_add_f32 v174, v174, v175
  v_add_f32 v172, v172, v174
  s_nop 1
  v_add_f32_dpp v172, v172, v172 row_ror:8 row_mask:0xf bank_mask:0xf
  s_nop 1
  v_add_f32_dpp v172, v172, v172 row_ror:4 row_mask:0xf bank_mask:0xf
  s_nop 1
  v_add_f32_dpp v172, v172, v172 row_ror:2 row_mask:0xf bank_mask:0xf
  s_nop 1
  v_add_f32_dpp v172, v172, v172 row_ror:1 row_mask:0xf bank_mask:0xf
  v_mov_b32 v174, v172
  s_nop 0
  s_nop 0
  v_permlane16_swap_b32 v172, v174
  v_add_f32 v172, v172, v174
  v_mov_b32 v174, v172
  s_nop 0
  s_nop 0
  v_permlane32_swap_b32 v172, v174
  v_add_f32 v172, v172, v174
  v_mul_f32 v172, 0x3b000000, v172
  v_sub_f32 v176, v232, v172
  v_sub_f32 v177, v233, v172
  v_sub_f32 v178, v234, v172
  v_sub_f32 v179, v235, v172
  v_sub_f32 v180, v236, v172
  v_sub_f32 v181, v237, v172
  v_sub_f32 v182, v238, v172
  v_sub_f32 v183, v239, v172
  v_mul_f32 v173, v176, v176
  v_mul_f32 v174, v177, v177
  v_fmac_f32 v173, v178, v178
  v_fmac_f32 v174, v179, v179
  v_fmac_f32 v173, v180, v180
  v_fmac_f32 v174, v181, v181
  v_fmac_f32 v173, v182, v182
  v_fmac_f32 v174, v183, v183
  v_add_f32 v173, v173, v174
  v_cvt_pk_bf16_f32 v172, 0, v172
  s_nop 0
  v_add_f32_dpp v173, v173, v173 row_ror:8 row_mask:0xf bank_mask:0xf
  v_sub_f32 v176, v232, v172
  v_sub_f32 v177, v233, v172
  v_add_f32_dpp v173, v173, v173 row_ror:4 row_mask:0xf bank_mask:0xf
  v_sub_f32 v178, v234, v172
  v_sub_f32 v179, v235, v172
  v_add_f32_dpp v173, v173, v173 row_ror:2 row_mask:0xf bank_mask:0xf
  v_sub_f32 v180, v236, v172
  v_sub_f32 v181, v237, v172
  v_add_f32_dpp v173, v173, v173 row_ror:1 row_mask:0xf bank_mask:0xf
  v_sub_f32 v182, v238, v172
  v_sub_f32 v183, v239, v172
  v_mov_b32 v174, v173
  v_cvt_pk_bf16_f32 v176, 0, v176
  v_cvt_pk_bf16_f32 v177, 0, v177
  v_permlane16_swap_b32 v173, v174
  v_cvt_pk_bf16_f32 v178, 0, v178
  v_cvt_pk_bf16_f32 v179, 0, v179
  v_add_f32 v173, v173, v174
  v_cvt_pk_bf16_f32 v180, 0, v180
  v_cvt_pk_bf16_f32 v181, 0, v181
  v_mov_b32 v174, v173
  v_cvt_pk_bf16_f32 v182, 0, v182
  v_cvt_pk_bf16_f32 v183, 0, v183
  v_permlane32_swap_b32 v173, v174
  v_add_f32 v173, v173, v174
  v_mul_f32 v173, 0x3b000000, v173
  v_cvt_pk_bf16_f32 v173, 0, v173
  v_add_f32 v173, 0x3727c5ac, v173
  v_cvt_pk_bf16_f32 v173, 0, v173
  v_sqrt_f32 v173, v173
  s_nop 0
  v_cvt_pk_bf16_f32 v173, 0, v173
  v_rcp_f32 v173, v173
  s_nop 0
  v_mul_f32 v176, v176, v173
  v_mul_f32 v177, v177, v173
  v_mul_f32 v178, v178, v173
  v_mul_f32 v179, v179, v173
  v_mul_f32 v180, v180, v173
  v_mul_f32 v181, v181, v173
  v_mul_f32 v182, v182, v173
  v_mul_f32 v183, v183, v173
  v_cvt_pk_bf16_f32 v160, v176, v177
  v_cvt_pk_bf16_f32 v161, v178, v179
  v_cvt_pk_bf16_f32 v162, v180, v181
  v_cvt_pk_bf16_f32 v163, v182, v183
  v_lshlrev_b32 v240, 16, v160
  v_and_b32 v241, 0xffff0000, v160
  v_lshlrev_b32 v242, 16, v161
  v_and_b32 v243, 0xffff0000, v161
  v_lshlrev_b32 v244, 16, v162
  v_and_b32 v245, 0xffff0000, v162
  v_lshlrev_b32 v246, 16, v163
  v_and_b32 v247, 0xffff0000, v163
  buffer_store_dwordx4 v[160:163], v0, s[4:7], s93 offen sc1
  v_add_f32 v232, v232, v240
  v_add_f32 v233, v233, v241
  v_add_f32 v234, v234, v242
  v_add_f32 v235, v235, v243
  v_add_f32 v236, v236, v244
  v_add_f32 v237, v237, v245
  v_add_f32 v238, v238, v246
  v_add_f32 v239, v239, v247
  v_cvt_pk_bf16_f32 v164, v232, v233
  v_cvt_pk_bf16_f32 v165, v234, v235
  v_cvt_pk_bf16_f32 v166, v236, v237
  v_cvt_pk_bf16_f32 v167, v238, v239
  v_mul_f32 v224, v240, v8
  v_mul_f32 v225, v241, v9
  v_fmac_f32 v224, v242, v10
  v_fmac_f32 v225, v243, v11
  v_fmac_f32 v224, v244, v12
  v_fmac_f32 v225, v245, v13
  v_fmac_f32 v224, v246, v14
  v_fmac_f32 v225, v247, v15
  v_add_f32 v224, v224, v225
  s_add_u32 s92, s91, 33554432
  s_bitcmp1_b32 s65, 10
  s_cselect_b64 s[80:81], s[68:69], s[4:5]
  s_cselect_b32 s82, s70, s6
  s_cselect_b32 s92, s91, s92
  buffer_store_dwordx4 v[164:167], v0, s[80:83], s92 offen sc1
  v_add_f32_dpp v224, v224, v224 row_ror:8 row_mask:0xf bank_mask:0xf
  s_nop 1
  v_add_f32_dpp v224, v224, v224 row_ror:4 row_mask:0xf bank_mask:0xf
  s_nop 1
  v_add_f32_dpp v224, v224, v224 row_ror:2 row_mask:0xf bank_mask:0xf
  s_nop 1
  v_add_f32_dpp v224, v224, v224 row_ror:1 row_mask:0xf bank_mask:0xf
  v_mov_b32 v225, v224
  s_nop 0
  s_nop 0
  v_permlane16_swap_b32 v224, v225
  v_add_f32 v224, v224, v225
  v_mov_b32 v225, v224
  s_nop 0
  s_nop 0
  v_permlane32_swap_b32 v224, v225
  v_add_f32 v224, v224, v225
  v_cvt_pk_bf16_f32 v224, 0, v224
  v_ashrrev_i32 v225, 31, v224
  v_or_b32 v225, 0x80000000, v225
  v_xor_b32 v224, v224, v225
  s_sub_u32 s92, 4095, s90
  v_and_b32 v224, 0xffff0000, v224
  v_or_b32 v224, s92, v224
  s_bfe_u32 s92, s65, 196619
  s_lshl_b32 s92, s92, 13
  s_lshl_b32 s93, s90, 2
  s_add_u32 s92, s92, s93
  s_add_u32 s92, s92, 5242880
  s_waitcnt vmcnt(0)
  s_mov_b64 exec, 1
  buffer_store_dword v224, off, s[4:7], s92 sc1
  s_mov_b64 exec, -1
o_fd_101:
  s_mov_b32 s65, 0
o_nofl_87:
  s_mov_b32 s63, s64
  s_cmp_eq_u32 s51, 1
  s_cbranch_scc1 o_d1_83
  s_cmp_eq_u32 s51, 2
  s_cbranch_scc1 o_d2_84
  s_cmp_eq_u32 s51, 4
  s_cbranch_scc1 o_tloop_86
  s_cmp_eq_u32 s51, 0
  s_cbranch_scc1 o_next_82
  s_add_u32 s47, s47, 4
o_next_82:
  s_add_u32 s49, s49, 4
  s_cmp_lt_u32 s49, 64
  s_cbranch_scc1 o_round_80
  s_mov_b32 s67, 0
  s_mov_b32 s26, 5251072
  s_mov_b32 s27, 5255168
k_w_104:
  buffer_load_dwordx4 v[160:163], v0, s[4:7], s26 offen offset:0 sc1
  buffer_load_dwordx4 v[164:167], v0, s[4:7], s26 offen offset:1024 sc1
  buffer_load_dwordx4 v[168:171], v0, s[4:7], s26 offen offset:2048 sc1
  buffer_load_dwordx4 v[172:175], v0, s[4:7], s26 offen offset:3072 sc1
  buffer_load_dwordx4 v[176:179], v0, s[4:7], s27 offen offset:0 sc1
  buffer_load_dwordx4 v[180:183], v0, s[4:7], s27 offen offset:1024 sc1
  buffer_load_dwordx4 v[184:187], v0, s[4:7], s27 offen offset:2048 sc1
  buffer_load_dwordx4 v[188:191], v0, s[4:7], s27 offen offset:3072 sc1
  s_add_u32 s67, s67, 1
  s_cmp_gt_u32 s67, 1048576
  s_cbranch_scc1 L_end
  s_sleep 2
  s_waitcnt vmcnt(0)
  v_min_u32 v192, v160, v161
  v_max_u32 v193, v160, v161
  v_min3_u32 v192, v162, v163, v192
  v_max3_u32 v193, v162, v163, v193
  v_min3_u32 v192, v164, v165, v192
  v_max3_u32 v193, v164, v165, v193
  v_min3_u32 v192, v166, v167, v192
  v_max3_u32 v193, v166, v167, v193
  v_min3_u32 v192, v168, v169, v192
  v_max3_u32 v193, v168, v169, v193
  v_min3_u32 v192, v170, v171, v192
  v_max3_u32 v193, v170, v171, v193
  v_min3_u32 v192, v172, v173, v192
  v_max3_u32 v193, v172, v173, v193
  v_min3_u32 v192, v174, v175, v192
  v_max3_u32 v193, v174, v175, v193
  v_min3_u32 v192, v176, v177, v192
  v_max3_u32 v193, v176, v177, v193
  v_min3_u32 v192, v178, v179, v192
  v_max3_u32 v193, v178, v179, v193
  v_min3_u32 v192, v180, v181, v192
  v_max3_u32 v193, v180, v181, v193
  v_min3_u32 v192, v182, v183, v192
  v_max3_u32 v193, v182, v183, v193
  v_min3_u32 v192, v184, v185, v192
  v_max3_u32 v193, v184, v185, v193
  v_min3_u32 v192, v186, v187, v192
  v_max3_u32 v193, v186, v187, v193
  v_min3_u32 v192, v188, v189, v192
  v_max3_u32 v193, v188, v189, v193
  v_min3_u32 v192, v190, v191, v192
  v_max3_u32 v193, v190, v191, v193
  v_cmp_eq_u32 vcc, 0, v192
  s_cbranch_vccnz k_w_104
  v_max_u32_dpp v193, v193, v193 row_ror:8 row_mask:0xf bank_mask:0xf
  s_nop 1
  v_max_u32_dpp v193, v193, v193 row_ror:4 row_mask:0xf bank_mask:0xf
  s_nop 1
  v_max_u32_dpp v193, v193, v193 row_ror:2 row_mask:0xf bank_mask:0xf
  s_nop 1
  v_max_u32_dpp v193, v193, v193 row_ror:1 row_mask:0xf bank_mask:0xf
  v_mov_b32 v192, v193
  s_nop 0
  s_nop 0
  v_permlane16_swap_b32 v193, v192
  v_max_u32 v193, v193, v192
  v_mov_b32 v192, v193
  s_nop 0
  s_nop 0
  v_permlane32_swap_b32 v193, v192
  v_max_u32 v193, v193, v192
  s_nop 0
  v_readfirstlane_b32 s78, v193
  s_mov_b32 s46, s78
  s_andn2_b32 s52, 0xfff, s46
  s_lshr_b32 s52, s52, 5
  s_cmp_ge_u32 s17, 2
  s_cbranch_scc1 f_done_105
  s_andn2_b32 s28, 0xfff, s46
  s_lshr_b32 s28, s28, 5
  s_lshl_b32 s77, s60, 5
  s_lshl_b32 s26, s61, 1
  s_add_u32 s77, s77, s26
  s_add_u32 s77, s77, s17
  s_add_u32 s26, s28, 3
  s_sub_u32 s26, s26, s60
  s_lshr_b32 s26, s26, 2
  s_lshl_b32 s26, 1, s26
  s_sub_u32 s26, s26, 1
  s_and_b32 s27, s26, s48
  s_mov_b32 s30, 268435456
  s_lshl_b32 s29, s77, 10
  s_add_u32 s31, s29, 33554432
  s_bitcmp1_b32 s27, 0
  s_cselect_b32 s31, s31, s30
  buffer_load_dwordx4 v[168:171], v0, s[4:7], s31 offen sc1
  s_add_u32 s31, s29, 33685504
  s_bitcmp1_b32 s27, 1
  s_cselect_b32 s31, s31, s30
  buffer_load_dwordx4 v[172:175], v0, s[4:7], s31 offen sc1
  s_add_u32 s31, s29, 33816576
  s_bitcmp1_b32 s27, 2
  s_cselect_b32 s31, s31, s30
  buffer_load_dwordx4 v[176:179], v0, s[4:7], s31 offen sc1
  s_add_u32 s31, s29, 33947648
  s_bitcmp1_b32 s27, 3
  s_cselect_b32 s31, s31, s30
  buffer_load_dwordx4 v[180:183], v0, s[4:7], s31 offen sc1
  s_add_u32 s31, s29, 34078720
  s_bitcmp1_b32 s27, 4
  s_cselect_b32 s31, s31, s30
  buffer_load_dwordx4 v[184:187], v0, s[4:7], s31 offen sc1
  s_add_u32 s31, s29, 34209792
  s_bitcmp1_b32 s27, 5
  s_cselect_b32 s31, s31, s30
  buffer_load_dwordx4 v[188:191], v0, s[4:7], s31 offen sc1
  s_add_u32 s31, s29, 34340864
  s_bitcmp1_b32 s27, 6
  s_cselect_b32 s31, s31, s30
  buffer_load_dwordx4 v[192:195], v0, s[4:7], s31 offen sc1
  s_add_u32 s31, s29, 34471936
  s_bitcmp1_b32 s27, 7
  s_cselect_b32 s31, s31, s30
  buffer_load_dwordx4 v[196:199], v0, s[4:7], s31 offen sc1
  s_add_u32 s31, s29, 34603008
  s_bitcmp1_b32 s27, 8
  s_cselect_b32 s31, s31, s30
  buffer_load_dwordx4 v[200:203], v0, s[4:7], s31 offen sc1
  s_add_u32 s31, s29, 34734080
  s_bitcmp1_b32 s27, 9
  s_cselect_b32 s31, s31, s30
  buffer_load_dwordx4 v[204:207], v0, s[4:7], s31 offen sc1
  s_add_u32 s31, s29, 34865152
  s_bitcmp1_b32 s27, 10
  s_cselect_b32 s31, s31, s30
  buffer_load_dwordx4 v[208:211], v0, s[4:7], s31 offen sc1
  s_add_u32 s31, s29, 34996224
  s_bitcmp1_b32 s27, 11
  s_cselect_b32 s31, s31, s30
  buffer_load_dwordx4 v[212:215], v0, s[4:7], s31 offen sc1
  s_add_u32 s31, s29, 35127296
  s_bitcmp1_b32 s27, 12
  s_cselect_b32 s31, s31, s30
  buffer_load_dwordx4 v[216:219], v0, s[4:7], s31 offen sc1
  s_add_u32 s31, s29, 35258368
  s_bitcmp1_b32 s27, 13
  s_cselect_b32 s31, s31, s30
  buffer_load_dwordx4 v[220:223], v0, s[4:7], s31 offen sc1
  s_add_u32 s31, s29, 35389440
  s_bitcmp1_b32 s27, 14
  s_cselect_b32 s31, s31, s30
  buffer_load_dwordx4 v[224:227], v0, s[4:7], s31 offen sc1
  s_add_u32 s31, s29, 35520512
  s_bitcmp1_b32 s27, 15
  s_cselect_b32 s31, s31, s30
  buffer_load_dwordx4 v[228:231], v0, s[4:7], s31 offen sc1
  v_lshlrev_b32 v160, 5, v0
  s_mov_b32 vcc_lo, s26
  s_mov_b32 vcc_hi, 0
  v_mov_b32 v161, 8192
  v_cndmask_b32 v161, v161, 0, vcc
  v_add_u32 v161, v161, v160
  s_lshl_b32 s31, s77, 2
  s_add_u32 s32, s31, 5275648
  s_add_u32 s31, s31, 5259264
  buffer_load_dword v162, v161, s[4:7], s31 offen sc1
  s_add_u32 s31, s29, 0
  s_bitcmp1_b32 s27, 0
  s_cselect_b32 s31, s31, s30
  s_waitcnt vmcnt(16)
  buffer_store_dwordx4 v[168:171], v0, s[68:71], s31 offen sc1
  s_add_u32 s31, s29, 131072
  s_bitcmp1_b32 s27, 1
  s_cselect_b32 s31, s31, s30
  s_waitcnt vmcnt(16)
  buffer_store_dwordx4 v[172:175], v0, s[68:71], s31 offen sc1
  s_add_u32 s31, s29, 262144
  s_bitcmp1_b32 s27, 2
  s_cselect_b32 s31, s31, s30
  s_waitcnt vmcnt(16)
  buffer_store_dwordx4 v[176:179], v0, s[68:71], s31 offen sc1
  s_add_u32 s31, s29, 393216
  s_bitcmp1_b32 s27, 3
  s_cselect_b32 s31, s31, s30
  s_waitcnt vmcnt(16)
  buffer_store_dwordx4 v[180:183], v0, s[68:71], s31 offen sc1
  s_add_u32 s31, s29, 524288
  s_bitcmp1_b32 s27, 4
  s_cselect_b32 s31, s31, s30
  s_waitcnt vmcnt(16)
  buffer_store_dwordx4 v[184:187], v0, s[68:71], s31 offen sc1
  s_add_u32 s31, s29, 655360
  s_bitcmp1_b32 s27, 5
  s_cselect_b32 s31, s31, s30
  s_waitcnt vmcnt(16)
  buffer_store_dwordx4 v[188:191], v0, s[68:71], s31 offen sc1
  s_add_u32 s31, s29, 786432
  s_bitcmp1_b32 s27, 6
  s_cselect_b32 s31, s31, s30
  s_waitcnt vmcnt(16)
  buffer_store_dwordx4 v[192:195], v0, s[68:71], s31 offen sc1
  s_add_u32 s31, s29, 917504
  s_bitcmp1_b32 s27, 7
  s_cselect_b32 s31, s31, s30
  s_waitcnt vmcnt(16)
  buffer_store_dwordx4 v[196:199], v0, s[68:71], s31 offen sc1
  s_add_u32 s31, s29, 1048576
  s_bitcmp1_b32 s27, 8
  s_cselect_b32 s31, s31, s30
  s_waitcnt vmcnt(16)
  buffer_store_dwordx4 v[200:203], v0, s[68:71], s31 offen sc1
  s_add_u32 s31, s29, 1179648
  s_bitcmp1_b32 s27, 9
  s_cselect_b32 s31, s31, s30
  s_waitcnt vmcnt(16)
  buffer_store_dwordx4 v[204:207], v0, s[68:71], s31 offen sc1
  s_add_u32 s31, s29, 1310720
  s_bitcmp1_b32 s27, 10
  s_cselect_b32 s31, s31, s30
  s_waitcnt vmcnt(16)
  buffer_store_dwordx4 v[208:211], v0, s[68:71], s31 offen sc1
  s_add_u32 s31, s29, 1441792
  s_bitcmp1_b32 s27, 11
  s_cselect_b32 s31, s31, s30
  s_waitcnt vmcnt(16)
  buffer_store_dwordx4 v[212:215], v0, s[68:71], s31 offen sc1
  s_add_u32 s31, s29, 1572864
  s_bitcmp1_b32 s27, 12
  s_cselect_b32 s31, s31, s30
  s_waitcnt vmcnt(16)
  buffer_store_dwordx4 v[216:219], v0, s[68:71], s31 offen sc1
  s_add_u32 s31, s29, 1703936
  s_bitcmp1_b32 s27, 13
  s_cselect_b32 s31, s31, s30
  s_waitcnt vmcnt(16)
  buffer_store_dwordx4 v[220:223], v0, s[68:71], s31 offen sc1
  s_add_u32 s31, s29, 1835008
  s_bitcmp1_b32 s27, 14
  s_cselect_b32 s31, s31, s30
  s_waitcnt vmcnt(16)
  buffer_store_dwordx4 v[224:227], v0, s[68:71], s31 offen sc1
  s_add_u32 s31, s29, 1966080
  s_bitcmp1_b32 s27, 15
  s_cselect_b32 s31, s31, s30
  s_waitcnt vmcnt(16)
  buffer_store_dwordx4 v[228:231], v0, s[68:71], s31 offen sc1
  s_mov_b32 vcc_lo, s48
  v_mov_b32 v161, 0x7ff00000
  v_cndmask_b32 v160, v161, v160, vcc
  s_waitcnt vmcnt(0)
  buffer_store_dword v162, v160, s[4:7], s32 offen sc1
f_done_105:
  s_mov_b32 s54, s47
  s_andn2_b32 s26, 31, s46
  s_or_b32 s26, s26, 32
  s_lshl_b32 s26, s26, 16
  s_or_b32 s26, s26, 26240
  s_cmp_eq_u32 s54, s52
  s_cselect_b32 s63, s26, 26176
  s_or_b32 s63, s63, s54
  s_or_b32 s26, s54, 25920
  s_cmp_lt_u32 s54, s52
  s_cselect_b32 s63, s26, s63
  s_cmp_lt_u32 s54, 64
  s_cselect_b32 s63, s63, 0
o_tloop_86:
  s_cmp_eq_u32 s63, 0
  s_cbranch_scc1 L_end
  s_add_u32 s54, s54, 4
  s_andn2_b32 s26, 31, s46
  s_or_b32 s26, s26, 32
  s_lshl_b32 s26, s26, 16
  s_or_b32 s26, s26, 26240
  s_cmp_eq_u32 s54, s52
  s_cselect_b32 s64, s26, 26176
  s_or_b32 s64, s64, s54
  s_or_b32 s26, s54, 25920
  s_cmp_lt_u32 s54, s52
  s_cselect_b32 s64, s26, s64
  s_cmp_lt_u32 s54, 64
  s_cselect_b32 s64, s64, 0
  s_mov_b32 s51, 4
  s_branch o_task_81
o_d1_83:
  s_cmp_lt_u32 s47, s52
  s_cbranch_scc1 o_d2_84
  s_lshr_b32 s26, s47, 2
  s_bitset1_b32 s48, s26
  s_mov_b32 s54, s47
  s_andn2_b32 s26, 31, s46
  s_or_b32 s26, s26, 32
  s_lshl_b32 s26, s26, 16
  s_or_b32 s26, s26, 24192
  s_cmp_eq_u32 s54, s52
  s_cselect_b32 s64, s26, 56896
  s_or_b32 s64, s64, s54
  s_mov_b32 s51, 2
  s_branch o_task_81
o_d2_84:
  s_mov_b32 s64, s53
  s_mov_b32 s51, 3
  s_branch o_task_81
L_o_x:
  s_mov_b32 s62, 0
  s_mov_b32 s46, 0
  s_mov_b32 s48, 0
  s_mov_b32 s65, 0
  s_mov_b32 s66, 0
  s_mov_b32 s76, 0
  s_mov_b32 s79, 268435456
  s_mov_b32 s84, 32768
  s_mov_b32 s47, s60
  s_mov_b32 s49, s60
o_round_106:
  s_mov_b32 s67, 0
  s_lshl_b32 s26, s49, 7
  s_add_u32 s26, s26, 5249664
d_w_116:
  buffer_load_dwordx2 v[160:161], v1, s[4:7], s26 offen sc1
  s_add_u32 s67, s67, 1
  s_cmp_gt_u32 s67, 1048576
  s_cbranch_scc1 L_end
  s_waitcnt vmcnt(0)
  v_min_u32 v162, v160, v161
  v_max_u32 v163, v160, v161
  v_cmp_eq_u32 vcc, 0, v162
  s_cbranch_vccnz d_w_116
  v_max_u32_dpp v163, v163, v163 row_ror:8 row_mask:0xf bank_mask:0xf
  s_nop 1
  v_max_u32_dpp v163, v163, v163 row_ror:4 row_mask:0xf bank_mask:0xf
  s_nop 1
  v_max_u32_dpp v163, v163, v163 row_ror:2 row_mask:0xf bank_mask:0xf
  s_nop 1
  v_max_u32_dpp v163, v163, v163 row_ror:1 row_mask:0xf bank_mask:0xf
  s_nop 0
  v_readlane_b32 s28, v163, 0
  v_readlane_b32 s29, v163, 16
  v_readlane_b32 s30, v163, 32
  v_readlane_b32 s31, v163, 48
  s_max_u32 s28, s28, s29
  s_max_u32 s30, s30, s31
  s_max_u32 s46, s46, s28
  s_max_u32 s46, s46, s30
  s_andn2_b32 s52, 0xfff, s46
  s_lshr_b32 s52, s52, 5
  s_or_b32 s63, s49, 18432
  s_add_u32 s53, s63, 4
  s_cmp_lt_u32 s49, 60
  s_cselect_b32 s53, s53, 0
  s_or_b32 s26, s47, 25920
  s_or_b32 s27, s47, 20800
  s_cmp_lt_u32 s47, s52
  s_cselect_b32 s64, s26, s27
  s_add_u32 s26, s47, 16
  s_cmp_le_u32 s26, s49
  s_cselect_b32 s64, s64, s53
  s_cselect_b32 s51, 1, 0
o_task_107:
  s_bitcmp1_b32 s63, 15
  s_cbranch_scc1 o_same_119
  s_cmp_lg_u32 s66, 0
  s_cbranch_scc1 o_have_118
  s_mov_b32 s67, 0
o_w1_117:
  s_and_b32 s26, s63, 0xff
  s_lshl_b32 s26, s26, 5
  s_add_u32 s26, s26, s85
  s_lshl_b32 s26, s26, 4
  s_and_b32 s27, s17, 1
  s_lshl_b32 s27, s27, 3
  s_add_u32 s26, s26, s27
  s_add_u32 s27, s26, 5406720
  s_add_u32 s26, s26, 5308416
  buffer_load_dwordx2 v[52:53], off, s[4:7], s26 sc1
  buffer_load_dwordx2 v[54:55], off, s[4:7], s27 sc1
  s_add_u32 s67, s67, 1
  s_cmp_gt_u32 s67, 1048576
  s_cbranch_scc1 L_end
  s_waitcnt vmcnt(0)
  v_mov_b32 v7, s62
  s_mov_b64 exec, 1
  buffer_store_dword v7, off, s[4:7], s79 sc1
  s_mov_b64 exec, -1
  s_mov_b32 s79, 268435456
  v_min3_u32 v52, v52, v53, v54
  v_min_u32 v52, v52, v55
  v_cmp_ne_u32 vcc, 0, v52
  s_cbranch_vccz o_w1_117
  s_and_b32 s32, s63, 0xff
  s_lshl_b32 s32, s32, 4
  s_add_u32 s32, s32, s61
  s_lshl_b32 s32, s32, 2
  s_add_u32 s32, s32, s17
  s_lshl_b32 s33, s32, 12
  s_add_u32 s33, s33, 142606336
  s_lshl_b32 s32, s32, 13
  s_add_u32 s32, s32, 41943040
  s_xor_b32 s34, s84, 114688
  s_lshl_b32 s35, s17, 12
  s_add_u32 s34, s34, s35
  s_add_u32 m0, s34, 32768
  s_add_u32 s34, s34, s35
  buffer_load_dwordx4 v0, s[4:7], s33 offen offset:0 sc1 lds
  buffer_load_dwordx4 v0, s[4:7], s33 offen offset:1024 sc1 lds
  buffer_load_dwordx4 v0, s[4:7], s33 offen offset:2048 sc1 lds
  buffer_load_dwordx4 v0, s[4:7], s33 offen offset:3072 sc1 lds
  s_add_u32 m0, s34, 0
  s_nop 0
  buffer_load_dwordx4 v0, s[4:7], s32 offen offset:0 sc1 lds
  buffer_load_dwordx4 v0, s[4:7], s32 offen offset:1024 sc1 lds
  buffer_load_dwordx4 v0, s[4:7], s32 offen offset:2048 sc1 lds
  buffer_load_dwordx4 v0, s[4:7], s32 offen offset:3072 sc1 lds
  s_add_u32 m0, s34, 4096
  s_add_u32 s32, s32, 4096
  buffer_load_dwordx4 v0, s[4:7], s32 offen offset:0 sc1 lds
  buffer_load_dwordx4 v0, s[4:7], s32 offen offset:1024 sc1 lds
  buffer_load_dwordx4 v0, s[4:7], s32 offen offset:2048 sc1 lds
  buffer_load_dwordx4 v0, s[4:7], s32 offen offset:3072 sc1 lds
  s_waitcnt vmcnt(0)
o_have_118:
  s_xor_b32 s84, s84, 114688
  s_mov_b32 s66, 0
  s_lshr_b32 s26, s17, 1
  s_lshl_b32 s27, s26, 14
  s_add_u32 s27, s27, s84
  v_add_u32 v49, s27, v0
  s_lshl_b32 s26, s26, 13
  s_and_b32 s27, s17, 1
  s_lshl_b32 s27, s27, 10
  s_add_u32 s26, s26, s27
  s_add_u32 s26, s26, s84
  v_add_u32 v50, s26, v0
  s_barrier
o_same_119:
  ds_read_b128 v[60:63], v50 offset:32768
  ds_read_b128 v[76:79], v49 offset:0
  ds_read_b128 v[92:95], v49 offset:1024
  ds_read_b128 v[64:67], v50 offset:34816
  ds_read_b128 v[80:83], v49 offset:4096
  ds_read_b128 v[96:99], v49 offset:5120
  ds_read_b128 v[68:71], v50 offset:36864
  ds_read_b128 v[84:87], v49 offset:8192
  ds_read_b128 v[100:103], v49 offset:9216
  ds_read_b128 v[72:75], v50 offset:38912
  ds_read_b128 v[88:91], v49 offset:12288
  ds_read_b128 v[104:107], v49 offset:13312
  s_and_b32 s26, s64, 0xff
  s_lshl_b32 s26, s26, 5
  s_add_u32 s26, s26, s85
  s_lshl_b32 s26, s26, 4
  s_and_b32 s27, s17, 1
  s_lshl_b32 s27, s27, 3
  s_add_u32 s26, s26, s27
  s_add_u32 s27, s26, 5406720
  s_add_u32 s26, s26, 5308416
  buffer_load_dwordx2 v[52:53], off, s[4:7], s26 sc1
  buffer_load_dwordx2 v[54:55], off, s[4:7], s27 sc1
  s_and_b32 s26, s64, 63
  s_lshl_b32 s26, s26, 5
  s_add_u32 s26, s26, s85
  s_bfe_u32 s27, s64, 131080
  s_lshl_b32 s26, s26, 4
  s_lshl_b32 s27, s27, 16
  s_add_u32 s26, s26, s27
  s_add_u32 s26, s26, 5513216
  buffer_load_dwordx4 v[56:59], off, s[4:7], s26 sc1
  v_xor_b32 v6, 16384, v6
  v_and_b32 v48, 16384, v6
  v_add_u32 v48, v48, v0
  s_waitcnt lgkmcnt(9)
  v_mfma_f32_16x16x32_bf16 v[140:143], v[76:79], v[60:63], 0
  ds_read_b128 v[108:111], v49 offset:2048
  v_mfma_f32_16x16x32_bf16 v[144:147], v[92:95], v[60:63], 0
  ds_read_b128 v[112:115], v49 offset:3072
  s_waitcnt lgkmcnt(8)
  v_mfma_f32_16x16x32_bf16 v[140:143], v[80:83], v[64:67], v[140:143]
  ds_read_b128 v[116:119], v49 offset:6144
  v_mfma_f32_16x16x32_bf16 v[144:147], v[96:99], v[64:67], v[144:147]
  ds_read_b128 v[120:123], v49 offset:7168
  s_waitcnt lgkmcnt(7)
  v_mfma_f32_16x16x32_bf16 v[140:143], v[84:87], v[68:71], v[140:143]
  ds_read_b128 v[124:127], v49 offset:10240
  v_mfma_f32_16x16x32_bf16 v[144:147], v[100:103], v[68:71], v[144:147]
  ds_read_b128 v[128:131], v49 offset:11264
  s_waitcnt lgkmcnt(6)
  v_mfma_f32_16x16x32_bf16 v[140:143], v[88:91], v[72:75], v[140:143]
  ds_read_b128 v[132:135], v49 offset:14336
  v_mfma_f32_16x16x32_bf16 v[144:147], v[104:107], v[72:75], v[144:147]
  ds_read_b128 v[136:139], v49 offset:15360
  v_mov_b32 v156, 0
  v_mov_b32 v159, 0
  v_mov_b32 v157, 0xff000000
  v_cmp_le_i32 s[90:91], 0, v3
  v_cmp_le_i32 s[92:93], 1, v3
  v_cmp_le_i32 s[94:95], 2, v3
  v_cmp_le_i32 s[96:97], 3, v3
  v_cndmask_b32 v140, v157, v140, s[90:91]
  v_cndmask_b32 v141, v157, v141, s[92:93]
  v_cndmask_b32 v142, v157, v142, s[94:95]
  v_cndmask_b32 v143, v157, v143, s[96:97]
  v_cmp_le_i32 s[90:91], 16, v3
  v_cmp_le_i32 s[92:93], 17, v3
  v_cmp_le_i32 s[94:95], 18, v3
  v_cmp_le_i32 s[96:97], 19, v3
  v_cndmask_b32 v144, v157, v144, s[90:91]
  v_cndmask_b32 v145, v157, v145, s[92:93]
  v_cndmask_b32 v146, v157, v146, s[94:95]
  v_cndmask_b32 v147, v157, v147, s[96:97]
  v_max3_f32 v152, v140, v141, v142
  v_max3_f32 v152, v143, v144, v152
  v_max3_f32 v152, v145, v146, v152
  s_waitcnt vmcnt(3)
  v_mov_b32 v7, s62
  s_mov_b64 exec, 1
  buffer_store_dword v7, off, s[4:7], s79 sc1
  s_mov_b64 exec, -1
  s_mov_b32 s79, 268435456
  s_cmp_lg_u32 s76, 0
  s_cbranch_scc1 o_havek_121
  s_mov_b32 s67, 0
  s_and_b32 s26, s63, 63
  s_lshl_b32 s26, s26, 5
  s_add_u32 s26, s26, s85
  s_bfe_u32 s27, s63, 131080
  s_lshl_b32 s26, s26, 4
  s_lshl_b32 s27, s27, 16
  s_add_u32 s26, s26, s27
  s_add_u32 s26, s26, 5513216
o_w2_120:
  buffer_load_dwordx4 v[160:163], off, s[4:7], s26 sc1
  s_add_u32 s67, s67, 1
  s_cmp_gt_u32 s67, 1048576
  s_cbranch_scc1 L_end
  s_waitcnt vmcnt(0)
  v_min3_u32 v160, v160, v161, v162
  v_min_u32 v160, v160, v163
  v_cmp_ne_u32 vcc, 0, v160
  s_cbranch_vccz o_w2_120
  s_and_b32 s32, s63, 63
  s_lshl_b32 s32, s32, 5
  s_add_u32 s32, s32, s85
  s_bfe_u32 s33, s63, 131080
  s_lshl_b32 s33, s33, 11
  s_add_u32 s32, s32, s33
  s_lshl_b32 s32, s32, 13
  s_add_u32 s32, s32, 192937984
  s_add_u32 s33, s32, 4096
  buffer_load_dwordx4 v[24:27], v0, s[4:7], s32 offen offset:0 sc1
  buffer_load_dwordx4 v[28:31], v0, s[4:7], s32 offen offset:2048 sc1
  buffer_load_dwordx4 v[32:35], v0, s[4:7], s33 offen offset:0 sc1
  buffer_load_dwordx4 v[36:39], v0, s[4:7], s33 offen offset:2048 sc1
  buffer_load_dwordx2 v[40:41], v1, s[4:7], s32 offen offset:1024 sc1
  buffer_load_dwordx2 v[42:43], v1, s[4:7], s32 offen offset:3072 sc1
  buffer_load_dwordx2 v[44:45], v1, s[4:7], s33 offen offset:1024 sc1
  buffer_load_dwordx2 v[46:47], v1, s[4:7], s33 offen offset:3072 sc1
  s_waitcnt vmcnt(4)
o_havek_121:
  v_mfma_f32_16x16x32_bf16 v[148:151], v[24:27], v[60:63], 0
  v_mfma_f32_16x16x32_bf16 v[148:151], v[28:31], v[64:67], v[148:151]
  v_mfma_f32_16x16x32_bf16 v[148:151], v[32:35], v[68:71], v[148:151]
  v_mfma_f32_16x16x32_bf16 v[148:151], v[36:39], v[72:75], v[148:151]
  v_max_f32 v152, v147, v152
  s_nop 3
  s_nop 0
  s_nop 0
  s_nop 0
  v_mul_f32 v148, s24, v148
  v_mul_f32 v149, s24, v149
  v_max3_f32 v152, v148, v149, v152
  v_mov_b32 v153, v152
  s_nop 0
  s_nop 0
  v_permlane16_swap_b32 v152, v153
  v_max_f32 v152, v152, v153
  v_mov_b32 v153, v152
  s_nop 0
  s_nop 0
  v_permlane32_swap_b32 v152, v153
  v_max_f32 v152, v152, v153
  v_sub_f32 v140, v140, v152
  v_sub_f32 v141, v141, v152
  v_sub_f32 v142, v142, v152
  v_sub_f32 v143, v143, v152
  v_sub_f32 v144, v144, v152
  v_sub_f32 v145, v145, v152
  v_sub_f32 v146, v146, v152
  v_sub_f32 v147, v147, v152
  v_sub_f32 v148, v148, v152
  v_sub_f32 v149, v149, v152
  v_exp_f32 v140, v140
  v_exp_f32 v141, v141
  v_exp_f32 v142, v142
  v_exp_f32 v143, v143
  v_exp_f32 v144, v144
  v_exp_f32 v145, v145
  v_exp_f32 v146, v146
  v_exp_f32 v147, v147
  v_exp_f32 v148, v148
  v_exp_f32 v149, v149
  v_add_f32 v152, v140, v141
  v_add_f32 v153, v142, v143
  v_add_f32 v152, v152, v144
  v_add_f32 v153, v153, v145
  v_add_f32 v152, v152, v146
  v_add_f32 v153, v153, v147
  v_add_f32 v152, v152, v148
  v_add_f32 v153, v153, v149
  v_add_f32 v152, v152, v153
  v_mov_b32 v153, v152
  s_nop 0
  s_nop 0
  v_permlane16_swap_b32 v152, v153
  v_add_f32 v152, v152, v153
  v_mov_b32 v153, v152
  s_nop 0
  s_nop 0
  v_permlane32_swap_b32 v152, v153
  v_add_f32 v152, v152, v153
  v_rcp_f32 v152, v152
  s_nop 0
  v_mul_f32 v140, v140, v152
  v_mul_f32 v141, v141, v152
  v_mul_f32 v142, v142, v152
  v_mul_f32 v143, v143, v152
  v_mul_f32 v144, v144, v152
  v_mul_f32 v145, v145, v152
  v_mul_f32 v146, v146, v152
  v_mul_f32 v147, v147, v152
  v_mul_f32 v148, v148, v152
  v_mul_f32 v149, v149, v152
  v_cvt_pk_bf16_f32 v152, v140, v141
  v_cvt_pk_bf16_f32 v153, v142, v143
  v_cvt_pk_bf16_f32 v154, v144, v145
  v_cvt_pk_bf16_f32 v155, v146, v147
  v_cvt_pk_bf16_f32 v157, v148, v149
  v_cvt_pk_bf16_f32 v158, v148, v149
  s_waitcnt lgkmcnt(0) vmcnt(0)
  v_mfma_f32_16x16x32_bf16 v[160:163], v[108:111], v[152:155], 0
  v_mfma_f32_16x16x32_bf16 v[164:167], v[112:115], v[152:155], 0
  v_mfma_f32_16x16x32_bf16 v[168:171], v[116:119], v[152:155], 0
  v_mfma_f32_16x16x32_bf16 v[172:175], v[120:123], v[152:155], 0
  v_mfma_f32_16x16x32_bf16 v[176:179], v[124:127], v[152:155], 0
  v_mfma_f32_16x16x32_bf16 v[180:183], v[128:131], v[152:155], 0
  v_mfma_f32_16x16x32_bf16 v[184:187], v[132:135], v[152:155], 0
  v_mfma_f32_16x16x32_bf16 v[188:191], v[136:139], v[152:155], 0
  v_min3_u32 v52, v52, v53, v54
  v_min3_u32 v56, v56, v57, v58
  v_min_u32 v52, v52, v55
  v_min_u32 v56, v56, v59
  v_lshl_or_b32 v52, v56, 1, v52
  s_and_b32 s27, s62, 1
  s_lshl_b32 s27, s27, 4
  s_add_u32 s27, s27, 131072
  v_mov_b32 v54, s27
  s_lshl_b32 s26, s17, 2
  v_add_u32 v53, s26, v54
  ds_write_b32 v53, v52
  v_mfma_f32_16x16x16_bf16 v[160:163], v[40:41], v[158:159], v[160:163]
  v_mfma_f32_16x16x16_bf16 v[164:167], v[40:41], v[156:157], v[164:167]
  v_mfma_f32_16x16x16_bf16 v[168:171], v[42:43], v[158:159], v[168:171]
  v_mfma_f32_16x16x16_bf16 v[172:175], v[42:43], v[156:157], v[172:175]
  v_mfma_f32_16x16x16_bf16 v[176:179], v[44:45], v[158:159], v[176:179]
  v_mfma_f32_16x16x16_bf16 v[180:183], v[44:45], v[156:157], v[180:183]
  v_mfma_f32_16x16x16_bf16 v[184:187], v[46:47], v[158:159], v[184:187]
  v_mfma_f32_16x16x16_bf16 v[188:191], v[46:47], v[156:157], v[188:191]
  s_nop 0
  v_cvt_pk_bf16_f32 v192, v160, v161
  v_cvt_pk_bf16_f32 v193, v162, v163
  v_cvt_pk_bf16_f32 v194, v164, v165
  v_cvt_pk_bf16_f32 v195, v166, v167
  ds_write_b128 v6, v[192:195] offset:0
  v_cvt_pk_bf16_f32 v196, v168, v169
  v_cvt_pk_bf16_f32 v197, v170, v171
  v_cvt_pk_bf16_f32 v198, v172, v173
  v_cvt_pk_bf16_f32 v199, v174, v175
  ds_write_b128 v6, v[196:199] offset:1024
  v_cvt_pk_bf16_f32 v200, v176, v177
  v_cvt_pk_bf16_f32 v201, v178, v179
  v_cvt_pk_bf16_f32 v202, v180, v181
  v_cvt_pk_bf16_f32 v203, v182, v183
  ds_write_b128 v6, v[200:203] offset:2048
  v_cvt_pk_bf16_f32 v204, v184, v185
  v_cvt_pk_bf16_f32 v205, v186, v187
  v_cvt_pk_bf16_f32 v206, v188, v189
  v_cvt_pk_bf16_f32 v207, v190, v191
  ds_write_b128 v6, v[204:207] offset:3072
  s_cmp_ge_u32 s17, 2
  s_cselect_b32 s65, 0, s65
  s_cmp_eq_u32 s65, 0
  s_cbranch_scc1 o_noob_122
  s_lshl_b32 s26, s60, 10
  s_add_u32 s26, s26, 5283840
  s_mov_b32 s67, 0
o_wob_123:
  buffer_load_dword v7, v2, s[4:7], s26 offen sc1
  s_add_u32 s67, s67, 1
  s_cmp_gt_u32 s67, 1048576
  s_cbranch_scc1 L_end
  s_waitcnt vmcnt(0)
  v_cmp_gt_u32 vcc, s62, v7
  s_cbranch_vccnz o_wob_123
o_noob_122:
  s_mov_b32 s95, s62
  s_add_u32 s62, s62, 1
  s_and_b32 s86, s62, 1
  s_lshl_b32 s86, s86, 19
  s_lshl_b32 s26, s60, 21
  s_add_u32 s86, s86, s26
  s_add_u32 s86, s86, 12582912
  s_waitcnt lgkmcnt(0)
  s_barrier
  s_cmp_lg_u32 s65, 0
  s_cbranch_scc1 o_wr1_124
  ds_read_b128 v[56:59], v54
  ds_read_b128 v[124:127], v48 offset:0
  ds_read_b128 v[128:131], v48 offset:1024
  ds_read_b128 v[132:135], v48 offset:2048
  s_waitcnt lgkmcnt(2)
  v_mfma_f32_16x16x32_bf16 v[60:63], v[124:127], a[0:3], 0
  v_mfma_f32_16x16x32_bf16 v[64:67], v[124:127], a[4:7], 0
  ds_read_b128 v[136:139], v48 offset:3072
  v_mfma_f32_16x16x32_bf16 v[68:71], v[124:127], a[8:11], 0
  v_mfma_f32_16x16x32_bf16 v[72:75], v[124:127], a[12:15], 0
  v_and_b32 v56, v56, v57
  v_and_b32 v58, v58, v59
  v_mfma_f32_16x16x32_bf16 v[76:79], v[124:127], a[16:19], 0
  v_mfma_f32_16x16x32_bf16 v[80:83], v[124:127], a[20:23], 0
  v_and_b32 v56, v56, v58
  s_bfe_u32 s26, s64, 131086
  v_readfirstlane_b32 s27, v56
  v_mfma_f32_16x16x32_bf16 v[84:87], v[124:127], a[24:27], 0
  v_mfma_f32_16x16x32_bf16 v[88:91], v[124:127], a[28:31], 0
  s_cmp_eq_u32 s26, 1
  s_cselect_b32 s66, s27, 0
  s_and_b32 s66, s66, 1
  s_cselect_b32 s87, 0, 268435456
  s_cmp_lg_u32 s26, 0
  s_cselect_b32 s76, s27, 0
  s_and_b32 s76, s76, 2
  s_cselect_b32 s88, 0, 268435456
  s_waitcnt lgkmcnt(2)
  v_mfma_f32_16x16x32_bf16 v[60:63], v[128:131], a[32:35], v[60:63]
  v_mfma_f32_16x16x32_bf16 v[64:67], v[128:131], a[36:39], v[64:67]
  ds_read_b128 v[124:127], v48 offset:8192
  v_mfma_f32_16x16x32_bf16 v[68:71], v[128:131], a[40:43], v[68:71]
  v_mfma_f32_16x16x32_bf16 v[72:75], v[128:131], a[44:47], v[72:75]
  v_mfma_f32_16x16x32_bf16 v[76:79], v[128:131], a[48:51], v[76:79]
  v_mfma_f32_16x16x32_bf16 v[80:83], v[128:131], a[52:55], v[80:83]
  v_mfma_f32_16x16x32_bf16 v[84:87], v[128:131], a[56:59], v[84:87]
  v_mfma_f32_16x16x32_bf16 v[88:91], v[128:131], a[60:63], v[88:91]
  s_waitcnt lgkmcnt(2)
  v_mfma_f32_16x16x32_bf16 v[60:63], v[132:135], a[64:67], v[60:63]
  v_mfma_f32_16x16x32_bf16 v[64:67], v[132:135], a[68:71], v[64:67]
  ds_read_b128 v[128:131], v48 offset:9216
  v_mfma_f32_16x16x32_bf16 v[68:71], v[132:135], a[72:75], v[68:71]
  v_mfma_f32_16x16x32_bf16 v[72:75], v[132:135], a[76:79], v[72:75]
  v_mfma_f32_16x16x32_bf16 v[76:79], v[132:135], a[80:83], v[76:79]
  v_mfma_f32_16x16x32_bf16 v[80:83], v[132:135], a[84:87], v[80:83]
  v_mfma_f32_16x16x32_bf16 v[84:87], v[132:135], a[88:91], v[84:87]
  v_mfma_f32_16x16x32_bf16 v[88:91], v[132:135], a[92:95], v[88:91]
  s_waitcnt lgkmcnt(2)
  v_mfma_f32_16x16x32_bf16 v[60:63], v[136:139], a[96:99], v[60:63]
  v_mfma_f32_16x16x32_bf16 v[64:67], v[136:139], a[100:103], v[64:67]
  ds_read_b128 v[132:135], v48 offset:10240
  v_mfma_f32_16x16x32_bf16 v[68:71], v[136:139], a[104:107], v[68:71]
  v_mfma_f32_16x16x32_bf16 v[72:75], v[136:139], a[108:111], v[72:75]
  s_and_b32 s32, s64, 0xff
  s_lshl_b32 s32, s32, 4
  s_add_u32 s32, s32, s61
  s_lshl_b32 s32, s32, 2
  s_add_u32 s32, s32, s17
  s_lshl_b32 s33, s32, 12
  v_mfma_f32_16x16x32_bf16 v[76:79], v[136:139], a[112:115], v[76:79]
  v_mfma_f32_16x16x32_bf16 v[80:83], v[136:139], a[116:119], v[80:83]
  s_add_u32 s33, s33, 142606336
  s_lshl_b32 s32, s32, 13
  s_add_u32 s32, s32, 41943040
  s_add_u32 s32, s32, s87
  s_add_u32 s33, s33, s87
  s_xor_b32 s34, s84, 114688
  v_mfma_f32_16x16x32_bf16 v[84:87], v[136:139], a[120:123], v[84:87]
  v_mfma_f32_16x16x32_bf16 v[88:91], v[136:139], a[124:127], v[88:91]
  s_lshl_b32 s35, s17, 12
  s_add_u32 s34, s34, s35
  s_add_u32 m0, s34, 32768
  s_add_u32 s34, s34, s35
  buffer_load_dwordx4 v0, s[4:7], s33 offen offset:0 sc1 lds
  s_waitcnt lgkmcnt(2)
  v_mfma_f32_16x16x32_bf16 v[60:63], v[124:127], a[128:131], v[60:63]
  v_mfma_f32_16x16x32_bf16 v[64:67], v[124:127], a[132:135], v[64:67]
  ds_read_b128 v[136:139], v48 offset:11264
  v_mfma_f32_16x16x32_bf16 v[68:71], v[124:127], a[136:139], v[68:71]
  v_mfma_f32_16x16x32_bf16 v[72:75], v[124:127], a[140:143], v[72:75]
  buffer_load_dwordx4 v0, s[4:7], s33 offen offset:1024 sc1 lds
  v_mfma_f32_16x16x32_bf16 v[76:79], v[124:127], a[144:147], v[76:79]
  v_mfma_f32_16x16x32_bf16 v[80:83], v[124:127], a[148:151], v[80:83]
  buffer_load_dwordx4 v0, s[4:7], s33 offen offset:2048 sc1 lds
  v_mfma_f32_16x16x32_bf16 v[84:87], v[124:127], a[152:155], v[84:87]
  v_mfma_f32_16x16x32_bf16 v[88:91], v[124:127], a[156:159], v[88:91]
  buffer_load_dwordx4 v0, s[4:7], s33 offen offset:3072 sc1 lds
  s_waitcnt lgkmcnt(2)
  v_mfma_f32_16x16x32_bf16 v[60:63], v[128:131], a[160:163], v[60:63]
  v_mfma_f32_16x16x32_bf16 v[64:67], v[128:131], a[164:167], v[64:67]
  ds_read_b128 v[124:127], v48 offset:4096
  v_mfma_f32_16x16x32_bf16 v[68:71], v[128:131], a[168:171], v[68:71]
  v_mfma_f32_16x16x32_bf16 v[72:75], v[128:131], a[172:175], v[72:75]
  s_add_u32 m0, s34, 0
  s_nop 0
  buffer_load_dwordx4 v0, s[4:7], s32 offen offset:0 sc1 lds
  v_mfma_f32_16x16x32_bf16 v[76:79], v[128:131], a[176:179], v[76:79]
  v_mfma_f32_16x16x32_bf16 v[80:83], v[128:131], a[180:183], v[80:83]
  buffer_load_dwordx4 v0, s[4:7], s32 offen offset:1024 sc1 lds
  v_mfma_f32_16x16x32_bf16 v[84:87], v[128:131], a[184:187], v[84:87]
  v_mfma_f32_16x16x32_bf16 v[88:91], v[128:131], a[188:191], v[88:91]
  buffer_load_dwordx4 v0, s[4:7], s32 offen offset:2048 sc1 lds
  s_waitcnt lgkmcnt(2)
  v_mfma_f32_16x16x32_bf16 v[60:63], v[132:135], a[192:195], v[60:63]
  v_mfma_f32_16x16x32_bf16 v[64:67], v[132:135], a[196:199], v[64:67]
  ds_read_b128 v[128:131], v48 offset:5120
  v_mfma_f32_16x16x32_bf16 v[68:71], v[132:135], a[200:203], v[68:71]
  v_mfma_f32_16x16x32_bf16 v[72:75], v[132:135], a[204:207], v[72:75]
  buffer_load_dwordx4 v0, s[4:7], s32 offen offset:3072 sc1 lds
  v_mfma_f32_16x16x32_bf16 v[76:79], v[132:135], a[208:211], v[76:79]
  v_mfma_f32_16x16x32_bf16 v[80:83], v[132:135], a[212:215], v[80:83]
  s_add_u32 m0, s34, 4096
  s_add_u32 s32, s32, 4096
  buffer_load_dwordx4 v0, s[4:7], s32 offen offset:0 sc1 lds
  v_mfma_f32_16x16x32_bf16 v[84:87], v[132:135], a[216:219], v[84:87]
  v_mfma_f32_16x16x32_bf16 v[88:91], v[132:135], a[220:223], v[88:91]
  buffer_load_dwordx4 v0, s[4:7], s32 offen offset:1024 sc1 lds
  s_waitcnt lgkmcnt(2)
  v_mfma_f32_16x16x32_bf16 v[60:63], v[136:139], a[224:227], v[60:63]
  v_mfma_f32_16x16x32_bf16 v[64:67], v[136:139], a[228:231], v[64:67]
  ds_read_b128 v[132:135], v48 offset:6144
  v_mfma_f32_16x16x32_bf16 v[68:71], v[136:139], a[232:235], v[68:71]
  v_mfma_f32_16x16x32_bf16 v[72:75], v[136:139], a[236:239], v[72:75]
  buffer_load_dwordx4 v0, s[4:7], s32 offen offset:2048 sc1 lds
  v_mfma_f32_16x16x32_bf16 v[76:79], v[136:139], a[240:243], v[76:79]
  v_mfma_f32_16x16x32_bf16 v[80:83], v[136:139], a[244:247], v[80:83]
  buffer_load_dwordx4 v0, s[4:7], s32 offen offset:3072 sc1 lds
  v_mfma_f32_16x16x32_bf16 v[84:87], v[136:139], a[248:251], v[84:87]
  v_mfma_f32_16x16x32_bf16 v[88:91], v[136:139], a[252:255], v[88:91]
  s_and_b32 s32, s64, 63
  s_lshl_b32 s32, s32, 5
  s_add_u32 s32, s32, s85
  s_bfe_u32 s33, s64, 131080
  s_lshl_b32 s33, s33, 11
  s_add_u32 s32, s32, s33
  s_waitcnt lgkmcnt(2)
  v_mfma_f32_16x16x32_bf16 v[92:95], v[124:127], a[0:3], 0
  v_mfma_f32_16x16x32_bf16 v[96:99], v[124:127], a[4:7], 0
  ds_read_b128 v[136:139], v48 offset:7168
  v_mfma_f32_16x16x32_bf16 v[100:103], v[124:127], a[8:11], 0
  v_mfma_f32_16x16x32_bf16 v[104:107], v[124:127], a[12:15], 0
  s_lshl_b32 s32, s32, 13
  s_add_u32 s32, s32, 192937984
  s_add_u32 s32, s32, s88
  s_add_u32 s33, s32, 4096
  buffer_load_dwordx4 v[24:27], v0, s[4:7], s32 offen offset:0 sc1
  v_mfma_f32_16x16x32_bf16 v[108:111], v[124:127], a[16:19], 0
  v_mfma_f32_16x16x32_bf16 v[112:115], v[124:127], a[20:23], 0
  buffer_load_dwordx4 v[28:31], v0, s[4:7], s32 offen offset:2048 sc1
  v_mfma_f32_16x16x32_bf16 v[116:119], v[124:127], a[24:27], 0
  v_mfma_f32_16x16x32_bf16 v[120:123], v[124:127], a[28:31], 0
  buffer_load_dwordx4 v[32:35], v0, s[4:7], s33 offen offset:0 sc1
  s_waitcnt lgkmcnt(2)
  v_mfma_f32_16x16x32_bf16 v[92:95], v[128:131], a[32:35], v[92:95]
  v_mfma_f32_16x16x32_bf16 v[96:99], v[128:131], a[36:39], v[96:99]
  ds_read_b128 v[124:127], v48 offset:12288
  v_mfma_f32_16x16x32_bf16 v[100:103], v[128:131], a[40:43], v[100:103]
  v_mfma_f32_16x16x32_bf16 v[104:107], v[128:131], a[44:47], v[104:107]
  buffer_load_dwordx4 v[36:39], v0, s[4:7], s33 offen offset:2048 sc1
  v_mfma_f32_16x16x32_bf16 v[108:111], v[128:131], a[48:51], v[108:111]
  v_mfma_f32_16x16x32_bf16 v[112:115], v[128:131], a[52:55], v[112:115]
  buffer_load_dwordx2 v[40:41], v1, s[4:7], s32 offen offset:1024 sc1
  v_mfma_f32_16x16x32_bf16 v[116:119], v[128:131], a[56:59], v[116:119]
  v_mfma_f32_16x16x32_bf16 v[120:123], v[128:131], a[60:63], v[120:123]
  buffer_load_dwordx2 v[42:43], v1, s[4:7], s32 offen offset:3072 sc1
  s_waitcnt lgkmcnt(2)
  v_mfma_f32_16x16x32_bf16 v[92:95], v[132:135], a[64:67], v[92:95]
  v_mfma_f32_16x16x32_bf16 v[96:99], v[132:135], a[68:71], v[96:99]
  ds_read_b128 v[128:131], v48 offset:13312
  v_mfma_f32_16x16x32_bf16 v[100:103], v[132:135], a[72:75], v[100:103]
  v_mfma_f32_16x16x32_bf16 v[104:107], v[132:135], a[76:79], v[104:107]
  buffer_load_dwordx2 v[44:45], v1, s[4:7], s33 offen offset:1024 sc1
  v_mfma_f32_16x16x32_bf16 v[108:111], v[132:135], a[80:83], v[108:111]
  v_mfma_f32_16x16x32_bf16 v[112:115], v[132:135], a[84:87], v[112:115]
  buffer_load_dwordx2 v[46:47], v1, s[4:7], s33 offen offset:3072 sc1
  v_mfma_f32_16x16x32_bf16 v[116:119], v[132:135], a[88:91], v[116:119]
  v_mfma_f32_16x16x32_bf16 v[120:123], v[132:135], a[92:95], v[120:123]
  v_cvt_pk_bf16_f32 v140, v60, v64
  v_cvt_pk_bf16_f32 v141, v68, v72
  s_waitcnt lgkmcnt(2)
  v_mfma_f32_16x16x32_bf16 v[92:95], v[136:139], a[96:99], v[92:95]
  v_mfma_f32_16x16x32_bf16 v[96:99], v[136:139], a[100:103], v[96:99]
  ds_read_b128 v[132:135], v48 offset:14336
  v_mfma_f32_16x16x32_bf16 v[100:103], v[136:139], a[104:107], v[100:103]
  v_mfma_f32_16x16x32_bf16 v[104:107], v[136:139], a[108:111], v[104:107]
  v_cvt_pk_bf16_f32 v142, v76, v80
  v_cvt_pk_bf16_f32 v143, v84, v88
  v_mfma_f32_16x16x32_bf16 v[108:111], v[136:139], a[112:115], v[108:111]
  v_mfma_f32_16x16x32_bf16 v[112:115], v[136:139], a[116:119], v[112:115]
  s_add_u32 s26, s86, 0
  buffer_store_dwordx4 v[140:143], v4, s[4:7], s26 offen sc1
  v_mfma_f32_16x16x32_bf16 v[116:119], v[136:139], a[120:123], v[116:119]
  v_mfma_f32_16x16x32_bf16 v[120:123], v[136:139], a[124:127], v[120:123]
  v_cvt_pk_bf16_f32 v144, v61, v65
  v_cvt_pk_bf16_f32 v145, v69, v73
  s_waitcnt lgkmcnt(2)
  v_mfma_f32_16x16x32_bf16 v[92:95], v[124:127], a[128:131], v[92:95]
  v_mfma_f32_16x16x32_bf16 v[96:99], v[124:127], a[132:135], v[96:99]
  ds_read_b128 v[136:139], v48 offset:15360
  v_mfma_f32_16x16x32_bf16 v[100:103], v[124:127], a[136:139], v[100:103]
  v_mfma_f32_16x16x32_bf16 v[104:107], v[124:127], a[140:143], v[104:107]
  v_cvt_pk_bf16_f32 v146, v77, v81
  v_cvt_pk_bf16_f32 v147, v85, v89
  v_mfma_f32_16x16x32_bf16 v[108:111], v[124:127], a[144:147], v[108:111]
  v_mfma_f32_16x16x32_bf16 v[112:115], v[124:127], a[148:151], v[112:115]
  s_add_u32 s26, s86, 16384
  buffer_store_dwordx4 v[144:147], v4, s[4:7], s26 offen sc1
  v_mfma_f32_16x16x32_bf16 v[116:119], v[124:127], a[152:155], v[116:119]
  v_mfma_f32_16x16x32_bf16 v[120:123], v[124:127], a[156:159], v[120:123]
  v_cvt_pk_bf16_f32 v148, v62, v66
  v_cvt_pk_bf16_f32 v149, v70, v74
  s_waitcnt lgkmcnt(2)
  v_mfma_f32_16x16x32_bf16 v[92:95], v[128:131], a[160:163], v[92:95]
  v_mfma_f32_16x16x32_bf16 v[96:99], v[128:131], a[164:167], v[96:99]
  v_cvt_pk_bf16_f32 v150, v78, v82
  v_cvt_pk_bf16_f32 v151, v86, v90
  v_mfma_f32_16x16x32_bf16 v[100:103], v[128:131], a[168:171], v[100:103]
  v_mfma_f32_16x16x32_bf16 v[104:107], v[128:131], a[172:175], v[104:107]
  s_add_u32 s26, s86, 32768
  buffer_store_dwordx4 v[148:151], v4, s[4:7], s26 offen sc1
  v_mfma_f32_16x16x32_bf16 v[108:111], v[128:131], a[176:179], v[108:111]
  v_mfma_f32_16x16x32_bf16 v[112:115], v[128:131], a[180:183], v[112:115]
  v_cvt_pk_bf16_f32 v152, v63, v67
  v_cvt_pk_bf16_f32 v153, v71, v75
  v_mfma_f32_16x16x32_bf16 v[116:119], v[128:131], a[184:187], v[116:119]
  v_mfma_f32_16x16x32_bf16 v[120:123], v[128:131], a[188:191], v[120:123]
  v_cvt_pk_bf16_f32 v154, v79, v83
  v_cvt_pk_bf16_f32 v155, v87, v91
  s_waitcnt lgkmcnt(1)
  v_mfma_f32_16x16x32_bf16 v[92:95], v[132:135], a[192:195], v[92:95]
  v_mfma_f32_16x16x32_bf16 v[96:99], v[132:135], a[196:199], v[96:99]
  s_add_u32 s26, s86, 49152
  buffer_store_dwordx4 v[152:155], v4, s[4:7], s26 offen sc1
  v_mfma_f32_16x16x32_bf16 v[100:103], v[132:135], a[200:203], v[100:103]
  v_mfma_f32_16x16x32_bf16 v[104:107], v[132:135], a[204:207], v[104:107]
  v_mfma_f32_16x16x32_bf16 v[108:111], v[132:135], a[208:211], v[108:111]
  v_mfma_f32_16x16x32_bf16 v[112:115], v[132:135], a[212:215], v[112:115]
  v_mfma_f32_16x16x32_bf16 v[116:119], v[132:135], a[216:219], v[116:119]
  v_mfma_f32_16x16x32_bf16 v[120:123], v[132:135], a[220:223], v[120:123]
  s_waitcnt lgkmcnt(0)
  v_mfma_f32_16x16x32_bf16 v[92:95], v[136:139], a[224:227], v[92:95]
  v_mfma_f32_16x16x32_bf16 v[96:99], v[136:139], a[228:231], v[96:99]
  v_mfma_f32_16x16x32_bf16 v[100:103], v[136:139], a[232:235], v[100:103]
  v_mfma_f32_16x16x32_bf16 v[104:107], v[136:139], a[236:239], v[104:107]
  v_mfma_f32_16x16x32_bf16 v[108:111], v[136:139], a[240:243], v[108:111]
  v_mfma_f32_16x16x32_bf16 v[112:115], v[136:139], a[244:247], v[112:115]
  v_mfma_f32_16x16x32_bf16 v[116:119], v[136:139], a[248:251], v[116:119]
  v_mfma_f32_16x16x32_bf16 v[120:123], v[136:139], a[252:255], v[120:123]
  s_nop 0
  s_nop 0
  v_cvt_pk_bf16_f32 v140, v92, v96
  s_nop 0
  v_cvt_pk_bf16_f32 v141, v100, v104
  s_nop 0
  v_cvt_pk_bf16_f32 v142, v108, v112
  s_nop 0
  v_cvt_pk_bf16_f32 v143, v116, v120
  s_add_u32 s26, s86, 262144
  buffer_store_dwordx4 v[140:143], v4, s[4:7], s26 offen sc1
  v_cvt_pk_bf16_f32 v144, v93, v97
  v_cvt_pk_bf16_f32 v145, v101, v105
  v_cvt_pk_bf16_f32 v146, v109, v113
  v_cvt_pk_bf16_f32 v147, v117, v121
  s_add_u32 s26, s86, 278528
  buffer_store_dwordx4 v[144:147], v4, s[4:7], s26 offen sc1
  v_cvt_pk_bf16_f32 v148, v94, v98
  v_cvt_pk_bf16_f32 v149, v102, v106
  v_cvt_pk_bf16_f32 v150, v110, v114
  v_cvt_pk_bf16_f32 v151, v118, v122
  s_add_u32 s26, s86, 294912
  buffer_store_dwordx4 v[148:151], v4, s[4:7], s26 offen sc1
  v_cvt_pk_bf16_f32 v152, v95, v99
  v_cvt_pk_bf16_f32 v153, v103, v107
  v_cvt_pk_bf16_f32 v154, v111, v115
  v_cvt_pk_bf16_f32 v155, v119, v123
  s_add_u32 s26, s86, 311296
  buffer_store_dwordx4 v[152:155], v4, s[4:7], s26 offen sc1
  s_waitcnt vmcnt(8)
  s_branch o_we_126
o_wr1_124:
  s_and_b32 s26, s65, 768
  s_cbranch_scc1 o_wr2_125
  ds_read_b128 v[56:59], v54
  ds_read_b128 v[124:127], v48 offset:0
  ds_read_b128 v[128:131], v48 offset:1024
  ds_read_b128 v[132:135], v48 offset:2048
  s_lshl_b32 s90, s61, 1
  s_add_u32 s90, s90, s17
  s_and_b32 s94, s95, 1
  s_lshl_b32 s94, s94, 5
  s_add_u32 s94, s94, s90
  s_lshl_b32 s94, s94, 14
  s_lshl_b32 s92, s60, 21
  s_add_u32 s94, s94, s92
  s_add_u32 s94, s94, 12582912
  buffer_load_dwordx4 v[156:159], v5, s[4:7], s94 offen offset:0 sc1
  buffer_load_dwordx4 v[160:163], v5, s[4:7], s94 offen offset:256 sc1
  buffer_load_dwordx4 v[164:167], v5, s[4:7], s94 offen offset:512 sc1
  buffer_load_dwordx4 v[168:171], v5, s[4:7], s94 offen offset:768 sc1
  s_add_u32 s94, s94, 4096
  buffer_load_dwordx4 v[172:175], v5, s[4:7], s94 offen offset:0 sc1
  buffer_load_dwordx4 v[176:179], v5, s[4:7], s94 offen offset:256 sc1
  buffer_load_dwordx4 v[180:183], v5, s[4:7], s94 offen offset:512 sc1
  buffer_load_dwordx4 v[184:187], v5, s[4:7], s94 offen offset:768 sc1
  s_add_u32 s94, s94, 4096
  buffer_load_dwordx4 v[188:191], v5, s[4:7], s94 offen offset:0 sc1
  buffer_load_dwordx4 v[192:195], v5, s[4:7], s94 offen offset:256 sc1
  buffer_load_dwordx4 v[196:199], v5, s[4:7], s94 offen offset:512 sc1
  buffer_load_dwordx4 v[200:203], v5, s[4:7], s94 offen offset:768 sc1
  s_add_u32 s94, s94, 4096
  buffer_load_dwordx4 v[204:207], v5, s[4:7], s94 offen offset:0 sc1
  buffer_load_dwordx4 v[208:211], v5, s[4:7], s94 offen offset:256 sc1
  buffer_load_dwordx4 v[212:215], v5, s[4:7], s94 offen offset:512 sc1
  buffer_load_dwordx4 v[216:219], v5, s[4:7], s94 offen offset:768 sc1
  s_and_b32 s91, s65, 63
  s_lshl_b32 s94, s91, 11
  s_lshl_b32 s91, s91, 5
  s_add_u32 s90, s90, s91
  s_lshl_b32 s91, s90, 10
  buffer_load_dwordx4 v[220:223], v0, s[72:75], s91 offen
  s_waitcnt lgkmcnt(2)
  v_mfma_f32_16x16x32_bf16 v[60:63], v[124:127], a[0:3], 0
  v_mfma_f32_16x16x32_bf16 v[64:67], v[124:127], a[4:7], 0
  ds_read_b128 v[136:139], v48 offset:3072
  v_mfma_f32_16x16x32_bf16 v[68:71], v[124:127], a[8:11], 0
  v_mfma_f32_16x16x32_bf16 v[72:75], v[124:127], a[12:15], 0
  v_and_b32 v56, v56, v57
  v_and_b32 v58, v58, v59
  v_mfma_f32_16x16x32_bf16 v[76:79], v[124:127], a[16:19], 0
  v_mfma_f32_16x16x32_bf16 v[80:83], v[124:127], a[20:23], 0
  v_and_b32 v56, v56, v58
  s_bfe_u32 s26, s64, 131086
  v_readfirstlane_b32 s27, v56
  v_mfma_f32_16x16x32_bf16 v[84:87], v[124:127], a[24:27], 0
  v_mfma_f32_16x16x32_bf16 v[88:91], v[124:127], a[28:31], 0
  s_cmp_eq_u32 s26, 1
  s_cselect_b32 s66, s27, 0
  s_and_b32 s66, s66, 1
  s_cselect_b32 s87, 0, 268435456
  s_cmp_lg_u32 s26, 0
  s_cselect_b32 s76, s27, 0
  s_and_b32 s76, s76, 2
  s_cselect_b32 s88, 0, 268435456
  s_waitcnt lgkmcnt(2)
  v_mfma_f32_16x16x32_bf16 v[60:63], v[128:131], a[32:35], v[60:63]
  v_mfma_f32_16x16x32_bf16 v[64:67], v[128:131], a[36:39], v[64:67]
  ds_read_b128 v[124:127], v48 offset:8192
  v_mfma_f32_16x16x32_bf16 v[68:71], v[128:131], a[40:43], v[68:71]
  v_mfma_f32_16x16x32_bf16 v[72:75], v[128:131], a[44:47], v[72:75]
  s_waitcnt vmcnt(16)
  v_mfma_f32_16x16x32_bf16 v[224:227], v[16:19], v[156:159], 0
  s_waitcnt vmcnt(15)
  v_mfma_f32_16x16x32_bf16 v[228:231], v[16:19], v[160:163], 0
  v_mfma_f32_16x16x32_bf16 v[76:79], v[128:131], a[48:51], v[76:79]
  s_waitcnt vmcnt(14)
  v_mfma_f32_16x16x32_bf16 v[224:227], v[20:23], v[164:167], v[224:227]
  s_waitcnt vmcnt(13)
  v_mfma_f32_16x16x32_bf16 v[228:231], v[20:23], v[168:171], v[228:231]
  v_mfma_f32_16x16x32_bf16 v[80:83], v[128:131], a[52:55], v[80:83]
  s_waitcnt vmcnt(12)
  v_mfma_f32_16x16x32_bf16 v[224:227], v[16:19], v[172:175], v[224:227]
  s_waitcnt vmcnt(11)
  v_mfma_f32_16x16x32_bf16 v[228:231], v[16:19], v[176:179], v[228:231]
  v_mfma_f32_16x16x32_bf16 v[84:87], v[128:131], a[56:59], v[84:87]
  s_waitcnt vmcnt(10)
  v_mfma_f32_16x16x32_bf16 v[224:227], v[20:23], v[180:183], v[224:227]
  s_waitcnt vmcnt(9)
  v_mfma_f32_16x16x32_bf16 v[228:231], v[20:23], v[184:187], v[228:231]
  v_mfma_f32_16x16x32_bf16 v[88:91], v[128:131], a[60:63], v[88:91]
  s_waitcnt vmcnt(8)
  v_mfma_f32_16x16x32_bf16 v[224:227], v[16:19], v[188:191], v[224:227]
  s_waitcnt vmcnt(7)
  v_mfma_f32_16x16x32_bf16 v[228:231], v[16:19], v[192:195], v[228:231]
  s_waitcnt lgkmcnt(2)
  v_mfma_f32_16x16x32_bf16 v[60:63], v[132:135], a[64:67], v[60:63]
  s_waitcnt vmcnt(6)
  v_mfma_f32_16x16x32_bf16 v[224:227], v[20:23], v[196:199], v[224:227]
  s_waitcnt vmcnt(5)
  v_mfma_f32_16x16x32_bf16 v[228:231], v[20:23], v[200:203], v[228:231]
  v_mfma_f32_16x16x32_bf16 v[64:67], v[132:135], a[68:71], v[64:67]
  ds_read_b128 v[128:131], v48 offset:9216
  v_mfma_f32_16x16x32_bf16 v[68:71], v[132:135], a[72:75], v[68:71]
  s_waitcnt vmcnt(4)
  v_mfma_f32_16x16x32_bf16 v[224:227], v[16:19], v[204:207], v[224:227]
  s_waitcnt vmcnt(3)
  v_mfma_f32_16x16x32_bf16 v[228:231], v[16:19], v[208:211], v[228:231]
  v_mfma_f32_16x16x32_bf16 v[72:75], v[132:135], a[76:79], v[72:75]
  s_waitcnt vmcnt(2)
  v_mfma_f32_16x16x32_bf16 v[224:227], v[20:23], v[212:215], v[224:227]
  s_waitcnt vmcnt(1)
  v_mfma_f32_16x16x32_bf16 v[228:231], v[20:23], v[216:219], v[228:231]
  v_mfma_f32_16x16x32_bf16 v[76:79], v[132:135], a[80:83], v[76:79]
  s_bfe_u32 s92, s65, 131080
  s_lshl_b32 s92, s92, 21
  s_add_u32 s92, s92, s91
  s_add_u32 s93, s92, 27262976
  s_add_u32 s92, s92, 20971520
  s_waitcnt vmcnt(0)
  v_lshlrev_b32 v232, 16, v220
  v_mfma_f32_16x16x32_bf16 v[80:83], v[132:135], a[84:87], v[80:83]
  v_and_b32 v233, 0xffff0000, v220
  v_lshlrev_b32 v234, 16, v221
  v_and_b32 v235, 0xffff0000, v221
  v_mfma_f32_16x16x32_bf16 v[84:87], v[132:135], a[88:91], v[84:87]
  v_lshlrev_b32 v236, 16, v222
  v_and_b32 v237, 0xffff0000, v222
  v_lshlrev_b32 v238, 16, v223
  v_mfma_f32_16x16x32_bf16 v[88:91], v[132:135], a[92:95], v[88:91]
  v_and_b32 v239, 0xffff0000, v223
  v_permlane16_swap_b32 v224, v228
  v_permlane16_swap_b32 v225, v229
  s_waitcnt lgkmcnt(2)
  v_mfma_f32_16x16x32_bf16 v[60:63], v[136:139], a[96:99], v[60:63]
  v_permlane16_swap_b32 v226, v230
  v_permlane16_swap_b32 v227, v231
  v_cvt_pk_bf16_f32 v224, 0, v224
  v_mfma_f32_16x16x32_bf16 v[64:67], v[136:139], a[100:103], v[64:67]
  ds_read_b128 v[132:135], v48 offset:10240
  v_mfma_f32_16x16x32_bf16 v[68:71], v[136:139], a[104:107], v[68:71]
  v_cvt_pk_bf16_f32 v225, 0, v225
  v_cvt_pk_bf16_f32 v226, 0, v226
  v_cvt_pk_bf16_f32 v227, 0, v227
  v_mfma_f32_16x16x32_bf16 v[72:75], v[136:139], a[108:111], v[72:75]
  s_and_b32 s32, s64, 0xff
  s_lshl_b32 s32, s32, 4
  s_add_u32 s32, s32, s61
  s_lshl_b32 s32, s32, 2
  s_add_u32 s32, s32, s17
  s_lshl_b32 s33, s32, 12
  v_cvt_pk_bf16_f32 v228, 0, v228
  v_mfma_f32_16x16x32_bf16 v[76:79], v[136:139], a[112:115], v[76:79]
  v_cvt_pk_bf16_f32 v229, 0, v229
  v_cvt_pk_bf16_f32 v230, 0, v230
  v_cvt_pk_bf16_f32 v231, 0, v231
  v_mfma_f32_16x16x32_bf16 v[80:83], v[136:139], a[116:119], v[80:83]
  s_add_u32 s33, s33, 142606336
  s_lshl_b32 s32, s32, 13
  s_add_u32 s32, s32, 41943040
  s_add_u32 s32, s32, s87
  s_add_u32 s33, s33, s87
  s_xor_b32 s34, s84, 114688
  v_add_f32 v232, v232, v224
  v_mfma_f32_16x16x32_bf16 v[84:87], v[136:139], a[120:123], v[84:87]
  v_add_f32 v233, v233, v225
  v_add_f32 v234, v234, v226
  v_add_f32 v235, v235, v227
  v_mfma_f32_16x16x32_bf16 v[88:91], v[136:139], a[124:127], v[88:91]
  s_lshl_b32 s35, s17, 12
  s_add_u32 s34, s34, s35
  s_add_u32 m0, s34, 32768
  s_add_u32 s34, s34, s35
  buffer_load_dwordx4 v0, s[4:7], s33 offen offset:0 sc1 lds
  s_waitcnt lgkmcnt(2)
  v_mfma_f32_16x16x32_bf16 v[60:63], v[124:127], a[128:131], v[60:63]
  v_add_f32 v236, v236, v228
  v_add_f32 v237, v237, v229
  v_add_f32 v238, v238, v230
  v_mfma_f32_16x16x32_bf16 v[64:67], v[124:127], a[132:135], v[64:67]
  ds_read_b128 v[136:139], v48 offset:11264
  v_mfma_f32_16x16x32_bf16 v[68:71], v[124:127], a[136:139], v[68:71]
  v_add_f32 v239, v239, v231
  v_cvt_pk_bf16_f32 v156, v232, v233
  v_cvt_pk_bf16_f32 v157, v234, v235
  v_mfma_f32_16x16x32_bf16 v[72:75], v[124:127], a[140:143], v[72:75]
  buffer_load_dwordx4 v0, s[4:7], s33 offen offset:1024 sc1 lds
  v_cvt_pk_bf16_f32 v158, v236, v237
  v_mfma_f32_16x16x32_bf16 v[76:79], v[124:127], a[144:147], v[76:79]
  v_cvt_pk_bf16_f32 v159, v238, v239
  v_lshlrev_b32 v232, 16, v156
  v_and_b32 v233, 0xffff0000, v156
  v_mfma_f32_16x16x32_bf16 v[80:83], v[124:127], a[148:151], v[80:83]
  buffer_load_dwordx4 v0, s[4:7], s33 offen offset:2048 sc1 lds
  v_lshlrev_b32 v234, 16, v157
  v_mfma_f32_16x16x32_bf16 v[84:87], v[124:127], a[152:155], v[84:87]
  v_and_b32 v235, 0xffff0000, v157
  v_lshlrev_b32 v236, 16, v158
  v_and_b32 v237, 0xffff0000, v158
  v_mfma_f32_16x16x32_bf16 v[88:91], v[124:127], a[156:159], v[88:91]
  buffer_load_dwordx4 v0, s[4:7], s33 offen offset:3072 sc1 lds
  v_lshlrev_b32 v238, 16, v159
  s_waitcnt lgkmcnt(2)
  v_mfma_f32_16x16x32_bf16 v[60:63], v[128:131], a[160:163], v[60:63]
  v_and_b32 v239, 0xffff0000, v159
  buffer_store_dwordx4 v[156:159], v0, s[4:7], s92 offen sc1
  v_mfma_f32_16x16x32_bf16 v[64:67], v[128:131], a[164:167], v[64:67]
  ds_read_b128 v[124:127], v48 offset:4096
  v_mfma_f32_16x16x32_bf16 v[68:71], v[128:131], a[168:171], v[68:71]
  v_add_f32 v172, v232, v233
  v_add_f32 v173, v234, v235
  v_add_f32 v174, v236, v237
  v_mfma_f32_16x16x32_bf16 v[72:75], v[128:131], a[172:175], v[72:75]
  s_add_u32 m0, s34, 0
  s_nop 0
  buffer_load_dwordx4 v0, s[4:7], s32 offen offset:0 sc1 lds
  v_add_f32 v175, v238, v239
  v_mfma_f32_16x16x32_bf16 v[76:79], v[128:131], a[176:179], v[76:79]
  v_add_f32 v172, v172, v173
  v_add_f32 v174, v174, v175
  v_add_f32 v172, v172, v174
  v_mfma_f32_16x16x32_bf16 v[80:83], v[128:131], a[180:183], v[80:83]
  buffer_load_dwordx4 v0, s[4:7], s32 offen offset:1024 sc1 lds
  v_add_f32_dpp v172, v172, v172 row_ror:8 row_mask:0xf bank_mask:0xf
  v_mfma_f32_16x16x32_bf16 v[84:87], v[128:131], a[184:187], v[84:87]
  s_nop 0
  v_add_f32_dpp v172, v172, v172 row_ror:4 row_mask:0xf bank_mask:0xf
  s_nop 1
  v_add_f32_dpp v172, v172, v172 row_ror:2 row_mask:0xf bank_mask:0xf
  s_nop 1
  v_add_f32_dpp v172, v172, v172 row_ror:1 row_mask:0xf bank_mask:0xf
  v_mfma_f32_16x16x32_bf16 v[88:91], v[128:131], a[188:191], v[88:91]
  buffer_load_dwordx4 v0, s[4:7], s32 offen offset:2048 sc1 lds
  v_mov_b32 v174, v172
  s_waitcnt lgkmcnt(2)
  v_mfma_f32_16x16x32_bf16 v[60:63], v[132:135], a[192:195], v[60:63]
  v_permlane16_swap_b32 v172, v174
  v_add_f32 v172, v172, v174
  v_mov_b32 v174, v172
  v_mfma_f32_16x16x32_bf16 v[64:67], v[132:135], a[196:199], v[64:67]
  ds_read_b128 v[128:131], v48 offset:5120
  v_mfma_f32_16x16x32_bf16 v[68:71], v[132:135], a[200:203], v[68:71]
  v_permlane32_swap_b32 v172, v174
  v_add_f32 v172, v172, v174
  v_mul_f32 v172, 0x3b000000, v172
  v_mfma_f32_16x16x32_bf16 v[72:75], v[132:135], a[204:207], v[72:75]
  buffer_load_dwordx4 v0, s[4:7], s32 offen offset:3072 sc1 lds
  v_sub_f32 v176, v232, v172
  v_mfma_f32_16x16x32_bf16 v[76:79], v[132:135], a[208:211], v[76:79]
  v_sub_f32 v177, v233, v172
  v_sub_f32 v178, v234, v172
  v_sub_f32 v179, v235, v172
  v_mfma_f32_16x16x32_bf16 v[80:83], v[132:135], a[212:215], v[80:83]
  s_add_u32 m0, s34, 4096
  s_add_u32 s32, s32, 4096
  buffer_load_dwordx4 v0, s[4:7], s32 offen offset:0 sc1 lds
  v_sub_f32 v180, v236, v172
  v_mfma_f32_16x16x32_bf16 v[84:87], v[132:135], a[216:219], v[84:87]
  v_sub_f32 v181, v237, v172
  v_sub_f32 v182, v238, v172
  v_sub_f32 v183, v239, v172
  v_mfma_f32_16x16x32_bf16 v[88:91], v[132:135], a[220:223], v[88:91]
  buffer_load_dwordx4 v0, s[4:7], s32 offen offset:1024 sc1 lds
  v_mul_f32 v173, v176, v176
  s_waitcnt lgkmcnt(2)
  v_mfma_f32_16x16x32_bf16 v[60:63], v[136:139], a[224:227], v[60:63]
  v_mul_f32 v174, v177, v177
  v_fmac_f32 v173, v178, v178
  v_fmac_f32 v174, v179, v179
  v_mfma_f32_16x16x32_bf16 v[64:67], v[136:139], a[228:231], v[64:67]
  ds_read_b128 v[132:135], v48 offset:6144
  v_mfma_f32_16x16x32_bf16 v[68:71], v[136:139], a[232:235], v[68:71]
  v_fmac_f32 v173, v180, v180
  v_fmac_f32 v174, v181, v181
  v_fmac_f32 v173, v182, v182
  v_mfma_f32_16x16x32_bf16 v[72:75], v[136:139], a[236:239], v[72:75]
  buffer_load_dwordx4 v0, s[4:7], s32 offen offset:2048 sc1 lds
  v_fmac_f32 v174, v183, v183
  v_mfma_f32_16x16x32_bf16 v[76:79], v[136:139], a[240:243], v[76:79]
  v_add_f32 v173, v173, v174
  v_cvt_pk_bf16_f32 v172, 0, v172
  s_nop 0
  v_add_f32_dpp v173, v173, v173 row_ror:8 row_mask:0xf bank_mask:0xf
  v_mfma_f32_16x16x32_bf16 v[80:83], v[136:139], a[244:247], v[80:83]
  buffer_load_dwordx4 v0, s[4:7], s32 offen offset:3072 sc1 lds
  v_sub_f32 v176, v232, v172
  v_mfma_f32_16x16x32_bf16 v[84:87], v[136:139], a[248:251], v[84:87]
  v_sub_f32 v177, v233, v172
  v_add_f32_dpp v173, v173, v173 row_ror:4 row_mask:0xf bank_mask:0xf
  v_sub_f32 v178, v234, v172
  v_mfma_f32_16x16x32_bf16 v[88:91], v[136:139], a[252:255], v[88:91]
  s_and_b32 s32, s64, 63
  s_lshl_b32 s32, s32, 5
  s_add_u32 s32, s32, s85
  s_bfe_u32 s33, s64, 131080
  s_lshl_b32 s33, s33, 11
  s_add_u32 s32, s32, s33
  v_sub_f32 v179, v235, v172
  s_waitcnt lgkmcnt(2)
  v_mfma_f32_16x16x32_bf16 v[92:95], v[124:127], a[0:3], 0
  v_add_f32_dpp v173, v173, v173 row_ror:2 row_mask:0xf bank_mask:0xf
  v_sub_f32 v180, v236, v172
  v_sub_f32 v181, v237, v172
  v_mfma_f32_16x16x32_bf16 v[96:99], v[124:127], a[4:7], 0
  ds_read_b128 v[136:139], v48 offset:7168
  v_mfma_f32_16x16x32_bf16 v[100:103], v[124:127], a[8:11], 0
  v_add_f32_dpp v173, v173, v173 row_ror:1 row_mask:0xf bank_mask:0xf
  v_sub_f32 v182, v238, v172
  v_sub_f32 v183, v239, v172
  v_mfma_f32_16x16x32_bf16 v[104:107], v[124:127], a[12:15], 0
  s_lshl_b32 s32, s32, 13
  s_add_u32 s32, s32, 192937984
  s_add_u32 s32, s32, s88
  s_add_u32 s33, s32, 4096
  buffer_load_dwordx4 v[24:27], v0, s[4:7], s32 offen offset:0 sc1
  v_mfma_f32_16x16x32_bf16 v[108:111], v[124:127], a[16:19], 0
  v_mov_b32 v174, v173
  v_cvt_pk_bf16_f32 v176, 0, v176
  v_cvt_pk_bf16_f32 v177, 0, v177
  v_mfma_f32_16x16x32_bf16 v[112:115], v[124:127], a[20:23], 0
  buffer_load_dwordx4 v[28:31], v0, s[4:7], s32 offen offset:2048 sc1
  v_permlane16_swap_b32 v173, v174
  v_mfma_f32_16x16x32_bf16 v[116:119], v[124:127], a[24:27], 0
  v_cvt_pk_bf16_f32 v178, 0, v178
  v_cvt_pk_bf16_f32 v179, 0, v179
  v_add_f32 v173, v173, v174
  v_mfma_f32_16x16x32_bf16 v[120:123], v[124:127], a[28:31], 0
  buffer_load_dwordx4 v[32:35], v0, s[4:7], s33 offen offset:0 sc1
  v_cvt_pk_bf16_f32 v180, 0, v180
  s_waitcnt lgkmcnt(2)
  v_mfma_f32_16x16x32_bf16 v[92:95], v[128:131], a[32:35], v[92:95]
  v_cvt_pk_bf16_f32 v181, 0, v181
  v_mov_b32 v174, v173
  v_cvt_pk_bf16_f32 v182, 0, v182
  v_mfma_f32_16x16x32_bf16 v[96:99], v[128:131], a[36:39], v[96:99]
  ds_read_b128 v[124:127], v48 offset:12288
  v_mfma_f32_16x16x32_bf16 v[100:103], v[128:131], a[40:43], v[100:103]
  v_cvt_pk_bf16_f32 v183, 0, v183
  v_permlane32_swap_b32 v173, v174
  v_add_f32 v173, v173, v174
  v_mfma_f32_16x16x32_bf16 v[104:107], v[128:131], a[44:47], v[104:107]
  buffer_load_dwordx4 v[36:39], v0, s[4:7], s33 offen offset:2048 sc1
  v_mul_f32 v173, 0x3b000000, v173
  v_mfma_f32_16x16x32_bf16 v[108:111], v[128:131], a[48:51], v[108:111]
  v_cvt_pk_bf16_f32 v173, 0, v173
  v_add_f32 v173, 0x3727c5ac, v173
  v_cvt_pk_bf16_f32 v173, 0, v173
  v_mfma_f32_16x16x32_bf16 v[112:115], v[128:131], a[52:55], v[112:115]
  buffer_load_dwordx2 v[40:41], v1, s[4:7], s32 offen offset:1024 sc1
  v_sqrt_f32 v173, v173
  v_mfma_f32_16x16x32_bf16 v[116:119], v[128:131], a[56:59], v[116:119]
  v_cvt_pk_bf16_f32 v173, 0, v173
  v_rcp_f32 v173, v173
  s_nop 0
  v_mul_f32 v176, v176, v173
  v_mfma_f32_16x16x32_bf16 v[120:123], v[128:131], a[60:63], v[120:123]
  buffer_load_dwordx2 v[42:43], v1, s[4:7], s32 offen offset:3072 sc1
  v_mul_f32 v177, v177, v173
  s_waitcnt lgkmcnt(2)
  v_mfma_f32_16x16x32_bf16 v[92:95], v[132:135], a[64:67], v[92:95]
  v_mul_f32 v178, v178, v173
  v_mul_f32 v179, v179, v173
  v_mul_f32 v180, v180, v173
  v_mfma_f32_16x16x32_bf16 v[96:99], v[132:135], a[68:71], v[96:99]
  ds_read_b128 v[128:131], v48 offset:13312
  v_mfma_f32_16x16x32_bf16 v[100:103], v[132:135], a[72:75], v[100:103]
  v_mul_f32 v181, v181, v173
  v_mul_f32 v182, v182, v173
  v_mul_f32 v183, v183, v173
  v_mfma_f32_16x16x32_bf16 v[104:107], v[132:135], a[76:79], v[104:107]
  buffer_load_dwordx2 v[44:45], v1, s[4:7], s33 offen offset:1024 sc1
  v_cvt_pk_bf16_f32 v160, v176, v177
  v_mfma_f32_16x16x32_bf16 v[108:111], v[132:135], a[80:83], v[108:111]
  v_cvt_pk_bf16_f32 v161, v178, v179
  v_cvt_pk_bf16_f32 v162, v180, v181
  v_cvt_pk_bf16_f32 v163, v182, v183
  v_mfma_f32_16x16x32_bf16 v[112:115], v[132:135], a[84:87], v[112:115]
  buffer_load_dwordx2 v[46:47], v1, s[4:7], s33 offen offset:3072 sc1
  v_lshlrev_b32 v240, 16, v160
  v_mfma_f32_16x16x32_bf16 v[116:119], v[132:135], a[88:91], v[116:119]
  v_and_b32 v241, 0xffff0000, v160
  v_lshlrev_b32 v242, 16, v161
  v_and_b32 v243, 0xffff0000, v161
  v_mfma_f32_16x16x32_bf16 v[120:123], v[132:135], a[92:95], v[120:123]
  v_cvt_pk_bf16_f32 v140, v60, v64
  v_cvt_pk_bf16_f32 v141, v68, v72
  v_lshlrev_b32 v244, 16, v162
  s_waitcnt lgkmcnt(2)
  v_mfma_f32_16x16x32_bf16 v[92:95], v[136:139], a[96:99], v[92:95]
  v_and_b32 v245, 0xffff0000, v162
  v_lshlrev_b32 v246, 16, v163
  v_and_b32 v247, 0xffff0000, v163
  v_mfma_f32_16x16x32_bf16 v[96:99], v[136:139], a[100:103], v[96:99]
  ds_read_b128 v[132:135], v48 offset:14336
  v_mfma_f32_16x16x32_bf16 v[100:103], v[136:139], a[104:107], v[100:103]
  buffer_store_dwordx4 v[160:163], v0, s[4:7], s93 offen sc1
  v_add_f32 v232, v232, v240
  v_mfma_f32_16x16x32_bf16 v[104:107], v[136:139], a[108:111], v[104:107]
  v_cvt_pk_bf16_f32 v142, v76, v80
  v_cvt_pk_bf16_f32 v143, v84, v88
  v_add_f32 v233, v233, v241
  v_mfma_f32_16x16x32_bf16 v[108:111], v[136:139], a[112:115], v[108:111]
  v_add_f32 v234, v234, v242
  v_add_f32 v235, v235, v243
  v_add_f32 v236, v236, v244
  v_mfma_f32_16x16x32_bf16 v[112:115], v[136:139], a[116:119], v[112:115]
  s_add_u32 s26, s86, 0
  buffer_store_dwordx4 v[140:143], v4, s[4:7], s26 offen sc1
  v_add_f32 v237, v237, v245
  v_mfma_f32_16x16x32_bf16 v[116:119], v[136:139], a[120:123], v[116:119]
  v_add_f32 v238, v238, v246
  v_add_f32 v239, v239, v247
  v_cvt_pk_bf16_f32 v164, v232, v233
  v_mfma_f32_16x16x32_bf16 v[120:123], v[136:139], a[124:127], v[120:123]
  v_cvt_pk_bf16_f32 v144, v61, v65
  v_cvt_pk_bf16_f32 v145, v69, v73
  v_cvt_pk_bf16_f32 v165, v234, v235
  s_waitcnt lgkmcnt(2)
  v_mfma_f32_16x16x32_bf16 v[92:95], v[124:127], a[128:131], v[92:95]
  v_cvt_pk_bf16_f32 v166, v236, v237
  v_cvt_pk_bf16_f32 v167, v238, v239
  v_mul_f32 v224, v240, v8
  v_mfma_f32_16x16x32_bf16 v[96:99], v[124:127], a[132:135], v[96:99]
  ds_read_b128 v[136:139], v48 offset:15360
  v_mfma_f32_16x16x32_bf16 v[100:103], v[124:127], a[136:139], v[100:103]
  v_mul_f32 v225, v241, v9
  v_fmac_f32 v224, v242, v10
  v_fmac_f32 v225, v243, v11
  v_mfma_f32_16x16x32_bf16 v[104:107], v[124:127], a[140:143], v[104:107]
  v_cvt_pk_bf16_f32 v146, v77, v81
  v_cvt_pk_bf16_f32 v147, v85, v89
  v_fmac_f32 v224, v244, v12
  v_mfma_f32_16x16x32_bf16 v[108:111], v[124:127], a[144:147], v[108:111]
  v_fmac_f32 v225, v245, v13
  v_fmac_f32 v224, v246, v14
  v_fmac_f32 v225, v247, v15
  v_mfma_f32_16x16x32_bf16 v[112:115], v[124:127], a[148:151], v[112:115]
  s_add_u32 s26, s86, 16384
  buffer_store_dwordx4 v[144:147], v4, s[4:7], s26 offen sc1
  v_add_f32 v224, v224, v225
  v_mfma_f32_16x16x32_bf16 v[116:119], v[124:127], a[152:155], v[116:119]
  s_add_u32 s92, s91, 10485760
  s_add_u32 s93, s91, 8388608
  buffer_store_dwordx4 v[164:167], v0, s[4:7], s92 offen sc1
  v_lshlrev_b32 v232, 16, v164
  v_mfma_f32_16x16x32_bf16 v[120:123], v[124:127], a[156:159], v[120:123]
  v_cvt_pk_bf16_f32 v148, v62, v66
  v_cvt_pk_bf16_f32 v149, v70, v74
  v_and_b32 v233, 0xffff0000, v164
  s_waitcnt lgkmcnt(2)
  v_mfma_f32_16x16x32_bf16 v[92:95], v[128:131], a[160:163], v[92:95]
  v_lshlrev_b32 v234, 16, v165
  v_and_b32 v235, 0xffff0000, v165
  v_lshlrev_b32 v236, 16, v166
  v_mfma_f32_16x16x32_bf16 v[96:99], v[128:131], a[164:167], v[96:99]
  v_cvt_pk_bf16_f32 v150, v78, v82
  v_cvt_pk_bf16_f32 v151, v86, v90
  v_and_b32 v237, 0xffff0000, v166
  v_mfma_f32_16x16x32_bf16 v[100:103], v[128:131], a[168:171], v[100:103]
  v_lshlrev_b32 v238, 16, v167
  v_and_b32 v239, 0xffff0000, v167
  v_add_f32 v172, v232, v233
  v_mfma_f32_16x16x32_bf16 v[104:107], v[128:131], a[172:175], v[104:107]
  s_add_u32 s26, s86, 32768
  buffer_store_dwordx4 v[148:151], v4, s[4:7], s26 offen sc1
  v_add_f32 v173, v234, v235
  v_mfma_f32_16x16x32_bf16 v[108:111], v[128:131], a[176:179], v[108:111]
  v_add_f32 v174, v236, v237
  v_add_f32 v175, v238, v239
  v_add_f32 v172, v172, v173
  v_mfma_f32_16x16x32_bf16 v[112:115], v[128:131], a[180:183], v[112:115]
  v_cvt_pk_bf16_f32 v152, v63, v67
  v_cvt_pk_bf16_f32 v153, v71, v75
  v_add_f32 v174, v174, v175
  v_mfma_f32_16x16x32_bf16 v[116:119], v[128:131], a[184:187], v[116:119]
  v_add_f32 v172, v172, v174
  s_nop 1
  v_add_f32_dpp v172, v172, v172 row_ror:8 row_mask:0xf bank_mask:0xf
  v_add_f32_dpp v224, v224, v224 row_ror:8 row_mask:0xf bank_mask:0xf
  v_mfma_f32_16x16x32_bf16 v[120:123], v[128:131], a[188:191], v[120:123]
  v_cvt_pk_bf16_f32 v154, v79, v83
  v_cvt_pk_bf16_f32 v155, v87, v91
  v_add_f32_dpp v172, v172, v172 row_ror:4 row_mask:0xf bank_mask:0xf
  s_waitcnt lgkmcnt(1)
  v_mfma_f32_16x16x32_bf16 v[92:95], v[132:135], a[192:195], v[92:95]
  v_add_f32_dpp v224, v224, v224 row_ror:4 row_mask:0xf bank_mask:0xf
  v_add_f32_dpp v172, v172, v172 row_ror:2 row_mask:0xf bank_mask:0xf
  s_nop 0
  v_add_f32_dpp v224, v224, v224 row_ror:2 row_mask:0xf bank_mask:0xf
  v_mfma_f32_16x16x32_bf16 v[96:99], v[132:135], a[196:199], v[96:99]
  s_add_u32 s26, s86, 49152
  buffer_store_dwordx4 v[152:155], v4, s[4:7], s26 offen sc1
  v_add_f32_dpp v172, v172, v172 row_ror:1 row_mask:0xf bank_mask:0xf
  v_mfma_f32_16x16x32_bf16 v[100:103], v[132:135], a[200:203], v[100:103]
  v_add_f32_dpp v224, v224, v224 row_ror:1 row_mask:0xf bank_mask:0xf
  v_mov_b32 v174, v172
  v_mov_b32 v175, v224
  v_mfma_f32_16x16x32_bf16 v[104:107], v[132:135], a[204:207], v[104:107]
  v_permlane16_swap_b32 v172, v174
  v_permlane16_swap_b32 v224, v175
  v_add_f32 v172, v172, v174
  v_mfma_f32_16x16x32_bf16 v[108:111], v[132:135], a[208:211], v[108:111]
  v_add_f32 v224, v224, v175
  v_mov_b32 v174, v172
  v_mov_b32 v175, v224
  v_mfma_f32_16x16x32_bf16 v[112:115], v[132:135], a[212:215], v[112:115]
  v_permlane32_swap_b32 v172, v174
  v_permlane32_swap_b32 v224, v175
  v_add_f32 v172, v172, v174
  v_mfma_f32_16x16x32_bf16 v[116:119], v[132:135], a[216:219], v[116:119]
  v_add_f32 v224, v224, v175
  v_mul_f32 v172, 0x3b000000, v172
  v_sub_f32 v176, v232, v172
  v_mfma_f32_16x16x32_bf16 v[120:123], v[132:135], a[220:223], v[120:123]
  v_sub_f32 v177, v233, v172
  v_sub_f32 v178, v234, v172
  v_sub_f32 v179, v235, v172
  s_waitcnt lgkmcnt(0)
  v_mfma_f32_16x16x32_bf16 v[92:95], v[136:139], a[224:227], v[92:95]
  v_sub_f32 v180, v236, v172
  v_sub_f32 v181, v237, v172
  v_sub_f32 v182, v238, v172
  v_mfma_f32_16x16x32_bf16 v[96:99], v[136:139], a[228:231], v[96:99]
  v_sub_f32 v183, v239, v172
  v_mul_f32 v173, v176, v176
  v_mul_f32 v174, v177, v177
  v_mfma_f32_16x16x32_bf16 v[100:103], v[136:139], a[232:235], v[100:103]
  v_fmac_f32 v173, v178, v178
  v_fmac_f32 v174, v179, v179
  v_fmac_f32 v173, v180, v180
  v_mfma_f32_16x16x32_bf16 v[104:107], v[136:139], a[236:239], v[104:107]
  v_fmac_f32 v174, v181, v181
  v_fmac_f32 v173, v182, v182
  v_fmac_f32 v174, v183, v183
  v_mfma_f32_16x16x32_bf16 v[108:111], v[136:139], a[240:243], v[108:111]
  v_add_f32 v173, v173, v174
  v_cvt_pk_bf16_f32 v172, 0, v172
  s_nop 0
  v_add_f32_dpp v173, v173, v173 row_ror:8 row_mask:0xf bank_mask:0xf
  v_mfma_f32_16x16x32_bf16 v[112:115], v[136:139], a[244:247], v[112:115]
  v_sub_f32 v176, v232, v172
  v_sub_f32 v177, v233, v172
  v_add_f32_dpp v173, v173, v173 row_ror:4 row_mask:0xf bank_mask:0xf
  v_mfma_f32_16x16x32_bf16 v[116:119], v[136:139], a[248:251], v[116:119]
  v_sub_f32 v178, v234, v172
  v_sub_f32 v179, v235, v172
  v_add_f32_dpp v173, v173, v173 row_ror:2 row_mask:0xf bank_mask:0xf
  v_mfma_f32_16x16x32_bf16 v[120:123], v[136:139], a[252:255], v[120:123]
  v_sub_f32 v180, v236, v172
  v_sub_f32 v181, v237, v172
  v_add_f32_dpp v173, v173, v173 row_ror:1 row_mask:0xf bank_mask:0xf
  v_sub_f32 v182, v238, v172
  v_sub_f32 v183, v239, v172
  v_mov_b32 v174, v173
  v_cvt_pk_bf16_f32 v176, 0, v176
  v_cvt_pk_bf16_f32 v177, 0, v177
  v_permlane16_swap_b32 v173, v174
  v_cvt_pk_bf16_f32 v178, 0, v178
  v_cvt_pk_bf16_f32 v179, 0, v179
  v_add_f32 v173, v173, v174
  v_cvt_pk_bf16_f32 v180, 0, v180
  v_cvt_pk_bf16_f32 v181, 0, v181
  v_mov_b32 v174, v173
  v_cvt_pk_bf16_f32 v182, 0, v182
  v_cvt_pk_bf16_f32 v183, 0, v183
  v_permlane32_swap_b32 v173, v174
  v_add_f32 v173, v173, v174
  v_mul_f32 v173, 0x3b000000, v173
  v_cvt_pk_bf16_f32 v173, 0, v173
  v_add_f32 v173, 0x3727c5ac, v173
  v_cvt_pk_bf16_f32 v173, 0, v173
  v_sqrt_f32 v173, v173
  s_nop 0
  v_cvt_pk_bf16_f32 v173, 0, v173
  v_rcp_f32 v173, v173
  s_nop 0
  v_mul_f32 v176, v176, v173
  v_mul_f32 v177, v177, v173
  v_mul_f32 v178, v178, v173
  v_mul_f32 v179, v179, v173
  v_mul_f32 v180, v180, v173
  v_mul_f32 v181, v181, v173
  v_mul_f32 v182, v182, v173
  v_mul_f32 v183, v183, v173
  v_cvt_pk_bf16_f32 v168, v176, v177
  v_cvt_pk_bf16_f32 v169, v178, v179
  v_cvt_pk_bf16_f32 v170, v180, v181
  v_cvt_pk_bf16_f32 v171, v182, v183
  buffer_store_dwordx4 v[168:171], v0, s[4:7], s93 offen sc1
  v_cvt_pk_bf16_f32 v224, 0, v224
  v_ashrrev_i32 v225, 31, v224
  v_or_b32 v225, 0x80000000, v225
  v_xor_b32 v224, v224, v225
  s_sub_u32 s92, 4095, s90
  v_and_b32 v224, 0xffff0000, v224
  v_or_b32 v224, s92, v224
  s_bfe_u32 s92, s65, 196619
  s_lshl_b32 s92, s92, 13
  s_lshl_b32 s93, s90, 2
  s_add_u32 s92, s92, s93
  s_add_u32 s92, s92, 5242880
  v_cvt_pk_bf16_f32 v140, v92, v96
  v_cvt_pk_bf16_f32 v141, v100, v104
  v_cvt_pk_bf16_f32 v142, v108, v112
  v_cvt_pk_bf16_f32 v143, v116, v120
  s_add_u32 s26, s86, 262144
  buffer_store_dwordx4 v[140:143], v4, s[4:7], s26 offen sc1
  v_cvt_pk_bf16_f32 v144, v93, v97
  v_cvt_pk_bf16_f32 v145, v101, v105
  v_cvt_pk_bf16_f32 v146, v109, v113
  v_cvt_pk_bf16_f32 v147, v117, v121
  s_add_u32 s26, s86, 278528
  buffer_store_dwordx4 v[144:147], v4, s[4:7], s26 offen sc1
  v_cvt_pk_bf16_f32 v148, v94, v98
  v_cvt_pk_bf16_f32 v149, v102, v106
  v_cvt_pk_bf16_f32 v150, v110, v114
  v_cvt_pk_bf16_f32 v151, v118, v122
  s_add_u32 s26, s86, 294912
  buffer_store_dwordx4 v[148:151], v4, s[4:7], s26 offen sc1
  v_cvt_pk_bf16_f32 v152, v95, v99
  v_cvt_pk_bf16_f32 v153, v103, v107
  v_cvt_pk_bf16_f32 v154, v111, v115
  v_cvt_pk_bf16_f32 v155, v119, v123
  s_add_u32 s26, s86, 311296
  buffer_store_dwordx4 v[152:155], v4, s[4:7], s26 offen sc1
  s_waitcnt vmcnt(4)
  s_mov_b64 exec, 1
  buffer_store_dword v224, off, s[4:7], s92 sc1
  s_mov_b64 exec, -1
  s_branch o_we_126
o_wr2_125:
  ds_read_b128 v[56:59], v54
  ds_read_b128 v[124:127], v48 offset:0
  ds_read_b128 v[128:131], v48 offset:1024
  ds_read_b128 v[132:135], v48 offset:2048
  s_lshl_b32 s90, s61, 1
  s_add_u32 s90, s90, s17
  s_and_b32 s94, s95, 1
  s_lshl_b32 s94, s94, 5
  s_add_u32 s94, s94, s90
  s_lshl_b32 s94, s94, 14
  s_lshl_b32 s92, s60, 21
  s_add_u32 s94, s94, s92
  s_add_u32 s94, s94, 12582912
  buffer_load_dwordx4 v[156:159], v5, s[4:7], s94 offen offset:0 sc1
  buffer_load_dwordx4 v[160:163], v5, s[4:7], s94 offen offset:256 sc1
  buffer_load_dwordx4 v[164:167], v5, s[4:7], s94 offen offset:512 sc1
  buffer_load_dwordx4 v[168:171], v5, s[4:7], s94 offen offset:768 sc1
  s_add_u32 s94, s94, 4096
  buffer_load_dwordx4 v[172:175], v5, s[4:7], s94 offen offset:0 sc1
  buffer_load_dwordx4 v[176:179], v5, s[4:7], s94 offen offset:256 sc1
  buffer_load_dwordx4 v[180:183], v5, s[4:7], s94 offen offset:512 sc1
  buffer_load_dwordx4 v[184:187], v5, s[4:7], s94 offen offset:768 sc1
  s_add_u32 s94, s94, 4096
  buffer_load_dwordx4 v[188:191], v5, s[4:7], s94 offen offset:0 sc1
  buffer_load_dwordx4 v[192:195], v5, s[4:7], s94 offen offset:256 sc1
  buffer_load_dwordx4 v[196:199], v5, s[4:7], s94 offen offset:512 sc1
  buffer_load_dwordx4 v[200:203], v5, s[4:7], s94 offen offset:768 sc1
  s_add_u32 s94, s94, 4096
  buffer_load_dwordx4 v[204:207], v5, s[4:7], s94 offen offset:0 sc1
  buffer_load_dwordx4 v[208:211], v5, s[4:7], s94 offen offset:256 sc1
  buffer_load_dwordx4 v[212:215], v5, s[4:7], s94 offen offset:512 sc1
  buffer_load_dwordx4 v[216:219], v5, s[4:7], s94 offen offset:768 sc1
  s_lshr_b32 s92, s65, 16
  s_xor_b32 s93, s90, 32
  s_and_b32 s91, s65, 63
  s_lshl_b32 s94, s91, 11
  s_lshl_b32 s91, s91, 5
  s_add_u32 s90, s90, s91
  s_lshl_b32 s91, s90, 10
  s_add_u32 s94, s94, 26214400
  s_cmp_eq_u32 s92, s93
  s_cselect_b32 s92, s94, s91
  s_add_u32 s92, s92, 10485760
  buffer_load_dwordx4 v[220:223], v0, s[4:7], s92 offen sc1
  s_waitcnt lgkmcnt(2)
  v_mfma_f32_16x16x32_bf16 v[60:63], v[124:127], a[0:3], 0
  v_mfma_f32_16x16x32_bf16 v[64:67], v[124:127], a[4:7], 0
  ds_read_b128 v[136:139], v48 offset:3072
  v_mfma_f32_16x16x32_bf16 v[68:71], v[124:127], a[8:11], 0
  v_mfma_f32_16x16x32_bf16 v[72:75], v[124:127], a[12:15], 0
  v_and_b32 v56, v56, v57
  v_and_b32 v58, v58, v59
  v_mfma_f32_16x16x32_bf16 v[76:79], v[124:127], a[16:19], 0
  v_mfma_f32_16x16x32_bf16 v[80:83], v[124:127], a[20:23], 0
  v_and_b32 v56, v56, v58
  s_bfe_u32 s26, s64, 131086
  v_readfirstlane_b32 s27, v56
  v_mfma_f32_16x16x32_bf16 v[84:87], v[124:127], a[24:27], 0
  v_mfma_f32_16x16x32_bf16 v[88:91], v[124:127], a[28:31], 0
  s_cmp_eq_u32 s26, 1
  s_cselect_b32 s66, s27, 0
  s_and_b32 s66, s66, 1
  s_cselect_b32 s87, 0, 268435456
  s_cmp_lg_u32 s26, 0
  s_cselect_b32 s76, s27, 0
  s_and_b32 s76, s76, 2
  s_cselect_b32 s88, 0, 268435456
  s_waitcnt lgkmcnt(2)
  v_mfma_f32_16x16x32_bf16 v[60:63], v[128:131], a[32:35], v[60:63]
  v_mfma_f32_16x16x32_bf16 v[64:67], v[128:131], a[36:39], v[64:67]
  ds_read_b128 v[124:127], v48 offset:8192
  v_mfma_f32_16x16x32_bf16 v[68:71], v[128:131], a[40:43], v[68:71]
  v_mfma_f32_16x16x32_bf16 v[72:75], v[128:131], a[44:47], v[72:75]
  s_waitcnt vmcnt(16)
  v_mfma_f32_16x16x32_bf16 v[224:227], v[16:19], v[156:159], 0
  v_mfma_f32_16x16x32_bf16 v[76:79], v[128:131], a[48:51], v[76:79]
  s_waitcnt vmcnt(15)
  v_mfma_f32_16x16x32_bf16 v[228:231], v[16:19], v[160:163], 0
  v_mfma_f32_16x16x32_bf16 v[80:83], v[128:131], a[52:55], v[80:83]
  s_waitcnt vmcnt(14)
  v_mfma_f32_16x16x32_bf16 v[224:227], v[20:23], v[164:167], v[224:227]
  v_mfma_f32_16x16x32_bf16 v[84:87], v[128:131], a[56:59], v[84:87]
  s_waitcnt vmcnt(13)
  v_mfma_f32_16x16x32_bf16 v[228:231], v[20:23], v[168:171], v[228:231]
  v_mfma_f32_16x16x32_bf16 v[88:91], v[128:131], a[60:63], v[88:91]
  s_waitcnt vmcnt(12)
  v_mfma_f32_16x16x32_bf16 v[224:227], v[16:19], v[172:175], v[224:227]
  s_waitcnt lgkmcnt(2)
  v_mfma_f32_16x16x32_bf16 v[60:63], v[132:135], a[64:67], v[60:63]
  s_waitcnt vmcnt(11)
  v_mfma_f32_16x16x32_bf16 v[228:231], v[16:19], v[176:179], v[228:231]
  v_mfma_f32_16x16x32_bf16 v[64:67], v[132:135], a[68:71], v[64:67]
  ds_read_b128 v[128:131], v48 offset:9216
  v_mfma_f32_16x16x32_bf16 v[68:71], v[132:135], a[72:75], v[68:71]
  s_waitcnt vmcnt(10)
  v_mfma_f32_16x16x32_bf16 v[224:227], v[20:23], v[180:183], v[224:227]
  v_mfma_f32_16x16x32_bf16 v[72:75], v[132:135], a[76:79], v[72:75]
  s_waitcnt vmcnt(9)
  v_mfma_f32_16x16x32_bf16 v[228:231], v[20:23], v[184:187], v[228:231]
  v_mfma_f32_16x16x32_bf16 v[76:79], v[132:135], a[80:83], v[76:79]
  s_waitcnt vmcnt(8)
  v_mfma_f32_16x16x32_bf16 v[224:227], v[16:19], v[188:191], v[224:227]
  v_mfma_f32_16x16x32_bf16 v[80:83], v[132:135], a[84:87], v[80:83]
  s_waitcnt vmcnt(7)
  v_mfma_f32_16x16x32_bf16 v[228:231], v[16:19], v[192:195], v[228:231]
  v_mfma_f32_16x16x32_bf16 v[84:87], v[132:135], a[88:91], v[84:87]
  s_waitcnt vmcnt(6)
  v_mfma_f32_16x16x32_bf16 v[224:227], v[20:23], v[196:199], v[224:227]
  v_mfma_f32_16x16x32_bf16 v[88:91], v[132:135], a[92:95], v[88:91]
  s_waitcnt vmcnt(5)
  v_mfma_f32_16x16x32_bf16 v[228:231], v[20:23], v[200:203], v[228:231]
  s_waitcnt lgkmcnt(2)
  v_mfma_f32_16x16x32_bf16 v[60:63], v[136:139], a[96:99], v[60:63]
  s_waitcnt vmcnt(4)
  v_mfma_f32_16x16x32_bf16 v[224:227], v[16:19], v[204:207], v[224:227]
  v_mfma_f32_16x16x32_bf16 v[64:67], v[136:139], a[100:103], v[64:67]
  ds_read_b128 v[132:135], v48 offset:10240
  v_mfma_f32_16x16x32_bf16 v[68:71], v[136:139], a[104:107], v[68:71]
  s_waitcnt vmcnt(3)
  v_mfma_f32_16x16x32_bf16 v[228:231], v[16:19], v[208:211], v[228:231]
  v_mfma_f32_16x16x32_bf16 v[72:75], v[136:139], a[108:111], v[72:75]
  s_and_b32 s32, s64, 0xff
  s_lshl_b32 s32, s32, 4
  s_add_u32 s32, s32, s61
  s_lshl_b32 s32, s32, 2
  s_add_u32 s32, s32, s17
  s_lshl_b32 s33, s32, 12
  v_mfma_f32_16x16x32_bf16 v[76:79], v[136:139], a[112:115], v[76:79]
  s_waitcnt vmcnt(2)
  v_mfma_f32_16x16x32_bf16 v[224:227], v[20:23], v[212:215], v[224:227]
  v_mfma_f32_16x16x32_bf16 v[80:83], v[136:139], a[116:119], v[80:83]
  s_add_u32 s33, s33, 142606336
  s_lshl_b32 s32, s32, 13
  s_add_u32 s32, s32, 41943040
  s_add_u32 s32, s32, s87
  s_add_u32 s33, s33, s87
  s_xor_b32 s34, s84, 114688
  v_mfma_f32_16x16x32_bf16 v[84:87], v[136:139], a[120:123], v[84:87]
  s_waitcnt vmcnt(1)
  v_mfma_f32_16x16x32_bf16 v[228:231], v[20:23], v[216:219], v[228:231]
  v_mfma_f32_16x16x32_bf16 v[88:91], v[136:139], a[124:127], v[88:91]
  s_lshl_b32 s35, s17, 12
  s_add_u32 s34, s34, s35
  s_add_u32 m0, s34, 32768
  s_add_u32 s34, s34, s35
  buffer_load_dwordx4 v0, s[4:7], s33 offen offset:0 sc1 lds
  s_waitcnt lgkmcnt(2)
  v_mfma_f32_16x16x32_bf16 v[60:63], v[124:127], a[128:131], v[60:63]
  s_bfe_u32 s92, s65, 131080
  s_lshl_b32 s92, s92, 21
  s_add_u32 s92, s92, s91
  s_add_u32 s93, s92, 27262976
  s_add_u32 s92, s92, 20971520
  s_waitcnt vmcnt(1)
  v_mfma_f32_16x16x32_bf16 v[64:67], v[124:127], a[132:135], v[64:67]
  ds_read_b128 v[136:139], v48 offset:11264
  v_mfma_f32_16x16x32_bf16 v[68:71], v[124:127], a[136:139], v[68:71]
  v_lshlrev_b32 v232, 16, v220
  v_and_b32 v233, 0xffff0000, v220
  v_mfma_f32_16x16x32_bf16 v[72:75], v[124:127], a[140:143], v[72:75]
  buffer_load_dwordx4 v0, s[4:7], s33 offen offset:1024 sc1 lds
  v_mfma_f32_16x16x32_bf16 v[76:79], v[124:127], a[144:147], v[76:79]
  v_lshlrev_b32 v234, 16, v221
  v_and_b32 v235, 0xffff0000, v221
  v_mfma_f32_16x16x32_bf16 v[80:83], v[124:127], a[148:151], v[80:83]
  buffer_load_dwordx4 v0, s[4:7], s33 offen offset:2048 sc1 lds
  v_mfma_f32_16x16x32_bf16 v[84:87], v[124:127], a[152:155], v[84:87]
  v_lshlrev_b32 v236, 16, v222
  v_and_b32 v237, 0xffff0000, v222
  v_mfma_f32_16x16x32_bf16 v[88:91], v[124:127], a[156:159], v[88:91]
  buffer_load_dwordx4 v0, s[4:7], s33 offen offset:3072 sc1 lds
  s_waitcnt lgkmcnt(2)
  v_mfma_f32_16x16x32_bf16 v[60:63], v[128:131], a[160:163], v[60:63]
  v_lshlrev_b32 v238, 16, v223
  v_and_b32 v239, 0xffff0000, v223
  v_mfma_f32_16x16x32_bf16 v[64:67], v[128:131], a[164:167], v[64:67]
  ds_read_b128 v[124:127], v48 offset:4096
  v_mfma_f32_16x16x32_bf16 v[68:71], v[128:131], a[168:171], v[68:71]
  v_permlane16_swap_b32 v224, v228
  v_permlane16_swap_b32 v225, v229
  v_mfma_f32_16x16x32_bf16 v[72:75], v[128:131], a[172:175], v[72:75]
  s_add_u32 m0, s34, 0
  s_nop 0
  buffer_load_dwordx4 v0, s[4:7], s32 offen offset:0 sc1 lds
  v_mfma_f32_16x16x32_bf16 v[76:79], v[128:131], a[176:179], v[76:79]
  v_permlane16_swap_b32 v226, v230
  v_permlane16_swap_b32 v227, v231
  v_mfma_f32_16x16x32_bf16 v[80:83], v[128:131], a[180:183], v[80:83]
  buffer_load_dwordx4 v0, s[4:7], s32 offen offset:1024 sc1 lds
  v_mfma_f32_16x16x32_bf16 v[84:87], v[128:131], a[184:187], v[84:87]
  v_cvt_pk_bf16_f32 v224, 0, v224
  v_cvt_pk_bf16_f32 v225, 0, v225
  v_mfma_f32_16x16x32_bf16 v[88:91], v[128:131], a[188:191], v[88:91]
  buffer_load_dwordx4 v0, s[4:7], s32 offen offset:2048 sc1 lds
  s_waitcnt lgkmcnt(2)
  v_mfma_f32_16x16x32_bf16 v[60:63], v[132:135], a[192:195], v[60:63]
  v_cvt_pk_bf16_f32 v226, 0, v226
  v_cvt_pk_bf16_f32 v227, 0, v227
  v_mfma_f32_16x16x32_bf16 v[64:67], v[132:135], a[196:199], v[64:67]
  ds_read_b128 v[128:131], v48 offset:5120
  v_mfma_f32_16x16x32_bf16 v[68:71], v[132:135], a[200:203], v[68:71]
  v_cvt_pk_bf16_f32 v228, 0, v228
  v_cvt_pk_bf16_f32 v229, 0, v229
  v_mfma_f32_16x16x32_bf16 v[72:75], v[132:135], a[204:207], v[72:75]
  buffer_load_dwordx4 v0, s[4:7], s32 offen offset:3072 sc1 lds
  v_mfma_f32_16x16x32_bf16 v[76:79], v[132:135], a[208:211], v[76:79]
  v_cvt_pk_bf16_f32 v230, 0, v230
  v_cvt_pk_bf16_f32 v231, 0, v231
  v_mfma_f32_16x16x32_bf16 v[80:83], v[132:135], a[212:215], v[80:83]
  s_add_u32 m0, s34, 4096
  s_add_u32 s32, s32, 4096
  buffer_load_dwordx4 v0, s[4:7], s32 offen offset:0 sc1 lds
  v_mfma_f32_16x16x32_bf16 v[84:87], v[132:135], a[216:219], v[84:87]
  v_add_f32 v232, v232, v224
  v_add_f32 v233, v233, v225
  v_mfma_f32_16x16x32_bf16 v[88:91], v[132:135], a[220:223], v[88:91]
  buffer_load_dwordx4 v0, s[4:7], s32 offen offset:1024 sc1 lds
  s_waitcnt lgkmcnt(2)
  v_mfma_f32_16x16x32_bf16 v[60:63], v[136:139], a[224:227], v[60:63]
  v_add_f32 v234, v234, v226
  v_add_f32 v235, v235, v227
  v_mfma_f32_16x16x32_bf16 v[64:67], v[136:139], a[228:231], v[64:67]
  ds_read_b128 v[132:135], v48 offset:6144
  v_mfma_f32_16x16x32_bf16 v[68:71], v[136:139], a[232:235], v[68:71]
  v_add_f32 v236, v236, v228
  v_add_f32 v237, v237, v229
  v_mfma_f32_16x16x32_bf16 v[72:75], v[136:139], a[236:239], v[72:75]
  buffer_load_dwordx4 v0, s[4:7], s32 offen offset:2048 sc1 lds
  v_mfma_f32_16x16x32_bf16 v[76:79], v[136:139], a[240:243], v[76:79]
  v_add_f32 v238, v238, v230
  v_add_f32 v239, v239, v231
  v_mfma_f32_16x16x32_bf16 v[80:83], v[136:139], a[244:247], v[80:83]
  buffer_load_dwordx4 v0, s[4:7], s32 offen offset:3072 sc1 lds
  v_mfma_f32_16x16x32_bf16 v[84:87], v[136:139], a[248:251], v[84:87]
  v_cvt_pk_bf16_f32 v156, v232, v233
  v_cvt_pk_bf16_f32 v157, v234, v235
  v_mfma_f32_16x16x32_bf16 v[88:91], v[136:139], a[252:255], v[88:91]
  s_and_b32 s32, s64, 63
  s_lshl_b32 s32, s32, 5
  s_add_u32 s32, s32, s85
  s_bfe_u32 s33, s64, 131080
  s_lshl_b32 s33, s33, 11
  s_add_u32 s32, s32, s33
  s_waitcnt lgkmcnt(2)
  v_mfma_f32_16x16x32_bf16 v[92:95], v[124:127], a[0:3], 0
  v_cvt_pk_bf16_f32 v158, v236, v237
  v_cvt_pk_bf16_f32 v159, v238, v239
  v_mfma_f32_16x16x32_bf16 v[96:99], v[124:127], a[4:7], 0
  ds_read_b128 v[136:139], v48 offset:7168
  v_mfma_f32_16x16x32_bf16 v[100:103], v[124:127], a[8:11], 0
  v_lshlrev_b32 v232, 16, v156
  v_and_b32 v233, 0xffff0000, v156
  v_mfma_f32_16x16x32_bf16 v[104:107], v[124:127], a[12:15], 0
  s_lshl_b32 s32, s32, 13
  s_add_u32 s32, s32, 192937984
  s_add_u32 s32, s32, s88
  s_add_u32 s33, s32, 4096
  buffer_load_dwordx4 v[24:27], v0, s[4:7], s32 offen offset:0 sc1
  v_mfma_f32_16x16x32_bf16 v[108:111], v[124:127], a[16:19], 0
  v_lshlrev_b32 v234, 16, v157
  v_and_b32 v235, 0xffff0000, v157
  v_mfma_f32_16x16x32_bf16 v[112:115], v[124:127], a[20:23], 0
  buffer_load_dwordx4 v[28:31], v0, s[4:7], s32 offen offset:2048 sc1
  v_mfma_f32_16x16x32_bf16 v[116:119], v[124:127], a[24:27], 0
  v_lshlrev_b32 v236, 16, v158
  v_and_b32 v237, 0xffff0000, v158
  v_mfma_f32_16x16x32_bf16 v[120:123], v[124:127], a[28:31], 0
  buffer_load_dwordx4 v[32:35], v0, s[4:7], s33 offen offset:0 sc1
  s_waitcnt lgkmcnt(2)
  v_mfma_f32_16x16x32_bf16 v[92:95], v[128:131], a[32:35], v[92:95]
  v_lshlrev_b32 v238, 16, v159
  v_and_b32 v239, 0xffff0000, v159
  v_mfma_f32_16x16x32_bf16 v[96:99], v[128:131], a[36:39], v[96:99]
  ds_read_b128 v[124:127], v48 offset:12288
  v_mfma_f32_16x16x32_bf16 v[100:103], v[128:131], a[40:43], v[100:103]
  buffer_store_dwordx4 v[156:159], v0, s[4:7], s92 offen sc1
  v_mfma_f32_16x16x32_bf16 v[104:107], v[128:131], a[44:47], v[104:107]
  buffer_load_dwordx4 v[36:39], v0, s[4:7], s33 offen offset:2048 sc1
  v_mfma_f32_16x16x32_bf16 v[108:111], v[128:131], a[48:51], v[108:111]
  v_add_f32 v172, v232, v233
  v_add_f32 v173, v234, v235
  v_mfma_f32_16x16x32_bf16 v[112:115], v[128:131], a[52:55], v[112:115]
  buffer_load_dwordx2 v[40:41], v1, s[4:7], s32 offen offset:1024 sc1
  v_mfma_f32_16x16x32_bf16 v[116:119], v[128:131], a[56:59], v[116:119]
  v_add_f32 v174, v236, v237
  v_add_f32 v175, v238, v239
  v_mfma_f32_16x16x32_bf16 v[120:123], v[128:131], a[60:63], v[120:123]
  buffer_load_dwordx2 v[42:43], v1, s[4:7], s32 offen offset:3072 sc1
  s_waitcnt lgkmcnt(2)
  v_mfma_f32_16x16x32_bf16 v[92:95], v[132:135], a[64:67], v[92:95]
  v_add_f32 v172, v172, v173
  v_add_f32 v174, v174, v175
  v_mfma_f32_16x16x32_bf16 v[96:99], v[132:135], a[68:71], v[96:99]
  ds_read_b128 v[128:131], v48 offset:13312
  v_mfma_f32_16x16x32_bf16 v[100:103], v[132:135], a[72:75], v[100:103]
  v_add_f32 v172, v172, v174
  s_nop 1
  v_add_f32_dpp v172, v172, v172 row_ror:8 row_mask:0xf bank_mask:0xf
  v_mfma_f32_16x16x32_bf16 v[104:107], v[132:135], a[76:79], v[104:107]
  buffer_load_dwordx2 v[44:45], v1, s[4:7], s33 offen offset:1024 sc1
  v_mfma_f32_16x16x32_bf16 v[108:111], v[132:135], a[80:83], v[108:111]
  v_add_f32_dpp v172, v172, v172 row_ror:4 row_mask:0xf bank_mask:0xf
  s_nop 1
  v_add_f32_dpp v172, v172, v172 row_ror:2 row_mask:0xf bank_mask:0xf
  v_mfma_f32_16x16x32_bf16 v[112:115], v[132:135], a[84:87], v[112:115]
  buffer_load_dwordx2 v[46:47], v1, s[4:7], s33 offen offset:3072 sc1
  v_mfma_f32_16x16x32_bf16 v[116:119], v[132:135], a[88:91], v[116:119]
  v_add_f32_dpp v172, v172, v172 row_ror:1 row_mask:0xf bank_mask:0xf
  v_mov_b32 v174, v172
  v_mfma_f32_16x16x32_bf16 v[120:123], v[132:135], a[92:95], v[120:123]
  v_cvt_pk_bf16_f32 v140, v60, v64
  v_cvt_pk_bf16_f32 v141, v68, v72
  s_waitcnt lgkmcnt(2)
  v_mfma_f32_16x16x32_bf16 v[92:95], v[136:139], a[96:99], v[92:95]
  v_permlane16_swap_b32 v172, v174
  v_add_f32 v172, v172, v174
  v_mfma_f32_16x16x32_bf16 v[96:99], v[136:139], a[100:103], v[96:99]
  ds_read_b128 v[132:135], v48 offset:14336
  v_mfma_f32_16x16x32_bf16 v[100:103], v[136:139], a[104:107], v[100:103]
  v_mov_b32 v174, v172
  s_nop 1
  v_permlane32_swap_b32 v172, v174
  v_mfma_f32_16x16x32_bf16 v[104:107], v[136:139], a[108:111], v[104:107]
  v_cvt_pk_bf16_f32 v142, v76, v80
  v_cvt_pk_bf16_f32 v143, v84, v88
  v_mfma_f32_16x16x32_bf16 v[108:111], v[136:139], a[112:115], v[108:111]
  v_add_f32 v172, v172, v174
  v_mul_f32 v172, 0x3b000000, v172
  v_mfma_f32_16x16x32_bf16 v[112:115], v[136:139], a[116:119], v[112:115]
  s_add_u32 s26, s86, 0
  buffer_store_dwordx4 v[140:143], v4, s[4:7], s26 offen sc1
  v_mfma_f32_16x16x32_bf16 v[116:119], v[136:139], a[120:123], v[116:119]
  v_sub_f32 v176, v232, v172
  v_sub_f32 v177, v233, v172
  v_mfma_f32_16x16x32_bf16 v[120:123], v[136:139], a[124:127], v[120:123]
  v_cvt_pk_bf16_f32 v144, v61, v65
  v_cvt_pk_bf16_f32 v145, v69, v73
  s_waitcnt lgkmcnt(2)
  v_mfma_f32_16x16x32_bf16 v[92:95], v[124:127], a[128:131], v[92:95]
  v_sub_f32 v178, v234, v172
  v_sub_f32 v179, v235, v172
  v_mfma_f32_16x16x32_bf16 v[96:99], v[124:127], a[132:135], v[96:99]
  ds_read_b128 v[136:139], v48 offset:15360
  v_mfma_f32_16x16x32_bf16 v[100:103], v[124:127], a[136:139], v[100:103]
  v_sub_f32 v180, v236, v172
  v_sub_f32 v181, v237, v172
  v_mfma_f32_16x16x32_bf16 v[104:107], v[124:127], a[140:143], v[104:107]
  v_cvt_pk_bf16_f32 v146, v77, v81
  v_cvt_pk_bf16_f32 v147, v85, v89
  v_mfma_f32_16x16x32_bf16 v[108:111], v[124:127], a[144:147], v[108:111]
  v_sub_f32 v182, v238, v172
  v_sub_f32 v183, v239, v172
  v_mfma_f32_16x16x32_bf16 v[112:115], v[124:127], a[148:151], v[112:115]
  s_add_u32 s26, s86, 16384
  buffer_store_dwordx4 v[144:147], v4, s[4:7], s26 offen sc1
  v_mfma_f32_16x16x32_bf16 v[116:119], v[124:127], a[152:155], v[116:119]
  v_mul_f32 v173, v176, v176
  v_mul_f32 v174, v177, v177
  v_mfma_f32_16x16x32_bf16 v[120:123], v[124:127], a[156:159], v[120:123]
  v_cvt_pk_bf16_f32 v148, v62, v66
  v_cvt_pk_bf16_f32 v149, v70, v74
  s_waitcnt lgkmcnt(2)
  v_mfma_f32_16x16x32_bf16 v[92:95], v[128:131], a[160:163], v[92:95]
  v_fmac_f32 v173, v178, v178
  v_fmac_f32 v174, v179, v179
  v_mfma_f32_16x16x32_bf16 v[96:99], v[128:131], a[164:167], v[96:99]
  v_cvt_pk_bf16_f32 v150, v78, v82
  v_cvt_pk_bf16_f32 v151, v86, v90
  v_mfma_f32_16x16x32_bf16 v[100:103], v[128:131], a[168:171], v[100:103]
  v_fmac_f32 v173, v180, v180
  v_fmac_f32 v174, v181, v181
  v_mfma_f32_16x16x32_bf16 v[104:107], v[128:131], a[172:175], v[104:107]
  s_add_u32 s26, s86, 32768
  buffer_store_dwordx4 v[148:151], v4, s[4:7], s26 offen sc1
  v_mfma_f32_16x16x32_bf16 v[108:111], v[128:131], a[176:179], v[108:111]
  v_fmac_f32 v173, v182, v182
  v_fmac_f32 v174, v183, v183
  v_mfma_f32_16x16x32_bf16 v[112:115], v[128:131], a[180:183], v[112:115]
  v_cvt_pk_bf16_f32 v152, v63, v67
  v_cvt_pk_bf16_f32 v153, v71, v75
  v_mfma_f32_16x16x32_bf16 v[116:119], v[128:131], a[184:187], v[116:119]
  v_add_f32 v173, v173, v174
  v_cvt_pk_bf16_f32 v172, 0, v172
  v_mfma_f32_16x16x32_bf16 v[120:123], v[128:131], a[188:191], v[120:123]
  v_cvt_pk_bf16_f32 v154, v79, v83
  v_cvt_pk_bf16_f32 v155, v87, v91
  s_waitcnt lgkmcnt(1)
  v_mfma_f32_16x16x32_bf16 v[92:95], v[132:135], a[192:195], v[92:95]
  v_add_f32_dpp v173, v173, v173 row_ror:8 row_mask:0xf bank_mask:0xf
  v_sub_f32 v176, v232, v172
  v_mfma_f32_16x16x32_bf16 v[96:99], v[132:135], a[196:199], v[96:99]
  s_add_u32 s26, s86, 49152
  buffer_store_dwordx4 v[152:155], v4, s[4:7], s26 offen sc1
  v_mfma_f32_16x16x32_bf16 v[100:103], v[132:135], a[200:203], v[100:103]
  v_sub_f32 v177, v233, v172
  v_add_f32_dpp v173, v173, v173 row_ror:4 row_mask:0xf bank_mask:0xf
  v_mfma_f32_16x16x32_bf16 v[104:107], v[132:135], a[204:207], v[104:107]
  v_sub_f32 v178, v234, v172
  v_sub_f32 v179, v235, v172
  v_mfma_f32_16x16x32_bf16 v[108:111], v[132:135], a[208:211], v[108:111]
  v_add_f32_dpp v173, v173, v173 row_ror:2 row_mask:0xf bank_mask:0xf
  v_sub_f32 v180, v236, v172
  v_mfma_f32_16x16x32_bf16 v[112:115], v[132:135], a[212:215], v[112:115]
  v_sub_f32 v181, v237, v172
  v_add_f32_dpp v173, v173, v173 row_ror:1 row_mask:0xf bank_mask:0xf
  v_mfma_f32_16x16x32_bf16 v[116:119], v[132:135], a[216:219], v[116:119]
  v_sub_f32 v182, v238, v172
  v_sub_f32 v183, v239, v172
  v_mfma_f32_16x16x32_bf16 v[120:123], v[132:135], a[220:223], v[120:123]
  v_mov_b32 v174, v173
  v_cvt_pk_bf16_f32 v176, 0, v176
  s_waitcnt lgkmcnt(0)
  v_mfma_f32_16x16x32_bf16 v[92:95], v[136:139], a[224:227], v[92:95]
  v_cvt_pk_bf16_f32 v177, 0, v177
  v_permlane16_swap_b32 v173, v174
  v_mfma_f32_16x16x32_bf16 v[96:99], v[136:139], a[228:231], v[96:99]
  v_cvt_pk_bf16_f32 v178, 0, v178
  v_cvt_pk_bf16_f32 v179, 0, v179
  v_mfma_f32_16x16x32_bf16 v[100:103], v[136:139], a[232:235], v[100:103]
  v_add_f32 v173, v173, v174
  v_cvt_pk_bf16_f32 v180, 0, v180
  v_mfma_f32_16x16x32_bf16 v[104:107], v[136:139], a[236:239], v[104:107]
  v_cvt_pk_bf16_f32 v181, 0, v181
  v_mov_b32 v174, v173
  v_mfma_f32_16x16x32_bf16 v[108:111], v[136:139], a[240:243], v[108:111]
  v_cvt_pk_bf16_f32 v182, 0, v182
  v_cvt_pk_bf16_f32 v183, 0, v183
  v_mfma_f32_16x16x32_bf16 v[112:115], v[136:139], a[244:247], v[112:115]
  v_permlane32_swap_b32 v173, v174
  v_add_f32 v173, v173, v174
  v_mfma_f32_16x16x32_bf16 v[116:119], v[136:139], a[248:251], v[116:119]
  v_mul_f32 v173, 0x3b000000, v173
  v_cvt_pk_bf16_f32 v173, 0, v173
  v_mfma_f32_16x16x32_bf16 v[120:123], v[136:139], a[252:255], v[120:123]
  v_add_f32 v173, 0x3727c5ac, v173
  v_cvt_pk_bf16_f32 v173, 0, v173
  v_sqrt_f32 v173, v173
  s_nop 0
  v_cvt_pk_bf16_f32 v173, 0, v173
  v_rcp_f32 v173, v173
  s_nop 0
  v_mul_f32 v176, v176, v173
  v_mul_f32 v177, v177, v173
  v_mul_f32 v178, v178, v173
  v_mul_f32 v179, v179, v173
  v_mul_f32 v180, v180, v173
  v_mul_f32 v181, v181, v173
  v_mul_f32 v182, v182, v173
  v_mul_f32 v183, v183, v173
  v_cvt_pk_bf16_f32 v160, v176, v177
  v_cvt_pk_bf16_f32 v161, v178, v179
  v_cvt_pk_bf16_f32 v162, v180, v181
  v_cvt_pk_bf16_f32 v163, v182, v183
  v_lshlrev_b32 v240, 16, v160
  v_and_b32 v241, 0xffff0000, v160
  v_lshlrev_b32 v242, 16, v161
  v_and_b32 v243, 0xffff0000, v161
  v_lshlrev_b32 v244, 16, v162
  v_and_b32 v245, 0xffff0000, v162
  v_lshlrev_b32 v246, 16, v163
  v_and_b32 v247, 0xffff0000, v163
  buffer_store_dwordx4 v[160:163], v0, s[4:7], s93 offen sc1
  v_add_f32 v232, v232, v240
  v_add_f32 v233, v233, v241
  v_add_f32 v234, v234, v242
  v_add_f32 v235, v235, v243
  v_add_f32 v236, v236, v244
  v_add_f32 v237, v237, v245
  v_add_f32 v238, v238, v246
  v_add_f32 v239, v239, v247
  v_cvt_pk_bf16_f32 v164, v232, v233
  v_cvt_pk_bf16_f32 v165, v234, v235
  v_cvt_pk_bf16_f32 v166, v236, v237
  v_cvt_pk_bf16_f32 v167, v238, v239
  v_mul_f32 v224, v240, v8
  v_mul_f32 v225, v241, v9
  v_fmac_f32 v224, v242, v10
  v_fmac_f32 v225, v243, v11
  v_fmac_f32 v224, v244, v12
  v_fmac_f32 v225, v245, v13
  v_fmac_f32 v224, v246, v14
  v_fmac_f32 v225, v247, v15
  v_add_f32 v224, v224, v225
  s_add_u32 s92, s91, 33554432
  s_bitcmp1_b32 s65, 10
  s_cselect_b64 s[80:81], s[68:69], s[4:5]
  s_cselect_b32 s82, s70, s6
  s_cselect_b32 s92, s91, s92
  buffer_store_dwordx4 v[164:167], v0, s[80:83], s92 offen sc1
  v_add_f32_dpp v224, v224, v224 row_ror:8 row_mask:0xf bank_mask:0xf
  s_nop 1
  v_add_f32_dpp v224, v224, v224 row_ror:4 row_mask:0xf bank_mask:0xf
  s_nop 1
  v_add_f32_dpp v224, v224, v224 row_ror:2 row_mask:0xf bank_mask:0xf
  s_nop 1
  v_add_f32_dpp v224, v224, v224 row_ror:1 row_mask:0xf bank_mask:0xf
  v_mov_b32 v225, v224
  s_nop 0
  s_nop 0
  v_permlane16_swap_b32 v224, v225
  v_add_f32 v224, v224, v225
  v_mov_b32 v225, v224
  s_nop 0
  s_nop 0
  v_permlane32_swap_b32 v224, v225
  v_add_f32 v224, v224, v225
  v_cvt_pk_bf16_f32 v224, 0, v224
  v_ashrrev_i32 v225, 31, v224
  v_or_b32 v225, 0x80000000, v225
  v_xor_b32 v224, v224, v225
  s_sub_u32 s92, 4095, s90
  v_and_b32 v224, 0xffff0000, v224
  v_or_b32 v224, s92, v224
  s_bfe_u32 s92, s65, 196619
  s_lshl_b32 s92, s92, 13
  s_lshl_b32 s93, s90, 2
  s_add_u32 s92, s92, s93
  s_add_u32 s92, s92, 5242880
  v_cvt_pk_bf16_f32 v140, v92, v96
  v_cvt_pk_bf16_f32 v141, v100, v104
  v_cvt_pk_bf16_f32 v142, v108, v112
  v_cvt_pk_bf16_f32 v143, v116, v120
  s_add_u32 s26, s86, 262144
  buffer_store_dwordx4 v[140:143], v4, s[4:7], s26 offen sc1
  v_cvt_pk_bf16_f32 v144, v93, v97
  v_cvt_pk_bf16_f32 v145, v101, v105
  v_cvt_pk_bf16_f32 v146, v109, v113
  v_cvt_pk_bf16_f32 v147, v117, v121
  s_add_u32 s26, s86, 278528
  buffer_store_dwordx4 v[144:147], v4, s[4:7], s26 offen sc1
  v_cvt_pk_bf16_f32 v148, v94, v98
  v_cvt_pk_bf16_f32 v149, v102, v106
  v_cvt_pk_bf16_f32 v150, v110, v114
  v_cvt_pk_bf16_f32 v151, v118, v122
  s_add_u32 s26, s86, 294912
  buffer_store_dwordx4 v[148:151], v4, s[4:7], s26 offen sc1
  v_cvt_pk_bf16_f32 v152, v95, v99
  v_cvt_pk_bf16_f32 v153, v103, v107
  v_cvt_pk_bf16_f32 v154, v111, v115
  v_cvt_pk_bf16_f32 v155, v119, v123
  s_add_u32 s26, s86, 311296
  buffer_store_dwordx4 v[152:155], v4, s[4:7], s26 offen sc1
  s_waitcnt vmcnt(4)
  s_mov_b64 exec, 1
  buffer_store_dword v224, off, s[4:7], s92 sc1
  s_mov_b64 exec, -1
o_we_126:
  s_mov_b32 s65, s63
  s_lshl_b32 s79, s60, 6
  s_add_u32 s79, s79, s61
  s_lshl_b32 s79, s79, 2
  s_add_u32 s79, s79, s17
  s_lshl_b32 s79, s79, 2
  s_add_u32 s79, s79, 5283840
  s_cmp_eq_u32 s51, 0
  s_cbranch_scc1 o_fl_114
  s_cmp_lg_u32 s76, 0
  s_cbranch_scc1 o_nofl_113
o_fl_114:
  s_waitcnt vmcnt(0)
  v_mov_b32 v7, s62
  s_mov_b64 exec, 1
  buffer_store_dword v7, off, s[4:7], s79 sc1
  s_mov_b64 exec, -1
  s_mov_b32 s79, 268435456
  s_cmp_ge_u32 s17, 2
  s_cbranch_scc1 o_fd_127
  s_cmp_eq_u32 s65, 0
  s_cbranch_scc1 o_fd_127
  s_lshl_b32 s26, s60, 10
  s_add_u32 s26, s26, 5283840
  s_mov_b32 s67, 0
o_wob_129:
  buffer_load_dword v7, v2, s[4:7], s26 offen sc1
  s_add_u32 s67, s67, 1
  s_cmp_gt_u32 s67, 1048576
  s_cbranch_scc1 L_end
  s_waitcnt vmcnt(0)
  v_cmp_gt_u32 vcc, s62, v7
  s_cbranch_vccnz o_wob_129
  s_and_b32 s26, s65, 768
  s_cbranch_scc1 o_f2_128
  s_lshl_b32 s90, s61, 1
  s_add_u32 s90, s90, s17
  s_and_b32 s94, s62, 1
  s_lshl_b32 s94, s94, 5
  s_add_u32 s94, s94, s90
  s_lshl_b32 s94, s94, 14
  s_lshl_b32 s92, s60, 21
  s_add_u32 s94, s94, s92
  s_add_u32 s94, s94, 12582912
  buffer_load_dwordx4 v[156:159], v5, s[4:7], s94 offen offset:0 sc1
  buffer_load_dwordx4 v[160:163], v5, s[4:7], s94 offen offset:256 sc1
  buffer_load_dwordx4 v[164:167], v5, s[4:7], s94 offen offset:512 sc1
  buffer_load_dwordx4 v[168:171], v5, s[4:7], s94 offen offset:768 sc1
  s_add_u32 s94, s94, 4096
  buffer_load_dwordx4 v[172:175], v5, s[4:7], s94 offen offset:0 sc1
  buffer_load_dwordx4 v[176:179], v5, s[4:7], s94 offen offset:256 sc1
  buffer_load_dwordx4 v[180:183], v5, s[4:7], s94 offen offset:512 sc1
  buffer_load_dwordx4 v[184:187], v5, s[4:7], s94 offen offset:768 sc1
  s_add_u32 s94, s94, 4096
  buffer_load_dwordx4 v[188:191], v5, s[4:7], s94 offen offset:0 sc1
  buffer_load_dwordx4 v[192:195], v5, s[4:7], s94 offen offset:256 sc1
  buffer_load_dwordx4 v[196:199], v5, s[4:7], s94 offen offset:512 sc1
  buffer_load_dwordx4 v[200:203], v5, s[4:7], s94 offen offset:768 sc1
  s_add_u32 s94, s94, 4096
  buffer_load_dwordx4 v[204:207], v5, s[4:7], s94 offen offset:0 sc1
  buffer_load_dwordx4 v[208:211], v5, s[4:7], s94 offen offset:256 sc1
  buffer_load_dwordx4 v[212:215], v5, s[4:7], s94 offen offset:512 sc1
  buffer_load_dwordx4 v[216:219], v5, s[4:7], s94 offen offset:768 sc1
  s_and_b32 s91, s65, 63
  s_lshl_b32 s94, s91, 11
  s_lshl_b32 s91, s91, 5
  s_add_u32 s90, s90, s91
  s_lshl_b32 s91, s90, 10
  buffer_load_dwordx4 v[220:223], v0, s[72:75], s91 offen
  s_waitcnt vmcnt(16)
  v_mfma_f32_16x16x32_bf16 v[224:227], v[16:19], v[156:159], 0
  s_waitcnt vmcnt(15)
  v_mfma_f32_16x16x32_bf16 v[228:231], v[16:19], v[160:163], 0
  s_waitcnt vmcnt(14)
  v_mfma_f32_16x16x32_bf16 v[224:227], v[20:23], v[164:167], v[224:227]
  s_waitcnt vmcnt(13)
  v_mfma_f32_16x16x32_bf16 v[228:231], v[20:23], v[168:171], v[228:231]
  s_waitcnt vmcnt(12)
  v_mfma_f32_16x16x32_bf16 v[224:227], v[16:19], v[172:175], v[224:227]
  s_waitcnt vmcnt(11)
  v_mfma_f32_16x16x32_bf16 v[228:231], v[16:19], v[176:179], v[228:231]
  s_waitcnt vmcnt(10)
  v_mfma_f32_16x16x32_bf16 v[224:227], v[20:23], v[180:183], v[224:227]
  s_waitcnt vmcnt(9)
  v_mfma_f32_16x16x32_bf16 v[228:231], v[20:23], v[184:187], v[228:231]
  s_waitcnt vmcnt(8)
  v_mfma_f32_16x16x32_bf16 v[224:227], v[16:19], v[188:191], v[224:227]
  s_waitcnt vmcnt(7)
  v_mfma_f32_16x16x32_bf16 v[228:231], v[16:19], v[192:195], v[228:231]
  s_waitcnt vmcnt(6)
  v_mfma_f32_16x16x32_bf16 v[224:227], v[20:23], v[196:199], v[224:227]
  s_waitcnt vmcnt(5)
  v_mfma_f32_16x16x32_bf16 v[228:231], v[20:23], v[200:203], v[228:231]
  s_waitcnt vmcnt(4)
  v_mfma_f32_16x16x32_bf16 v[224:227], v[16:19], v[204:207], v[224:227]
  s_waitcnt vmcnt(3)
  v_mfma_f32_16x16x32_bf16 v[228:231], v[16:19], v[208:211], v[228:231]
  s_waitcnt vmcnt(2)
  v_mfma_f32_16x16x32_bf16 v[224:227], v[20:23], v[212:215], v[224:227]
  s_waitcnt vmcnt(1)
  v_mfma_f32_16x16x32_bf16 v[228:231], v[20:23], v[216:219], v[228:231]
  s_bfe_u32 s92, s65, 131080
  s_lshl_b32 s92, s92, 21
  s_add_u32 s92, s92, s91
  s_add_u32 s93, s92, 27262976
  s_add_u32 s92, s92, 20971520
  s_waitcnt vmcnt(0)
  v_lshlrev_b32 v232, 16, v220
  v_and_b32 v233, 0xffff0000, v220
  v_lshlrev_b32 v234, 16, v221
  v_and_b32 v235, 0xffff0000, v221
  v_lshlrev_b32 v236, 16, v222
  v_and_b32 v237, 0xffff0000, v222
  v_lshlrev_b32 v238, 16, v223
  v_and_b32 v239, 0xffff0000, v223
  v_permlane16_swap_b32 v224, v228
  v_permlane16_swap_b32 v225, v229
  v_permlane16_swap_b32 v226, v230
  v_permlane16_swap_b32 v227, v231
  v_cvt_pk_bf16_f32 v224, 0, v224
  v_cvt_pk_bf16_f32 v225, 0, v225
  v_cvt_pk_bf16_f32 v226, 0, v226
  v_cvt_pk_bf16_f32 v227, 0, v227
  v_cvt_pk_bf16_f32 v228, 0, v228
  v_cvt_pk_bf16_f32 v229, 0, v229
  v_cvt_pk_bf16_f32 v230, 0, v230
  v_cvt_pk_bf16_f32 v231, 0, v231
  v_add_f32 v232, v232, v224
  v_add_f32 v233, v233, v225
  v_add_f32 v234, v234, v226
  v_add_f32 v235, v235, v227
  v_add_f32 v236, v236, v228
  v_add_f32 v237, v237, v229
  v_add_f32 v238, v238, v230
  v_add_f32 v239, v239, v231
  v_cvt_pk_bf16_f32 v156, v232, v233
  v_cvt_pk_bf16_f32 v157, v234, v235
  v_cvt_pk_bf16_f32 v158, v236, v237
  v_cvt_pk_bf16_f32 v159, v238, v239
  v_lshlrev_b32 v232, 16, v156
  v_and_b32 v233, 0xffff0000, v156
  v_lshlrev_b32 v234, 16, v157
  v_and_b32 v235, 0xffff0000, v157
  v_lshlrev_b32 v236, 16, v158
  v_and_b32 v237, 0xffff0000, v158
  v_lshlrev_b32 v238, 16, v159
  v_and_b32 v239, 0xffff0000, v159
  buffer_store_dwordx4 v[156:159], v0, s[4:7], s92 offen sc1
  v_add_f32 v172, v232, v233
  v_add_f32 v173, v234, v235
  v_add_f32 v174, v236, v237
  v_add_f32 v175, v238, v239
  v_add_f32 v172, v172, v173
  v_add_f32 v174, v174, v175
  v_add_f32 v172, v172, v174
  s_nop 1
  v_add_f32_dpp v172, v172, v172 row_ror:8 row_mask:0xf bank_mask:0xf
  s_nop 1
  v_add_f32_dpp v172, v172, v172 row_ror:4 row_mask:0xf bank_mask:0xf
  s_nop 1
  v_add_f32_dpp v172, v172, v172 row_ror:2 row_mask:0xf bank_mask:0xf
  s_nop 1
  v_add_f32_dpp v172, v172, v172 row_ror:1 row_mask:0xf bank_mask:0xf
  v_mov_b32 v174, v172
  s_nop 0
  s_nop 0
  v_permlane16_swap_b32 v172, v174
  v_add_f32 v172, v172, v174
  v_mov_b32 v174, v172
  s_nop 0
  s_nop 0
  v_permlane32_swap_b32 v172, v174
  v_add_f32 v172, v172, v174
  v_mul_f32 v172, 0x3b000000, v172
  v_sub_f32 v176, v232, v172
  v_sub_f32 v177, v233, v172
  v_sub_f32 v178, v234, v172
  v_sub_f32 v179, v235, v172
  v_sub_f32 v180, v236, v172
  v_sub_f32 v181, v237, v172
  v_sub_f32 v182, v238, v172
  v_sub_f32 v183, v239, v172
  v_mul_f32 v173, v176, v176
  v_mul_f32 v174, v177, v177
  v_fmac_f32 v173, v178, v178
  v_fmac_f32 v174, v179, v179
  v_fmac_f32 v173, v180, v180
  v_fmac_f32 v174, v181, v181
  v_fmac_f32 v173, v182, v182
  v_fmac_f32 v174, v183, v183
  v_add_f32 v173, v173, v174
  v_cvt_pk_bf16_f32 v172, 0, v172
  s_nop 0
  v_add_f32_dpp v173, v173, v173 row_ror:8 row_mask:0xf bank_mask:0xf
  v_sub_f32 v176, v232, v172
  v_sub_f32 v177, v233, v172
  v_add_f32_dpp v173, v173, v173 row_ror:4 row_mask:0xf bank_mask:0xf
  v_sub_f32 v178, v234, v172
  v_sub_f32 v179, v235, v172
  v_add_f32_dpp v173, v173, v173 row_ror:2 row_mask:0xf bank_mask:0xf
  v_sub_f32 v180, v236, v172
  v_sub_f32 v181, v237, v172
  v_add_f32_dpp v173, v173, v173 row_ror:1 row_mask:0xf bank_mask:0xf
  v_sub_f32 v182, v238, v172
  v_sub_f32 v183, v239, v172
  v_mov_b32 v174, v173
  v_cvt_pk_bf16_f32 v176, 0, v176
  v_cvt_pk_bf16_f32 v177, 0, v177
  v_permlane16_swap_b32 v173, v174
  v_cvt_pk_bf16_f32 v178, 0, v178
  v_cvt_pk_bf16_f32 v179, 0, v179
  v_add_f32 v173, v173, v174
  v_cvt_pk_bf16_f32 v180, 0, v180
  v_cvt_pk_bf16_f32 v181, 0, v181
  v_mov_b32 v174, v173
  v_cvt_pk_bf16_f32 v182, 0, v182
  v_cvt_pk_bf16_f32 v183, 0, v183
  v_permlane32_swap_b32 v173, v174
  v_add_f32 v173, v173, v174
  v_mul_f32 v173, 0x3b000000, v173
  v_cvt_pk_bf16_f32 v173, 0, v173
  v_add_f32 v173, 0x3727c5ac, v173
  v_cvt_pk_bf16_f32 v173, 0, v173
  v_sqrt_f32 v173, v173
  s_nop 0
  v_cvt_pk_bf16_f32 v173, 0, v173
  v_rcp_f32 v173, v173
  s_nop 0
  v_mul_f32 v176, v176, v173
  v_mul_f32 v177, v177, v173
  v_mul_f32 v178, v178, v173
  v_mul_f32 v179, v179, v173
  v_mul_f32 v180, v180, v173
  v_mul_f32 v181, v181, v173
  v_mul_f32 v182, v182, v173
  v_mul_f32 v183, v183, v173
  v_cvt_pk_bf16_f32 v160, v176, v177
  v_cvt_pk_bf16_f32 v161, v178, v179
  v_cvt_pk_bf16_f32 v162, v180, v181
  v_cvt_pk_bf16_f32 v163, v182, v183
  v_lshlrev_b32 v240, 16, v160
  v_and_b32 v241, 0xffff0000, v160
  v_lshlrev_b32 v242, 16, v161
  v_and_b32 v243, 0xffff0000, v161
  v_lshlrev_b32 v244, 16, v162
  v_and_b32 v245, 0xffff0000, v162
  v_lshlrev_b32 v246, 16, v163
  v_and_b32 v247, 0xffff0000, v163
  buffer_store_dwordx4 v[160:163], v0, s[4:7], s93 offen sc1
  v_add_f32 v232, v232, v240
  v_add_f32 v233, v233, v241
  v_add_f32 v234, v234, v242
  v_add_f32 v235, v235, v243
  v_add_f32 v236, v236, v244
  v_add_f32 v237, v237, v245
  v_add_f32 v238, v238, v246
  v_add_f32 v239, v239, v247
  v_cvt_pk_bf16_f32 v164, v232, v233
  v_cvt_pk_bf16_f32 v165, v234, v235
  v_cvt_pk_bf16_f32 v166, v236, v237
  v_cvt_pk_bf16_f32 v167, v238, v239
  v_mul_f32 v224, v240, v8
  v_mul_f32 v225, v241, v9
  v_fmac_f32 v224, v242, v10
  v_fmac_f32 v225, v243, v11
  v_fmac_f32 v224, v244, v12
  v_fmac_f32 v225, v245, v13
  v_fmac_f32 v224, v246, v14
  v_fmac_f32 v225, v247, v15
  v_add_f32 v224, v224, v225
  s_add_u32 s92, s91, 10485760
  s_add_u32 s93, s91, 8388608
  buffer_store_dwordx4 v[164:167], v0, s[4:7], s92 offen sc1
  v_lshlrev_b32 v232, 16, v164
  v_and_b32 v233, 0xffff0000, v164
  v_lshlrev_b32 v234, 16, v165
  v_and_b32 v235, 0xffff0000, v165
  v_lshlrev_b32 v236, 16, v166
  v_and_b32 v237, 0xffff0000, v166
  v_lshlrev_b32 v238, 16, v167
  v_and_b32 v239, 0xffff0000, v167
  v_add_f32 v172, v232, v233
  v_add_f32 v173, v234, v235
  v_add_f32 v174, v236, v237
  v_add_f32 v175, v238, v239
  v_add_f32 v172, v172, v173
  v_add_f32 v174, v174, v175
  v_add_f32 v172, v172, v174
  s_nop 1
  v_add_f32_dpp v172, v172, v172 row_ror:8 row_mask:0xf bank_mask:0xf
  v_add_f32_dpp v224, v224, v224 row_ror:8 row_mask:0xf bank_mask:0xf
  s_nop 0
  v_add_f32_dpp v172, v172, v172 row_ror:4 row_mask:0xf bank_mask:0xf
  v_add_f32_dpp v224, v224, v224 row_ror:4 row_mask:0xf bank_mask:0xf
  s_nop 0
  v_add_f32_dpp v172, v172, v172 row_ror:2 row_mask:0xf bank_mask:0xf
  v_add_f32_dpp v224, v224, v224 row_ror:2 row_mask:0xf bank_mask:0xf
  s_nop 0
  v_add_f32_dpp v172, v172, v172 row_ror:1 row_mask:0xf bank_mask:0xf
  v_add_f32_dpp v224, v224, v224 row_ror:1 row_mask:0xf bank_mask:0xf
  v_mov_b32 v174, v172
  v_mov_b32 v175, v224
  s_nop 0
  v_permlane16_swap_b32 v172, v174
  v_permlane16_swap_b32 v224, v175
  v_add_f32 v172, v172, v174
  v_add_f32 v224, v224, v175
  v_mov_b32 v174, v172
  v_mov_b32 v175, v224
  s_nop 0
  v_permlane32_swap_b32 v172, v174
  v_permlane32_swap_b32 v224, v175
  v_add_f32 v172, v172, v174
  v_add_f32 v224, v224, v175
  v_mul_f32 v172, 0x3b000000, v172
  v_sub_f32 v176, v232, v172
  v_sub_f32 v177, v233, v172
  v_sub_f32 v178, v234, v172
  v_sub_f32 v179, v235, v172
  v_sub_f32 v180, v236, v172
  v_sub_f32 v181, v237, v172
  v_sub_f32 v182, v238, v172
  v_sub_f32 v183, v239, v172
  v_mul_f32 v173, v176, v176
  v_mul_f32 v174, v177, v177
  v_fmac_f32 v173, v178, v178
  v_fmac_f32 v174, v179, v179
  v_fmac_f32 v173, v180, v180
  v_fmac_f32 v174, v181, v181
  v_fmac_f32 v173, v182, v182
  v_fmac_f32 v174, v183, v183
  v_add_f32 v173, v173, v174
  v_cvt_pk_bf16_f32 v172, 0, v172
  s_nop 0
  v_add_f32_dpp v173, v173, v173 row_ror:8 row_mask:0xf bank_mask:0xf
  v_sub_f32 v176, v232, v172
  v_sub_f32 v177, v233, v172
  v_add_f32_dpp v173, v173, v173 row_ror:4 row_mask:0xf bank_mask:0xf
  v_sub_f32 v178, v234, v172
  v_sub_f32 v179, v235, v172
  v_add_f32_dpp v173, v173, v173 row_ror:2 row_mask:0xf bank_mask:0xf
  v_sub_f32 v180, v236, v172
  v_sub_f32 v181, v237, v172
  v_add_f32_dpp v173, v173, v173 row_ror:1 row_mask:0xf bank_mask:0xf
  v_sub_f32 v182, v238, v172
  v_sub_f32 v183, v239, v172
  v_mov_b32 v174, v173
  v_cvt_pk_bf16_f32 v176, 0, v176
  v_cvt_pk_bf16_f32 v177, 0, v177
  v_permlane16_swap_b32 v173, v174
  v_cvt_pk_bf16_f32 v178, 0, v178
  v_cvt_pk_bf16_f32 v179, 0, v179
  v_add_f32 v173, v173, v174
  v_cvt_pk_bf16_f32 v180, 0, v180
  v_cvt_pk_bf16_f32 v181, 0, v181
  v_mov_b32 v174, v173
  v_cvt_pk_bf16_f32 v182, 0, v182
  v_cvt_pk_bf16_f32 v183, 0, v183
  v_permlane32_swap_b32 v173, v174
  v_add_f32 v173, v173, v174
  v_mul_f32 v173, 0x3b000000, v173
  v_cvt_pk_bf16_f32 v173, 0, v173
  v_add_f32 v173, 0x3727c5ac, v173
  v_cvt_pk_bf16_f32 v173, 0, v173
  v_sqrt_f32 v173, v173
  s_nop 0
  v_cvt_pk_bf16_f32 v173, 0, v173
  v_rcp_f32 v173, v173
  s_nop 0
  v_mul_f32 v176, v176, v173
  v_mul_f32 v177, v177, v173
  v_mul_f32 v178, v178, v173
  v_mul_f32 v179, v179, v173
  v_mul_f32 v180, v180, v173
  v_mul_f32 v181, v181, v173
  v_mul_f32 v182, v182, v173
  v_mul_f32 v183, v183, v173
  v_cvt_pk_bf16_f32 v168, v176, v177
  v_cvt_pk_bf16_f32 v169, v178, v179
  v_cvt_pk_bf16_f32 v170, v180, v181
  v_cvt_pk_bf16_f32 v171, v182, v183
  buffer_store_dwordx4 v[168:171], v0, s[4:7], s93 offen sc1
  v_cvt_pk_bf16_f32 v224, 0, v224
  v_ashrrev_i32 v225, 31, v224
  v_or_b32 v225, 0x80000000, v225
  v_xor_b32 v224, v224, v225
  s_sub_u32 s92, 4095, s90
  v_and_b32 v224, 0xffff0000, v224
  v_or_b32 v224, s92, v224
  s_bfe_u32 s92, s65, 196619
  s_lshl_b32 s92, s92, 13
  s_lshl_b32 s93, s90, 2
  s_add_u32 s92, s92, s93
  s_add_u32 s92, s92, 5242880
  s_waitcnt vmcnt(0)
  s_mov_b64 exec, 1
  buffer_store_dword v224, off, s[4:7], s92 sc1
  s_mov_b64 exec, -1
  s_branch o_fd_127
o_f2_128:
  s_lshl_b32 s90, s61, 1
  s_add_u32 s90, s90, s17
  s_and_b32 s94, s62, 1
  s_lshl_b32 s94, s94, 5
  s_add_u32 s94, s94, s90
  s_lshl_b32 s94, s94, 14
  s_lshl_b32 s92, s60, 21
  s_add_u32 s94, s94, s92
  s_add_u32 s94, s94, 12582912
  buffer_load_dwordx4 v[156:159], v5, s[4:7], s94 offen offset:0 sc1
  buffer_load_dwordx4 v[160:163], v5, s[4:7], s94 offen offset:256 sc1
  buffer_load_dwordx4 v[164:167], v5, s[4:7], s94 offen offset:512 sc1
  buffer_load_dwordx4 v[168:171], v5, s[4:7], s94 offen offset:768 sc1
  s_add_u32 s94, s94, 4096
  buffer_load_dwordx4 v[172:175], v5, s[4:7], s94 offen offset:0 sc1
  buffer_load_dwordx4 v[176:179], v5, s[4:7], s94 offen offset:256 sc1
  buffer_load_dwordx4 v[180:183], v5, s[4:7], s94 offen offset:512 sc1
  buffer_load_dwordx4 v[184:187], v5, s[4:7], s94 offen offset:768 sc1
  s_add_u32 s94, s94, 4096
  buffer_load_dwordx4 v[188:191], v5, s[4:7], s94 offen offset:0 sc1
  buffer_load_dwordx4 v[192:195], v5, s[4:7], s94 offen offset:256 sc1
  buffer_load_dwordx4 v[196:199], v5, s[4:7], s94 offen offset:512 sc1
  buffer_load_dwordx4 v[200:203], v5, s[4:7], s94 offen offset:768 sc1
  s_add_u32 s94, s94, 4096
  buffer_load_dwordx4 v[204:207], v5, s[4:7], s94 offen offset:0 sc1
  buffer_load_dwordx4 v[208:211], v5, s[4:7], s94 offen offset:256 sc1
  buffer_load_dwordx4 v[212:215], v5, s[4:7], s94 offen offset:512 sc1
  buffer_load_dwordx4 v[216:219], v5, s[4:7], s94 offen offset:768 sc1
  s_lshr_b32 s92, s65, 16
  s_xor_b32 s93, s90, 32
  s_and_b32 s91, s65, 63
  s_lshl_b32 s94, s91, 11
  s_lshl_b32 s91, s91, 5
  s_add_u32 s90, s90, s91
  s_lshl_b32 s91, s90, 10
  s_add_u32 s94, s94, 26214400
  s_cmp_eq_u32 s92, s93
  s_cselect_b32 s92, s94, s91
  s_add_u32 s92, s92, 10485760
  buffer_load_dwordx4 v[220:223], v0, s[4:7], s92 offen sc1
  s_waitcnt vmcnt(16)
  v_mfma_f32_16x16x32_bf16 v[224:227], v[16:19], v[156:159], 0
  s_waitcnt vmcnt(15)
  v_mfma_f32_16x16x32_bf16 v[228:231], v[16:19], v[160:163], 0
  s_waitcnt vmcnt(14)
  v_mfma_f32_16x16x32_bf16 v[224:227], v[20:23], v[164:167], v[224:227]
  s_waitcnt vmcnt(13)
  v_mfma_f32_16x16x32_bf16 v[228:231], v[20:23], v[168:171], v[228:231]
  s_waitcnt vmcnt(12)
  v_mfma_f32_16x16x32_bf16 v[224:227], v[16:19], v[172:175], v[224:227]
  s_waitcnt vmcnt(11)
  v_mfma_f32_16x16x32_bf16 v[228:231], v[16:19], v[176:179], v[228:231]
  s_waitcnt vmcnt(10)
  v_mfma_f32_16x16x32_bf16 v[224:227], v[20:23], v[180:183], v[224:227]
  s_waitcnt vmcnt(9)
  v_mfma_f32_16x16x32_bf16 v[228:231], v[20:23], v[184:187], v[228:231]
  s_waitcnt vmcnt(8)
  v_mfma_f32_16x16x32_bf16 v[224:227], v[16:19], v[188:191], v[224:227]
  s_waitcnt vmcnt(7)
  v_mfma_f32_16x16x32_bf16 v[228:231], v[16:19], v[192:195], v[228:231]
  s_waitcnt vmcnt(6)
  v_mfma_f32_16x16x32_bf16 v[224:227], v[20:23], v[196:199], v[224:227]
  s_waitcnt vmcnt(5)
  v_mfma_f32_16x16x32_bf16 v[228:231], v[20:23], v[200:203], v[228:231]
  s_waitcnt vmcnt(4)
  v_mfma_f32_16x16x32_bf16 v[224:227], v[16:19], v[204:207], v[224:227]
  s_waitcnt vmcnt(3)
  v_mfma_f32_16x16x32_bf16 v[228:231], v[16:19], v[208:211], v[228:231]
  s_waitcnt vmcnt(2)
  v_mfma_f32_16x16x32_bf16 v[224:227], v[20:23], v[212:215], v[224:227]
  s_waitcnt vmcnt(1)
  v_mfma_f32_16x16x32_bf16 v[228:231], v[20:23], v[216:219], v[228:231]
  s_bfe_u32 s92, s65, 131080
  s_lshl_b32 s92, s92, 21
  s_add_u32 s92, s92, s91
  s_add_u32 s93, s92, 27262976
  s_add_u32 s92, s92, 20971520
  s_waitcnt vmcnt(0)
  v_lshlrev_b32 v232, 16, v220
  v_and_b32 v233, 0xffff0000, v220
  v_lshlrev_b32 v234, 16, v221
  v_and_b32 v235, 0xffff0000, v221
  v_lshlrev_b32 v236, 16, v222
  v_and_b32 v237, 0xffff0000, v222
  v_lshlrev_b32 v238, 16, v223
  v_and_b32 v239, 0xffff0000, v223
  v_permlane16_swap_b32 v224, v228
  v_permlane16_swap_b32 v225, v229
  v_permlane16_swap_b32 v226, v230
  v_permlane16_swap_b32 v227, v231
  v_cvt_pk_bf16_f32 v224, 0, v224
  v_cvt_pk_bf16_f32 v225, 0, v225
  v_cvt_pk_bf16_f32 v226, 0, v226
  v_cvt_pk_bf16_f32 v227, 0, v227
  v_cvt_pk_bf16_f32 v228, 0, v228
  v_cvt_pk_bf16_f32 v229, 0, v229
  v_cvt_pk_bf16_f32 v230, 0, v230
  v_cvt_pk_bf16_f32 v231, 0, v231
  v_add_f32 v232, v232, v224
  v_add_f32 v233, v233, v225
  v_add_f32 v234, v234, v226
  v_add_f32 v235, v235, v227
  v_add_f32 v236, v236, v228
  v_add_f32 v237, v237, v229
  v_add_f32 v238, v238, v230
  v_add_f32 v239, v239, v231
  v_cvt_pk_bf16_f32 v156, v232, v233
  v_cvt_pk_bf16_f32 v157, v234, v235
  v_cvt_pk_bf16_f32 v158, v236, v237
  v_cvt_pk_bf16_f32 v159, v238, v239
  v_lshlrev_b32 v232, 16, v156
  v_and_b32 v233, 0xffff0000, v156
  v_lshlrev_b32 v234, 16, v157
  v_and_b32 v235, 0xffff0000, v157
  v_lshlrev_b32 v236, 16, v158
  v_and_b32 v237, 0xffff0000, v158
  v_lshlrev_b32 v238, 16, v159
  v_and_b32 v239, 0xffff0000, v159
  buffer_store_dwordx4 v[156:159], v0, s[4:7], s92 offen sc1
  v_add_f32 v172, v232, v233
  v_add_f32 v173, v234, v235
  v_add_f32 v174, v236, v237
  v_add_f32 v175, v238, v239
  v_add_f32 v172, v172, v173
  v_add_f32 v174, v174, v175
  v_add_f32 v172, v172, v174
  s_nop 1
  v_add_f32_dpp v172, v172, v172 row_ror:8 row_mask:0xf bank_mask:0xf
  s_nop 1
  v_add_f32_dpp v172, v172, v172 row_ror:4 row_mask:0xf bank_mask:0xf
  s_nop 1
  v_add_f32_dpp v172, v172, v172 row_ror:2 row_mask:0xf bank_mask:0xf
  s_nop 1
  v_add_f32_dpp v172, v172, v172 row_ror:1 row_mask:0xf bank_mask:0xf
  v_mov_b32 v174, v172
  s_nop 0
  s_nop 0
  v_permlane16_swap_b32 v172, v174
  v_add_f32 v172, v172, v174
  v_mov_b32 v174, v172
  s_nop 0
  s_nop 0
  v_permlane32_swap_b32 v172, v174
  v_add_f32 v172, v172, v174
  v_mul_f32 v172, 0x3b000000, v172
  v_sub_f32 v176, v232, v172
  v_sub_f32 v177, v233, v172
  v_sub_f32 v178, v234, v172
  v_sub_f32 v179, v235, v172
  v_sub_f32 v180, v236, v172
  v_sub_f32 v181, v237, v172
  v_sub_f32 v182, v238, v172
  v_sub_f32 v183, v239, v172
  v_mul_f32 v173, v176, v176
  v_mul_f32 v174, v177, v177
  v_fmac_f32 v173, v178, v178
  v_fmac_f32 v174, v179, v179
  v_fmac_f32 v173, v180, v180
  v_fmac_f32 v174, v181, v181
  v_fmac_f32 v173, v182, v182
  v_fmac_f32 v174, v183, v183
  v_add_f32 v173, v173, v174
  v_cvt_pk_bf16_f32 v172, 0, v172
  s_nop 0
  v_add_f32_dpp v173, v173, v173 row_ror:8 row_mask:0xf bank_mask:0xf
  v_sub_f32 v176, v232, v172
  v_sub_f32 v177, v233, v172
  v_add_f32_dpp v173, v173, v173 row_ror:4 row_mask:0xf bank_mask:0xf
  v_sub_f32 v178, v234, v172
  v_sub_f32 v179, v235, v172
  v_add_f32_dpp v173, v173, v173 row_ror:2 row_mask:0xf bank_mask:0xf
  v_sub_f32 v180, v236, v172
  v_sub_f32 v181, v237, v172
  v_add_f32_dpp v173, v173, v173 row_ror:1 row_mask:0xf bank_mask:0xf
  v_sub_f32 v182, v238, v172
  v_sub_f32 v183, v239, v172
  v_mov_b32 v174, v173
  v_cvt_pk_bf16_f32 v176, 0, v176
  v_cvt_pk_bf16_f32 v177, 0, v177
  v_permlane16_swap_b32 v173, v174
  v_cvt_pk_bf16_f32 v178, 0, v178
  v_cvt_pk_bf16_f32 v179, 0, v179
  v_add_f32 v173, v173, v174
  v_cvt_pk_bf16_f32 v180, 0, v180
  v_cvt_pk_bf16_f32 v181, 0, v181
  v_mov_b32 v174, v173
  v_cvt_pk_bf16_f32 v182, 0, v182
  v_cvt_pk_bf16_f32 v183, 0, v183
  v_permlane32_swap_b32 v173, v174
  v_add_f32 v173, v173, v174
  v_mul_f32 v173, 0x3b000000, v173
  v_cvt_pk_bf16_f32 v173, 0, v173
  v_add_f32 v173, 0x3727c5ac, v173
  v_cvt_pk_bf16_f32 v173, 0, v173
  v_sqrt_f32 v173, v173
  s_nop 0
  v_cvt_pk_bf16_f32 v173, 0, v173
  v_rcp_f32 v173, v173
  s_nop 0
  v_mul_f32 v176, v176, v173
  v_mul_f32 v177, v177, v173
  v_mul_f32 v178, v178, v173
  v_mul_f32 v179, v179, v173
  v_mul_f32 v180, v180, v173
  v_mul_f32 v181, v181, v173
  v_mul_f32 v182, v182, v173
  v_mul_f32 v183, v183, v173
  v_cvt_pk_bf16_f32 v160, v176, v177
  v_cvt_pk_bf16_f32 v161, v178, v179
  v_cvt_pk_bf16_f32 v162, v180, v181
  v_cvt_pk_bf16_f32 v163, v182, v183
  v_lshlrev_b32 v240, 16, v160
  v_and_b32 v241, 0xffff0000, v160
  v_lshlrev_b32 v242, 16, v161
  v_and_b32 v243, 0xffff0000, v161
  v_lshlrev_b32 v244, 16, v162
  v_and_b32 v245, 0xffff0000, v162
  v_lshlrev_b32 v246, 16, v163
  v_and_b32 v247, 0xffff0000, v163
  buffer_store_dwordx4 v[160:163], v0, s[4:7], s93 offen sc1
  v_add_f32 v232, v232, v240
  v_add_f32 v233, v233, v241
  v_add_f32 v234, v234, v242
  v_add_f32 v235, v235, v243
  v_add_f32 v236, v236, v244
  v_add_f32 v237, v237, v245
  v_add_f32 v238, v238, v246
  v_add_f32 v239, v239, v247
  v_cvt_pk_bf16_f32 v164, v232, v233
  v_cvt_pk_bf16_f32 v165, v234, v235
  v_cvt_pk_bf16_f32 v166, v236, v237
  v_cvt_pk_bf16_f32 v167, v238, v239
  v_mul_f32 v224, v240, v8
  v_mul_f32 v225, v241, v9
  v_fmac_f32 v224, v242, v10
  v_fmac_f32 v225, v243, v11
  v_fmac_f32 v224, v244, v12
  v_fmac_f32 v225, v245, v13
  v_fmac_f32 v224, v246, v14
  v_fmac_f32 v225, v247, v15
  v_add_f32 v224, v224, v225
  s_add_u32 s92, s91, 33554432
  s_bitcmp1_b32 s65, 10
  s_cselect_b64 s[80:81], s[68:69], s[4:5]
  s_cselect_b32 s82, s70, s6
  s_cselect_b32 s92, s91, s92
  buffer_store_dwordx4 v[164:167], v0, s[80:83], s92 offen sc1
  v_add_f32_dpp v224, v224, v224 row_ror:8 row_mask:0xf bank_mask:0xf
  s_nop 1
  v_add_f32_dpp v224, v224, v224 row_ror:4 row_mask:0xf bank_mask:0xf
  s_nop 1
  v_add_f32_dpp v224, v224, v224 row_ror:2 row_mask:0xf bank_mask:0xf
  s_nop 1
  v_add_f32_dpp v224, v224, v224 row_ror:1 row_mask:0xf bank_mask:0xf
  v_mov_b32 v225, v224
  s_nop 0
  s_nop 0
  v_permlane16_swap_b32 v224, v225
  v_add_f32 v224, v224, v225
  v_mov_b32 v225, v224
  s_nop 0
  s_nop 0
  v_permlane32_swap_b32 v224, v225
  v_add_f32 v224, v224, v225
  v_cvt_pk_bf16_f32 v224, 0, v224
  v_ashrrev_i32 v225, 31, v224
  v_or_b32 v225, 0x80000000, v225
  v_xor_b32 v224, v224, v225
  s_sub_u32 s92, 4095, s90
  v_and_b32 v224, 0xffff0000, v224
  v_or_b32 v224, s92, v224
  s_bfe_u32 s92, s65, 196619
  s_lshl_b32 s92, s92, 13
  s_lshl_b32 s93, s90, 2
  s_add_u32 s92, s92, s93
  s_add_u32 s92, s92, 5242880
  s_waitcnt vmcnt(0)
  s_mov_b64 exec, 1
  buffer_store_dword v224, off, s[4:7], s92 sc1
  s_mov_b64 exec, -1
o_fd_127:
  s_mov_b32 s65, 0
o_nofl_113:
  s_mov_b32 s63, s64
  s_cmp_eq_u32 s51, 1
  s_cbranch_scc1 o_d1_109
  s_cmp_eq_u32 s51, 2
  s_cbranch_scc1 o_d2_110
  s_cmp_eq_u32 s51, 4
  s_cbranch_scc1 o_tloop_112
  s_cmp_eq_u32 s51, 0
  s_cbranch_scc1 o_next_108
  s_add_u32 s47, s47, 4
o_next_108:
  s_add_u32 s49, s49, 4
  s_cmp_lt_u32 s49, 64
  s_cbranch_scc1 o_round_106
  s_mov_b32 s67, 0
  s_mov_b32 s26, 5251072
  s_mov_b32 s27, 5255168
k_w_130:
  buffer_load_dwordx4 v[160:163], v0, s[4:7], s26 offen offset:0 sc1
  buffer_load_dwordx4 v[164:167], v0, s[4:7], s26 offen offset:1024 sc1
  buffer_load_dwordx4 v[168:171], v0, s[4:7], s26 offen offset:2048 sc1
  buffer_load_dwordx4 v[172:175], v0, s[4:7], s26 offen offset:3072 sc1
  buffer_load_dwordx4 v[176:179], v0, s[4:7], s27 offen offset:0 sc1
  buffer_load_dwordx4 v[180:183], v0, s[4:7], s27 offen offset:1024 sc1
  buffer_load_dwordx4 v[184:187], v0, s[4:7], s27 offen offset:2048 sc1
  buffer_load_dwordx4 v[188:191], v0, s[4:7], s27 offen offset:3072 sc1
  s_add_u32 s67, s67, 1
  s_cmp_gt_u32 s67, 1048576
  s_cbranch_scc1 L_end
  s_sleep 2
  s_waitcnt vmcnt(0)
  v_min_u32 v192, v160, v161
  v_max_u32 v193, v160, v161
  v_min3_u32 v192, v162, v163, v192
  v_max3_u32 v193, v162, v163, v193
  v_min3_u32 v192, v164, v165, v192
  v_max3_u32 v193, v164, v165, v193
  v_min3_u32 v192, v166, v167, v192
  v_max3_u32 v193, v166, v167, v193
  v_min3_u32 v192, v168, v169, v192
  v_max3_u32 v193, v168, v169, v193
  v_min3_u32 v192, v170, v171, v192
  v_max3_u32 v193, v170, v171, v193
  v_min3_u32 v192, v172, v173, v192
  v_max3_u32 v193, v172, v173, v193
  v_min3_u32 v192, v174, v175, v192
  v_max3_u32 v193, v174, v175, v193
  v_min3_u32 v192, v176, v177, v192
  v_max3_u32 v193, v176, v177, v193
  v_min3_u32 v192, v178, v179, v192
  v_max3_u32 v193, v178, v179, v193
  v_min3_u32 v192, v180, v181, v192
  v_max3_u32 v193, v180, v181, v193
  v_min3_u32 v192, v182, v183, v192
  v_max3_u32 v193, v182, v183, v193
  v_min3_u32 v192, v184, v185, v192
  v_max3_u32 v193, v184, v185, v193
  v_min3_u32 v192, v186, v187, v192
  v_max3_u32 v193, v186, v187, v193
  v_min3_u32 v192, v188, v189, v192
  v_max3_u32 v193, v188, v189, v193
  v_min3_u32 v192, v190, v191, v192
  v_max3_u32 v193, v190, v191, v193
  v_cmp_eq_u32 vcc, 0, v192
  s_cbranch_vccnz k_w_130
  v_max_u32_dpp v193, v193, v193 row_ror:8 row_mask:0xf bank_mask:0xf
  s_nop 1
  v_max_u32_dpp v193, v193, v193 row_ror:4 row_mask:0xf bank_mask:0xf
  s_nop 1
  v_max_u32_dpp v193, v193, v193 row_ror:2 row_mask:0xf bank_mask:0xf
  s_nop 1
  v_max_u32_dpp v193, v193, v193 row_ror:1 row_mask:0xf bank_mask:0xf
  v_mov_b32 v192, v193
  s_nop 0
  s_nop 0
  v_permlane16_swap_b32 v193, v192
  v_max_u32 v193, v193, v192
  v_mov_b32 v192, v193
  s_nop 0
  s_nop 0
  v_permlane32_swap_b32 v193, v192
  v_max_u32 v193, v193, v192
  s_nop 0
  v_readfirstlane_b32 s78, v193
  s_mov_b32 s46, s78
  s_andn2_b32 s52, 0xfff, s46
  s_lshr_b32 s52, s52, 5
  s_cmp_ge_u32 s17, 2
  s_cbranch_scc1 f_done_131
  s_andn2_b32 s28, 0xfff, s46
  s_lshr_b32 s28, s28, 5
  s_lshl_b32 s77, s60, 5
  s_lshl_b32 s26, s61, 1
  s_add_u32 s77, s77, s26
  s_add_u32 s77, s77, s17
  s_add_u32 s26, s28, 3
  s_sub_u32 s26, s26, s60
  s_lshr_b32 s26, s26, 2
  s_lshl_b32 s26, 1, s26
  s_sub_u32 s26, s26, 1
  s_and_b32 s27, s26, s48
  s_mov_b32 s30, 268435456
  s_lshl_b32 s29, s77, 10
  s_add_u32 s31, s29, 33554432
  s_bitcmp1_b32 s27, 0
  s_cselect_b32 s31, s31, s30
  buffer_load_dwordx4 v[168:171], v0, s[4:7], s31 offen sc1
  s_add_u32 s31, s29, 33685504
  s_bitcmp1_b32 s27, 1
  s_cselect_b32 s31, s31, s30
  buffer_load_dwordx4 v[172:175], v0, s[4:7], s31 offen sc1
  s_add_u32 s31, s29, 33816576
  s_bitcmp1_b32 s27, 2
  s_cselect_b32 s31, s31, s30
  buffer_load_dwordx4 v[176:179], v0, s[4:7], s31 offen sc1
  s_add_u32 s31, s29, 33947648
  s_bitcmp1_b32 s27, 3
  s_cselect_b32 s31, s31, s30
  buffer_load_dwordx4 v[180:183], v0, s[4:7], s31 offen sc1
  s_add_u32 s31, s29, 34078720
  s_bitcmp1_b32 s27, 4
  s_cselect_b32 s31, s31, s30
  buffer_load_dwordx4 v[184:187], v0, s[4:7], s31 offen sc1
  s_add_u32 s31, s29, 34209792
  s_bitcmp1_b32 s27, 5
  s_cselect_b32 s31, s31, s30
  buffer_load_dwordx4 v[188:191], v0, s[4:7], s31 offen sc1
  s_add_u32 s31, s29, 34340864
  s_bitcmp1_b32 s27, 6
  s_cselect_b32 s31, s31, s30
  buffer_load_dwordx4 v[192:195], v0, s[4:7], s31 offen sc1
  s_add_u32 s31, s29, 34471936
  s_bitcmp1_b32 s27, 7
  s_cselect_b32 s31, s31, s30
  buffer_load_dwordx4 v[196:199], v0, s[4:7], s31 offen sc1
  s_add_u32 s31, s29, 34603008
  s_bitcmp1_b32 s27, 8
  s_cselect_b32 s31, s31, s30
  buffer_load_dwordx4 v[200:203], v0, s[4:7], s31 offen sc1
  s_add_u32 s31, s29, 34734080
  s_bitcmp1_b32 s27, 9
  s_cselect_b32 s31, s31, s30
  buffer_load_dwordx4 v[204:207], v0, s[4:7], s31 offen sc1
  s_add_u32 s31, s29, 34865152
  s_bitcmp1_b32 s27, 10
  s_cselect_b32 s31, s31, s30
  buffer_load_dwordx4 v[208:211], v0, s[4:7], s31 offen sc1
  s_add_u32 s31, s29, 34996224
  s_bitcmp1_b32 s27, 11
  s_cselect_b32 s31, s31, s30
  buffer_load_dwordx4 v[212:215], v0, s[4:7], s31 offen sc1
  s_add_u32 s31, s29, 35127296
  s_bitcmp1_b32 s27, 12
  s_cselect_b32 s31, s31, s30
  buffer_load_dwordx4 v[216:219], v0, s[4:7], s31 offen sc1
  s_add_u32 s31, s29, 35258368
  s_bitcmp1_b32 s27, 13
  s_cselect_b32 s31, s31, s30
  buffer_load_dwordx4 v[220:223], v0, s[4:7], s31 offen sc1
  s_add_u32 s31, s29, 35389440
  s_bitcmp1_b32 s27, 14
  s_cselect_b32 s31, s31, s30
  buffer_load_dwordx4 v[224:227], v0, s[4:7], s31 offen sc1
  s_add_u32 s31, s29, 35520512
  s_bitcmp1_b32 s27, 15
  s_cselect_b32 s31, s31, s30
  buffer_load_dwordx4 v[228:231], v0, s[4:7], s31 offen sc1
  v_lshlrev_b32 v160, 5, v0
  s_mov_b32 vcc_lo, s26
  s_mov_b32 vcc_hi, 0
  v_mov_b32 v161, 8192
  v_cndmask_b32 v161, v161, 0, vcc
  v_add_u32 v161, v161, v160
  s_lshl_b32 s31, s77, 2
  s_add_u32 s32, s31, 5275648
  s_add_u32 s31, s31, 5259264
  buffer_load_dword v162, v161, s[4:7], s31 offen sc1
  s_add_u32 s31, s29, 0
  s_bitcmp1_b32 s27, 0
  s_cselect_b32 s31, s31, s30
  s_waitcnt vmcnt(16)
  buffer_store_dwordx4 v[168:171], v0, s[68:71], s31 offen sc1
  s_add_u32 s31, s29, 131072
  s_bitcmp1_b32 s27, 1
  s_cselect_b32 s31, s31, s30
  s_waitcnt vmcnt(16)
  buffer_store_dwordx4 v[172:175], v0, s[68:71], s31 offen sc1
  s_add_u32 s31, s29, 262144
  s_bitcmp1_b32 s27, 2
  s_cselect_b32 s31, s31, s30
  s_waitcnt vmcnt(16)
  buffer_store_dwordx4 v[176:179], v0, s[68:71], s31 offen sc1
  s_add_u32 s31, s29, 393216
  s_bitcmp1_b32 s27, 3
  s_cselect_b32 s31, s31, s30
  s_waitcnt vmcnt(16)
  buffer_store_dwordx4 v[180:183], v0, s[68:71], s31 offen sc1
  s_add_u32 s31, s29, 524288
  s_bitcmp1_b32 s27, 4
  s_cselect_b32 s31, s31, s30
  s_waitcnt vmcnt(16)
  buffer_store_dwordx4 v[184:187], v0, s[68:71], s31 offen sc1
  s_add_u32 s31, s29, 655360
  s_bitcmp1_b32 s27, 5
  s_cselect_b32 s31, s31, s30
  s_waitcnt vmcnt(16)
  buffer_store_dwordx4 v[188:191], v0, s[68:71], s31 offen sc1
  s_add_u32 s31, s29, 786432
  s_bitcmp1_b32 s27, 6
  s_cselect_b32 s31, s31, s30
  s_waitcnt vmcnt(16)
  buffer_store_dwordx4 v[192:195], v0, s[68:71], s31 offen sc1
  s_add_u32 s31, s29, 917504
  s_bitcmp1_b32 s27, 7
  s_cselect_b32 s31, s31, s30
  s_waitcnt vmcnt(16)
  buffer_store_dwordx4 v[196:199], v0, s[68:71], s31 offen sc1
  s_add_u32 s31, s29, 1048576
  s_bitcmp1_b32 s27, 8
  s_cselect_b32 s31, s31, s30
  s_waitcnt vmcnt(16)
  buffer_store_dwordx4 v[200:203], v0, s[68:71], s31 offen sc1
  s_add_u32 s31, s29, 1179648
  s_bitcmp1_b32 s27, 9
  s_cselect_b32 s31, s31, s30
  s_waitcnt vmcnt(16)
  buffer_store_dwordx4 v[204:207], v0, s[68:71], s31 offen sc1
  s_add_u32 s31, s29, 1310720
  s_bitcmp1_b32 s27, 10
  s_cselect_b32 s31, s31, s30
  s_waitcnt vmcnt(16)
  buffer_store_dwordx4 v[208:211], v0, s[68:71], s31 offen sc1
  s_add_u32 s31, s29, 1441792
  s_bitcmp1_b32 s27, 11
  s_cselect_b32 s31, s31, s30
  s_waitcnt vmcnt(16)
  buffer_store_dwordx4 v[212:215], v0, s[68:71], s31 offen sc1
  s_add_u32 s31, s29, 1572864
  s_bitcmp1_b32 s27, 12
  s_cselect_b32 s31, s31, s30
  s_waitcnt vmcnt(16)
  buffer_store_dwordx4 v[216:219], v0, s[68:71], s31 offen sc1
  s_add_u32 s31, s29, 1703936
  s_bitcmp1_b32 s27, 13
  s_cselect_b32 s31, s31, s30
  s_waitcnt vmcnt(16)
  buffer_store_dwordx4 v[220:223], v0, s[68:71], s31 offen sc1
  s_add_u32 s31, s29, 1835008
  s_bitcmp1_b32 s27, 14
  s_cselect_b32 s31, s31, s30
  s_waitcnt vmcnt(16)
  buffer_store_dwordx4 v[224:227], v0, s[68:71], s31 offen sc1
  s_add_u32 s31, s29, 1966080
  s_bitcmp1_b32 s27, 15
  s_cselect_b32 s31, s31, s30
  s_waitcnt vmcnt(16)
  buffer_store_dwordx4 v[228:231], v0, s[68:71], s31 offen sc1
  s_mov_b32 vcc_lo, s48
  v_mov_b32 v161, 0x7ff00000
  v_cndmask_b32 v160, v161, v160, vcc
  s_waitcnt vmcnt(0)
  buffer_store_dword v162, v160, s[4:7], s32 offen sc1
f_done_131:
  s_mov_b32 s54, s47
  s_andn2_b32 s26, 31, s46
  s_or_b32 s26, s26, 32
  s_lshl_b32 s26, s26, 16
  s_or_b32 s26, s26, 26240
  s_cmp_eq_u32 s54, s52
  s_cselect_b32 s63, s26, 26176
  s_or_b32 s63, s63, s54
  s_or_b32 s26, s54, 25920
  s_cmp_lt_u32 s54, s52
  s_cselect_b32 s63, s26, s63
  s_cmp_lt_u32 s54, 64
  s_cselect_b32 s63, s63, 0
o_tloop_112:
  s_cmp_eq_u32 s63, 0
  s_cbranch_scc1 L_end
  s_add_u32 s54, s54, 4
  s_andn2_b32 s26, 31, s46
  s_or_b32 s26, s26, 32
  s_lshl_b32 s26, s26, 16
  s_or_b32 s26, s26, 26240
  s_cmp_eq_u32 s54, s52
  s_cselect_b32 s64, s26, 26176
  s_or_b32 s64, s64, s54
  s_or_b32 s26, s54, 25920
  s_cmp_lt_u32 s54, s52
  s_cselect_b32 s64, s26, s64
  s_cmp_lt_u32 s54, 64
  s_cselect_b32 s64, s64, 0
  s_mov_b32 s51, 4
  s_branch o_task_107
o_d1_109:
  s_cmp_lt_u32 s47, s52
  s_cbranch_scc1 o_d2_110
  s_lshr_b32 s26, s47, 2
  s_bitset1_b32 s48, s26
  s_mov_b32 s54, s47
  s_andn2_b32 s26, 31, s46
  s_or_b32 s26, s26, 32
  s_lshl_b32 s26, s26, 16
  s_or_b32 s26, s26, 24192
  s_cmp_eq_u32 s54, s52
  s_cselect_b32 s64, s26, 56896
  s_or_b32 s64, s64, s54
  s_mov_b32 s51, 2
  s_branch o_task_107
o_d2_110:
  s_mov_b32 s64, s53
  s_mov_b32 s51, 3
  s_branch o_task_107
.p2align 2
qkv_tab:
.long 0x830300, 0x830280, 0x860303, 0x860283, 0x890306, 0x890286, 0x8c0309, 0x8c0289, 0x8f030c, 0x8f028c, 0x92030f, 0x92028f, 0x950312, 0x950292, 0x980315, 0x980295, 0xc00318, 0xc00298, 0x9b13c0, 0x9b0640, 0x9b0ac0, 0xc2031b, 0xc2029b, 0x9d13c2, 0x9d0642, 0x9d0ac2, 0xc4031d, 0xc4029d, 0x9f13c4, 0x9f0644, 0x9f0ac4, 0xc6031f, 0xc6029f, 0xa113c6, 0xa10646, 0xa10ac6, 0xc80321, 0xc802a1, 0xa313c8, 0xa30648, 0xa30ac8, 0xca0323, 0xca02a3, 0xa513ca, 0xa5064a, 0xa50aca, 0xcc0325, 0xcc02a5, 0xa713cc, 0xa7064c, 0xa70acc, 0xce0327, 0xce02a7, 0xa913ce, 0xa9064e, 0xa90ace, 0xd00329, 0xd002a9, 0xab13d0, 0xab0650, 0xab0ad0, 0xd2032b, 0xd202ab, 0xad13d2, 0xad0652, 0xad0ad2, 0xd4032d, 0xd402ad, 0xaf13d4, 0xaf0654, 0xaf0ad4, 0xd6032f, 0xd602af, 0xb113d6, 0xb10656, 0xb10ad6, 0xd80331, 0xd802b1, 0xb313d8, 0xb30658, 0xb30ad8, 0xda0333, 0xda02b3, 0xb513da, 0xb5065a, 0xb50ada, 0xdc0335, 0xdc02b5, 0xb713dc, 0xb7065c, 0xb70adc, 0xde0337, 0xde02b7, 0xb913de, 0xb9065e, 0xb90ade, 0xe00339, 0xe002b9, 0xbb13e0, 0xbb0660, 0xbb0ae0, 0xe2033b, 0xe202bb, 0xbd13e2, 0xbd0662, 0xbd0ae2, 0xe4033d, 0xe402bd, 0xbf13e4, 0xbf0664, 0xbf0ae4, 0xe6033f, 0xe602bf, 0xe813e6, 0xe80666, 0xe80ae6, 0xea13e8, 0xea0668, 0xea0ae8, 0xec13ea, 0xec066a, 0xec0aea, 0xee13ec, 0xee066c, 0xee0aec, 0xf013ee, 0xf0066e, 0xf00aee, 0xf213f0, 0xf20670, 0xf20af0, 0xf413f2, 0xf40672, 0xf40af2, 0xf613f4, 0xf60674, 0xf60af4, 0xf813f6, 0xf80676, 0xf80af6, 0xfa13f8, 0xfa0678, 0xfa0af8, 0xfc13fa, 0xfc067a, 0xfc0afa, 0xfe13fc, 0xfe067c, 0xfe0afc, 0x13fe, 0x67e, 0xafe, 0x0, 0x0
.long 0x840301, 0x840281, 0x870304, 0x870284, 0x8a0307, 0x8a0287, 0x8d030a, 0x8d028a, 0x90030d, 0x90028d, 0x930310, 0x930290, 0x960313, 0x960293, 0x990316, 0x990296, 0xc10319, 0xc10299, 0x9c13c1, 0x9c0641, 0x9c0ac1, 0xc3031c, 0xc3029c, 0x9e13c3, 0x9e0643, 0x9e0ac3, 0xc5031e, 0xc5029e, 0xa013c5, 0xa00645, 0xa00ac5, 0xc70320, 0xc702a0, 0xa213c7, 0xa20647, 0xa20ac7, 0xc90322, 0xc902a2, 0xa413c9, 0xa40649, 0xa40ac9, 0xcb0324, 0xcb02a4, 0xa613cb, 0xa6064b, 0xa60acb, 0xcd0326, 0xcd02a6, 0xa813cd, 0xa8064d, 0xa80acd, 0xcf0328, 0xcf02a8, 0xaa13cf, 0xaa064f, 0xaa0acf, 0xd1032a, 0xd102aa, 0xac13d1, 0xac0651, 0xac0ad1, 0xd3032c, 0xd302ac, 0xae13d3, 0xae0653, 0xae0ad3, 0xd5032e, 0xd502ae, 0xb013d5, 0xb00655, 0xb00ad5, 0xd70330, 0xd702b0, 0xb213d7, 0xb20657, 0xb20ad7, 0xd90332, 0xd902b2, 0xb413d9, 0xb40659, 0xb40ad9, 0xdb0334, 0xdb02b4, 0xb613db, 0xb6065b, 0xb60adb, 0xdd0336, 0xdd02b6, 0xb813dd, 0xb8065d, 0xb80add, 0xdf0338, 0xdf02b8, 0xba13df, 0xba065f, 0xba0adf, 0xe1033a, 0xe102ba, 0xbc13e1, 0xbc0661, 0xbc0ae1, 0xe3033c, 0xe302bc, 0xbe13e3, 0xbe0663, 0xbe0ae3, 0xe5033e, 0xe502be, 0xe713e5, 0xe70665, 0xe70ae5, 0xe913e7, 0xe90667, 0xe90ae7, 0xeb13e9, 0xeb0669, 0xeb0ae9, 0xed13eb, 0xed066b, 0xed0aeb, 0xef13ed, 0xef066d, 0xef0aed, 0xf113ef, 0xf1066f, 0xf10aef, 0xf313f1, 0xf30671, 0xf30af1, 0xf513f3, 0xf50673, 0xf50af3, 0xf713f5, 0xf70675, 0xf70af5, 0xf913f7, 0xf90677, 0xf90af7, 0xfb13f9, 0xfb0679, 0xfb0af9, 0xfd13fb, 0xfd067b, 0xfd0afb, 0xff13fd, 0xff067d, 0xff0afd, 0x13ff, 0x67f, 0xaff, 0x0, 0x0, 0x0, 0x0
.long 0x850302, 0x850282, 0x880305, 0x880285, 0x8b0308, 0x8b0288, 0x8e030b, 0x8e028b, 0x91030e, 0x91028e, 0x940311, 0x940291, 0x970314, 0x970294, 0x9a0317, 0x9a0297, 0xc0031a, 0xc0029a, 0xc10340, 0xc20341, 0xc30342, 0xc40343, 0xc50344, 0xc60345, 0xc70346, 0xc80347, 0xc90348, 0xca0349, 0xcb034a, 0xcc034b, 0xcd034c, 0xce034d, 0xcf034e, 0xd0034f, 0xd10350, 0xd20351, 0xd30352, 0xd40353, 0xd50354, 0xd60355, 0xd70356, 0xd80357, 0xd90358, 0xda0359, 0xdb035a, 0xdc035b, 0xdd035c, 0xde035d, 0xdf035e, 0xe0035f, 0xe10360, 0xe20361, 0xe30362, 0xe40363, 0xe50364, 0xe60365, 0xe70366, 0xe80367, 0xe90368, 0xea0369, 0xeb036a, 0xec036b, 0xed036c, 0xee036d, 0xef036e, 0xf0036f, 0xf10370, 0xf20371, 0xf30372, 0xf40373, 0xf50374, 0xf60375, 0xf70376, 0xf80377, 0xf90378, 0xfa0379, 0xfb037a, 0xfc037b, 0xfd037c, 0xfe037d, 0xff037e, 0x37f, 0x0, 0x0, 0x0, 0x0, 0x0, 0x0, 0x0, 0x0, 0x0, 0x0, 0x0, 0x0, 0x0, 0x0, 0x0, 0x0, 0x0, 0x0, 0x0, 0x0, 0x0, 0x0, 0x0, 0x0, 0x0, 0x0, 0x0, 0x0, 0x0, 0x0, 0x0, 0x0, 0x0, 0x0, 0x0, 0x0, 0x0, 0x0, 0x0, 0x0, 0x0, 0x0, 0x0, 0x0, 0x0, 0x0, 0x0, 0x0, 0x0, 0x0, 0x0, 0x0, 0x0, 0x0, 0x0, 0x0, 0x0, 0x0, 0x0, 0x0, 0x0, 0x0, 0x0, 0x0, 0x0, 0x0, 0x0, 0x0, 0x0, 0x0, 0x0, 0x0

.section .rodata,"a"
.p2align 6
.amdhsa_kernel interleave_layers__memory_aug_recurrent_mem_tr__moe_arch_mod__prompt_kernel
  .amdhsa_next_free_vgpr 512
  .amdhsa_next_free_sgpr 102
  .amdhsa_accum_offset 256
  .amdhsa_group_segment_fixed_size 0
  .amdhsa_kernarg_size 120
  .amdhsa_user_sgpr_count 2
  .amdhsa_user_sgpr_kernarg_segment_ptr 1
  .amdhsa_system_sgpr_workgroup_id_x 1
  .amdhsa_float_denorm_mode_32 3
.end_amdhsa_kernel
```

```asm
; @launch grid=(256,1,1) block=(256,1,1) lds=163840
.amdgcn_target "amdgcn-amd-amdhsa--gfx950"
.text
.globl interleave_layers__memory_aug_recurrent_mem_tr__moe_arch_mod__prompt_kernel
.p2align 8
.type interleave_layers__memory_aug_recurrent_mem_tr__moe_arch_mod__prompt_kernel,@function
interleave_layers__memory_aug_recurrent_mem_tr__moe_arch_mod__prompt_kernel:
  s_cmp_ge_u32 s2, 256
  s_cbranch_scc1 L_end
  s_load_dwordx2 s[4:5], s[0:1], 112
  s_load_dwordx2 s[12:13], s[0:1], 104
  s_mov_b32 s6, 268435456
  s_mov_b32 s7, 0x20000
  s_mov_b32 s11, 0x20000
  s_getreg_b32 s89, hwreg(HW_REG_XCC_ID)
  s_and_b32 s89, s89, 7
  v_lshrrev_b32 v1, 6, v0
  s_and_b32 s91, s2, 7
  s_lshr_b32 s90, s2, 3
  v_readfirstlane_b32 s17, v1
  s_lshl_b32 s100, s91, 5
  s_add_u32 s100, s100, s90
  s_lshl_b32 s100, s100, 2
  s_add_u32 s100, s100, s17
  s_lshl_b32 s100, s100, 12
  s_add_u32 s100, s100, 37748736
  s_waitcnt lgkmcnt(0)
  s_cmp_lt_u32 s91, 3
  s_cbranch_scc1 L_chain
  s_cmp_eq_u32 s91, 7
  s_cbranch_scc1 L_qkv
  s_bitcmp1_b32 s90, 4
  s_cbranch_scc1 L_qkv
  s_branch L_o
L_end:
  s_endpgm
L_chain:
  s_mov_b32 s16, s90
  s_mov_b32 s60, s91
  s_min_u32 s61, s91, 1
  v_lshrrev_b32 v18, 6, v0
  v_and_b32 v19, 63, v0
  v_readfirstlane_b32 s17, v18
  v_and_b32 v7, 15, v19
  v_lshrrev_b32 v17, 4, v19
  v_lshlrev_b32 v0, 4, v19
  s_load_dwordx2 s[56:57], s[0:1], 8
  s_mov_b32 s44, 0x05040100
  s_mov_b32 s45, 0x07060302
  s_mov_b32 s18, 0xcccccccc
  s_mov_b32 s19, 0xcccccccc
  s_mov_b32 s24, 0x3e0293ee
  s_lshl_b32 s26, s17, 10
  v_add_u32 v8, s26, v0
  v_xor_b32 v9, 1024, v8
  v_xor_b32 v10, 2048, v8
  v_xor_b32 v11, 3072, v8
  s_mov_b32 s14, 0x3f803f80
  s_mov_b32 s15, 0x3f803f80
  s_mul_i32 s27, s17, 24576
  s_add_u32 s27, s27, 65536
  v_add_u32 v1, s27, v0
  v_lshrrev_b32 v20, 2, v7
  v_xor_b32 v21, v17, v20
  v_lshlrev_b32 v22, 5, v7
  v_add_u32 v22, s26, v22
  v_lshl_add_u32 v2, v21, 3, v22
  v_and_b32 v21, 3, v7
  v_xor_b32 v21, v21, v17
  v_lshl_add_u32 v22, v17, 2, v20
  v_lshlrev_b32 v22, 5, v22
  v_lshl_add_u32 v3, v21, 3, v22
  v_add_u32 v12, s26, v3
  v_xor_b32 v13, 1024, v12
  v_xor_b32 v14, 2048, v12
  v_xor_b32 v15, 3072, v12
  v_lshlrev_b32 v21, 13, v20
  v_and_b32 v22, 3, v7
  v_lshl_add_u32 v22, v17, 2, v22
  v_lshl_add_u32 v21, v22, 4, v21
  s_lshl_b32 s27, s17, 16
  s_lshl_b32 s28, s16, 8
  s_add_u32 s27, s27, s28
  v_add_u32 v4, s27, v21
  v_and_b32 v21, 1, v7
  v_lshl_add_u32 v21, v17, 2, v21
  v_bfe_u32 v22, v7, 2, 1
  v_lshl_add_u32 v21, v22, 1, v21
  v_lshlrev_b32 v21, 4, v21
  v_bfe_u32 v22, v7, 1, 1
  v_lshl_add_u32 v21, v22, 3, v21
  v_add_u32 v5, s28, v21
  v_cmp_lt_u32 vcc, 7, v7
  v_mov_b32 v22, 0x7ff00000
  s_nop 0
  v_cndmask_b32 v5, v5, v22, vcc
  v_mov_b32 v21, 0x4444
  v_mov_b32 v22, 0xeeee
  v_cndmask_b32 v6, v21, v22, s[18:19]
  s_lshl_b32 s40, s60, 20
  s_add_u32 s40, s40, 0
  s_add_u32 s41, s40, 32768
  s_lshl_b32 s62, s60, 16
  s_add_u32 s62, s62, 4194304
  v_mov_b32 v24, -1
  v_mov_b32 v25, -1
  v_mov_b32 v26, -1
  v_mov_b32 v27, -1
  buffer_store_dwordx4 v[24:27], v4, s[4:7], s40 offen sc1
  buffer_store_dwordx4 v[24:27], v4, s[4:7], s41 offen sc1
  s_add_u32 s27, s62, 8192
  buffer_store_dwordx2 v[24:25], v5, s[4:7], s27 offen sc1
  s_add_u32 s27, s62, 16384
  buffer_store_dwordx2 v[24:25], v5, s[4:7], s27 offen sc1
  s_mov_b32 s58, 8192
  s_mov_b32 s59, 0x20000
  v_and_b32 v21, 1, v7
  v_lshl_add_u32 v21, v17, 1, v21
  v_lshlrev_b32 v21, 10, v21
  v_bfe_u32 v22, v7, 1, 2
  v_lshl_add_u32 v21, v22, 1, v21
  s_lshr_b32 s27, s16, 3
  s_lshl_b32 s27, s27, 8
  s_and_b32 s28, s16, 3
  s_lshl_b32 s28, s28, 6
  s_add_u32 s27, s27, s28
  s_and_b32 s28, s16, 4
  s_lshl_b32 s28, s28, 1
  s_add_u32 s27, s27, s28
  s_waitcnt lgkmcnt(0)
  buffer_load_ushort v28, v21, s[56:59], s27 offen offset:0
  buffer_load_ushort v29, v21, s[56:59], s27 offen offset:16
  buffer_load_ushort v30, v21, s[56:59], s27 offen offset:32
  buffer_load_ushort v31, v21, s[56:59], s27 offen offset:48
  s_lshl_b32 s66, s91, 3
  s_add_u32 s66, s66, 128
  s_load_dwordx2 s[8:9], s[0:1], 40
  s_load_dwordx2 s[52:53], s[0:1], 16
  s_load_dwordx2 s[32:33], s[0:1], 24
  s_load_dwordx2 s[48:49], s[0:1], 32
  s_mov_b32 s10, 4194304
  s_mov_b32 s11, 0x20000
  s_mov_b32 s54, 4194304
  s_mov_b32 s55, 0x20000
  s_mov_b32 s34, 4194304
  s_mov_b32 s35, 0x20000
  s_mov_b32 s50, 4194304
  s_mov_b32 s51, 0x20000
  v_and_b32 v20, 1, v17
  v_lshlrev_b32 v20, 5, v20
  v_lshrrev_b32 v21, 1, v17
  v_lshl_add_u32 v20, v21, 2, v20
  v_lshlrev_b32 v20, 10, v20
  v_lshl_add_u32 v20, v7, 4, v20
  s_lshl_b32 s26, s16, 17
  s_lshl_b32 s27, s17, 8
  s_add_u32 s26, s26, s27
  s_waitcnt lgkmcnt(0)
  s_add_u32 s27, s26, 0
  buffer_load_dwordx4 v[128:131], v20, s[8:11], s27 offen
  s_add_u32 s27, s26, 1024
  buffer_load_dwordx4 v[132:135], v20, s[8:11], s27 offen
  s_add_u32 s27, s26, 16384
  buffer_load_dwordx4 v[136:139], v20, s[8:11], s27 offen
  s_add_u32 s27, s26, 17408
  buffer_load_dwordx4 v[140:143], v20, s[8:11], s27 offen
  s_add_u32 s27, s26, 2048
  buffer_load_dwordx4 v[144:147], v20, s[8:11], s27 offen
  s_add_u32 s27, s26, 3072
  buffer_load_dwordx4 v[148:151], v20, s[8:11], s27 offen
  s_add_u32 s27, s26, 18432
  buffer_load_dwordx4 v[152:155], v20, s[8:11], s27 offen
  s_add_u32 s27, s26, 19456
  buffer_load_dwordx4 v[156:159], v20, s[8:11], s27 offen
  s_add_u32 s27, s26, 8192
  buffer_load_dwordx4 v[160:163], v20, s[8:11], s27 offen
  s_add_u32 s27, s26, 9216
  buffer_load_dwordx4 v[164:167], v20, s[8:11], s27 offen
  s_add_u32 s27, s26, 24576
  buffer_load_dwordx4 v[168:171], v20, s[8:11], s27 offen
  s_add_u32 s27, s26, 25600
  buffer_load_dwordx4 v[172:175], v20, s[8:11], s27 offen
  s_add_u32 s27, s26, 10240
  buffer_load_dwordx4 v[176:179], v20, s[8:11], s27 offen
  s_add_u32 s27, s26, 11264
  buffer_load_dwordx4 v[180:183], v20, s[8:11], s27 offen
  s_add_u32 s27, s26, 26624
  buffer_load_dwordx4 v[184:187], v20, s[8:11], s27 offen
  s_add_u32 s27, s26, 27648
  buffer_load_dwordx4 v[188:191], v20, s[8:11], s27 offen
  s_add_u32 s27, s26, 65536
  buffer_load_dwordx4 v[192:195], v20, s[8:11], s27 offen
  s_add_u32 s27, s26, 66560
  buffer_load_dwordx4 v[196:199], v20, s[8:11], s27 offen
  s_add_u32 s27, s26, 81920
  buffer_load_dwordx4 v[200:203], v20, s[8:11], s27 offen
  s_add_u32 s27, s26, 82944
  buffer_load_dwordx4 v[204:207], v20, s[8:11], s27 offen
  s_add_u32 s27, s26, 67584
  buffer_load_dwordx4 v[208:211], v20, s[8:11], s27 offen
  s_add_u32 s27, s26, 68608
  buffer_load_dwordx4 v[212:215], v20, s[8:11], s27 offen
  s_add_u32 s27, s26, 83968
  buffer_load_dwordx4 v[216:219], v20, s[8:11], s27 offen
  s_add_u32 s27, s26, 84992
  buffer_load_dwordx4 v[220:223], v20, s[8:11], s27 offen
  s_add_u32 s27, s26, 73728
  buffer_load_dwordx4 v[224:227], v20, s[8:11], s27 offen
  s_add_u32 s27, s26, 74752
  buffer_load_dwordx4 v[228:231], v20, s[8:11], s27 offen
  s_add_u32 s27, s26, 90112
  buffer_load_dwordx4 v[232:235], v20, s[8:11], s27 offen
  s_add_u32 s27, s26, 91136
  buffer_load_dwordx4 v[236:239], v20, s[8:11], s27 offen
  s_add_u32 s27, s26, 75776
  buffer_load_dwordx4 v[240:243], v20, s[8:11], s27 offen
  s_add_u32 s27, s26, 76800
  buffer_load_dwordx4 v[244:247], v20, s[8:11], s27 offen
  s_add_u32 s27, s26, 92160
  buffer_load_dwordx4 v[248:251], v20, s[8:11], s27 offen
  s_add_u32 s27, s26, 93184
  buffer_load_dwordx4 v[252:255], v20, s[8:11], s27 offen
  v_lshrrev_b32 v20, 8, v0
  v_and_b32 v22, 0xf0, v0
  v_lshlrev_b32 v23, 6, v20
  v_xor_b32 v22, v22, v23
  v_lshl_add_u32 v22, v20, 13, v22
  v_xor_b32 v23, 32, v22
  s_lshr_b32 s26, s17, 1
  s_lshl_b32 s26, s26, 20
  s_and_b32 s27, s17, 1
  s_lshl_b32 s27, s27, 18
  s_add_u32 s26, s26, s27
  s_lshl_b32 s27, s16, 8
  s_add_u32 s26, s26, s27
  s_lshl_b32 s28, s17, 13
  s_add_u32 s27, s26, 0
  s_add_u32 m0, s28, 65536
  s_nop 0
  buffer_load_dwordx4 v22, s[32:35], s27 offen lds
  s_add_u32 m0, s28, 66560
  s_add_u32 s27, s27, 32768
  buffer_load_dwordx4 v22, s[32:35], s27 offen lds
  s_add_u32 m0, s28, 67584
  s_add_u32 s27, s27, 32768
  buffer_load_dwordx4 v23, s[32:35], s27 offen lds
  s_add_u32 m0, s28, 68608
  s_add_u32 s27, s27, 32768
  buffer_load_dwordx4 v23, s[32:35], s27 offen lds
  s_add_u32 m0, s28, 69632
  s_add_u32 s27, s27, 32768
  buffer_load_dwordx4 v22, s[32:35], s27 offen lds
  s_add_u32 m0, s28, 70656
  s_add_u32 s27, s27, 32768
  buffer_load_dwordx4 v22, s[32:35], s27 offen lds
  s_add_u32 m0, s28, 71680
  s_add_u32 s27, s27, 32768
  buffer_load_dwordx4 v23, s[32:35], s27 offen lds
  s_add_u32 m0, s28, 72704
  s_add_u32 s27, s27, 32768
  buffer_load_dwordx4 v23, s[32:35], s27 offen lds
  s_add_u32 s27, s26, 524288
  s_add_u32 m0, s28, 98304
  s_nop 0
  buffer_load_dwordx4 v22, s[32:35], s27 offen lds
  s_add_u32 m0, s28, 99328
  s_add_u32 s27, s27, 32768
  buffer_load_dwordx4 v22, s[32:35], s27 offen lds
  s_add_u32 m0, s28, 100352
  s_add_u32 s27, s27, 32768
  buffer_load_dwordx4 v23, s[32:35], s27 offen lds
  s_add_u32 m0, s28, 101376
  s_add_u32 s27, s27, 32768
  buffer_load_dwordx4 v23, s[32:35], s27 offen lds
  s_add_u32 m0, s28, 102400
  s_add_u32 s27, s27, 32768
  buffer_load_dwordx4 v22, s[32:35], s27 offen lds
  s_add_u32 m0, s28, 103424
  s_add_u32 s27, s27, 32768
  buffer_load_dwordx4 v22, s[32:35], s27 offen lds
  s_add_u32 m0, s28, 104448
  s_add_u32 s27, s27, 32768
  buffer_load_dwordx4 v23, s[32:35], s27 offen lds
  s_add_u32 m0, s28, 105472
  s_add_u32 s27, s27, 32768
  buffer_load_dwordx4 v23, s[32:35], s27 offen lds
  s_waitcnt vmcnt(48)
  v_lshl_or_b32 v28, v29, 16, v28
  v_lshl_or_b32 v29, v31, 16, v30
  v_min_u32 v28, -2, v28
  v_min_u32 v29, -2, v29
  buffer_store_dwordx2 v[28:29], v5, s[4:7], s62 offen sc1
  s_add_u32 s27, s26, 2097152
  s_add_u32 m0, s28, 131072
  s_nop 0
  buffer_load_dwordx4 v22, s[32:35], s27 offen lds
  s_add_u32 m0, s28, 132096
  s_add_u32 s27, s27, 32768
  buffer_load_dwordx4 v22, s[32:35], s27 offen lds
  s_add_u32 m0, s28, 133120
  s_add_u32 s27, s27, 32768
  buffer_load_dwordx4 v23, s[32:35], s27 offen lds
  s_add_u32 m0, s28, 134144
  s_add_u32 s27, s27, 32768
  buffer_load_dwordx4 v23, s[32:35], s27 offen lds
  s_add_u32 m0, s28, 135168
  s_add_u32 s27, s27, 32768
  buffer_load_dwordx4 v22, s[32:35], s27 offen lds
  s_add_u32 m0, s28, 136192
  s_add_u32 s27, s27, 32768
  buffer_load_dwordx4 v22, s[32:35], s27 offen lds
  s_add_u32 m0, s28, 137216
  s_add_u32 s27, s27, 32768
  buffer_load_dwordx4 v23, s[32:35], s27 offen lds
  s_add_u32 m0, s28, 138240
  s_add_u32 s27, s27, 32768
  buffer_load_dwordx4 v23, s[32:35], s27 offen lds
  v_bfe_u32 v20, v7, 2, 1
  v_lshrrev_b32 v21, 3, v7
  v_and_b32 v104, 1, v17
  v_lshl_add_u32 v21, v21, 1, v104
  v_lshl_add_u32 v104, v20, 3, v21
  v_lshrrev_b32 v105, 1, v17
  v_lshl_add_u32 v104, v105, 5, v104
  v_lshl_add_u32 v20, v21, 1, v20
  s_lshl_b32 s29, s17, 1
  v_xor_b32 v20, s29, v20
  v_lshlrev_b32 v20, 5, v20
  v_lshl_add_u32 v20, v104, 8, v20
  v_and_b32 v21, 3, v7
  v_lshl_add_u32 v20, v21, 3, v20
  s_lshr_b32 s29, s17, 1
  s_lshl_b32 s29, s29, 14
  s_and_b32 s30, s17, 1
  s_lshl_b32 s30, s30, 10
  s_add_u32 s29, s29, s30
  s_add_u32 s29, s29, 65536
  v_add_u32 v20, s29, v20
  v_xor_b32 v104, 0, v20
  v_add_u32 v112, 65536, v104
  v_xor_b32 v105, 32, v20
  v_add_u32 v113, 65536, v105
  v_xor_b32 v106, 1024, v20
  v_add_u32 v114, 65536, v106
  v_xor_b32 v107, 1056, v20
  v_add_u32 v115, 65536, v107
  v_xor_b32 v108, 16384, v20
  v_add_u32 v116, 65536, v108
  v_xor_b32 v109, 16416, v20
  v_add_u32 v117, 65536, v109
  v_xor_b32 v110, 17408, v20
  v_add_u32 v118, 65536, v110
  v_xor_b32 v111, 17440, v20
  v_add_u32 v119, 65536, v111
  s_waitcnt vmcnt(49)
  v_perm_b32 v120, v132, v128, s44
  v_perm_b32 v121, v140, v136, s44
  v_perm_b32 v122, v148, v144, s44
  v_perm_b32 v123, v156, v152, s44
  v_accvgpr_write_b32 a248, v120
  v_accvgpr_write_b32 a249, v121
  v_accvgpr_write_b32 a250, v122
  v_accvgpr_write_b32 a251, v123
  v_perm_b32 v124, v132, v128, s45
  v_perm_b32 v125, v140, v136, s45
  v_perm_b32 v126, v148, v144, s45
  v_perm_b32 v127, v156, v152, s45
  v_accvgpr_write_b32 a232, v124
  v_accvgpr_write_b32 a233, v125
  v_accvgpr_write_b32 a234, v126
  v_accvgpr_write_b32 a235, v127
  v_perm_b32 v120, v133, v129, s44
  v_perm_b32 v121, v141, v137, s44
  v_perm_b32 v122, v149, v145, s44
  v_perm_b32 v123, v157, v153, s44
  v_accvgpr_write_b32 a216, v120
  v_accvgpr_write_b32 a217, v121
  v_accvgpr_write_b32 a218, v122
  v_accvgpr_write_b32 a219, v123
  v_perm_b32 v124, v133, v129, s45
  v_perm_b32 v125, v141, v137, s45
  v_perm_b32 v126, v149, v145, s45
  v_perm_b32 v127, v157, v153, s45
  v_accvgpr_write_b32 a200, v124
  v_accvgpr_write_b32 a201, v125
  v_accvgpr_write_b32 a202, v126
  v_accvgpr_write_b32 a203, v127
  v_perm_b32 v120, v134, v130, s44
  v_perm_b32 v121, v142, v138, s44
  v_perm_b32 v122, v150, v146, s44
  v_perm_b32 v123, v158, v154, s44
  v_accvgpr_write_b32 a184, v120
  v_accvgpr_write_b32 a185, v121
  v_accvgpr_write_b32 a186, v122
  v_accvgpr_write_b32 a187, v123
  v_perm_b32 v124, v134, v130, s45
  v_perm_b32 v125, v142, v138, s45
  v_perm_b32 v126, v150, v146, s45
  v_perm_b32 v127, v158, v154, s45
  ds_write_b128 v8, v[124:127] offset:16384
  s_waitcnt lgkmcnt(0)
  v_perm_b32 v120, v135, v131, s44
  v_perm_b32 v121, v143, v139, s44
  v_perm_b32 v122, v151, v147, s44
  v_perm_b32 v123, v159, v155, s44
  ds_write_b128 v8, v[120:123] offset:32768
  s_waitcnt lgkmcnt(0)
  v_perm_b32 v124, v135, v131, s45
  v_perm_b32 v125, v143, v139, s45
  v_perm_b32 v126, v151, v147, s45
  v_perm_b32 v127, v159, v155, s45
  ds_write_b128 v8, v[124:127] offset:49152
  s_waitcnt lgkmcnt(0)
  s_waitcnt vmcnt(41)
  v_perm_b32 v120, v164, v160, s44
  v_perm_b32 v121, v172, v168, s44
  v_perm_b32 v122, v180, v176, s44
  v_perm_b32 v123, v188, v184, s44
  v_accvgpr_write_b32 a252, v120
  v_accvgpr_write_b32 a253, v121
  v_accvgpr_write_b32 a254, v122
  v_accvgpr_write_b32 a255, v123
  v_perm_b32 v124, v164, v160, s45
  v_perm_b32 v125, v172, v168, s45
  v_perm_b32 v126, v180, v176, s45
  v_perm_b32 v127, v188, v184, s45
  v_accvgpr_write_b32 a236, v124
  v_accvgpr_write_b32 a237, v125
  v_accvgpr_write_b32 a238, v126
  v_accvgpr_write_b32 a239, v127
  v_perm_b32 v120, v165, v161, s44
  v_perm_b32 v121, v173, v169, s44
  v_perm_b32 v122, v181, v177, s44
  v_perm_b32 v123, v189, v185, s44
  v_accvgpr_write_b32 a220, v120
  v_accvgpr_write_b32 a221, v121
  v_accvgpr_write_b32 a222, v122
  v_accvgpr_write_b32 a223, v123
  v_perm_b32 v124, v165, v161, s45
  v_perm_b32 v125, v173, v169, s45
  v_perm_b32 v126, v181, v177, s45
  v_perm_b32 v127, v189, v185, s45
  v_accvgpr_write_b32 a204, v124
  v_accvgpr_write_b32 a205, v125
  v_accvgpr_write_b32 a206, v126
  v_accvgpr_write_b32 a207, v127
  v_perm_b32 v120, v166, v162, s44
  v_perm_b32 v121, v174, v170, s44
  v_perm_b32 v122, v182, v178, s44
  v_perm_b32 v123, v190, v186, s44
  v_accvgpr_write_b32 a188, v120
  v_accvgpr_write_b32 a189, v121
  v_accvgpr_write_b32 a190, v122
  v_accvgpr_write_b32 a191, v123
  v_perm_b32 v124, v166, v162, s45
  v_perm_b32 v125, v174, v170, s45
  v_perm_b32 v126, v182, v178, s45
  v_perm_b32 v127, v190, v186, s45
  ds_write_b128 v8, v[124:127] offset:20480
  s_waitcnt lgkmcnt(0)
  v_perm_b32 v120, v167, v163, s44
  v_perm_b32 v121, v175, v171, s44
  v_perm_b32 v122, v183, v179, s44
  v_perm_b32 v123, v191, v187, s44
  ds_write_b128 v8, v[120:123] offset:36864
  s_waitcnt lgkmcnt(0)
  v_perm_b32 v124, v167, v163, s45
  v_perm_b32 v125, v175, v171, s45
  v_perm_b32 v126, v183, v179, s45
  v_perm_b32 v127, v191, v187, s45
  ds_write_b128 v8, v[124:127] offset:53248
  s_waitcnt lgkmcnt(0)
  s_waitcnt vmcnt(33)
  v_perm_b32 v120, v196, v192, s44
  v_perm_b32 v121, v204, v200, s44
  v_perm_b32 v122, v212, v208, s44
  v_perm_b32 v123, v220, v216, s44
  v_accvgpr_write_b32 a240, v120
  v_accvgpr_write_b32 a241, v121
  v_accvgpr_write_b32 a242, v122
  v_accvgpr_write_b32 a243, v123
  v_perm_b32 v124, v196, v192, s45
  v_perm_b32 v125, v204, v200, s45
  v_perm_b32 v126, v212, v208, s45
  v_perm_b32 v127, v220, v216, s45
  v_accvgpr_write_b32 a224, v124
  v_accvgpr_write_b32 a225, v125
  v_accvgpr_write_b32 a226, v126
  v_accvgpr_write_b32 a227, v127
  v_perm_b32 v120, v197, v193, s44
  v_perm_b32 v121, v205, v201, s44
  v_perm_b32 v122, v213, v209, s44
  v_perm_b32 v123, v221, v217, s44
  v_accvgpr_write_b32 a208, v120
  v_accvgpr_write_b32 a209, v121
  v_accvgpr_write_b32 a210, v122
  v_accvgpr_write_b32 a211, v123
  v_perm_b32 v124, v197, v193, s45
  v_perm_b32 v125, v205, v201, s45
  v_perm_b32 v126, v213, v209, s45
  v_perm_b32 v127, v221, v217, s45
  v_accvgpr_write_b32 a192, v124
  v_accvgpr_write_b32 a193, v125
  v_accvgpr_write_b32 a194, v126
  v_accvgpr_write_b32 a195, v127
  v_perm_b32 v120, v198, v194, s44
  v_perm_b32 v121, v206, v202, s44
  v_perm_b32 v122, v214, v210, s44
  v_perm_b32 v123, v222, v218, s44
  v_accvgpr_write_b32 a176, v120
  v_accvgpr_write_b32 a177, v121
  v_accvgpr_write_b32 a178, v122
  v_accvgpr_write_b32 a179, v123
  v_perm_b32 v124, v198, v194, s45
  v_perm_b32 v125, v206, v202, s45
  v_perm_b32 v126, v214, v210, s45
  v_perm_b32 v127, v222, v218, s45
  ds_write_b128 v8, v[124:127] offset:24576
  s_waitcnt lgkmcnt(0)
  v_perm_b32 v120, v199, v195, s44
  v_perm_b32 v121, v207, v203, s44
  v_perm_b32 v122, v215, v211, s44
  v_perm_b32 v123, v223, v219, s44
  ds_write_b128 v8, v[120:123] offset:40960
  s_waitcnt lgkmcnt(0)
  v_perm_b32 v124, v199, v195, s45
  v_perm_b32 v125, v207, v203, s45
  v_perm_b32 v126, v215, v211, s45
  v_perm_b32 v127, v223, v219, s45
  ds_write_b128 v8, v[124:127] offset:57344
  s_waitcnt lgkmcnt(0)
  s_waitcnt vmcnt(25)
  v_perm_b32 v120, v228, v224, s44
  v_perm_b32 v121, v236, v232, s44
  v_perm_b32 v122, v244, v240, s44
  v_perm_b32 v123, v252, v248, s44
  v_accvgpr_write_b32 a244, v120
  v_accvgpr_write_b32 a245, v121
  v_accvgpr_write_b32 a246, v122
  v_accvgpr_write_b32 a247, v123
  v_perm_b32 v124, v228, v224, s45
  v_perm_b32 v125, v236, v232, s45
  v_perm_b32 v126, v244, v240, s45
  v_perm_b32 v127, v252, v248, s45
  v_accvgpr_write_b32 a228, v124
  v_accvgpr_write_b32 a229, v125
  v_accvgpr_write_b32 a230, v126
  v_accvgpr_write_b32 a231, v127
  v_perm_b32 v120, v229, v225, s44
  v_perm_b32 v121, v237, v233, s44
  v_perm_b32 v122, v245, v241, s44
  v_perm_b32 v123, v253, v249, s44
  v_accvgpr_write_b32 a212, v120
  v_accvgpr_write_b32 a213, v121
  v_accvgpr_write_b32 a214, v122
  v_accvgpr_write_b32 a215, v123
  v_perm_b32 v124, v229, v225, s45
  v_perm_b32 v125, v237, v233, s45
  v_perm_b32 v126, v245, v241, s45
  v_perm_b32 v127, v253, v249, s45
  v_accvgpr_write_b32 a196, v124
  v_accvgpr_write_b32 a197, v125
  v_accvgpr_write_b32 a198, v126
  v_accvgpr_write_b32 a199, v127
  v_perm_b32 v120, v230, v226, s44
  v_perm_b32 v121, v238, v234, s44
  v_perm_b32 v122, v246, v242, s44
  v_perm_b32 v123, v254, v250, s44
  v_accvgpr_write_b32 a180, v120
  v_accvgpr_write_b32 a181, v121
  v_accvgpr_write_b32 a182, v122
  v_accvgpr_write_b32 a183, v123
  v_perm_b32 v124, v230, v226, s45
  v_perm_b32 v125, v238, v234, s45
  v_perm_b32 v126, v246, v242, s45
  v_perm_b32 v127, v254, v250, s45
  ds_write_b128 v8, v[124:127] offset:28672
  s_waitcnt lgkmcnt(0)
  v_perm_b32 v120, v231, v227, s44
  v_perm_b32 v121, v239, v235, s44
  v_perm_b32 v122, v247, v243, s44
  v_perm_b32 v123, v255, v251, s44
  ds_write_b128 v8, v[120:123] offset:45056
  s_waitcnt lgkmcnt(0)
  v_perm_b32 v124, v231, v227, s45
  v_perm_b32 v125, v239, v235, s45
  v_perm_b32 v126, v247, v243, s45
  v_perm_b32 v127, v255, v251, s45
  ds_write_b128 v8, v[124:127] offset:61440
  s_waitcnt lgkmcnt(0)
  s_waitcnt vmcnt(17)
  s_barrier
  ds_read_b64_tr_b16 v[40:41], v104 offset:0
  ds_read_b64_tr_b16 v[42:43], v104 offset:4096
  ds_read_b64_tr_b16 v[48:49], v105 offset:0
  ds_read_b64_tr_b16 v[50:51], v105 offset:4096
  ds_read_b64_tr_b16 a[72:73], v106 offset:0
  ds_read_b64_tr_b16 a[74:75], v106 offset:4096
  ds_read_b64_tr_b16 a[24:25], v107 offset:0
  ds_read_b64_tr_b16 a[26:27], v107 offset:4096
  ds_read_b64_tr_b16 a[64:65], v108 offset:0
  ds_read_b64_tr_b16 a[66:67], v108 offset:4096
  ds_read_b64_tr_b16 a[16:17], v109 offset:0
  ds_read_b64_tr_b16 a[18:19], v109 offset:4096
  ds_read_b64_tr_b16 a[56:57], v110 offset:0
  ds_read_b64_tr_b16 a[58:59], v110 offset:4096
  ds_read_b64_tr_b16 a[8:9], v111 offset:0
  ds_read_b64_tr_b16 a[10:11], v111 offset:4096
  s_waitcnt lgkmcnt(0)
  s_barrier
  s_add_u32 s27, s26, 2621440
  s_add_u32 m0, s28, 65536
  s_nop 0
  buffer_load_dwordx4 v22, s[32:35], s27 offen lds
  s_add_u32 m0, s28, 66560
  s_add_u32 s27, s27, 32768
  buffer_load_dwordx4 v22, s[32:35], s27 offen lds
  s_add_u32 m0, s28, 67584
  s_add_u32 s27, s27, 32768
  buffer_load_dwordx4 v23, s[32:35], s27 offen lds
  s_add_u32 m0, s28, 68608
  s_add_u32 s27, s27, 32768
  buffer_load_dwordx4 v23, s[32:35], s27 offen lds
  s_add_u32 m0, s28, 69632
  s_add_u32 s27, s27, 32768
  buffer_load_dwordx4 v22, s[32:35], s27 offen lds
  s_add_u32 m0, s28, 70656
  s_add_u32 s27, s27, 32768
  buffer_load_dwordx4 v22, s[32:35], s27 offen lds
  s_add_u32 m0, s28, 71680
  s_add_u32 s27, s27, 32768
  buffer_load_dwordx4 v23, s[32:35], s27 offen lds
  s_add_u32 m0, s28, 72704
  s_add_u32 s27, s27, 32768
  buffer_load_dwordx4 v23, s[32:35], s27 offen lds
  s_waitcnt vmcnt(17)
  s_barrier
  ds_read_b64_tr_b16 v[44:45], v104 offset:32768
  ds_read_b64_tr_b16 v[46:47], v104 offset:36864
  ds_read_b64_tr_b16 v[52:53], v105 offset:32768
  ds_read_b64_tr_b16 v[54:55], v105 offset:36864
  ds_read_b64_tr_b16 a[76:77], v106 offset:32768
  ds_read_b64_tr_b16 a[78:79], v106 offset:36864
  ds_read_b64_tr_b16 a[28:29], v107 offset:32768
  ds_read_b64_tr_b16 a[30:31], v107 offset:36864
  ds_read_b64_tr_b16 a[68:69], v108 offset:32768
  ds_read_b64_tr_b16 a[70:71], v108 offset:36864
  ds_read_b64_tr_b16 a[20:21], v109 offset:32768
  ds_read_b64_tr_b16 a[22:23], v109 offset:36864
  ds_read_b64_tr_b16 a[60:61], v110 offset:32768
  ds_read_b64_tr_b16 a[62:63], v110 offset:36864
  ds_read_b64_tr_b16 a[12:13], v111 offset:32768
  ds_read_b64_tr_b16 a[14:15], v111 offset:36864
  s_waitcnt lgkmcnt(0)
  s_barrier
  s_add_u32 s27, s26, 0
  s_add_u32 m0, s28, 98304
  s_nop 0
  buffer_load_dwordx4 v22, s[48:51], s27 offen lds
  s_add_u32 m0, s28, 99328
  s_add_u32 s27, s27, 32768
  buffer_load_dwordx4 v22, s[48:51], s27 offen lds
  s_add_u32 m0, s28, 100352
  s_add_u32 s27, s27, 32768
  buffer_load_dwordx4 v23, s[48:51], s27 offen lds
  s_add_u32 m0, s28, 101376
  s_add_u32 s27, s27, 32768
  buffer_load_dwordx4 v23, s[48:51], s27 offen lds
  s_add_u32 m0, s28, 102400
  s_add_u32 s27, s27, 32768
  buffer_load_dwordx4 v22, s[48:51], s27 offen lds
  s_add_u32 m0, s28, 103424
  s_add_u32 s27, s27, 32768
  buffer_load_dwordx4 v22, s[48:51], s27 offen lds
  s_add_u32 m0, s28, 104448
  s_add_u32 s27, s27, 32768
  buffer_load_dwordx4 v23, s[48:51], s27 offen lds
  s_add_u32 m0, s28, 105472
  s_add_u32 s27, s27, 32768
  buffer_load_dwordx4 v23, s[48:51], s27 offen lds
  s_waitcnt vmcnt(16)
  s_barrier
  s_cmp_lg_u32 s17, 0
  s_cbranch_scc1 g_ar_1
  s_lshl_b32 s36, s89, 3
  s_lshl_b64 s[36:37], 1, s36
  v_mov_b32 v122, s66
  v_mov_b32 v120, s36
  v_mov_b32 v121, s37
  s_mov_b64 exec, 1
  global_atomic_add_x2 v122, v[120:121], s[12:13]
  s_mov_b64 exec, -1
g_ar_1:
  ds_read_b64_tr_b16 v[72:73], v112 offset:0
  ds_read_b64_tr_b16 v[74:75], v112 offset:4096
  ds_read_b64_tr_b16 v[80:81], v113 offset:0
  ds_read_b64_tr_b16 v[82:83], v113 offset:4096
  ds_read_b64_tr_b16 a[48:49], v114 offset:0
  ds_read_b64_tr_b16 a[50:51], v114 offset:4096
  ds_read_b64_tr_b16 a[0:1], v115 offset:0
  ds_read_b64_tr_b16 a[2:3], v115 offset:4096
  ds_read_b64_tr_b16 a[40:41], v116 offset:0
  ds_read_b64_tr_b16 a[42:43], v116 offset:4096
  ds_read_b64_tr_b16 v[248:249], v117 offset:0
  ds_read_b64_tr_b16 v[250:251], v117 offset:4096
  ds_read_b64_tr_b16 a[32:33], v118 offset:0
  ds_read_b64_tr_b16 a[34:35], v118 offset:4096
  ds_read_b64_tr_b16 v[240:241], v119 offset:0
  ds_read_b64_tr_b16 v[242:243], v119 offset:4096
  s_waitcnt lgkmcnt(0)
  s_barrier
  s_add_u32 s27, s26, 524288
  s_add_u32 m0, s28, 131072
  s_nop 0
  buffer_load_dwordx4 v22, s[48:51], s27 offen lds
  s_add_u32 m0, s28, 132096
  s_add_u32 s27, s27, 32768
  buffer_load_dwordx4 v22, s[48:51], s27 offen lds
  s_add_u32 m0, s28, 133120
  s_add_u32 s27, s27, 32768
  buffer_load_dwordx4 v23, s[48:51], s27 offen lds
  s_add_u32 m0, s28, 134144
  s_add_u32 s27, s27, 32768
  buffer_load_dwordx4 v23, s[48:51], s27 offen lds
  s_add_u32 m0, s28, 135168
  s_add_u32 s27, s27, 32768
  buffer_load_dwordx4 v22, s[48:51], s27 offen lds
  s_add_u32 m0, s28, 136192
  s_add_u32 s27, s27, 32768
  buffer_load_dwordx4 v22, s[48:51], s27 offen lds
  s_add_u32 m0, s28, 137216
  s_add_u32 s27, s27, 32768
  buffer_load_dwordx4 v23, s[48:51], s27 offen lds
  s_add_u32 m0, s28, 138240
  s_add_u32 s27, s27, 32768
  buffer_load_dwordx4 v23, s[48:51], s27 offen lds
  s_waitcnt vmcnt(16)
  s_barrier
  ds_read_b64_tr_b16 v[76:77], v104 offset:0
  ds_read_b64_tr_b16 v[78:79], v104 offset:4096
  ds_read_b64_tr_b16 v[84:85], v105 offset:0
  ds_read_b64_tr_b16 v[86:87], v105 offset:4096
  ds_read_b64_tr_b16 a[52:53], v106 offset:0
  ds_read_b64_tr_b16 a[54:55], v106 offset:4096
  ds_read_b64_tr_b16 a[4:5], v107 offset:0
  ds_read_b64_tr_b16 a[6:7], v107 offset:4096
  ds_read_b64_tr_b16 a[44:45], v108 offset:0
  ds_read_b64_tr_b16 a[46:47], v108 offset:4096
  ds_read_b64_tr_b16 v[252:253], v109 offset:0
  ds_read_b64_tr_b16 v[254:255], v109 offset:4096
  ds_read_b64_tr_b16 a[36:37], v110 offset:0
  ds_read_b64_tr_b16 a[38:39], v110 offset:4096
  ds_read_b64_tr_b16 v[244:245], v111 offset:0
  ds_read_b64_tr_b16 v[246:247], v111 offset:4096
  s_waitcnt lgkmcnt(0)
  s_barrier
  s_add_u32 s27, s26, 2097152
  s_add_u32 m0, s28, 65536
  s_nop 0
  buffer_load_dwordx4 v22, s[48:51], s27 offen lds
  s_add_u32 m0, s28, 66560
  s_add_u32 s27, s27, 32768
  buffer_load_dwordx4 v22, s[48:51], s27 offen lds
  s_add_u32 m0, s28, 67584
  s_add_u32 s27, s27, 32768
  buffer_load_dwordx4 v23, s[48:51], s27 offen lds
  s_add_u32 m0, s28, 68608
  s_add_u32 s27, s27, 32768
  buffer_load_dwordx4 v23, s[48:51], s27 offen lds
  s_add_u32 m0, s28, 69632
  s_add_u32 s27, s27, 32768
  buffer_load_dwordx4 v22, s[48:51], s27 offen lds
  s_add_u32 m0, s28, 70656
  s_add_u32 s27, s27, 32768
  buffer_load_dwordx4 v22, s[48:51], s27 offen lds
  s_add_u32 m0, s28, 71680
  s_add_u32 s27, s27, 32768
  buffer_load_dwordx4 v23, s[48:51], s27 offen lds
  s_add_u32 m0, s28, 72704
  s_add_u32 s27, s27, 32768
  buffer_load_dwordx4 v23, s[48:51], s27 offen lds
  s_waitcnt vmcnt(16)
  s_barrier
  ds_read_b64_tr_b16 v[88:89], v104 offset:32768
  ds_read_b64_tr_b16 v[90:91], v104 offset:36864
  ds_read_b64_tr_b16 v[96:97], v105 offset:32768
  ds_read_b64_tr_b16 v[98:99], v105 offset:36864
  ds_read_b64_tr_b16 v[232:233], v106 offset:32768
  ds_read_b64_tr_b16 v[234:235], v106 offset:36864
  ds_read_b64_tr_b16 v[176:177], v107 offset:32768
  ds_read_b64_tr_b16 v[178:179], v107 offset:36864
  ds_read_b64_tr_b16 v[224:225], v108 offset:32768
  ds_read_b64_tr_b16 v[226:227], v108 offset:36864
  ds_read_b64_tr_b16 v[168:169], v109 offset:32768
  ds_read_b64_tr_b16 v[170:171], v109 offset:36864
  ds_read_b64_tr_b16 v[216:217], v110 offset:32768
  ds_read_b64_tr_b16 v[218:219], v110 offset:36864
  ds_read_b64_tr_b16 v[160:161], v111 offset:32768
  ds_read_b64_tr_b16 v[162:163], v111 offset:36864
  s_waitcnt lgkmcnt(0)
  s_barrier
  s_add_u32 s27, s26, 2621440
  s_add_u32 m0, s28, 98304
  s_nop 0
  buffer_load_dwordx4 v22, s[48:51], s27 offen lds
  s_add_u32 m0, s28, 99328
  s_add_u32 s27, s27, 32768
  buffer_load_dwordx4 v22, s[48:51], s27 offen lds
  s_add_u32 m0, s28, 100352
  s_add_u32 s27, s27, 32768
  buffer_load_dwordx4 v23, s[48:51], s27 offen lds
  s_add_u32 m0, s28, 101376
  s_add_u32 s27, s27, 32768
  buffer_load_dwordx4 v23, s[48:51], s27 offen lds
  s_add_u32 m0, s28, 102400
  s_add_u32 s27, s27, 32768
  buffer_load_dwordx4 v22, s[48:51], s27 offen lds
  s_add_u32 m0, s28, 103424
  s_add_u32 s27, s27, 32768
  buffer_load_dwordx4 v22, s[48:51], s27 offen lds
  s_add_u32 m0, s28, 104448
  s_add_u32 s27, s27, 32768
  buffer_load_dwordx4 v23, s[48:51], s27 offen lds
  s_add_u32 m0, s28, 105472
  s_add_u32 s27, s27, 32768
  buffer_load_dwordx4 v23, s[48:51], s27 offen lds
  s_waitcnt vmcnt(16)
  s_barrier
  ds_read_b64_tr_b16 v[92:93], v112 offset:0
  ds_read_b64_tr_b16 v[94:95], v112 offset:4096
  ds_read_b64_tr_b16 v[100:101], v113 offset:0
  ds_read_b64_tr_b16 v[102:103], v113 offset:4096
  ds_read_b64_tr_b16 v[236:237], v114 offset:0
  ds_read_b64_tr_b16 v[238:239], v114 offset:4096
  ds_read_b64_tr_b16 v[180:181], v115 offset:0
  ds_read_b64_tr_b16 v[182:183], v115 offset:4096
  ds_read_b64_tr_b16 v[228:229], v116 offset:0
  ds_read_b64_tr_b16 v[230:231], v116 offset:4096
  ds_read_b64_tr_b16 v[172:173], v117 offset:0
  ds_read_b64_tr_b16 v[174:175], v117 offset:4096
  ds_read_b64_tr_b16 v[220:221], v118 offset:0
  ds_read_b64_tr_b16 v[222:223], v118 offset:4096
  ds_read_b64_tr_b16 v[164:165], v119 offset:0
  ds_read_b64_tr_b16 v[166:167], v119 offset:4096
  s_waitcnt lgkmcnt(0)
  s_barrier
  s_add_u32 s27, s26, 0
  s_add_u32 m0, s28, 131072
  s_nop 0
  buffer_load_dwordx4 v22, s[52:55], s27 offen lds
  s_add_u32 m0, s28, 132096
  s_add_u32 s27, s27, 32768
  buffer_load_dwordx4 v22, s[52:55], s27 offen lds
  s_add_u32 m0, s28, 133120
  s_add_u32 s27, s27, 32768
  buffer_load_dwordx4 v23, s[52:55], s27 offen lds
  s_add_u32 m0, s28, 134144
  s_add_u32 s27, s27, 32768
  buffer_load_dwordx4 v23, s[52:55], s27 offen lds
  s_add_u32 m0, s28, 135168
  s_add_u32 s27, s27, 32768
  buffer_load_dwordx4 v22, s[52:55], s27 offen lds
  s_add_u32 m0, s28, 136192
  s_add_u32 s27, s27, 32768
  buffer_load_dwordx4 v22, s[52:55], s27 offen lds
  s_add_u32 m0, s28, 137216
  s_add_u32 s27, s27, 32768
  buffer_load_dwordx4 v23, s[52:55], s27 offen lds
  s_add_u32 m0, s28, 138240
  s_add_u32 s27, s27, 32768
  buffer_load_dwordx4 v23, s[52:55], s27 offen lds
  s_waitcnt vmcnt(16)
  s_barrier
  ds_read_b64_tr_b16 v[208:209], v104 offset:0
  ds_read_b64_tr_b16 v[210:211], v104 offset:4096
  ds_read_b64_tr_b16 v[152:153], v105 offset:0
  ds_read_b64_tr_b16 v[154:155], v105 offset:4096
  ds_read_b64_tr_b16 v[200:201], v106 offset:0
  ds_read_b64_tr_b16 v[202:203], v106 offset:4096
  ds_read_b64_tr_b16 v[144:145], v107 offset:0
  ds_read_b64_tr_b16 v[146:147], v107 offset:4096
  ds_read_b64_tr_b16 v[192:193], v108 offset:0
  ds_read_b64_tr_b16 v[194:195], v108 offset:4096
  ds_read_b64_tr_b16 v[136:137], v109 offset:0
  ds_read_b64_tr_b16 v[138:139], v109 offset:4096
  ds_read_b64_tr_b16 v[184:185], v110 offset:0
  ds_read_b64_tr_b16 v[186:187], v110 offset:4096
  ds_read_b64_tr_b16 v[128:129], v111 offset:0
  ds_read_b64_tr_b16 v[130:131], v111 offset:4096
  s_waitcnt lgkmcnt(0)
  s_barrier
  s_add_u32 s27, s26, 524288
  s_add_u32 m0, s28, 65536
  s_nop 0
  buffer_load_dwordx4 v22, s[52:55], s27 offen lds
  s_add_u32 m0, s28, 66560
  s_add_u32 s27, s27, 32768
  buffer_load_dwordx4 v22, s[52:55], s27 offen lds
  s_add_u32 m0, s28, 67584
  s_add_u32 s27, s27, 32768
  buffer_load_dwordx4 v23, s[52:55], s27 offen lds
  s_add_u32 m0, s28, 68608
  s_add_u32 s27, s27, 32768
  buffer_load_dwordx4 v23, s[52:55], s27 offen lds
  s_add_u32 m0, s28, 69632
  s_add_u32 s27, s27, 32768
  buffer_load_dwordx4 v22, s[52:55], s27 offen lds
  s_add_u32 m0, s28, 70656
  s_add_u32 s27, s27, 32768
  buffer_load_dwordx4 v22, s[52:55], s27 offen lds
  s_add_u32 m0, s28, 71680
  s_add_u32 s27, s27, 32768
  buffer_load_dwordx4 v23, s[52:55], s27 offen lds
  s_add_u32 m0, s28, 72704
  s_add_u32 s27, s27, 32768
  buffer_load_dwordx4 v23, s[52:55], s27 offen lds
  s_waitcnt vmcnt(16)
  s_barrier
  ds_read_b64_tr_b16 v[212:213], v104 offset:32768
  ds_read_b64_tr_b16 v[214:215], v104 offset:36864
  ds_read_b64_tr_b16 v[156:157], v105 offset:32768
  ds_read_b64_tr_b16 v[158:159], v105 offset:36864
  ds_read_b64_tr_b16 v[204:205], v106 offset:32768
  ds_read_b64_tr_b16 v[206:207], v106 offset:36864
  ds_read_b64_tr_b16 v[148:149], v107 offset:32768
  ds_read_b64_tr_b16 v[150:151], v107 offset:36864
  ds_read_b64_tr_b16 v[196:197], v108 offset:32768
  ds_read_b64_tr_b16 v[198:199], v108 offset:36864
  ds_read_b64_tr_b16 v[140:141], v109 offset:32768
  ds_read_b64_tr_b16 v[142:143], v109 offset:36864
  ds_read_b64_tr_b16 v[188:189], v110 offset:32768
  ds_read_b64_tr_b16 v[190:191], v110 offset:36864
  ds_read_b64_tr_b16 v[132:133], v111 offset:32768
  ds_read_b64_tr_b16 v[134:135], v111 offset:36864
  s_waitcnt lgkmcnt(0)
  s_barrier
  s_add_u32 s27, s26, 2097152
  s_add_u32 m0, s28, 98304
  s_nop 0
  buffer_load_dwordx4 v22, s[52:55], s27 offen lds
  s_add_u32 m0, s28, 99328
  s_add_u32 s27, s27, 32768
  buffer_load_dwordx4 v22, s[52:55], s27 offen lds
  s_add_u32 m0, s28, 100352
  s_add_u32 s27, s27, 32768
  buffer_load_dwordx4 v23, s[52:55], s27 offen lds
  s_add_u32 m0, s28, 101376
  s_add_u32 s27, s27, 32768
  buffer_load_dwordx4 v23, s[52:55], s27 offen lds
  s_add_u32 m0, s28, 102400
  s_add_u32 s27, s27, 32768
  buffer_load_dwordx4 v22, s[52:55], s27 offen lds
  s_add_u32 m0, s28, 103424
  s_add_u32 s27, s27, 32768
  buffer_load_dwordx4 v22, s[52:55], s27 offen lds
  s_add_u32 m0, s28, 104448
  s_add_u32 s27, s27, 32768
  buffer_load_dwordx4 v23, s[52:55], s27 offen lds
  s_add_u32 m0, s28, 105472
  s_add_u32 s27, s27, 32768
  buffer_load_dwordx4 v23, s[52:55], s27 offen lds
  s_waitcnt vmcnt(16)
  s_barrier
  ds_read_b64_tr_b16 v[24:25], v112 offset:0
  ds_read_b64_tr_b16 v[26:27], v112 offset:4096
  ds_read_b64_tr_b16 v[32:33], v113 offset:0
  ds_read_b64_tr_b16 v[34:35], v113 offset:4096
  ds_read_b64_tr_b16 a[168:169], v114 offset:0
  ds_read_b64_tr_b16 a[170:171], v114 offset:4096
  ds_read_b64_tr_b16 a[120:121], v115 offset:0
  ds_read_b64_tr_b16 a[122:123], v115 offset:4096
  ds_read_b64_tr_b16 a[160:161], v116 offset:0
  ds_read_b64_tr_b16 a[162:163], v116 offset:4096
  ds_read_b64_tr_b16 a[112:113], v117 offset:0
  ds_read_b64_tr_b16 a[114:115], v117 offset:4096
  ds_read_b64_tr_b16 a[152:153], v118 offset:0
  ds_read_b64_tr_b16 a[154:155], v118 offset:4096
  ds_read_b64_tr_b16 a[104:105], v119 offset:0
  ds_read_b64_tr_b16 a[106:107], v119 offset:4096
  s_waitcnt lgkmcnt(0)
  s_barrier
  s_add_u32 s27, s26, 2621440
  s_add_u32 m0, s28, 131072
  s_nop 0
  buffer_load_dwordx4 v22, s[52:55], s27 offen lds
  s_add_u32 m0, s28, 132096
  s_add_u32 s27, s27, 32768
  buffer_load_dwordx4 v22, s[52:55], s27 offen lds
  s_add_u32 m0, s28, 133120
  s_add_u32 s27, s27, 32768
  buffer_load_dwordx4 v23, s[52:55], s27 offen lds
  s_add_u32 m0, s28, 134144
  s_add_u32 s27, s27, 32768
  buffer_load_dwordx4 v23, s[52:55], s27 offen lds
  s_add_u32 m0, s28, 135168
  s_add_u32 s27, s27, 32768
  buffer_load_dwordx4 v22, s[52:55], s27 offen lds
  s_add_u32 m0, s28, 136192
  s_add_u32 s27, s27, 32768
  buffer_load_dwordx4 v22, s[52:55], s27 offen lds
  s_add_u32 m0, s28, 137216
  s_add_u32 s27, s27, 32768
  buffer_load_dwordx4 v23, s[52:55], s27 offen lds
  s_add_u32 m0, s28, 138240
  s_add_u32 s27, s27, 32768
  buffer_load_dwordx4 v23, s[52:55], s27 offen lds
  s_waitcnt vmcnt(16)
  s_barrier
  ds_read_b64_tr_b16 v[28:29], v104 offset:0
  ds_read_b64_tr_b16 v[30:31], v104 offset:4096
  ds_read_b64_tr_b16 v[36:37], v105 offset:0
  ds_read_b64_tr_b16 v[38:39], v105 offset:4096
  ds_read_b64_tr_b16 a[172:173], v106 offset:0
  ds_read_b64_tr_b16 a[174:175], v106 offset:4096
  ds_read_b64_tr_b16 a[124:125], v107 offset:0
  ds_read_b64_tr_b16 a[126:127], v107 offset:4096
  ds_read_b64_tr_b16 a[164:165], v108 offset:0
  ds_read_b64_tr_b16 a[166:167], v108 offset:4096
  ds_read_b64_tr_b16 a[116:117], v109 offset:0
  ds_read_b64_tr_b16 a[118:119], v109 offset:4096
  ds_read_b64_tr_b16 a[156:157], v110 offset:0
  ds_read_b64_tr_b16 a[158:159], v110 offset:4096
  ds_read_b64_tr_b16 a[108:109], v111 offset:0
  ds_read_b64_tr_b16 a[110:111], v111 offset:4096
  s_waitcnt lgkmcnt(0)
  s_barrier
  s_waitcnt vmcnt(8)
  s_barrier
  ds_read_b64_tr_b16 v[56:57], v104 offset:32768
  ds_read_b64_tr_b16 v[58:59], v104 offset:36864
  ds_read_b64_tr_b16 v[64:65], v105 offset:32768
  ds_read_b64_tr_b16 v[66:67], v105 offset:36864
  ds_read_b64_tr_b16 a[144:145], v106 offset:32768
  ds_read_b64_tr_b16 a[146:147], v106 offset:36864
  ds_read_b64_tr_b16 a[96:97], v107 offset:32768
  ds_read_b64_tr_b16 a[98:99], v107 offset:36864
  ds_read_b64_tr_b16 a[136:137], v108 offset:32768
  ds_read_b64_tr_b16 a[138:139], v108 offset:36864
  ds_read_b64_tr_b16 a[88:89], v109 offset:32768
  ds_read_b64_tr_b16 a[90:91], v109 offset:36864
  ds_read_b64_tr_b16 a[128:129], v110 offset:32768
  ds_read_b64_tr_b16 a[130:131], v110 offset:36864
  ds_read_b64_tr_b16 a[80:81], v111 offset:32768
  ds_read_b64_tr_b16 a[82:83], v111 offset:36864
  s_waitcnt lgkmcnt(0)
  s_barrier
  s_waitcnt vmcnt(0)
  s_barrier
  ds_read_b64_tr_b16 v[60:61], v112 offset:0
  ds_read_b64_tr_b16 v[62:63], v112 offset:4096
  ds_read_b64_tr_b16 v[68:69], v113 offset:0
  ds_read_b64_tr_b16 v[70:71], v113 offset:4096
  ds_read_b64_tr_b16 a[148:149], v114 offset:0
  ds_read_b64_tr_b16 a[150:151], v114 offset:4096
  ds_read_b64_tr_b16 a[100:101], v115 offset:0
  ds_read_b64_tr_b16 a[102:103], v115 offset:4096
  ds_read_b64_tr_b16 a[140:141], v116 offset:0
  ds_read_b64_tr_b16 a[142:143], v116 offset:4096
  ds_read_b64_tr_b16 a[92:93], v117 offset:0
  ds_read_b64_tr_b16 a[94:95], v117 offset:4096
  ds_read_b64_tr_b16 a[132:133], v118 offset:0
  ds_read_b64_tr_b16 a[134:135], v118 offset:4096
  ds_read_b64_tr_b16 a[84:85], v119 offset:0
  ds_read_b64_tr_b16 a[86:87], v119 offset:4096
  s_waitcnt lgkmcnt(0)
  s_barrier
  s_cmp_eq_u32 s60, 0
  s_cbranch_scc1 c_nw_2
  s_lshl_b32 s26, s60, 5
  s_add_u32 s26, s26, s16
  s_lshl_b32 s26, s26, 2
  s_add_u32 s26, s26, s17
  s_mul_i32 s26, s26, 7168
  s_sub_u32 s26, s26, 917504
  s_add_u32 s27, s26, 4096
  s_mov_b32 s10, 1835008
  s_load_dwordx2 s[8:9], s[0:1], 72
  s_waitcnt lgkmcnt(0)
  buffer_load_dwordx4 v[124:127], v0, s[8:11], s26 offen offset:0
  buffer_load_dwordx4 v[124:127], v0, s[8:11], s26 offen offset:1024
  buffer_load_dwordx4 v[124:127], v0, s[8:11], s26 offen offset:2048
  buffer_load_dwordx4 v[124:127], v0, s[8:11], s26 offen offset:3072
  buffer_load_dwordx4 v[124:127], v0, s[8:11], s27 offen offset:0
  buffer_load_dwordx4 v[124:127], v0, s[8:11], s27 offen offset:1024
  buffer_load_dwordx4 v[124:127], v0, s[8:11], s27 offen offset:2048
  s_load_dwordx2 s[8:9], s[0:1], 80
  s_waitcnt lgkmcnt(0)
  buffer_load_dwordx4 v[124:127], v0, s[8:11], s26 offen offset:0
  buffer_load_dwordx4 v[124:127], v0, s[8:11], s26 offen offset:1024
  buffer_load_dwordx4 v[124:127], v0, s[8:11], s26 offen offset:2048
  buffer_load_dwordx4 v[124:127], v0, s[8:11], s26 offen offset:3072
  buffer_load_dwordx4 v[124:127], v0, s[8:11], s27 offen offset:0
  buffer_load_dwordx4 v[124:127], v0, s[8:11], s27 offen offset:1024
  buffer_load_dwordx4 v[124:127], v0, s[8:11], s27 offen offset:2048
  s_load_dwordx2 s[8:9], s[0:1], 88
  s_waitcnt lgkmcnt(0)
  buffer_load_dwordx4 v[124:127], v0, s[8:11], s26 offen offset:0
  buffer_load_dwordx4 v[124:127], v0, s[8:11], s26 offen offset:1024
  buffer_load_dwordx4 v[124:127], v0, s[8:11], s26 offen offset:2048
  buffer_load_dwordx4 v[124:127], v0, s[8:11], s26 offen offset:3072
  buffer_load_dwordx4 v[124:127], v0, s[8:11], s27 offen offset:0
  buffer_load_dwordx4 v[124:127], v0, s[8:11], s27 offen offset:1024
  buffer_load_dwordx4 v[124:127], v0, s[8:11], s27 offen offset:2048
c_nw_2:
  ds_write_b128 v1, v[24:27] offset:0
  ds_write_b128 v1, v[28:31] offset:1024
  ds_write_b128 v1, v[32:35] offset:2048
  ds_write_b128 v1, v[36:39] offset:3072
  ds_write_b128 v1, v[40:43] offset:4096
  ds_write_b128 v1, v[44:47] offset:5120
  ds_write_b128 v1, v[48:51] offset:6144
  ds_write_b128 v1, v[52:55] offset:7168
  ds_write_b128 v1, v[56:59] offset:8192
  ds_write_b128 v1, v[60:63] offset:9216
  ds_write_b128 v1, v[64:67] offset:10240
  ds_write_b128 v1, v[68:71] offset:11264
  ds_write_b128 v1, v[72:75] offset:12288
  ds_write_b128 v1, v[76:79] offset:13312
  ds_write_b128 v1, v[80:83] offset:14336
  ds_write_b128 v1, v[84:87] offset:15360
  ds_write_b128 v1, v[88:91] offset:16384
  ds_write_b128 v1, v[92:95] offset:17408
  ds_write_b128 v1, v[96:99] offset:18432
  ds_write_b128 v1, v[100:103] offset:19456
  s_mul_i32 s27, s17, 24576
  s_add_u32 m0, s27, 86016
  s_waitcnt lgkmcnt(0)
  v_mbcnt_lo_u32_b32 v20, -1, 0
  v_and_b32 v20, 7, v20
  v_lshlrev_b32 v20, 2, v20
  v_add_u32 v20, 0, v20
  s_mov_b32 s26, 0
g_wt_3:
  global_load_dword v21, v20, s[12:13] sc1
  s_add_u32 s26, s26, 1
  s_cmp_gt_u32 s26, 1048576
  s_cbranch_scc1 L_end
  s_waitcnt vmcnt(0)
  v_readlane_b32 s32, v21, 0
  v_readlane_b32 s33, v21, 1
  v_readlane_b32 s34, v21, 2
  v_readlane_b32 s35, v21, 3
  v_readlane_b32 s36, v21, 4
  v_readlane_b32 s37, v21, 5
  v_readlane_b32 s38, v21, 6
  v_readlane_b32 s39, v21, 7
  s_add_u32 s27, s32, s33
  s_add_u32 s27, s27, s34
  s_add_u32 s27, s27, s35
  s_add_u32 s27, s27, s36
  s_add_u32 s27, s27, s37
  s_add_u32 s27, s27, s38
  s_add_u32 s27, s27, s39
  s_mul_i32 s27, s27, 0x01010101
  s_lshr_b32 s27, s27, 24
  s_cmp_lt_u32 s27, 64
  s_cbranch_scc1 g_wt_3
  v_mbcnt_lo_u32_b32 v20, -1, 0
  v_and_b32 v20, 1, v20
  v_lshlrev_b32 v20, 2, v20
  v_add_u32 v20, s66, v20
  s_mov_b32 s26, 0
g_wt_4:
  global_load_dword v21, v20, s[12:13] sc1
  s_add_u32 s26, s26, 1
  s_cmp_gt_u32 s26, 1048576
  s_cbranch_scc1 L_end
  s_waitcnt vmcnt(0)
  v_readlane_b32 s32, v21, 0
  v_readlane_b32 s33, v21, 1
  s_add_u32 s27, s32, s33
  s_mul_i32 s27, s27, 0x01010101
  s_lshr_b32 s27, s27, 24
  s_cmp_lt_u32 s27, 32
  s_cbranch_scc1 g_wt_4
  s_lshl_b32 s26, s89, 3
  s_lshr_b64 s[32:33], s[32:33], s26
  s_and_b32 s32, s32, 0xff
  s_cmp_lg_u32 s32, 32
  s_cbranch_scc1 L_chain_x
  s_mov_b32 s22, 0
  s_mov_b32 s42, s62
  s_add_u32 s43, s62, 4096
  s_mov_b32 s46, 0
  s_mov_b32 s47, 0
  s_lshl_b32 s26, s16, 2
  s_add_u32 s26, s26, s17
  s_lshl_b32 s27, s60, 13
  s_add_u32 s27, s27, s26
  s_lshr_b32 s25, s27, 2
  s_lshl_b32 s25, s25, 13
  s_add_u32 s25, s25, 192937984
  s_lshr_b32 s64, s27, 2
  s_lshl_b32 s64, s64, 6
  s_add_u32 s64, s64, 512882688
  s_cmp_eq_u32 s17, 3
  s_cselect_b32 s2, 268435456, 0
  s_lshl_b32 s27, s61, 13
  s_add_u32 s27, s27, s26
  s_lshl_b32 s23, s27, 12
  s_add_u32 s23, s23, 41943040
  s_lshl_b32 s63, s27, 5
  s_add_u32 s63, s63, 243662848
  s_mov_b32 s97, 268435456
  s_cmp_eq_u32 s60, 2
  s_cselect_b32 s93, 1, 3
  s_lshl_b32 s26, s17, 2
  s_add_u32 s26, s26, s60
  s_cmp_eq_u32 s26, 1
  s_cselect_b32 s97, 244842496, s97
  s_mov_b32 s95, 0
  s_mov_b32 s96, s23
  s_mov_b32 s29, 0
c_gw_13:
  buffer_load_dword v7, off, s[4:7], s63 sc1
  s_add_u32 s29, s29, 1
  s_cmp_gt_u32 s29, 1048576
  s_cbranch_scc1 c_fail_11
  s_waitcnt vmcnt(0)
  v_readfirstlane_b32 s65, v7
  s_cmp_eq_u32 s65, 0
  s_cbranch_scc1 c_gw_13
  s_and_b32 s65, s65, s93
  s_cbranch_scc1 c_kvx_15
  s_mov_b32 s95, 1
  s_add_u32 s96, s23, 33554432
  s_add_u32 s92, s63, 262144
c_kvw_14:
  buffer_load_dword v7, off, s[4:7], s92 sc1
  s_add_u32 s29, s29, 1
  s_cmp_gt_u32 s29, 1048576
  s_cbranch_scc1 c_fail_11
  s_waitcnt vmcnt(0)
  v_readfirstlane_b32 s65, v7
  s_cmp_eq_u32 s65, 0
  s_cbranch_scc1 c_kvw_14
c_kvx_15:
  buffer_load_dwordx4 v0, s[4:7], s96 offen offset:0  lds
  buffer_load_dwordx4 v0, s[4:7], s96 offen offset:1024  lds
  buffer_load_dwordx4 v0, s[4:7], s96 offen offset:2048  lds
  buffer_load_dwordx4 v0, s[4:7], s96 offen offset:3072  lds
  s_add_u32 s23, s23, 524288
  s_add_u32 s63, s63, 4096
  s_mov_b32 s65, 0
  s_mov_b32 s95, 0
  s_mov_b32 s96, s23
  ds_read_b128 v[72:75], v1 offset:6144
  ds_read_b128 v[76:79], v1 offset:7168
  ds_read_b128 v[80:83], v1 offset:8192
  ds_read_b128 v[84:87], v1 offset:9216
  ds_read_b128 v[88:91], v1 offset:10240
  ds_read_b128 v[92:95], v1 offset:11264
  ds_read_b128 v[96:99], v1 offset:12288
  ds_read_b128 v[100:103], v1 offset:13312
  ds_read_b128 v[104:107], v1 offset:14336
  ds_read_b128 v[108:111], v1 offset:15360
  ds_read_b128 v[112:115], v1 offset:16384
  ds_read_b128 v[116:119], v1 offset:17408
  ds_read_b128 v[120:123], v1 offset:18432
  ds_read_b128 v[124:127], v1 offset:19456
  v_mov_b64 v[48:49], 0
  v_mov_b64 v[50:51], 0
  v_mov_b64 v[52:53], 0
  v_mov_b64 v[54:55], 0
  v_mov_b64 v[56:57], 0
  v_mov_b64 v[58:59], 0
  v_mov_b64 v[60:61], 0
  v_mov_b64 v[62:63], 0
  v_mov_b64 v[64:65], 0
  v_mov_b64 v[66:67], 0
  v_mov_b64 v[68:69], 0
  v_mov_b64 v[70:71], 0
  s_lshl_b32 s38, s16, 13
  s_add_u32 s38, s38, s40
  s_add_u32 s39, s38, 4096
  ds_read_b128 v[24:27], v1 offset:0
  ds_read_b128 v[28:31], v1 offset:1024
  ds_read_b128 v[32:35], v1 offset:2048
  ds_read_b128 v[36:39], v1 offset:3072
  ds_read_b128 v[40:43], v1 offset:4096
  ds_read_b128 v[44:47], v1 offset:5120
  s_waitcnt lgkmcnt(0)
c_loop_5:
  buffer_load_dwordx4 v[16:19], v8, s[4:7], s42 offen sc1
  buffer_load_dwordx4 v[20:23], v8, s[4:7], s43 offen sc1
  s_mov_b32 s28, 0
  s_cmp_eq_u32 s17, 0
  s_cbranch_scc1 c_w0a_16
  s_nop 15
  s_nop 8
  buffer_load_dwordx4 v[16:19], v8, s[4:7], s42 offen sc1
  buffer_load_dwordx4 v[20:23], v8, s[4:7], s43 offen sc1
  s_nop 15
  s_nop 8
  buffer_load_dwordx4 v[16:19], v8, s[4:7], s42 offen sc1
  buffer_load_dwordx4 v[20:23], v8, s[4:7], s43 offen sc1
c_w0b_17:
  s_waitcnt lgkmcnt(0)
  s_waitcnt vmcnt(5)
  v_max3_u32 v7, v16, v17, v18
  v_max_u32 v7, v7, v19
  ds_write_b128 v8, v[16:19] offset:0
  v_smfmac_f32_16x16x64_bf16 v[48:51], v[16:19], v[24:31], v6
  s_waitcnt vmcnt(4)
c_got_7:
  v_max3_u32 v7, v20, v21, v7
  v_max3_u32 v7, v22, v23, v7
  ds_write_b128 v8, v[20:23] offset:4096
  v_smfmac_f32_16x16x64_bf16 v[52:55], v[16:19], v[32:39], v6
  v_cmp_eq_u32 vcc, -1, v7
  v_smfmac_f32_16x16x64_bf16 v[56:59], v[16:19], v[40:47], v6
  s_cbranch_vccnz c_retry_6
  v_smfmac_f32_16x16x64_bf16 v[60:63], v[16:19], v[72:79], v6
  s_and_b32 s65, s65, s93
  s_cbranch_scc0 c_kvs_18
c_kvr_19:
  v_smfmac_f32_16x16x64_bf16 v[48:51], v[20:23], v[80:87], v6
  v_mov_b32 v7, 1
  v_smfmac_f32_16x16x64_bf16 v[52:55], v[20:23], v[88:95], v6
  v_smfmac_f32_16x16x64_bf16 v[56:59], v[20:23], v[96:103], v6
  s_waitcnt lgkmcnt(0)
  s_barrier
  ds_read_b128 v[24:27], v9 offset:0
  ds_read_b128 v[28:31], v10 offset:0
  v_smfmac_f32_16x16x64_bf16 v[60:63], v[20:23], v[104:111], v6
  ds_read_b128 v[32:35], v11 offset:0
  v_smfmac_f32_16x16x64_bf16 v[64:67], v[16:19], v[112:119], v6
  ds_read_b128 v[36:39], v9 offset:4096
  v_smfmac_f32_16x16x64_bf16 v[68:71], v[16:19], v[120:127], v6
  ds_read_b128 v[40:43], v10 offset:4096
  v_smfmac_f32_16x16x64_bf16 v[64:67], v[20:23], v[208:215], v6
  ds_read_b128 v[44:47], v11 offset:4096
  s_waitcnt lgkmcnt(5)
  v_smfmac_f32_16x16x64_bf16 v[48:51], v[24:27], a[168:175], v6
  ds_read_b128 v[72:75], v1 offset:20480
  s_waitcnt lgkmcnt(5)
  v_smfmac_f32_16x16x64_bf16 v[48:51], v[28:31], a[160:167], v6
  ds_read_b128 v[76:79], v1 offset:21504
  s_waitcnt lgkmcnt(5)
  v_smfmac_f32_16x16x64_bf16 v[48:51], v[32:35], a[152:159], v6
  ds_read_b128 v[80:83], v1 offset:22528
  s_waitcnt lgkmcnt(5)
  v_smfmac_f32_16x16x64_bf16 v[48:51], v[36:39], a[144:151], v6
  ds_read_b128 v[84:87], v1 offset:23552
  s_waitcnt lgkmcnt(5)
  v_smfmac_f32_16x16x64_bf16 v[48:51], v[40:43], a[136:143], v6
  ds_read_b128 v[104:107], v8 offset:16384
  s_waitcnt lgkmcnt(5)
  v_smfmac_f32_16x16x64_bf16 v[48:51], v[44:47], a[128:135], v6
  ds_read_b128 v[108:111], v8 offset:20480
  v_smfmac_f32_16x16x64_bf16 v[52:55], v[24:27], a[120:127], v6
  s_waitcnt lgkmcnt(5)
  buffer_load_dwordx4 v0, s[4:7], s96 offen offset:0  lds
  s_mov_b64 exec, 1
  buffer_store_dword v7, off, s[4:7], s64 sc1
  s_mov_b64 exec, -1
  v_smfmac_f32_16x16x64_bf16 v[52:55], v[28:31], a[112:119], v6
  s_waitcnt lgkmcnt(2)
  ds_read_b64 v[100:101], v5 offset:0
  v_smfmac_f32_16x16x64_bf16 v[52:55], v[32:35], a[104:111], v6
  v_add_f32 v48, v48, v50
  v_smfmac_f32_16x16x64_bf16 v[52:55], v[36:39], a[96:103], v6
  v_add_f32 v49, v49, v51
  v_smfmac_f32_16x16x64_bf16 v[52:55], v[40:43], a[88:95], v6
  v_cvt_pk_bf16_f32 v50, v48, v49
  v_smfmac_f32_16x16x64_bf16 v[52:55], v[44:47], a[80:87], v6
  v_cvt_pk_bf16_f32 v51, v48, v49
  v_smfmac_f32_16x16x64_bf16 v[56:59], v[24:27], a[72:79], v6
  ds_write_b64 v2, v[50:51] offset:8192
  v_smfmac_f32_16x16x64_bf16 v[56:59], v[28:31], a[64:71], v6
  ds_read_b64_tr_b16 v[88:89], v12 offset:8192
  s_nop 0
  v_smfmac_f32_16x16x64_bf16 v[56:59], v[32:35], a[56:63], v6
  s_nop 0
  v_add_f32 v52, v52, v54
  v_add_f32 v53, v53, v55
  v_cvt_pk_bf16_f32 v54, v52, v53
  v_cvt_pk_bf16_f32 v55, v52, v53
  ds_write_b64 v2, v[54:55] offset:8704
  v_smfmac_f32_16x16x64_bf16 v[56:59], v[36:39], a[48:55], v6
  ds_read_b64_tr_b16 v[90:91], v12 offset:8704
  v_smfmac_f32_16x16x64_bf16 v[56:59], v[40:43], a[40:47], v6
  buffer_load_dwordx4 v0, s[4:7], s96 offen offset:1024  lds
  v_smfmac_f32_16x16x64_bf16 v[56:59], v[44:47], a[32:39], v6
  ds_read_b128 v[112:115], v8 offset:24576
  v_smfmac_f32_16x16x64_bf16 v[60:63], v[24:27], a[24:31], v6
  buffer_load_dwordx4 v0, s[4:7], s96 offen offset:2048  lds
  v_smfmac_f32_16x16x64_bf16 v[60:63], v[28:31], a[16:23], v6
  s_waitcnt lgkmcnt(1)
  v_mfma_f32_16x16x32_bf16 v[92:95], v[72:75], v[88:91], 0
  buffer_load_dwordx4 v0, s[4:7], s96 offen offset:3072  lds
  v_mfma_f32_16x16x32_bf16 v[96:99], v[76:79], v[88:91], 0
  v_add_f32 v56, v56, v58
  v_add_f32 v57, v57, v59
  v_smfmac_f32_16x16x64_bf16 v[60:63], v[32:35], a[8:15], v6
  v_cvt_pk_bf16_f32 v58, v56, v57
  v_smfmac_f32_16x16x64_bf16 v[60:63], v[36:39], a[0:7], v6
  ds_write_b32 v2, v58 offset:8192
  v_smfmac_f32_16x16x64_bf16 v[60:63], v[40:43], v[248:255], v6
  s_nop 0
  v_cndmask_b32 v48, v92, v96, s[18:19]
  v_smfmac_f32_16x16x64_bf16 v[60:63], v[44:47], v[240:247], v6
  v_cndmask_b32 v49, v93, v97, s[18:19]
  v_cndmask_b32 v50, v94, v98, s[18:19]
  v_cndmask_b32 v51, v95, v99, s[18:19]
  ds_write_b128 v8, v[48:51] offset:12288
  v_smfmac_f32_16x16x64_bf16 v[68:71], v[20:23], v[152:159], v6
  s_nop 1
  s_nop 0
  v_add_f32 v60, v60, v62
  v_add_f32 v61, v61, v63
  v_cvt_pk_bf16_f32 v62, v60, v61
  ds_write_b32 v2, v62 offset:8704
  v_smfmac_f32_16x16x64_bf16 v[64:67], v[24:27], v[232:239], v6
  v_mov_b32 v76, 0
  buffer_store_dwordx2 v[100:101], v5, s[4:7], s97 offen sc1
  v_smfmac_f32_16x16x64_bf16 v[64:67], v[28:31], v[224:231], v6
  v_mov_b32 v79, 0
  s_waitcnt vmcnt(6)
  v_smfmac_f32_16x16x64_bf16 v[64:67], v[32:35], v[216:223], v6
  ds_read_b128 v[116:119], v8 offset:28672
  v_smfmac_f32_16x16x64_bf16 v[64:67], v[36:39], v[200:207], v6
  s_waitcnt lgkmcnt(1)
  s_barrier
  ds_read_b128 v[52:55], v9 offset:12288
  ds_read_b128 v[56:59], v10 offset:12288
  v_smfmac_f32_16x16x64_bf16 v[64:67], v[40:43], v[192:199], v6
  ds_read_b128 v[60:63], v11 offset:12288
  v_smfmac_f32_16x16x64_bf16 v[64:67], v[44:47], v[184:191], v6
  ds_read_b64_tr_b16 v[88:89], v12 offset:8192
  ds_read_b64_tr_b16 v[90:91], v12 offset:8704
  v_smfmac_f32_16x16x64_bf16 v[68:71], v[24:27], v[176:183], v6
  ds_read_b64_tr_b16 v[92:93], v13 offset:8192
  ds_read_b64_tr_b16 v[94:95], v13 offset:8704
  v_smfmac_f32_16x16x64_bf16 v[68:71], v[28:31], v[168:175], v6
  ds_read_b64_tr_b16 v[96:97], v14 offset:8192
  ds_read_b64_tr_b16 v[98:99], v14 offset:8704
  v_smfmac_f32_16x16x64_bf16 v[68:71], v[32:35], v[160:167], v6
  ds_read_b64_tr_b16 v[100:101], v15 offset:8192
  ds_read_b64_tr_b16 v[102:103], v15 offset:8704
  s_waitcnt lgkmcnt(8)
  v_smfmac_f32_16x16x64_bf16 v[68:71], v[36:39], v[144:151], v6
  v_add_f32 v48, v48, v52
  v_smfmac_f32_16x16x64_bf16 v[68:71], v[40:43], v[136:143], v6
  v_add_f32 v49, v49, v53
  v_smfmac_f32_16x16x64_bf16 v[68:71], v[44:47], v[128:135], v6
  v_add_f32 v50, v50, v54
  s_waitcnt lgkmcnt(4)
  v_mfma_f32_16x16x32_bf16 v[16:19], v[88:91], v[88:91], 0
  v_add_f32 v51, v51, v55
  v_add_f32 v56, v56, v60
  v_mfma_f32_16x16x32_bf16 v[16:19], v[92:95], v[92:95], v[16:19]
  v_add_f32 v57, v57, v61
  s_waitcnt lgkmcnt(0)
  v_add_f32 v58, v58, v62
  v_mfma_f32_16x16x32_bf16 v[16:19], v[96:99], v[96:99], v[16:19]
  v_add_f32 v59, v59, v63
  v_add_f32 v48, v48, v56
  v_mfma_f32_16x16x32_bf16 v[16:19], v[100:103], v[100:103], v[16:19]
  v_add_f32 v49, v49, v57
  v_add_f32 v50, v50, v58
  v_add_f32 v51, v51, v59
  v_exp_f32 v24, v48
  v_exp_f32 v25, v49
  v_exp_f32 v26, v50
  v_exp_f32 v27, v51
  v_mov_b64 v[20:21], s[14:15]
  v_cvt_pk_bf16_f32 v24, v24, v25
  v_cvt_pk_bf16_f32 v25, v26, v27
  v_cndmask_b32 v72, v24, 0, s[18:19]
  v_cndmask_b32 v73, v25, 0, s[18:19]
  v_cndmask_b32 v74, 0, v24, s[18:19]
  v_cndmask_b32 v75, 0, v25, s[18:19]
  v_mul_f32 v16, s24, v16
  v_mul_f32 v17, s24, v17
  v_mfma_f32_16x16x32_bf16 v[52:55], v[72:75], v[80:83], 0
  buffer_store_dwordx4 v[88:91], v8, s[4:7], s25 offen sc1
  v_exp_f32 v28, v16
  v_mov_b64 v[22:23], s[14:15]
  v_mfma_f32_16x16x32_bf16 v[56:59], v[72:75], v[84:87], 0
  v_exp_f32 v29, v17
  v_mfma_f32_16x16x32_bf16 v[60:63], v[72:75], v[20:23], 0
  v_add_f32 v64, v64, v66
  v_add_f32 v65, v65, v67
  v_cvt_pk_bf16_f32 v28, v28, v29
  v_cvt_pk_bf16_f32 v66, v64, v65
  v_cndmask_b32 v77, 0, v28, s[18:19]
  v_cndmask_b32 v78, 0, v28, s[18:19]
  v_add_f32 v68, v68, v70
  v_add_f32 v69, v69, v71
  v_cvt_pk_bf16_f32 v67, v68, v69
  v_mfma_f32_16x16x16_bf16 v[60:63], v[76:77], v[20:21], v[60:63]
  v_max3_f32 v7, |v48|, |v49|, |v50|
  v_max_f32 v26, |v16|, |v17|
  v_mfma_f32_16x16x16_bf16 v[52:55], v[78:79], v[66:67], v[52:55]
  v_cndmask_b32 v26, 0, v26, s[18:19]
  v_max3_f32 v7, |v51|, v26, v7
  v_mfma_f32_16x16x16_bf16 v[56:59], v[76:77], v[66:67], v[56:59]
  v_cmp_lt_f32 vcc, 0x42700000, v7
  v_mov_b64 v[44:45], 0
  v_add_f32 v60, v60, v62
  v_add_f32 v61, v61, v63
  s_cbranch_vccnz c_fb_9
c_fbr_10:
  v_rcp_f32 v60, v60
  v_rcp_f32 v61, v61
  v_pk_add_f32 v[52:53], v[52:53], v[54:55]
  v_pk_add_f32 v[56:57], v[56:57], v[58:59]
  v_pk_mul_f32 v[52:53], v[52:53], v[60:61]
  v_pk_mul_f32 v[56:57], v[56:57], v[60:61]
  v_cvt_pk_bf16_f32 v54, v52, v53
  v_cvt_pk_bf16_f32 v55, v56, v57
  ds_write_b64 v2, v[54:55] offset:0
  v_mov_b64 v[46:47], 0
  v_mov_b64 v[40:41], 0
  v_mov_b64 v[42:43], 0
  v_mov_b64 v[36:37], 0
  v_mov_b64 v[38:39], 0
  v_mov_b64 v[32:33], 0
  v_mov_b64 v[34:35], 0
  v_mov_b64 v[28:29], 0
  v_mov_b64 v[30:31], 0
  v_mov_b64 v[24:25], 0
  v_mov_b64 v[26:27], 0
  v_mov_b64 v[80:81], 0
  v_lshrrev_b32 v7, 1, v8
  s_add_u32 s30, s25, 4096
  s_waitcnt lgkmcnt(0)
  s_barrier
  ds_read_b64_tr_b16 v[72:73], v3 offset:0
  ds_read_b64_tr_b16 v[74:75], v3 offset:1024
  ds_read_b64_tr_b16 v[76:77], v3 offset:2048
  ds_read_b64_tr_b16 v[78:79], v3 offset:3072
  s_waitcnt lgkmcnt(2)
  v_smfmac_f32_16x16x64_bf16 v[44:47], v[72:75], a[248:255], v6
  ds_read_b128 v[120:123], v8 offset:32768
  s_and_b32 s3, s22, 1
  s_add_u32 s22, s22, 1
  buffer_store_dwordx2 v[66:67], v7, s[4:7], s30 offen sc1
  s_waitcnt lgkmcnt(1)
  v_smfmac_f32_16x16x64_bf16 v[44:47], v[76:79], a[240:247], v6
  ds_read_b128 v[124:127], v8 offset:36864
  s_and_b32 s42, s22, 3
  s_lshl_b32 s42, s42, 13
  s_cmp_eq_u32 s22, 64
  s_cbranch_scc1 c_last_12
  v_smfmac_f32_16x16x64_bf16 v[40:43], v[72:75], a[232:239], v6
  ds_read_b128 v[16:19], v8 offset:40960
  v_smfmac_f32_16x16x64_bf16 v[40:43], v[76:79], a[224:231], v6
  ds_read_b128 v[20:23], v8 offset:45056
  v_smfmac_f32_16x16x64_bf16 v[36:39], v[72:75], a[216:223], v6
  v_mov_b64 v[82:83], 0
  v_mov_b64 v[84:85], 0
  v_mov_b64 v[86:87], 0
  v_smfmac_f32_16x16x64_bf16 v[36:39], v[76:79], a[208:215], v6
  ds_read_b128 v[88:91], v8 offset:49152
  v_smfmac_f32_16x16x64_bf16 v[32:35], v[72:75], a[200:207], v6
  v_add_f32 v44, v44, v46
  v_add_f32 v45, v45, v47
  v_cvt_pk_bf16_f32 v48, v44, v45
  v_smfmac_f32_16x16x64_bf16 v[32:35], v[76:79], a[192:199], v6
  ds_read_b128 v[92:95], v8 offset:53248
  v_smfmac_f32_16x16x64_bf16 v[28:31], v[72:75], a[184:191], v6
  v_and_or_b32 v48, v48, -2, s3
  v_add_f32 v40, v40, v42
  v_add_f32 v41, v41, v43
  v_smfmac_f32_16x16x64_bf16 v[28:31], v[76:79], a[176:183], v6
  ds_read_b128 v[96:99], v8 offset:57344
  v_smfmac_f32_16x16x64_bf16 v[24:27], v[72:75], v[104:111], v6
  v_cvt_pk_bf16_f32 v49, v40, v41
  v_add_f32 v36, v36, v38
  v_add_f32 v37, v37, v39
  v_smfmac_f32_16x16x64_bf16 v[24:27], v[76:79], v[112:119], v6
  ds_read_b128 v[100:103], v8 offset:61440
  s_waitcnt lgkmcnt(6)
  v_smfmac_f32_16x16x64_bf16 v[80:83], v[72:75], v[120:127], v6
  v_cvt_pk_bf16_f32 v50, v36, v37
  v_add_f32 v32, v32, v34
  v_add_f32 v33, v33, v35
  s_waitcnt lgkmcnt(4)
  v_smfmac_f32_16x16x64_bf16 v[80:83], v[76:79], v[16:23], v6
  v_cvt_pk_bf16_f32 v51, v32, v33
  v_add_f32 v28, v28, v30
  v_add_f32 v29, v29, v31
  buffer_store_dwordx4 v[48:51], v4, s[4:7], s40 offen
  s_waitcnt lgkmcnt(2)
  v_smfmac_f32_16x16x64_bf16 v[84:87], v[72:75], v[88:95], v6
  v_cvt_pk_bf16_f32 v52, v28, v29
  v_and_or_b32 v52, v52, -2, s3
  v_add_f32 v24, v24, v26
  s_waitcnt lgkmcnt(0)
  v_smfmac_f32_16x16x64_bf16 v[84:87], v[76:79], v[96:103], v6
  v_add_f32 v25, v25, v27
  v_cvt_pk_bf16_f32 v53, v24, v25
  v_add_f32 v80, v80, v82
  v_add_f32 v81, v81, v83
  v_cvt_pk_bf16_f32 v54, v80, v81
  s_nop 2
  v_pk_add_f32 v[84:85], v[84:85], v[86:87]
  v_cvt_pk_bf16_f32 v55, v84, v85
  buffer_store_dwordx4 v[52:55], v4, s[4:7], s41 offen
  s_add_u32 s42, s42, s62
  s_add_u32 s43, s42, 4096
  s_add_u32 s23, s23, 524288
  s_add_u32 s25, s25, 262144
  s_add_u32 s63, s63, 4096
  s_add_u32 s64, s64, 2048
  s_andn2_b32 s64, s64, s2
  s_mov_b32 s96, s23
  s_add_u32 s97, s97, 8192
  s_buffer_load_dword s65, s[4:7], s63
  v_mov_b64 v[56:57], 0
  v_mov_b64 v[58:59], 0
  v_mov_b64 v[60:61], 0
  v_mov_b64 v[62:63], 0
  v_mov_b64 v[48:49], 0
  v_mov_b64 v[50:51], 0
  v_mov_b64 v[52:53], 0
  v_mov_b64 v[54:55], 0
  s_cmp_lg_u32 s17, 0
  s_cbranch_scc1 c_oth_20
  s_mov_b32 s28, 0
  s_add_u32 s46, s46, 1
  v_mov_b64 v[120:121], -1
  s_xor_b32 s34, s42, 16384
  buffer_store_dwordx2 v[120:121], v5, s[4:7], s34 offen
  s_mov_b32 vcc_lo, 0xaaaaaaaa
  s_mov_b32 vcc_hi, 0xaaaaaaaa
  v_mov_b32 v7, 0x3f80
  v_cndmask_b32 v7, v7, 1.0, vcc
  s_mov_b32 vcc_lo, 0x30003
  s_mov_b32 vcc_hi, 0x30003
  v_cndmask_b32 v68, 0, v7, vcc
  s_mov_b32 vcc_lo, 0xc000c
  s_mov_b32 vcc_hi, 0xc000c
  v_cndmask_b32 v69, 0, v7, vcc
  s_mov_b32 vcc_lo, 0x300030
  s_mov_b32 vcc_hi, 0x300030
  v_cndmask_b32 v70, 0, v7, vcc
  s_mov_b32 vcc_lo, 0xc000c0
  s_mov_b32 vcc_hi, 0xc000c0
  v_cndmask_b32 v71, 0, v7, vcc
  s_nop 15
  s_nop 15
  s_nop 15
  s_nop 15
  s_nop 5
  buffer_load_dwordx4 v[16:19], v0, s[4:7], s38 offen offset:0 sc1
  buffer_load_dwordx4 v[20:23], v0, s[4:7], s38 offen offset:1024 sc1
  buffer_load_dwordx4 v[24:27], v0, s[4:7], s38 offen offset:2048 sc1
  buffer_load_dwordx4 v[28:31], v0, s[4:7], s38 offen offset:3072 sc1
  buffer_load_dwordx4 v[32:35], v0, s[4:7], s39 offen offset:0 sc1
  buffer_load_dwordx4 v[36:39], v0, s[4:7], s39 offen offset:1024 sc1
  buffer_load_dwordx4 v[40:43], v0, s[4:7], s39 offen offset:2048 sc1
  buffer_load_dwordx4 v[44:47], v0, s[4:7], s39 offen offset:3072 sc1
  s_nop 14
  buffer_load_dwordx4 v[72:75], v0, s[4:7], s38 offen offset:0 sc1
  buffer_load_dwordx4 v[76:79], v0, s[4:7], s38 offen offset:1024 sc1
  buffer_load_dwordx4 v[80:83], v0, s[4:7], s38 offen offset:2048 sc1
  buffer_load_dwordx4 v[84:87], v0, s[4:7], s38 offen offset:3072 sc1
  buffer_load_dwordx4 v[88:91], v0, s[4:7], s39 offen offset:0 sc1
  buffer_load_dwordx4 v[92:95], v0, s[4:7], s39 offen offset:1024 sc1
  buffer_load_dwordx4 v[96:99], v0, s[4:7], s39 offen offset:2048 sc1
  buffer_load_dwordx4 v[100:103], v0, s[4:7], s39 offen offset:3072 sc1
  s_waitcnt vmcnt(15)
  v_mfma_f32_16x16x32_bf16 v[64:67], v[16:19], v[68:71], 0
  v_xor_b32 v7, s3, v16
  s_waitcnt vmcnt(14)
  v_mfma_f32_16x16x32_bf16 v[64:67], v[20:23], v[68:71], v[64:67]
  v_bitop3_b32 v7, v7, v20, s3 bitop3:0xf6
  s_waitcnt vmcnt(13)
  v_mfma_f32_16x16x32_bf16 v[64:67], v[24:27], v[68:71], v[64:67]
  v_bitop3_b32 v7, v7, v24, s3 bitop3:0xf6
  s_waitcnt vmcnt(12)
  v_mfma_f32_16x16x32_bf16 v[64:67], v[28:31], v[68:71], v[64:67]
  v_bitop3_b32 v7, v7, v28, s3 bitop3:0xf6
  s_waitcnt vmcnt(11)
  v_mfma_f32_16x16x32_bf16 v[64:67], v[32:35], v[68:71], v[64:67]
  v_bitop3_b32 v7, v7, v32, s3 bitop3:0xf6
  s_waitcnt vmcnt(10)
  v_mfma_f32_16x16x32_bf16 v[64:67], v[36:39], v[68:71], v[64:67]
  v_bitop3_b32 v7, v7, v36, s3 bitop3:0xf6
  s_waitcnt vmcnt(9)
  v_mfma_f32_16x16x32_bf16 v[64:67], v[40:43], v[68:71], v[64:67]
  v_bitop3_b32 v7, v7, v40, s3 bitop3:0xf6
  s_waitcnt vmcnt(8)
  v_mfma_f32_16x16x32_bf16 v[64:67], v[44:47], v[68:71], v[64:67]
  v_bitop3_b32 v7, v7, v44, s3 bitop3:0xf6
  v_and_b32 v7, 1, v7
  v_cmp_ne_u32 vcc, 0, v7
  v_mov_b32 v7, 0
  v_mov_b32 v7, 0
  s_cbranch_vccnz c_p1r_21
c_publ_22:
  s_nop 1
  v_cvt_pk_bf16_f32 v64, v64, v65
  v_cvt_pk_bf16_f32 v65, v66, v67
  v_min_u32 v64, -2, v64
  v_min_u32 v65, -2, v65
  buffer_store_dwordx2 v[64:65], v5, s[4:7], s42 offen
c_hop2_8:
  s_barrier
  s_nop 15
  s_nop 13
  s_cmp_eq_u32 s95, 0
  s_cbranch_scc1 c_loop_5
  s_mov_b32 s29, 0
c_fk_23:
  buffer_load_dwordx4 v[16:19], v8, s[4:7], s42 offen sc1
  buffer_load_dwordx4 v[20:23], v8, s[4:7], s43 offen sc1
  s_add_u32 s29, s29, 1
  s_cmp_gt_u32 s29, 1048576
  s_cbranch_scc1 c_fail_11
  s_waitcnt vmcnt(0)
  v_max3_u32 v7, v16, v17, v18
  v_max3_u32 v7, v19, v20, v7
  v_max3_u32 v7, v21, v22, v7
  v_max_u32 v7, v7, v23
  v_cmp_eq_u32 vcc, -1, v7
  s_cbranch_vccnz c_fk_23
  s_lshl_b32 s42, s22, 13
  s_add_u32 s42, s42, 244842496
  s_add_u32 s43, s42, 4096
  s_mov_b32 s95, 0
  s_branch c_loop_5
c_kvs_18:
  s_cmp_ge_u32 s22, 63
  s_cbranch_scc1 c_kvr_19
  s_mov_b32 s29, 0
c_gw_24:
  buffer_load_dword v7, off, s[4:7], s63 sc1
  s_add_u32 s29, s29, 1
  s_cmp_gt_u32 s29, 1048576
  s_cbranch_scc1 c_fail_11
  s_waitcnt vmcnt(0)
  v_readfirstlane_b32 s65, v7
  s_cmp_eq_u32 s65, 0
  s_cbranch_scc1 c_gw_24
  s_and_b32 s65, s65, s93
  s_cbranch_scc1 c_kvx_26
  s_mov_b32 s95, 1
  s_add_u32 s96, s23, 33554432
  s_add_u32 s92, s63, 262144
c_kvw_25:
  buffer_load_dword v7, off, s[4:7], s92 sc1
  s_add_u32 s29, s29, 1
  s_cmp_gt_u32 s29, 1048576
  s_cbranch_scc1 c_fail_11
  s_waitcnt vmcnt(0)
  v_readfirstlane_b32 s65, v7
  s_cmp_eq_u32 s65, 0
  s_cbranch_scc1 c_kvw_25
c_kvx_26:
  s_branch c_kvr_19
c_last_12:
  s_add_u32 s64, s64, 2048
  v_mov_b32 v7, 1
  s_waitcnt vmcnt(0)
  s_barrier
  s_mov_b64 exec, 1
  buffer_store_dword v7, off, s[4:7], s64 sc1
  s_mov_b64 exec, -1
  s_branch c_fail_11
c_oth_20:
  ds_read_b128 v[24:27], v1 offset:0
  ds_read_b128 v[28:31], v1 offset:1024
  ds_read_b128 v[32:35], v1 offset:2048
  ds_read_b128 v[36:39], v1 offset:3072
  ds_read_b128 v[40:43], v1 offset:4096
  ds_read_b128 v[44:47], v1 offset:5120
  ds_read_b128 v[72:75], v1 offset:6144
  ds_read_b128 v[76:79], v1 offset:7168
  ds_read_b128 v[80:83], v1 offset:8192
  ds_read_b128 v[84:87], v1 offset:9216
  ds_read_b128 v[88:91], v1 offset:10240
  ds_read_b128 v[92:95], v1 offset:11264
  ds_read_b128 v[96:99], v1 offset:12288
  ds_read_b128 v[100:103], v1 offset:13312
  ds_read_b128 v[104:107], v1 offset:14336
  ds_read_b128 v[108:111], v1 offset:15360
  ds_read_b128 v[112:115], v1 offset:16384
  ds_read_b128 v[116:119], v1 offset:17408
  ds_read_b128 v[120:123], v1 offset:18432
  ds_read_b128 v[124:127], v1 offset:19456
  v_mov_b64 v[64:65], 0
  v_mov_b64 v[66:67], 0
  v_mov_b64 v[68:69], 0
  v_mov_b64 v[70:71], 0
  s_branch c_hop2_8
c_w0a_16:
  s_waitcnt vmcnt(3)
  ds_read_b128 v[24:27], v1 offset:0
  ds_read_b128 v[28:31], v1 offset:1024
  ds_read_b128 v[32:35], v1 offset:2048
  ds_read_b128 v[36:39], v1 offset:3072
  ds_read_b128 v[40:43], v1 offset:4096
  ds_read_b128 v[44:47], v1 offset:5120
  ds_read_b128 v[72:75], v1 offset:6144
  ds_read_b128 v[76:79], v1 offset:7168
  ds_read_b128 v[80:83], v1 offset:8192
  ds_read_b128 v[84:87], v1 offset:9216
  buffer_load_dwordx4 v[16:19], v8, s[4:7], s42 offen sc1
  buffer_load_dwordx4 v[20:23], v8, s[4:7], s43 offen sc1
  ds_read_b128 v[88:91], v1 offset:10240
  ds_read_b128 v[92:95], v1 offset:11264
  ds_read_b128 v[96:99], v1 offset:12288
  ds_read_b128 v[100:103], v1 offset:13312
  ds_read_b128 v[104:107], v1 offset:14336
  ds_read_b128 v[108:111], v1 offset:15360
  ds_read_b128 v[112:115], v1 offset:16384
  ds_read_b128 v[116:119], v1 offset:17408
  ds_read_b128 v[120:123], v1 offset:18432
  ds_read_b128 v[124:127], v1 offset:19456
  buffer_load_dwordx4 v[16:19], v8, s[4:7], s42 offen sc1
  buffer_load_dwordx4 v[20:23], v8, s[4:7], s43 offen sc1
  v_mov_b64 v[64:65], 0
  v_mov_b64 v[66:67], 0
  v_mov_b64 v[68:69], 0
  v_mov_b64 v[70:71], 0
  s_branch c_w0b_17
c_p1r_21:
  buffer_load_dwordx4 v[16:19], v0, s[4:7], s38 offen offset:0 sc1
  buffer_load_dwordx4 v[20:23], v0, s[4:7], s38 offen offset:1024 sc1
  buffer_load_dwordx4 v[24:27], v0, s[4:7], s38 offen offset:2048 sc1
  buffer_load_dwordx4 v[28:31], v0, s[4:7], s38 offen offset:3072 sc1
  buffer_load_dwordx4 v[32:35], v0, s[4:7], s39 offen offset:0 sc1
  buffer_load_dwordx4 v[36:39], v0, s[4:7], s39 offen offset:1024 sc1
  buffer_load_dwordx4 v[40:43], v0, s[4:7], s39 offen offset:2048 sc1
  buffer_load_dwordx4 v[44:47], v0, s[4:7], s39 offen offset:3072 sc1
  s_add_u32 s46, s46, 1
  s_waitcnt vmcnt(15)
  v_mfma_f32_16x16x32_bf16 v[64:67], v[72:75], v[68:71], 0
  v_xor_b32 v7, s3, v72
  s_waitcnt vmcnt(14)
  v_mfma_f32_16x16x32_bf16 v[64:67], v[76:79], v[68:71], v[64:67]
  v_bitop3_b32 v7, v7, v76, s3 bitop3:0xf6
  s_waitcnt vmcnt(13)
  v_mfma_f32_16x16x32_bf16 v[64:67], v[80:83], v[68:71], v[64:67]
  v_bitop3_b32 v7, v7, v80, s3 bitop3:0xf6
  s_waitcnt vmcnt(12)
  v_mfma_f32_16x16x32_bf16 v[64:67], v[84:87], v[68:71], v[64:67]
  v_bitop3_b32 v7, v7, v84, s3 bitop3:0xf6
  s_waitcnt vmcnt(11)
  v_mfma_f32_16x16x32_bf16 v[64:67], v[88:91], v[68:71], v[64:67]
  v_bitop3_b32 v7, v7, v88, s3 bitop3:0xf6
  s_waitcnt vmcnt(10)
  v_mfma_f32_16x16x32_bf16 v[64:67], v[92:95], v[68:71], v[64:67]
  v_bitop3_b32 v7, v7, v92, s3 bitop3:0xf6
  s_waitcnt vmcnt(9)
  v_mfma_f32_16x16x32_bf16 v[64:67], v[96:99], v[68:71], v[64:67]
  v_bitop3_b32 v7, v7, v96, s3 bitop3:0xf6
  s_waitcnt vmcnt(8)
  v_mfma_f32_16x16x32_bf16 v[64:67], v[100:103], v[68:71], v[64:67]
  v_bitop3_b32 v7, v7, v100, s3 bitop3:0xf6
  v_and_b32 v7, 1, v7
  v_cmp_ne_u32 vcc, 0, v7
  v_mov_b32 v7, 0
  v_mov_b32 v7, 0
  s_cbranch_vccnz c_p1s_27
  s_branch c_publ_22
c_p1s_27:
  buffer_load_dwordx4 v[72:75], v0, s[4:7], s38 offen offset:0 sc1
  buffer_load_dwordx4 v[76:79], v0, s[4:7], s38 offen offset:1024 sc1
  buffer_load_dwordx4 v[80:83], v0, s[4:7], s38 offen offset:2048 sc1
  buffer_load_dwordx4 v[84:87], v0, s[4:7], s38 offen offset:3072 sc1
  buffer_load_dwordx4 v[88:91], v0, s[4:7], s39 offen offset:0 sc1
  buffer_load_dwordx4 v[92:95], v0, s[4:7], s39 offen offset:1024 sc1
  buffer_load_dwordx4 v[96:99], v0, s[4:7], s39 offen offset:2048 sc1
  buffer_load_dwordx4 v[100:103], v0, s[4:7], s39 offen offset:3072 sc1
  s_add_u32 s28, s28, 1
  s_add_u32 s46, s46, 1
  s_cmp_gt_u32 s28, 1048576
  s_cbranch_scc1 c_fail_11
  s_waitcnt vmcnt(15)
  v_mfma_f32_16x16x32_bf16 v[64:67], v[16:19], v[68:71], 0
  v_xor_b32 v7, s3, v16
  s_waitcnt vmcnt(14)
  v_mfma_f32_16x16x32_bf16 v[64:67], v[20:23], v[68:71], v[64:67]
  v_bitop3_b32 v7, v7, v20, s3 bitop3:0xf6
  s_waitcnt vmcnt(13)
  v_mfma_f32_16x16x32_bf16 v[64:67], v[24:27], v[68:71], v[64:67]
  v_bitop3_b32 v7, v7, v24, s3 bitop3:0xf6
  s_waitcnt vmcnt(12)
  v_mfma_f32_16x16x32_bf16 v[64:67], v[28:31], v[68:71], v[64:67]
  v_bitop3_b32 v7, v7, v28, s3 bitop3:0xf6
  s_waitcnt vmcnt(11)
  v_mfma_f32_16x16x32_bf16 v[64:67], v[32:35], v[68:71], v[64:67]
  v_bitop3_b32 v7, v7, v32, s3 bitop3:0xf6
  s_waitcnt vmcnt(10)
  v_mfma_f32_16x16x32_bf16 v[64:67], v[36:39], v[68:71], v[64:67]
  v_bitop3_b32 v7, v7, v36, s3 bitop3:0xf6
  s_waitcnt vmcnt(9)
  v_mfma_f32_16x16x32_bf16 v[64:67], v[40:43], v[68:71], v[64:67]
  v_bitop3_b32 v7, v7, v40, s3 bitop3:0xf6
  s_waitcnt vmcnt(8)
  v_mfma_f32_16x16x32_bf16 v[64:67], v[44:47], v[68:71], v[64:67]
  v_bitop3_b32 v7, v7, v44, s3 bitop3:0xf6
  v_and_b32 v7, 1, v7
  v_cmp_ne_u32 vcc, 0, v7
  v_mov_b32 v7, 0
  v_mov_b32 v7, 0
  s_cbranch_vccnz c_p1r_21
  s_branch c_publ_22
c_retry_6:
  buffer_load_dwordx4 v[16:19], v8, s[4:7], s42 offen sc1
  buffer_load_dwordx4 v[20:23], v8, s[4:7], s43 offen sc1
  s_add_u32 s28, s28, 1
  s_add_u32 s47, s47, 1
  s_cmp_gt_u32 s28, 1048576
  s_cbranch_scc1 c_fail_11
  v_mov_b64 v[48:49], 0
  v_mov_b64 v[50:51], 0
  v_mov_b64 v[52:53], 0
  v_mov_b64 v[54:55], 0
  v_mov_b64 v[56:57], 0
  v_mov_b64 v[58:59], 0
  s_waitcnt vmcnt(4)
  v_max3_u32 v7, v16, v17, v18
  v_max_u32 v7, v7, v19
  ds_write_b128 v8, v[16:19] offset:0
  v_smfmac_f32_16x16x64_bf16 v[48:51], v[16:19], v[24:31], v6
  s_branch c_got_7
c_fb_9:
  v_max3_f32 v7, v48, v49, v50
  v_max_f32 v7, v51, v7
  s_mov_b64 exec, s[18:19]
  v_max3_f32 v7, v16, v17, v7
  s_mov_b64 exec, -1
  s_nop 0
  v_max_f32_dpp v7, v7, v7 quad_perm:[2,3,0,1] row_mask:0xf bank_mask:0xf
  v_mov_b32 v24, v7
  s_nop 0
  s_nop 0
  v_permlane16_swap_b32 v7, v24
  v_max_f32 v7, v7, v24
  v_mov_b32 v24, v7
  s_nop 0
  s_nop 0
  v_permlane32_swap_b32 v7, v24
  v_max_f32 v7, v7, v24
  v_sub_f32 v24, v48, v7
  v_sub_f32 v25, v49, v7
  v_sub_f32 v26, v50, v7
  v_sub_f32 v27, v51, v7
  v_sub_f32 v28, v16, v7
  v_sub_f32 v29, v17, v7
  v_exp_f32 v24, v24
  v_exp_f32 v25, v25
  v_exp_f32 v26, v26
  v_exp_f32 v27, v27
  v_exp_f32 v28, v28
  v_exp_f32 v29, v29
  v_cvt_pk_bf16_f32 v24, v24, v25
  v_cvt_pk_bf16_f32 v25, v26, v27
  v_cvt_pk_bf16_f32 v28, v28, v29
  v_cndmask_b32 v72, v24, 0, s[18:19]
  v_cndmask_b32 v73, v25, 0, s[18:19]
  v_cndmask_b32 v74, 0, v24, s[18:19]
  v_cndmask_b32 v75, 0, v25, s[18:19]
  v_cndmask_b32 v77, 0, v28, s[18:19]
  v_cndmask_b32 v78, 0, v28, s[18:19]
  v_mfma_f32_16x16x32_bf16 v[60:63], v[72:75], v[20:23], 0
  v_mfma_f32_16x16x32_bf16 v[52:55], v[72:75], v[80:83], 0
  v_mfma_f32_16x16x32_bf16 v[56:59], v[72:75], v[84:87], 0
  s_nop 5
  v_mfma_f32_16x16x16_bf16 v[60:63], v[76:77], v[20:21], v[60:63]
  v_mfma_f32_16x16x16_bf16 v[52:55], v[78:79], v[66:67], v[52:55]
  v_mfma_f32_16x16x16_bf16 v[56:59], v[76:77], v[66:67], v[56:59]
  s_nop 7
  v_add_f32 v60, v60, v62
  v_add_f32 v61, v61, v63
  s_branch c_fbr_10
c_fail_11:
  s_endpgm
L_chain_x:
  s_mov_b32 s22, 0
  s_mov_b32 s42, s62
  s_add_u32 s43, s62, 4096
  s_mov_b32 s46, 0
  s_mov_b32 s47, 0
  s_lshl_b32 s26, s16, 2
  s_add_u32 s26, s26, s17
  s_lshl_b32 s27, s60, 13
  s_add_u32 s27, s27, s26
  s_lshr_b32 s25, s27, 2
  s_lshl_b32 s25, s25, 13
  s_add_u32 s25, s25, 192937984
  s_lshr_b32 s64, s27, 2
  s_lshl_b32 s64, s64, 6
  s_add_u32 s64, s64, 512882688
  s_cmp_eq_u32 s17, 3
  s_cselect_b32 s2, 268435456, 0
  s_lshl_b32 s27, s61, 13
  s_add_u32 s27, s27, s26
  s_lshl_b32 s23, s27, 12
  s_add_u32 s23, s23, 41943040
  s_lshl_b32 s63, s27, 5
  s_add_u32 s63, s63, 243662848
  s_mov_b32 s97, 268435456
  s_cmp_eq_u32 s60, 2
  s_cselect_b32 s93, 1, 3
  s_lshl_b32 s26, s17, 2
  s_add_u32 s26, s26, s60
  s_cmp_eq_u32 s26, 1
  s_cselect_b32 s97, 244842496, s97
  s_mov_b32 s95, 0
  s_mov_b32 s96, s23
  s_mov_b32 s29, 0
c_gw_36:
  buffer_load_dword v7, off, s[4:7], s63 sc1
  s_add_u32 s29, s29, 1
  s_cmp_gt_u32 s29, 1048576
  s_cbranch_scc1 c_fail_34
  s_waitcnt vmcnt(0)
  v_readfirstlane_b32 s65, v7
  s_cmp_eq_u32 s65, 0
  s_cbranch_scc1 c_gw_36
  s_and_b32 s65, s65, s93
  s_cbranch_scc1 c_kvx_38
  s_mov_b32 s95, 1
  s_add_u32 s96, s23, 33554432
  s_add_u32 s92, s63, 262144
c_kvw_37:
  buffer_load_dword v7, off, s[4:7], s92 sc1
  s_add_u32 s29, s29, 1
  s_cmp_gt_u32 s29, 1048576
  s_cbranch_scc1 c_fail_34
  s_waitcnt vmcnt(0)
  v_readfirstlane_b32 s65, v7
  s_cmp_eq_u32 s65, 0
  s_cbranch_scc1 c_kvw_37
c_kvx_38:
  buffer_load_dwordx4 v0, s[4:7], s96 offen offset:0  lds
  buffer_load_dwordx4 v0, s[4:7], s96 offen offset:1024  lds
  buffer_load_dwordx4 v0, s[4:7], s96 offen offset:2048  lds
  buffer_load_dwordx4 v0, s[4:7], s96 offen offset:3072  lds
  s_add_u32 s23, s23, 524288
  s_add_u32 s63, s63, 4096
  s_mov_b32 s65, 0
  s_mov_b32 s95, 0
  s_mov_b32 s96, s23
  ds_read_b128 v[72:75], v1 offset:6144
  ds_read_b128 v[76:79], v1 offset:7168
  ds_read_b128 v[80:83], v1 offset:8192
  ds_read_b128 v[84:87], v1 offset:9216
  ds_read_b128 v[88:91], v1 offset:10240
  ds_read_b128 v[92:95], v1 offset:11264
  ds_read_b128 v[96:99], v1 offset:12288
  ds_read_b128 v[100:103], v1 offset:13312
  ds_read_b128 v[104:107], v1 offset:14336
  ds_read_b128 v[108:111], v1 offset:15360
  ds_read_b128 v[112:115], v1 offset:16384
  ds_read_b128 v[116:119], v1 offset:17408
  ds_read_b128 v[120:123], v1 offset:18432
  ds_read_b128 v[124:127], v1 offset:19456
  v_mov_b64 v[48:49], 0
  v_mov_b64 v[50:51], 0
  v_mov_b64 v[52:53], 0
  v_mov_b64 v[54:55], 0
  v_mov_b64 v[56:57], 0
  v_mov_b64 v[58:59], 0
  v_mov_b64 v[60:61], 0
  v_mov_b64 v[62:63], 0
  v_mov_b64 v[64:65], 0
  v_mov_b64 v[66:67], 0
  v_mov_b64 v[68:69], 0
  v_mov_b64 v[70:71], 0
  s_lshl_b32 s38, s16, 13
  s_add_u32 s38, s38, s40
  s_add_u32 s39, s38, 4096
  ds_read_b128 v[24:27], v1 offset:0
  ds_read_b128 v[28:31], v1 offset:1024
  ds_read_b128 v[32:35], v1 offset:2048
  ds_read_b128 v[36:39], v1 offset:3072
  ds_read_b128 v[40:43], v1 offset:4096
  ds_read_b128 v[44:47], v1 offset:5120
  s_waitcnt lgkmcnt(0)
c_loop_28:
  buffer_load_dwordx4 v[16:19], v8, s[4:7], s42 offen sc1
  buffer_load_dwordx4 v[20:23], v8, s[4:7], s43 offen sc1
  s_mov_b32 s28, 0
  s_cmp_eq_u32 s17, 0
  s_cbranch_scc1 c_w0a_39
  s_nop 15
  s_nop 8
  buffer_load_dwordx4 v[16:19], v8, s[4:7], s42 offen sc1
  buffer_load_dwordx4 v[20:23], v8, s[4:7], s43 offen sc1
  s_nop 15
  s_nop 8
  buffer_load_dwordx4 v[16:19], v8, s[4:7], s42 offen sc1
  buffer_load_dwordx4 v[20:23], v8, s[4:7], s43 offen sc1
c_w0b_40:
  s_waitcnt lgkmcnt(0)
  s_waitcnt vmcnt(5)
  v_max3_u32 v7, v16, v17, v18
  v_max_u32 v7, v7, v19
  ds_write_b128 v8, v[16:19] offset:0
  v_smfmac_f32_16x16x64_bf16 v[48:51], v[16:19], v[24:31], v6
  s_waitcnt vmcnt(4)
c_got_30:
  v_max3_u32 v7, v20, v21, v7
  v_max3_u32 v7, v22, v23, v7
  ds_write_b128 v8, v[20:23] offset:4096
  v_smfmac_f32_16x16x64_bf16 v[52:55], v[16:19], v[32:39], v6
  v_cmp_eq_u32 vcc, -1, v7
  v_smfmac_f32_16x16x64_bf16 v[56:59], v[16:19], v[40:47], v6
  s_cbranch_vccnz c_retry_29
  v_smfmac_f32_16x16x64_bf16 v[60:63], v[16:19], v[72:79], v6
  s_and_b32 s65, s65, s93
  s_cbranch_scc0 c_kvs_41
c_kvr_42:
  v_smfmac_f32_16x16x64_bf16 v[48:51], v[20:23], v[80:87], v6
  v_mov_b32 v7, 1
  v_smfmac_f32_16x16x64_bf16 v[52:55], v[20:23], v[88:95], v6
  v_smfmac_f32_16x16x64_bf16 v[56:59], v[20:23], v[96:103], v6
  s_waitcnt lgkmcnt(0)
  s_barrier
  ds_read_b128 v[24:27], v9 offset:0
  ds_read_b128 v[28:31], v10 offset:0
  v_smfmac_f32_16x16x64_bf16 v[60:63], v[20:23], v[104:111], v6
  ds_read_b128 v[32:35], v11 offset:0
  v_smfmac_f32_16x16x64_bf16 v[64:67], v[16:19], v[112:119], v6
  ds_read_b128 v[36:39], v9 offset:4096
  v_smfmac_f32_16x16x64_bf16 v[68:71], v[16:19], v[120:127], v6
  ds_read_b128 v[40:43], v10 offset:4096
  v_smfmac_f32_16x16x64_bf16 v[64:67], v[20:23], v[208:215], v6
  ds_read_b128 v[44:47], v11 offset:4096
  s_waitcnt lgkmcnt(5)
  v_smfmac_f32_16x16x64_bf16 v[48:51], v[24:27], a[168:175], v6
  ds_read_b128 v[72:75], v1 offset:20480
  s_waitcnt lgkmcnt(5)
  v_smfmac_f32_16x16x64_bf16 v[48:51], v[28:31], a[160:167], v6
  ds_read_b128 v[76:79], v1 offset:21504
  s_waitcnt lgkmcnt(5)
  v_smfmac_f32_16x16x64_bf16 v[48:51], v[32:35], a[152:159], v6
  ds_read_b128 v[80:83], v1 offset:22528
  s_waitcnt lgkmcnt(5)
  v_smfmac_f32_16x16x64_bf16 v[48:51], v[36:39], a[144:151], v6
  ds_read_b128 v[84:87], v1 offset:23552
  s_waitcnt lgkmcnt(5)
  v_smfmac_f32_16x16x64_bf16 v[48:51], v[40:43], a[136:143], v6
  ds_read_b128 v[104:107], v8 offset:16384
  s_waitcnt lgkmcnt(5)
  v_smfmac_f32_16x16x64_bf16 v[48:51], v[44:47], a[128:135], v6
  ds_read_b128 v[108:111], v8 offset:20480
  v_smfmac_f32_16x16x64_bf16 v[52:55], v[24:27], a[120:127], v6
  s_waitcnt lgkmcnt(5)
  buffer_load_dwordx4 v0, s[4:7], s96 offen offset:0  lds
  s_mov_b64 exec, 1
  buffer_store_dword v7, off, s[4:7], s64 sc1
  s_mov_b64 exec, -1
  v_smfmac_f32_16x16x64_bf16 v[52:55], v[28:31], a[112:119], v6
  s_waitcnt lgkmcnt(2)
  ds_read_b64 v[100:101], v5 offset:0
  v_smfmac_f32_16x16x64_bf16 v[52:55], v[32:35], a[104:111], v6
  v_add_f32 v48, v48, v50
  v_smfmac_f32_16x16x64_bf16 v[52:55], v[36:39], a[96:103], v6
  v_add_f32 v49, v49, v51
  v_smfmac_f32_16x16x64_bf16 v[52:55], v[40:43], a[88:95], v6
  v_cvt_pk_bf16_f32 v50, v48, v49
  v_smfmac_f32_16x16x64_bf16 v[52:55], v[44:47], a[80:87], v6
  v_cvt_pk_bf16_f32 v51, v48, v49
  v_smfmac_f32_16x16x64_bf16 v[56:59], v[24:27], a[72:79], v6
  ds_write_b64 v2, v[50:51] offset:8192
  v_smfmac_f32_16x16x64_bf16 v[56:59], v[28:31], a[64:71], v6
  ds_read_b64_tr_b16 v[88:89], v12 offset:8192
  s_nop 0
  v_smfmac_f32_16x16x64_bf16 v[56:59], v[32:35], a[56:63], v6
  s_nop 0
  v_add_f32 v52, v52, v54
  v_add_f32 v53, v53, v55
  v_cvt_pk_bf16_f32 v54, v52, v53
  v_cvt_pk_bf16_f32 v55, v52, v53
  ds_write_b64 v2, v[54:55] offset:8704
  v_smfmac_f32_16x16x64_bf16 v[56:59], v[36:39], a[48:55], v6
  ds_read_b64_tr_b16 v[90:91], v12 offset:8704
  v_smfmac_f32_16x16x64_bf16 v[56:59], v[40:43], a[40:47], v6
  buffer_load_dwordx4 v0, s[4:7], s96 offen offset:1024  lds
  v_smfmac_f32_16x16x64_bf16 v[56:59], v[44:47], a[32:39], v6
  ds_read_b128 v[112:115], v8 offset:24576
  v_smfmac_f32_16x16x64_bf16 v[60:63], v[24:27], a[24:31], v6
  buffer_load_dwordx4 v0, s[4:7], s96 offen offset:2048  lds
  v_smfmac_f32_16x16x64_bf16 v[60:63], v[28:31], a[16:23], v6
  s_waitcnt lgkmcnt(1)
  v_mfma_f32_16x16x32_bf16 v[92:95], v[72:75], v[88:91], 0
  buffer_load_dwordx4 v0, s[4:7], s96 offen offset:3072  lds
  v_mfma_f32_16x16x32_bf16 v[96:99], v[76:79], v[88:91], 0
  v_add_f32 v56, v56, v58
  v_add_f32 v57, v57, v59
  v_smfmac_f32_16x16x64_bf16 v[60:63], v[32:35], a[8:15], v6
  v_cvt_pk_bf16_f32 v58, v56, v57
  v_smfmac_f32_16x16x64_bf16 v[60:63], v[36:39], a[0:7], v6
  ds_write_b32 v2, v58 offset:8192
  v_smfmac_f32_16x16x64_bf16 v[60:63], v[40:43], v[248:255], v6
  s_nop 0
  v_cndmask_b32 v48, v92, v96, s[18:19]
  v_smfmac_f32_16x16x64_bf16 v[60:63], v[44:47], v[240:247], v6
  v_cndmask_b32 v49, v93, v97, s[18:19]
  v_cndmask_b32 v50, v94, v98, s[18:19]
  v_cndmask_b32 v51, v95, v99, s[18:19]
  ds_write_b128 v8, v[48:51] offset:12288
  v_smfmac_f32_16x16x64_bf16 v[68:71], v[20:23], v[152:159], v6
  s_nop 1
  s_nop 0
  v_add_f32 v60, v60, v62
  v_add_f32 v61, v61, v63
  v_cvt_pk_bf16_f32 v62, v60, v61
  ds_write_b32 v2, v62 offset:8704
  v_smfmac_f32_16x16x64_bf16 v[64:67], v[24:27], v[232:239], v6
  v_mov_b32 v76, 0
  buffer_store_dwordx2 v[100:101], v5, s[4:7], s97 offen sc1
  v_smfmac_f32_16x16x64_bf16 v[64:67], v[28:31], v[224:231], v6
  v_mov_b32 v79, 0
  s_waitcnt vmcnt(6)
  v_smfmac_f32_16x16x64_bf16 v[64:67], v[32:35], v[216:223], v6
  ds_read_b128 v[116:119], v8 offset:28672
  v_smfmac_f32_16x16x64_bf16 v[64:67], v[36:39], v[200:207], v6
  s_waitcnt lgkmcnt(1)
  s_barrier
  ds_read_b128 v[52:55], v9 offset:12288
  ds_read_b128 v[56:59], v10 offset:12288
  v_smfmac_f32_16x16x64_bf16 v[64:67], v[40:43], v[192:199], v6
  ds_read_b128 v[60:63], v11 offset:12288
  v_smfmac_f32_16x16x64_bf16 v[64:67], v[44:47], v[184:191], v6
  ds_read_b64_tr_b16 v[88:89], v12 offset:8192
  ds_read_b64_tr_b16 v[90:91], v12 offset:8704
  v_smfmac_f32_16x16x64_bf16 v[68:71], v[24:27], v[176:183], v6
  ds_read_b64_tr_b16 v[92:93], v13 offset:8192
  ds_read_b64_tr_b16 v[94:95], v13 offset:8704
  v_smfmac_f32_16x16x64_bf16 v[68:71], v[28:31], v[168:175], v6
  ds_read_b64_tr_b16 v[96:97], v14 offset:8192
  ds_read_b64_tr_b16 v[98:99], v14 offset:8704
  v_smfmac_f32_16x16x64_bf16 v[68:71], v[32:35], v[160:167], v6
  ds_read_b64_tr_b16 v[100:101], v15 offset:8192
  ds_read_b64_tr_b16 v[102:103], v15 offset:8704
  s_waitcnt lgkmcnt(8)
  v_smfmac_f32_16x16x64_bf16 v[68:71], v[36:39], v[144:151], v6
  v_add_f32 v48, v48, v52
  v_smfmac_f32_16x16x64_bf16 v[68:71], v[40:43], v[136:143], v6
  v_add_f32 v49, v49, v53
  v_smfmac_f32_16x16x64_bf16 v[68:71], v[44:47], v[128:135], v6
  v_add_f32 v50, v50, v54
  s_waitcnt lgkmcnt(4)
  v_mfma_f32_16x16x32_bf16 v[16:19], v[88:91], v[88:91], 0
  v_add_f32 v51, v51, v55
  v_add_f32 v56, v56, v60
  v_mfma_f32_16x16x32_bf16 v[16:19], v[92:95], v[92:95], v[16:19]
  v_add_f32 v57, v57, v61
  s_waitcnt lgkmcnt(0)
  v_add_f32 v58, v58, v62
  v_mfma_f32_16x16x32_bf16 v[16:19], v[96:99], v[96:99], v[16:19]
  v_add_f32 v59, v59, v63
  v_add_f32 v48, v48, v56
  v_mfma_f32_16x16x32_bf16 v[16:19], v[100:103], v[100:103], v[16:19]
  v_add_f32 v49, v49, v57
  v_add_f32 v50, v50, v58
  v_add_f32 v51, v51, v59
  v_exp_f32 v24, v48
  v_exp_f32 v25, v49
  v_exp_f32 v26, v50
  v_exp_f32 v27, v51
  v_mov_b64 v[20:21], s[14:15]
  v_cvt_pk_bf16_f32 v24, v24, v25
  v_cvt_pk_bf16_f32 v25, v26, v27
  v_cndmask_b32 v72, v24, 0, s[18:19]
  v_cndmask_b32 v73, v25, 0, s[18:19]
  v_cndmask_b32 v74, 0, v24, s[18:19]
  v_cndmask_b32 v75, 0, v25, s[18:19]
  v_mul_f32 v16, s24, v16
  v_mul_f32 v17, s24, v17
  v_mfma_f32_16x16x32_bf16 v[52:55], v[72:75], v[80:83], 0
  buffer_store_dwordx4 v[88:91], v8, s[4:7], s25 offen sc1
  v_exp_f32 v28, v16
  v_mov_b64 v[22:23], s[14:15]
  v_mfma_f32_16x16x32_bf16 v[56:59], v[72:75], v[84:87], 0
  v_exp_f32 v29, v17
  v_mfma_f32_16x16x32_bf16 v[60:63], v[72:75], v[20:23], 0
  v_add_f32 v64, v64, v66
  v_add_f32 v65, v65, v67
  v_cvt_pk_bf16_f32 v28, v28, v29
  v_cvt_pk_bf16_f32 v66, v64, v65
  v_cndmask_b32 v77, 0, v28, s[18:19]
  v_cndmask_b32 v78, 0, v28, s[18:19]
  v_add_f32 v68, v68, v70
  v_add_f32 v69, v69, v71
  v_cvt_pk_bf16_f32 v67, v68, v69
  v_mfma_f32_16x16x16_bf16 v[60:63], v[76:77], v[20:21], v[60:63]
  v_max3_f32 v7, |v48|, |v49|, |v50|
  v_max_f32 v26, |v16|, |v17|
  v_mfma_f32_16x16x16_bf16 v[52:55], v[78:79], v[66:67], v[52:55]
  v_cndmask_b32 v26, 0, v26, s[18:19]
  v_max3_f32 v7, |v51|, v26, v7
  v_mfma_f32_16x16x16_bf16 v[56:59], v[76:77], v[66:67], v[56:59]
  v_cmp_lt_f32 vcc, 0x42700000, v7
  v_mov_b64 v[44:45], 0
  v_add_f32 v60, v60, v62
  v_add_f32 v61, v61, v63
  s_cbranch_vccnz c_fb_32
c_fbr_33:
  v_rcp_f32 v60, v60
  v_rcp_f32 v61, v61
  v_pk_add_f32 v[52:53], v[52:53], v[54:55]
  v_pk_add_f32 v[56:57], v[56:57], v[58:59]
  v_pk_mul_f32 v[52:53], v[52:53], v[60:61]
  v_pk_mul_f32 v[56:57], v[56:57], v[60:61]
  v_cvt_pk_bf16_f32 v54, v52, v53
  v_cvt_pk_bf16_f32 v55, v56, v57
  ds_write_b64 v2, v[54:55] offset:0
  v_mov_b64 v[46:47], 0
  v_mov_b64 v[40:41], 0
  v_mov_b64 v[42:43], 0
  v_mov_b64 v[36:37], 0
  v_mov_b64 v[38:39], 0
  v_mov_b64 v[32:33], 0
  v_mov_b64 v[34:35], 0
  v_mov_b64 v[28:29], 0
  v_mov_b64 v[30:31], 0
  v_mov_b64 v[24:25], 0
  v_mov_b64 v[26:27], 0
  v_mov_b64 v[80:81], 0
  v_lshrrev_b32 v7, 1, v8
  s_add_u32 s30, s25, 4096
  s_waitcnt lgkmcnt(0)
  s_barrier
  ds_read_b64_tr_b16 v[72:73], v3 offset:0
  ds_read_b64_tr_b16 v[74:75], v3 offset:1024
  ds_read_b64_tr_b16 v[76:77], v3 offset:2048
  ds_read_b64_tr_b16 v[78:79], v3 offset:3072
  s_waitcnt lgkmcnt(2)
  v_smfmac_f32_16x16x64_bf16 v[44:47], v[72:75], a[248:255], v6
  ds_read_b128 v[120:123], v8 offset:32768
  s_and_b32 s3, s22, 1
  s_add_u32 s22, s22, 1
  buffer_store_dwordx2 v[66:67], v7, s[4:7], s30 offen sc1
  s_waitcnt lgkmcnt(1)
  v_smfmac_f32_16x16x64_bf16 v[44:47], v[76:79], a[240:247], v6
  ds_read_b128 v[124:127], v8 offset:36864
  s_and_b32 s42, s22, 3
  s_lshl_b32 s42, s42, 13
  s_cmp_eq_u32 s22, 64
  s_cbranch_scc1 c_last_35
  v_smfmac_f32_16x16x64_bf16 v[40:43], v[72:75], a[232:239], v6
  ds_read_b128 v[16:19], v8 offset:40960
  v_smfmac_f32_16x16x64_bf16 v[40:43], v[76:79], a[224:231], v6
  ds_read_b128 v[20:23], v8 offset:45056
  v_smfmac_f32_16x16x64_bf16 v[36:39], v[72:75], a[216:223], v6
  v_mov_b64 v[82:83], 0
  v_mov_b64 v[84:85], 0
  v_mov_b64 v[86:87], 0
  v_smfmac_f32_16x16x64_bf16 v[36:39], v[76:79], a[208:215], v6
  ds_read_b128 v[88:91], v8 offset:49152
  v_smfmac_f32_16x16x64_bf16 v[32:35], v[72:75], a[200:207], v6
  v_add_f32 v44, v44, v46
  v_add_f32 v45, v45, v47
  v_cvt_pk_bf16_f32 v48, v44, v45
  v_smfmac_f32_16x16x64_bf16 v[32:35], v[76:79], a[192:199], v6
  ds_read_b128 v[92:95], v8 offset:53248
  v_smfmac_f32_16x16x64_bf16 v[28:31], v[72:75], a[184:191], v6
  v_and_or_b32 v48, v48, -2, s3
  v_add_f32 v40, v40, v42
  v_add_f32 v41, v41, v43
  v_smfmac_f32_16x16x64_bf16 v[28:31], v[76:79], a[176:183], v6
  ds_read_b128 v[96:99], v8 offset:57344
  v_smfmac_f32_16x16x64_bf16 v[24:27], v[72:75], v[104:111], v6
  v_cvt_pk_bf16_f32 v49, v40, v41
  v_add_f32 v36, v36, v38
  v_add_f32 v37, v37, v39
  v_smfmac_f32_16x16x64_bf16 v[24:27], v[76:79], v[112:119], v6
  ds_read_b128 v[100:103], v8 offset:61440
  s_waitcnt lgkmcnt(6)
  v_smfmac_f32_16x16x64_bf16 v[80:83], v[72:75], v[120:127], v6
  v_cvt_pk_bf16_f32 v50, v36, v37
  v_add_f32 v32, v32, v34
  v_add_f32 v33, v33, v35
  s_waitcnt lgkmcnt(4)
  v_smfmac_f32_16x16x64_bf16 v[80:83], v[76:79], v[16:23], v6
  v_cvt_pk_bf16_f32 v51, v32, v33
  v_add_f32 v28, v28, v30
  v_add_f32 v29, v29, v31
  buffer_store_dwordx4 v[48:51], v4, s[4:7], s40 offen sc1
  s_waitcnt lgkmcnt(2)
  v_smfmac_f32_16x16x64_bf16 v[84:87], v[72:75], v[88:95], v6
  v_cvt_pk_bf16_f32 v52, v28, v29
  v_and_or_b32 v52, v52, -2, s3
  v_add_f32 v24, v24, v26
  s_waitcnt lgkmcnt(0)
  v_smfmac_f32_16x16x64_bf16 v[84:87], v[76:79], v[96:103], v6
  v_add_f32 v25, v25, v27
  v_cvt_pk_bf16_f32 v53, v24, v25
  v_add_f32 v80, v80, v82
  v_add_f32 v81, v81, v83
  v_cvt_pk_bf16_f32 v54, v80, v81
  s_nop 2
  v_pk_add_f32 v[84:85], v[84:85], v[86:87]
  v_cvt_pk_bf16_f32 v55, v84, v85
  buffer_store_dwordx4 v[52:55], v4, s[4:7], s41 offen sc1
  s_add_u32 s42, s42, s62
  s_add_u32 s43, s42, 4096
  s_add_u32 s23, s23, 524288
  s_add_u32 s25, s25, 262144
  s_add_u32 s63, s63, 4096
  s_add_u32 s64, s64, 2048
  s_andn2_b32 s64, s64, s2
  s_mov_b32 s96, s23
  s_add_u32 s97, s97, 8192
  s_buffer_load_dword s65, s[4:7], s63
  v_mov_b64 v[56:57], 0
  v_mov_b64 v[58:59], 0
  v_mov_b64 v[60:61], 0
  v_mov_b64 v[62:63], 0
  v_mov_b64 v[48:49], 0
  v_mov_b64 v[50:51], 0
  v_mov_b64 v[52:53], 0
  v_mov_b64 v[54:55], 0
  s_cmp_lg_u32 s17, 0
  s_cbranch_scc1 c_oth_43
  s_mov_b32 s28, 0
  s_add_u32 s46, s46, 1
  v_mov_b64 v[120:121], -1
  s_xor_b32 s34, s42, 16384
  buffer_store_dwordx2 v[120:121], v5, s[4:7], s34 offen sc1
  s_mov_b32 vcc_lo, 0xaaaaaaaa
  s_mov_b32 vcc_hi, 0xaaaaaaaa
  v_mov_b32 v7, 0x3f80
  v_cndmask_b32 v7, v7, 1.0, vcc
  s_mov_b32 vcc_lo, 0x30003
  s_mov_b32 vcc_hi, 0x30003
  v_cndmask_b32 v68, 0, v7, vcc
  s_mov_b32 vcc_lo, 0xc000c
  s_mov_b32 vcc_hi, 0xc000c
  v_cndmask_b32 v69, 0, v7, vcc
  s_mov_b32 vcc_lo, 0x300030
  s_mov_b32 vcc_hi, 0x300030
  v_cndmask_b32 v70, 0, v7, vcc
  s_mov_b32 vcc_lo, 0xc000c0
  s_mov_b32 vcc_hi, 0xc000c0
  v_cndmask_b32 v71, 0, v7, vcc
  s_nop 15
  s_nop 15
  s_nop 15
  s_nop 15
  s_nop 5
  buffer_load_dwordx4 v[16:19], v0, s[4:7], s38 offen offset:0 sc1
  buffer_load_dwordx4 v[20:23], v0, s[4:7], s38 offen offset:1024 sc1
  buffer_load_dwordx4 v[24:27], v0, s[4:7], s38 offen offset:2048 sc1
  buffer_load_dwordx4 v[28:31], v0, s[4:7], s38 offen offset:3072 sc1
  buffer_load_dwordx4 v[32:35], v0, s[4:7], s39 offen offset:0 sc1
  buffer_load_dwordx4 v[36:39], v0, s[4:7], s39 offen offset:1024 sc1
  buffer_load_dwordx4 v[40:43], v0, s[4:7], s39 offen offset:2048 sc1
  buffer_load_dwordx4 v[44:47], v0, s[4:7], s39 offen offset:3072 sc1
  s_nop 14
  buffer_load_dwordx4 v[72:75], v0, s[4:7], s38 offen offset:0 sc1
  buffer_load_dwordx4 v[76:79], v0, s[4:7], s38 offen offset:1024 sc1
  buffer_load_dwordx4 v[80:83], v0, s[4:7], s38 offen offset:2048 sc1
  buffer_load_dwordx4 v[84:87], v0, s[4:7], s38 offen offset:3072 sc1
  buffer_load_dwordx4 v[88:91], v0, s[4:7], s39 offen offset:0 sc1
  buffer_load_dwordx4 v[92:95], v0, s[4:7], s39 offen offset:1024 sc1
  buffer_load_dwordx4 v[96:99], v0, s[4:7], s39 offen offset:2048 sc1
  buffer_load_dwordx4 v[100:103], v0, s[4:7], s39 offen offset:3072 sc1
  s_waitcnt vmcnt(15)
  v_mfma_f32_16x16x32_bf16 v[64:67], v[16:19], v[68:71], 0
  v_xor_b32 v7, s3, v16
  s_waitcnt vmcnt(14)
  v_mfma_f32_16x16x32_bf16 v[64:67], v[20:23], v[68:71], v[64:67]
  v_bitop3_b32 v7, v7, v20, s3 bitop3:0xf6
  s_waitcnt vmcnt(13)
  v_mfma_f32_16x16x32_bf16 v[64:67], v[24:27], v[68:71], v[64:67]
  v_bitop3_b32 v7, v7, v24, s3 bitop3:0xf6
  s_waitcnt vmcnt(12)
  v_mfma_f32_16x16x32_bf16 v[64:67], v[28:31], v[68:71], v[64:67]
  v_bitop3_b32 v7, v7, v28, s3 bitop3:0xf6
  s_waitcnt vmcnt(11)
  v_mfma_f32_16x16x32_bf16 v[64:67], v[32:35], v[68:71], v[64:67]
  v_bitop3_b32 v7, v7, v32, s3 bitop3:0xf6
  s_waitcnt vmcnt(10)
  v_mfma_f32_16x16x32_bf16 v[64:67], v[36:39], v[68:71], v[64:67]
  v_bitop3_b32 v7, v7, v36, s3 bitop3:0xf6
  s_waitcnt vmcnt(9)
  v_mfma_f32_16x16x32_bf16 v[64:67], v[40:43], v[68:71], v[64:67]
  v_bitop3_b32 v7, v7, v40, s3 bitop3:0xf6
  s_waitcnt vmcnt(8)
  v_mfma_f32_16x16x32_bf16 v[64:67], v[44:47], v[68:71], v[64:67]
  v_bitop3_b32 v7, v7, v44, s3 bitop3:0xf6
  v_and_b32 v7, 1, v7
  v_cmp_ne_u32 vcc, 0, v7
  v_mov_b32 v7, 0
  v_mov_b32 v7, 0
  s_cbranch_vccnz c_p1r_44
c_publ_45:
  s_nop 1
  v_cvt_pk_bf16_f32 v64, v64, v65
  v_cvt_pk_bf16_f32 v65, v66, v67
  v_min_u32 v64, -2, v64
  v_min_u32 v65, -2, v65
  buffer_store_dwordx2 v[64:65], v5, s[4:7], s42 offen sc1
c_hop2_31:
  s_barrier
  s_nop 15
  s_nop 13
  s_cmp_eq_u32 s95, 0
  s_cbranch_scc1 c_loop_28
  s_mov_b32 s29, 0
c_fk_46:
  buffer_load_dwordx4 v[16:19], v8, s[4:7], s42 offen sc1
  buffer_load_dwordx4 v[20:23], v8, s[4:7], s43 offen sc1
  s_add_u32 s29, s29, 1
  s_cmp_gt_u32 s29, 1048576
  s_cbranch_scc1 c_fail_34
  s_waitcnt vmcnt(0)
  v_max3_u32 v7, v16, v17, v18
  v_max3_u32 v7, v19, v20, v7
  v_max3_u32 v7, v21, v22, v7
  v_max_u32 v7, v7, v23
  v_cmp_eq_u32 vcc, -1, v7
  s_cbranch_vccnz c_fk_46
  s_lshl_b32 s42, s22, 13
  s_add_u32 s42, s42, 244842496
  s_add_u32 s43, s42, 4096
  s_mov_b32 s95, 0
  s_branch c_loop_28
c_kvs_41:
  s_cmp_ge_u32 s22, 63
  s_cbranch_scc1 c_kvr_42
  s_mov_b32 s29, 0
c_gw_47:
  buffer_load_dword v7, off, s[4:7], s63 sc1
  s_add_u32 s29, s29, 1
  s_cmp_gt_u32 s29, 1048576
  s_cbranch_scc1 c_fail_34
  s_waitcnt vmcnt(0)
  v_readfirstlane_b32 s65, v7
  s_cmp_eq_u32 s65, 0
  s_cbranch_scc1 c_gw_47
  s_and_b32 s65, s65, s93
  s_cbranch_scc1 c_kvx_49
  s_mov_b32 s95, 1
  s_add_u32 s96, s23, 33554432
  s_add_u32 s92, s63, 262144
c_kvw_48:
  buffer_load_dword v7, off, s[4:7], s92 sc1
  s_add_u32 s29, s29, 1
  s_cmp_gt_u32 s29, 1048576
  s_cbranch_scc1 c_fail_34
  s_waitcnt vmcnt(0)
  v_readfirstlane_b32 s65, v7
  s_cmp_eq_u32 s65, 0
  s_cbranch_scc1 c_kvw_48
c_kvx_49:
  s_branch c_kvr_42
c_last_35:
  s_add_u32 s64, s64, 2048
  v_mov_b32 v7, 1
  s_waitcnt vmcnt(0)
  s_barrier
  s_mov_b64 exec, 1
  buffer_store_dword v7, off, s[4:7], s64 sc1
  s_mov_b64 exec, -1
  s_branch c_fail_34
c_oth_43:
  ds_read_b128 v[24:27], v1 offset:0
  ds_read_b128 v[28:31], v1 offset:1024
  ds_read_b128 v[32:35], v1 offset:2048
  ds_read_b128 v[36:39], v1 offset:3072
  ds_read_b128 v[40:43], v1 offset:4096
  ds_read_b128 v[44:47], v1 offset:5120
  ds_read_b128 v[72:75], v1 offset:6144
  ds_read_b128 v[76:79], v1 offset:7168
  ds_read_b128 v[80:83], v1 offset:8192
  ds_read_b128 v[84:87], v1 offset:9216
  ds_read_b128 v[88:91], v1 offset:10240
  ds_read_b128 v[92:95], v1 offset:11264
  ds_read_b128 v[96:99], v1 offset:12288
  ds_read_b128 v[100:103], v1 offset:13312
  ds_read_b128 v[104:107], v1 offset:14336
  ds_read_b128 v[108:111], v1 offset:15360
  ds_read_b128 v[112:115], v1 offset:16384
  ds_read_b128 v[116:119], v1 offset:17408
  ds_read_b128 v[120:123], v1 offset:18432
  ds_read_b128 v[124:127], v1 offset:19456
  v_mov_b64 v[64:65], 0
  v_mov_b64 v[66:67], 0
  v_mov_b64 v[68:69], 0
  v_mov_b64 v[70:71], 0
  s_branch c_hop2_31
c_w0a_39:
  s_waitcnt vmcnt(3)
  ds_read_b128 v[24:27], v1 offset:0
  ds_read_b128 v[28:31], v1 offset:1024
  ds_read_b128 v[32:35], v1 offset:2048
  ds_read_b128 v[36:39], v1 offset:3072
  ds_read_b128 v[40:43], v1 offset:4096
  ds_read_b128 v[44:47], v1 offset:5120
  ds_read_b128 v[72:75], v1 offset:6144
  ds_read_b128 v[76:79], v1 offset:7168
  ds_read_b128 v[80:83], v1 offset:8192
  ds_read_b128 v[84:87], v1 offset:9216
  buffer_load_dwordx4 v[16:19], v8, s[4:7], s42 offen sc1
  buffer_load_dwordx4 v[20:23], v8, s[4:7], s43 offen sc1
  ds_read_b128 v[88:91], v1 offset:10240
  ds_read_b128 v[92:95], v1 offset:11264
  ds_read_b128 v[96:99], v1 offset:12288
  ds_read_b128 v[100:103], v1 offset:13312
  ds_read_b128 v[104:107], v1 offset:14336
  ds_read_b128 v[108:111], v1 offset:15360
  ds_read_b128 v[112:115], v1 offset:16384
  ds_read_b128 v[116:119], v1 offset:17408
  ds_read_b128 v[120:123], v1 offset:18432
  ds_read_b128 v[124:127], v1 offset:19456
  buffer_load_dwordx4 v[16:19], v8, s[4:7], s42 offen sc1
  buffer_load_dwordx4 v[20:23], v8, s[4:7], s43 offen sc1
  v_mov_b64 v[64:65], 0
  v_mov_b64 v[66:67], 0
  v_mov_b64 v[68:69], 0
  v_mov_b64 v[70:71], 0
  s_branch c_w0b_40
c_p1r_44:
  buffer_load_dwordx4 v[16:19], v0, s[4:7], s38 offen offset:0 sc1
  buffer_load_dwordx4 v[20:23], v0, s[4:7], s38 offen offset:1024 sc1
  buffer_load_dwordx4 v[24:27], v0, s[4:7], s38 offen offset:2048 sc1
  buffer_load_dwordx4 v[28:31], v0, s[4:7], s38 offen offset:3072 sc1
  buffer_load_dwordx4 v[32:35], v0, s[4:7], s39 offen offset:0 sc1
  buffer_load_dwordx4 v[36:39], v0, s[4:7], s39 offen offset:1024 sc1
  buffer_load_dwordx4 v[40:43], v0, s[4:7], s39 offen offset:2048 sc1
  buffer_load_dwordx4 v[44:47], v0, s[4:7], s39 offen offset:3072 sc1
  s_add_u32 s46, s46, 1
  s_waitcnt vmcnt(15)
  v_mfma_f32_16x16x32_bf16 v[64:67], v[72:75], v[68:71], 0
  v_xor_b32 v7, s3, v72
  s_waitcnt vmcnt(14)
  v_mfma_f32_16x16x32_bf16 v[64:67], v[76:79], v[68:71], v[64:67]
  v_bitop3_b32 v7, v7, v76, s3 bitop3:0xf6
  s_waitcnt vmcnt(13)
  v_mfma_f32_16x16x32_bf16 v[64:67], v[80:83], v[68:71], v[64:67]
  v_bitop3_b32 v7, v7, v80, s3 bitop3:0xf6
  s_waitcnt vmcnt(12)
  v_mfma_f32_16x16x32_bf16 v[64:67], v[84:87], v[68:71], v[64:67]
  v_bitop3_b32 v7, v7, v84, s3 bitop3:0xf6
  s_waitcnt vmcnt(11)
  v_mfma_f32_16x16x32_bf16 v[64:67], v[88:91], v[68:71], v[64:67]
  v_bitop3_b32 v7, v7, v88, s3 bitop3:0xf6
  s_waitcnt vmcnt(10)
  v_mfma_f32_16x16x32_bf16 v[64:67], v[92:95], v[68:71], v[64:67]
  v_bitop3_b32 v7, v7, v92, s3 bitop3:0xf6
  s_waitcnt vmcnt(9)
  v_mfma_f32_16x16x32_bf16 v[64:67], v[96:99], v[68:71], v[64:67]
  v_bitop3_b32 v7, v7, v96, s3 bitop3:0xf6
  s_waitcnt vmcnt(8)
  v_mfma_f32_16x16x32_bf16 v[64:67], v[100:103], v[68:71], v[64:67]
  v_bitop3_b32 v7, v7, v100, s3 bitop3:0xf6
  v_and_b32 v7, 1, v7
  v_cmp_ne_u32 vcc, 0, v7
  v_mov_b32 v7, 0
  v_mov_b32 v7, 0
  s_cbranch_vccnz c_p1s_50
  s_branch c_publ_45
c_p1s_50:
  buffer_load_dwordx4 v[72:75], v0, s[4:7], s38 offen offset:0 sc1
  buffer_load_dwordx4 v[76:79], v0, s[4:7], s38 offen offset:1024 sc1
  buffer_load_dwordx4 v[80:83], v0, s[4:7], s38 offen offset:2048 sc1
  buffer_load_dwordx4 v[84:87], v0, s[4:7], s38 offen offset:3072 sc1
  buffer_load_dwordx4 v[88:91], v0, s[4:7], s39 offen offset:0 sc1
  buffer_load_dwordx4 v[92:95], v0, s[4:7], s39 offen offset:1024 sc1
  buffer_load_dwordx4 v[96:99], v0, s[4:7], s39 offen offset:2048 sc1
  buffer_load_dwordx4 v[100:103], v0, s[4:7], s39 offen offset:3072 sc1
  s_add_u32 s28, s28, 1
  s_add_u32 s46, s46, 1
  s_cmp_gt_u32 s28, 1048576
  s_cbranch_scc1 c_fail_34
  s_waitcnt vmcnt(15)
  v_mfma_f32_16x16x32_bf16 v[64:67], v[16:19], v[68:71], 0
  v_xor_b32 v7, s3, v16
  s_waitcnt vmcnt(14)
  v_mfma_f32_16x16x32_bf16 v[64:67], v[20:23], v[68:71], v[64:67]
  v_bitop3_b32 v7, v7, v20, s3 bitop3:0xf6
  s_waitcnt vmcnt(13)
  v_mfma_f32_16x16x32_bf16 v[64:67], v[24:27], v[68:71], v[64:67]
  v_bitop3_b32 v7, v7, v24, s3 bitop3:0xf6
  s_waitcnt vmcnt(12)
  v_mfma_f32_16x16x32_bf16 v[64:67], v[28:31], v[68:71], v[64:67]
  v_bitop3_b32 v7, v7, v28, s3 bitop3:0xf6
  s_waitcnt vmcnt(11)
  v_mfma_f32_16x16x32_bf16 v[64:67], v[32:35], v[68:71], v[64:67]
  v_bitop3_b32 v7, v7, v32, s3 bitop3:0xf6
  s_waitcnt vmcnt(10)
  v_mfma_f32_16x16x32_bf16 v[64:67], v[36:39], v[68:71], v[64:67]
  v_bitop3_b32 v7, v7, v36, s3 bitop3:0xf6
  s_waitcnt vmcnt(9)
  v_mfma_f32_16x16x32_bf16 v[64:67], v[40:43], v[68:71], v[64:67]
  v_bitop3_b32 v7, v7, v40, s3 bitop3:0xf6
  s_waitcnt vmcnt(8)
  v_mfma_f32_16x16x32_bf16 v[64:67], v[44:47], v[68:71], v[64:67]
  v_bitop3_b32 v7, v7, v44, s3 bitop3:0xf6
  v_and_b32 v7, 1, v7
  v_cmp_ne_u32 vcc, 0, v7
  v_mov_b32 v7, 0
  v_mov_b32 v7, 0
  s_cbranch_vccnz c_p1r_44
  s_branch c_publ_45
c_retry_29:
  buffer_load_dwordx4 v[16:19], v8, s[4:7], s42 offen sc1
  buffer_load_dwordx4 v[20:23], v8, s[4:7], s43 offen sc1
  s_add_u32 s28, s28, 1
  s_add_u32 s47, s47, 1
  s_cmp_gt_u32 s28, 1048576
  s_cbranch_scc1 c_fail_34
  v_mov_b64 v[48:49], 0
  v_mov_b64 v[50:51], 0
  v_mov_b64 v[52:53], 0
  v_mov_b64 v[54:55], 0
  v_mov_b64 v[56:57], 0
  v_mov_b64 v[58:59], 0
  s_waitcnt vmcnt(4)
  v_max3_u32 v7, v16, v17, v18
  v_max_u32 v7, v7, v19
  ds_write_b128 v8, v[16:19] offset:0
  v_smfmac_f32_16x16x64_bf16 v[48:51], v[16:19], v[24:31], v6
  s_branch c_got_30
c_fb_32:
  v_max3_f32 v7, v48, v49, v50
  v_max_f32 v7, v51, v7
  s_mov_b64 exec, s[18:19]
  v_max3_f32 v7, v16, v17, v7
  s_mov_b64 exec, -1
  s_nop 0
  v_max_f32_dpp v7, v7, v7 quad_perm:[2,3,0,1] row_mask:0xf bank_mask:0xf
  v_mov_b32 v24, v7
  s_nop 0
  s_nop 0
  v_permlane16_swap_b32 v7, v24
  v_max_f32 v7, v7, v24
  v_mov_b32 v24, v7
  s_nop 0
  s_nop 0
  v_permlane32_swap_b32 v7, v24
  v_max_f32 v7, v7, v24
  v_sub_f32 v24, v48, v7
  v_sub_f32 v25, v49, v7
  v_sub_f32 v26, v50, v7
  v_sub_f32 v27, v51, v7
  v_sub_f32 v28, v16, v7
  v_sub_f32 v29, v17, v7
  v_exp_f32 v24, v24
  v_exp_f32 v25, v25
  v_exp_f32 v26, v26
  v_exp_f32 v27, v27
  v_exp_f32 v28, v28
  v_exp_f32 v29, v29
  v_cvt_pk_bf16_f32 v24, v24, v25
  v_cvt_pk_bf16_f32 v25, v26, v27
  v_cvt_pk_bf16_f32 v28, v28, v29
  v_cndmask_b32 v72, v24, 0, s[18:19]
  v_cndmask_b32 v73, v25, 0, s[18:19]
  v_cndmask_b32 v74, 0, v24, s[18:19]
  v_cndmask_b32 v75, 0, v25, s[18:19]
  v_cndmask_b32 v77, 0, v28, s[18:19]
  v_cndmask_b32 v78, 0, v28, s[18:19]
  v_mfma_f32_16x16x32_bf16 v[60:63], v[72:75], v[20:23], 0
  v_mfma_f32_16x16x32_bf16 v[52:55], v[72:75], v[80:83], 0
  v_mfma_f32_16x16x32_bf16 v[56:59], v[72:75], v[84:87], 0
  s_nop 5
  v_mfma_f32_16x16x16_bf16 v[60:63], v[76:77], v[20:21], v[60:63]
  v_mfma_f32_16x16x16_bf16 v[52:55], v[78:79], v[66:67], v[52:55]
  v_mfma_f32_16x16x16_bf16 v[56:59], v[76:77], v[66:67], v[56:59]
  s_nop 7
  v_add_f32 v60, v60, v62
  v_add_f32 v61, v61, v63
  s_branch c_fbr_33
c_fail_34:
  s_endpgm
L_qkv:
  s_sub_u32 s26, s91, 3
  s_lshl_b32 s26, s26, 4
  s_and_b32 s27, s90, 31
  s_add_u32 s26, s26, s27
  s_cmp_eq_u32 s91, 7
  s_cselect_b32 s27, 0, 16
  s_sub_u32 s26, s26, s27
  s_mul_i32 s16, s26, 171
  s_lshr_b32 s16, s16, 9
  s_mul_i32 s27, s16, 3
  s_sub_u32 s60, s26, s27
  v_and_b32 v19, 63, v0
  v_and_b32 v6, 15, v19
  v_lshrrev_b32 v7, 4, v19
  v_lshlrev_b32 v1, 2, v19
  v_lshlrev_b32 v0, 4, v19
  v_lshlrev_b32 v9, 5, v19
  s_mov_b32 s24, 0x3e0293ee
  s_lshl_b32 s57, s16, 2
  s_add_u32 s57, s57, s17
  s_mul_i32 s26, s17, 3
  s_add_u32 s26, s26, s60
  s_lshl_b32 s26, s26, 5
  s_add_u32 s26, s26, s16
  s_lshl_b32 s26, s26, 10
  s_add_u32 s26, s26, 247463936
  v_mov_b64 v[20:21], -1
  v_mov_b64 v[22:23], -1
  buffer_store_dwordx4 v[20:23], v0, s[4:7], s26 offen sc1
  s_add_u32 s26, s26, 393216
  buffer_store_dwordx4 v[20:23], v0, s[4:7], s26 offen sc1
  s_add_u32 s26, s26, 393216
  buffer_store_dwordx4 v[20:23], v0, s[4:7], s26 offen sc1
  s_add_u32 s26, s26, 393216
  buffer_store_dwordx4 v[20:23], v0, s[4:7], s26 offen sc1
  s_add_u32 s26, s26, 393216
  buffer_store_dwordx4 v[20:23], v0, s[4:7], s26 offen sc1
  s_add_u32 s26, s26, 393216
  buffer_store_dwordx4 v[20:23], v0, s[4:7], s26 offen sc1
  s_add_u32 s26, s26, 393216
  v_lshrrev_b32 v24, 1, v7
  v_xor_b32 v24, v24, v6
  v_lshlrev_b32 v24, 4, v24
  v_and_b32 v25, 31, v19
  v_lshl_add_u32 v24, v25, 10, v24
  v_xor_b32 v120, 0, v24
  v_xor_b32 v121, 32, v24
  v_xor_b32 v122, 64, v24
  v_xor_b32 v123, 96, v24
  v_xor_b32 v124, 128, v24
  v_xor_b32 v125, 160, v24
  v_xor_b32 v126, 192, v24
  v_xor_b32 v127, 224, v24
  v_and_b32 v24, 1, v7
  v_lshlrev_b32 v24, 10, v24
  v_lshl_add_u32 v24, v6, 4, v24
  v_lshrrev_b32 v25, 1, v7
  v_lshl_add_u32 v8, v25, 8, v24
  s_and_b32 s26, s17, 1
  s_lshl_b32 s26, s26, 7
  v_xor_b32 v24, s26, v0
  v_xor_b32 v12, 0, v24
  v_xor_b32 v13, 16, v24
  v_xor_b32 v14, 32, v24
  v_xor_b32 v15, 48, v24
  v_xor_b32 v16, 64, v24
  v_xor_b32 v17, 80, v24
  v_xor_b32 v18, 96, v24
  v_xor_b32 v19, 112, v24
  s_lshl_b32 s26, s17, 2
  s_add_u32 s26, s26, 162816
  v_mov_b32 v118, s26
  v_mov_b32 v119, 162816
  v_lshrrev_b32 v25, 8, v0
  v_and_b32 v20, 0xf0, v0
  v_lshlrev_b32 v21, 6, v25
  v_xor_b32 v20, v20, v21
  v_lshl_add_u32 v20, v25, 13, v20
  v_xor_b32 v21, 32, v20
  s_load_dwordx2 s[64:65], s[0:1], 24
  s_load_dwordx2 s[68:69], s[0:1], 32
  s_load_dwordx2 s[8:9], s[0:1], 16
  s_mov_b32 s10, 4194304
  s_mov_b32 s11, 0x20000
  s_mov_b32 s66, 4194304
  s_mov_b32 s67, 0x20000
  s_mov_b32 s70, 4194304
  s_mov_b32 s71, 0x20000
  v_lshrrev_b32 v25, 2, v6
  v_lshrrev_b32 v26, 1, v7
  v_lshl_add_u32 v27, v26, 3, v25
  v_lshlrev_b32 v27, 8, v27
  v_lshl_add_u32 v26, v25, 1, v26
  v_and_b32 v25, 1, v7
  v_xor_b32 v26, v26, v25
  s_lshl_b32 s26, s17, 1
  v_xor_b32 v26, s26, v26
  v_lshl_add_u32 v27, v26, 5, v27
  v_and_b32 v25, 3, v6
  v_lshl_add_u32 v22, v25, 3, v27
  v_add_u32 v23, 65536, v22
  v_add_u32 v24, 131072, v22
  s_lshl_b32 s28, s17, 13
  s_lshl_b32 s26, s17, 18
  s_lshl_b32 s27, s16, 8
  s_add_u32 s26, s26, s27
  s_waitcnt lgkmcnt(0)
  s_add_u32 s27, s26, 0
  s_add_u32 m0, s28, 0
  s_nop 0
  buffer_load_dwordx4 v20, s[64:67], s27 offen lds
  s_add_u32 m0, s28, 1024
  s_add_u32 s27, s27, 32768
  buffer_load_dwordx4 v20, s[64:67], s27 offen lds
  s_add_u32 m0, s28, 2048
  s_add_u32 s27, s27, 32768
  buffer_load_dwordx4 v21, s[64:67], s27 offen lds
  s_add_u32 m0, s28, 3072
  s_add_u32 s27, s27, 32768
  buffer_load_dwordx4 v21, s[64:67], s27 offen lds
  s_add_u32 m0, s28, 4096
  s_add_u32 s27, s27, 32768
  buffer_load_dwordx4 v20, s[64:67], s27 offen lds
  s_add_u32 m0, s28, 5120
  s_add_u32 s27, s27, 32768
  buffer_load_dwordx4 v20, s[64:67], s27 offen lds
  s_add_u32 m0, s28, 6144
  s_add_u32 s27, s27, 32768
  buffer_load_dwordx4 v21, s[64:67], s27 offen lds
  s_add_u32 m0, s28, 7168
  s_add_u32 s27, s27, 32768
  buffer_load_dwordx4 v21, s[64:67], s27 offen lds
  s_add_u32 s27, s26, 1048576
  s_add_u32 m0, s28, 32768
  s_nop 0
  buffer_load_dwordx4 v20, s[64:67], s27 offen lds
  s_add_u32 m0, s28, 33792
  s_add_u32 s27, s27, 32768
  buffer_load_dwordx4 v20, s[64:67], s27 offen lds
  s_add_u32 m0, s28, 34816
  s_add_u32 s27, s27, 32768
  buffer_load_dwordx4 v21, s[64:67], s27 offen lds
  s_add_u32 m0, s28, 35840
  s_add_u32 s27, s27, 32768
  buffer_load_dwordx4 v21, s[64:67], s27 offen lds
  s_add_u32 m0, s28, 36864
  s_add_u32 s27, s27, 32768
  buffer_load_dwordx4 v20, s[64:67], s27 offen lds
  s_add_u32 m0, s28, 37888
  s_add_u32 s27, s27, 32768
  buffer_load_dwordx4 v20, s[64:67], s27 offen lds
  s_add_u32 m0, s28, 38912
  s_add_u32 s27, s27, 32768
  buffer_load_dwordx4 v21, s[64:67], s27 offen lds
  s_add_u32 m0, s28, 39936
  s_add_u32 s27, s27, 32768
  buffer_load_dwordx4 v21, s[64:67], s27 offen lds
  s_add_u32 s27, s26, 2097152
  s_add_u32 m0, s28, 65536
  s_nop 0
  buffer_load_dwordx4 v20, s[64:67], s27 offen lds
  s_add_u32 m0, s28, 66560
  s_add_u32 s27, s27, 32768
  buffer_load_dwordx4 v20, s[64:67], s27 offen lds
  s_add_u32 m0, s28, 67584
  s_add_u32 s27, s27, 32768
  buffer_load_dwordx4 v21, s[64:67], s27 offen lds
  s_add_u32 m0, s28, 68608
  s_add_u32 s27, s27, 32768
  buffer_load_dwordx4 v21, s[64:67], s27 offen lds
  s_add_u32 m0, s28, 69632
  s_add_u32 s27, s27, 32768
  buffer_load_dwordx4 v20, s[64:67], s27 offen lds
  s_add_u32 m0, s28, 70656
  s_add_u32 s27, s27, 32768
  buffer_load_dwordx4 v20, s[64:67], s27 offen lds
  s_add_u32 m0, s28, 71680
  s_add_u32 s27, s27, 32768
  buffer_load_dwordx4 v21, s[64:67], s27 offen lds
  s_add_u32 m0, s28, 72704
  s_add_u32 s27, s27, 32768
  buffer_load_dwordx4 v21, s[64:67], s27 offen lds
  s_add_u32 s27, s26, 3145728
  s_add_u32 m0, s28, 98304
  s_nop 0
  buffer_load_dwordx4 v20, s[64:67], s27 offen lds
  s_add_u32 m0, s28, 99328
  s_add_u32 s27, s27, 32768
  buffer_load_dwordx4 v20, s[64:67], s27 offen lds
  s_add_u32 m0, s28, 100352
  s_add_u32 s27, s27, 32768
  buffer_load_dwordx4 v21, s[64:67], s27 offen lds
  s_add_u32 m0, s28, 101376
  s_add_u32 s27, s27, 32768
  buffer_load_dwordx4 v21, s[64:67], s27 offen lds
  s_add_u32 m0, s28, 102400
  s_add_u32 s27, s27, 32768
  buffer_load_dwordx4 v20, s[64:67], s27 offen lds
  s_add_u32 m0, s28, 103424
  s_add_u32 s27, s27, 32768
  buffer_load_dwordx4 v20, s[64:67], s27 offen lds
  s_add_u32 m0, s28, 104448
  s_add_u32 s27, s27, 32768
  buffer_load_dwordx4 v21, s[64:67], s27 offen lds
  s_add_u32 m0, s28, 105472
  s_add_u32 s27, s27, 32768
  buffer_load_dwordx4 v21, s[64:67], s27 offen lds
  s_add_u32 s27, s26, 0
  s_add_u32 m0, s28, 131072
  s_nop 0
  buffer_load_dwordx4 v20, s[68:71], s27 offen lds
  s_add_u32 m0, s28, 132096
  s_add_u32 s27, s27, 32768
  buffer_load_dwordx4 v20, s[68:71], s27 offen lds
  s_add_u32 m0, s28, 133120
  s_add_u32 s27, s27, 32768
  buffer_load_dwordx4 v21, s[68:71], s27 offen lds
  s_add_u32 m0, s28, 134144
  s_add_u32 s27, s27, 32768
  buffer_load_dwordx4 v21, s[68:71], s27 offen lds
  s_add_u32 m0, s28, 135168
  s_add_u32 s27, s27, 32768
  buffer_load_dwordx4 v20, s[68:71], s27 offen lds
  s_add_u32 m0, s28, 136192
  s_add_u32 s27, s27, 32768
  buffer_load_dwordx4 v20, s[68:71], s27 offen lds
  s_add_u32 m0, s28, 137216
  s_add_u32 s27, s27, 32768
  buffer_load_dwordx4 v21, s[68:71], s27 offen lds
  s_add_u32 m0, s28, 138240
  s_add_u32 s27, s27, 32768
  buffer_load_dwordx4 v21, s[68:71], s27 offen lds
  s_waitcnt vmcnt(32)
  s_barrier
  s_cmp_lg_u32 s17, 0
  s_cbranch_scc1 g_ar_51
  s_lshl_b32 s36, s89, 3
  s_lshl_b64 s[36:37], 1, s36
  v_mov_b32 v32, 160
  v_mov_b32 v30, s36
  v_mov_b32 v31, s37
  s_mov_b64 exec, 1
  global_atomic_add_x2 v32, v[30:31], s[12:13]
  s_mov_b64 exec, -1
g_ar_51:
  ds_read_b64_tr_b16 v[128:129], v22 offset:0
  ds_read_b64_tr_b16 v[130:131], v22 offset:1024
  ds_read_b64_tr_b16 v[132:133], v22 offset:4096
  ds_read_b64_tr_b16 v[134:135], v22 offset:5120
  ds_read_b64_tr_b16 v[136:137], v22 offset:8192
  ds_read_b64_tr_b16 v[138:139], v22 offset:9216
  ds_read_b64_tr_b16 v[140:141], v22 offset:12288
  ds_read_b64_tr_b16 v[142:143], v22 offset:13312
  ds_read_b64_tr_b16 v[144:145], v22 offset:16384
  ds_read_b64_tr_b16 v[146:147], v22 offset:17408
  ds_read_b64_tr_b16 v[148:149], v22 offset:20480
  ds_read_b64_tr_b16 v[150:151], v22 offset:21504
  ds_read_b64_tr_b16 v[152:153], v22 offset:24576
  ds_read_b64_tr_b16 v[154:155], v22 offset:25600
  ds_read_b64_tr_b16 v[156:157], v22 offset:28672
  ds_read_b64_tr_b16 v[158:159], v22 offset:29696
  s_waitcnt lgkmcnt(0)
  s_barrier
  s_add_u32 s27, s26, 1048576
  s_add_u32 m0, s28, 0
  s_nop 0
  buffer_load_dwordx4 v20, s[68:71], s27 offen lds
  s_add_u32 m0, s28, 1024
  s_add_u32 s27, s27, 32768
  buffer_load_dwordx4 v20, s[68:71], s27 offen lds
  s_add_u32 m0, s28, 2048
  s_add_u32 s27, s27, 32768
  buffer_load_dwordx4 v21, s[68:71], s27 offen lds
  s_add_u32 m0, s28, 3072
  s_add_u32 s27, s27, 32768
  buffer_load_dwordx4 v21, s[68:71], s27 offen lds
  s_add_u32 m0, s28, 4096
  s_add_u32 s27, s27, 32768
  buffer_load_dwordx4 v20, s[68:71], s27 offen lds
  s_add_u32 m0, s28, 5120
  s_add_u32 s27, s27, 32768
  buffer_load_dwordx4 v20, s[68:71], s27 offen lds
  s_add_u32 m0, s28, 6144
  s_add_u32 s27, s27, 32768
  buffer_load_dwordx4 v21, s[68:71], s27 offen lds
  s_add_u32 m0, s28, 7168
  s_add_u32 s27, s27, 32768
  buffer_load_dwordx4 v21, s[68:71], s27 offen lds
  s_waitcnt vmcnt(32)
  s_barrier
  ds_read_b64_tr_b16 v[160:161], v22 offset:32768
  ds_read_b64_tr_b16 v[162:163], v22 offset:33792
  ds_read_b64_tr_b16 v[164:165], v22 offset:36864
  ds_read_b64_tr_b16 v[166:167], v22 offset:37888
  ds_read_b64_tr_b16 v[168:169], v22 offset:40960
  ds_read_b64_tr_b16 v[170:171], v22 offset:41984
  ds_read_b64_tr_b16 v[172:173], v22 offset:45056
  ds_read_b64_tr_b16 v[174:175], v22 offset:46080
  ds_read_b64_tr_b16 v[176:177], v22 offset:49152
  ds_read_b64_tr_b16 v[178:179], v22 offset:50176
  ds_read_b64_tr_b16 v[180:181], v22 offset:53248
  ds_read_b64_tr_b16 v[182:183], v22 offset:54272
  ds_read_b64_tr_b16 v[184:185], v22 offset:57344
  ds_read_b64_tr_b16 v[186:187], v22 offset:58368
  ds_read_b64_tr_b16 v[188:189], v22 offset:61440
  ds_read_b64_tr_b16 v[190:191], v22 offset:62464
  s_waitcnt lgkmcnt(0)
  s_barrier
  s_add_u32 s27, s26, 2097152
  s_add_u32 m0, s28, 32768
  s_nop 0
  buffer_load_dwordx4 v20, s[68:71], s27 offen lds
  s_add_u32 m0, s28, 33792
  s_add_u32 s27, s27, 32768
  buffer_load_dwordx4 v20, s[68:71], s27 offen lds
  s_add_u32 m0, s28, 34816
  s_add_u32 s27, s27, 32768
  buffer_load_dwordx4 v21, s[68:71], s27 offen lds
  s_add_u32 m0, s28, 35840
  s_add_u32 s27, s27, 32768
  buffer_load_dwordx4 v21, s[68:71], s27 offen lds
  s_add_u32 m0, s28, 36864
  s_add_u32 s27, s27, 32768
  buffer_load_dwordx4 v20, s[68:71], s27 offen lds
  s_add_u32 m0, s28, 37888
  s_add_u32 s27, s27, 32768
  buffer_load_dwordx4 v20, s[68:71], s27 offen lds
  s_add_u32 m0, s28, 38912
  s_add_u32 s27, s27, 32768
  buffer_load_dwordx4 v21, s[68:71], s27 offen lds
  s_add_u32 m0, s28, 39936
  s_add_u32 s27, s27, 32768
  buffer_load_dwordx4 v21, s[68:71], s27 offen lds
  s_waitcnt vmcnt(32)
  s_barrier
  ds_read_b64_tr_b16 v[192:193], v23 offset:0
  ds_read_b64_tr_b16 v[194:195], v23 offset:1024
  ds_read_b64_tr_b16 v[196:197], v23 offset:4096
  ds_read_b64_tr_b16 v[198:199], v23 offset:5120
  ds_read_b64_tr_b16 v[200:201], v23 offset:8192
  ds_read_b64_tr_b16 v[202:203], v23 offset:9216
  ds_read_b64_tr_b16 v[204:205], v23 offset:12288
  ds_read_b64_tr_b16 v[206:207], v23 offset:13312
  ds_read_b64_tr_b16 v[208:209], v23 offset:16384
  ds_read_b64_tr_b16 v[210:211], v23 offset:17408
  ds_read_b64_tr_b16 v[212:213], v23 offset:20480
  ds_read_b64_tr_b16 v[214:215], v23 offset:21504
  ds_read_b64_tr_b16 v[216:217], v23 offset:24576
  ds_read_b64_tr_b16 v[218:219], v23 offset:25600
  ds_read_b64_tr_b16 v[220:221], v23 offset:28672
  ds_read_b64_tr_b16 v[222:223], v23 offset:29696
  s_waitcnt lgkmcnt(0)
  s_barrier
  s_add_u32 s27, s26, 3145728
  s_add_u32 m0, s28, 65536
  s_nop 0
  buffer_load_dwordx4 v20, s[68:71], s27 offen lds
  s_add_u32 m0, s28, 66560
  s_add_u32 s27, s27, 32768
  buffer_load_dwordx4 v20, s[68:71], s27 offen lds
  s_add_u32 m0, s28, 67584
  s_add_u32 s27, s27, 32768
  buffer_load_dwordx4 v21, s[68:71], s27 offen lds
  s_add_u32 m0, s28, 68608
  s_add_u32 s27, s27, 32768
  buffer_load_dwordx4 v21, s[68:71], s27 offen lds
  s_add_u32 m0, s28, 69632
  s_add_u32 s27, s27, 32768
  buffer_load_dwordx4 v20, s[68:71], s27 offen lds
  s_add_u32 m0, s28, 70656
  s_add_u32 s27, s27, 32768
  buffer_load_dwordx4 v20, s[68:71], s27 offen lds
  s_add_u32 m0, s28, 71680
  s_add_u32 s27, s27, 32768
  buffer_load_dwordx4 v21, s[68:71], s27 offen lds
  s_add_u32 m0, s28, 72704
  s_add_u32 s27, s27, 32768
  buffer_load_dwordx4 v21, s[68:71], s27 offen lds
  s_waitcnt vmcnt(32)
  s_barrier
  ds_read_b64_tr_b16 v[224:225], v23 offset:32768
  ds_read_b64_tr_b16 v[226:227], v23 offset:33792
  ds_read_b64_tr_b16 v[228:229], v23 offset:36864
  ds_read_b64_tr_b16 v[230:231], v23 offset:37888
  ds_read_b64_tr_b16 v[232:233], v23 offset:40960
  ds_read_b64_tr_b16 v[234:235], v23 offset:41984
  ds_read_b64_tr_b16 v[236:237], v23 offset:45056
  ds_read_b64_tr_b16 v[238:239], v23 offset:46080
  ds_read_b64_tr_b16 v[240:241], v23 offset:49152
  ds_read_b64_tr_b16 v[242:243], v23 offset:50176
  ds_read_b64_tr_b16 v[244:245], v23 offset:53248
  ds_read_b64_tr_b16 v[246:247], v23 offset:54272
  ds_read_b64_tr_b16 v[248:249], v23 offset:57344
  ds_read_b64_tr_b16 v[250:251], v23 offset:58368
  ds_read_b64_tr_b16 v[252:253], v23 offset:61440
  ds_read_b64_tr_b16 v[254:255], v23 offset:62464
  s_waitcnt lgkmcnt(0)
  s_barrier
  s_add_u32 s27, s26, 0
  s_add_u32 m0, s28, 98304
  s_nop 0
  buffer_load_dwordx4 v20, s[8:11], s27 offen lds
  s_add_u32 m0, s28, 99328
  s_add_u32 s27, s27, 32768
  buffer_load_dwordx4 v20, s[8:11], s27 offen lds
  s_add_u32 m0, s28, 100352
  s_add_u32 s27, s27, 32768
  buffer_load_dwordx4 v21, s[8:11], s27 offen lds
  s_add_u32 m0, s28, 101376
  s_add_u32 s27, s27, 32768
  buffer_load_dwordx4 v21, s[8:11], s27 offen lds
  s_add_u32 m0, s28, 102400
  s_add_u32 s27, s27, 32768
  buffer_load_dwordx4 v20, s[8:11], s27 offen lds
  s_add_u32 m0, s28, 103424
  s_add_u32 s27, s27, 32768
  buffer_load_dwordx4 v20, s[8:11], s27 offen lds
  s_add_u32 m0, s28, 104448
  s_add_u32 s27, s27, 32768
  buffer_load_dwordx4 v21, s[8:11], s27 offen lds
  s_add_u32 m0, s28, 105472
  s_add_u32 s27, s27, 32768
  buffer_load_dwordx4 v21, s[8:11], s27 offen lds
  s_waitcnt vmcnt(32)
  s_barrier
  ds_read_b64_tr_b16 a[0:1], v24 offset:0
  ds_read_b64_tr_b16 a[2:3], v24 offset:1024
  ds_read_b64_tr_b16 a[4:5], v24 offset:4096
  ds_read_b64_tr_b16 a[6:7], v24 offset:5120
  ds_read_b64_tr_b16 a[8:9], v24 offset:8192
  ds_read_b64_tr_b16 a[10:11], v24 offset:9216
  ds_read_b64_tr_b16 a[12:13], v24 offset:12288
  ds_read_b64_tr_b16 a[14:15], v24 offset:13312
  ds_read_b64_tr_b16 a[16:17], v24 offset:16384
  ds_read_b64_tr_b16 a[18:19], v24 offset:17408
  ds_read_b64_tr_b16 a[20:21], v24 offset:20480
  ds_read_b64_tr_b16 a[22:23], v24 offset:21504
  ds_read_b64_tr_b16 a[24:25], v24 offset:24576
  ds_read_b64_tr_b16 a[26:27], v24 offset:25600
  ds_read_b64_tr_b16 a[28:29], v24 offset:28672
  ds_read_b64_tr_b16 a[30:31], v24 offset:29696
  s_waitcnt lgkmcnt(0)
  s_barrier
  s_add_u32 s27, s26, 1048576
  s_add_u32 m0, s28, 131072
  s_nop 0
  buffer_load_dwordx4 v20, s[8:11], s27 offen lds
  s_add_u32 m0, s28, 132096
  s_add_u32 s27, s27, 32768
  buffer_load_dwordx4 v20, s[8:11], s27 offen lds
  s_add_u32 m0, s28, 133120
  s_add_u32 s27, s27, 32768
  buffer_load_dwordx4 v21, s[8:11], s27 offen lds
  s_add_u32 m0, s28, 134144
  s_add_u32 s27, s27, 32768
  buffer_load_dwordx4 v21, s[8:11], s27 offen lds
  s_add_u32 m0, s28, 135168
  s_add_u32 s27, s27, 32768
  buffer_load_dwordx4 v20, s[8:11], s27 offen lds
  s_add_u32 m0, s28, 136192
  s_add_u32 s27, s27, 32768
  buffer_load_dwordx4 v20, s[8:11], s27 offen lds
  s_add_u32 m0, s28, 137216
  s_add_u32 s27, s27, 32768
  buffer_load_dwordx4 v21, s[8:11], s27 offen lds
  s_add_u32 m0, s28, 138240
  s_add_u32 s27, s27, 32768
  buffer_load_dwordx4 v21, s[8:11], s27 offen lds
  s_waitcnt vmcnt(32)
  s_barrier
  ds_read_b64_tr_b16 a[32:33], v22 offset:0
  ds_read_b64_tr_b16 a[34:35], v22 offset:1024
  ds_read_b64_tr_b16 a[36:37], v22 offset:4096
  ds_read_b64_tr_b16 a[38:39], v22 offset:5120
  ds_read_b64_tr_b16 a[40:41], v22 offset:8192
  ds_read_b64_tr_b16 a[42:43], v22 offset:9216
  ds_read_b64_tr_b16 a[44:45], v22 offset:12288
  ds_read_b64_tr_b16 a[46:47], v22 offset:13312
  ds_read_b64_tr_b16 a[48:49], v22 offset:16384
  ds_read_b64_tr_b16 a[50:51], v22 offset:17408
  ds_read_b64_tr_b16 a[52:53], v22 offset:20480
  ds_read_b64_tr_b16 a[54:55], v22 offset:21504
  ds_read_b64_tr_b16 a[56:57], v22 offset:24576
  ds_read_b64_tr_b16 a[58:59], v22 offset:25600
  ds_read_b64_tr_b16 a[60:61], v22 offset:28672
  ds_read_b64_tr_b16 a[62:63], v22 offset:29696
  s_waitcnt lgkmcnt(0)
  s_barrier
  s_add_u32 s27, s26, 2097152
  s_add_u32 m0, s28, 0
  s_nop 0
  buffer_load_dwordx4 v20, s[8:11], s27 offen lds
  s_add_u32 m0, s28, 1024
  s_add_u32 s27, s27, 32768
  buffer_load_dwordx4 v20, s[8:11], s27 offen lds
  s_add_u32 m0, s28, 2048
  s_add_u32 s27, s27, 32768
  buffer_load_dwordx4 v21, s[8:11], s27 offen lds
  s_add_u32 m0, s28, 3072
  s_add_u32 s27, s27, 32768
  buffer_load_dwordx4 v21, s[8:11], s27 offen lds
  s_add_u32 m0, s28, 4096
  s_add_u32 s27, s27, 32768
  buffer_load_dwordx4 v20, s[8:11], s27 offen lds
  s_add_u32 m0, s28, 5120
  s_add_u32 s27, s27, 32768
  buffer_load_dwordx4 v20, s[8:11], s27 offen lds
  s_add_u32 m0, s28, 6144
  s_add_u32 s27, s27, 32768
  buffer_load_dwordx4 v21, s[8:11], s27 offen lds
  s_add_u32 m0, s28, 7168
  s_add_u32 s27, s27, 32768
  buffer_load_dwordx4 v21, s[8:11], s27 offen lds
  s_waitcnt vmcnt(32)
  s_barrier
  ds_read_b64_tr_b16 a[64:65], v22 offset:32768
  ds_read_b64_tr_b16 a[66:67], v22 offset:33792
  ds_read_b64_tr_b16 a[68:69], v22 offset:36864
  ds_read_b64_tr_b16 a[70:71], v22 offset:37888
  ds_read_b64_tr_b16 a[72:73], v22 offset:40960
  ds_read_b64_tr_b16 a[74:75], v22 offset:41984
  ds_read_b64_tr_b16 a[76:77], v22 offset:45056
  ds_read_b64_tr_b16 a[78:79], v22 offset:46080
  ds_read_b64_tr_b16 a[80:81], v22 offset:49152
  ds_read_b64_tr_b16 a[82:83], v22 offset:50176
  ds_read_b64_tr_b16 a[84:85], v22 offset:53248
  ds_read_b64_tr_b16 a[86:87], v22 offset:54272
  ds_read_b64_tr_b16 a[88:89], v22 offset:57344
  ds_read_b64_tr_b16 a[90:91], v22 offset:58368
  ds_read_b64_tr_b16 a[92:93], v22 offset:61440
  ds_read_b64_tr_b16 a[94:95], v22 offset:62464
  s_waitcnt lgkmcnt(0)
  s_barrier
  s_add_u32 s27, s26, 3145728
  s_add_u32 m0, s28, 32768
  s_nop 0
  buffer_load_dwordx4 v20, s[8:11], s27 offen lds
  s_add_u32 m0, s28, 33792
  s_add_u32 s27, s27, 32768
  buffer_load_dwordx4 v20, s[8:11], s27 offen lds
  s_add_u32 m0, s28, 34816
  s_add_u32 s27, s27, 32768
  buffer_load_dwordx4 v21, s[8:11], s27 offen lds
  s_add_u32 m0, s28, 35840
  s_add_u32 s27, s27, 32768
  buffer_load_dwordx4 v21, s[8:11], s27 offen lds
  s_add_u32 m0, s28, 36864
  s_add_u32 s27, s27, 32768
  buffer_load_dwordx4 v20, s[8:11], s27 offen lds
  s_add_u32 m0, s28, 37888
  s_add_u32 s27, s27, 32768
  buffer_load_dwordx4 v20, s[8:11], s27 offen lds
  s_add_u32 m0, s28, 38912
  s_add_u32 s27, s27, 32768
  buffer_load_dwordx4 v21, s[8:11], s27 offen lds
  s_add_u32 m0, s28, 39936
  s_add_u32 s27, s27, 32768
  buffer_load_dwordx4 v21, s[8:11], s27 offen lds
  s_waitcnt vmcnt(32)
  s_barrier
  ds_read_b64_tr_b16 a[96:97], v23 offset:0
  ds_read_b64_tr_b16 a[98:99], v23 offset:1024
  ds_read_b64_tr_b16 a[100:101], v23 offset:4096
  ds_read_b64_tr_b16 a[102:103], v23 offset:5120
  ds_read_b64_tr_b16 a[104:105], v23 offset:8192
  ds_read_b64_tr_b16 a[106:107], v23 offset:9216
  ds_read_b64_tr_b16 a[108:109], v23 offset:12288
  ds_read_b64_tr_b16 a[110:111], v23 offset:13312
  ds_read_b64_tr_b16 a[112:113], v23 offset:16384
  ds_read_b64_tr_b16 a[114:115], v23 offset:17408
  ds_read_b64_tr_b16 a[116:117], v23 offset:20480
  ds_read_b64_tr_b16 a[118:119], v23 offset:21504
  ds_read_b64_tr_b16 a[120:121], v23 offset:24576
  ds_read_b64_tr_b16 a[122:123], v23 offset:25600
  ds_read_b64_tr_b16 a[124:125], v23 offset:28672
  ds_read_b64_tr_b16 a[126:127], v23 offset:29696
  s_waitcnt vmcnt(24)
  s_barrier
  ds_read_b64_tr_b16 a[128:129], v23 offset:32768
  ds_read_b64_tr_b16 a[130:131], v23 offset:33792
  ds_read_b64_tr_b16 a[132:133], v23 offset:36864
  ds_read_b64_tr_b16 a[134:135], v23 offset:37888
  ds_read_b64_tr_b16 a[136:137], v23 offset:40960
  ds_read_b64_tr_b16 a[138:139], v23 offset:41984
  ds_read_b64_tr_b16 a[140:141], v23 offset:45056
  ds_read_b64_tr_b16 a[142:143], v23 offset:46080
  ds_read_b64_tr_b16 a[144:145], v23 offset:49152
  ds_read_b64_tr_b16 a[146:147], v23 offset:50176
  ds_read_b64_tr_b16 a[148:149], v23 offset:53248
  ds_read_b64_tr_b16 a[150:151], v23 offset:54272
  ds_read_b64_tr_b16 a[152:153], v23 offset:57344
  ds_read_b64_tr_b16 a[154:155], v23 offset:58368
  ds_read_b64_tr_b16 a[156:157], v23 offset:61440
  ds_read_b64_tr_b16 a[158:159], v23 offset:62464
  s_waitcnt vmcnt(16)
  s_barrier
  ds_read_b64_tr_b16 a[160:161], v24 offset:0
  ds_read_b64_tr_b16 a[162:163], v24 offset:1024
  ds_read_b64_tr_b16 a[164:165], v24 offset:4096
  ds_read_b64_tr_b16 a[166:167], v24 offset:5120
  ds_read_b64_tr_b16 a[168:169], v24 offset:8192
  ds_read_b64_tr_b16 a[170:171], v24 offset:9216
  ds_read_b64_tr_b16 a[172:173], v24 offset:12288
  ds_read_b64_tr_b16 a[174:175], v24 offset:13312
  ds_read_b64_tr_b16 a[176:177], v24 offset:16384
  ds_read_b64_tr_b16 a[178:179], v24 offset:17408
  ds_read_b64_tr_b16 a[180:181], v24 offset:20480
  ds_read_b64_tr_b16 a[182:183], v24 offset:21504
  ds_read_b64_tr_b16 a[184:185], v24 offset:24576
  ds_read_b64_tr_b16 a[186:187], v24 offset:25600
  ds_read_b64_tr_b16 a[188:189], v24 offset:28672
  ds_read_b64_tr_b16 a[190:191], v24 offset:29696
  s_waitcnt vmcnt(8)
  s_barrier
  ds_read_b64_tr_b16 a[192:193], v22 offset:0
  ds_read_b64_tr_b16 a[194:195], v22 offset:1024
  ds_read_b64_tr_b16 a[196:197], v22 offset:4096
  ds_read_b64_tr_b16 a[198:199], v22 offset:5120
  ds_read_b64_tr_b16 a[200:201], v22 offset:8192
  ds_read_b64_tr_b16 a[202:203], v22 offset:9216
  ds_read_b64_tr_b16 a[204:205], v22 offset:12288
  ds_read_b64_tr_b16 a[206:207], v22 offset:13312
  ds_read_b64_tr_b16 a[208:209], v22 offset:16384
  ds_read_b64_tr_b16 a[210:211], v22 offset:17408
  ds_read_b64_tr_b16 a[212:213], v22 offset:20480
  ds_read_b64_tr_b16 a[214:215], v22 offset:21504
  ds_read_b64_tr_b16 a[216:217], v22 offset:24576
  ds_read_b64_tr_b16 a[218:219], v22 offset:25600
  ds_read_b64_tr_b16 a[220:221], v22 offset:28672
  ds_read_b64_tr_b16 a[222:223], v22 offset:29696
  s_waitcnt vmcnt(0)
  s_barrier
  ds_read_b64_tr_b16 a[224:225], v22 offset:32768
  ds_read_b64_tr_b16 a[226:227], v22 offset:33792
  ds_read_b64_tr_b16 a[228:229], v22 offset:36864
  ds_read_b64_tr_b16 a[230:231], v22 offset:37888
  ds_read_b64_tr_b16 a[232:233], v22 offset:40960
  ds_read_b64_tr_b16 a[234:235], v22 offset:41984
  ds_read_b64_tr_b16 a[236:237], v22 offset:45056
  ds_read_b64_tr_b16 a[238:239], v22 offset:46080
  ds_read_b64_tr_b16 a[240:241], v22 offset:49152
  ds_read_b64_tr_b16 a[242:243], v22 offset:50176
  ds_read_b64_tr_b16 a[244:245], v22 offset:53248
  ds_read_b64_tr_b16 a[246:247], v22 offset:54272
  ds_read_b64_tr_b16 a[248:249], v22 offset:57344
  ds_read_b64_tr_b16 a[250:251], v22 offset:58368
  ds_read_b64_tr_b16 a[252:253], v22 offset:61440
  ds_read_b64_tr_b16 a[254:255], v22 offset:62464
  s_waitcnt lgkmcnt(0)
  s_barrier
  v_mbcnt_lo_u32_b32 v20, -1, 0
  v_and_b32 v20, 7, v20
  v_lshlrev_b32 v20, 2, v20
  v_add_u32 v20, 0, v20
  s_mov_b32 s26, 0
g_wt_52:
  global_load_dword v21, v20, s[12:13] sc1
  s_add_u32 s26, s26, 1
  s_cmp_gt_u32 s26, 1048576
  s_cbranch_scc1 L_end
  s_waitcnt vmcnt(0)
  v_readlane_b32 s32, v21, 0
  v_readlane_b32 s33, v21, 1
  v_readlane_b32 s34, v21, 2
  v_readlane_b32 s35, v21, 3
  v_readlane_b32 s36, v21, 4
  v_readlane_b32 s37, v21, 5
  v_readlane_b32 s38, v21, 6
  v_readlane_b32 s39, v21, 7
  s_add_u32 s27, s32, s33
  s_add_u32 s27, s27, s34
  s_add_u32 s27, s27, s35
  s_add_u32 s27, s27, s36
  s_add_u32 s27, s27, s37
  s_add_u32 s27, s27, s38
  s_add_u32 s27, s27, s39
  s_mul_i32 s27, s27, 0x01010101
  s_lshr_b32 s27, s27, 24
  s_cmp_lt_u32 s27, 64
  s_cbranch_scc1 g_wt_52
  v_mbcnt_lo_u32_b32 v20, -1, 0
  v_and_b32 v20, 1, v20
  v_lshlrev_b32 v20, 2, v20
  v_add_u32 v20, 160, v20
  s_mov_b32 s26, 0
g_wt_53:
  global_load_dword v21, v20, s[12:13] sc1
  s_add_u32 s26, s26, 1
  s_cmp_gt_u32 s26, 1048576
  s_cbranch_scc1 L_end
  s_waitcnt vmcnt(0)
  v_readlane_b32 s32, v21, 0
  v_readlane_b32 s33, v21, 1
  s_add_u32 s27, s32, s33
  s_mul_i32 s27, s27, 0x01010101
  s_lshr_b32 s27, s27, 24
  s_cmp_lt_u32 s27, 96
  s_cbranch_scc1 g_wt_53
  s_mov_b32 s47, s60
  s_add_u32 s40, s60, 3
  s_add_u32 s41, s60, 64
  s_mov_b32 s42, 5
  s_mov_b32 s48, 0
  s_mov_b32 s49, 268435456
  s_mov_b32 s43, 268435456
  s_mov_b32 s50, 32768
  s_mov_b32 s56, 0
  s_mov_b32 s61, 0
  s_mov_b32 s62, 0
  s_lshl_b32 s54, s17, 13
  s_mov_b32 s50, 0
  v_mov_b32 v4, 1
  s_cmp_lt_u32 s40, 64
  s_cselect_b32 s42, s42, 0
  s_cmp_lg_u32 s42, 0
  s_cselect_b32 s76, s40, s41
  s_cselect_b32 s26, 3, 0
  s_cselect_b32 s42, s42, 2
  s_sub_u32 s42, s42, 1
  s_add_u32 s40, s40, s26
  s_xor_b32 s26, s26, 3
  s_add_u32 s41, s41, s26
q_slow_54:
  s_nop 1
  s_nop 6
  v_cvt_pk_bf16_f32 v100, v52, v53
  v_cvt_pk_bf16_f32 v101, v54, v55
  v_cvt_pk_bf16_f32 v102, v60, v61
  v_cvt_pk_bf16_f32 v103, v62, v63
  buffer_store_dwordx4 v[100:103], v8, s[4:7], s43 offen offset:0 sc1
  v_cvt_pk_bf16_f32 v104, v56, v57
  v_cvt_pk_bf16_f32 v105, v58, v59
  v_cvt_pk_bf16_f32 v106, v64, v65
  v_cvt_pk_bf16_f32 v107, v66, v67
  buffer_store_dwordx4 v[104:107], v8, s[4:7], s43 offen offset:512 sc1
  s_mov_b32 s43, 268435456
  s_xor_b32 s50, s50, 32768
  s_cmp_lg_u32 s62, 0
  s_cbranch_scc1 q_patch_59
  s_cmp_ge_u32 s47, 128
  s_cbranch_scc1 q_end_55
  s_cmp_lg_u32 s48, 0
  s_cbranch_scc1 q_have_56
  s_mov_b32 s53, 0
q_poll_57:
  s_cmp_lt_u32 s47, 64
  s_cselect_b32 s26, 3, 0
  s_add_u32 s26, s26, s47
  s_lshl_b32 s26, s26, 10
  s_add_u32 s26, s26, 243266560
  buffer_load_dword v116, v9, s[4:7], s26 offen sc1
  buffer_load_dword v117, v9, s[4:7], s26 offen offset:2048 sc1
  s_add_u32 s53, s53, 1
  s_cmp_gt_u32 s53, 1048576
  s_cbranch_scc1 q_fail_58
  s_waitcnt vmcnt(0)
  s_mov_b64 exec, 1
  buffer_store_dword v4, off, s[4:7], s49 sc1
  s_mov_b64 exec, -1
  s_mov_b32 s49, 268435456
  v_min_u32 v2, v116, v117
  v_cmp_eq_u32 vcc, 0, v2
  s_cbranch_vccnz q_poll_57
  s_and_b32 s63, s47, 127
  s_lshl_b32 s63, s63, 15
  s_xor_b32 s27, s50, 32768
  s_add_u32 m0, s27, s54
  s_add_u32 s63, s63, s54
  s_add_u32 s63, s63, 6291456
  buffer_load_dwordx4 v12, s[4:7], s63 offen offset:0 sc1 lds
  buffer_load_dwordx4 v13, s[4:7], s63 offen offset:1024 sc1 lds
  buffer_load_dwordx4 v14, s[4:7], s63 offen offset:2048 sc1 lds
  buffer_load_dwordx4 v15, s[4:7], s63 offen offset:3072 sc1 lds
  s_add_u32 m0, m0, 4096
  s_add_u32 s63, s63, 4096
  buffer_load_dwordx4 v16, s[4:7], s63 offen offset:0 sc1 lds
  buffer_load_dwordx4 v17, s[4:7], s63 offen offset:1024 sc1 lds
  buffer_load_dwordx4 v18, s[4:7], s63 offen offset:2048 sc1 lds
  buffer_load_dwordx4 v19, s[4:7], s63 offen offset:3072 sc1 lds
  v_min_u32 v2, v116, v117
  v_max_u32 v116, v116, v117
  v_cmp_eq_u32 vcc, 0, v2
  s_nop 0
  v_max_u32_dpp v116, v116, v116 row_ror:8 row_mask:0xf bank_mask:0xf
  s_nop 0
  s_nop 0
  v_max_u32_dpp v116, v116, v116 row_ror:4 row_mask:0xf bank_mask:0xf
  s_nop 0
  s_nop 0
  v_max_u32_dpp v116, v116, v116 row_ror:2 row_mask:0xf bank_mask:0xf
  s_nop 0
  s_nop 0
  v_max_u32_dpp v116, v116, v116 row_ror:1 row_mask:0xf bank_mask:0xf
  s_nop 0
  v_readlane_b32 s28, v116, 0
  v_readlane_b32 s29, v116, 16
  v_readlane_b32 s30, v116, 32
  v_readlane_b32 s31, v116, 48
  s_max_u32 s28, s28, s29
  s_max_u32 s30, s30, s31
  s_max_u32 s28, s28, s30
  s_cmp_eq_u64 vcc, 0
  s_cselect_b32 s48, 1, 0
  s_bitcmp1_b32 s47, 6
  s_cselect_b32 s28, s28, 0
  s_max_u32 s56, s56, s28
  s_bfe_u32 s28, s56, 0x70005
  s_xor_b32 s28, s28, 63
  s_cmp_eq_u32 s28, s47
  s_cselect_b32 s55, 1, 0
q_have_56:
  s_xor_b32 s50, s50, 32768
  s_cmp_lg_u32 s55, 0
  s_cbranch_scc1 q_fork_61
  s_waitcnt vmcnt(0)
  s_sub_u32 s26, s47, s60
  s_cmp_lg_u32 s26, 9
  s_cbranch_scc1 q_cold_62
  s_load_dwordx2 s[64:65], s[0:1], 72
  s_load_dwordx2 s[68:69], s[0:1], 80
  s_load_dwordx2 s[8:9], s[0:1], 88
  s_mov_b32 s66, 1835008
  s_mov_b32 s70, 1835008
  s_mov_b32 s10, 1835008
  v_lshrrev_b32 v2, 8, v0
  v_and_b32 v3, 0x70, v0
  s_mov_b32 s26, 114688
  v_mul_lo_u32 v6, v2, s26
  v_add_u32 v6, v6, v3
  v_cmp_eq_u32 vcc, 0x70, v3
  v_mov_b32 v3, 0x7ff00000
  s_nop 0
  v_cndmask_b32 v6, v6, v3, vcc
  v_mul_u32_u24 v7, 14336, v2
  v_and_b32 v3, 0xf0, v0
  v_add_u32 v7, v7, v3
  s_mul_i32 s34, s17, 458752
  s_mul_i32 s27, s16, 112
  s_add_u32 s34, s34, s27
  s_add_u32 s34, s34, 0
  s_mul_i32 s35, s16, 57344
  s_lshl_b32 s27, s17, 8
  s_add_u32 s35, s35, s27
  s_mov_b32 s36, 0x00ff00ff
  s_mov_b32 s37, 0x00ff00ff
  s_waitcnt lgkmcnt(0)
  s_mul_i32 s26, s17, 23552
  s_add_u32 m0, s26, 65536
  s_mov_b64 exec, s[36:37]
  buffer_load_dwordx4 v6, s[64:67], s34 offen lds
  s_not_b64 exec, exec
  buffer_load_dwordx4 v6, s[68:71], s34 offen lds
  s_add_u32 s34, s34, 3584
  s_add_u32 m0, m0, 1024
  s_mov_b64 exec, s[36:37]
  buffer_load_dwordx4 v6, s[64:67], s34 offen lds
  s_not_b64 exec, exec
  buffer_load_dwordx4 v6, s[68:71], s34 offen lds
  s_add_u32 s34, s34, 3584
  s_add_u32 m0, m0, 1024
  s_mov_b64 exec, s[36:37]
  buffer_load_dwordx4 v6, s[64:67], s34 offen lds
  s_not_b64 exec, exec
  buffer_load_dwordx4 v6, s[68:71], s34 offen lds
  s_add_u32 s34, s34, 3584
  s_add_u32 m0, m0, 1024
  s_mov_b64 exec, s[36:37]
  buffer_load_dwordx4 v6, s[64:67], s34 offen lds
  s_not_b64 exec, exec
  buffer_load_dwordx4 v6, s[68:71], s34 offen lds
  s_add_u32 s34, s34, 3584
  s_add_u32 m0, m0, 1024
  s_mov_b64 exec, s[36:37]
  buffer_load_dwordx4 v6, s[64:67], s34 offen lds
  s_not_b64 exec, exec
  buffer_load_dwordx4 v6, s[68:71], s34 offen lds
  s_add_u32 s34, s34, 3584
  s_add_u32 m0, m0, 1024
  s_mov_b64 exec, s[36:37]
  buffer_load_dwordx4 v6, s[64:67], s34 offen lds
  s_not_b64 exec, exec
  buffer_load_dwordx4 v6, s[68:71], s34 offen lds
  s_add_u32 s34, s34, 3584
  s_add_u32 m0, m0, 1024
  s_mov_b64 exec, s[36:37]
  buffer_load_dwordx4 v6, s[64:67], s34 offen lds
  s_not_b64 exec, exec
  buffer_load_dwordx4 v6, s[68:71], s34 offen lds
  s_add_u32 s34, s34, 3584
  s_add_u32 m0, m0, 1024
  s_mov_b64 exec, s[36:37]
  buffer_load_dwordx4 v6, s[64:67], s34 offen lds
  s_not_b64 exec, exec
  buffer_load_dwordx4 v6, s[68:71], s34 offen lds
  s_add_u32 s34, s34, 3584
  s_add_u32 m0, m0, 1024
  s_mov_b64 exec, s[36:37]
  buffer_load_dwordx4 v6, s[64:67], s34 offen lds
  s_not_b64 exec, exec
  buffer_load_dwordx4 v6, s[68:71], s34 offen lds
  s_add_u32 s34, s34, 3584
  s_add_u32 m0, m0, 1024
  s_mov_b64 exec, s[36:37]
  buffer_load_dwordx4 v6, s[64:67], s34 offen lds
  s_not_b64 exec, exec
  buffer_load_dwordx4 v6, s[68:71], s34 offen lds
  s_add_u32 s34, s34, 3584
  s_add_u32 m0, m0, 1024
  s_mov_b64 exec, s[36:37]
  buffer_load_dwordx4 v6, s[64:67], s34 offen lds
  s_not_b64 exec, exec
  buffer_load_dwordx4 v6, s[68:71], s34 offen lds
  s_add_u32 s34, s34, 3584
  s_add_u32 m0, m0, 1024
  s_mov_b64 exec, s[36:37]
  buffer_load_dwordx4 v6, s[64:67], s34 offen lds
  s_not_b64 exec, exec
  buffer_load_dwordx4 v6, s[68:71], s34 offen lds
  s_add_u32 s34, s34, 3584
  s_add_u32 m0, m0, 1024
  s_mov_b64 exec, s[36:37]
  buffer_load_dwordx4 v6, s[64:67], s34 offen lds
  s_not_b64 exec, exec
  buffer_load_dwordx4 v6, s[68:71], s34 offen lds
  s_add_u32 s34, s34, 3584
  s_add_u32 m0, m0, 1024
  s_mov_b64 exec, s[36:37]
  buffer_load_dwordx4 v6, s[64:67], s34 offen lds
  s_not_b64 exec, exec
  buffer_load_dwordx4 v6, s[68:71], s34 offen lds
  s_add_u32 s34, s34, 3584
  s_add_u32 m0, m0, 1024
  s_mov_b64 exec, s[36:37]
  buffer_load_dwordx4 v6, s[64:67], s34 offen lds
  s_not_b64 exec, exec
  buffer_load_dwordx4 v6, s[68:71], s34 offen lds
  s_add_u32 s34, s34, 3584
  s_add_u32 m0, m0, 1024
  s_mov_b64 exec, s[36:37]
  buffer_load_dwordx4 v6, s[64:67], s34 offen lds
  s_not_b64 exec, exec
  buffer_load_dwordx4 v6, s[68:71], s34 offen lds
  s_add_u32 s34, s34, 3584
  s_add_u32 m0, m0, 1024
  s_mov_b64 exec, s[36:37]
  buffer_load_dwordx4 v6, s[64:67], s34 offen lds
  s_not_b64 exec, exec
  buffer_load_dwordx4 v6, s[68:71], s34 offen lds
  s_add_u32 s34, s34, 3584
  s_add_u32 m0, m0, 1024
  s_mov_b64 exec, s[36:37]
  buffer_load_dwordx4 v6, s[64:67], s34 offen lds
  s_not_b64 exec, exec
  buffer_load_dwordx4 v6, s[68:71], s34 offen lds
  s_add_u32 s34, s34, 3584
  s_add_u32 m0, m0, 1024
  s_mov_b64 exec, s[36:37]
  buffer_load_dwordx4 v6, s[64:67], s34 offen lds
  s_not_b64 exec, exec
  buffer_load_dwordx4 v6, s[68:71], s34 offen lds
  s_add_u32 s34, s34, 3584
  s_add_u32 m0, m0, 1024
  s_mov_b64 exec, s[36:37]
  buffer_load_dwordx4 v6, s[64:67], s34 offen lds
  s_not_b64 exec, exec
  buffer_load_dwordx4 v6, s[68:71], s34 offen lds
  s_add_u32 s34, s34, 3584
  s_add_u32 m0, m0, 1024
  s_mov_b64 exec, s[36:37]
  buffer_load_dwordx4 v6, s[64:67], s34 offen lds
  s_not_b64 exec, exec
  buffer_load_dwordx4 v6, s[68:71], s34 offen lds
  s_add_u32 s34, s34, 3584
  s_add_u32 m0, m0, 1024
  s_mov_b64 exec, s[36:37]
  buffer_load_dwordx4 v6, s[64:67], s34 offen lds
  s_not_b64 exec, exec
  buffer_load_dwordx4 v6, s[68:71], s34 offen lds
  s_add_u32 s34, s34, 3584
  s_add_u32 m0, m0, 1024
  s_mov_b64 exec, s[36:37]
  buffer_load_dwordx4 v6, s[64:67], s34 offen lds
  s_not_b64 exec, exec
  buffer_load_dwordx4 v6, s[68:71], s34 offen lds
  s_add_u32 s34, s34, 3584
  s_add_u32 m0, m0, 1024
  s_mov_b64 exec, -1
q_cold_62:
  s_waitcnt lgkmcnt(0)
  s_barrier
  s_cmp_lg_u32 s50, 0
  s_cbranch_scc1 q_c1_64
q_c0_63:
  ds_read_b128 v[68:71], v120 offset:0
  ds_read_b128 v[72:75], v121 offset:0
  ds_read_b128 v[76:79], v122 offset:0
  ds_read_b128 v[80:83], v123 offset:0
q_w0_65:
  s_waitcnt lgkmcnt(2)
  v_mfma_f32_32x32x16_bf16 v[20:35], v[128:131], v[68:71], 0
  ds_read_b128 v[84:87], v124 offset:0
  ds_read_b128 v[88:91], v125 offset:0
  s_mov_b32 s46, s47
  s_mov_b32 s47, s76
  s_cmp_lt_u32 s47, 64
  s_cselect_b32 s26, 3, 0
  v_mfma_f32_32x32x16_bf16 v[20:35], v[132:135], v[72:75], v[20:35]
  ds_read_b128 v[92:95], v126 offset:0
  s_add_u32 s26, s26, s47
  s_lshl_b32 s26, s26, 10
  s_add_u32 s26, s26, 243266560
  s_waitcnt lgkmcnt(3)
  v_mfma_f32_32x32x16_bf16 v[20:35], v[136:139], v[76:79], v[20:35]
  ds_read_b128 v[96:99], v127 offset:0
  buffer_load_dword v116, v9, s[4:7], s26 offen sc1
  v_mfma_f32_32x32x16_bf16 v[20:35], v[140:143], v[80:83], v[20:35]
  ds_read_b128 v[68:71], v120 offset:256
  s_waitcnt lgkmcnt(3)
  v_mfma_f32_32x32x16_bf16 v[20:35], v[144:147], v[84:87], v[20:35]
  ds_read_b128 v[72:75], v121 offset:256
  buffer_load_dword v117, v9, s[4:7], s26 offen offset:2048 sc1
  v_cvt_pk_bf16_f32 v100, v52, v53
  v_cvt_pk_bf16_f32 v101, v54, v55
  v_mfma_f32_32x32x16_bf16 v[20:35], v[148:151], v[88:91], v[20:35]
  ds_read_b128 v[76:79], v122 offset:256
  v_cvt_pk_bf16_f32 v102, v60, v61
  v_cvt_pk_bf16_f32 v103, v62, v63
  s_waitcnt lgkmcnt(3)
  v_mfma_f32_32x32x16_bf16 v[20:35], v[152:155], v[92:95], v[20:35]
  ds_read_b128 v[80:83], v123 offset:256
  buffer_store_dwordx4 v[100:103], v8, s[4:7], s43 offen offset:0 sc1
  v_cvt_pk_bf16_f32 v104, v56, v57
  v_cvt_pk_bf16_f32 v105, v58, v59
  v_mfma_f32_32x32x16_bf16 v[20:35], v[156:159], v[96:99], v[20:35]
  ds_read_b128 v[84:87], v124 offset:256
  v_cvt_pk_bf16_f32 v106, v64, v65
  v_cvt_pk_bf16_f32 v107, v66, v67
  s_waitcnt lgkmcnt(3)
  v_mfma_f32_32x32x16_bf16 v[20:35], v[160:163], v[68:71], v[20:35]
  ds_read_b128 v[88:91], v125 offset:256
  buffer_store_dwordx4 v[104:107], v8, s[4:7], s43 offen offset:512 sc1
  s_lshl_b32 s52, s46, 7
  s_add_u32 s52, s52, s57
  v_mfma_f32_32x32x16_bf16 v[20:35], v[164:167], v[72:75], v[20:35]
  ds_read_b128 v[92:95], v126 offset:256
  s_lshl_b32 s44, s52, 12
  s_add_u32 s44, s44, 41943040
  s_lshl_b32 s43, s52, 11
  s_add_u32 s43, s43, 142606336
  s_lshl_b32 s51, s52, 5
  s_waitcnt lgkmcnt(3)
  v_mfma_f32_32x32x16_bf16 v[20:35], v[168:171], v[76:79], v[20:35]
  ds_read_b128 v[96:99], v127 offset:256
  s_add_u32 s51, s51, 243662848
  v_mfma_f32_32x32x16_bf16 v[20:35], v[172:175], v[80:83], v[20:35]
  ds_read_b128 v[68:71], v120 offset:512
  s_waitcnt lgkmcnt(3)
  v_mfma_f32_32x32x16_bf16 v[20:35], v[176:179], v[84:87], v[20:35]
  ds_read_b128 v[72:75], v121 offset:512
  v_mfma_f32_32x32x16_bf16 v[20:35], v[180:183], v[88:91], v[20:35]
  ds_read_b128 v[76:79], v122 offset:512
  s_waitcnt lgkmcnt(3)
  v_mfma_f32_32x32x16_bf16 v[20:35], v[184:187], v[92:95], v[20:35]
  ds_read_b128 v[80:83], v123 offset:512
  v_mfma_f32_32x32x16_bf16 v[20:35], v[188:191], v[96:99], v[20:35]
  ds_read_b128 v[84:87], v124 offset:512
  s_waitcnt lgkmcnt(3)
  v_mfma_f32_32x32x16_bf16 v[20:35], v[192:195], v[68:71], v[20:35]
  ds_read_b128 v[88:91], v125 offset:512
  s_waitcnt vmcnt(2)
  v_min_u32 v2, v116, v117
  v_max_u32 v116, v116, v117
  v_cmp_eq_u32 vcc, 0, v2
  s_nop 0
  v_max_u32_dpp v116, v116, v116 row_ror:8 row_mask:0xf bank_mask:0xf
  v_mfma_f32_32x32x16_bf16 v[20:35], v[196:199], v[72:75], v[20:35]
  ds_read_b128 v[92:95], v126 offset:512
  s_nop 0
  v_max_u32_dpp v116, v116, v116 row_ror:4 row_mask:0xf bank_mask:0xf
  s_nop 0
  s_nop 0
  v_max_u32_dpp v116, v116, v116 row_ror:2 row_mask:0xf bank_mask:0xf
  s_nop 0
  s_waitcnt lgkmcnt(3)
  v_mfma_f32_32x32x16_bf16 v[20:35], v[200:203], v[76:79], v[20:35]
  ds_read_b128 v[96:99], v127 offset:512
  v_max_u32_dpp v116, v116, v116 row_ror:1 row_mask:0xf bank_mask:0xf
  s_nop 0
  v_readlane_b32 s28, v116, 0
  v_readlane_b32 s29, v116, 16
  v_readlane_b32 s30, v116, 32
  v_mfma_f32_32x32x16_bf16 v[20:35], v[204:207], v[80:83], v[20:35]
  ds_read_b128 v[68:71], v120 offset:768
  v_readlane_b32 s31, v116, 48
  s_max_u32 s28, s28, s29
  s_max_u32 s30, s30, s31
  s_max_u32 s28, s28, s30
  s_cmp_eq_u64 vcc, 0
  s_cselect_b32 s48, 1, 0
  s_waitcnt lgkmcnt(3)
  v_mfma_f32_32x32x16_bf16 v[20:35], v[208:211], v[84:87], v[20:35]
  ds_read_b128 v[72:75], v121 offset:768
  s_bitcmp1_b32 s47, 6
  s_cselect_b32 s28, s28, 0
  s_max_u32 s56, s56, s28
  s_bfe_u32 s28, s56, 0x70005
  s_xor_b32 s28, s28, 63
  v_mfma_f32_32x32x16_bf16 v[20:35], v[212:215], v[88:91], v[20:35]
  ds_read_b128 v[76:79], v122 offset:768
  s_cmp_eq_u32 s28, s47
  s_cselect_b32 s55, 1, 0
  s_cmp_lg_u32 s48, 0
  s_cselect_b32 s28, s47, s46
  s_and_b32 s63, s28, 127
  s_waitcnt lgkmcnt(3)
  v_mfma_f32_32x32x16_bf16 v[20:35], v[216:219], v[92:95], v[20:35]
  ds_read_b128 v[80:83], v123 offset:768
  s_lshl_b32 s63, s63, 15
  s_xor_b32 s27, s50, 32768
  s_add_u32 m0, s27, s54
  s_add_u32 s63, s63, s54
  s_add_u32 s63, s63, 6291456
  v_mfma_f32_32x32x16_bf16 v[20:35], v[220:223], v[96:99], v[20:35]
  ds_read_b128 v[84:87], v124 offset:768
  s_waitcnt lgkmcnt(3)
  v_mfma_f32_32x32x16_bf16 v[20:35], v[224:227], v[68:71], v[20:35]
  ds_read_b128 v[88:91], v125 offset:768
  buffer_load_dwordx4 v12, s[4:7], s63 offen offset:0 sc1 lds
  v_mfma_f32_32x32x16_bf16 v[20:35], v[228:231], v[72:75], v[20:35]
  ds_read_b128 v[92:95], v126 offset:768
  s_waitcnt lgkmcnt(3)
  v_mfma_f32_32x32x16_bf16 v[20:35], v[232:235], v[76:79], v[20:35]
  ds_read_b128 v[96:99], v127 offset:768
  buffer_load_dwordx4 v13, s[4:7], s63 offen offset:1024 sc1 lds
  v_mfma_f32_32x32x16_bf16 v[20:35], v[236:239], v[80:83], v[20:35]
  ds_read_b128 v[68:71], v120 offset:0
  s_waitcnt lgkmcnt(3)
  v_mfma_f32_32x32x16_bf16 v[20:35], v[240:243], v[84:87], v[20:35]
  ds_read_b128 v[72:75], v121 offset:0
  buffer_load_dwordx4 v14, s[4:7], s63 offen offset:2048 sc1 lds
  v_mfma_f32_32x32x16_bf16 v[20:35], v[244:247], v[88:91], v[20:35]
  ds_read_b128 v[76:79], v122 offset:0
  s_waitcnt lgkmcnt(3)
  v_mfma_f32_32x32x16_bf16 v[20:35], v[248:251], v[92:95], v[20:35]
  ds_read_b128 v[80:83], v123 offset:0
  buffer_load_dwordx4 v15, s[4:7], s63 offen offset:3072 sc1 lds
  s_add_u32 m0, m0, 4096
  s_add_u32 s63, s63, 4096
  v_mfma_f32_32x32x16_bf16 v[20:35], v[252:255], v[96:99], v[20:35]
  ds_read_b128 v[84:87], v124 offset:0
  s_waitcnt lgkmcnt(3)
  v_mfma_f32_32x32x16_bf16 v[36:51], v[68:71], a[0:3], 0
  ds_read_b128 v[88:91], v125 offset:0
  buffer_load_dwordx4 v16, s[4:7], s63 offen offset:0 sc1 lds
  v_mfma_f32_32x32x16_bf16 v[36:51], v[72:75], a[4:7], v[36:51]
  ds_read_b128 v[92:95], v126 offset:0
  s_waitcnt lgkmcnt(3)
  v_mfma_f32_32x32x16_bf16 v[36:51], v[76:79], a[8:11], v[36:51]
  ds_read_b128 v[96:99], v127 offset:0
  buffer_load_dwordx4 v17, s[4:7], s63 offen offset:1024 sc1 lds
  v_mfma_f32_32x32x16_bf16 v[36:51], v[80:83], a[12:15], v[36:51]
  ds_read_b128 v[68:71], v120 offset:256
  s_waitcnt lgkmcnt(3)
  v_mfma_f32_32x32x16_bf16 v[36:51], v[84:87], a[16:19], v[36:51]
  ds_read_b128 v[72:75], v121 offset:256
  buffer_load_dwordx4 v18, s[4:7], s63 offen offset:2048 sc1 lds
  v_mfma_f32_32x32x16_bf16 v[36:51], v[88:91], a[20:23], v[36:51]
  ds_read_b128 v[76:79], v122 offset:256
  s_waitcnt lgkmcnt(3)
  v_mfma_f32_32x32x16_bf16 v[36:51], v[92:95], a[24:27], v[36:51]
  ds_read_b128 v[80:83], v123 offset:256
  buffer_load_dwordx4 v19, s[4:7], s63 offen offset:3072 sc1 lds
  v_mfma_f32_32x32x16_bf16 v[36:51], v[96:99], a[28:31], v[36:51]
  ds_read_b128 v[84:87], v124 offset:256
  s_waitcnt lgkmcnt(3)
  v_mfma_f32_32x32x16_bf16 v[36:51], v[68:71], a[32:35], v[36:51]
  ds_read_b128 v[88:91], v125 offset:256
  v_mfma_f32_32x32x16_bf16 v[36:51], v[72:75], a[36:39], v[36:51]
  ds_read_b128 v[92:95], v126 offset:256
  s_waitcnt lgkmcnt(3)
  v_mfma_f32_32x32x16_bf16 v[36:51], v[76:79], a[40:43], v[36:51]
  ds_read_b128 v[96:99], v127 offset:256
  v_mfma_f32_32x32x16_bf16 v[36:51], v[80:83], a[44:47], v[36:51]
  ds_read_b128 v[68:71], v120 offset:512
  s_waitcnt lgkmcnt(3)
  v_mfma_f32_32x32x16_bf16 v[36:51], v[84:87], a[48:51], v[36:51]
  ds_read_b128 v[72:75], v121 offset:512
  s_waitcnt vmcnt(8)
  s_mov_b64 exec, 1
  buffer_store_dword v4, off, s[4:7], s49 sc1
  s_mov_b64 exec, -1
  v_mfma_f32_32x32x16_bf16 v[36:51], v[88:91], a[52:55], v[36:51]
  ds_read_b128 v[76:79], v122 offset:512
  s_add_u32 s49, s51, 16
  s_or_b32 s26, s55, s62
  s_lshr_b32 s27, s47, 7
  s_or_b32 s26, s26, s27
  s_sub_u32 s27, s47, s60
  s_waitcnt lgkmcnt(3)
  v_mfma_f32_32x32x16_bf16 v[36:51], v[92:95], a[56:59], v[36:51]
  ds_read_b128 v[80:83], v123 offset:512
  s_cmp_eq_u32 s27, 9
  s_cselect_b32 s26, 1, s26
  s_andn2_b32 s26, s48, s26
  v_mov_b32 v2, s26
  s_add_u32 s26, s62, 1
  v_mfma_f32_32x32x16_bf16 v[36:51], v[96:99], a[60:63], v[36:51]
  ds_read_b128 v[84:87], v124 offset:512
  v_mov_b32 v4, s26
  ds_write_b32 v118, v2 offset:0
  v_mul_f32 v20, s24, v20
  v_mul_f32 v21, s24, v21
  v_mul_f32 v22, s24, v22
  s_waitcnt lgkmcnt(4)
  v_mfma_f32_32x32x16_bf16 v[36:51], v[68:71], a[64:67], v[36:51]
  ds_read_b128 v[88:91], v125 offset:512
  v_mul_f32 v23, s24, v23
  v_mul_f32 v24, s24, v24
  v_mul_f32 v25, s24, v25
  v_mul_f32 v26, s24, v26
  v_mul_f32 v27, s24, v27
  v_mfma_f32_32x32x16_bf16 v[36:51], v[72:75], a[68:71], v[36:51]
  ds_read_b128 v[92:95], v126 offset:512
  v_mul_f32 v28, s24, v28
  v_mul_f32 v29, s24, v29
  v_mul_f32 v30, s24, v30
  v_mul_f32 v31, s24, v31
  v_mul_f32 v32, s24, v32
  s_waitcnt lgkmcnt(4)
  v_mfma_f32_32x32x16_bf16 v[36:51], v[76:79], a[72:75], v[36:51]
  ds_read_b128 v[96:99], v127 offset:512
  v_mul_f32 v33, s24, v33
  v_mul_f32 v34, s24, v34
  v_mul_f32 v35, s24, v35
  v_cvt_pk_bf16_f32 v108, v20, v21
  v_cvt_pk_bf16_f32 v109, v22, v23
  v_mfma_f32_32x32x16_bf16 v[36:51], v[80:83], a[76:79], v[36:51]
  ds_read_b128 v[68:71], v120 offset:768
  v_cvt_pk_bf16_f32 v110, v28, v29
  v_cvt_pk_bf16_f32 v111, v30, v31
  s_waitcnt lgkmcnt(3)
  v_mfma_f32_32x32x16_bf16 v[36:51], v[84:87], a[80:83], v[36:51]
  ds_read_b128 v[72:75], v121 offset:768
  buffer_store_dwordx4 v[108:111], v8, s[4:7], s44 offen offset:0 sc1
  v_cvt_pk_bf16_f32 v112, v24, v25
  v_cvt_pk_bf16_f32 v113, v26, v27
  v_mfma_f32_32x32x16_bf16 v[36:51], v[88:91], a[84:87], v[36:51]
  ds_read_b128 v[76:79], v122 offset:768
  v_cvt_pk_bf16_f32 v114, v32, v33
  v_cvt_pk_bf16_f32 v115, v34, v35
  s_waitcnt lgkmcnt(3)
  v_mfma_f32_32x32x16_bf16 v[36:51], v[92:95], a[88:91], v[36:51]
  ds_read_b128 v[80:83], v123 offset:768
  buffer_store_dwordx4 v[112:115], v8, s[4:7], s44 offen offset:512 sc1
  v_mfma_f32_32x32x16_bf16 v[36:51], v[96:99], a[92:95], v[36:51]
  ds_read_b128 v[84:87], v124 offset:768
  s_waitcnt lgkmcnt(3)
  v_mfma_f32_32x32x16_bf16 v[36:51], v[68:71], a[96:99], v[36:51]
  ds_read_b128 v[88:91], v125 offset:768
  v_mfma_f32_32x32x16_bf16 v[36:51], v[72:75], a[100:103], v[36:51]
  ds_read_b128 v[92:95], v126 offset:768
  s_waitcnt lgkmcnt(3)
  v_mfma_f32_32x32x16_bf16 v[36:51], v[76:79], a[104:107], v[36:51]
  ds_read_b128 v[96:99], v127 offset:768
  v_mfma_f32_32x32x16_bf16 v[36:51], v[80:83], a[108:111], v[36:51]
  ds_read_b128 v[68:71], v120 offset:0
  s_waitcnt lgkmcnt(3)
  v_mfma_f32_32x32x16_bf16 v[36:51], v[84:87], a[112:115], v[36:51]
  ds_read_b128 v[72:75], v121 offset:0
  v_mfma_f32_32x32x16_bf16 v[36:51], v[88:91], a[116:119], v[36:51]
  ds_read_b128 v[76:79], v122 offset:0
  s_waitcnt lgkmcnt(3)
  v_mfma_f32_32x32x16_bf16 v[36:51], v[92:95], a[120:123], v[36:51]
  ds_read_b128 v[80:83], v123 offset:0
  v_mfma_f32_32x32x16_bf16 v[36:51], v[96:99], a[124:127], v[36:51]
  ds_read_b128 v[84:87], v124 offset:0
  s_waitcnt lgkmcnt(3)
  v_mfma_f32_32x32x16_bf16 v[52:67], a[128:131], v[68:71], 0
  ds_read_b128 v[88:91], v125 offset:0
  v_mfma_f32_32x32x16_bf16 v[52:67], a[132:135], v[72:75], v[52:67]
  ds_read_b128 v[92:95], v126 offset:0
  s_waitcnt lgkmcnt(3)
  v_mfma_f32_32x32x16_bf16 v[52:67], a[136:139], v[76:79], v[52:67]
  ds_read_b128 v[96:99], v127 offset:0
  v_mfma_f32_32x32x16_bf16 v[52:67], a[140:143], v[80:83], v[52:67]
  ds_read_b128 v[68:71], v120 offset:256
  s_nop 0
  v_cvt_pk_bf16_f32 v100, v36, v37
  v_cvt_pk_bf16_f32 v101, v38, v39
  v_cvt_pk_bf16_f32 v102, v44, v45
  v_cvt_pk_bf16_f32 v103, v46, v47
  s_waitcnt lgkmcnt(3)
  v_mfma_f32_32x32x16_bf16 v[52:67], a[144:147], v[84:87], v[52:67]
  ds_read_b128 v[72:75], v121 offset:256
  buffer_store_dwordx4 v[100:103], v8, s[4:7], s44 offen offset:2048 sc1
  v_cvt_pk_bf16_f32 v104, v40, v41
  v_cvt_pk_bf16_f32 v105, v42, v43
  v_mfma_f32_32x32x16_bf16 v[52:67], a[148:151], v[88:91], v[52:67]
  ds_read_b128 v[76:79], v122 offset:256
  v_cvt_pk_bf16_f32 v106, v48, v49
  v_cvt_pk_bf16_f32 v107, v50, v51
  s_waitcnt lgkmcnt(3)
  v_mfma_f32_32x32x16_bf16 v[52:67], a[152:155], v[92:95], v[52:67]
  ds_read_b128 v[80:83], v123 offset:256
  buffer_store_dwordx4 v[104:107], v8, s[4:7], s44 offen offset:2560 sc1
  s_cmp_lt_u32 s40, 64
  s_cselect_b32 s42, s42, 0
  s_cmp_lg_u32 s42, 0
  s_cselect_b32 s76, s40, s41
  s_cselect_b32 s26, 3, 0
  s_cselect_b32 s42, s42, 2
  v_mfma_f32_32x32x16_bf16 v[52:67], a[156:159], v[96:99], v[52:67]
  ds_read_b128 v[84:87], v124 offset:256
  s_sub_u32 s42, s42, 1
  s_add_u32 s40, s40, s26
  s_xor_b32 s26, s26, 3
  s_add_u32 s41, s41, s26
  s_waitcnt lgkmcnt(3)
  v_mfma_f32_32x32x16_bf16 v[52:67], a[160:163], v[68:71], v[52:67]
  ds_read_b128 v[88:91], v125 offset:256
  v_mfma_f32_32x32x16_bf16 v[52:67], a[164:167], v[72:75], v[52:67]
  ds_read_b128 v[92:95], v126 offset:256
  s_waitcnt lgkmcnt(3)
  v_mfma_f32_32x32x16_bf16 v[52:67], a[168:171], v[76:79], v[52:67]
  ds_read_b128 v[96:99], v127 offset:256
  v_mfma_f32_32x32x16_bf16 v[52:67], a[172:175], v[80:83], v[52:67]
  ds_read_b128 v[68:71], v120 offset:512
  s_waitcnt lgkmcnt(3)
  v_mfma_f32_32x32x16_bf16 v[52:67], a[176:179], v[84:87], v[52:67]
  ds_read_b128 v[72:75], v121 offset:512
  v_mfma_f32_32x32x16_bf16 v[52:67], a[180:183], v[88:91], v[52:67]
  ds_read_b128 v[76:79], v122 offset:512
  s_waitcnt lgkmcnt(3)
  v_mfma_f32_32x32x16_bf16 v[52:67], a[184:187], v[92:95], v[52:67]
  ds_read_b128 v[80:83], v123 offset:512
  v_mfma_f32_32x32x16_bf16 v[52:67], a[188:191], v[96:99], v[52:67]
  ds_read_b128 v[84:87], v124 offset:512
  s_waitcnt lgkmcnt(3)
  v_mfma_f32_32x32x16_bf16 v[52:67], a[192:195], v[68:71], v[52:67]
  ds_read_b128 v[88:91], v125 offset:512
  v_mfma_f32_32x32x16_bf16 v[52:67], a[196:199], v[72:75], v[52:67]
  ds_read_b128 v[92:95], v126 offset:512
  s_waitcnt lgkmcnt(3)
  v_mfma_f32_32x32x16_bf16 v[52:67], a[200:203], v[76:79], v[52:67]
  ds_read_b128 v[96:99], v127 offset:512
  v_mfma_f32_32x32x16_bf16 v[52:67], a[204:207], v[80:83], v[52:67]
  ds_read_b128 v[68:71], v120 offset:768
  s_waitcnt lgkmcnt(3)
  v_mfma_f32_32x32x16_bf16 v[52:67], a[208:211], v[84:87], v[52:67]
  ds_read_b128 v[72:75], v121 offset:768
  v_mfma_f32_32x32x16_bf16 v[52:67], a[212:215], v[88:91], v[52:67]
  ds_read_b128 v[76:79], v122 offset:768
  ds_read_b128 v[80:83], v123 offset:768
  s_waitcnt lgkmcnt(4)
  v_mfma_f32_32x32x16_bf16 v[52:67], a[216:219], v[92:95], v[52:67]
  ds_read_b128 v[84:87], v124 offset:768
  ds_read_b128 v[88:91], v125 offset:768
  v_mfma_f32_32x32x16_bf16 v[52:67], a[220:223], v[96:99], v[52:67]
  ds_read_b128 v[92:95], v126 offset:768
  ds_read_b128 v[96:99], v127 offset:768
  s_waitcnt lgkmcnt(6)
  v_mfma_f32_32x32x16_bf16 v[52:67], a[224:227], v[68:71], v[52:67]
  v_mfma_f32_32x32x16_bf16 v[52:67], a[228:231], v[72:75], v[52:67]
  s_waitcnt lgkmcnt(4)
  v_mfma_f32_32x32x16_bf16 v[52:67], a[232:235], v[76:79], v[52:67]
  s_waitcnt vmcnt(5) lgkmcnt(0)
  s_barrier
  ds_read_b128 v[108:111], v119 offset:0
  v_mfma_f32_32x32x16_bf16 v[52:67], a[236:239], v[80:83], v[52:67]
  ds_read_b128 v[68:71], v120 offset:32768
  v_mfma_f32_32x32x16_bf16 v[52:67], a[240:243], v[84:87], v[52:67]
  ds_read_b128 v[72:75], v121 offset:32768
  s_xor_b32 s50, s50, 32768
  v_mfma_f32_32x32x16_bf16 v[52:67], a[244:247], v[88:91], v[52:67]
  ds_read_b128 v[76:79], v122 offset:32768
  s_waitcnt vmcnt(0)
  s_mov_b64 exec, 1
  buffer_store_dword v4, off, s[4:7], s51 sc1
  s_mov_b64 exec, -1
  v_mfma_f32_32x32x16_bf16 v[52:67], a[248:251], v[92:95], v[52:67]
  ds_read_b128 v[80:83], v123 offset:32768
  s_waitcnt lgkmcnt(4)
  v_and_b32 v108, v108, v109
  v_and_b32 v110, v110, v111
  v_and_b32 v108, v108, v110
  s_nop 0
  v_readfirstlane_b32 s45, v108
  v_mfma_f32_32x32x16_bf16 v[52:67], a[252:255], v[96:99], v[52:67]
  s_cmp_lg_u32 s45, 0
  s_cbranch_scc1 q_w1_66
  s_branch q_slow_54
q_c1_64:
  ds_read_b128 v[68:71], v120 offset:32768
  ds_read_b128 v[72:75], v121 offset:32768
  ds_read_b128 v[76:79], v122 offset:32768
  ds_read_b128 v[80:83], v123 offset:32768
q_w1_66:
  s_waitcnt lgkmcnt(2)
  v_mfma_f32_32x32x16_bf16 v[20:35], v[128:131], v[68:71], 0
  ds_read_b128 v[84:87], v124 offset:32768
  ds_read_b128 v[88:91], v125 offset:32768
  s_mov_b32 s46, s47
  s_mov_b32 s47, s76
  s_cmp_lt_u32 s47, 64
  s_cselect_b32 s26, 3, 0
  v_mfma_f32_32x32x16_bf16 v[20:35], v[132:135], v[72:75], v[20:35]
  ds_read_b128 v[92:95], v126 offset:32768
  s_add_u32 s26, s26, s47
  s_lshl_b32 s26, s26, 10
  s_add_u32 s26, s26, 243266560
  s_waitcnt lgkmcnt(3)
  v_mfma_f32_32x32x16_bf16 v[20:35], v[136:139], v[76:79], v[20:35]
  ds_read_b128 v[96:99], v127 offset:32768
  buffer_load_dword v116, v9, s[4:7], s26 offen sc1
  v_mfma_f32_32x32x16_bf16 v[20:35], v[140:143], v[80:83], v[20:35]
  ds_read_b128 v[68:71], v120 offset:33024
  s_waitcnt lgkmcnt(3)
  v_mfma_f32_32x32x16_bf16 v[20:35], v[144:147], v[84:87], v[20:35]
  ds_read_b128 v[72:75], v121 offset:33024
  buffer_load_dword v117, v9, s[4:7], s26 offen offset:2048 sc1
  v_cvt_pk_bf16_f32 v100, v52, v53
  v_cvt_pk_bf16_f32 v101, v54, v55
  v_mfma_f32_32x32x16_bf16 v[20:35], v[148:151], v[88:91], v[20:35]
  ds_read_b128 v[76:79], v122 offset:33024
  v_cvt_pk_bf16_f32 v102, v60, v61
  v_cvt_pk_bf16_f32 v103, v62, v63
  s_waitcnt lgkmcnt(3)
  v_mfma_f32_32x32x16_bf16 v[20:35], v[152:155], v[92:95], v[20:35]
  ds_read_b128 v[80:83], v123 offset:33024
  buffer_store_dwordx4 v[100:103], v8, s[4:7], s43 offen offset:0 sc1
  v_cvt_pk_bf16_f32 v104, v56, v57
  v_cvt_pk_bf16_f32 v105, v58, v59
  v_mfma_f32_32x32x16_bf16 v[20:35], v[156:159], v[96:99], v[20:35]
  ds_read_b128 v[84:87], v124 offset:33024
  v_cvt_pk_bf16_f32 v106, v64, v65
  v_cvt_pk_bf16_f32 v107, v66, v67
  s_waitcnt lgkmcnt(3)
  v_mfma_f32_32x32x16_bf16 v[20:35], v[160:163], v[68:71], v[20:35]
  ds_read_b128 v[88:91], v125 offset:33024
  buffer_store_dwordx4 v[104:107], v8, s[4:7], s43 offen offset:512 sc1
  s_lshl_b32 s52, s46, 7
  s_add_u32 s52, s52, s57
  v_mfma_f32_32x32x16_bf16 v[20:35], v[164:167], v[72:75], v[20:35]
  ds_read_b128 v[92:95], v126 offset:33024
  s_lshl_b32 s44, s52, 12
  s_add_u32 s44, s44, 41943040
  s_lshl_b32 s43, s52, 11
  s_add_u32 s43, s43, 142606336
  s_lshl_b32 s51, s52, 5
  s_waitcnt lgkmcnt(3)
  v_mfma_f32_32x32x16_bf16 v[20:35], v[168:171], v[76:79], v[20:35]
  ds_read_b128 v[96:99], v127 offset:33024
  s_add_u32 s51, s51, 243662848
  v_mfma_f32_32x32x16_bf16 v[20:35], v[172:175], v[80:83], v[20:35]
  ds_read_b128 v[68:71], v120 offset:33280
  s_waitcnt lgkmcnt(3)
  v_mfma_f32_32x32x16_bf16 v[20:35], v[176:179], v[84:87], v[20:35]
  ds_read_b128 v[72:75], v121 offset:33280
  v_mfma_f32_32x32x16_bf16 v[20:35], v[180:183], v[88:91], v[20:35]
  ds_read_b128 v[76:79], v122 offset:33280
  s_waitcnt lgkmcnt(3)
  v_mfma_f32_32x32x16_bf16 v[20:35], v[184:187], v[92:95], v[20:35]
  ds_read_b128 v[80:83], v123 offset:33280
  v_mfma_f32_32x32x16_bf16 v[20:35], v[188:191], v[96:99], v[20:35]
  ds_read_b128 v[84:87], v124 offset:33280
  s_waitcnt lgkmcnt(3)
  v_mfma_f32_32x32x16_bf16 v[20:35], v[192:195], v[68:71], v[20:35]
  ds_read_b128 v[88:91], v125 offset:33280
  s_waitcnt vmcnt(2)
  v_min_u32 v2, v116, v117
  v_max_u32 v116, v116, v117
  v_cmp_eq_u32 vcc, 0, v2
  s_nop 0
  v_max_u32_dpp v116, v116, v116 row_ror:8 row_mask:0xf bank_mask:0xf
  v_mfma_f32_32x32x16_bf16 v[20:35], v[196:199], v[72:75], v[20:35]
  ds_read_b128 v[92:95], v126 offset:33280
  s_nop 0
  v_max_u32_dpp v116, v116, v116 row_ror:4 row_mask:0xf bank_mask:0xf
  s_nop 0
  s_nop 0
  v_max_u32_dpp v116, v116, v116 row_ror:2 row_mask:0xf bank_mask:0xf
  s_nop 0
  s_waitcnt lgkmcnt(3)
  v_mfma_f32_32x32x16_bf16 v[20:35], v[200:203], v[76:79], v[20:35]
  ds_read_b128 v[96:99], v127 offset:33280
  v_max_u32_dpp v116, v116, v116 row_ror:1 row_mask:0xf bank_mask:0xf
  s_nop 0
  v_readlane_b32 s28, v116, 0
  v_readlane_b32 s29, v116, 16
  v_readlane_b32 s30, v116, 32
  v_mfma_f32_32x32x16_bf16 v[20:35], v[204:207], v[80:83], v[20:35]
  ds_read_b128 v[68:71], v120 offset:33536
  v_readlane_b32 s31, v116, 48
  s_max_u32 s28, s28, s29
  s_max_u32 s30, s30, s31
  s_max_u32 s28, s28, s30
  s_cmp_eq_u64 vcc, 0
  s_cselect_b32 s48, 1, 0
  s_waitcnt lgkmcnt(3)
  v_mfma_f32_32x32x16_bf16 v[20:35], v[208:211], v[84:87], v[20:35]
  ds_read_b128 v[72:75], v121 offset:33536
  s_bitcmp1_b32 s47, 6
  s_cselect_b32 s28, s28, 0
  s_max_u32 s56, s56, s28
  s_bfe_u32 s28, s56, 0x70005
  s_xor_b32 s28, s28, 63
  v_mfma_f32_32x32x16_bf16 v[20:35], v[212:215], v[88:91], v[20:35]
  ds_read_b128 v[76:79], v122 offset:33536
  s_cmp_eq_u32 s28, s47
  s_cselect_b32 s55, 1, 0
  s_cmp_lg_u32 s48, 0
  s_cselect_b32 s28, s47, s46
  s_and_b32 s63, s28, 127
  s_waitcnt lgkmcnt(3)
  v_mfma_f32_32x32x16_bf16 v[20:35], v[216:219], v[92:95], v[20:35]
  ds_read_b128 v[80:83], v123 offset:33536
  s_lshl_b32 s63, s63, 15
  s_xor_b32 s27, s50, 32768
  s_add_u32 m0, s27, s54
  s_add_u32 s63, s63, s54
  s_add_u32 s63, s63, 6291456
  v_mfma_f32_32x32x16_bf16 v[20:35], v[220:223], v[96:99], v[20:35]
  ds_read_b128 v[84:87], v124 offset:33536
  s_waitcnt lgkmcnt(3)
  v_mfma_f32_32x32x16_bf16 v[20:35], v[224:227], v[68:71], v[20:35]
  ds_read_b128 v[88:91], v125 offset:33536
  buffer_load_dwordx4 v12, s[4:7], s63 offen offset:0 sc1 lds
  v_mfma_f32_32x32x16_bf16 v[20:35], v[228:231], v[72:75], v[20:35]
  ds_read_b128 v[92:95], v126 offset:33536
  s_waitcnt lgkmcnt(3)
  v_mfma_f32_32x32x16_bf16 v[20:35], v[232:235], v[76:79], v[20:35]
  ds_read_b128 v[96:99], v127 offset:33536
  buffer_load_dwordx4 v13, s[4:7], s63 offen offset:1024 sc1 lds
  v_mfma_f32_32x32x16_bf16 v[20:35], v[236:239], v[80:83], v[20:35]
  ds_read_b128 v[68:71], v120 offset:32768
  s_waitcnt lgkmcnt(3)
  v_mfma_f32_32x32x16_bf16 v[20:35], v[240:243], v[84:87], v[20:35]
  ds_read_b128 v[72:75], v121 offset:32768
  buffer_load_dwordx4 v14, s[4:7], s63 offen offset:2048 sc1 lds
  v_mfma_f32_32x32x16_bf16 v[20:35], v[244:247], v[88:91], v[20:35]
  ds_read_b128 v[76:79], v122 offset:32768
  s_waitcnt lgkmcnt(3)
  v_mfma_f32_32x32x16_bf16 v[20:35], v[248:251], v[92:95], v[20:35]
  ds_read_b128 v[80:83], v123 offset:32768
  buffer_load_dwordx4 v15, s[4:7], s63 offen offset:3072 sc1 lds
  s_add_u32 m0, m0, 4096
  s_add_u32 s63, s63, 4096
  v_mfma_f32_32x32x16_bf16 v[20:35], v[252:255], v[96:99], v[20:35]
  ds_read_b128 v[84:87], v124 offset:32768
  s_waitcnt lgkmcnt(3)
  v_mfma_f32_32x32x16_bf16 v[36:51], v[68:71], a[0:3], 0
  ds_read_b128 v[88:91], v125 offset:32768
  buffer_load_dwordx4 v16, s[4:7], s63 offen offset:0 sc1 lds
  v_mfma_f32_32x32x16_bf16 v[36:51], v[72:75], a[4:7], v[36:51]
  ds_read_b128 v[92:95], v126 offset:32768
  s_waitcnt lgkmcnt(3)
  v_mfma_f32_32x32x16_bf16 v[36:51], v[76:79], a[8:11], v[36:51]
  ds_read_b128 v[96:99], v127 offset:32768
  buffer_load_dwordx4 v17, s[4:7], s63 offen offset:1024 sc1 lds
  v_mfma_f32_32x32x16_bf16 v[36:51], v[80:83], a[12:15], v[36:51]
  ds_read_b128 v[68:71], v120 offset:33024
  s_waitcnt lgkmcnt(3)
  v_mfma_f32_32x32x16_bf16 v[36:51], v[84:87], a[16:19], v[36:51]
  ds_read_b128 v[72:75], v121 offset:33024
  buffer_load_dwordx4 v18, s[4:7], s63 offen offset:2048 sc1 lds
  v_mfma_f32_32x32x16_bf16 v[36:51], v[88:91], a[20:23], v[36:51]
  ds_read_b128 v[76:79], v122 offset:33024
  s_waitcnt lgkmcnt(3)
  v_mfma_f32_32x32x16_bf16 v[36:51], v[92:95], a[24:27], v[36:51]
  ds_read_b128 v[80:83], v123 offset:33024
  buffer_load_dwordx4 v19, s[4:7], s63 offen offset:3072 sc1 lds
  v_mfma_f32_32x32x16_bf16 v[36:51], v[96:99], a[28:31], v[36:51]
  ds_read_b128 v[84:87], v124 offset:33024
  s_waitcnt lgkmcnt(3)
  v_mfma_f32_32x32x16_bf16 v[36:51], v[68:71], a[32:35], v[36:51]
  ds_read_b128 v[88:91], v125 offset:33024
  v_mfma_f32_32x32x16_bf16 v[36:51], v[72:75], a[36:39], v[36:51]
  ds_read_b128 v[92:95], v126 offset:33024
  s_waitcnt lgkmcnt(3)
  v_mfma_f32_32x32x16_bf16 v[36:51], v[76:79], a[40:43], v[36:51]
  ds_read_b128 v[96:99], v127 offset:33024
  v_mfma_f32_32x32x16_bf16 v[36:51], v[80:83], a[44:47], v[36:51]
  ds_read_b128 v[68:71], v120 offset:33280
  s_waitcnt lgkmcnt(3)
  v_mfma_f32_32x32x16_bf16 v[36:51], v[84:87], a[48:51], v[36:51]
  ds_read_b128 v[72:75], v121 offset:33280
  s_waitcnt vmcnt(8)
  s_mov_b64 exec, 1
  buffer_store_dword v4, off, s[4:7], s49 sc1
  s_mov_b64 exec, -1
  v_mfma_f32_32x32x16_bf16 v[36:51], v[88:91], a[52:55], v[36:51]
  ds_read_b128 v[76:79], v122 offset:33280
  s_add_u32 s49, s51, 16
  s_or_b32 s26, s55, s62
  s_lshr_b32 s27, s47, 7
  s_or_b32 s26, s26, s27
  s_sub_u32 s27, s47, s60
  s_waitcnt lgkmcnt(3)
  v_mfma_f32_32x32x16_bf16 v[36:51], v[92:95], a[56:59], v[36:51]
  ds_read_b128 v[80:83], v123 offset:33280
  s_cmp_eq_u32 s27, 9
  s_cselect_b32 s26, 1, s26
  s_andn2_b32 s26, s48, s26
  v_mov_b32 v2, s26
  s_add_u32 s26, s62, 1
  v_mfma_f32_32x32x16_bf16 v[36:51], v[96:99], a[60:63], v[36:51]
  ds_read_b128 v[84:87], v124 offset:33280
  v_mov_b32 v4, s26
  ds_write_b32 v118, v2 offset:16
  v_mul_f32 v20, s24, v20
  v_mul_f32 v21, s24, v21
  v_mul_f32 v22, s24, v22
  s_waitcnt lgkmcnt(4)
  v_mfma_f32_32x32x16_bf16 v[36:51], v[68:71], a[64:67], v[36:51]
  ds_read_b128 v[88:91], v125 offset:33280
  v_mul_f32 v23, s24, v23
  v_mul_f32 v24, s24, v24
  v_mul_f32 v25, s24, v25
  v_mul_f32 v26, s24, v26
  v_mul_f32 v27, s24, v27
  v_mfma_f32_32x32x16_bf16 v[36:51], v[72:75], a[68:71], v[36:51]
  ds_read_b128 v[92:95], v126 offset:33280
  v_mul_f32 v28, s24, v28
  v_mul_f32 v29, s24, v29
  v_mul_f32 v30, s24, v30
  v_mul_f32 v31, s24, v31
  v_mul_f32 v32, s24, v32
  s_waitcnt lgkmcnt(4)
  v_mfma_f32_32x32x16_bf16 v[36:51], v[76:79], a[72:75], v[36:51]
  ds_read_b128 v[96:99], v127 offset:33280
  v_mul_f32 v33, s24, v33
  v_mul_f32 v34, s24, v34
  v_mul_f32 v35, s24, v35
  v_cvt_pk_bf16_f32 v108, v20, v21
  v_cvt_pk_bf16_f32 v109, v22, v23
  v_mfma_f32_32x32x16_bf16 v[36:51], v[80:83], a[76:79], v[36:51]
  ds_read_b128 v[68:71], v120 offset:33536
  v_cvt_pk_bf16_f32 v110, v28, v29
  v_cvt_pk_bf16_f32 v111, v30, v31
  s_waitcnt lgkmcnt(3)
  v_mfma_f32_32x32x16_bf16 v[36:51], v[84:87], a[80:83], v[36:51]
  ds_read_b128 v[72:75], v121 offset:33536
  buffer_store_dwordx4 v[108:111], v8, s[4:7], s44 offen offset:0 sc1
  v_cvt_pk_bf16_f32 v112, v24, v25
  v_cvt_pk_bf16_f32 v113, v26, v27
  v_mfma_f32_32x32x16_bf16 v[36:51], v[88:91], a[84:87], v[36:51]
  ds_read_b128 v[76:79], v122 offset:33536
  v_cvt_pk_bf16_f32 v114, v32, v33
  v_cvt_pk_bf16_f32 v115, v34, v35
  s_waitcnt lgkmcnt(3)
  v_mfma_f32_32x32x16_bf16 v[36:51], v[92:95], a[88:91], v[36:51]
  ds_read_b128 v[80:83], v123 offset:33536
  buffer_store_dwordx4 v[112:115], v8, s[4:7], s44 offen offset:512 sc1
  v_mfma_f32_32x32x16_bf16 v[36:51], v[96:99], a[92:95], v[36:51]
  ds_read_b128 v[84:87], v124 offset:33536
  s_waitcnt lgkmcnt(3)
  v_mfma_f32_32x32x16_bf16 v[36:51], v[68:71], a[96:99], v[36:51]
  ds_read_b128 v[88:91], v125 offset:33536
  v_mfma_f32_32x32x16_bf16 v[36:51], v[72:75], a[100:103], v[36:51]
  ds_read_b128 v[92:95], v126 offset:33536
  s_waitcnt lgkmcnt(3)
  v_mfma_f32_32x32x16_bf16 v[36:51], v[76:79], a[104:107], v[36:51]
  ds_read_b128 v[96:99], v127 offset:33536
  v_mfma_f32_32x32x16_bf16 v[36:51], v[80:83], a[108:111], v[36:51]
  ds_read_b128 v[68:71], v120 offset:32768
  s_waitcnt lgkmcnt(3)
  v_mfma_f32_32x32x16_bf16 v[36:51], v[84:87], a[112:115], v[36:51]
  ds_read_b128 v[72:75], v121 offset:32768
  v_mfma_f32_32x32x16_bf16 v[36:51], v[88:91], a[116:119], v[36:51]
  ds_read_b128 v[76:79], v122 offset:32768
  s_waitcnt lgkmcnt(3)
  v_mfma_f32_32x32x16_bf16 v[36:51], v[92:95], a[120:123], v[36:51]
  ds_read_b128 v[80:83], v123 offset:32768
  v_mfma_f32_32x32x16_bf16 v[36:51], v[96:99], a[124:127], v[36:51]
  ds_read_b128 v[84:87], v124 offset:32768
  s_waitcnt lgkmcnt(3)
  v_mfma_f32_32x32x16_bf16 v[52:67], a[128:131], v[68:71], 0
  ds_read_b128 v[88:91], v125 offset:32768
  v_mfma_f32_32x32x16_bf16 v[52:67], a[132:135], v[72:75], v[52:67]
  ds_read_b128 v[92:95], v126 offset:32768
  s_waitcnt lgkmcnt(3)
  v_mfma_f32_32x32x16_bf16 v[52:67], a[136:139], v[76:79], v[52:67]
  ds_read_b128 v[96:99], v127 offset:32768
  v_mfma_f32_32x32x16_bf16 v[52:67], a[140:143], v[80:83], v[52:67]
  ds_read_b128 v[68:71], v120 offset:33024
  s_nop 0
  v_cvt_pk_bf16_f32 v100, v36, v37
  v_cvt_pk_bf16_f32 v101, v38, v39
  v_cvt_pk_bf16_f32 v102, v44, v45
  v_cvt_pk_bf16_f32 v103, v46, v47
  s_waitcnt lgkmcnt(3)
  v_mfma_f32_32x32x16_bf16 v[52:67], a[144:147], v[84:87], v[52:67]
  ds_read_b128 v[72:75], v121 offset:33024
  buffer_store_dwordx4 v[100:103], v8, s[4:7], s44 offen offset:2048 sc1
  v_cvt_pk_bf16_f32 v104, v40, v41
  v_cvt_pk_bf16_f32 v105, v42, v43
  v_mfma_f32_32x32x16_bf16 v[52:67], a[148:151], v[88:91], v[52:67]
  ds_read_b128 v[76:79], v122 offset:33024
  v_cvt_pk_bf16_f32 v106, v48, v49
  v_cvt_pk_bf16_f32 v107, v50, v51
  s_waitcnt lgkmcnt(3)
  v_mfma_f32_32x32x16_bf16 v[52:67], a[152:155], v[92:95], v[52:67]
  ds_read_b128 v[80:83], v123 offset:33024
  buffer_store_dwordx4 v[104:107], v8, s[4:7], s44 offen offset:2560 sc1
  s_cmp_lt_u32 s40, 64
  s_cselect_b32 s42, s42, 0
  s_cmp_lg_u32 s42, 0
  s_cselect_b32 s76, s40, s41
  s_cselect_b32 s26, 3, 0
  s_cselect_b32 s42, s42, 2
  v_mfma_f32_32x32x16_bf16 v[52:67], a[156:159], v[96:99], v[52:67]
  ds_read_b128 v[84:87], v124 offset:33024
  s_sub_u32 s42, s42, 1
  s_add_u32 s40, s40, s26
  s_xor_b32 s26, s26, 3
  s_add_u32 s41, s41, s26
  s_waitcnt lgkmcnt(3)
  v_mfma_f32_32x32x16_bf16 v[52:67], a[160:163], v[68:71], v[52:67]
  ds_read_b128 v[88:91], v125 offset:33024
  v_mfma_f32_32x32x16_bf16 v[52:67], a[164:167], v[72:75], v[52:67]
  ds_read_b128 v[92:95], v126 offset:33024
  s_waitcnt lgkmcnt(3)
  v_mfma_f32_32x32x16_bf16 v[52:67], a[168:171], v[76:79], v[52:67]
  ds_read_b128 v[96:99], v127 offset:33024
  v_mfma_f32_32x32x16_bf16 v[52:67], a[172:175], v[80:83], v[52:67]
  ds_read_b128 v[68:71], v120 offset:33280
  s_waitcnt lgkmcnt(3)
  v_mfma_f32_32x32x16_bf16 v[52:67], a[176:179], v[84:87], v[52:67]
  ds_read_b128 v[72:75], v121 offset:33280
  v_mfma_f32_32x32x16_bf16 v[52:67], a[180:183], v[88:91], v[52:67]
  ds_read_b128 v[76:79], v122 offset:33280
  s_waitcnt lgkmcnt(3)
  v_mfma_f32_32x32x16_bf16 v[52:67], a[184:187], v[92:95], v[52:67]
  ds_read_b128 v[80:83], v123 offset:33280
  v_mfma_f32_32x32x16_bf16 v[52:67], a[188:191], v[96:99], v[52:67]
  ds_read_b128 v[84:87], v124 offset:33280
  s_waitcnt lgkmcnt(3)
  v_mfma_f32_32x32x16_bf16 v[52:67], a[192:195], v[68:71], v[52:67]
  ds_read_b128 v[88:91], v125 offset:33280
  v_mfma_f32_32x32x16_bf16 v[52:67], a[196:199], v[72:75], v[52:67]
  ds_read_b128 v[92:95], v126 offset:33280
  s_waitcnt lgkmcnt(3)
  v_mfma_f32_32x32x16_bf16 v[52:67], a[200:203], v[76:79], v[52:67]
  ds_read_b128 v[96:99], v127 offset:33280
  v_mfma_f32_32x32x16_bf16 v[52:67], a[204:207], v[80:83], v[52:67]
  ds_read_b128 v[68:71], v120 offset:33536
  s_waitcnt lgkmcnt(3)
  v_mfma_f32_32x32x16_bf16 v[52:67], a[208:211], v[84:87], v[52:67]
  ds_read_b128 v[72:75], v121 offset:33536
  v_mfma_f32_32x32x16_bf16 v[52:67], a[212:215], v[88:91], v[52:67]
  ds_read_b128 v[76:79], v122 offset:33536
  ds_read_b128 v[80:83], v123 offset:33536
  s_waitcnt lgkmcnt(4)
  v_mfma_f32_32x32x16_bf16 v[52:67], a[216:219], v[92:95], v[52:67]
  ds_read_b128 v[84:87], v124 offset:33536
  ds_read_b128 v[88:91], v125 offset:33536
  v_mfma_f32_32x32x16_bf16 v[52:67], a[220:223], v[96:99], v[52:67]
  ds_read_b128 v[92:95], v126 offset:33536
  ds_read_b128 v[96:99], v127 offset:33536
  s_waitcnt lgkmcnt(6)
  v_mfma_f32_32x32x16_bf16 v[52:67], a[224:227], v[68:71], v[52:67]
  v_mfma_f32_32x32x16_bf16 v[52:67], a[228:231], v[72:75], v[52:67]
  s_waitcnt lgkmcnt(4)
  v_mfma_f32_32x32x16_bf16 v[52:67], a[232:235], v[76:79], v[52:67]
  s_waitcnt vmcnt(5) lgkmcnt(0)
  s_barrier
  ds_read_b128 v[108:111], v119 offset:16
  v_mfma_f32_32x32x16_bf16 v[52:67], a[236:239], v[80:83], v[52:67]
  ds_read_b128 v[68:71], v120 offset:0
  v_mfma_f32_32x32x16_bf16 v[52:67], a[240:243], v[84:87], v[52:67]
  ds_read_b128 v[72:75], v121 offset:0
  s_xor_b32 s50, s50, 32768
  v_mfma_f32_32x32x16_bf16 v[52:67], a[244:247], v[88:91], v[52:67]
  ds_read_b128 v[76:79], v122 offset:0
  s_waitcnt vmcnt(0)
  s_mov_b64 exec, 1
  buffer_store_dword v4, off, s[4:7], s51 sc1
  s_mov_b64 exec, -1
  v_mfma_f32_32x32x16_bf16 v[52:67], a[248:251], v[92:95], v[52:67]
  ds_read_b128 v[80:83], v123 offset:0
  s_waitcnt lgkmcnt(4)
  v_and_b32 v108, v108, v109
  v_and_b32 v110, v110, v111
  v_and_b32 v108, v108, v110
  s_nop 0
  v_readfirstlane_b32 s45, v108
  v_mfma_f32_32x32x16_bf16 v[52:67], a[252:255], v[96:99], v[52:67]
  s_cmp_lg_u32 s45, 0
  s_cbranch_scc1 q_w0_65
  s_branch q_slow_54
q_fork_61:
  s_mov_b32 s58, s56
  s_mov_b32 s62, 1
  s_mov_b32 s77, s40
  s_mov_b32 s78, s41
  s_mov_b32 s79, s42
  s_load_dwordx2 s[64:65], s[0:1], 72
  s_load_dwordx2 s[68:69], s[0:1], 80
  s_load_dwordx2 s[8:9], s[0:1], 88
  s_mov_b32 s66, 1835008
  s_mov_b32 s70, 1835008
  s_mov_b32 s10, 1835008
  v_lshrrev_b32 v2, 8, v0
  v_and_b32 v3, 0x70, v0
  s_mov_b32 s26, 114688
  v_mul_lo_u32 v6, v2, s26
  v_add_u32 v6, v6, v3
  v_cmp_eq_u32 vcc, 0x70, v3
  v_mov_b32 v3, 0x7ff00000
  s_nop 0
  v_cndmask_b32 v6, v6, v3, vcc
  v_mul_u32_u24 v7, 14336, v2
  v_and_b32 v3, 0xf0, v0
  v_add_u32 v7, v7, v3
  s_mul_i32 s34, s17, 458752
  s_mul_i32 s27, s16, 112
  s_add_u32 s34, s34, s27
  s_add_u32 s34, s34, 82432
  s_mul_i32 s35, s16, 57344
  s_lshl_b32 s27, s17, 8
  s_add_u32 s35, s35, s27
  s_mov_b32 s36, 0x00ff00ff
  s_mov_b32 s37, 0x00ff00ff
  s_waitcnt lgkmcnt(0)
  s_andn2_b32 s59, 0xfff, s58
  s_lshl_b32 s26, s61, 21
  s_lshl_b32 s27, s59, 10
  s_add_u32 s26, s26, s27
  s_lshl_b32 s27, s17, 8
  s_add_u32 s26, s26, s27
  s_add_u32 s26, s26, 27262976
  v_lshrrev_b32 v3, 8, v0
  v_lshlrev_b32 v3, 6, v3
  buffer_load_dwordx4 v[36:39], v3, s[4:7], s26 offen offset:0 sc1
  buffer_load_dwordx4 v[40:43], v3, s[4:7], s26 offen offset:16 sc1
  buffer_load_dwordx4 v[44:47], v3, s[4:7], s26 offen offset:32 sc1
  buffer_load_dwordx4 v[48:51], v3, s[4:7], s26 offen offset:48 sc1
  s_mov_b64 exec, s[36:37]
  buffer_load_dwordx4 v[64:67], v6, s[64:67], s34 offen
  s_not_b64 exec, exec
  buffer_load_dwordx4 v[64:67], v6, s[68:71], s34 offen
  s_mov_b64 exec, -1
  s_add_u32 s34, s34, 3584
  s_mov_b64 exec, s[36:37]
  buffer_load_dwordx4 v[68:71], v6, s[64:67], s34 offen
  s_not_b64 exec, exec
  buffer_load_dwordx4 v[68:71], v6, s[68:71], s34 offen
  s_mov_b64 exec, -1
  s_add_u32 s34, s34, 3584
  s_mov_b64 exec, s[36:37]
  buffer_load_dwordx4 v[72:75], v6, s[64:67], s34 offen
  s_not_b64 exec, exec
  buffer_load_dwordx4 v[72:75], v6, s[68:71], s34 offen
  s_mov_b64 exec, -1
  s_add_u32 s34, s34, 3584
  s_mov_b64 exec, s[36:37]
  buffer_load_dwordx4 v[76:79], v6, s[64:67], s34 offen
  s_not_b64 exec, exec
  buffer_load_dwordx4 v[76:79], v6, s[68:71], s34 offen
  s_mov_b64 exec, -1
  s_add_u32 s34, s34, 3584
  s_mov_b64 exec, s[36:37]
  buffer_load_dwordx4 v[80:83], v6, s[64:67], s34 offen
  s_not_b64 exec, exec
  buffer_load_dwordx4 v[80:83], v6, s[68:71], s34 offen
  s_mov_b64 exec, -1
  s_add_u32 s34, s34, 3584
  s_mov_b64 exec, s[36:37]
  buffer_load_dwordx4 v[84:87], v6, s[64:67], s34 offen
  s_not_b64 exec, exec
  buffer_load_dwordx4 v[84:87], v6, s[68:71], s34 offen
  s_mov_b64 exec, -1
  s_add_u32 s34, s34, 3584
  s_mov_b64 exec, s[36:37]
  buffer_load_dwordx4 v[88:91], v6, s[64:67], s34 offen
  s_not_b64 exec, exec
  buffer_load_dwordx4 v[88:91], v6, s[68:71], s34 offen
  s_mov_b64 exec, -1
  s_add_u32 s34, s34, 3584
  s_mov_b64 exec, s[36:37]
  buffer_load_dwordx4 v[92:95], v6, s[64:67], s34 offen
  s_not_b64 exec, exec
  buffer_load_dwordx4 v[92:95], v6, s[68:71], s34 offen
  s_mov_b64 exec, -1
  s_add_u32 s34, s34, 3584
  s_mov_b64 exec, s[36:37]
  buffer_load_dwordx4 v[96:99], v6, s[64:67], s34 offen
  s_not_b64 exec, exec
  buffer_load_dwordx4 v[96:99], v6, s[68:71], s34 offen
  s_mov_b64 exec, -1
  s_add_u32 s34, s34, 3584
  buffer_load_dwordx4 v[100:103], v7, s[8:11], s35 offen offset:0
  buffer_load_dwordx4 v[104:107], v7, s[8:11], s35 offen offset:1024
  buffer_load_dwordx4 v[108:111], v7, s[8:11], s35 offen offset:2048
  buffer_load_dwordx4 v[112:115], v7, s[8:11], s35 offen offset:3072
  s_add_u32 s35, s35, 4096
  s_mov_b32 vcc_lo, 0xaaaaaaaa
  s_mov_b32 vcc_hi, 0xaaaaaaaa
  v_mov_b32 v3, 0xffff
  v_mov_b32 v28, 0xffff0000
  v_cndmask_b32 v3, v3, v28, vcc
  s_mov_b32 vcc_lo, 0x30003
  s_mov_b32 vcc_hi, 0x30003
  v_cndmask_b32 v28, 0, v3, vcc
  s_mov_b32 vcc_lo, 0xc000c
  s_mov_b32 vcc_hi, 0xc000c
  v_cndmask_b32 v29, 0, v3, vcc
  s_mov_b32 vcc_lo, 0x300030
  s_mov_b32 vcc_hi, 0x300030
  v_cndmask_b32 v30, 0, v3, vcc
  s_mov_b32 vcc_lo, 0xc000c0
  s_mov_b32 vcc_hi, 0xc000c0
  v_cndmask_b32 v31, 0, v3, vcc
  s_mov_b32 s30, 0x01000100
  s_mov_b32 s31, 0x03020302
  s_mul_i32 s26, s17, 23552
  s_add_u32 s26, s26, 65536
  v_add_u32 v5, s26, v0
  ds_read_b128 v[52:55], v5 offset:0
  ds_read_b128 v[56:59], v5 offset:1024
  ds_read_b128 v[60:63], v5 offset:2048
  s_waitcnt vmcnt(22)
  v_perm_b32 v3, v36, v36, s30
  v_and_b32 v20, v28, v3
  v_and_b32 v21, v29, v3
  v_and_b32 v22, v30, v3
  v_and_b32 v23, v31, v3
  s_waitcnt lgkmcnt(2)
  s_nop 0
  v_mfma_f32_16x16x32_bf16 v[32:35], v[20:23], v[52:55], 0
  ds_read_b128 v[52:55], v5 offset:3072
  v_perm_b32 v3, v36, v36, s31
  v_and_b32 v24, v28, v3
  v_and_b32 v25, v29, v3
  v_and_b32 v26, v30, v3
  v_and_b32 v27, v31, v3
  s_waitcnt lgkmcnt(2)
  s_nop 0
  v_mfma_f32_16x16x32_bf16 v[32:35], v[24:27], v[56:59], v[32:35]
  ds_read_b128 v[56:59], v5 offset:4096
  v_perm_b32 v3, v37, v37, s30
  v_and_b32 v20, v28, v3
  v_and_b32 v21, v29, v3
  v_and_b32 v22, v30, v3
  v_and_b32 v23, v31, v3
  s_waitcnt lgkmcnt(2)
  s_nop 0
  v_mfma_f32_16x16x32_bf16 v[32:35], v[20:23], v[60:63], v[32:35]
  ds_read_b128 v[60:63], v5 offset:5120
  v_perm_b32 v3, v37, v37, s31
  v_and_b32 v24, v28, v3
  v_and_b32 v25, v29, v3
  v_and_b32 v26, v30, v3
  v_and_b32 v27, v31, v3
  s_waitcnt lgkmcnt(2)
  s_nop 0
  v_mfma_f32_16x16x32_bf16 v[32:35], v[24:27], v[52:55], v[32:35]
  ds_read_b128 v[52:55], v5 offset:6144
  v_perm_b32 v3, v38, v38, s30
  v_and_b32 v20, v28, v3
  v_and_b32 v21, v29, v3
  v_and_b32 v22, v30, v3
  v_and_b32 v23, v31, v3
  s_waitcnt lgkmcnt(2)
  s_nop 0
  v_mfma_f32_16x16x32_bf16 v[32:35], v[20:23], v[56:59], v[32:35]
  ds_read_b128 v[56:59], v5 offset:7168
  v_perm_b32 v3, v38, v38, s31
  v_and_b32 v24, v28, v3
  v_and_b32 v25, v29, v3
  v_and_b32 v26, v30, v3
  v_and_b32 v27, v31, v3
  s_waitcnt lgkmcnt(2)
  s_nop 0
  v_mfma_f32_16x16x32_bf16 v[32:35], v[24:27], v[60:63], v[32:35]
  ds_read_b128 v[60:63], v5 offset:8192
  v_perm_b32 v3, v39, v39, s30
  v_and_b32 v20, v28, v3
  v_and_b32 v21, v29, v3
  v_and_b32 v22, v30, v3
  v_and_b32 v23, v31, v3
  s_waitcnt lgkmcnt(2)
  s_nop 0
  v_mfma_f32_16x16x32_bf16 v[32:35], v[20:23], v[52:55], v[32:35]
  ds_read_b128 v[52:55], v5 offset:9216
  v_perm_b32 v3, v39, v39, s31
  v_and_b32 v24, v28, v3
  v_and_b32 v25, v29, v3
  v_and_b32 v26, v30, v3
  v_and_b32 v27, v31, v3
  s_waitcnt lgkmcnt(2)
  s_nop 0
  v_mfma_f32_16x16x32_bf16 v[32:35], v[24:27], v[56:59], v[32:35]
  ds_read_b128 v[56:59], v5 offset:10240
  v_perm_b32 v3, v40, v40, s30
  v_and_b32 v20, v28, v3
  v_and_b32 v21, v29, v3
  v_and_b32 v22, v30, v3
  v_and_b32 v23, v31, v3
  s_waitcnt lgkmcnt(2)
  s_nop 0
  v_mfma_f32_16x16x32_bf16 v[32:35], v[20:23], v[60:63], v[32:35]
  ds_read_b128 v[60:63], v5 offset:11264
  v_perm_b32 v3, v40, v40, s31
  v_and_b32 v24, v28, v3
  v_and_b32 v25, v29, v3
  v_and_b32 v26, v30, v3
  v_and_b32 v27, v31, v3
  s_waitcnt lgkmcnt(2)
  s_nop 0
  v_mfma_f32_16x16x32_bf16 v[32:35], v[24:27], v[52:55], v[32:35]
  ds_read_b128 v[52:55], v5 offset:12288
  v_perm_b32 v3, v41, v41, s30
  v_and_b32 v20, v28, v3
  v_and_b32 v21, v29, v3
  v_and_b32 v22, v30, v3
  v_and_b32 v23, v31, v3
  s_waitcnt lgkmcnt(2)
  s_nop 0
  v_mfma_f32_16x16x32_bf16 v[32:35], v[20:23], v[56:59], v[32:35]
  ds_read_b128 v[56:59], v5 offset:13312
  v_perm_b32 v3, v41, v41, s31
  v_and_b32 v24, v28, v3
  v_and_b32 v25, v29, v3
  v_and_b32 v26, v30, v3
  v_and_b32 v27, v31, v3
  s_waitcnt lgkmcnt(2)
  s_nop 0
  v_mfma_f32_16x16x32_bf16 v[32:35], v[24:27], v[60:63], v[32:35]
  ds_read_b128 v[60:63], v5 offset:14336
  v_perm_b32 v3, v42, v42, s30
  v_and_b32 v20, v28, v3
  v_and_b32 v21, v29, v3
  v_and_b32 v22, v30, v3
  v_and_b32 v23, v31, v3
  s_waitcnt lgkmcnt(2)
  s_nop 0
  v_mfma_f32_16x16x32_bf16 v[32:35], v[20:23], v[52:55], v[32:35]
  ds_read_b128 v[52:55], v5 offset:15360
  v_perm_b32 v3, v42, v42, s31
  v_and_b32 v24, v28, v3
  v_and_b32 v25, v29, v3
  v_and_b32 v26, v30, v3
  v_and_b32 v27, v31, v3
  s_waitcnt lgkmcnt(2)
  s_nop 0
  v_mfma_f32_16x16x32_bf16 v[32:35], v[24:27], v[56:59], v[32:35]
  ds_read_b128 v[56:59], v5 offset:16384
  v_perm_b32 v3, v43, v43, s30
  v_and_b32 v20, v28, v3
  v_and_b32 v21, v29, v3
  v_and_b32 v22, v30, v3
  v_and_b32 v23, v31, v3
  s_waitcnt lgkmcnt(2)
  s_nop 0
  v_mfma_f32_16x16x32_bf16 v[32:35], v[20:23], v[60:63], v[32:35]
  ds_read_b128 v[60:63], v5 offset:17408
  v_perm_b32 v3, v43, v43, s31
  v_and_b32 v24, v28, v3
  v_and_b32 v25, v29, v3
  v_and_b32 v26, v30, v3
  v_and_b32 v27, v31, v3
  s_waitcnt lgkmcnt(2)
  s_nop 0
  v_mfma_f32_16x16x32_bf16 v[32:35], v[24:27], v[52:55], v[32:35]
  ds_read_b128 v[52:55], v5 offset:18432
  v_perm_b32 v3, v44, v44, s30
  v_and_b32 v20, v28, v3
  v_and_b32 v21, v29, v3
  v_and_b32 v22, v30, v3
  v_and_b32 v23, v31, v3
  s_waitcnt lgkmcnt(2)
  s_nop 0
  v_mfma_f32_16x16x32_bf16 v[32:35], v[20:23], v[56:59], v[32:35]
  ds_read_b128 v[56:59], v5 offset:19456
  v_perm_b32 v3, v44, v44, s31
  v_and_b32 v24, v28, v3
  v_and_b32 v25, v29, v3
  v_and_b32 v26, v30, v3
  v_and_b32 v27, v31, v3
  s_waitcnt lgkmcnt(2)
  s_nop 0
  v_mfma_f32_16x16x32_bf16 v[32:35], v[24:27], v[60:63], v[32:35]
  ds_read_b128 v[60:63], v5 offset:20480
  v_perm_b32 v3, v45, v45, s30
  v_and_b32 v20, v28, v3
  v_and_b32 v21, v29, v3
  v_and_b32 v22, v30, v3
  v_and_b32 v23, v31, v3
  s_waitcnt lgkmcnt(2)
  s_nop 0
  v_mfma_f32_16x16x32_bf16 v[32:35], v[20:23], v[52:55], v[32:35]
  ds_read_b128 v[52:55], v5 offset:21504
  v_perm_b32 v3, v45, v45, s31
  v_and_b32 v24, v28, v3
  v_and_b32 v25, v29, v3
  v_and_b32 v26, v30, v3
  v_and_b32 v27, v31, v3
  s_waitcnt lgkmcnt(2)
  s_nop 0
  v_mfma_f32_16x16x32_bf16 v[32:35], v[24:27], v[56:59], v[32:35]
  ds_read_b128 v[56:59], v5 offset:22528
  v_perm_b32 v3, v46, v46, s30
  v_and_b32 v20, v28, v3
  v_and_b32 v21, v29, v3
  v_and_b32 v22, v30, v3
  v_and_b32 v23, v31, v3
  s_waitcnt lgkmcnt(2)
  s_nop 0
  v_mfma_f32_16x16x32_bf16 v[32:35], v[20:23], v[60:63], v[32:35]
  buffer_load_dwordx4 v[60:63], v7, s[8:11], s35 offen offset:0
  v_perm_b32 v3, v46, v46, s31
  v_and_b32 v24, v28, v3
  v_and_b32 v25, v29, v3
  v_and_b32 v26, v30, v3
  v_and_b32 v27, v31, v3
  s_waitcnt lgkmcnt(1)
  s_nop 0
  v_mfma_f32_16x16x32_bf16 v[32:35], v[24:27], v[52:55], v[32:35]
  buffer_load_dwordx4 v[52:55], v7, s[8:11], s35 offen offset:1024
  v_perm_b32 v3, v47, v47, s30
  v_and_b32 v20, v28, v3
  v_and_b32 v21, v29, v3
  v_and_b32 v22, v30, v3
  v_and_b32 v23, v31, v3
  s_waitcnt lgkmcnt(0)
  s_nop 0
  v_mfma_f32_16x16x32_bf16 v[32:35], v[20:23], v[56:59], v[32:35]
  buffer_load_dwordx4 v[56:59], v7, s[8:11], s35 offen offset:2048
  v_perm_b32 v3, v47, v47, s31
  v_and_b32 v24, v28, v3
  v_and_b32 v25, v29, v3
  v_and_b32 v26, v30, v3
  v_and_b32 v27, v31, v3
  s_waitcnt vmcnt(23)
  s_nop 0
  v_mfma_f32_16x16x32_bf16 v[32:35], v[24:27], v[64:67], v[32:35]
  buffer_load_dwordx4 v[64:67], v7, s[8:11], s35 offen offset:3072
  s_add_u32 s35, s35, 4096
  v_perm_b32 v3, v48, v48, s30
  v_and_b32 v20, v28, v3
  v_and_b32 v21, v29, v3
  v_and_b32 v22, v30, v3
  v_and_b32 v23, v31, v3
  s_waitcnt vmcnt(22)
  s_nop 0
  v_mfma_f32_16x16x32_bf16 v[32:35], v[20:23], v[68:71], v[32:35]
  buffer_load_dwordx4 v[68:71], v7, s[8:11], s35 offen offset:0
  v_perm_b32 v3, v48, v48, s31
  v_and_b32 v24, v28, v3
  v_and_b32 v25, v29, v3
  v_and_b32 v26, v30, v3
  v_and_b32 v27, v31, v3
  s_waitcnt vmcnt(21)
  s_nop 0
  v_mfma_f32_16x16x32_bf16 v[32:35], v[24:27], v[72:75], v[32:35]
  buffer_load_dwordx4 v[72:75], v7, s[8:11], s35 offen offset:1024
  v_perm_b32 v3, v49, v49, s30
  v_and_b32 v20, v28, v3
  v_and_b32 v21, v29, v3
  v_and_b32 v22, v30, v3
  v_and_b32 v23, v31, v3
  s_waitcnt vmcnt(20)
  s_nop 0
  v_mfma_f32_16x16x32_bf16 v[32:35], v[20:23], v[76:79], v[32:35]
  buffer_load_dwordx4 v[76:79], v7, s[8:11], s35 offen offset:2048
  v_perm_b32 v3, v49, v49, s31
  v_and_b32 v24, v28, v3
  v_and_b32 v25, v29, v3
  v_and_b32 v26, v30, v3
  v_and_b32 v27, v31, v3
  s_waitcnt vmcnt(19)
  s_nop 0
  v_mfma_f32_16x16x32_bf16 v[32:35], v[24:27], v[80:83], v[32:35]
  buffer_load_dwordx4 v[80:83], v7, s[8:11], s35 offen offset:3072
  s_add_u32 s35, s35, 4096
  v_perm_b32 v3, v50, v50, s30
  v_and_b32 v20, v28, v3
  v_and_b32 v21, v29, v3
  v_and_b32 v22, v30, v3
  v_and_b32 v23, v31, v3
  s_waitcnt vmcnt(18)
  s_nop 0
  v_mfma_f32_16x16x32_bf16 v[32:35], v[20:23], v[84:87], v[32:35]
  buffer_load_dwordx4 v[84:87], v7, s[8:11], s35 offen offset:0
  v_perm_b32 v3, v50, v50, s31
  v_and_b32 v24, v28, v3
  v_and_b32 v25, v29, v3
  v_and_b32 v26, v30, v3
  v_and_b32 v27, v31, v3
  s_waitcnt vmcnt(17)
  s_nop 0
  v_mfma_f32_16x16x32_bf16 v[32:35], v[24:27], v[88:91], v[32:35]
  buffer_load_dwordx4 v[88:91], v7, s[8:11], s35 offen offset:1024
  v_perm_b32 v3, v51, v51, s30
  v_and_b32 v20, v28, v3
  v_and_b32 v21, v29, v3
  v_and_b32 v22, v30, v3
  v_and_b32 v23, v31, v3
  s_waitcnt vmcnt(16)
  s_nop 0
  v_mfma_f32_16x16x32_bf16 v[32:35], v[20:23], v[92:95], v[32:35]
  v_perm_b32 v3, v51, v51, s31
  v_and_b32 v24, v28, v3
  v_and_b32 v25, v29, v3
  v_and_b32 v26, v30, v3
  v_and_b32 v27, v31, v3
  s_waitcnt vmcnt(14)
  s_nop 0
  v_mfma_f32_16x16x32_bf16 v[32:35], v[24:27], v[96:99], v[32:35]
  v_lshrrev_b32 v2, 8, v0
  v_and_b32 v3, 0xf0, v0
  v_lshlrev_b32 v3, 1, v3
  v_lshl_add_u32 v3, v2, 4, v3
  s_lshl_b32 s26, s17, 9
  s_add_u32 s26, s26, 159744
  v_add_u32 v5, s26, v3
  s_mov_b32 exec_hi, 0
  ds_write_b128 v5, v[32:35]
  s_mov_b32 exec_hi, -1
  v_add_u32 v5, 159744, v1
  s_waitcnt lgkmcnt(0)
  s_barrier
  ds_read_b32 v36, v5 offset:0
  ds_read_b32 v37, v5 offset:256
  ds_read_b32 v38, v5 offset:512
  ds_read_b32 v39, v5 offset:768
  ds_read_b32 v40, v5 offset:1024
  ds_read_b32 v41, v5 offset:1280
  ds_read_b32 v42, v5 offset:1536
  ds_read_b32 v43, v5 offset:1792
  s_waitcnt lgkmcnt(0)
  v_add_f32 v36, v36, v38
  v_add_f32 v40, v40, v42
  v_add_f32 v36, v36, v40
  v_cvt_pk_bf16_f32 v36, 0, v36
  v_add_f32 v37, v37, v39
  v_add_f32 v41, v41, v43
  v_add_f32 v37, v37, v41
  v_cvt_pk_bf16_f32 v37, 0, v37
  v_mul_f32 v40, 0xbfb8aa3b, v36
  v_exp_f32 v40, v40
  s_nop 0
  v_add_f32 v40, 1.0, v40
  v_rcp_f32 v40, v40
  s_nop 0
  v_mul_f32 v36, v36, v40
  v_cvt_pk_bf16_f32 v36, 0, v36
  v_mul_f32 v36, v36, v37
  v_cvt_pk_bf16_f32 v36, v36, v36
  s_lshl_b32 s26, s17, 8
  s_add_u32 s26, s26, 161792
  v_add_u32 v5, s26, v1
  ds_write_b32 v5, v36
  v_mul_u32_u24 v5, 56, v2
  v_add_u32 v5, s26, v5
  ds_read_b64 v[36:37], v5 offset:0
  ds_read_b64 v[38:39], v5 offset:8
  ds_read_b64 v[40:41], v5 offset:16
  ds_read_b64 v[42:43], v5 offset:24
  ds_read_b64 v[44:45], v5 offset:32
  ds_read_b64 v[46:47], v5 offset:40
  ds_read_b64 v[48:49], v5 offset:48
  s_waitcnt lgkmcnt(0)
  v_and_b32 v20, v28, v36
  v_and_b32 v21, v29, v36
  v_and_b32 v22, v30, v36
  v_and_b32 v23, v31, v36
  s_waitcnt vmcnt(13)
  s_nop 0
  v_mfma_f32_16x16x32_bf16 v[32:35], v[20:23], v[100:103], 0
  v_and_b32 v24, v28, v37
  v_and_b32 v25, v29, v37
  v_and_b32 v26, v30, v37
  v_and_b32 v27, v31, v37
  s_waitcnt vmcnt(12)
  s_nop 0
  v_mfma_f32_16x16x32_bf16 v[32:35], v[24:27], v[104:107], v[32:35]
  v_and_b32 v20, v28, v38
  v_and_b32 v21, v29, v38
  v_and_b32 v22, v30, v38
  v_and_b32 v23, v31, v38
  s_waitcnt vmcnt(11)
  s_nop 0
  v_mfma_f32_16x16x32_bf16 v[32:35], v[20:23], v[108:111], v[32:35]
  v_and_b32 v24, v28, v39
  v_and_b32 v25, v29, v39
  v_and_b32 v26, v30, v39
  v_and_b32 v27, v31, v39
  s_waitcnt vmcnt(10)
  s_nop 0
  v_mfma_f32_16x16x32_bf16 v[32:35], v[24:27], v[112:115], v[32:35]
  v_and_b32 v20, v28, v40
  v_and_b32 v21, v29, v40
  v_and_b32 v22, v30, v40
  v_and_b32 v23, v31, v40
  s_waitcnt vmcnt(9)
  s_nop 0
  v_mfma_f32_16x16x32_bf16 v[32:35], v[20:23], v[60:63], v[32:35]
  v_and_b32 v24, v28, v41
  v_and_b32 v25, v29, v41
  v_and_b32 v26, v30, v41
  v_and_b32 v27, v31, v41
  s_waitcnt vmcnt(8)
  s_nop 0
  v_mfma_f32_16x16x32_bf16 v[32:35], v[24:27], v[52:55], v[32:35]
  v_and_b32 v20, v28, v42
  v_and_b32 v21, v29, v42
  v_and_b32 v22, v30, v42
  v_and_b32 v23, v31, v42
  s_waitcnt vmcnt(7)
  s_nop 0
  v_mfma_f32_16x16x32_bf16 v[32:35], v[20:23], v[56:59], v[32:35]
  v_and_b32 v24, v28, v43
  v_and_b32 v25, v29, v43
  v_and_b32 v26, v30, v43
  v_and_b32 v27, v31, v43
  s_waitcnt vmcnt(6)
  s_nop 0
  v_mfma_f32_16x16x32_bf16 v[32:35], v[24:27], v[64:67], v[32:35]
  v_and_b32 v20, v28, v44
  v_and_b32 v21, v29, v44
  v_and_b32 v22, v30, v44
  v_and_b32 v23, v31, v44
  s_waitcnt vmcnt(5)
  s_nop 0
  v_mfma_f32_16x16x32_bf16 v[32:35], v[20:23], v[68:71], v[32:35]
  v_and_b32 v24, v28, v45
  v_and_b32 v25, v29, v45
  v_and_b32 v26, v30, v45
  v_and_b32 v27, v31, v45
  s_waitcnt vmcnt(4)
  s_nop 0
  v_mfma_f32_16x16x32_bf16 v[32:35], v[24:27], v[72:75], v[32:35]
  v_and_b32 v20, v28, v46
  v_and_b32 v21, v29, v46
  v_and_b32 v22, v30, v46
  v_and_b32 v23, v31, v46
  s_waitcnt vmcnt(3)
  s_nop 0
  v_mfma_f32_16x16x32_bf16 v[32:35], v[20:23], v[76:79], v[32:35]
  v_and_b32 v24, v28, v47
  v_and_b32 v25, v29, v47
  v_and_b32 v26, v30, v47
  v_and_b32 v27, v31, v47
  s_waitcnt vmcnt(2)
  s_nop 0
  v_mfma_f32_16x16x32_bf16 v[32:35], v[24:27], v[80:83], v[32:35]
  v_and_b32 v20, v28, v48
  v_and_b32 v21, v29, v48
  v_and_b32 v22, v30, v48
  v_and_b32 v23, v31, v48
  s_waitcnt vmcnt(1)
  s_nop 0
  v_mfma_f32_16x16x32_bf16 v[32:35], v[20:23], v[84:87], v[32:35]
  v_and_b32 v24, v28, v49
  v_and_b32 v25, v29, v49
  v_and_b32 v26, v30, v49
  v_and_b32 v27, v31, v49
  s_waitcnt vmcnt(0)
  s_nop 0
  v_mfma_f32_16x16x32_bf16 v[32:35], v[24:27], v[88:91], v[32:35]
  v_lshrrev_b32 v3, 1, v3
  s_lshl_b32 s26, s47, 7
  s_add_u32 s26, s26, s57
  s_lshl_b32 s26, s26, 8
  s_add_u32 s26, s26, 245366784
  s_nop 2
  v_cvt_pk_bf16_f32 v32, v32, v33
  v_cvt_pk_bf16_f32 v33, v34, v35
  v_min_u32 v32, -2, v32
  v_min_u32 v33, -2, v33
  s_mov_b32 exec_hi, 0
  buffer_store_dwordx2 v[32:33], v3, s[4:7], s26 offen sc1
  s_mov_b32 exec_hi, -1
  s_branch q_cold_62
q_patch_59:
  s_lshl_b32 s26, s61, 21
  s_lshl_b32 s27, s59, 10
  s_add_u32 s26, s26, s27
  s_add_u32 s27, s26, 20971520
  s_add_u32 s28, s26, 27262976
  s_lshl_b32 s26, s46, 7
  s_add_u32 s26, s26, s17
  s_lshl_b32 s26, s26, 8
  s_add_u32 s26, s26, 245366784
  v_lshrrev_b32 v2, 8, v0
  v_and_b32 v3, 0xf0, v0
  v_lshl_add_u32 v5, v2, 10, v3
  buffer_load_dwordx4 v[36:39], v0, s[4:7], s27 offen sc1
  buffer_load_dwordx4 v[40:43], v0, s[4:7], s28 offen sc1
  s_mov_b32 s53, 0
m_w_68:
  s_add_u32 s27, s26, 0
  buffer_load_dwordx4 v[60:63], v5, s[4:7], s27 offen sc1
  s_add_u32 s27, s26, 4096
  buffer_load_dwordx4 v[64:67], v5, s[4:7], s27 offen sc1
  s_add_u32 s27, s26, 8192
  buffer_load_dwordx4 v[68:71], v5, s[4:7], s27 offen sc1
  s_add_u32 s27, s26, 12288
  buffer_load_dwordx4 v[72:75], v5, s[4:7], s27 offen sc1
  s_add_u32 s27, s26, 16384
  buffer_load_dwordx4 v[76:79], v5, s[4:7], s27 offen sc1
  s_add_u32 s27, s26, 20480
  buffer_load_dwordx4 v[80:83], v5, s[4:7], s27 offen sc1
  s_add_u32 s27, s26, 24576
  buffer_load_dwordx4 v[84:87], v5, s[4:7], s27 offen sc1
  s_add_u32 s27, s26, 28672
  buffer_load_dwordx4 v[88:91], v5, s[4:7], s27 offen sc1
  s_add_u32 s53, s53, 1
  s_cmp_gt_u32 s53, 1048576
  s_cbranch_scc1 q_fail_58
  s_mov_b32 vcc_lo, 0xaaaaaaaa
  s_mov_b32 vcc_hi, 0xaaaaaaaa
  v_mov_b32 v28, 0x3f80
  v_mov_b32 v20, 1.0
  v_cndmask_b32 v28, v28, v20, vcc
  s_mov_b32 vcc_lo, 0x30003
  s_mov_b32 vcc_hi, 0x30003
  v_cndmask_b32 v20, 0, v28, vcc
  s_mov_b32 vcc_lo, 0xc000c
  s_mov_b32 vcc_hi, 0xc000c
  v_cndmask_b32 v21, 0, v28, vcc
  s_mov_b32 vcc_lo, 0x300030
  s_mov_b32 vcc_hi, 0x300030
  v_cndmask_b32 v22, 0, v28, vcc
  s_mov_b32 vcc_lo, 0xc000c0
  s_mov_b32 vcc_hi, 0xc000c0
  v_cndmask_b32 v23, 0, v28, vcc
  s_waitcnt vmcnt(7)
  s_nop 0
  v_mfma_f32_16x16x32_bf16 v[28:31], v[20:23], v[60:63], 0
  v_max3_u32 v44, v60, v61, 0
  v_max3_u32 v44, v62, v63, v44
  s_waitcnt vmcnt(6)
  v_mfma_f32_16x16x32_bf16 v[28:31], v[20:23], v[64:67], v[28:31]
  v_max3_u32 v44, v64, v65, v44
  v_max3_u32 v44, v66, v67, v44
  s_waitcnt vmcnt(5)
  v_mfma_f32_16x16x32_bf16 v[28:31], v[20:23], v[68:71], v[28:31]
  v_max3_u32 v44, v68, v69, v44
  v_max3_u32 v44, v70, v71, v44
  s_waitcnt vmcnt(4)
  v_mfma_f32_16x16x32_bf16 v[28:31], v[20:23], v[72:75], v[28:31]
  v_max3_u32 v44, v72, v73, v44
  v_max3_u32 v44, v74, v75, v44
  s_waitcnt vmcnt(3)
  v_mfma_f32_16x16x32_bf16 v[28:31], v[20:23], v[76:79], v[28:31]
  v_max3_u32 v44, v76, v77, v44
  v_max3_u32 v44, v78, v79, v44
  s_waitcnt vmcnt(2)
  v_mfma_f32_16x16x32_bf16 v[28:31], v[20:23], v[80:83], v[28:31]
  v_max3_u32 v44, v80, v81, v44
  v_max3_u32 v44, v82, v83, v44
  s_waitcnt vmcnt(1)
  v_mfma_f32_16x16x32_bf16 v[28:31], v[20:23], v[84:87], v[28:31]
  v_max3_u32 v44, v84, v85, v44
  v_max3_u32 v44, v86, v87, v44
  s_waitcnt vmcnt(0)
  v_mfma_f32_16x16x32_bf16 v[28:31], v[20:23], v[88:91], v[28:31]
  v_max3_u32 v44, v88, v89, v44
  v_max3_u32 v44, v90, v91, v44
  v_cmp_eq_u32 vcc, -1, v44
  s_cbranch_vccnz m_w_68
  v_lshlrev_b32 v3, 1, v3
  v_lshl_add_u32 v3, v2, 4, v3
  s_lshl_b32 s26, s17, 9
  s_add_u32 s26, s26, 159744
  v_add_u32 v3, s26, v3
  s_mov_b32 exec_hi, 0
  ds_write_b128 v3, v[28:31]
  s_mov_b32 exec_hi, -1
  v_add_u32 v3, 159744, v9
  v_lshlrev_b32 v44, 16, v36
  v_and_b32 v45, 0xffff0000, v36
  v_lshlrev_b32 v46, 16, v37
  v_and_b32 v47, 0xffff0000, v37
  v_lshlrev_b32 v48, 16, v38
  v_and_b32 v49, 0xffff0000, v38
  v_lshlrev_b32 v50, 16, v39
  v_and_b32 v51, 0xffff0000, v39
  v_lshlrev_b32 v52, 16, v40
  v_and_b32 v53, 0xffff0000, v40
  v_lshlrev_b32 v54, 16, v41
  v_and_b32 v55, 0xffff0000, v41
  v_lshlrev_b32 v56, 16, v42
  v_and_b32 v57, 0xffff0000, v42
  v_lshlrev_b32 v58, 16, v43
  v_and_b32 v59, 0xffff0000, v43
  s_waitcnt lgkmcnt(0)
  s_barrier
  s_cmp_lg_u32 s17, 0
  s_cbranch_scc1 m_done_67
  ds_read_b128 v[28:31], v3
  ds_read_b128 v[32:35], v3 offset:16
  s_and_b32 s29, s58, 0xffff0000
  s_xor_b32 s27, s29, 0x80000000
  s_xor_b32 s28, s29, 0xffff0000
  s_bitcmp1_b32 s29, 31
  s_cselect_b32 s29, s27, s28
  v_mov_b32 v36, s29
  v_mul_f32 v36, 0xbfb8aa3b, v36
  v_exp_f32 v36, v36
  s_nop 0
  v_add_f32 v36, 1.0, v36
  v_rcp_f32 v36, v36
  s_nop 0
  v_cvt_pk_bf16_f32 v36, 0, v36
  s_waitcnt lgkmcnt(0)
  v_cvt_pk_bf16_f32 v28, 0, v28
  v_cvt_pk_bf16_f32 v29, 0, v29
  v_cvt_pk_bf16_f32 v30, 0, v30
  v_cvt_pk_bf16_f32 v31, 0, v31
  v_cvt_pk_bf16_f32 v32, 0, v32
  v_cvt_pk_bf16_f32 v33, 0, v33
  v_cvt_pk_bf16_f32 v34, 0, v34
  v_cvt_pk_bf16_f32 v35, 0, v35
  v_mul_f32 v28, v28, v36
  v_mul_f32 v29, v29, v36
  v_mul_f32 v30, v30, v36
  v_mul_f32 v31, v31, v36
  v_mul_f32 v32, v32, v36
  v_mul_f32 v33, v33, v36
  v_mul_f32 v34, v34, v36
  v_mul_f32 v35, v35, v36
  v_cvt_pk_bf16_f32 v28, 0, v28
  v_cvt_pk_bf16_f32 v29, 0, v29
  v_cvt_pk_bf16_f32 v30, 0, v30
  v_cvt_pk_bf16_f32 v31, 0, v31
  v_cvt_pk_bf16_f32 v32, 0, v32
  v_cvt_pk_bf16_f32 v33, 0, v33
  v_cvt_pk_bf16_f32 v34, 0, v34
  v_cvt_pk_bf16_f32 v35, 0, v35
  v_add_f32 v28, v28, v52
  v_add_f32 v29, v29, v53
  v_add_f32 v30, v30, v54
  v_add_f32 v31, v31, v55
  v_add_f32 v32, v32, v56
  v_add_f32 v33, v33, v57
  v_add_f32 v34, v34, v58
  v_add_f32 v35, v35, v59
  v_cvt_pk_bf16_f32 v28, 0, v28
  v_cvt_pk_bf16_f32 v29, 0, v29
  v_cvt_pk_bf16_f32 v30, 0, v30
  v_cvt_pk_bf16_f32 v31, 0, v31
  v_cvt_pk_bf16_f32 v32, 0, v32
  v_cvt_pk_bf16_f32 v33, 0, v33
  v_cvt_pk_bf16_f32 v34, 0, v34
  v_cvt_pk_bf16_f32 v35, 0, v35
  v_add_f32 v44, v44, v28
  v_add_f32 v45, v45, v29
  v_add_f32 v46, v46, v30
  v_add_f32 v47, v47, v31
  v_add_f32 v48, v48, v32
  v_add_f32 v49, v49, v33
  v_add_f32 v50, v50, v34
  v_add_f32 v51, v51, v35
  v_cvt_pk_bf16_f32 v40, v44, v45
  v_cvt_pk_bf16_f32 v41, v46, v47
  v_cvt_pk_bf16_f32 v42, v48, v49
  v_cvt_pk_bf16_f32 v43, v50, v51
  v_lshlrev_b32 v44, 16, v40
  v_and_b32 v45, 0xffff0000, v40
  v_lshlrev_b32 v46, 16, v41
  v_and_b32 v47, 0xffff0000, v41
  v_lshlrev_b32 v48, 16, v42
  v_and_b32 v49, 0xffff0000, v42
  v_lshlrev_b32 v50, 16, v43
  v_and_b32 v51, 0xffff0000, v43
  s_lshl_b32 s27, s46, 5
  s_add_u32 s27, s27, s16
  s_lshl_b32 s27, s27, 10
  s_add_u32 s27, s27, 33554432
  buffer_store_dwordx4 v[40:43], v0, s[4:7], s27 offen sc1
  v_add_f32 v60, v44, v45
  v_mul_f32 v61, v44, v44
  v_add_f32 v62, v46, v47
  v_mul_f32 v63, v45, v45
  v_fmac_f32 v61, v46, v46
  v_fmac_f32 v63, v47, v47
  v_add_f32 v60, v60, v48
  v_fmac_f32 v61, v48, v48
  v_add_f32 v62, v62, v49
  v_fmac_f32 v63, v49, v49
  v_add_f32 v60, v60, v50
  v_fmac_f32 v61, v50, v50
  v_add_f32 v62, v62, v51
  v_fmac_f32 v63, v51, v51
  v_add_f32 v60, v60, v62
  v_add_f32 v61, v61, v63
  s_nop 0
  v_add_f32_dpp v60, v60, v60 row_ror:8 row_mask:0xf bank_mask:0xf
  v_add_f32_dpp v61, v61, v61 row_ror:8 row_mask:0xf bank_mask:0xf
  s_nop 0
  v_add_f32_dpp v60, v60, v60 row_ror:4 row_mask:0xf bank_mask:0xf
  v_add_f32_dpp v61, v61, v61 row_ror:4 row_mask:0xf bank_mask:0xf
  s_nop 0
  v_add_f32_dpp v60, v60, v60 row_ror:2 row_mask:0xf bank_mask:0xf
  v_add_f32_dpp v61, v61, v61 row_ror:2 row_mask:0xf bank_mask:0xf
  s_nop 0
  v_add_f32_dpp v60, v60, v60 row_ror:1 row_mask:0xf bank_mask:0xf
  v_add_f32_dpp v61, v61, v61 row_ror:1 row_mask:0xf bank_mask:0xf
  v_mov_b32 v64, v60
  v_mov_b32 v65, v61
  s_nop 0
  v_permlane16_swap_b32 v60, v64
  v_permlane16_swap_b32 v61, v65
  v_add_f32 v60, v60, v64
  v_add_f32 v61, v61, v65
  v_mov_b32 v64, v60
  v_mov_b32 v65, v61
  s_nop 0
  v_permlane32_swap_b32 v60, v64
  v_permlane32_swap_b32 v61, v65
  v_add_f32 v60, v60, v64
  v_add_f32 v61, v61, v65
  v_mul_f32 v60, 0x3b000000, v60
  v_mul_f32 v61, 0x3b000000, v61
  v_fma_f32 v61, -v60, v60, v61
  v_cvt_pk_bf16_f32 v60, 0, v60
  v_max_f32 v61, 0, v61
  v_sub_f32 v64, v44, v60
  v_sub_f32 v65, v45, v60
  v_cvt_pk_bf16_f32 v61, 0, v61
  v_sub_f32 v66, v46, v60
  v_sub_f32 v67, v47, v60
  v_add_f32 v61, 0x3727c5ac, v61
  v_sub_f32 v68, v48, v60
  v_sub_f32 v69, v49, v60
  v_cvt_pk_bf16_f32 v61, 0, v61
  v_sub_f32 v70, v50, v60
  v_sub_f32 v71, v51, v60
  v_sqrt_f32 v61, v61
  v_cvt_pk_bf16_f32 v64, 0, v64
  v_cvt_pk_bf16_f32 v65, 0, v65
  v_cvt_pk_bf16_f32 v61, 0, v61
  v_cvt_pk_bf16_f32 v66, 0, v66
  v_cvt_pk_bf16_f32 v67, 0, v67
  v_rcp_f32 v61, v61
  v_cvt_pk_bf16_f32 v68, 0, v68
  v_cvt_pk_bf16_f32 v69, 0, v69
  v_cvt_pk_bf16_f32 v70, 0, v70
  v_cvt_pk_bf16_f32 v71, 0, v71
  v_mul_f32 v64, v64, v61
  v_mul_f32 v65, v65, v61
  v_mul_f32 v66, v66, v61
  v_mul_f32 v67, v67, v61
  v_mul_f32 v68, v68, v61
  v_mul_f32 v69, v69, v61
  v_mul_f32 v70, v70, v61
  v_mul_f32 v71, v71, v61
  v_cvt_pk_bf16_f32 v72, v64, v65
  v_cvt_pk_bf16_f32 v73, v66, v67
  v_cvt_pk_bf16_f32 v74, v68, v69
  v_cvt_pk_bf16_f32 v75, v70, v71
  s_and_b32 s26, s59, 31
  s_lshl_b32 s27, s26, 10
  s_add_u32 s27, s27, s50
  s_and_b32 s26, s26, 15
  s_lshl_b32 s26, s26, 4
  s_or_b32 s26, s26, s27
  v_xor_b32 v3, s26, v0
  ds_write_b128 v3, v[72:75]
m_done_67:
  s_mov_b32 s40, s77
  s_mov_b32 s41, s78
  s_mov_b32 s42, s79
  s_mov_b32 s76, s47
  s_add_u32 s47, s46, 64
  s_mov_b32 s62, 0
  s_branch q_cold_62
q_end_55:
  s_waitcnt vmcnt(0)
  s_mov_b64 exec, 1
  buffer_store_dword v4, off, s[4:7], s49 sc1
  s_mov_b64 exec, -1
  s_cmp_lg_u32 s60, 0
  s_cbranch_scc1 q_fail_58
  s_load_dwordx2 s[72:73], s[0:1], 96
  s_mov_b32 s74, 2097152
  s_mov_b32 s75, 0x20000
  s_load_dwordx2 s[64:65], s[0:1], 72
  s_load_dwordx2 s[68:69], s[0:1], 80
  s_load_dwordx2 s[8:9], s[0:1], 88
  s_mov_b32 s66, 1835008
  s_mov_b32 s70, 1835008
  s_mov_b32 s10, 1835008
  v_lshrrev_b32 v2, 8, v0
  v_and_b32 v3, 0x70, v0
  s_mov_b32 s26, 114688
  v_mul_lo_u32 v6, v2, s26
  v_add_u32 v6, v6, v3
  v_cmp_eq_u32 vcc, 0x70, v3
  v_mov_b32 v3, 0x7ff00000
  s_nop 0
  v_cndmask_b32 v6, v6, v3, vcc
  v_mul_u32_u24 v7, 14336, v2
  v_and_b32 v3, 0xf0, v0
  v_add_u32 v7, v7, v3
  s_mul_i32 s34, s17, 458752
  s_mul_i32 s27, s16, 112
  s_add_u32 s34, s34, s27
  s_add_u32 s34, s34, 82432
  s_mul_i32 s35, s16, 57344
  s_lshl_b32 s27, s17, 8
  s_add_u32 s35, s35, s27
  s_mov_b32 s36, 0x00ff00ff
  s_mov_b32 s37, 0x00ff00ff
  s_waitcnt lgkmcnt(0)
  s_mov_b64 exec, s[36:37]
  buffer_load_dwordx4 a[0:3], v6, s[64:67], s34 offen
  s_not_b64 exec, exec
  buffer_load_dwordx4 a[0:3], v6, s[68:71], s34 offen
  s_mov_b64 exec, -1
  s_add_u32 s34, s34, 3584
  s_mov_b64 exec, s[36:37]
  buffer_load_dwordx4 a[4:7], v6, s[64:67], s34 offen
  s_not_b64 exec, exec
  buffer_load_dwordx4 a[4:7], v6, s[68:71], s34 offen
  s_mov_b64 exec, -1
  s_add_u32 s34, s34, 3584
  s_mov_b64 exec, s[36:37]
  buffer_load_dwordx4 a[8:11], v6, s[64:67], s34 offen
  s_not_b64 exec, exec
  buffer_load_dwordx4 a[8:11], v6, s[68:71], s34 offen
  s_mov_b64 exec, -1
  s_add_u32 s34, s34, 3584
  s_mov_b64 exec, s[36:37]
  buffer_load_dwordx4 a[12:15], v6, s[64:67], s34 offen
  s_not_b64 exec, exec
  buffer_load_dwordx4 a[12:15], v6, s[68:71], s34 offen
  s_mov_b64 exec, -1
  s_add_u32 s34, s34, 3584
  s_mov_b64 exec, s[36:37]
  buffer_load_dwordx4 a[16:19], v6, s[64:67], s34 offen
  s_not_b64 exec, exec
  buffer_load_dwordx4 a[16:19], v6, s[68:71], s34 offen
  s_mov_b64 exec, -1
  s_add_u32 s34, s34, 3584
  s_mov_b64 exec, s[36:37]
  buffer_load_dwordx4 a[20:23], v6, s[64:67], s34 offen
  s_not_b64 exec, exec
  buffer_load_dwordx4 a[20:23], v6, s[68:71], s34 offen
  s_mov_b64 exec, -1
  s_add_u32 s34, s34, 3584
  s_mov_b64 exec, s[36:37]
  buffer_load_dwordx4 a[24:27], v6, s[64:67], s34 offen
  s_not_b64 exec, exec
  buffer_load_dwordx4 a[24:27], v6, s[68:71], s34 offen
  s_mov_b64 exec, -1
  s_add_u32 s34, s34, 3584
  s_mov_b64 exec, s[36:37]
  buffer_load_dwordx4 a[28:31], v6, s[64:67], s34 offen
  s_not_b64 exec, exec
  buffer_load_dwordx4 a[28:31], v6, s[68:71], s34 offen
  s_mov_b64 exec, -1
  s_add_u32 s34, s34, 3584
  s_mov_b64 exec, s[36:37]
  buffer_load_dwordx4 a[32:35], v6, s[64:67], s34 offen
  s_not_b64 exec, exec
  buffer_load_dwordx4 a[32:35], v6, s[68:71], s34 offen
  s_mov_b64 exec, -1
  s_add_u32 s34, s34, 3584
  buffer_load_dwordx4 a[36:39], v7, s[8:11], s35 offen offset:0
  buffer_load_dwordx4 a[40:43], v7, s[8:11], s35 offen offset:1024
  buffer_load_dwordx4 a[44:47], v7, s[8:11], s35 offen offset:2048
  buffer_load_dwordx4 a[48:51], v7, s[8:11], s35 offen offset:3072
  s_add_u32 s35, s35, 4096
  buffer_load_dwordx4 a[52:55], v7, s[8:11], s35 offen offset:0
  buffer_load_dwordx4 a[56:59], v7, s[8:11], s35 offen offset:1024
  buffer_load_dwordx4 a[60:63], v7, s[8:11], s35 offen offset:2048
  buffer_load_dwordx4 a[64:67], v7, s[8:11], s35 offen offset:3072
  s_add_u32 s35, s35, 4096
  buffer_load_dwordx4 a[68:71], v7, s[8:11], s35 offen offset:0
  buffer_load_dwordx4 a[72:75], v7, s[8:11], s35 offen offset:1024
  buffer_load_dwordx4 a[76:79], v7, s[8:11], s35 offen offset:2048
  buffer_load_dwordx4 a[80:83], v7, s[8:11], s35 offen offset:3072
  s_add_u32 s35, s35, 4096
  buffer_load_dwordx4 a[84:87], v7, s[8:11], s35 offen offset:0
  buffer_load_dwordx4 a[88:91], v7, s[8:11], s35 offen offset:1024
  s_mov_b32 s53, 0
  s_mov_b32 s26, 243531776
  v_mov_b32 v53, 0
k_w_69:
  buffer_load_dword v20, v9, s[4:7], s26 offen sc1
  buffer_load_dword v21, v9, s[4:7], s26 offen offset:2048 sc1
  s_add_u32 s53, s53, 1
  s_cmp_gt_u32 s53, 1048576
  s_cbranch_scc1 q_fail_58
  s_waitcnt vmcnt(0)
  v_min_u32 v52, v20, v21
  v_max3_u32 v53, v20, v21, v53
  v_cmp_eq_u32 vcc, 0, v52
  s_cbranch_vccnz k_w_69
  s_add_u32 s26, s26, 4096
  s_cmp_lt_u32 s26, 243597312
  s_cbranch_scc1 k_w_69
  v_max_u32_dpp v53, v53, v53 row_ror:8 row_mask:0xf bank_mask:0xf
  s_nop 1
  v_max_u32_dpp v53, v53, v53 row_ror:4 row_mask:0xf bank_mask:0xf
  s_nop 1
  v_max_u32_dpp v53, v53, v53 row_ror:2 row_mask:0xf bank_mask:0xf
  s_nop 1
  v_max_u32_dpp v53, v53, v53 row_ror:1 row_mask:0xf bank_mask:0xf
  v_mov_b32 v52, v53
  s_nop 0
  s_nop 0
  v_permlane16_swap_b32 v53, v52
  v_max_u32 v53, v53, v52
  v_mov_b32 v52, v53
  s_nop 0
  s_nop 0
  v_permlane32_swap_b32 v53, v52
  v_max_u32 v53, v53, v52
  s_nop 0
  v_readfirstlane_b32 s58, v53
  s_andn2_b32 s26, 0xfe0, s56
  s_andn2_b32 s27, 0xfe0, s58
  s_cmp_lt_u32 s27, s26
  s_cselect_b32 s61, 1, 2
  s_andn2_b32 s59, 0xfff, s58
  s_lshl_b32 s26, s61, 21
  s_lshl_b32 s27, s59, 10
  s_add_u32 s26, s26, s27
  s_lshl_b32 s27, s17, 8
  s_add_u32 s26, s26, s27
  s_add_u32 s26, s26, 27262976
  v_lshrrev_b32 v3, 8, v0
  v_lshlrev_b32 v3, 6, v3
  buffer_load_dwordx4 v[36:39], v3, s[4:7], s26 offen offset:0 sc1
  buffer_load_dwordx4 v[40:43], v3, s[4:7], s26 offen offset:16 sc1
  buffer_load_dwordx4 v[44:47], v3, s[4:7], s26 offen offset:32 sc1
  buffer_load_dwordx4 v[48:51], v3, s[4:7], s26 offen offset:48 sc1
  s_mov_b32 vcc_lo, 0xaaaaaaaa
  s_mov_b32 vcc_hi, 0xaaaaaaaa
  v_mov_b32 v3, 0xffff
  v_mov_b32 v28, 0xffff0000
  v_cndmask_b32 v3, v3, v28, vcc
  s_mov_b32 vcc_lo, 0x30003
  s_mov_b32 vcc_hi, 0x30003
  v_cndmask_b32 v28, 0, v3, vcc
  s_mov_b32 vcc_lo, 0xc000c
  s_mov_b32 vcc_hi, 0xc000c
  v_cndmask_b32 v29, 0, v3, vcc
  s_mov_b32 vcc_lo, 0x300030
  s_mov_b32 vcc_hi, 0x300030
  v_cndmask_b32 v30, 0, v3, vcc
  s_mov_b32 vcc_lo, 0xc000c0
  s_mov_b32 vcc_hi, 0xc000c0
  v_cndmask_b32 v31, 0, v3, vcc
  s_mov_b32 s30, 0x01000100
  s_mov_b32 s31, 0x03020302
  s_mul_i32 s26, s17, 23552
  s_add_u32 s26, s26, 65536
  v_add_u32 v5, s26, v0
  ds_read_b128 v[52:55], v5 offset:0
  ds_read_b128 v[56:59], v5 offset:1024
  ds_read_b128 v[60:63], v5 offset:2048
  s_waitcnt vmcnt(0)
  v_perm_b32 v3, v36, v36, s30
  v_and_b32 v20, v28, v3
  v_and_b32 v21, v29, v3
  v_and_b32 v22, v30, v3
  v_and_b32 v23, v31, v3
  s_waitcnt lgkmcnt(2)
  s_nop 0
  v_mfma_f32_16x16x32_bf16 v[32:35], v[20:23], v[52:55], 0
  ds_read_b128 v[52:55], v5 offset:3072
  v_perm_b32 v3, v36, v36, s31
  v_and_b32 v24, v28, v3
  v_and_b32 v25, v29, v3
  v_and_b32 v26, v30, v3
  v_and_b32 v27, v31, v3
  s_waitcnt lgkmcnt(2)
  s_nop 0
  v_mfma_f32_16x16x32_bf16 v[32:35], v[24:27], v[56:59], v[32:35]
  ds_read_b128 v[56:59], v5 offset:4096
  v_perm_b32 v3, v37, v37, s30
  v_and_b32 v20, v28, v3
  v_and_b32 v21, v29, v3
  v_and_b32 v22, v30, v3
  v_and_b32 v23, v31, v3
  s_waitcnt lgkmcnt(2)
  s_nop 0
  v_mfma_f32_16x16x32_bf16 v[32:35], v[20:23], v[60:63], v[32:35]
  ds_read_b128 v[60:63], v5 offset:5120
  v_perm_b32 v3, v37, v37, s31
  v_and_b32 v24, v28, v3
  v_and_b32 v25, v29, v3
  v_and_b32 v26, v30, v3
  v_and_b32 v27, v31, v3
  s_waitcnt lgkmcnt(2)
  s_nop 0
  v_mfma_f32_16x16x32_bf16 v[32:35], v[24:27], v[52:55], v[32:35]
  ds_read_b128 v[52:55], v5 offset:6144
  v_perm_b32 v3, v38, v38, s30
  v_and_b32 v20, v28, v3
  v_and_b32 v21, v29, v3
  v_and_b32 v22, v30, v3
  v_and_b32 v23, v31, v3
  s_waitcnt lgkmcnt(2)
  s_nop 0
  v_mfma_f32_16x16x32_bf16 v[32:35], v[20:23], v[56:59], v[32:35]
  ds_read_b128 v[56:59], v5 offset:7168
  v_perm_b32 v3, v38, v38, s31
  v_and_b32 v24, v28, v3
  v_and_b32 v25, v29, v3
  v_and_b32 v26, v30, v3
  v_and_b32 v27, v31, v3
  s_waitcnt lgkmcnt(2)
  s_nop 0
  v_mfma_f32_16x16x32_bf16 v[32:35], v[24:27], v[60:63], v[32:35]
  ds_read_b128 v[60:63], v5 offset:8192
  v_perm_b32 v3, v39, v39, s30
  v_and_b32 v20, v28, v3
  v_and_b32 v21, v29, v3
  v_and_b32 v22, v30, v3
  v_and_b32 v23, v31, v3
  s_waitcnt lgkmcnt(2)
  s_nop 0
  v_mfma_f32_16x16x32_bf16 v[32:35], v[20:23], v[52:55], v[32:35]
  ds_read_b128 v[52:55], v5 offset:9216
  v_perm_b32 v3, v39, v39, s31
  v_and_b32 v24, v28, v3
  v_and_b32 v25, v29, v3
  v_and_b32 v26, v30, v3
  v_and_b32 v27, v31, v3
  s_waitcnt lgkmcnt(2)
  s_nop 0
  v_mfma_f32_16x16x32_bf16 v[32:35], v[24:27], v[56:59], v[32:35]
  ds_read_b128 v[56:59], v5 offset:10240
  v_perm_b32 v3, v40, v40, s30
  v_and_b32 v20, v28, v3
  v_and_b32 v21, v29, v3
  v_and_b32 v22, v30, v3
  v_and_b32 v23, v31, v3
  s_waitcnt lgkmcnt(2)
  s_nop 0
  v_mfma_f32_16x16x32_bf16 v[32:35], v[20:23], v[60:63], v[32:35]
  ds_read_b128 v[60:63], v5 offset:11264
  v_perm_b32 v3, v40, v40, s31
  v_and_b32 v24, v28, v3
  v_and_b32 v25, v29, v3
  v_and_b32 v26, v30, v3
  v_and_b32 v27, v31, v3
  s_waitcnt lgkmcnt(2)
  s_nop 0
  v_mfma_f32_16x16x32_bf16 v[32:35], v[24:27], v[52:55], v[32:35]
  ds_read_b128 v[52:55], v5 offset:12288
  v_perm_b32 v3, v41, v41, s30
  v_and_b32 v20, v28, v3
  v_and_b32 v21, v29, v3
  v_and_b32 v22, v30, v3
  v_and_b32 v23, v31, v3
  s_waitcnt lgkmcnt(2)
  s_nop 0
  v_mfma_f32_16x16x32_bf16 v[32:35], v[20:23], v[56:59], v[32:35]
  ds_read_b128 v[56:59], v5 offset:13312
  v_perm_b32 v3, v41, v41, s31
  v_and_b32 v24, v28, v3
  v_and_b32 v25, v29, v3
  v_and_b32 v26, v30, v3
  v_and_b32 v27, v31, v3
  s_waitcnt lgkmcnt(2)
  s_nop 0
  v_mfma_f32_16x16x32_bf16 v[32:35], v[24:27], v[60:63], v[32:35]
  ds_read_b128 v[60:63], v5 offset:14336
  v_perm_b32 v3, v42, v42, s30
  v_and_b32 v20, v28, v3
  v_and_b32 v21, v29, v3
  v_and_b32 v22, v30, v3
  v_and_b32 v23, v31, v3
  s_waitcnt lgkmcnt(2)
  s_nop 0
  v_mfma_f32_16x16x32_bf16 v[32:35], v[20:23], v[52:55], v[32:35]
  ds_read_b128 v[52:55], v5 offset:15360
  v_perm_b32 v3, v42, v42, s31
  v_and_b32 v24, v28, v3
  v_and_b32 v25, v29, v3
  v_and_b32 v26, v30, v3
  v_and_b32 v27, v31, v3
  s_waitcnt lgkmcnt(2)
  s_nop 0
  v_mfma_f32_16x16x32_bf16 v[32:35], v[24:27], v[56:59], v[32:35]
  ds_read_b128 v[56:59], v5 offset:16384
  v_perm_b32 v3, v43, v43, s30
  v_and_b32 v20, v28, v3
  v_and_b32 v21, v29, v3
  v_and_b32 v22, v30, v3
  v_and_b32 v23, v31, v3
  s_waitcnt lgkmcnt(2)
  s_nop 0
  v_mfma_f32_16x16x32_bf16 v[32:35], v[20:23], v[60:63], v[32:35]
  ds_read_b128 v[60:63], v5 offset:17408
  v_perm_b32 v3, v43, v43, s31
  v_and_b32 v24, v28, v3
  v_and_b32 v25, v29, v3
  v_and_b32 v26, v30, v3
  v_and_b32 v27, v31, v3
  s_waitcnt lgkmcnt(2)
  s_nop 0
  v_mfma_f32_16x16x32_bf16 v[32:35], v[24:27], v[52:55], v[32:35]
  ds_read_b128 v[52:55], v5 offset:18432
  v_perm_b32 v3, v44, v44, s30
  v_and_b32 v20, v28, v3
  v_and_b32 v21, v29, v3
  v_and_b32 v22, v30, v3
  v_and_b32 v23, v31, v3
  s_waitcnt lgkmcnt(2)
  s_nop 0
  v_mfma_f32_16x16x32_bf16 v[32:35], v[20:23], v[56:59], v[32:35]
  ds_read_b128 v[56:59], v5 offset:19456
  v_perm_b32 v3, v44, v44, s31
  v_and_b32 v24, v28, v3
  v_and_b32 v25, v29, v3
  v_and_b32 v26, v30, v3
  v_and_b32 v27, v31, v3
  s_waitcnt lgkmcnt(2)
  s_nop 0
  v_mfma_f32_16x16x32_bf16 v[32:35], v[24:27], v[60:63], v[32:35]
  ds_read_b128 v[60:63], v5 offset:20480
  v_perm_b32 v3, v45, v45, s30
  v_and_b32 v20, v28, v3
  v_and_b32 v21, v29, v3
  v_and_b32 v22, v30, v3
  v_and_b32 v23, v31, v3
  s_waitcnt lgkmcnt(2)
  s_nop 0
  v_mfma_f32_16x16x32_bf16 v[32:35], v[20:23], v[52:55], v[32:35]
  ds_read_b128 v[52:55], v5 offset:21504
  v_perm_b32 v3, v45, v45, s31
  v_and_b32 v24, v28, v3
  v_and_b32 v25, v29, v3
  v_and_b32 v26, v30, v3
  v_and_b32 v27, v31, v3
  s_waitcnt lgkmcnt(2)
  s_nop 0
  v_mfma_f32_16x16x32_bf16 v[32:35], v[24:27], v[56:59], v[32:35]
  ds_read_b128 v[56:59], v5 offset:22528
  v_perm_b32 v3, v46, v46, s30
  v_and_b32 v20, v28, v3
  v_and_b32 v21, v29, v3
  v_and_b32 v22, v30, v3
  v_and_b32 v23, v31, v3
  s_waitcnt lgkmcnt(2)
  s_nop 0
  v_mfma_f32_16x16x32_bf16 v[32:35], v[20:23], v[60:63], v[32:35]
  v_perm_b32 v3, v46, v46, s31
  v_and_b32 v24, v28, v3
  v_and_b32 v25, v29, v3
  v_and_b32 v26, v30, v3
  v_and_b32 v27, v31, v3
  s_waitcnt lgkmcnt(1)
  s_nop 0
  v_mfma_f32_16x16x32_bf16 v[32:35], v[24:27], v[52:55], v[32:35]
  v_perm_b32 v3, v47, v47, s30
  v_and_b32 v20, v28, v3
  v_and_b32 v21, v29, v3
  v_and_b32 v22, v30, v3
  v_and_b32 v23, v31, v3
  s_waitcnt lgkmcnt(0)
  s_nop 0
  v_mfma_f32_16x16x32_bf16 v[32:35], v[20:23], v[56:59], v[32:35]
  v_perm_b32 v3, v47, v47, s31
  v_and_b32 v24, v28, v3
  v_and_b32 v25, v29, v3
  v_and_b32 v26, v30, v3
  v_and_b32 v27, v31, v3
  s_nop 0
  s_nop 0
  v_mfma_f32_16x16x32_bf16 v[32:35], v[24:27], a[0:3], v[32:35]
  v_perm_b32 v3, v48, v48, s30
  v_and_b32 v20, v28, v3
  v_and_b32 v21, v29, v3
  v_and_b32 v22, v30, v3
  v_and_b32 v23, v31, v3
  s_nop 0
  s_nop 0
  v_mfma_f32_16x16x32_bf16 v[32:35], v[20:23], a[4:7], v[32:35]
  v_perm_b32 v3, v48, v48, s31
  v_and_b32 v24, v28, v3
  v_and_b32 v25, v29, v3
  v_and_b32 v26, v30, v3
  v_and_b32 v27, v31, v3
  s_nop 0
  s_nop 0
  v_mfma_f32_16x16x32_bf16 v[32:35], v[24:27], a[8:11], v[32:35]
  v_perm_b32 v3, v49, v49, s30
  v_and_b32 v20, v28, v3
  v_and_b32 v21, v29, v3
  v_and_b32 v22, v30, v3
  v_and_b32 v23, v31, v3
  s_nop 0
  s_nop 0
  v_mfma_f32_16x16x32_bf16 v[32:35], v[20:23], a[12:15], v[32:35]
  v_perm_b32 v3, v49, v49, s31
  v_and_b32 v24, v28, v3
  v_and_b32 v25, v29, v3
  v_and_b32 v26, v30, v3
  v_and_b32 v27, v31, v3
  s_nop 0
  s_nop 0
  v_mfma_f32_16x16x32_bf16 v[32:35], v[24:27], a[16:19], v[32:35]
  v_perm_b32 v3, v50, v50, s30
  v_and_b32 v20, v28, v3
  v_and_b32 v21, v29, v3
  v_and_b32 v22, v30, v3
  v_and_b32 v23, v31, v3
  s_nop 0
  s_nop 0
  v_mfma_f32_16x16x32_bf16 v[32:35], v[20:23], a[20:23], v[32:35]
  v_perm_b32 v3, v50, v50, s31
  v_and_b32 v24, v28, v3
  v_and_b32 v25, v29, v3
  v_and_b32 v26, v30, v3
  v_and_b32 v27, v31, v3
  s_nop 0
  s_nop 0
  v_mfma_f32_16x16x32_bf16 v[32:35], v[24:27], a[24:27], v[32:35]
  v_perm_b32 v3, v51, v51, s30
  v_and_b32 v20, v28, v3
  v_and_b32 v21, v29, v3
  v_and_b32 v22, v30, v3
  v_and_b32 v23, v31, v3
  s_nop 0
  s_nop 0
  v_mfma_f32_16x16x32_bf16 v[32:35], v[20:23], a[28:31], v[32:35]
  v_perm_b32 v3, v51, v51, s31
  v_and_b32 v24, v28, v3
  v_and_b32 v25, v29, v3
  v_and_b32 v26, v30, v3
  v_and_b32 v27, v31, v3
  s_nop 0
  s_nop 0
  v_mfma_f32_16x16x32_bf16 v[32:35], v[24:27], a[32:35], v[32:35]
  v_lshrrev_b32 v2, 8, v0
  v_and_b32 v3, 0xf0, v0
  v_lshlrev_b32 v3, 1, v3
  v_lshl_add_u32 v3, v2, 4, v3
  s_lshl_b32 s26, s17, 9
  s_add_u32 s26, s26, 159744
  v_add_u32 v5, s26, v3
  s_mov_b32 exec_hi, 0
  ds_write_b128 v5, v[32:35]
  s_mov_b32 exec_hi, -1
  v_add_u32 v5, 159744, v1
  s_waitcnt lgkmcnt(0)
  s_barrier
  ds_read_b32 v36, v5 offset:0
  ds_read_b32 v37, v5 offset:256
  ds_read_b32 v38, v5 offset:512
  ds_read_b32 v39, v5 offset:768
  ds_read_b32 v40, v5 offset:1024
  ds_read_b32 v41, v5 offset:1280
  ds_read_b32 v42, v5 offset:1536
  ds_read_b32 v43, v5 offset:1792
  s_waitcnt lgkmcnt(0)
  v_add_f32 v36, v36, v38
  v_add_f32 v40, v40, v42
  v_add_f32 v36, v36, v40
  v_cvt_pk_bf16_f32 v36, 0, v36
  v_add_f32 v37, v37, v39
  v_add_f32 v41, v41, v43
  v_add_f32 v37, v37, v41
  v_cvt_pk_bf16_f32 v37, 0, v37
  v_mul_f32 v40, 0xbfb8aa3b, v36
  v_exp_f32 v40, v40
  s_nop 0
  v_add_f32 v40, 1.0, v40
  v_rcp_f32 v40, v40
  s_nop 0
  v_mul_f32 v36, v36, v40
  v_cvt_pk_bf16_f32 v36, 0, v36
  v_mul_f32 v36, v36, v37
  v_cvt_pk_bf16_f32 v36, v36, v36
  s_lshl_b32 s26, s17, 8
  s_add_u32 s26, s26, 161792
  v_add_u32 v5, s26, v1
  ds_write_b32 v5, v36
  v_mul_u32_u24 v5, 56, v2
  v_add_u32 v5, s26, v5
  ds_read_b64 v[36:37], v5 offset:0
  ds_read_b64 v[38:39], v5 offset:8
  ds_read_b64 v[40:41], v5 offset:16
  ds_read_b64 v[42:43], v5 offset:24
  ds_read_b64 v[44:45], v5 offset:32
  ds_read_b64 v[46:47], v5 offset:40
  ds_read_b64 v[48:49], v5 offset:48
  s_waitcnt lgkmcnt(0)
  v_and_b32 v20, v28, v36
  v_and_b32 v21, v29, v36
  v_and_b32 v22, v30, v36
  v_and_b32 v23, v31, v36
  s_nop 0
  s_nop 0
  v_mfma_f32_16x16x32_bf16 v[32:35], v[20:23], a[36:39], 0
  v_and_b32 v24, v28, v37
  v_and_b32 v25, v29, v37
  v_and_b32 v26, v30, v37
  v_and_b32 v27, v31, v37
  s_nop 0
  s_nop 0
  v_mfma_f32_16x16x32_bf16 v[32:35], v[24:27], a[40:43], v[32:35]
  v_and_b32 v20, v28, v38
  v_and_b32 v21, v29, v38
  v_and_b32 v22, v30, v38
  v_and_b32 v23, v31, v38
  s_nop 0
  s_nop 0
  v_mfma_f32_16x16x32_bf16 v[32:35], v[20:23], a[44:47], v[32:35]
  v_and_b32 v24, v28, v39
  v_and_b32 v25, v29, v39
  v_and_b32 v26, v30, v39
  v_and_b32 v27, v31, v39
  s_nop 0
  s_nop 0
  v_mfma_f32_16x16x32_bf16 v[32:35], v[24:27], a[48:51], v[32:35]
  v_and_b32 v20, v28, v40
  v_and_b32 v21, v29, v40
  v_and_b32 v22, v30, v40
  v_and_b32 v23, v31, v40
  s_nop 0
  s_nop 0
  v_mfma_f32_16x16x32_bf16 v[32:35], v[20:23], a[52:55], v[32:35]
  v_and_b32 v24, v28, v41
  v_and_b32 v25, v29, v41
  v_and_b32 v26, v30, v41
  v_and_b32 v27, v31, v41
  s_nop 0
  s_nop 0
  v_mfma_f32_16x16x32_bf16 v[32:35], v[24:27], a[56:59], v[32:35]
  v_and_b32 v20, v28, v42
  v_and_b32 v21, v29, v42
  v_and_b32 v22, v30, v42
  v_and_b32 v23, v31, v42
  s_nop 0
  s_nop 0
  v_mfma_f32_16x16x32_bf16 v[32:35], v[20:23], a[60:63], v[32:35]
  v_and_b32 v24, v28, v43
  v_and_b32 v25, v29, v43
  v_and_b32 v26, v30, v43
  v_and_b32 v27, v31, v43
  s_nop 0
  s_nop 0
  v_mfma_f32_16x16x32_bf16 v[32:35], v[24:27], a[64:67], v[32:35]
  v_and_b32 v20, v28, v44
  v_and_b32 v21, v29, v44
  v_and_b32 v22, v30, v44
  v_and_b32 v23, v31, v44
  s_nop 0
  s_nop 0
  v_mfma_f32_16x16x32_bf16 v[32:35], v[20:23], a[68:71], v[32:35]
  v_and_b32 v24, v28, v45
  v_and_b32 v25, v29, v45
  v_and_b32 v26, v30, v45
  v_and_b32 v27, v31, v45
  s_nop 0
  s_nop 0
  v_mfma_f32_16x16x32_bf16 v[32:35], v[24:27], a[72:75], v[32:35]
  v_and_b32 v20, v28, v46
  v_and_b32 v21, v29, v46
  v_and_b32 v22, v30, v46
  v_and_b32 v23, v31, v46
  s_nop 0
  s_nop 0
  v_mfma_f32_16x16x32_bf16 v[32:35], v[20:23], a[76:79], v[32:35]
  v_and_b32 v24, v28, v47
  v_and_b32 v25, v29, v47
  v_and_b32 v26, v30, v47
  v_and_b32 v27, v31, v47
  s_nop 0
  s_nop 0
  v_mfma_f32_16x16x32_bf16 v[32:35], v[24:27], a[80:83], v[32:35]
  v_and_b32 v20, v28, v48
  v_and_b32 v21, v29, v48
  v_and_b32 v22, v30, v48
  v_and_b32 v23, v31, v48
  s_nop 0
  s_nop 0
  v_mfma_f32_16x16x32_bf16 v[32:35], v[20:23], a[84:87], v[32:35]
  v_and_b32 v24, v28, v49
  v_and_b32 v25, v29, v49
  v_and_b32 v26, v30, v49
  v_and_b32 v27, v31, v49
  s_nop 0
  s_nop 0
  v_mfma_f32_16x16x32_bf16 v[32:35], v[24:27], a[88:91], v[32:35]
  v_lshrrev_b32 v3, 1, v3
  s_lshl_b32 s26, s47, 7
  s_add_u32 s26, s26, s57
  s_lshl_b32 s26, s26, 8
  s_add_u32 s26, s26, 245366784
  s_nop 2
  v_cvt_pk_bf16_f32 v32, v32, v33
  v_cvt_pk_bf16_f32 v33, v34, v35
  v_min_u32 v32, -2, v32
  v_min_u32 v33, -2, v33
  s_mov_b32 exec_hi, 0
  buffer_store_dwordx2 v[32:33], v3, s[4:7], s26 offen sc1
  s_mov_b32 exec_hi, -1
  s_cmp_lg_u32 s16, 0
  s_cbranch_scc1 q_fail_58
  s_barrier
  s_lshl_b32 s26, s61, 21
  s_lshl_b32 s27, s59, 10
  s_add_u32 s26, s26, s27
  s_add_u32 s27, s26, 20971520
  s_add_u32 s28, s26, 27262976
  s_lshl_b32 s26, s47, 7
  s_add_u32 s26, s26, s17
  s_lshl_b32 s26, s26, 8
  s_add_u32 s26, s26, 245366784
  v_lshrrev_b32 v2, 8, v0
  v_and_b32 v3, 0xf0, v0
  v_lshl_add_u32 v5, v2, 10, v3
  buffer_load_dwordx4 v[36:39], v0, s[4:7], s27 offen sc1
  buffer_load_dwordx4 v[40:43], v0, s[4:7], s28 offen sc1
  s_mov_b32 s53, 0
m_w_71:
  s_add_u32 s27, s26, 0
  buffer_load_dwordx4 v[60:63], v5, s[4:7], s27 offen sc1
  s_add_u32 s27, s26, 4096
  buffer_load_dwordx4 v[64:67], v5, s[4:7], s27 offen sc1
  s_add_u32 s27, s26, 8192
  buffer_load_dwordx4 v[68:71], v5, s[4:7], s27 offen sc1
  s_add_u32 s27, s26, 12288
  buffer_load_dwordx4 v[72:75], v5, s[4:7], s27 offen sc1
  s_add_u32 s27, s26, 16384
  buffer_load_dwordx4 v[76:79], v5, s[4:7], s27 offen sc1
  s_add_u32 s27, s26, 20480
  buffer_load_dwordx4 v[80:83], v5, s[4:7], s27 offen sc1
  s_add_u32 s27, s26, 24576
  buffer_load_dwordx4 v[84:87], v5, s[4:7], s27 offen sc1
  s_add_u32 s27, s26, 28672
  buffer_load_dwordx4 v[88:91], v5, s[4:7], s27 offen sc1
  s_add_u32 s53, s53, 1
  s_cmp_gt_u32 s53, 1048576
  s_cbranch_scc1 q_fail_58
  s_mov_b32 vcc_lo, 0xaaaaaaaa
  s_mov_b32 vcc_hi, 0xaaaaaaaa
  v_mov_b32 v28, 0x3f80
  v_mov_b32 v20, 1.0
  v_cndmask_b32 v28, v28, v20, vcc
  s_mov_b32 vcc_lo, 0x30003
  s_mov_b32 vcc_hi, 0x30003
  v_cndmask_b32 v20, 0, v28, vcc
  s_mov_b32 vcc_lo, 0xc000c
  s_mov_b32 vcc_hi, 0xc000c
  v_cndmask_b32 v21, 0, v28, vcc
  s_mov_b32 vcc_lo, 0x300030
  s_mov_b32 vcc_hi, 0x300030
  v_cndmask_b32 v22, 0, v28, vcc
  s_mov_b32 vcc_lo, 0xc000c0
  s_mov_b32 vcc_hi, 0xc000c0
  v_cndmask_b32 v23, 0, v28, vcc
  s_waitcnt vmcnt(7)
  s_nop 0
  v_mfma_f32_16x16x32_bf16 v[28:31], v[20:23], v[60:63], 0
  v_max3_u32 v44, v60, v61, 0
  v_max3_u32 v44, v62, v63, v44
  s_waitcnt vmcnt(6)
  v_mfma_f32_16x16x32_bf16 v[28:31], v[20:23], v[64:67], v[28:31]
  v_max3_u32 v44, v64, v65, v44
  v_max3_u32 v44, v66, v67, v44
  s_waitcnt vmcnt(5)
  v_mfma_f32_16x16x32_bf16 v[28:31], v[20:23], v[68:71], v[28:31]
  v_max3_u32 v44, v68, v69, v44
  v_max3_u32 v44, v70, v71, v44
  s_waitcnt vmcnt(4)
  v_mfma_f32_16x16x32_bf16 v[28:31], v[20:23], v[72:75], v[28:31]
  v_max3_u32 v44, v72, v73, v44
  v_max3_u32 v44, v74, v75, v44
  s_waitcnt vmcnt(3)
  v_mfma_f32_16x16x32_bf16 v[28:31], v[20:23], v[76:79], v[28:31]
  v_max3_u32 v44, v76, v77, v44
  v_max3_u32 v44, v78, v79, v44
  s_waitcnt vmcnt(2)
  v_mfma_f32_16x16x32_bf16 v[28:31], v[20:23], v[80:83], v[28:31]
  v_max3_u32 v44, v80, v81, v44
  v_max3_u32 v44, v82, v83, v44
  s_waitcnt vmcnt(1)
  v_mfma_f32_16x16x32_bf16 v[28:31], v[20:23], v[84:87], v[28:31]
  v_max3_u32 v44, v84, v85, v44
  v_max3_u32 v44, v86, v87, v44
  s_waitcnt vmcnt(0)
  v_mfma_f32_16x16x32_bf16 v[28:31], v[20:23], v[88:91], v[28:31]
  v_max3_u32 v44, v88, v89, v44
  v_max3_u32 v44, v90, v91, v44
  v_cmp_eq_u32 vcc, -1, v44
  s_cbranch_vccnz m_w_71
  v_lshlrev_b32 v3, 1, v3
  v_lshl_add_u32 v3, v2, 4, v3
  s_lshl_b32 s26, s17, 9
  s_add_u32 s26, s26, 159744
  v_add_u32 v3, s26, v3
  s_mov_b32 exec_hi, 0
  ds_write_b128 v3, v[28:31]
  s_mov_b32 exec_hi, -1
  v_add_u32 v3, 159744, v9
  v_lshlrev_b32 v44, 16, v36
  v_and_b32 v45, 0xffff0000, v36
  v_lshlrev_b32 v46, 16, v37
  v_and_b32 v47, 0xffff0000, v37
  v_lshlrev_b32 v48, 16, v38
  v_and_b32 v49, 0xffff0000, v38
  v_lshlrev_b32 v50, 16, v39
  v_and_b32 v51, 0xffff0000, v39
  v_lshlrev_b32 v52, 16, v40
  v_and_b32 v53, 0xffff0000, v40
  v_lshlrev_b32 v54, 16, v41
  v_and_b32 v55, 0xffff0000, v41
  v_lshlrev_b32 v56, 16, v42
  v_and_b32 v57, 0xffff0000, v42
  v_lshlrev_b32 v58, 16, v43
  v_and_b32 v59, 0xffff0000, v43
  s_waitcnt lgkmcnt(0)
  s_barrier
  s_cmp_lg_u32 s17, 0
  s_cbranch_scc1 m_done_70
  ds_read_b128 v[28:31], v3
  ds_read_b128 v[32:35], v3 offset:16
  s_and_b32 s29, s58, 0xffff0000
  s_xor_b32 s27, s29, 0x80000000
  s_xor_b32 s28, s29, 0xffff0000
  s_bitcmp1_b32 s29, 31
  s_cselect_b32 s29, s27, s28
  v_mov_b32 v36, s29
  v_mul_f32 v36, 0xbfb8aa3b, v36
  v_exp_f32 v36, v36
  s_nop 0
  v_add_f32 v36, 1.0, v36
  v_rcp_f32 v36, v36
  s_nop 0
  v_cvt_pk_bf16_f32 v36, 0, v36
  s_waitcnt lgkmcnt(0)
  v_cvt_pk_bf16_f32 v28, 0, v28
  v_cvt_pk_bf16_f32 v29, 0, v29
  v_cvt_pk_bf16_f32 v30, 0, v30
  v_cvt_pk_bf16_f32 v31, 0, v31
  v_cvt_pk_bf16_f32 v32, 0, v32
  v_cvt_pk_bf16_f32 v33, 0, v33
  v_cvt_pk_bf16_f32 v34, 0, v34
  v_cvt_pk_bf16_f32 v35, 0, v35
  v_mul_f32 v28, v28, v36
  v_mul_f32 v29, v29, v36
  v_mul_f32 v30, v30, v36
  v_mul_f32 v31, v31, v36
  v_mul_f32 v32, v32, v36
  v_mul_f32 v33, v33, v36
  v_mul_f32 v34, v34, v36
  v_mul_f32 v35, v35, v36
  v_cvt_pk_bf16_f32 v28, 0, v28
  v_cvt_pk_bf16_f32 v29, 0, v29
  v_cvt_pk_bf16_f32 v30, 0, v30
  v_cvt_pk_bf16_f32 v31, 0, v31
  v_cvt_pk_bf16_f32 v32, 0, v32
  v_cvt_pk_bf16_f32 v33, 0, v33
  v_cvt_pk_bf16_f32 v34, 0, v34
  v_cvt_pk_bf16_f32 v35, 0, v35
  v_add_f32 v28, v28, v52
  v_add_f32 v29, v29, v53
  v_add_f32 v30, v30, v54
  v_add_f32 v31, v31, v55
  v_add_f32 v32, v32, v56
  v_add_f32 v33, v33, v57
  v_add_f32 v34, v34, v58
  v_add_f32 v35, v35, v59
  v_cvt_pk_bf16_f32 v28, 0, v28
  v_cvt_pk_bf16_f32 v29, 0, v29
  v_cvt_pk_bf16_f32 v30, 0, v30
  v_cvt_pk_bf16_f32 v31, 0, v31
  v_cvt_pk_bf16_f32 v32, 0, v32
  v_cvt_pk_bf16_f32 v33, 0, v33
  v_cvt_pk_bf16_f32 v34, 0, v34
  v_cvt_pk_bf16_f32 v35, 0, v35
  v_add_f32 v44, v44, v28
  v_add_f32 v45, v45, v29
  v_add_f32 v46, v46, v30
  v_add_f32 v47, v47, v31
  v_add_f32 v48, v48, v32
  v_add_f32 v49, v49, v33
  v_add_f32 v50, v50, v34
  v_add_f32 v51, v51, v35
  v_cvt_pk_bf16_f32 v40, v44, v45
  v_cvt_pk_bf16_f32 v41, v46, v47
  v_cvt_pk_bf16_f32 v42, v48, v49
  v_cvt_pk_bf16_f32 v43, v50, v51
  v_lshlrev_b32 v44, 16, v40
  v_and_b32 v45, 0xffff0000, v40
  v_lshlrev_b32 v46, 16, v41
  v_and_b32 v47, 0xffff0000, v41
  v_lshlrev_b32 v48, 16, v42
  v_and_b32 v49, 0xffff0000, v42
  v_lshlrev_b32 v50, 16, v43
  v_and_b32 v51, 0xffff0000, v43
  s_lshl_b32 s26, s59, 10
  buffer_store_dwordx4 v[40:43], v0, s[72:75], s26 offen sc1
m_done_70:
q_fail_58:
  s_endpgm
L_o:
  s_sub_u32 s60, s91, 3
  s_and_b32 s61, s90, 15
  s_lshl_b32 s26, s60, 4
  s_add_u32 s26, s26, s61
  s_lshl_b32 s26, s26, 12
  s_add_u32 s26, s26, 243269632
  v_lshlrev_b32 v1, 4, v0
  v_mov_b64 v[4:5], 0
  v_mov_b64 v[6:7], 0
  v_mov_b64 v[8:9], -1
  v_mov_b64 v[10:11], -1
  buffer_store_dwordx4 v[4:7], v1, s[4:7], s26 offen sc1
  s_add_u32 s26, s26, 262144
  buffer_store_dwordx4 v[4:7], v1, s[4:7], s26 offen sc1
  s_add_u32 s26, s26, 262144
  buffer_store_dwordx4 v[4:7], v1, s[4:7], s26 offen sc1
  s_add_u32 s26, s26, 262144
  buffer_store_dwordx4 v[4:7], v1, s[4:7], s26 offen sc1
  s_add_u32 s26, s26, 262144
  buffer_store_dwordx4 v[4:7], v1, s[4:7], s26 offen sc1
  s_add_u32 s26, s26, 262144
  buffer_store_dwordx4 v[4:7], v1, s[4:7], s26 offen sc1
  s_add_u32 s26, s26, 262144
  buffer_store_dwordx4 v[8:11], v1, s[4:7], s26 offen sc1
  s_add_u32 s26, s26, 262144
  buffer_store_dwordx4 v[8:11], v1, s[4:7], s26 offen sc1
  s_add_u32 s26, s26, 262144
  s_lshl_b32 s92, s60, 3
  s_load_dwordx2 s[80:81], s[0:1], 40
  s_mov_b32 s82, 4194304
  v_and_b32 v42, 63, v0
  v_and_b32 v40, 15, v42
  v_lshrrev_b32 v41, 4, v42
  v_lshlrev_b32 v1, 3, v42
  v_lshlrev_b32 v2, 2, v42
  v_lshlrev_b32 v0, 4, v42
  s_mov_b32 s24, 0x3e0293ee
  s_mov_b32 s44, 0x05040100
  s_mov_b32 s45, 0x07060302
  s_and_b32 s26, s17, 1
  s_lshl_b32 s26, s26, 4
  v_lshlrev_b32 v43, 2, v41
  v_sub_u32 v43, v40, v43
  v_add_u32 v43, s26, v43
  v_mov_b32 v7, 0xfe000000
  v_cmp_le_i32 vcc, 0, v43
  s_nop 1
  v_cndmask_b32 v24, v7, 0, vcc
  v_cmp_le_i32 vcc, 1, v43
  s_nop 1
  v_cndmask_b32 v25, v7, 0, vcc
  v_cmp_le_i32 vcc, 2, v43
  s_nop 1
  v_cndmask_b32 v26, v7, 0, vcc
  v_cmp_le_i32 vcc, 3, v43
  s_nop 1
  v_cndmask_b32 v27, v7, 0, vcc
  v_cmp_le_i32 vcc, 16, v43
  s_nop 1
  v_cndmask_b32 v28, v7, 0, vcc
  v_cmp_le_i32 vcc, 17, v43
  s_nop 1
  v_cndmask_b32 v29, v7, 0, vcc
  v_cmp_le_i32 vcc, 18, v43
  s_nop 1
  v_cndmask_b32 v30, v7, 0, vcc
  v_cmp_le_i32 vcc, 19, v43
  s_nop 1
  v_cndmask_b32 v31, v7, 0, vcc
  v_lshrrev_b32 v43, 5, v42
  v_lshlrev_b32 v43, 16, v43
  v_and_b32 v4, 0xff, v1
  v_add_u32 v43, v43, v4
  s_lshl_b32 s26, s61, 10
  s_lshl_b32 s27, s17, 8
  s_add_u32 s26, s26, s27
  v_add_u32 v4, s26, v43
  v_lshlrev_b32 v43, 10, v41
  v_lshl_add_u32 v5, v40, 4, v43
  s_lshl_b32 s26, s17, 12
  v_add_u32 v6, s26, v0
  v_and_b32 v43, 1, v41
  v_lshlrev_b32 v43, 12, v43
  v_lshl_add_u32 v43, v40, 4, v43
  v_lshrrev_b32 v3, 1, v41
  v_lshl_add_u32 v3, v3, 8, v43
  s_lshr_b32 s26, s17, 1
  s_lshl_b32 s27, s26, 14
  s_add_u32 s27, s27, 16384
  v_add_u32 v32, s27, v0
  s_lshl_b32 s27, s26, 13
  s_and_b32 s28, s17, 1
  s_lshl_b32 s28, s28, 10
  s_add_u32 s28, s28, s27
  s_add_u32 s28, s28, 49152
  v_add_u32 v33, s28, v0
  s_add_u32 s27, s27, 65536
  v_add_u32 v34, s27, v0
  v_add_u32 v35, s27, v1
  v_and_b32 v36, 0x70, v0
  s_lshl_b32 s26, s17, 2
  s_add_u32 s26, s26, 81920
  v_mov_b32 v39, s26
  s_mov_b32 vcc_lo, 0xaaaaaaaa
  s_mov_b32 vcc_hi, 0xaaaaaaaa
  v_mov_b32 v43, 0x3f80
  v_mov_b32 v16, 1.0
  v_cndmask_b32 v43, v43, v16, vcc
  s_mov_b32 vcc_lo, 0x30003
  s_mov_b32 vcc_hi, 0x30003
  v_cndmask_b32 v16, 0, v43, vcc
  s_mov_b32 vcc_lo, 0xc000c
  s_mov_b32 vcc_hi, 0xc000c
  v_cndmask_b32 v17, 0, v43, vcc
  s_mov_b32 vcc_lo, 0x300030
  s_mov_b32 vcc_hi, 0x300030
  v_cndmask_b32 v18, 0, v43, vcc
  s_mov_b32 vcc_lo, 0xc000c0
  s_mov_b32 vcc_hi, 0xc000c0
  v_cndmask_b32 v19, 0, v43, vcc
  s_mov_b32 vcc_lo, 0x3000300
  s_mov_b32 vcc_hi, 0x3000300
  v_cndmask_b32 v20, 0, v43, vcc
  s_mov_b32 vcc_lo, 0xc000c00
  s_mov_b32 vcc_hi, 0xc000c00
  v_cndmask_b32 v21, 0, v43, vcc
  s_mov_b32 vcc_lo, 0x30003000
  s_mov_b32 vcc_hi, 0x30003000
  v_cndmask_b32 v22, 0, v43, vcc
  s_mov_b32 vcc_lo, 0xc000c000
  s_mov_b32 vcc_hi, 0xc000c000
  v_cndmask_b32 v23, 0, v43, vcc
  s_load_dwordx2 s[68:69], s[0:1], 96
  s_load_dwordx2 s[72:73], s[0:1], 0
  s_load_dwordx2 s[8:9], s[0:1], 64
  s_mov_b32 s70, 2097152
  s_mov_b32 s71, 0x20000
  s_mov_b32 s74, 2097152
  s_mov_b32 s75, 0x20000
  s_mov_b32 s10, 1024
  s_mov_b32 s83, 0x20000
  s_lshr_b32 s85, s17, 1
  s_lshl_b32 s26, s61, 1
  s_add_u32 s85, s85, s26
  s_add_u32 s43, s26, s17
  s_lshl_b32 s14, s85, 7
  s_lshl_b32 s15, s85, 6
  s_add_u32 s15, s15, 244449280
  s_add_u32 s14, s14, 243662848
  s_lshl_b32 s26, s61, 2
  s_add_u32 s26, s26, s17
  s_lshl_b32 s18, s26, 13
  s_add_u32 s18, s18, 41943040
  s_lshl_b32 s19, s26, 12
  s_add_u32 s19, s19, 142606336
  s_lshl_b32 s42, s60, 8
  s_add_u32 s42, s42, s26
  s_lshl_b32 s42, s42, 2
  s_add_u32 s42, s42, 243597312
  s_lshl_b32 s20, s85, 13
  s_add_u32 s20, s20, 192937984
  s_and_b32 s26, s17, 1
  s_mul_i32 s26, s26, 3072
  s_add_u32 s21, s20, s26
  s_lshr_b32 s40, s17, 1
  s_lshl_b32 s40, s40, 13
  s_add_u32 s40, s40, s26
  s_add_u32 s40, s40, 65536
  s_lshl_b32 s22, s17, 12
  s_add_u32 s22, s22, 49152
  s_lshl_b32 s23, s17, 13
  s_add_u32 s23, s23, 16384
  s_lshl_b32 s41, s60, 21
  s_add_u32 s41, s41, 12582912
  v_lshlrev_b32 v246, 1, v0
  s_mov_b32 s11, 0x20000
  s_waitcnt lgkmcnt(0)
  s_lshl_b32 s77, s60, 4
  s_add_u32 s77, s77, s61
  s_lshl_b32 s77, s77, 2
  s_add_u32 s77, s77, s17
  s_lshl_b32 s26, s77, 10
  buffer_load_dwordx4 v[56:59], v0, s[8:11], 0 offen
  buffer_load_dwordx4 v[176:179], v0, s[72:75], s26 offen
  s_add_u32 s26, s26, 262144
  buffer_load_dwordx4 v[180:183], v0, s[72:75], s26 offen
  s_add_u32 s26, s26, 262144
  buffer_load_dwordx4 v[184:187], v0, s[72:75], s26 offen
  s_add_u32 s26, s26, 262144
  buffer_load_dwordx4 v[188:191], v0, s[72:75], s26 offen
  s_add_u32 s26, s26, 262144
  buffer_load_dwordx4 v[192:195], v0, s[72:75], s26 offen
  s_add_u32 s26, s26, 262144
  buffer_load_dwordx4 v[196:199], v0, s[72:75], s26 offen
  s_add_u32 s26, s26, 262144
  buffer_load_dwordx4 v[200:203], v0, s[72:75], s26 offen
  s_add_u32 s26, s26, 262144
  buffer_load_dwordx4 v[204:207], v0, s[72:75], s26 offen
  s_add_u32 s26, s26, 262144
  v_lshrrev_b32 v44, 9, v0
  v_lshlrev_b32 v44, 12, v44
  v_and_b32 v45, 0xff, v1
  v_add_u32 v44, v44, v45
  s_lshl_b32 s30, s61, 18
  s_lshl_b32 s27, s17, 8
  s_add_u32 s30, s30, s27
  s_add_u32 s27, s30, 0
  buffer_load_dwordx2 v[64:65], v44, s[80:83], s27 offen
  s_add_u32 s27, s30, 1024
  buffer_load_dwordx2 v[66:67], v44, s[80:83], s27 offen
  s_add_u32 s27, s30, 2048
  buffer_load_dwordx2 v[68:69], v44, s[80:83], s27 offen
  s_add_u32 s27, s30, 3072
  buffer_load_dwordx2 v[70:71], v44, s[80:83], s27 offen
  s_add_u32 s27, s30, 16384
  buffer_load_dwordx2 v[72:73], v44, s[80:83], s27 offen
  s_add_u32 s27, s30, 17408
  buffer_load_dwordx2 v[74:75], v44, s[80:83], s27 offen
  s_add_u32 s27, s30, 18432
  buffer_load_dwordx2 v[76:77], v44, s[80:83], s27 offen
  s_add_u32 s27, s30, 19456
  buffer_load_dwordx2 v[78:79], v44, s[80:83], s27 offen
  s_add_u32 s27, s30, 8192
  buffer_load_dwordx2 v[80:81], v44, s[80:83], s27 offen
  s_add_u32 s27, s30, 9216
  buffer_load_dwordx2 v[82:83], v44, s[80:83], s27 offen
  s_add_u32 s27, s30, 10240
  buffer_load_dwordx2 v[84:85], v44, s[80:83], s27 offen
  s_add_u32 s27, s30, 11264
  buffer_load_dwordx2 v[86:87], v44, s[80:83], s27 offen
  s_add_u32 s27, s30, 24576
  buffer_load_dwordx2 v[88:89], v44, s[80:83], s27 offen
  s_add_u32 s27, s30, 25600
  buffer_load_dwordx2 v[90:91], v44, s[80:83], s27 offen
  s_add_u32 s27, s30, 26624
  buffer_load_dwordx2 v[92:93], v44, s[80:83], s27 offen
  s_add_u32 s27, s30, 27648
  buffer_load_dwordx2 v[94:95], v44, s[80:83], s27 offen
  s_add_u32 s27, s30, 32768
  buffer_load_dwordx2 v[96:97], v44, s[80:83], s27 offen
  s_add_u32 s27, s30, 33792
  buffer_load_dwordx2 v[98:99], v44, s[80:83], s27 offen
  s_add_u32 s27, s30, 34816
  buffer_load_dwordx2 v[100:101], v44, s[80:83], s27 offen
  s_add_u32 s27, s30, 35840
  buffer_load_dwordx2 v[102:103], v44, s[80:83], s27 offen
  s_add_u32 s27, s30, 49152
  buffer_load_dwordx2 v[104:105], v44, s[80:83], s27 offen
  s_add_u32 s27, s30, 50176
  buffer_load_dwordx2 v[106:107], v44, s[80:83], s27 offen
  s_add_u32 s27, s30, 51200
  buffer_load_dwordx2 v[108:109], v44, s[80:83], s27 offen
  s_add_u32 s27, s30, 52224
  buffer_load_dwordx2 v[110:111], v44, s[80:83], s27 offen
  s_add_u32 s27, s30, 40960
  buffer_load_dwordx2 v[112:113], v44, s[80:83], s27 offen
  s_add_u32 s27, s30, 41984
  buffer_load_dwordx2 v[114:115], v44, s[80:83], s27 offen
  s_add_u32 s27, s30, 43008
  buffer_load_dwordx2 v[116:117], v44, s[80:83], s27 offen
  s_add_u32 s27, s30, 44032
  buffer_load_dwordx2 v[118:119], v44, s[80:83], s27 offen
  s_add_u32 s27, s30, 57344
  buffer_load_dwordx2 v[120:121], v44, s[80:83], s27 offen
  s_add_u32 s27, s30, 58368
  buffer_load_dwordx2 v[122:123], v44, s[80:83], s27 offen
  s_add_u32 s27, s30, 59392
  buffer_load_dwordx2 v[124:125], v44, s[80:83], s27 offen
  s_add_u32 s27, s30, 60416
  buffer_load_dwordx2 v[126:127], v44, s[80:83], s27 offen
  s_add_u32 s27, s30, 65536
  buffer_load_dwordx2 v[128:129], v44, s[80:83], s27 offen
  s_add_u32 s27, s30, 66560
  buffer_load_dwordx2 v[130:131], v44, s[80:83], s27 offen
  s_add_u32 s27, s30, 67584
  buffer_load_dwordx2 v[132:133], v44, s[80:83], s27 offen
  s_add_u32 s27, s30, 68608
  buffer_load_dwordx2 v[134:135], v44, s[80:83], s27 offen
  s_add_u32 s27, s30, 81920
  buffer_load_dwordx2 v[136:137], v44, s[80:83], s27 offen
  s_add_u32 s27, s30, 82944
  buffer_load_dwordx2 v[138:139], v44, s[80:83], s27 offen
  s_add_u32 s27, s30, 83968
  buffer_load_dwordx2 v[140:141], v44, s[80:83], s27 offen
  s_add_u32 s27, s30, 84992
  buffer_load_dwordx2 v[142:143], v44, s[80:83], s27 offen
  s_waitcnt vmcnt(48)
  s_barrier
  s_cmp_lg_u32 s17, 0
  s_cbranch_scc1 g_ar_72
  s_lshl_b32 s36, s89, 3
  s_lshl_b64 s[36:37], 1, s36
  v_mov_b32 v62, s92
  v_mov_b32 v60, s36
  v_mov_b32 v61, s37
  s_mov_b64 exec, 1
  global_atomic_add_x2 v62, v[60:61], s[12:13]
  s_mov_b64 exec, -1
g_ar_72:
  s_add_u32 s27, s30, 73728
  buffer_load_dwordx2 v[144:145], v44, s[80:83], s27 offen
  s_add_u32 s27, s30, 74752
  buffer_load_dwordx2 v[146:147], v44, s[80:83], s27 offen
  s_add_u32 s27, s30, 75776
  buffer_load_dwordx2 v[148:149], v44, s[80:83], s27 offen
  s_add_u32 s27, s30, 76800
  buffer_load_dwordx2 v[150:151], v44, s[80:83], s27 offen
  s_add_u32 s27, s30, 90112
  buffer_load_dwordx2 v[152:153], v44, s[80:83], s27 offen
  s_add_u32 s27, s30, 91136
  buffer_load_dwordx2 v[154:155], v44, s[80:83], s27 offen
  s_add_u32 s27, s30, 92160
  buffer_load_dwordx2 v[156:157], v44, s[80:83], s27 offen
  s_add_u32 s27, s30, 93184
  buffer_load_dwordx2 v[158:159], v44, s[80:83], s27 offen
  v_lshlrev_b32 v8, 16, v56
  v_and_b32 v9, 0xffff0000, v56
  v_lshlrev_b32 v10, 16, v57
  v_and_b32 v11, 0xffff0000, v57
  v_lshlrev_b32 v12, 16, v58
  v_and_b32 v13, 0xffff0000, v58
  v_lshlrev_b32 v14, 16, v59
  v_and_b32 v15, 0xffff0000, v59
  v_mul_f32 v56, v8, v8
  v_fmac_f32 v56, v9, v9
  v_fmac_f32 v56, v10, v10
  v_fmac_f32 v56, v11, v11
  v_fmac_f32 v56, v12, v12
  v_fmac_f32 v56, v13, v13
  v_fmac_f32 v56, v14, v14
  v_fmac_f32 v56, v15, v15
  s_nop 0
  s_nop 0
  v_add_f32_dpp v56, v56, v56 row_ror:8 row_mask:0xf bank_mask:0xf
  s_nop 1
  v_add_f32_dpp v56, v56, v56 row_ror:4 row_mask:0xf bank_mask:0xf
  s_nop 1
  v_add_f32_dpp v56, v56, v56 row_ror:2 row_mask:0xf bank_mask:0xf
  s_nop 1
  v_add_f32_dpp v56, v56, v56 row_ror:1 row_mask:0xf bank_mask:0xf
  v_mov_b32 v57, v56
  s_nop 0
  s_nop 0
  v_permlane16_swap_b32 v56, v57
  v_add_f32 v56, v56, v57
  v_mov_b32 v57, v56
  s_nop 0
  s_nop 0
  v_permlane32_swap_b32 v56, v57
  v_add_f32 v56, v56, v57
  v_sqrt_f32 v56, v56
  s_mov_b32 s28, 0x40598569
  v_writelane_b32 v247, s28, 0
  s_mov_b32 s28, 0x40598569
  v_writelane_b32 v247, s28, 1
  s_mov_b32 s28, 0x4058ade7
  v_writelane_b32 v247, s28, 2
  s_mov_b32 s28, 0x40577c32
  v_writelane_b32 v247, s28, 3
  s_mov_b32 s28, 0x40563297
  v_writelane_b32 v247, s28, 4
  s_mov_b32 s28, 0x4054cd28
  v_writelane_b32 v247, s28, 5
  s_mov_b32 s28, 0x405346f2
  v_writelane_b32 v247, s28, 6
  s_mov_b32 s28, 0x40519992
  v_writelane_b32 v247, s28, 7
  s_mov_b32 s28, 0x404fbc99
  v_writelane_b32 v247, s28, 8
  s_mov_b32 s28, 0x404da49a
  v_writelane_b32 v247, s28, 9
  s_mov_b32 s28, 0x404b418a
  v_writelane_b32 v247, s28, 10
  s_mov_b32 s28, 0x40487bed
  v_writelane_b32 v247, s28, 11
  s_mov_b32 s28, 0x40452f68
  v_writelane_b32 v247, s28, 12
  s_mov_b32 s28, 0x0
  v_writelane_b32 v247, s28, 13
  s_mov_b32 s28, 0x0
  v_writelane_b32 v247, s28, 14
  s_mov_b32 s28, 0x0
  v_writelane_b32 v247, s28, 15
  v_mul_f32 v247, v247, v56
  v_or_b32 v247, 0x80000000, v247
  s_waitcnt vmcnt(48)
  s_add_u32 s27, s30, 98304
  buffer_load_dwordx2 v[160:161], v44, s[80:83], s27 offen
  s_add_u32 s27, s30, 99328
  buffer_load_dwordx2 v[162:163], v44, s[80:83], s27 offen
  s_add_u32 s27, s30, 100352
  buffer_load_dwordx2 v[164:165], v44, s[80:83], s27 offen
  s_add_u32 s27, s30, 101376
  buffer_load_dwordx2 v[166:167], v44, s[80:83], s27 offen
  s_add_u32 s27, s30, 114688
  buffer_load_dwordx2 v[168:169], v44, s[80:83], s27 offen
  s_add_u32 s27, s30, 115712
  buffer_load_dwordx2 v[170:171], v44, s[80:83], s27 offen
  s_add_u32 s27, s30, 116736
  buffer_load_dwordx2 v[172:173], v44, s[80:83], s27 offen
  s_add_u32 s27, s30, 117760
  buffer_load_dwordx2 v[174:175], v44, s[80:83], s27 offen
  s_lshl_b32 s29, s77, 10
  s_add_u32 s29, s29, 6291456
  v_lshlrev_b32 v208, 16, v176
  v_and_b32 v209, 0xffff0000, v176
  v_lshlrev_b32 v210, 16, v177
  v_and_b32 v211, 0xffff0000, v177
  v_lshlrev_b32 v212, 16, v178
  v_and_b32 v213, 0xffff0000, v178
  v_lshlrev_b32 v214, 16, v179
  v_and_b32 v215, 0xffff0000, v179
  v_add_f32 v216, v208, v209
  v_add_f32 v217, v210, v211
  v_add_f32 v218, v212, v213
  v_add_f32 v219, v214, v215
  v_add_f32 v216, v216, v217
  v_add_f32 v218, v218, v219
  v_add_f32 v216, v216, v218
  s_nop 1
  v_add_f32_dpp v216, v216, v216 row_ror:8 row_mask:0xf bank_mask:0xf
  s_nop 1
  v_add_f32_dpp v216, v216, v216 row_ror:4 row_mask:0xf bank_mask:0xf
  s_nop 1
  v_add_f32_dpp v216, v216, v216 row_ror:2 row_mask:0xf bank_mask:0xf
  s_nop 1
  v_add_f32_dpp v216, v216, v216 row_ror:1 row_mask:0xf bank_mask:0xf
  v_mov_b32 v218, v216
  s_nop 0
  s_nop 0
  v_permlane16_swap_b32 v216, v218
  v_add_f32 v216, v216, v218
  v_mov_b32 v218, v216
  s_nop 0
  s_nop 0
  v_permlane32_swap_b32 v216, v218
  v_add_f32 v216, v216, v218
  v_mul_f32 v216, 0x3b000000, v216
  v_sub_f32 v220, v208, v216
  v_sub_f32 v221, v209, v216
  v_sub_f32 v222, v210, v216
  v_sub_f32 v223, v211, v216
  v_sub_f32 v224, v212, v216
  v_sub_f32 v225, v213, v216
  v_sub_f32 v226, v214, v216
  v_sub_f32 v227, v215, v216
  v_mul_f32 v217, v220, v220
  v_mul_f32 v218, v221, v221
  v_fmac_f32 v217, v222, v222
  v_fmac_f32 v218, v223, v223
  v_fmac_f32 v217, v224, v224
  v_fmac_f32 v218, v225, v225
  v_fmac_f32 v217, v226, v226
  v_fmac_f32 v218, v227, v227
  v_add_f32 v217, v217, v218
  v_cvt_pk_bf16_f32 v216, 0, v216
  s_nop 0
  v_add_f32_dpp v217, v217, v217 row_ror:8 row_mask:0xf bank_mask:0xf
  v_sub_f32 v220, v208, v216
  v_sub_f32 v221, v209, v216
  v_add_f32_dpp v217, v217, v217 row_ror:4 row_mask:0xf bank_mask:0xf
  v_sub_f32 v222, v210, v216
  v_sub_f32 v223, v211, v216
  v_add_f32_dpp v217, v217, v217 row_ror:2 row_mask:0xf bank_mask:0xf
  v_sub_f32 v224, v212, v216
  v_sub_f32 v225, v213, v216
  v_add_f32_dpp v217, v217, v217 row_ror:1 row_mask:0xf bank_mask:0xf
  v_sub_f32 v226, v214, v216
  v_sub_f32 v227, v215, v216
  v_mov_b32 v218, v217
  v_cvt_pk_bf16_f32 v220, 0, v220
  v_cvt_pk_bf16_f32 v221, 0, v221
  v_permlane16_swap_b32 v217, v218
  v_cvt_pk_bf16_f32 v222, 0, v222
  v_cvt_pk_bf16_f32 v223, 0, v223
  v_add_f32 v217, v217, v218
  v_cvt_pk_bf16_f32 v224, 0, v224
  v_cvt_pk_bf16_f32 v225, 0, v225
  v_mov_b32 v218, v217
  v_cvt_pk_bf16_f32 v226, 0, v226
  v_cvt_pk_bf16_f32 v227, 0, v227
  v_permlane32_swap_b32 v217, v218
  v_add_f32 v217, v217, v218
  v_mul_f32 v217, 0x3b000000, v217
  v_cvt_pk_bf16_f32 v217, 0, v217
  v_add_f32 v217, 0x3727c5ac, v217
  v_cvt_pk_bf16_f32 v217, 0, v217
  v_sqrt_f32 v217, v217
  s_nop 0
  v_cvt_pk_bf16_f32 v217, 0, v217
  v_rcp_f32 v217, v217
  s_nop 0
  v_mul_f32 v220, v220, v217
  v_mul_f32 v221, v221, v217
  v_mul_f32 v222, v222, v217
  v_mul_f32 v223, v223, v217
  v_mul_f32 v224, v224, v217
  v_mul_f32 v225, v225, v217
  v_mul_f32 v226, v226, v217
  v_mul_f32 v227, v227, v217
  v_cvt_pk_bf16_f32 v176, v220, v221
  v_cvt_pk_bf16_f32 v177, v222, v223
  v_cvt_pk_bf16_f32 v178, v224, v225
  v_cvt_pk_bf16_f32 v179, v226, v227
  buffer_store_dwordx4 v[176:179], v0, s[4:7], s29 offen sc1
  s_add_u32 s29, s29, 262144
  v_lshlrev_b32 v208, 16, v180
  v_and_b32 v209, 0xffff0000, v180
  v_lshlrev_b32 v210, 16, v181
  v_and_b32 v211, 0xffff0000, v181
  v_lshlrev_b32 v212, 16, v182
  v_and_b32 v213, 0xffff0000, v182
  v_lshlrev_b32 v214, 16, v183
  v_and_b32 v215, 0xffff0000, v183
  v_add_f32 v216, v208, v209
  v_add_f32 v217, v210, v211
  v_add_f32 v218, v212, v213
  v_add_f32 v219, v214, v215
  v_add_f32 v216, v216, v217
  v_add_f32 v218, v218, v219
  v_add_f32 v216, v216, v218
  s_nop 1
  v_add_f32_dpp v216, v216, v216 row_ror:8 row_mask:0xf bank_mask:0xf
  s_nop 1
  v_add_f32_dpp v216, v216, v216 row_ror:4 row_mask:0xf bank_mask:0xf
  s_nop 1
  v_add_f32_dpp v216, v216, v216 row_ror:2 row_mask:0xf bank_mask:0xf
  s_nop 1
  v_add_f32_dpp v216, v216, v216 row_ror:1 row_mask:0xf bank_mask:0xf
  v_mov_b32 v218, v216
  s_nop 0
  s_nop 0
  v_permlane16_swap_b32 v216, v218
  v_add_f32 v216, v216, v218
  v_mov_b32 v218, v216
  s_nop 0
  s_nop 0
  v_permlane32_swap_b32 v216, v218
  v_add_f32 v216, v216, v218
  v_mul_f32 v216, 0x3b000000, v216
  v_sub_f32 v220, v208, v216
  v_sub_f32 v221, v209, v216
  v_sub_f32 v222, v210, v216
  v_sub_f32 v223, v211, v216
  v_sub_f32 v224, v212, v216
  v_sub_f32 v225, v213, v216
  v_sub_f32 v226, v214, v216
  v_sub_f32 v227, v215, v216
  v_mul_f32 v217, v220, v220
  v_mul_f32 v218, v221, v221
  v_fmac_f32 v217, v222, v222
  v_fmac_f32 v218, v223, v223
  v_fmac_f32 v217, v224, v224
  v_fmac_f32 v218, v225, v225
  v_fmac_f32 v217, v226, v226
  v_fmac_f32 v218, v227, v227
  v_add_f32 v217, v217, v218
  v_cvt_pk_bf16_f32 v216, 0, v216
  s_nop 0
  v_add_f32_dpp v217, v217, v217 row_ror:8 row_mask:0xf bank_mask:0xf
  v_sub_f32 v220, v208, v216
  v_sub_f32 v221, v209, v216
  v_add_f32_dpp v217, v217, v217 row_ror:4 row_mask:0xf bank_mask:0xf
  v_sub_f32 v222, v210, v216
  v_sub_f32 v223, v211, v216
  v_add_f32_dpp v217, v217, v217 row_ror:2 row_mask:0xf bank_mask:0xf
  v_sub_f32 v224, v212, v216
  v_sub_f32 v225, v213, v216
  v_add_f32_dpp v217, v217, v217 row_ror:1 row_mask:0xf bank_mask:0xf
  v_sub_f32 v226, v214, v216
  v_sub_f32 v227, v215, v216
  v_mov_b32 v218, v217
  v_cvt_pk_bf16_f32 v220, 0, v220
  v_cvt_pk_bf16_f32 v221, 0, v221
  v_permlane16_swap_b32 v217, v218
  v_cvt_pk_bf16_f32 v222, 0, v222
  v_cvt_pk_bf16_f32 v223, 0, v223
  v_add_f32 v217, v217, v218
  v_cvt_pk_bf16_f32 v224, 0, v224
  v_cvt_pk_bf16_f32 v225, 0, v225
  v_mov_b32 v218, v217
  v_cvt_pk_bf16_f32 v226, 0, v226
  v_cvt_pk_bf16_f32 v227, 0, v227
  v_permlane32_swap_b32 v217, v218
  v_add_f32 v217, v217, v218
  v_mul_f32 v217, 0x3b000000, v217
  v_cvt_pk_bf16_f32 v217, 0, v217
  v_add_f32 v217, 0x3727c5ac, v217
  v_cvt_pk_bf16_f32 v217, 0, v217
  v_sqrt_f32 v217, v217
  s_nop 0
  v_cvt_pk_bf16_f32 v217, 0, v217
  v_rcp_f32 v217, v217
  s_nop 0
  v_mul_f32 v220, v220, v217
  v_mul_f32 v221, v221, v217
  v_mul_f32 v222, v222, v217
  v_mul_f32 v223, v223, v217
  v_mul_f32 v224, v224, v217
  v_mul_f32 v225, v225, v217
  v_mul_f32 v226, v226, v217
  v_mul_f32 v227, v227, v217
  v_cvt_pk_bf16_f32 v180, v220, v221
  v_cvt_pk_bf16_f32 v181, v222, v223
  v_cvt_pk_bf16_f32 v182, v224, v225
  v_cvt_pk_bf16_f32 v183, v226, v227
  buffer_store_dwordx4 v[180:183], v0, s[4:7], s29 offen sc1
  s_add_u32 s29, s29, 262144
  v_lshlrev_b32 v208, 16, v184
  v_and_b32 v209, 0xffff0000, v184
  v_lshlrev_b32 v210, 16, v185
  v_and_b32 v211, 0xffff0000, v185
  v_lshlrev_b32 v212, 16, v186
  v_and_b32 v213, 0xffff0000, v186
  v_lshlrev_b32 v214, 16, v187
  v_and_b32 v215, 0xffff0000, v187
  v_add_f32 v216, v208, v209
  v_add_f32 v217, v210, v211
  v_add_f32 v218, v212, v213
  v_add_f32 v219, v214, v215
  v_add_f32 v216, v216, v217
  v_add_f32 v218, v218, v219
  v_add_f32 v216, v216, v218
  s_nop 1
  v_add_f32_dpp v216, v216, v216 row_ror:8 row_mask:0xf bank_mask:0xf
  s_nop 1
  v_add_f32_dpp v216, v216, v216 row_ror:4 row_mask:0xf bank_mask:0xf
  s_nop 1
  v_add_f32_dpp v216, v216, v216 row_ror:2 row_mask:0xf bank_mask:0xf
  s_nop 1
  v_add_f32_dpp v216, v216, v216 row_ror:1 row_mask:0xf bank_mask:0xf
  v_mov_b32 v218, v216
  s_nop 0
  s_nop 0
  v_permlane16_swap_b32 v216, v218
  v_add_f32 v216, v216, v218
  v_mov_b32 v218, v216
  s_nop 0
  s_nop 0
  v_permlane32_swap_b32 v216, v218
  v_add_f32 v216, v216, v218
  v_mul_f32 v216, 0x3b000000, v216
  v_sub_f32 v220, v208, v216
  v_sub_f32 v221, v209, v216
  v_sub_f32 v222, v210, v216
  v_sub_f32 v223, v211, v216
  v_sub_f32 v224, v212, v216
  v_sub_f32 v225, v213, v216
  v_sub_f32 v226, v214, v216
  v_sub_f32 v227, v215, v216
  v_mul_f32 v217, v220, v220
  v_mul_f32 v218, v221, v221
  v_fmac_f32 v217, v222, v222
  v_fmac_f32 v218, v223, v223
  v_fmac_f32 v217, v224, v224
  v_fmac_f32 v218, v225, v225
  v_fmac_f32 v217, v226, v226
  v_fmac_f32 v218, v227, v227
  v_add_f32 v217, v217, v218
  v_cvt_pk_bf16_f32 v216, 0, v216
  s_nop 0
  v_add_f32_dpp v217, v217, v217 row_ror:8 row_mask:0xf bank_mask:0xf
  v_sub_f32 v220, v208, v216
  v_sub_f32 v221, v209, v216
  v_add_f32_dpp v217, v217, v217 row_ror:4 row_mask:0xf bank_mask:0xf
  v_sub_f32 v222, v210, v216
  v_sub_f32 v223, v211, v216
  v_add_f32_dpp v217, v217, v217 row_ror:2 row_mask:0xf bank_mask:0xf
  v_sub_f32 v224, v212, v216
  v_sub_f32 v225, v213, v216
  v_add_f32_dpp v217, v217, v217 row_ror:1 row_mask:0xf bank_mask:0xf
  v_sub_f32 v226, v214, v216
  v_sub_f32 v227, v215, v216
  v_mov_b32 v218, v217
  v_cvt_pk_bf16_f32 v220, 0, v220
  v_cvt_pk_bf16_f32 v221, 0, v221
  v_permlane16_swap_b32 v217, v218
  v_cvt_pk_bf16_f32 v222, 0, v222
  v_cvt_pk_bf16_f32 v223, 0, v223
  v_add_f32 v217, v217, v218
  v_cvt_pk_bf16_f32 v224, 0, v224
  v_cvt_pk_bf16_f32 v225, 0, v225
  v_mov_b32 v218, v217
  v_cvt_pk_bf16_f32 v226, 0, v226
  v_cvt_pk_bf16_f32 v227, 0, v227
  v_permlane32_swap_b32 v217, v218
  v_add_f32 v217, v217, v218
  v_mul_f32 v217, 0x3b000000, v217
  v_cvt_pk_bf16_f32 v217, 0, v217
  v_add_f32 v217, 0x3727c5ac, v217
  v_cvt_pk_bf16_f32 v217, 0, v217
  v_sqrt_f32 v217, v217
  s_nop 0
  v_cvt_pk_bf16_f32 v217, 0, v217
  v_rcp_f32 v217, v217
  s_nop 0
  v_mul_f32 v220, v220, v217
  v_mul_f32 v221, v221, v217
  v_mul_f32 v222, v222, v217
  v_mul_f32 v223, v223, v217
  v_mul_f32 v224, v224, v217
  v_mul_f32 v225, v225, v217
  v_mul_f32 v226, v226, v217
  v_mul_f32 v227, v227, v217
  v_cvt_pk_bf16_f32 v184, v220, v221
  v_cvt_pk_bf16_f32 v185, v222, v223
  v_cvt_pk_bf16_f32 v186, v224, v225
  v_cvt_pk_bf16_f32 v187, v226, v227
  buffer_store_dwordx4 v[184:187], v0, s[4:7], s29 offen sc1
  s_add_u32 s29, s29, 262144
  v_lshlrev_b32 v208, 16, v188
  v_and_b32 v209, 0xffff0000, v188
  v_lshlrev_b32 v210, 16, v189
  v_and_b32 v211, 0xffff0000, v189
  v_lshlrev_b32 v212, 16, v190
  v_and_b32 v213, 0xffff0000, v190
  v_lshlrev_b32 v214, 16, v191
  v_and_b32 v215, 0xffff0000, v191
  v_add_f32 v216, v208, v209
  v_add_f32 v217, v210, v211
  v_add_f32 v218, v212, v213
  v_add_f32 v219, v214, v215
  v_add_f32 v216, v216, v217
  v_add_f32 v218, v218, v219
  v_add_f32 v216, v216, v218
  s_nop 1
  v_add_f32_dpp v216, v216, v216 row_ror:8 row_mask:0xf bank_mask:0xf
  s_nop 1
  v_add_f32_dpp v216, v216, v216 row_ror:4 row_mask:0xf bank_mask:0xf
  s_nop 1
  v_add_f32_dpp v216, v216, v216 row_ror:2 row_mask:0xf bank_mask:0xf
  s_nop 1
  v_add_f32_dpp v216, v216, v216 row_ror:1 row_mask:0xf bank_mask:0xf
  v_mov_b32 v218, v216
  s_nop 0
  s_nop 0
  v_permlane16_swap_b32 v216, v218
  v_add_f32 v216, v216, v218
  v_mov_b32 v218, v216
  s_nop 0
  s_nop 0
  v_permlane32_swap_b32 v216, v218
  v_add_f32 v216, v216, v218
  v_mul_f32 v216, 0x3b000000, v216
  v_sub_f32 v220, v208, v216
  v_sub_f32 v221, v209, v216
  v_sub_f32 v222, v210, v216
  v_sub_f32 v223, v211, v216
  v_sub_f32 v224, v212, v216
  v_sub_f32 v225, v213, v216
  v_sub_f32 v226, v214, v216
  v_sub_f32 v227, v215, v216
  v_mul_f32 v217, v220, v220
  v_mul_f32 v218, v221, v221
  v_fmac_f32 v217, v222, v222
  v_fmac_f32 v218, v223, v223
  v_fmac_f32 v217, v224, v224
  v_fmac_f32 v218, v225, v225
  v_fmac_f32 v217, v226, v226
  v_fmac_f32 v218, v227, v227
  v_add_f32 v217, v217, v218
  v_cvt_pk_bf16_f32 v216, 0, v216
  s_nop 0
  v_add_f32_dpp v217, v217, v217 row_ror:8 row_mask:0xf bank_mask:0xf
  v_sub_f32 v220, v208, v216
  v_sub_f32 v221, v209, v216
  v_add_f32_dpp v217, v217, v217 row_ror:4 row_mask:0xf bank_mask:0xf
  v_sub_f32 v222, v210, v216
  v_sub_f32 v223, v211, v216
  v_add_f32_dpp v217, v217, v217 row_ror:2 row_mask:0xf bank_mask:0xf
  v_sub_f32 v224, v212, v216
  v_sub_f32 v225, v213, v216
  v_add_f32_dpp v217, v217, v217 row_ror:1 row_mask:0xf bank_mask:0xf
  v_sub_f32 v226, v214, v216
  v_sub_f32 v227, v215, v216
  v_mov_b32 v218, v217
  v_cvt_pk_bf16_f32 v220, 0, v220
  v_cvt_pk_bf16_f32 v221, 0, v221
  v_permlane16_swap_b32 v217, v218
  v_cvt_pk_bf16_f32 v222, 0, v222
  v_cvt_pk_bf16_f32 v223, 0, v223
  v_add_f32 v217, v217, v218
  v_cvt_pk_bf16_f32 v224, 0, v224
  v_cvt_pk_bf16_f32 v225, 0, v225
  v_mov_b32 v218, v217
  v_cvt_pk_bf16_f32 v226, 0, v226
  v_cvt_pk_bf16_f32 v227, 0, v227
  v_permlane32_swap_b32 v217, v218
  v_add_f32 v217, v217, v218
  v_mul_f32 v217, 0x3b000000, v217
  v_cvt_pk_bf16_f32 v217, 0, v217
  v_add_f32 v217, 0x3727c5ac, v217
  v_cvt_pk_bf16_f32 v217, 0, v217
  v_sqrt_f32 v217, v217
  s_nop 0
  v_cvt_pk_bf16_f32 v217, 0, v217
  v_rcp_f32 v217, v217
  s_nop 0
  v_mul_f32 v220, v220, v217
  v_mul_f32 v221, v221, v217
  v_mul_f32 v222, v222, v217
  v_mul_f32 v223, v223, v217
  v_mul_f32 v224, v224, v217
  v_mul_f32 v225, v225, v217
  v_mul_f32 v226, v226, v217
  v_mul_f32 v227, v227, v217
  v_cvt_pk_bf16_f32 v188, v220, v221
  v_cvt_pk_bf16_f32 v189, v222, v223
  v_cvt_pk_bf16_f32 v190, v224, v225
  v_cvt_pk_bf16_f32 v191, v226, v227
  buffer_store_dwordx4 v[188:191], v0, s[4:7], s29 offen sc1
  s_add_u32 s29, s29, 262144
  v_lshlrev_b32 v208, 16, v192
  v_and_b32 v209, 0xffff0000, v192
  v_lshlrev_b32 v210, 16, v193
  v_and_b32 v211, 0xffff0000, v193
  v_lshlrev_b32 v212, 16, v194
  v_and_b32 v213, 0xffff0000, v194
  v_lshlrev_b32 v214, 16, v195
  v_and_b32 v215, 0xffff0000, v195
  v_add_f32 v216, v208, v209
  v_add_f32 v217, v210, v211
  v_add_f32 v218, v212, v213
  v_add_f32 v219, v214, v215
  v_add_f32 v216, v216, v217
  v_add_f32 v218, v218, v219
  v_add_f32 v216, v216, v218
  s_nop 1
  v_add_f32_dpp v216, v216, v216 row_ror:8 row_mask:0xf bank_mask:0xf
  s_nop 1
  v_add_f32_dpp v216, v216, v216 row_ror:4 row_mask:0xf bank_mask:0xf
  s_nop 1
  v_add_f32_dpp v216, v216, v216 row_ror:2 row_mask:0xf bank_mask:0xf
  s_nop 1
  v_add_f32_dpp v216, v216, v216 row_ror:1 row_mask:0xf bank_mask:0xf
  v_mov_b32 v218, v216
  s_nop 0
  s_nop 0
  v_permlane16_swap_b32 v216, v218
  v_add_f32 v216, v216, v218
  v_mov_b32 v218, v216
  s_nop 0
  s_nop 0
  v_permlane32_swap_b32 v216, v218
  v_add_f32 v216, v216, v218
  v_mul_f32 v216, 0x3b000000, v216
  v_sub_f32 v220, v208, v216
  v_sub_f32 v221, v209, v216
  v_sub_f32 v222, v210, v216
  v_sub_f32 v223, v211, v216
  v_sub_f32 v224, v212, v216
  v_sub_f32 v225, v213, v216
  v_sub_f32 v226, v214, v216
  v_sub_f32 v227, v215, v216
  v_mul_f32 v217, v220, v220
  v_mul_f32 v218, v221, v221
  v_fmac_f32 v217, v222, v222
  v_fmac_f32 v218, v223, v223
  v_fmac_f32 v217, v224, v224
  v_fmac_f32 v218, v225, v225
  v_fmac_f32 v217, v226, v226
  v_fmac_f32 v218, v227, v227
  v_add_f32 v217, v217, v218
  v_cvt_pk_bf16_f32 v216, 0, v216
  s_nop 0
  v_add_f32_dpp v217, v217, v217 row_ror:8 row_mask:0xf bank_mask:0xf
  v_sub_f32 v220, v208, v216
  v_sub_f32 v221, v209, v216
  v_add_f32_dpp v217, v217, v217 row_ror:4 row_mask:0xf bank_mask:0xf
  v_sub_f32 v222, v210, v216
  v_sub_f32 v223, v211, v216
  v_add_f32_dpp v217, v217, v217 row_ror:2 row_mask:0xf bank_mask:0xf
  v_sub_f32 v224, v212, v216
  v_sub_f32 v225, v213, v216
  v_add_f32_dpp v217, v217, v217 row_ror:1 row_mask:0xf bank_mask:0xf
  v_sub_f32 v226, v214, v216
  v_sub_f32 v227, v215, v216
  v_mov_b32 v218, v217
  v_cvt_pk_bf16_f32 v220, 0, v220
  v_cvt_pk_bf16_f32 v221, 0, v221
  v_permlane16_swap_b32 v217, v218
  v_cvt_pk_bf16_f32 v222, 0, v222
  v_cvt_pk_bf16_f32 v223, 0, v223
  v_add_f32 v217, v217, v218
  v_cvt_pk_bf16_f32 v224, 0, v224
  v_cvt_pk_bf16_f32 v225, 0, v225
  v_mov_b32 v218, v217
  v_cvt_pk_bf16_f32 v226, 0, v226
  v_cvt_pk_bf16_f32 v227, 0, v227
  v_permlane32_swap_b32 v217, v218
  v_add_f32 v217, v217, v218
  v_mul_f32 v217, 0x3b000000, v217
  v_cvt_pk_bf16_f32 v217, 0, v217
  v_add_f32 v217, 0x3727c5ac, v217
  v_cvt_pk_bf16_f32 v217, 0, v217
  v_sqrt_f32 v217, v217
  s_nop 0
  v_cvt_pk_bf16_f32 v217, 0, v217
  v_rcp_f32 v217, v217
  s_nop 0
  v_mul_f32 v220, v220, v217
  v_mul_f32 v221, v221, v217
  v_mul_f32 v222, v222, v217
  v_mul_f32 v223, v223, v217
  v_mul_f32 v224, v224, v217
  v_mul_f32 v225, v225, v217
  v_mul_f32 v226, v226, v217
  v_mul_f32 v227, v227, v217
  v_cvt_pk_bf16_f32 v192, v220, v221
  v_cvt_pk_bf16_f32 v193, v222, v223
  v_cvt_pk_bf16_f32 v194, v224, v225
  v_cvt_pk_bf16_f32 v195, v226, v227
  s_waitcnt vmcnt(52)
  v_perm_b32 v48, v66, v64, s44
  v_perm_b32 v49, v70, v68, s44
  v_perm_b32 v50, v74, v72, s44
  v_perm_b32 v51, v78, v76, s44
  v_accvgpr_write_b32 a0, v48
  v_accvgpr_write_b32 a1, v49
  v_accvgpr_write_b32 a2, v50
  v_accvgpr_write_b32 a3, v51
  v_perm_b32 v52, v66, v64, s45
  v_perm_b32 v53, v70, v68, s45
  v_perm_b32 v54, v74, v72, s45
  v_perm_b32 v55, v78, v76, s45
  v_accvgpr_write_b32 a4, v52
  v_accvgpr_write_b32 a5, v53
  v_accvgpr_write_b32 a6, v54
  v_accvgpr_write_b32 a7, v55
  v_perm_b32 v48, v67, v65, s44
  v_perm_b32 v49, v71, v69, s44
  v_perm_b32 v50, v75, v73, s44
  v_perm_b32 v51, v79, v77, s44
  v_accvgpr_write_b32 a8, v48
  v_accvgpr_write_b32 a9, v49
  v_accvgpr_write_b32 a10, v50
  v_accvgpr_write_b32 a11, v51
  v_perm_b32 v52, v67, v65, s45
  v_perm_b32 v53, v71, v69, s45
  v_perm_b32 v54, v75, v73, s45
  v_perm_b32 v55, v79, v77, s45
  v_accvgpr_write_b32 a12, v52
  v_accvgpr_write_b32 a13, v53
  v_accvgpr_write_b32 a14, v54
  v_accvgpr_write_b32 a15, v55
  buffer_store_dwordx4 v[192:195], v0, s[4:7], s29 offen sc1
  s_add_u32 s29, s29, 262144
  v_lshlrev_b32 v208, 16, v196
  v_and_b32 v209, 0xffff0000, v196
  v_lshlrev_b32 v210, 16, v197
  v_and_b32 v211, 0xffff0000, v197
  v_lshlrev_b32 v212, 16, v198
  v_and_b32 v213, 0xffff0000, v198
  v_lshlrev_b32 v214, 16, v199
  v_and_b32 v215, 0xffff0000, v199
  v_add_f32 v216, v208, v209
  v_add_f32 v217, v210, v211
  v_add_f32 v218, v212, v213
  v_add_f32 v219, v214, v215
  v_add_f32 v216, v216, v217
  v_add_f32 v218, v218, v219
  v_add_f32 v216, v216, v218
  s_nop 1
  v_add_f32_dpp v216, v216, v216 row_ror:8 row_mask:0xf bank_mask:0xf
  s_nop 1
  v_add_f32_dpp v216, v216, v216 row_ror:4 row_mask:0xf bank_mask:0xf
  s_nop 1
  v_add_f32_dpp v216, v216, v216 row_ror:2 row_mask:0xf bank_mask:0xf
  s_nop 1
  v_add_f32_dpp v216, v216, v216 row_ror:1 row_mask:0xf bank_mask:0xf
  v_mov_b32 v218, v216
  s_nop 0
  s_nop 0
  v_permlane16_swap_b32 v216, v218
  v_add_f32 v216, v216, v218
  v_mov_b32 v218, v216
  s_nop 0
  s_nop 0
  v_permlane32_swap_b32 v216, v218
  v_add_f32 v216, v216, v218
  v_mul_f32 v216, 0x3b000000, v216
  v_sub_f32 v220, v208, v216
  v_sub_f32 v221, v209, v216
  v_sub_f32 v222, v210, v216
  v_sub_f32 v223, v211, v216
  v_sub_f32 v224, v212, v216
  v_sub_f32 v225, v213, v216
  v_sub_f32 v226, v214, v216
  v_sub_f32 v227, v215, v216
  v_mul_f32 v217, v220, v220
  v_mul_f32 v218, v221, v221
  v_fmac_f32 v217, v222, v222
  v_fmac_f32 v218, v223, v223
  v_fmac_f32 v217, v224, v224
  v_fmac_f32 v218, v225, v225
  v_fmac_f32 v217, v226, v226
  v_fmac_f32 v218, v227, v227
  v_add_f32 v217, v217, v218
  v_cvt_pk_bf16_f32 v216, 0, v216
  s_nop 0
  v_add_f32_dpp v217, v217, v217 row_ror:8 row_mask:0xf bank_mask:0xf
  v_sub_f32 v220, v208, v216
  v_sub_f32 v221, v209, v216
  v_add_f32_dpp v217, v217, v217 row_ror:4 row_mask:0xf bank_mask:0xf
  v_sub_f32 v222, v210, v216
  v_sub_f32 v223, v211, v216
  v_add_f32_dpp v217, v217, v217 row_ror:2 row_mask:0xf bank_mask:0xf
  v_sub_f32 v224, v212, v216
  v_sub_f32 v225, v213, v216
  v_add_f32_dpp v217, v217, v217 row_ror:1 row_mask:0xf bank_mask:0xf
  v_sub_f32 v226, v214, v216
  v_sub_f32 v227, v215, v216
  v_mov_b32 v218, v217
  v_cvt_pk_bf16_f32 v220, 0, v220
  v_cvt_pk_bf16_f32 v221, 0, v221
  v_permlane16_swap_b32 v217, v218
  v_cvt_pk_bf16_f32 v222, 0, v222
  v_cvt_pk_bf16_f32 v223, 0, v223
  v_add_f32 v217, v217, v218
  v_cvt_pk_bf16_f32 v224, 0, v224
  v_cvt_pk_bf16_f32 v225, 0, v225
  v_mov_b32 v218, v217
  v_cvt_pk_bf16_f32 v226, 0, v226
  v_cvt_pk_bf16_f32 v227, 0, v227
  v_permlane32_swap_b32 v217, v218
  v_add_f32 v217, v217, v218
  v_mul_f32 v217, 0x3b000000, v217
  v_cvt_pk_bf16_f32 v217, 0, v217
  v_add_f32 v217, 0x3727c5ac, v217
  v_cvt_pk_bf16_f32 v217, 0, v217
  v_sqrt_f32 v217, v217
  s_nop 0
  v_cvt_pk_bf16_f32 v217, 0, v217
  v_rcp_f32 v217, v217
  s_nop 0
  v_mul_f32 v220, v220, v217
  v_mul_f32 v221, v221, v217
  v_mul_f32 v222, v222, v217
  v_mul_f32 v223, v223, v217
  v_mul_f32 v224, v224, v217
  v_mul_f32 v225, v225, v217
  v_mul_f32 v226, v226, v217
  v_mul_f32 v227, v227, v217
  v_cvt_pk_bf16_f32 v196, v220, v221
  v_cvt_pk_bf16_f32 v197, v222, v223
  v_cvt_pk_bf16_f32 v198, v224, v225
  v_cvt_pk_bf16_f32 v199, v226, v227
  s_waitcnt vmcnt(45)
  v_perm_b32 v48, v82, v80, s44
  v_perm_b32 v49, v86, v84, s44
  v_perm_b32 v50, v90, v88, s44
  v_perm_b32 v51, v94, v92, s44
  v_accvgpr_write_b32 a16, v48
  v_accvgpr_write_b32 a17, v49
  v_accvgpr_write_b32 a18, v50
  v_accvgpr_write_b32 a19, v51
  v_perm_b32 v52, v82, v80, s45
  v_perm_b32 v53, v86, v84, s45
  v_perm_b32 v54, v90, v88, s45
  v_perm_b32 v55, v94, v92, s45
  v_accvgpr_write_b32 a20, v52
  v_accvgpr_write_b32 a21, v53
  v_accvgpr_write_b32 a22, v54
  v_accvgpr_write_b32 a23, v55
  v_perm_b32 v48, v83, v81, s44
  v_perm_b32 v49, v87, v85, s44
  v_perm_b32 v50, v91, v89, s44
  v_perm_b32 v51, v95, v93, s44
  v_accvgpr_write_b32 a24, v48
  v_accvgpr_write_b32 a25, v49
  v_accvgpr_write_b32 a26, v50
  v_accvgpr_write_b32 a27, v51
  v_perm_b32 v52, v83, v81, s45
  v_perm_b32 v53, v87, v85, s45
  v_perm_b32 v54, v91, v89, s45
  v_perm_b32 v55, v95, v93, s45
  v_accvgpr_write_b32 a28, v52
  v_accvgpr_write_b32 a29, v53
  v_accvgpr_write_b32 a30, v54
  v_accvgpr_write_b32 a31, v55
  buffer_store_dwordx4 v[196:199], v0, s[4:7], s29 offen sc1
  s_add_u32 s29, s29, 262144
  v_lshlrev_b32 v208, 16, v200
  v_and_b32 v209, 0xffff0000, v200
  v_lshlrev_b32 v210, 16, v201
  v_and_b32 v211, 0xffff0000, v201
  v_lshlrev_b32 v212, 16, v202
  v_and_b32 v213, 0xffff0000, v202
  v_lshlrev_b32 v214, 16, v203
  v_and_b32 v215, 0xffff0000, v203
  v_add_f32 v216, v208, v209
  v_add_f32 v217, v210, v211
  v_add_f32 v218, v212, v213
  v_add_f32 v219, v214, v215
  v_add_f32 v216, v216, v217
  v_add_f32 v218, v218, v219
  v_add_f32 v216, v216, v218
  s_nop 1
  v_add_f32_dpp v216, v216, v216 row_ror:8 row_mask:0xf bank_mask:0xf
  s_nop 1
  v_add_f32_dpp v216, v216, v216 row_ror:4 row_mask:0xf bank_mask:0xf
  s_nop 1
  v_add_f32_dpp v216, v216, v216 row_ror:2 row_mask:0xf bank_mask:0xf
  s_nop 1
  v_add_f32_dpp v216, v216, v216 row_ror:1 row_mask:0xf bank_mask:0xf
  v_mov_b32 v218, v216
  s_nop 0
  s_nop 0
  v_permlane16_swap_b32 v216, v218
  v_add_f32 v216, v216, v218
  v_mov_b32 v218, v216
  s_nop 0
  s_nop 0
  v_permlane32_swap_b32 v216, v218
  v_add_f32 v216, v216, v218
  v_mul_f32 v216, 0x3b000000, v216
  v_sub_f32 v220, v208, v216
  v_sub_f32 v221, v209, v216
  v_sub_f32 v222, v210, v216
  v_sub_f32 v223, v211, v216
  v_sub_f32 v224, v212, v216
  v_sub_f32 v225, v213, v216
  v_sub_f32 v226, v214, v216
  v_sub_f32 v227, v215, v216
  v_mul_f32 v217, v220, v220
  v_mul_f32 v218, v221, v221
  v_fmac_f32 v217, v222, v222
  v_fmac_f32 v218, v223, v223
  v_fmac_f32 v217, v224, v224
  v_fmac_f32 v218, v225, v225
  v_fmac_f32 v217, v226, v226
  v_fmac_f32 v218, v227, v227
  v_add_f32 v217, v217, v218
  v_cvt_pk_bf16_f32 v216, 0, v216
  s_nop 0
  v_add_f32_dpp v217, v217, v217 row_ror:8 row_mask:0xf bank_mask:0xf
  v_sub_f32 v220, v208, v216
  v_sub_f32 v221, v209, v216
  v_add_f32_dpp v217, v217, v217 row_ror:4 row_mask:0xf bank_mask:0xf
  v_sub_f32 v222, v210, v216
  v_sub_f32 v223, v211, v216
  v_add_f32_dpp v217, v217, v217 row_ror:2 row_mask:0xf bank_mask:0xf
  v_sub_f32 v224, v212, v216
  v_sub_f32 v225, v213, v216
  v_add_f32_dpp v217, v217, v217 row_ror:1 row_mask:0xf bank_mask:0xf
  v_sub_f32 v226, v214, v216
  v_sub_f32 v227, v215, v216
  v_mov_b32 v218, v217
  v_cvt_pk_bf16_f32 v220, 0, v220
  v_cvt_pk_bf16_f32 v221, 0, v221
  v_permlane16_swap_b32 v217, v218
  v_cvt_pk_bf16_f32 v222, 0, v222
  v_cvt_pk_bf16_f32 v223, 0, v223
  v_add_f32 v217, v217, v218
  v_cvt_pk_bf16_f32 v224, 0, v224
  v_cvt_pk_bf16_f32 v225, 0, v225
  v_mov_b32 v218, v217
  v_cvt_pk_bf16_f32 v226, 0, v226
  v_cvt_pk_bf16_f32 v227, 0, v227
  v_permlane32_swap_b32 v217, v218
  v_add_f32 v217, v217, v218
  v_mul_f32 v217, 0x3b000000, v217
  v_cvt_pk_bf16_f32 v217, 0, v217
  v_add_f32 v217, 0x3727c5ac, v217
  v_cvt_pk_bf16_f32 v217, 0, v217
  v_sqrt_f32 v217, v217
  s_nop 0
  v_cvt_pk_bf16_f32 v217, 0, v217
  v_rcp_f32 v217, v217
  s_nop 0
  v_mul_f32 v220, v220, v217
  v_mul_f32 v221, v221, v217
  v_mul_f32 v222, v222, v217
  v_mul_f32 v223, v223, v217
  v_mul_f32 v224, v224, v217
  v_mul_f32 v225, v225, v217
  v_mul_f32 v226, v226, v217
  v_mul_f32 v227, v227, v217
  v_cvt_pk_bf16_f32 v200, v220, v221
  v_cvt_pk_bf16_f32 v201, v222, v223
  v_cvt_pk_bf16_f32 v202, v224, v225
  v_cvt_pk_bf16_f32 v203, v226, v227
  s_waitcnt vmcnt(38)
  v_perm_b32 v48, v98, v96, s44
  v_perm_b32 v49, v102, v100, s44
  v_perm_b32 v50, v106, v104, s44
  v_perm_b32 v51, v110, v108, s44
  v_accvgpr_write_b32 a32, v48
  v_accvgpr_write_b32 a33, v49
  v_accvgpr_write_b32 a34, v50
  v_accvgpr_write_b32 a35, v51
  v_perm_b32 v52, v98, v96, s45
  v_perm_b32 v53, v102, v100, s45
  v_perm_b32 v54, v106, v104, s45
  v_perm_b32 v55, v110, v108, s45
  v_accvgpr_write_b32 a36, v52
  v_accvgpr_write_b32 a37, v53
  v_accvgpr_write_b32 a38, v54
  v_accvgpr_write_b32 a39, v55
  v_perm_b32 v48, v99, v97, s44
  v_perm_b32 v49, v103, v101, s44
  v_perm_b32 v50, v107, v105, s44
  v_perm_b32 v51, v111, v109, s44
  v_accvgpr_write_b32 a40, v48
  v_accvgpr_write_b32 a41, v49
  v_accvgpr_write_b32 a42, v50
  v_accvgpr_write_b32 a43, v51
  v_perm_b32 v52, v99, v97, s45
  v_perm_b32 v53, v103, v101, s45
  v_perm_b32 v54, v107, v105, s45
  v_perm_b32 v55, v111, v109, s45
  v_accvgpr_write_b32 a44, v52
  v_accvgpr_write_b32 a45, v53
  v_accvgpr_write_b32 a46, v54
  v_accvgpr_write_b32 a47, v55
  buffer_store_dwordx4 v[200:203], v0, s[4:7], s29 offen sc1
  s_add_u32 s29, s29, 262144
  v_lshlrev_b32 v208, 16, v204
  v_and_b32 v209, 0xffff0000, v204
  v_lshlrev_b32 v210, 16, v205
  v_and_b32 v211, 0xffff0000, v205
  v_lshlrev_b32 v212, 16, v206
  v_and_b32 v213, 0xffff0000, v206
  v_lshlrev_b32 v214, 16, v207
  v_and_b32 v215, 0xffff0000, v207
  v_add_f32 v216, v208, v209
  v_add_f32 v217, v210, v211
  v_add_f32 v218, v212, v213
  v_add_f32 v219, v214, v215
  v_add_f32 v216, v216, v217
  v_add_f32 v218, v218, v219
  v_add_f32 v216, v216, v218
  s_nop 1
  v_add_f32_dpp v216, v216, v216 row_ror:8 row_mask:0xf bank_mask:0xf
  s_nop 1
  v_add_f32_dpp v216, v216, v216 row_ror:4 row_mask:0xf bank_mask:0xf
  s_nop 1
  v_add_f32_dpp v216, v216, v216 row_ror:2 row_mask:0xf bank_mask:0xf
  s_nop 1
  v_add_f32_dpp v216, v216, v216 row_ror:1 row_mask:0xf bank_mask:0xf
  v_mov_b32 v218, v216
  s_nop 0
  s_nop 0
  v_permlane16_swap_b32 v216, v218
  v_add_f32 v216, v216, v218
  v_mov_b32 v218, v216
  s_nop 0
  s_nop 0
  v_permlane32_swap_b32 v216, v218
  v_add_f32 v216, v216, v218
  v_mul_f32 v216, 0x3b000000, v216
  v_sub_f32 v220, v208, v216
  v_sub_f32 v221, v209, v216
  v_sub_f32 v222, v210, v216
  v_sub_f32 v223, v211, v216
  v_sub_f32 v224, v212, v216
  v_sub_f32 v225, v213, v216
  v_sub_f32 v226, v214, v216
  v_sub_f32 v227, v215, v216
  v_mul_f32 v217, v220, v220
  v_mul_f32 v218, v221, v221
  v_fmac_f32 v217, v222, v222
  v_fmac_f32 v218, v223, v223
  v_fmac_f32 v217, v224, v224
  v_fmac_f32 v218, v225, v225
  v_fmac_f32 v217, v226, v226
  v_fmac_f32 v218, v227, v227
  v_add_f32 v217, v217, v218
  v_cvt_pk_bf16_f32 v216, 0, v216
  s_nop 0
  v_add_f32_dpp v217, v217, v217 row_ror:8 row_mask:0xf bank_mask:0xf
  v_sub_f32 v220, v208, v216
  v_sub_f32 v221, v209, v216
  v_add_f32_dpp v217, v217, v217 row_ror:4 row_mask:0xf bank_mask:0xf
  v_sub_f32 v222, v210, v216
  v_sub_f32 v223, v211, v216
  v_add_f32_dpp v217, v217, v217 row_ror:2 row_mask:0xf bank_mask:0xf
  v_sub_f32 v224, v212, v216
  v_sub_f32 v225, v213, v216
  v_add_f32_dpp v217, v217, v217 row_ror:1 row_mask:0xf bank_mask:0xf
  v_sub_f32 v226, v214, v216
  v_sub_f32 v227, v215, v216
  v_mov_b32 v218, v217
  v_cvt_pk_bf16_f32 v220, 0, v220
  v_cvt_pk_bf16_f32 v221, 0, v221
  v_permlane16_swap_b32 v217, v218
  v_cvt_pk_bf16_f32 v222, 0, v222
  v_cvt_pk_bf16_f32 v223, 0, v223
  v_add_f32 v217, v217, v218
  v_cvt_pk_bf16_f32 v224, 0, v224
  v_cvt_pk_bf16_f32 v225, 0, v225
  v_mov_b32 v218, v217
  v_cvt_pk_bf16_f32 v226, 0, v226
  v_cvt_pk_bf16_f32 v227, 0, v227
  v_permlane32_swap_b32 v217, v218
  v_add_f32 v217, v217, v218
  v_mul_f32 v217, 0x3b000000, v217
  v_cvt_pk_bf16_f32 v217, 0, v217
  v_add_f32 v217, 0x3727c5ac, v217
  v_cvt_pk_bf16_f32 v217, 0, v217
  v_sqrt_f32 v217, v217
  s_nop 0
  v_cvt_pk_bf16_f32 v217, 0, v217
  v_rcp_f32 v217, v217
  s_nop 0
  v_mul_f32 v220, v220, v217
  v_mul_f32 v221, v221, v217
  v_mul_f32 v222, v222, v217
  v_mul_f32 v223, v223, v217
  v_mul_f32 v224, v224, v217
  v_mul_f32 v225, v225, v217
  v_mul_f32 v226, v226, v217
  v_mul_f32 v227, v227, v217
  v_cvt_pk_bf16_f32 v204, v220, v221
  v_cvt_pk_bf16_f32 v205, v222, v223
  v_cvt_pk_bf16_f32 v206, v224, v225
  v_cvt_pk_bf16_f32 v207, v226, v227
  s_waitcnt vmcnt(31)
  v_perm_b32 v48, v114, v112, s44
  v_perm_b32 v49, v118, v116, s44
  v_perm_b32 v50, v122, v120, s44
  v_perm_b32 v51, v126, v124, s44
  v_accvgpr_write_b32 a48, v48
  v_accvgpr_write_b32 a49, v49
  v_accvgpr_write_b32 a50, v50
  v_accvgpr_write_b32 a51, v51
  v_perm_b32 v52, v114, v112, s45
  v_perm_b32 v53, v118, v116, s45
  v_perm_b32 v54, v122, v120, s45
  v_perm_b32 v55, v126, v124, s45
  v_accvgpr_write_b32 a52, v52
  v_accvgpr_write_b32 a53, v53
  v_accvgpr_write_b32 a54, v54
  v_accvgpr_write_b32 a55, v55
  v_perm_b32 v48, v115, v113, s44
  v_perm_b32 v49, v119, v117, s44
  v_perm_b32 v50, v123, v121, s44
  v_perm_b32 v51, v127, v125, s44
  v_accvgpr_write_b32 a56, v48
  v_accvgpr_write_b32 a57, v49
  v_accvgpr_write_b32 a58, v50
  v_accvgpr_write_b32 a59, v51
  v_perm_b32 v52, v115, v113, s45
  v_perm_b32 v53, v119, v117, s45
  v_perm_b32 v54, v123, v121, s45
  v_perm_b32 v55, v127, v125, s45
  v_accvgpr_write_b32 a60, v52
  v_accvgpr_write_b32 a61, v53
  v_accvgpr_write_b32 a62, v54
  v_accvgpr_write_b32 a63, v55
  buffer_store_dwordx4 v[204:207], v0, s[4:7], s29 offen sc1
  s_add_u32 s29, s29, 262144
  s_waitcnt vmcnt(24)
  v_perm_b32 v48, v130, v128, s44
  v_perm_b32 v49, v134, v132, s44
  v_perm_b32 v50, v138, v136, s44
  v_perm_b32 v51, v142, v140, s44
  v_accvgpr_write_b32 a64, v48
  v_accvgpr_write_b32 a65, v49
  v_accvgpr_write_b32 a66, v50
  v_accvgpr_write_b32 a67, v51
  v_perm_b32 v52, v130, v128, s45
  v_perm_b32 v53, v134, v132, s45
  v_perm_b32 v54, v138, v136, s45
  v_perm_b32 v55, v142, v140, s45
  v_accvgpr_write_b32 a68, v52
  v_accvgpr_write_b32 a69, v53
  v_accvgpr_write_b32 a70, v54
  v_accvgpr_write_b32 a71, v55
  v_perm_b32 v48, v131, v129, s44
  v_perm_b32 v49, v135, v133, s44
  v_perm_b32 v50, v139, v137, s44
  v_perm_b32 v51, v143, v141, s44
  v_accvgpr_write_b32 a72, v48
  v_accvgpr_write_b32 a73, v49
  v_accvgpr_write_b32 a74, v50
  v_accvgpr_write_b32 a75, v51
  v_perm_b32 v52, v131, v129, s45
  v_perm_b32 v53, v135, v133, s45
  v_perm_b32 v54, v139, v137, s45
  v_perm_b32 v55, v143, v141, s45
  v_accvgpr_write_b32 a76, v52
  v_accvgpr_write_b32 a77, v53
  v_accvgpr_write_b32 a78, v54
  v_accvgpr_write_b32 a79, v55
  s_waitcnt vmcnt(16)
  v_perm_b32 v48, v146, v144, s44
  v_perm_b32 v49, v150, v148, s44
  v_perm_b32 v50, v154, v152, s44
  v_perm_b32 v51, v158, v156, s44
  v_accvgpr_write_b32 a80, v48
  v_accvgpr_write_b32 a81, v49
  v_accvgpr_write_b32 a82, v50
  v_accvgpr_write_b32 a83, v51
  v_perm_b32 v52, v146, v144, s45
  v_perm_b32 v53, v150, v148, s45
  v_perm_b32 v54, v154, v152, s45
  v_perm_b32 v55, v158, v156, s45
  v_accvgpr_write_b32 a84, v52
  v_accvgpr_write_b32 a85, v53
  v_accvgpr_write_b32 a86, v54
  v_accvgpr_write_b32 a87, v55
  v_perm_b32 v48, v147, v145, s44
  v_perm_b32 v49, v151, v149, s44
  v_perm_b32 v50, v155, v153, s44
  v_perm_b32 v51, v159, v157, s44
  v_accvgpr_write_b32 a88, v48
  v_accvgpr_write_b32 a89, v49
  v_accvgpr_write_b32 a90, v50
  v_accvgpr_write_b32 a91, v51
  v_perm_b32 v52, v147, v145, s45
  v_perm_b32 v53, v151, v149, s45
  v_perm_b32 v54, v155, v153, s45
  v_perm_b32 v55, v159, v157, s45
  v_accvgpr_write_b32 a92, v52
  v_accvgpr_write_b32 a93, v53
  v_accvgpr_write_b32 a94, v54
  v_accvgpr_write_b32 a95, v55
  s_waitcnt vmcnt(8)
  v_perm_b32 v48, v162, v160, s44
  v_perm_b32 v49, v166, v164, s44
  v_perm_b32 v50, v170, v168, s44
  v_perm_b32 v51, v174, v172, s44
  v_accvgpr_write_b32 a96, v48
  v_accvgpr_write_b32 a97, v49
  v_accvgpr_write_b32 a98, v50
  v_accvgpr_write_b32 a99, v51
  v_perm_b32 v52, v162, v160, s45
  v_perm_b32 v53, v166, v164, s45
  v_perm_b32 v54, v170, v168, s45
  v_perm_b32 v55, v174, v172, s45
  v_accvgpr_write_b32 a100, v52
  v_accvgpr_write_b32 a101, v53
  v_accvgpr_write_b32 a102, v54
  v_accvgpr_write_b32 a103, v55
  v_perm_b32 v48, v163, v161, s44
  v_perm_b32 v49, v167, v165, s44
  v_perm_b32 v50, v171, v169, s44
  v_perm_b32 v51, v175, v173, s44
  v_accvgpr_write_b32 a104, v48
  v_accvgpr_write_b32 a105, v49
  v_accvgpr_write_b32 a106, v50
  v_accvgpr_write_b32 a107, v51
  v_perm_b32 v52, v163, v161, s45
  v_perm_b32 v53, v167, v165, s45
  v_perm_b32 v54, v171, v169, s45
  v_perm_b32 v55, v175, v173, s45
  v_accvgpr_write_b32 a108, v52
  v_accvgpr_write_b32 a109, v53
  v_accvgpr_write_b32 a110, v54
  v_accvgpr_write_b32 a111, v55
  v_mbcnt_lo_u32_b32 v60, -1, 0
  v_and_b32 v60, 7, v60
  v_lshlrev_b32 v60, 2, v60
  v_add_u32 v60, 0, v60
  s_mov_b32 s26, 0
g_wt_73:
  global_load_dword v61, v60, s[12:13] sc1
  s_add_u32 s26, s26, 1
  s_cmp_gt_u32 s26, 1048576
  s_cbranch_scc1 L_end
  s_waitcnt vmcnt(0)
  v_readlane_b32 s32, v61, 0
  v_readlane_b32 s33, v61, 1
  v_readlane_b32 s34, v61, 2
  v_readlane_b32 s35, v61, 3
  v_readlane_b32 s36, v61, 4
  v_readlane_b32 s37, v61, 5
  v_readlane_b32 s38, v61, 6
  v_readlane_b32 s39, v61, 7
  s_add_u32 s27, s32, s33
  s_add_u32 s27, s27, s34
  s_add_u32 s27, s27, s35
  s_add_u32 s27, s27, s36
  s_add_u32 s27, s27, s37
  s_add_u32 s27, s27, s38
  s_add_u32 s27, s27, s39
  s_mul_i32 s27, s27, 0x01010101
  s_lshr_b32 s27, s27, 24
  s_cmp_lt_u32 s27, 64
  s_cbranch_scc1 g_wt_73
  s_lshl_b32 s27, s77, 5
  s_add_u32 s27, s27, 243269632
  v_lshlrev_b32 v61, 9, v0
  v_mov_b32 v60, 1
  s_mov_b64 exec, 0xff
  buffer_store_dword v60, v61, s[4:7], s27 offen sc1
  s_mov_b64 exec, -1
  s_add_u32 s27, s30, 106496
  buffer_load_dwordx2 v[64:65], v44, s[80:83], s27 offen
  s_add_u32 s27, s30, 107520
  buffer_load_dwordx2 v[66:67], v44, s[80:83], s27 offen
  s_add_u32 s27, s30, 108544
  buffer_load_dwordx2 v[68:69], v44, s[80:83], s27 offen
  s_add_u32 s27, s30, 109568
  buffer_load_dwordx2 v[70:71], v44, s[80:83], s27 offen
  s_add_u32 s27, s30, 122880
  buffer_load_dwordx2 v[72:73], v44, s[80:83], s27 offen
  s_add_u32 s27, s30, 123904
  buffer_load_dwordx2 v[74:75], v44, s[80:83], s27 offen
  s_add_u32 s27, s30, 124928
  buffer_load_dwordx2 v[76:77], v44, s[80:83], s27 offen
  s_add_u32 s27, s30, 125952
  buffer_load_dwordx2 v[78:79], v44, s[80:83], s27 offen
  s_add_u32 s27, s30, 131072
  buffer_load_dwordx2 v[80:81], v44, s[80:83], s27 offen
  s_add_u32 s27, s30, 132096
  buffer_load_dwordx2 v[82:83], v44, s[80:83], s27 offen
  s_add_u32 s27, s30, 133120
  buffer_load_dwordx2 v[84:85], v44, s[80:83], s27 offen
  s_add_u32 s27, s30, 134144
  buffer_load_dwordx2 v[86:87], v44, s[80:83], s27 offen
  s_add_u32 s27, s30, 147456
  buffer_load_dwordx2 v[88:89], v44, s[80:83], s27 offen
  s_add_u32 s27, s30, 148480
  buffer_load_dwordx2 v[90:91], v44, s[80:83], s27 offen
  s_add_u32 s27, s30, 149504
  buffer_load_dwordx2 v[92:93], v44, s[80:83], s27 offen
  s_add_u32 s27, s30, 150528
  buffer_load_dwordx2 v[94:95], v44, s[80:83], s27 offen
  s_add_u32 s27, s30, 139264
  buffer_load_dwordx2 v[96:97], v44, s[80:83], s27 offen
  s_add_u32 s27, s30, 140288
  buffer_load_dwordx2 v[98:99], v44, s[80:83], s27 offen
  s_add_u32 s27, s30, 141312
  buffer_load_dwordx2 v[100:101], v44, s[80:83], s27 offen
  s_add_u32 s27, s30, 142336
  buffer_load_dwordx2 v[102:103], v44, s[80:83], s27 offen
  s_add_u32 s27, s30, 155648
  buffer_load_dwordx2 v[104:105], v44, s[80:83], s27 offen
  s_add_u32 s27, s30, 156672
  buffer_load_dwordx2 v[106:107], v44, s[80:83], s27 offen
  s_add_u32 s27, s30, 157696
  buffer_load_dwordx2 v[108:109], v44, s[80:83], s27 offen
  s_add_u32 s27, s30, 158720
  buffer_load_dwordx2 v[110:111], v44, s[80:83], s27 offen
  s_add_u32 s27, s30, 163840
  buffer_load_dwordx2 v[112:113], v44, s[80:83], s27 offen
  s_add_u32 s27, s30, 164864
  buffer_load_dwordx2 v[114:115], v44, s[80:83], s27 offen
  s_add_u32 s27, s30, 165888
  buffer_load_dwordx2 v[116:117], v44, s[80:83], s27 offen
  s_add_u32 s27, s30, 166912
  buffer_load_dwordx2 v[118:119], v44, s[80:83], s27 offen
  s_add_u32 s27, s30, 180224
  buffer_load_dwordx2 v[120:121], v44, s[80:83], s27 offen
  s_add_u32 s27, s30, 181248
  buffer_load_dwordx2 v[122:123], v44, s[80:83], s27 offen
  s_add_u32 s27, s30, 182272
  buffer_load_dwordx2 v[124:125], v44, s[80:83], s27 offen
  s_add_u32 s27, s30, 183296
  buffer_load_dwordx2 v[126:127], v44, s[80:83], s27 offen
  s_add_u32 s27, s30, 172032
  buffer_load_dwordx2 v[128:129], v44, s[80:83], s27 offen
  s_add_u32 s27, s30, 173056
  buffer_load_dwordx2 v[130:131], v44, s[80:83], s27 offen
  s_add_u32 s27, s30, 174080
  buffer_load_dwordx2 v[132:133], v44, s[80:83], s27 offen
  s_add_u32 s27, s30, 175104
  buffer_load_dwordx2 v[134:135], v44, s[80:83], s27 offen
  s_add_u32 s27, s30, 188416
  buffer_load_dwordx2 v[136:137], v44, s[80:83], s27 offen
  s_add_u32 s27, s30, 189440
  buffer_load_dwordx2 v[138:139], v44, s[80:83], s27 offen
  s_add_u32 s27, s30, 190464
  buffer_load_dwordx2 v[140:141], v44, s[80:83], s27 offen
  s_add_u32 s27, s30, 191488
  buffer_load_dwordx2 v[142:143], v44, s[80:83], s27 offen
  s_add_u32 s27, s30, 196608
  buffer_load_dwordx2 v[144:145], v44, s[80:83], s27 offen
  s_add_u32 s27, s30, 197632
  buffer_load_dwordx2 v[146:147], v44, s[80:83], s27 offen
  s_add_u32 s27, s30, 198656
  buffer_load_dwordx2 v[148:149], v44, s[80:83], s27 offen
  s_add_u32 s27, s30, 199680
  buffer_load_dwordx2 v[150:151], v44, s[80:83], s27 offen
  s_add_u32 s27, s30, 212992
  buffer_load_dwordx2 v[152:153], v44, s[80:83], s27 offen
  s_add_u32 s27, s30, 214016
  buffer_load_dwordx2 v[154:155], v44, s[80:83], s27 offen
  s_add_u32 s27, s30, 215040
  buffer_load_dwordx2 v[156:157], v44, s[80:83], s27 offen
  s_add_u32 s27, s30, 216064
  buffer_load_dwordx2 v[158:159], v44, s[80:83], s27 offen
  s_add_u32 s27, s30, 204800
  buffer_load_dwordx2 v[160:161], v44, s[80:83], s27 offen
  s_add_u32 s27, s30, 205824
  buffer_load_dwordx2 v[162:163], v44, s[80:83], s27 offen
  s_add_u32 s27, s30, 206848
  buffer_load_dwordx2 v[164:165], v44, s[80:83], s27 offen
  s_add_u32 s27, s30, 207872
  buffer_load_dwordx2 v[166:167], v44, s[80:83], s27 offen
  s_add_u32 s27, s30, 221184
  buffer_load_dwordx2 v[168:169], v44, s[80:83], s27 offen
  s_add_u32 s27, s30, 222208
  buffer_load_dwordx2 v[170:171], v44, s[80:83], s27 offen
  s_add_u32 s27, s30, 223232
  buffer_load_dwordx2 v[172:173], v44, s[80:83], s27 offen
  s_add_u32 s27, s30, 224256
  buffer_load_dwordx2 v[174:175], v44, s[80:83], s27 offen
  s_waitcnt vmcnt(48)
  v_perm_b32 v48, v66, v64, s44
  v_perm_b32 v49, v70, v68, s44
  v_perm_b32 v50, v74, v72, s44
  v_perm_b32 v51, v78, v76, s44
  v_accvgpr_write_b32 a112, v48
  v_accvgpr_write_b32 a113, v49
  v_accvgpr_write_b32 a114, v50
  v_accvgpr_write_b32 a115, v51
  v_perm_b32 v52, v66, v64, s45
  v_perm_b32 v53, v70, v68, s45
  v_perm_b32 v54, v74, v72, s45
  v_perm_b32 v55, v78, v76, s45
  v_accvgpr_write_b32 a116, v52
  v_accvgpr_write_b32 a117, v53
  v_accvgpr_write_b32 a118, v54
  v_accvgpr_write_b32 a119, v55
  v_perm_b32 v48, v67, v65, s44
  v_perm_b32 v49, v71, v69, s44
  v_perm_b32 v50, v75, v73, s44
  v_perm_b32 v51, v79, v77, s44
  v_accvgpr_write_b32 a120, v48
  v_accvgpr_write_b32 a121, v49
  v_accvgpr_write_b32 a122, v50
  v_accvgpr_write_b32 a123, v51
  v_perm_b32 v52, v67, v65, s45
  v_perm_b32 v53, v71, v69, s45
  v_perm_b32 v54, v75, v73, s45
  v_perm_b32 v55, v79, v77, s45
  v_accvgpr_write_b32 a124, v52
  v_accvgpr_write_b32 a125, v53
  v_accvgpr_write_b32 a126, v54
  v_accvgpr_write_b32 a127, v55
  s_add_u32 s27, s30, 229376
  buffer_load_dwordx2 v[64:65], v44, s[80:83], s27 offen
  s_add_u32 s27, s30, 230400
  buffer_load_dwordx2 v[66:67], v44, s[80:83], s27 offen
  s_add_u32 s27, s30, 231424
  buffer_load_dwordx2 v[68:69], v44, s[80:83], s27 offen
  s_add_u32 s27, s30, 232448
  buffer_load_dwordx2 v[70:71], v44, s[80:83], s27 offen
  s_add_u32 s27, s30, 245760
  buffer_load_dwordx2 v[72:73], v44, s[80:83], s27 offen
  s_add_u32 s27, s30, 246784
  buffer_load_dwordx2 v[74:75], v44, s[80:83], s27 offen
  s_add_u32 s27, s30, 247808
  buffer_load_dwordx2 v[76:77], v44, s[80:83], s27 offen
  s_add_u32 s27, s30, 248832
  buffer_load_dwordx2 v[78:79], v44, s[80:83], s27 offen
  s_waitcnt vmcnt(48)
  v_perm_b32 v48, v82, v80, s44
  v_perm_b32 v49, v86, v84, s44
  v_perm_b32 v50, v90, v88, s44
  v_perm_b32 v51, v94, v92, s44
  v_accvgpr_write_b32 a128, v48
  v_accvgpr_write_b32 a129, v49
  v_accvgpr_write_b32 a130, v50
  v_accvgpr_write_b32 a131, v51
  v_perm_b32 v52, v82, v80, s45
  v_perm_b32 v53, v86, v84, s45
  v_perm_b32 v54, v90, v88, s45
  v_perm_b32 v55, v94, v92, s45
  v_accvgpr_write_b32 a132, v52
  v_accvgpr_write_b32 a133, v53
  v_accvgpr_write_b32 a134, v54
  v_accvgpr_write_b32 a135, v55
  v_perm_b32 v48, v83, v81, s44
  v_perm_b32 v49, v87, v85, s44
  v_perm_b32 v50, v91, v89, s44
  v_perm_b32 v51, v95, v93, s44
  v_accvgpr_write_b32 a136, v48
  v_accvgpr_write_b32 a137, v49
  v_accvgpr_write_b32 a138, v50
  v_accvgpr_write_b32 a139, v51
  v_perm_b32 v52, v83, v81, s45
  v_perm_b32 v53, v87, v85, s45
  v_perm_b32 v54, v91, v89, s45
  v_perm_b32 v55, v95, v93, s45
  v_accvgpr_write_b32 a140, v52
  v_accvgpr_write_b32 a141, v53
  v_accvgpr_write_b32 a142, v54
  v_accvgpr_write_b32 a143, v55
  s_add_u32 s27, s30, 237568
  buffer_load_dwordx2 v[80:81], v44, s[80:83], s27 offen
  s_add_u32 s27, s30, 238592
  buffer_load_dwordx2 v[82:83], v44, s[80:83], s27 offen
  s_add_u32 s27, s30, 239616
  buffer_load_dwordx2 v[84:85], v44, s[80:83], s27 offen
  s_add_u32 s27, s30, 240640
  buffer_load_dwordx2 v[86:87], v44, s[80:83], s27 offen
  s_add_u32 s27, s30, 253952
  buffer_load_dwordx2 v[88:89], v44, s[80:83], s27 offen
  s_add_u32 s27, s30, 254976
  buffer_load_dwordx2 v[90:91], v44, s[80:83], s27 offen
  s_add_u32 s27, s30, 256000
  buffer_load_dwordx2 v[92:93], v44, s[80:83], s27 offen
  s_add_u32 s27, s30, 257024
  buffer_load_dwordx2 v[94:95], v44, s[80:83], s27 offen
  s_waitcnt vmcnt(48)
  v_perm_b32 v48, v98, v96, s44
  v_perm_b32 v49, v102, v100, s44
  v_perm_b32 v50, v106, v104, s44
  v_perm_b32 v51, v110, v108, s44
  v_accvgpr_write_b32 a144, v48
  v_accvgpr_write_b32 a145, v49
  v_accvgpr_write_b32 a146, v50
  v_accvgpr_write_b32 a147, v51
  v_perm_b32 v52, v98, v96, s45
  v_perm_b32 v53, v102, v100, s45
  v_perm_b32 v54, v106, v104, s45
  v_perm_b32 v55, v110, v108, s45
  v_accvgpr_write_b32 a148, v52
  v_accvgpr_write_b32 a149, v53
  v_accvgpr_write_b32 a150, v54
  v_accvgpr_write_b32 a151, v55
  v_perm_b32 v48, v99, v97, s44
  v_perm_b32 v49, v103, v101, s44
  v_perm_b32 v50, v107, v105, s44
  v_perm_b32 v51, v111, v109, s44
  v_accvgpr_write_b32 a152, v48
  v_accvgpr_write_b32 a153, v49
  v_accvgpr_write_b32 a154, v50
  v_accvgpr_write_b32 a155, v51
  v_perm_b32 v52, v99, v97, s45
  v_perm_b32 v53, v103, v101, s45
  v_perm_b32 v54, v107, v105, s45
  v_perm_b32 v55, v111, v109, s45
  v_accvgpr_write_b32 a156, v52
  v_accvgpr_write_b32 a157, v53
  v_accvgpr_write_b32 a158, v54
  v_accvgpr_write_b32 a159, v55
  s_waitcnt vmcnt(40)
  v_perm_b32 v48, v114, v112, s44
  v_perm_b32 v49, v118, v116, s44
  v_perm_b32 v50, v122, v120, s44
  v_perm_b32 v51, v126, v124, s44
  v_accvgpr_write_b32 a160, v48
  v_accvgpr_write_b32 a161, v49
  v_accvgpr_write_b32 a162, v50
  v_accvgpr_write_b32 a163, v51
  v_perm_b32 v52, v114, v112, s45
  v_perm_b32 v53, v118, v116, s45
  v_perm_b32 v54, v122, v120, s45
  v_perm_b32 v55, v126, v124, s45
  v_accvgpr_write_b32 a164, v52
  v_accvgpr_write_b32 a165, v53
  v_accvgpr_write_b32 a166, v54
  v_accvgpr_write_b32 a167, v55
  v_perm_b32 v48, v115, v113, s44
  v_perm_b32 v49, v119, v117, s44
  v_perm_b32 v50, v123, v121, s44
  v_perm_b32 v51, v127, v125, s44
  v_accvgpr_write_b32 a168, v48
  v_accvgpr_write_b32 a169, v49
  v_accvgpr_write_b32 a170, v50
  v_accvgpr_write_b32 a171, v51
  v_perm_b32 v52, v115, v113, s45
  v_perm_b32 v53, v119, v117, s45
  v_perm_b32 v54, v123, v121, s45
  v_perm_b32 v55, v127, v125, s45
  v_accvgpr_write_b32 a172, v52
  v_accvgpr_write_b32 a173, v53
  v_accvgpr_write_b32 a174, v54
  v_accvgpr_write_b32 a175, v55
  s_waitcnt vmcnt(32)
  v_perm_b32 v48, v130, v128, s44
  v_perm_b32 v49, v134, v132, s44
  v_perm_b32 v50, v138, v136, s44
  v_perm_b32 v51, v142, v140, s44
  v_accvgpr_write_b32 a176, v48
  v_accvgpr_write_b32 a177, v49
  v_accvgpr_write_b32 a178, v50
  v_accvgpr_write_b32 a179, v51
  v_perm_b32 v52, v130, v128, s45
  v_perm_b32 v53, v134, v132, s45
  v_perm_b32 v54, v138, v136, s45
  v_perm_b32 v55, v142, v140, s45
  v_accvgpr_write_b32 a180, v52
  v_accvgpr_write_b32 a181, v53
  v_accvgpr_write_b32 a182, v54
  v_accvgpr_write_b32 a183, v55
  v_perm_b32 v48, v131, v129, s44
  v_perm_b32 v49, v135, v133, s44
  v_perm_b32 v50, v139, v137, s44
  v_perm_b32 v51, v143, v141, s44
  v_accvgpr_write_b32 a184, v48
  v_accvgpr_write_b32 a185, v49
  v_accvgpr_write_b32 a186, v50
  v_accvgpr_write_b32 a187, v51
  v_perm_b32 v52, v131, v129, s45
  v_perm_b32 v53, v135, v133, s45
  v_perm_b32 v54, v139, v137, s45
  v_perm_b32 v55, v143, v141, s45
  v_accvgpr_write_b32 a188, v52
  v_accvgpr_write_b32 a189, v53
  v_accvgpr_write_b32 a190, v54
  v_accvgpr_write_b32 a191, v55
  s_waitcnt vmcnt(24)
  v_perm_b32 v48, v146, v144, s44
  v_perm_b32 v49, v150, v148, s44
  v_perm_b32 v50, v154, v152, s44
  v_perm_b32 v51, v158, v156, s44
  v_accvgpr_write_b32 a192, v48
  v_accvgpr_write_b32 a193, v49
  v_accvgpr_write_b32 a194, v50
  v_accvgpr_write_b32 a195, v51
  v_perm_b32 v52, v146, v144, s45
  v_perm_b32 v53, v150, v148, s45
  v_perm_b32 v54, v154, v152, s45
  v_perm_b32 v55, v158, v156, s45
  v_accvgpr_write_b32 a196, v52
  v_accvgpr_write_b32 a197, v53
  v_accvgpr_write_b32 a198, v54
  v_accvgpr_write_b32 a199, v55
  v_perm_b32 v48, v147, v145, s44
  v_perm_b32 v49, v151, v149, s44
  v_perm_b32 v50, v155, v153, s44
  v_perm_b32 v51, v159, v157, s44
  v_accvgpr_write_b32 a200, v48
  v_accvgpr_write_b32 a201, v49
  v_accvgpr_write_b32 a202, v50
  v_accvgpr_write_b32 a203, v51
  v_perm_b32 v52, v147, v145, s45
  v_perm_b32 v53, v151, v149, s45
  v_perm_b32 v54, v155, v153, s45
  v_perm_b32 v55, v159, v157, s45
  v_accvgpr_write_b32 a204, v52
  v_accvgpr_write_b32 a205, v53
  v_accvgpr_write_b32 a206, v54
  v_accvgpr_write_b32 a207, v55
  s_waitcnt vmcnt(16)
  v_perm_b32 v48, v162, v160, s44
  v_perm_b32 v49, v166, v164, s44
  v_perm_b32 v50, v170, v168, s44
  v_perm_b32 v51, v174, v172, s44
  v_accvgpr_write_b32 a208, v48
  v_accvgpr_write_b32 a209, v49
  v_accvgpr_write_b32 a210, v50
  v_accvgpr_write_b32 a211, v51
  v_perm_b32 v52, v162, v160, s45
  v_perm_b32 v53, v166, v164, s45
  v_perm_b32 v54, v170, v168, s45
  v_perm_b32 v55, v174, v172, s45
  v_accvgpr_write_b32 a212, v52
  v_accvgpr_write_b32 a213, v53
  v_accvgpr_write_b32 a214, v54
  v_accvgpr_write_b32 a215, v55
  v_perm_b32 v48, v163, v161, s44
  v_perm_b32 v49, v167, v165, s44
  v_perm_b32 v50, v171, v169, s44
  v_perm_b32 v51, v175, v173, s44
  v_accvgpr_write_b32 a216, v48
  v_accvgpr_write_b32 a217, v49
  v_accvgpr_write_b32 a218, v50
  v_accvgpr_write_b32 a219, v51
  v_perm_b32 v52, v163, v161, s45
  v_perm_b32 v53, v167, v165, s45
  v_perm_b32 v54, v171, v169, s45
  v_perm_b32 v55, v175, v173, s45
  v_accvgpr_write_b32 a220, v52
  v_accvgpr_write_b32 a221, v53
  v_accvgpr_write_b32 a222, v54
  v_accvgpr_write_b32 a223, v55
  s_waitcnt vmcnt(8)
  v_perm_b32 v48, v66, v64, s44
  v_perm_b32 v49, v70, v68, s44
  v_perm_b32 v50, v74, v72, s44
  v_perm_b32 v51, v78, v76, s44
  v_accvgpr_write_b32 a224, v48
  v_accvgpr_write_b32 a225, v49
  v_accvgpr_write_b32 a226, v50
  v_accvgpr_write_b32 a227, v51
  v_perm_b32 v52, v66, v64, s45
  v_perm_b32 v53, v70, v68, s45
  v_perm_b32 v54, v74, v72, s45
  v_perm_b32 v55, v78, v76, s45
  v_accvgpr_write_b32 a228, v52
  v_accvgpr_write_b32 a229, v53
  v_accvgpr_write_b32 a230, v54
  v_accvgpr_write_b32 a231, v55
  v_perm_b32 v48, v67, v65, s44
  v_perm_b32 v49, v71, v69, s44
  v_perm_b32 v50, v75, v73, s44
  v_perm_b32 v51, v79, v77, s44
  v_accvgpr_write_b32 a232, v48
  v_accvgpr_write_b32 a233, v49
  v_accvgpr_write_b32 a234, v50
  v_accvgpr_write_b32 a235, v51
  v_perm_b32 v52, v67, v65, s45
  v_perm_b32 v53, v71, v69, s45
  v_perm_b32 v54, v75, v73, s45
  v_perm_b32 v55, v79, v77, s45
  v_accvgpr_write_b32 a236, v52
  v_accvgpr_write_b32 a237, v53
  v_accvgpr_write_b32 a238, v54
  v_accvgpr_write_b32 a239, v55
  s_waitcnt vmcnt(0)
  v_perm_b32 v48, v82, v80, s44
  v_perm_b32 v49, v86, v84, s44
  v_perm_b32 v50, v90, v88, s44
  v_perm_b32 v51, v94, v92, s44
  v_accvgpr_write_b32 a240, v48
  v_accvgpr_write_b32 a241, v49
  v_accvgpr_write_b32 a242, v50
  v_accvgpr_write_b32 a243, v51
  v_perm_b32 v52, v82, v80, s45
  v_perm_b32 v53, v86, v84, s45
  v_perm_b32 v54, v90, v88, s45
  v_perm_b32 v55, v94, v92, s45
  v_accvgpr_write_b32 a244, v52
  v_accvgpr_write_b32 a245, v53
  v_accvgpr_write_b32 a246, v54
  v_accvgpr_write_b32 a247, v55
  v_perm_b32 v48, v83, v81, s44
  v_perm_b32 v49, v87, v85, s44
  v_perm_b32 v50, v91, v89, s44
  v_perm_b32 v51, v95, v93, s44
  v_accvgpr_write_b32 a248, v48
  v_accvgpr_write_b32 a249, v49
  v_accvgpr_write_b32 a250, v50
  v_accvgpr_write_b32 a251, v51
  v_perm_b32 v52, v83, v81, s45
  v_perm_b32 v53, v87, v85, s45
  v_perm_b32 v54, v91, v89, s45
  v_perm_b32 v55, v95, v93, s45
  v_accvgpr_write_b32 a252, v52
  v_accvgpr_write_b32 a253, v53
  v_accvgpr_write_b32 a254, v54
  v_accvgpr_write_b32 a255, v55
  v_mbcnt_lo_u32_b32 v60, -1, 0
  v_and_b32 v60, 1, v60
  v_lshlrev_b32 v60, 2, v60
  v_add_u32 v60, s92, v60
  s_mov_b32 s26, 0
g_wt_74:
  global_load_dword v61, v60, s[12:13] sc1
  s_add_u32 s26, s26, 1
  s_cmp_gt_u32 s26, 1048576
  s_cbranch_scc1 L_end
  s_waitcnt vmcnt(0)
  v_readlane_b32 s32, v61, 0
  v_readlane_b32 s33, v61, 1
  s_add_u32 s27, s32, s33
  s_mul_i32 s27, s27, 0x01010101
  s_lshr_b32 s27, s27, 24
  s_cmp_lt_u32 s27, 16
  s_cbranch_scc1 g_wt_74
  s_lshl_b32 s26, s89, 3
  s_lshr_b64 s[32:33], s[32:33], s26
  s_and_b32 s32, s32, 0xff
  s_cmp_lg_u32 s32, 16
  s_cbranch_scc1 L_o_x
  s_mov_b32 s62, 0
  s_mov_b32 s46, 0
  s_mov_b32 s65, 0
  s_mov_b32 s66, 0
  s_mov_b32 s76, 0
  s_mov_b32 s50, 0
  s_mov_b32 s55, 0
  s_mov_b32 s56, 0
  s_mov_b32 s57, 0
  s_mov_b32 s79, 268435456
  s_mov_b32 s84, 268435456
  s_mov_b32 s86, s41
  s_mov_b32 s49, s60
  s_mov_b32 s47, 3579139413
o_round_75:
  s_mov_b32 s67, 0
  s_lshl_b32 s26, s49, 10
  s_add_u32 s26, s26, 243323904
d_w_82:
  buffer_load_dword v160, v246, s[4:7], s26 offen sc1
  buffer_load_dword v161, v246, s[4:7], s26 offen offset:2048 sc1
  s_add_u32 s67, s67, 1
  s_cmp_gt_u32 s67, 1048576
  s_cbranch_scc1 L_end
  s_waitcnt vmcnt(0)
  v_min_u32 v162, v160, v161
  v_max_u32 v163, v160, v161
  v_cmp_eq_u32 vcc, 0, v162
  s_cbranch_vccnz d_w_82
  v_max_u32_dpp v163, v163, v163 row_ror:8 row_mask:0xf bank_mask:0xf
  s_nop 1
  v_max_u32_dpp v163, v163, v163 row_ror:4 row_mask:0xf bank_mask:0xf
  s_nop 1
  v_max_u32_dpp v163, v163, v163 row_ror:2 row_mask:0xf bank_mask:0xf
  s_nop 1
  v_max_u32_dpp v163, v163, v163 row_ror:1 row_mask:0xf bank_mask:0xf
  s_nop 0
  v_readlane_b32 s28, v163, 0
  v_readlane_b32 s29, v163, 16
  v_readlane_b32 s30, v163, 32
  v_readlane_b32 s31, v163, 48
  s_max_u32 s28, s28, s29
  s_max_u32 s30, s30, s31
  s_max_u32 s46, s46, s28
  s_max_u32 s46, s46, s30
  s_andn2_b32 s52, 0xfff, s46
  s_lshr_b32 s52, s52, 5
  s_min_u32 s52, s52, 64
  s_add_u32 s26, s52, 3
  s_sub_u32 s26, s26, s60
  s_lshr_b32 s26, s26, 2
  s_bfm_b32 s54, s26, 0
  s_mul_i32 s63, s49, 257
  s_or_b32 s63, s63, 1179648
  s_add_u32 s53, s63, 1028
  s_cmp_lt_u32 s49, 60
  s_cselect_b32 s53, s53, 0
  s_lshr_b32 s26, s49, 2
  s_nop 3
  v_readlane_b32 s89, v247, s26
  s_sub_i32 s26, s26, 3
  s_max_i32 s26, s26, 0
  s_bfm_b32 s58, s26, 0
  s_and_b32 s59, s47, 3
  s_lshr_b32 s47, s47, 2
o_pick_80:
  s_cmp_eq_u32 s59, 0
  s_cbranch_scc1 o_none_87
  s_sub_u32 s59, s59, 1
  s_andn2_b32 s27, s58, s55
  s_and_b32 s26, s27, s54
  s_cbranch_scc1 o_gaf_85
  s_andn2_b32 s28, s58, s54
  s_andn2_b32 s28, s28, s56
  s_cmp_lg_u32 s50, 0
  s_cselect_b32 s27, 0, s27
  s_cmp_ge_u32 s46, s89
  s_cselect_b32 s26, 0, s27
  s_cmp_lg_u32 s26, 0
  s_cbranch_scc1 o_ga_83
  s_mov_b32 s26, s28
  s_cmp_lg_u32 s26, 0
  s_cbranch_scc1 o_gb_84
  s_mov_b32 s26, s27
  s_cmp_lg_u32 s26, 0
  s_cbranch_scc1 o_ga_83
o_none_87:
  s_mov_b32 s64, s53
  s_mov_b32 s51, 0
  s_branch o_task_76
o_gaf_85:
  s_ff1_i32_b32 s26, s26
  s_bitset1_b32 s55, s26
  s_bitset1_b32 s57, s26
  s_mov_b32 s64, 1654848
  s_branch o_gd_86
o_ga_83:
  s_ff1_i32_b32 s26, s26
  s_bitset1_b32 s55, s26
  s_mov_b32 s64, 1327168
  s_branch o_gd_86
o_gb_84:
  s_ff1_i32_b32 s26, s26
  s_bitset1_b32 s56, s26
  s_andn2_b32 s27, 31, s46
  s_or_b32 s27, s27, 32
  s_lshl_b32 s27, s27, 22
  s_or_b32 s27, s27, 1540224
  s_lshl_b32 s28, s26, 2
  s_add_u32 s28, s28, s60
  s_cmp_eq_u32 s28, s52
  s_cselect_b32 s64, s27, 1540160
  s_lshl_b32 s27, s50, 17
  s_add_u32 s64, s64, s27
o_gd_86:
  s_lshl_b32 s26, s26, 2
  s_add_u32 s26, s26, s60
  s_mul_i32 s26, s26, 257
  s_or_b32 s64, s64, s26
  s_xor_b32 s26, s64, s63
  s_and_b32 s26, s26, 0xff
  s_cselect_b32 s26, 0, 2097152
  s_or_b32 s64, s64, s26
  s_mov_b32 s51, 1
o_task_76:
  s_cmp_eq_u32 s63, 0
  s_cbranch_scc1 o_nofl_78
  s_cmp_lg_u32 s66, 0
  s_cbranch_scc1 o_have_89
  s_mov_b32 s67, 0
o_w1_88:
  s_and_b32 s32, s63, 0xff
  s_lshl_b32 s32, s32, 12
  s_add_u32 s32, s32, s14
  buffer_load_dword v37, v36, s[4:7], s32 offen sc1
  s_add_u32 s67, s67, 1
  s_cmp_gt_u32 s67, 1048576
  s_cbranch_scc1 L_end
  s_waitcnt vmcnt(0)
  v_mov_b32 v7, s62
  s_mov_b64 exec, 1
  buffer_store_dword v7, off, s[4:7], s79
  s_mov_b64 exec, -1
  s_mov_b32 s79, 268435456
  s_mov_b64 exec, 1
  buffer_store_dword v38, off, s[4:7], s84 sc1
  s_mov_b64 exec, -1
  s_mov_b32 s84, 268435456
  v_cmp_eq_u32 vcc, 0, v37
  s_cbranch_vccnz o_w1_88
  s_and_b32 s87, s63, 0xff
  s_lshl_b32 s33, s87, 18
  s_lshl_b32 s32, s87, 19
  s_add_u32 m0, s22, 0
  s_add_u32 s33, s33, s19
  buffer_load_dwordx4 v0, s[4:7], s33 offen offset:0 sc1 lds
  buffer_load_dwordx4 v0, s[4:7], s33 offen offset:1024 sc1 lds
  buffer_load_dwordx4 v0, s[4:7], s33 offen offset:2048 sc1 lds
  buffer_load_dwordx4 v0, s[4:7], s33 offen offset:3072 sc1 lds
  s_add_u32 m0, s23, 0
  s_add_u32 s32, s32, s18
  buffer_load_dwordx4 v0, s[4:7], s32 offen offset:0 sc1 lds
  buffer_load_dwordx4 v0, s[4:7], s32 offen offset:1024 sc1 lds
  buffer_load_dwordx4 v0, s[4:7], s32 offen offset:2048 sc1 lds
  buffer_load_dwordx4 v0, s[4:7], s32 offen offset:3072 sc1 lds
  s_add_u32 m0, m0, 4096
  s_add_u32 s32, s32, 4096
  buffer_load_dwordx4 v0, s[4:7], s32 offen offset:0 sc1 lds
  buffer_load_dwordx4 v0, s[4:7], s32 offen offset:1024 sc1 lds
  buffer_load_dwordx4 v0, s[4:7], s32 offen offset:2048 sc1 lds
  buffer_load_dwordx4 v0, s[4:7], s32 offen offset:3072 sc1 lds
  s_waitcnt vmcnt(0)
  s_barrier
o_have_89:
  ds_read_b128 v[120:123], v33 offset:0
  ds_read_b128 v[40:43], v32 offset:0
  ds_read_b128 v[56:59], v32 offset:1024
  ds_read_b128 v[124:127], v33 offset:2048
  ds_read_b128 v[44:47], v32 offset:4096
  ds_read_b128 v[60:63], v32 offset:5120
  ds_read_b128 v[128:131], v33 offset:4096
  ds_read_b128 v[48:51], v32 offset:8192
  ds_read_b128 v[64:67], v32 offset:9216
  ds_read_b128 v[132:135], v33 offset:6144
  ds_read_b128 v[52:55], v32 offset:12288
  ds_read_b128 v[68:71], v32 offset:13312
  s_and_b32 s32, s64, 0xff
  s_lshl_b32 s32, s32, 12
  s_add_u32 s32, s32, s14
  buffer_load_dword v37, v36, s[4:7], s32 offen sc1
  s_and_b32 s32, s64, 0xff00
  s_lshl_b32 s32, s32, 3
  s_add_u32 s32, s32, s15
  buffer_load_dword v245, off, s[4:7], s32 sc1
  s_waitcnt lgkmcnt(9)
  v_mfma_f32_16x16x32_bf16 v[104:107], v[40:43], v[120:123], v[24:27]
  ds_read_b128 v[136:139], v34 offset:0
  v_mfma_f32_16x16x32_bf16 v[108:111], v[56:59], v[120:123], v[28:31]
  ds_read_b64 v[200:201], v35 offset:4096
  s_waitcnt lgkmcnt(8)
  v_mfma_f32_16x16x32_bf16 v[104:107], v[44:47], v[124:127], v[104:107]
  ds_read_b128 v[140:143], v34 offset:1024
  v_mfma_f32_16x16x32_bf16 v[108:111], v[60:63], v[124:127], v[108:111]
  ds_read_b64 v[202:203], v35 offset:4608
  s_waitcnt lgkmcnt(7)
  v_mfma_f32_16x16x32_bf16 v[104:107], v[48:51], v[128:131], v[104:107]
  ds_read_b128 v[144:147], v34 offset:2048
  v_mfma_f32_16x16x32_bf16 v[108:111], v[64:67], v[128:131], v[108:111]
  ds_read_b64 v[204:205], v35 offset:5120
  s_waitcnt lgkmcnt(6)
  v_mfma_f32_16x16x32_bf16 v[104:107], v[52:55], v[132:135], v[104:107]
  ds_read_b128 v[148:151], v34 offset:3072
  v_mfma_f32_16x16x32_bf16 v[108:111], v[68:71], v[132:135], v[108:111]
  ds_read_b64 v[206:207], v35 offset:5632
  s_cmp_lg_u32 s76, 0
  s_cbranch_scc1 o_klds_92
  ds_read_b128 v[152:155], v32 offset:2048
  ds_read_b128 v[156:159], v32 offset:3072
  ds_read_b128 v[160:163], v32 offset:6144
  ds_read_b128 v[164:167], v32 offset:7168
  ds_read_b128 v[168:171], v32 offset:10240
  ds_read_b128 v[172:175], v32 offset:11264
  ds_read_b128 v[176:179], v32 offset:14336
  ds_read_b128 v[180:183], v32 offset:15360
  v_mov_b32 v196, 0
  v_mov_b32 v199, 0
  v_exp_f32 v56, v104
  v_exp_f32 v57, v105
  v_exp_f32 v58, v106
  v_exp_f32 v59, v107
  v_exp_f32 v60, v108
  v_exp_f32 v61, v109
  v_exp_f32 v62, v110
  v_exp_f32 v63, v111
  v_max3_f32 v116, v104, v105, v106
  v_max3_f32 v116, v107, v108, v116
  v_max3_f32 v116, v109, v110, v116
  v_add_f32 v117, v56, v57
  v_add_f32 v118, v58, v59
  v_add_f32 v117, v117, v60
  v_add_f32 v118, v118, v61
  v_add_f32 v117, v117, v62
  v_add_f32 v118, v118, v63
  s_waitcnt vmcnt(0) lgkmcnt(0)
  v_mov_b32 v7, s62
  s_mov_b64 exec, 1
  buffer_store_dword v7, off, s[4:7], s79
  s_mov_b64 exec, -1
  s_mov_b32 s79, 268435456
  s_mov_b64 exec, 1
  buffer_store_dword v38, off, s[4:7], s84 sc1
  s_mov_b64 exec, -1
  s_mov_b32 s84, 268435456
  s_mov_b32 s67, 0
o_w2_90:
  s_and_b32 s32, s63, 0xff00
  s_lshl_b32 s32, s32, 3
  s_add_u32 s32, s32, s15
  buffer_load_dword v244, off, s[4:7], s32 sc1
  s_add_u32 s67, s67, 1
  s_cmp_gt_u32 s67, 1048576
  s_cbranch_scc1 L_end
  s_waitcnt vmcnt(0)
  v_cmp_eq_u32 vcc, 0, v244
  s_cbranch_vccnz o_w2_90
  s_and_b32 s32, s63, 0xff00
  s_lshl_b32 s32, s32, 10
  s_add_u32 s32, s32, s20
  buffer_load_dwordx4 v[136:139], v0, s[4:7], s32 offen offset:0 sc1
  buffer_load_dwordx4 v[140:143], v0, s[4:7], s32 offen offset:1024 sc1
  buffer_load_dwordx4 v[144:147], v0, s[4:7], s32 offen offset:2048 sc1
  buffer_load_dwordx4 v[148:151], v0, s[4:7], s32 offen offset:3072 sc1
  s_add_u32 s32, s32, 4096
  buffer_load_dwordx2 v[200:201], v1, s[4:7], s32 offen offset:0 sc1
  buffer_load_dwordx2 v[202:203], v1, s[4:7], s32 offen offset:512 sc1
  buffer_load_dwordx2 v[204:205], v1, s[4:7], s32 offen offset:1024 sc1
  buffer_load_dwordx2 v[206:207], v1, s[4:7], s32 offen offset:1536 sc1
  s_waitcnt vmcnt(7)
  v_mfma_f32_16x16x32_bf16 v[112:115], v[136:139], v[120:123], 0
  s_waitcnt vmcnt(6)
  v_mfma_f32_16x16x32_bf16 v[112:115], v[140:143], v[124:127], v[112:115]
  s_waitcnt vmcnt(5)
  v_mfma_f32_16x16x32_bf16 v[112:115], v[144:147], v[128:131], v[112:115]
  s_waitcnt vmcnt(4)
  v_mfma_f32_16x16x32_bf16 v[112:115], v[148:151], v[132:135], v[112:115]
  s_waitcnt vmcnt(0)
  s_branch o_havek_91
o_klds_92:
  s_waitcnt lgkmcnt(1)
  v_mfma_f32_16x16x32_bf16 v[112:115], v[136:139], v[120:123], 0
  ds_read_b128 v[152:155], v32 offset:2048
  ds_read_b128 v[156:159], v32 offset:3072
  v_mfma_f32_16x16x32_bf16 v[112:115], v[140:143], v[124:127], v[112:115]
  ds_read_b128 v[160:163], v32 offset:6144
  ds_read_b128 v[164:167], v32 offset:7168
  v_mfma_f32_16x16x32_bf16 v[112:115], v[144:147], v[128:131], v[112:115]
  ds_read_b128 v[168:171], v32 offset:10240
  ds_read_b128 v[172:175], v32 offset:11264
  v_mfma_f32_16x16x32_bf16 v[112:115], v[148:151], v[132:135], v[112:115]
  ds_read_b128 v[176:179], v32 offset:14336
  ds_read_b128 v[180:183], v32 offset:15360
  v_mov_b32 v196, 0
  v_mov_b32 v199, 0
  v_exp_f32 v56, v104
  v_exp_f32 v57, v105
  v_exp_f32 v58, v106
  v_exp_f32 v59, v107
  v_exp_f32 v60, v108
  v_exp_f32 v61, v109
  v_exp_f32 v62, v110
  v_exp_f32 v63, v111
  v_max3_f32 v116, v104, v105, v106
  v_max3_f32 v116, v107, v108, v116
  v_max3_f32 v116, v109, v110, v116
  v_add_f32 v117, v56, v57
  v_add_f32 v118, v58, v59
  v_add_f32 v117, v117, v60
  v_add_f32 v118, v118, v61
  v_add_f32 v117, v117, v62
  v_add_f32 v118, v118, v63
  s_waitcnt vmcnt(2)
  v_mov_b32 v7, s62
  s_mov_b64 exec, 1
  buffer_store_dword v7, off, s[4:7], s79
  s_mov_b64 exec, -1
  s_mov_b32 s79, 268435456
o_havek_91:
  s_nop 1
  s_nop 1
  s_nop 1
  v_mul_f32 v112, s24, v112
  v_mul_f32 v113, s24, v113
  v_exp_f32 v64, v112
  v_exp_f32 v65, v113
  v_max_f32 v116, v111, v116
  v_max3_f32 v116, v112, v113, v116
  v_add_f32 v117, v117, v64
  v_add_f32 v118, v118, v65
  v_add_f32 v117, v117, v118
  v_cmp_lt_f32 vcc, 0x42700000, v116
  s_mov_b32 s28, 0x21800000
  s_and_b32 s26, s42, -256
  v_mov_b32 v118, v117
  s_nop 1
  v_permlane16_swap_b32 v117, v118
  v_add_f32 v117, v117, v118
  v_mov_b32 v118, v117
  s_nop 0
  s_nop 0
  v_permlane32_swap_b32 v117, v118
  v_add_f32 v117, v117, v118
  v_cmp_gt_f32 s[30:31], s28, v117
  v_rcp_f32 v117, v117
  s_or_b64 vcc, vcc, s[30:31]
  s_cbranch_vccnz o_fb_94
o_fbr_95:
  buffer_load_dword v7, v2, s[4:7], s26 offen sc1
  v_pk_mul_f32 v[56:57], v[56:57], v[116:117] op_sel:[0,1] op_sel_hi:[1,1]
  v_pk_mul_f32 v[58:59], v[58:59], v[116:117] op_sel:[0,1] op_sel_hi:[1,1]
  v_pk_mul_f32 v[60:61], v[60:61], v[116:117] op_sel:[0,1] op_sel_hi:[1,1]
  v_pk_mul_f32 v[62:63], v[62:63], v[116:117] op_sel:[0,1] op_sel_hi:[1,1]
  v_pk_mul_f32 v[64:65], v[64:65], v[116:117] op_sel:[0,1] op_sel_hi:[1,1]
  v_cvt_pk_bf16_f32 v116, v56, v57
  v_cvt_pk_bf16_f32 v117, v58, v59
  v_cvt_pk_bf16_f32 v118, v60, v61
  v_cvt_pk_bf16_f32 v119, v62, v63
  s_waitcnt lgkmcnt(0)
  s_nop 0
  v_mfma_f32_16x16x32_bf16 v[72:75], v[152:155], v[116:119], 0
  s_mov_b32 s95, s86
  v_cvt_pk_bf16_f32 v197, v64, v65
  v_cvt_pk_bf16_f32 v198, v64, v65
  v_mfma_f32_16x16x32_bf16 v[76:79], v[156:159], v[116:119], 0
  s_mov_b32 s96, s62
  v_mfma_f32_16x16x32_bf16 v[80:83], v[160:163], v[116:119], 0
  s_add_u32 s62, s62, 1
  v_mfma_f32_16x16x32_bf16 v[84:87], v[164:167], v[116:119], 0
  s_and_b32 s86, s62, 1
  v_mfma_f32_16x16x32_bf16 v[88:91], v[168:171], v[116:119], 0
  s_lshl_b32 s86, s86, 19
  v_mfma_f32_16x16x32_bf16 v[92:95], v[172:175], v[116:119], 0
  s_add_u32 s86, s86, s41
  v_mfma_f32_16x16x32_bf16 v[96:99], v[176:179], v[116:119], 0
  s_cmp_ge_u32 s17, 2
  v_mfma_f32_16x16x32_bf16 v[100:103], v[180:183], v[116:119], 0
  s_cselect_b32 s65, 0, s65
  v_mfma_f32_16x16x16_bf16 v[72:75], v[200:201], v[198:199], v[72:75]
  s_nop 1
  v_mfma_f32_16x16x16_bf16 v[76:79], v[200:201], v[196:197], v[76:79]
  s_nop 1
  v_mfma_f32_16x16x16_bf16 v[80:83], v[202:203], v[198:199], v[80:83]
  s_nop 1
  v_mfma_f32_16x16x16_bf16 v[84:87], v[202:203], v[196:197], v[84:87]
  s_nop 1
  v_mfma_f32_16x16x16_bf16 v[88:91], v[204:205], v[198:199], v[88:91]
  s_nop 0
  v_cvt_pk_bf16_f32 v40, v72, v73
  v_cvt_pk_bf16_f32 v41, v74, v75
  v_mfma_f32_16x16x16_bf16 v[92:95], v[204:205], v[196:197], v[92:95]
  s_nop 0
  v_cvt_pk_bf16_f32 v42, v76, v77
  v_cvt_pk_bf16_f32 v43, v78, v79
  v_mfma_f32_16x16x16_bf16 v[96:99], v[206:207], v[198:199], v[96:99]
  s_nop 0
  ds_write_b128 v6, v[40:43] offset:0
  v_cvt_pk_bf16_f32 v44, v80, v81
  v_mfma_f32_16x16x16_bf16 v[100:103], v[206:207], v[196:197], v[100:103]
  s_nop 0
  v_cvt_pk_bf16_f32 v45, v82, v83
  v_cvt_pk_bf16_f32 v46, v84, v85
  v_cvt_pk_bf16_f32 v47, v86, v87
  ds_write_b128 v6, v[44:47] offset:1024
  v_cvt_pk_bf16_f32 v48, v88, v89
  v_cvt_pk_bf16_f32 v49, v90, v91
  v_cvt_pk_bf16_f32 v50, v92, v93
  v_cvt_pk_bf16_f32 v51, v94, v95
  ds_write_b128 v6, v[48:51] offset:2048
  v_cvt_pk_bf16_f32 v52, v96, v97
  v_cvt_pk_bf16_f32 v53, v98, v99
  v_cvt_pk_bf16_f32 v54, v100, v101
  v_cvt_pk_bf16_f32 v55, v102, v103
  ds_write_b128 v6, v[52:55] offset:3072
  s_cmp_eq_u32 s65, 0
  s_cbranch_scc1 o_noob_93
  s_mov_b32 s67, 0
o_obl_96:
  s_waitcnt vmcnt(0)
  v_cmp_gt_u32 vcc, s96, v7
  s_cbranch_vccz o_obk_100
  buffer_load_dword v7, v2, s[4:7], s26 offen sc1
  s_add_u32 s67, s67, 1
  s_cmp_gt_u32 s67, 1048576
  s_cbranch_scc1 L_end
  s_branch o_obl_96
o_obk_100:
  s_lshl_b32 s94, s43, 14
  s_add_u32 s94, s94, s95
  buffer_load_dwordx4 v[120:123], v5, s[4:7], s94 offen offset:0 sc1
  buffer_load_dwordx4 v[124:127], v5, s[4:7], s94 offen offset:256 sc1
  buffer_load_dwordx4 v[128:131], v5, s[4:7], s94 offen offset:512 sc1
  buffer_load_dwordx4 v[132:135], v5, s[4:7], s94 offen offset:768 sc1
  s_add_u32 s94, s94, 4096
  buffer_load_dwordx4 v[136:139], v5, s[4:7], s94 offen offset:0 sc1
  buffer_load_dwordx4 v[140:143], v5, s[4:7], s94 offen offset:256 sc1
  buffer_load_dwordx4 v[144:147], v5, s[4:7], s94 offen offset:512 sc1
  buffer_load_dwordx4 v[148:151], v5, s[4:7], s94 offen offset:768 sc1
  s_add_u32 s94, s94, 4096
  buffer_load_dwordx4 v[152:155], v5, s[4:7], s94 offen offset:0 sc1
  buffer_load_dwordx4 v[156:159], v5, s[4:7], s94 offen offset:256 sc1
  buffer_load_dwordx4 v[160:163], v5, s[4:7], s94 offen offset:512 sc1
  buffer_load_dwordx4 v[164:167], v5, s[4:7], s94 offen offset:768 sc1
  s_add_u32 s94, s94, 4096
  buffer_load_dwordx4 v[168:171], v5, s[4:7], s94 offen offset:0 sc1
  buffer_load_dwordx4 v[172:175], v5, s[4:7], s94 offen offset:256 sc1
  buffer_load_dwordx4 v[176:179], v5, s[4:7], s94 offen offset:512 sc1
  buffer_load_dwordx4 v[180:183], v5, s[4:7], s94 offen offset:768 sc1
  s_waitcnt lgkmcnt(0)
  s_barrier
  s_branch o_wr1_97
o_noob_93:
  s_waitcnt lgkmcnt(0) vmcnt(0)
  s_barrier
  ds_read_b128 v[104:107], v3 offset:0
  ds_read_b128 v[108:111], v3 offset:512
  ds_read_b128 v[112:115], v3 offset:1024
  s_waitcnt lgkmcnt(2)
  v_mfma_f32_32x32x16_bf16 v[40:55], v[104:107], a[0:3], 0
  s_bfe_u32 s26, s64, 131092
  s_and_b32 s87, s64, 0xff
  s_bfe_u32 s88, s64, 0x80008
  v_cmp_eq_u32 vcc, 0, v37
  s_cmp_eq_u64 vcc, 0
  s_cselect_b32 s66, s26, 0
  s_cmp_eq_u32 s66, 1
  s_cselect_b32 s87, s87, 1024
  s_cselect_b32 s34, 0, 0x20000
  v_mfma_f32_32x32x16_bf16 v[56:71], v[104:107], a[4:7], 0
  ds_read_b128 v[116:119], v3 offset:1536
  s_cmp_eq_u32 s26, 3
  s_cselect_b32 s66, 1, s66
  v_cmp_eq_u32 vcc, 0, v245
  s_cmp_eq_u64 vcc, 0
  s_cselect_b32 s76, s26, 0
  s_and_b32 s76, s76, 1
  s_cselect_b32 s88, s88, 1024
  v_mfma_f32_32x32x16_bf16 v[72:87], v[104:107], a[8:11], 0
  s_lshl_b32 s32, s88, 18
  s_mov_b32 m0, s40
  s_add_u32 s32, s32, s21
  v_mfma_f32_32x32x16_bf16 v[88:103], v[104:107], a[12:15], 0
  buffer_load_dwordx4 v0, s[4:7], s32 offen offset:0 sc1 lds
  s_waitcnt lgkmcnt(2)
  v_mfma_f32_32x32x16_bf16 v[40:55], v[108:111], a[16:19], v[40:55]
  v_mfma_f32_32x32x16_bf16 v[56:71], v[108:111], a[20:23], v[56:71]
  ds_read_b128 v[104:107], v3 offset:2048
  buffer_load_dwordx4 v0, s[4:7], s32 offen offset:1024 sc1 lds
  v_mfma_f32_32x32x16_bf16 v[72:87], v[108:111], a[24:27], v[72:87]
  v_mfma_f32_32x32x16_bf16 v[88:103], v[108:111], a[28:31], v[88:103]
  buffer_load_dwordx4 v0, s[4:7], s32 offen offset:2048 sc1 lds
  s_lshl_b32 s33, s87, 18
  s_lshl_b32 s32, s87, 19
  s_waitcnt lgkmcnt(2)
  v_mfma_f32_32x32x16_bf16 v[40:55], v[112:115], a[32:35], v[40:55]
  s_add_u32 m0, s22, s34
  s_add_u32 s33, s33, s19
  v_mfma_f32_32x32x16_bf16 v[56:71], v[112:115], a[36:39], v[56:71]
  ds_read_b128 v[108:111], v3 offset:2560
  buffer_load_dwordx4 v0, s[4:7], s33 offen offset:0 sc1 lds
  v_mfma_f32_32x32x16_bf16 v[72:87], v[112:115], a[40:43], v[72:87]
  v_mfma_f32_32x32x16_bf16 v[88:103], v[112:115], a[44:47], v[88:103]
  buffer_load_dwordx4 v0, s[4:7], s33 offen offset:1024 sc1 lds
  s_waitcnt lgkmcnt(2)
  v_mfma_f32_32x32x16_bf16 v[40:55], v[116:119], a[48:51], v[40:55]
  v_mfma_f32_32x32x16_bf16 v[56:71], v[116:119], a[52:55], v[56:71]
  ds_read_b128 v[112:115], v3 offset:3072
  buffer_load_dwordx4 v0, s[4:7], s33 offen offset:2048 sc1 lds
  v_mfma_f32_32x32x16_bf16 v[72:87], v[116:119], a[56:59], v[72:87]
  v_mfma_f32_32x32x16_bf16 v[88:103], v[116:119], a[60:63], v[88:103]
  buffer_load_dwordx4 v0, s[4:7], s33 offen offset:3072 sc1 lds
  s_add_u32 m0, s23, s34
  s_add_u32 s32, s32, s18
  s_waitcnt lgkmcnt(2)
  v_mfma_f32_32x32x16_bf16 v[40:55], v[104:107], a[64:67], v[40:55]
  v_mfma_f32_32x32x16_bf16 v[56:71], v[104:107], a[68:71], v[56:71]
  ds_read_b128 v[116:119], v3 offset:3584
  buffer_load_dwordx4 v0, s[4:7], s32 offen offset:0 sc1 lds
  v_mfma_f32_32x32x16_bf16 v[72:87], v[104:107], a[72:75], v[72:87]
  v_mfma_f32_32x32x16_bf16 v[88:103], v[104:107], a[76:79], v[88:103]
  buffer_load_dwordx4 v0, s[4:7], s32 offen offset:1024 sc1 lds
  s_waitcnt lgkmcnt(2)
  v_mfma_f32_32x32x16_bf16 v[40:55], v[108:111], a[80:83], v[40:55]
  v_mfma_f32_32x32x16_bf16 v[56:71], v[108:111], a[84:87], v[56:71]
  ds_read_b128 v[104:107], v3 offset:8192
  buffer_load_dwordx4 v0, s[4:7], s32 offen offset:2048 sc1 lds
  v_mfma_f32_32x32x16_bf16 v[72:87], v[108:111], a[88:91], v[72:87]
  v_mfma_f32_32x32x16_bf16 v[88:103], v[108:111], a[92:95], v[88:103]
  buffer_load_dwordx4 v0, s[4:7], s32 offen offset:3072 sc1 lds
  s_add_u32 m0, m0, 4096
  s_add_u32 s32, s32, 4096
  s_waitcnt lgkmcnt(2)
  v_mfma_f32_32x32x16_bf16 v[40:55], v[112:115], a[96:99], v[40:55]
  v_mfma_f32_32x32x16_bf16 v[56:71], v[112:115], a[100:103], v[56:71]
  ds_read_b128 v[108:111], v3 offset:8704
  buffer_load_dwordx4 v0, s[4:7], s32 offen offset:0 sc1 lds
  v_mfma_f32_32x32x16_bf16 v[72:87], v[112:115], a[104:107], v[72:87]
  v_mfma_f32_32x32x16_bf16 v[88:103], v[112:115], a[108:111], v[88:103]
  buffer_load_dwordx4 v0, s[4:7], s32 offen offset:1024 sc1 lds
  s_waitcnt lgkmcnt(2)
  v_mfma_f32_32x32x16_bf16 v[40:55], v[116:119], a[112:115], v[40:55]
  v_mfma_f32_32x32x16_bf16 v[56:71], v[116:119], a[116:119], v[56:71]
  ds_read_b128 v[112:115], v3 offset:9216
  buffer_load_dwordx4 v0, s[4:7], s32 offen offset:2048 sc1 lds
  v_mfma_f32_32x32x16_bf16 v[72:87], v[116:119], a[120:123], v[72:87]
  v_mfma_f32_32x32x16_bf16 v[88:103], v[116:119], a[124:127], v[88:103]
  buffer_load_dwordx4 v0, s[4:7], s32 offen offset:3072 sc1 lds
  s_lshl_b32 s26, s76, 1
  s_or_b32 s26, s26, s66
  s_waitcnt lgkmcnt(2)
  v_mfma_f32_32x32x16_bf16 v[40:55], v[104:107], a[128:131], v[40:55]
  v_mov_b32 v37, s26
  ds_write_b32 v39, v37
  v_mfma_f32_32x32x16_bf16 v[56:71], v[104:107], a[132:135], v[56:71]
  ds_read_b128 v[116:119], v3 offset:9728
  v_mfma_f32_32x32x16_bf16 v[72:87], v[104:107], a[136:139], v[72:87]
  v_mfma_f32_32x32x16_bf16 v[88:103], v[104:107], a[140:143], v[88:103]
  s_waitcnt lgkmcnt(3)
  v_mfma_f32_32x32x16_bf16 v[40:55], v[108:111], a[144:147], v[40:55]
  v_mfma_f32_32x32x16_bf16 v[56:71], v[108:111], a[148:151], v[56:71]
  ds_read_b128 v[104:107], v3 offset:10240
  v_mfma_f32_32x32x16_bf16 v[72:87], v[108:111], a[152:155], v[72:87]
  v_mfma_f32_32x32x16_bf16 v[88:103], v[108:111], a[156:159], v[88:103]
  s_waitcnt lgkmcnt(3)
  v_mfma_f32_32x32x16_bf16 v[40:55], v[112:115], a[160:163], v[40:55]
  v_mfma_f32_32x32x16_bf16 v[56:71], v[112:115], a[164:167], v[56:71]
  ds_read_b128 v[108:111], v3 offset:10752
  v_mfma_f32_32x32x16_bf16 v[72:87], v[112:115], a[168:171], v[72:87]
  v_mfma_f32_32x32x16_bf16 v[88:103], v[112:115], a[172:175], v[88:103]
  s_waitcnt lgkmcnt(2)
  v_mfma_f32_32x32x16_bf16 v[40:55], v[116:119], a[176:179], v[40:55]
  v_mfma_f32_32x32x16_bf16 v[56:71], v[116:119], a[180:183], v[56:71]
  ds_read_b128 v[112:115], v3 offset:11264
  v_mfma_f32_32x32x16_bf16 v[72:87], v[116:119], a[184:187], v[72:87]
  v_mfma_f32_32x32x16_bf16 v[88:103], v[116:119], a[188:191], v[88:103]
  s_waitcnt lgkmcnt(2)
  v_mfma_f32_32x32x16_bf16 v[40:55], v[104:107], a[192:195], v[40:55]
  v_mfma_f32_32x32x16_bf16 v[56:71], v[104:107], a[196:199], v[56:71]
  ds_read_b128 v[116:119], v3 offset:11776
  v_mfma_f32_32x32x16_bf16 v[72:87], v[104:107], a[200:203], v[72:87]
  v_mfma_f32_32x32x16_bf16 v[88:103], v[104:107], a[204:207], v[88:103]
  s_waitcnt lgkmcnt(2)
  v_mfma_f32_32x32x16_bf16 v[40:55], v[108:111], a[208:211], v[40:55]
  v_mfma_f32_32x32x16_bf16 v[56:71], v[108:111], a[212:215], v[56:71]
  v_mfma_f32_32x32x16_bf16 v[72:87], v[108:111], a[216:219], v[72:87]
  v_mfma_f32_32x32x16_bf16 v[88:103], v[108:111], a[220:223], v[88:103]
  s_waitcnt lgkmcnt(1)
  v_mfma_f32_32x32x16_bf16 v[40:55], v[112:115], a[224:227], v[40:55]
  v_mfma_f32_32x32x16_bf16 v[56:71], v[112:115], a[228:231], v[56:71]
  v_mfma_f32_32x32x16_bf16 v[72:87], v[112:115], a[232:235], v[72:87]
  v_mfma_f32_32x32x16_bf16 v[88:103], v[112:115], a[236:239], v[88:103]
  s_waitcnt lgkmcnt(0)
  v_mfma_f32_32x32x16_bf16 v[40:55], v[116:119], a[240:243], v[40:55]
  v_mfma_f32_32x32x16_bf16 v[56:71], v[116:119], a[244:247], v[56:71]
  v_mfma_f32_32x32x16_bf16 v[72:87], v[116:119], a[248:251], v[72:87]
  v_mfma_f32_32x32x16_bf16 v[88:103], v[116:119], a[252:255], v[88:103]
  s_nop 3
  s_nop 0
  s_nop 3
  s_nop 0
  v_cvt_pk_bf16_f32 v212, v40, v56
  s_nop 0
  v_cvt_pk_bf16_f32 v213, v72, v88
  s_add_u32 s26, s86, 0
  buffer_store_dwordx2 v[212:213], v4, s[4:7], s26 offen
  v_cvt_pk_bf16_f32 v214, v41, v57
  v_cvt_pk_bf16_f32 v215, v73, v89
  s_add_u32 s26, s86, 16384
  buffer_store_dwordx2 v[214:215], v4, s[4:7], s26 offen
  v_cvt_pk_bf16_f32 v216, v42, v58
  v_cvt_pk_bf16_f32 v217, v74, v90
  s_add_u32 s26, s86, 32768
  buffer_store_dwordx2 v[216:217], v4, s[4:7], s26 offen
  v_cvt_pk_bf16_f32 v218, v43, v59
  v_cvt_pk_bf16_f32 v219, v75, v91
  s_add_u32 s26, s86, 49152
  buffer_store_dwordx2 v[218:219], v4, s[4:7], s26 offen
  v_cvt_pk_bf16_f32 v220, v44, v60
  v_cvt_pk_bf16_f32 v221, v76, v92
  s_add_u32 s26, s86, 131072
  buffer_store_dwordx2 v[220:221], v4, s[4:7], s26 offen
  v_cvt_pk_bf16_f32 v222, v45, v61
  v_cvt_pk_bf16_f32 v223, v77, v93
  s_add_u32 s26, s86, 147456
  buffer_store_dwordx2 v[222:223], v4, s[4:7], s26 offen
  v_cvt_pk_bf16_f32 v224, v46, v62
  v_cvt_pk_bf16_f32 v225, v78, v94
  s_add_u32 s26, s86, 163840
  buffer_store_dwordx2 v[224:225], v4, s[4:7], s26 offen
  v_cvt_pk_bf16_f32 v226, v47, v63
  v_cvt_pk_bf16_f32 v227, v79, v95
  s_add_u32 s26, s86, 180224
  buffer_store_dwordx2 v[226:227], v4, s[4:7], s26 offen
  v_cvt_pk_bf16_f32 v228, v48, v64
  v_cvt_pk_bf16_f32 v229, v80, v96
  s_add_u32 s26, s86, 262144
  buffer_store_dwordx2 v[228:229], v4, s[4:7], s26 offen
  v_cvt_pk_bf16_f32 v230, v49, v65
  v_cvt_pk_bf16_f32 v231, v81, v97
  s_add_u32 s26, s86, 278528
  buffer_store_dwordx2 v[230:231], v4, s[4:7], s26 offen
  v_cvt_pk_bf16_f32 v232, v50, v66
  v_cvt_pk_bf16_f32 v233, v82, v98
  s_add_u32 s26, s86, 294912
  buffer_store_dwordx2 v[232:233], v4, s[4:7], s26 offen
  v_cvt_pk_bf16_f32 v234, v51, v67
  v_cvt_pk_bf16_f32 v235, v83, v99
  s_add_u32 s26, s86, 311296
  buffer_store_dwordx2 v[234:235], v4, s[4:7], s26 offen
  v_cvt_pk_bf16_f32 v236, v52, v68
  v_cvt_pk_bf16_f32 v237, v84, v100
  s_add_u32 s26, s86, 393216
  buffer_store_dwordx2 v[236:237], v4, s[4:7], s26 offen
  v_cvt_pk_bf16_f32 v238, v53, v69
  v_cvt_pk_bf16_f32 v239, v85, v101
  s_add_u32 s26, s86, 409600
  buffer_store_dwordx2 v[238:239], v4, s[4:7], s26 offen
  v_cvt_pk_bf16_f32 v240, v54, v70
  v_cvt_pk_bf16_f32 v241, v86, v102
  s_add_u32 s26, s86, 425984
  buffer_store_dwordx2 v[240:241], v4, s[4:7], s26 offen
  v_cvt_pk_bf16_f32 v242, v55, v71
  v_cvt_pk_bf16_f32 v243, v87, v103
  s_add_u32 s26, s86, 442368
  buffer_store_dwordx2 v[242:243], v4, s[4:7], s26 offen
  s_waitcnt vmcnt(16)
  s_branch o_we_99
o_wr1_97:
  s_and_b32 s26, s65, 49152
  s_cbranch_scc1 o_wr2_98
  ds_read_b128 v[104:107], v3 offset:0
  ds_read_b128 v[108:111], v3 offset:512
  ds_read_b128 v[112:115], v3 offset:1024
  s_waitcnt lgkmcnt(2)
  v_mfma_f32_32x32x16_bf16 v[40:55], v[104:107], a[0:3], 0
  s_and_b32 s91, s65, 63
  s_lshl_b32 s90, s91, 5
  s_add_u32 s90, s90, s43
  s_lshl_b32 s91, s90, 10
  buffer_load_dwordx4 v[184:187], v0, s[72:75], s91 offen
  v_mfma_f32_32x32x16_bf16 v[56:71], v[104:107], a[4:7], 0
  ds_read_b128 v[116:119], v3 offset:1536
  s_mov_b64 exec, 1
  buffer_store_dword v38, off, s[4:7], s84 sc1
  s_mov_b64 exec, -1
  s_waitcnt vmcnt(14)
  v_mfma_f32_16x16x32_bf16 v[188:191], v[16:19], v[120:123], 0
  v_mfma_f32_32x32x16_bf16 v[72:87], v[104:107], a[8:11], 0
  s_bfe_u32 s26, s64, 131092
  s_and_b32 s87, s64, 0xff
  s_bfe_u32 s88, s64, 0x80008
  v_cmp_eq_u32 vcc, 0, v37
  s_cmp_eq_u64 vcc, 0
  s_cselect_b32 s66, s26, 0
  s_cmp_eq_u32 s66, 1
  s_cselect_b32 s87, s87, 1024
  s_cselect_b32 s34, 0, 0x20000
  v_mfma_f32_32x32x16_bf16 v[88:103], v[104:107], a[12:15], 0
  s_cmp_eq_u32 s26, 3
  s_cselect_b32 s66, 1, s66
  v_cmp_eq_u32 vcc, 0, v245
  s_cmp_eq_u64 vcc, 0
  s_cselect_b32 s76, s26, 0
  s_and_b32 s76, s76, 1
  s_cselect_b32 s88, s88, 1024
  s_waitcnt lgkmcnt(2)
  v_mfma_f32_32x32x16_bf16 v[40:55], v[108:111], a[16:19], v[40:55]
  s_lshl_b32 s32, s88, 18
  s_mov_b32 m0, s40
  s_add_u32 s32, s32, s21
  v_mfma_f32_16x16x32_bf16 v[192:195], v[16:19], v[124:127], 0
  v_mfma_f32_16x16x32_bf16 v[188:191], v[20:23], v[128:131], v[188:191]
  v_mfma_f32_32x32x16_bf16 v[56:71], v[108:111], a[20:23], v[56:71]
  ds_read_b128 v[104:107], v3 offset:2048
  buffer_load_dwordx4 v0, s[4:7], s32 offen offset:0 sc1 lds
  v_mfma_f32_16x16x32_bf16 v[192:195], v[20:23], v[132:135], v[192:195]
  v_mfma_f32_32x32x16_bf16 v[72:87], v[108:111], a[24:27], v[72:87]
  s_waitcnt vmcnt(11)
  v_mfma_f32_16x16x32_bf16 v[188:191], v[16:19], v[136:139], v[188:191]
  v_mfma_f32_16x16x32_bf16 v[192:195], v[16:19], v[140:143], v[192:195]
  v_mfma_f32_16x16x32_bf16 v[188:191], v[20:23], v[144:147], v[188:191]
  v_mfma_f32_32x32x16_bf16 v[88:103], v[108:111], a[28:31], v[88:103]
  buffer_load_dwordx4 v0, s[4:7], s32 offen offset:1024 sc1 lds
  v_mfma_f32_16x16x32_bf16 v[192:195], v[20:23], v[148:151], v[192:195]
  s_waitcnt lgkmcnt(2)
  v_mfma_f32_32x32x16_bf16 v[40:55], v[112:115], a[32:35], v[40:55]
  s_waitcnt vmcnt(8)
  v_mfma_f32_16x16x32_bf16 v[188:191], v[16:19], v[152:155], v[188:191]
  v_mfma_f32_16x16x32_bf16 v[192:195], v[16:19], v[156:159], v[192:195]
  v_mfma_f32_16x16x32_bf16 v[188:191], v[20:23], v[160:163], v[188:191]
  v_mfma_f32_32x32x16_bf16 v[56:71], v[112:115], a[36:39], v[56:71]
  ds_read_b128 v[108:111], v3 offset:2560
  buffer_load_dwordx4 v0, s[4:7], s32 offen offset:2048 sc1 lds
  s_lshl_b32 s33, s87, 18
  s_lshl_b32 s32, s87, 19
  v_mfma_f32_32x32x16_bf16 v[72:87], v[112:115], a[40:43], v[72:87]
  s_add_u32 m0, s22, s34
  s_add_u32 s33, s33, s19
  v_mfma_f32_16x16x32_bf16 v[192:195], v[20:23], v[164:167], v[192:195]
  s_waitcnt vmcnt(5)
  v_mfma_f32_16x16x32_bf16 v[188:191], v[16:19], v[168:171], v[188:191]
  v_mfma_f32_32x32x16_bf16 v[88:103], v[112:115], a[44:47], v[88:103]
  buffer_load_dwordx4 v0, s[4:7], s33 offen offset:0 sc1 lds
  v_mfma_f32_16x16x32_bf16 v[192:195], v[16:19], v[172:175], v[192:195]
  s_waitcnt lgkmcnt(2)
  v_mfma_f32_32x32x16_bf16 v[40:55], v[116:119], a[48:51], v[40:55]
  v_mfma_f32_16x16x32_bf16 v[188:191], v[20:23], v[176:179], v[188:191]
  v_mfma_f32_16x16x32_bf16 v[192:195], v[20:23], v[180:183], v[192:195]
  s_bfe_u32 s92, s65, 131086
  s_lshl_b32 s92, s92, 21
  v_mfma_f32_32x32x16_bf16 v[56:71], v[116:119], a[52:55], v[56:71]
  ds_read_b128 v[112:115], v3 offset:3072
  buffer_load_dwordx4 v0, s[4:7], s33 offen offset:1024 sc1 lds
  s_add_u32 s92, s92, s91
  s_add_u32 s93, s92, 27262976
  v_mfma_f32_32x32x16_bf16 v[72:87], v[116:119], a[56:59], v[72:87]
  s_add_u32 s92, s92, 20971520
  s_waitcnt vmcnt(6)
  v_lshlrev_b32 v196, 16, v184
  v_and_b32 v197, 0xffff0000, v184
  v_lshlrev_b32 v198, 16, v185
  v_and_b32 v199, 0xffff0000, v185
  v_mfma_f32_32x32x16_bf16 v[88:103], v[116:119], a[60:63], v[88:103]
  buffer_load_dwordx4 v0, s[4:7], s33 offen offset:2048 sc1 lds
  v_lshlrev_b32 v200, 16, v186
  v_and_b32 v201, 0xffff0000, v186
  s_waitcnt lgkmcnt(2)
  v_mfma_f32_32x32x16_bf16 v[40:55], v[104:107], a[64:67], v[40:55]
  v_lshlrev_b32 v202, 16, v187
  v_and_b32 v203, 0xffff0000, v187
  v_permlane16_swap_b32 v188, v192
  v_permlane16_swap_b32 v189, v193
  v_mfma_f32_32x32x16_bf16 v[56:71], v[104:107], a[68:71], v[56:71]
  ds_read_b128 v[116:119], v3 offset:3584
  buffer_load_dwordx4 v0, s[4:7], s33 offen offset:3072 sc1 lds
  s_add_u32 m0, s23, s34
  s_add_u32 s32, s32, s18
  v_mfma_f32_32x32x16_bf16 v[72:87], v[104:107], a[72:75], v[72:87]
  v_permlane16_swap_b32 v190, v194
  v_permlane16_swap_b32 v191, v195
  v_cvt_pk_bf16_f32 v188, 0, v188
  v_cvt_pk_bf16_f32 v189, 0, v189
  v_mfma_f32_32x32x16_bf16 v[88:103], v[104:107], a[76:79], v[88:103]
  buffer_load_dwordx4 v0, s[4:7], s32 offen offset:0 sc1 lds
  v_cvt_pk_bf16_f32 v190, 0, v190
  v_cvt_pk_bf16_f32 v191, 0, v191
  s_waitcnt lgkmcnt(2)
  v_mfma_f32_32x32x16_bf16 v[40:55], v[108:111], a[80:83], v[40:55]
  v_cvt_pk_bf16_f32 v192, 0, v192
  v_cvt_pk_bf16_f32 v193, 0, v193
  v_cvt_pk_bf16_f32 v194, 0, v194
  v_cvt_pk_bf16_f32 v195, 0, v195
  v_add_f32 v196, v196, v188
  v_add_f32 v197, v197, v189
  v_mfma_f32_32x32x16_bf16 v[56:71], v[108:111], a[84:87], v[56:71]
  ds_read_b128 v[104:107], v3 offset:8192
  buffer_load_dwordx4 v0, s[4:7], s32 offen offset:1024 sc1 lds
  v_add_f32 v198, v198, v190
  v_add_f32 v199, v199, v191
  v_mfma_f32_32x32x16_bf16 v[72:87], v[108:111], a[88:91], v[72:87]
  v_add_f32 v200, v200, v192
  v_add_f32 v201, v201, v193
  v_add_f32 v202, v202, v194
  v_add_f32 v203, v203, v195
  v_cvt_pk_bf16_f32 v120, v196, v197
  v_cvt_pk_bf16_f32 v121, v198, v199
  v_mfma_f32_32x32x16_bf16 v[88:103], v[108:111], a[92:95], v[88:103]
  buffer_load_dwordx4 v0, s[4:7], s32 offen offset:2048 sc1 lds
  v_cvt_pk_bf16_f32 v122, v200, v201
  v_cvt_pk_bf16_f32 v123, v202, v203
  s_waitcnt lgkmcnt(2)
  v_mfma_f32_32x32x16_bf16 v[40:55], v[112:115], a[96:99], v[40:55]
  v_lshlrev_b32 v196, 16, v120
  v_and_b32 v197, 0xffff0000, v120
  v_lshlrev_b32 v198, 16, v121
  v_and_b32 v199, 0xffff0000, v121
  v_lshlrev_b32 v200, 16, v122
  v_and_b32 v201, 0xffff0000, v122
  v_mfma_f32_32x32x16_bf16 v[56:71], v[112:115], a[100:103], v[56:71]
  ds_read_b128 v[108:111], v3 offset:8704
  buffer_load_dwordx4 v0, s[4:7], s32 offen offset:3072 sc1 lds
  s_add_u32 m0, m0, 4096
  s_add_u32 s32, s32, 4096
  v_mfma_f32_32x32x16_bf16 v[72:87], v[112:115], a[104:107], v[72:87]
  v_lshlrev_b32 v202, 16, v123
  v_and_b32 v203, 0xffff0000, v123
  buffer_store_dwordx4 v[120:123], v0, s[4:7], s92 offen sc1
  v_add_f32 v136, v196, v197
  v_mfma_f32_32x32x16_bf16 v[88:103], v[112:115], a[108:111], v[88:103]
  buffer_load_dwordx4 v0, s[4:7], s32 offen offset:0 sc1 lds
  v_mul_f32 v137, v196, v196
  v_add_f32 v138, v198, v199
  s_waitcnt lgkmcnt(2)
  v_mfma_f32_32x32x16_bf16 v[40:55], v[116:119], a[112:115], v[40:55]
  v_mul_f32 v139, v197, v197
  v_fmac_f32 v137, v198, v198
  v_fmac_f32 v139, v199, v199
  v_add_f32 v136, v136, v200
  v_fmac_f32 v137, v200, v200
  v_add_f32 v138, v138, v201
  v_mfma_f32_32x32x16_bf16 v[56:71], v[116:119], a[116:119], v[56:71]
  ds_read_b128 v[112:115], v3 offset:9216
  buffer_load_dwordx4 v0, s[4:7], s32 offen offset:1024 sc1 lds
  v_fmac_f32 v139, v201, v201
  v_add_f32 v136, v136, v202
  v_mfma_f32_32x32x16_bf16 v[72:87], v[116:119], a[120:123], v[72:87]
  v_fmac_f32 v137, v202, v202
  v_add_f32 v138, v138, v203
  v_fmac_f32 v139, v203, v203
  v_add_f32 v136, v136, v138
  v_add_f32 v137, v137, v139
  s_nop 0
  v_add_f32_dpp v136, v136, v136 row_ror:8 row_mask:0xf bank_mask:0xf
  v_mfma_f32_32x32x16_bf16 v[88:103], v[116:119], a[124:127], v[88:103]
  buffer_load_dwordx4 v0, s[4:7], s32 offen offset:2048 sc1 lds
  v_add_f32_dpp v137, v137, v137 row_ror:8 row_mask:0xf bank_mask:0xf
  v_add_f32_dpp v136, v136, v136 row_ror:4 row_mask:0xf bank_mask:0xf
  s_waitcnt lgkmcnt(2)
  v_mfma_f32_32x32x16_bf16 v[40:55], v[104:107], a[128:131], v[40:55]
  v_add_f32_dpp v137, v137, v137 row_ror:4 row_mask:0xf bank_mask:0xf
  v_add_f32_dpp v136, v136, v136 row_ror:2 row_mask:0xf bank_mask:0xf
  s_nop 0
  v_add_f32_dpp v137, v137, v137 row_ror:2 row_mask:0xf bank_mask:0xf
  v_add_f32_dpp v136, v136, v136 row_ror:1 row_mask:0xf bank_mask:0xf
  s_nop 0
  v_add_f32_dpp v137, v137, v137 row_ror:1 row_mask:0xf bank_mask:0xf
  v_mov_b32 v140, v136
  v_mfma_f32_32x32x16_bf16 v[56:71], v[104:107], a[132:135], v[56:71]
  ds_read_b128 v[116:119], v3 offset:9728
  buffer_load_dwordx4 v0, s[4:7], s32 offen offset:3072 sc1 lds
  s_lshl_b32 s26, s76, 1
  s_or_b32 s26, s26, s66
  v_mfma_f32_32x32x16_bf16 v[72:87], v[104:107], a[136:139], v[72:87]
  v_mov_b32 v37, s26
  ds_write_b32 v39, v37
  v_mov_b32 v141, v137
  v_permlane16_swap_b32 v136, v140
  v_mfma_f32_32x32x16_bf16 v[88:103], v[104:107], a[140:143], v[88:103]
  v_permlane16_swap_b32 v137, v141
  v_add_f32 v136, v136, v140
  v_add_f32 v137, v137, v141
  v_mov_b32 v140, v136
  s_waitcnt lgkmcnt(3)
  v_mfma_f32_32x32x16_bf16 v[40:55], v[108:111], a[144:147], v[40:55]
  v_mov_b32 v141, v137
  v_permlane32_swap_b32 v136, v140
  s_nop 0
  v_permlane32_swap_b32 v137, v141
  v_add_f32 v136, v136, v140
  v_mfma_f32_32x32x16_bf16 v[56:71], v[108:111], a[148:151], v[56:71]
  ds_read_b128 v[104:107], v3 offset:10240
  v_add_f32 v137, v137, v141
  v_mul_f32 v136, 0x3b000000, v136
  v_mul_f32 v137, 0x3b000000, v137
  v_fma_f32 v137, -v136, v136, v137
  v_cvt_pk_bf16_f32 v136, 0, v136
  v_mfma_f32_32x32x16_bf16 v[72:87], v[108:111], a[152:155], v[72:87]
  v_max_f32 v137, 0, v137
  v_sub_f32 v140, v196, v136
  v_sub_f32 v141, v197, v136
  v_cvt_pk_bf16_f32 v137, 0, v137
  v_sub_f32 v142, v198, v136
  v_sub_f32 v143, v199, v136
  v_mfma_f32_32x32x16_bf16 v[88:103], v[108:111], a[156:159], v[88:103]
  v_add_f32 v137, 0x3727c5ac, v137
  v_sub_f32 v144, v200, v136
  v_sub_f32 v145, v201, v136
  v_cvt_pk_bf16_f32 v137, 0, v137
  v_sub_f32 v146, v202, v136
  s_waitcnt lgkmcnt(3)
  v_mfma_f32_32x32x16_bf16 v[40:55], v[112:115], a[160:163], v[40:55]
  v_sub_f32 v147, v203, v136
  v_sqrt_f32 v137, v137
  v_cvt_pk_bf16_f32 v140, 0, v140
  v_cvt_pk_bf16_f32 v141, 0, v141
  v_cvt_pk_bf16_f32 v137, 0, v137
  v_mfma_f32_32x32x16_bf16 v[56:71], v[112:115], a[164:167], v[56:71]
  ds_read_b128 v[108:111], v3 offset:10752
  v_cvt_pk_bf16_f32 v142, 0, v142
  v_cvt_pk_bf16_f32 v143, 0, v143
  v_rcp_f32 v137, v137
  v_cvt_pk_bf16_f32 v144, 0, v144
  v_mfma_f32_32x32x16_bf16 v[72:87], v[112:115], a[168:171], v[72:87]
  v_cvt_pk_bf16_f32 v145, 0, v145
  v_cvt_pk_bf16_f32 v146, 0, v146
  v_cvt_pk_bf16_f32 v147, 0, v147
  v_mul_f32 v140, v140, v137
  v_mul_f32 v141, v141, v137
  v_mul_f32 v142, v142, v137
  v_mfma_f32_32x32x16_bf16 v[88:103], v[112:115], a[172:175], v[88:103]
  v_mul_f32 v143, v143, v137
  v_mul_f32 v144, v144, v137
  v_mul_f32 v145, v145, v137
  v_mul_f32 v146, v146, v137
  v_mul_f32 v147, v147, v137
  s_waitcnt lgkmcnt(3)
  v_mfma_f32_32x32x16_bf16 v[40:55], v[116:119], a[176:179], v[40:55]
  v_cvt_pk_bf16_f32 v124, v140, v141
  v_cvt_pk_bf16_f32 v125, v142, v143
  v_cvt_pk_bf16_f32 v126, v144, v145
  v_cvt_pk_bf16_f32 v127, v146, v147
  v_lshlrev_b32 v204, 16, v124
  v_and_b32 v205, 0xffff0000, v124
  v_mfma_f32_32x32x16_bf16 v[56:71], v[116:119], a[180:183], v[56:71]
  ds_read_b128 v[112:115], v3 offset:11264
  v_lshlrev_b32 v206, 16, v125
  v_and_b32 v207, 0xffff0000, v125
  v_lshlrev_b32 v208, 16, v126
  v_and_b32 v209, 0xffff0000, v126
  v_lshlrev_b32 v210, 16, v127
  v_mfma_f32_32x32x16_bf16 v[72:87], v[116:119], a[184:187], v[72:87]
  v_and_b32 v211, 0xffff0000, v127
  buffer_store_dwordx4 v[124:127], v0, s[4:7], s93 offen sc1
  v_add_f32 v196, v196, v204
  v_add_f32 v197, v197, v205
  v_mfma_f32_32x32x16_bf16 v[88:103], v[116:119], a[188:191], v[88:103]
  v_add_f32 v198, v198, v206
  v_add_f32 v199, v199, v207
  v_add_f32 v200, v200, v208
  v_add_f32 v201, v201, v209
  v_add_f32 v202, v202, v210
  s_waitcnt lgkmcnt(2)
  v_mfma_f32_32x32x16_bf16 v[40:55], v[104:107], a[192:195], v[40:55]
  v_add_f32 v203, v203, v211
  v_cvt_pk_bf16_f32 v128, v196, v197
  v_cvt_pk_bf16_f32 v129, v198, v199
  v_cvt_pk_bf16_f32 v130, v200, v201
  v_cvt_pk_bf16_f32 v131, v202, v203
  v_mul_f32 v188, v204, v8
  v_mfma_f32_32x32x16_bf16 v[56:71], v[104:107], a[196:199], v[56:71]
  ds_read_b128 v[116:119], v3 offset:11776
  v_mul_f32 v189, v205, v9
  v_fmac_f32 v188, v206, v10
  v_fmac_f32 v189, v207, v11
  v_fmac_f32 v188, v208, v12
  v_fmac_f32 v189, v209, v13
  v_mfma_f32_32x32x16_bf16 v[72:87], v[104:107], a[200:203], v[72:87]
  v_fmac_f32 v188, v210, v14
  v_fmac_f32 v189, v211, v15
  v_add_f32 v188, v188, v189
  s_add_u32 s92, s91, 10485760
  s_add_u32 s93, s91, 8388608
  buffer_store_dwordx4 v[128:131], v0, s[4:7], s92 offen sc1
  v_mfma_f32_32x32x16_bf16 v[88:103], v[104:107], a[204:207], v[88:103]
  v_lshlrev_b32 v196, 16, v128
  v_and_b32 v197, 0xffff0000, v128
  v_lshlrev_b32 v198, 16, v129
  v_and_b32 v199, 0xffff0000, v129
  v_lshlrev_b32 v200, 16, v130
  s_waitcnt lgkmcnt(2)
  v_mfma_f32_32x32x16_bf16 v[40:55], v[108:111], a[208:211], v[40:55]
  v_and_b32 v201, 0xffff0000, v130
  v_lshlrev_b32 v202, 16, v131
  v_and_b32 v203, 0xffff0000, v131
  v_add_f32 v136, v196, v197
  v_mul_f32 v137, v196, v196
  v_add_f32 v138, v198, v199
  v_mfma_f32_32x32x16_bf16 v[56:71], v[108:111], a[212:215], v[56:71]
  v_mul_f32 v139, v197, v197
  v_fmac_f32 v137, v198, v198
  v_fmac_f32 v139, v199, v199
  v_add_f32 v136, v136, v200
  v_fmac_f32 v137, v200, v200
  v_add_f32 v138, v138, v201
  v_mfma_f32_32x32x16_bf16 v[72:87], v[108:111], a[216:219], v[72:87]
  v_fmac_f32 v139, v201, v201
  v_add_f32 v136, v136, v202
  v_fmac_f32 v137, v202, v202
  v_add_f32 v138, v138, v203
  v_fmac_f32 v139, v203, v203
  v_add_f32 v136, v136, v138
  v_mfma_f32_32x32x16_bf16 v[88:103], v[108:111], a[220:223], v[88:103]
  v_add_f32 v137, v137, v139
  v_add_f32_dpp v136, v136, v136 row_ror:8 row_mask:0xf bank_mask:0xf
  s_nop 0
  v_add_f32_dpp v137, v137, v137 row_ror:8 row_mask:0xf bank_mask:0xf
  v_add_f32_dpp v188, v188, v188 row_ror:8 row_mask:0xf bank_mask:0xf
  v_add_f32_dpp v136, v136, v136 row_ror:4 row_mask:0xf bank_mask:0xf
  s_waitcnt lgkmcnt(1)
  v_mfma_f32_32x32x16_bf16 v[40:55], v[112:115], a[224:227], v[40:55]
  v_add_f32_dpp v137, v137, v137 row_ror:4 row_mask:0xf bank_mask:0xf
  v_add_f32_dpp v188, v188, v188 row_ror:4 row_mask:0xf bank_mask:0xf
  v_add_f32_dpp v136, v136, v136 row_ror:2 row_mask:0xf bank_mask:0xf
  v_add_f32_dpp v137, v137, v137 row_ror:2 row_mask:0xf bank_mask:0xf
  v_add_f32_dpp v188, v188, v188 row_ror:2 row_mask:0xf bank_mask:0xf
  v_add_f32_dpp v136, v136, v136 row_ror:1 row_mask:0xf bank_mask:0xf
  v_mfma_f32_32x32x16_bf16 v[56:71], v[112:115], a[228:231], v[56:71]
  v_add_f32_dpp v137, v137, v137 row_ror:1 row_mask:0xf bank_mask:0xf
  v_add_f32_dpp v188, v188, v188 row_ror:1 row_mask:0xf bank_mask:0xf
  v_mov_b32 v140, v136
  v_mov_b32 v141, v137
  v_mov_b32 v142, v188
  v_permlane16_swap_b32 v136, v140
  v_mfma_f32_32x32x16_bf16 v[72:87], v[112:115], a[232:235], v[72:87]
  v_permlane16_swap_b32 v137, v141
  v_permlane16_swap_b32 v188, v142
  v_add_f32 v136, v136, v140
  v_add_f32 v137, v137, v141
  v_mfma_f32_32x32x16_bf16 v[88:103], v[112:115], a[236:239], v[88:103]
  v_add_f32 v188, v188, v142
  v_mov_b32 v140, v136
  v_mov_b32 v141, v137
  v_mov_b32 v142, v188
  v_permlane32_swap_b32 v136, v140
  s_waitcnt lgkmcnt(0)
  v_mfma_f32_32x32x16_bf16 v[40:55], v[116:119], a[240:243], v[40:55]
  v_permlane32_swap_b32 v137, v141
  v_permlane32_swap_b32 v188, v142
  v_add_f32 v136, v136, v140
  v_add_f32 v137, v137, v141
  v_mfma_f32_32x32x16_bf16 v[56:71], v[116:119], a[244:247], v[56:71]
  v_add_f32 v188, v188, v142
  v_mul_f32 v136, 0x3b000000, v136
  v_mul_f32 v137, 0x3b000000, v137
  v_fma_f32 v137, -v136, v136, v137
  v_cvt_pk_bf16_f32 v136, 0, v136
  v_max_f32 v137, 0, v137
  v_mfma_f32_32x32x16_bf16 v[72:87], v[116:119], a[248:251], v[72:87]
  v_sub_f32 v140, v196, v136
  v_sub_f32 v141, v197, v136
  v_cvt_pk_bf16_f32 v137, 0, v137
  v_sub_f32 v142, v198, v136
  v_sub_f32 v143, v199, v136
  v_add_f32 v137, 0x3727c5ac, v137
  v_mfma_f32_32x32x16_bf16 v[88:103], v[116:119], a[252:255], v[88:103]
  v_sub_f32 v144, v200, v136
  v_sub_f32 v145, v201, v136
  v_cvt_pk_bf16_f32 v137, 0, v137
  v_sub_f32 v146, v202, v136
  v_sub_f32 v147, v203, v136
  v_sqrt_f32 v137, v137
  v_cvt_pk_bf16_f32 v140, 0, v140
  v_cvt_pk_bf16_f32 v141, 0, v141
  v_cvt_pk_bf16_f32 v137, 0, v137
  v_cvt_pk_bf16_f32 v142, 0, v142
  v_cvt_pk_bf16_f32 v143, 0, v143
  v_rcp_f32 v137, v137
  v_cvt_pk_bf16_f32 v144, 0, v144
  v_cvt_pk_bf16_f32 v145, 0, v145
  v_cvt_pk_bf16_f32 v146, 0, v146
  v_cvt_pk_bf16_f32 v147, 0, v147
  v_mul_f32 v140, v140, v137
  v_mul_f32 v141, v141, v137
  v_mul_f32 v142, v142, v137
  v_mul_f32 v143, v143, v137
  v_mul_f32 v144, v144, v137
  v_mul_f32 v145, v145, v137
  v_mul_f32 v146, v146, v137
  v_mul_f32 v147, v147, v137
  v_cvt_pk_bf16_f32 v132, v140, v141
  v_cvt_pk_bf16_f32 v133, v142, v143
  v_cvt_pk_bf16_f32 v134, v144, v145
  v_cvt_pk_bf16_f32 v135, v146, v147
  buffer_store_dwordx4 v[132:135], v0, s[4:7], s93 offen sc1
  v_cvt_pk_bf16_f32 v188, 0, v188
  v_ashrrev_i32 v189, 31, v188
  v_or_b32 v189, 0x80000000, v189
  v_xor_b32 v188, v188, v189
  s_sub_u32 s92, 4095, s90
  v_and_b32 v188, 0xffff0000, v188
  v_or_b32 v38, s92, v188
  s_bfe_u32 s92, s65, 196625
  s_lshl_b32 s92, s92, 16
  s_lshl_b32 s93, s90, 5
  s_add_u32 s92, s92, s93
  s_add_u32 s84, s92, 243269632
  v_cvt_pk_bf16_f32 v212, v40, v56
  v_cvt_pk_bf16_f32 v213, v72, v88
  s_add_u32 s26, s86, 0
  buffer_store_dwordx2 v[212:213], v4, s[4:7], s26 offen
  v_cvt_pk_bf16_f32 v214, v41, v57
  v_cvt_pk_bf16_f32 v215, v73, v89
  s_add_u32 s26, s86, 16384
  buffer_store_dwordx2 v[214:215], v4, s[4:7], s26 offen
  v_cvt_pk_bf16_f32 v216, v42, v58
  v_cvt_pk_bf16_f32 v217, v74, v90
  s_add_u32 s26, s86, 32768
  buffer_store_dwordx2 v[216:217], v4, s[4:7], s26 offen
  v_cvt_pk_bf16_f32 v218, v43, v59
  v_cvt_pk_bf16_f32 v219, v75, v91
  s_add_u32 s26, s86, 49152
  buffer_store_dwordx2 v[218:219], v4, s[4:7], s26 offen
  v_cvt_pk_bf16_f32 v220, v44, v60
  v_cvt_pk_bf16_f32 v221, v76, v92
  s_add_u32 s26, s86, 131072
  buffer_store_dwordx2 v[220:221], v4, s[4:7], s26 offen
  v_cvt_pk_bf16_f32 v222, v45, v61
  v_cvt_pk_bf16_f32 v223, v77, v93
  s_add_u32 s26, s86, 147456
  buffer_store_dwordx2 v[222:223], v4, s[4:7], s26 offen
  v_cvt_pk_bf16_f32 v224, v46, v62
  v_cvt_pk_bf16_f32 v225, v78, v94
  s_add_u32 s26, s86, 163840
  buffer_store_dwordx2 v[224:225], v4, s[4:7], s26 offen
  v_cvt_pk_bf16_f32 v226, v47, v63
  v_cvt_pk_bf16_f32 v227, v79, v95
  s_add_u32 s26, s86, 180224
  buffer_store_dwordx2 v[226:227], v4, s[4:7], s26 offen
  v_cvt_pk_bf16_f32 v228, v48, v64
  v_cvt_pk_bf16_f32 v229, v80, v96
  s_add_u32 s26, s86, 262144
  buffer_store_dwordx2 v[228:229], v4, s[4:7], s26 offen
  v_cvt_pk_bf16_f32 v230, v49, v65
  v_cvt_pk_bf16_f32 v231, v81, v97
  s_add_u32 s26, s86, 278528
  buffer_store_dwordx2 v[230:231], v4, s[4:7], s26 offen
  v_cvt_pk_bf16_f32 v232, v50, v66
  v_cvt_pk_bf16_f32 v233, v82, v98
  s_add_u32 s26, s86, 294912
  buffer_store_dwordx2 v[232:233], v4, s[4:7], s26 offen
  v_cvt_pk_bf16_f32 v234, v51, v67
  v_cvt_pk_bf16_f32 v235, v83, v99
  s_add_u32 s26, s86, 311296
  buffer_store_dwordx2 v[234:235], v4, s[4:7], s26 offen
  v_cvt_pk_bf16_f32 v236, v52, v68
  v_cvt_pk_bf16_f32 v237, v84, v100
  s_add_u32 s26, s86, 393216
  buffer_store_dwordx2 v[236:237], v4, s[4:7], s26 offen
  v_cvt_pk_bf16_f32 v238, v53, v69
  v_cvt_pk_bf16_f32 v239, v85, v101
  s_add_u32 s26, s86, 409600
  buffer_store_dwordx2 v[238:239], v4, s[4:7], s26 offen
  v_cvt_pk_bf16_f32 v240, v54, v70
  v_cvt_pk_bf16_f32 v241, v86, v102
  s_add_u32 s26, s86, 425984
  buffer_store_dwordx2 v[240:241], v4, s[4:7], s26 offen
  v_cvt_pk_bf16_f32 v242, v55, v71
  v_cvt_pk_bf16_f32 v243, v87, v103
  s_add_u32 s26, s86, 442368
  buffer_store_dwordx2 v[242:243], v4, s[4:7], s26 offen
  s_waitcnt vmcnt(16)
  s_mov_b64 exec, 1
  buffer_store_dword v38, off, s[4:7], s84 sc1
  s_mov_b64 exec, -1
  s_mov_b32 s84, 268435456
  s_branch o_we_99
o_fb_94:
  v_mov_b32 v118, v116
  s_nop 1
  v_permlane16_swap_b32 v116, v118
  v_max_f32 v116, v116, v118
  v_mov_b32 v118, v116
  s_nop 0
  s_nop 0
  v_permlane32_swap_b32 v116, v118
  v_max_f32 v116, v116, v118
  v_sub_f32 v56, v104, v116
  v_sub_f32 v57, v105, v116
  v_sub_f32 v58, v106, v116
  v_sub_f32 v59, v107, v116
  v_sub_f32 v60, v108, v116
  v_sub_f32 v61, v109, v116
  v_sub_f32 v62, v110, v116
  v_sub_f32 v63, v111, v116
  v_sub_f32 v64, v112, v116
  v_sub_f32 v65, v113, v116
  v_exp_f32 v56, v56
  v_exp_f32 v57, v57
  v_exp_f32 v58, v58
  v_exp_f32 v59, v59
  v_exp_f32 v60, v60
  v_exp_f32 v61, v61
  v_exp_f32 v62, v62
  v_exp_f32 v63, v63
  v_exp_f32 v64, v64
  v_exp_f32 v65, v65
  v_add_f32 v117, v56, v57
  v_add_f32 v117, v117, v58
  v_add_f32 v117, v117, v59
  v_add_f32 v117, v117, v60
  v_add_f32 v117, v117, v61
  v_add_f32 v117, v117, v62
  v_add_f32 v117, v117, v63
  v_add_f32 v117, v117, v64
  v_add_f32 v117, v117, v65
  v_mov_b32 v118, v117
  s_nop 0
  s_nop 0
  v_permlane16_swap_b32 v117, v118
  v_add_f32 v117, v117, v118
  v_mov_b32 v118, v117
  s_nop 0
  s_nop 0
  v_permlane32_swap_b32 v117, v118
  v_add_f32 v117, v117, v118
  v_rcp_f32 v117, v117
  s_branch o_fbr_95
o_wr2_98:
  ds_read_b128 v[104:107], v3 offset:0
  ds_read_b128 v[108:111], v3 offset:512
  ds_read_b128 v[112:115], v3 offset:1024
  s_waitcnt lgkmcnt(2)
  v_mfma_f32_32x32x16_bf16 v[40:55], v[104:107], a[0:3], 0
  s_and_b32 s91, s65, 63
  s_lshl_b32 s90, s91, 5
  s_add_u32 s90, s90, s43
  s_lshl_b32 s94, s91, 5
  s_add_u32 s94, s94, s85
  s_lshl_b32 s94, s94, 10
  v_mfma_f32_32x32x16_bf16 v[56:71], v[104:107], a[4:7], 0
  ds_read_b128 v[116:119], v3 offset:1536
  s_lshr_b32 s92, s65, 22
  s_xor_b32 s93, s43, 32
  s_lshl_b32 s91, s90, 10
  s_add_u32 s94, s94, 25165824
  s_cmp_eq_u32 s92, s93
  s_cselect_b32 s92, s94, s91
  v_mfma_f32_32x32x16_bf16 v[72:87], v[104:107], a[8:11], 0
  s_bfe_u32 s26, s64, 131092
  s_and_b32 s87, s64, 0xff
  s_bfe_u32 s88, s64, 0x80008
  v_cmp_eq_u32 vcc, 0, v37
  s_cmp_eq_u64 vcc, 0
  s_cselect_b32 s66, s26, 0
  s_cmp_eq_u32 s66, 1
  s_cselect_b32 s87, s87, 1024
  s_cselect_b32 s34, 0, 0x20000
  v_mfma_f32_32x32x16_bf16 v[88:103], v[104:107], a[12:15], 0
  s_cmp_eq_u32 s26, 3
  s_cselect_b32 s66, 1, s66
  v_cmp_eq_u32 vcc, 0, v245
  s_cmp_eq_u64 vcc, 0
  s_cselect_b32 s76, s26, 0
  s_and_b32 s76, s76, 1
  s_cselect_b32 s88, s88, 1024
  s_waitcnt lgkmcnt(2)
  v_mfma_f32_32x32x16_bf16 v[40:55], v[108:111], a[16:19], v[40:55]
  s_lshl_b32 s32, s88, 18
  s_mov_b32 m0, s40
  s_add_u32 s32, s32, s21
  s_add_u32 s92, s92, 10485760
  buffer_load_dwordx4 v[184:187], v0, s[4:7], s92 offen sc1
  v_mfma_f32_32x32x16_bf16 v[56:71], v[108:111], a[20:23], v[56:71]
  ds_read_b128 v[104:107], v3 offset:2048
  buffer_load_dwordx4 v0, s[4:7], s32 offen offset:0 sc1 lds
  s_mov_b64 exec, 1
  buffer_store_dword v38, off, s[4:7], s84 sc1
  s_mov_b64 exec, -1
  v_mfma_f32_32x32x16_bf16 v[72:87], v[108:111], a[24:27], v[72:87]
  s_waitcnt vmcnt(15)
  v_mfma_f32_16x16x32_bf16 v[188:191], v[16:19], v[120:123], 0
  v_mfma_f32_16x16x32_bf16 v[192:195], v[16:19], v[124:127], 0
  v_mfma_f32_16x16x32_bf16 v[188:191], v[20:23], v[128:131], v[188:191]
  v_mfma_f32_32x32x16_bf16 v[88:103], v[108:111], a[28:31], v[88:103]
  buffer_load_dwordx4 v0, s[4:7], s32 offen offset:1024 sc1 lds
  v_mfma_f32_16x16x32_bf16 v[192:195], v[20:23], v[132:135], v[192:195]
  s_waitcnt lgkmcnt(2)
  v_mfma_f32_32x32x16_bf16 v[40:55], v[112:115], a[32:35], v[40:55]
  s_waitcnt vmcnt(12)
  v_mfma_f32_16x16x32_bf16 v[188:191], v[16:19], v[136:139], v[188:191]
  v_mfma_f32_16x16x32_bf16 v[192:195], v[16:19], v[140:143], v[192:195]
  v_mfma_f32_16x16x32_bf16 v[188:191], v[20:23], v[144:147], v[188:191]
  v_mfma_f32_32x32x16_bf16 v[56:71], v[112:115], a[36:39], v[56:71]
  ds_read_b128 v[108:111], v3 offset:2560
  buffer_load_dwordx4 v0, s[4:7], s32 offen offset:2048 sc1 lds
  s_lshl_b32 s33, s87, 18
  s_lshl_b32 s32, s87, 19
  v_mfma_f32_32x32x16_bf16 v[72:87], v[112:115], a[40:43], v[72:87]
  s_add_u32 m0, s22, s34
  s_add_u32 s33, s33, s19
  v_mfma_f32_16x16x32_bf16 v[192:195], v[20:23], v[148:151], v[192:195]
  s_waitcnt vmcnt(9)
  v_mfma_f32_16x16x32_bf16 v[188:191], v[16:19], v[152:155], v[188:191]
  v_mfma_f32_32x32x16_bf16 v[88:103], v[112:115], a[44:47], v[88:103]
  buffer_load_dwordx4 v0, s[4:7], s33 offen offset:0 sc1 lds
  v_mfma_f32_16x16x32_bf16 v[192:195], v[16:19], v[156:159], v[192:195]
  s_waitcnt lgkmcnt(2)
  v_mfma_f32_32x32x16_bf16 v[40:55], v[116:119], a[48:51], v[40:55]
  v_mfma_f32_16x16x32_bf16 v[188:191], v[20:23], v[160:163], v[188:191]
  v_mfma_f32_16x16x32_bf16 v[192:195], v[20:23], v[164:167], v[192:195]
  s_waitcnt vmcnt(6)
  v_mfma_f32_16x16x32_bf16 v[188:191], v[16:19], v[168:171], v[188:191]
  v_mfma_f32_32x32x16_bf16 v[56:71], v[116:119], a[52:55], v[56:71]
  ds_read_b128 v[112:115], v3 offset:3072
  buffer_load_dwordx4 v0, s[4:7], s33 offen offset:1024 sc1 lds
  v_mfma_f32_16x16x32_bf16 v[192:195], v[16:19], v[172:175], v[192:195]
  v_mfma_f32_32x32x16_bf16 v[72:87], v[116:119], a[56:59], v[72:87]
  v_mfma_f32_16x16x32_bf16 v[188:191], v[20:23], v[176:179], v[188:191]
  v_mfma_f32_16x16x32_bf16 v[192:195], v[20:23], v[180:183], v[192:195]
  s_bfe_u32 s92, s65, 131086
  s_lshl_b32 s92, s92, 21
  v_mfma_f32_32x32x16_bf16 v[88:103], v[116:119], a[60:63], v[88:103]
  buffer_load_dwordx4 v0, s[4:7], s33 offen offset:2048 sc1 lds
  s_add_u32 s92, s92, s91
  s_add_u32 s93, s92, 27262976
  s_waitcnt lgkmcnt(2)
  v_mfma_f32_32x32x16_bf16 v[40:55], v[104:107], a[64:67], v[40:55]
  s_add_u32 s92, s92, 20971520
  s_waitcnt vmcnt(7)
  v_lshlrev_b32 v196, 16, v184
  v_and_b32 v197, 0xffff0000, v184
  v_lshlrev_b32 v198, 16, v185
  v_and_b32 v199, 0xffff0000, v185
  v_mfma_f32_32x32x16_bf16 v[56:71], v[104:107], a[68:71], v[56:71]
  ds_read_b128 v[116:119], v3 offset:3584
  buffer_load_dwordx4 v0, s[4:7], s33 offen offset:3072 sc1 lds
  s_add_u32 m0, s23, s34
  s_add_u32 s32, s32, s18
  v_mfma_f32_32x32x16_bf16 v[72:87], v[104:107], a[72:75], v[72:87]
  v_lshlrev_b32 v200, 16, v186
  v_and_b32 v201, 0xffff0000, v186
  v_lshlrev_b32 v202, 16, v187
  v_and_b32 v203, 0xffff0000, v187
  v_permlane16_swap_b32 v188, v192
  v_mfma_f32_32x32x16_bf16 v[88:103], v[104:107], a[76:79], v[88:103]
  buffer_load_dwordx4 v0, s[4:7], s32 offen offset:0 sc1 lds
  v_permlane16_swap_b32 v189, v193
  s_waitcnt lgkmcnt(2)
  v_mfma_f32_32x32x16_bf16 v[40:55], v[108:111], a[80:83], v[40:55]
  v_permlane16_swap_b32 v190, v194
  v_permlane16_swap_b32 v191, v195
  v_cvt_pk_bf16_f32 v188, 0, v188
  v_cvt_pk_bf16_f32 v189, 0, v189
  v_mfma_f32_32x32x16_bf16 v[56:71], v[108:111], a[84:87], v[56:71]
  ds_read_b128 v[104:107], v3 offset:8192
  buffer_load_dwordx4 v0, s[4:7], s32 offen offset:1024 sc1 lds
  v_cvt_pk_bf16_f32 v190, 0, v190
  v_cvt_pk_bf16_f32 v191, 0, v191
  v_mfma_f32_32x32x16_bf16 v[72:87], v[108:111], a[88:91], v[72:87]
  v_cvt_pk_bf16_f32 v192, 0, v192
  v_cvt_pk_bf16_f32 v193, 0, v193
  v_cvt_pk_bf16_f32 v194, 0, v194
  v_cvt_pk_bf16_f32 v195, 0, v195
  v_add_f32 v196, v196, v188
  v_add_f32 v197, v197, v189
  v_mfma_f32_32x32x16_bf16 v[88:103], v[108:111], a[92:95], v[88:103]
  buffer_load_dwordx4 v0, s[4:7], s32 offen offset:2048 sc1 lds
  v_add_f32 v198, v198, v190
  v_add_f32 v199, v199, v191
  s_waitcnt lgkmcnt(2)
  v_mfma_f32_32x32x16_bf16 v[40:55], v[112:115], a[96:99], v[40:55]
  v_add_f32 v200, v200, v192
  v_add_f32 v201, v201, v193
  v_add_f32 v202, v202, v194
  v_add_f32 v203, v203, v195
  v_cvt_pk_bf16_f32 v120, v196, v197
  v_cvt_pk_bf16_f32 v121, v198, v199
  v_mfma_f32_32x32x16_bf16 v[56:71], v[112:115], a[100:103], v[56:71]
  ds_read_b128 v[108:111], v3 offset:8704
  buffer_load_dwordx4 v0, s[4:7], s32 offen offset:3072 sc1 lds
  s_add_u32 m0, m0, 4096
  s_add_u32 s32, s32, 4096
  v_mfma_f32_32x32x16_bf16 v[72:87], v[112:115], a[104:107], v[72:87]
  v_cvt_pk_bf16_f32 v122, v200, v201
  v_cvt_pk_bf16_f32 v123, v202, v203
  v_lshlrev_b32 v196, 16, v120
  v_and_b32 v197, 0xffff0000, v120
  v_lshlrev_b32 v198, 16, v121
  v_and_b32 v199, 0xffff0000, v121
  v_mfma_f32_32x32x16_bf16 v[88:103], v[112:115], a[108:111], v[88:103]
  buffer_load_dwordx4 v0, s[4:7], s32 offen offset:0 sc1 lds
  v_lshlrev_b32 v200, 16, v122
  v_and_b32 v201, 0xffff0000, v122
  s_waitcnt lgkmcnt(2)
  v_mfma_f32_32x32x16_bf16 v[40:55], v[116:119], a[112:115], v[40:55]
  v_lshlrev_b32 v202, 16, v123
  v_and_b32 v203, 0xffff0000, v123
  buffer_store_dwordx4 v[120:123], v0, s[4:7], s92 offen sc1
  v_add_f32 v136, v196, v197
  v_mfma_f32_32x32x16_bf16 v[56:71], v[116:119], a[116:119], v[56:71]
  ds_read_b128 v[112:115], v3 offset:9216
  buffer_load_dwordx4 v0, s[4:7], s32 offen offset:1024 sc1 lds
  v_mul_f32 v137, v196, v196
  v_add_f32 v138, v198, v199
  v_mfma_f32_32x32x16_bf16 v[72:87], v[116:119], a[120:123], v[72:87]
  v_mul_f32 v139, v197, v197
  v_fmac_f32 v137, v198, v198
  v_fmac_f32 v139, v199, v199
  v_add_f32 v136, v136, v200
  v_fmac_f32 v137, v200, v200
  v_add_f32 v138, v138, v201
  v_mfma_f32_32x32x16_bf16 v[88:103], v[116:119], a[124:127], v[88:103]
  buffer_load_dwordx4 v0, s[4:7], s32 offen offset:2048 sc1 lds
  v_fmac_f32 v139, v201, v201
  v_add_f32 v136, v136, v202
  s_waitcnt lgkmcnt(2)
  v_mfma_f32_32x32x16_bf16 v[40:55], v[104:107], a[128:131], v[40:55]
  v_fmac_f32 v137, v202, v202
  v_add_f32 v138, v138, v203
  v_fmac_f32 v139, v203, v203
  v_add_f32 v136, v136, v138
  v_add_f32 v137, v137, v139
  s_nop 0
  v_add_f32_dpp v136, v136, v136 row_ror:8 row_mask:0xf bank_mask:0xf
  v_mfma_f32_32x32x16_bf16 v[56:71], v[104:107], a[132:135], v[56:71]
  ds_read_b128 v[116:119], v3 offset:9728
  buffer_load_dwordx4 v0, s[4:7], s32 offen offset:3072 sc1 lds
  s_lshl_b32 s26, s76, 1
  s_or_b32 s26, s26, s66
  v_mfma_f32_32x32x16_bf16 v[72:87], v[104:107], a[136:139], v[72:87]
  v_mov_b32 v37, s26
  ds_write_b32 v39, v37
  v_add_f32_dpp v137, v137, v137 row_ror:8 row_mask:0xf bank_mask:0xf
  v_add_f32_dpp v136, v136, v136 row_ror:4 row_mask:0xf bank_mask:0xf
  s_nop 0
  v_add_f32_dpp v137, v137, v137 row_ror:4 row_mask:0xf bank_mask:0xf
  v_mfma_f32_32x32x16_bf16 v[88:103], v[104:107], a[140:143], v[88:103]
  v_add_f32_dpp v136, v136, v136 row_ror:2 row_mask:0xf bank_mask:0xf
  v_add_f32_dpp v137, v137, v137 row_ror:2 row_mask:0xf bank_mask:0xf
  s_nop 0
  v_add_f32_dpp v136, v136, v136 row_ror:1 row_mask:0xf bank_mask:0xf
  v_add_f32_dpp v137, v137, v137 row_ror:1 row_mask:0xf bank_mask:0xf
  v_mov_b32 v140, v136
  s_waitcnt lgkmcnt(3)
  v_mfma_f32_32x32x16_bf16 v[40:55], v[108:111], a[144:147], v[40:55]
  v_mov_b32 v141, v137
  v_permlane16_swap_b32 v136, v140
  s_nop 0
  v_permlane16_swap_b32 v137, v141
  v_add_f32 v136, v136, v140
  v_mfma_f32_32x32x16_bf16 v[56:71], v[108:111], a[148:151], v[56:71]
  ds_read_b128 v[104:107], v3 offset:10240
  v_add_f32 v137, v137, v141
  v_mov_b32 v140, v136
  v_mov_b32 v141, v137
  s_nop 0
  v_permlane32_swap_b32 v136, v140
  v_mfma_f32_32x32x16_bf16 v[72:87], v[108:111], a[152:155], v[72:87]
  v_permlane32_swap_b32 v137, v141
  v_add_f32 v136, v136, v140
  v_add_f32 v137, v137, v141
  v_mul_f32 v136, 0x3b000000, v136
  v_mul_f32 v137, 0x3b000000, v137
  v_mfma_f32_32x32x16_bf16 v[88:103], v[108:111], a[156:159], v[88:103]
  v_fma_f32 v137, -v136, v136, v137
  v_cvt_pk_bf16_f32 v136, 0, v136
  v_max_f32 v137, 0, v137
  v_sub_f32 v140, v196, v136
  v_sub_f32 v141, v197, v136
  s_waitcnt lgkmcnt(3)
  v_mfma_f32_32x32x16_bf16 v[40:55], v[112:115], a[160:163], v[40:55]
  v_cvt_pk_bf16_f32 v137, 0, v137
  v_sub_f32 v142, v198, v136
  v_sub_f32 v143, v199, v136
  v_add_f32 v137, 0x3727c5ac, v137
  v_sub_f32 v144, v200, v136
  v_sub_f32 v145, v201, v136
  v_mfma_f32_32x32x16_bf16 v[56:71], v[112:115], a[164:167], v[56:71]
  ds_read_b128 v[108:111], v3 offset:10752
  v_cvt_pk_bf16_f32 v137, 0, v137
  v_sub_f32 v146, v202, v136
  v_sub_f32 v147, v203, v136
  v_sqrt_f32 v137, v137
  v_mfma_f32_32x32x16_bf16 v[72:87], v[112:115], a[168:171], v[72:87]
  v_cvt_pk_bf16_f32 v140, 0, v140
  v_cvt_pk_bf16_f32 v141, 0, v141
  v_cvt_pk_bf16_f32 v137, 0, v137
  v_cvt_pk_bf16_f32 v142, 0, v142
  v_cvt_pk_bf16_f32 v143, 0, v143
  v_rcp_f32 v137, v137
  v_mfma_f32_32x32x16_bf16 v[88:103], v[112:115], a[172:175], v[88:103]
  v_cvt_pk_bf16_f32 v144, 0, v144
  v_cvt_pk_bf16_f32 v145, 0, v145
  v_cvt_pk_bf16_f32 v146, 0, v146
  v_cvt_pk_bf16_f32 v147, 0, v147
  v_mul_f32 v140, v140, v137
  s_waitcnt lgkmcnt(3)
  v_mfma_f32_32x32x16_bf16 v[40:55], v[116:119], a[176:179], v[40:55]
  v_mul_f32 v141, v141, v137
  v_mul_f32 v142, v142, v137
  v_mul_f32 v143, v143, v137
  v_mul_f32 v144, v144, v137
  v_mul_f32 v145, v145, v137
  v_mul_f32 v146, v146, v137
  v_mfma_f32_32x32x16_bf16 v[56:71], v[116:119], a[180:183], v[56:71]
  ds_read_b128 v[112:115], v3 offset:11264
  v_mul_f32 v147, v147, v137
  v_cvt_pk_bf16_f32 v124, v140, v141
  v_cvt_pk_bf16_f32 v125, v142, v143
  v_cvt_pk_bf16_f32 v126, v144, v145
  v_cvt_pk_bf16_f32 v127, v146, v147
  v_mfma_f32_32x32x16_bf16 v[72:87], v[116:119], a[184:187], v[72:87]
  v_lshlrev_b32 v204, 16, v124
  v_and_b32 v205, 0xffff0000, v124
  v_lshlrev_b32 v206, 16, v125
  v_and_b32 v207, 0xffff0000, v125
  v_lshlrev_b32 v208, 16, v126
  v_and_b32 v209, 0xffff0000, v126
  v_mfma_f32_32x32x16_bf16 v[88:103], v[116:119], a[188:191], v[88:103]
  v_lshlrev_b32 v210, 16, v127
  v_and_b32 v211, 0xffff0000, v127
  buffer_store_dwordx4 v[124:127], v0, s[4:7], s93 offen sc1
  s_waitcnt lgkmcnt(2)
  v_mfma_f32_32x32x16_bf16 v[40:55], v[104:107], a[192:195], v[40:55]
  v_add_f32 v196, v196, v204
  v_add_f32 v197, v197, v205
  v_add_f32 v198, v198, v206
  v_add_f32 v199, v199, v207
  v_add_f32 v200, v200, v208
  v_add_f32 v201, v201, v209
  v_mfma_f32_32x32x16_bf16 v[56:71], v[104:107], a[196:199], v[56:71]
  ds_read_b128 v[116:119], v3 offset:11776
  v_add_f32 v202, v202, v210
  v_add_f32 v203, v203, v211
  v_cvt_pk_bf16_f32 v128, v196, v197
  v_cvt_pk_bf16_f32 v129, v198, v199
  v_cvt_pk_bf16_f32 v130, v200, v201
  v_mfma_f32_32x32x16_bf16 v[72:87], v[104:107], a[200:203], v[72:87]
  v_cvt_pk_bf16_f32 v131, v202, v203
  v_mul_f32 v188, v204, v8
  v_mul_f32 v189, v205, v9
  v_fmac_f32 v188, v206, v10
  v_fmac_f32 v189, v207, v11
  v_fmac_f32 v188, v208, v12
  v_mfma_f32_32x32x16_bf16 v[88:103], v[104:107], a[204:207], v[88:103]
  v_fmac_f32 v189, v209, v13
  v_fmac_f32 v188, v210, v14
  v_fmac_f32 v189, v211, v15
  v_add_f32 v188, v188, v189
  s_add_u32 s92, s91, 33554432
  s_waitcnt lgkmcnt(2)
  v_mfma_f32_32x32x16_bf16 v[40:55], v[108:111], a[208:211], v[40:55]
  s_bitcmp1_b32 s65, 16
  s_cselect_b64 s[80:81], s[68:69], s[4:5]
  s_cselect_b32 s82, s70, s6
  s_cselect_b32 s92, s91, s92
  buffer_store_dwordx4 v[128:131], v0, s[80:83], s92 offen sc1
  v_mfma_f32_32x32x16_bf16 v[56:71], v[108:111], a[212:215], v[56:71]
  v_add_f32_dpp v188, v188, v188 row_ror:8 row_mask:0xf bank_mask:0xf
  s_nop 1
  v_add_f32_dpp v188, v188, v188 row_ror:4 row_mask:0xf bank_mask:0xf
  s_nop 1
  v_add_f32_dpp v188, v188, v188 row_ror:2 row_mask:0xf bank_mask:0xf
  s_nop 1
  v_add_f32_dpp v188, v188, v188 row_ror:1 row_mask:0xf bank_mask:0xf
  v_mov_b32 v189, v188
  s_nop 0
  s_nop 0
  v_permlane16_swap_b32 v188, v189
  v_mfma_f32_32x32x16_bf16 v[72:87], v[108:111], a[216:219], v[72:87]
  v_add_f32 v188, v188, v189
  v_mov_b32 v189, v188
  s_nop 0
  s_nop 0
  v_permlane32_swap_b32 v188, v189
  v_add_f32 v188, v188, v189
  v_cvt_pk_bf16_f32 v188, 0, v188
  v_mfma_f32_32x32x16_bf16 v[88:103], v[108:111], a[220:223], v[88:103]
  v_ashrrev_i32 v189, 31, v188
  v_or_b32 v189, 0x80000000, v189
  v_xor_b32 v188, v188, v189
  s_sub_u32 s92, 4095, s90
  v_and_b32 v188, 0xffff0000, v188
  s_waitcnt lgkmcnt(1)
  v_mfma_f32_32x32x16_bf16 v[40:55], v[112:115], a[224:227], v[40:55]
  v_or_b32 v38, s92, v188
  s_bfe_u32 s92, s65, 196625
  s_lshl_b32 s92, s92, 16
  s_lshl_b32 s93, s90, 5
  s_add_u32 s92, s92, s93
  s_add_u32 s84, s92, 243269632
  v_mfma_f32_32x32x16_bf16 v[56:71], v[112:115], a[228:231], v[56:71]
  v_mfma_f32_32x32x16_bf16 v[72:87], v[112:115], a[232:235], v[72:87]
  v_mfma_f32_32x32x16_bf16 v[88:103], v[112:115], a[236:239], v[88:103]
  s_waitcnt lgkmcnt(0)
  v_mfma_f32_32x32x16_bf16 v[40:55], v[116:119], a[240:243], v[40:55]
  v_mfma_f32_32x32x16_bf16 v[56:71], v[116:119], a[244:247], v[56:71]
  v_mfma_f32_32x32x16_bf16 v[72:87], v[116:119], a[248:251], v[72:87]
  v_mfma_f32_32x32x16_bf16 v[88:103], v[116:119], a[252:255], v[88:103]
  s_nop 4
  s_nop 3
  s_nop 0
  v_cvt_pk_bf16_f32 v212, v40, v56
  s_nop 0
  v_cvt_pk_bf16_f32 v213, v72, v88
  s_add_u32 s26, s86, 0
  buffer_store_dwordx2 v[212:213], v4, s[4:7], s26 offen
  v_cvt_pk_bf16_f32 v214, v41, v57
  v_cvt_pk_bf16_f32 v215, v73, v89
  s_add_u32 s26, s86, 16384
  buffer_store_dwordx2 v[214:215], v4, s[4:7], s26 offen
  v_cvt_pk_bf16_f32 v216, v42, v58
  v_cvt_pk_bf16_f32 v217, v74, v90
  s_add_u32 s26, s86, 32768
  buffer_store_dwordx2 v[216:217], v4, s[4:7], s26 offen
  v_cvt_pk_bf16_f32 v218, v43, v59
  v_cvt_pk_bf16_f32 v219, v75, v91
  s_add_u32 s26, s86, 49152
  buffer_store_dwordx2 v[218:219], v4, s[4:7], s26 offen
  v_cvt_pk_bf16_f32 v220, v44, v60
  v_cvt_pk_bf16_f32 v221, v76, v92
  s_add_u32 s26, s86, 131072
  buffer_store_dwordx2 v[220:221], v4, s[4:7], s26 offen
  v_cvt_pk_bf16_f32 v222, v45, v61
  v_cvt_pk_bf16_f32 v223, v77, v93
  s_add_u32 s26, s86, 147456
  buffer_store_dwordx2 v[222:223], v4, s[4:7], s26 offen
  v_cvt_pk_bf16_f32 v224, v46, v62
  v_cvt_pk_bf16_f32 v225, v78, v94
  s_add_u32 s26, s86, 163840
  buffer_store_dwordx2 v[224:225], v4, s[4:7], s26 offen
  v_cvt_pk_bf16_f32 v226, v47, v63
  v_cvt_pk_bf16_f32 v227, v79, v95
  s_add_u32 s26, s86, 180224
  buffer_store_dwordx2 v[226:227], v4, s[4:7], s26 offen
  v_cvt_pk_bf16_f32 v228, v48, v64
  v_cvt_pk_bf16_f32 v229, v80, v96
  s_add_u32 s26, s86, 262144
  buffer_store_dwordx2 v[228:229], v4, s[4:7], s26 offen
  v_cvt_pk_bf16_f32 v230, v49, v65
  v_cvt_pk_bf16_f32 v231, v81, v97
  s_add_u32 s26, s86, 278528
  buffer_store_dwordx2 v[230:231], v4, s[4:7], s26 offen
  v_cvt_pk_bf16_f32 v232, v50, v66
  v_cvt_pk_bf16_f32 v233, v82, v98
  s_add_u32 s26, s86, 294912
  buffer_store_dwordx2 v[232:233], v4, s[4:7], s26 offen
  v_cvt_pk_bf16_f32 v234, v51, v67
  v_cvt_pk_bf16_f32 v235, v83, v99
  s_add_u32 s26, s86, 311296
  buffer_store_dwordx2 v[234:235], v4, s[4:7], s26 offen
  v_cvt_pk_bf16_f32 v236, v52, v68
  v_cvt_pk_bf16_f32 v237, v84, v100
  s_add_u32 s26, s86, 393216
  buffer_store_dwordx2 v[236:237], v4, s[4:7], s26 offen
  v_cvt_pk_bf16_f32 v238, v53, v69
  v_cvt_pk_bf16_f32 v239, v85, v101
  s_add_u32 s26, s86, 409600
  buffer_store_dwordx2 v[238:239], v4, s[4:7], s26 offen
  v_cvt_pk_bf16_f32 v240, v54, v70
  v_cvt_pk_bf16_f32 v241, v86, v102
  s_add_u32 s26, s86, 425984
  buffer_store_dwordx2 v[240:241], v4, s[4:7], s26 offen
  v_cvt_pk_bf16_f32 v242, v55, v71
  v_cvt_pk_bf16_f32 v243, v87, v103
  s_add_u32 s26, s86, 442368
  buffer_store_dwordx2 v[242:243], v4, s[4:7], s26 offen
  s_waitcnt vmcnt(18)
o_we_99:
  v_and_b32 v37, -16, v39
  s_waitcnt lgkmcnt(0)
  s_barrier
  ds_read_b128 v[104:107], v37
  s_mov_b32 s65, s63
  s_mov_b32 s79, s42
  s_waitcnt lgkmcnt(0)
  v_and_b32 v104, v104, v105
  v_and_b32 v106, v106, v107
  v_and_b32 v104, v104, v106
  s_nop 0
  v_readfirstlane_b32 s26, v104
  s_and_b32 s66, s26, 1
  s_and_b32 s76, s26, 2
  s_cmp_lg_u32 s76, 0
  s_cbranch_scc1 o_nofl_78
  s_and_b32 s26, s63, 49152
  s_cbranch_scc0 o_fl_79
  s_and_b32 s26, s64, 1097728
  s_cmp_eq_u32 s26, 1048576
  s_cbranch_scc1 o_nofl_78
o_fl_79:
  s_waitcnt vmcnt(0)
  v_mov_b32 v7, s62
  s_mov_b64 exec, 1
  buffer_store_dword v7, off, s[4:7], s79
  s_mov_b64 exec, -1
  s_mov_b32 s79, 268435456
  s_mov_b64 exec, 1
  buffer_store_dword v38, off, s[4:7], s84 sc1
  s_mov_b64 exec, -1
  s_mov_b32 s84, 268435456
  s_cmp_ge_u32 s17, 2
  s_cbranch_scc1 o_fd_101
  s_cmp_eq_u32 s65, 0
  s_cbranch_scc1 o_fd_101
  s_and_b32 s26, s42, -256
  s_mov_b32 s67, 0
o_wob_103:
  buffer_load_dword v7, v2, s[4:7], s26 offen sc1
  s_add_u32 s67, s67, 1
  s_cmp_gt_u32 s67, 1048576
  s_cbranch_scc1 L_end
  s_waitcnt vmcnt(0)
  v_cmp_gt_u32 vcc, s62, v7
  s_cbranch_vccnz o_wob_103
  s_and_b32 s26, s65, 49152
  s_cbranch_scc1 o_f2_102
  s_lshl_b32 s94, s43, 14
  s_add_u32 s94, s94, s86
  buffer_load_dwordx4 v[120:123], v5, s[4:7], s94 offen offset:0 sc1
  buffer_load_dwordx4 v[124:127], v5, s[4:7], s94 offen offset:256 sc1
  buffer_load_dwordx4 v[128:131], v5, s[4:7], s94 offen offset:512 sc1
  buffer_load_dwordx4 v[132:135], v5, s[4:7], s94 offen offset:768 sc1
  s_add_u32 s94, s94, 4096
  buffer_load_dwordx4 v[136:139], v5, s[4:7], s94 offen offset:0 sc1
  buffer_load_dwordx4 v[140:143], v5, s[4:7], s94 offen offset:256 sc1
  buffer_load_dwordx4 v[144:147], v5, s[4:7], s94 offen offset:512 sc1
  buffer_load_dwordx4 v[148:151], v5, s[4:7], s94 offen offset:768 sc1
  s_add_u32 s94, s94, 4096
  buffer_load_dwordx4 v[152:155], v5, s[4:7], s94 offen offset:0 sc1
  buffer_load_dwordx4 v[156:159], v5, s[4:7], s94 offen offset:256 sc1
  buffer_load_dwordx4 v[160:163], v5, s[4:7], s94 offen offset:512 sc1
  buffer_load_dwordx4 v[164:167], v5, s[4:7], s94 offen offset:768 sc1
  s_add_u32 s94, s94, 4096
  buffer_load_dwordx4 v[168:171], v5, s[4:7], s94 offen offset:0 sc1
  buffer_load_dwordx4 v[172:175], v5, s[4:7], s94 offen offset:256 sc1
  buffer_load_dwordx4 v[176:179], v5, s[4:7], s94 offen offset:512 sc1
  buffer_load_dwordx4 v[180:183], v5, s[4:7], s94 offen offset:768 sc1
  s_and_b32 s91, s65, 63
  s_lshl_b32 s90, s91, 5
  s_add_u32 s90, s90, s43
  s_lshl_b32 s91, s90, 10
  buffer_load_dwordx4 v[184:187], v0, s[72:75], s91 offen
  s_mov_b64 exec, 1
  buffer_store_dword v38, off, s[4:7], s84 sc1
  s_mov_b64 exec, -1
  s_waitcnt vmcnt(14)
  v_mfma_f32_16x16x32_bf16 v[188:191], v[16:19], v[120:123], 0
  v_mfma_f32_16x16x32_bf16 v[192:195], v[16:19], v[124:127], 0
  v_mfma_f32_16x16x32_bf16 v[188:191], v[20:23], v[128:131], v[188:191]
  v_mfma_f32_16x16x32_bf16 v[192:195], v[20:23], v[132:135], v[192:195]
  s_waitcnt vmcnt(10)
  v_mfma_f32_16x16x32_bf16 v[188:191], v[16:19], v[136:139], v[188:191]
  v_mfma_f32_16x16x32_bf16 v[192:195], v[16:19], v[140:143], v[192:195]
  v_mfma_f32_16x16x32_bf16 v[188:191], v[20:23], v[144:147], v[188:191]
  v_mfma_f32_16x16x32_bf16 v[192:195], v[20:23], v[148:151], v[192:195]
  s_waitcnt vmcnt(6)
  v_mfma_f32_16x16x32_bf16 v[188:191], v[16:19], v[152:155], v[188:191]
  v_mfma_f32_16x16x32_bf16 v[192:195], v[16:19], v[156:159], v[192:195]
  v_mfma_f32_16x16x32_bf16 v[188:191], v[20:23], v[160:163], v[188:191]
  v_mfma_f32_16x16x32_bf16 v[192:195], v[20:23], v[164:167], v[192:195]
  s_waitcnt vmcnt(2)
  v_mfma_f32_16x16x32_bf16 v[188:191], v[16:19], v[168:171], v[188:191]
  v_mfma_f32_16x16x32_bf16 v[192:195], v[16:19], v[172:175], v[192:195]
  v_mfma_f32_16x16x32_bf16 v[188:191], v[20:23], v[176:179], v[188:191]
  v_mfma_f32_16x16x32_bf16 v[192:195], v[20:23], v[180:183], v[192:195]
  s_bfe_u32 s92, s65, 131086
  s_lshl_b32 s92, s92, 21
  s_add_u32 s92, s92, s91
  s_add_u32 s93, s92, 27262976
  s_add_u32 s92, s92, 20971520
  s_waitcnt vmcnt(1)
  v_lshlrev_b32 v196, 16, v184
  v_and_b32 v197, 0xffff0000, v184
  v_lshlrev_b32 v198, 16, v185
  v_and_b32 v199, 0xffff0000, v185
  v_lshlrev_b32 v200, 16, v186
  v_and_b32 v201, 0xffff0000, v186
  v_lshlrev_b32 v202, 16, v187
  v_and_b32 v203, 0xffff0000, v187
  v_permlane16_swap_b32 v188, v192
  v_permlane16_swap_b32 v189, v193
  v_permlane16_swap_b32 v190, v194
  v_permlane16_swap_b32 v191, v195
  v_cvt_pk_bf16_f32 v188, 0, v188
  v_cvt_pk_bf16_f32 v189, 0, v189
  v_cvt_pk_bf16_f32 v190, 0, v190
  v_cvt_pk_bf16_f32 v191, 0, v191
  v_cvt_pk_bf16_f32 v192, 0, v192
  v_cvt_pk_bf16_f32 v193, 0, v193
  v_cvt_pk_bf16_f32 v194, 0, v194
  v_cvt_pk_bf16_f32 v195, 0, v195
  v_add_f32 v196, v196, v188
  v_add_f32 v197, v197, v189
  v_add_f32 v198, v198, v190
  v_add_f32 v199, v199, v191
  v_add_f32 v200, v200, v192
  v_add_f32 v201, v201, v193
  v_add_f32 v202, v202, v194
  v_add_f32 v203, v203, v195
  v_cvt_pk_bf16_f32 v120, v196, v197
  v_cvt_pk_bf16_f32 v121, v198, v199
  v_cvt_pk_bf16_f32 v122, v200, v201
  v_cvt_pk_bf16_f32 v123, v202, v203
  v_lshlrev_b32 v196, 16, v120
  v_and_b32 v197, 0xffff0000, v120
  v_lshlrev_b32 v198, 16, v121
  v_and_b32 v199, 0xffff0000, v121
  v_lshlrev_b32 v200, 16, v122
  v_and_b32 v201, 0xffff0000, v122
  v_lshlrev_b32 v202, 16, v123
  v_and_b32 v203, 0xffff0000, v123
  buffer_store_dwordx4 v[120:123], v0, s[4:7], s92 offen sc1
  v_add_f32 v136, v196, v197
  v_mul_f32 v137, v196, v196
  v_add_f32 v138, v198, v199
  v_mul_f32 v139, v197, v197
  v_fmac_f32 v137, v198, v198
  v_fmac_f32 v139, v199, v199
  v_add_f32 v136, v136, v200
  v_fmac_f32 v137, v200, v200
  v_add_f32 v138, v138, v201
  v_fmac_f32 v139, v201, v201
  v_add_f32 v136, v136, v202
  v_fmac_f32 v137, v202, v202
  v_add_f32 v138, v138, v203
  v_fmac_f32 v139, v203, v203
  v_add_f32 v136, v136, v138
  v_add_f32 v137, v137, v139
  s_nop 0
  v_add_f32_dpp v136, v136, v136 row_ror:8 row_mask:0xf bank_mask:0xf
  v_add_f32_dpp v137, v137, v137 row_ror:8 row_mask:0xf bank_mask:0xf
  s_nop 0
  v_add_f32_dpp v136, v136, v136 row_ror:4 row_mask:0xf bank_mask:0xf
  v_add_f32_dpp v137, v137, v137 row_ror:4 row_mask:0xf bank_mask:0xf
  s_nop 0
  v_add_f32_dpp v136, v136, v136 row_ror:2 row_mask:0xf bank_mask:0xf
  v_add_f32_dpp v137, v137, v137 row_ror:2 row_mask:0xf bank_mask:0xf
  s_nop 0
  v_add_f32_dpp v136, v136, v136 row_ror:1 row_mask:0xf bank_mask:0xf
  v_add_f32_dpp v137, v137, v137 row_ror:1 row_mask:0xf bank_mask:0xf
  v_mov_b32 v140, v136
  v_mov_b32 v141, v137
  s_nop 0
  v_permlane16_swap_b32 v136, v140
  v_permlane16_swap_b32 v137, v141
  v_add_f32 v136, v136, v140
  v_add_f32 v137, v137, v141
  v_mov_b32 v140, v136
  v_mov_b32 v141, v137
  s_nop 0
  v_permlane32_swap_b32 v136, v140
  v_permlane32_swap_b32 v137, v141
  v_add_f32 v136, v136, v140
  v_add_f32 v137, v137, v141
  v_mul_f32 v136, 0x3b000000, v136
  v_mul_f32 v137, 0x3b000000, v137
  v_fma_f32 v137, -v136, v136, v137
  v_cvt_pk_bf16_f32 v136, 0, v136
  v_max_f32 v137, 0, v137
  v_sub_f32 v140, v196, v136
  v_sub_f32 v141, v197, v136
  v_cvt_pk_bf16_f32 v137, 0, v137
  v_sub_f32 v142, v198, v136
  v_sub_f32 v143, v199, v136
  v_add_f32 v137, 0x3727c5ac, v137
  v_sub_f32 v144, v200, v136
  v_sub_f32 v145, v201, v136
  v_cvt_pk_bf16_f32 v137, 0, v137
  v_sub_f32 v146, v202, v136
  v_sub_f32 v147, v203, v136
  v_sqrt_f32 v137, v137
  v_cvt_pk_bf16_f32 v140, 0, v140
  v_cvt_pk_bf16_f32 v141, 0, v141
  v_cvt_pk_bf16_f32 v137, 0, v137
  v_cvt_pk_bf16_f32 v142, 0, v142
  v_cvt_pk_bf16_f32 v143, 0, v143
  v_rcp_f32 v137, v137
  v_cvt_pk_bf16_f32 v144, 0, v144
  v_cvt_pk_bf16_f32 v145, 0, v145
  v_cvt_pk_bf16_f32 v146, 0, v146
  v_cvt_pk_bf16_f32 v147, 0, v147
  v_mul_f32 v140, v140, v137
  v_mul_f32 v141, v141, v137
  v_mul_f32 v142, v142, v137
  v_mul_f32 v143, v143, v137
  v_mul_f32 v144, v144, v137
  v_mul_f32 v145, v145, v137
  v_mul_f32 v146, v146, v137
  v_mul_f32 v147, v147, v137
  v_cvt_pk_bf16_f32 v124, v140, v141
  v_cvt_pk_bf16_f32 v125, v142, v143
  v_cvt_pk_bf16_f32 v126, v144, v145
  v_cvt_pk_bf16_f32 v127, v146, v147
  v_lshlrev_b32 v204, 16, v124
  v_and_b32 v205, 0xffff0000, v124
  v_lshlrev_b32 v206, 16, v125
  v_and_b32 v207, 0xffff0000, v125
  v_lshlrev_b32 v208, 16, v126
  v_and_b32 v209, 0xffff0000, v126
  v_lshlrev_b32 v210, 16, v127
  v_and_b32 v211, 0xffff0000, v127
  buffer_store_dwordx4 v[124:127], v0, s[4:7], s93 offen sc1
  v_add_f32 v196, v196, v204
  v_add_f32 v197, v197, v205
  v_add_f32 v198, v198, v206
  v_add_f32 v199, v199, v207
  v_add_f32 v200, v200, v208
  v_add_f32 v201, v201, v209
  v_add_f32 v202, v202, v210
  v_add_f32 v203, v203, v211
  v_cvt_pk_bf16_f32 v128, v196, v197
  v_cvt_pk_bf16_f32 v129, v198, v199
  v_cvt_pk_bf16_f32 v130, v200, v201
  v_cvt_pk_bf16_f32 v131, v202, v203
  v_mul_f32 v188, v204, v8
  v_mul_f32 v189, v205, v9
  v_fmac_f32 v188, v206, v10
  v_fmac_f32 v189, v207, v11
  v_fmac_f32 v188, v208, v12
  v_fmac_f32 v189, v209, v13
  v_fmac_f32 v188, v210, v14
  v_fmac_f32 v189, v211, v15
  v_add_f32 v188, v188, v189
  s_add_u32 s92, s91, 10485760
  s_add_u32 s93, s91, 8388608
  buffer_store_dwordx4 v[128:131], v0, s[4:7], s92 offen sc1
  v_lshlrev_b32 v196, 16, v128
  v_and_b32 v197, 0xffff0000, v128
  v_lshlrev_b32 v198, 16, v129
  v_and_b32 v199, 0xffff0000, v129
  v_lshlrev_b32 v200, 16, v130
  v_and_b32 v201, 0xffff0000, v130
  v_lshlrev_b32 v202, 16, v131
  v_and_b32 v203, 0xffff0000, v131
  v_add_f32 v136, v196, v197
  v_mul_f32 v137, v196, v196
  v_add_f32 v138, v198, v199
  v_mul_f32 v139, v197, v197
  v_fmac_f32 v137, v198, v198
  v_fmac_f32 v139, v199, v199
  v_add_f32 v136, v136, v200
  v_fmac_f32 v137, v200, v200
  v_add_f32 v138, v138, v201
  v_fmac_f32 v139, v201, v201
  v_add_f32 v136, v136, v202
  v_fmac_f32 v137, v202, v202
  v_add_f32 v138, v138, v203
  v_fmac_f32 v139, v203, v203
  v_add_f32 v136, v136, v138
  v_add_f32 v137, v137, v139
  s_nop 0
  v_add_f32_dpp v136, v136, v136 row_ror:8 row_mask:0xf bank_mask:0xf
  v_add_f32_dpp v137, v137, v137 row_ror:8 row_mask:0xf bank_mask:0xf
  v_add_f32_dpp v188, v188, v188 row_ror:8 row_mask:0xf bank_mask:0xf
  v_add_f32_dpp v136, v136, v136 row_ror:4 row_mask:0xf bank_mask:0xf
  v_add_f32_dpp v137, v137, v137 row_ror:4 row_mask:0xf bank_mask:0xf
  v_add_f32_dpp v188, v188, v188 row_ror:4 row_mask:0xf bank_mask:0xf
  v_add_f32_dpp v136, v136, v136 row_ror:2 row_mask:0xf bank_mask:0xf
  v_add_f32_dpp v137, v137, v137 row_ror:2 row_mask:0xf bank_mask:0xf
  v_add_f32_dpp v188, v188, v188 row_ror:2 row_mask:0xf bank_mask:0xf
  v_add_f32_dpp v136, v136, v136 row_ror:1 row_mask:0xf bank_mask:0xf
  v_add_f32_dpp v137, v137, v137 row_ror:1 row_mask:0xf bank_mask:0xf
  v_add_f32_dpp v188, v188, v188 row_ror:1 row_mask:0xf bank_mask:0xf
  v_mov_b32 v140, v136
  v_mov_b32 v141, v137
  v_mov_b32 v142, v188
  v_permlane16_swap_b32 v136, v140
  v_permlane16_swap_b32 v137, v141
  v_permlane16_swap_b32 v188, v142
  v_add_f32 v136, v136, v140
  v_add_f32 v137, v137, v141
  v_add_f32 v188, v188, v142
  v_mov_b32 v140, v136
  v_mov_b32 v141, v137
  v_mov_b32 v142, v188
  v_permlane32_swap_b32 v136, v140
  v_permlane32_swap_b32 v137, v141
  v_permlane32_swap_b32 v188, v142
  v_add_f32 v136, v136, v140
  v_add_f32 v137, v137, v141
  v_add_f32 v188, v188, v142
  v_mul_f32 v136, 0x3b000000, v136
  v_mul_f32 v137, 0x3b000000, v137
  v_fma_f32 v137, -v136, v136, v137
  v_cvt_pk_bf16_f32 v136, 0, v136
  v_max_f32 v137, 0, v137
  v_sub_f32 v140, v196, v136
  v_sub_f32 v141, v197, v136
  v_cvt_pk_bf16_f32 v137, 0, v137
  v_sub_f32 v142, v198, v136
  v_sub_f32 v143, v199, v136
  v_add_f32 v137, 0x3727c5ac, v137
  v_sub_f32 v144, v200, v136
  v_sub_f32 v145, v201, v136
  v_cvt_pk_bf16_f32 v137, 0, v137
  v_sub_f32 v146, v202, v136
  v_sub_f32 v147, v203, v136
  v_sqrt_f32 v137, v137
  v_cvt_pk_bf16_f32 v140, 0, v140
  v_cvt_pk_bf16_f32 v141, 0, v141
  v_cvt_pk_bf16_f32 v137, 0, v137
  v_cvt_pk_bf16_f32 v142, 0, v142
  v_cvt_pk_bf16_f32 v143, 0, v143
  v_rcp_f32 v137, v137
  v_cvt_pk_bf16_f32 v144, 0, v144
  v_cvt_pk_bf16_f32 v145, 0, v145
  v_cvt_pk_bf16_f32 v146, 0, v146
  v_cvt_pk_bf16_f32 v147, 0, v147
  v_mul_f32 v140, v140, v137
  v_mul_f32 v141, v141, v137
  v_mul_f32 v142, v142, v137
  v_mul_f32 v143, v143, v137
  v_mul_f32 v144, v144, v137
  v_mul_f32 v145, v145, v137
  v_mul_f32 v146, v146, v137
  v_mul_f32 v147, v147, v137
  v_cvt_pk_bf16_f32 v132, v140, v141
  v_cvt_pk_bf16_f32 v133, v142, v143
  v_cvt_pk_bf16_f32 v134, v144, v145
  v_cvt_pk_bf16_f32 v135, v146, v147
  buffer_store_dwordx4 v[132:135], v0, s[4:7], s93 offen sc1
  v_cvt_pk_bf16_f32 v188, 0, v188
  v_ashrrev_i32 v189, 31, v188
  v_or_b32 v189, 0x80000000, v189
  v_xor_b32 v188, v188, v189
  s_sub_u32 s92, 4095, s90
  v_and_b32 v188, 0xffff0000, v188
  v_or_b32 v38, s92, v188
  s_bfe_u32 s92, s65, 196625
  s_lshl_b32 s92, s92, 16
  s_lshl_b32 s93, s90, 5
  s_add_u32 s92, s92, s93
  s_add_u32 s84, s92, 243269632
  s_waitcnt vmcnt(0)
  s_mov_b64 exec, 1
  buffer_store_dword v38, off, s[4:7], s84 sc1
  s_mov_b64 exec, -1
  s_mov_b32 s84, 268435456
  s_branch o_fd_101
o_f2_102:
  s_lshl_b32 s94, s43, 14
  s_add_u32 s94, s94, s86
  buffer_load_dwordx4 v[120:123], v5, s[4:7], s94 offen offset:0 sc1
  buffer_load_dwordx4 v[124:127], v5, s[4:7], s94 offen offset:256 sc1
  buffer_load_dwordx4 v[128:131], v5, s[4:7], s94 offen offset:512 sc1
  buffer_load_dwordx4 v[132:135], v5, s[4:7], s94 offen offset:768 sc1
  s_add_u32 s94, s94, 4096
  buffer_load_dwordx4 v[136:139], v5, s[4:7], s94 offen offset:0 sc1
  buffer_load_dwordx4 v[140:143], v5, s[4:7], s94 offen offset:256 sc1
  buffer_load_dwordx4 v[144:147], v5, s[4:7], s94 offen offset:512 sc1
  buffer_load_dwordx4 v[148:151], v5, s[4:7], s94 offen offset:768 sc1
  s_add_u32 s94, s94, 4096
  buffer_load_dwordx4 v[152:155], v5, s[4:7], s94 offen offset:0 sc1
  buffer_load_dwordx4 v[156:159], v5, s[4:7], s94 offen offset:256 sc1
  buffer_load_dwordx4 v[160:163], v5, s[4:7], s94 offen offset:512 sc1
  buffer_load_dwordx4 v[164:167], v5, s[4:7], s94 offen offset:768 sc1
  s_add_u32 s94, s94, 4096
  buffer_load_dwordx4 v[168:171], v5, s[4:7], s94 offen offset:0 sc1
  buffer_load_dwordx4 v[172:175], v5, s[4:7], s94 offen offset:256 sc1
  buffer_load_dwordx4 v[176:179], v5, s[4:7], s94 offen offset:512 sc1
  buffer_load_dwordx4 v[180:183], v5, s[4:7], s94 offen offset:768 sc1
  s_and_b32 s91, s65, 63
  s_lshl_b32 s90, s91, 5
  s_add_u32 s90, s90, s43
  s_lshl_b32 s94, s91, 5
  s_add_u32 s94, s94, s85
  s_lshl_b32 s94, s94, 10
  s_lshr_b32 s92, s65, 22
  s_xor_b32 s93, s43, 32
  s_lshl_b32 s91, s90, 10
  s_add_u32 s94, s94, 25165824
  s_cmp_eq_u32 s92, s93
  s_cselect_b32 s92, s94, s91
  s_add_u32 s92, s92, 10485760
  buffer_load_dwordx4 v[184:187], v0, s[4:7], s92 offen sc1
  s_mov_b64 exec, 1
  buffer_store_dword v38, off, s[4:7], s84 sc1
  s_mov_b64 exec, -1
  s_waitcnt vmcnt(14)
  v_mfma_f32_16x16x32_bf16 v[188:191], v[16:19], v[120:123], 0
  v_mfma_f32_16x16x32_bf16 v[192:195], v[16:19], v[124:127], 0
  v_mfma_f32_16x16x32_bf16 v[188:191], v[20:23], v[128:131], v[188:191]
  v_mfma_f32_16x16x32_bf16 v[192:195], v[20:23], v[132:135], v[192:195]
  s_waitcnt vmcnt(10)
  v_mfma_f32_16x16x32_bf16 v[188:191], v[16:19], v[136:139], v[188:191]
  v_mfma_f32_16x16x32_bf16 v[192:195], v[16:19], v[140:143], v[192:195]
  v_mfma_f32_16x16x32_bf16 v[188:191], v[20:23], v[144:147], v[188:191]
  v_mfma_f32_16x16x32_bf16 v[192:195], v[20:23], v[148:151], v[192:195]
  s_waitcnt vmcnt(6)
  v_mfma_f32_16x16x32_bf16 v[188:191], v[16:19], v[152:155], v[188:191]
  v_mfma_f32_16x16x32_bf16 v[192:195], v[16:19], v[156:159], v[192:195]
  v_mfma_f32_16x16x32_bf16 v[188:191], v[20:23], v[160:163], v[188:191]
  v_mfma_f32_16x16x32_bf16 v[192:195], v[20:23], v[164:167], v[192:195]
  s_waitcnt vmcnt(2)
  v_mfma_f32_16x16x32_bf16 v[188:191], v[16:19], v[168:171], v[188:191]
  v_mfma_f32_16x16x32_bf16 v[192:195], v[16:19], v[172:175], v[192:195]
  v_mfma_f32_16x16x32_bf16 v[188:191], v[20:23], v[176:179], v[188:191]
  v_mfma_f32_16x16x32_bf16 v[192:195], v[20:23], v[180:183], v[192:195]
  s_bfe_u32 s92, s65, 131086
  s_lshl_b32 s92, s92, 21
  s_add_u32 s92, s92, s91
  s_add_u32 s93, s92, 27262976
  s_add_u32 s92, s92, 20971520
  s_waitcnt vmcnt(1)
  v_lshlrev_b32 v196, 16, v184
  v_and_b32 v197, 0xffff0000, v184
  v_lshlrev_b32 v198, 16, v185
  v_and_b32 v199, 0xffff0000, v185
  v_lshlrev_b32 v200, 16, v186
  v_and_b32 v201, 0xffff0000, v186
  v_lshlrev_b32 v202, 16, v187
  v_and_b32 v203, 0xffff0000, v187
  v_permlane16_swap_b32 v188, v192
  v_permlane16_swap_b32 v189, v193
  v_permlane16_swap_b32 v190, v194
  v_permlane16_swap_b32 v191, v195
  v_cvt_pk_bf16_f32 v188, 0, v188
  v_cvt_pk_bf16_f32 v189, 0, v189
  v_cvt_pk_bf16_f32 v190, 0, v190
  v_cvt_pk_bf16_f32 v191, 0, v191
  v_cvt_pk_bf16_f32 v192, 0, v192
  v_cvt_pk_bf16_f32 v193, 0, v193
  v_cvt_pk_bf16_f32 v194, 0, v194
  v_cvt_pk_bf16_f32 v195, 0, v195
  v_add_f32 v196, v196, v188
  v_add_f32 v197, v197, v189
  v_add_f32 v198, v198, v190
  v_add_f32 v199, v199, v191
  v_add_f32 v200, v200, v192
  v_add_f32 v201, v201, v193
  v_add_f32 v202, v202, v194
  v_add_f32 v203, v203, v195
  v_cvt_pk_bf16_f32 v120, v196, v197
  v_cvt_pk_bf16_f32 v121, v198, v199
  v_cvt_pk_bf16_f32 v122, v200, v201
  v_cvt_pk_bf16_f32 v123, v202, v203
  v_lshlrev_b32 v196, 16, v120
  v_and_b32 v197, 0xffff0000, v120
  v_lshlrev_b32 v198, 16, v121
  v_and_b32 v199, 0xffff0000, v121
  v_lshlrev_b32 v200, 16, v122
  v_and_b32 v201, 0xffff0000, v122
  v_lshlrev_b32 v202, 16, v123
  v_and_b32 v203, 0xffff0000, v123
  buffer_store_dwordx4 v[120:123], v0, s[4:7], s92 offen sc1
  v_add_f32 v136, v196, v197
  v_mul_f32 v137, v196, v196
  v_add_f32 v138, v198, v199
  v_mul_f32 v139, v197, v197
  v_fmac_f32 v137, v198, v198
  v_fmac_f32 v139, v199, v199
  v_add_f32 v136, v136, v200
  v_fmac_f32 v137, v200, v200
  v_add_f32 v138, v138, v201
  v_fmac_f32 v139, v201, v201
  v_add_f32 v136, v136, v202
  v_fmac_f32 v137, v202, v202
  v_add_f32 v138, v138, v203
  v_fmac_f32 v139, v203, v203
  v_add_f32 v136, v136, v138
  v_add_f32 v137, v137, v139
  s_nop 0
  v_add_f32_dpp v136, v136, v136 row_ror:8 row_mask:0xf bank_mask:0xf
  v_add_f32_dpp v137, v137, v137 row_ror:8 row_mask:0xf bank_mask:0xf
  s_nop 0
  v_add_f32_dpp v136, v136, v136 row_ror:4 row_mask:0xf bank_mask:0xf
  v_add_f32_dpp v137, v137, v137 row_ror:4 row_mask:0xf bank_mask:0xf
  s_nop 0
  v_add_f32_dpp v136, v136, v136 row_ror:2 row_mask:0xf bank_mask:0xf
  v_add_f32_dpp v137, v137, v137 row_ror:2 row_mask:0xf bank_mask:0xf
  s_nop 0
  v_add_f32_dpp v136, v136, v136 row_ror:1 row_mask:0xf bank_mask:0xf
  v_add_f32_dpp v137, v137, v137 row_ror:1 row_mask:0xf bank_mask:0xf
  v_mov_b32 v140, v136
  v_mov_b32 v141, v137
  s_nop 0
  v_permlane16_swap_b32 v136, v140
  v_permlane16_swap_b32 v137, v141
  v_add_f32 v136, v136, v140
  v_add_f32 v137, v137, v141
  v_mov_b32 v140, v136
  v_mov_b32 v141, v137
  s_nop 0
  v_permlane32_swap_b32 v136, v140
  v_permlane32_swap_b32 v137, v141
  v_add_f32 v136, v136, v140
  v_add_f32 v137, v137, v141
  v_mul_f32 v136, 0x3b000000, v136
  v_mul_f32 v137, 0x3b000000, v137
  v_fma_f32 v137, -v136, v136, v137
  v_cvt_pk_bf16_f32 v136, 0, v136
  v_max_f32 v137, 0, v137
  v_sub_f32 v140, v196, v136
  v_sub_f32 v141, v197, v136
  v_cvt_pk_bf16_f32 v137, 0, v137
  v_sub_f32 v142, v198, v136
  v_sub_f32 v143, v199, v136
  v_add_f32 v137, 0x3727c5ac, v137
  v_sub_f32 v144, v200, v136
  v_sub_f32 v145, v201, v136
  v_cvt_pk_bf16_f32 v137, 0, v137
  v_sub_f32 v146, v202, v136
  v_sub_f32 v147, v203, v136
  v_sqrt_f32 v137, v137
  v_cvt_pk_bf16_f32 v140, 0, v140
  v_cvt_pk_bf16_f32 v141, 0, v141
  v_cvt_pk_bf16_f32 v137, 0, v137
  v_cvt_pk_bf16_f32 v142, 0, v142
  v_cvt_pk_bf16_f32 v143, 0, v143
  v_rcp_f32 v137, v137
  v_cvt_pk_bf16_f32 v144, 0, v144
  v_cvt_pk_bf16_f32 v145, 0, v145
  v_cvt_pk_bf16_f32 v146, 0, v146
  v_cvt_pk_bf16_f32 v147, 0, v147
  v_mul_f32 v140, v140, v137
  v_mul_f32 v141, v141, v137
  v_mul_f32 v142, v142, v137
  v_mul_f32 v143, v143, v137
  v_mul_f32 v144, v144, v137
  v_mul_f32 v145, v145, v137
  v_mul_f32 v146, v146, v137
  v_mul_f32 v147, v147, v137
  v_cvt_pk_bf16_f32 v124, v140, v141
  v_cvt_pk_bf16_f32 v125, v142, v143
  v_cvt_pk_bf16_f32 v126, v144, v145
  v_cvt_pk_bf16_f32 v127, v146, v147
  v_lshlrev_b32 v204, 16, v124
  v_and_b32 v205, 0xffff0000, v124
  v_lshlrev_b32 v206, 16, v125
  v_and_b32 v207, 0xffff0000, v125
  v_lshlrev_b32 v208, 16, v126
  v_and_b32 v209, 0xffff0000, v126
  v_lshlrev_b32 v210, 16, v127
  v_and_b32 v211, 0xffff0000, v127
  buffer_store_dwordx4 v[124:127], v0, s[4:7], s93 offen sc1
  v_add_f32 v196, v196, v204
  v_add_f32 v197, v197, v205
  v_add_f32 v198, v198, v206
  v_add_f32 v199, v199, v207
  v_add_f32 v200, v200, v208
  v_add_f32 v201, v201, v209
  v_add_f32 v202, v202, v210
  v_add_f32 v203, v203, v211
  v_cvt_pk_bf16_f32 v128, v196, v197
  v_cvt_pk_bf16_f32 v129, v198, v199
  v_cvt_pk_bf16_f32 v130, v200, v201
  v_cvt_pk_bf16_f32 v131, v202, v203
  v_mul_f32 v188, v204, v8
  v_mul_f32 v189, v205, v9
  v_fmac_f32 v188, v206, v10
  v_fmac_f32 v189, v207, v11
  v_fmac_f32 v188, v208, v12
  v_fmac_f32 v189, v209, v13
  v_fmac_f32 v188, v210, v14
  v_fmac_f32 v189, v211, v15
  v_add_f32 v188, v188, v189
  s_add_u32 s92, s91, 33554432
  s_bitcmp1_b32 s65, 16
  s_cselect_b64 s[80:81], s[68:69], s[4:5]
  s_cselect_b32 s82, s70, s6
  s_cselect_b32 s92, s91, s92
  buffer_store_dwordx4 v[128:131], v0, s[80:83], s92 offen sc1
  v_add_f32_dpp v188, v188, v188 row_ror:8 row_mask:0xf bank_mask:0xf
  s_nop 1
  v_add_f32_dpp v188, v188, v188 row_ror:4 row_mask:0xf bank_mask:0xf
  s_nop 1
  v_add_f32_dpp v188, v188, v188 row_ror:2 row_mask:0xf bank_mask:0xf
  s_nop 1
  v_add_f32_dpp v188, v188, v188 row_ror:1 row_mask:0xf bank_mask:0xf
  v_mov_b32 v189, v188
  s_nop 0
  s_nop 0
  v_permlane16_swap_b32 v188, v189
  v_add_f32 v188, v188, v189
  v_mov_b32 v189, v188
  s_nop 0
  s_nop 0
  v_permlane32_swap_b32 v188, v189
  v_add_f32 v188, v188, v189
  v_cvt_pk_bf16_f32 v188, 0, v188
  v_ashrrev_i32 v189, 31, v188
  v_or_b32 v189, 0x80000000, v189
  v_xor_b32 v188, v188, v189
  s_sub_u32 s92, 4095, s90
  v_and_b32 v188, 0xffff0000, v188
  v_or_b32 v38, s92, v188
  s_bfe_u32 s92, s65, 196625
  s_lshl_b32 s92, s92, 16
  s_lshl_b32 s93, s90, 5
  s_add_u32 s92, s92, s93
  s_add_u32 s84, s92, 243269632
  s_waitcnt vmcnt(0)
  s_mov_b64 exec, 1
  buffer_store_dword v38, off, s[4:7], s84 sc1
  s_mov_b64 exec, -1
  s_mov_b32 s84, 268435456
o_fd_101:
  s_mov_b32 s65, 0
o_nofl_78:
  s_mov_b32 s63, s64
  s_cmp_lg_u32 s51, 0
  s_cbranch_scc1 o_pick_80
  s_cmp_lg_u32 s50, 0
  s_cbranch_scc1 L_end
  s_add_u32 s49, s49, 4
  s_cmp_lt_u32 s49, 64
  s_cbranch_scc1 o_round_75
  s_mov_b32 s67, 0
  s_mov_b32 s26, 243388416
  v_mov_b32 v193, s46
k_w_104:
  buffer_load_dword v160, v246, s[4:7], s26 offen sc1
  buffer_load_dword v161, v246, s[4:7], s26 offen offset:2048 sc1
  s_add_u32 s67, s67, 1
  s_cmp_gt_u32 s67, 1048576
  s_cbranch_scc1 L_end
  s_waitcnt vmcnt(0)
  v_min_u32 v192, v160, v161
  v_max3_u32 v193, v160, v161, v193
  v_cmp_eq_u32 vcc, 0, v192
  s_cbranch_vccnz k_w_104
  s_add_u32 s26, s26, 4096
  s_cmp_lt_u32 s26, 243400704
  s_cbranch_scc1 k_w_104
  v_max_u32_dpp v193, v193, v193 row_ror:8 row_mask:0xf bank_mask:0xf
  s_nop 1
  v_max_u32_dpp v193, v193, v193 row_ror:4 row_mask:0xf bank_mask:0xf
  s_nop 1
  v_max_u32_dpp v193, v193, v193 row_ror:2 row_mask:0xf bank_mask:0xf
  s_nop 1
  v_max_u32_dpp v193, v193, v193 row_ror:1 row_mask:0xf bank_mask:0xf
  v_mov_b32 v192, v193
  s_nop 0
  s_nop 0
  v_permlane16_swap_b32 v193, v192
  v_max_u32 v193, v193, v192
  v_mov_b32 v192, v193
  s_nop 0
  s_nop 0
  v_permlane32_swap_b32 v193, v192
  v_max_u32 v193, v193, v192
  s_nop 0
  v_readfirstlane_b32 s78, v193
  s_mov_b32 s46, s78
  s_andn2_b32 s52, 0xfff, s46
  s_lshr_b32 s52, s52, 5
  s_min_u32 s52, s52, 64
  s_add_u32 s26, s52, 3
  s_sub_u32 s26, s26, s60
  s_lshr_b32 s26, s26, 2
  s_bfm_b32 s54, s26, 0
  s_andn2_b32 s26, s55, s57
  s_and_b32 s26, s26, s54
  s_andn2_b32 s27, s56, s54
  s_or_b32 s48, s26, s27
  s_cmp_ge_u32 s17, 2
  s_cbranch_scc1 f_done_105
  s_andn2_b32 s28, 0xfff, s46
  s_lshr_b32 s28, s28, 5
  s_lshl_b32 s77, s60, 5
  s_lshl_b32 s26, s61, 1
  s_add_u32 s77, s77, s26
  s_add_u32 s77, s77, s17
  s_add_u32 s26, s28, 3
  s_sub_u32 s26, s26, s60
  s_lshr_b32 s26, s26, 2
  s_lshl_b32 s26, 1, s26
  s_sub_u32 s26, s26, 1
  s_and_b32 s27, s26, s48
  s_mov_b32 s30, 268435456
  s_lshl_b32 s29, s77, 10
  s_add_u32 s31, s29, 33554432
  s_bitcmp1_b32 s27, 0
  s_cselect_b32 s31, s31, s30
  buffer_load_dwordx4 v[168:171], v0, s[4:7], s31 offen sc1
  s_add_u32 s31, s29, 33685504
  s_bitcmp1_b32 s27, 1
  s_cselect_b32 s31, s31, s30
  buffer_load_dwordx4 v[172:175], v0, s[4:7], s31 offen sc1
  s_add_u32 s31, s29, 33816576
  s_bitcmp1_b32 s27, 2
  s_cselect_b32 s31, s31, s30
  buffer_load_dwordx4 v[176:179], v0, s[4:7], s31 offen sc1
  s_add_u32 s31, s29, 33947648
  s_bitcmp1_b32 s27, 3
  s_cselect_b32 s31, s31, s30
  buffer_load_dwordx4 v[180:183], v0, s[4:7], s31 offen sc1
  s_add_u32 s31, s29, 34078720
  s_bitcmp1_b32 s27, 4
  s_cselect_b32 s31, s31, s30
  buffer_load_dwordx4 v[184:187], v0, s[4:7], s31 offen sc1
  s_add_u32 s31, s29, 34209792
  s_bitcmp1_b32 s27, 5
  s_cselect_b32 s31, s31, s30
  buffer_load_dwordx4 v[188:191], v0, s[4:7], s31 offen sc1
  s_add_u32 s31, s29, 34340864
  s_bitcmp1_b32 s27, 6
  s_cselect_b32 s31, s31, s30
  buffer_load_dwordx4 v[192:195], v0, s[4:7], s31 offen sc1
  s_add_u32 s31, s29, 34471936
  s_bitcmp1_b32 s27, 7
  s_cselect_b32 s31, s31, s30
  buffer_load_dwordx4 v[196:199], v0, s[4:7], s31 offen sc1
  s_add_u32 s31, s29, 34603008
  s_bitcmp1_b32 s27, 8
  s_cselect_b32 s31, s31, s30
  buffer_load_dwordx4 v[200:203], v0, s[4:7], s31 offen sc1
  s_add_u32 s31, s29, 34734080
  s_bitcmp1_b32 s27, 9
  s_cselect_b32 s31, s31, s30
  buffer_load_dwordx4 v[204:207], v0, s[4:7], s31 offen sc1
  s_add_u32 s31, s29, 34865152
  s_bitcmp1_b32 s27, 10
  s_cselect_b32 s31, s31, s30
  buffer_load_dwordx4 v[208:211], v0, s[4:7], s31 offen sc1
  s_add_u32 s31, s29, 34996224
  s_bitcmp1_b32 s27, 11
  s_cselect_b32 s31, s31, s30
  buffer_load_dwordx4 v[212:215], v0, s[4:7], s31 offen sc1
  s_add_u32 s31, s29, 35127296
  s_bitcmp1_b32 s27, 12
  s_cselect_b32 s31, s31, s30
  buffer_load_dwordx4 v[216:219], v0, s[4:7], s31 offen sc1
  s_add_u32 s31, s29, 35258368
  s_bitcmp1_b32 s27, 13
  s_cselect_b32 s31, s31, s30
  buffer_load_dwordx4 v[220:223], v0, s[4:7], s31 offen sc1
  s_add_u32 s31, s29, 35389440
  s_bitcmp1_b32 s27, 14
  s_cselect_b32 s31, s31, s30
  buffer_load_dwordx4 v[224:227], v0, s[4:7], s31 offen sc1
  s_add_u32 s31, s29, 35520512
  s_bitcmp1_b32 s27, 15
  s_cselect_b32 s31, s31, s30
  buffer_load_dwordx4 v[228:231], v0, s[4:7], s31 offen sc1
  v_lshlrev_b32 v160, 8, v0
  s_mov_b32 vcc_lo, s26
  s_mov_b32 vcc_hi, 0
  v_mov_b32 v161, 65536
  v_cndmask_b32 v161, v161, 0, vcc
  v_add_u32 v161, v161, v160
  s_lshl_b32 s31, s77, 5
  s_add_u32 s32, s31, 243531776
  s_add_u32 s31, s31, 243400704
  buffer_load_dword v162, v161, s[4:7], s31 offen sc1
  s_add_u32 s31, s29, 0
  s_bitcmp1_b32 s27, 0
  s_cselect_b32 s31, s31, s30
  s_waitcnt vmcnt(16)
  buffer_store_dwordx4 v[168:171], v0, s[68:71], s31 offen sc1
  s_add_u32 s31, s29, 131072
  s_bitcmp1_b32 s27, 1
  s_cselect_b32 s31, s31, s30
  s_waitcnt vmcnt(16)
  buffer_store_dwordx4 v[172:175], v0, s[68:71], s31 offen sc1
  s_add_u32 s31, s29, 262144
  s_bitcmp1_b32 s27, 2
  s_cselect_b32 s31, s31, s30
  s_waitcnt vmcnt(16)
  buffer_store_dwordx4 v[176:179], v0, s[68:71], s31 offen sc1
  s_add_u32 s31, s29, 393216
  s_bitcmp1_b32 s27, 3
  s_cselect_b32 s31, s31, s30
  s_waitcnt vmcnt(16)
  buffer_store_dwordx4 v[180:183], v0, s[68:71], s31 offen sc1
  s_add_u32 s31, s29, 524288
  s_bitcmp1_b32 s27, 4
  s_cselect_b32 s31, s31, s30
  s_waitcnt vmcnt(16)
  buffer_store_dwordx4 v[184:187], v0, s[68:71], s31 offen sc1
  s_add_u32 s31, s29, 655360
  s_bitcmp1_b32 s27, 5
  s_cselect_b32 s31, s31, s30
  s_waitcnt vmcnt(16)
  buffer_store_dwordx4 v[188:191], v0, s[68:71], s31 offen sc1
  s_add_u32 s31, s29, 786432
  s_bitcmp1_b32 s27, 6
  s_cselect_b32 s31, s31, s30
  s_waitcnt vmcnt(16)
  buffer_store_dwordx4 v[192:195], v0, s[68:71], s31 offen sc1
  s_add_u32 s31, s29, 917504
  s_bitcmp1_b32 s27, 7
  s_cselect_b32 s31, s31, s30
  s_waitcnt vmcnt(16)
  buffer_store_dwordx4 v[196:199], v0, s[68:71], s31 offen sc1
  s_add_u32 s31, s29, 1048576
  s_bitcmp1_b32 s27, 8
  s_cselect_b32 s31, s31, s30
  s_waitcnt vmcnt(16)
  buffer_store_dwordx4 v[200:203], v0, s[68:71], s31 offen sc1
  s_add_u32 s31, s29, 1179648
  s_bitcmp1_b32 s27, 9
  s_cselect_b32 s31, s31, s30
  s_waitcnt vmcnt(16)
  buffer_store_dwordx4 v[204:207], v0, s[68:71], s31 offen sc1
  s_add_u32 s31, s29, 1310720
  s_bitcmp1_b32 s27, 10
  s_cselect_b32 s31, s31, s30
  s_waitcnt vmcnt(16)
  buffer_store_dwordx4 v[208:211], v0, s[68:71], s31 offen sc1
  s_add_u32 s31, s29, 1441792
  s_bitcmp1_b32 s27, 11
  s_cselect_b32 s31, s31, s30
  s_waitcnt vmcnt(16)
  buffer_store_dwordx4 v[212:215], v0, s[68:71], s31 offen sc1
  s_add_u32 s31, s29, 1572864
  s_bitcmp1_b32 s27, 12
  s_cselect_b32 s31, s31, s30
  s_waitcnt vmcnt(16)
  buffer_store_dwordx4 v[216:219], v0, s[68:71], s31 offen sc1
  s_add_u32 s31, s29, 1703936
  s_bitcmp1_b32 s27, 13
  s_cselect_b32 s31, s31, s30
  s_waitcnt vmcnt(16)
  buffer_store_dwordx4 v[220:223], v0, s[68:71], s31 offen sc1
  s_add_u32 s31, s29, 1835008
  s_bitcmp1_b32 s27, 14
  s_cselect_b32 s31, s31, s30
  s_waitcnt vmcnt(16)
  buffer_store_dwordx4 v[224:227], v0, s[68:71], s31 offen sc1
  s_add_u32 s31, s29, 1966080
  s_bitcmp1_b32 s27, 15
  s_cselect_b32 s31, s31, s30
  s_waitcnt vmcnt(16)
  buffer_store_dwordx4 v[228:231], v0, s[68:71], s31 offen sc1
  s_mov_b32 vcc_lo, s48
  v_mov_b32 v161, 0x7ff00000
  v_cndmask_b32 v160, v161, v160, vcc
  s_waitcnt vmcnt(0)
  buffer_store_dword v162, v160, s[4:7], s32 offen sc1
f_done_105:
  s_mov_b32 s50, 1
  s_mov_b32 s58, 0xffff
  s_mov_b32 s59, 64
  s_branch o_pick_80
L_o_x:
  s_mov_b32 s62, 0
  s_mov_b32 s46, 0
  s_mov_b32 s65, 0
  s_mov_b32 s66, 0
  s_mov_b32 s76, 0
  s_mov_b32 s50, 0
  s_mov_b32 s55, 0
  s_mov_b32 s56, 0
  s_mov_b32 s57, 0
  s_mov_b32 s79, 268435456
  s_mov_b32 s84, 268435456
  s_mov_b32 s86, s41
  s_mov_b32 s49, s60
  s_mov_b32 s47, 3579139413
o_round_106:
  s_mov_b32 s67, 0
  s_lshl_b32 s26, s49, 10
  s_add_u32 s26, s26, 243323904
d_w_113:
  buffer_load_dword v160, v246, s[4:7], s26 offen sc1
  buffer_load_dword v161, v246, s[4:7], s26 offen offset:2048 sc1
  s_add_u32 s67, s67, 1
  s_cmp_gt_u32 s67, 1048576
  s_cbranch_scc1 L_end
  s_waitcnt vmcnt(0)
  v_min_u32 v162, v160, v161
  v_max_u32 v163, v160, v161
  v_cmp_eq_u32 vcc, 0, v162
  s_cbranch_vccnz d_w_113
  v_max_u32_dpp v163, v163, v163 row_ror:8 row_mask:0xf bank_mask:0xf
  s_nop 1
  v_max_u32_dpp v163, v163, v163 row_ror:4 row_mask:0xf bank_mask:0xf
  s_nop 1
  v_max_u32_dpp v163, v163, v163 row_ror:2 row_mask:0xf bank_mask:0xf
  s_nop 1
  v_max_u32_dpp v163, v163, v163 row_ror:1 row_mask:0xf bank_mask:0xf
  s_nop 0
  v_readlane_b32 s28, v163, 0
  v_readlane_b32 s29, v163, 16
  v_readlane_b32 s30, v163, 32
  v_readlane_b32 s31, v163, 48
  s_max_u32 s28, s28, s29
  s_max_u32 s30, s30, s31
  s_max_u32 s46, s46, s28
  s_max_u32 s46, s46, s30
  s_andn2_b32 s52, 0xfff, s46
  s_lshr_b32 s52, s52, 5
  s_min_u32 s52, s52, 64
  s_add_u32 s26, s52, 3
  s_sub_u32 s26, s26, s60
  s_lshr_b32 s26, s26, 2
  s_bfm_b32 s54, s26, 0
  s_mul_i32 s63, s49, 257
  s_or_b32 s63, s63, 1179648
  s_add_u32 s53, s63, 1028
  s_cmp_lt_u32 s49, 60
  s_cselect_b32 s53, s53, 0
  s_lshr_b32 s26, s49, 2
  s_nop 3
  v_readlane_b32 s89, v247, s26
  s_sub_i32 s26, s26, 3
  s_max_i32 s26, s26, 0
  s_bfm_b32 s58, s26, 0
  s_and_b32 s59, s47, 3
  s_lshr_b32 s47, s47, 2
o_pick_111:
  s_cmp_eq_u32 s59, 0
  s_cbranch_scc1 o_none_118
  s_sub_u32 s59, s59, 1
  s_andn2_b32 s27, s58, s55
  s_and_b32 s26, s27, s54
  s_cbranch_scc1 o_gaf_116
  s_andn2_b32 s28, s58, s54
  s_andn2_b32 s28, s28, s56
  s_cmp_lg_u32 s50, 0
  s_cselect_b32 s27, 0, s27
  s_cmp_ge_u32 s46, s89
  s_cselect_b32 s26, 0, s27
  s_cmp_lg_u32 s26, 0
  s_cbranch_scc1 o_ga_114
  s_mov_b32 s26, s28
  s_cmp_lg_u32 s26, 0
  s_cbranch_scc1 o_gb_115
  s_mov_b32 s26, s27
  s_cmp_lg_u32 s26, 0
  s_cbranch_scc1 o_ga_114
o_none_118:
  s_mov_b32 s64, s53
  s_mov_b32 s51, 0
  s_branch o_task_107
o_gaf_116:
  s_ff1_i32_b32 s26, s26
  s_bitset1_b32 s55, s26
  s_bitset1_b32 s57, s26
  s_mov_b32 s64, 1654848
  s_branch o_gd_117
o_ga_114:
  s_ff1_i32_b32 s26, s26
  s_bitset1_b32 s55, s26
  s_mov_b32 s64, 1327168
  s_branch o_gd_117
o_gb_115:
  s_ff1_i32_b32 s26, s26
  s_bitset1_b32 s56, s26
  s_andn2_b32 s27, 31, s46
  s_or_b32 s27, s27, 32
  s_lshl_b32 s27, s27, 22
  s_or_b32 s27, s27, 1540224
  s_lshl_b32 s28, s26, 2
  s_add_u32 s28, s28, s60
  s_cmp_eq_u32 s28, s52
  s_cselect_b32 s64, s27, 1540160
  s_lshl_b32 s27, s50, 17
  s_add_u32 s64, s64, s27
o_gd_117:
  s_lshl_b32 s26, s26, 2
  s_add_u32 s26, s26, s60
  s_mul_i32 s26, s26, 257
  s_or_b32 s64, s64, s26
  s_xor_b32 s26, s64, s63
  s_and_b32 s26, s26, 0xff
  s_cselect_b32 s26, 0, 2097152
  s_or_b32 s64, s64, s26
  s_mov_b32 s51, 1
o_task_107:
  s_cmp_eq_u32 s63, 0
  s_cbranch_scc1 o_nofl_109
  s_cmp_lg_u32 s66, 0
  s_cbranch_scc1 o_have_120
  s_mov_b32 s67, 0
o_w1_119:
  s_and_b32 s32, s63, 0xff
  s_lshl_b32 s32, s32, 12
  s_add_u32 s32, s32, s14
  buffer_load_dword v37, v36, s[4:7], s32 offen sc1
  s_add_u32 s67, s67, 1
  s_cmp_gt_u32 s67, 1048576
  s_cbranch_scc1 L_end
  s_waitcnt vmcnt(0)
  v_mov_b32 v7, s62
  s_mov_b64 exec, 1
  buffer_store_dword v7, off, s[4:7], s79 sc1
  s_mov_b64 exec, -1
  s_mov_b32 s79, 268435456
  s_mov_b64 exec, 1
  buffer_store_dword v38, off, s[4:7], s84 sc1
  s_mov_b64 exec, -1
  s_mov_b32 s84, 268435456
  v_cmp_eq_u32 vcc, 0, v37
  s_cbranch_vccnz o_w1_119
  s_and_b32 s87, s63, 0xff
  s_lshl_b32 s33, s87, 18
  s_lshl_b32 s32, s87, 19
  s_add_u32 m0, s22, 0
  s_add_u32 s33, s33, s19
  buffer_load_dwordx4 v0, s[4:7], s33 offen offset:0 sc1 lds
  buffer_load_dwordx4 v0, s[4:7], s33 offen offset:1024 sc1 lds
  buffer_load_dwordx4 v0, s[4:7], s33 offen offset:2048 sc1 lds
  buffer_load_dwordx4 v0, s[4:7], s33 offen offset:3072 sc1 lds
  s_add_u32 m0, s23, 0
  s_add_u32 s32, s32, s18
  buffer_load_dwordx4 v0, s[4:7], s32 offen offset:0 sc1 lds
  buffer_load_dwordx4 v0, s[4:7], s32 offen offset:1024 sc1 lds
  buffer_load_dwordx4 v0, s[4:7], s32 offen offset:2048 sc1 lds
  buffer_load_dwordx4 v0, s[4:7], s32 offen offset:3072 sc1 lds
  s_add_u32 m0, m0, 4096
  s_add_u32 s32, s32, 4096
  buffer_load_dwordx4 v0, s[4:7], s32 offen offset:0 sc1 lds
  buffer_load_dwordx4 v0, s[4:7], s32 offen offset:1024 sc1 lds
  buffer_load_dwordx4 v0, s[4:7], s32 offen offset:2048 sc1 lds
  buffer_load_dwordx4 v0, s[4:7], s32 offen offset:3072 sc1 lds
  s_waitcnt vmcnt(0)
  s_barrier
o_have_120:
  ds_read_b128 v[120:123], v33 offset:0
  ds_read_b128 v[40:43], v32 offset:0
  ds_read_b128 v[56:59], v32 offset:1024
  ds_read_b128 v[124:127], v33 offset:2048
  ds_read_b128 v[44:47], v32 offset:4096
  ds_read_b128 v[60:63], v32 offset:5120
  ds_read_b128 v[128:131], v33 offset:4096
  ds_read_b128 v[48:51], v32 offset:8192
  ds_read_b128 v[64:67], v32 offset:9216
  ds_read_b128 v[132:135], v33 offset:6144
  ds_read_b128 v[52:55], v32 offset:12288
  ds_read_b128 v[68:71], v32 offset:13312
  s_and_b32 s32, s64, 0xff
  s_lshl_b32 s32, s32, 12
  s_add_u32 s32, s32, s14
  buffer_load_dword v37, v36, s[4:7], s32 offen sc1
  s_and_b32 s32, s64, 0xff00
  s_lshl_b32 s32, s32, 3
  s_add_u32 s32, s32, s15
  buffer_load_dword v245, off, s[4:7], s32 sc1
  s_waitcnt lgkmcnt(9)
  v_mfma_f32_16x16x32_bf16 v[104:107], v[40:43], v[120:123], v[24:27]
  ds_read_b128 v[136:139], v34 offset:0
  v_mfma_f32_16x16x32_bf16 v[108:111], v[56:59], v[120:123], v[28:31]
  ds_read_b64 v[200:201], v35 offset:4096
  s_waitcnt lgkmcnt(8)
  v_mfma_f32_16x16x32_bf16 v[104:107], v[44:47], v[124:127], v[104:107]
  ds_read_b128 v[140:143], v34 offset:1024
  v_mfma_f32_16x16x32_bf16 v[108:111], v[60:63], v[124:127], v[108:111]
  ds_read_b64 v[202:203], v35 offset:4608
  s_waitcnt lgkmcnt(7)
  v_mfma_f32_16x16x32_bf16 v[104:107], v[48:51], v[128:131], v[104:107]
  ds_read_b128 v[144:147], v34 offset:2048
  v_mfma_f32_16x16x32_bf16 v[108:111], v[64:67], v[128:131], v[108:111]
  ds_read_b64 v[204:205], v35 offset:5120
  s_waitcnt lgkmcnt(6)
  v_mfma_f32_16x16x32_bf16 v[104:107], v[52:55], v[132:135], v[104:107]
  ds_read_b128 v[148:151], v34 offset:3072
  v_mfma_f32_16x16x32_bf16 v[108:111], v[68:71], v[132:135], v[108:111]
  ds_read_b64 v[206:207], v35 offset:5632
  s_cmp_lg_u32 s76, 0
  s_cbranch_scc1 o_klds_123
  ds_read_b128 v[152:155], v32 offset:2048
  ds_read_b128 v[156:159], v32 offset:3072
  ds_read_b128 v[160:163], v32 offset:6144
  ds_read_b128 v[164:167], v32 offset:7168
  ds_read_b128 v[168:171], v32 offset:10240
  ds_read_b128 v[172:175], v32 offset:11264
  ds_read_b128 v[176:179], v32 offset:14336
  ds_read_b128 v[180:183], v32 offset:15360
  v_mov_b32 v196, 0
  v_mov_b32 v199, 0
  v_exp_f32 v56, v104
  v_exp_f32 v57, v105
  v_exp_f32 v58, v106
  v_exp_f32 v59, v107
  v_exp_f32 v60, v108
  v_exp_f32 v61, v109
  v_exp_f32 v62, v110
  v_exp_f32 v63, v111
  v_max3_f32 v116, v104, v105, v106
  v_max3_f32 v116, v107, v108, v116
  v_max3_f32 v116, v109, v110, v116
  v_add_f32 v117, v56, v57
  v_add_f32 v118, v58, v59
  v_add_f32 v117, v117, v60
  v_add_f32 v118, v118, v61
  v_add_f32 v117, v117, v62
  v_add_f32 v118, v118, v63
  s_waitcnt vmcnt(0) lgkmcnt(0)
  v_mov_b32 v7, s62
  s_mov_b64 exec, 1
  buffer_store_dword v7, off, s[4:7], s79 sc1
  s_mov_b64 exec, -1
  s_mov_b32 s79, 268435456
  s_mov_b64 exec, 1
  buffer_store_dword v38, off, s[4:7], s84 sc1
  s_mov_b64 exec, -1
  s_mov_b32 s84, 268435456
  s_mov_b32 s67, 0
o_w2_121:
  s_and_b32 s32, s63, 0xff00
  s_lshl_b32 s32, s32, 3
  s_add_u32 s32, s32, s15
  buffer_load_dword v244, off, s[4:7], s32 sc1
  s_add_u32 s67, s67, 1
  s_cmp_gt_u32 s67, 1048576
  s_cbranch_scc1 L_end
  s_waitcnt vmcnt(0)
  v_cmp_eq_u32 vcc, 0, v244
  s_cbranch_vccnz o_w2_121
  s_and_b32 s32, s63, 0xff00
  s_lshl_b32 s32, s32, 10
  s_add_u32 s32, s32, s20
  buffer_load_dwordx4 v[136:139], v0, s[4:7], s32 offen offset:0 sc1
  buffer_load_dwordx4 v[140:143], v0, s[4:7], s32 offen offset:1024 sc1
  buffer_load_dwordx4 v[144:147], v0, s[4:7], s32 offen offset:2048 sc1
  buffer_load_dwordx4 v[148:151], v0, s[4:7], s32 offen offset:3072 sc1
  s_add_u32 s32, s32, 4096
  buffer_load_dwordx2 v[200:201], v1, s[4:7], s32 offen offset:0 sc1
  buffer_load_dwordx2 v[202:203], v1, s[4:7], s32 offen offset:512 sc1
  buffer_load_dwordx2 v[204:205], v1, s[4:7], s32 offen offset:1024 sc1
  buffer_load_dwordx2 v[206:207], v1, s[4:7], s32 offen offset:1536 sc1
  s_waitcnt vmcnt(7)
  v_mfma_f32_16x16x32_bf16 v[112:115], v[136:139], v[120:123], 0
  s_waitcnt vmcnt(6)
  v_mfma_f32_16x16x32_bf16 v[112:115], v[140:143], v[124:127], v[112:115]
  s_waitcnt vmcnt(5)
  v_mfma_f32_16x16x32_bf16 v[112:115], v[144:147], v[128:131], v[112:115]
  s_waitcnt vmcnt(4)
  v_mfma_f32_16x16x32_bf16 v[112:115], v[148:151], v[132:135], v[112:115]
  s_waitcnt vmcnt(0)
  s_branch o_havek_122
o_klds_123:
  s_waitcnt lgkmcnt(1)
  v_mfma_f32_16x16x32_bf16 v[112:115], v[136:139], v[120:123], 0
  ds_read_b128 v[152:155], v32 offset:2048
  ds_read_b128 v[156:159], v32 offset:3072
  v_mfma_f32_16x16x32_bf16 v[112:115], v[140:143], v[124:127], v[112:115]
  ds_read_b128 v[160:163], v32 offset:6144
  ds_read_b128 v[164:167], v32 offset:7168
  v_mfma_f32_16x16x32_bf16 v[112:115], v[144:147], v[128:131], v[112:115]
  ds_read_b128 v[168:171], v32 offset:10240
  ds_read_b128 v[172:175], v32 offset:11264
  v_mfma_f32_16x16x32_bf16 v[112:115], v[148:151], v[132:135], v[112:115]
  ds_read_b128 v[176:179], v32 offset:14336
  ds_read_b128 v[180:183], v32 offset:15360
  v_mov_b32 v196, 0
  v_mov_b32 v199, 0
  v_exp_f32 v56, v104
  v_exp_f32 v57, v105
  v_exp_f32 v58, v106
  v_exp_f32 v59, v107
  v_exp_f32 v60, v108
  v_exp_f32 v61, v109
  v_exp_f32 v62, v110
  v_exp_f32 v63, v111
  v_max3_f32 v116, v104, v105, v106
  v_max3_f32 v116, v107, v108, v116
  v_max3_f32 v116, v109, v110, v116
  v_add_f32 v117, v56, v57
  v_add_f32 v118, v58, v59
  v_add_f32 v117, v117, v60
  v_add_f32 v118, v118, v61
  v_add_f32 v117, v117, v62
  v_add_f32 v118, v118, v63
  s_waitcnt vmcnt(2)
  v_mov_b32 v7, s62
  s_mov_b64 exec, 1
  buffer_store_dword v7, off, s[4:7], s79 sc1
  s_mov_b64 exec, -1
  s_mov_b32 s79, 268435456
o_havek_122:
  s_nop 1
  s_nop 1
  s_nop 1
  v_mul_f32 v112, s24, v112
  v_mul_f32 v113, s24, v113
  v_exp_f32 v64, v112
  v_exp_f32 v65, v113
  v_max_f32 v116, v111, v116
  v_max3_f32 v116, v112, v113, v116
  v_add_f32 v117, v117, v64
  v_add_f32 v118, v118, v65
  v_add_f32 v117, v117, v118
  v_cmp_lt_f32 vcc, 0x42700000, v116
  s_mov_b32 s28, 0x21800000
  s_and_b32 s26, s42, -256
  v_mov_b32 v118, v117
  s_nop 1
  v_permlane16_swap_b32 v117, v118
  v_add_f32 v117, v117, v118
  v_mov_b32 v118, v117
  s_nop 0
  s_nop 0
  v_permlane32_swap_b32 v117, v118
  v_add_f32 v117, v117, v118
  v_cmp_gt_f32 s[30:31], s28, v117
  v_rcp_f32 v117, v117
  s_or_b64 vcc, vcc, s[30:31]
  s_cbranch_vccnz o_fb_125
o_fbr_126:
  buffer_load_dword v7, v2, s[4:7], s26 offen sc1
  v_pk_mul_f32 v[56:57], v[56:57], v[116:117] op_sel:[0,1] op_sel_hi:[1,1]
  v_pk_mul_f32 v[58:59], v[58:59], v[116:117] op_sel:[0,1] op_sel_hi:[1,1]
  v_pk_mul_f32 v[60:61], v[60:61], v[116:117] op_sel:[0,1] op_sel_hi:[1,1]
  v_pk_mul_f32 v[62:63], v[62:63], v[116:117] op_sel:[0,1] op_sel_hi:[1,1]
  v_pk_mul_f32 v[64:65], v[64:65], v[116:117] op_sel:[0,1] op_sel_hi:[1,1]
  v_cvt_pk_bf16_f32 v116, v56, v57
  v_cvt_pk_bf16_f32 v117, v58, v59
  v_cvt_pk_bf16_f32 v118, v60, v61
  v_cvt_pk_bf16_f32 v119, v62, v63
  s_waitcnt lgkmcnt(0)
  s_nop 0
  v_mfma_f32_16x16x32_bf16 v[72:75], v[152:155], v[116:119], 0
  s_mov_b32 s95, s86
  v_cvt_pk_bf16_f32 v197, v64, v65
  v_cvt_pk_bf16_f32 v198, v64, v65
  v_mfma_f32_16x16x32_bf16 v[76:79], v[156:159], v[116:119], 0
  s_mov_b32 s96, s62
  v_mfma_f32_16x16x32_bf16 v[80:83], v[160:163], v[116:119], 0
  s_add_u32 s62, s62, 1
  v_mfma_f32_16x16x32_bf16 v[84:87], v[164:167], v[116:119], 0
  s_and_b32 s86, s62, 1
  v_mfma_f32_16x16x32_bf16 v[88:91], v[168:171], v[116:119], 0
  s_lshl_b32 s86, s86, 19
  v_mfma_f32_16x16x32_bf16 v[92:95], v[172:175], v[116:119], 0
  s_add_u32 s86, s86, s41
  v_mfma_f32_16x16x32_bf16 v[96:99], v[176:179], v[116:119], 0
  s_cmp_ge_u32 s17, 2
  v_mfma_f32_16x16x32_bf16 v[100:103], v[180:183], v[116:119], 0
  s_cselect_b32 s65, 0, s65
  v_mfma_f32_16x16x16_bf16 v[72:75], v[200:201], v[198:199], v[72:75]
  s_nop 1
  v_mfma_f32_16x16x16_bf16 v[76:79], v[200:201], v[196:197], v[76:79]
  s_nop 1
  v_mfma_f32_16x16x16_bf16 v[80:83], v[202:203], v[198:199], v[80:83]
  s_nop 1
  v_mfma_f32_16x16x16_bf16 v[84:87], v[202:203], v[196:197], v[84:87]
  s_nop 1
  v_mfma_f32_16x16x16_bf16 v[88:91], v[204:205], v[198:199], v[88:91]
  s_nop 0
  v_cvt_pk_bf16_f32 v40, v72, v73
  v_cvt_pk_bf16_f32 v41, v74, v75
  v_mfma_f32_16x16x16_bf16 v[92:95], v[204:205], v[196:197], v[92:95]
  s_nop 0
  v_cvt_pk_bf16_f32 v42, v76, v77
  v_cvt_pk_bf16_f32 v43, v78, v79
  v_mfma_f32_16x16x16_bf16 v[96:99], v[206:207], v[198:199], v[96:99]
  s_nop 0
  ds_write_b128 v6, v[40:43] offset:0
  v_cvt_pk_bf16_f32 v44, v80, v81
  v_mfma_f32_16x16x16_bf16 v[100:103], v[206:207], v[196:197], v[100:103]
  s_nop 0
  v_cvt_pk_bf16_f32 v45, v82, v83
  v_cvt_pk_bf16_f32 v46, v84, v85
  v_cvt_pk_bf16_f32 v47, v86, v87
  ds_write_b128 v6, v[44:47] offset:1024
  v_cvt_pk_bf16_f32 v48, v88, v89
  v_cvt_pk_bf16_f32 v49, v90, v91
  v_cvt_pk_bf16_f32 v50, v92, v93
  v_cvt_pk_bf16_f32 v51, v94, v95
  ds_write_b128 v6, v[48:51] offset:2048
  v_cvt_pk_bf16_f32 v52, v96, v97
  v_cvt_pk_bf16_f32 v53, v98, v99
  v_cvt_pk_bf16_f32 v54, v100, v101
  v_cvt_pk_bf16_f32 v55, v102, v103
  ds_write_b128 v6, v[52:55] offset:3072
  s_cmp_eq_u32 s65, 0
  s_cbranch_scc1 o_noob_124
  s_mov_b32 s67, 0
o_obl_127:
  s_waitcnt vmcnt(0)
  v_cmp_gt_u32 vcc, s96, v7
  s_cbranch_vccz o_obk_131
  buffer_load_dword v7, v2, s[4:7], s26 offen sc1
  s_add_u32 s67, s67, 1
  s_cmp_gt_u32 s67, 1048576
  s_cbranch_scc1 L_end
  s_branch o_obl_127
o_obk_131:
  s_lshl_b32 s94, s43, 14
  s_add_u32 s94, s94, s95
  buffer_load_dwordx4 v[120:123], v5, s[4:7], s94 offen offset:0 sc1
  buffer_load_dwordx4 v[124:127], v5, s[4:7], s94 offen offset:256 sc1
  buffer_load_dwordx4 v[128:131], v5, s[4:7], s94 offen offset:512 sc1
  buffer_load_dwordx4 v[132:135], v5, s[4:7], s94 offen offset:768 sc1
  s_add_u32 s94, s94, 4096
  buffer_load_dwordx4 v[136:139], v5, s[4:7], s94 offen offset:0 sc1
  buffer_load_dwordx4 v[140:143], v5, s[4:7], s94 offen offset:256 sc1
  buffer_load_dwordx4 v[144:147], v5, s[4:7], s94 offen offset:512 sc1
  buffer_load_dwordx4 v[148:151], v5, s[4:7], s94 offen offset:768 sc1
  s_add_u32 s94, s94, 4096
  buffer_load_dwordx4 v[152:155], v5, s[4:7], s94 offen offset:0 sc1
  buffer_load_dwordx4 v[156:159], v5, s[4:7], s94 offen offset:256 sc1
  buffer_load_dwordx4 v[160:163], v5, s[4:7], s94 offen offset:512 sc1
  buffer_load_dwordx4 v[164:167], v5, s[4:7], s94 offen offset:768 sc1
  s_add_u32 s94, s94, 4096
  buffer_load_dwordx4 v[168:171], v5, s[4:7], s94 offen offset:0 sc1
  buffer_load_dwordx4 v[172:175], v5, s[4:7], s94 offen offset:256 sc1
  buffer_load_dwordx4 v[176:179], v5, s[4:7], s94 offen offset:512 sc1
  buffer_load_dwordx4 v[180:183], v5, s[4:7], s94 offen offset:768 sc1
  s_waitcnt lgkmcnt(0)
  s_barrier
  s_branch o_wr1_128
o_noob_124:
  s_waitcnt lgkmcnt(0) vmcnt(0)
  s_barrier
  ds_read_b128 v[104:107], v3 offset:0
  ds_read_b128 v[108:111], v3 offset:512
  ds_read_b128 v[112:115], v3 offset:1024
  s_waitcnt lgkmcnt(2)
  v_mfma_f32_32x32x16_bf16 v[40:55], v[104:107], a[0:3], 0
  s_bfe_u32 s26, s64, 131092
  s_and_b32 s87, s64, 0xff
  s_bfe_u32 s88, s64, 0x80008
  v_cmp_eq_u32 vcc, 0, v37
  s_cmp_eq_u64 vcc, 0
  s_cselect_b32 s66, s26, 0
  s_cmp_eq_u32 s66, 1
  s_cselect_b32 s87, s87, 1024
  s_cselect_b32 s34, 0, 0x20000
  v_mfma_f32_32x32x16_bf16 v[56:71], v[104:107], a[4:7], 0
  ds_read_b128 v[116:119], v3 offset:1536
  s_cmp_eq_u32 s26, 3
  s_cselect_b32 s66, 1, s66
  v_cmp_eq_u32 vcc, 0, v245
  s_cmp_eq_u64 vcc, 0
  s_cselect_b32 s76, s26, 0
  s_and_b32 s76, s76, 1
  s_cselect_b32 s88, s88, 1024
  v_mfma_f32_32x32x16_bf16 v[72:87], v[104:107], a[8:11], 0
  s_lshl_b32 s32, s88, 18
  s_mov_b32 m0, s40
  s_add_u32 s32, s32, s21
  v_mfma_f32_32x32x16_bf16 v[88:103], v[104:107], a[12:15], 0
  buffer_load_dwordx4 v0, s[4:7], s32 offen offset:0 sc1 lds
  s_waitcnt lgkmcnt(2)
  v_mfma_f32_32x32x16_bf16 v[40:55], v[108:111], a[16:19], v[40:55]
  v_mfma_f32_32x32x16_bf16 v[56:71], v[108:111], a[20:23], v[56:71]
  ds_read_b128 v[104:107], v3 offset:2048
  buffer_load_dwordx4 v0, s[4:7], s32 offen offset:1024 sc1 lds
  v_mfma_f32_32x32x16_bf16 v[72:87], v[108:111], a[24:27], v[72:87]
  v_mfma_f32_32x32x16_bf16 v[88:103], v[108:111], a[28:31], v[88:103]
  buffer_load_dwordx4 v0, s[4:7], s32 offen offset:2048 sc1 lds
  s_lshl_b32 s33, s87, 18
  s_lshl_b32 s32, s87, 19
  s_waitcnt lgkmcnt(2)
  v_mfma_f32_32x32x16_bf16 v[40:55], v[112:115], a[32:35], v[40:55]
  s_add_u32 m0, s22, s34
  s_add_u32 s33, s33, s19
  v_mfma_f32_32x32x16_bf16 v[56:71], v[112:115], a[36:39], v[56:71]
  ds_read_b128 v[108:111], v3 offset:2560
  buffer_load_dwordx4 v0, s[4:7], s33 offen offset:0 sc1 lds
  v_mfma_f32_32x32x16_bf16 v[72:87], v[112:115], a[40:43], v[72:87]
  v_mfma_f32_32x32x16_bf16 v[88:103], v[112:115], a[44:47], v[88:103]
  buffer_load_dwordx4 v0, s[4:7], s33 offen offset:1024 sc1 lds
  s_waitcnt lgkmcnt(2)
  v_mfma_f32_32x32x16_bf16 v[40:55], v[116:119], a[48:51], v[40:55]
  v_mfma_f32_32x32x16_bf16 v[56:71], v[116:119], a[52:55], v[56:71]
  ds_read_b128 v[112:115], v3 offset:3072
  buffer_load_dwordx4 v0, s[4:7], s33 offen offset:2048 sc1 lds
  v_mfma_f32_32x32x16_bf16 v[72:87], v[116:119], a[56:59], v[72:87]
  v_mfma_f32_32x32x16_bf16 v[88:103], v[116:119], a[60:63], v[88:103]
  buffer_load_dwordx4 v0, s[4:7], s33 offen offset:3072 sc1 lds
  s_add_u32 m0, s23, s34
  s_add_u32 s32, s32, s18
  s_waitcnt lgkmcnt(2)
  v_mfma_f32_32x32x16_bf16 v[40:55], v[104:107], a[64:67], v[40:55]
  v_mfma_f32_32x32x16_bf16 v[56:71], v[104:107], a[68:71], v[56:71]
  ds_read_b128 v[116:119], v3 offset:3584
  buffer_load_dwordx4 v0, s[4:7], s32 offen offset:0 sc1 lds
  v_mfma_f32_32x32x16_bf16 v[72:87], v[104:107], a[72:75], v[72:87]
  v_mfma_f32_32x32x16_bf16 v[88:103], v[104:107], a[76:79], v[88:103]
  buffer_load_dwordx4 v0, s[4:7], s32 offen offset:1024 sc1 lds
  s_waitcnt lgkmcnt(2)
  v_mfma_f32_32x32x16_bf16 v[40:55], v[108:111], a[80:83], v[40:55]
  v_mfma_f32_32x32x16_bf16 v[56:71], v[108:111], a[84:87], v[56:71]
  ds_read_b128 v[104:107], v3 offset:8192
  buffer_load_dwordx4 v0, s[4:7], s32 offen offset:2048 sc1 lds
  v_mfma_f32_32x32x16_bf16 v[72:87], v[108:111], a[88:91], v[72:87]
  v_mfma_f32_32x32x16_bf16 v[88:103], v[108:111], a[92:95], v[88:103]
  buffer_load_dwordx4 v0, s[4:7], s32 offen offset:3072 sc1 lds
  s_add_u32 m0, m0, 4096
  s_add_u32 s32, s32, 4096
  s_waitcnt lgkmcnt(2)
  v_mfma_f32_32x32x16_bf16 v[40:55], v[112:115], a[96:99], v[40:55]
  v_mfma_f32_32x32x16_bf16 v[56:71], v[112:115], a[100:103], v[56:71]
  ds_read_b128 v[108:111], v3 offset:8704
  buffer_load_dwordx4 v0, s[4:7], s32 offen offset:0 sc1 lds
  v_mfma_f32_32x32x16_bf16 v[72:87], v[112:115], a[104:107], v[72:87]
  v_mfma_f32_32x32x16_bf16 v[88:103], v[112:115], a[108:111], v[88:103]
  buffer_load_dwordx4 v0, s[4:7], s32 offen offset:1024 sc1 lds
  s_waitcnt lgkmcnt(2)
  v_mfma_f32_32x32x16_bf16 v[40:55], v[116:119], a[112:115], v[40:55]
  v_mfma_f32_32x32x16_bf16 v[56:71], v[116:119], a[116:119], v[56:71]
  ds_read_b128 v[112:115], v3 offset:9216
  buffer_load_dwordx4 v0, s[4:7], s32 offen offset:2048 sc1 lds
  v_mfma_f32_32x32x16_bf16 v[72:87], v[116:119], a[120:123], v[72:87]
  v_mfma_f32_32x32x16_bf16 v[88:103], v[116:119], a[124:127], v[88:103]
  buffer_load_dwordx4 v0, s[4:7], s32 offen offset:3072 sc1 lds
  s_lshl_b32 s26, s76, 1
  s_or_b32 s26, s26, s66
  s_waitcnt lgkmcnt(2)
  v_mfma_f32_32x32x16_bf16 v[40:55], v[104:107], a[128:131], v[40:55]
  v_mov_b32 v37, s26
  ds_write_b32 v39, v37
  v_mfma_f32_32x32x16_bf16 v[56:71], v[104:107], a[132:135], v[56:71]
  ds_read_b128 v[116:119], v3 offset:9728
  v_mfma_f32_32x32x16_bf16 v[72:87], v[104:107], a[136:139], v[72:87]
  v_mfma_f32_32x32x16_bf16 v[88:103], v[104:107], a[140:143], v[88:103]
  s_waitcnt lgkmcnt(3)
  v_mfma_f32_32x32x16_bf16 v[40:55], v[108:111], a[144:147], v[40:55]
  v_mfma_f32_32x32x16_bf16 v[56:71], v[108:111], a[148:151], v[56:71]
  ds_read_b128 v[104:107], v3 offset:10240
  v_mfma_f32_32x32x16_bf16 v[72:87], v[108:111], a[152:155], v[72:87]
  v_mfma_f32_32x32x16_bf16 v[88:103], v[108:111], a[156:159], v[88:103]
  s_waitcnt lgkmcnt(3)
  v_mfma_f32_32x32x16_bf16 v[40:55], v[112:115], a[160:163], v[40:55]
  v_mfma_f32_32x32x16_bf16 v[56:71], v[112:115], a[164:167], v[56:71]
  ds_read_b128 v[108:111], v3 offset:10752
  v_mfma_f32_32x32x16_bf16 v[72:87], v[112:115], a[168:171], v[72:87]
  v_mfma_f32_32x32x16_bf16 v[88:103], v[112:115], a[172:175], v[88:103]
  s_waitcnt lgkmcnt(2)
  v_mfma_f32_32x32x16_bf16 v[40:55], v[116:119], a[176:179], v[40:55]
  v_mfma_f32_32x32x16_bf16 v[56:71], v[116:119], a[180:183], v[56:71]
  ds_read_b128 v[112:115], v3 offset:11264
  v_mfma_f32_32x32x16_bf16 v[72:87], v[116:119], a[184:187], v[72:87]
  v_mfma_f32_32x32x16_bf16 v[88:103], v[116:119], a[188:191], v[88:103]
  s_waitcnt lgkmcnt(2)
  v_mfma_f32_32x32x16_bf16 v[40:55], v[104:107], a[192:195], v[40:55]
  v_mfma_f32_32x32x16_bf16 v[56:71], v[104:107], a[196:199], v[56:71]
  ds_read_b128 v[116:119], v3 offset:11776
  v_mfma_f32_32x32x16_bf16 v[72:87], v[104:107], a[200:203], v[72:87]
  v_mfma_f32_32x32x16_bf16 v[88:103], v[104:107], a[204:207], v[88:103]
  s_waitcnt lgkmcnt(2)
  v_mfma_f32_32x32x16_bf16 v[40:55], v[108:111], a[208:211], v[40:55]
  v_mfma_f32_32x32x16_bf16 v[56:71], v[108:111], a[212:215], v[56:71]
  v_mfma_f32_32x32x16_bf16 v[72:87], v[108:111], a[216:219], v[72:87]
  v_mfma_f32_32x32x16_bf16 v[88:103], v[108:111], a[220:223], v[88:103]
  s_waitcnt lgkmcnt(1)
  v_mfma_f32_32x32x16_bf16 v[40:55], v[112:115], a[224:227], v[40:55]
  v_mfma_f32_32x32x16_bf16 v[56:71], v[112:115], a[228:231], v[56:71]
  v_mfma_f32_32x32x16_bf16 v[72:87], v[112:115], a[232:235], v[72:87]
  v_mfma_f32_32x32x16_bf16 v[88:103], v[112:115], a[236:239], v[88:103]
  s_waitcnt lgkmcnt(0)
  v_mfma_f32_32x32x16_bf16 v[40:55], v[116:119], a[240:243], v[40:55]
  v_mfma_f32_32x32x16_bf16 v[56:71], v[116:119], a[244:247], v[56:71]
  v_mfma_f32_32x32x16_bf16 v[72:87], v[116:119], a[248:251], v[72:87]
  v_mfma_f32_32x32x16_bf16 v[88:103], v[116:119], a[252:255], v[88:103]
  s_nop 3
  s_nop 0
  s_nop 3
  s_nop 0
  v_cvt_pk_bf16_f32 v212, v40, v56
  s_nop 0
  v_cvt_pk_bf16_f32 v213, v72, v88
  s_add_u32 s26, s86, 0
  buffer_store_dwordx2 v[212:213], v4, s[4:7], s26 offen sc1
  v_cvt_pk_bf16_f32 v214, v41, v57
  v_cvt_pk_bf16_f32 v215, v73, v89
  s_add_u32 s26, s86, 16384
  buffer_store_dwordx2 v[214:215], v4, s[4:7], s26 offen sc1
  v_cvt_pk_bf16_f32 v216, v42, v58
  v_cvt_pk_bf16_f32 v217, v74, v90
  s_add_u32 s26, s86, 32768
  buffer_store_dwordx2 v[216:217], v4, s[4:7], s26 offen sc1
  v_cvt_pk_bf16_f32 v218, v43, v59
  v_cvt_pk_bf16_f32 v219, v75, v91
  s_add_u32 s26, s86, 49152
  buffer_store_dwordx2 v[218:219], v4, s[4:7], s26 offen sc1
  v_cvt_pk_bf16_f32 v220, v44, v60
  v_cvt_pk_bf16_f32 v221, v76, v92
  s_add_u32 s26, s86, 131072
  buffer_store_dwordx2 v[220:221], v4, s[4:7], s26 offen sc1
  v_cvt_pk_bf16_f32 v222, v45, v61
  v_cvt_pk_bf16_f32 v223, v77, v93
  s_add_u32 s26, s86, 147456
  buffer_store_dwordx2 v[222:223], v4, s[4:7], s26 offen sc1
  v_cvt_pk_bf16_f32 v224, v46, v62
  v_cvt_pk_bf16_f32 v225, v78, v94
  s_add_u32 s26, s86, 163840
  buffer_store_dwordx2 v[224:225], v4, s[4:7], s26 offen sc1
  v_cvt_pk_bf16_f32 v226, v47, v63
  v_cvt_pk_bf16_f32 v227, v79, v95
  s_add_u32 s26, s86, 180224
  buffer_store_dwordx2 v[226:227], v4, s[4:7], s26 offen sc1
  v_cvt_pk_bf16_f32 v228, v48, v64
  v_cvt_pk_bf16_f32 v229, v80, v96
  s_add_u32 s26, s86, 262144
  buffer_store_dwordx2 v[228:229], v4, s[4:7], s26 offen sc1
  v_cvt_pk_bf16_f32 v230, v49, v65
  v_cvt_pk_bf16_f32 v231, v81, v97
  s_add_u32 s26, s86, 278528
  buffer_store_dwordx2 v[230:231], v4, s[4:7], s26 offen sc1
  v_cvt_pk_bf16_f32 v232, v50, v66
  v_cvt_pk_bf16_f32 v233, v82, v98
  s_add_u32 s26, s86, 294912
  buffer_store_dwordx2 v[232:233], v4, s[4:7], s26 offen sc1
  v_cvt_pk_bf16_f32 v234, v51, v67
  v_cvt_pk_bf16_f32 v235, v83, v99
  s_add_u32 s26, s86, 311296
  buffer_store_dwordx2 v[234:235], v4, s[4:7], s26 offen sc1
  v_cvt_pk_bf16_f32 v236, v52, v68
  v_cvt_pk_bf16_f32 v237, v84, v100
  s_add_u32 s26, s86, 393216
  buffer_store_dwordx2 v[236:237], v4, s[4:7], s26 offen sc1
  v_cvt_pk_bf16_f32 v238, v53, v69
  v_cvt_pk_bf16_f32 v239, v85, v101
  s_add_u32 s26, s86, 409600
  buffer_store_dwordx2 v[238:239], v4, s[4:7], s26 offen sc1
  v_cvt_pk_bf16_f32 v240, v54, v70
  v_cvt_pk_bf16_f32 v241, v86, v102
  s_add_u32 s26, s86, 425984
  buffer_store_dwordx2 v[240:241], v4, s[4:7], s26 offen sc1
  v_cvt_pk_bf16_f32 v242, v55, v71
  v_cvt_pk_bf16_f32 v243, v87, v103
  s_add_u32 s26, s86, 442368
  buffer_store_dwordx2 v[242:243], v4, s[4:7], s26 offen sc1
  s_waitcnt vmcnt(16)
  s_branch o_we_130
o_wr1_128:
  s_and_b32 s26, s65, 49152
  s_cbranch_scc1 o_wr2_129
  ds_read_b128 v[104:107], v3 offset:0
  ds_read_b128 v[108:111], v3 offset:512
  ds_read_b128 v[112:115], v3 offset:1024
  s_waitcnt lgkmcnt(2)
  v_mfma_f32_32x32x16_bf16 v[40:55], v[104:107], a[0:3], 0
  s_and_b32 s91, s65, 63
  s_lshl_b32 s90, s91, 5
  s_add_u32 s90, s90, s43
  s_lshl_b32 s91, s90, 10
  buffer_load_dwordx4 v[184:187], v0, s[72:75], s91 offen
  v_mfma_f32_32x32x16_bf16 v[56:71], v[104:107], a[4:7], 0
  ds_read_b128 v[116:119], v3 offset:1536
  s_mov_b64 exec, 1
  buffer_store_dword v38, off, s[4:7], s84 sc1
  s_mov_b64 exec, -1
  s_waitcnt vmcnt(14)
  v_mfma_f32_16x16x32_bf16 v[188:191], v[16:19], v[120:123], 0
  v_mfma_f32_32x32x16_bf16 v[72:87], v[104:107], a[8:11], 0
  s_bfe_u32 s26, s64, 131092
  s_and_b32 s87, s64, 0xff
  s_bfe_u32 s88, s64, 0x80008
  v_cmp_eq_u32 vcc, 0, v37
  s_cmp_eq_u64 vcc, 0
  s_cselect_b32 s66, s26, 0
  s_cmp_eq_u32 s66, 1
  s_cselect_b32 s87, s87, 1024
  s_cselect_b32 s34, 0, 0x20000
  v_mfma_f32_32x32x16_bf16 v[88:103], v[104:107], a[12:15], 0
  s_cmp_eq_u32 s26, 3
  s_cselect_b32 s66, 1, s66
  v_cmp_eq_u32 vcc, 0, v245
  s_cmp_eq_u64 vcc, 0
  s_cselect_b32 s76, s26, 0
  s_and_b32 s76, s76, 1
  s_cselect_b32 s88, s88, 1024
  s_waitcnt lgkmcnt(2)
  v_mfma_f32_32x32x16_bf16 v[40:55], v[108:111], a[16:19], v[40:55]
  s_lshl_b32 s32, s88, 18
  s_mov_b32 m0, s40
  s_add_u32 s32, s32, s21
  v_mfma_f32_16x16x32_bf16 v[192:195], v[16:19], v[124:127], 0
  v_mfma_f32_16x16x32_bf16 v[188:191], v[20:23], v[128:131], v[188:191]
  v_mfma_f32_32x32x16_bf16 v[56:71], v[108:111], a[20:23], v[56:71]
  ds_read_b128 v[104:107], v3 offset:2048
  buffer_load_dwordx4 v0, s[4:7], s32 offen offset:0 sc1 lds
  v_mfma_f32_16x16x32_bf16 v[192:195], v[20:23], v[132:135], v[192:195]
  v_mfma_f32_32x32x16_bf16 v[72:87], v[108:111], a[24:27], v[72:87]
  s_waitcnt vmcnt(11)
  v_mfma_f32_16x16x32_bf16 v[188:191], v[16:19], v[136:139], v[188:191]
  v_mfma_f32_16x16x32_bf16 v[192:195], v[16:19], v[140:143], v[192:195]
  v_mfma_f32_16x16x32_bf16 v[188:191], v[20:23], v[144:147], v[188:191]
  v_mfma_f32_32x32x16_bf16 v[88:103], v[108:111], a[28:31], v[88:103]
  buffer_load_dwordx4 v0, s[4:7], s32 offen offset:1024 sc1 lds
  v_mfma_f32_16x16x32_bf16 v[192:195], v[20:23], v[148:151], v[192:195]
  s_waitcnt lgkmcnt(2)
  v_mfma_f32_32x32x16_bf16 v[40:55], v[112:115], a[32:35], v[40:55]
  s_waitcnt vmcnt(8)
  v_mfma_f32_16x16x32_bf16 v[188:191], v[16:19], v[152:155], v[188:191]
  v_mfma_f32_16x16x32_bf16 v[192:195], v[16:19], v[156:159], v[192:195]
  v_mfma_f32_16x16x32_bf16 v[188:191], v[20:23], v[160:163], v[188:191]
  v_mfma_f32_32x32x16_bf16 v[56:71], v[112:115], a[36:39], v[56:71]
  ds_read_b128 v[108:111], v3 offset:2560
  buffer_load_dwordx4 v0, s[4:7], s32 offen offset:2048 sc1 lds
  s_lshl_b32 s33, s87, 18
  s_lshl_b32 s32, s87, 19
  v_mfma_f32_32x32x16_bf16 v[72:87], v[112:115], a[40:43], v[72:87]
  s_add_u32 m0, s22, s34
  s_add_u32 s33, s33, s19
  v_mfma_f32_16x16x32_bf16 v[192:195], v[20:23], v[164:167], v[192:195]
  s_waitcnt vmcnt(5)
  v_mfma_f32_16x16x32_bf16 v[188:191], v[16:19], v[168:171], v[188:191]
  v_mfma_f32_32x32x16_bf16 v[88:103], v[112:115], a[44:47], v[88:103]
  buffer_load_dwordx4 v0, s[4:7], s33 offen offset:0 sc1 lds
  v_mfma_f32_16x16x32_bf16 v[192:195], v[16:19], v[172:175], v[192:195]
  s_waitcnt lgkmcnt(2)
  v_mfma_f32_32x32x16_bf16 v[40:55], v[116:119], a[48:51], v[40:55]
  v_mfma_f32_16x16x32_bf16 v[188:191], v[20:23], v[176:179], v[188:191]
  v_mfma_f32_16x16x32_bf16 v[192:195], v[20:23], v[180:183], v[192:195]
  s_bfe_u32 s92, s65, 131086
  s_lshl_b32 s92, s92, 21
  v_mfma_f32_32x32x16_bf16 v[56:71], v[116:119], a[52:55], v[56:71]
  ds_read_b128 v[112:115], v3 offset:3072
  buffer_load_dwordx4 v0, s[4:7], s33 offen offset:1024 sc1 lds
  s_add_u32 s92, s92, s91
  s_add_u32 s93, s92, 27262976
  v_mfma_f32_32x32x16_bf16 v[72:87], v[116:119], a[56:59], v[72:87]
  s_add_u32 s92, s92, 20971520
  s_waitcnt vmcnt(6)
  v_lshlrev_b32 v196, 16, v184
  v_and_b32 v197, 0xffff0000, v184
  v_lshlrev_b32 v198, 16, v185
  v_and_b32 v199, 0xffff0000, v185
  v_mfma_f32_32x32x16_bf16 v[88:103], v[116:119], a[60:63], v[88:103]
  buffer_load_dwordx4 v0, s[4:7], s33 offen offset:2048 sc1 lds
  v_lshlrev_b32 v200, 16, v186
  v_and_b32 v201, 0xffff0000, v186
  s_waitcnt lgkmcnt(2)
  v_mfma_f32_32x32x16_bf16 v[40:55], v[104:107], a[64:67], v[40:55]
  v_lshlrev_b32 v202, 16, v187
  v_and_b32 v203, 0xffff0000, v187
  v_permlane16_swap_b32 v188, v192
  v_permlane16_swap_b32 v189, v193
  v_mfma_f32_32x32x16_bf16 v[56:71], v[104:107], a[68:71], v[56:71]
  ds_read_b128 v[116:119], v3 offset:3584
  buffer_load_dwordx4 v0, s[4:7], s33 offen offset:3072 sc1 lds
  s_add_u32 m0, s23, s34
  s_add_u32 s32, s32, s18
  v_mfma_f32_32x32x16_bf16 v[72:87], v[104:107], a[72:75], v[72:87]
  v_permlane16_swap_b32 v190, v194
  v_permlane16_swap_b32 v191, v195
  v_cvt_pk_bf16_f32 v188, 0, v188
  v_cvt_pk_bf16_f32 v189, 0, v189
  v_mfma_f32_32x32x16_bf16 v[88:103], v[104:107], a[76:79], v[88:103]
  buffer_load_dwordx4 v0, s[4:7], s32 offen offset:0 sc1 lds
  v_cvt_pk_bf16_f32 v190, 0, v190
  v_cvt_pk_bf16_f32 v191, 0, v191
  s_waitcnt lgkmcnt(2)
  v_mfma_f32_32x32x16_bf16 v[40:55], v[108:111], a[80:83], v[40:55]
  v_cvt_pk_bf16_f32 v192, 0, v192
  v_cvt_pk_bf16_f32 v193, 0, v193
  v_cvt_pk_bf16_f32 v194, 0, v194
  v_cvt_pk_bf16_f32 v195, 0, v195
  v_add_f32 v196, v196, v188
  v_add_f32 v197, v197, v189
  v_mfma_f32_32x32x16_bf16 v[56:71], v[108:111], a[84:87], v[56:71]
  ds_read_b128 v[104:107], v3 offset:8192
  buffer_load_dwordx4 v0, s[4:7], s32 offen offset:1024 sc1 lds
  v_add_f32 v198, v198, v190
  v_add_f32 v199, v199, v191
  v_mfma_f32_32x32x16_bf16 v[72:87], v[108:111], a[88:91], v[72:87]
  v_add_f32 v200, v200, v192
  v_add_f32 v201, v201, v193
  v_add_f32 v202, v202, v194
  v_add_f32 v203, v203, v195
  v_cvt_pk_bf16_f32 v120, v196, v197
  v_cvt_pk_bf16_f32 v121, v198, v199
  v_mfma_f32_32x32x16_bf16 v[88:103], v[108:111], a[92:95], v[88:103]
  buffer_load_dwordx4 v0, s[4:7], s32 offen offset:2048 sc1 lds
  v_cvt_pk_bf16_f32 v122, v200, v201
  v_cvt_pk_bf16_f32 v123, v202, v203
  s_waitcnt lgkmcnt(2)
  v_mfma_f32_32x32x16_bf16 v[40:55], v[112:115], a[96:99], v[40:55]
  v_lshlrev_b32 v196, 16, v120
  v_and_b32 v197, 0xffff0000, v120
  v_lshlrev_b32 v198, 16, v121
  v_and_b32 v199, 0xffff0000, v121
  v_lshlrev_b32 v200, 16, v122
  v_and_b32 v201, 0xffff0000, v122
  v_mfma_f32_32x32x16_bf16 v[56:71], v[112:115], a[100:103], v[56:71]
  ds_read_b128 v[108:111], v3 offset:8704
  buffer_load_dwordx4 v0, s[4:7], s32 offen offset:3072 sc1 lds
  s_add_u32 m0, m0, 4096
  s_add_u32 s32, s32, 4096
  v_mfma_f32_32x32x16_bf16 v[72:87], v[112:115], a[104:107], v[72:87]
  v_lshlrev_b32 v202, 16, v123
  v_and_b32 v203, 0xffff0000, v123
  buffer_store_dwordx4 v[120:123], v0, s[4:7], s92 offen sc1
  v_add_f32 v136, v196, v197
  v_mfma_f32_32x32x16_bf16 v[88:103], v[112:115], a[108:111], v[88:103]
  buffer_load_dwordx4 v0, s[4:7], s32 offen offset:0 sc1 lds
  v_mul_f32 v137, v196, v196
  v_add_f32 v138, v198, v199
  s_waitcnt lgkmcnt(2)
  v_mfma_f32_32x32x16_bf16 v[40:55], v[116:119], a[112:115], v[40:55]
  v_mul_f32 v139, v197, v197
  v_fmac_f32 v137, v198, v198
  v_fmac_f32 v139, v199, v199
  v_add_f32 v136, v136, v200
  v_fmac_f32 v137, v200, v200
  v_add_f32 v138, v138, v201
  v_mfma_f32_32x32x16_bf16 v[56:71], v[116:119], a[116:119], v[56:71]
  ds_read_b128 v[112:115], v3 offset:9216
  buffer_load_dwordx4 v0, s[4:7], s32 offen offset:1024 sc1 lds
  v_fmac_f32 v139, v201, v201
  v_add_f32 v136, v136, v202
  v_mfma_f32_32x32x16_bf16 v[72:87], v[116:119], a[120:123], v[72:87]
  v_fmac_f32 v137, v202, v202
  v_add_f32 v138, v138, v203
  v_fmac_f32 v139, v203, v203
  v_add_f32 v136, v136, v138
  v_add_f32 v137, v137, v139
  s_nop 0
  v_add_f32_dpp v136, v136, v136 row_ror:8 row_mask:0xf bank_mask:0xf
  v_mfma_f32_32x32x16_bf16 v[88:103], v[116:119], a[124:127], v[88:103]
  buffer_load_dwordx4 v0, s[4:7], s32 offen offset:2048 sc1 lds
  v_add_f32_dpp v137, v137, v137 row_ror:8 row_mask:0xf bank_mask:0xf
  v_add_f32_dpp v136, v136, v136 row_ror:4 row_mask:0xf bank_mask:0xf
  s_waitcnt lgkmcnt(2)
  v_mfma_f32_32x32x16_bf16 v[40:55], v[104:107], a[128:131], v[40:55]
  v_add_f32_dpp v137, v137, v137 row_ror:4 row_mask:0xf bank_mask:0xf
  v_add_f32_dpp v136, v136, v136 row_ror:2 row_mask:0xf bank_mask:0xf
  s_nop 0
  v_add_f32_dpp v137, v137, v137 row_ror:2 row_mask:0xf bank_mask:0xf
  v_add_f32_dpp v136, v136, v136 row_ror:1 row_mask:0xf bank_mask:0xf
  s_nop 0
  v_add_f32_dpp v137, v137, v137 row_ror:1 row_mask:0xf bank_mask:0xf
  v_mov_b32 v140, v136
  v_mfma_f32_32x32x16_bf16 v[56:71], v[104:107], a[132:135], v[56:71]
  ds_read_b128 v[116:119], v3 offset:9728
  buffer_load_dwordx4 v0, s[4:7], s32 offen offset:3072 sc1 lds
  s_lshl_b32 s26, s76, 1
  s_or_b32 s26, s26, s66
  v_mfma_f32_32x32x16_bf16 v[72:87], v[104:107], a[136:139], v[72:87]
  v_mov_b32 v37, s26
  ds_write_b32 v39, v37
  v_mov_b32 v141, v137
  v_permlane16_swap_b32 v136, v140
  v_mfma_f32_32x32x16_bf16 v[88:103], v[104:107], a[140:143], v[88:103]
  v_permlane16_swap_b32 v137, v141
  v_add_f32 v136, v136, v140
  v_add_f32 v137, v137, v141
  v_mov_b32 v140, v136
  s_waitcnt lgkmcnt(3)
  v_mfma_f32_32x32x16_bf16 v[40:55], v[108:111], a[144:147], v[40:55]
  v_mov_b32 v141, v137
  v_permlane32_swap_b32 v136, v140
  s_nop 0
  v_permlane32_swap_b32 v137, v141
  v_add_f32 v136, v136, v140
  v_mfma_f32_32x32x16_bf16 v[56:71], v[108:111], a[148:151], v[56:71]
  ds_read_b128 v[104:107], v3 offset:10240
  v_add_f32 v137, v137, v141
  v_mul_f32 v136, 0x3b000000, v136
  v_mul_f32 v137, 0x3b000000, v137
  v_fma_f32 v137, -v136, v136, v137
  v_cvt_pk_bf16_f32 v136, 0, v136
  v_mfma_f32_32x32x16_bf16 v[72:87], v[108:111], a[152:155], v[72:87]
  v_max_f32 v137, 0, v137
  v_sub_f32 v140, v196, v136
  v_sub_f32 v141, v197, v136
  v_cvt_pk_bf16_f32 v137, 0, v137
  v_sub_f32 v142, v198, v136
  v_sub_f32 v143, v199, v136
  v_mfma_f32_32x32x16_bf16 v[88:103], v[108:111], a[156:159], v[88:103]
  v_add_f32 v137, 0x3727c5ac, v137
  v_sub_f32 v144, v200, v136
  v_sub_f32 v145, v201, v136
  v_cvt_pk_bf16_f32 v137, 0, v137
  v_sub_f32 v146, v202, v136
  s_waitcnt lgkmcnt(3)
  v_mfma_f32_32x32x16_bf16 v[40:55], v[112:115], a[160:163], v[40:55]
  v_sub_f32 v147, v203, v136
  v_sqrt_f32 v137, v137
  v_cvt_pk_bf16_f32 v140, 0, v140
  v_cvt_pk_bf16_f32 v141, 0, v141
  v_cvt_pk_bf16_f32 v137, 0, v137
  v_mfma_f32_32x32x16_bf16 v[56:71], v[112:115], a[164:167], v[56:71]
  ds_read_b128 v[108:111], v3 offset:10752
  v_cvt_pk_bf16_f32 v142, 0, v142
  v_cvt_pk_bf16_f32 v143, 0, v143
  v_rcp_f32 v137, v137
  v_cvt_pk_bf16_f32 v144, 0, v144
  v_mfma_f32_32x32x16_bf16 v[72:87], v[112:115], a[168:171], v[72:87]
  v_cvt_pk_bf16_f32 v145, 0, v145
  v_cvt_pk_bf16_f32 v146, 0, v146
  v_cvt_pk_bf16_f32 v147, 0, v147
  v_mul_f32 v140, v140, v137
  v_mul_f32 v141, v141, v137
  v_mul_f32 v142, v142, v137
  v_mfma_f32_32x32x16_bf16 v[88:103], v[112:115], a[172:175], v[88:103]
  v_mul_f32 v143, v143, v137
  v_mul_f32 v144, v144, v137
  v_mul_f32 v145, v145, v137
  v_mul_f32 v146, v146, v137
  v_mul_f32 v147, v147, v137
  s_waitcnt lgkmcnt(3)
  v_mfma_f32_32x32x16_bf16 v[40:55], v[116:119], a[176:179], v[40:55]
  v_cvt_pk_bf16_f32 v124, v140, v141
  v_cvt_pk_bf16_f32 v125, v142, v143
  v_cvt_pk_bf16_f32 v126, v144, v145
  v_cvt_pk_bf16_f32 v127, v146, v147
  v_lshlrev_b32 v204, 16, v124
  v_and_b32 v205, 0xffff0000, v124
  v_mfma_f32_32x32x16_bf16 v[56:71], v[116:119], a[180:183], v[56:71]
  ds_read_b128 v[112:115], v3 offset:11264
  v_lshlrev_b32 v206, 16, v125
  v_and_b32 v207, 0xffff0000, v125
  v_lshlrev_b32 v208, 16, v126
  v_and_b32 v209, 0xffff0000, v126
  v_lshlrev_b32 v210, 16, v127
  v_mfma_f32_32x32x16_bf16 v[72:87], v[116:119], a[184:187], v[72:87]
  v_and_b32 v211, 0xffff0000, v127
  buffer_store_dwordx4 v[124:127], v0, s[4:7], s93 offen sc1
  v_add_f32 v196, v196, v204
  v_add_f32 v197, v197, v205
  v_mfma_f32_32x32x16_bf16 v[88:103], v[116:119], a[188:191], v[88:103]
  v_add_f32 v198, v198, v206
  v_add_f32 v199, v199, v207
  v_add_f32 v200, v200, v208
  v_add_f32 v201, v201, v209
  v_add_f32 v202, v202, v210
  s_waitcnt lgkmcnt(2)
  v_mfma_f32_32x32x16_bf16 v[40:55], v[104:107], a[192:195], v[40:55]
  v_add_f32 v203, v203, v211
  v_cvt_pk_bf16_f32 v128, v196, v197
  v_cvt_pk_bf16_f32 v129, v198, v199
  v_cvt_pk_bf16_f32 v130, v200, v201
  v_cvt_pk_bf16_f32 v131, v202, v203
  v_mul_f32 v188, v204, v8
  v_mfma_f32_32x32x16_bf16 v[56:71], v[104:107], a[196:199], v[56:71]
  ds_read_b128 v[116:119], v3 offset:11776
  v_mul_f32 v189, v205, v9
  v_fmac_f32 v188, v206, v10
  v_fmac_f32 v189, v207, v11
  v_fmac_f32 v188, v208, v12
  v_fmac_f32 v189, v209, v13
  v_mfma_f32_32x32x16_bf16 v[72:87], v[104:107], a[200:203], v[72:87]
  v_fmac_f32 v188, v210, v14
  v_fmac_f32 v189, v211, v15
  v_add_f32 v188, v188, v189
  s_add_u32 s92, s91, 10485760
  s_add_u32 s93, s91, 8388608
  buffer_store_dwordx4 v[128:131], v0, s[4:7], s92 offen sc1
  v_mfma_f32_32x32x16_bf16 v[88:103], v[104:107], a[204:207], v[88:103]
  v_lshlrev_b32 v196, 16, v128
  v_and_b32 v197, 0xffff0000, v128
  v_lshlrev_b32 v198, 16, v129
  v_and_b32 v199, 0xffff0000, v129
  v_lshlrev_b32 v200, 16, v130
  s_waitcnt lgkmcnt(2)
  v_mfma_f32_32x32x16_bf16 v[40:55], v[108:111], a[208:211], v[40:55]
  v_and_b32 v201, 0xffff0000, v130
  v_lshlrev_b32 v202, 16, v131
  v_and_b32 v203, 0xffff0000, v131
  v_add_f32 v136, v196, v197
  v_mul_f32 v137, v196, v196
  v_add_f32 v138, v198, v199
  v_mfma_f32_32x32x16_bf16 v[56:71], v[108:111], a[212:215], v[56:71]
  v_mul_f32 v139, v197, v197
  v_fmac_f32 v137, v198, v198
  v_fmac_f32 v139, v199, v199
  v_add_f32 v136, v136, v200
  v_fmac_f32 v137, v200, v200
  v_add_f32 v138, v138, v201
  v_mfma_f32_32x32x16_bf16 v[72:87], v[108:111], a[216:219], v[72:87]
  v_fmac_f32 v139, v201, v201
  v_add_f32 v136, v136, v202
  v_fmac_f32 v137, v202, v202
  v_add_f32 v138, v138, v203
  v_fmac_f32 v139, v203, v203
  v_add_f32 v136, v136, v138
  v_mfma_f32_32x32x16_bf16 v[88:103], v[108:111], a[220:223], v[88:103]
  v_add_f32 v137, v137, v139
  v_add_f32_dpp v136, v136, v136 row_ror:8 row_mask:0xf bank_mask:0xf
  s_nop 0
  v_add_f32_dpp v137, v137, v137 row_ror:8 row_mask:0xf bank_mask:0xf
  v_add_f32_dpp v188, v188, v188 row_ror:8 row_mask:0xf bank_mask:0xf
  v_add_f32_dpp v136, v136, v136 row_ror:4 row_mask:0xf bank_mask:0xf
  s_waitcnt lgkmcnt(1)
  v_mfma_f32_32x32x16_bf16 v[40:55], v[112:115], a[224:227], v[40:55]
  v_add_f32_dpp v137, v137, v137 row_ror:4 row_mask:0xf bank_mask:0xf
  v_add_f32_dpp v188, v188, v188 row_ror:4 row_mask:0xf bank_mask:0xf
  v_add_f32_dpp v136, v136, v136 row_ror:2 row_mask:0xf bank_mask:0xf
  v_add_f32_dpp v137, v137, v137 row_ror:2 row_mask:0xf bank_mask:0xf
  v_add_f32_dpp v188, v188, v188 row_ror:2 row_mask:0xf bank_mask:0xf
  v_add_f32_dpp v136, v136, v136 row_ror:1 row_mask:0xf bank_mask:0xf
  v_mfma_f32_32x32x16_bf16 v[56:71], v[112:115], a[228:231], v[56:71]
  v_add_f32_dpp v137, v137, v137 row_ror:1 row_mask:0xf bank_mask:0xf
  v_add_f32_dpp v188, v188, v188 row_ror:1 row_mask:0xf bank_mask:0xf
  v_mov_b32 v140, v136
  v_mov_b32 v141, v137
  v_mov_b32 v142, v188
  v_permlane16_swap_b32 v136, v140
  v_mfma_f32_32x32x16_bf16 v[72:87], v[112:115], a[232:235], v[72:87]
  v_permlane16_swap_b32 v137, v141
  v_permlane16_swap_b32 v188, v142
  v_add_f32 v136, v136, v140
  v_add_f32 v137, v137, v141
  v_mfma_f32_32x32x16_bf16 v[88:103], v[112:115], a[236:239], v[88:103]
  v_add_f32 v188, v188, v142
  v_mov_b32 v140, v136
  v_mov_b32 v141, v137
  v_mov_b32 v142, v188
  v_permlane32_swap_b32 v136, v140
  s_waitcnt lgkmcnt(0)
  v_mfma_f32_32x32x16_bf16 v[40:55], v[116:119], a[240:243], v[40:55]
  v_permlane32_swap_b32 v137, v141
  v_permlane32_swap_b32 v188, v142
  v_add_f32 v136, v136, v140
  v_add_f32 v137, v137, v141
  v_mfma_f32_32x32x16_bf16 v[56:71], v[116:119], a[244:247], v[56:71]
  v_add_f32 v188, v188, v142
  v_mul_f32 v136, 0x3b000000, v136
  v_mul_f32 v137, 0x3b000000, v137
  v_fma_f32 v137, -v136, v136, v137
  v_cvt_pk_bf16_f32 v136, 0, v136
  v_max_f32 v137, 0, v137
  v_mfma_f32_32x32x16_bf16 v[72:87], v[116:119], a[248:251], v[72:87]
  v_sub_f32 v140, v196, v136
  v_sub_f32 v141, v197, v136
  v_cvt_pk_bf16_f32 v137, 0, v137
  v_sub_f32 v142, v198, v136
  v_sub_f32 v143, v199, v136
  v_add_f32 v137, 0x3727c5ac, v137
  v_mfma_f32_32x32x16_bf16 v[88:103], v[116:119], a[252:255], v[88:103]
  v_sub_f32 v144, v200, v136
  v_sub_f32 v145, v201, v136
  v_cvt_pk_bf16_f32 v137, 0, v137
  v_sub_f32 v146, v202, v136
  v_sub_f32 v147, v203, v136
  v_sqrt_f32 v137, v137
  v_cvt_pk_bf16_f32 v140, 0, v140
  v_cvt_pk_bf16_f32 v141, 0, v141
  v_cvt_pk_bf16_f32 v137, 0, v137
  v_cvt_pk_bf16_f32 v142, 0, v142
  v_cvt_pk_bf16_f32 v143, 0, v143
  v_rcp_f32 v137, v137
  v_cvt_pk_bf16_f32 v144, 0, v144
  v_cvt_pk_bf16_f32 v145, 0, v145
  v_cvt_pk_bf16_f32 v146, 0, v146
  v_cvt_pk_bf16_f32 v147, 0, v147
  v_mul_f32 v140, v140, v137
  v_mul_f32 v141, v141, v137
  v_mul_f32 v142, v142, v137
  v_mul_f32 v143, v143, v137
  v_mul_f32 v144, v144, v137
  v_mul_f32 v145, v145, v137
  v_mul_f32 v146, v146, v137
  v_mul_f32 v147, v147, v137
  v_cvt_pk_bf16_f32 v132, v140, v141
  v_cvt_pk_bf16_f32 v133, v142, v143
  v_cvt_pk_bf16_f32 v134, v144, v145
  v_cvt_pk_bf16_f32 v135, v146, v147
  buffer_store_dwordx4 v[132:135], v0, s[4:7], s93 offen sc1
  v_cvt_pk_bf16_f32 v188, 0, v188
  v_ashrrev_i32 v189, 31, v188
  v_or_b32 v189, 0x80000000, v189
  v_xor_b32 v188, v188, v189
  s_sub_u32 s92, 4095, s90
  v_and_b32 v188, 0xffff0000, v188
  v_or_b32 v38, s92, v188
  s_bfe_u32 s92, s65, 196625
  s_lshl_b32 s92, s92, 16
  s_lshl_b32 s93, s90, 5
  s_add_u32 s92, s92, s93
  s_add_u32 s84, s92, 243269632
  v_cvt_pk_bf16_f32 v212, v40, v56
  v_cvt_pk_bf16_f32 v213, v72, v88
  s_add_u32 s26, s86, 0
  buffer_store_dwordx2 v[212:213], v4, s[4:7], s26 offen sc1
  v_cvt_pk_bf16_f32 v214, v41, v57
  v_cvt_pk_bf16_f32 v215, v73, v89
  s_add_u32 s26, s86, 16384
  buffer_store_dwordx2 v[214:215], v4, s[4:7], s26 offen sc1
  v_cvt_pk_bf16_f32 v216, v42, v58
  v_cvt_pk_bf16_f32 v217, v74, v90
  s_add_u32 s26, s86, 32768
  buffer_store_dwordx2 v[216:217], v4, s[4:7], s26 offen sc1
  v_cvt_pk_bf16_f32 v218, v43, v59
  v_cvt_pk_bf16_f32 v219, v75, v91
  s_add_u32 s26, s86, 49152
  buffer_store_dwordx2 v[218:219], v4, s[4:7], s26 offen sc1
  v_cvt_pk_bf16_f32 v220, v44, v60
  v_cvt_pk_bf16_f32 v221, v76, v92
  s_add_u32 s26, s86, 131072
  buffer_store_dwordx2 v[220:221], v4, s[4:7], s26 offen sc1
  v_cvt_pk_bf16_f32 v222, v45, v61
  v_cvt_pk_bf16_f32 v223, v77, v93
  s_add_u32 s26, s86, 147456
  buffer_store_dwordx2 v[222:223], v4, s[4:7], s26 offen sc1
  v_cvt_pk_bf16_f32 v224, v46, v62
  v_cvt_pk_bf16_f32 v225, v78, v94
  s_add_u32 s26, s86, 163840
  buffer_store_dwordx2 v[224:225], v4, s[4:7], s26 offen sc1
  v_cvt_pk_bf16_f32 v226, v47, v63
  v_cvt_pk_bf16_f32 v227, v79, v95
  s_add_u32 s26, s86, 180224
  buffer_store_dwordx2 v[226:227], v4, s[4:7], s26 offen sc1
  v_cvt_pk_bf16_f32 v228, v48, v64
  v_cvt_pk_bf16_f32 v229, v80, v96
  s_add_u32 s26, s86, 262144
  buffer_store_dwordx2 v[228:229], v4, s[4:7], s26 offen sc1
  v_cvt_pk_bf16_f32 v230, v49, v65
  v_cvt_pk_bf16_f32 v231, v81, v97
  s_add_u32 s26, s86, 278528
  buffer_store_dwordx2 v[230:231], v4, s[4:7], s26 offen sc1
  v_cvt_pk_bf16_f32 v232, v50, v66
  v_cvt_pk_bf16_f32 v233, v82, v98
  s_add_u32 s26, s86, 294912
  buffer_store_dwordx2 v[232:233], v4, s[4:7], s26 offen sc1
  v_cvt_pk_bf16_f32 v234, v51, v67
  v_cvt_pk_bf16_f32 v235, v83, v99
  s_add_u32 s26, s86, 311296
  buffer_store_dwordx2 v[234:235], v4, s[4:7], s26 offen sc1
  v_cvt_pk_bf16_f32 v236, v52, v68
  v_cvt_pk_bf16_f32 v237, v84, v100
  s_add_u32 s26, s86, 393216
  buffer_store_dwordx2 v[236:237], v4, s[4:7], s26 offen sc1
  v_cvt_pk_bf16_f32 v238, v53, v69
  v_cvt_pk_bf16_f32 v239, v85, v101
  s_add_u32 s26, s86, 409600
  buffer_store_dwordx2 v[238:239], v4, s[4:7], s26 offen sc1
  v_cvt_pk_bf16_f32 v240, v54, v70
  v_cvt_pk_bf16_f32 v241, v86, v102
  s_add_u32 s26, s86, 425984
  buffer_store_dwordx2 v[240:241], v4, s[4:7], s26 offen sc1
  v_cvt_pk_bf16_f32 v242, v55, v71
  v_cvt_pk_bf16_f32 v243, v87, v103
  s_add_u32 s26, s86, 442368
  buffer_store_dwordx2 v[242:243], v4, s[4:7], s26 offen sc1
  s_waitcnt vmcnt(16)
  s_mov_b64 exec, 1
  buffer_store_dword v38, off, s[4:7], s84 sc1
  s_mov_b64 exec, -1
  s_mov_b32 s84, 268435456
  s_branch o_we_130
o_fb_125:
  v_mov_b32 v118, v116
  s_nop 1
  v_permlane16_swap_b32 v116, v118
  v_max_f32 v116, v116, v118
  v_mov_b32 v118, v116
  s_nop 0
  s_nop 0
  v_permlane32_swap_b32 v116, v118
  v_max_f32 v116, v116, v118
  v_sub_f32 v56, v104, v116
  v_sub_f32 v57, v105, v116
  v_sub_f32 v58, v106, v116
  v_sub_f32 v59, v107, v116
  v_sub_f32 v60, v108, v116
  v_sub_f32 v61, v109, v116
  v_sub_f32 v62, v110, v116
  v_sub_f32 v63, v111, v116
  v_sub_f32 v64, v112, v116
  v_sub_f32 v65, v113, v116
  v_exp_f32 v56, v56
  v_exp_f32 v57, v57
  v_exp_f32 v58, v58
  v_exp_f32 v59, v59
  v_exp_f32 v60, v60
  v_exp_f32 v61, v61
  v_exp_f32 v62, v62
  v_exp_f32 v63, v63
  v_exp_f32 v64, v64
  v_exp_f32 v65, v65
  v_add_f32 v117, v56, v57
  v_add_f32 v117, v117, v58
  v_add_f32 v117, v117, v59
  v_add_f32 v117, v117, v60
  v_add_f32 v117, v117, v61
  v_add_f32 v117, v117, v62
  v_add_f32 v117, v117, v63
  v_add_f32 v117, v117, v64
  v_add_f32 v117, v117, v65
  v_mov_b32 v118, v117
  s_nop 0
  s_nop 0
  v_permlane16_swap_b32 v117, v118
  v_add_f32 v117, v117, v118
  v_mov_b32 v118, v117
  s_nop 0
  s_nop 0
  v_permlane32_swap_b32 v117, v118
  v_add_f32 v117, v117, v118
  v_rcp_f32 v117, v117
  s_branch o_fbr_126
o_wr2_129:
  ds_read_b128 v[104:107], v3 offset:0
  ds_read_b128 v[108:111], v3 offset:512
  ds_read_b128 v[112:115], v3 offset:1024
  s_waitcnt lgkmcnt(2)
  v_mfma_f32_32x32x16_bf16 v[40:55], v[104:107], a[0:3], 0
  s_and_b32 s91, s65, 63
  s_lshl_b32 s90, s91, 5
  s_add_u32 s90, s90, s43
  s_lshl_b32 s94, s91, 5
  s_add_u32 s94, s94, s85
  s_lshl_b32 s94, s94, 10
  v_mfma_f32_32x32x16_bf16 v[56:71], v[104:107], a[4:7], 0
  ds_read_b128 v[116:119], v3 offset:1536
  s_lshr_b32 s92, s65, 22
  s_xor_b32 s93, s43, 32
  s_lshl_b32 s91, s90, 10
  s_add_u32 s94, s94, 25165824
  s_cmp_eq_u32 s92, s93
  s_cselect_b32 s92, s94, s91
  v_mfma_f32_32x32x16_bf16 v[72:87], v[104:107], a[8:11], 0
  s_bfe_u32 s26, s64, 131092
  s_and_b32 s87, s64, 0xff
  s_bfe_u32 s88, s64, 0x80008
  v_cmp_eq_u32 vcc, 0, v37
  s_cmp_eq_u64 vcc, 0
  s_cselect_b32 s66, s26, 0
  s_cmp_eq_u32 s66, 1
  s_cselect_b32 s87, s87, 1024
  s_cselect_b32 s34, 0, 0x20000
  v_mfma_f32_32x32x16_bf16 v[88:103], v[104:107], a[12:15], 0
  s_cmp_eq_u32 s26, 3
  s_cselect_b32 s66, 1, s66
  v_cmp_eq_u32 vcc, 0, v245
  s_cmp_eq_u64 vcc, 0
  s_cselect_b32 s76, s26, 0
  s_and_b32 s76, s76, 1
  s_cselect_b32 s88, s88, 1024
  s_waitcnt lgkmcnt(2)
  v_mfma_f32_32x32x16_bf16 v[40:55], v[108:111], a[16:19], v[40:55]
  s_lshl_b32 s32, s88, 18
  s_mov_b32 m0, s40
  s_add_u32 s32, s32, s21
  s_add_u32 s92, s92, 10485760
  buffer_load_dwordx4 v[184:187], v0, s[4:7], s92 offen sc1
  v_mfma_f32_32x32x16_bf16 v[56:71], v[108:111], a[20:23], v[56:71]
  ds_read_b128 v[104:107], v3 offset:2048
  buffer_load_dwordx4 v0, s[4:7], s32 offen offset:0 sc1 lds
  s_mov_b64 exec, 1
  buffer_store_dword v38, off, s[4:7], s84 sc1
  s_mov_b64 exec, -1
  v_mfma_f32_32x32x16_bf16 v[72:87], v[108:111], a[24:27], v[72:87]
  s_waitcnt vmcnt(15)
  v_mfma_f32_16x16x32_bf16 v[188:191], v[16:19], v[120:123], 0
  v_mfma_f32_16x16x32_bf16 v[192:195], v[16:19], v[124:127], 0
  v_mfma_f32_16x16x32_bf16 v[188:191], v[20:23], v[128:131], v[188:191]
  v_mfma_f32_32x32x16_bf16 v[88:103], v[108:111], a[28:31], v[88:103]
  buffer_load_dwordx4 v0, s[4:7], s32 offen offset:1024 sc1 lds
  v_mfma_f32_16x16x32_bf16 v[192:195], v[20:23], v[132:135], v[192:195]
  s_waitcnt lgkmcnt(2)
  v_mfma_f32_32x32x16_bf16 v[40:55], v[112:115], a[32:35], v[40:55]
  s_waitcnt vmcnt(12)
  v_mfma_f32_16x16x32_bf16 v[188:191], v[16:19], v[136:139], v[188:191]
  v_mfma_f32_16x16x32_bf16 v[192:195], v[16:19], v[140:143], v[192:195]
  v_mfma_f32_16x16x32_bf16 v[188:191], v[20:23], v[144:147], v[188:191]
  v_mfma_f32_32x32x16_bf16 v[56:71], v[112:115], a[36:39], v[56:71]
  ds_read_b128 v[108:111], v3 offset:2560
  buffer_load_dwordx4 v0, s[4:7], s32 offen offset:2048 sc1 lds
  s_lshl_b32 s33, s87, 18
  s_lshl_b32 s32, s87, 19
  v_mfma_f32_32x32x16_bf16 v[72:87], v[112:115], a[40:43], v[72:87]
  s_add_u32 m0, s22, s34
  s_add_u32 s33, s33, s19
  v_mfma_f32_16x16x32_bf16 v[192:195], v[20:23], v[148:151], v[192:195]
  s_waitcnt vmcnt(9)
  v_mfma_f32_16x16x32_bf16 v[188:191], v[16:19], v[152:155], v[188:191]
  v_mfma_f32_32x32x16_bf16 v[88:103], v[112:115], a[44:47], v[88:103]
  buffer_load_dwordx4 v0, s[4:7], s33 offen offset:0 sc1 lds
  v_mfma_f32_16x16x32_bf16 v[192:195], v[16:19], v[156:159], v[192:195]
  s_waitcnt lgkmcnt(2)
  v_mfma_f32_32x32x16_bf16 v[40:55], v[116:119], a[48:51], v[40:55]
  v_mfma_f32_16x16x32_bf16 v[188:191], v[20:23], v[160:163], v[188:191]
  v_mfma_f32_16x16x32_bf16 v[192:195], v[20:23], v[164:167], v[192:195]
  s_waitcnt vmcnt(6)
  v_mfma_f32_16x16x32_bf16 v[188:191], v[16:19], v[168:171], v[188:191]
  v_mfma_f32_32x32x16_bf16 v[56:71], v[116:119], a[52:55], v[56:71]
  ds_read_b128 v[112:115], v3 offset:3072
  buffer_load_dwordx4 v0, s[4:7], s33 offen offset:1024 sc1 lds
  v_mfma_f32_16x16x32_bf16 v[192:195], v[16:19], v[172:175], v[192:195]
  v_mfma_f32_32x32x16_bf16 v[72:87], v[116:119], a[56:59], v[72:87]
  v_mfma_f32_16x16x32_bf16 v[188:191], v[20:23], v[176:179], v[188:191]
  v_mfma_f32_16x16x32_bf16 v[192:195], v[20:23], v[180:183], v[192:195]
  s_bfe_u32 s92, s65, 131086
  s_lshl_b32 s92, s92, 21
  v_mfma_f32_32x32x16_bf16 v[88:103], v[116:119], a[60:63], v[88:103]
  buffer_load_dwordx4 v0, s[4:7], s33 offen offset:2048 sc1 lds
  s_add_u32 s92, s92, s91
  s_add_u32 s93, s92, 27262976
  s_waitcnt lgkmcnt(2)
  v_mfma_f32_32x32x16_bf16 v[40:55], v[104:107], a[64:67], v[40:55]
  s_add_u32 s92, s92, 20971520
  s_waitcnt vmcnt(7)
  v_lshlrev_b32 v196, 16, v184
  v_and_b32 v197, 0xffff0000, v184
  v_lshlrev_b32 v198, 16, v185
  v_and_b32 v199, 0xffff0000, v185
  v_mfma_f32_32x32x16_bf16 v[56:71], v[104:107], a[68:71], v[56:71]
  ds_read_b128 v[116:119], v3 offset:3584
  buffer_load_dwordx4 v0, s[4:7], s33 offen offset:3072 sc1 lds
  s_add_u32 m0, s23, s34
  s_add_u32 s32, s32, s18
  v_mfma_f32_32x32x16_bf16 v[72:87], v[104:107], a[72:75], v[72:87]
  v_lshlrev_b32 v200, 16, v186
  v_and_b32 v201, 0xffff0000, v186
  v_lshlrev_b32 v202, 16, v187
  v_and_b32 v203, 0xffff0000, v187
  v_permlane16_swap_b32 v188, v192
  v_mfma_f32_32x32x16_bf16 v[88:103], v[104:107], a[76:79], v[88:103]
  buffer_load_dwordx4 v0, s[4:7], s32 offen offset:0 sc1 lds
  v_permlane16_swap_b32 v189, v193
  s_waitcnt lgkmcnt(2)
  v_mfma_f32_32x32x16_bf16 v[40:55], v[108:111], a[80:83], v[40:55]
  v_permlane16_swap_b32 v190, v194
  v_permlane16_swap_b32 v191, v195
  v_cvt_pk_bf16_f32 v188, 0, v188
  v_cvt_pk_bf16_f32 v189, 0, v189
  v_mfma_f32_32x32x16_bf16 v[56:71], v[108:111], a[84:87], v[56:71]
  ds_read_b128 v[104:107], v3 offset:8192
  buffer_load_dwordx4 v0, s[4:7], s32 offen offset:1024 sc1 lds
  v_cvt_pk_bf16_f32 v190, 0, v190
  v_cvt_pk_bf16_f32 v191, 0, v191
  v_mfma_f32_32x32x16_bf16 v[72:87], v[108:111], a[88:91], v[72:87]
  v_cvt_pk_bf16_f32 v192, 0, v192
  v_cvt_pk_bf16_f32 v193, 0, v193
  v_cvt_pk_bf16_f32 v194, 0, v194
  v_cvt_pk_bf16_f32 v195, 0, v195
  v_add_f32 v196, v196, v188
  v_add_f32 v197, v197, v189
  v_mfma_f32_32x32x16_bf16 v[88:103], v[108:111], a[92:95], v[88:103]
  buffer_load_dwordx4 v0, s[4:7], s32 offen offset:2048 sc1 lds
  v_add_f32 v198, v198, v190
  v_add_f32 v199, v199, v191
  s_waitcnt lgkmcnt(2)
  v_mfma_f32_32x32x16_bf16 v[40:55], v[112:115], a[96:99], v[40:55]
  v_add_f32 v200, v200, v192
  v_add_f32 v201, v201, v193
  v_add_f32 v202, v202, v194
  v_add_f32 v203, v203, v195
  v_cvt_pk_bf16_f32 v120, v196, v197
  v_cvt_pk_bf16_f32 v121, v198, v199
  v_mfma_f32_32x32x16_bf16 v[56:71], v[112:115], a[100:103], v[56:71]
  ds_read_b128 v[108:111], v3 offset:8704
  buffer_load_dwordx4 v0, s[4:7], s32 offen offset:3072 sc1 lds
  s_add_u32 m0, m0, 4096
  s_add_u32 s32, s32, 4096
  v_mfma_f32_32x32x16_bf16 v[72:87], v[112:115], a[104:107], v[72:87]
  v_cvt_pk_bf16_f32 v122, v200, v201
  v_cvt_pk_bf16_f32 v123, v202, v203
  v_lshlrev_b32 v196, 16, v120
  v_and_b32 v197, 0xffff0000, v120
  v_lshlrev_b32 v198, 16, v121
  v_and_b32 v199, 0xffff0000, v121
  v_mfma_f32_32x32x16_bf16 v[88:103], v[112:115], a[108:111], v[88:103]
  buffer_load_dwordx4 v0, s[4:7], s32 offen offset:0 sc1 lds
  v_lshlrev_b32 v200, 16, v122
  v_and_b32 v201, 0xffff0000, v122
  s_waitcnt lgkmcnt(2)
  v_mfma_f32_32x32x16_bf16 v[40:55], v[116:119], a[112:115], v[40:55]
  v_lshlrev_b32 v202, 16, v123
  v_and_b32 v203, 0xffff0000, v123
  buffer_store_dwordx4 v[120:123], v0, s[4:7], s92 offen sc1
  v_add_f32 v136, v196, v197
  v_mfma_f32_32x32x16_bf16 v[56:71], v[116:119], a[116:119], v[56:71]
  ds_read_b128 v[112:115], v3 offset:9216
  buffer_load_dwordx4 v0, s[4:7], s32 offen offset:1024 sc1 lds
  v_mul_f32 v137, v196, v196
  v_add_f32 v138, v198, v199
  v_mfma_f32_32x32x16_bf16 v[72:87], v[116:119], a[120:123], v[72:87]
  v_mul_f32 v139, v197, v197
  v_fmac_f32 v137, v198, v198
  v_fmac_f32 v139, v199, v199
  v_add_f32 v136, v136, v200
  v_fmac_f32 v137, v200, v200
  v_add_f32 v138, v138, v201
  v_mfma_f32_32x32x16_bf16 v[88:103], v[116:119], a[124:127], v[88:103]
  buffer_load_dwordx4 v0, s[4:7], s32 offen offset:2048 sc1 lds
  v_fmac_f32 v139, v201, v201
  v_add_f32 v136, v136, v202
  s_waitcnt lgkmcnt(2)
  v_mfma_f32_32x32x16_bf16 v[40:55], v[104:107], a[128:131], v[40:55]
  v_fmac_f32 v137, v202, v202
  v_add_f32 v138, v138, v203
  v_fmac_f32 v139, v203, v203
  v_add_f32 v136, v136, v138
  v_add_f32 v137, v137, v139
  s_nop 0
  v_add_f32_dpp v136, v136, v136 row_ror:8 row_mask:0xf bank_mask:0xf
  v_mfma_f32_32x32x16_bf16 v[56:71], v[104:107], a[132:135], v[56:71]
  ds_read_b128 v[116:119], v3 offset:9728
  buffer_load_dwordx4 v0, s[4:7], s32 offen offset:3072 sc1 lds
  s_lshl_b32 s26, s76, 1
  s_or_b32 s26, s26, s66
  v_mfma_f32_32x32x16_bf16 v[72:87], v[104:107], a[136:139], v[72:87]
  v_mov_b32 v37, s26
  ds_write_b32 v39, v37
  v_add_f32_dpp v137, v137, v137 row_ror:8 row_mask:0xf bank_mask:0xf
  v_add_f32_dpp v136, v136, v136 row_ror:4 row_mask:0xf bank_mask:0xf
  s_nop 0
  v_add_f32_dpp v137, v137, v137 row_ror:4 row_mask:0xf bank_mask:0xf
  v_mfma_f32_32x32x16_bf16 v[88:103], v[104:107], a[140:143], v[88:103]
  v_add_f32_dpp v136, v136, v136 row_ror:2 row_mask:0xf bank_mask:0xf
  v_add_f32_dpp v137, v137, v137 row_ror:2 row_mask:0xf bank_mask:0xf
  s_nop 0
  v_add_f32_dpp v136, v136, v136 row_ror:1 row_mask:0xf bank_mask:0xf
  v_add_f32_dpp v137, v137, v137 row_ror:1 row_mask:0xf bank_mask:0xf
  v_mov_b32 v140, v136
  s_waitcnt lgkmcnt(3)
  v_mfma_f32_32x32x16_bf16 v[40:55], v[108:111], a[144:147], v[40:55]
  v_mov_b32 v141, v137
  v_permlane16_swap_b32 v136, v140
  s_nop 0
  v_permlane16_swap_b32 v137, v141
  v_add_f32 v136, v136, v140
  v_mfma_f32_32x32x16_bf16 v[56:71], v[108:111], a[148:151], v[56:71]
  ds_read_b128 v[104:107], v3 offset:10240
  v_add_f32 v137, v137, v141
  v_mov_b32 v140, v136
  v_mov_b32 v141, v137
  s_nop 0
  v_permlane32_swap_b32 v136, v140
  v_mfma_f32_32x32x16_bf16 v[72:87], v[108:111], a[152:155], v[72:87]
  v_permlane32_swap_b32 v137, v141
  v_add_f32 v136, v136, v140
  v_add_f32 v137, v137, v141
  v_mul_f32 v136, 0x3b000000, v136
  v_mul_f32 v137, 0x3b000000, v137
  v_mfma_f32_32x32x16_bf16 v[88:103], v[108:111], a[156:159], v[88:103]
  v_fma_f32 v137, -v136, v136, v137
  v_cvt_pk_bf16_f32 v136, 0, v136
  v_max_f32 v137, 0, v137
  v_sub_f32 v140, v196, v136
  v_sub_f32 v141, v197, v136
  s_waitcnt lgkmcnt(3)
  v_mfma_f32_32x32x16_bf16 v[40:55], v[112:115], a[160:163], v[40:55]
  v_cvt_pk_bf16_f32 v137, 0, v137
  v_sub_f32 v142, v198, v136
  v_sub_f32 v143, v199, v136
  v_add_f32 v137, 0x3727c5ac, v137
  v_sub_f32 v144, v200, v136
  v_sub_f32 v145, v201, v136
  v_mfma_f32_32x32x16_bf16 v[56:71], v[112:115], a[164:167], v[56:71]
  ds_read_b128 v[108:111], v3 offset:10752
  v_cvt_pk_bf16_f32 v137, 0, v137
  v_sub_f32 v146, v202, v136
  v_sub_f32 v147, v203, v136
  v_sqrt_f32 v137, v137
  v_mfma_f32_32x32x16_bf16 v[72:87], v[112:115], a[168:171], v[72:87]
  v_cvt_pk_bf16_f32 v140, 0, v140
  v_cvt_pk_bf16_f32 v141, 0, v141
  v_cvt_pk_bf16_f32 v137, 0, v137
  v_cvt_pk_bf16_f32 v142, 0, v142
  v_cvt_pk_bf16_f32 v143, 0, v143
  v_rcp_f32 v137, v137
  v_mfma_f32_32x32x16_bf16 v[88:103], v[112:115], a[172:175], v[88:103]
  v_cvt_pk_bf16_f32 v144, 0, v144
  v_cvt_pk_bf16_f32 v145, 0, v145
  v_cvt_pk_bf16_f32 v146, 0, v146
  v_cvt_pk_bf16_f32 v147, 0, v147
  v_mul_f32 v140, v140, v137
  s_waitcnt lgkmcnt(3)
  v_mfma_f32_32x32x16_bf16 v[40:55], v[116:119], a[176:179], v[40:55]
  v_mul_f32 v141, v141, v137
  v_mul_f32 v142, v142, v137
  v_mul_f32 v143, v143, v137
  v_mul_f32 v144, v144, v137
  v_mul_f32 v145, v145, v137
  v_mul_f32 v146, v146, v137
  v_mfma_f32_32x32x16_bf16 v[56:71], v[116:119], a[180:183], v[56:71]
  ds_read_b128 v[112:115], v3 offset:11264
  v_mul_f32 v147, v147, v137
  v_cvt_pk_bf16_f32 v124, v140, v141
  v_cvt_pk_bf16_f32 v125, v142, v143
  v_cvt_pk_bf16_f32 v126, v144, v145
  v_cvt_pk_bf16_f32 v127, v146, v147
  v_mfma_f32_32x32x16_bf16 v[72:87], v[116:119], a[184:187], v[72:87]
  v_lshlrev_b32 v204, 16, v124
  v_and_b32 v205, 0xffff0000, v124
  v_lshlrev_b32 v206, 16, v125
  v_and_b32 v207, 0xffff0000, v125
  v_lshlrev_b32 v208, 16, v126
  v_and_b32 v209, 0xffff0000, v126
  v_mfma_f32_32x32x16_bf16 v[88:103], v[116:119], a[188:191], v[88:103]
  v_lshlrev_b32 v210, 16, v127
  v_and_b32 v211, 0xffff0000, v127
  buffer_store_dwordx4 v[124:127], v0, s[4:7], s93 offen sc1
  s_waitcnt lgkmcnt(2)
  v_mfma_f32_32x32x16_bf16 v[40:55], v[104:107], a[192:195], v[40:55]
  v_add_f32 v196, v196, v204
  v_add_f32 v197, v197, v205
  v_add_f32 v198, v198, v206
  v_add_f32 v199, v199, v207
  v_add_f32 v200, v200, v208
  v_add_f32 v201, v201, v209
  v_mfma_f32_32x32x16_bf16 v[56:71], v[104:107], a[196:199], v[56:71]
  ds_read_b128 v[116:119], v3 offset:11776
  v_add_f32 v202, v202, v210
  v_add_f32 v203, v203, v211
  v_cvt_pk_bf16_f32 v128, v196, v197
  v_cvt_pk_bf16_f32 v129, v198, v199
  v_cvt_pk_bf16_f32 v130, v200, v201
  v_mfma_f32_32x32x16_bf16 v[72:87], v[104:107], a[200:203], v[72:87]
  v_cvt_pk_bf16_f32 v131, v202, v203
  v_mul_f32 v188, v204, v8
  v_mul_f32 v189, v205, v9
  v_fmac_f32 v188, v206, v10
  v_fmac_f32 v189, v207, v11
  v_fmac_f32 v188, v208, v12
  v_mfma_f32_32x32x16_bf16 v[88:103], v[104:107], a[204:207], v[88:103]
  v_fmac_f32 v189, v209, v13
  v_fmac_f32 v188, v210, v14
  v_fmac_f32 v189, v211, v15
  v_add_f32 v188, v188, v189
  s_add_u32 s92, s91, 33554432
  s_waitcnt lgkmcnt(2)
  v_mfma_f32_32x32x16_bf16 v[40:55], v[108:111], a[208:211], v[40:55]
  s_bitcmp1_b32 s65, 16
  s_cselect_b64 s[80:81], s[68:69], s[4:5]
  s_cselect_b32 s82, s70, s6
  s_cselect_b32 s92, s91, s92
  buffer_store_dwordx4 v[128:131], v0, s[80:83], s92 offen sc1
  v_mfma_f32_32x32x16_bf16 v[56:71], v[108:111], a[212:215], v[56:71]
  v_add_f32_dpp v188, v188, v188 row_ror:8 row_mask:0xf bank_mask:0xf
  s_nop 1
  v_add_f32_dpp v188, v188, v188 row_ror:4 row_mask:0xf bank_mask:0xf
  s_nop 1
  v_add_f32_dpp v188, v188, v188 row_ror:2 row_mask:0xf bank_mask:0xf
  s_nop 1
  v_add_f32_dpp v188, v188, v188 row_ror:1 row_mask:0xf bank_mask:0xf
  v_mov_b32 v189, v188
  s_nop 0
  s_nop 0
  v_permlane16_swap_b32 v188, v189
  v_mfma_f32_32x32x16_bf16 v[72:87], v[108:111], a[216:219], v[72:87]
  v_add_f32 v188, v188, v189
  v_mov_b32 v189, v188
  s_nop 0
  s_nop 0
  v_permlane32_swap_b32 v188, v189
  v_add_f32 v188, v188, v189
  v_cvt_pk_bf16_f32 v188, 0, v188
  v_mfma_f32_32x32x16_bf16 v[88:103], v[108:111], a[220:223], v[88:103]
  v_ashrrev_i32 v189, 31, v188
  v_or_b32 v189, 0x80000000, v189
  v_xor_b32 v188, v188, v189
  s_sub_u32 s92, 4095, s90
  v_and_b32 v188, 0xffff0000, v188
  s_waitcnt lgkmcnt(1)
  v_mfma_f32_32x32x16_bf16 v[40:55], v[112:115], a[224:227], v[40:55]
  v_or_b32 v38, s92, v188
  s_bfe_u32 s92, s65, 196625
  s_lshl_b32 s92, s92, 16
  s_lshl_b32 s93, s90, 5
  s_add_u32 s92, s92, s93
  s_add_u32 s84, s92, 243269632
  v_mfma_f32_32x32x16_bf16 v[56:71], v[112:115], a[228:231], v[56:71]
  v_mfma_f32_32x32x16_bf16 v[72:87], v[112:115], a[232:235], v[72:87]
  v_mfma_f32_32x32x16_bf16 v[88:103], v[112:115], a[236:239], v[88:103]
  s_waitcnt lgkmcnt(0)
  v_mfma_f32_32x32x16_bf16 v[40:55], v[116:119], a[240:243], v[40:55]
  v_mfma_f32_32x32x16_bf16 v[56:71], v[116:119], a[244:247], v[56:71]
  v_mfma_f32_32x32x16_bf16 v[72:87], v[116:119], a[248:251], v[72:87]
  v_mfma_f32_32x32x16_bf16 v[88:103], v[116:119], a[252:255], v[88:103]
  s_nop 4
  s_nop 3
  s_nop 0
  v_cvt_pk_bf16_f32 v212, v40, v56
  s_nop 0
  v_cvt_pk_bf16_f32 v213, v72, v88
  s_add_u32 s26, s86, 0
  buffer_store_dwordx2 v[212:213], v4, s[4:7], s26 offen sc1
  v_cvt_pk_bf16_f32 v214, v41, v57
  v_cvt_pk_bf16_f32 v215, v73, v89
  s_add_u32 s26, s86, 16384
  buffer_store_dwordx2 v[214:215], v4, s[4:7], s26 offen sc1
  v_cvt_pk_bf16_f32 v216, v42, v58
  v_cvt_pk_bf16_f32 v217, v74, v90
  s_add_u32 s26, s86, 32768
  buffer_store_dwordx2 v[216:217], v4, s[4:7], s26 offen sc1
  v_cvt_pk_bf16_f32 v218, v43, v59
  v_cvt_pk_bf16_f32 v219, v75, v91
  s_add_u32 s26, s86, 49152
  buffer_store_dwordx2 v[218:219], v4, s[4:7], s26 offen sc1
  v_cvt_pk_bf16_f32 v220, v44, v60
  v_cvt_pk_bf16_f32 v221, v76, v92
  s_add_u32 s26, s86, 131072
  buffer_store_dwordx2 v[220:221], v4, s[4:7], s26 offen sc1
  v_cvt_pk_bf16_f32 v222, v45, v61
  v_cvt_pk_bf16_f32 v223, v77, v93
  s_add_u32 s26, s86, 147456
  buffer_store_dwordx2 v[222:223], v4, s[4:7], s26 offen sc1
  v_cvt_pk_bf16_f32 v224, v46, v62
  v_cvt_pk_bf16_f32 v225, v78, v94
  s_add_u32 s26, s86, 163840
  buffer_store_dwordx2 v[224:225], v4, s[4:7], s26 offen sc1
  v_cvt_pk_bf16_f32 v226, v47, v63
  v_cvt_pk_bf16_f32 v227, v79, v95
  s_add_u32 s26, s86, 180224
  buffer_store_dwordx2 v[226:227], v4, s[4:7], s26 offen sc1
  v_cvt_pk_bf16_f32 v228, v48, v64
  v_cvt_pk_bf16_f32 v229, v80, v96
  s_add_u32 s26, s86, 262144
  buffer_store_dwordx2 v[228:229], v4, s[4:7], s26 offen sc1
  v_cvt_pk_bf16_f32 v230, v49, v65
  v_cvt_pk_bf16_f32 v231, v81, v97
  s_add_u32 s26, s86, 278528
  buffer_store_dwordx2 v[230:231], v4, s[4:7], s26 offen sc1
  v_cvt_pk_bf16_f32 v232, v50, v66
  v_cvt_pk_bf16_f32 v233, v82, v98
  s_add_u32 s26, s86, 294912
  buffer_store_dwordx2 v[232:233], v4, s[4:7], s26 offen sc1
  v_cvt_pk_bf16_f32 v234, v51, v67
  v_cvt_pk_bf16_f32 v235, v83, v99
  s_add_u32 s26, s86, 311296
  buffer_store_dwordx2 v[234:235], v4, s[4:7], s26 offen sc1
  v_cvt_pk_bf16_f32 v236, v52, v68
  v_cvt_pk_bf16_f32 v237, v84, v100
  s_add_u32 s26, s86, 393216
  buffer_store_dwordx2 v[236:237], v4, s[4:7], s26 offen sc1
  v_cvt_pk_bf16_f32 v238, v53, v69
  v_cvt_pk_bf16_f32 v239, v85, v101
  s_add_u32 s26, s86, 409600
  buffer_store_dwordx2 v[238:239], v4, s[4:7], s26 offen sc1
  v_cvt_pk_bf16_f32 v240, v54, v70
  v_cvt_pk_bf16_f32 v241, v86, v102
  s_add_u32 s26, s86, 425984
  buffer_store_dwordx2 v[240:241], v4, s[4:7], s26 offen sc1
  v_cvt_pk_bf16_f32 v242, v55, v71
  v_cvt_pk_bf16_f32 v243, v87, v103
  s_add_u32 s26, s86, 442368
  buffer_store_dwordx2 v[242:243], v4, s[4:7], s26 offen sc1
  s_waitcnt vmcnt(18)
o_we_130:
  v_and_b32 v37, -16, v39
  s_waitcnt lgkmcnt(0)
  s_barrier
  ds_read_b128 v[104:107], v37
  s_mov_b32 s65, s63
  s_mov_b32 s79, s42
  s_waitcnt lgkmcnt(0)
  v_and_b32 v104, v104, v105
  v_and_b32 v106, v106, v107
  v_and_b32 v104, v104, v106
  s_nop 0
  v_readfirstlane_b32 s26, v104
  s_and_b32 s66, s26, 1
  s_and_b32 s76, s26, 2
  s_cmp_lg_u32 s76, 0
  s_cbranch_scc1 o_nofl_109
  s_and_b32 s26, s63, 49152
  s_cbranch_scc0 o_fl_110
  s_and_b32 s26, s64, 1097728
  s_cmp_eq_u32 s26, 1048576
  s_cbranch_scc1 o_nofl_109
o_fl_110:
  s_waitcnt vmcnt(0)
  v_mov_b32 v7, s62
  s_mov_b64 exec, 1
  buffer_store_dword v7, off, s[4:7], s79 sc1
  s_mov_b64 exec, -1
  s_mov_b32 s79, 268435456
  s_mov_b64 exec, 1
  buffer_store_dword v38, off, s[4:7], s84 sc1
  s_mov_b64 exec, -1
  s_mov_b32 s84, 268435456
  s_cmp_ge_u32 s17, 2
  s_cbranch_scc1 o_fd_132
  s_cmp_eq_u32 s65, 0
  s_cbranch_scc1 o_fd_132
  s_and_b32 s26, s42, -256
  s_mov_b32 s67, 0
o_wob_134:
  buffer_load_dword v7, v2, s[4:7], s26 offen sc1
  s_add_u32 s67, s67, 1
  s_cmp_gt_u32 s67, 1048576
  s_cbranch_scc1 L_end
  s_waitcnt vmcnt(0)
  v_cmp_gt_u32 vcc, s62, v7
  s_cbranch_vccnz o_wob_134
  s_and_b32 s26, s65, 49152
  s_cbranch_scc1 o_f2_133
  s_lshl_b32 s94, s43, 14
  s_add_u32 s94, s94, s86
  buffer_load_dwordx4 v[120:123], v5, s[4:7], s94 offen offset:0 sc1
  buffer_load_dwordx4 v[124:127], v5, s[4:7], s94 offen offset:256 sc1
  buffer_load_dwordx4 v[128:131], v5, s[4:7], s94 offen offset:512 sc1
  buffer_load_dwordx4 v[132:135], v5, s[4:7], s94 offen offset:768 sc1
  s_add_u32 s94, s94, 4096
  buffer_load_dwordx4 v[136:139], v5, s[4:7], s94 offen offset:0 sc1
  buffer_load_dwordx4 v[140:143], v5, s[4:7], s94 offen offset:256 sc1
  buffer_load_dwordx4 v[144:147], v5, s[4:7], s94 offen offset:512 sc1
  buffer_load_dwordx4 v[148:151], v5, s[4:7], s94 offen offset:768 sc1
  s_add_u32 s94, s94, 4096
  buffer_load_dwordx4 v[152:155], v5, s[4:7], s94 offen offset:0 sc1
  buffer_load_dwordx4 v[156:159], v5, s[4:7], s94 offen offset:256 sc1
  buffer_load_dwordx4 v[160:163], v5, s[4:7], s94 offen offset:512 sc1
  buffer_load_dwordx4 v[164:167], v5, s[4:7], s94 offen offset:768 sc1
  s_add_u32 s94, s94, 4096
  buffer_load_dwordx4 v[168:171], v5, s[4:7], s94 offen offset:0 sc1
  buffer_load_dwordx4 v[172:175], v5, s[4:7], s94 offen offset:256 sc1
  buffer_load_dwordx4 v[176:179], v5, s[4:7], s94 offen offset:512 sc1
  buffer_load_dwordx4 v[180:183], v5, s[4:7], s94 offen offset:768 sc1
  s_and_b32 s91, s65, 63
  s_lshl_b32 s90, s91, 5
  s_add_u32 s90, s90, s43
  s_lshl_b32 s91, s90, 10
  buffer_load_dwordx4 v[184:187], v0, s[72:75], s91 offen
  s_mov_b64 exec, 1
  buffer_store_dword v38, off, s[4:7], s84 sc1
  s_mov_b64 exec, -1
  s_waitcnt vmcnt(14)
  v_mfma_f32_16x16x32_bf16 v[188:191], v[16:19], v[120:123], 0
  v_mfma_f32_16x16x32_bf16 v[192:195], v[16:19], v[124:127], 0
  v_mfma_f32_16x16x32_bf16 v[188:191], v[20:23], v[128:131], v[188:191]
  v_mfma_f32_16x16x32_bf16 v[192:195], v[20:23], v[132:135], v[192:195]
  s_waitcnt vmcnt(10)
  v_mfma_f32_16x16x32_bf16 v[188:191], v[16:19], v[136:139], v[188:191]
  v_mfma_f32_16x16x32_bf16 v[192:195], v[16:19], v[140:143], v[192:195]
  v_mfma_f32_16x16x32_bf16 v[188:191], v[20:23], v[144:147], v[188:191]
  v_mfma_f32_16x16x32_bf16 v[192:195], v[20:23], v[148:151], v[192:195]
  s_waitcnt vmcnt(6)
  v_mfma_f32_16x16x32_bf16 v[188:191], v[16:19], v[152:155], v[188:191]
  v_mfma_f32_16x16x32_bf16 v[192:195], v[16:19], v[156:159], v[192:195]
  v_mfma_f32_16x16x32_bf16 v[188:191], v[20:23], v[160:163], v[188:191]
  v_mfma_f32_16x16x32_bf16 v[192:195], v[20:23], v[164:167], v[192:195]
  s_waitcnt vmcnt(2)
  v_mfma_f32_16x16x32_bf16 v[188:191], v[16:19], v[168:171], v[188:191]
  v_mfma_f32_16x16x32_bf16 v[192:195], v[16:19], v[172:175], v[192:195]
  v_mfma_f32_16x16x32_bf16 v[188:191], v[20:23], v[176:179], v[188:191]
  v_mfma_f32_16x16x32_bf16 v[192:195], v[20:23], v[180:183], v[192:195]
  s_bfe_u32 s92, s65, 131086
  s_lshl_b32 s92, s92, 21
  s_add_u32 s92, s92, s91
  s_add_u32 s93, s92, 27262976
  s_add_u32 s92, s92, 20971520
  s_waitcnt vmcnt(1)
  v_lshlrev_b32 v196, 16, v184
  v_and_b32 v197, 0xffff0000, v184
  v_lshlrev_b32 v198, 16, v185
  v_and_b32 v199, 0xffff0000, v185
  v_lshlrev_b32 v200, 16, v186
  v_and_b32 v201, 0xffff0000, v186
  v_lshlrev_b32 v202, 16, v187
  v_and_b32 v203, 0xffff0000, v187
  v_permlane16_swap_b32 v188, v192
  v_permlane16_swap_b32 v189, v193
  v_permlane16_swap_b32 v190, v194
  v_permlane16_swap_b32 v191, v195
  v_cvt_pk_bf16_f32 v188, 0, v188
  v_cvt_pk_bf16_f32 v189, 0, v189
  v_cvt_pk_bf16_f32 v190, 0, v190
  v_cvt_pk_bf16_f32 v191, 0, v191
  v_cvt_pk_bf16_f32 v192, 0, v192
  v_cvt_pk_bf16_f32 v193, 0, v193
  v_cvt_pk_bf16_f32 v194, 0, v194
  v_cvt_pk_bf16_f32 v195, 0, v195
  v_add_f32 v196, v196, v188
  v_add_f32 v197, v197, v189
  v_add_f32 v198, v198, v190
  v_add_f32 v199, v199, v191
  v_add_f32 v200, v200, v192
  v_add_f32 v201, v201, v193
  v_add_f32 v202, v202, v194
  v_add_f32 v203, v203, v195
  v_cvt_pk_bf16_f32 v120, v196, v197
  v_cvt_pk_bf16_f32 v121, v198, v199
  v_cvt_pk_bf16_f32 v122, v200, v201
  v_cvt_pk_bf16_f32 v123, v202, v203
  v_lshlrev_b32 v196, 16, v120
  v_and_b32 v197, 0xffff0000, v120
  v_lshlrev_b32 v198, 16, v121
  v_and_b32 v199, 0xffff0000, v121
  v_lshlrev_b32 v200, 16, v122
  v_and_b32 v201, 0xffff0000, v122
  v_lshlrev_b32 v202, 16, v123
  v_and_b32 v203, 0xffff0000, v123
  buffer_store_dwordx4 v[120:123], v0, s[4:7], s92 offen sc1
  v_add_f32 v136, v196, v197
  v_mul_f32 v137, v196, v196
  v_add_f32 v138, v198, v199
  v_mul_f32 v139, v197, v197
  v_fmac_f32 v137, v198, v198
  v_fmac_f32 v139, v199, v199
  v_add_f32 v136, v136, v200
  v_fmac_f32 v137, v200, v200
  v_add_f32 v138, v138, v201
  v_fmac_f32 v139, v201, v201
  v_add_f32 v136, v136, v202
  v_fmac_f32 v137, v202, v202
  v_add_f32 v138, v138, v203
  v_fmac_f32 v139, v203, v203
  v_add_f32 v136, v136, v138
  v_add_f32 v137, v137, v139
  s_nop 0
  v_add_f32_dpp v136, v136, v136 row_ror:8 row_mask:0xf bank_mask:0xf
  v_add_f32_dpp v137, v137, v137 row_ror:8 row_mask:0xf bank_mask:0xf
  s_nop 0
  v_add_f32_dpp v136, v136, v136 row_ror:4 row_mask:0xf bank_mask:0xf
  v_add_f32_dpp v137, v137, v137 row_ror:4 row_mask:0xf bank_mask:0xf
  s_nop 0
  v_add_f32_dpp v136, v136, v136 row_ror:2 row_mask:0xf bank_mask:0xf
  v_add_f32_dpp v137, v137, v137 row_ror:2 row_mask:0xf bank_mask:0xf
  s_nop 0
  v_add_f32_dpp v136, v136, v136 row_ror:1 row_mask:0xf bank_mask:0xf
  v_add_f32_dpp v137, v137, v137 row_ror:1 row_mask:0xf bank_mask:0xf
  v_mov_b32 v140, v136
  v_mov_b32 v141, v137
  s_nop 0
  v_permlane16_swap_b32 v136, v140
  v_permlane16_swap_b32 v137, v141
  v_add_f32 v136, v136, v140
  v_add_f32 v137, v137, v141
  v_mov_b32 v140, v136
  v_mov_b32 v141, v137
  s_nop 0
  v_permlane32_swap_b32 v136, v140
  v_permlane32_swap_b32 v137, v141
  v_add_f32 v136, v136, v140
  v_add_f32 v137, v137, v141
  v_mul_f32 v136, 0x3b000000, v136
  v_mul_f32 v137, 0x3b000000, v137
  v_fma_f32 v137, -v136, v136, v137
  v_cvt_pk_bf16_f32 v136, 0, v136
  v_max_f32 v137, 0, v137
  v_sub_f32 v140, v196, v136
  v_sub_f32 v141, v197, v136
  v_cvt_pk_bf16_f32 v137, 0, v137
  v_sub_f32 v142, v198, v136
  v_sub_f32 v143, v199, v136
  v_add_f32 v137, 0x3727c5ac, v137
  v_sub_f32 v144, v200, v136
  v_sub_f32 v145, v201, v136
  v_cvt_pk_bf16_f32 v137, 0, v137
  v_sub_f32 v146, v202, v136
  v_sub_f32 v147, v203, v136
  v_sqrt_f32 v137, v137
  v_cvt_pk_bf16_f32 v140, 0, v140
  v_cvt_pk_bf16_f32 v141, 0, v141
  v_cvt_pk_bf16_f32 v137, 0, v137
  v_cvt_pk_bf16_f32 v142, 0, v142
  v_cvt_pk_bf16_f32 v143, 0, v143
  v_rcp_f32 v137, v137
  v_cvt_pk_bf16_f32 v144, 0, v144
  v_cvt_pk_bf16_f32 v145, 0, v145
  v_cvt_pk_bf16_f32 v146, 0, v146
  v_cvt_pk_bf16_f32 v147, 0, v147
  v_mul_f32 v140, v140, v137
  v_mul_f32 v141, v141, v137
  v_mul_f32 v142, v142, v137
  v_mul_f32 v143, v143, v137
  v_mul_f32 v144, v144, v137
  v_mul_f32 v145, v145, v137
  v_mul_f32 v146, v146, v137
  v_mul_f32 v147, v147, v137
  v_cvt_pk_bf16_f32 v124, v140, v141
  v_cvt_pk_bf16_f32 v125, v142, v143
  v_cvt_pk_bf16_f32 v126, v144, v145
  v_cvt_pk_bf16_f32 v127, v146, v147
  v_lshlrev_b32 v204, 16, v124
  v_and_b32 v205, 0xffff0000, v124
  v_lshlrev_b32 v206, 16, v125
  v_and_b32 v207, 0xffff0000, v125
  v_lshlrev_b32 v208, 16, v126
  v_and_b32 v209, 0xffff0000, v126
  v_lshlrev_b32 v210, 16, v127
  v_and_b32 v211, 0xffff0000, v127
  buffer_store_dwordx4 v[124:127], v0, s[4:7], s93 offen sc1
  v_add_f32 v196, v196, v204
  v_add_f32 v197, v197, v205
  v_add_f32 v198, v198, v206
  v_add_f32 v199, v199, v207
  v_add_f32 v200, v200, v208
  v_add_f32 v201, v201, v209
  v_add_f32 v202, v202, v210
  v_add_f32 v203, v203, v211
  v_cvt_pk_bf16_f32 v128, v196, v197
  v_cvt_pk_bf16_f32 v129, v198, v199
  v_cvt_pk_bf16_f32 v130, v200, v201
  v_cvt_pk_bf16_f32 v131, v202, v203
  v_mul_f32 v188, v204, v8
  v_mul_f32 v189, v205, v9
  v_fmac_f32 v188, v206, v10
  v_fmac_f32 v189, v207, v11
  v_fmac_f32 v188, v208, v12
  v_fmac_f32 v189, v209, v13
  v_fmac_f32 v188, v210, v14
  v_fmac_f32 v189, v211, v15
  v_add_f32 v188, v188, v189
  s_add_u32 s92, s91, 10485760
  s_add_u32 s93, s91, 8388608
  buffer_store_dwordx4 v[128:131], v0, s[4:7], s92 offen sc1
  v_lshlrev_b32 v196, 16, v128
  v_and_b32 v197, 0xffff0000, v128
  v_lshlrev_b32 v198, 16, v129
  v_and_b32 v199, 0xffff0000, v129
  v_lshlrev_b32 v200, 16, v130
  v_and_b32 v201, 0xffff0000, v130
  v_lshlrev_b32 v202, 16, v131
  v_and_b32 v203, 0xffff0000, v131
  v_add_f32 v136, v196, v197
  v_mul_f32 v137, v196, v196
  v_add_f32 v138, v198, v199
  v_mul_f32 v139, v197, v197
  v_fmac_f32 v137, v198, v198
  v_fmac_f32 v139, v199, v199
  v_add_f32 v136, v136, v200
  v_fmac_f32 v137, v200, v200
  v_add_f32 v138, v138, v201
  v_fmac_f32 v139, v201, v201
  v_add_f32 v136, v136, v202
  v_fmac_f32 v137, v202, v202
  v_add_f32 v138, v138, v203
  v_fmac_f32 v139, v203, v203
  v_add_f32 v136, v136, v138
  v_add_f32 v137, v137, v139
  s_nop 0
  v_add_f32_dpp v136, v136, v136 row_ror:8 row_mask:0xf bank_mask:0xf
  v_add_f32_dpp v137, v137, v137 row_ror:8 row_mask:0xf bank_mask:0xf
  v_add_f32_dpp v188, v188, v188 row_ror:8 row_mask:0xf bank_mask:0xf
  v_add_f32_dpp v136, v136, v136 row_ror:4 row_mask:0xf bank_mask:0xf
  v_add_f32_dpp v137, v137, v137 row_ror:4 row_mask:0xf bank_mask:0xf
  v_add_f32_dpp v188, v188, v188 row_ror:4 row_mask:0xf bank_mask:0xf
  v_add_f32_dpp v136, v136, v136 row_ror:2 row_mask:0xf bank_mask:0xf
  v_add_f32_dpp v137, v137, v137 row_ror:2 row_mask:0xf bank_mask:0xf
  v_add_f32_dpp v188, v188, v188 row_ror:2 row_mask:0xf bank_mask:0xf
  v_add_f32_dpp v136, v136, v136 row_ror:1 row_mask:0xf bank_mask:0xf
  v_add_f32_dpp v137, v137, v137 row_ror:1 row_mask:0xf bank_mask:0xf
  v_add_f32_dpp v188, v188, v188 row_ror:1 row_mask:0xf bank_mask:0xf
  v_mov_b32 v140, v136
  v_mov_b32 v141, v137
  v_mov_b32 v142, v188
  v_permlane16_swap_b32 v136, v140
  v_permlane16_swap_b32 v137, v141
  v_permlane16_swap_b32 v188, v142
  v_add_f32 v136, v136, v140
  v_add_f32 v137, v137, v141
  v_add_f32 v188, v188, v142
  v_mov_b32 v140, v136
  v_mov_b32 v141, v137
  v_mov_b32 v142, v188
  v_permlane32_swap_b32 v136, v140
  v_permlane32_swap_b32 v137, v141
  v_permlane32_swap_b32 v188, v142
  v_add_f32 v136, v136, v140
  v_add_f32 v137, v137, v141
  v_add_f32 v188, v188, v142
  v_mul_f32 v136, 0x3b000000, v136
  v_mul_f32 v137, 0x3b000000, v137
  v_fma_f32 v137, -v136, v136, v137
  v_cvt_pk_bf16_f32 v136, 0, v136
  v_max_f32 v137, 0, v137
  v_sub_f32 v140, v196, v136
  v_sub_f32 v141, v197, v136
  v_cvt_pk_bf16_f32 v137, 0, v137
  v_sub_f32 v142, v198, v136
  v_sub_f32 v143, v199, v136
  v_add_f32 v137, 0x3727c5ac, v137
  v_sub_f32 v144, v200, v136
  v_sub_f32 v145, v201, v136
  v_cvt_pk_bf16_f32 v137, 0, v137
  v_sub_f32 v146, v202, v136
  v_sub_f32 v147, v203, v136
  v_sqrt_f32 v137, v137
  v_cvt_pk_bf16_f32 v140, 0, v140
  v_cvt_pk_bf16_f32 v141, 0, v141
  v_cvt_pk_bf16_f32 v137, 0, v137
  v_cvt_pk_bf16_f32 v142, 0, v142
  v_cvt_pk_bf16_f32 v143, 0, v143
  v_rcp_f32 v137, v137
  v_cvt_pk_bf16_f32 v144, 0, v144
  v_cvt_pk_bf16_f32 v145, 0, v145
  v_cvt_pk_bf16_f32 v146, 0, v146
  v_cvt_pk_bf16_f32 v147, 0, v147
  v_mul_f32 v140, v140, v137
  v_mul_f32 v141, v141, v137
  v_mul_f32 v142, v142, v137
  v_mul_f32 v143, v143, v137
  v_mul_f32 v144, v144, v137
  v_mul_f32 v145, v145, v137
  v_mul_f32 v146, v146, v137
  v_mul_f32 v147, v147, v137
  v_cvt_pk_bf16_f32 v132, v140, v141
  v_cvt_pk_bf16_f32 v133, v142, v143
  v_cvt_pk_bf16_f32 v134, v144, v145
  v_cvt_pk_bf16_f32 v135, v146, v147
  buffer_store_dwordx4 v[132:135], v0, s[4:7], s93 offen sc1
  v_cvt_pk_bf16_f32 v188, 0, v188
  v_ashrrev_i32 v189, 31, v188
  v_or_b32 v189, 0x80000000, v189
  v_xor_b32 v188, v188, v189
  s_sub_u32 s92, 4095, s90
  v_and_b32 v188, 0xffff0000, v188
  v_or_b32 v38, s92, v188
  s_bfe_u32 s92, s65, 196625
  s_lshl_b32 s92, s92, 16
  s_lshl_b32 s93, s90, 5
  s_add_u32 s92, s92, s93
  s_add_u32 s84, s92, 243269632
  s_waitcnt vmcnt(0)
  s_mov_b64 exec, 1
  buffer_store_dword v38, off, s[4:7], s84 sc1
  s_mov_b64 exec, -1
  s_mov_b32 s84, 268435456
  s_branch o_fd_132
o_f2_133:
  s_lshl_b32 s94, s43, 14
  s_add_u32 s94, s94, s86
  buffer_load_dwordx4 v[120:123], v5, s[4:7], s94 offen offset:0 sc1
  buffer_load_dwordx4 v[124:127], v5, s[4:7], s94 offen offset:256 sc1
  buffer_load_dwordx4 v[128:131], v5, s[4:7], s94 offen offset:512 sc1
  buffer_load_dwordx4 v[132:135], v5, s[4:7], s94 offen offset:768 sc1
  s_add_u32 s94, s94, 4096
  buffer_load_dwordx4 v[136:139], v5, s[4:7], s94 offen offset:0 sc1
  buffer_load_dwordx4 v[140:143], v5, s[4:7], s94 offen offset:256 sc1
  buffer_load_dwordx4 v[144:147], v5, s[4:7], s94 offen offset:512 sc1
  buffer_load_dwordx4 v[148:151], v5, s[4:7], s94 offen offset:768 sc1
  s_add_u32 s94, s94, 4096
  buffer_load_dwordx4 v[152:155], v5, s[4:7], s94 offen offset:0 sc1
  buffer_load_dwordx4 v[156:159], v5, s[4:7], s94 offen offset:256 sc1
  buffer_load_dwordx4 v[160:163], v5, s[4:7], s94 offen offset:512 sc1
  buffer_load_dwordx4 v[164:167], v5, s[4:7], s94 offen offset:768 sc1
  s_add_u32 s94, s94, 4096
  buffer_load_dwordx4 v[168:171], v5, s[4:7], s94 offen offset:0 sc1
  buffer_load_dwordx4 v[172:175], v5, s[4:7], s94 offen offset:256 sc1
  buffer_load_dwordx4 v[176:179], v5, s[4:7], s94 offen offset:512 sc1
  buffer_load_dwordx4 v[180:183], v5, s[4:7], s94 offen offset:768 sc1
  s_and_b32 s91, s65, 63
  s_lshl_b32 s90, s91, 5
  s_add_u32 s90, s90, s43
  s_lshl_b32 s94, s91, 5
  s_add_u32 s94, s94, s85
  s_lshl_b32 s94, s94, 10
  s_lshr_b32 s92, s65, 22
  s_xor_b32 s93, s43, 32
  s_lshl_b32 s91, s90, 10
  s_add_u32 s94, s94, 25165824
  s_cmp_eq_u32 s92, s93
  s_cselect_b32 s92, s94, s91
  s_add_u32 s92, s92, 10485760
  buffer_load_dwordx4 v[184:187], v0, s[4:7], s92 offen sc1
  s_mov_b64 exec, 1
  buffer_store_dword v38, off, s[4:7], s84 sc1
  s_mov_b64 exec, -1
  s_waitcnt vmcnt(14)
  v_mfma_f32_16x16x32_bf16 v[188:191], v[16:19], v[120:123], 0
  v_mfma_f32_16x16x32_bf16 v[192:195], v[16:19], v[124:127], 0
  v_mfma_f32_16x16x32_bf16 v[188:191], v[20:23], v[128:131], v[188:191]
  v_mfma_f32_16x16x32_bf16 v[192:195], v[20:23], v[132:135], v[192:195]
  s_waitcnt vmcnt(10)
  v_mfma_f32_16x16x32_bf16 v[188:191], v[16:19], v[136:139], v[188:191]
  v_mfma_f32_16x16x32_bf16 v[192:195], v[16:19], v[140:143], v[192:195]
  v_mfma_f32_16x16x32_bf16 v[188:191], v[20:23], v[144:147], v[188:191]
  v_mfma_f32_16x16x32_bf16 v[192:195], v[20:23], v[148:151], v[192:195]
  s_waitcnt vmcnt(6)
  v_mfma_f32_16x16x32_bf16 v[188:191], v[16:19], v[152:155], v[188:191]
  v_mfma_f32_16x16x32_bf16 v[192:195], v[16:19], v[156:159], v[192:195]
  v_mfma_f32_16x16x32_bf16 v[188:191], v[20:23], v[160:163], v[188:191]
  v_mfma_f32_16x16x32_bf16 v[192:195], v[20:23], v[164:167], v[192:195]
  s_waitcnt vmcnt(2)
  v_mfma_f32_16x16x32_bf16 v[188:191], v[16:19], v[168:171], v[188:191]
  v_mfma_f32_16x16x32_bf16 v[192:195], v[16:19], v[172:175], v[192:195]
  v_mfma_f32_16x16x32_bf16 v[188:191], v[20:23], v[176:179], v[188:191]
  v_mfma_f32_16x16x32_bf16 v[192:195], v[20:23], v[180:183], v[192:195]
  s_bfe_u32 s92, s65, 131086
  s_lshl_b32 s92, s92, 21
  s_add_u32 s92, s92, s91
  s_add_u32 s93, s92, 27262976
  s_add_u32 s92, s92, 20971520
  s_waitcnt vmcnt(1)
  v_lshlrev_b32 v196, 16, v184
  v_and_b32 v197, 0xffff0000, v184
  v_lshlrev_b32 v198, 16, v185
  v_and_b32 v199, 0xffff0000, v185
  v_lshlrev_b32 v200, 16, v186
  v_and_b32 v201, 0xffff0000, v186
  v_lshlrev_b32 v202, 16, v187
  v_and_b32 v203, 0xffff0000, v187
  v_permlane16_swap_b32 v188, v192
  v_permlane16_swap_b32 v189, v193
  v_permlane16_swap_b32 v190, v194
  v_permlane16_swap_b32 v191, v195
  v_cvt_pk_bf16_f32 v188, 0, v188
  v_cvt_pk_bf16_f32 v189, 0, v189
  v_cvt_pk_bf16_f32 v190, 0, v190
  v_cvt_pk_bf16_f32 v191, 0, v191
  v_cvt_pk_bf16_f32 v192, 0, v192
  v_cvt_pk_bf16_f32 v193, 0, v193
  v_cvt_pk_bf16_f32 v194, 0, v194
  v_cvt_pk_bf16_f32 v195, 0, v195
  v_add_f32 v196, v196, v188
  v_add_f32 v197, v197, v189
  v_add_f32 v198, v198, v190
  v_add_f32 v199, v199, v191
  v_add_f32 v200, v200, v192
  v_add_f32 v201, v201, v193
  v_add_f32 v202, v202, v194
  v_add_f32 v203, v203, v195
  v_cvt_pk_bf16_f32 v120, v196, v197
  v_cvt_pk_bf16_f32 v121, v198, v199
  v_cvt_pk_bf16_f32 v122, v200, v201
  v_cvt_pk_bf16_f32 v123, v202, v203
  v_lshlrev_b32 v196, 16, v120
  v_and_b32 v197, 0xffff0000, v120
  v_lshlrev_b32 v198, 16, v121
  v_and_b32 v199, 0xffff0000, v121
  v_lshlrev_b32 v200, 16, v122
  v_and_b32 v201, 0xffff0000, v122
  v_lshlrev_b32 v202, 16, v123
  v_and_b32 v203, 0xffff0000, v123
  buffer_store_dwordx4 v[120:123], v0, s[4:7], s92 offen sc1
  v_add_f32 v136, v196, v197
  v_mul_f32 v137, v196, v196
  v_add_f32 v138, v198, v199
  v_mul_f32 v139, v197, v197
  v_fmac_f32 v137, v198, v198
  v_fmac_f32 v139, v199, v199
  v_add_f32 v136, v136, v200
  v_fmac_f32 v137, v200, v200
  v_add_f32 v138, v138, v201
  v_fmac_f32 v139, v201, v201
  v_add_f32 v136, v136, v202
  v_fmac_f32 v137, v202, v202
  v_add_f32 v138, v138, v203
  v_fmac_f32 v139, v203, v203
  v_add_f32 v136, v136, v138
  v_add_f32 v137, v137, v139
  s_nop 0
  v_add_f32_dpp v136, v136, v136 row_ror:8 row_mask:0xf bank_mask:0xf
  v_add_f32_dpp v137, v137, v137 row_ror:8 row_mask:0xf bank_mask:0xf
  s_nop 0
  v_add_f32_dpp v136, v136, v136 row_ror:4 row_mask:0xf bank_mask:0xf
  v_add_f32_dpp v137, v137, v137 row_ror:4 row_mask:0xf bank_mask:0xf
  s_nop 0
  v_add_f32_dpp v136, v136, v136 row_ror:2 row_mask:0xf bank_mask:0xf
  v_add_f32_dpp v137, v137, v137 row_ror:2 row_mask:0xf bank_mask:0xf
  s_nop 0
  v_add_f32_dpp v136, v136, v136 row_ror:1 row_mask:0xf bank_mask:0xf
  v_add_f32_dpp v137, v137, v137 row_ror:1 row_mask:0xf bank_mask:0xf
  v_mov_b32 v140, v136
  v_mov_b32 v141, v137
  s_nop 0
  v_permlane16_swap_b32 v136, v140
  v_permlane16_swap_b32 v137, v141
  v_add_f32 v136, v136, v140
  v_add_f32 v137, v137, v141
  v_mov_b32 v140, v136
  v_mov_b32 v141, v137
  s_nop 0
  v_permlane32_swap_b32 v136, v140
  v_permlane32_swap_b32 v137, v141
  v_add_f32 v136, v136, v140
  v_add_f32 v137, v137, v141
  v_mul_f32 v136, 0x3b000000, v136
  v_mul_f32 v137, 0x3b000000, v137
  v_fma_f32 v137, -v136, v136, v137
  v_cvt_pk_bf16_f32 v136, 0, v136
  v_max_f32 v137, 0, v137
  v_sub_f32 v140, v196, v136
  v_sub_f32 v141, v197, v136
  v_cvt_pk_bf16_f32 v137, 0, v137
  v_sub_f32 v142, v198, v136
  v_sub_f32 v143, v199, v136
  v_add_f32 v137, 0x3727c5ac, v137
  v_sub_f32 v144, v200, v136
  v_sub_f32 v145, v201, v136
  v_cvt_pk_bf16_f32 v137, 0, v137
  v_sub_f32 v146, v202, v136
  v_sub_f32 v147, v203, v136
  v_sqrt_f32 v137, v137
  v_cvt_pk_bf16_f32 v140, 0, v140
  v_cvt_pk_bf16_f32 v141, 0, v141
  v_cvt_pk_bf16_f32 v137, 0, v137
  v_cvt_pk_bf16_f32 v142, 0, v142
  v_cvt_pk_bf16_f32 v143, 0, v143
  v_rcp_f32 v137, v137
  v_cvt_pk_bf16_f32 v144, 0, v144
  v_cvt_pk_bf16_f32 v145, 0, v145
  v_cvt_pk_bf16_f32 v146, 0, v146
  v_cvt_pk_bf16_f32 v147, 0, v147
  v_mul_f32 v140, v140, v137
  v_mul_f32 v141, v141, v137
  v_mul_f32 v142, v142, v137
  v_mul_f32 v143, v143, v137
  v_mul_f32 v144, v144, v137
  v_mul_f32 v145, v145, v137
  v_mul_f32 v146, v146, v137
  v_mul_f32 v147, v147, v137
  v_cvt_pk_bf16_f32 v124, v140, v141
  v_cvt_pk_bf16_f32 v125, v142, v143
  v_cvt_pk_bf16_f32 v126, v144, v145
  v_cvt_pk_bf16_f32 v127, v146, v147
  v_lshlrev_b32 v204, 16, v124
  v_and_b32 v205, 0xffff0000, v124
  v_lshlrev_b32 v206, 16, v125
  v_and_b32 v207, 0xffff0000, v125
  v_lshlrev_b32 v208, 16, v126
  v_and_b32 v209, 0xffff0000, v126
  v_lshlrev_b32 v210, 16, v127
  v_and_b32 v211, 0xffff0000, v127
  buffer_store_dwordx4 v[124:127], v0, s[4:7], s93 offen sc1
  v_add_f32 v196, v196, v204
  v_add_f32 v197, v197, v205
  v_add_f32 v198, v198, v206
  v_add_f32 v199, v199, v207
  v_add_f32 v200, v200, v208
  v_add_f32 v201, v201, v209
  v_add_f32 v202, v202, v210
  v_add_f32 v203, v203, v211
  v_cvt_pk_bf16_f32 v128, v196, v197
  v_cvt_pk_bf16_f32 v129, v198, v199
  v_cvt_pk_bf16_f32 v130, v200, v201
  v_cvt_pk_bf16_f32 v131, v202, v203
  v_mul_f32 v188, v204, v8
  v_mul_f32 v189, v205, v9
  v_fmac_f32 v188, v206, v10
  v_fmac_f32 v189, v207, v11
  v_fmac_f32 v188, v208, v12
  v_fmac_f32 v189, v209, v13
  v_fmac_f32 v188, v210, v14
  v_fmac_f32 v189, v211, v15
  v_add_f32 v188, v188, v189
  s_add_u32 s92, s91, 33554432
  s_bitcmp1_b32 s65, 16
  s_cselect_b64 s[80:81], s[68:69], s[4:5]
  s_cselect_b32 s82, s70, s6
  s_cselect_b32 s92, s91, s92
  buffer_store_dwordx4 v[128:131], v0, s[80:83], s92 offen sc1
  v_add_f32_dpp v188, v188, v188 row_ror:8 row_mask:0xf bank_mask:0xf
  s_nop 1
  v_add_f32_dpp v188, v188, v188 row_ror:4 row_mask:0xf bank_mask:0xf
  s_nop 1
  v_add_f32_dpp v188, v188, v188 row_ror:2 row_mask:0xf bank_mask:0xf
  s_nop 1
  v_add_f32_dpp v188, v188, v188 row_ror:1 row_mask:0xf bank_mask:0xf
  v_mov_b32 v189, v188
  s_nop 0
  s_nop 0
  v_permlane16_swap_b32 v188, v189
  v_add_f32 v188, v188, v189
  v_mov_b32 v189, v188
  s_nop 0
  s_nop 0
  v_permlane32_swap_b32 v188, v189
  v_add_f32 v188, v188, v189
  v_cvt_pk_bf16_f32 v188, 0, v188
  v_ashrrev_i32 v189, 31, v188
  v_or_b32 v189, 0x80000000, v189
  v_xor_b32 v188, v188, v189
  s_sub_u32 s92, 4095, s90
  v_and_b32 v188, 0xffff0000, v188
  v_or_b32 v38, s92, v188
  s_bfe_u32 s92, s65, 196625
  s_lshl_b32 s92, s92, 16
  s_lshl_b32 s93, s90, 5
  s_add_u32 s92, s92, s93
  s_add_u32 s84, s92, 243269632
  s_waitcnt vmcnt(0)
  s_mov_b64 exec, 1
  buffer_store_dword v38, off, s[4:7], s84 sc1
  s_mov_b64 exec, -1
  s_mov_b32 s84, 268435456
o_fd_132:
  s_mov_b32 s65, 0
o_nofl_109:
  s_mov_b32 s63, s64
  s_cmp_lg_u32 s51, 0
  s_cbranch_scc1 o_pick_111
  s_cmp_lg_u32 s50, 0
  s_cbranch_scc1 L_end
  s_add_u32 s49, s49, 4
  s_cmp_lt_u32 s49, 64
  s_cbranch_scc1 o_round_106
  s_mov_b32 s67, 0
  s_mov_b32 s26, 243388416
  v_mov_b32 v193, s46
k_w_135:
  buffer_load_dword v160, v246, s[4:7], s26 offen sc1
  buffer_load_dword v161, v246, s[4:7], s26 offen offset:2048 sc1
  s_add_u32 s67, s67, 1
  s_cmp_gt_u32 s67, 1048576
  s_cbranch_scc1 L_end
  s_waitcnt vmcnt(0)
  v_min_u32 v192, v160, v161
  v_max3_u32 v193, v160, v161, v193
  v_cmp_eq_u32 vcc, 0, v192
  s_cbranch_vccnz k_w_135
  s_add_u32 s26, s26, 4096
  s_cmp_lt_u32 s26, 243400704
  s_cbranch_scc1 k_w_135
  v_max_u32_dpp v193, v193, v193 row_ror:8 row_mask:0xf bank_mask:0xf
  s_nop 1
  v_max_u32_dpp v193, v193, v193 row_ror:4 row_mask:0xf bank_mask:0xf
  s_nop 1
  v_max_u32_dpp v193, v193, v193 row_ror:2 row_mask:0xf bank_mask:0xf
  s_nop 1
  v_max_u32_dpp v193, v193, v193 row_ror:1 row_mask:0xf bank_mask:0xf
  v_mov_b32 v192, v193
  s_nop 0
  s_nop 0
  v_permlane16_swap_b32 v193, v192
  v_max_u32 v193, v193, v192
  v_mov_b32 v192, v193
  s_nop 0
  s_nop 0
  v_permlane32_swap_b32 v193, v192
  v_max_u32 v193, v193, v192
  s_nop 0
  v_readfirstlane_b32 s78, v193
  s_mov_b32 s46, s78
  s_andn2_b32 s52, 0xfff, s46
  s_lshr_b32 s52, s52, 5
  s_min_u32 s52, s52, 64
  s_add_u32 s26, s52, 3
  s_sub_u32 s26, s26, s60
  s_lshr_b32 s26, s26, 2
  s_bfm_b32 s54, s26, 0
  s_andn2_b32 s26, s55, s57
  s_and_b32 s26, s26, s54
  s_andn2_b32 s27, s56, s54
  s_or_b32 s48, s26, s27
  s_cmp_ge_u32 s17, 2
  s_cbranch_scc1 f_done_136
  s_andn2_b32 s28, 0xfff, s46
  s_lshr_b32 s28, s28, 5
  s_lshl_b32 s77, s60, 5
  s_lshl_b32 s26, s61, 1
  s_add_u32 s77, s77, s26
  s_add_u32 s77, s77, s17
  s_add_u32 s26, s28, 3
  s_sub_u32 s26, s26, s60
  s_lshr_b32 s26, s26, 2
  s_lshl_b32 s26, 1, s26
  s_sub_u32 s26, s26, 1
  s_and_b32 s27, s26, s48
  s_mov_b32 s30, 268435456
  s_lshl_b32 s29, s77, 10
  s_add_u32 s31, s29, 33554432
  s_bitcmp1_b32 s27, 0
  s_cselect_b32 s31, s31, s30
  buffer_load_dwordx4 v[168:171], v0, s[4:7], s31 offen sc1
  s_add_u32 s31, s29, 33685504
  s_bitcmp1_b32 s27, 1
  s_cselect_b32 s31, s31, s30
  buffer_load_dwordx4 v[172:175], v0, s[4:7], s31 offen sc1
  s_add_u32 s31, s29, 33816576
  s_bitcmp1_b32 s27, 2
  s_cselect_b32 s31, s31, s30
  buffer_load_dwordx4 v[176:179], v0, s[4:7], s31 offen sc1
  s_add_u32 s31, s29, 33947648
  s_bitcmp1_b32 s27, 3
  s_cselect_b32 s31, s31, s30
  buffer_load_dwordx4 v[180:183], v0, s[4:7], s31 offen sc1
  s_add_u32 s31, s29, 34078720
  s_bitcmp1_b32 s27, 4
  s_cselect_b32 s31, s31, s30
  buffer_load_dwordx4 v[184:187], v0, s[4:7], s31 offen sc1
  s_add_u32 s31, s29, 34209792
  s_bitcmp1_b32 s27, 5
  s_cselect_b32 s31, s31, s30
  buffer_load_dwordx4 v[188:191], v0, s[4:7], s31 offen sc1
  s_add_u32 s31, s29, 34340864
  s_bitcmp1_b32 s27, 6
  s_cselect_b32 s31, s31, s30
  buffer_load_dwordx4 v[192:195], v0, s[4:7], s31 offen sc1
  s_add_u32 s31, s29, 34471936
  s_bitcmp1_b32 s27, 7
  s_cselect_b32 s31, s31, s30
  buffer_load_dwordx4 v[196:199], v0, s[4:7], s31 offen sc1
  s_add_u32 s31, s29, 34603008
  s_bitcmp1_b32 s27, 8
  s_cselect_b32 s31, s31, s30
  buffer_load_dwordx4 v[200:203], v0, s[4:7], s31 offen sc1
  s_add_u32 s31, s29, 34734080
  s_bitcmp1_b32 s27, 9
  s_cselect_b32 s31, s31, s30
  buffer_load_dwordx4 v[204:207], v0, s[4:7], s31 offen sc1
  s_add_u32 s31, s29, 34865152
  s_bitcmp1_b32 s27, 10
  s_cselect_b32 s31, s31, s30
  buffer_load_dwordx4 v[208:211], v0, s[4:7], s31 offen sc1
  s_add_u32 s31, s29, 34996224
  s_bitcmp1_b32 s27, 11
  s_cselect_b32 s31, s31, s30
  buffer_load_dwordx4 v[212:215], v0, s[4:7], s31 offen sc1
  s_add_u32 s31, s29, 35127296
  s_bitcmp1_b32 s27, 12
  s_cselect_b32 s31, s31, s30
  buffer_load_dwordx4 v[216:219], v0, s[4:7], s31 offen sc1
  s_add_u32 s31, s29, 35258368
  s_bitcmp1_b32 s27, 13
  s_cselect_b32 s31, s31, s30
  buffer_load_dwordx4 v[220:223], v0, s[4:7], s31 offen sc1
  s_add_u32 s31, s29, 35389440
  s_bitcmp1_b32 s27, 14
  s_cselect_b32 s31, s31, s30
  buffer_load_dwordx4 v[224:227], v0, s[4:7], s31 offen sc1
  s_add_u32 s31, s29, 35520512
  s_bitcmp1_b32 s27, 15
  s_cselect_b32 s31, s31, s30
  buffer_load_dwordx4 v[228:231], v0, s[4:7], s31 offen sc1
  v_lshlrev_b32 v160, 8, v0
  s_mov_b32 vcc_lo, s26
  s_mov_b32 vcc_hi, 0
  v_mov_b32 v161, 65536
  v_cndmask_b32 v161, v161, 0, vcc
  v_add_u32 v161, v161, v160
  s_lshl_b32 s31, s77, 5
  s_add_u32 s32, s31, 243531776
  s_add_u32 s31, s31, 243400704
  buffer_load_dword v162, v161, s[4:7], s31 offen sc1
  s_add_u32 s31, s29, 0
  s_bitcmp1_b32 s27, 0
  s_cselect_b32 s31, s31, s30
  s_waitcnt vmcnt(16)
  buffer_store_dwordx4 v[168:171], v0, s[68:71], s31 offen sc1
  s_add_u32 s31, s29, 131072
  s_bitcmp1_b32 s27, 1
  s_cselect_b32 s31, s31, s30
  s_waitcnt vmcnt(16)
  buffer_store_dwordx4 v[172:175], v0, s[68:71], s31 offen sc1
  s_add_u32 s31, s29, 262144
  s_bitcmp1_b32 s27, 2
  s_cselect_b32 s31, s31, s30
  s_waitcnt vmcnt(16)
  buffer_store_dwordx4 v[176:179], v0, s[68:71], s31 offen sc1
  s_add_u32 s31, s29, 393216
  s_bitcmp1_b32 s27, 3
  s_cselect_b32 s31, s31, s30
  s_waitcnt vmcnt(16)
  buffer_store_dwordx4 v[180:183], v0, s[68:71], s31 offen sc1
  s_add_u32 s31, s29, 524288
  s_bitcmp1_b32 s27, 4
  s_cselect_b32 s31, s31, s30
  s_waitcnt vmcnt(16)
  buffer_store_dwordx4 v[184:187], v0, s[68:71], s31 offen sc1
  s_add_u32 s31, s29, 655360
  s_bitcmp1_b32 s27, 5
  s_cselect_b32 s31, s31, s30
  s_waitcnt vmcnt(16)
  buffer_store_dwordx4 v[188:191], v0, s[68:71], s31 offen sc1
  s_add_u32 s31, s29, 786432
  s_bitcmp1_b32 s27, 6
  s_cselect_b32 s31, s31, s30
  s_waitcnt vmcnt(16)
  buffer_store_dwordx4 v[192:195], v0, s[68:71], s31 offen sc1
  s_add_u32 s31, s29, 917504
  s_bitcmp1_b32 s27, 7
  s_cselect_b32 s31, s31, s30
  s_waitcnt vmcnt(16)
  buffer_store_dwordx4 v[196:199], v0, s[68:71], s31 offen sc1
  s_add_u32 s31, s29, 1048576
  s_bitcmp1_b32 s27, 8
  s_cselect_b32 s31, s31, s30
  s_waitcnt vmcnt(16)
  buffer_store_dwordx4 v[200:203], v0, s[68:71], s31 offen sc1
  s_add_u32 s31, s29, 1179648
  s_bitcmp1_b32 s27, 9
  s_cselect_b32 s31, s31, s30
  s_waitcnt vmcnt(16)
  buffer_store_dwordx4 v[204:207], v0, s[68:71], s31 offen sc1
  s_add_u32 s31, s29, 1310720
  s_bitcmp1_b32 s27, 10
  s_cselect_b32 s31, s31, s30
  s_waitcnt vmcnt(16)
  buffer_store_dwordx4 v[208:211], v0, s[68:71], s31 offen sc1
  s_add_u32 s31, s29, 1441792
  s_bitcmp1_b32 s27, 11
  s_cselect_b32 s31, s31, s30
  s_waitcnt vmcnt(16)
  buffer_store_dwordx4 v[212:215], v0, s[68:71], s31 offen sc1
  s_add_u32 s31, s29, 1572864
  s_bitcmp1_b32 s27, 12
  s_cselect_b32 s31, s31, s30
  s_waitcnt vmcnt(16)
  buffer_store_dwordx4 v[216:219], v0, s[68:71], s31 offen sc1
  s_add_u32 s31, s29, 1703936
  s_bitcmp1_b32 s27, 13
  s_cselect_b32 s31, s31, s30
  s_waitcnt vmcnt(16)
  buffer_store_dwordx4 v[220:223], v0, s[68:71], s31 offen sc1
  s_add_u32 s31, s29, 1835008
  s_bitcmp1_b32 s27, 14
  s_cselect_b32 s31, s31, s30
  s_waitcnt vmcnt(16)
  buffer_store_dwordx4 v[224:227], v0, s[68:71], s31 offen sc1
  s_add_u32 s31, s29, 1966080
  s_bitcmp1_b32 s27, 15
  s_cselect_b32 s31, s31, s30
  s_waitcnt vmcnt(16)
  buffer_store_dwordx4 v[228:231], v0, s[68:71], s31 offen sc1
  s_mov_b32 vcc_lo, s48
  v_mov_b32 v161, 0x7ff00000
  v_cndmask_b32 v160, v161, v160, vcc
  s_waitcnt vmcnt(0)
  buffer_store_dword v162, v160, s[4:7], s32 offen sc1
f_done_136:
  s_mov_b32 s50, 1
  s_mov_b32 s58, 0xffff
  s_mov_b32 s59, 64
  s_branch o_pick_111

.section .rodata,"a"
.p2align 6
.amdhsa_kernel interleave_layers__memory_aug_recurrent_mem_tr__moe_arch_mod__prompt_kernel
  .amdhsa_next_free_vgpr 512
  .amdhsa_next_free_sgpr 102
  .amdhsa_accum_offset 256
  .amdhsa_group_segment_fixed_size 0
  .amdhsa_kernarg_size 120
  .amdhsa_user_sgpr_count 2
  .amdhsa_user_sgpr_kernarg_segment_ptr 1
  .amdhsa_system_sgpr_workgroup_id_x 1
  .amdhsa_float_denorm_mode_32 3
.end_amdhsa_kernel
```

```asm
; @launch grid=(256,1,1) block=(256,1,1) lds=163840
.amdgcn_target "amdgcn-amd-amdhsa--gfx950"
.text
.globl interleave_layers__memory_aug_recurrent_mem_tr__moe_arch_mod__prompt_kernel
.p2align 8
.type interleave_layers__memory_aug_recurrent_mem_tr__moe_arch_mod__prompt_kernel,@function
interleave_layers__memory_aug_recurrent_mem_tr__moe_arch_mod__prompt_kernel:
  s_cmp_ge_u32 s2, 256
  s_cbranch_scc1 L_end
  s_mov_b32 s6, 268435456
  s_mov_b32 s7, 0x20000
  s_mov_b32 s11, 0x20000
  s_getreg_b32 s89, hwreg(HW_REG_XCC_ID)
  s_and_b32 s89, s89, 7
  v_lshrrev_b32 v1, 6, v0
  s_and_b32 s91, s2, 7
  s_lshr_b32 s90, s2, 3
  v_readfirstlane_b32 s17, v1
  s_lshl_b32 s100, s91, 5
  s_add_u32 s100, s100, s90
  s_lshl_b32 s100, s100, 2
  s_add_u32 s100, s100, s17
  s_lshl_b32 s100, s100, 12
  s_add_u32 s100, s100, 37748736
  s_cmp_lt_u32 s91, 3
  s_cbranch_scc1 L_chain
  s_cmp_eq_u32 s91, 7
  s_cbranch_scc1 L_qkv
  s_bitcmp1_b32 s90, 4
  s_cbranch_scc1 L_qkv
  s_branch L_o
L_end:
  s_endpgm
L_chain:
  s_load_dwordx2 s[4:5], s[0:1], 112
  s_load_dwordx2 s[12:13], s[0:1], 104
  s_mov_b32 s16, s90
  s_mov_b32 s60, s91
  s_min_u32 s61, s91, 1
  v_lshrrev_b32 v18, 6, v0
  v_and_b32 v19, 63, v0
  v_readfirstlane_b32 s17, v18
  v_and_b32 v7, 15, v19
  v_lshrrev_b32 v17, 4, v19
  v_lshlrev_b32 v0, 4, v19
  s_load_dwordx2 s[56:57], s[0:1], 8
  s_mov_b32 s44, 0x05040100
  s_mov_b32 s45, 0x07060302
  s_mov_b32 s18, 0xcccccccc
  s_mov_b32 s19, 0xcccccccc
  s_mov_b32 s24, 0x3e0293ee
  s_lshl_b32 s26, s17, 10
  v_add_u32 v8, s26, v0
  v_xor_b32 v9, 1024, v8
  v_xor_b32 v10, 2048, v8
  v_xor_b32 v11, 3072, v8
  s_mov_b32 s14, 0x3f803f80
  s_mov_b32 s15, 0x3f803f80
  s_mul_i32 s27, s17, 24576
  s_add_u32 s27, s27, 65536
  v_add_u32 v1, s27, v0
  v_lshrrev_b32 v20, 2, v7
  v_xor_b32 v21, v17, v20
  v_lshlrev_b32 v22, 5, v7
  v_add_u32 v22, s26, v22
  v_lshl_add_u32 v2, v21, 3, v22
  v_and_b32 v21, 3, v7
  v_xor_b32 v21, v21, v17
  v_lshl_add_u32 v22, v17, 2, v20
  v_lshlrev_b32 v22, 5, v22
  v_lshl_add_u32 v3, v21, 3, v22
  v_add_u32 v12, s26, v3
  v_xor_b32 v13, 1024, v12
  v_xor_b32 v14, 2048, v12
  v_xor_b32 v15, 3072, v12
  v_lshlrev_b32 v21, 13, v20
  v_and_b32 v22, 3, v7
  v_lshl_add_u32 v22, v17, 2, v22
  v_lshl_add_u32 v21, v22, 4, v21
  s_lshl_b32 s27, s17, 16
  s_lshl_b32 s28, s16, 8
  s_add_u32 s27, s27, s28
  v_add_u32 v4, s27, v21
  v_and_b32 v21, 1, v7
  v_lshl_add_u32 v21, v17, 2, v21
  v_bfe_u32 v22, v7, 2, 1
  v_lshl_add_u32 v21, v22, 1, v21
  v_lshlrev_b32 v21, 4, v21
  v_bfe_u32 v22, v7, 1, 1
  v_lshl_add_u32 v21, v22, 3, v21
  v_add_u32 v5, s28, v21
  v_cmp_lt_u32 vcc, 7, v7
  v_mov_b32 v22, 0x7ff00000
  s_nop 0
  v_cndmask_b32 v5, v5, v22, vcc
  v_mov_b32 v21, 0x4444
  v_mov_b32 v22, 0xeeee
  v_cndmask_b32 v6, v21, v22, s[18:19]
  s_lshl_b32 s40, s60, 20
  s_add_u32 s40, s40, 0
  s_add_u32 s41, s40, 32768
  s_lshl_b32 s62, s60, 16
  s_add_u32 s62, s62, 4194304
  v_mov_b32 v24, -1
  v_mov_b32 v25, -1
  v_mov_b32 v26, -1
  v_mov_b32 v27, -1
  s_waitcnt lgkmcnt(0)
  buffer_store_dwordx4 v[24:27], v4, s[4:7], s40 offen sc1
  buffer_store_dwordx4 v[24:27], v4, s[4:7], s41 offen sc1
  s_add_u32 s27, s62, 0
  buffer_store_dwordx2 v[24:25], v5, s[4:7], s27 offen sc1
  s_add_u32 s27, s62, 8192
  buffer_store_dwordx2 v[24:25], v5, s[4:7], s27 offen sc1
  s_add_u32 s27, s62, 16384
  buffer_store_dwordx2 v[24:25], v5, s[4:7], s27 offen sc1
  s_lshl_b32 s26, s16, 12
  s_cmp_eq_u32 s91, 0
  s_cbranch_scc1 L_ch0
  s_cmp_eq_u32 s91, 2
  s_cbranch_scc1 L_ch2
  v_mov_b64 v[28:29], 0
  v_mov_b64 v[30:31], 0
  s_add_u32 s27, s26, 243269632
  buffer_store_dwordx4 v[28:31], v8, s[4:7], s27 offen sc1
  s_add_u32 s27, s26, 243400704
  buffer_store_dwordx4 v[28:31], v8, s[4:7], s27 offen sc1
  s_add_u32 s27, s26, 243531776
  buffer_store_dwordx4 v[28:31], v8, s[4:7], s27 offen sc1
  s_add_u32 s27, s26, 243662848
  buffer_store_dwordx4 v[28:31], v8, s[4:7], s27 offen sc1
  s_add_u32 s27, s26, 243793920
  buffer_store_dwordx4 v[28:31], v8, s[4:7], s27 offen sc1
  s_add_u32 s27, s26, 243924992
  buffer_store_dwordx4 v[28:31], v8, s[4:7], s27 offen sc1
  s_add_u32 s27, s26, 244056064
  buffer_store_dwordx4 v[28:31], v8, s[4:7], s27 offen sc1
  s_add_u32 s27, s26, 244187136
  buffer_store_dwordx4 v[28:31], v8, s[4:7], s27 offen sc1
  s_add_u32 s27, s26, 244318208
  buffer_store_dwordx4 v[28:31], v8, s[4:7], s27 offen sc1
  s_add_u32 s27, s26, 244449280
  buffer_store_dwordx4 v[28:31], v8, s[4:7], s27 offen sc1
  s_add_u32 s27, s26, 244580352
  buffer_store_dwordx4 v[28:31], v8, s[4:7], s27 offen sc1
  s_add_u32 s27, s26, 244711424
  buffer_store_dwordx4 v[28:31], v8, s[4:7], s27 offen sc1
  s_add_u32 s27, s26, 244842496
  buffer_store_dwordx4 v[28:31], v8, s[4:7], s27 offen sc1
  s_add_u32 s27, s26, 244973568
  buffer_store_dwordx4 v[28:31], v8, s[4:7], s27 offen sc1
  s_add_u32 s27, s26, 245104640
  buffer_store_dwordx4 v[28:31], v8, s[4:7], s27 offen sc1
  s_add_u32 s27, s26, 245235712
  buffer_store_dwordx4 v[28:31], v8, s[4:7], s27 offen sc1
  s_add_u32 s27, s26, 245366784
  buffer_store_dwordx4 v[28:31], v8, s[4:7], s27 offen sc1
  s_branch L_ch0
L_ch2:
  s_add_u32 s27, s26, 245891072
  buffer_store_dwordx4 v[24:27], v8, s[4:7], s27 offen sc1
  s_add_u32 s27, s26, 246022144
  buffer_store_dwordx4 v[24:27], v8, s[4:7], s27 offen sc1
  s_add_u32 s27, s26, 246153216
  buffer_store_dwordx4 v[24:27], v8, s[4:7], s27 offen sc1
  s_add_u32 s27, s26, 246284288
  buffer_store_dwordx4 v[24:27], v8, s[4:7], s27 offen sc1
  s_add_u32 s27, s26, 246415360
  buffer_store_dwordx4 v[24:27], v8, s[4:7], s27 offen sc1
  s_add_u32 s27, s26, 246546432
  buffer_store_dwordx4 v[24:27], v8, s[4:7], s27 offen sc1
  s_add_u32 s27, s26, 246677504
  buffer_store_dwordx4 v[24:27], v8, s[4:7], s27 offen sc1
  s_add_u32 s27, s26, 246808576
  buffer_store_dwordx4 v[24:27], v8, s[4:7], s27 offen sc1
  s_add_u32 s27, s26, 246939648
  buffer_store_dwordx4 v[24:27], v8, s[4:7], s27 offen sc1
  s_add_u32 s27, s26, 247070720
  buffer_store_dwordx4 v[24:27], v8, s[4:7], s27 offen sc1
  s_add_u32 s27, s26, 247201792
  buffer_store_dwordx4 v[24:27], v8, s[4:7], s27 offen sc1
  s_add_u32 s27, s26, 247332864
  buffer_store_dwordx4 v[24:27], v8, s[4:7], s27 offen sc1
  s_add_u32 s27, s26, 247463936
  buffer_store_dwordx4 v[24:27], v8, s[4:7], s27 offen sc1
  s_add_u32 s27, s26, 247595008
  buffer_store_dwordx4 v[24:27], v8, s[4:7], s27 offen sc1
  s_add_u32 s27, s26, 247726080
  buffer_store_dwordx4 v[24:27], v8, s[4:7], s27 offen sc1
  s_add_u32 s27, s26, 247857152
  buffer_store_dwordx4 v[24:27], v8, s[4:7], s27 offen sc1
  s_add_u32 s27, s26, 247988224
  buffer_store_dwordx4 v[24:27], v8, s[4:7], s27 offen sc1
  s_add_u32 s27, s26, 248119296
  buffer_store_dwordx4 v[24:27], v8, s[4:7], s27 offen sc1
  s_add_u32 s27, s26, 248250368
  buffer_store_dwordx4 v[24:27], v8, s[4:7], s27 offen sc1
  s_add_u32 s27, s26, 248381440
  buffer_store_dwordx4 v[24:27], v8, s[4:7], s27 offen sc1
  s_add_u32 s27, s26, 248512512
  buffer_store_dwordx4 v[24:27], v8, s[4:7], s27 offen sc1
  s_add_u32 s27, s26, 248643584
  buffer_store_dwordx4 v[24:27], v8, s[4:7], s27 offen sc1
L_ch0:
  s_waitcnt vmcnt(0)
  s_barrier
  s_cmp_lg_u32 s17, 0
  s_cbranch_scc1 g_ar_1
  s_lshl_b32 s36, s89, 3
  s_lshl_b64 s[36:37], 1, s36
  v_lshlrev_b32 v124, 3, s91
  v_mov_b32 v120, s36
  v_mov_b32 v121, s37
  s_mov_b64 exec, 1
  global_atomic_add_x2 v[122:123], v124, v[120:121], s[12:13] sc0
  s_mov_b64 exec, -1
g_ar_1:
  s_cmp_lg_u32 s91, 1
  s_cbranch_scc1 L_ch1
  s_waitcnt vmcnt(0)
  s_cmp_lg_u32 s17, 0
  s_cbranch_scc1 g_af_2
  v_readfirstlane_b32 s36, v122
  v_readfirstlane_b32 s37, v123
  s_add_u32 s38, s36, s37
  s_mul_i32 s38, s38, 0x01010101
  s_lshr_b32 s38, s38, 24
  s_cmp_lg_u32 s38, 31
  s_cbranch_scc1 g_af_2
  s_lshl_b32 s38, s89, 3
  s_lshr_b64 s[36:37], s[36:37], s38
  s_and_b32 s36, s36, 0xff
  s_cmp_eq_u32 s36, 31
  s_cselect_b32 s36, 1, 2
  v_mov_b32 v120, s36
  v_lshrrev_b32 v124, 1, v124
  s_mov_b64 exec, 1
  global_store_dword v124, v120, s[12:13] offset:128 sc1
  s_mov_b64 exec, -1
g_af_2:
  v_mov_b64 v[122:123], 0
L_ch1:
  s_mov_b32 s58, 8192
  s_mov_b32 s59, 0x20000
  v_and_b32 v21, 1, v7
  v_lshl_add_u32 v21, v17, 1, v21
  v_lshlrev_b32 v21, 10, v21
  v_bfe_u32 v22, v7, 1, 2
  v_lshl_add_u32 v21, v22, 1, v21
  s_lshr_b32 s27, s16, 3
  s_lshl_b32 s27, s27, 8
  s_and_b32 s28, s16, 3
  s_lshl_b32 s28, s28, 6
  s_add_u32 s27, s27, s28
  s_and_b32 s28, s16, 4
  s_lshl_b32 s28, s28, 1
  s_add_u32 s27, s27, s28
  s_waitcnt lgkmcnt(0)
  buffer_load_ushort v28, v21, s[56:59], s27 offen offset:0
  buffer_load_ushort v29, v21, s[56:59], s27 offen offset:16
  buffer_load_ushort v30, v21, s[56:59], s27 offen offset:32
  buffer_load_ushort v31, v21, s[56:59], s27 offen offset:48
  s_load_dwordx2 s[8:9], s[0:1], 40
  s_load_dwordx2 s[52:53], s[0:1], 16
  s_load_dwordx2 s[32:33], s[0:1], 24
  s_load_dwordx2 s[48:49], s[0:1], 32
  s_mov_b32 s10, 4194304
  s_mov_b32 s11, 0x20000
  s_mov_b32 s54, 4194304
  s_mov_b32 s55, 0x20000
  s_mov_b32 s34, 4194304
  s_mov_b32 s35, 0x20000
  s_mov_b32 s50, 4194304
  s_mov_b32 s51, 0x20000
  v_and_b32 v20, 1, v17
  v_lshlrev_b32 v20, 5, v20
  v_lshrrev_b32 v21, 1, v17
  v_lshl_add_u32 v20, v21, 2, v20
  v_lshlrev_b32 v20, 10, v20
  v_lshl_add_u32 v20, v7, 4, v20
  s_lshl_b32 s26, s16, 17
  s_lshl_b32 s27, s17, 8
  s_add_u32 s26, s26, s27
  s_waitcnt lgkmcnt(0)
  s_add_u32 s27, s26, 0
  buffer_load_dwordx4 v[128:131], v20, s[8:11], s27 offen
  s_add_u32 s27, s26, 1024
  buffer_load_dwordx4 v[132:135], v20, s[8:11], s27 offen
  s_add_u32 s27, s26, 16384
  buffer_load_dwordx4 v[136:139], v20, s[8:11], s27 offen
  s_add_u32 s27, s26, 17408
  buffer_load_dwordx4 v[140:143], v20, s[8:11], s27 offen
  s_add_u32 s27, s26, 2048
  buffer_load_dwordx4 v[144:147], v20, s[8:11], s27 offen
  s_add_u32 s27, s26, 3072
  buffer_load_dwordx4 v[148:151], v20, s[8:11], s27 offen
  s_add_u32 s27, s26, 18432
  buffer_load_dwordx4 v[152:155], v20, s[8:11], s27 offen
  s_add_u32 s27, s26, 19456
  buffer_load_dwordx4 v[156:159], v20, s[8:11], s27 offen
  s_add_u32 s27, s26, 8192
  buffer_load_dwordx4 v[160:163], v20, s[8:11], s27 offen
  s_add_u32 s27, s26, 9216
  buffer_load_dwordx4 v[164:167], v20, s[8:11], s27 offen
  s_add_u32 s27, s26, 24576
  buffer_load_dwordx4 v[168:171], v20, s[8:11], s27 offen
  s_add_u32 s27, s26, 25600
  buffer_load_dwordx4 v[172:175], v20, s[8:11], s27 offen
  s_add_u32 s27, s26, 10240
  buffer_load_dwordx4 v[176:179], v20, s[8:11], s27 offen
  s_add_u32 s27, s26, 11264
  buffer_load_dwordx4 v[180:183], v20, s[8:11], s27 offen
  s_add_u32 s27, s26, 26624
  buffer_load_dwordx4 v[184:187], v20, s[8:11], s27 offen
  s_add_u32 s27, s26, 27648
  buffer_load_dwordx4 v[188:191], v20, s[8:11], s27 offen
  s_add_u32 s27, s26, 65536
  buffer_load_dwordx4 v[192:195], v20, s[8:11], s27 offen
  s_add_u32 s27, s26, 66560
  buffer_load_dwordx4 v[196:199], v20, s[8:11], s27 offen
  s_add_u32 s27, s26, 81920
  buffer_load_dwordx4 v[200:203], v20, s[8:11], s27 offen
  s_add_u32 s27, s26, 82944
  buffer_load_dwordx4 v[204:207], v20, s[8:11], s27 offen
  s_add_u32 s27, s26, 67584
  buffer_load_dwordx4 v[208:211], v20, s[8:11], s27 offen
  s_add_u32 s27, s26, 68608
  buffer_load_dwordx4 v[212:215], v20, s[8:11], s27 offen
  s_add_u32 s27, s26, 83968
  buffer_load_dwordx4 v[216:219], v20, s[8:11], s27 offen
  s_add_u32 s27, s26, 84992
  buffer_load_dwordx4 v[220:223], v20, s[8:11], s27 offen
  s_add_u32 s27, s26, 73728
  buffer_load_dwordx4 v[224:227], v20, s[8:11], s27 offen
  s_add_u32 s27, s26, 74752
  buffer_load_dwordx4 v[228:231], v20, s[8:11], s27 offen
  s_add_u32 s27, s26, 90112
  buffer_load_dwordx4 v[232:235], v20, s[8:11], s27 offen
  s_add_u32 s27, s26, 91136
  buffer_load_dwordx4 v[236:239], v20, s[8:11], s27 offen
  s_add_u32 s27, s26, 75776
  buffer_load_dwordx4 v[240:243], v20, s[8:11], s27 offen
  s_add_u32 s27, s26, 76800
  buffer_load_dwordx4 v[244:247], v20, s[8:11], s27 offen
  s_add_u32 s27, s26, 92160
  buffer_load_dwordx4 v[248:251], v20, s[8:11], s27 offen
  s_add_u32 s27, s26, 93184
  buffer_load_dwordx4 v[252:255], v20, s[8:11], s27 offen
  s_waitcnt vmcnt(36)
  s_cmp_lg_u32 s17, 0
  s_cbranch_scc1 g_af_3
  v_readfirstlane_b32 s36, v122
  v_readfirstlane_b32 s37, v123
  s_add_u32 s38, s36, s37
  s_mul_i32 s38, s38, 0x01010101
  s_lshr_b32 s38, s38, 24
  s_cmp_lg_u32 s38, 31
  s_cbranch_scc1 g_af_3
  s_lshl_b32 s38, s89, 3
  s_lshr_b64 s[36:37], s[36:37], s38
  s_and_b32 s36, s36, 0xff
  s_cmp_eq_u32 s36, 31
  s_cselect_b32 s36, 1, 2
  v_mov_b32 v120, s36
  v_lshrrev_b32 v124, 1, v124
  s_mov_b64 exec, 1
  global_store_dword v124, v120, s[12:13] offset:128 sc1
  s_mov_b64 exec, -1
g_af_3:
  v_lshrrev_b32 v20, 8, v0
  v_and_b32 v22, 0xf0, v0
  v_lshlrev_b32 v23, 6, v20
  v_xor_b32 v22, v22, v23
  v_lshl_add_u32 v22, v20, 13, v22
  v_xor_b32 v23, 32, v22
  s_lshr_b32 s26, s17, 1
  s_lshl_b32 s26, s26, 20
  s_and_b32 s27, s17, 1
  s_lshl_b32 s27, s27, 18
  s_add_u32 s26, s26, s27
  s_lshl_b32 s27, s16, 8
  s_add_u32 s26, s26, s27
  s_lshl_b32 s28, s17, 13
  s_add_u32 s27, s26, 0
  s_add_u32 m0, s28, 65536
  s_nop 0
  buffer_load_dwordx4 v22, s[32:35], s27 offen lds
  s_add_u32 m0, s28, 66560
  s_add_u32 s27, s27, 32768
  buffer_load_dwordx4 v22, s[32:35], s27 offen lds
  s_add_u32 m0, s28, 67584
  s_add_u32 s27, s27, 32768
  buffer_load_dwordx4 v23, s[32:35], s27 offen lds
  s_add_u32 m0, s28, 68608
  s_add_u32 s27, s27, 32768
  buffer_load_dwordx4 v23, s[32:35], s27 offen lds
  s_add_u32 m0, s28, 69632
  s_add_u32 s27, s27, 32768
  buffer_load_dwordx4 v22, s[32:35], s27 offen lds
  s_add_u32 m0, s28, 70656
  s_add_u32 s27, s27, 32768
  buffer_load_dwordx4 v22, s[32:35], s27 offen lds
  s_add_u32 m0, s28, 71680
  s_add_u32 s27, s27, 32768
  buffer_load_dwordx4 v23, s[32:35], s27 offen lds
  s_add_u32 m0, s28, 72704
  s_add_u32 s27, s27, 32768
  buffer_load_dwordx4 v23, s[32:35], s27 offen lds
  s_add_u32 s27, s26, 524288
  s_add_u32 m0, s28, 98304
  s_nop 0
  buffer_load_dwordx4 v22, s[32:35], s27 offen lds
  s_add_u32 m0, s28, 99328
  s_add_u32 s27, s27, 32768
  buffer_load_dwordx4 v22, s[32:35], s27 offen lds
  s_add_u32 m0, s28, 100352
  s_add_u32 s27, s27, 32768
  buffer_load_dwordx4 v23, s[32:35], s27 offen lds
  s_add_u32 m0, s28, 101376
  s_add_u32 s27, s27, 32768
  buffer_load_dwordx4 v23, s[32:35], s27 offen lds
  s_add_u32 m0, s28, 102400
  s_add_u32 s27, s27, 32768
  buffer_load_dwordx4 v22, s[32:35], s27 offen lds
  s_add_u32 m0, s28, 103424
  s_add_u32 s27, s27, 32768
  buffer_load_dwordx4 v22, s[32:35], s27 offen lds
  s_add_u32 m0, s28, 104448
  s_add_u32 s27, s27, 32768
  buffer_load_dwordx4 v23, s[32:35], s27 offen lds
  s_add_u32 m0, s28, 105472
  s_add_u32 s27, s27, 32768
  buffer_load_dwordx4 v23, s[32:35], s27 offen lds
  s_waitcnt vmcnt(48)
  v_lshl_or_b32 v28, v29, 16, v28
  v_lshl_or_b32 v29, v31, 16, v30
  v_min_u32 v28, -2, v28
  v_min_u32 v29, -2, v29
  buffer_store_dwordx2 v[28:29], v5, s[4:7], s62 offen sc1
  s_add_u32 s27, s26, 2097152
  s_add_u32 m0, s28, 131072
  s_nop 0
  buffer_load_dwordx4 v22, s[32:35], s27 offen lds
  s_add_u32 m0, s28, 132096
  s_add_u32 s27, s27, 32768
  buffer_load_dwordx4 v22, s[32:35], s27 offen lds
  s_add_u32 m0, s28, 133120
  s_add_u32 s27, s27, 32768
  buffer_load_dwordx4 v23, s[32:35], s27 offen lds
  s_add_u32 m0, s28, 134144
  s_add_u32 s27, s27, 32768
  buffer_load_dwordx4 v23, s[32:35], s27 offen lds
  s_add_u32 m0, s28, 135168
  s_add_u32 s27, s27, 32768
  buffer_load_dwordx4 v22, s[32:35], s27 offen lds
  s_add_u32 m0, s28, 136192
  s_add_u32 s27, s27, 32768
  buffer_load_dwordx4 v22, s[32:35], s27 offen lds
  s_add_u32 m0, s28, 137216
  s_add_u32 s27, s27, 32768
  buffer_load_dwordx4 v23, s[32:35], s27 offen lds
  s_add_u32 m0, s28, 138240
  s_add_u32 s27, s27, 32768
  buffer_load_dwordx4 v23, s[32:35], s27 offen lds
  v_bfe_u32 v20, v7, 2, 1
  v_lshrrev_b32 v21, 3, v7
  v_and_b32 v104, 1, v17
  v_lshl_add_u32 v21, v21, 1, v104
  v_lshl_add_u32 v104, v20, 3, v21
  v_lshrrev_b32 v105, 1, v17
  v_lshl_add_u32 v104, v105, 5, v104
  v_lshl_add_u32 v20, v21, 1, v20
  s_lshl_b32 s29, s17, 1
  v_xor_b32 v20, s29, v20
  v_lshlrev_b32 v20, 5, v20
  v_lshl_add_u32 v20, v104, 8, v20
  v_and_b32 v21, 3, v7
  v_lshl_add_u32 v20, v21, 3, v20
  s_lshr_b32 s29, s17, 1
  s_lshl_b32 s29, s29, 14
  s_and_b32 s30, s17, 1
  s_lshl_b32 s30, s30, 10
  s_add_u32 s29, s29, s30
  s_add_u32 s29, s29, 65536
  v_add_u32 v20, s29, v20
  v_xor_b32 v104, 0, v20
  v_xor_b32 v105, 32, v20
  v_xor_b32 v106, 1024, v20
  v_xor_b32 v107, 1056, v20
  v_xor_b32 v108, 16384, v20
  v_xor_b32 v109, 16416, v20
  v_xor_b32 v110, 17408, v20
  v_xor_b32 v111, 17440, v20
  s_waitcnt vmcnt(49)
  v_perm_b32 v120, v132, v128, s44
  v_perm_b32 v121, v140, v136, s44
  v_perm_b32 v122, v148, v144, s44
  v_perm_b32 v123, v156, v152, s44
  v_accvgpr_write_b32 a248, v120
  v_accvgpr_write_b32 a249, v121
  v_accvgpr_write_b32 a250, v122
  v_accvgpr_write_b32 a251, v123
  v_perm_b32 v124, v132, v128, s45
  v_perm_b32 v125, v140, v136, s45
  v_perm_b32 v126, v148, v144, s45
  v_perm_b32 v127, v156, v152, s45
  v_accvgpr_write_b32 a232, v124
  v_accvgpr_write_b32 a233, v125
  v_accvgpr_write_b32 a234, v126
  v_accvgpr_write_b32 a235, v127
  v_perm_b32 v120, v133, v129, s44
  v_perm_b32 v121, v141, v137, s44
  v_perm_b32 v122, v149, v145, s44
  v_perm_b32 v123, v157, v153, s44
  v_accvgpr_write_b32 a216, v120
  v_accvgpr_write_b32 a217, v121
  v_accvgpr_write_b32 a218, v122
  v_accvgpr_write_b32 a219, v123
  v_perm_b32 v124, v133, v129, s45
  v_perm_b32 v125, v141, v137, s45
  v_perm_b32 v126, v149, v145, s45
  v_perm_b32 v127, v157, v153, s45
  v_accvgpr_write_b32 a200, v124
  v_accvgpr_write_b32 a201, v125
  v_accvgpr_write_b32 a202, v126
  v_accvgpr_write_b32 a203, v127
  v_perm_b32 v120, v134, v130, s44
  v_perm_b32 v121, v142, v138, s44
  v_perm_b32 v122, v150, v146, s44
  v_perm_b32 v123, v158, v154, s44
  v_accvgpr_write_b32 a184, v120
  v_accvgpr_write_b32 a185, v121
  v_accvgpr_write_b32 a186, v122
  v_accvgpr_write_b32 a187, v123
  v_perm_b32 v24, v134, v130, s45
  v_perm_b32 v25, v142, v138, s45
  v_perm_b32 v26, v150, v146, s45
  v_perm_b32 v27, v158, v154, s45
  v_perm_b32 v40, v135, v131, s44
  v_perm_b32 v41, v143, v139, s44
  v_perm_b32 v42, v151, v147, s44
  v_perm_b32 v43, v159, v155, s44
  v_perm_b32 v56, v135, v131, s45
  v_perm_b32 v57, v143, v139, s45
  v_perm_b32 v58, v151, v147, s45
  v_perm_b32 v59, v159, v155, s45
  s_waitcnt vmcnt(41)
  v_perm_b32 v120, v164, v160, s44
  v_perm_b32 v121, v172, v168, s44
  v_perm_b32 v122, v180, v176, s44
  v_perm_b32 v123, v188, v184, s44
  v_accvgpr_write_b32 a252, v120
  v_accvgpr_write_b32 a253, v121
  v_accvgpr_write_b32 a254, v122
  v_accvgpr_write_b32 a255, v123
  v_perm_b32 v124, v164, v160, s45
  v_perm_b32 v125, v172, v168, s45
  v_perm_b32 v126, v180, v176, s45
  v_perm_b32 v127, v188, v184, s45
  v_accvgpr_write_b32 a236, v124
  v_accvgpr_write_b32 a237, v125
  v_accvgpr_write_b32 a238, v126
  v_accvgpr_write_b32 a239, v127
  v_perm_b32 v120, v165, v161, s44
  v_perm_b32 v121, v173, v169, s44
  v_perm_b32 v122, v181, v177, s44
  v_perm_b32 v123, v189, v185, s44
  v_accvgpr_write_b32 a220, v120
  v_accvgpr_write_b32 a221, v121
  v_accvgpr_write_b32 a222, v122
  v_accvgpr_write_b32 a223, v123
  v_perm_b32 v124, v165, v161, s45
  v_perm_b32 v125, v173, v169, s45
  v_perm_b32 v126, v181, v177, s45
  v_perm_b32 v127, v189, v185, s45
  v_accvgpr_write_b32 a204, v124
  v_accvgpr_write_b32 a205, v125
  v_accvgpr_write_b32 a206, v126
  v_accvgpr_write_b32 a207, v127
  v_perm_b32 v120, v166, v162, s44
  v_perm_b32 v121, v174, v170, s44
  v_perm_b32 v122, v182, v178, s44
  v_perm_b32 v123, v190, v186, s44
  v_accvgpr_write_b32 a188, v120
  v_accvgpr_write_b32 a189, v121
  v_accvgpr_write_b32 a190, v122
  v_accvgpr_write_b32 a191, v123
  v_perm_b32 v28, v166, v162, s45
  v_perm_b32 v29, v174, v170, s45
  v_perm_b32 v30, v182, v178, s45
  v_perm_b32 v31, v190, v186, s45
  v_perm_b32 v44, v167, v163, s44
  v_perm_b32 v45, v175, v171, s44
  v_perm_b32 v46, v183, v179, s44
  v_perm_b32 v47, v191, v187, s44
  v_perm_b32 v60, v167, v163, s45
  v_perm_b32 v61, v175, v171, s45
  v_perm_b32 v62, v183, v179, s45
  v_perm_b32 v63, v191, v187, s45
  s_waitcnt vmcnt(33)
  v_perm_b32 v120, v196, v192, s44
  v_perm_b32 v121, v204, v200, s44
  v_perm_b32 v122, v212, v208, s44
  v_perm_b32 v123, v220, v216, s44
  v_accvgpr_write_b32 a240, v120
  v_accvgpr_write_b32 a241, v121
  v_accvgpr_write_b32 a242, v122
  v_accvgpr_write_b32 a243, v123
  v_perm_b32 v124, v196, v192, s45
  v_perm_b32 v125, v204, v200, s45
  v_perm_b32 v126, v212, v208, s45
  v_perm_b32 v127, v220, v216, s45
  v_accvgpr_write_b32 a224, v124
  v_accvgpr_write_b32 a225, v125
  v_accvgpr_write_b32 a226, v126
  v_accvgpr_write_b32 a227, v127
  v_perm_b32 v120, v197, v193, s44
  v_perm_b32 v121, v205, v201, s44
  v_perm_b32 v122, v213, v209, s44
  v_perm_b32 v123, v221, v217, s44
  v_accvgpr_write_b32 a208, v120
  v_accvgpr_write_b32 a209, v121
  v_accvgpr_write_b32 a210, v122
  v_accvgpr_write_b32 a211, v123
  v_perm_b32 v124, v197, v193, s45
  v_perm_b32 v125, v205, v201, s45
  v_perm_b32 v126, v213, v209, s45
  v_perm_b32 v127, v221, v217, s45
  v_accvgpr_write_b32 a192, v124
  v_accvgpr_write_b32 a193, v125
  v_accvgpr_write_b32 a194, v126
  v_accvgpr_write_b32 a195, v127
  v_perm_b32 v120, v198, v194, s44
  v_perm_b32 v121, v206, v202, s44
  v_perm_b32 v122, v214, v210, s44
  v_perm_b32 v123, v222, v218, s44
  v_accvgpr_write_b32 a176, v120
  v_accvgpr_write_b32 a177, v121
  v_accvgpr_write_b32 a178, v122
  v_accvgpr_write_b32 a179, v123
  v_perm_b32 v32, v198, v194, s45
  v_perm_b32 v33, v206, v202, s45
  v_perm_b32 v34, v214, v210, s45
  v_perm_b32 v35, v222, v218, s45
  v_perm_b32 v48, v199, v195, s44
  v_perm_b32 v49, v207, v203, s44
  v_perm_b32 v50, v215, v211, s44
  v_perm_b32 v51, v223, v219, s44
  v_perm_b32 v64, v199, v195, s45
  v_perm_b32 v65, v207, v203, s45
  v_perm_b32 v66, v215, v211, s45
  v_perm_b32 v67, v223, v219, s45
  s_waitcnt vmcnt(25)
  v_perm_b32 v120, v228, v224, s44
  v_perm_b32 v121, v236, v232, s44
  v_perm_b32 v122, v244, v240, s44
  v_perm_b32 v123, v252, v248, s44
  v_accvgpr_write_b32 a244, v120
  v_accvgpr_write_b32 a245, v121
  v_accvgpr_write_b32 a246, v122
  v_accvgpr_write_b32 a247, v123
  v_perm_b32 v124, v228, v224, s45
  v_perm_b32 v125, v236, v232, s45
  v_perm_b32 v126, v244, v240, s45
  v_perm_b32 v127, v252, v248, s45
  v_accvgpr_write_b32 a228, v124
  v_accvgpr_write_b32 a229, v125
  v_accvgpr_write_b32 a230, v126
  v_accvgpr_write_b32 a231, v127
  v_perm_b32 v120, v229, v225, s44
  v_perm_b32 v121, v237, v233, s44
  v_perm_b32 v122, v245, v241, s44
  v_perm_b32 v123, v253, v249, s44
  v_accvgpr_write_b32 a212, v120
  v_accvgpr_write_b32 a213, v121
  v_accvgpr_write_b32 a214, v122
  v_accvgpr_write_b32 a215, v123
  v_perm_b32 v124, v229, v225, s45
  v_perm_b32 v125, v237, v233, s45
  v_perm_b32 v126, v245, v241, s45
  v_perm_b32 v127, v253, v249, s45
  v_accvgpr_write_b32 a196, v124
  v_accvgpr_write_b32 a197, v125
  v_accvgpr_write_b32 a198, v126
  v_accvgpr_write_b32 a199, v127
  v_perm_b32 v120, v230, v226, s44
  v_perm_b32 v121, v238, v234, s44
  v_perm_b32 v122, v246, v242, s44
  v_perm_b32 v123, v254, v250, s44
  v_accvgpr_write_b32 a180, v120
  v_accvgpr_write_b32 a181, v121
  v_accvgpr_write_b32 a182, v122
  v_accvgpr_write_b32 a183, v123
  v_perm_b32 v36, v230, v226, s45
  v_perm_b32 v37, v238, v234, s45
  v_perm_b32 v38, v246, v242, s45
  v_perm_b32 v39, v254, v250, s45
  v_perm_b32 v52, v231, v227, s44
  v_perm_b32 v53, v239, v235, s44
  v_perm_b32 v54, v247, v243, s44
  v_perm_b32 v55, v255, v251, s44
  v_perm_b32 v68, v231, v227, s45
  v_perm_b32 v69, v239, v235, s45
  v_perm_b32 v70, v247, v243, s45
  v_perm_b32 v71, v255, v251, s45
  v_mov_b64 v[128:129], v[24:25]
  v_mov_b64 v[130:131], v[26:27]
  v_mov_b64 v[132:133], v[28:29]
  v_mov_b64 v[134:135], v[30:31]
  v_mov_b64 v[136:137], v[32:33]
  v_mov_b64 v[138:139], v[34:35]
  v_mov_b64 v[140:141], v[36:37]
  v_mov_b64 v[142:143], v[38:39]
  v_mov_b64 v[144:145], v[40:41]
  v_mov_b64 v[146:147], v[42:43]
  v_mov_b64 v[148:149], v[44:45]
  v_mov_b64 v[150:151], v[46:47]
  v_mov_b64 v[152:153], v[48:49]
  v_mov_b64 v[154:155], v[50:51]
  v_mov_b64 v[156:157], v[52:53]
  v_mov_b64 v[158:159], v[54:55]
  v_mov_b64 v[184:185], v[56:57]
  v_mov_b64 v[186:187], v[58:59]
  v_mov_b64 v[188:189], v[60:61]
  v_mov_b64 v[190:191], v[62:63]
  v_mov_b64 v[192:193], v[64:65]
  v_mov_b64 v[194:195], v[66:67]
  v_mov_b64 v[196:197], v[68:69]
  v_mov_b64 v[198:199], v[70:71]
  s_waitcnt vmcnt(17)
  s_barrier
  s_add_u32 s27, s26, 2621440
  s_add_u32 m0, s28, 0
  s_nop 0
  buffer_load_dwordx4 v22, s[32:35], s27 offen lds
  s_add_u32 m0, s28, 1024
  s_add_u32 s27, s27, 32768
  buffer_load_dwordx4 v22, s[32:35], s27 offen lds
  s_add_u32 m0, s28, 2048
  s_add_u32 s27, s27, 32768
  buffer_load_dwordx4 v23, s[32:35], s27 offen lds
  s_add_u32 m0, s28, 3072
  s_add_u32 s27, s27, 32768
  buffer_load_dwordx4 v23, s[32:35], s27 offen lds
  s_add_u32 m0, s28, 4096
  s_add_u32 s27, s27, 32768
  buffer_load_dwordx4 v22, s[32:35], s27 offen lds
  s_add_u32 m0, s28, 5120
  s_add_u32 s27, s27, 32768
  buffer_load_dwordx4 v22, s[32:35], s27 offen lds
  s_add_u32 m0, s28, 6144
  s_add_u32 s27, s27, 32768
  buffer_load_dwordx4 v23, s[32:35], s27 offen lds
  s_add_u32 m0, s28, 7168
  s_add_u32 s27, s27, 32768
  buffer_load_dwordx4 v23, s[32:35], s27 offen lds
  ds_read_b64_tr_b16 v[40:41], v104 offset:0
  ds_read_b64_tr_b16 v[42:43], v104 offset:4096
  ds_read_b64_tr_b16 v[48:49], v105 offset:0
  ds_read_b64_tr_b16 v[50:51], v105 offset:4096
  ds_read_b64_tr_b16 a[72:73], v106 offset:0
  ds_read_b64_tr_b16 a[74:75], v106 offset:4096
  ds_read_b64_tr_b16 a[24:25], v107 offset:0
  ds_read_b64_tr_b16 a[26:27], v107 offset:4096
  ds_read_b64_tr_b16 a[64:65], v108 offset:0
  ds_read_b64_tr_b16 a[66:67], v108 offset:4096
  ds_read_b64_tr_b16 a[16:17], v109 offset:0
  ds_read_b64_tr_b16 a[18:19], v109 offset:4096
  ds_read_b64_tr_b16 a[56:57], v110 offset:0
  ds_read_b64_tr_b16 a[58:59], v110 offset:4096
  ds_read_b64_tr_b16 a[8:9], v111 offset:0
  ds_read_b64_tr_b16 a[10:11], v111 offset:4096
  s_waitcnt lgkmcnt(0)
  s_waitcnt vmcnt(17)
  s_barrier
  s_add_u32 s27, s26, 0
  s_add_u32 m0, s28, 32768
  s_nop 0
  buffer_load_dwordx4 v22, s[52:55], s27 offen lds
  s_add_u32 m0, s28, 33792
  s_add_u32 s27, s27, 32768
  buffer_load_dwordx4 v22, s[52:55], s27 offen lds
  s_add_u32 m0, s28, 34816
  s_add_u32 s27, s27, 32768
  buffer_load_dwordx4 v23, s[52:55], s27 offen lds
  s_add_u32 m0, s28, 35840
  s_add_u32 s27, s27, 32768
  buffer_load_dwordx4 v23, s[52:55], s27 offen lds
  s_add_u32 m0, s28, 36864
  s_add_u32 s27, s27, 32768
  buffer_load_dwordx4 v22, s[52:55], s27 offen lds
  s_add_u32 m0, s28, 37888
  s_add_u32 s27, s27, 32768
  buffer_load_dwordx4 v22, s[52:55], s27 offen lds
  s_add_u32 m0, s28, 38912
  s_add_u32 s27, s27, 32768
  buffer_load_dwordx4 v23, s[52:55], s27 offen lds
  s_add_u32 m0, s28, 39936
  s_add_u32 s27, s27, 32768
  buffer_load_dwordx4 v23, s[52:55], s27 offen lds
  ds_read_b64_tr_b16 v[44:45], v104 offset:32768
  ds_read_b64_tr_b16 v[46:47], v104 offset:36864
  ds_read_b64_tr_b16 v[52:53], v105 offset:32768
  ds_read_b64_tr_b16 v[54:55], v105 offset:36864
  ds_read_b64_tr_b16 a[76:77], v106 offset:32768
  ds_read_b64_tr_b16 a[78:79], v106 offset:36864
  ds_read_b64_tr_b16 a[28:29], v107 offset:32768
  ds_read_b64_tr_b16 a[30:31], v107 offset:36864
  ds_read_b64_tr_b16 a[68:69], v108 offset:32768
  ds_read_b64_tr_b16 a[70:71], v108 offset:36864
  ds_read_b64_tr_b16 a[20:21], v109 offset:32768
  ds_read_b64_tr_b16 a[22:23], v109 offset:36864
  ds_read_b64_tr_b16 a[60:61], v110 offset:32768
  ds_read_b64_tr_b16 a[62:63], v110 offset:36864
  ds_read_b64_tr_b16 a[12:13], v111 offset:32768
  ds_read_b64_tr_b16 a[14:15], v111 offset:36864
  s_waitcnt lgkmcnt(0)
  v_add_u32 v104, 65536, v104
  v_add_u32 v105, 65536, v105
  v_add_u32 v106, 65536, v106
  v_add_u32 v107, 65536, v107
  v_add_u32 v108, 65536, v108
  v_add_u32 v109, 65536, v109
  v_add_u32 v110, 65536, v110
  v_add_u32 v111, 65536, v111
  s_waitcnt vmcnt(16)
  s_barrier
  s_add_u32 s27, s26, 524288
  s_add_u32 m0, s28, 65536
  s_nop 0
  buffer_load_dwordx4 v22, s[52:55], s27 offen lds
  s_add_u32 m0, s28, 66560
  s_add_u32 s27, s27, 32768
  buffer_load_dwordx4 v22, s[52:55], s27 offen lds
  s_add_u32 m0, s28, 67584
  s_add_u32 s27, s27, 32768
  buffer_load_dwordx4 v23, s[52:55], s27 offen lds
  s_add_u32 m0, s28, 68608
  s_add_u32 s27, s27, 32768
  buffer_load_dwordx4 v23, s[52:55], s27 offen lds
  s_add_u32 m0, s28, 69632
  s_add_u32 s27, s27, 32768
  buffer_load_dwordx4 v22, s[52:55], s27 offen lds
  s_add_u32 m0, s28, 70656
  s_add_u32 s27, s27, 32768
  buffer_load_dwordx4 v22, s[52:55], s27 offen lds
  s_add_u32 m0, s28, 71680
  s_add_u32 s27, s27, 32768
  buffer_load_dwordx4 v23, s[52:55], s27 offen lds
  s_add_u32 m0, s28, 72704
  s_add_u32 s27, s27, 32768
  buffer_load_dwordx4 v23, s[52:55], s27 offen lds
  ds_read_b64_tr_b16 v[72:73], v104 offset:0
  ds_read_b64_tr_b16 v[74:75], v104 offset:4096
  ds_read_b64_tr_b16 v[80:81], v105 offset:0
  ds_read_b64_tr_b16 v[82:83], v105 offset:4096
  ds_read_b64_tr_b16 a[48:49], v106 offset:0
  ds_read_b64_tr_b16 a[50:51], v106 offset:4096
  ds_read_b64_tr_b16 a[0:1], v107 offset:0
  ds_read_b64_tr_b16 a[2:3], v107 offset:4096
  ds_read_b64_tr_b16 a[40:41], v108 offset:0
  ds_read_b64_tr_b16 a[42:43], v108 offset:4096
  ds_read_b64_tr_b16 v[248:249], v109 offset:0
  ds_read_b64_tr_b16 v[250:251], v109 offset:4096
  ds_read_b64_tr_b16 a[32:33], v110 offset:0
  ds_read_b64_tr_b16 a[34:35], v110 offset:4096
  ds_read_b64_tr_b16 v[240:241], v111 offset:0
  ds_read_b64_tr_b16 v[242:243], v111 offset:4096
  s_waitcnt lgkmcnt(0)
  v_add_u32 v104, -131072, v104
  v_add_u32 v105, -131072, v105
  v_add_u32 v106, -131072, v106
  v_add_u32 v107, -131072, v107
  v_add_u32 v108, -131072, v108
  v_add_u32 v109, -131072, v109
  v_add_u32 v110, -131072, v110
  v_add_u32 v111, -131072, v111
  s_waitcnt vmcnt(16)
  s_barrier
  s_add_u32 s27, s26, 2097152
  s_add_u32 m0, s28, 98304
  s_nop 0
  buffer_load_dwordx4 v22, s[52:55], s27 offen lds
  s_add_u32 m0, s28, 99328
  s_add_u32 s27, s27, 32768
  buffer_load_dwordx4 v22, s[52:55], s27 offen lds
  s_add_u32 m0, s28, 100352
  s_add_u32 s27, s27, 32768
  buffer_load_dwordx4 v23, s[52:55], s27 offen lds
  s_add_u32 m0, s28, 101376
  s_add_u32 s27, s27, 32768
  buffer_load_dwordx4 v23, s[52:55], s27 offen lds
  s_add_u32 m0, s28, 102400
  s_add_u32 s27, s27, 32768
  buffer_load_dwordx4 v22, s[52:55], s27 offen lds
  s_add_u32 m0, s28, 103424
  s_add_u32 s27, s27, 32768
  buffer_load_dwordx4 v22, s[52:55], s27 offen lds
  s_add_u32 m0, s28, 104448
  s_add_u32 s27, s27, 32768
  buffer_load_dwordx4 v23, s[52:55], s27 offen lds
  s_add_u32 m0, s28, 105472
  s_add_u32 s27, s27, 32768
  buffer_load_dwordx4 v23, s[52:55], s27 offen lds
  ds_read_b64_tr_b16 v[76:77], v104 offset:0
  ds_read_b64_tr_b16 v[78:79], v104 offset:4096
  ds_read_b64_tr_b16 v[84:85], v105 offset:0
  ds_read_b64_tr_b16 v[86:87], v105 offset:4096
  ds_read_b64_tr_b16 a[52:53], v106 offset:0
  ds_read_b64_tr_b16 a[54:55], v106 offset:4096
  ds_read_b64_tr_b16 a[4:5], v107 offset:0
  ds_read_b64_tr_b16 a[6:7], v107 offset:4096
  ds_read_b64_tr_b16 a[44:45], v108 offset:0
  ds_read_b64_tr_b16 a[46:47], v108 offset:4096
  ds_read_b64_tr_b16 v[252:253], v109 offset:0
  ds_read_b64_tr_b16 v[254:255], v109 offset:4096
  ds_read_b64_tr_b16 a[36:37], v110 offset:0
  ds_read_b64_tr_b16 a[38:39], v110 offset:4096
  ds_read_b64_tr_b16 v[244:245], v111 offset:0
  ds_read_b64_tr_b16 v[246:247], v111 offset:4096
  s_waitcnt lgkmcnt(0)
  s_waitcnt vmcnt(16)
  s_barrier
  s_add_u32 s27, s26, 2621440
  s_add_u32 m0, s28, 131072
  s_nop 0
  buffer_load_dwordx4 v22, s[52:55], s27 offen lds
  s_add_u32 m0, s28, 132096
  s_add_u32 s27, s27, 32768
  buffer_load_dwordx4 v22, s[52:55], s27 offen lds
  s_add_u32 m0, s28, 133120
  s_add_u32 s27, s27, 32768
  buffer_load_dwordx4 v23, s[52:55], s27 offen lds
  s_add_u32 m0, s28, 134144
  s_add_u32 s27, s27, 32768
  buffer_load_dwordx4 v23, s[52:55], s27 offen lds
  s_add_u32 m0, s28, 135168
  s_add_u32 s27, s27, 32768
  buffer_load_dwordx4 v22, s[52:55], s27 offen lds
  s_add_u32 m0, s28, 136192
  s_add_u32 s27, s27, 32768
  buffer_load_dwordx4 v22, s[52:55], s27 offen lds
  s_add_u32 m0, s28, 137216
  s_add_u32 s27, s27, 32768
  buffer_load_dwordx4 v23, s[52:55], s27 offen lds
  s_add_u32 m0, s28, 138240
  s_add_u32 s27, s27, 32768
  buffer_load_dwordx4 v23, s[52:55], s27 offen lds
  ds_read_b64_tr_b16 v[24:25], v104 offset:32768
  ds_read_b64_tr_b16 v[26:27], v104 offset:36864
  ds_read_b64_tr_b16 v[32:33], v105 offset:32768
  ds_read_b64_tr_b16 v[34:35], v105 offset:36864
  ds_read_b64_tr_b16 a[168:169], v106 offset:32768
  ds_read_b64_tr_b16 a[170:171], v106 offset:36864
  ds_read_b64_tr_b16 a[120:121], v107 offset:32768
  ds_read_b64_tr_b16 a[122:123], v107 offset:36864
  ds_read_b64_tr_b16 a[160:161], v108 offset:32768
  ds_read_b64_tr_b16 a[162:163], v108 offset:36864
  ds_read_b64_tr_b16 a[112:113], v109 offset:32768
  ds_read_b64_tr_b16 a[114:115], v109 offset:36864
  ds_read_b64_tr_b16 a[152:153], v110 offset:32768
  ds_read_b64_tr_b16 a[154:155], v110 offset:36864
  ds_read_b64_tr_b16 a[104:105], v111 offset:32768
  ds_read_b64_tr_b16 a[106:107], v111 offset:36864
  s_waitcnt lgkmcnt(0)
  v_add_u32 v104, 65536, v104
  v_add_u32 v105, 65536, v105
  v_add_u32 v106, 65536, v106
  v_add_u32 v107, 65536, v107
  v_add_u32 v108, 65536, v108
  v_add_u32 v109, 65536, v109
  v_add_u32 v110, 65536, v110
  v_add_u32 v111, 65536, v111
  s_waitcnt vmcnt(16)
  s_barrier
  s_add_u32 s27, s26, 0
  s_add_u32 m0, s28, 0
  s_nop 0
  buffer_load_dwordx4 v22, s[48:51], s27 offen lds
  s_add_u32 m0, s28, 1024
  s_add_u32 s27, s27, 32768
  buffer_load_dwordx4 v22, s[48:51], s27 offen lds
  s_add_u32 m0, s28, 2048
  s_add_u32 s27, s27, 32768
  buffer_load_dwordx4 v23, s[48:51], s27 offen lds
  s_add_u32 m0, s28, 3072
  s_add_u32 s27, s27, 32768
  buffer_load_dwordx4 v23, s[48:51], s27 offen lds
  s_add_u32 m0, s28, 4096
  s_add_u32 s27, s27, 32768
  buffer_load_dwordx4 v22, s[48:51], s27 offen lds
  s_add_u32 m0, s28, 5120
  s_add_u32 s27, s27, 32768
  buffer_load_dwordx4 v22, s[48:51], s27 offen lds
  s_add_u32 m0, s28, 6144
  s_add_u32 s27, s27, 32768
  buffer_load_dwordx4 v23, s[48:51], s27 offen lds
  s_add_u32 m0, s28, 7168
  s_add_u32 s27, s27, 32768
  buffer_load_dwordx4 v23, s[48:51], s27 offen lds
  ds_read_b64_tr_b16 v[28:29], v104 offset:0
  ds_read_b64_tr_b16 v[30:31], v104 offset:4096
  ds_read_b64_tr_b16 v[36:37], v105 offset:0
  ds_read_b64_tr_b16 v[38:39], v105 offset:4096
  ds_read_b64_tr_b16 a[172:173], v106 offset:0
  ds_read_b64_tr_b16 a[174:175], v106 offset:4096
  ds_read_b64_tr_b16 a[124:125], v107 offset:0
  ds_read_b64_tr_b16 a[126:127], v107 offset:4096
  ds_read_b64_tr_b16 a[164:165], v108 offset:0
  ds_read_b64_tr_b16 a[166:167], v108 offset:4096
  ds_read_b64_tr_b16 a[116:117], v109 offset:0
  ds_read_b64_tr_b16 a[118:119], v109 offset:4096
  ds_read_b64_tr_b16 a[156:157], v110 offset:0
  ds_read_b64_tr_b16 a[158:159], v110 offset:4096
  ds_read_b64_tr_b16 a[108:109], v111 offset:0
  ds_read_b64_tr_b16 a[110:111], v111 offset:4096
  s_waitcnt lgkmcnt(0)
  s_waitcnt vmcnt(16)
  s_barrier
  s_add_u32 s27, s26, 524288
  s_add_u32 m0, s28, 32768
  s_nop 0
  buffer_load_dwordx4 v22, s[48:51], s27 offen lds
  s_add_u32 m0, s28, 33792
  s_add_u32 s27, s27, 32768
  buffer_load_dwordx4 v22, s[48:51], s27 offen lds
  s_add_u32 m0, s28, 34816
  s_add_u32 s27, s27, 32768
  buffer_load_dwordx4 v23, s[48:51], s27 offen lds
  s_add_u32 m0, s28, 35840
  s_add_u32 s27, s27, 32768
  buffer_load_dwordx4 v23, s[48:51], s27 offen lds
  s_add_u32 m0, s28, 36864
  s_add_u32 s27, s27, 32768
  buffer_load_dwordx4 v22, s[48:51], s27 offen lds
  s_add_u32 m0, s28, 37888
  s_add_u32 s27, s27, 32768
  buffer_load_dwordx4 v22, s[48:51], s27 offen lds
  s_add_u32 m0, s28, 38912
  s_add_u32 s27, s27, 32768
  buffer_load_dwordx4 v23, s[48:51], s27 offen lds
  s_add_u32 m0, s28, 39936
  s_add_u32 s27, s27, 32768
  buffer_load_dwordx4 v23, s[48:51], s27 offen lds
  ds_read_b64_tr_b16 v[56:57], v104 offset:32768
  ds_read_b64_tr_b16 v[58:59], v104 offset:36864
  ds_read_b64_tr_b16 v[64:65], v105 offset:32768
  ds_read_b64_tr_b16 v[66:67], v105 offset:36864
  ds_read_b64_tr_b16 a[144:145], v106 offset:32768
  ds_read_b64_tr_b16 a[146:147], v106 offset:36864
  ds_read_b64_tr_b16 a[96:97], v107 offset:32768
  ds_read_b64_tr_b16 a[98:99], v107 offset:36864
  ds_read_b64_tr_b16 a[136:137], v108 offset:32768
  ds_read_b64_tr_b16 a[138:139], v108 offset:36864
  ds_read_b64_tr_b16 a[88:89], v109 offset:32768
  ds_read_b64_tr_b16 a[90:91], v109 offset:36864
  ds_read_b64_tr_b16 a[128:129], v110 offset:32768
  ds_read_b64_tr_b16 a[130:131], v110 offset:36864
  ds_read_b64_tr_b16 a[80:81], v111 offset:32768
  ds_read_b64_tr_b16 a[82:83], v111 offset:36864
  s_waitcnt lgkmcnt(0)
  v_add_u32 v104, 65536, v104
  v_add_u32 v105, 65536, v105
  v_add_u32 v106, 65536, v106
  v_add_u32 v107, 65536, v107
  v_add_u32 v108, 65536, v108
  v_add_u32 v109, 65536, v109
  v_add_u32 v110, 65536, v110
  v_add_u32 v111, 65536, v111
  s_waitcnt vmcnt(16)
  s_barrier
  s_add_u32 s27, s26, 2097152
  s_add_u32 m0, s28, 65536
  s_nop 0
  buffer_load_dwordx4 v22, s[48:51], s27 offen lds
  s_add_u32 m0, s28, 66560
  s_add_u32 s27, s27, 32768
  buffer_load_dwordx4 v22, s[48:51], s27 offen lds
  s_add_u32 m0, s28, 67584
  s_add_u32 s27, s27, 32768
  buffer_load_dwordx4 v23, s[48:51], s27 offen lds
  s_add_u32 m0, s28, 68608
  s_add_u32 s27, s27, 32768
  buffer_load_dwordx4 v23, s[48:51], s27 offen lds
  s_add_u32 m0, s28, 69632
  s_add_u32 s27, s27, 32768
  buffer_load_dwordx4 v22, s[48:51], s27 offen lds
  s_add_u32 m0, s28, 70656
  s_add_u32 s27, s27, 32768
  buffer_load_dwordx4 v22, s[48:51], s27 offen lds
  s_add_u32 m0, s28, 71680
  s_add_u32 s27, s27, 32768
  buffer_load_dwordx4 v23, s[48:51], s27 offen lds
  s_add_u32 m0, s28, 72704
  s_add_u32 s27, s27, 32768
  buffer_load_dwordx4 v23, s[48:51], s27 offen lds
  ds_read_b64_tr_b16 v[60:61], v104 offset:0
  ds_read_b64_tr_b16 v[62:63], v104 offset:4096
  ds_read_b64_tr_b16 v[68:69], v105 offset:0
  ds_read_b64_tr_b16 v[70:71], v105 offset:4096
  ds_read_b64_tr_b16 a[148:149], v106 offset:0
  ds_read_b64_tr_b16 a[150:151], v106 offset:4096
  ds_read_b64_tr_b16 a[100:101], v107 offset:0
  ds_read_b64_tr_b16 a[102:103], v107 offset:4096
  ds_read_b64_tr_b16 a[140:141], v108 offset:0
  ds_read_b64_tr_b16 a[142:143], v108 offset:4096
  ds_read_b64_tr_b16 a[92:93], v109 offset:0
  ds_read_b64_tr_b16 a[94:95], v109 offset:4096
  ds_read_b64_tr_b16 a[132:133], v110 offset:0
  ds_read_b64_tr_b16 a[134:135], v110 offset:4096
  ds_read_b64_tr_b16 a[84:85], v111 offset:0
  ds_read_b64_tr_b16 a[86:87], v111 offset:4096
  s_waitcnt lgkmcnt(0)
  v_add_u32 v104, -131072, v104
  v_add_u32 v105, -131072, v105
  v_add_u32 v106, -131072, v106
  v_add_u32 v107, -131072, v107
  v_add_u32 v108, -131072, v108
  v_add_u32 v109, -131072, v109
  v_add_u32 v110, -131072, v110
  v_add_u32 v111, -131072, v111
  s_waitcnt vmcnt(16)
  s_barrier
  s_add_u32 s27, s26, 2621440
  s_add_u32 m0, s28, 98304
  s_nop 0
  buffer_load_dwordx4 v22, s[48:51], s27 offen lds
  s_add_u32 m0, s28, 99328
  s_add_u32 s27, s27, 32768
  buffer_load_dwordx4 v22, s[48:51], s27 offen lds
  s_add_u32 m0, s28, 100352
  s_add_u32 s27, s27, 32768
  buffer_load_dwordx4 v23, s[48:51], s27 offen lds
  s_add_u32 m0, s28, 101376
  s_add_u32 s27, s27, 32768
  buffer_load_dwordx4 v23, s[48:51], s27 offen lds
  s_add_u32 m0, s28, 102400
  s_add_u32 s27, s27, 32768
  buffer_load_dwordx4 v22, s[48:51], s27 offen lds
  s_add_u32 m0, s28, 103424
  s_add_u32 s27, s27, 32768
  buffer_load_dwordx4 v22, s[48:51], s27 offen lds
  s_add_u32 m0, s28, 104448
  s_add_u32 s27, s27, 32768
  buffer_load_dwordx4 v23, s[48:51], s27 offen lds
  s_add_u32 m0, s28, 105472
  s_add_u32 s27, s27, 32768
  buffer_load_dwordx4 v23, s[48:51], s27 offen lds
  ds_read_b64_tr_b16 v[88:89], v104 offset:0
  ds_read_b64_tr_b16 v[90:91], v104 offset:4096
  ds_read_b64_tr_b16 v[96:97], v105 offset:0
  ds_read_b64_tr_b16 v[98:99], v105 offset:4096
  ds_read_b64_tr_b16 v[232:233], v106 offset:0
  ds_read_b64_tr_b16 v[234:235], v106 offset:4096
  ds_read_b64_tr_b16 v[176:177], v107 offset:0
  ds_read_b64_tr_b16 v[178:179], v107 offset:4096
  ds_read_b64_tr_b16 v[224:225], v108 offset:0
  ds_read_b64_tr_b16 v[226:227], v108 offset:4096
  ds_read_b64_tr_b16 v[168:169], v109 offset:0
  ds_read_b64_tr_b16 v[170:171], v109 offset:4096
  ds_read_b64_tr_b16 v[216:217], v110 offset:0
  ds_read_b64_tr_b16 v[218:219], v110 offset:4096
  ds_read_b64_tr_b16 v[160:161], v111 offset:0
  ds_read_b64_tr_b16 v[162:163], v111 offset:4096
  s_waitcnt lgkmcnt(0)
  s_waitcnt vmcnt(16)
  s_barrier
  ds_read_b64_tr_b16 v[92:93], v104 offset:32768
  ds_read_b64_tr_b16 v[94:95], v104 offset:36864
  ds_read_b64_tr_b16 v[100:101], v105 offset:32768
  ds_read_b64_tr_b16 v[102:103], v105 offset:36864
  ds_read_b64_tr_b16 v[236:237], v106 offset:32768
  ds_read_b64_tr_b16 v[238:239], v106 offset:36864
  ds_read_b64_tr_b16 v[180:181], v107 offset:32768
  ds_read_b64_tr_b16 v[182:183], v107 offset:36864
  ds_read_b64_tr_b16 v[228:229], v108 offset:32768
  ds_read_b64_tr_b16 v[230:231], v108 offset:36864
  ds_read_b64_tr_b16 v[172:173], v109 offset:32768
  ds_read_b64_tr_b16 v[174:175], v109 offset:36864
  ds_read_b64_tr_b16 v[220:221], v110 offset:32768
  ds_read_b64_tr_b16 v[222:223], v110 offset:36864
  ds_read_b64_tr_b16 v[164:165], v111 offset:32768
  ds_read_b64_tr_b16 v[166:167], v111 offset:36864
  s_waitcnt lgkmcnt(0)
  s_barrier
  v_add_u32 v104, 65536, v104
  v_add_u32 v105, 65536, v105
  v_add_u32 v106, 65536, v106
  v_add_u32 v107, 65536, v107
  v_add_u32 v108, 65536, v108
  v_add_u32 v109, 65536, v109
  v_add_u32 v110, 65536, v110
  v_add_u32 v111, 65536, v111
  ds_write_b128 v8, v[128:131] offset:16384
  ds_write_b128 v8, v[132:135] offset:20480
  ds_write_b128 v8, v[136:139] offset:24576
  ds_write_b128 v8, v[140:143] offset:28672
  ds_write_b128 v8, v[144:147] offset:32768
  ds_write_b128 v8, v[148:151] offset:36864
  ds_write_b128 v8, v[152:155] offset:40960
  ds_write_b128 v8, v[156:159] offset:45056
  ds_write_b128 v8, v[184:187] offset:49152
  ds_write_b128 v8, v[188:191] offset:53248
  ds_write_b128 v8, v[192:195] offset:57344
  ds_write_b128 v8, v[196:199] offset:61440
  s_waitcnt lgkmcnt(0)
  s_waitcnt vmcnt(8)
  s_barrier
  ds_read_b64_tr_b16 v[208:209], v104 offset:0
  ds_read_b64_tr_b16 v[210:211], v104 offset:4096
  ds_read_b64_tr_b16 v[152:153], v105 offset:0
  ds_read_b64_tr_b16 v[154:155], v105 offset:4096
  ds_read_b64_tr_b16 v[200:201], v106 offset:0
  ds_read_b64_tr_b16 v[202:203], v106 offset:4096
  ds_read_b64_tr_b16 v[144:145], v107 offset:0
  ds_read_b64_tr_b16 v[146:147], v107 offset:4096
  ds_read_b64_tr_b16 v[192:193], v108 offset:0
  ds_read_b64_tr_b16 v[194:195], v108 offset:4096
  ds_read_b64_tr_b16 v[136:137], v109 offset:0
  ds_read_b64_tr_b16 v[138:139], v109 offset:4096
  ds_read_b64_tr_b16 v[184:185], v110 offset:0
  ds_read_b64_tr_b16 v[186:187], v110 offset:4096
  ds_read_b64_tr_b16 v[128:129], v111 offset:0
  ds_read_b64_tr_b16 v[130:131], v111 offset:4096
  s_waitcnt lgkmcnt(0)
  s_waitcnt vmcnt(0)
  s_barrier
  ds_read_b64_tr_b16 v[212:213], v104 offset:32768
  ds_read_b64_tr_b16 v[214:215], v104 offset:36864
  ds_read_b64_tr_b16 v[156:157], v105 offset:32768
  ds_read_b64_tr_b16 v[158:159], v105 offset:36864
  ds_read_b64_tr_b16 v[204:205], v106 offset:32768
  ds_read_b64_tr_b16 v[206:207], v106 offset:36864
  ds_read_b64_tr_b16 v[148:149], v107 offset:32768
  ds_read_b64_tr_b16 v[150:151], v107 offset:36864
  ds_read_b64_tr_b16 v[196:197], v108 offset:32768
  ds_read_b64_tr_b16 v[198:199], v108 offset:36864
  ds_read_b64_tr_b16 v[140:141], v109 offset:32768
  ds_read_b64_tr_b16 v[142:143], v109 offset:36864
  ds_read_b64_tr_b16 v[188:189], v110 offset:32768
  ds_read_b64_tr_b16 v[190:191], v110 offset:36864
  ds_read_b64_tr_b16 v[132:133], v111 offset:32768
  ds_read_b64_tr_b16 v[134:135], v111 offset:36864
  s_waitcnt lgkmcnt(0)
  s_barrier
  s_cmp_eq_u32 s60, 0
  s_cbranch_scc1 c_nw_4
  s_lshl_b32 s26, s60, 5
  s_add_u32 s26, s26, s16
  s_lshl_b32 s26, s26, 2
  s_add_u32 s26, s26, s17
  s_mul_i32 s26, s26, 7168
  s_sub_u32 s26, s26, 917504
  s_add_u32 s27, s26, 4096
  s_mov_b32 s10, 1835008
  s_load_dwordx2 s[8:9], s[0:1], 72
  s_waitcnt lgkmcnt(0)
  buffer_load_dwordx4 v[116:119], v0, s[8:11], s26 offen offset:0
  buffer_load_dwordx4 v[116:119], v0, s[8:11], s26 offen offset:1024
  buffer_load_dwordx4 v[116:119], v0, s[8:11], s26 offen offset:2048
  buffer_load_dwordx4 v[116:119], v0, s[8:11], s26 offen offset:3072
  buffer_load_dwordx4 v[116:119], v0, s[8:11], s27 offen offset:0
  buffer_load_dwordx4 v[116:119], v0, s[8:11], s27 offen offset:1024
  buffer_load_dwordx4 v[116:119], v0, s[8:11], s27 offen offset:2048
  s_load_dwordx2 s[8:9], s[0:1], 80
  s_waitcnt lgkmcnt(0)
  buffer_load_dwordx4 v[116:119], v0, s[8:11], s26 offen offset:0
  buffer_load_dwordx4 v[116:119], v0, s[8:11], s26 offen offset:1024
  buffer_load_dwordx4 v[116:119], v0, s[8:11], s26 offen offset:2048
  buffer_load_dwordx4 v[116:119], v0, s[8:11], s26 offen offset:3072
  buffer_load_dwordx4 v[116:119], v0, s[8:11], s27 offen offset:0
  buffer_load_dwordx4 v[116:119], v0, s[8:11], s27 offen offset:1024
  buffer_load_dwordx4 v[116:119], v0, s[8:11], s27 offen offset:2048
  s_load_dwordx2 s[8:9], s[0:1], 88
  s_waitcnt lgkmcnt(0)
  buffer_load_dwordx4 v[116:119], v0, s[8:11], s26 offen offset:0
  buffer_load_dwordx4 v[116:119], v0, s[8:11], s26 offen offset:1024
  buffer_load_dwordx4 v[116:119], v0, s[8:11], s26 offen offset:2048
  buffer_load_dwordx4 v[116:119], v0, s[8:11], s26 offen offset:3072
  buffer_load_dwordx4 v[116:119], v0, s[8:11], s27 offen offset:0
  buffer_load_dwordx4 v[116:119], v0, s[8:11], s27 offen offset:1024
  buffer_load_dwordx4 v[116:119], v0, s[8:11], s27 offen offset:2048
c_nw_4:
  ds_write_b128 v1, v[24:27] offset:0
  ds_write_b128 v1, v[28:31] offset:1024
  ds_write_b128 v1, v[32:35] offset:2048
  ds_write_b128 v1, v[36:39] offset:3072
  ds_write_b128 v1, v[40:43] offset:4096
  ds_write_b128 v1, v[44:47] offset:5120
  ds_write_b128 v1, v[48:51] offset:6144
  ds_write_b128 v1, v[52:55] offset:7168
  ds_write_b128 v1, v[56:59] offset:8192
  ds_write_b128 v1, v[60:63] offset:9216
  ds_write_b128 v1, v[64:67] offset:10240
  ds_write_b128 v1, v[68:71] offset:11264
  ds_write_b128 v1, v[72:75] offset:12288
  ds_write_b128 v1, v[76:79] offset:13312
  ds_write_b128 v1, v[80:83] offset:14336
  ds_write_b128 v1, v[84:87] offset:15360
  ds_write_b128 v1, v[88:91] offset:16384
  ds_write_b128 v1, v[92:95] offset:17408
  ds_write_b128 v1, v[96:99] offset:18432
  ds_write_b128 v1, v[100:103] offset:19456
  s_mul_i32 s27, s17, 24576
  s_add_u32 m0, s27, 86016
  s_waitcnt lgkmcnt(0)
  v_mbcnt_lo_u32_b32 v20, -1, 0
  v_and_b32 v20, 1, v20
  v_add_lshl_u32 v20, v20, s61, 2
  s_mov_b32 s26, 0
g_wt_5:
  global_load_dword v21, v20, s[12:13] offset:128 sc1
  s_add_u32 s26, s26, 1
  s_cmp_gt_u32 s26, 1048576
  s_cbranch_scc1 L_end
  s_waitcnt vmcnt(0)
  v_cmp_eq_u32 vcc, 0, v21
  v_readfirstlane_b32 s27, v21
  s_cbranch_vccnz g_wt_5
  s_lshr_b32 s26, s91, 1
  s_nop 3
  v_readlane_b32 s27, v21, s26
  s_cmp_lg_u32 s27, 1
  s_cbranch_scc1 L_chain_x
  s_mov_b32 s22, 0
  s_mov_b32 s42, s62
  s_add_u32 s43, s62, 4096
  s_mov_b32 s46, 0
  s_mov_b32 s47, 0
  s_lshl_b32 s26, s16, 2
  s_add_u32 s26, s26, s17
  s_lshl_b32 s27, s60, 13
  s_add_u32 s27, s27, s26
  s_lshr_b32 s25, s27, 2
  s_lshl_b32 s25, s25, 13
  s_add_u32 s25, s25, 192937984
  s_lshr_b32 s64, s27, 2
  s_lshl_b32 s64, s64, 6
  s_add_u32 s64, s64, 513538048
  s_cmp_eq_u32 s17, 3
  s_cselect_b32 s2, 268435456, 0
  s_lshl_b32 s27, s61, 13
  s_add_u32 s27, s27, s26
  s_lshl_b32 s23, s27, 12
  s_add_u32 s23, s23, 41943040
  s_lshl_b32 s63, s27, 5
  s_add_u32 s63, s63, 244318208
  s_mov_b32 s97, 268435456
  s_cmp_eq_u32 s60, 2
  s_cselect_b32 s93, 1, 3
  s_lshl_b32 s26, s17, 2
  s_add_u32 s26, s26, s60
  s_cmp_eq_u32 s26, 1
  s_cselect_b32 s97, 245891072, s97
  s_mov_b32 s95, 0
  s_mov_b32 s96, s23
  s_add_u32 s23, s23, 524288
  s_add_u32 s63, s63, 4096
  s_mov_b32 s29, 0
  s_sub_u32 s92, s63, 4096
  s_sub_u32 s96, s23, 524288
  s_mov_b32 s95, 0
c_gw_14:
  buffer_load_dword v7, off, s[4:7], s92 sc1
  s_add_u32 s29, s29, 1
  s_cmp_gt_u32 s29, 1048576
  s_cbranch_scc1 c_fail_12
  s_waitcnt vmcnt(0) lgkmcnt(0)
  v_readfirstlane_b32 s65, v7
  s_cmp_eq_u32 s65, 0
  s_cbranch_scc1 c_gw_14
  s_and_b32 s65, s65, s93
  s_cbranch_scc1 c_kvx_16
  s_mov_b32 s95, 1
  s_add_u32 s96, s96, 33554432
  s_add_u32 s92, s92, 262144
c_kvw_15:
  buffer_load_dword v7, off, s[4:7], s92 sc1
  s_add_u32 s29, s29, 1
  s_cmp_gt_u32 s29, 1048576
  s_cbranch_scc1 c_fail_12
  s_waitcnt vmcnt(0) lgkmcnt(0)
  v_readfirstlane_b32 s65, v7
  s_cmp_eq_u32 s65, 0
  s_cbranch_scc1 c_kvw_15
c_kvx_16:
  buffer_load_dword v7, off, s[4:7], s63 sc1
  buffer_load_dwordx4 v0, s[4:7], s96 offen offset:0  lds
  buffer_load_dwordx4 v0, s[4:7], s96 offen offset:1024  lds
  buffer_load_dwordx4 v0, s[4:7], s96 offen offset:2048  lds
  buffer_load_dwordx4 v0, s[4:7], s96 offen offset:3072  lds
  s_waitcnt vmcnt(4)
  v_readfirstlane_b32 s65, v7
  ds_read_b128 v[72:75], v1 offset:6144
  ds_read_b128 v[76:79], v1 offset:7168
  ds_read_b128 v[80:83], v1 offset:8192
  ds_read_b128 v[84:87], v1 offset:9216
  ds_read_b128 v[88:91], v1 offset:10240
  ds_read_b128 v[92:95], v1 offset:11264
  ds_read_b128 v[96:99], v1 offset:12288
  ds_read_b128 v[100:103], v1 offset:13312
  ds_read_b128 v[104:107], v1 offset:14336
  ds_read_b128 v[108:111], v1 offset:15360
  ds_read_b128 v[112:115], v1 offset:16384
  ds_read_b128 v[116:119], v1 offset:17408
  ds_read_b128 v[120:123], v1 offset:18432
  ds_read_b128 v[124:127], v1 offset:19456
  v_mov_b64 v[48:49], 0
  v_mov_b64 v[50:51], 0
  v_mov_b64 v[52:53], 0
  v_mov_b64 v[54:55], 0
  v_mov_b64 v[56:57], 0
  v_mov_b64 v[58:59], 0
  v_mov_b64 v[60:61], 0
  v_mov_b64 v[62:63], 0
  v_mov_b64 v[64:65], 0
  v_mov_b64 v[66:67], 0
  v_mov_b64 v[68:69], 0
  v_mov_b64 v[70:71], 0
  s_lshl_b32 s38, s16, 13
  s_add_u32 s38, s38, s40
  s_add_u32 s39, s38, 4096
  ds_read_b128 v[24:27], v1 offset:0
  ds_read_b128 v[28:31], v1 offset:1024
  ds_read_b128 v[32:35], v1 offset:2048
  ds_read_b128 v[36:39], v1 offset:3072
  ds_read_b128 v[40:43], v1 offset:4096
  ds_read_b128 v[44:47], v1 offset:5120
  s_waitcnt lgkmcnt(0)
c_loop_6:
  buffer_load_dwordx4 v[16:19], v8, s[4:7], s42 offen sc1
  buffer_load_dwordx4 v[20:23], v8, s[4:7], s43 offen sc1
  s_mov_b32 s28, 0
  s_cmp_eq_u32 s17, 0
  s_cbranch_scc1 c_w0a_17
  s_nop 15
  s_nop 8
  buffer_load_dwordx4 v[16:19], v8, s[4:7], s42 offen sc1
  buffer_load_dwordx4 v[20:23], v8, s[4:7], s43 offen sc1
  s_nop 15
  s_nop 8
  buffer_load_dwordx4 v[16:19], v8, s[4:7], s42 offen sc1
  buffer_load_dwordx4 v[20:23], v8, s[4:7], s43 offen sc1
c_w0b_18:
  s_waitcnt lgkmcnt(0)
  s_waitcnt vmcnt(5)
  v_max3_u32 v7, v16, v17, v18
  v_max_u32 v7, v7, v19
  ds_write_b128 v8, v[16:19] offset:0
  v_smfmac_f32_16x16x64_bf16 v[48:51], v[16:19], v[24:31], v6
  s_waitcnt vmcnt(4)
c_got_8:
  v_max3_u32 v7, v20, v21, v7
  v_max3_u32 v7, v22, v23, v7
  ds_write_b128 v8, v[20:23] offset:4096
  v_smfmac_f32_16x16x64_bf16 v[52:55], v[16:19], v[32:39], v6
  v_cmp_eq_u32 vcc, -1, v7
  v_smfmac_f32_16x16x64_bf16 v[56:59], v[16:19], v[40:47], v6
  s_cbranch_vccnz c_retry_7
  v_smfmac_f32_16x16x64_bf16 v[60:63], v[16:19], v[72:79], v6
  s_and_b32 s65, s65, s93
  s_cselect_b32 s96, s23, 268435456
  v_smfmac_f32_16x16x64_bf16 v[48:51], v[20:23], v[80:87], v6
  v_mov_b32 v7, 1
  v_smfmac_f32_16x16x64_bf16 v[52:55], v[20:23], v[88:95], v6
  v_smfmac_f32_16x16x64_bf16 v[56:59], v[20:23], v[96:103], v6
  s_waitcnt lgkmcnt(0)
  s_barrier
  ds_read_b128 v[24:27], v9 offset:0
  ds_read_b128 v[28:31], v10 offset:0
  v_smfmac_f32_16x16x64_bf16 v[60:63], v[20:23], v[104:111], v6
  ds_read_b128 v[32:35], v11 offset:0
  v_smfmac_f32_16x16x64_bf16 v[64:67], v[16:19], v[112:119], v6
  ds_read_b128 v[36:39], v9 offset:4096
  v_smfmac_f32_16x16x64_bf16 v[68:71], v[16:19], v[120:127], v6
  ds_read_b128 v[40:43], v10 offset:4096
  v_smfmac_f32_16x16x64_bf16 v[64:67], v[20:23], v[208:215], v6
  ds_read_b128 v[44:47], v11 offset:4096
  s_waitcnt lgkmcnt(5)
  v_smfmac_f32_16x16x64_bf16 v[48:51], v[24:27], a[168:175], v6
  ds_read_b128 v[72:75], v1 offset:20480
  s_waitcnt lgkmcnt(5)
  v_smfmac_f32_16x16x64_bf16 v[48:51], v[28:31], a[160:167], v6
  ds_read_b128 v[76:79], v1 offset:21504
  s_waitcnt lgkmcnt(5)
  v_smfmac_f32_16x16x64_bf16 v[48:51], v[32:35], a[152:159], v6
  ds_read_b128 v[80:83], v1 offset:22528
  s_waitcnt lgkmcnt(5)
  v_smfmac_f32_16x16x64_bf16 v[48:51], v[36:39], a[144:151], v6
  ds_read_b128 v[84:87], v1 offset:23552
  s_waitcnt lgkmcnt(5)
  v_smfmac_f32_16x16x64_bf16 v[48:51], v[40:43], a[136:143], v6
  ds_read_b128 v[104:107], v8 offset:16384
  s_waitcnt lgkmcnt(5)
  v_smfmac_f32_16x16x64_bf16 v[48:51], v[44:47], a[128:135], v6
  ds_read_b128 v[108:111], v8 offset:20480
  v_smfmac_f32_16x16x64_bf16 v[52:55], v[24:27], a[120:127], v6
  s_waitcnt lgkmcnt(5)
  buffer_load_dwordx4 v0, s[4:7], s96 offen offset:0  lds
  s_mov_b64 exec, 1
  buffer_store_dword v7, off, s[4:7], s64 sc1
  s_mov_b64 exec, -1
  v_smfmac_f32_16x16x64_bf16 v[52:55], v[28:31], a[112:119], v6
  s_waitcnt lgkmcnt(2)
  ds_read_b64 v[100:101], v5 offset:0
  v_smfmac_f32_16x16x64_bf16 v[52:55], v[32:35], a[104:111], v6
  v_add_f32 v48, v48, v50
  v_smfmac_f32_16x16x64_bf16 v[52:55], v[36:39], a[96:103], v6
  v_add_f32 v49, v49, v51
  v_smfmac_f32_16x16x64_bf16 v[52:55], v[40:43], a[88:95], v6
  v_cvt_pk_bf16_f32 v50, v48, v49
  v_smfmac_f32_16x16x64_bf16 v[52:55], v[44:47], a[80:87], v6
  v_cvt_pk_bf16_f32 v51, v48, v49
  v_smfmac_f32_16x16x64_bf16 v[56:59], v[24:27], a[72:79], v6
  ds_write_b64 v2, v[50:51] offset:8192
  v_smfmac_f32_16x16x64_bf16 v[56:59], v[28:31], a[64:71], v6
  ds_read_b64_tr_b16 v[88:89], v12 offset:8192
  s_nop 0
  v_smfmac_f32_16x16x64_bf16 v[56:59], v[32:35], a[56:63], v6
  s_nop 0
  v_add_f32 v52, v52, v54
  v_add_f32 v53, v53, v55
  v_cvt_pk_bf16_f32 v54, v52, v53
  v_cvt_pk_bf16_f32 v55, v52, v53
  ds_write_b64 v2, v[54:55] offset:8704
  v_smfmac_f32_16x16x64_bf16 v[56:59], v[36:39], a[48:55], v6
  ds_read_b64_tr_b16 v[90:91], v12 offset:8704
  v_smfmac_f32_16x16x64_bf16 v[56:59], v[40:43], a[40:47], v6
  buffer_load_dwordx4 v0, s[4:7], s96 offen offset:1024  lds
  v_smfmac_f32_16x16x64_bf16 v[56:59], v[44:47], a[32:39], v6
  ds_read_b128 v[112:115], v8 offset:24576
  v_smfmac_f32_16x16x64_bf16 v[60:63], v[24:27], a[24:31], v6
  buffer_load_dwordx4 v0, s[4:7], s96 offen offset:2048  lds
  v_smfmac_f32_16x16x64_bf16 v[60:63], v[28:31], a[16:23], v6
  s_waitcnt lgkmcnt(1)
  v_mfma_f32_16x16x32_bf16 v[92:95], v[72:75], v[88:91], 0
  buffer_load_dwordx4 v0, s[4:7], s96 offen offset:3072  lds
  v_mfma_f32_16x16x32_bf16 v[96:99], v[76:79], v[88:91], 0
  v_add_f32 v56, v56, v58
  v_add_f32 v57, v57, v59
  v_smfmac_f32_16x16x64_bf16 v[60:63], v[32:35], a[8:15], v6
  v_cvt_pk_bf16_f32 v58, v56, v57
  v_smfmac_f32_16x16x64_bf16 v[60:63], v[36:39], a[0:7], v6
  ds_write_b32 v2, v58 offset:8192
  v_smfmac_f32_16x16x64_bf16 v[60:63], v[40:43], v[248:255], v6
  s_nop 0
  v_cndmask_b32 v48, v92, v96, s[18:19]
  v_smfmac_f32_16x16x64_bf16 v[60:63], v[44:47], v[240:247], v6
  v_cndmask_b32 v49, v93, v97, s[18:19]
  v_cndmask_b32 v50, v94, v98, s[18:19]
  v_cndmask_b32 v51, v95, v99, s[18:19]
  ds_write_b128 v8, v[48:51] offset:12288
  v_smfmac_f32_16x16x64_bf16 v[68:71], v[20:23], v[152:159], v6
  s_nop 1
  s_nop 0
  v_add_f32 v60, v60, v62
  v_add_f32 v61, v61, v63
  v_cvt_pk_bf16_f32 v62, v60, v61
  ds_write_b32 v2, v62 offset:8704
  v_smfmac_f32_16x16x64_bf16 v[64:67], v[24:27], v[232:239], v6
  v_mov_b32 v76, 0
  buffer_store_dwordx2 v[100:101], v5, s[4:7], s97 offen sc1
  v_smfmac_f32_16x16x64_bf16 v[64:67], v[28:31], v[224:231], v6
  v_mov_b32 v79, 0
  s_waitcnt vmcnt(6)
  v_smfmac_f32_16x16x64_bf16 v[64:67], v[32:35], v[216:223], v6
  ds_read_b128 v[116:119], v8 offset:28672
  v_smfmac_f32_16x16x64_bf16 v[64:67], v[36:39], v[200:207], v6
  s_waitcnt lgkmcnt(1)
  s_barrier
  ds_read_b128 v[52:55], v9 offset:12288
  ds_read_b128 v[56:59], v10 offset:12288
  v_smfmac_f32_16x16x64_bf16 v[64:67], v[40:43], v[192:199], v6
  ds_read_b128 v[60:63], v11 offset:12288
  v_smfmac_f32_16x16x64_bf16 v[64:67], v[44:47], v[184:191], v6
  ds_read_b64_tr_b16 v[88:89], v12 offset:8192
  ds_read_b64_tr_b16 v[90:91], v12 offset:8704
  v_smfmac_f32_16x16x64_bf16 v[68:71], v[24:27], v[176:183], v6
  ds_read_b64_tr_b16 v[92:93], v13 offset:8192
  ds_read_b64_tr_b16 v[94:95], v13 offset:8704
  v_smfmac_f32_16x16x64_bf16 v[68:71], v[28:31], v[168:175], v6
  ds_read_b64_tr_b16 v[96:97], v14 offset:8192
  ds_read_b64_tr_b16 v[98:99], v14 offset:8704
  v_smfmac_f32_16x16x64_bf16 v[68:71], v[32:35], v[160:167], v6
  ds_read_b64_tr_b16 v[100:101], v15 offset:8192
  ds_read_b64_tr_b16 v[102:103], v15 offset:8704
  s_waitcnt lgkmcnt(8)
  v_smfmac_f32_16x16x64_bf16 v[68:71], v[36:39], v[144:151], v6
  v_add_f32 v48, v48, v52
  v_smfmac_f32_16x16x64_bf16 v[68:71], v[40:43], v[136:143], v6
  v_add_f32 v49, v49, v53
  v_smfmac_f32_16x16x64_bf16 v[68:71], v[44:47], v[128:135], v6
  v_add_f32 v50, v50, v54
  s_waitcnt lgkmcnt(4)
  v_mfma_f32_16x16x32_bf16 v[16:19], v[88:91], v[88:91], 0
  v_add_f32 v51, v51, v55
  v_add_f32 v56, v56, v60
  v_mfma_f32_16x16x32_bf16 v[16:19], v[92:95], v[92:95], v[16:19]
  v_add_f32 v57, v57, v61
  s_waitcnt lgkmcnt(0)
  v_add_f32 v58, v58, v62
  v_mfma_f32_16x16x32_bf16 v[16:19], v[96:99], v[96:99], v[16:19]
  v_add_f32 v59, v59, v63
  v_add_f32 v48, v48, v56
  v_mfma_f32_16x16x32_bf16 v[16:19], v[100:103], v[100:103], v[16:19]
  v_add_f32 v49, v49, v57
  v_add_f32 v50, v50, v58
  v_add_f32 v51, v51, v59
  v_exp_f32 v24, v48
  v_exp_f32 v25, v49
  v_exp_f32 v26, v50
  v_exp_f32 v27, v51
  v_mov_b64 v[20:21], s[14:15]
  v_cvt_pk_bf16_f32 v24, v24, v25
  v_cvt_pk_bf16_f32 v25, v26, v27
  v_cndmask_b32 v72, v24, 0, s[18:19]
  v_cndmask_b32 v73, v25, 0, s[18:19]
  v_cndmask_b32 v74, 0, v24, s[18:19]
  v_cndmask_b32 v75, 0, v25, s[18:19]
  v_mul_f32 v16, s24, v16
  v_mul_f32 v17, s24, v17
  v_mfma_f32_16x16x32_bf16 v[52:55], v[72:75], v[80:83], 0
  buffer_store_dwordx4 v[88:91], v8, s[4:7], s25 offen sc1
  v_exp_f32 v28, v16
  v_mov_b64 v[22:23], s[14:15]
  v_mfma_f32_16x16x32_bf16 v[56:59], v[72:75], v[84:87], 0
  v_exp_f32 v29, v17
  v_mfma_f32_16x16x32_bf16 v[60:63], v[72:75], v[20:23], 0
  v_add_f32 v64, v64, v66
  v_add_f32 v65, v65, v67
  v_cvt_pk_bf16_f32 v28, v28, v29
  v_cvt_pk_bf16_f32 v66, v64, v65
  v_cndmask_b32 v77, 0, v28, s[18:19]
  v_cndmask_b32 v78, 0, v28, s[18:19]
  v_add_f32 v68, v68, v70
  v_add_f32 v69, v69, v71
  v_cvt_pk_bf16_f32 v67, v68, v69
  v_mfma_f32_16x16x16_bf16 v[60:63], v[76:77], v[20:21], v[60:63]
  v_max3_f32 v7, |v48|, |v49|, |v50|
  v_max_f32 v26, |v16|, |v17|
  v_mfma_f32_16x16x16_bf16 v[52:55], v[78:79], v[66:67], v[52:55]
  v_cndmask_b32 v26, 0, v26, s[18:19]
  v_max3_f32 v7, |v51|, v26, v7
  v_mfma_f32_16x16x16_bf16 v[56:59], v[76:77], v[66:67], v[56:59]
  v_cmp_lt_f32 vcc, 0x42700000, v7
  v_mov_b64 v[44:45], 0
  v_add_f32 v60, v60, v62
  v_add_f32 v61, v61, v63
  s_cbranch_vccnz c_fb_10
c_fbr_11:
  v_rcp_f32 v60, v60
  v_rcp_f32 v61, v61
  v_pk_add_f32 v[52:53], v[52:53], v[54:55]
  v_pk_add_f32 v[56:57], v[56:57], v[58:59]
  v_pk_mul_f32 v[52:53], v[52:53], v[60:61]
  v_pk_mul_f32 v[56:57], v[56:57], v[60:61]
  v_cvt_pk_bf16_f32 v54, v52, v53
  v_cvt_pk_bf16_f32 v55, v56, v57
  ds_write_b64 v2, v[54:55] offset:0
  v_mov_b64 v[46:47], 0
  v_mov_b64 v[40:41], 0
  v_mov_b64 v[42:43], 0
  v_mov_b64 v[36:37], 0
  v_mov_b64 v[38:39], 0
  v_mov_b64 v[32:33], 0
  v_mov_b64 v[34:35], 0
  v_mov_b64 v[28:29], 0
  v_mov_b64 v[30:31], 0
  v_mov_b64 v[24:25], 0
  v_mov_b64 v[26:27], 0
  v_mov_b64 v[80:81], 0
  v_lshrrev_b32 v7, 1, v8
  s_add_u32 s30, s25, 4096
  s_waitcnt lgkmcnt(0)
  s_barrier
  ds_read_b64_tr_b16 v[72:73], v3 offset:0
  ds_read_b64_tr_b16 v[74:75], v3 offset:1024
  ds_read_b64_tr_b16 v[76:77], v3 offset:2048
  ds_read_b64_tr_b16 v[78:79], v3 offset:3072
  s_waitcnt lgkmcnt(2)
  v_smfmac_f32_16x16x64_bf16 v[44:47], v[72:75], a[248:255], v6
  ds_read_b128 v[120:123], v8 offset:32768
  s_and_b32 s3, s22, 1
  s_add_u32 s22, s22, 1
  buffer_store_dwordx2 v[66:67], v7, s[4:7], s30 offen sc1
  s_waitcnt lgkmcnt(1)
  v_smfmac_f32_16x16x64_bf16 v[44:47], v[76:79], a[240:247], v6
  ds_read_b128 v[124:127], v8 offset:36864
  s_and_b32 s42, s22, 3
  s_lshl_b32 s42, s42, 13
  s_cmp_eq_u32 s22, 64
  s_cbranch_scc1 c_last_13
  v_smfmac_f32_16x16x64_bf16 v[40:43], v[72:75], a[232:239], v6
  ds_read_b128 v[16:19], v8 offset:40960
  v_smfmac_f32_16x16x64_bf16 v[40:43], v[76:79], a[224:231], v6
  ds_read_b128 v[20:23], v8 offset:45056
  v_smfmac_f32_16x16x64_bf16 v[36:39], v[72:75], a[216:223], v6
  v_mov_b64 v[82:83], 0
  v_mov_b64 v[84:85], 0
  v_mov_b64 v[86:87], 0
  v_smfmac_f32_16x16x64_bf16 v[36:39], v[76:79], a[208:215], v6
  ds_read_b128 v[88:91], v8 offset:49152
  v_smfmac_f32_16x16x64_bf16 v[32:35], v[72:75], a[200:207], v6
  v_add_f32 v44, v44, v46
  v_add_f32 v45, v45, v47
  v_cvt_pk_bf16_f32 v48, v44, v45
  v_smfmac_f32_16x16x64_bf16 v[32:35], v[76:79], a[192:199], v6
  ds_read_b128 v[92:95], v8 offset:53248
  v_smfmac_f32_16x16x64_bf16 v[28:31], v[72:75], a[184:191], v6
  v_and_or_b32 v48, v48, -2, s3
  v_add_f32 v40, v40, v42
  v_add_f32 v41, v41, v43
  v_smfmac_f32_16x16x64_bf16 v[28:31], v[76:79], a[176:183], v6
  ds_read_b128 v[96:99], v8 offset:57344
  v_smfmac_f32_16x16x64_bf16 v[24:27], v[72:75], v[104:111], v6
  v_cvt_pk_bf16_f32 v49, v40, v41
  v_add_f32 v36, v36, v38
  v_add_f32 v37, v37, v39
  v_smfmac_f32_16x16x64_bf16 v[24:27], v[76:79], v[112:119], v6
  ds_read_b128 v[100:103], v8 offset:61440
  s_waitcnt lgkmcnt(6)
  v_smfmac_f32_16x16x64_bf16 v[80:83], v[72:75], v[120:127], v6
  v_cvt_pk_bf16_f32 v50, v36, v37
  v_add_f32 v32, v32, v34
  v_add_f32 v33, v33, v35
  s_waitcnt lgkmcnt(4)
  v_smfmac_f32_16x16x64_bf16 v[80:83], v[76:79], v[16:23], v6
  v_cvt_pk_bf16_f32 v51, v32, v33
  v_add_f32 v28, v28, v30
  v_add_f32 v29, v29, v31
  buffer_store_dwordx4 v[48:51], v4, s[4:7], s40 offen
  s_waitcnt lgkmcnt(2)
  v_smfmac_f32_16x16x64_bf16 v[84:87], v[72:75], v[88:95], v6
  v_cvt_pk_bf16_f32 v52, v28, v29
  v_and_or_b32 v52, v52, -2, s3
  v_add_f32 v24, v24, v26
  s_waitcnt lgkmcnt(0)
  v_smfmac_f32_16x16x64_bf16 v[84:87], v[76:79], v[96:103], v6
  v_add_f32 v25, v25, v27
  v_cvt_pk_bf16_f32 v53, v24, v25
  v_add_f32 v80, v80, v82
  v_add_f32 v81, v81, v83
  v_cvt_pk_bf16_f32 v54, v80, v81
  s_nop 2
  v_pk_add_f32 v[84:85], v[84:85], v[86:87]
  v_cvt_pk_bf16_f32 v55, v84, v85
  buffer_store_dwordx4 v[52:55], v4, s[4:7], s41 offen
  s_add_u32 s42, s42, s62
  s_add_u32 s43, s42, 4096
  s_add_u32 s23, s23, 524288
  s_add_u32 s25, s25, 262144
  s_add_u32 s63, s63, 4096
  s_add_u32 s64, s64, 2048
  s_andn2_b32 s64, s64, s2
  s_add_u32 s97, s97, 8192
  s_buffer_load_dword s65, s[4:7], s63
  v_mov_b64 v[56:57], 0
  v_mov_b64 v[58:59], 0
  v_mov_b64 v[60:61], 0
  v_mov_b64 v[62:63], 0
  v_mov_b64 v[48:49], 0
  v_mov_b64 v[50:51], 0
  v_mov_b64 v[52:53], 0
  v_mov_b64 v[54:55], 0
  s_cmp_lg_u32 s17, 0
  s_cbranch_scc1 c_oth_21
  s_mov_b32 s28, 0
  s_add_u32 s46, s46, 1
  v_mov_b64 v[120:121], -1
  s_xor_b32 s34, s42, 16384
  buffer_store_dwordx2 v[120:121], v5, s[4:7], s34 offen
  s_mov_b32 vcc_lo, 0xaaaaaaaa
  s_mov_b32 vcc_hi, 0xaaaaaaaa
  v_mov_b32 v7, 0x3f80
  v_cndmask_b32 v7, v7, 1.0, vcc
  s_mov_b32 vcc_lo, 0x30003
  s_mov_b32 vcc_hi, 0x30003
  v_cndmask_b32 v68, 0, v7, vcc
  s_mov_b32 vcc_lo, 0xc000c
  s_mov_b32 vcc_hi, 0xc000c
  v_cndmask_b32 v69, 0, v7, vcc
  s_mov_b32 vcc_lo, 0x300030
  s_mov_b32 vcc_hi, 0x300030
  v_cndmask_b32 v70, 0, v7, vcc
  s_mov_b32 vcc_lo, 0xc000c0
  s_mov_b32 vcc_hi, 0xc000c0
  v_cndmask_b32 v71, 0, v7, vcc
  s_nop 15
  s_nop 15
  s_nop 15
  s_nop 15
  s_nop 5
  buffer_load_dwordx4 v[16:19], v0, s[4:7], s38 offen offset:0 sc1
  buffer_load_dwordx4 v[20:23], v0, s[4:7], s38 offen offset:1024 sc1
  buffer_load_dwordx4 v[24:27], v0, s[4:7], s38 offen offset:2048 sc1
  buffer_load_dwordx4 v[28:31], v0, s[4:7], s38 offen offset:3072 sc1
  buffer_load_dwordx4 v[32:35], v0, s[4:7], s39 offen offset:0 sc1
  buffer_load_dwordx4 v[36:39], v0, s[4:7], s39 offen offset:1024 sc1
  buffer_load_dwordx4 v[40:43], v0, s[4:7], s39 offen offset:2048 sc1
  buffer_load_dwordx4 v[44:47], v0, s[4:7], s39 offen offset:3072 sc1
  s_nop 14
  buffer_load_dwordx4 v[72:75], v0, s[4:7], s38 offen offset:0 sc1
  buffer_load_dwordx4 v[76:79], v0, s[4:7], s38 offen offset:1024 sc1
  buffer_load_dwordx4 v[80:83], v0, s[4:7], s38 offen offset:2048 sc1
  buffer_load_dwordx4 v[84:87], v0, s[4:7], s38 offen offset:3072 sc1
  buffer_load_dwordx4 v[88:91], v0, s[4:7], s39 offen offset:0 sc1
  buffer_load_dwordx4 v[92:95], v0, s[4:7], s39 offen offset:1024 sc1
  buffer_load_dwordx4 v[96:99], v0, s[4:7], s39 offen offset:2048 sc1
  buffer_load_dwordx4 v[100:103], v0, s[4:7], s39 offen offset:3072 sc1
  s_waitcnt vmcnt(15)
  v_mfma_f32_16x16x32_bf16 v[64:67], v[16:19], v[68:71], 0
  v_xor_b32 v7, s3, v16
  s_waitcnt vmcnt(14)
  v_mfma_f32_16x16x32_bf16 v[64:67], v[20:23], v[68:71], v[64:67]
  v_bitop3_b32 v7, v7, v20, s3 bitop3:0xf6
  s_waitcnt vmcnt(13)
  v_mfma_f32_16x16x32_bf16 v[64:67], v[24:27], v[68:71], v[64:67]
  v_bitop3_b32 v7, v7, v24, s3 bitop3:0xf6
  s_waitcnt vmcnt(12)
  v_mfma_f32_16x16x32_bf16 v[64:67], v[28:31], v[68:71], v[64:67]
  v_bitop3_b32 v7, v7, v28, s3 bitop3:0xf6
  s_waitcnt vmcnt(11)
  v_mfma_f32_16x16x32_bf16 v[64:67], v[32:35], v[68:71], v[64:67]
  v_bitop3_b32 v7, v7, v32, s3 bitop3:0xf6
  s_waitcnt vmcnt(10)
  v_mfma_f32_16x16x32_bf16 v[64:67], v[36:39], v[68:71], v[64:67]
  v_bitop3_b32 v7, v7, v36, s3 bitop3:0xf6
  s_waitcnt vmcnt(9)
  v_mfma_f32_16x16x32_bf16 v[64:67], v[40:43], v[68:71], v[64:67]
  v_bitop3_b32 v7, v7, v40, s3 bitop3:0xf6
  s_waitcnt vmcnt(8)
  v_mfma_f32_16x16x32_bf16 v[64:67], v[44:47], v[68:71], v[64:67]
  v_bitop3_b32 v7, v7, v44, s3 bitop3:0xf6
  v_and_b32 v7, 1, v7
  v_cmp_ne_u32 vcc, 0, v7
  v_mov_b32 v7, 0
  v_mov_b32 v7, 0
  s_cbranch_vccnz c_p1r_22
c_publ_23:
  s_nop 1
  v_cvt_pk_bf16_f32 v64, v64, v65
  v_cvt_pk_bf16_f32 v65, v66, v67
  v_min_u32 v64, -2, v64
  v_min_u32 v65, -2, v65
  buffer_store_dwordx2 v[64:65], v5, s[4:7], s42 offen
c_hop2_9:
  s_barrier
  s_nop 15
  s_nop 13
  s_cmp_lg_u32 s96, 268435456
  s_cbranch_scc1 c_loop_6
  buffer_store_dwordx2 v[64:65], v5, s[4:7], s97 offen sc1
  s_mov_b32 s29, 0
  s_sub_u32 s92, s63, 4096
  s_sub_u32 s96, s23, 524288
  s_mov_b32 s95, 0
c_gw_24:
  buffer_load_dword v7, off, s[4:7], s92 sc1
  s_add_u32 s29, s29, 1
  s_cmp_gt_u32 s29, 1048576
  s_cbranch_scc1 c_fail_12
  s_waitcnt vmcnt(0) lgkmcnt(0)
  v_readfirstlane_b32 s65, v7
  s_cmp_eq_u32 s65, 0
  s_cbranch_scc1 c_gw_24
  s_and_b32 s65, s65, s93
  s_cbranch_scc1 c_kvx_26
  s_mov_b32 s95, 1
  s_add_u32 s96, s96, 33554432
  s_add_u32 s92, s92, 262144
c_kvw_25:
  buffer_load_dword v7, off, s[4:7], s92 sc1
  s_add_u32 s29, s29, 1
  s_cmp_gt_u32 s29, 1048576
  s_cbranch_scc1 c_fail_12
  s_waitcnt vmcnt(0) lgkmcnt(0)
  v_readfirstlane_b32 s65, v7
  s_cmp_eq_u32 s65, 0
  s_cbranch_scc1 c_kvw_25
c_kvx_26:
  buffer_load_dword v7, off, s[4:7], s63 sc1
  buffer_load_dwordx4 v0, s[4:7], s96 offen offset:0  lds
  buffer_load_dwordx4 v0, s[4:7], s96 offen offset:1024  lds
  buffer_load_dwordx4 v0, s[4:7], s96 offen offset:2048  lds
  buffer_load_dwordx4 v0, s[4:7], s96 offen offset:3072  lds
  s_waitcnt vmcnt(4)
  v_readfirstlane_b32 s65, v7
  s_cmp_eq_u32 s95, 0
  s_cbranch_scc1 c_loop_6
  s_mov_b32 s29, 0
c_fk_27:
  buffer_load_dwordx4 v[16:19], v8, s[4:7], s42 offen sc1
  buffer_load_dwordx4 v[20:23], v8, s[4:7], s43 offen sc1
  s_add_u32 s29, s29, 1
  s_cmp_gt_u32 s29, 1048576
  s_cbranch_scc1 c_fail_12
  s_waitcnt vmcnt(0)
  v_max3_u32 v7, v16, v17, v18
  v_max3_u32 v7, v19, v20, v7
  v_max3_u32 v7, v21, v22, v7
  v_max_u32 v7, v7, v23
  v_cmp_eq_u32 vcc, -1, v7
  s_cbranch_vccnz c_fk_27
  s_lshl_b32 s42, s22, 13
  s_add_u32 s42, s42, 245891072
  s_add_u32 s43, s42, 4096
  s_mov_b32 s95, 0
  s_branch c_loop_6
c_last_13:
  s_add_u32 s64, s64, 2048
  v_mov_b32 v7, 1
  s_waitcnt vmcnt(0)
  s_barrier
  s_mov_b64 exec, 1
  buffer_store_dword v7, off, s[4:7], s64 sc1
  s_mov_b64 exec, -1
  s_branch c_fail_12
c_oth_21:
  ds_read_b128 v[24:27], v1 offset:0
  ds_read_b128 v[28:31], v1 offset:1024
  ds_read_b128 v[32:35], v1 offset:2048
  ds_read_b128 v[36:39], v1 offset:3072
  ds_read_b128 v[40:43], v1 offset:4096
  ds_read_b128 v[44:47], v1 offset:5120
  ds_read_b128 v[72:75], v1 offset:6144
  ds_read_b128 v[76:79], v1 offset:7168
  ds_read_b128 v[80:83], v1 offset:8192
  ds_read_b128 v[84:87], v1 offset:9216
  ds_read_b128 v[88:91], v1 offset:10240
  ds_read_b128 v[92:95], v1 offset:11264
  ds_read_b128 v[96:99], v1 offset:12288
  ds_read_b128 v[100:103], v1 offset:13312
  ds_read_b128 v[104:107], v1 offset:14336
  ds_read_b128 v[108:111], v1 offset:15360
  ds_read_b128 v[112:115], v1 offset:16384
  ds_read_b128 v[116:119], v1 offset:17408
  ds_read_b128 v[120:123], v1 offset:18432
  ds_read_b128 v[124:127], v1 offset:19456
  v_mov_b64 v[64:65], 0
  v_mov_b64 v[66:67], 0
  v_mov_b64 v[68:69], 0
  v_mov_b64 v[70:71], 0
  s_branch c_hop2_9
c_w0a_17:
  s_waitcnt vmcnt(3)
  ds_read_b128 v[24:27], v1 offset:0
  ds_read_b128 v[28:31], v1 offset:1024
  ds_read_b128 v[32:35], v1 offset:2048
  ds_read_b128 v[36:39], v1 offset:3072
  ds_read_b128 v[40:43], v1 offset:4096
  ds_read_b128 v[44:47], v1 offset:5120
  ds_read_b128 v[72:75], v1 offset:6144
  ds_read_b128 v[76:79], v1 offset:7168
  ds_read_b128 v[80:83], v1 offset:8192
  ds_read_b128 v[84:87], v1 offset:9216
  buffer_load_dwordx4 v[16:19], v8, s[4:7], s42 offen sc1
  buffer_load_dwordx4 v[20:23], v8, s[4:7], s43 offen sc1
  ds_read_b128 v[88:91], v1 offset:10240
  ds_read_b128 v[92:95], v1 offset:11264
  ds_read_b128 v[96:99], v1 offset:12288
  ds_read_b128 v[100:103], v1 offset:13312
  ds_read_b128 v[104:107], v1 offset:14336
  ds_read_b128 v[108:111], v1 offset:15360
  ds_read_b128 v[112:115], v1 offset:16384
  ds_read_b128 v[116:119], v1 offset:17408
  ds_read_b128 v[120:123], v1 offset:18432
  ds_read_b128 v[124:127], v1 offset:19456
  buffer_load_dwordx4 v[16:19], v8, s[4:7], s42 offen sc1
  buffer_load_dwordx4 v[20:23], v8, s[4:7], s43 offen sc1
  v_mov_b64 v[64:65], 0
  v_mov_b64 v[66:67], 0
  v_mov_b64 v[68:69], 0
  v_mov_b64 v[70:71], 0
  s_branch c_w0b_18
c_p1r_22:
  buffer_load_dwordx4 v[16:19], v0, s[4:7], s38 offen offset:0 sc1
  buffer_load_dwordx4 v[20:23], v0, s[4:7], s38 offen offset:1024 sc1
  buffer_load_dwordx4 v[24:27], v0, s[4:7], s38 offen offset:2048 sc1
  buffer_load_dwordx4 v[28:31], v0, s[4:7], s38 offen offset:3072 sc1
  buffer_load_dwordx4 v[32:35], v0, s[4:7], s39 offen offset:0 sc1
  buffer_load_dwordx4 v[36:39], v0, s[4:7], s39 offen offset:1024 sc1
  buffer_load_dwordx4 v[40:43], v0, s[4:7], s39 offen offset:2048 sc1
  buffer_load_dwordx4 v[44:47], v0, s[4:7], s39 offen offset:3072 sc1
  s_add_u32 s46, s46, 1
  s_waitcnt vmcnt(15)
  v_mfma_f32_16x16x32_bf16 v[64:67], v[72:75], v[68:71], 0
  v_xor_b32 v7, s3, v72
  s_waitcnt vmcnt(14)
  v_mfma_f32_16x16x32_bf16 v[64:67], v[76:79], v[68:71], v[64:67]
  v_bitop3_b32 v7, v7, v76, s3 bitop3:0xf6
  s_waitcnt vmcnt(13)
  v_mfma_f32_16x16x32_bf16 v[64:67], v[80:83], v[68:71], v[64:67]
  v_bitop3_b32 v7, v7, v80, s3 bitop3:0xf6
  s_waitcnt vmcnt(12)
  v_mfma_f32_16x16x32_bf16 v[64:67], v[84:87], v[68:71], v[64:67]
  v_bitop3_b32 v7, v7, v84, s3 bitop3:0xf6
  s_waitcnt vmcnt(11)
  v_mfma_f32_16x16x32_bf16 v[64:67], v[88:91], v[68:71], v[64:67]
  v_bitop3_b32 v7, v7, v88, s3 bitop3:0xf6
  s_waitcnt vmcnt(10)
  v_mfma_f32_16x16x32_bf16 v[64:67], v[92:95], v[68:71], v[64:67]
  v_bitop3_b32 v7, v7, v92, s3 bitop3:0xf6
  s_waitcnt vmcnt(9)
  v_mfma_f32_16x16x32_bf16 v[64:67], v[96:99], v[68:71], v[64:67]
  v_bitop3_b32 v7, v7, v96, s3 bitop3:0xf6
  s_waitcnt vmcnt(8)
  v_mfma_f32_16x16x32_bf16 v[64:67], v[100:103], v[68:71], v[64:67]
  v_bitop3_b32 v7, v7, v100, s3 bitop3:0xf6
  v_and_b32 v7, 1, v7
  v_cmp_ne_u32 vcc, 0, v7
  v_mov_b32 v7, 0
  v_mov_b32 v7, 0
  s_cbranch_vccnz c_p1s_28
  s_branch c_publ_23
c_p1s_28:
  buffer_load_dwordx4 v[72:75], v0, s[4:7], s38 offen offset:0 sc1
  buffer_load_dwordx4 v[76:79], v0, s[4:7], s38 offen offset:1024 sc1
  buffer_load_dwordx4 v[80:83], v0, s[4:7], s38 offen offset:2048 sc1
  buffer_load_dwordx4 v[84:87], v0, s[4:7], s38 offen offset:3072 sc1
  buffer_load_dwordx4 v[88:91], v0, s[4:7], s39 offen offset:0 sc1
  buffer_load_dwordx4 v[92:95], v0, s[4:7], s39 offen offset:1024 sc1
  buffer_load_dwordx4 v[96:99], v0, s[4:7], s39 offen offset:2048 sc1
  buffer_load_dwordx4 v[100:103], v0, s[4:7], s39 offen offset:3072 sc1
  s_add_u32 s28, s28, 1
  s_add_u32 s46, s46, 1
  s_cmp_gt_u32 s28, 1048576
  s_cbranch_scc1 c_fail_12
  s_waitcnt vmcnt(15)
  v_mfma_f32_16x16x32_bf16 v[64:67], v[16:19], v[68:71], 0
  v_xor_b32 v7, s3, v16
  s_waitcnt vmcnt(14)
  v_mfma_f32_16x16x32_bf16 v[64:67], v[20:23], v[68:71], v[64:67]
  v_bitop3_b32 v7, v7, v20, s3 bitop3:0xf6
  s_waitcnt vmcnt(13)
  v_mfma_f32_16x16x32_bf16 v[64:67], v[24:27], v[68:71], v[64:67]
  v_bitop3_b32 v7, v7, v24, s3 bitop3:0xf6
  s_waitcnt vmcnt(12)
  v_mfma_f32_16x16x32_bf16 v[64:67], v[28:31], v[68:71], v[64:67]
  v_bitop3_b32 v7, v7, v28, s3 bitop3:0xf6
  s_waitcnt vmcnt(11)
  v_mfma_f32_16x16x32_bf16 v[64:67], v[32:35], v[68:71], v[64:67]
  v_bitop3_b32 v7, v7, v32, s3 bitop3:0xf6
  s_waitcnt vmcnt(10)
  v_mfma_f32_16x16x32_bf16 v[64:67], v[36:39], v[68:71], v[64:67]
  v_bitop3_b32 v7, v7, v36, s3 bitop3:0xf6
  s_waitcnt vmcnt(9)
  v_mfma_f32_16x16x32_bf16 v[64:67], v[40:43], v[68:71], v[64:67]
  v_bitop3_b32 v7, v7, v40, s3 bitop3:0xf6
  s_waitcnt vmcnt(8)
  v_mfma_f32_16x16x32_bf16 v[64:67], v[44:47], v[68:71], v[64:67]
  v_bitop3_b32 v7, v7, v44, s3 bitop3:0xf6
  v_and_b32 v7, 1, v7
  v_cmp_ne_u32 vcc, 0, v7
  v_mov_b32 v7, 0
  v_mov_b32 v7, 0
  s_cbranch_vccnz c_p1r_22
  s_branch c_publ_23
c_retry_7:
  buffer_load_dwordx4 v[16:19], v8, s[4:7], s42 offen sc1
  buffer_load_dwordx4 v[20:23], v8, s[4:7], s43 offen sc1
  s_add_u32 s28, s28, 1
  s_add_u32 s47, s47, 1
  s_cmp_gt_u32 s28, 1048576
  s_cbranch_scc1 c_fail_12
  v_mov_b64 v[48:49], 0
  v_mov_b64 v[50:51], 0
  v_mov_b64 v[52:53], 0
  v_mov_b64 v[54:55], 0
  v_mov_b64 v[56:57], 0
  v_mov_b64 v[58:59], 0
  s_waitcnt vmcnt(4)
  v_max3_u32 v7, v16, v17, v18
  v_max_u32 v7, v7, v19
  ds_write_b128 v8, v[16:19] offset:0
  v_smfmac_f32_16x16x64_bf16 v[48:51], v[16:19], v[24:31], v6
  s_branch c_got_8
c_fb_10:
  v_max3_f32 v7, v48, v49, v50
  v_max_f32 v7, v51, v7
  s_mov_b64 exec, s[18:19]
  v_max3_f32 v7, v16, v17, v7
  s_mov_b64 exec, -1
  s_nop 0
  v_max_f32_dpp v7, v7, v7 quad_perm:[2,3,0,1] row_mask:0xf bank_mask:0xf
  v_mov_b32 v24, v7
  s_nop 0
  s_nop 0
  v_permlane16_swap_b32 v7, v24
  v_max_f32 v7, v7, v24
  v_mov_b32 v24, v7
  s_nop 0
  s_nop 0
  v_permlane32_swap_b32 v7, v24
  v_max_f32 v7, v7, v24
  v_sub_f32 v24, v48, v7
  v_sub_f32 v25, v49, v7
  v_sub_f32 v26, v50, v7
  v_sub_f32 v27, v51, v7
  v_sub_f32 v28, v16, v7
  v_sub_f32 v29, v17, v7
  v_exp_f32 v24, v24
  v_exp_f32 v25, v25
  v_exp_f32 v26, v26
  v_exp_f32 v27, v27
  v_exp_f32 v28, v28
  v_exp_f32 v29, v29
  v_cvt_pk_bf16_f32 v24, v24, v25
  v_cvt_pk_bf16_f32 v25, v26, v27
  v_cvt_pk_bf16_f32 v28, v28, v29
  v_cndmask_b32 v72, v24, 0, s[18:19]
  v_cndmask_b32 v73, v25, 0, s[18:19]
  v_cndmask_b32 v74, 0, v24, s[18:19]
  v_cndmask_b32 v75, 0, v25, s[18:19]
  v_cndmask_b32 v77, 0, v28, s[18:19]
  v_cndmask_b32 v78, 0, v28, s[18:19]
  v_mfma_f32_16x16x32_bf16 v[60:63], v[72:75], v[20:23], 0
  v_mfma_f32_16x16x32_bf16 v[52:55], v[72:75], v[80:83], 0
  v_mfma_f32_16x16x32_bf16 v[56:59], v[72:75], v[84:87], 0
  s_nop 5
  v_mfma_f32_16x16x16_bf16 v[60:63], v[76:77], v[20:21], v[60:63]
  v_mfma_f32_16x16x16_bf16 v[52:55], v[78:79], v[66:67], v[52:55]
  v_mfma_f32_16x16x16_bf16 v[56:59], v[76:77], v[66:67], v[56:59]
  s_nop 7
  v_add_f32 v60, v60, v62
  v_add_f32 v61, v61, v63
  s_branch c_fbr_11
c_fail_12:
  s_endpgm
L_chain_x:
  s_mov_b32 s22, 0
  s_mov_b32 s42, s62
  s_add_u32 s43, s62, 4096
  s_mov_b32 s46, 0
  s_mov_b32 s47, 0
  s_lshl_b32 s26, s16, 2
  s_add_u32 s26, s26, s17
  s_lshl_b32 s27, s60, 13
  s_add_u32 s27, s27, s26
  s_lshr_b32 s25, s27, 2
  s_lshl_b32 s25, s25, 13
  s_add_u32 s25, s25, 192937984
  s_lshr_b32 s64, s27, 2
  s_lshl_b32 s64, s64, 6
  s_add_u32 s64, s64, 513538048
  s_cmp_eq_u32 s17, 3
  s_cselect_b32 s2, 268435456, 0
  s_lshl_b32 s27, s61, 13
  s_add_u32 s27, s27, s26
  s_lshl_b32 s23, s27, 12
  s_add_u32 s23, s23, 41943040
  s_lshl_b32 s63, s27, 5
  s_add_u32 s63, s63, 244318208
  s_mov_b32 s97, 268435456
  s_cmp_eq_u32 s60, 2
  s_cselect_b32 s93, 1, 3
  s_lshl_b32 s26, s17, 2
  s_add_u32 s26, s26, s60
  s_cmp_eq_u32 s26, 1
  s_cselect_b32 s97, 245891072, s97
  s_mov_b32 s95, 0
  s_mov_b32 s96, s23
  s_add_u32 s23, s23, 524288
  s_add_u32 s63, s63, 4096
  s_mov_b32 s29, 0
  s_sub_u32 s92, s63, 4096
  s_sub_u32 s96, s23, 524288
  s_mov_b32 s95, 0
c_gw_37:
  buffer_load_dword v7, off, s[4:7], s92 sc1
  s_add_u32 s29, s29, 1
  s_cmp_gt_u32 s29, 1048576
  s_cbranch_scc1 c_fail_35
  s_waitcnt vmcnt(0) lgkmcnt(0)
  v_readfirstlane_b32 s65, v7
  s_cmp_eq_u32 s65, 0
  s_cbranch_scc1 c_gw_37
  s_and_b32 s65, s65, s93
  s_cbranch_scc1 c_kvx_39
  s_mov_b32 s95, 1
  s_add_u32 s96, s96, 33554432
  s_add_u32 s92, s92, 262144
c_kvw_38:
  buffer_load_dword v7, off, s[4:7], s92 sc1
  s_add_u32 s29, s29, 1
  s_cmp_gt_u32 s29, 1048576
  s_cbranch_scc1 c_fail_35
  s_waitcnt vmcnt(0) lgkmcnt(0)
  v_readfirstlane_b32 s65, v7
  s_cmp_eq_u32 s65, 0
  s_cbranch_scc1 c_kvw_38
c_kvx_39:
  buffer_load_dword v7, off, s[4:7], s63 sc1
  buffer_load_dwordx4 v0, s[4:7], s96 offen offset:0  lds
  buffer_load_dwordx4 v0, s[4:7], s96 offen offset:1024  lds
  buffer_load_dwordx4 v0, s[4:7], s96 offen offset:2048  lds
  buffer_load_dwordx4 v0, s[4:7], s96 offen offset:3072  lds
  s_waitcnt vmcnt(4)
  v_readfirstlane_b32 s65, v7
  ds_read_b128 v[72:75], v1 offset:6144
  ds_read_b128 v[76:79], v1 offset:7168
  ds_read_b128 v[80:83], v1 offset:8192
  ds_read_b128 v[84:87], v1 offset:9216
  ds_read_b128 v[88:91], v1 offset:10240
  ds_read_b128 v[92:95], v1 offset:11264
  ds_read_b128 v[96:99], v1 offset:12288
  ds_read_b128 v[100:103], v1 offset:13312
  ds_read_b128 v[104:107], v1 offset:14336
  ds_read_b128 v[108:111], v1 offset:15360
  ds_read_b128 v[112:115], v1 offset:16384
  ds_read_b128 v[116:119], v1 offset:17408
  ds_read_b128 v[120:123], v1 offset:18432
  ds_read_b128 v[124:127], v1 offset:19456
  v_mov_b64 v[48:49], 0
  v_mov_b64 v[50:51], 0
  v_mov_b64 v[52:53], 0
  v_mov_b64 v[54:55], 0
  v_mov_b64 v[56:57], 0
  v_mov_b64 v[58:59], 0
  v_mov_b64 v[60:61], 0
  v_mov_b64 v[62:63], 0
  v_mov_b64 v[64:65], 0
  v_mov_b64 v[66:67], 0
  v_mov_b64 v[68:69], 0
  v_mov_b64 v[70:71], 0
  s_lshl_b32 s38, s16, 13
  s_add_u32 s38, s38, s40
  s_add_u32 s39, s38, 4096
  ds_read_b128 v[24:27], v1 offset:0
  ds_read_b128 v[28:31], v1 offset:1024
  ds_read_b128 v[32:35], v1 offset:2048
  ds_read_b128 v[36:39], v1 offset:3072
  ds_read_b128 v[40:43], v1 offset:4096
  ds_read_b128 v[44:47], v1 offset:5120
  s_waitcnt lgkmcnt(0)
c_loop_29:
  buffer_load_dwordx4 v[16:19], v8, s[4:7], s42 offen sc1
  buffer_load_dwordx4 v[20:23], v8, s[4:7], s43 offen sc1
  s_mov_b32 s28, 0
  s_cmp_eq_u32 s17, 0
  s_cbranch_scc1 c_w0a_40
  s_nop 15
  s_nop 8
  buffer_load_dwordx4 v[16:19], v8, s[4:7], s42 offen sc1
  buffer_load_dwordx4 v[20:23], v8, s[4:7], s43 offen sc1
  s_nop 15
  s_nop 8
  buffer_load_dwordx4 v[16:19], v8, s[4:7], s42 offen sc1
  buffer_load_dwordx4 v[20:23], v8, s[4:7], s43 offen sc1
c_w0b_41:
  s_waitcnt lgkmcnt(0)
  s_waitcnt vmcnt(5)
  v_max3_u32 v7, v16, v17, v18
  v_max_u32 v7, v7, v19
  ds_write_b128 v8, v[16:19] offset:0
  v_smfmac_f32_16x16x64_bf16 v[48:51], v[16:19], v[24:31], v6
  s_waitcnt vmcnt(4)
c_got_31:
  v_max3_u32 v7, v20, v21, v7
  v_max3_u32 v7, v22, v23, v7
  ds_write_b128 v8, v[20:23] offset:4096
  v_smfmac_f32_16x16x64_bf16 v[52:55], v[16:19], v[32:39], v6
  v_cmp_eq_u32 vcc, -1, v7
  v_smfmac_f32_16x16x64_bf16 v[56:59], v[16:19], v[40:47], v6
  s_cbranch_vccnz c_retry_30
  v_smfmac_f32_16x16x64_bf16 v[60:63], v[16:19], v[72:79], v6
  s_and_b32 s65, s65, s93
  s_cselect_b32 s96, s23, 268435456
  v_smfmac_f32_16x16x64_bf16 v[48:51], v[20:23], v[80:87], v6
  v_mov_b32 v7, 1
  v_smfmac_f32_16x16x64_bf16 v[52:55], v[20:23], v[88:95], v6
  v_smfmac_f32_16x16x64_bf16 v[56:59], v[20:23], v[96:103], v6
  s_waitcnt lgkmcnt(0)
  s_barrier
  ds_read_b128 v[24:27], v9 offset:0
  ds_read_b128 v[28:31], v10 offset:0
  v_smfmac_f32_16x16x64_bf16 v[60:63], v[20:23], v[104:111], v6
  ds_read_b128 v[32:35], v11 offset:0
  v_smfmac_f32_16x16x64_bf16 v[64:67], v[16:19], v[112:119], v6
  ds_read_b128 v[36:39], v9 offset:4096
  v_smfmac_f32_16x16x64_bf16 v[68:71], v[16:19], v[120:127], v6
  ds_read_b128 v[40:43], v10 offset:4096
  v_smfmac_f32_16x16x64_bf16 v[64:67], v[20:23], v[208:215], v6
  ds_read_b128 v[44:47], v11 offset:4096
  s_waitcnt lgkmcnt(5)
  v_smfmac_f32_16x16x64_bf16 v[48:51], v[24:27], a[168:175], v6
  ds_read_b128 v[72:75], v1 offset:20480
  s_waitcnt lgkmcnt(5)
  v_smfmac_f32_16x16x64_bf16 v[48:51], v[28:31], a[160:167], v6
  ds_read_b128 v[76:79], v1 offset:21504
  s_waitcnt lgkmcnt(5)
  v_smfmac_f32_16x16x64_bf16 v[48:51], v[32:35], a[152:159], v6
  ds_read_b128 v[80:83], v1 offset:22528
  s_waitcnt lgkmcnt(5)
  v_smfmac_f32_16x16x64_bf16 v[48:51], v[36:39], a[144:151], v6
  ds_read_b128 v[84:87], v1 offset:23552
  s_waitcnt lgkmcnt(5)
  v_smfmac_f32_16x16x64_bf16 v[48:51], v[40:43], a[136:143], v6
  ds_read_b128 v[104:107], v8 offset:16384
  s_waitcnt lgkmcnt(5)
  v_smfmac_f32_16x16x64_bf16 v[48:51], v[44:47], a[128:135], v6
  ds_read_b128 v[108:111], v8 offset:20480
  v_smfmac_f32_16x16x64_bf16 v[52:55], v[24:27], a[120:127], v6
  s_waitcnt lgkmcnt(5)
  buffer_load_dwordx4 v0, s[4:7], s96 offen offset:0  lds
  s_mov_b64 exec, 1
  buffer_store_dword v7, off, s[4:7], s64 sc1
  s_mov_b64 exec, -1
  v_smfmac_f32_16x16x64_bf16 v[52:55], v[28:31], a[112:119], v6
  s_waitcnt lgkmcnt(2)
  ds_read_b64 v[100:101], v5 offset:0
  v_smfmac_f32_16x16x64_bf16 v[52:55], v[32:35], a[104:111], v6
  v_add_f32 v48, v48, v50
  v_smfmac_f32_16x16x64_bf16 v[52:55], v[36:39], a[96:103], v6
  v_add_f32 v49, v49, v51
  v_smfmac_f32_16x16x64_bf16 v[52:55], v[40:43], a[88:95], v6
  v_cvt_pk_bf16_f32 v50, v48, v49
  v_smfmac_f32_16x16x64_bf16 v[52:55], v[44:47], a[80:87], v6
  v_cvt_pk_bf16_f32 v51, v48, v49
  v_smfmac_f32_16x16x64_bf16 v[56:59], v[24:27], a[72:79], v6
  ds_write_b64 v2, v[50:51] offset:8192
  v_smfmac_f32_16x16x64_bf16 v[56:59], v[28:31], a[64:71], v6
  ds_read_b64_tr_b16 v[88:89], v12 offset:8192
  s_nop 0
  v_smfmac_f32_16x16x64_bf16 v[56:59], v[32:35], a[56:63], v6
  s_nop 0
  v_add_f32 v52, v52, v54
  v_add_f32 v53, v53, v55
  v_cvt_pk_bf16_f32 v54, v52, v53
  v_cvt_pk_bf16_f32 v55, v52, v53
  ds_write_b64 v2, v[54:55] offset:8704
  v_smfmac_f32_16x16x64_bf16 v[56:59], v[36:39], a[48:55], v6
  ds_read_b64_tr_b16 v[90:91], v12 offset:8704
  v_smfmac_f32_16x16x64_bf16 v[56:59], v[40:43], a[40:47], v6
  buffer_load_dwordx4 v0, s[4:7], s96 offen offset:1024  lds
  v_smfmac_f32_16x16x64_bf16 v[56:59], v[44:47], a[32:39], v6
  ds_read_b128 v[112:115], v8 offset:24576
  v_smfmac_f32_16x16x64_bf16 v[60:63], v[24:27], a[24:31], v6
  buffer_load_dwordx4 v0, s[4:7], s96 offen offset:2048  lds
  v_smfmac_f32_16x16x64_bf16 v[60:63], v[28:31], a[16:23], v6
  s_waitcnt lgkmcnt(1)
  v_mfma_f32_16x16x32_bf16 v[92:95], v[72:75], v[88:91], 0
  buffer_load_dwordx4 v0, s[4:7], s96 offen offset:3072  lds
  v_mfma_f32_16x16x32_bf16 v[96:99], v[76:79], v[88:91], 0
  v_add_f32 v56, v56, v58
  v_add_f32 v57, v57, v59
  v_smfmac_f32_16x16x64_bf16 v[60:63], v[32:35], a[8:15], v6
  v_cvt_pk_bf16_f32 v58, v56, v57
  v_smfmac_f32_16x16x64_bf16 v[60:63], v[36:39], a[0:7], v6
  ds_write_b32 v2, v58 offset:8192
  v_smfmac_f32_16x16x64_bf16 v[60:63], v[40:43], v[248:255], v6
  s_nop 0
  v_cndmask_b32 v48, v92, v96, s[18:19]
  v_smfmac_f32_16x16x64_bf16 v[60:63], v[44:47], v[240:247], v6
  v_cndmask_b32 v49, v93, v97, s[18:19]
  v_cndmask_b32 v50, v94, v98, s[18:19]
  v_cndmask_b32 v51, v95, v99, s[18:19]
  ds_write_b128 v8, v[48:51] offset:12288
  v_smfmac_f32_16x16x64_bf16 v[68:71], v[20:23], v[152:159], v6
  s_nop 1
  s_nop 0
  v_add_f32 v60, v60, v62
  v_add_f32 v61, v61, v63
  v_cvt_pk_bf16_f32 v62, v60, v61
  ds_write_b32 v2, v62 offset:8704
  v_smfmac_f32_16x16x64_bf16 v[64:67], v[24:27], v[232:239], v6
  v_mov_b32 v76, 0
  buffer_store_dwordx2 v[100:101], v5, s[4:7], s97 offen sc1
  v_smfmac_f32_16x16x64_bf16 v[64:67], v[28:31], v[224:231], v6
  v_mov_b32 v79, 0
  s_waitcnt vmcnt(6)
  v_smfmac_f32_16x16x64_bf16 v[64:67], v[32:35], v[216:223], v6
  ds_read_b128 v[116:119], v8 offset:28672
  v_smfmac_f32_16x16x64_bf16 v[64:67], v[36:39], v[200:207], v6
  s_waitcnt lgkmcnt(1)
  s_barrier
  ds_read_b128 v[52:55], v9 offset:12288
  ds_read_b128 v[56:59], v10 offset:12288
  v_smfmac_f32_16x16x64_bf16 v[64:67], v[40:43], v[192:199], v6
  ds_read_b128 v[60:63], v11 offset:12288
  v_smfmac_f32_16x16x64_bf16 v[64:67], v[44:47], v[184:191], v6
  ds_read_b64_tr_b16 v[88:89], v12 offset:8192
  ds_read_b64_tr_b16 v[90:91], v12 offset:8704
  v_smfmac_f32_16x16x64_bf16 v[68:71], v[24:27], v[176:183], v6
  ds_read_b64_tr_b16 v[92:93], v13 offset:8192
  ds_read_b64_tr_b16 v[94:95], v13 offset:8704
  v_smfmac_f32_16x16x64_bf16 v[68:71], v[28:31], v[168:175], v6
  ds_read_b64_tr_b16 v[96:97], v14 offset:8192
  ds_read_b64_tr_b16 v[98:99], v14 offset:8704
  v_smfmac_f32_16x16x64_bf16 v[68:71], v[32:35], v[160:167], v6
  ds_read_b64_tr_b16 v[100:101], v15 offset:8192
  ds_read_b64_tr_b16 v[102:103], v15 offset:8704
  s_waitcnt lgkmcnt(8)
  v_smfmac_f32_16x16x64_bf16 v[68:71], v[36:39], v[144:151], v6
  v_add_f32 v48, v48, v52
  v_smfmac_f32_16x16x64_bf16 v[68:71], v[40:43], v[136:143], v6
  v_add_f32 v49, v49, v53
  v_smfmac_f32_16x16x64_bf16 v[68:71], v[44:47], v[128:135], v6
  v_add_f32 v50, v50, v54
  s_waitcnt lgkmcnt(4)
  v_mfma_f32_16x16x32_bf16 v[16:19], v[88:91], v[88:91], 0
  v_add_f32 v51, v51, v55
  v_add_f32 v56, v56, v60
  v_mfma_f32_16x16x32_bf16 v[16:19], v[92:95], v[92:95], v[16:19]
  v_add_f32 v57, v57, v61
  s_waitcnt lgkmcnt(0)
  v_add_f32 v58, v58, v62
  v_mfma_f32_16x16x32_bf16 v[16:19], v[96:99], v[96:99], v[16:19]
  v_add_f32 v59, v59, v63
  v_add_f32 v48, v48, v56
  v_mfma_f32_16x16x32_bf16 v[16:19], v[100:103], v[100:103], v[16:19]
  v_add_f32 v49, v49, v57
  v_add_f32 v50, v50, v58
  v_add_f32 v51, v51, v59
  v_exp_f32 v24, v48
  v_exp_f32 v25, v49
  v_exp_f32 v26, v50
  v_exp_f32 v27, v51
  v_mov_b64 v[20:21], s[14:15]
  v_cvt_pk_bf16_f32 v24, v24, v25
  v_cvt_pk_bf16_f32 v25, v26, v27
  v_cndmask_b32 v72, v24, 0, s[18:19]
  v_cndmask_b32 v73, v25, 0, s[18:19]
  v_cndmask_b32 v74, 0, v24, s[18:19]
  v_cndmask_b32 v75, 0, v25, s[18:19]
  v_mul_f32 v16, s24, v16
  v_mul_f32 v17, s24, v17
  v_mfma_f32_16x16x32_bf16 v[52:55], v[72:75], v[80:83], 0
  buffer_store_dwordx4 v[88:91], v8, s[4:7], s25 offen sc1
  v_exp_f32 v28, v16
  v_mov_b64 v[22:23], s[14:15]
  v_mfma_f32_16x16x32_bf16 v[56:59], v[72:75], v[84:87], 0
  v_exp_f32 v29, v17
  v_mfma_f32_16x16x32_bf16 v[60:63], v[72:75], v[20:23], 0
  v_add_f32 v64, v64, v66
  v_add_f32 v65, v65, v67
  v_cvt_pk_bf16_f32 v28, v28, v29
  v_cvt_pk_bf16_f32 v66, v64, v65
  v_cndmask_b32 v77, 0, v28, s[18:19]
  v_cndmask_b32 v78, 0, v28, s[18:19]
  v_add_f32 v68, v68, v70
  v_add_f32 v69, v69, v71
  v_cvt_pk_bf16_f32 v67, v68, v69
  v_mfma_f32_16x16x16_bf16 v[60:63], v[76:77], v[20:21], v[60:63]
  v_max3_f32 v7, |v48|, |v49|, |v50|
  v_max_f32 v26, |v16|, |v17|
  v_mfma_f32_16x16x16_bf16 v[52:55], v[78:79], v[66:67], v[52:55]
  v_cndmask_b32 v26, 0, v26, s[18:19]
  v_max3_f32 v7, |v51|, v26, v7
  v_mfma_f32_16x16x16_bf16 v[56:59], v[76:77], v[66:67], v[56:59]
  v_cmp_lt_f32 vcc, 0x42700000, v7
  v_mov_b64 v[44:45], 0
  v_add_f32 v60, v60, v62
  v_add_f32 v61, v61, v63
  s_cbranch_vccnz c_fb_33
c_fbr_34:
  v_rcp_f32 v60, v60
  v_rcp_f32 v61, v61
  v_pk_add_f32 v[52:53], v[52:53], v[54:55]
  v_pk_add_f32 v[56:57], v[56:57], v[58:59]
  v_pk_mul_f32 v[52:53], v[52:53], v[60:61]
  v_pk_mul_f32 v[56:57], v[56:57], v[60:61]
  v_cvt_pk_bf16_f32 v54, v52, v53
  v_cvt_pk_bf16_f32 v55, v56, v57
  ds_write_b64 v2, v[54:55] offset:0
  v_mov_b64 v[46:47], 0
  v_mov_b64 v[40:41], 0
  v_mov_b64 v[42:43], 0
  v_mov_b64 v[36:37], 0
  v_mov_b64 v[38:39], 0
  v_mov_b64 v[32:33], 0
  v_mov_b64 v[34:35], 0
  v_mov_b64 v[28:29], 0
  v_mov_b64 v[30:31], 0
  v_mov_b64 v[24:25], 0
  v_mov_b64 v[26:27], 0
  v_mov_b64 v[80:81], 0
  v_lshrrev_b32 v7, 1, v8
  s_add_u32 s30, s25, 4096
  s_waitcnt lgkmcnt(0)
  s_barrier
  ds_read_b64_tr_b16 v[72:73], v3 offset:0
  ds_read_b64_tr_b16 v[74:75], v3 offset:1024
  ds_read_b64_tr_b16 v[76:77], v3 offset:2048
  ds_read_b64_tr_b16 v[78:79], v3 offset:3072
  s_waitcnt lgkmcnt(2)
  v_smfmac_f32_16x16x64_bf16 v[44:47], v[72:75], a[248:255], v6
  ds_read_b128 v[120:123], v8 offset:32768
  s_and_b32 s3, s22, 1
  s_add_u32 s22, s22, 1
  buffer_store_dwordx2 v[66:67], v7, s[4:7], s30 offen sc1
  s_waitcnt lgkmcnt(1)
  v_smfmac_f32_16x16x64_bf16 v[44:47], v[76:79], a[240:247], v6
  ds_read_b128 v[124:127], v8 offset:36864
  s_and_b32 s42, s22, 3
  s_lshl_b32 s42, s42, 13
  s_cmp_eq_u32 s22, 64
  s_cbranch_scc1 c_last_36
  v_smfmac_f32_16x16x64_bf16 v[40:43], v[72:75], a[232:239], v6
  ds_read_b128 v[16:19], v8 offset:40960
  v_smfmac_f32_16x16x64_bf16 v[40:43], v[76:79], a[224:231], v6
  ds_read_b128 v[20:23], v8 offset:45056
  v_smfmac_f32_16x16x64_bf16 v[36:39], v[72:75], a[216:223], v6
  v_mov_b64 v[82:83], 0
  v_mov_b64 v[84:85], 0
  v_mov_b64 v[86:87], 0
  v_smfmac_f32_16x16x64_bf16 v[36:39], v[76:79], a[208:215], v6
  ds_read_b128 v[88:91], v8 offset:49152
  v_smfmac_f32_16x16x64_bf16 v[32:35], v[72:75], a[200:207], v6
  v_add_f32 v44, v44, v46
  v_add_f32 v45, v45, v47
  v_cvt_pk_bf16_f32 v48, v44, v45
  v_smfmac_f32_16x16x64_bf16 v[32:35], v[76:79], a[192:199], v6
  ds_read_b128 v[92:95], v8 offset:53248
  v_smfmac_f32_16x16x64_bf16 v[28:31], v[72:75], a[184:191], v6
  v_and_or_b32 v48, v48, -2, s3
  v_add_f32 v40, v40, v42
  v_add_f32 v41, v41, v43
  v_smfmac_f32_16x16x64_bf16 v[28:31], v[76:79], a[176:183], v6
  ds_read_b128 v[96:99], v8 offset:57344
  v_smfmac_f32_16x16x64_bf16 v[24:27], v[72:75], v[104:111], v6
  v_cvt_pk_bf16_f32 v49, v40, v41
  v_add_f32 v36, v36, v38
  v_add_f32 v37, v37, v39
  v_smfmac_f32_16x16x64_bf16 v[24:27], v[76:79], v[112:119], v6
  ds_read_b128 v[100:103], v8 offset:61440
  s_waitcnt lgkmcnt(6)
  v_smfmac_f32_16x16x64_bf16 v[80:83], v[72:75], v[120:127], v6
  v_cvt_pk_bf16_f32 v50, v36, v37
  v_add_f32 v32, v32, v34
  v_add_f32 v33, v33, v35
  s_waitcnt lgkmcnt(4)
  v_smfmac_f32_16x16x64_bf16 v[80:83], v[76:79], v[16:23], v6
  v_cvt_pk_bf16_f32 v51, v32, v33
  v_add_f32 v28, v28, v30
  v_add_f32 v29, v29, v31
  buffer_store_dwordx4 v[48:51], v4, s[4:7], s40 offen sc1
  s_waitcnt lgkmcnt(2)
  v_smfmac_f32_16x16x64_bf16 v[84:87], v[72:75], v[88:95], v6
  v_cvt_pk_bf16_f32 v52, v28, v29
  v_and_or_b32 v52, v52, -2, s3
  v_add_f32 v24, v24, v26
  s_waitcnt lgkmcnt(0)
  v_smfmac_f32_16x16x64_bf16 v[84:87], v[76:79], v[96:103], v6
  v_add_f32 v25, v25, v27
  v_cvt_pk_bf16_f32 v53, v24, v25
  v_add_f32 v80, v80, v82
  v_add_f32 v81, v81, v83
  v_cvt_pk_bf16_f32 v54, v80, v81
  s_nop 2
  v_pk_add_f32 v[84:85], v[84:85], v[86:87]
  v_cvt_pk_bf16_f32 v55, v84, v85
  buffer_store_dwordx4 v[52:55], v4, s[4:7], s41 offen sc1
  s_add_u32 s42, s42, s62
  s_add_u32 s43, s42, 4096
  s_add_u32 s23, s23, 524288
  s_add_u32 s25, s25, 262144
  s_add_u32 s63, s63, 4096
  s_add_u32 s64, s64, 2048
  s_andn2_b32 s64, s64, s2
  s_add_u32 s97, s97, 8192
  s_buffer_load_dword s65, s[4:7], s63
  v_mov_b64 v[56:57], 0
  v_mov_b64 v[58:59], 0
  v_mov_b64 v[60:61], 0
  v_mov_b64 v[62:63], 0
  v_mov_b64 v[48:49], 0
  v_mov_b64 v[50:51], 0
  v_mov_b64 v[52:53], 0
  v_mov_b64 v[54:55], 0
  s_cmp_lg_u32 s17, 0
  s_cbranch_scc1 c_oth_44
  s_mov_b32 s28, 0
  s_add_u32 s46, s46, 1
  v_mov_b64 v[120:121], -1
  s_xor_b32 s34, s42, 16384
  buffer_store_dwordx2 v[120:121], v5, s[4:7], s34 offen sc1
  s_mov_b32 vcc_lo, 0xaaaaaaaa
  s_mov_b32 vcc_hi, 0xaaaaaaaa
  v_mov_b32 v7, 0x3f80
  v_cndmask_b32 v7, v7, 1.0, vcc
  s_mov_b32 vcc_lo, 0x30003
  s_mov_b32 vcc_hi, 0x30003
  v_cndmask_b32 v68, 0, v7, vcc
  s_mov_b32 vcc_lo, 0xc000c
  s_mov_b32 vcc_hi, 0xc000c
  v_cndmask_b32 v69, 0, v7, vcc
  s_mov_b32 vcc_lo, 0x300030
  s_mov_b32 vcc_hi, 0x300030
  v_cndmask_b32 v70, 0, v7, vcc
  s_mov_b32 vcc_lo, 0xc000c0
  s_mov_b32 vcc_hi, 0xc000c0
  v_cndmask_b32 v71, 0, v7, vcc
  s_nop 15
  s_nop 15
  s_nop 15
  s_nop 15
  s_nop 5
  buffer_load_dwordx4 v[16:19], v0, s[4:7], s38 offen offset:0 sc1
  buffer_load_dwordx4 v[20:23], v0, s[4:7], s38 offen offset:1024 sc1
  buffer_load_dwordx4 v[24:27], v0, s[4:7], s38 offen offset:2048 sc1
  buffer_load_dwordx4 v[28:31], v0, s[4:7], s38 offen offset:3072 sc1
  buffer_load_dwordx4 v[32:35], v0, s[4:7], s39 offen offset:0 sc1
  buffer_load_dwordx4 v[36:39], v0, s[4:7], s39 offen offset:1024 sc1
  buffer_load_dwordx4 v[40:43], v0, s[4:7], s39 offen offset:2048 sc1
  buffer_load_dwordx4 v[44:47], v0, s[4:7], s39 offen offset:3072 sc1
  s_nop 14
  buffer_load_dwordx4 v[72:75], v0, s[4:7], s38 offen offset:0 sc1
  buffer_load_dwordx4 v[76:79], v0, s[4:7], s38 offen offset:1024 sc1
  buffer_load_dwordx4 v[80:83], v0, s[4:7], s38 offen offset:2048 sc1
  buffer_load_dwordx4 v[84:87], v0, s[4:7], s38 offen offset:3072 sc1
  buffer_load_dwordx4 v[88:91], v0, s[4:7], s39 offen offset:0 sc1
  buffer_load_dwordx4 v[92:95], v0, s[4:7], s39 offen offset:1024 sc1
  buffer_load_dwordx4 v[96:99], v0, s[4:7], s39 offen offset:2048 sc1
  buffer_load_dwordx4 v[100:103], v0, s[4:7], s39 offen offset:3072 sc1
  s_waitcnt vmcnt(15)
  v_mfma_f32_16x16x32_bf16 v[64:67], v[16:19], v[68:71], 0
  v_xor_b32 v7, s3, v16
  s_waitcnt vmcnt(14)
  v_mfma_f32_16x16x32_bf16 v[64:67], v[20:23], v[68:71], v[64:67]
  v_bitop3_b32 v7, v7, v20, s3 bitop3:0xf6
  s_waitcnt vmcnt(13)
  v_mfma_f32_16x16x32_bf16 v[64:67], v[24:27], v[68:71], v[64:67]
  v_bitop3_b32 v7, v7, v24, s3 bitop3:0xf6
  s_waitcnt vmcnt(12)
  v_mfma_f32_16x16x32_bf16 v[64:67], v[28:31], v[68:71], v[64:67]
  v_bitop3_b32 v7, v7, v28, s3 bitop3:0xf6
  s_waitcnt vmcnt(11)
  v_mfma_f32_16x16x32_bf16 v[64:67], v[32:35], v[68:71], v[64:67]
  v_bitop3_b32 v7, v7, v32, s3 bitop3:0xf6
  s_waitcnt vmcnt(10)
  v_mfma_f32_16x16x32_bf16 v[64:67], v[36:39], v[68:71], v[64:67]
  v_bitop3_b32 v7, v7, v36, s3 bitop3:0xf6
  s_waitcnt vmcnt(9)
  v_mfma_f32_16x16x32_bf16 v[64:67], v[40:43], v[68:71], v[64:67]
  v_bitop3_b32 v7, v7, v40, s3 bitop3:0xf6
  s_waitcnt vmcnt(8)
  v_mfma_f32_16x16x32_bf16 v[64:67], v[44:47], v[68:71], v[64:67]
  v_bitop3_b32 v7, v7, v44, s3 bitop3:0xf6
  v_and_b32 v7, 1, v7
  v_cmp_ne_u32 vcc, 0, v7
  v_mov_b32 v7, 0
  v_mov_b32 v7, 0
  s_cbranch_vccnz c_p1r_45
c_publ_46:
  s_nop 1
  v_cvt_pk_bf16_f32 v64, v64, v65
  v_cvt_pk_bf16_f32 v65, v66, v67
  v_min_u32 v64, -2, v64
  v_min_u32 v65, -2, v65
  buffer_store_dwordx2 v[64:65], v5, s[4:7], s42 offen sc1
c_hop2_32:
  s_barrier
  s_nop 15
  s_nop 13
  s_cmp_lg_u32 s96, 268435456
  s_cbranch_scc1 c_loop_29
  buffer_store_dwordx2 v[64:65], v5, s[4:7], s97 offen sc1
  s_mov_b32 s29, 0
  s_sub_u32 s92, s63, 4096
  s_sub_u32 s96, s23, 524288
  s_mov_b32 s95, 0
c_gw_47:
  buffer_load_dword v7, off, s[4:7], s92 sc1
  s_add_u32 s29, s29, 1
  s_cmp_gt_u32 s29, 1048576
  s_cbranch_scc1 c_fail_35
  s_waitcnt vmcnt(0) lgkmcnt(0)
  v_readfirstlane_b32 s65, v7
  s_cmp_eq_u32 s65, 0
  s_cbranch_scc1 c_gw_47
  s_and_b32 s65, s65, s93
  s_cbranch_scc1 c_kvx_49
  s_mov_b32 s95, 1
  s_add_u32 s96, s96, 33554432
  s_add_u32 s92, s92, 262144
c_kvw_48:
  buffer_load_dword v7, off, s[4:7], s92 sc1
  s_add_u32 s29, s29, 1
  s_cmp_gt_u32 s29, 1048576
  s_cbranch_scc1 c_fail_35
  s_waitcnt vmcnt(0) lgkmcnt(0)
  v_readfirstlane_b32 s65, v7
  s_cmp_eq_u32 s65, 0
  s_cbranch_scc1 c_kvw_48
c_kvx_49:
  buffer_load_dword v7, off, s[4:7], s63 sc1
  buffer_load_dwordx4 v0, s[4:7], s96 offen offset:0  lds
  buffer_load_dwordx4 v0, s[4:7], s96 offen offset:1024  lds
  buffer_load_dwordx4 v0, s[4:7], s96 offen offset:2048  lds
  buffer_load_dwordx4 v0, s[4:7], s96 offen offset:3072  lds
  s_waitcnt vmcnt(4)
  v_readfirstlane_b32 s65, v7
  s_cmp_eq_u32 s95, 0
  s_cbranch_scc1 c_loop_29
  s_mov_b32 s29, 0
c_fk_50:
  buffer_load_dwordx4 v[16:19], v8, s[4:7], s42 offen sc1
  buffer_load_dwordx4 v[20:23], v8, s[4:7], s43 offen sc1
  s_add_u32 s29, s29, 1
  s_cmp_gt_u32 s29, 1048576
  s_cbranch_scc1 c_fail_35
  s_waitcnt vmcnt(0)
  v_max3_u32 v7, v16, v17, v18
  v_max3_u32 v7, v19, v20, v7
  v_max3_u32 v7, v21, v22, v7
  v_max_u32 v7, v7, v23
  v_cmp_eq_u32 vcc, -1, v7
  s_cbranch_vccnz c_fk_50
  s_lshl_b32 s42, s22, 13
  s_add_u32 s42, s42, 245891072
  s_add_u32 s43, s42, 4096
  s_mov_b32 s95, 0
  s_branch c_loop_29
c_last_36:
  s_add_u32 s64, s64, 2048
  v_mov_b32 v7, 1
  s_waitcnt vmcnt(0)
  s_barrier
  s_mov_b64 exec, 1
  buffer_store_dword v7, off, s[4:7], s64 sc1
  s_mov_b64 exec, -1
  s_branch c_fail_35
c_oth_44:
  ds_read_b128 v[24:27], v1 offset:0
  ds_read_b128 v[28:31], v1 offset:1024
  ds_read_b128 v[32:35], v1 offset:2048
  ds_read_b128 v[36:39], v1 offset:3072
  ds_read_b128 v[40:43], v1 offset:4096
  ds_read_b128 v[44:47], v1 offset:5120
  ds_read_b128 v[72:75], v1 offset:6144
  ds_read_b128 v[76:79], v1 offset:7168
  ds_read_b128 v[80:83], v1 offset:8192
  ds_read_b128 v[84:87], v1 offset:9216
  ds_read_b128 v[88:91], v1 offset:10240
  ds_read_b128 v[92:95], v1 offset:11264
  ds_read_b128 v[96:99], v1 offset:12288
  ds_read_b128 v[100:103], v1 offset:13312
  ds_read_b128 v[104:107], v1 offset:14336
  ds_read_b128 v[108:111], v1 offset:15360
  ds_read_b128 v[112:115], v1 offset:16384
  ds_read_b128 v[116:119], v1 offset:17408
  ds_read_b128 v[120:123], v1 offset:18432
  ds_read_b128 v[124:127], v1 offset:19456
  v_mov_b64 v[64:65], 0
  v_mov_b64 v[66:67], 0
  v_mov_b64 v[68:69], 0
  v_mov_b64 v[70:71], 0
  s_branch c_hop2_32
c_w0a_40:
  s_waitcnt vmcnt(3)
  ds_read_b128 v[24:27], v1 offset:0
  ds_read_b128 v[28:31], v1 offset:1024
  ds_read_b128 v[32:35], v1 offset:2048
  ds_read_b128 v[36:39], v1 offset:3072
  ds_read_b128 v[40:43], v1 offset:4096
  ds_read_b128 v[44:47], v1 offset:5120
  ds_read_b128 v[72:75], v1 offset:6144
  ds_read_b128 v[76:79], v1 offset:7168
  ds_read_b128 v[80:83], v1 offset:8192
  ds_read_b128 v[84:87], v1 offset:9216
  buffer_load_dwordx4 v[16:19], v8, s[4:7], s42 offen sc1
  buffer_load_dwordx4 v[20:23], v8, s[4:7], s43 offen sc1
  ds_read_b128 v[88:91], v1 offset:10240
  ds_read_b128 v[92:95], v1 offset:11264
  ds_read_b128 v[96:99], v1 offset:12288
  ds_read_b128 v[100:103], v1 offset:13312
  ds_read_b128 v[104:107], v1 offset:14336
  ds_read_b128 v[108:111], v1 offset:15360
  ds_read_b128 v[112:115], v1 offset:16384
  ds_read_b128 v[116:119], v1 offset:17408
  ds_read_b128 v[120:123], v1 offset:18432
  ds_read_b128 v[124:127], v1 offset:19456
  buffer_load_dwordx4 v[16:19], v8, s[4:7], s42 offen sc1
  buffer_load_dwordx4 v[20:23], v8, s[4:7], s43 offen sc1
  v_mov_b64 v[64:65], 0
  v_mov_b64 v[66:67], 0
  v_mov_b64 v[68:69], 0
  v_mov_b64 v[70:71], 0
  s_branch c_w0b_41
c_p1r_45:
  buffer_load_dwordx4 v[16:19], v0, s[4:7], s38 offen offset:0 sc1
  buffer_load_dwordx4 v[20:23], v0, s[4:7], s38 offen offset:1024 sc1
  buffer_load_dwordx4 v[24:27], v0, s[4:7], s38 offen offset:2048 sc1
  buffer_load_dwordx4 v[28:31], v0, s[4:7], s38 offen offset:3072 sc1
  buffer_load_dwordx4 v[32:35], v0, s[4:7], s39 offen offset:0 sc1
  buffer_load_dwordx4 v[36:39], v0, s[4:7], s39 offen offset:1024 sc1
  buffer_load_dwordx4 v[40:43], v0, s[4:7], s39 offen offset:2048 sc1
  buffer_load_dwordx4 v[44:47], v0, s[4:7], s39 offen offset:3072 sc1
  s_add_u32 s46, s46, 1
  s_waitcnt vmcnt(15)
  v_mfma_f32_16x16x32_bf16 v[64:67], v[72:75], v[68:71], 0
  v_xor_b32 v7, s3, v72
  s_waitcnt vmcnt(14)
  v_mfma_f32_16x16x32_bf16 v[64:67], v[76:79], v[68:71], v[64:67]
  v_bitop3_b32 v7, v7, v76, s3 bitop3:0xf6
  s_waitcnt vmcnt(13)
  v_mfma_f32_16x16x32_bf16 v[64:67], v[80:83], v[68:71], v[64:67]
  v_bitop3_b32 v7, v7, v80, s3 bitop3:0xf6
  s_waitcnt vmcnt(12)
  v_mfma_f32_16x16x32_bf16 v[64:67], v[84:87], v[68:71], v[64:67]
  v_bitop3_b32 v7, v7, v84, s3 bitop3:0xf6
  s_waitcnt vmcnt(11)
  v_mfma_f32_16x16x32_bf16 v[64:67], v[88:91], v[68:71], v[64:67]
  v_bitop3_b32 v7, v7, v88, s3 bitop3:0xf6
  s_waitcnt vmcnt(10)
  v_mfma_f32_16x16x32_bf16 v[64:67], v[92:95], v[68:71], v[64:67]
  v_bitop3_b32 v7, v7, v92, s3 bitop3:0xf6
  s_waitcnt vmcnt(9)
  v_mfma_f32_16x16x32_bf16 v[64:67], v[96:99], v[68:71], v[64:67]
  v_bitop3_b32 v7, v7, v96, s3 bitop3:0xf6
  s_waitcnt vmcnt(8)
  v_mfma_f32_16x16x32_bf16 v[64:67], v[100:103], v[68:71], v[64:67]
  v_bitop3_b32 v7, v7, v100, s3 bitop3:0xf6
  v_and_b32 v7, 1, v7
  v_cmp_ne_u32 vcc, 0, v7
  v_mov_b32 v7, 0
  v_mov_b32 v7, 0
  s_cbranch_vccnz c_p1s_51
  s_branch c_publ_46
c_p1s_51:
  buffer_load_dwordx4 v[72:75], v0, s[4:7], s38 offen offset:0 sc1
  buffer_load_dwordx4 v[76:79], v0, s[4:7], s38 offen offset:1024 sc1
  buffer_load_dwordx4 v[80:83], v0, s[4:7], s38 offen offset:2048 sc1
  buffer_load_dwordx4 v[84:87], v0, s[4:7], s38 offen offset:3072 sc1
  buffer_load_dwordx4 v[88:91], v0, s[4:7], s39 offen offset:0 sc1
  buffer_load_dwordx4 v[92:95], v0, s[4:7], s39 offen offset:1024 sc1
  buffer_load_dwordx4 v[96:99], v0, s[4:7], s39 offen offset:2048 sc1
  buffer_load_dwordx4 v[100:103], v0, s[4:7], s39 offen offset:3072 sc1
  s_add_u32 s28, s28, 1
  s_add_u32 s46, s46, 1
  s_cmp_gt_u32 s28, 1048576
  s_cbranch_scc1 c_fail_35
  s_waitcnt vmcnt(15)
  v_mfma_f32_16x16x32_bf16 v[64:67], v[16:19], v[68:71], 0
  v_xor_b32 v7, s3, v16
  s_waitcnt vmcnt(14)
  v_mfma_f32_16x16x32_bf16 v[64:67], v[20:23], v[68:71], v[64:67]
  v_bitop3_b32 v7, v7, v20, s3 bitop3:0xf6
  s_waitcnt vmcnt(13)
  v_mfma_f32_16x16x32_bf16 v[64:67], v[24:27], v[68:71], v[64:67]
  v_bitop3_b32 v7, v7, v24, s3 bitop3:0xf6
  s_waitcnt vmcnt(12)
  v_mfma_f32_16x16x32_bf16 v[64:67], v[28:31], v[68:71], v[64:67]
  v_bitop3_b32 v7, v7, v28, s3 bitop3:0xf6
  s_waitcnt vmcnt(11)
  v_mfma_f32_16x16x32_bf16 v[64:67], v[32:35], v[68:71], v[64:67]
  v_bitop3_b32 v7, v7, v32, s3 bitop3:0xf6
  s_waitcnt vmcnt(10)
  v_mfma_f32_16x16x32_bf16 v[64:67], v[36:39], v[68:71], v[64:67]
  v_bitop3_b32 v7, v7, v36, s3 bitop3:0xf6
  s_waitcnt vmcnt(9)
  v_mfma_f32_16x16x32_bf16 v[64:67], v[40:43], v[68:71], v[64:67]
  v_bitop3_b32 v7, v7, v40, s3 bitop3:0xf6
  s_waitcnt vmcnt(8)
  v_mfma_f32_16x16x32_bf16 v[64:67], v[44:47], v[68:71], v[64:67]
  v_bitop3_b32 v7, v7, v44, s3 bitop3:0xf6
  v_and_b32 v7, 1, v7
  v_cmp_ne_u32 vcc, 0, v7
  v_mov_b32 v7, 0
  v_mov_b32 v7, 0
  s_cbranch_vccnz c_p1r_45
  s_branch c_publ_46
c_retry_30:
  buffer_load_dwordx4 v[16:19], v8, s[4:7], s42 offen sc1
  buffer_load_dwordx4 v[20:23], v8, s[4:7], s43 offen sc1
  s_add_u32 s28, s28, 1
  s_add_u32 s47, s47, 1
  s_cmp_gt_u32 s28, 1048576
  s_cbranch_scc1 c_fail_35
  v_mov_b64 v[48:49], 0
  v_mov_b64 v[50:51], 0
  v_mov_b64 v[52:53], 0
  v_mov_b64 v[54:55], 0
  v_mov_b64 v[56:57], 0
  v_mov_b64 v[58:59], 0
  s_waitcnt vmcnt(4)
  v_max3_u32 v7, v16, v17, v18
  v_max_u32 v7, v7, v19
  ds_write_b128 v8, v[16:19] offset:0
  v_smfmac_f32_16x16x64_bf16 v[48:51], v[16:19], v[24:31], v6
  s_branch c_got_31
c_fb_33:
  v_max3_f32 v7, v48, v49, v50
  v_max_f32 v7, v51, v7
  s_mov_b64 exec, s[18:19]
  v_max3_f32 v7, v16, v17, v7
  s_mov_b64 exec, -1
  s_nop 0
  v_max_f32_dpp v7, v7, v7 quad_perm:[2,3,0,1] row_mask:0xf bank_mask:0xf
  v_mov_b32 v24, v7
  s_nop 0
  s_nop 0
  v_permlane16_swap_b32 v7, v24
  v_max_f32 v7, v7, v24
  v_mov_b32 v24, v7
  s_nop 0
  s_nop 0
  v_permlane32_swap_b32 v7, v24
  v_max_f32 v7, v7, v24
  v_sub_f32 v24, v48, v7
  v_sub_f32 v25, v49, v7
  v_sub_f32 v26, v50, v7
  v_sub_f32 v27, v51, v7
  v_sub_f32 v28, v16, v7
  v_sub_f32 v29, v17, v7
  v_exp_f32 v24, v24
  v_exp_f32 v25, v25
  v_exp_f32 v26, v26
  v_exp_f32 v27, v27
  v_exp_f32 v28, v28
  v_exp_f32 v29, v29
  v_cvt_pk_bf16_f32 v24, v24, v25
  v_cvt_pk_bf16_f32 v25, v26, v27
  v_cvt_pk_bf16_f32 v28, v28, v29
  v_cndmask_b32 v72, v24, 0, s[18:19]
  v_cndmask_b32 v73, v25, 0, s[18:19]
  v_cndmask_b32 v74, 0, v24, s[18:19]
  v_cndmask_b32 v75, 0, v25, s[18:19]
  v_cndmask_b32 v77, 0, v28, s[18:19]
  v_cndmask_b32 v78, 0, v28, s[18:19]
  v_mfma_f32_16x16x32_bf16 v[60:63], v[72:75], v[20:23], 0
  v_mfma_f32_16x16x32_bf16 v[52:55], v[72:75], v[80:83], 0
  v_mfma_f32_16x16x32_bf16 v[56:59], v[72:75], v[84:87], 0
  s_nop 5
  v_mfma_f32_16x16x16_bf16 v[60:63], v[76:77], v[20:21], v[60:63]
  v_mfma_f32_16x16x16_bf16 v[52:55], v[78:79], v[66:67], v[52:55]
  v_mfma_f32_16x16x16_bf16 v[56:59], v[76:77], v[66:67], v[56:59]
  s_nop 7
  v_add_f32 v60, v60, v62
  v_add_f32 v61, v61, v63
  s_branch c_fbr_34
c_fail_35:
  s_endpgm
L_qkv:
  s_mul_i32 s26, s91, 15
  s_add_u32 s26, s26, s90
  s_sub_u32 s26, s26, 61
  s_add_u32 s27, s91, 89
  s_cmp_eq_u32 s90, 31
  s_cselect_b32 s26, s27, s26
  s_add_u32 s27, s90, 60
  s_cmp_eq_u32 s91, 7
  s_cselect_b32 s26, s27, s26
  s_mul_i32 s16, s26, 171
  s_lshr_b32 s16, s16, 9
  s_mul_i32 s27, s16, 3
  s_sub_u32 s60, s26, s27
  s_add_u32 s16, s16, 4
  s_and_b32 s16, s16, 31
  v_and_b32 v19, 63, v0
  v_and_b32 v6, 15, v19
  v_lshrrev_b32 v7, 4, v19
  v_lshlrev_b32 v1, 2, v19
  v_lshlrev_b32 v0, 4, v19
  v_lshlrev_b32 v9, 7, v19
  s_mov_b32 s24, 0x3e0293ee
  s_lshl_b32 s57, s16, 2
  s_add_u32 s57, s57, s17
  v_lshrrev_b32 v24, 1, v7
  v_xor_b32 v24, v24, v6
  v_lshlrev_b32 v24, 4, v24
  v_and_b32 v25, 31, v19
  v_lshl_add_u32 v24, v25, 10, v24
  v_xor_b32 v120, 0, v24
  v_xor_b32 v121, 32, v24
  v_xor_b32 v122, 64, v24
  v_xor_b32 v123, 96, v24
  v_xor_b32 v124, 128, v24
  v_xor_b32 v125, 160, v24
  v_xor_b32 v126, 192, v24
  v_xor_b32 v127, 224, v24
  v_and_b32 v24, 1, v7
  v_lshlrev_b32 v24, 10, v24
  v_lshl_add_u32 v24, v6, 4, v24
  v_lshrrev_b32 v25, 1, v7
  v_lshl_add_u32 v8, v25, 8, v24
  s_and_b32 s26, s17, 1
  s_lshl_b32 s26, s26, 7
  v_xor_b32 v24, s26, v0
  v_xor_b32 v12, 0, v24
  v_xor_b32 v13, 16, v24
  v_xor_b32 v14, 32, v24
  v_xor_b32 v15, 48, v24
  v_xor_b32 v16, 64, v24
  v_xor_b32 v17, 80, v24
  v_xor_b32 v18, 96, v24
  v_xor_b32 v19, 112, v24
  s_lshl_b32 s26, s17, 2
  s_add_u32 s26, s26, 162816
  v_mov_b32 v118, s26
  v_mov_b32 v119, 162816
  v_lshrrev_b32 v25, 8, v0
  v_and_b32 v20, 0xf0, v0
  v_lshlrev_b32 v21, 6, v25
  v_xor_b32 v20, v20, v21
  v_lshl_add_u32 v20, v25, 13, v20
  v_xor_b32 v21, 32, v20
  s_load_dwordx2 s[64:65], s[0:1], 24
  s_load_dwordx2 s[68:69], s[0:1], 32
  s_load_dwordx2 s[8:9], s[0:1], 16
  s_mov_b32 s10, 4194304
  s_mov_b32 s11, 0x20000
  s_mov_b32 s66, 4194304
  s_mov_b32 s67, 0x20000
  s_mov_b32 s70, 4194304
  s_mov_b32 s71, 0x20000
  v_lshrrev_b32 v25, 2, v6
  v_lshrrev_b32 v26, 1, v7
  v_lshl_add_u32 v27, v26, 3, v25
  v_lshlrev_b32 v27, 8, v27
  v_lshl_add_u32 v26, v25, 1, v26
  v_and_b32 v25, 1, v7
  v_xor_b32 v26, v26, v25
  s_lshl_b32 s26, s17, 1
  v_xor_b32 v26, s26, v26
  v_lshl_add_u32 v27, v26, 5, v27
  v_and_b32 v25, 3, v6
  v_lshl_add_u32 v22, v25, 3, v27
  v_add_u32 v23, 65536, v22
  v_add_u32 v24, 131072, v22
  s_lshl_b32 s28, s17, 13
  s_lshl_b32 s26, s17, 18
  s_lshl_b32 s27, s16, 8
  s_add_u32 s26, s26, s27
  s_waitcnt lgkmcnt(0)
  s_cmp_eq_u32 s60, 1
  s_cbranch_scc1 q_ld_53
  s_cmp_eq_u32 s60, 2
  s_cbranch_scc1 q_ld_54
q_ld_52:
  s_add_u32 s27, s26, 0
  s_add_u32 m0, s28, 0
  s_nop 0
  buffer_load_dwordx4 v20, s[64:67], s27 offen lds
  s_add_u32 m0, s28, 1024
  s_add_u32 s27, s27, 32768
  buffer_load_dwordx4 v20, s[64:67], s27 offen lds
  s_add_u32 m0, s28, 2048
  s_add_u32 s27, s27, 32768
  buffer_load_dwordx4 v21, s[64:67], s27 offen lds
  s_add_u32 m0, s28, 3072
  s_add_u32 s27, s27, 32768
  buffer_load_dwordx4 v21, s[64:67], s27 offen lds
  s_add_u32 m0, s28, 4096
  s_add_u32 s27, s27, 32768
  buffer_load_dwordx4 v20, s[64:67], s27 offen lds
  s_add_u32 m0, s28, 5120
  s_add_u32 s27, s27, 32768
  buffer_load_dwordx4 v20, s[64:67], s27 offen lds
  s_add_u32 m0, s28, 6144
  s_add_u32 s27, s27, 32768
  buffer_load_dwordx4 v21, s[64:67], s27 offen lds
  s_add_u32 m0, s28, 7168
  s_add_u32 s27, s27, 32768
  buffer_load_dwordx4 v21, s[64:67], s27 offen lds
  s_add_u32 s27, s26, 1048576
  s_add_u32 m0, s28, 32768
  s_nop 0
  buffer_load_dwordx4 v20, s[64:67], s27 offen lds
  s_add_u32 m0, s28, 33792
  s_add_u32 s27, s27, 32768
  buffer_load_dwordx4 v20, s[64:67], s27 offen lds
  s_add_u32 m0, s28, 34816
  s_add_u32 s27, s27, 32768
  buffer_load_dwordx4 v21, s[64:67], s27 offen lds
  s_add_u32 m0, s28, 35840
  s_add_u32 s27, s27, 32768
  buffer_load_dwordx4 v21, s[64:67], s27 offen lds
  s_add_u32 m0, s28, 36864
  s_add_u32 s27, s27, 32768
  buffer_load_dwordx4 v20, s[64:67], s27 offen lds
  s_add_u32 m0, s28, 37888
  s_add_u32 s27, s27, 32768
  buffer_load_dwordx4 v20, s[64:67], s27 offen lds
  s_add_u32 m0, s28, 38912
  s_add_u32 s27, s27, 32768
  buffer_load_dwordx4 v21, s[64:67], s27 offen lds
  s_add_u32 m0, s28, 39936
  s_add_u32 s27, s27, 32768
  buffer_load_dwordx4 v21, s[64:67], s27 offen lds
  s_add_u32 s27, s26, 2097152
  s_add_u32 m0, s28, 65536
  s_nop 0
  buffer_load_dwordx4 v20, s[64:67], s27 offen lds
  s_add_u32 m0, s28, 66560
  s_add_u32 s27, s27, 32768
  buffer_load_dwordx4 v20, s[64:67], s27 offen lds
  s_add_u32 m0, s28, 67584
  s_add_u32 s27, s27, 32768
  buffer_load_dwordx4 v21, s[64:67], s27 offen lds
  s_add_u32 m0, s28, 68608
  s_add_u32 s27, s27, 32768
  buffer_load_dwordx4 v21, s[64:67], s27 offen lds
  s_add_u32 m0, s28, 69632
  s_add_u32 s27, s27, 32768
  buffer_load_dwordx4 v20, s[64:67], s27 offen lds
  s_add_u32 m0, s28, 70656
  s_add_u32 s27, s27, 32768
  buffer_load_dwordx4 v20, s[64:67], s27 offen lds
  s_add_u32 m0, s28, 71680
  s_add_u32 s27, s27, 32768
  buffer_load_dwordx4 v21, s[64:67], s27 offen lds
  s_add_u32 m0, s28, 72704
  s_add_u32 s27, s27, 32768
  buffer_load_dwordx4 v21, s[64:67], s27 offen lds
  s_load_dwordx2 s[4:5], s[0:1], 112
  s_load_dwordx2 s[12:13], s[0:1], 104
  s_waitcnt vmcnt(16)
  s_barrier
  s_add_u32 s27, s26, 3145728
  s_add_u32 m0, s28, 98304
  s_nop 0
  buffer_load_dwordx4 v20, s[64:67], s27 offen lds
  s_add_u32 m0, s28, 99328
  s_add_u32 s27, s27, 32768
  buffer_load_dwordx4 v20, s[64:67], s27 offen lds
  s_add_u32 m0, s28, 100352
  s_add_u32 s27, s27, 32768
  buffer_load_dwordx4 v21, s[64:67], s27 offen lds
  s_add_u32 m0, s28, 101376
  s_add_u32 s27, s27, 32768
  buffer_load_dwordx4 v21, s[64:67], s27 offen lds
  s_add_u32 m0, s28, 102400
  s_add_u32 s27, s27, 32768
  buffer_load_dwordx4 v20, s[64:67], s27 offen lds
  s_add_u32 m0, s28, 103424
  s_add_u32 s27, s27, 32768
  buffer_load_dwordx4 v20, s[64:67], s27 offen lds
  s_add_u32 m0, s28, 104448
  s_add_u32 s27, s27, 32768
  buffer_load_dwordx4 v21, s[64:67], s27 offen lds
  s_add_u32 m0, s28, 105472
  s_add_u32 s27, s27, 32768
  buffer_load_dwordx4 v21, s[64:67], s27 offen lds
  ds_read_b64_tr_b16 v[128:129], v22 offset:0
  ds_read_b64_tr_b16 v[130:131], v22 offset:1024
  ds_read_b64_tr_b16 v[132:133], v22 offset:4096
  ds_read_b64_tr_b16 v[134:135], v22 offset:5120
  ds_read_b64_tr_b16 v[136:137], v22 offset:8192
  ds_read_b64_tr_b16 v[138:139], v22 offset:9216
  ds_read_b64_tr_b16 v[140:141], v22 offset:12288
  ds_read_b64_tr_b16 v[142:143], v22 offset:13312
  ds_read_b64_tr_b16 v[144:145], v22 offset:16384
  ds_read_b64_tr_b16 v[146:147], v22 offset:17408
  ds_read_b64_tr_b16 v[148:149], v22 offset:20480
  ds_read_b64_tr_b16 v[150:151], v22 offset:21504
  ds_read_b64_tr_b16 v[152:153], v22 offset:24576
  ds_read_b64_tr_b16 v[154:155], v22 offset:25600
  ds_read_b64_tr_b16 v[156:157], v22 offset:28672
  ds_read_b64_tr_b16 v[158:159], v22 offset:29696
  s_waitcnt lgkmcnt(0)
  s_waitcnt vmcnt(16)
  s_barrier
  s_add_u32 s27, s26, 0
  s_add_u32 m0, s28, 131072
  s_nop 0
  buffer_load_dwordx4 v20, s[68:71], s27 offen lds
  s_add_u32 m0, s28, 132096
  s_add_u32 s27, s27, 32768
  buffer_load_dwordx4 v20, s[68:71], s27 offen lds
  s_add_u32 m0, s28, 133120
  s_add_u32 s27, s27, 32768
  buffer_load_dwordx4 v21, s[68:71], s27 offen lds
  s_add_u32 m0, s28, 134144
  s_add_u32 s27, s27, 32768
  buffer_load_dwordx4 v21, s[68:71], s27 offen lds
  s_add_u32 m0, s28, 135168
  s_add_u32 s27, s27, 32768
  buffer_load_dwordx4 v20, s[68:71], s27 offen lds
  s_add_u32 m0, s28, 136192
  s_add_u32 s27, s27, 32768
  buffer_load_dwordx4 v20, s[68:71], s27 offen lds
  s_add_u32 m0, s28, 137216
  s_add_u32 s27, s27, 32768
  buffer_load_dwordx4 v21, s[68:71], s27 offen lds
  s_add_u32 m0, s28, 138240
  s_add_u32 s27, s27, 32768
  buffer_load_dwordx4 v21, s[68:71], s27 offen lds
  ds_read_b64_tr_b16 v[160:161], v22 offset:32768
  ds_read_b64_tr_b16 v[162:163], v22 offset:33792
  ds_read_b64_tr_b16 v[164:165], v22 offset:36864
  ds_read_b64_tr_b16 v[166:167], v22 offset:37888
  ds_read_b64_tr_b16 v[168:169], v22 offset:40960
  ds_read_b64_tr_b16 v[170:171], v22 offset:41984
  ds_read_b64_tr_b16 v[172:173], v22 offset:45056
  ds_read_b64_tr_b16 v[174:175], v22 offset:46080
  ds_read_b64_tr_b16 v[176:177], v22 offset:49152
  ds_read_b64_tr_b16 v[178:179], v22 offset:50176
  ds_read_b64_tr_b16 v[180:181], v22 offset:53248
  ds_read_b64_tr_b16 v[182:183], v22 offset:54272
  ds_read_b64_tr_b16 v[184:185], v22 offset:57344
  ds_read_b64_tr_b16 v[186:187], v22 offset:58368
  ds_read_b64_tr_b16 v[188:189], v22 offset:61440
  ds_read_b64_tr_b16 v[190:191], v22 offset:62464
  s_waitcnt lgkmcnt(0)
  s_waitcnt vmcnt(16)
  s_barrier
  s_add_u32 s27, s26, 1048576
  s_add_u32 m0, s28, 0
  s_nop 0
  buffer_load_dwordx4 v20, s[68:71], s27 offen lds
  s_add_u32 m0, s28, 1024
  s_add_u32 s27, s27, 32768
  buffer_load_dwordx4 v20, s[68:71], s27 offen lds
  s_add_u32 m0, s28, 2048
  s_add_u32 s27, s27, 32768
  buffer_load_dwordx4 v21, s[68:71], s27 offen lds
  s_add_u32 m0, s28, 3072
  s_add_u32 s27, s27, 32768
  buffer_load_dwordx4 v21, s[68:71], s27 offen lds
  s_add_u32 m0, s28, 4096
  s_add_u32 s27, s27, 32768
  buffer_load_dwordx4 v20, s[68:71], s27 offen lds
  s_add_u32 m0, s28, 5120
  s_add_u32 s27, s27, 32768
  buffer_load_dwordx4 v20, s[68:71], s27 offen lds
  s_add_u32 m0, s28, 6144
  s_add_u32 s27, s27, 32768
  buffer_load_dwordx4 v21, s[68:71], s27 offen lds
  s_add_u32 m0, s28, 7168
  s_add_u32 s27, s27, 32768
  buffer_load_dwordx4 v21, s[68:71], s27 offen lds
  ds_read_b64_tr_b16 v[192:193], v23 offset:0
  ds_read_b64_tr_b16 v[194:195], v23 offset:1024
  ds_read_b64_tr_b16 v[196:197], v23 offset:4096
  ds_read_b64_tr_b16 v[198:199], v23 offset:5120
  ds_read_b64_tr_b16 v[200:201], v23 offset:8192
  ds_read_b64_tr_b16 v[202:203], v23 offset:9216
  ds_read_b64_tr_b16 v[204:205], v23 offset:12288
  ds_read_b64_tr_b16 v[206:207], v23 offset:13312
  ds_read_b64_tr_b16 v[208:209], v23 offset:16384
  ds_read_b64_tr_b16 v[210:211], v23 offset:17408
  ds_read_b64_tr_b16 v[212:213], v23 offset:20480
  ds_read_b64_tr_b16 v[214:215], v23 offset:21504
  ds_read_b64_tr_b16 v[216:217], v23 offset:24576
  ds_read_b64_tr_b16 v[218:219], v23 offset:25600
  ds_read_b64_tr_b16 v[220:221], v23 offset:28672
  ds_read_b64_tr_b16 v[222:223], v23 offset:29696
  s_waitcnt lgkmcnt(0)
  s_waitcnt vmcnt(16)
  s_barrier
  s_add_u32 s27, s26, 2097152
  s_add_u32 m0, s28, 32768
  s_nop 0
  buffer_load_dwordx4 v20, s[68:71], s27 offen lds
  s_add_u32 m0, s28, 33792
  s_add_u32 s27, s27, 32768
  buffer_load_dwordx4 v20, s[68:71], s27 offen lds
  s_add_u32 m0, s28, 34816
  s_add_u32 s27, s27, 32768
  buffer_load_dwordx4 v21, s[68:71], s27 offen lds
  s_add_u32 m0, s28, 35840
  s_add_u32 s27, s27, 32768
  buffer_load_dwordx4 v21, s[68:71], s27 offen lds
  s_add_u32 m0, s28, 36864
  s_add_u32 s27, s27, 32768
  buffer_load_dwordx4 v20, s[68:71], s27 offen lds
  s_add_u32 m0, s28, 37888
  s_add_u32 s27, s27, 32768
  buffer_load_dwordx4 v20, s[68:71], s27 offen lds
  s_add_u32 m0, s28, 38912
  s_add_u32 s27, s27, 32768
  buffer_load_dwordx4 v21, s[68:71], s27 offen lds
  s_add_u32 m0, s28, 39936
  s_add_u32 s27, s27, 32768
  buffer_load_dwordx4 v21, s[68:71], s27 offen lds
  ds_read_b64_tr_b16 v[224:225], v23 offset:32768
  ds_read_b64_tr_b16 v[226:227], v23 offset:33792
  ds_read_b64_tr_b16 v[228:229], v23 offset:36864
  ds_read_b64_tr_b16 v[230:231], v23 offset:37888
  ds_read_b64_tr_b16 v[232:233], v23 offset:40960
  ds_read_b64_tr_b16 v[234:235], v23 offset:41984
  ds_read_b64_tr_b16 v[236:237], v23 offset:45056
  ds_read_b64_tr_b16 v[238:239], v23 offset:46080
  ds_read_b64_tr_b16 v[240:241], v23 offset:49152
  ds_read_b64_tr_b16 v[242:243], v23 offset:50176
  ds_read_b64_tr_b16 v[244:245], v23 offset:53248
  ds_read_b64_tr_b16 v[246:247], v23 offset:54272
  ds_read_b64_tr_b16 v[248:249], v23 offset:57344
  ds_read_b64_tr_b16 v[250:251], v23 offset:58368
  ds_read_b64_tr_b16 v[252:253], v23 offset:61440
  ds_read_b64_tr_b16 v[254:255], v23 offset:62464
  s_waitcnt lgkmcnt(0)
  s_waitcnt vmcnt(16)
  s_barrier
  s_add_u32 s27, s26, 3145728
  s_add_u32 m0, s28, 65536
  s_nop 0
  buffer_load_dwordx4 v20, s[68:71], s27 offen lds
  s_add_u32 m0, s28, 66560
  s_add_u32 s27, s27, 32768
  buffer_load_dwordx4 v20, s[68:71], s27 offen lds
  s_add_u32 m0, s28, 67584
  s_add_u32 s27, s27, 32768
  buffer_load_dwordx4 v21, s[68:71], s27 offen lds
  s_add_u32 m0, s28, 68608
  s_add_u32 s27, s27, 32768
  buffer_load_dwordx4 v21, s[68:71], s27 offen lds
  s_add_u32 m0, s28, 69632
  s_add_u32 s27, s27, 32768
  buffer_load_dwordx4 v20, s[68:71], s27 offen lds
  s_add_u32 m0, s28, 70656
  s_add_u32 s27, s27, 32768
  buffer_load_dwordx4 v20, s[68:71], s27 offen lds
  s_add_u32 m0, s28, 71680
  s_add_u32 s27, s27, 32768
  buffer_load_dwordx4 v21, s[68:71], s27 offen lds
  s_add_u32 m0, s28, 72704
  s_add_u32 s27, s27, 32768
  buffer_load_dwordx4 v21, s[68:71], s27 offen lds
  ds_read_b64_tr_b16 a[0:1], v24 offset:0
  ds_read_b64_tr_b16 a[2:3], v24 offset:1024
  ds_read_b64_tr_b16 a[4:5], v24 offset:4096
  ds_read_b64_tr_b16 a[6:7], v24 offset:5120
  ds_read_b64_tr_b16 a[8:9], v24 offset:8192
  ds_read_b64_tr_b16 a[10:11], v24 offset:9216
  ds_read_b64_tr_b16 a[12:13], v24 offset:12288
  ds_read_b64_tr_b16 a[14:15], v24 offset:13312
  ds_read_b64_tr_b16 a[16:17], v24 offset:16384
  ds_read_b64_tr_b16 a[18:19], v24 offset:17408
  ds_read_b64_tr_b16 a[20:21], v24 offset:20480
  ds_read_b64_tr_b16 a[22:23], v24 offset:21504
  ds_read_b64_tr_b16 a[24:25], v24 offset:24576
  ds_read_b64_tr_b16 a[26:27], v24 offset:25600
  ds_read_b64_tr_b16 a[28:29], v24 offset:28672
  ds_read_b64_tr_b16 a[30:31], v24 offset:29696
  s_waitcnt lgkmcnt(0)
  s_waitcnt vmcnt(16)
  s_barrier
  s_add_u32 s27, s26, 0
  s_add_u32 m0, s28, 98304
  s_nop 0
  buffer_load_dwordx4 v20, s[8:11], s27 offen lds
  s_add_u32 m0, s28, 99328
  s_add_u32 s27, s27, 32768
  buffer_load_dwordx4 v20, s[8:11], s27 offen lds
  s_add_u32 m0, s28, 100352
  s_add_u32 s27, s27, 32768
  buffer_load_dwordx4 v21, s[8:11], s27 offen lds
  s_add_u32 m0, s28, 101376
  s_add_u32 s27, s27, 32768
  buffer_load_dwordx4 v21, s[8:11], s27 offen lds
  s_add_u32 m0, s28, 102400
  s_add_u32 s27, s27, 32768
  buffer_load_dwordx4 v20, s[8:11], s27 offen lds
  s_add_u32 m0, s28, 103424
  s_add_u32 s27, s27, 32768
  buffer_load_dwordx4 v20, s[8:11], s27 offen lds
  s_add_u32 m0, s28, 104448
  s_add_u32 s27, s27, 32768
  buffer_load_dwordx4 v21, s[8:11], s27 offen lds
  s_add_u32 m0, s28, 105472
  s_add_u32 s27, s27, 32768
  buffer_load_dwordx4 v21, s[8:11], s27 offen lds
  ds_read_b64_tr_b16 a[32:33], v22 offset:0
  ds_read_b64_tr_b16 a[34:35], v22 offset:1024
  ds_read_b64_tr_b16 a[36:37], v22 offset:4096
  ds_read_b64_tr_b16 a[38:39], v22 offset:5120
  ds_read_b64_tr_b16 a[40:41], v22 offset:8192
  ds_read_b64_tr_b16 a[42:43], v22 offset:9216
  ds_read_b64_tr_b16 a[44:45], v22 offset:12288
  ds_read_b64_tr_b16 a[46:47], v22 offset:13312
  ds_read_b64_tr_b16 a[48:49], v22 offset:16384
  ds_read_b64_tr_b16 a[50:51], v22 offset:17408
  ds_read_b64_tr_b16 a[52:53], v22 offset:20480
  ds_read_b64_tr_b16 a[54:55], v22 offset:21504
  ds_read_b64_tr_b16 a[56:57], v22 offset:24576
  ds_read_b64_tr_b16 a[58:59], v22 offset:25600
  ds_read_b64_tr_b16 a[60:61], v22 offset:28672
  ds_read_b64_tr_b16 a[62:63], v22 offset:29696
  s_waitcnt lgkmcnt(0)
  s_waitcnt vmcnt(16)
  s_barrier
  s_add_u32 s27, s26, 1048576
  s_add_u32 m0, s28, 131072
  s_nop 0
  buffer_load_dwordx4 v20, s[8:11], s27 offen lds
  s_add_u32 m0, s28, 132096
  s_add_u32 s27, s27, 32768
  buffer_load_dwordx4 v20, s[8:11], s27 offen lds
  s_add_u32 m0, s28, 133120
  s_add_u32 s27, s27, 32768
  buffer_load_dwordx4 v21, s[8:11], s27 offen lds
  s_add_u32 m0, s28, 134144
  s_add_u32 s27, s27, 32768
  buffer_load_dwordx4 v21, s[8:11], s27 offen lds
  s_add_u32 m0, s28, 135168
  s_add_u32 s27, s27, 32768
  buffer_load_dwordx4 v20, s[8:11], s27 offen lds
  s_add_u32 m0, s28, 136192
  s_add_u32 s27, s27, 32768
  buffer_load_dwordx4 v20, s[8:11], s27 offen lds
  s_add_u32 m0, s28, 137216
  s_add_u32 s27, s27, 32768
  buffer_load_dwordx4 v21, s[8:11], s27 offen lds
  s_add_u32 m0, s28, 138240
  s_add_u32 s27, s27, 32768
  buffer_load_dwordx4 v21, s[8:11], s27 offen lds
  ds_read_b64_tr_b16 a[64:65], v22 offset:32768
  ds_read_b64_tr_b16 a[66:67], v22 offset:33792
  ds_read_b64_tr_b16 a[68:69], v22 offset:36864
  ds_read_b64_tr_b16 a[70:71], v22 offset:37888
  ds_read_b64_tr_b16 a[72:73], v22 offset:40960
  ds_read_b64_tr_b16 a[74:75], v22 offset:41984
  ds_read_b64_tr_b16 a[76:77], v22 offset:45056
  ds_read_b64_tr_b16 a[78:79], v22 offset:46080
  ds_read_b64_tr_b16 a[80:81], v22 offset:49152
  ds_read_b64_tr_b16 a[82:83], v22 offset:50176
  ds_read_b64_tr_b16 a[84:85], v22 offset:53248
  ds_read_b64_tr_b16 a[86:87], v22 offset:54272
  ds_read_b64_tr_b16 a[88:89], v22 offset:57344
  ds_read_b64_tr_b16 a[90:91], v22 offset:58368
  ds_read_b64_tr_b16 a[92:93], v22 offset:61440
  ds_read_b64_tr_b16 a[94:95], v22 offset:62464
  s_waitcnt lgkmcnt(0)
  s_waitcnt vmcnt(16)
  s_barrier
  s_add_u32 s27, s26, 2097152
  s_add_u32 m0, s28, 0
  s_nop 0
  buffer_load_dwordx4 v20, s[8:11], s27 offen lds
  s_add_u32 m0, s28, 1024
  s_add_u32 s27, s27, 32768
  buffer_load_dwordx4 v20, s[8:11], s27 offen lds
  s_add_u32 m0, s28, 2048
  s_add_u32 s27, s27, 32768
  buffer_load_dwordx4 v21, s[8:11], s27 offen lds
  s_add_u32 m0, s28, 3072
  s_add_u32 s27, s27, 32768
  buffer_load_dwordx4 v21, s[8:11], s27 offen lds
  s_add_u32 m0, s28, 4096
  s_add_u32 s27, s27, 32768
  buffer_load_dwordx4 v20, s[8:11], s27 offen lds
  s_add_u32 m0, s28, 5120
  s_add_u32 s27, s27, 32768
  buffer_load_dwordx4 v20, s[8:11], s27 offen lds
  s_add_u32 m0, s28, 6144
  s_add_u32 s27, s27, 32768
  buffer_load_dwordx4 v21, s[8:11], s27 offen lds
  s_add_u32 m0, s28, 7168
  s_add_u32 s27, s27, 32768
  buffer_load_dwordx4 v21, s[8:11], s27 offen lds
  ds_read_b64_tr_b16 a[96:97], v23 offset:0
  ds_read_b64_tr_b16 a[98:99], v23 offset:1024
  ds_read_b64_tr_b16 a[100:101], v23 offset:4096
  ds_read_b64_tr_b16 a[102:103], v23 offset:5120
  ds_read_b64_tr_b16 a[104:105], v23 offset:8192
  ds_read_b64_tr_b16 a[106:107], v23 offset:9216
  ds_read_b64_tr_b16 a[108:109], v23 offset:12288
  ds_read_b64_tr_b16 a[110:111], v23 offset:13312
  ds_read_b64_tr_b16 a[112:113], v23 offset:16384
  ds_read_b64_tr_b16 a[114:115], v23 offset:17408
  ds_read_b64_tr_b16 a[116:117], v23 offset:20480
  ds_read_b64_tr_b16 a[118:119], v23 offset:21504
  ds_read_b64_tr_b16 a[120:121], v23 offset:24576
  ds_read_b64_tr_b16 a[122:123], v23 offset:25600
  ds_read_b64_tr_b16 a[124:125], v23 offset:28672
  ds_read_b64_tr_b16 a[126:127], v23 offset:29696
  s_waitcnt lgkmcnt(0)
  s_waitcnt vmcnt(16)
  s_barrier
  s_add_u32 s27, s26, 3145728
  s_add_u32 m0, s28, 32768
  s_nop 0
  buffer_load_dwordx4 v20, s[8:11], s27 offen lds
  s_add_u32 m0, s28, 33792
  s_add_u32 s27, s27, 32768
  buffer_load_dwordx4 v20, s[8:11], s27 offen lds
  s_add_u32 m0, s28, 34816
  s_add_u32 s27, s27, 32768
  buffer_load_dwordx4 v21, s[8:11], s27 offen lds
  s_add_u32 m0, s28, 35840
  s_add_u32 s27, s27, 32768
  buffer_load_dwordx4 v21, s[8:11], s27 offen lds
  s_add_u32 m0, s28, 36864
  s_add_u32 s27, s27, 32768
  buffer_load_dwordx4 v20, s[8:11], s27 offen lds
  s_add_u32 m0, s28, 37888
  s_add_u32 s27, s27, 32768
  buffer_load_dwordx4 v20, s[8:11], s27 offen lds
  s_add_u32 m0, s28, 38912
  s_add_u32 s27, s27, 32768
  buffer_load_dwordx4 v21, s[8:11], s27 offen lds
  s_add_u32 m0, s28, 39936
  s_add_u32 s27, s27, 32768
  buffer_load_dwordx4 v21, s[8:11], s27 offen lds
  ds_read_b64_tr_b16 a[128:129], v23 offset:32768
  ds_read_b64_tr_b16 a[130:131], v23 offset:33792
  ds_read_b64_tr_b16 a[132:133], v23 offset:36864
  ds_read_b64_tr_b16 a[134:135], v23 offset:37888
  ds_read_b64_tr_b16 a[136:137], v23 offset:40960
  ds_read_b64_tr_b16 a[138:139], v23 offset:41984
  ds_read_b64_tr_b16 a[140:141], v23 offset:45056
  ds_read_b64_tr_b16 a[142:143], v23 offset:46080
  ds_read_b64_tr_b16 a[144:145], v23 offset:49152
  ds_read_b64_tr_b16 a[146:147], v23 offset:50176
  ds_read_b64_tr_b16 a[148:149], v23 offset:53248
  ds_read_b64_tr_b16 a[150:151], v23 offset:54272
  ds_read_b64_tr_b16 a[152:153], v23 offset:57344
  ds_read_b64_tr_b16 a[154:155], v23 offset:58368
  ds_read_b64_tr_b16 a[156:157], v23 offset:61440
  ds_read_b64_tr_b16 a[158:159], v23 offset:62464
  s_waitcnt lgkmcnt(0)
  s_waitcnt vmcnt(16)
  s_barrier
  ds_read_b64_tr_b16 a[160:161], v24 offset:0
  ds_read_b64_tr_b16 a[162:163], v24 offset:1024
  ds_read_b64_tr_b16 a[164:165], v24 offset:4096
  ds_read_b64_tr_b16 a[166:167], v24 offset:5120
  ds_read_b64_tr_b16 a[168:169], v24 offset:8192
  ds_read_b64_tr_b16 a[170:171], v24 offset:9216
  ds_read_b64_tr_b16 a[172:173], v24 offset:12288
  ds_read_b64_tr_b16 a[174:175], v24 offset:13312
  ds_read_b64_tr_b16 a[176:177], v24 offset:16384
  ds_read_b64_tr_b16 a[178:179], v24 offset:17408
  ds_read_b64_tr_b16 a[180:181], v24 offset:20480
  ds_read_b64_tr_b16 a[182:183], v24 offset:21504
  ds_read_b64_tr_b16 a[184:185], v24 offset:24576
  ds_read_b64_tr_b16 a[186:187], v24 offset:25600
  ds_read_b64_tr_b16 a[188:189], v24 offset:28672
  ds_read_b64_tr_b16 a[190:191], v24 offset:29696
  s_waitcnt lgkmcnt(0)
  s_waitcnt vmcnt(8)
  s_barrier
  ds_read_b64_tr_b16 a[192:193], v22 offset:0
  ds_read_b64_tr_b16 a[194:195], v22 offset:1024
  ds_read_b64_tr_b16 a[196:197], v22 offset:4096
  ds_read_b64_tr_b16 a[198:199], v22 offset:5120
  ds_read_b64_tr_b16 a[200:201], v22 offset:8192
  ds_read_b64_tr_b16 a[202:203], v22 offset:9216
  ds_read_b64_tr_b16 a[204:205], v22 offset:12288
  ds_read_b64_tr_b16 a[206:207], v22 offset:13312
  ds_read_b64_tr_b16 a[208:209], v22 offset:16384
  ds_read_b64_tr_b16 a[210:211], v22 offset:17408
  ds_read_b64_tr_b16 a[212:213], v22 offset:20480
  ds_read_b64_tr_b16 a[214:215], v22 offset:21504
  ds_read_b64_tr_b16 a[216:217], v22 offset:24576
  ds_read_b64_tr_b16 a[218:219], v22 offset:25600
  ds_read_b64_tr_b16 a[220:221], v22 offset:28672
  ds_read_b64_tr_b16 a[222:223], v22 offset:29696
  s_waitcnt lgkmcnt(0)
  s_waitcnt vmcnt(0)
  s_barrier
  ds_read_b64_tr_b16 a[224:225], v22 offset:32768
  ds_read_b64_tr_b16 a[226:227], v22 offset:33792
  ds_read_b64_tr_b16 a[228:229], v22 offset:36864
  ds_read_b64_tr_b16 a[230:231], v22 offset:37888
  ds_read_b64_tr_b16 a[232:233], v22 offset:40960
  ds_read_b64_tr_b16 a[234:235], v22 offset:41984
  ds_read_b64_tr_b16 a[236:237], v22 offset:45056
  ds_read_b64_tr_b16 a[238:239], v22 offset:46080
  ds_read_b64_tr_b16 a[240:241], v22 offset:49152
  ds_read_b64_tr_b16 a[242:243], v22 offset:50176
  ds_read_b64_tr_b16 a[244:245], v22 offset:53248
  ds_read_b64_tr_b16 a[246:247], v22 offset:54272
  ds_read_b64_tr_b16 a[248:249], v22 offset:57344
  ds_read_b64_tr_b16 a[250:251], v22 offset:58368
  ds_read_b64_tr_b16 a[252:253], v22 offset:61440
  ds_read_b64_tr_b16 a[254:255], v22 offset:62464
  s_waitcnt lgkmcnt(0)
  s_branch q_ld_55
q_ld_53:
  s_add_u32 s27, s26, 0
  s_add_u32 m0, s28, 0
  s_nop 0
  buffer_load_dwordx4 v20, s[68:71], s27 offen lds
  s_add_u32 m0, s28, 1024
  s_add_u32 s27, s27, 32768
  buffer_load_dwordx4 v20, s[68:71], s27 offen lds
  s_add_u32 m0, s28, 2048
  s_add_u32 s27, s27, 32768
  buffer_load_dwordx4 v21, s[68:71], s27 offen lds
  s_add_u32 m0, s28, 3072
  s_add_u32 s27, s27, 32768
  buffer_load_dwordx4 v21, s[68:71], s27 offen lds
  s_add_u32 m0, s28, 4096
  s_add_u32 s27, s27, 32768
  buffer_load_dwordx4 v20, s[68:71], s27 offen lds
  s_add_u32 m0, s28, 5120
  s_add_u32 s27, s27, 32768
  buffer_load_dwordx4 v20, s[68:71], s27 offen lds
  s_add_u32 m0, s28, 6144
  s_add_u32 s27, s27, 32768
  buffer_load_dwordx4 v21, s[68:71], s27 offen lds
  s_add_u32 m0, s28, 7168
  s_add_u32 s27, s27, 32768
  buffer_load_dwordx4 v21, s[68:71], s27 offen lds
  s_add_u32 s27, s26, 1048576
  s_add_u32 m0, s28, 32768
  s_nop 0
  buffer_load_dwordx4 v20, s[68:71], s27 offen lds
  s_add_u32 m0, s28, 33792
  s_add_u32 s27, s27, 32768
  buffer_load_dwordx4 v20, s[68:71], s27 offen lds
  s_add_u32 m0, s28, 34816
  s_add_u32 s27, s27, 32768
  buffer_load_dwordx4 v21, s[68:71], s27 offen lds
  s_add_u32 m0, s28, 35840
  s_add_u32 s27, s27, 32768
  buffer_load_dwordx4 v21, s[68:71], s27 offen lds
  s_add_u32 m0, s28, 36864
  s_add_u32 s27, s27, 32768
  buffer_load_dwordx4 v20, s[68:71], s27 offen lds
  s_add_u32 m0, s28, 37888
  s_add_u32 s27, s27, 32768
  buffer_load_dwordx4 v20, s[68:71], s27 offen lds
  s_add_u32 m0, s28, 38912
  s_add_u32 s27, s27, 32768
  buffer_load_dwordx4 v21, s[68:71], s27 offen lds
  s_add_u32 m0, s28, 39936
  s_add_u32 s27, s27, 32768
  buffer_load_dwordx4 v21, s[68:71], s27 offen lds
  s_add_u32 s27, s26, 2097152
  s_add_u32 m0, s28, 65536
  s_nop 0
  buffer_load_dwordx4 v20, s[68:71], s27 offen lds
  s_add_u32 m0, s28, 66560
  s_add_u32 s27, s27, 32768
  buffer_load_dwordx4 v20, s[68:71], s27 offen lds
  s_add_u32 m0, s28, 67584
  s_add_u32 s27, s27, 32768
  buffer_load_dwordx4 v21, s[68:71], s27 offen lds
  s_add_u32 m0, s28, 68608
  s_add_u32 s27, s27, 32768
  buffer_load_dwordx4 v21, s[68:71], s27 offen lds
  s_add_u32 m0, s28, 69632
  s_add_u32 s27, s27, 32768
  buffer_load_dwordx4 v20, s[68:71], s27 offen lds
  s_add_u32 m0, s28, 70656
  s_add_u32 s27, s27, 32768
  buffer_load_dwordx4 v20, s[68:71], s27 offen lds
  s_add_u32 m0, s28, 71680
  s_add_u32 s27, s27, 32768
  buffer_load_dwordx4 v21, s[68:71], s27 offen lds
  s_add_u32 m0, s28, 72704
  s_add_u32 s27, s27, 32768
  buffer_load_dwordx4 v21, s[68:71], s27 offen lds
  s_load_dwordx2 s[4:5], s[0:1], 112
  s_load_dwordx2 s[12:13], s[0:1], 104
  s_waitcnt vmcnt(16)
  s_barrier
  s_add_u32 s27, s26, 3145728
  s_add_u32 m0, s28, 98304
  s_nop 0
  buffer_load_dwordx4 v20, s[68:71], s27 offen lds
  s_add_u32 m0, s28, 99328
  s_add_u32 s27, s27, 32768
  buffer_load_dwordx4 v20, s[68:71], s27 offen lds
  s_add_u32 m0, s28, 100352
  s_add_u32 s27, s27, 32768
  buffer_load_dwordx4 v21, s[68:71], s27 offen lds
  s_add_u32 m0, s28, 101376
  s_add_u32 s27, s27, 32768
  buffer_load_dwordx4 v21, s[68:71], s27 offen lds
  s_add_u32 m0, s28, 102400
  s_add_u32 s27, s27, 32768
  buffer_load_dwordx4 v20, s[68:71], s27 offen lds
  s_add_u32 m0, s28, 103424
  s_add_u32 s27, s27, 32768
  buffer_load_dwordx4 v20, s[68:71], s27 offen lds
  s_add_u32 m0, s28, 104448
  s_add_u32 s27, s27, 32768
  buffer_load_dwordx4 v21, s[68:71], s27 offen lds
  s_add_u32 m0, s28, 105472
  s_add_u32 s27, s27, 32768
  buffer_load_dwordx4 v21, s[68:71], s27 offen lds
  ds_read_b64_tr_b16 a[0:1], v22 offset:0
  ds_read_b64_tr_b16 a[2:3], v22 offset:1024
  ds_read_b64_tr_b16 a[4:5], v22 offset:4096
  ds_read_b64_tr_b16 a[6:7], v22 offset:5120
  ds_read_b64_tr_b16 a[8:9], v22 offset:8192
  ds_read_b64_tr_b16 a[10:11], v22 offset:9216
  ds_read_b64_tr_b16 a[12:13], v22 offset:12288
  ds_read_b64_tr_b16 a[14:15], v22 offset:13312
  ds_read_b64_tr_b16 a[16:17], v22 offset:16384
  ds_read_b64_tr_b16 a[18:19], v22 offset:17408
  ds_read_b64_tr_b16 a[20:21], v22 offset:20480
  ds_read_b64_tr_b16 a[22:23], v22 offset:21504
  ds_read_b64_tr_b16 a[24:25], v22 offset:24576
  ds_read_b64_tr_b16 a[26:27], v22 offset:25600
  ds_read_b64_tr_b16 a[28:29], v22 offset:28672
  ds_read_b64_tr_b16 a[30:31], v22 offset:29696
  s_waitcnt lgkmcnt(0)
  s_waitcnt vmcnt(16)
  s_barrier
  s_add_u32 s27, s26, 0
  s_add_u32 m0, s28, 131072
  s_nop 0
  buffer_load_dwordx4 v20, s[8:11], s27 offen lds
  s_add_u32 m0, s28, 132096
  s_add_u32 s27, s27, 32768
  buffer_load_dwordx4 v20, s[8:11], s27 offen lds
  s_add_u32 m0, s28, 133120
  s_add_u32 s27, s27, 32768
  buffer_load_dwordx4 v21, s[8:11], s27 offen lds
  s_add_u32 m0, s28, 134144
  s_add_u32 s27, s27, 32768
  buffer_load_dwordx4 v21, s[8:11], s27 offen lds
  s_add_u32 m0, s28, 135168
  s_add_u32 s27, s27, 32768
  buffer_load_dwordx4 v20, s[8:11], s27 offen lds
  s_add_u32 m0, s28, 136192
  s_add_u32 s27, s27, 32768
  buffer_load_dwordx4 v20, s[8:11], s27 offen lds
  s_add_u32 m0, s28, 137216
  s_add_u32 s27, s27, 32768
  buffer_load_dwordx4 v21, s[8:11], s27 offen lds
  s_add_u32 m0, s28, 138240
  s_add_u32 s27, s27, 32768
  buffer_load_dwordx4 v21, s[8:11], s27 offen lds
  ds_read_b64_tr_b16 a[32:33], v22 offset:32768
  ds_read_b64_tr_b16 a[34:35], v22 offset:33792
  ds_read_b64_tr_b16 a[36:37], v22 offset:36864
  ds_read_b64_tr_b16 a[38:39], v22 offset:37888
  ds_read_b64_tr_b16 a[40:41], v22 offset:40960
  ds_read_b64_tr_b16 a[42:43], v22 offset:41984
  ds_read_b64_tr_b16 a[44:45], v22 offset:45056
  ds_read_b64_tr_b16 a[46:47], v22 offset:46080
  ds_read_b64_tr_b16 a[48:49], v22 offset:49152
  ds_read_b64_tr_b16 a[50:51], v22 offset:50176
  ds_read_b64_tr_b16 a[52:53], v22 offset:53248
  ds_read_b64_tr_b16 a[54:55], v22 offset:54272
  ds_read_b64_tr_b16 a[56:57], v22 offset:57344
  ds_read_b64_tr_b16 a[58:59], v22 offset:58368
  ds_read_b64_tr_b16 a[60:61], v22 offset:61440
  ds_read_b64_tr_b16 a[62:63], v22 offset:62464
  s_waitcnt lgkmcnt(0)
  s_waitcnt vmcnt(16)
  s_barrier
  s_add_u32 s27, s26, 1048576
  s_add_u32 m0, s28, 0
  s_nop 0
  buffer_load_dwordx4 v20, s[8:11], s27 offen lds
  s_add_u32 m0, s28, 1024
  s_add_u32 s27, s27, 32768
  buffer_load_dwordx4 v20, s[8:11], s27 offen lds
  s_add_u32 m0, s28, 2048
  s_add_u32 s27, s27, 32768
  buffer_load_dwordx4 v21, s[8:11], s27 offen lds
  s_add_u32 m0, s28, 3072
  s_add_u32 s27, s27, 32768
  buffer_load_dwordx4 v21, s[8:11], s27 offen lds
  s_add_u32 m0, s28, 4096
  s_add_u32 s27, s27, 32768
  buffer_load_dwordx4 v20, s[8:11], s27 offen lds
  s_add_u32 m0, s28, 5120
  s_add_u32 s27, s27, 32768
  buffer_load_dwordx4 v20, s[8:11], s27 offen lds
  s_add_u32 m0, s28, 6144
  s_add_u32 s27, s27, 32768
  buffer_load_dwordx4 v21, s[8:11], s27 offen lds
  s_add_u32 m0, s28, 7168
  s_add_u32 s27, s27, 32768
  buffer_load_dwordx4 v21, s[8:11], s27 offen lds
  ds_read_b64_tr_b16 a[64:65], v23 offset:0
  ds_read_b64_tr_b16 a[66:67], v23 offset:1024
  ds_read_b64_tr_b16 a[68:69], v23 offset:4096
  ds_read_b64_tr_b16 a[70:71], v23 offset:5120
  ds_read_b64_tr_b16 a[72:73], v23 offset:8192
  ds_read_b64_tr_b16 a[74:75], v23 offset:9216
  ds_read_b64_tr_b16 a[76:77], v23 offset:12288
  ds_read_b64_tr_b16 a[78:79], v23 offset:13312
  ds_read_b64_tr_b16 a[80:81], v23 offset:16384
  ds_read_b64_tr_b16 a[82:83], v23 offset:17408
  ds_read_b64_tr_b16 a[84:85], v23 offset:20480
  ds_read_b64_tr_b16 a[86:87], v23 offset:21504
  ds_read_b64_tr_b16 a[88:89], v23 offset:24576
  ds_read_b64_tr_b16 a[90:91], v23 offset:25600
  ds_read_b64_tr_b16 a[92:93], v23 offset:28672
  ds_read_b64_tr_b16 a[94:95], v23 offset:29696
  s_waitcnt lgkmcnt(0)
  s_waitcnt vmcnt(16)
  s_barrier
  s_add_u32 s27, s26, 2097152
  s_add_u32 m0, s28, 32768
  s_nop 0
  buffer_load_dwordx4 v20, s[8:11], s27 offen lds
  s_add_u32 m0, s28, 33792
  s_add_u32 s27, s27, 32768
  buffer_load_dwordx4 v20, s[8:11], s27 offen lds
  s_add_u32 m0, s28, 34816
  s_add_u32 s27, s27, 32768
  buffer_load_dwordx4 v21, s[8:11], s27 offen lds
  s_add_u32 m0, s28, 35840
  s_add_u32 s27, s27, 32768
  buffer_load_dwordx4 v21, s[8:11], s27 offen lds
  s_add_u32 m0, s28, 36864
  s_add_u32 s27, s27, 32768
  buffer_load_dwordx4 v20, s[8:11], s27 offen lds
  s_add_u32 m0, s28, 37888
  s_add_u32 s27, s27, 32768
  buffer_load_dwordx4 v20, s[8:11], s27 offen lds
  s_add_u32 m0, s28, 38912
  s_add_u32 s27, s27, 32768
  buffer_load_dwordx4 v21, s[8:11], s27 offen lds
  s_add_u32 m0, s28, 39936
  s_add_u32 s27, s27, 32768
  buffer_load_dwordx4 v21, s[8:11], s27 offen lds
  ds_read_b64_tr_b16 a[96:97], v23 offset:32768
  ds_read_b64_tr_b16 a[98:99], v23 offset:33792
  ds_read_b64_tr_b16 a[100:101], v23 offset:36864
  ds_read_b64_tr_b16 a[102:103], v23 offset:37888
  ds_read_b64_tr_b16 a[104:105], v23 offset:40960
  ds_read_b64_tr_b16 a[106:107], v23 offset:41984
  ds_read_b64_tr_b16 a[108:109], v23 offset:45056
  ds_read_b64_tr_b16 a[110:111], v23 offset:46080
  ds_read_b64_tr_b16 a[112:113], v23 offset:49152
  ds_read_b64_tr_b16 a[114:115], v23 offset:50176
  ds_read_b64_tr_b16 a[116:117], v23 offset:53248
  ds_read_b64_tr_b16 a[118:119], v23 offset:54272
  ds_read_b64_tr_b16 a[120:121], v23 offset:57344
  ds_read_b64_tr_b16 a[122:123], v23 offset:58368
  ds_read_b64_tr_b16 a[124:125], v23 offset:61440
  ds_read_b64_tr_b16 a[126:127], v23 offset:62464
  s_waitcnt lgkmcnt(0)
  s_waitcnt vmcnt(16)
  s_barrier
  s_add_u32 s27, s26, 3145728
  s_add_u32 m0, s28, 65536
  s_nop 0
  buffer_load_dwordx4 v20, s[8:11], s27 offen lds
  s_add_u32 m0, s28, 66560
  s_add_u32 s27, s27, 32768
  buffer_load_dwordx4 v20, s[8:11], s27 offen lds
  s_add_u32 m0, s28, 67584
  s_add_u32 s27, s27, 32768
  buffer_load_dwordx4 v21, s[8:11], s27 offen lds
  s_add_u32 m0, s28, 68608
  s_add_u32 s27, s27, 32768
  buffer_load_dwordx4 v21, s[8:11], s27 offen lds
  s_add_u32 m0, s28, 69632
  s_add_u32 s27, s27, 32768
  buffer_load_dwordx4 v20, s[8:11], s27 offen lds
  s_add_u32 m0, s28, 70656
  s_add_u32 s27, s27, 32768
  buffer_load_dwordx4 v20, s[8:11], s27 offen lds
  s_add_u32 m0, s28, 71680
  s_add_u32 s27, s27, 32768
  buffer_load_dwordx4 v21, s[8:11], s27 offen lds
  s_add_u32 m0, s28, 72704
  s_add_u32 s27, s27, 32768
  buffer_load_dwordx4 v21, s[8:11], s27 offen lds
  ds_read_b64_tr_b16 a[128:129], v24 offset:0
  ds_read_b64_tr_b16 a[130:131], v24 offset:1024
  ds_read_b64_tr_b16 a[132:133], v24 offset:4096
  ds_read_b64_tr_b16 a[134:135], v24 offset:5120
  ds_read_b64_tr_b16 a[136:137], v24 offset:8192
  ds_read_b64_tr_b16 a[138:139], v24 offset:9216
  ds_read_b64_tr_b16 a[140:141], v24 offset:12288
  ds_read_b64_tr_b16 a[142:143], v24 offset:13312
  ds_read_b64_tr_b16 a[144:145], v24 offset:16384
  ds_read_b64_tr_b16 a[146:147], v24 offset:17408
  ds_read_b64_tr_b16 a[148:149], v24 offset:20480
  ds_read_b64_tr_b16 a[150:151], v24 offset:21504
  ds_read_b64_tr_b16 a[152:153], v24 offset:24576
  ds_read_b64_tr_b16 a[154:155], v24 offset:25600
  ds_read_b64_tr_b16 a[156:157], v24 offset:28672
  ds_read_b64_tr_b16 a[158:159], v24 offset:29696
  s_waitcnt lgkmcnt(0)
  s_waitcnt vmcnt(16)
  s_barrier
  s_add_u32 s27, s26, 0
  s_add_u32 m0, s28, 98304
  s_nop 0
  buffer_load_dwordx4 v20, s[64:67], s27 offen lds
  s_add_u32 m0, s28, 99328
  s_add_u32 s27, s27, 32768
  buffer_load_dwordx4 v20, s[64:67], s27 offen lds
  s_add_u32 m0, s28, 100352
  s_add_u32 s27, s27, 32768
  buffer_load_dwordx4 v21, s[64:67], s27 offen lds
  s_add_u32 m0, s28, 101376
  s_add_u32 s27, s27, 32768
  buffer_load_dwordx4 v21, s[64:67], s27 offen lds
  s_add_u32 m0, s28, 102400
  s_add_u32 s27, s27, 32768
  buffer_load_dwordx4 v20, s[64:67], s27 offen lds
  s_add_u32 m0, s28, 103424
  s_add_u32 s27, s27, 32768
  buffer_load_dwordx4 v20, s[64:67], s27 offen lds
  s_add_u32 m0, s28, 104448
  s_add_u32 s27, s27, 32768
  buffer_load_dwordx4 v21, s[64:67], s27 offen lds
  s_add_u32 m0, s28, 105472
  s_add_u32 s27, s27, 32768
  buffer_load_dwordx4 v21, s[64:67], s27 offen lds
  ds_read_b64_tr_b16 a[160:161], v22 offset:0
  ds_read_b64_tr_b16 a[162:163], v22 offset:1024
  ds_read_b64_tr_b16 a[164:165], v22 offset:4096
  ds_read_b64_tr_b16 a[166:167], v22 offset:5120
  ds_read_b64_tr_b16 a[168:169], v22 offset:8192
  ds_read_b64_tr_b16 a[170:171], v22 offset:9216
  ds_read_b64_tr_b16 a[172:173], v22 offset:12288
  ds_read_b64_tr_b16 a[174:175], v22 offset:13312
  ds_read_b64_tr_b16 a[176:177], v22 offset:16384
  ds_read_b64_tr_b16 a[178:179], v22 offset:17408
  ds_read_b64_tr_b16 a[180:181], v22 offset:20480
  ds_read_b64_tr_b16 a[182:183], v22 offset:21504
  ds_read_b64_tr_b16 a[184:185], v22 offset:24576
  ds_read_b64_tr_b16 a[186:187], v22 offset:25600
  ds_read_b64_tr_b16 a[188:189], v22 offset:28672
  ds_read_b64_tr_b16 a[190:191], v22 offset:29696
  s_waitcnt lgkmcnt(0)
  s_waitcnt vmcnt(16)
  s_barrier
  s_add_u32 s27, s26, 1048576
  s_add_u32 m0, s28, 131072
  s_nop 0
  buffer_load_dwordx4 v20, s[64:67], s27 offen lds
  s_add_u32 m0, s28, 132096
  s_add_u32 s27, s27, 32768
  buffer_load_dwordx4 v20, s[64:67], s27 offen lds
  s_add_u32 m0, s28, 133120
  s_add_u32 s27, s27, 32768
  buffer_load_dwordx4 v21, s[64:67], s27 offen lds
  s_add_u32 m0, s28, 134144
  s_add_u32 s27, s27, 32768
  buffer_load_dwordx4 v21, s[64:67], s27 offen lds
  s_add_u32 m0, s28, 135168
  s_add_u32 s27, s27, 32768
  buffer_load_dwordx4 v20, s[64:67], s27 offen lds
  s_add_u32 m0, s28, 136192
  s_add_u32 s27, s27, 32768
  buffer_load_dwordx4 v20, s[64:67], s27 offen lds
  s_add_u32 m0, s28, 137216
  s_add_u32 s27, s27, 32768
  buffer_load_dwordx4 v21, s[64:67], s27 offen lds
  s_add_u32 m0, s28, 138240
  s_add_u32 s27, s27, 32768
  buffer_load_dwordx4 v21, s[64:67], s27 offen lds
  ds_read_b64_tr_b16 a[192:193], v22 offset:32768
  ds_read_b64_tr_b16 a[194:195], v22 offset:33792
  ds_read_b64_tr_b16 a[196:197], v22 offset:36864
  ds_read_b64_tr_b16 a[198:199], v22 offset:37888
  ds_read_b64_tr_b16 a[200:201], v22 offset:40960
  ds_read_b64_tr_b16 a[202:203], v22 offset:41984
  ds_read_b64_tr_b16 a[204:205], v22 offset:45056
  ds_read_b64_tr_b16 a[206:207], v22 offset:46080
  ds_read_b64_tr_b16 a[208:209], v22 offset:49152
  ds_read_b64_tr_b16 a[210:211], v22 offset:50176
  ds_read_b64_tr_b16 a[212:213], v22 offset:53248
  ds_read_b64_tr_b16 a[214:215], v22 offset:54272
  ds_read_b64_tr_b16 a[216:217], v22 offset:57344
  ds_read_b64_tr_b16 a[218:219], v22 offset:58368
  ds_read_b64_tr_b16 a[220:221], v22 offset:61440
  ds_read_b64_tr_b16 a[222:223], v22 offset:62464
  s_waitcnt lgkmcnt(0)
  s_waitcnt vmcnt(16)
  s_barrier
  s_add_u32 s27, s26, 2097152
  s_add_u32 m0, s28, 0
  s_nop 0
  buffer_load_dwordx4 v20, s[64:67], s27 offen lds
  s_add_u32 m0, s28, 1024
  s_add_u32 s27, s27, 32768
  buffer_load_dwordx4 v20, s[64:67], s27 offen lds
  s_add_u32 m0, s28, 2048
  s_add_u32 s27, s27, 32768
  buffer_load_dwordx4 v21, s[64:67], s27 offen lds
  s_add_u32 m0, s28, 3072
  s_add_u32 s27, s27, 32768
  buffer_load_dwordx4 v21, s[64:67], s27 offen lds
  s_add_u32 m0, s28, 4096
  s_add_u32 s27, s27, 32768
  buffer_load_dwordx4 v20, s[64:67], s27 offen lds
  s_add_u32 m0, s28, 5120
  s_add_u32 s27, s27, 32768
  buffer_load_dwordx4 v20, s[64:67], s27 offen lds
  s_add_u32 m0, s28, 6144
  s_add_u32 s27, s27, 32768
  buffer_load_dwordx4 v21, s[64:67], s27 offen lds
  s_add_u32 m0, s28, 7168
  s_add_u32 s27, s27, 32768
  buffer_load_dwordx4 v21, s[64:67], s27 offen lds
  ds_read_b64_tr_b16 a[224:225], v23 offset:0
  ds_read_b64_tr_b16 a[226:227], v23 offset:1024
  ds_read_b64_tr_b16 a[228:229], v23 offset:4096
  ds_read_b64_tr_b16 a[230:231], v23 offset:5120
  ds_read_b64_tr_b16 a[232:233], v23 offset:8192
  ds_read_b64_tr_b16 a[234:235], v23 offset:9216
  ds_read_b64_tr_b16 a[236:237], v23 offset:12288
  ds_read_b64_tr_b16 a[238:239], v23 offset:13312
  ds_read_b64_tr_b16 a[240:241], v23 offset:16384
  ds_read_b64_tr_b16 a[242:243], v23 offset:17408
  ds_read_b64_tr_b16 a[244:245], v23 offset:20480
  ds_read_b64_tr_b16 a[246:247], v23 offset:21504
  ds_read_b64_tr_b16 a[248:249], v23 offset:24576
  ds_read_b64_tr_b16 a[250:251], v23 offset:25600
  ds_read_b64_tr_b16 a[252:253], v23 offset:28672
  ds_read_b64_tr_b16 a[254:255], v23 offset:29696
  s_waitcnt lgkmcnt(0)
  s_waitcnt vmcnt(16)
  s_barrier
  s_add_u32 s27, s26, 3145728
  s_add_u32 m0, s28, 32768
  s_nop 0
  buffer_load_dwordx4 v20, s[64:67], s27 offen lds
  s_add_u32 m0, s28, 33792
  s_add_u32 s27, s27, 32768
  buffer_load_dwordx4 v20, s[64:67], s27 offen lds
  s_add_u32 m0, s28, 34816
  s_add_u32 s27, s27, 32768
  buffer_load_dwordx4 v21, s[64:67], s27 offen lds
  s_add_u32 m0, s28, 35840
  s_add_u32 s27, s27, 32768
  buffer_load_dwordx4 v21, s[64:67], s27 offen lds
  s_add_u32 m0, s28, 36864
  s_add_u32 s27, s27, 32768
  buffer_load_dwordx4 v20, s[64:67], s27 offen lds
  s_add_u32 m0, s28, 37888
  s_add_u32 s27, s27, 32768
  buffer_load_dwordx4 v20, s[64:67], s27 offen lds
  s_add_u32 m0, s28, 38912
  s_add_u32 s27, s27, 32768
  buffer_load_dwordx4 v21, s[64:67], s27 offen lds
  s_add_u32 m0, s28, 39936
  s_add_u32 s27, s27, 32768
  buffer_load_dwordx4 v21, s[64:67], s27 offen lds
  ds_read_b64_tr_b16 v[128:129], v23 offset:32768
  ds_read_b64_tr_b16 v[130:131], v23 offset:33792
  ds_read_b64_tr_b16 v[132:133], v23 offset:36864
  ds_read_b64_tr_b16 v[134:135], v23 offset:37888
  ds_read_b64_tr_b16 v[136:137], v23 offset:40960
  ds_read_b64_tr_b16 v[138:139], v23 offset:41984
  ds_read_b64_tr_b16 v[140:141], v23 offset:45056
  ds_read_b64_tr_b16 v[142:143], v23 offset:46080
  ds_read_b64_tr_b16 v[144:145], v23 offset:49152
  ds_read_b64_tr_b16 v[146:147], v23 offset:50176
  ds_read_b64_tr_b16 v[148:149], v23 offset:53248
  ds_read_b64_tr_b16 v[150:151], v23 offset:54272
  ds_read_b64_tr_b16 v[152:153], v23 offset:57344
  ds_read_b64_tr_b16 v[154:155], v23 offset:58368
  ds_read_b64_tr_b16 v[156:157], v23 offset:61440
  ds_read_b64_tr_b16 v[158:159], v23 offset:62464
  s_waitcnt lgkmcnt(0)
  s_waitcnt vmcnt(16)
  s_barrier
  ds_read_b64_tr_b16 v[160:161], v24 offset:0
  ds_read_b64_tr_b16 v[162:163], v24 offset:1024
  ds_read_b64_tr_b16 v[164:165], v24 offset:4096
  ds_read_b64_tr_b16 v[166:167], v24 offset:5120
  ds_read_b64_tr_b16 v[168:169], v24 offset:8192
  ds_read_b64_tr_b16 v[170:171], v24 offset:9216
  ds_read_b64_tr_b16 v[172:173], v24 offset:12288
  ds_read_b64_tr_b16 v[174:175], v24 offset:13312
  ds_read_b64_tr_b16 v[176:177], v24 offset:16384
  ds_read_b64_tr_b16 v[178:179], v24 offset:17408
  ds_read_b64_tr_b16 v[180:181], v24 offset:20480
  ds_read_b64_tr_b16 v[182:183], v24 offset:21504
  ds_read_b64_tr_b16 v[184:185], v24 offset:24576
  ds_read_b64_tr_b16 v[186:187], v24 offset:25600
  ds_read_b64_tr_b16 v[188:189], v24 offset:28672
  ds_read_b64_tr_b16 v[190:191], v24 offset:29696
  s_waitcnt lgkmcnt(0)
  s_waitcnt vmcnt(8)
  s_barrier
  ds_read_b64_tr_b16 v[192:193], v22 offset:0
  ds_read_b64_tr_b16 v[194:195], v22 offset:1024
  ds_read_b64_tr_b16 v[196:197], v22 offset:4096
  ds_read_b64_tr_b16 v[198:199], v22 offset:5120
  ds_read_b64_tr_b16 v[200:201], v22 offset:8192
  ds_read_b64_tr_b16 v[202:203], v22 offset:9216
  ds_read_b64_tr_b16 v[204:205], v22 offset:12288
  ds_read_b64_tr_b16 v[206:207], v22 offset:13312
  ds_read_b64_tr_b16 v[208:209], v22 offset:16384
  ds_read_b64_tr_b16 v[210:211], v22 offset:17408
  ds_read_b64_tr_b16 v[212:213], v22 offset:20480
  ds_read_b64_tr_b16 v[214:215], v22 offset:21504
  ds_read_b64_tr_b16 v[216:217], v22 offset:24576
  ds_read_b64_tr_b16 v[218:219], v22 offset:25600
  ds_read_b64_tr_b16 v[220:221], v22 offset:28672
  ds_read_b64_tr_b16 v[222:223], v22 offset:29696
  s_waitcnt lgkmcnt(0)
  s_waitcnt vmcnt(0)
  s_barrier
  ds_read_b64_tr_b16 v[224:225], v22 offset:32768
  ds_read_b64_tr_b16 v[226:227], v22 offset:33792
  ds_read_b64_tr_b16 v[228:229], v22 offset:36864
  ds_read_b64_tr_b16 v[230:231], v22 offset:37888
  ds_read_b64_tr_b16 v[232:233], v22 offset:40960
  ds_read_b64_tr_b16 v[234:235], v22 offset:41984
  ds_read_b64_tr_b16 v[236:237], v22 offset:45056
  ds_read_b64_tr_b16 v[238:239], v22 offset:46080
  ds_read_b64_tr_b16 v[240:241], v22 offset:49152
  ds_read_b64_tr_b16 v[242:243], v22 offset:50176
  ds_read_b64_tr_b16 v[244:245], v22 offset:53248
  ds_read_b64_tr_b16 v[246:247], v22 offset:54272
  ds_read_b64_tr_b16 v[248:249], v22 offset:57344
  ds_read_b64_tr_b16 v[250:251], v22 offset:58368
  ds_read_b64_tr_b16 v[252:253], v22 offset:61440
  ds_read_b64_tr_b16 v[254:255], v22 offset:62464
  s_waitcnt lgkmcnt(0)
  s_branch q_ld_55
q_ld_54:
  s_add_u32 s27, s26, 0
  s_add_u32 m0, s28, 0
  s_nop 0
  buffer_load_dwordx4 v20, s[8:11], s27 offen lds
  s_add_u32 m0, s28, 1024
  s_add_u32 s27, s27, 32768
  buffer_load_dwordx4 v20, s[8:11], s27 offen lds
  s_add_u32 m0, s28, 2048
  s_add_u32 s27, s27, 32768
  buffer_load_dwordx4 v21, s[8:11], s27 offen lds
  s_add_u32 m0, s28, 3072
  s_add_u32 s27, s27, 32768
  buffer_load_dwordx4 v21, s[8:11], s27 offen lds
  s_add_u32 m0, s28, 4096
  s_add_u32 s27, s27, 32768
  buffer_load_dwordx4 v20, s[8:11], s27 offen lds
  s_add_u32 m0, s28, 5120
  s_add_u32 s27, s27, 32768
  buffer_load_dwordx4 v20, s[8:11], s27 offen lds
  s_add_u32 m0, s28, 6144
  s_add_u32 s27, s27, 32768
  buffer_load_dwordx4 v21, s[8:11], s27 offen lds
  s_add_u32 m0, s28, 7168
  s_add_u32 s27, s27, 32768
  buffer_load_dwordx4 v21, s[8:11], s27 offen lds
  s_add_u32 s27, s26, 1048576
  s_add_u32 m0, s28, 32768
  s_nop 0
  buffer_load_dwordx4 v20, s[8:11], s27 offen lds
  s_add_u32 m0, s28, 33792
  s_add_u32 s27, s27, 32768
  buffer_load_dwordx4 v20, s[8:11], s27 offen lds
  s_add_u32 m0, s28, 34816
  s_add_u32 s27, s27, 32768
  buffer_load_dwordx4 v21, s[8:11], s27 offen lds
  s_add_u32 m0, s28, 35840
  s_add_u32 s27, s27, 32768
  buffer_load_dwordx4 v21, s[8:11], s27 offen lds
  s_add_u32 m0, s28, 36864
  s_add_u32 s27, s27, 32768
  buffer_load_dwordx4 v20, s[8:11], s27 offen lds
  s_add_u32 m0, s28, 37888
  s_add_u32 s27, s27, 32768
  buffer_load_dwordx4 v20, s[8:11], s27 offen lds
  s_add_u32 m0, s28, 38912
  s_add_u32 s27, s27, 32768
  buffer_load_dwordx4 v21, s[8:11], s27 offen lds
  s_add_u32 m0, s28, 39936
  s_add_u32 s27, s27, 32768
  buffer_load_dwordx4 v21, s[8:11], s27 offen lds
  s_add_u32 s27, s26, 2097152
  s_add_u32 m0, s28, 65536
  s_nop 0
  buffer_load_dwordx4 v20, s[8:11], s27 offen lds
  s_add_u32 m0, s28, 66560
  s_add_u32 s27, s27, 32768
  buffer_load_dwordx4 v20, s[8:11], s27 offen lds
  s_add_u32 m0, s28, 67584
  s_add_u32 s27, s27, 32768
  buffer_load_dwordx4 v21, s[8:11], s27 offen lds
  s_add_u32 m0, s28, 68608
  s_add_u32 s27, s27, 32768
  buffer_load_dwordx4 v21, s[8:11], s27 offen lds
  s_add_u32 m0, s28, 69632
  s_add_u32 s27, s27, 32768
  buffer_load_dwordx4 v20, s[8:11], s27 offen lds
  s_add_u32 m0, s28, 70656
  s_add_u32 s27, s27, 32768
  buffer_load_dwordx4 v20, s[8:11], s27 offen lds
  s_add_u32 m0, s28, 71680
  s_add_u32 s27, s27, 32768
  buffer_load_dwordx4 v21, s[8:11], s27 offen lds
  s_add_u32 m0, s28, 72704
  s_add_u32 s27, s27, 32768
  buffer_load_dwordx4 v21, s[8:11], s27 offen lds
  s_load_dwordx2 s[4:5], s[0:1], 112
  s_load_dwordx2 s[12:13], s[0:1], 104
  s_waitcnt vmcnt(16)
  s_barrier
  s_add_u32 s27, s26, 3145728
  s_add_u32 m0, s28, 98304
  s_nop 0
  buffer_load_dwordx4 v20, s[8:11], s27 offen lds
  s_add_u32 m0, s28, 99328
  s_add_u32 s27, s27, 32768
  buffer_load_dwordx4 v20, s[8:11], s27 offen lds
  s_add_u32 m0, s28, 100352
  s_add_u32 s27, s27, 32768
  buffer_load_dwordx4 v21, s[8:11], s27 offen lds
  s_add_u32 m0, s28, 101376
  s_add_u32 s27, s27, 32768
  buffer_load_dwordx4 v21, s[8:11], s27 offen lds
  s_add_u32 m0, s28, 102400
  s_add_u32 s27, s27, 32768
  buffer_load_dwordx4 v20, s[8:11], s27 offen lds
  s_add_u32 m0, s28, 103424
  s_add_u32 s27, s27, 32768
  buffer_load_dwordx4 v20, s[8:11], s27 offen lds
  s_add_u32 m0, s28, 104448
  s_add_u32 s27, s27, 32768
  buffer_load_dwordx4 v21, s[8:11], s27 offen lds
  s_add_u32 m0, s28, 105472
  s_add_u32 s27, s27, 32768
  buffer_load_dwordx4 v21, s[8:11], s27 offen lds
  ds_read_b64_tr_b16 a[128:129], v22 offset:0
  ds_read_b64_tr_b16 a[130:131], v22 offset:1024
  ds_read_b64_tr_b16 a[132:133], v22 offset:4096
  ds_read_b64_tr_b16 a[134:135], v22 offset:5120
  ds_read_b64_tr_b16 a[136:137], v22 offset:8192
  ds_read_b64_tr_b16 a[138:139], v22 offset:9216
  ds_read_b64_tr_b16 a[140:141], v22 offset:12288
  ds_read_b64_tr_b16 a[142:143], v22 offset:13312
  ds_read_b64_tr_b16 a[144:145], v22 offset:16384
  ds_read_b64_tr_b16 a[146:147], v22 offset:17408
  ds_read_b64_tr_b16 a[148:149], v22 offset:20480
  ds_read_b64_tr_b16 a[150:151], v22 offset:21504
  ds_read_b64_tr_b16 a[152:153], v22 offset:24576
  ds_read_b64_tr_b16 a[154:155], v22 offset:25600
  ds_read_b64_tr_b16 a[156:157], v22 offset:28672
  ds_read_b64_tr_b16 a[158:159], v22 offset:29696
  s_waitcnt lgkmcnt(0)
  s_waitcnt vmcnt(16)
  s_barrier
  s_add_u32 s27, s26, 0
  s_add_u32 m0, s28, 131072
  s_nop 0
  buffer_load_dwordx4 v20, s[64:67], s27 offen lds
  s_add_u32 m0, s28, 132096
  s_add_u32 s27, s27, 32768
  buffer_load_dwordx4 v20, s[64:67], s27 offen lds
  s_add_u32 m0, s28, 133120
  s_add_u32 s27, s27, 32768
  buffer_load_dwordx4 v21, s[64:67], s27 offen lds
  s_add_u32 m0, s28, 134144
  s_add_u32 s27, s27, 32768
  buffer_load_dwordx4 v21, s[64:67], s27 offen lds
  s_add_u32 m0, s28, 135168
  s_add_u32 s27, s27, 32768
  buffer_load_dwordx4 v20, s[64:67], s27 offen lds
  s_add_u32 m0, s28, 136192
  s_add_u32 s27, s27, 32768
  buffer_load_dwordx4 v20, s[64:67], s27 offen lds
  s_add_u32 m0, s28, 137216
  s_add_u32 s27, s27, 32768
  buffer_load_dwordx4 v21, s[64:67], s27 offen lds
  s_add_u32 m0, s28, 138240
  s_add_u32 s27, s27, 32768
  buffer_load_dwordx4 v21, s[64:67], s27 offen lds
  ds_read_b64_tr_b16 a[160:161], v22 offset:32768
  ds_read_b64_tr_b16 a[162:163], v22 offset:33792
  ds_read_b64_tr_b16 a[164:165], v22 offset:36864
  ds_read_b64_tr_b16 a[166:167], v22 offset:37888
  ds_read_b64_tr_b16 a[168:169], v22 offset:40960
  ds_read_b64_tr_b16 a[170:171], v22 offset:41984
  ds_read_b64_tr_b16 a[172:173], v22 offset:45056
  ds_read_b64_tr_b16 a[174:175], v22 offset:46080
  ds_read_b64_tr_b16 a[176:177], v22 offset:49152
  ds_read_b64_tr_b16 a[178:179], v22 offset:50176
  ds_read_b64_tr_b16 a[180:181], v22 offset:53248
  ds_read_b64_tr_b16 a[182:183], v22 offset:54272
  ds_read_b64_tr_b16 a[184:185], v22 offset:57344
  ds_read_b64_tr_b16 a[186:187], v22 offset:58368
  ds_read_b64_tr_b16 a[188:189], v22 offset:61440
  ds_read_b64_tr_b16 a[190:191], v22 offset:62464
  s_waitcnt lgkmcnt(0)
  s_waitcnt vmcnt(16)
  s_barrier
  s_add_u32 s27, s26, 1048576
  s_add_u32 m0, s28, 0
  s_nop 0
  buffer_load_dwordx4 v20, s[64:67], s27 offen lds
  s_add_u32 m0, s28, 1024
  s_add_u32 s27, s27, 32768
  buffer_load_dwordx4 v20, s[64:67], s27 offen lds
  s_add_u32 m0, s28, 2048
  s_add_u32 s27, s27, 32768
  buffer_load_dwordx4 v21, s[64:67], s27 offen lds
  s_add_u32 m0, s28, 3072
  s_add_u32 s27, s27, 32768
  buffer_load_dwordx4 v21, s[64:67], s27 offen lds
  s_add_u32 m0, s28, 4096
  s_add_u32 s27, s27, 32768
  buffer_load_dwordx4 v20, s[64:67], s27 offen lds
  s_add_u32 m0, s28, 5120
  s_add_u32 s27, s27, 32768
  buffer_load_dwordx4 v20, s[64:67], s27 offen lds
  s_add_u32 m0, s28, 6144
  s_add_u32 s27, s27, 32768
  buffer_load_dwordx4 v21, s[64:67], s27 offen lds
  s_add_u32 m0, s28, 7168
  s_add_u32 s27, s27, 32768
  buffer_load_dwordx4 v21, s[64:67], s27 offen lds
  ds_read_b64_tr_b16 a[192:193], v23 offset:0
  ds_read_b64_tr_b16 a[194:195], v23 offset:1024
  ds_read_b64_tr_b16 a[196:197], v23 offset:4096
  ds_read_b64_tr_b16 a[198:199], v23 offset:5120
  ds_read_b64_tr_b16 a[200:201], v23 offset:8192
  ds_read_b64_tr_b16 a[202:203], v23 offset:9216
  ds_read_b64_tr_b16 a[204:205], v23 offset:12288
  ds_read_b64_tr_b16 a[206:207], v23 offset:13312
  ds_read_b64_tr_b16 a[208:209], v23 offset:16384
  ds_read_b64_tr_b16 a[210:211], v23 offset:17408
  ds_read_b64_tr_b16 a[212:213], v23 offset:20480
  ds_read_b64_tr_b16 a[214:215], v23 offset:21504
  ds_read_b64_tr_b16 a[216:217], v23 offset:24576
  ds_read_b64_tr_b16 a[218:219], v23 offset:25600
  ds_read_b64_tr_b16 a[220:221], v23 offset:28672
  ds_read_b64_tr_b16 a[222:223], v23 offset:29696
  s_waitcnt lgkmcnt(0)
  s_waitcnt vmcnt(16)
  s_barrier
  s_add_u32 s27, s26, 2097152
  s_add_u32 m0, s28, 32768
  s_nop 0
  buffer_load_dwordx4 v20, s[64:67], s27 offen lds
  s_add_u32 m0, s28, 33792
  s_add_u32 s27, s27, 32768
  buffer_load_dwordx4 v20, s[64:67], s27 offen lds
  s_add_u32 m0, s28, 34816
  s_add_u32 s27, s27, 32768
  buffer_load_dwordx4 v21, s[64:67], s27 offen lds
  s_add_u32 m0, s28, 35840
  s_add_u32 s27, s27, 32768
  buffer_load_dwordx4 v21, s[64:67], s27 offen lds
  s_add_u32 m0, s28, 36864
  s_add_u32 s27, s27, 32768
  buffer_load_dwordx4 v20, s[64:67], s27 offen lds
  s_add_u32 m0, s28, 37888
  s_add_u32 s27, s27, 32768
  buffer_load_dwordx4 v20, s[64:67], s27 offen lds
  s_add_u32 m0, s28, 38912
  s_add_u32 s27, s27, 32768
  buffer_load_dwordx4 v21, s[64:67], s27 offen lds
  s_add_u32 m0, s28, 39936
  s_add_u32 s27, s27, 32768
  buffer_load_dwordx4 v21, s[64:67], s27 offen lds
  ds_read_b64_tr_b16 a[224:225], v23 offset:32768
  ds_read_b64_tr_b16 a[226:227], v23 offset:33792
  ds_read_b64_tr_b16 a[228:229], v23 offset:36864
  ds_read_b64_tr_b16 a[230:231], v23 offset:37888
  ds_read_b64_tr_b16 a[232:233], v23 offset:40960
  ds_read_b64_tr_b16 a[234:235], v23 offset:41984
  ds_read_b64_tr_b16 a[236:237], v23 offset:45056
  ds_read_b64_tr_b16 a[238:239], v23 offset:46080
  ds_read_b64_tr_b16 a[240:241], v23 offset:49152
  ds_read_b64_tr_b16 a[242:243], v23 offset:50176
  ds_read_b64_tr_b16 a[244:245], v23 offset:53248
  ds_read_b64_tr_b16 a[246:247], v23 offset:54272
  ds_read_b64_tr_b16 a[248:249], v23 offset:57344
  ds_read_b64_tr_b16 a[250:251], v23 offset:58368
  ds_read_b64_tr_b16 a[252:253], v23 offset:61440
  ds_read_b64_tr_b16 a[254:255], v23 offset:62464
  s_waitcnt lgkmcnt(0)
  s_waitcnt vmcnt(16)
  s_barrier
  s_add_u32 s27, s26, 3145728
  s_add_u32 m0, s28, 65536
  s_nop 0
  buffer_load_dwordx4 v20, s[64:67], s27 offen lds
  s_add_u32 m0, s28, 66560
  s_add_u32 s27, s27, 32768
  buffer_load_dwordx4 v20, s[64:67], s27 offen lds
  s_add_u32 m0, s28, 67584
  s_add_u32 s27, s27, 32768
  buffer_load_dwordx4 v21, s[64:67], s27 offen lds
  s_add_u32 m0, s28, 68608
  s_add_u32 s27, s27, 32768
  buffer_load_dwordx4 v21, s[64:67], s27 offen lds
  s_add_u32 m0, s28, 69632
  s_add_u32 s27, s27, 32768
  buffer_load_dwordx4 v20, s[64:67], s27 offen lds
  s_add_u32 m0, s28, 70656
  s_add_u32 s27, s27, 32768
  buffer_load_dwordx4 v20, s[64:67], s27 offen lds
  s_add_u32 m0, s28, 71680
  s_add_u32 s27, s27, 32768
  buffer_load_dwordx4 v21, s[64:67], s27 offen lds
  s_add_u32 m0, s28, 72704
  s_add_u32 s27, s27, 32768
  buffer_load_dwordx4 v21, s[64:67], s27 offen lds
  ds_read_b64_tr_b16 v[128:129], v24 offset:0
  ds_read_b64_tr_b16 v[130:131], v24 offset:1024
  ds_read_b64_tr_b16 v[132:133], v24 offset:4096
  ds_read_b64_tr_b16 v[134:135], v24 offset:5120
  ds_read_b64_tr_b16 v[136:137], v24 offset:8192
  ds_read_b64_tr_b16 v[138:139], v24 offset:9216
  ds_read_b64_tr_b16 v[140:141], v24 offset:12288
  ds_read_b64_tr_b16 v[142:143], v24 offset:13312
  ds_read_b64_tr_b16 v[144:145], v24 offset:16384
  ds_read_b64_tr_b16 v[146:147], v24 offset:17408
  ds_read_b64_tr_b16 v[148:149], v24 offset:20480
  ds_read_b64_tr_b16 v[150:151], v24 offset:21504
  ds_read_b64_tr_b16 v[152:153], v24 offset:24576
  ds_read_b64_tr_b16 v[154:155], v24 offset:25600
  ds_read_b64_tr_b16 v[156:157], v24 offset:28672
  ds_read_b64_tr_b16 v[158:159], v24 offset:29696
  s_waitcnt lgkmcnt(0)
  s_waitcnt vmcnt(16)
  s_barrier
  s_add_u32 s27, s26, 0
  s_add_u32 m0, s28, 98304
  s_nop 0
  buffer_load_dwordx4 v20, s[68:71], s27 offen lds
  s_add_u32 m0, s28, 99328
  s_add_u32 s27, s27, 32768
  buffer_load_dwordx4 v20, s[68:71], s27 offen lds
  s_add_u32 m0, s28, 100352
  s_add_u32 s27, s27, 32768
  buffer_load_dwordx4 v21, s[68:71], s27 offen lds
  s_add_u32 m0, s28, 101376
  s_add_u32 s27, s27, 32768
  buffer_load_dwordx4 v21, s[68:71], s27 offen lds
  s_add_u32 m0, s28, 102400
  s_add_u32 s27, s27, 32768
  buffer_load_dwordx4 v20, s[68:71], s27 offen lds
  s_add_u32 m0, s28, 103424
  s_add_u32 s27, s27, 32768
  buffer_load_dwordx4 v20, s[68:71], s27 offen lds
  s_add_u32 m0, s28, 104448
  s_add_u32 s27, s27, 32768
  buffer_load_dwordx4 v21, s[68:71], s27 offen lds
  s_add_u32 m0, s28, 105472
  s_add_u32 s27, s27, 32768
  buffer_load_dwordx4 v21, s[68:71], s27 offen lds
  ds_read_b64_tr_b16 v[160:161], v22 offset:0
  ds_read_b64_tr_b16 v[162:163], v22 offset:1024
  ds_read_b64_tr_b16 v[164:165], v22 offset:4096
  ds_read_b64_tr_b16 v[166:167], v22 offset:5120
  ds_read_b64_tr_b16 v[168:169], v22 offset:8192
  ds_read_b64_tr_b16 v[170:171], v22 offset:9216
  ds_read_b64_tr_b16 v[172:173], v22 offset:12288
  ds_read_b64_tr_b16 v[174:175], v22 offset:13312
  ds_read_b64_tr_b16 v[176:177], v22 offset:16384
  ds_read_b64_tr_b16 v[178:179], v22 offset:17408
  ds_read_b64_tr_b16 v[180:181], v22 offset:20480
  ds_read_b64_tr_b16 v[182:183], v22 offset:21504
  ds_read_b64_tr_b16 v[184:185], v22 offset:24576
  ds_read_b64_tr_b16 v[186:187], v22 offset:25600
  ds_read_b64_tr_b16 v[188:189], v22 offset:28672
  ds_read_b64_tr_b16 v[190:191], v22 offset:29696
  s_waitcnt lgkmcnt(0)
  s_waitcnt vmcnt(16)
  s_barrier
  s_add_u32 s27, s26, 1048576
  s_add_u32 m0, s28, 131072
  s_nop 0
  buffer_load_dwordx4 v20, s[68:71], s27 offen lds
  s_add_u32 m0, s28, 132096
  s_add_u32 s27, s27, 32768
  buffer_load_dwordx4 v20, s[68:71], s27 offen lds
  s_add_u32 m0, s28, 133120
  s_add_u32 s27, s27, 32768
  buffer_load_dwordx4 v21, s[68:71], s27 offen lds
  s_add_u32 m0, s28, 134144
  s_add_u32 s27, s27, 32768
  buffer_load_dwordx4 v21, s[68:71], s27 offen lds
  s_add_u32 m0, s28, 135168
  s_add_u32 s27, s27, 32768
  buffer_load_dwordx4 v20, s[68:71], s27 offen lds
  s_add_u32 m0, s28, 136192
  s_add_u32 s27, s27, 32768
  buffer_load_dwordx4 v20, s[68:71], s27 offen lds
  s_add_u32 m0, s28, 137216
  s_add_u32 s27, s27, 32768
  buffer_load_dwordx4 v21, s[68:71], s27 offen lds
  s_add_u32 m0, s28, 138240
  s_add_u32 s27, s27, 32768
  buffer_load_dwordx4 v21, s[68:71], s27 offen lds
  ds_read_b64_tr_b16 v[192:193], v22 offset:32768
  ds_read_b64_tr_b16 v[194:195], v22 offset:33792
  ds_read_b64_tr_b16 v[196:197], v22 offset:36864
  ds_read_b64_tr_b16 v[198:199], v22 offset:37888
  ds_read_b64_tr_b16 v[200:201], v22 offset:40960
  ds_read_b64_tr_b16 v[202:203], v22 offset:41984
  ds_read_b64_tr_b16 v[204:205], v22 offset:45056
  ds_read_b64_tr_b16 v[206:207], v22 offset:46080
  ds_read_b64_tr_b16 v[208:209], v22 offset:49152
  ds_read_b64_tr_b16 v[210:211], v22 offset:50176
  ds_read_b64_tr_b16 v[212:213], v22 offset:53248
  ds_read_b64_tr_b16 v[214:215], v22 offset:54272
  ds_read_b64_tr_b16 v[216:217], v22 offset:57344
  ds_read_b64_tr_b16 v[218:219], v22 offset:58368
  ds_read_b64_tr_b16 v[220:221], v22 offset:61440
  ds_read_b64_tr_b16 v[222:223], v22 offset:62464
  s_waitcnt lgkmcnt(0)
  s_waitcnt vmcnt(16)
  s_barrier
  s_add_u32 s27, s26, 2097152
  s_add_u32 m0, s28, 0
  s_nop 0
  buffer_load_dwordx4 v20, s[68:71], s27 offen lds
  s_add_u32 m0, s28, 1024
  s_add_u32 s27, s27, 32768
  buffer_load_dwordx4 v20, s[68:71], s27 offen lds
  s_add_u32 m0, s28, 2048
  s_add_u32 s27, s27, 32768
  buffer_load_dwordx4 v21, s[68:71], s27 offen lds
  s_add_u32 m0, s28, 3072
  s_add_u32 s27, s27, 32768
  buffer_load_dwordx4 v21, s[68:71], s27 offen lds
  s_add_u32 m0, s28, 4096
  s_add_u32 s27, s27, 32768
  buffer_load_dwordx4 v20, s[68:71], s27 offen lds
  s_add_u32 m0, s28, 5120
  s_add_u32 s27, s27, 32768
  buffer_load_dwordx4 v20, s[68:71], s27 offen lds
  s_add_u32 m0, s28, 6144
  s_add_u32 s27, s27, 32768
  buffer_load_dwordx4 v21, s[68:71], s27 offen lds
  s_add_u32 m0, s28, 7168
  s_add_u32 s27, s27, 32768
  buffer_load_dwordx4 v21, s[68:71], s27 offen lds
  ds_read_b64_tr_b16 v[224:225], v23 offset:0
  ds_read_b64_tr_b16 v[226:227], v23 offset:1024
  ds_read_b64_tr_b16 v[228:229], v23 offset:4096
  ds_read_b64_tr_b16 v[230:231], v23 offset:5120
  ds_read_b64_tr_b16 v[232:233], v23 offset:8192
  ds_read_b64_tr_b16 v[234:235], v23 offset:9216
  ds_read_b64_tr_b16 v[236:237], v23 offset:12288
  ds_read_b64_tr_b16 v[238:239], v23 offset:13312
  ds_read_b64_tr_b16 v[240:241], v23 offset:16384
  ds_read_b64_tr_b16 v[242:243], v23 offset:17408
  ds_read_b64_tr_b16 v[244:245], v23 offset:20480
  ds_read_b64_tr_b16 v[246:247], v23 offset:21504
  ds_read_b64_tr_b16 v[248:249], v23 offset:24576
  ds_read_b64_tr_b16 v[250:251], v23 offset:25600
  ds_read_b64_tr_b16 v[252:253], v23 offset:28672
  ds_read_b64_tr_b16 v[254:255], v23 offset:29696
  s_waitcnt lgkmcnt(0)
  s_waitcnt vmcnt(16)
  s_barrier
  s_add_u32 s27, s26, 3145728
  s_add_u32 m0, s28, 32768
  s_nop 0
  buffer_load_dwordx4 v20, s[68:71], s27 offen lds
  s_add_u32 m0, s28, 33792
  s_add_u32 s27, s27, 32768
  buffer_load_dwordx4 v20, s[68:71], s27 offen lds
  s_add_u32 m0, s28, 34816
  s_add_u32 s27, s27, 32768
  buffer_load_dwordx4 v21, s[68:71], s27 offen lds
  s_add_u32 m0, s28, 35840
  s_add_u32 s27, s27, 32768
  buffer_load_dwordx4 v21, s[68:71], s27 offen lds
  s_add_u32 m0, s28, 36864
  s_add_u32 s27, s27, 32768
  buffer_load_dwordx4 v20, s[68:71], s27 offen lds
  s_add_u32 m0, s28, 37888
  s_add_u32 s27, s27, 32768
  buffer_load_dwordx4 v20, s[68:71], s27 offen lds
  s_add_u32 m0, s28, 38912
  s_add_u32 s27, s27, 32768
  buffer_load_dwordx4 v21, s[68:71], s27 offen lds
  s_add_u32 m0, s28, 39936
  s_add_u32 s27, s27, 32768
  buffer_load_dwordx4 v21, s[68:71], s27 offen lds
  ds_read_b64_tr_b16 a[0:1], v23 offset:32768
  ds_read_b64_tr_b16 a[2:3], v23 offset:33792
  ds_read_b64_tr_b16 a[4:5], v23 offset:36864
  ds_read_b64_tr_b16 a[6:7], v23 offset:37888
  ds_read_b64_tr_b16 a[8:9], v23 offset:40960
  ds_read_b64_tr_b16 a[10:11], v23 offset:41984
  ds_read_b64_tr_b16 a[12:13], v23 offset:45056
  ds_read_b64_tr_b16 a[14:15], v23 offset:46080
  ds_read_b64_tr_b16 a[16:17], v23 offset:49152
  ds_read_b64_tr_b16 a[18:19], v23 offset:50176
  ds_read_b64_tr_b16 a[20:21], v23 offset:53248
  ds_read_b64_tr_b16 a[22:23], v23 offset:54272
  ds_read_b64_tr_b16 a[24:25], v23 offset:57344
  ds_read_b64_tr_b16 a[26:27], v23 offset:58368
  ds_read_b64_tr_b16 a[28:29], v23 offset:61440
  ds_read_b64_tr_b16 a[30:31], v23 offset:62464
  s_waitcnt lgkmcnt(0)
  s_waitcnt vmcnt(16)
  s_barrier
  ds_read_b64_tr_b16 a[32:33], v24 offset:0
  ds_read_b64_tr_b16 a[34:35], v24 offset:1024
  ds_read_b64_tr_b16 a[36:37], v24 offset:4096
  ds_read_b64_tr_b16 a[38:39], v24 offset:5120
  ds_read_b64_tr_b16 a[40:41], v24 offset:8192
  ds_read_b64_tr_b16 a[42:43], v24 offset:9216
  ds_read_b64_tr_b16 a[44:45], v24 offset:12288
  ds_read_b64_tr_b16 a[46:47], v24 offset:13312
  ds_read_b64_tr_b16 a[48:49], v24 offset:16384
  ds_read_b64_tr_b16 a[50:51], v24 offset:17408
  ds_read_b64_tr_b16 a[52:53], v24 offset:20480
  ds_read_b64_tr_b16 a[54:55], v24 offset:21504
  ds_read_b64_tr_b16 a[56:57], v24 offset:24576
  ds_read_b64_tr_b16 a[58:59], v24 offset:25600
  ds_read_b64_tr_b16 a[60:61], v24 offset:28672
  ds_read_b64_tr_b16 a[62:63], v24 offset:29696
  s_waitcnt lgkmcnt(0)
  s_waitcnt vmcnt(8)
  s_barrier
  ds_read_b64_tr_b16 a[64:65], v22 offset:0
  ds_read_b64_tr_b16 a[66:67], v22 offset:1024
  ds_read_b64_tr_b16 a[68:69], v22 offset:4096
  ds_read_b64_tr_b16 a[70:71], v22 offset:5120
  ds_read_b64_tr_b16 a[72:73], v22 offset:8192
  ds_read_b64_tr_b16 a[74:75], v22 offset:9216
  ds_read_b64_tr_b16 a[76:77], v22 offset:12288
  ds_read_b64_tr_b16 a[78:79], v22 offset:13312
  ds_read_b64_tr_b16 a[80:81], v22 offset:16384
  ds_read_b64_tr_b16 a[82:83], v22 offset:17408
  ds_read_b64_tr_b16 a[84:85], v22 offset:20480
  ds_read_b64_tr_b16 a[86:87], v22 offset:21504
  ds_read_b64_tr_b16 a[88:89], v22 offset:24576
  ds_read_b64_tr_b16 a[90:91], v22 offset:25600
  ds_read_b64_tr_b16 a[92:93], v22 offset:28672
  ds_read_b64_tr_b16 a[94:95], v22 offset:29696
  s_waitcnt lgkmcnt(0)
  s_waitcnt vmcnt(0)
  s_barrier
  ds_read_b64_tr_b16 a[96:97], v22 offset:32768
  ds_read_b64_tr_b16 a[98:99], v22 offset:33792
  ds_read_b64_tr_b16 a[100:101], v22 offset:36864
  ds_read_b64_tr_b16 a[102:103], v22 offset:37888
  ds_read_b64_tr_b16 a[104:105], v22 offset:40960
  ds_read_b64_tr_b16 a[106:107], v22 offset:41984
  ds_read_b64_tr_b16 a[108:109], v22 offset:45056
  ds_read_b64_tr_b16 a[110:111], v22 offset:46080
  ds_read_b64_tr_b16 a[112:113], v22 offset:49152
  ds_read_b64_tr_b16 a[114:115], v22 offset:50176
  ds_read_b64_tr_b16 a[116:117], v22 offset:53248
  ds_read_b64_tr_b16 a[118:119], v22 offset:54272
  ds_read_b64_tr_b16 a[120:121], v22 offset:57344
  ds_read_b64_tr_b16 a[122:123], v22 offset:58368
  ds_read_b64_tr_b16 a[124:125], v22 offset:61440
  ds_read_b64_tr_b16 a[126:127], v22 offset:62464
  s_waitcnt lgkmcnt(0)
q_ld_55:
  s_waitcnt lgkmcnt(0)
  s_barrier
  v_mbcnt_lo_u32_b32 v20, -1, 0
  v_and_b32 v20, 0, v20
  v_add_lshl_u32 v20, v20, 1, 2
  s_mov_b32 s26, 0
g_wt_56:
  global_load_dword v21, v20, s[12:13] offset:128 sc1
  s_add_u32 s26, s26, 1
  s_cmp_gt_u32 s26, 1048576
  s_cbranch_scc1 L_end
  s_waitcnt vmcnt(0)
  v_cmp_eq_u32 vcc, 0, v21
  v_readfirstlane_b32 s27, v21
  s_cbranch_vccnz g_wt_56
  v_lshrrev_b32 v7, 7, v0
  v_lshlrev_b32 v7, 12, v7
  v_and_b32 v2, 1023, v9
  s_lshl_b32 s26, s17, 10
  v_add3_u32 v7, v7, v2, s26
  v_mov_b32 v116, 0
  s_mov_b32 s47, s60
  s_add_u32 s40, s60, 3
  s_add_u32 s41, s60, 64
  s_mov_b32 s42, 5
  s_mov_b32 s48, 0
  s_mov_b32 s49, 268435456
  s_mov_b32 s43, 268435456
  s_mov_b32 s50, 32768
  s_mov_b32 s56, 0
  s_mov_b32 s61, 0
  s_mov_b32 s62, 0
  s_lshl_b32 s54, s17, 13
  s_mov_b32 s50, 0
  v_mov_b32 v4, 1
  s_cmp_lt_u32 s40, 64
  s_cselect_b32 s42, s42, 0
  s_cmp_lg_u32 s42, 0
  s_cselect_b32 s76, s40, s41
  s_cselect_b32 s26, 3, 0
  s_cselect_b32 s42, s42, 2
  s_sub_u32 s42, s42, 1
  s_add_u32 s40, s40, s26
  s_xor_b32 s26, s26, 3
  s_add_u32 s41, s41, s26
q_slow_57:
  s_nop 0
  s_nop 5
  v_cvt_pk_bf16_f32 v100, v52, v53
  v_cvt_pk_bf16_f32 v101, v54, v55
  v_cvt_pk_bf16_f32 v102, v60, v61
  v_cvt_pk_bf16_f32 v103, v62, v63
  buffer_store_dwordx4 v[100:103], v8, s[4:7], s43 offen offset:0 sc1
  v_cvt_pk_bf16_f32 v104, v56, v57
  v_cvt_pk_bf16_f32 v105, v58, v59
  v_cvt_pk_bf16_f32 v106, v64, v65
  v_cvt_pk_bf16_f32 v107, v66, v67
  buffer_store_dwordx4 v[104:107], v8, s[4:7], s43 offen offset:512 sc1
  s_mov_b32 s43, 268435456
  s_xor_b32 s50, s50, 32768
  s_cmp_lg_u32 s62, 0
  s_cbranch_scc1 q_patch_62
  s_cmp_ge_u32 s47, 128
  s_cbranch_scc1 q_end_58
  s_cmp_lg_u32 s48, 0
  s_cbranch_scc1 q_have_59
  s_mov_b32 s53, 0
q_poll_60:
  s_cmp_lt_u32 s47, 64
  s_cselect_b32 s26, 2, 0
  s_add_u32 s26, s26, s47
  s_lshl_b32 s26, s26, 12
  s_add_u32 s26, s26, 243261440
  s_mov_b64 exec, 0xffffff
  buffer_load_dword v116, v7, s[4:7], s26 offen sc1
  s_mov_b64 exec, -1
  s_add_u32 s53, s53, 1
  s_cmp_gt_u32 s53, 1048576
  s_cbranch_scc1 q_fail_61
  s_waitcnt vmcnt(0)
  s_mov_b64 exec, 1
  buffer_store_dword v4, off, s[4:7], s49 sc1
  s_mov_b64 exec, -1
  s_mov_b32 s49, 268435456
  v_cmp_eq_u32 vcc, 0, v116
  s_nop 0
  s_and_b32 s26, vcc_lo, 0xffffff
  s_cbranch_scc1 q_poll_60
  s_and_b32 s63, s47, 127
  s_lshl_b32 s63, s63, 15
  s_xor_b32 s27, s50, 32768
  s_add_u32 m0, s27, s54
  s_add_u32 s63, s63, s54
  s_add_u32 s63, s63, 6291456
  buffer_load_dwordx4 v12, s[4:7], s63 offen offset:0 sc1 lds
  buffer_load_dwordx4 v13, s[4:7], s63 offen offset:1024 sc1 lds
  buffer_load_dwordx4 v14, s[4:7], s63 offen offset:2048 sc1 lds
  buffer_load_dwordx4 v15, s[4:7], s63 offen offset:3072 sc1 lds
  s_add_u32 m0, m0, 4096
  s_add_u32 s63, s63, 4096
  buffer_load_dwordx4 v16, s[4:7], s63 offen offset:0 sc1 lds
  buffer_load_dwordx4 v17, s[4:7], s63 offen offset:1024 sc1 lds
  buffer_load_dwordx4 v18, s[4:7], s63 offen offset:2048 sc1 lds
  buffer_load_dwordx4 v19, s[4:7], s63 offen offset:3072 sc1 lds
  v_cmp_eq_u32 vcc, 0, v116
  v_max_u32_dpp v117, v116, v116 row_ror:8 row_mask:0xf bank_mask:0xf
  s_nop 0
  s_nop 0
  v_max_u32_dpp v117, v117, v117 row_ror:4 row_mask:0xf bank_mask:0xf
  s_nop 0
  s_nop 0
  v_max_u32_dpp v117, v117, v117 row_ror:2 row_mask:0xf bank_mask:0xf
  s_nop 0
  s_nop 0
  v_max_u32_dpp v117, v117, v117 row_ror:1 row_mask:0xf bank_mask:0xf
  s_nop 0
  v_readlane_b32 s48, v117, 0
  v_readlane_b32 s28, v117, 16
  s_max_u32 s48, s48, s28
  s_and_b32 s28, vcc_lo, 0xffffff
  s_cselect_b32 s48, 0, s48
q_have_59:
  v_mov_b32 v2, s48
  ds_write_b32 v118, v2 offset:32
  s_xor_b32 s50, s50, 32768
  s_waitcnt lgkmcnt(0)
  s_barrier
  ds_read_b128 v[108:111], v119 offset:32
  s_waitcnt lgkmcnt(0)
  v_min3_u32 v112, v108, v109, v110
  v_max3_u32 v108, v108, v109, v110
  v_min_u32 v112, v112, v111
  v_max_u32 v108, v108, v111
  v_readfirstlane_b32 s45, v112
  v_readfirstlane_b32 s28, v108
  s_max_u32 s56, s56, s28
  s_bfe_u32 s28, s56, 0x70005
  s_xor_b32 s28, s28, 63
  s_cmp_eq_u32 s28, s47
  s_cbranch_scc1 q_fork_64
  s_waitcnt vmcnt(0)
  s_sub_u32 s26, s47, s60
  s_cmp_lg_u32 s26, 9
  s_cbranch_scc1 q_cold_65
  v_mbcnt_lo_u32_b32 v20, -1, 0
  v_and_b32 v20, 0, v20
  v_add_lshl_u32 v20, v20, 2, 2
  s_mov_b32 s26, 0
g_wt_70:
  global_load_dword v21, v20, s[12:13] offset:128 sc1
  s_add_u32 s26, s26, 1
  s_cmp_gt_u32 s26, 1048576
  s_cbranch_scc1 L_end
  s_waitcnt vmcnt(0)
  v_cmp_eq_u32 vcc, 0, v21
  v_readfirstlane_b32 s27, v21
  s_cbranch_vccnz g_wt_70
  s_load_dwordx2 s[64:65], s[0:1], 72
  s_load_dwordx2 s[68:69], s[0:1], 80
  s_load_dwordx2 s[8:9], s[0:1], 88
  s_mov_b32 s66, 1835008
  s_mov_b32 s70, 1835008
  s_mov_b32 s10, 1835008
  v_lshrrev_b32 v2, 8, v0
  v_and_b32 v3, 0x70, v0
  s_mov_b32 s26, 114688
  v_mul_lo_u32 v6, v2, s26
  v_add_u32 v6, v6, v3
  v_cmp_eq_u32 vcc, 0x70, v3
  v_mov_b32 v3, 0x7ff00000
  s_nop 0
  v_cndmask_b32 v6, v6, v3, vcc
  v_mul_u32_u24 v7, 14336, v2
  v_and_b32 v3, 0xf0, v0
  v_add_u32 v7, v7, v3
  s_mul_i32 s34, s17, 458752
  s_mul_i32 s27, s16, 112
  s_add_u32 s34, s34, s27
  s_add_u32 s34, s34, 0
  s_mul_i32 s35, s16, 57344
  s_lshl_b32 s27, s17, 8
  s_add_u32 s35, s35, s27
  s_mov_b32 s36, 0x00ff00ff
  s_mov_b32 s37, 0x00ff00ff
  s_waitcnt lgkmcnt(0)
  s_mul_i32 s26, s17, 23552
  s_add_u32 m0, s26, 65536
  s_mov_b64 exec, s[36:37]
  buffer_load_dwordx4 v6, s[64:67], s34 offen lds
  s_not_b64 exec, exec
  buffer_load_dwordx4 v6, s[68:71], s34 offen lds
  s_add_u32 s34, s34, 3584
  s_add_u32 m0, m0, 1024
  s_mov_b64 exec, s[36:37]
  buffer_load_dwordx4 v6, s[64:67], s34 offen lds
  s_not_b64 exec, exec
  buffer_load_dwordx4 v6, s[68:71], s34 offen lds
  s_add_u32 s34, s34, 3584
  s_add_u32 m0, m0, 1024
  s_mov_b64 exec, s[36:37]
  buffer_load_dwordx4 v6, s[64:67], s34 offen lds
  s_not_b64 exec, exec
  buffer_load_dwordx4 v6, s[68:71], s34 offen lds
  s_add_u32 s34, s34, 3584
  s_add_u32 m0, m0, 1024
  s_mov_b64 exec, s[36:37]
  buffer_load_dwordx4 v6, s[64:67], s34 offen lds
  s_not_b64 exec, exec
  buffer_load_dwordx4 v6, s[68:71], s34 offen lds
  s_add_u32 s34, s34, 3584
  s_add_u32 m0, m0, 1024
  s_mov_b64 exec, s[36:37]
  buffer_load_dwordx4 v6, s[64:67], s34 offen lds
  s_not_b64 exec, exec
  buffer_load_dwordx4 v6, s[68:71], s34 offen lds
  s_add_u32 s34, s34, 3584
  s_add_u32 m0, m0, 1024
  s_mov_b64 exec, s[36:37]
  buffer_load_dwordx4 v6, s[64:67], s34 offen lds
  s_not_b64 exec, exec
  buffer_load_dwordx4 v6, s[68:71], s34 offen lds
  s_add_u32 s34, s34, 3584
  s_add_u32 m0, m0, 1024
  s_mov_b64 exec, s[36:37]
  buffer_load_dwordx4 v6, s[64:67], s34 offen lds
  s_not_b64 exec, exec
  buffer_load_dwordx4 v6, s[68:71], s34 offen lds
  s_add_u32 s34, s34, 3584
  s_add_u32 m0, m0, 1024
  s_mov_b64 exec, s[36:37]
  buffer_load_dwordx4 v6, s[64:67], s34 offen lds
  s_not_b64 exec, exec
  buffer_load_dwordx4 v6, s[68:71], s34 offen lds
  s_add_u32 s34, s34, 3584
  s_add_u32 m0, m0, 1024
  s_mov_b64 exec, s[36:37]
  buffer_load_dwordx4 v6, s[64:67], s34 offen lds
  s_not_b64 exec, exec
  buffer_load_dwordx4 v6, s[68:71], s34 offen lds
  s_add_u32 s34, s34, 3584
  s_add_u32 m0, m0, 1024
  s_mov_b64 exec, s[36:37]
  buffer_load_dwordx4 v6, s[64:67], s34 offen lds
  s_not_b64 exec, exec
  buffer_load_dwordx4 v6, s[68:71], s34 offen lds
  s_add_u32 s34, s34, 3584
  s_add_u32 m0, m0, 1024
  s_mov_b64 exec, s[36:37]
  buffer_load_dwordx4 v6, s[64:67], s34 offen lds
  s_not_b64 exec, exec
  buffer_load_dwordx4 v6, s[68:71], s34 offen lds
  s_add_u32 s34, s34, 3584
  s_add_u32 m0, m0, 1024
  s_mov_b64 exec, s[36:37]
  buffer_load_dwordx4 v6, s[64:67], s34 offen lds
  s_not_b64 exec, exec
  buffer_load_dwordx4 v6, s[68:71], s34 offen lds
  s_add_u32 s34, s34, 3584
  s_add_u32 m0, m0, 1024
  s_mov_b64 exec, s[36:37]
  buffer_load_dwordx4 v6, s[64:67], s34 offen lds
  s_not_b64 exec, exec
  buffer_load_dwordx4 v6, s[68:71], s34 offen lds
  s_add_u32 s34, s34, 3584
  s_add_u32 m0, m0, 1024
  s_mov_b64 exec, s[36:37]
  buffer_load_dwordx4 v6, s[64:67], s34 offen lds
  s_not_b64 exec, exec
  buffer_load_dwordx4 v6, s[68:71], s34 offen lds
  s_add_u32 s34, s34, 3584
  s_add_u32 m0, m0, 1024
  s_mov_b64 exec, s[36:37]
  buffer_load_dwordx4 v6, s[64:67], s34 offen lds
  s_not_b64 exec, exec
  buffer_load_dwordx4 v6, s[68:71], s34 offen lds
  s_add_u32 s34, s34, 3584
  s_add_u32 m0, m0, 1024
  s_mov_b64 exec, s[36:37]
  buffer_load_dwordx4 v6, s[64:67], s34 offen lds
  s_not_b64 exec, exec
  buffer_load_dwordx4 v6, s[68:71], s34 offen lds
  s_add_u32 s34, s34, 3584
  s_add_u32 m0, m0, 1024
  s_mov_b64 exec, s[36:37]
  buffer_load_dwordx4 v6, s[64:67], s34 offen lds
  s_not_b64 exec, exec
  buffer_load_dwordx4 v6, s[68:71], s34 offen lds
  s_add_u32 s34, s34, 3584
  s_add_u32 m0, m0, 1024
  s_mov_b64 exec, s[36:37]
  buffer_load_dwordx4 v6, s[64:67], s34 offen lds
  s_not_b64 exec, exec
  buffer_load_dwordx4 v6, s[68:71], s34 offen lds
  s_add_u32 s34, s34, 3584
  s_add_u32 m0, m0, 1024
  s_mov_b64 exec, s[36:37]
  buffer_load_dwordx4 v6, s[64:67], s34 offen lds
  s_not_b64 exec, exec
  buffer_load_dwordx4 v6, s[68:71], s34 offen lds
  s_add_u32 s34, s34, 3584
  s_add_u32 m0, m0, 1024
  s_mov_b64 exec, s[36:37]
  buffer_load_dwordx4 v6, s[64:67], s34 offen lds
  s_not_b64 exec, exec
  buffer_load_dwordx4 v6, s[68:71], s34 offen lds
  s_add_u32 s34, s34, 3584
  s_add_u32 m0, m0, 1024
  s_mov_b64 exec, s[36:37]
  buffer_load_dwordx4 v6, s[64:67], s34 offen lds
  s_not_b64 exec, exec
  buffer_load_dwordx4 v6, s[68:71], s34 offen lds
  s_add_u32 s34, s34, 3584
  s_add_u32 m0, m0, 1024
  s_mov_b64 exec, s[36:37]
  buffer_load_dwordx4 v6, s[64:67], s34 offen lds
  s_not_b64 exec, exec
  buffer_load_dwordx4 v6, s[68:71], s34 offen lds
  s_add_u32 s34, s34, 3584
  s_add_u32 m0, m0, 1024
  s_mov_b64 exec, s[36:37]
  buffer_load_dwordx4 v6, s[64:67], s34 offen lds
  s_not_b64 exec, exec
  buffer_load_dwordx4 v6, s[68:71], s34 offen lds
  s_add_u32 s34, s34, 3584
  s_add_u32 m0, m0, 1024
  s_mov_b64 exec, -1
  v_lshrrev_b32 v7, 7, v0
  v_lshlrev_b32 v7, 12, v7
  v_and_b32 v2, 1023, v9
  s_lshl_b32 s26, s17, 10
  v_add3_u32 v7, v7, v2, s26
  v_mov_b32 v116, 0
q_cold_65:
  s_waitcnt lgkmcnt(0)
  s_barrier
  s_cmp_lg_u32 s50, 0
  s_cbranch_scc1 q_c1_67
q_c0_66:
  ds_read_b128 v[68:71], v120 offset:0
  ds_read_b128 v[72:75], v121 offset:0
  ds_read_b128 v[76:79], v122 offset:0
q_w0_68:
  s_waitcnt lgkmcnt(2)
  v_mfma_f32_32x32x16_bf16 v[20:35], v[128:131], v[68:71], 0
  ds_read_b128 v[80:83], v123 offset:0
  s_mov_b32 s46, s47
  s_mov_b32 s47, s76
  s_lshl_b32 s52, s46, 7
  s_add_u32 s52, s52, s57
  s_lshl_b32 s44, s52, 12
  v_mfma_f32_32x32x16_bf16 v[36:51], v[68:71], a[0:3], 0
  s_add_u32 s44, s44, 41943040
  v_cvt_pk_bf16_f32 v100, v52, v53
  v_cvt_pk_bf16_f32 v101, v54, v55
  v_cvt_pk_bf16_f32 v102, v60, v61
  v_cvt_pk_bf16_f32 v103, v62, v63
  s_waitcnt lgkmcnt(2)
  v_mfma_f32_32x32x16_bf16 v[20:35], v[132:135], v[72:75], v[20:35]
  ds_read_b128 v[84:87], v124 offset:0
  buffer_store_dwordx4 v[100:103], v8, s[4:7], s43 offen offset:0 sc1
  v_cvt_pk_bf16_f32 v104, v56, v57
  v_cvt_pk_bf16_f32 v105, v58, v59
  v_mfma_f32_32x32x16_bf16 v[36:51], v[72:75], a[4:7], v[36:51]
  v_cvt_pk_bf16_f32 v106, v64, v65
  v_cvt_pk_bf16_f32 v107, v66, v67
  s_waitcnt lgkmcnt(2)
  v_mfma_f32_32x32x16_bf16 v[20:35], v[136:139], v[76:79], v[20:35]
  ds_read_b128 v[88:91], v125 offset:0
  buffer_store_dwordx4 v[104:107], v8, s[4:7], s43 offen offset:512 sc1
  s_lshl_b32 s43, s52, 11
  s_add_u32 s43, s43, 142606336
  v_mfma_f32_32x32x16_bf16 v[36:51], v[76:79], a[8:11], v[36:51]
  s_lshl_b32 s51, s52, 5
  s_add_u32 s51, s51, 244318208
  s_lshr_b32 s55, s47, 7
  s_or_b32 s55, s55, s62
  s_sub_u32 s27, s47, s60
  s_cmp_eq_u32 s27, 9
  s_cselect_b32 s55, 1, s55
  s_waitcnt lgkmcnt(2)
  v_mfma_f32_32x32x16_bf16 v[20:35], v[140:143], v[80:83], v[20:35]
  ds_read_b128 v[92:95], v126 offset:0
  s_cmp_lt_u32 s40, 64
  s_cselect_b32 s42, s42, 0
  s_cmp_lg_u32 s42, 0
  s_cselect_b32 s76, s40, s41
  s_cselect_b32 s26, 3, 0
  s_cselect_b32 s42, s42, 2
  v_mfma_f32_32x32x16_bf16 v[36:51], v[80:83], a[12:15], v[36:51]
  s_sub_u32 s42, s42, 1
  s_add_u32 s40, s40, s26
  s_xor_b32 s26, s26, 3
  s_add_u32 s41, s41, s26
  s_waitcnt lgkmcnt(2)
  v_mfma_f32_32x32x16_bf16 v[20:35], v[144:147], v[84:87], v[20:35]
  ds_read_b128 v[96:99], v127 offset:0
  v_mfma_f32_32x32x16_bf16 v[36:51], v[84:87], a[16:19], v[36:51]
  s_waitcnt lgkmcnt(2)
  v_mfma_f32_32x32x16_bf16 v[20:35], v[148:151], v[88:91], v[20:35]
  ds_read_b128 v[68:71], v120 offset:256
  v_mfma_f32_32x32x16_bf16 v[36:51], v[88:91], a[20:23], v[36:51]
  s_waitcnt lgkmcnt(2)
  v_mfma_f32_32x32x16_bf16 v[20:35], v[152:155], v[92:95], v[20:35]
  ds_read_b128 v[72:75], v121 offset:256
  s_cmp_lt_u32 s47, 64
  s_cselect_b32 s26, 2, 0
  s_add_u32 s26, s26, s47
  s_lshl_b32 s26, s26, 12
  s_add_u32 s26, s26, 243261440
  v_mfma_f32_32x32x16_bf16 v[36:51], v[92:95], a[24:27], v[36:51]
  s_mov_b64 exec, 0xffffff
  buffer_load_dword v116, v7, s[4:7], s26 offen sc1
  s_mov_b64 exec, -1
  s_waitcnt lgkmcnt(2)
  v_mfma_f32_32x32x16_bf16 v[20:35], v[156:159], v[96:99], v[20:35]
  ds_read_b128 v[76:79], v122 offset:256
  v_mfma_f32_32x32x16_bf16 v[36:51], v[96:99], a[28:31], v[36:51]
  s_waitcnt lgkmcnt(2)
  v_mfma_f32_32x32x16_bf16 v[20:35], v[160:163], v[68:71], v[20:35]
  ds_read_b128 v[80:83], v123 offset:256
  v_mfma_f32_32x32x16_bf16 v[36:51], v[68:71], a[32:35], v[36:51]
  s_waitcnt lgkmcnt(2)
  v_mfma_f32_32x32x16_bf16 v[20:35], v[164:167], v[72:75], v[20:35]
  ds_read_b128 v[84:87], v124 offset:256
  v_mfma_f32_32x32x16_bf16 v[36:51], v[72:75], a[36:39], v[36:51]
  s_waitcnt lgkmcnt(2)
  v_mfma_f32_32x32x16_bf16 v[20:35], v[168:171], v[76:79], v[20:35]
  ds_read_b128 v[88:91], v125 offset:256
  v_mfma_f32_32x32x16_bf16 v[36:51], v[76:79], a[40:43], v[36:51]
  s_waitcnt lgkmcnt(2)
  v_mfma_f32_32x32x16_bf16 v[20:35], v[172:175], v[80:83], v[20:35]
  ds_read_b128 v[92:95], v126 offset:256
  v_mfma_f32_32x32x16_bf16 v[36:51], v[80:83], a[44:47], v[36:51]
  s_waitcnt lgkmcnt(2)
  v_mfma_f32_32x32x16_bf16 v[20:35], v[176:179], v[84:87], v[20:35]
  ds_read_b128 v[96:99], v127 offset:256
  v_mfma_f32_32x32x16_bf16 v[36:51], v[84:87], a[48:51], v[36:51]
  s_waitcnt lgkmcnt(2)
  v_mfma_f32_32x32x16_bf16 v[20:35], v[180:183], v[88:91], v[20:35]
  ds_read_b128 v[68:71], v120 offset:512
  v_mfma_f32_32x32x16_bf16 v[36:51], v[88:91], a[52:55], v[36:51]
  s_waitcnt lgkmcnt(2)
  v_mfma_f32_32x32x16_bf16 v[20:35], v[184:187], v[92:95], v[20:35]
  ds_read_b128 v[72:75], v121 offset:512
  v_mfma_f32_32x32x16_bf16 v[36:51], v[92:95], a[56:59], v[36:51]
  s_waitcnt lgkmcnt(2)
  v_mfma_f32_32x32x16_bf16 v[20:35], v[188:191], v[96:99], v[20:35]
  ds_read_b128 v[76:79], v122 offset:512
  v_mfma_f32_32x32x16_bf16 v[36:51], v[96:99], a[60:63], v[36:51]
  s_waitcnt lgkmcnt(2)
  v_mfma_f32_32x32x16_bf16 v[20:35], v[192:195], v[68:71], v[20:35]
  ds_read_b128 v[80:83], v123 offset:512
  v_mfma_f32_32x32x16_bf16 v[36:51], v[68:71], a[64:67], v[36:51]
  s_waitcnt lgkmcnt(2)
  v_mfma_f32_32x32x16_bf16 v[20:35], v[196:199], v[72:75], v[20:35]
  ds_read_b128 v[84:87], v124 offset:512
  v_mfma_f32_32x32x16_bf16 v[36:51], v[72:75], a[68:71], v[36:51]
  s_waitcnt lgkmcnt(2)
  v_mfma_f32_32x32x16_bf16 v[20:35], v[200:203], v[76:79], v[20:35]
  ds_read_b128 v[88:91], v125 offset:512
  v_mfma_f32_32x32x16_bf16 v[36:51], v[76:79], a[72:75], v[36:51]
  s_waitcnt lgkmcnt(2)
  v_mfma_f32_32x32x16_bf16 v[20:35], v[204:207], v[80:83], v[20:35]
  ds_read_b128 v[92:95], v126 offset:512
  s_waitcnt vmcnt(0)
  s_mov_b64 exec, 1
  buffer_store_dword v4, off, s[4:7], s49 sc1
  s_mov_b64 exec, -1
  v_mfma_f32_32x32x16_bf16 v[36:51], v[80:83], a[76:79], v[36:51]
  v_cmp_eq_u32 vcc, 0, v116
  v_max_u32_dpp v117, v116, v116 row_ror:8 row_mask:0xf bank_mask:0xf
  s_nop 0
  s_nop 0
  v_max_u32_dpp v117, v117, v117 row_ror:4 row_mask:0xf bank_mask:0xf
  s_nop 0
  s_waitcnt lgkmcnt(2)
  v_mfma_f32_32x32x16_bf16 v[20:35], v[208:211], v[84:87], v[20:35]
  ds_read_b128 v[96:99], v127 offset:512
  s_nop 0
  v_max_u32_dpp v117, v117, v117 row_ror:2 row_mask:0xf bank_mask:0xf
  s_nop 0
  s_nop 0
  v_max_u32_dpp v117, v117, v117 row_ror:1 row_mask:0xf bank_mask:0xf
  v_mfma_f32_32x32x16_bf16 v[36:51], v[84:87], a[80:83], v[36:51]
  s_nop 0
  v_readlane_b32 s48, v117, 0
  v_readlane_b32 s28, v117, 16
  s_max_u32 s48, s48, s28
  s_and_b32 s28, vcc_lo, 0xffffff
  s_cselect_b32 s48, 0, s48
  s_waitcnt lgkmcnt(2)
  v_mfma_f32_32x32x16_bf16 v[20:35], v[212:215], v[88:91], v[20:35]
  ds_read_b128 v[68:71], v120 offset:768
  s_cmp_lg_u32 s48, 0
  s_cselect_b32 s28, s47, s46
  s_and_b32 s63, s28, 127
  s_lshl_b32 s63, s63, 15
  s_xor_b32 s27, s50, 32768
  v_mfma_f32_32x32x16_bf16 v[36:51], v[88:91], a[84:87], v[36:51]
  s_add_u32 m0, s27, s54
  s_add_u32 s63, s63, s54
  s_add_u32 s63, s63, 6291456
  s_waitcnt lgkmcnt(2)
  v_mfma_f32_32x32x16_bf16 v[20:35], v[216:219], v[92:95], v[20:35]
  ds_read_b128 v[72:75], v121 offset:768
  buffer_load_dwordx4 v12, s[4:7], s63 offen offset:0 sc1 lds
  v_mfma_f32_32x32x16_bf16 v[36:51], v[92:95], a[88:91], v[36:51]
  s_waitcnt lgkmcnt(2)
  v_mfma_f32_32x32x16_bf16 v[20:35], v[220:223], v[96:99], v[20:35]
  ds_read_b128 v[76:79], v122 offset:768
  buffer_load_dwordx4 v13, s[4:7], s63 offen offset:1024 sc1 lds
  v_mfma_f32_32x32x16_bf16 v[36:51], v[96:99], a[92:95], v[36:51]
  s_waitcnt lgkmcnt(2)
  v_mfma_f32_32x32x16_bf16 v[20:35], v[224:227], v[68:71], v[20:35]
  ds_read_b128 v[80:83], v123 offset:768
  buffer_load_dwordx4 v14, s[4:7], s63 offen offset:2048 sc1 lds
  v_mfma_f32_32x32x16_bf16 v[36:51], v[68:71], a[96:99], v[36:51]
  s_waitcnt lgkmcnt(2)
  v_mfma_f32_32x32x16_bf16 v[20:35], v[228:231], v[72:75], v[20:35]
  ds_read_b128 v[84:87], v124 offset:768
  buffer_load_dwordx4 v15, s[4:7], s63 offen offset:3072 sc1 lds
  s_add_u32 m0, m0, 4096
  s_add_u32 s63, s63, 4096
  v_mfma_f32_32x32x16_bf16 v[36:51], v[72:75], a[100:103], v[36:51]
  s_waitcnt lgkmcnt(2)
  v_mfma_f32_32x32x16_bf16 v[20:35], v[232:235], v[76:79], v[20:35]
  ds_read_b128 v[88:91], v125 offset:768
  buffer_load_dwordx4 v16, s[4:7], s63 offen offset:0 sc1 lds
  v_mfma_f32_32x32x16_bf16 v[36:51], v[76:79], a[104:107], v[36:51]
  s_waitcnt lgkmcnt(2)
  v_mfma_f32_32x32x16_bf16 v[20:35], v[236:239], v[80:83], v[20:35]
  ds_read_b128 v[92:95], v126 offset:768
  buffer_load_dwordx4 v17, s[4:7], s63 offen offset:1024 sc1 lds
  v_mfma_f32_32x32x16_bf16 v[36:51], v[80:83], a[108:111], v[36:51]
  s_waitcnt lgkmcnt(2)
  v_mfma_f32_32x32x16_bf16 v[20:35], v[240:243], v[84:87], v[20:35]
  ds_read_b128 v[96:99], v127 offset:768
  buffer_load_dwordx4 v18, s[4:7], s63 offen offset:2048 sc1 lds
  v_mfma_f32_32x32x16_bf16 v[36:51], v[84:87], a[112:115], v[36:51]
  s_waitcnt lgkmcnt(2)
  v_mfma_f32_32x32x16_bf16 v[20:35], v[244:247], v[88:91], v[20:35]
  ds_read_b128 v[68:71], v120 offset:0
  buffer_load_dwordx4 v19, s[4:7], s63 offen offset:3072 sc1 lds
  s_add_u32 s49, s51, 16
  s_add_u32 s26, s62, 1
  v_mfma_f32_32x32x16_bf16 v[36:51], v[88:91], a[116:119], v[36:51]
  ds_read_b128 v[72:75], v121 offset:0
  v_mov_b32 v4, s26
  s_cmp_lt_u32 s47, 128
  s_cselect_b32 s26, s48, 0
  v_mov_b32 v2, s26
  ds_write_b32 v118, v2 offset:0
  s_waitcnt lgkmcnt(4)
  v_mfma_f32_32x32x16_bf16 v[20:35], v[248:251], v[92:95], v[20:35]
  ds_read_b128 v[76:79], v122 offset:0
  v_mfma_f32_32x32x16_bf16 v[36:51], v[92:95], a[120:123], v[36:51]
  ds_read_b128 v[80:83], v123 offset:0
  s_waitcnt lgkmcnt(5)
  v_mfma_f32_32x32x16_bf16 v[20:35], v[252:255], v[96:99], v[20:35]
  ds_read_b128 v[84:87], v124 offset:0
  v_mfma_f32_32x32x16_bf16 v[36:51], v[96:99], a[124:127], v[36:51]
  ds_read_b128 v[88:91], v125 offset:0
  s_waitcnt lgkmcnt(5)
  v_mfma_f32_32x32x16_bf16 v[52:67], a[128:131], v[68:71], 0
  ds_read_b128 v[92:95], v126 offset:0
  v_mfma_f32_32x32x16_bf16 v[52:67], a[132:135], v[72:75], v[52:67]
  ds_read_b128 v[96:99], v127 offset:0
  s_nop 3
  v_mul_f32 v20, s24, v20
  v_mul_f32 v21, s24, v21
  v_mul_f32 v22, s24, v22
  v_mul_f32 v23, s24, v23
  v_mul_f32 v24, s24, v24
  s_waitcnt lgkmcnt(4)
  v_mfma_f32_32x32x16_bf16 v[52:67], a[136:139], v[76:79], v[52:67]
  ds_read_b128 v[68:71], v120 offset:256
  v_mul_f32 v25, s24, v25
  v_cvt_pk_bf16_f32 v100, v36, v37
  v_cvt_pk_bf16_f32 v101, v38, v39
  v_cvt_pk_bf16_f32 v102, v44, v45
  v_cvt_pk_bf16_f32 v103, v46, v47
  v_mfma_f32_32x32x16_bf16 v[52:67], a[140:143], v[80:83], v[52:67]
  ds_read_b128 v[72:75], v121 offset:256
  buffer_store_dwordx4 v[100:103], v8, s[4:7], s44 offen offset:2048 sc1
  v_cvt_pk_bf16_f32 v104, v40, v41
  v_cvt_pk_bf16_f32 v105, v42, v43
  s_waitcnt lgkmcnt(4)
  v_mfma_f32_32x32x16_bf16 v[52:67], a[144:147], v[84:87], v[52:67]
  ds_read_b128 v[76:79], v122 offset:256
  v_cvt_pk_bf16_f32 v106, v48, v49
  v_cvt_pk_bf16_f32 v107, v50, v51
  buffer_store_dwordx4 v[104:107], v8, s[4:7], s44 offen offset:2560 sc1
  v_mfma_f32_32x32x16_bf16 v[52:67], a[148:151], v[88:91], v[52:67]
  ds_read_b128 v[80:83], v123 offset:256
  v_mul_f32 v26, s24, v26
  v_mul_f32 v27, s24, v27
  v_mul_f32 v28, s24, v28
  v_mul_f32 v29, s24, v29
  v_mul_f32 v30, s24, v30
  s_waitcnt lgkmcnt(4)
  v_mfma_f32_32x32x16_bf16 v[52:67], a[152:155], v[92:95], v[52:67]
  ds_read_b128 v[84:87], v124 offset:256
  v_mul_f32 v31, s24, v31
  v_mul_f32 v32, s24, v32
  v_mul_f32 v33, s24, v33
  v_mul_f32 v34, s24, v34
  v_mul_f32 v35, s24, v35
  v_mfma_f32_32x32x16_bf16 v[52:67], a[156:159], v[96:99], v[52:67]
  ds_read_b128 v[88:91], v125 offset:256
  v_cvt_pk_bf16_f32 v108, v20, v21
  v_cvt_pk_bf16_f32 v109, v22, v23
  v_cvt_pk_bf16_f32 v110, v28, v29
  v_cvt_pk_bf16_f32 v111, v30, v31
  buffer_store_dwordx4 v[108:111], v8, s[4:7], s44 offen offset:0 sc1
  s_waitcnt lgkmcnt(4)
  v_mfma_f32_32x32x16_bf16 v[52:67], a[160:163], v[68:71], v[52:67]
  ds_read_b128 v[92:95], v126 offset:256
  v_cvt_pk_bf16_f32 v112, v24, v25
  v_cvt_pk_bf16_f32 v113, v26, v27
  v_cvt_pk_bf16_f32 v114, v32, v33
  v_cvt_pk_bf16_f32 v115, v34, v35
  buffer_store_dwordx4 v[112:115], v8, s[4:7], s44 offen offset:512 sc1
  v_mfma_f32_32x32x16_bf16 v[52:67], a[164:167], v[72:75], v[52:67]
  ds_read_b128 v[96:99], v127 offset:256
  s_waitcnt lgkmcnt(4)
  v_mfma_f32_32x32x16_bf16 v[52:67], a[168:171], v[76:79], v[52:67]
  ds_read_b128 v[68:71], v120 offset:512
  v_mfma_f32_32x32x16_bf16 v[52:67], a[172:175], v[80:83], v[52:67]
  ds_read_b128 v[72:75], v121 offset:512
  s_waitcnt lgkmcnt(4)
  v_mfma_f32_32x32x16_bf16 v[52:67], a[176:179], v[84:87], v[52:67]
  ds_read_b128 v[76:79], v122 offset:512
  v_mfma_f32_32x32x16_bf16 v[52:67], a[180:183], v[88:91], v[52:67]
  ds_read_b128 v[80:83], v123 offset:512
  s_waitcnt lgkmcnt(4)
  v_mfma_f32_32x32x16_bf16 v[52:67], a[184:187], v[92:95], v[52:67]
  ds_read_b128 v[84:87], v124 offset:512
  v_mfma_f32_32x32x16_bf16 v[52:67], a[188:191], v[96:99], v[52:67]
  ds_read_b128 v[88:91], v125 offset:512
  s_waitcnt lgkmcnt(4)
  v_mfma_f32_32x32x16_bf16 v[52:67], a[192:195], v[68:71], v[52:67]
  ds_read_b128 v[92:95], v126 offset:512
  v_mfma_f32_32x32x16_bf16 v[52:67], a[196:199], v[72:75], v[52:67]
  ds_read_b128 v[96:99], v127 offset:512
  s_waitcnt lgkmcnt(4)
  v_mfma_f32_32x32x16_bf16 v[52:67], a[200:203], v[76:79], v[52:67]
  ds_read_b128 v[68:71], v120 offset:768
  v_mfma_f32_32x32x16_bf16 v[52:67], a[204:207], v[80:83], v[52:67]
  ds_read_b128 v[72:75], v121 offset:768
  s_waitcnt lgkmcnt(4)
  v_mfma_f32_32x32x16_bf16 v[52:67], a[208:211], v[84:87], v[52:67]
  ds_read_b128 v[76:79], v122 offset:768
  ds_read_b128 v[80:83], v123 offset:768
  v_mfma_f32_32x32x16_bf16 v[52:67], a[212:215], v[88:91], v[52:67]
  ds_read_b128 v[84:87], v124 offset:768
  ds_read_b128 v[88:91], v125 offset:768
  s_waitcnt lgkmcnt(6)
  v_mfma_f32_32x32x16_bf16 v[52:67], a[216:219], v[92:95], v[52:67]
  ds_read_b128 v[92:95], v126 offset:768
  v_mfma_f32_32x32x16_bf16 v[52:67], a[220:223], v[96:99], v[52:67]
  ds_read_b128 v[96:99], v127 offset:768
  s_waitcnt lgkmcnt(6)
  v_mfma_f32_32x32x16_bf16 v[52:67], a[224:227], v[68:71], v[52:67]
  v_mfma_f32_32x32x16_bf16 v[52:67], a[228:231], v[72:75], v[52:67]
  s_waitcnt vmcnt(4) lgkmcnt(0)
  s_barrier
  ds_read_b128 v[100:103], v119 offset:0
  v_mfma_f32_32x32x16_bf16 v[52:67], a[232:235], v[76:79], v[52:67]
  ds_read_b128 v[68:71], v120 offset:32768
  v_mfma_f32_32x32x16_bf16 v[52:67], a[236:239], v[80:83], v[52:67]
  ds_read_b128 v[72:75], v121 offset:32768
  s_xor_b32 s50, s50, 32768
  v_mfma_f32_32x32x16_bf16 v[52:67], a[240:243], v[84:87], v[52:67]
  ds_read_b128 v[76:79], v122 offset:32768
  s_waitcnt vmcnt(0)
  s_mov_b64 exec, 1
  buffer_store_dword v4, off, s[4:7], s51 sc1
  s_mov_b64 exec, -1
  v_mfma_f32_32x32x16_bf16 v[52:67], a[244:247], v[88:91], v[52:67]
  s_waitcnt lgkmcnt(3)
  v_min3_u32 v104, v100, v101, v102
  v_max3_u32 v100, v100, v101, v102
  v_min_u32 v104, v104, v103
  v_max_u32 v100, v100, v103
  v_readfirstlane_b32 s45, v104
  v_readfirstlane_b32 s28, v100
  v_mfma_f32_32x32x16_bf16 v[52:67], a[248:251], v[92:95], v[52:67]
  s_max_u32 s56, s56, s28
  s_bfe_u32 s28, s56, 0x70005
  s_xor_b32 s28, s28, 63
  s_cmp_eq_u32 s28, s47
  s_cselect_b32 s55, 1, s55
  v_mfma_f32_32x32x16_bf16 v[52:67], a[252:255], v[96:99], v[52:67]
  s_cmp_gt_u32 s55, 0
  s_cselect_b32 s45, 0, s45
  s_cmp_lg_u32 s45, 0
  s_cbranch_scc1 q_w1_69
  s_branch q_slow_57
q_c1_67:
  ds_read_b128 v[68:71], v120 offset:32768
  ds_read_b128 v[72:75], v121 offset:32768
  ds_read_b128 v[76:79], v122 offset:32768
q_w1_69:
  s_waitcnt lgkmcnt(2)
  v_mfma_f32_32x32x16_bf16 v[20:35], v[128:131], v[68:71], 0
  ds_read_b128 v[80:83], v123 offset:32768
  s_mov_b32 s46, s47
  s_mov_b32 s47, s76
  s_lshl_b32 s52, s46, 7
  s_add_u32 s52, s52, s57
  s_lshl_b32 s44, s52, 12
  v_mfma_f32_32x32x16_bf16 v[36:51], v[68:71], a[0:3], 0
  s_add_u32 s44, s44, 41943040
  v_cvt_pk_bf16_f32 v100, v52, v53
  v_cvt_pk_bf16_f32 v101, v54, v55
  v_cvt_pk_bf16_f32 v102, v60, v61
  v_cvt_pk_bf16_f32 v103, v62, v63
  s_waitcnt lgkmcnt(2)
  v_mfma_f32_32x32x16_bf16 v[20:35], v[132:135], v[72:75], v[20:35]
  ds_read_b128 v[84:87], v124 offset:32768
  buffer_store_dwordx4 v[100:103], v8, s[4:7], s43 offen offset:0 sc1
  v_cvt_pk_bf16_f32 v104, v56, v57
  v_cvt_pk_bf16_f32 v105, v58, v59
  v_mfma_f32_32x32x16_bf16 v[36:51], v[72:75], a[4:7], v[36:51]
  v_cvt_pk_bf16_f32 v106, v64, v65
  v_cvt_pk_bf16_f32 v107, v66, v67
  s_waitcnt lgkmcnt(2)
  v_mfma_f32_32x32x16_bf16 v[20:35], v[136:139], v[76:79], v[20:35]
  ds_read_b128 v[88:91], v125 offset:32768
  buffer_store_dwordx4 v[104:107], v8, s[4:7], s43 offen offset:512 sc1
  s_lshl_b32 s43, s52, 11
  s_add_u32 s43, s43, 142606336
  v_mfma_f32_32x32x16_bf16 v[36:51], v[76:79], a[8:11], v[36:51]
  s_lshl_b32 s51, s52, 5
  s_add_u32 s51, s51, 244318208
  s_lshr_b32 s55, s47, 7
  s_or_b32 s55, s55, s62
  s_sub_u32 s27, s47, s60
  s_cmp_eq_u32 s27, 9
  s_cselect_b32 s55, 1, s55
  s_waitcnt lgkmcnt(2)
  v_mfma_f32_32x32x16_bf16 v[20:35], v[140:143], v[80:83], v[20:35]
  ds_read_b128 v[92:95], v126 offset:32768
  s_cmp_lt_u32 s40, 64
  s_cselect_b32 s42, s42, 0
  s_cmp_lg_u32 s42, 0
  s_cselect_b32 s76, s40, s41
  s_cselect_b32 s26, 3, 0
  s_cselect_b32 s42, s42, 2
  v_mfma_f32_32x32x16_bf16 v[36:51], v[80:83], a[12:15], v[36:51]
  s_sub_u32 s42, s42, 1
  s_add_u32 s40, s40, s26
  s_xor_b32 s26, s26, 3
  s_add_u32 s41, s41, s26
  s_waitcnt lgkmcnt(2)
  v_mfma_f32_32x32x16_bf16 v[20:35], v[144:147], v[84:87], v[20:35]
  ds_read_b128 v[96:99], v127 offset:32768
  v_mfma_f32_32x32x16_bf16 v[36:51], v[84:87], a[16:19], v[36:51]
  s_waitcnt lgkmcnt(2)
  v_mfma_f32_32x32x16_bf16 v[20:35], v[148:151], v[88:91], v[20:35]
  ds_read_b128 v[68:71], v120 offset:33024
  v_mfma_f32_32x32x16_bf16 v[36:51], v[88:91], a[20:23], v[36:51]
  s_waitcnt lgkmcnt(2)
  v_mfma_f32_32x32x16_bf16 v[20:35], v[152:155], v[92:95], v[20:35]
  ds_read_b128 v[72:75], v121 offset:33024
  s_cmp_lt_u32 s47, 64
  s_cselect_b32 s26, 2, 0
  s_add_u32 s26, s26, s47
  s_lshl_b32 s26, s26, 12
  s_add_u32 s26, s26, 243261440
  v_mfma_f32_32x32x16_bf16 v[36:51], v[92:95], a[24:27], v[36:51]
  s_mov_b64 exec, 0xffffff
  buffer_load_dword v116, v7, s[4:7], s26 offen sc1
  s_mov_b64 exec, -1
  s_waitcnt lgkmcnt(2)
  v_mfma_f32_32x32x16_bf16 v[20:35], v[156:159], v[96:99], v[20:35]
  ds_read_b128 v[76:79], v122 offset:33024
  v_mfma_f32_32x32x16_bf16 v[36:51], v[96:99], a[28:31], v[36:51]
  s_waitcnt lgkmcnt(2)
  v_mfma_f32_32x32x16_bf16 v[20:35], v[160:163], v[68:71], v[20:35]
  ds_read_b128 v[80:83], v123 offset:33024
  v_mfma_f32_32x32x16_bf16 v[36:51], v[68:71], a[32:35], v[36:51]
  s_waitcnt lgkmcnt(2)
  v_mfma_f32_32x32x16_bf16 v[20:35], v[164:167], v[72:75], v[20:35]
  ds_read_b128 v[84:87], v124 offset:33024
  v_mfma_f32_32x32x16_bf16 v[36:51], v[72:75], a[36:39], v[36:51]
  s_waitcnt lgkmcnt(2)
  v_mfma_f32_32x32x16_bf16 v[20:35], v[168:171], v[76:79], v[20:35]
  ds_read_b128 v[88:91], v125 offset:33024
  v_mfma_f32_32x32x16_bf16 v[36:51], v[76:79], a[40:43], v[36:51]
  s_waitcnt lgkmcnt(2)
  v_mfma_f32_32x32x16_bf16 v[20:35], v[172:175], v[80:83], v[20:35]
  ds_read_b128 v[92:95], v126 offset:33024
  v_mfma_f32_32x32x16_bf16 v[36:51], v[80:83], a[44:47], v[36:51]
  s_waitcnt lgkmcnt(2)
  v_mfma_f32_32x32x16_bf16 v[20:35], v[176:179], v[84:87], v[20:35]
  ds_read_b128 v[96:99], v127 offset:33024
  v_mfma_f32_32x32x16_bf16 v[36:51], v[84:87], a[48:51], v[36:51]
  s_waitcnt lgkmcnt(2)
  v_mfma_f32_32x32x16_bf16 v[20:35], v[180:183], v[88:91], v[20:35]
  ds_read_b128 v[68:71], v120 offset:33280
  v_mfma_f32_32x32x16_bf16 v[36:51], v[88:91], a[52:55], v[36:51]
  s_waitcnt lgkmcnt(2)
  v_mfma_f32_32x32x16_bf16 v[20:35], v[184:187], v[92:95], v[20:35]
  ds_read_b128 v[72:75], v121 offset:33280
  v_mfma_f32_32x32x16_bf16 v[36:51], v[92:95], a[56:59], v[36:51]
  s_waitcnt lgkmcnt(2)
  v_mfma_f32_32x32x16_bf16 v[20:35], v[188:191], v[96:99], v[20:35]
  ds_read_b128 v[76:79], v122 offset:33280
  v_mfma_f32_32x32x16_bf16 v[36:51], v[96:99], a[60:63], v[36:51]
  s_waitcnt lgkmcnt(2)
  v_mfma_f32_32x32x16_bf16 v[20:35], v[192:195], v[68:71], v[20:35]
  ds_read_b128 v[80:83], v123 offset:33280
  v_mfma_f32_32x32x16_bf16 v[36:51], v[68:71], a[64:67], v[36:51]
  s_waitcnt lgkmcnt(2)
  v_mfma_f32_32x32x16_bf16 v[20:35], v[196:199], v[72:75], v[20:35]
  ds_read_b128 v[84:87], v124 offset:33280
  v_mfma_f32_32x32x16_bf16 v[36:51], v[72:75], a[68:71], v[36:51]
  s_waitcnt lgkmcnt(2)
  v_mfma_f32_32x32x16_bf16 v[20:35], v[200:203], v[76:79], v[20:35]
  ds_read_b128 v[88:91], v125 offset:33280
  v_mfma_f32_32x32x16_bf16 v[36:51], v[76:79], a[72:75], v[36:51]
  s_waitcnt lgkmcnt(2)
  v_mfma_f32_32x32x16_bf16 v[20:35], v[204:207], v[80:83], v[20:35]
  ds_read_b128 v[92:95], v126 offset:33280
  s_waitcnt vmcnt(0)
  s_mov_b64 exec, 1
  buffer_store_dword v4, off, s[4:7], s49 sc1
  s_mov_b64 exec, -1
  v_mfma_f32_32x32x16_bf16 v[36:51], v[80:83], a[76:79], v[36:51]
  v_cmp_eq_u32 vcc, 0, v116
  v_max_u32_dpp v117, v116, v116 row_ror:8 row_mask:0xf bank_mask:0xf
  s_nop 0
  s_nop 0
  v_max_u32_dpp v117, v117, v117 row_ror:4 row_mask:0xf bank_mask:0xf
  s_nop 0
  s_waitcnt lgkmcnt(2)
  v_mfma_f32_32x32x16_bf16 v[20:35], v[208:211], v[84:87], v[20:35]
  ds_read_b128 v[96:99], v127 offset:33280
  s_nop 0
  v_max_u32_dpp v117, v117, v117 row_ror:2 row_mask:0xf bank_mask:0xf
  s_nop 0
  s_nop 0
  v_max_u32_dpp v117, v117, v117 row_ror:1 row_mask:0xf bank_mask:0xf
  v_mfma_f32_32x32x16_bf16 v[36:51], v[84:87], a[80:83], v[36:51]
  s_nop 0
  v_readlane_b32 s48, v117, 0
  v_readlane_b32 s28, v117, 16
  s_max_u32 s48, s48, s28
  s_and_b32 s28, vcc_lo, 0xffffff
  s_cselect_b32 s48, 0, s48
  s_waitcnt lgkmcnt(2)
  v_mfma_f32_32x32x16_bf16 v[20:35], v[212:215], v[88:91], v[20:35]
  ds_read_b128 v[68:71], v120 offset:33536
  s_cmp_lg_u32 s48, 0
  s_cselect_b32 s28, s47, s46
  s_and_b32 s63, s28, 127
  s_lshl_b32 s63, s63, 15
  s_xor_b32 s27, s50, 32768
  v_mfma_f32_32x32x16_bf16 v[36:51], v[88:91], a[84:87], v[36:51]
  s_add_u32 m0, s27, s54
  s_add_u32 s63, s63, s54
  s_add_u32 s63, s63, 6291456
  s_waitcnt lgkmcnt(2)
  v_mfma_f32_32x32x16_bf16 v[20:35], v[216:219], v[92:95], v[20:35]
  ds_read_b128 v[72:75], v121 offset:33536
  buffer_load_dwordx4 v12, s[4:7], s63 offen offset:0 sc1 lds
  v_mfma_f32_32x32x16_bf16 v[36:51], v[92:95], a[88:91], v[36:51]
  s_waitcnt lgkmcnt(2)
  v_mfma_f32_32x32x16_bf16 v[20:35], v[220:223], v[96:99], v[20:35]
  ds_read_b128 v[76:79], v122 offset:33536
  buffer_load_dwordx4 v13, s[4:7], s63 offen offset:1024 sc1 lds
  v_mfma_f32_32x32x16_bf16 v[36:51], v[96:99], a[92:95], v[36:51]
  s_waitcnt lgkmcnt(2)
  v_mfma_f32_32x32x16_bf16 v[20:35], v[224:227], v[68:71], v[20:35]
  ds_read_b128 v[80:83], v123 offset:33536
  buffer_load_dwordx4 v14, s[4:7], s63 offen offset:2048 sc1 lds
  v_mfma_f32_32x32x16_bf16 v[36:51], v[68:71], a[96:99], v[36:51]
  s_waitcnt lgkmcnt(2)
  v_mfma_f32_32x32x16_bf16 v[20:35], v[228:231], v[72:75], v[20:35]
  ds_read_b128 v[84:87], v124 offset:33536
  buffer_load_dwordx4 v15, s[4:7], s63 offen offset:3072 sc1 lds
  s_add_u32 m0, m0, 4096
  s_add_u32 s63, s63, 4096
  v_mfma_f32_32x32x16_bf16 v[36:51], v[72:75], a[100:103], v[36:51]
  s_waitcnt lgkmcnt(2)
  v_mfma_f32_32x32x16_bf16 v[20:35], v[232:235], v[76:79], v[20:35]
  ds_read_b128 v[88:91], v125 offset:33536
  buffer_load_dwordx4 v16, s[4:7], s63 offen offset:0 sc1 lds
  v_mfma_f32_32x32x16_bf16 v[36:51], v[76:79], a[104:107], v[36:51]
  s_waitcnt lgkmcnt(2)
  v_mfma_f32_32x32x16_bf16 v[20:35], v[236:239], v[80:83], v[20:35]
  ds_read_b128 v[92:95], v126 offset:33536
  buffer_load_dwordx4 v17, s[4:7], s63 offen offset:1024 sc1 lds
  v_mfma_f32_32x32x16_bf16 v[36:51], v[80:83], a[108:111], v[36:51]
  s_waitcnt lgkmcnt(2)
  v_mfma_f32_32x32x16_bf16 v[20:35], v[240:243], v[84:87], v[20:35]
  ds_read_b128 v[96:99], v127 offset:33536
  buffer_load_dwordx4 v18, s[4:7], s63 offen offset:2048 sc1 lds
  v_mfma_f32_32x32x16_bf16 v[36:51], v[84:87], a[112:115], v[36:51]
  s_waitcnt lgkmcnt(2)
  v_mfma_f32_32x32x16_bf16 v[20:35], v[244:247], v[88:91], v[20:35]
  ds_read_b128 v[68:71], v120 offset:32768
  buffer_load_dwordx4 v19, s[4:7], s63 offen offset:3072 sc1 lds
  s_add_u32 s49, s51, 16
  s_add_u32 s26, s62, 1
  v_mfma_f32_32x32x16_bf16 v[36:51], v[88:91], a[116:119], v[36:51]
  ds_read_b128 v[72:75], v121 offset:32768
  v_mov_b32 v4, s26
  s_cmp_lt_u32 s47, 128
  s_cselect_b32 s26, s48, 0
  v_mov_b32 v2, s26
  ds_write_b32 v118, v2 offset:16
  s_waitcnt lgkmcnt(4)
  v_mfma_f32_32x32x16_bf16 v[20:35], v[248:251], v[92:95], v[20:35]
  ds_read_b128 v[76:79], v122 offset:32768
  v_mfma_f32_32x32x16_bf16 v[36:51], v[92:95], a[120:123], v[36:51]
  ds_read_b128 v[80:83], v123 offset:32768
  s_waitcnt lgkmcnt(5)
  v_mfma_f32_32x32x16_bf16 v[20:35], v[252:255], v[96:99], v[20:35]
  ds_read_b128 v[84:87], v124 offset:32768
  v_mfma_f32_32x32x16_bf16 v[36:51], v[96:99], a[124:127], v[36:51]
  ds_read_b128 v[88:91], v125 offset:32768
  s_waitcnt lgkmcnt(5)
  v_mfma_f32_32x32x16_bf16 v[52:67], a[128:131], v[68:71], 0
  ds_read_b128 v[92:95], v126 offset:32768
  v_mfma_f32_32x32x16_bf16 v[52:67], a[132:135], v[72:75], v[52:67]
  ds_read_b128 v[96:99], v127 offset:32768
  s_nop 3
  v_mul_f32 v20, s24, v20
  v_mul_f32 v21, s24, v21
  v_mul_f32 v22, s24, v22
  v_mul_f32 v23, s24, v23
  v_mul_f32 v24, s24, v24
  s_waitcnt lgkmcnt(4)
  v_mfma_f32_32x32x16_bf16 v[52:67], a[136:139], v[76:79], v[52:67]
  ds_read_b128 v[68:71], v120 offset:33024
  v_mul_f32 v25, s24, v25
  v_cvt_pk_bf16_f32 v100, v36, v37
  v_cvt_pk_bf16_f32 v101, v38, v39
  v_cvt_pk_bf16_f32 v102, v44, v45
  v_cvt_pk_bf16_f32 v103, v46, v47
  v_mfma_f32_32x32x16_bf16 v[52:67], a[140:143], v[80:83], v[52:67]
  ds_read_b128 v[72:75], v121 offset:33024
  buffer_store_dwordx4 v[100:103], v8, s[4:7], s44 offen offset:2048 sc1
  v_cvt_pk_bf16_f32 v104, v40, v41
  v_cvt_pk_bf16_f32 v105, v42, v43
  s_waitcnt lgkmcnt(4)
  v_mfma_f32_32x32x16_bf16 v[52:67], a[144:147], v[84:87], v[52:67]
  ds_read_b128 v[76:79], v122 offset:33024
  v_cvt_pk_bf16_f32 v106, v48, v49
  v_cvt_pk_bf16_f32 v107, v50, v51
  buffer_store_dwordx4 v[104:107], v8, s[4:7], s44 offen offset:2560 sc1
  v_mfma_f32_32x32x16_bf16 v[52:67], a[148:151], v[88:91], v[52:67]
  ds_read_b128 v[80:83], v123 offset:33024
  v_mul_f32 v26, s24, v26
  v_mul_f32 v27, s24, v27
  v_mul_f32 v28, s24, v28
  v_mul_f32 v29, s24, v29
  v_mul_f32 v30, s24, v30
  s_waitcnt lgkmcnt(4)
  v_mfma_f32_32x32x16_bf16 v[52:67], a[152:155], v[92:95], v[52:67]
  ds_read_b128 v[84:87], v124 offset:33024
  v_mul_f32 v31, s24, v31
  v_mul_f32 v32, s24, v32
  v_mul_f32 v33, s24, v33
  v_mul_f32 v34, s24, v34
  v_mul_f32 v35, s24, v35
  v_mfma_f32_32x32x16_bf16 v[52:67], a[156:159], v[96:99], v[52:67]
  ds_read_b128 v[88:91], v125 offset:33024
  v_cvt_pk_bf16_f32 v108, v20, v21
  v_cvt_pk_bf16_f32 v109, v22, v23
  v_cvt_pk_bf16_f32 v110, v28, v29
  v_cvt_pk_bf16_f32 v111, v30, v31
  buffer_store_dwordx4 v[108:111], v8, s[4:7], s44 offen offset:0 sc1
  s_waitcnt lgkmcnt(4)
  v_mfma_f32_32x32x16_bf16 v[52:67], a[160:163], v[68:71], v[52:67]
  ds_read_b128 v[92:95], v126 offset:33024
  v_cvt_pk_bf16_f32 v112, v24, v25
  v_cvt_pk_bf16_f32 v113, v26, v27
  v_cvt_pk_bf16_f32 v114, v32, v33
  v_cvt_pk_bf16_f32 v115, v34, v35
  buffer_store_dwordx4 v[112:115], v8, s[4:7], s44 offen offset:512 sc1
  v_mfma_f32_32x32x16_bf16 v[52:67], a[164:167], v[72:75], v[52:67]
  ds_read_b128 v[96:99], v127 offset:33024
  s_waitcnt lgkmcnt(4)
  v_mfma_f32_32x32x16_bf16 v[52:67], a[168:171], v[76:79], v[52:67]
  ds_read_b128 v[68:71], v120 offset:33280
  v_mfma_f32_32x32x16_bf16 v[52:67], a[172:175], v[80:83], v[52:67]
  ds_read_b128 v[72:75], v121 offset:33280
  s_waitcnt lgkmcnt(4)
  v_mfma_f32_32x32x16_bf16 v[52:67], a[176:179], v[84:87], v[52:67]
  ds_read_b128 v[76:79], v122 offset:33280
  v_mfma_f32_32x32x16_bf16 v[52:67], a[180:183], v[88:91], v[52:67]
  ds_read_b128 v[80:83], v123 offset:33280
  s_waitcnt lgkmcnt(4)
  v_mfma_f32_32x32x16_bf16 v[52:67], a[184:187], v[92:95], v[52:67]
  ds_read_b128 v[84:87], v124 offset:33280
  v_mfma_f32_32x32x16_bf16 v[52:67], a[188:191], v[96:99], v[52:67]
  ds_read_b128 v[88:91], v125 offset:33280
  s_waitcnt lgkmcnt(4)
  v_mfma_f32_32x32x16_bf16 v[52:67], a[192:195], v[68:71], v[52:67]
  ds_read_b128 v[92:95], v126 offset:33280
  v_mfma_f32_32x32x16_bf16 v[52:67], a[196:199], v[72:75], v[52:67]
  ds_read_b128 v[96:99], v127 offset:33280
  s_waitcnt lgkmcnt(4)
  v_mfma_f32_32x32x16_bf16 v[52:67], a[200:203], v[76:79], v[52:67]
  ds_read_b128 v[68:71], v120 offset:33536
  v_mfma_f32_32x32x16_bf16 v[52:67], a[204:207], v[80:83], v[52:67]
  ds_read_b128 v[72:75], v121 offset:33536
  s_waitcnt lgkmcnt(4)
  v_mfma_f32_32x32x16_bf16 v[52:67], a[208:211], v[84:87], v[52:67]
  ds_read_b128 v[76:79], v122 offset:33536
  ds_read_b128 v[80:83], v123 offset:33536
  v_mfma_f32_32x32x16_bf16 v[52:67], a[212:215], v[88:91], v[52:67]
  ds_read_b128 v[84:87], v124 offset:33536
  ds_read_b128 v[88:91], v125 offset:33536
  s_waitcnt lgkmcnt(6)
  v_mfma_f32_32x32x16_bf16 v[52:67], a[216:219], v[92:95], v[52:67]
  ds_read_b128 v[92:95], v126 offset:33536
  v_mfma_f32_32x32x16_bf16 v[52:67], a[220:223], v[96:99], v[52:67]
  ds_read_b128 v[96:99], v127 offset:33536
  s_waitcnt lgkmcnt(6)
  v_mfma_f32_32x32x16_bf16 v[52:67], a[224:227], v[68:71], v[52:67]
  v_mfma_f32_32x32x16_bf16 v[52:67], a[228:231], v[72:75], v[52:67]
  s_waitcnt vmcnt(4) lgkmcnt(0)
  s_barrier
  ds_read_b128 v[100:103], v119 offset:16
  v_mfma_f32_32x32x16_bf16 v[52:67], a[232:235], v[76:79], v[52:67]
  ds_read_b128 v[68:71], v120 offset:0
  v_mfma_f32_32x32x16_bf16 v[52:67], a[236:239], v[80:83], v[52:67]
  ds_read_b128 v[72:75], v121 offset:0
  s_xor_b32 s50, s50, 32768
  v_mfma_f32_32x32x16_bf16 v[52:67], a[240:243], v[84:87], v[52:67]
  ds_read_b128 v[76:79], v122 offset:0
  s_waitcnt vmcnt(0)
  s_mov_b64 exec, 1
  buffer_store_dword v4, off, s[4:7], s51 sc1
  s_mov_b64 exec, -1
  v_mfma_f32_32x32x16_bf16 v[52:67], a[244:247], v[88:91], v[52:67]
  s_waitcnt lgkmcnt(3)
  v_min3_u32 v104, v100, v101, v102
  v_max3_u32 v100, v100, v101, v102
  v_min_u32 v104, v104, v103
  v_max_u32 v100, v100, v103
  v_readfirstlane_b32 s45, v104
  v_readfirstlane_b32 s28, v100
  v_mfma_f32_32x32x16_bf16 v[52:67], a[248:251], v[92:95], v[52:67]
  s_max_u32 s56, s56, s28
  s_bfe_u32 s28, s56, 0x70005
  s_xor_b32 s28, s28, 63
  s_cmp_eq_u32 s28, s47
  s_cselect_b32 s55, 1, s55
  v_mfma_f32_32x32x16_bf16 v[52:67], a[252:255], v[96:99], v[52:67]
  s_cmp_gt_u32 s55, 0
  s_cselect_b32 s45, 0, s45
  s_cmp_lg_u32 s45, 0
  s_cbranch_scc1 q_w0_68
  s_branch q_slow_57
q_fork_64:
  s_mov_b32 s58, s56
  s_mov_b32 s62, 1
  s_mov_b32 s77, s40
  s_mov_b32 s78, s41
  s_mov_b32 s79, s42
  s_load_dwordx2 s[64:65], s[0:1], 72
  s_load_dwordx2 s[68:69], s[0:1], 80
  s_load_dwordx2 s[8:9], s[0:1], 88
  s_mov_b32 s66, 1835008
  s_mov_b32 s70, 1835008
  s_mov_b32 s10, 1835008
  v_lshrrev_b32 v2, 8, v0
  v_and_b32 v3, 0x70, v0
  s_mov_b32 s26, 114688
  v_mul_lo_u32 v6, v2, s26
  v_add_u32 v6, v6, v3
  v_cmp_eq_u32 vcc, 0x70, v3
  v_mov_b32 v3, 0x7ff00000
  s_nop 0
  v_cndmask_b32 v6, v6, v3, vcc
  v_mul_u32_u24 v7, 14336, v2
  v_and_b32 v3, 0xf0, v0
  v_add_u32 v7, v7, v3
  s_mul_i32 s34, s17, 458752
  s_mul_i32 s27, s16, 112
  s_add_u32 s34, s34, s27
  s_add_u32 s34, s34, 82432
  s_mul_i32 s35, s16, 57344
  s_lshl_b32 s27, s17, 8
  s_add_u32 s35, s35, s27
  s_mov_b32 s36, 0x00ff00ff
  s_mov_b32 s37, 0x00ff00ff
  s_waitcnt lgkmcnt(0)
  s_andn2_b32 s59, 0xfff, s58
  s_lshl_b32 s26, s61, 21
  s_lshl_b32 s27, s59, 10
  s_add_u32 s26, s26, s27
  s_lshl_b32 s27, s17, 8
  s_add_u32 s26, s26, s27
  s_add_u32 s26, s26, 27262976
  v_lshrrev_b32 v3, 8, v0
  v_lshlrev_b32 v3, 6, v3
  buffer_load_dwordx4 v[36:39], v3, s[4:7], s26 offen offset:0 sc1
  buffer_load_dwordx4 v[40:43], v3, s[4:7], s26 offen offset:16 sc1
  buffer_load_dwordx4 v[44:47], v3, s[4:7], s26 offen offset:32 sc1
  buffer_load_dwordx4 v[48:51], v3, s[4:7], s26 offen offset:48 sc1
  s_mov_b64 exec, s[36:37]
  buffer_load_dwordx4 v[64:67], v6, s[64:67], s34 offen
  s_not_b64 exec, exec
  buffer_load_dwordx4 v[64:67], v6, s[68:71], s34 offen
  s_mov_b64 exec, -1
  s_add_u32 s34, s34, 3584
  s_mov_b64 exec, s[36:37]
  buffer_load_dwordx4 v[68:71], v6, s[64:67], s34 offen
  s_not_b64 exec, exec
  buffer_load_dwordx4 v[68:71], v6, s[68:71], s34 offen
  s_mov_b64 exec, -1
  s_add_u32 s34, s34, 3584
  s_mov_b64 exec, s[36:37]
  buffer_load_dwordx4 v[72:75], v6, s[64:67], s34 offen
  s_not_b64 exec, exec
  buffer_load_dwordx4 v[72:75], v6, s[68:71], s34 offen
  s_mov_b64 exec, -1
  s_add_u32 s34, s34, 3584
  s_mov_b64 exec, s[36:37]
  buffer_load_dwordx4 v[76:79], v6, s[64:67], s34 offen
  s_not_b64 exec, exec
  buffer_load_dwordx4 v[76:79], v6, s[68:71], s34 offen
  s_mov_b64 exec, -1
  s_add_u32 s34, s34, 3584
  s_mov_b64 exec, s[36:37]
  buffer_load_dwordx4 v[80:83], v6, s[64:67], s34 offen
  s_not_b64 exec, exec
  buffer_load_dwordx4 v[80:83], v6, s[68:71], s34 offen
  s_mov_b64 exec, -1
  s_add_u32 s34, s34, 3584
  s_mov_b64 exec, s[36:37]
  buffer_load_dwordx4 v[84:87], v6, s[64:67], s34 offen
  s_not_b64 exec, exec
  buffer_load_dwordx4 v[84:87], v6, s[68:71], s34 offen
  s_mov_b64 exec, -1
  s_add_u32 s34, s34, 3584
  s_mov_b64 exec, s[36:37]
  buffer_load_dwordx4 v[88:91], v6, s[64:67], s34 offen
  s_not_b64 exec, exec
  buffer_load_dwordx4 v[88:91], v6, s[68:71], s34 offen
  s_mov_b64 exec, -1
  s_add_u32 s34, s34, 3584
  s_mov_b64 exec, s[36:37]
  buffer_load_dwordx4 v[92:95], v6, s[64:67], s34 offen
  s_not_b64 exec, exec
  buffer_load_dwordx4 v[92:95], v6, s[68:71], s34 offen
  s_mov_b64 exec, -1
  s_add_u32 s34, s34, 3584
  s_mov_b64 exec, s[36:37]
  buffer_load_dwordx4 v[96:99], v6, s[64:67], s34 offen
  s_not_b64 exec, exec
  buffer_load_dwordx4 v[96:99], v6, s[68:71], s34 offen
  s_mov_b64 exec, -1
  s_add_u32 s34, s34, 3584
  buffer_load_dwordx4 v[100:103], v7, s[8:11], s35 offen offset:0
  buffer_load_dwordx4 v[104:107], v7, s[8:11], s35 offen offset:1024
  buffer_load_dwordx4 v[108:111], v7, s[8:11], s35 offen offset:2048
  buffer_load_dwordx4 v[112:115], v7, s[8:11], s35 offen offset:3072
  s_add_u32 s35, s35, 4096
  s_mov_b32 vcc_lo, 0xaaaaaaaa
  s_mov_b32 vcc_hi, 0xaaaaaaaa
  v_mov_b32 v3, 0xffff
  v_mov_b32 v28, 0xffff0000
  v_cndmask_b32 v3, v3, v28, vcc
  s_mov_b32 vcc_lo, 0x30003
  s_mov_b32 vcc_hi, 0x30003
  v_cndmask_b32 v28, 0, v3, vcc
  s_mov_b32 vcc_lo, 0xc000c
  s_mov_b32 vcc_hi, 0xc000c
  v_cndmask_b32 v29, 0, v3, vcc
  s_mov_b32 vcc_lo, 0x300030
  s_mov_b32 vcc_hi, 0x300030
  v_cndmask_b32 v30, 0, v3, vcc
  s_mov_b32 vcc_lo, 0xc000c0
  s_mov_b32 vcc_hi, 0xc000c0
  v_cndmask_b32 v31, 0, v3, vcc
  s_mov_b32 s30, 0x01000100
  s_mov_b32 s31, 0x03020302
  s_mul_i32 s26, s17, 23552
  s_add_u32 s26, s26, 65536
  v_add_u32 v5, s26, v0
  ds_read_b128 v[52:55], v5 offset:0
  ds_read_b128 v[56:59], v5 offset:1024
  ds_read_b128 v[60:63], v5 offset:2048
  s_waitcnt vmcnt(22)
  v_perm_b32 v3, v36, v36, s30
  v_and_b32 v20, v28, v3
  v_and_b32 v21, v29, v3
  v_and_b32 v22, v30, v3
  v_and_b32 v23, v31, v3
  s_waitcnt lgkmcnt(2)
  s_nop 0
  v_mfma_f32_16x16x32_bf16 v[32:35], v[20:23], v[52:55], 0
  ds_read_b128 v[52:55], v5 offset:3072
  v_perm_b32 v3, v36, v36, s31
  v_and_b32 v24, v28, v3
  v_and_b32 v25, v29, v3
  v_and_b32 v26, v30, v3
  v_and_b32 v27, v31, v3
  s_waitcnt lgkmcnt(2)
  s_nop 0
  v_mfma_f32_16x16x32_bf16 v[32:35], v[24:27], v[56:59], v[32:35]
  ds_read_b128 v[56:59], v5 offset:4096
  v_perm_b32 v3, v37, v37, s30
  v_and_b32 v20, v28, v3
  v_and_b32 v21, v29, v3
  v_and_b32 v22, v30, v3
  v_and_b32 v23, v31, v3
  s_waitcnt lgkmcnt(2)
  s_nop 0
  v_mfma_f32_16x16x32_bf16 v[32:35], v[20:23], v[60:63], v[32:35]
  ds_read_b128 v[60:63], v5 offset:5120
  v_perm_b32 v3, v37, v37, s31
  v_and_b32 v24, v28, v3
  v_and_b32 v25, v29, v3
  v_and_b32 v26, v30, v3
  v_and_b32 v27, v31, v3
  s_waitcnt lgkmcnt(2)
  s_nop 0
  v_mfma_f32_16x16x32_bf16 v[32:35], v[24:27], v[52:55], v[32:35]
  ds_read_b128 v[52:55], v5 offset:6144
  v_perm_b32 v3, v38, v38, s30
  v_and_b32 v20, v28, v3
  v_and_b32 v21, v29, v3
  v_and_b32 v22, v30, v3
  v_and_b32 v23, v31, v3
  s_waitcnt lgkmcnt(2)
  s_nop 0
  v_mfma_f32_16x16x32_bf16 v[32:35], v[20:23], v[56:59], v[32:35]
  ds_read_b128 v[56:59], v5 offset:7168
  v_perm_b32 v3, v38, v38, s31
  v_and_b32 v24, v28, v3
  v_and_b32 v25, v29, v3
  v_and_b32 v26, v30, v3
  v_and_b32 v27, v31, v3
  s_waitcnt lgkmcnt(2)
  s_nop 0
  v_mfma_f32_16x16x32_bf16 v[32:35], v[24:27], v[60:63], v[32:35]
  ds_read_b128 v[60:63], v5 offset:8192
  v_perm_b32 v3, v39, v39, s30
  v_and_b32 v20, v28, v3
  v_and_b32 v21, v29, v3
  v_and_b32 v22, v30, v3
  v_and_b32 v23, v31, v3
  s_waitcnt lgkmcnt(2)
  s_nop 0
  v_mfma_f32_16x16x32_bf16 v[32:35], v[20:23], v[52:55], v[32:35]
  ds_read_b128 v[52:55], v5 offset:9216
  v_perm_b32 v3, v39, v39, s31
  v_and_b32 v24, v28, v3
  v_and_b32 v25, v29, v3
  v_and_b32 v26, v30, v3
  v_and_b32 v27, v31, v3
  s_waitcnt lgkmcnt(2)
  s_nop 0
  v_mfma_f32_16x16x32_bf16 v[32:35], v[24:27], v[56:59], v[32:35]
  ds_read_b128 v[56:59], v5 offset:10240
  v_perm_b32 v3, v40, v40, s30
  v_and_b32 v20, v28, v3
  v_and_b32 v21, v29, v3
  v_and_b32 v22, v30, v3
  v_and_b32 v23, v31, v3
  s_waitcnt lgkmcnt(2)
  s_nop 0
  v_mfma_f32_16x16x32_bf16 v[32:35], v[20:23], v[60:63], v[32:35]
  ds_read_b128 v[60:63], v5 offset:11264
  v_perm_b32 v3, v40, v40, s31
  v_and_b32 v24, v28, v3
  v_and_b32 v25, v29, v3
  v_and_b32 v26, v30, v3
  v_and_b32 v27, v31, v3
  s_waitcnt lgkmcnt(2)
  s_nop 0
  v_mfma_f32_16x16x32_bf16 v[32:35], v[24:27], v[52:55], v[32:35]
  ds_read_b128 v[52:55], v5 offset:12288
  v_perm_b32 v3, v41, v41, s30
  v_and_b32 v20, v28, v3
  v_and_b32 v21, v29, v3
  v_and_b32 v22, v30, v3
  v_and_b32 v23, v31, v3
  s_waitcnt lgkmcnt(2)
  s_nop 0
  v_mfma_f32_16x16x32_bf16 v[32:35], v[20:23], v[56:59], v[32:35]
  ds_read_b128 v[56:59], v5 offset:13312
  v_perm_b32 v3, v41, v41, s31
  v_and_b32 v24, v28, v3
  v_and_b32 v25, v29, v3
  v_and_b32 v26, v30, v3
  v_and_b32 v27, v31, v3
  s_waitcnt lgkmcnt(2)
  s_nop 0
  v_mfma_f32_16x16x32_bf16 v[32:35], v[24:27], v[60:63], v[32:35]
  ds_read_b128 v[60:63], v5 offset:14336
  v_perm_b32 v3, v42, v42, s30
  v_and_b32 v20, v28, v3
  v_and_b32 v21, v29, v3
  v_and_b32 v22, v30, v3
  v_and_b32 v23, v31, v3
  s_waitcnt lgkmcnt(2)
  s_nop 0
  v_mfma_f32_16x16x32_bf16 v[32:35], v[20:23], v[52:55], v[32:35]
  ds_read_b128 v[52:55], v5 offset:15360
  v_perm_b32 v3, v42, v42, s31
  v_and_b32 v24, v28, v3
  v_and_b32 v25, v29, v3
  v_and_b32 v26, v30, v3
  v_and_b32 v27, v31, v3
  s_waitcnt lgkmcnt(2)
  s_nop 0
  v_mfma_f32_16x16x32_bf16 v[32:35], v[24:27], v[56:59], v[32:35]
  ds_read_b128 v[56:59], v5 offset:16384
  v_perm_b32 v3, v43, v43, s30
  v_and_b32 v20, v28, v3
  v_and_b32 v21, v29, v3
  v_and_b32 v22, v30, v3
  v_and_b32 v23, v31, v3
  s_waitcnt lgkmcnt(2)
  s_nop 0
  v_mfma_f32_16x16x32_bf16 v[32:35], v[20:23], v[60:63], v[32:35]
  ds_read_b128 v[60:63], v5 offset:17408
  v_perm_b32 v3, v43, v43, s31
  v_and_b32 v24, v28, v3
  v_and_b32 v25, v29, v3
  v_and_b32 v26, v30, v3
  v_and_b32 v27, v31, v3
  s_waitcnt lgkmcnt(2)
  s_nop 0
  v_mfma_f32_16x16x32_bf16 v[32:35], v[24:27], v[52:55], v[32:35]
  ds_read_b128 v[52:55], v5 offset:18432
  v_perm_b32 v3, v44, v44, s30
  v_and_b32 v20, v28, v3
  v_and_b32 v21, v29, v3
  v_and_b32 v22, v30, v3
  v_and_b32 v23, v31, v3
  s_waitcnt lgkmcnt(2)
  s_nop 0
  v_mfma_f32_16x16x32_bf16 v[32:35], v[20:23], v[56:59], v[32:35]
  ds_read_b128 v[56:59], v5 offset:19456
  v_perm_b32 v3, v44, v44, s31
  v_and_b32 v24, v28, v3
  v_and_b32 v25, v29, v3
  v_and_b32 v26, v30, v3
  v_and_b32 v27, v31, v3
  s_waitcnt lgkmcnt(2)
  s_nop 0
  v_mfma_f32_16x16x32_bf16 v[32:35], v[24:27], v[60:63], v[32:35]
  ds_read_b128 v[60:63], v5 offset:20480
  v_perm_b32 v3, v45, v45, s30
  v_and_b32 v20, v28, v3
  v_and_b32 v21, v29, v3
  v_and_b32 v22, v30, v3
  v_and_b32 v23, v31, v3
  s_waitcnt lgkmcnt(2)
  s_nop 0
  v_mfma_f32_16x16x32_bf16 v[32:35], v[20:23], v[52:55], v[32:35]
  ds_read_b128 v[52:55], v5 offset:21504
  v_perm_b32 v3, v45, v45, s31
  v_and_b32 v24, v28, v3
  v_and_b32 v25, v29, v3
  v_and_b32 v26, v30, v3
  v_and_b32 v27, v31, v3
  s_waitcnt lgkmcnt(2)
  s_nop 0
  v_mfma_f32_16x16x32_bf16 v[32:35], v[24:27], v[56:59], v[32:35]
  ds_read_b128 v[56:59], v5 offset:22528
  v_perm_b32 v3, v46, v46, s30
  v_and_b32 v20, v28, v3
  v_and_b32 v21, v29, v3
  v_and_b32 v22, v30, v3
  v_and_b32 v23, v31, v3
  s_waitcnt lgkmcnt(2)
  s_nop 0
  v_mfma_f32_16x16x32_bf16 v[32:35], v[20:23], v[60:63], v[32:35]
  buffer_load_dwordx4 v[60:63], v7, s[8:11], s35 offen offset:0
  v_perm_b32 v3, v46, v46, s31
  v_and_b32 v24, v28, v3
  v_and_b32 v25, v29, v3
  v_and_b32 v26, v30, v3
  v_and_b32 v27, v31, v3
  s_waitcnt lgkmcnt(1)
  s_nop 0
  v_mfma_f32_16x16x32_bf16 v[32:35], v[24:27], v[52:55], v[32:35]
  buffer_load_dwordx4 v[52:55], v7, s[8:11], s35 offen offset:1024
  v_perm_b32 v3, v47, v47, s30
  v_and_b32 v20, v28, v3
  v_and_b32 v21, v29, v3
  v_and_b32 v22, v30, v3
  v_and_b32 v23, v31, v3
  s_waitcnt lgkmcnt(0)
  s_nop 0
  v_mfma_f32_16x16x32_bf16 v[32:35], v[20:23], v[56:59], v[32:35]
  buffer_load_dwordx4 v[56:59], v7, s[8:11], s35 offen offset:2048
  v_perm_b32 v3, v47, v47, s31
  v_and_b32 v24, v28, v3
  v_and_b32 v25, v29, v3
  v_and_b32 v26, v30, v3
  v_and_b32 v27, v31, v3
  s_waitcnt vmcnt(23)
  s_nop 0
  v_mfma_f32_16x16x32_bf16 v[32:35], v[24:27], v[64:67], v[32:35]
  buffer_load_dwordx4 v[64:67], v7, s[8:11], s35 offen offset:3072
  s_add_u32 s35, s35, 4096
  v_perm_b32 v3, v48, v48, s30
  v_and_b32 v20, v28, v3
  v_and_b32 v21, v29, v3
  v_and_b32 v22, v30, v3
  v_and_b32 v23, v31, v3
  s_waitcnt vmcnt(22)
  s_nop 0
  v_mfma_f32_16x16x32_bf16 v[32:35], v[20:23], v[68:71], v[32:35]
  buffer_load_dwordx4 v[68:71], v7, s[8:11], s35 offen offset:0
  v_perm_b32 v3, v48, v48, s31
  v_and_b32 v24, v28, v3
  v_and_b32 v25, v29, v3
  v_and_b32 v26, v30, v3
  v_and_b32 v27, v31, v3
  s_waitcnt vmcnt(21)
  s_nop 0
  v_mfma_f32_16x16x32_bf16 v[32:35], v[24:27], v[72:75], v[32:35]
  buffer_load_dwordx4 v[72:75], v7, s[8:11], s35 offen offset:1024
  v_perm_b32 v3, v49, v49, s30
  v_and_b32 v20, v28, v3
  v_and_b32 v21, v29, v3
  v_and_b32 v22, v30, v3
  v_and_b32 v23, v31, v3
  s_waitcnt vmcnt(20)
  s_nop 0
  v_mfma_f32_16x16x32_bf16 v[32:35], v[20:23], v[76:79], v[32:35]
  buffer_load_dwordx4 v[76:79], v7, s[8:11], s35 offen offset:2048
  v_perm_b32 v3, v49, v49, s31
  v_and_b32 v24, v28, v3
  v_and_b32 v25, v29, v3
  v_and_b32 v26, v30, v3
  v_and_b32 v27, v31, v3
  s_waitcnt vmcnt(19)
  s_nop 0
  v_mfma_f32_16x16x32_bf16 v[32:35], v[24:27], v[80:83], v[32:35]
  buffer_load_dwordx4 v[80:83], v7, s[8:11], s35 offen offset:3072
  s_add_u32 s35, s35, 4096
  v_perm_b32 v3, v50, v50, s30
  v_and_b32 v20, v28, v3
  v_and_b32 v21, v29, v3
  v_and_b32 v22, v30, v3
  v_and_b32 v23, v31, v3
  s_waitcnt vmcnt(18)
  s_nop 0
  v_mfma_f32_16x16x32_bf16 v[32:35], v[20:23], v[84:87], v[32:35]
  buffer_load_dwordx4 v[84:87], v7, s[8:11], s35 offen offset:0
  v_perm_b32 v3, v50, v50, s31
  v_and_b32 v24, v28, v3
  v_and_b32 v25, v29, v3
  v_and_b32 v26, v30, v3
  v_and_b32 v27, v31, v3
  s_waitcnt vmcnt(17)
  s_nop 0
  v_mfma_f32_16x16x32_bf16 v[32:35], v[24:27], v[88:91], v[32:35]
  buffer_load_dwordx4 v[88:91], v7, s[8:11], s35 offen offset:1024
  v_perm_b32 v3, v51, v51, s30
  v_and_b32 v20, v28, v3
  v_and_b32 v21, v29, v3
  v_and_b32 v22, v30, v3
  v_and_b32 v23, v31, v3
  s_waitcnt vmcnt(16)
  s_nop 0
  v_mfma_f32_16x16x32_bf16 v[32:35], v[20:23], v[92:95], v[32:35]
  v_perm_b32 v3, v51, v51, s31
  v_and_b32 v24, v28, v3
  v_and_b32 v25, v29, v3
  v_and_b32 v26, v30, v3
  v_and_b32 v27, v31, v3
  s_waitcnt vmcnt(14)
  s_nop 0
  v_mfma_f32_16x16x32_bf16 v[32:35], v[24:27], v[96:99], v[32:35]
  v_lshrrev_b32 v2, 8, v0
  v_and_b32 v3, 0xf0, v0
  v_lshlrev_b32 v3, 1, v3
  v_lshl_add_u32 v3, v2, 4, v3
  s_lshl_b32 s26, s17, 9
  s_add_u32 s26, s26, 159744
  v_add_u32 v5, s26, v3
  s_mov_b32 exec_hi, 0
  ds_write_b128 v5, v[32:35]
  s_mov_b32 exec_hi, -1
  v_add_u32 v5, 159744, v1
  s_waitcnt lgkmcnt(0)
  s_barrier
  ds_read_b32 v36, v5 offset:0
  ds_read_b32 v37, v5 offset:256
  ds_read_b32 v38, v5 offset:512
  ds_read_b32 v39, v5 offset:768
  ds_read_b32 v40, v5 offset:1024
  ds_read_b32 v41, v5 offset:1280
  ds_read_b32 v42, v5 offset:1536
  ds_read_b32 v43, v5 offset:1792
  s_waitcnt lgkmcnt(0)
  v_add_f32 v36, v36, v38
  v_add_f32 v40, v40, v42
  v_add_f32 v36, v36, v40
  v_cvt_pk_bf16_f32 v36, 0, v36
  v_add_f32 v37, v37, v39
  v_add_f32 v41, v41, v43
  v_add_f32 v37, v37, v41
  v_cvt_pk_bf16_f32 v37, 0, v37
  v_mul_f32 v40, 0xbfb8aa3b, v36
  v_exp_f32 v40, v40
  s_nop 0
  v_add_f32 v40, 1.0, v40
  v_rcp_f32 v40, v40
  s_nop 0
  v_mul_f32 v36, v36, v40
  v_cvt_pk_bf16_f32 v36, 0, v36
  v_mul_f32 v36, v36, v37
  v_cvt_pk_bf16_f32 v36, v36, v36
  s_lshl_b32 s26, s17, 8
  s_add_u32 s26, s26, 161792
  v_add_u32 v5, s26, v1
  ds_write_b32 v5, v36
  v_mul_u32_u24 v5, 56, v2
  v_add_u32 v5, s26, v5
  ds_read_b64 v[36:37], v5 offset:0
  ds_read_b64 v[38:39], v5 offset:8
  ds_read_b64 v[40:41], v5 offset:16
  ds_read_b64 v[42:43], v5 offset:24
  ds_read_b64 v[44:45], v5 offset:32
  ds_read_b64 v[46:47], v5 offset:40
  ds_read_b64 v[48:49], v5 offset:48
  s_waitcnt lgkmcnt(0)
  v_and_b32 v20, v28, v36
  v_and_b32 v21, v29, v36
  v_and_b32 v22, v30, v36
  v_and_b32 v23, v31, v36
  s_waitcnt vmcnt(13)
  s_nop 0
  v_mfma_f32_16x16x32_bf16 v[32:35], v[20:23], v[100:103], 0
  v_and_b32 v24, v28, v37
  v_and_b32 v25, v29, v37
  v_and_b32 v26, v30, v37
  v_and_b32 v27, v31, v37
  s_waitcnt vmcnt(12)
  s_nop 0
  v_mfma_f32_16x16x32_bf16 v[32:35], v[24:27], v[104:107], v[32:35]
  v_and_b32 v20, v28, v38
  v_and_b32 v21, v29, v38
  v_and_b32 v22, v30, v38
  v_and_b32 v23, v31, v38
  s_waitcnt vmcnt(11)
  s_nop 0
  v_mfma_f32_16x16x32_bf16 v[32:35], v[20:23], v[108:111], v[32:35]
  v_and_b32 v24, v28, v39
  v_and_b32 v25, v29, v39
  v_and_b32 v26, v30, v39
  v_and_b32 v27, v31, v39
  s_waitcnt vmcnt(10)
  s_nop 0
  v_mfma_f32_16x16x32_bf16 v[32:35], v[24:27], v[112:115], v[32:35]
  v_and_b32 v20, v28, v40
  v_and_b32 v21, v29, v40
  v_and_b32 v22, v30, v40
  v_and_b32 v23, v31, v40
  s_waitcnt vmcnt(9)
  s_nop 0
  v_mfma_f32_16x16x32_bf16 v[32:35], v[20:23], v[60:63], v[32:35]
  v_and_b32 v24, v28, v41
  v_and_b32 v25, v29, v41
  v_and_b32 v26, v30, v41
  v_and_b32 v27, v31, v41
  s_waitcnt vmcnt(8)
  s_nop 0
  v_mfma_f32_16x16x32_bf16 v[32:35], v[24:27], v[52:55], v[32:35]
  v_and_b32 v20, v28, v42
  v_and_b32 v21, v29, v42
  v_and_b32 v22, v30, v42
  v_and_b32 v23, v31, v42
  s_waitcnt vmcnt(7)
  s_nop 0
  v_mfma_f32_16x16x32_bf16 v[32:35], v[20:23], v[56:59], v[32:35]
  v_and_b32 v24, v28, v43
  v_and_b32 v25, v29, v43
  v_and_b32 v26, v30, v43
  v_and_b32 v27, v31, v43
  s_waitcnt vmcnt(6)
  s_nop 0
  v_mfma_f32_16x16x32_bf16 v[32:35], v[24:27], v[64:67], v[32:35]
  v_and_b32 v20, v28, v44
  v_and_b32 v21, v29, v44
  v_and_b32 v22, v30, v44
  v_and_b32 v23, v31, v44
  s_waitcnt vmcnt(5)
  s_nop 0
  v_mfma_f32_16x16x32_bf16 v[32:35], v[20:23], v[68:71], v[32:35]
  v_and_b32 v24, v28, v45
  v_and_b32 v25, v29, v45
  v_and_b32 v26, v30, v45
  v_and_b32 v27, v31, v45
  s_waitcnt vmcnt(4)
  s_nop 0
  v_mfma_f32_16x16x32_bf16 v[32:35], v[24:27], v[72:75], v[32:35]
  v_and_b32 v20, v28, v46
  v_and_b32 v21, v29, v46
  v_and_b32 v22, v30, v46
  v_and_b32 v23, v31, v46
  s_waitcnt vmcnt(3)
  s_nop 0
  v_mfma_f32_16x16x32_bf16 v[32:35], v[20:23], v[76:79], v[32:35]
  v_and_b32 v24, v28, v47
  v_and_b32 v25, v29, v47
  v_and_b32 v26, v30, v47
  v_and_b32 v27, v31, v47
  s_waitcnt vmcnt(2)
  s_nop 0
  v_mfma_f32_16x16x32_bf16 v[32:35], v[24:27], v[80:83], v[32:35]
  v_and_b32 v20, v28, v48
  v_and_b32 v21, v29, v48
  v_and_b32 v22, v30, v48
  v_and_b32 v23, v31, v48
  s_waitcnt vmcnt(1)
  s_nop 0
  v_mfma_f32_16x16x32_bf16 v[32:35], v[20:23], v[84:87], v[32:35]
  v_and_b32 v24, v28, v49
  v_and_b32 v25, v29, v49
  v_and_b32 v26, v30, v49
  v_and_b32 v27, v31, v49
  s_waitcnt vmcnt(0)
  s_nop 0
  v_mfma_f32_16x16x32_bf16 v[32:35], v[24:27], v[88:91], v[32:35]
  v_lshrrev_b32 v3, 1, v3
  s_lshl_b32 s26, s47, 7
  s_add_u32 s26, s26, s57
  s_lshl_b32 s26, s26, 8
  s_add_u32 s26, s26, 244318208
  s_nop 2
  v_cvt_pk_bf16_f32 v32, v32, v33
  v_cvt_pk_bf16_f32 v33, v34, v35
  v_min_u32 v32, -2, v32
  v_min_u32 v33, -2, v33
  s_mov_b32 exec_hi, 0
  buffer_store_dwordx2 v[32:33], v3, s[4:7], s26 offen sc1
  s_mov_b32 exec_hi, -1
  v_lshrrev_b32 v7, 7, v0
  v_lshlrev_b32 v7, 12, v7
  v_and_b32 v2, 1023, v9
  s_lshl_b32 s26, s17, 10
  v_add3_u32 v7, v7, v2, s26
  v_mov_b32 v116, 0
  s_branch q_cold_65
q_patch_62:
  s_lshl_b32 s26, s61, 21
  s_lshl_b32 s27, s59, 10
  s_add_u32 s26, s26, s27
  s_add_u32 s27, s26, 20971520
  s_add_u32 s28, s26, 27262976
  s_lshl_b32 s26, s46, 7
  s_add_u32 s26, s26, s17
  s_lshl_b32 s26, s26, 8
  s_add_u32 s26, s26, 244318208
  v_lshrrev_b32 v2, 8, v0
  v_and_b32 v3, 0xf0, v0
  v_lshl_add_u32 v5, v2, 10, v3
  buffer_load_dwordx4 v[36:39], v0, s[4:7], s27 offen sc1
  buffer_load_dwordx4 v[40:43], v0, s[4:7], s28 offen sc1
  s_mov_b32 s53, 0
m_w_72:
  s_add_u32 s27, s26, 0
  buffer_load_dwordx4 v[60:63], v5, s[4:7], s27 offen sc1
  s_add_u32 s27, s26, 4096
  buffer_load_dwordx4 v[64:67], v5, s[4:7], s27 offen sc1
  s_add_u32 s27, s26, 8192
  buffer_load_dwordx4 v[68:71], v5, s[4:7], s27 offen sc1
  s_add_u32 s27, s26, 12288
  buffer_load_dwordx4 v[72:75], v5, s[4:7], s27 offen sc1
  s_add_u32 s27, s26, 16384
  buffer_load_dwordx4 v[76:79], v5, s[4:7], s27 offen sc1
  s_add_u32 s27, s26, 20480
  buffer_load_dwordx4 v[80:83], v5, s[4:7], s27 offen sc1
  s_add_u32 s27, s26, 24576
  buffer_load_dwordx4 v[84:87], v5, s[4:7], s27 offen sc1
  s_add_u32 s27, s26, 28672
  buffer_load_dwordx4 v[88:91], v5, s[4:7], s27 offen sc1
  s_add_u32 s53, s53, 1
  s_cmp_gt_u32 s53, 1048576
  s_cbranch_scc1 q_fail_61
  s_mov_b32 vcc_lo, 0xaaaaaaaa
  s_mov_b32 vcc_hi, 0xaaaaaaaa
  v_mov_b32 v28, 0x3f80
  v_mov_b32 v20, 1.0
  v_cndmask_b32 v28, v28, v20, vcc
  s_mov_b32 vcc_lo, 0x30003
  s_mov_b32 vcc_hi, 0x30003
  v_cndmask_b32 v20, 0, v28, vcc
  s_mov_b32 vcc_lo, 0xc000c
  s_mov_b32 vcc_hi, 0xc000c
  v_cndmask_b32 v21, 0, v28, vcc
  s_mov_b32 vcc_lo, 0x300030
  s_mov_b32 vcc_hi, 0x300030
  v_cndmask_b32 v22, 0, v28, vcc
  s_mov_b32 vcc_lo, 0xc000c0
  s_mov_b32 vcc_hi, 0xc000c0
  v_cndmask_b32 v23, 0, v28, vcc
  s_waitcnt vmcnt(7)
  s_nop 0
  v_mfma_f32_16x16x32_bf16 v[28:31], v[20:23], v[60:63], 0
  v_max3_u32 v44, v60, v61, 0
  v_max3_u32 v44, v62, v63, v44
  s_waitcnt vmcnt(6)
  v_mfma_f32_16x16x32_bf16 v[28:31], v[20:23], v[64:67], v[28:31]
  v_max3_u32 v44, v64, v65, v44
  v_max3_u32 v44, v66, v67, v44
  s_waitcnt vmcnt(5)
  v_mfma_f32_16x16x32_bf16 v[28:31], v[20:23], v[68:71], v[28:31]
  v_max3_u32 v44, v68, v69, v44
  v_max3_u32 v44, v70, v71, v44
  s_waitcnt vmcnt(4)
  v_mfma_f32_16x16x32_bf16 v[28:31], v[20:23], v[72:75], v[28:31]
  v_max3_u32 v44, v72, v73, v44
  v_max3_u32 v44, v74, v75, v44
  s_waitcnt vmcnt(3)
  v_mfma_f32_16x16x32_bf16 v[28:31], v[20:23], v[76:79], v[28:31]
  v_max3_u32 v44, v76, v77, v44
  v_max3_u32 v44, v78, v79, v44
  s_waitcnt vmcnt(2)
  v_mfma_f32_16x16x32_bf16 v[28:31], v[20:23], v[80:83], v[28:31]
  v_max3_u32 v44, v80, v81, v44
  v_max3_u32 v44, v82, v83, v44
  s_waitcnt vmcnt(1)
  v_mfma_f32_16x16x32_bf16 v[28:31], v[20:23], v[84:87], v[28:31]
  v_max3_u32 v44, v84, v85, v44
  v_max3_u32 v44, v86, v87, v44
  s_waitcnt vmcnt(0)
  v_mfma_f32_16x16x32_bf16 v[28:31], v[20:23], v[88:91], v[28:31]
  v_max3_u32 v44, v88, v89, v44
  v_max3_u32 v44, v90, v91, v44
  v_cmp_eq_u32 vcc, -1, v44
  s_cbranch_vccnz m_w_72
  v_lshlrev_b32 v3, 1, v3
  v_lshl_add_u32 v3, v2, 4, v3
  s_lshl_b32 s26, s17, 9
  s_add_u32 s26, s26, 159744
  v_add_u32 v3, s26, v3
  s_mov_b32 exec_hi, 0
  ds_write_b128 v3, v[28:31]
  s_mov_b32 exec_hi, -1
  v_lshlrev_b32 v3, 1, v0
  v_add_u32 v3, 159744, v3
  v_lshlrev_b32 v44, 16, v36
  v_and_b32 v45, 0xffff0000, v36
  v_lshlrev_b32 v46, 16, v37
  v_and_b32 v47, 0xffff0000, v37
  v_lshlrev_b32 v48, 16, v38
  v_and_b32 v49, 0xffff0000, v38
  v_lshlrev_b32 v50, 16, v39
  v_and_b32 v51, 0xffff0000, v39
  v_lshlrev_b32 v52, 16, v40
  v_and_b32 v53, 0xffff0000, v40
  v_lshlrev_b32 v54, 16, v41
  v_and_b32 v55, 0xffff0000, v41
  v_lshlrev_b32 v56, 16, v42
  v_and_b32 v57, 0xffff0000, v42
  v_lshlrev_b32 v58, 16, v43
  v_and_b32 v59, 0xffff0000, v43
  s_waitcnt lgkmcnt(0)
  s_barrier
  s_cmp_lg_u32 s17, 0
  s_cbranch_scc1 m_done_71
  ds_read_b128 v[28:31], v3
  ds_read_b128 v[32:35], v3 offset:16
  s_and_b32 s29, s58, 0xffff0000
  s_xor_b32 s27, s29, 0x80000000
  s_xor_b32 s28, s29, 0xffff0000
  s_bitcmp1_b32 s29, 31
  s_cselect_b32 s29, s27, s28
  v_mov_b32 v36, s29
  v_mul_f32 v36, 0xbfb8aa3b, v36
  v_exp_f32 v36, v36
  s_nop 0
  v_add_f32 v36, 1.0, v36
  v_rcp_f32 v36, v36
  s_nop 0
  v_cvt_pk_bf16_f32 v36, 0, v36
  s_waitcnt lgkmcnt(0)
  v_cvt_pk_bf16_f32 v28, 0, v28
  v_cvt_pk_bf16_f32 v29, 0, v29
  v_cvt_pk_bf16_f32 v30, 0, v30
  v_cvt_pk_bf16_f32 v31, 0, v31
  v_cvt_pk_bf16_f32 v32, 0, v32
  v_cvt_pk_bf16_f32 v33, 0, v33
  v_cvt_pk_bf16_f32 v34, 0, v34
  v_cvt_pk_bf16_f32 v35, 0, v35
  v_mul_f32 v28, v28, v36
  v_mul_f32 v29, v29, v36
  v_mul_f32 v30, v30, v36
  v_mul_f32 v31, v31, v36
  v_mul_f32 v32, v32, v36
  v_mul_f32 v33, v33, v36
  v_mul_f32 v34, v34, v36
  v_mul_f32 v35, v35, v36
  v_cvt_pk_bf16_f32 v28, 0, v28
  v_cvt_pk_bf16_f32 v29, 0, v29
  v_cvt_pk_bf16_f32 v30, 0, v30
  v_cvt_pk_bf16_f32 v31, 0, v31
  v_cvt_pk_bf16_f32 v32, 0, v32
  v_cvt_pk_bf16_f32 v33, 0, v33
  v_cvt_pk_bf16_f32 v34, 0, v34
  v_cvt_pk_bf16_f32 v35, 0, v35
  v_add_f32 v28, v28, v52
  v_add_f32 v29, v29, v53
  v_add_f32 v30, v30, v54
  v_add_f32 v31, v31, v55
  v_add_f32 v32, v32, v56
  v_add_f32 v33, v33, v57
  v_add_f32 v34, v34, v58
  v_add_f32 v35, v35, v59
  v_cvt_pk_bf16_f32 v28, 0, v28
  v_cvt_pk_bf16_f32 v29, 0, v29
  v_cvt_pk_bf16_f32 v30, 0, v30
  v_cvt_pk_bf16_f32 v31, 0, v31
  v_cvt_pk_bf16_f32 v32, 0, v32
  v_cvt_pk_bf16_f32 v33, 0, v33
  v_cvt_pk_bf16_f32 v34, 0, v34
  v_cvt_pk_bf16_f32 v35, 0, v35
  v_add_f32 v44, v44, v28
  v_add_f32 v45, v45, v29
  v_add_f32 v46, v46, v30
  v_add_f32 v47, v47, v31
  v_add_f32 v48, v48, v32
  v_add_f32 v49, v49, v33
  v_add_f32 v50, v50, v34
  v_add_f32 v51, v51, v35
  v_cvt_pk_bf16_f32 v40, v44, v45
  v_cvt_pk_bf16_f32 v41, v46, v47
  v_cvt_pk_bf16_f32 v42, v48, v49
  v_cvt_pk_bf16_f32 v43, v50, v51
  v_lshlrev_b32 v44, 16, v40
  v_and_b32 v45, 0xffff0000, v40
  v_lshlrev_b32 v46, 16, v41
  v_and_b32 v47, 0xffff0000, v41
  v_lshlrev_b32 v48, 16, v42
  v_and_b32 v49, 0xffff0000, v42
  v_lshlrev_b32 v50, 16, v43
  v_and_b32 v51, 0xffff0000, v43
  s_lshl_b32 s27, s46, 5
  s_add_u32 s27, s27, s16
  s_lshl_b32 s27, s27, 10
  s_add_u32 s27, s27, 33554432
  buffer_store_dwordx4 v[40:43], v0, s[4:7], s27 offen sc1
  v_add_f32 v60, v44, v45
  v_mul_f32 v61, v44, v44
  v_add_f32 v62, v46, v47
  v_mul_f32 v63, v45, v45
  v_fmac_f32 v61, v46, v46
  v_fmac_f32 v63, v47, v47
  v_add_f32 v60, v60, v48
  v_fmac_f32 v61, v48, v48
  v_add_f32 v62, v62, v49
  v_fmac_f32 v63, v49, v49
  v_add_f32 v60, v60, v50
  v_fmac_f32 v61, v50, v50
  v_add_f32 v62, v62, v51
  v_fmac_f32 v63, v51, v51
  v_add_f32 v60, v60, v62
  v_add_f32 v61, v61, v63
  s_nop 0
  v_add_f32_dpp v60, v60, v60 row_ror:8 row_mask:0xf bank_mask:0xf
  v_add_f32_dpp v61, v61, v61 row_ror:8 row_mask:0xf bank_mask:0xf
  s_nop 0
  v_add_f32_dpp v60, v60, v60 row_ror:4 row_mask:0xf bank_mask:0xf
  v_add_f32_dpp v61, v61, v61 row_ror:4 row_mask:0xf bank_mask:0xf
  s_nop 0
  v_add_f32_dpp v60, v60, v60 row_ror:2 row_mask:0xf bank_mask:0xf
  v_add_f32_dpp v61, v61, v61 row_ror:2 row_mask:0xf bank_mask:0xf
  s_nop 0
  v_add_f32_dpp v60, v60, v60 row_ror:1 row_mask:0xf bank_mask:0xf
  v_add_f32_dpp v61, v61, v61 row_ror:1 row_mask:0xf bank_mask:0xf
  v_mov_b32 v64, v60
  v_mov_b32 v65, v61
  s_nop 0
  v_permlane16_swap_b32 v60, v64
  v_permlane16_swap_b32 v61, v65
  v_add_f32 v60, v60, v64
  v_add_f32 v61, v61, v65
  v_mov_b32 v64, v60
  v_mov_b32 v65, v61
  s_nop 0
  v_permlane32_swap_b32 v60, v64
  v_permlane32_swap_b32 v61, v65
  v_add_f32 v60, v60, v64
  v_add_f32 v61, v61, v65
  v_mul_f32 v60, 0x3b000000, v60
  v_mul_f32 v61, 0x3b000000, v61
  v_fma_f32 v61, -v60, v60, v61
  v_cvt_pk_bf16_f32 v60, 0, v60
  v_max_f32 v61, 0, v61
  v_sub_f32 v64, v44, v60
  v_sub_f32 v65, v45, v60
  v_cvt_pk_bf16_f32 v61, 0, v61
  v_sub_f32 v66, v46, v60
  v_sub_f32 v67, v47, v60
  v_add_f32 v61, 0x3727c5ac, v61
  v_sub_f32 v68, v48, v60
  v_sub_f32 v69, v49, v60
  v_cvt_pk_bf16_f32 v61, 0, v61
  v_sub_f32 v70, v50, v60
  v_sub_f32 v71, v51, v60
  v_sqrt_f32 v61, v61
  v_cvt_pk_bf16_f32 v64, 0, v64
  v_cvt_pk_bf16_f32 v65, 0, v65
  v_cvt_pk_bf16_f32 v61, 0, v61
  v_cvt_pk_bf16_f32 v66, 0, v66
  v_cvt_pk_bf16_f32 v67, 0, v67
  v_rcp_f32 v61, v61
  v_cvt_pk_bf16_f32 v68, 0, v68
  v_cvt_pk_bf16_f32 v69, 0, v69
  v_cvt_pk_bf16_f32 v70, 0, v70
  v_cvt_pk_bf16_f32 v71, 0, v71
  v_mul_f32 v64, v64, v61
  v_mul_f32 v65, v65, v61
  v_mul_f32 v66, v66, v61
  v_mul_f32 v67, v67, v61
  v_mul_f32 v68, v68, v61
  v_mul_f32 v69, v69, v61
  v_mul_f32 v70, v70, v61
  v_mul_f32 v71, v71, v61
  v_cvt_pk_bf16_f32 v72, v64, v65
  v_cvt_pk_bf16_f32 v73, v66, v67
  v_cvt_pk_bf16_f32 v74, v68, v69
  v_cvt_pk_bf16_f32 v75, v70, v71
  s_and_b32 s26, s59, 31
  s_lshl_b32 s27, s26, 10
  s_add_u32 s27, s27, s50
  s_and_b32 s26, s26, 15
  s_lshl_b32 s26, s26, 4
  s_or_b32 s26, s26, s27
  v_xor_b32 v3, s26, v0
  ds_write_b128 v3, v[72:75]
m_done_71:
  s_mov_b32 s62, 0
  s_mov_b32 s40, s47
  s_add_u32 s47, s46, 64
  s_sub_u32 s26, s76, 55
  s_cmp_lt_u32 s40, 64
  s_cselect_b32 s26, s26, 255
  s_cmp_ge_u32 s40, s26
  s_cbranch_scc1 q_cold_65
  s_mov_b32 s76, s40
  s_mov_b32 s40, s77
  s_mov_b32 s41, s78
  s_mov_b32 s42, s79
  s_branch q_cold_65
q_end_58:
  s_waitcnt vmcnt(0)
  s_mov_b64 exec, 1
  buffer_store_dword v4, off, s[4:7], s49 sc1
  s_mov_b64 exec, -1
  s_cmp_lg_u32 s60, 0
  s_cbranch_scc1 q_fail_61
  s_load_dwordx2 s[72:73], s[0:1], 96
  s_mov_b32 s74, 2097152
  s_mov_b32 s75, 0x20000
  s_load_dwordx2 s[64:65], s[0:1], 72
  s_load_dwordx2 s[68:69], s[0:1], 80
  s_load_dwordx2 s[8:9], s[0:1], 88
  s_mov_b32 s66, 1835008
  s_mov_b32 s70, 1835008
  s_mov_b32 s10, 1835008
  v_lshrrev_b32 v2, 8, v0
  v_and_b32 v3, 0x70, v0
  s_mov_b32 s26, 114688
  v_mul_lo_u32 v6, v2, s26
  v_add_u32 v6, v6, v3
  v_cmp_eq_u32 vcc, 0x70, v3
  v_mov_b32 v3, 0x7ff00000
  s_nop 0
  v_cndmask_b32 v6, v6, v3, vcc
  v_mul_u32_u24 v7, 14336, v2
  v_and_b32 v3, 0xf0, v0
  v_add_u32 v7, v7, v3
  s_mul_i32 s34, s17, 458752
  s_mul_i32 s27, s16, 112
  s_add_u32 s34, s34, s27
  s_add_u32 s34, s34, 82432
  s_mul_i32 s35, s16, 57344
  s_lshl_b32 s27, s17, 8
  s_add_u32 s35, s35, s27
  s_mov_b32 s36, 0x00ff00ff
  s_mov_b32 s37, 0x00ff00ff
  s_waitcnt lgkmcnt(0)
  s_mov_b64 exec, s[36:37]
  buffer_load_dwordx4 a[0:3], v6, s[64:67], s34 offen
  s_not_b64 exec, exec
  buffer_load_dwordx4 a[0:3], v6, s[68:71], s34 offen
  s_mov_b64 exec, -1
  s_add_u32 s34, s34, 3584
  s_mov_b64 exec, s[36:37]
  buffer_load_dwordx4 a[4:7], v6, s[64:67], s34 offen
  s_not_b64 exec, exec
  buffer_load_dwordx4 a[4:7], v6, s[68:71], s34 offen
  s_mov_b64 exec, -1
  s_add_u32 s34, s34, 3584
  s_mov_b64 exec, s[36:37]
  buffer_load_dwordx4 a[8:11], v6, s[64:67], s34 offen
  s_not_b64 exec, exec
  buffer_load_dwordx4 a[8:11], v6, s[68:71], s34 offen
  s_mov_b64 exec, -1
  s_add_u32 s34, s34, 3584
  s_mov_b64 exec, s[36:37]
  buffer_load_dwordx4 a[12:15], v6, s[64:67], s34 offen
  s_not_b64 exec, exec
  buffer_load_dwordx4 a[12:15], v6, s[68:71], s34 offen
  s_mov_b64 exec, -1
  s_add_u32 s34, s34, 3584
  s_mov_b64 exec, s[36:37]
  buffer_load_dwordx4 a[16:19], v6, s[64:67], s34 offen
  s_not_b64 exec, exec
  buffer_load_dwordx4 a[16:19], v6, s[68:71], s34 offen
  s_mov_b64 exec, -1
  s_add_u32 s34, s34, 3584
  s_mov_b64 exec, s[36:37]
  buffer_load_dwordx4 a[20:23], v6, s[64:67], s34 offen
  s_not_b64 exec, exec
  buffer_load_dwordx4 a[20:23], v6, s[68:71], s34 offen
  s_mov_b64 exec, -1
  s_add_u32 s34, s34, 3584
  s_mov_b64 exec, s[36:37]
  buffer_load_dwordx4 a[24:27], v6, s[64:67], s34 offen
  s_not_b64 exec, exec
  buffer_load_dwordx4 a[24:27], v6, s[68:71], s34 offen
  s_mov_b64 exec, -1
  s_add_u32 s34, s34, 3584
  s_mov_b64 exec, s[36:37]
  buffer_load_dwordx4 a[28:31], v6, s[64:67], s34 offen
  s_not_b64 exec, exec
  buffer_load_dwordx4 a[28:31], v6, s[68:71], s34 offen
  s_mov_b64 exec, -1
  s_add_u32 s34, s34, 3584
  s_mov_b64 exec, s[36:37]
  buffer_load_dwordx4 a[32:35], v6, s[64:67], s34 offen
  s_not_b64 exec, exec
  buffer_load_dwordx4 a[32:35], v6, s[68:71], s34 offen
  s_mov_b64 exec, -1
  s_add_u32 s34, s34, 3584
  buffer_load_dwordx4 a[36:39], v7, s[8:11], s35 offen offset:0
  buffer_load_dwordx4 a[40:43], v7, s[8:11], s35 offen offset:1024
  buffer_load_dwordx4 a[44:47], v7, s[8:11], s35 offen offset:2048
  buffer_load_dwordx4 a[48:51], v7, s[8:11], s35 offen offset:3072
  s_add_u32 s35, s35, 4096
  buffer_load_dwordx4 a[52:55], v7, s[8:11], s35 offen offset:0
  buffer_load_dwordx4 a[56:59], v7, s[8:11], s35 offen offset:1024
  buffer_load_dwordx4 a[60:63], v7, s[8:11], s35 offen offset:2048
  buffer_load_dwordx4 a[64:67], v7, s[8:11], s35 offen offset:3072
  s_add_u32 s35, s35, 4096
  buffer_load_dwordx4 a[68:71], v7, s[8:11], s35 offen offset:0
  buffer_load_dwordx4 a[72:75], v7, s[8:11], s35 offen offset:1024
  buffer_load_dwordx4 a[76:79], v7, s[8:11], s35 offen offset:2048
  buffer_load_dwordx4 a[80:83], v7, s[8:11], s35 offen offset:3072
  s_add_u32 s35, s35, 4096
  buffer_load_dwordx4 a[84:87], v7, s[8:11], s35 offen offset:0
  buffer_load_dwordx4 a[88:91], v7, s[8:11], s35 offen offset:1024
  s_andn2_b32 s28, 0xfe0, s56
  s_lshl_b32 s28, s28, 7
  s_mov_b32 s29, 243793920
  v_mov_b32 v24, 262144
  s_mov_b32 s53, 0
  s_mov_b32 s26, 0
  v_mov_b32 v53, 0
k_w_74:
  s_add_u32 s27, s26, 8192
  v_add_u32 v22, s26, v9
  v_cmp_le_u32 vcc, s28, v22
  s_nop 1
  v_cndmask_b32 v25, 0, v24, vcc
  v_add_u32 v22, v22, v25
  buffer_load_dword v20, v22, s[4:7], s29 offen sc1
  v_add_u32 v23, s27, v9
  v_cmp_le_u32 vcc, s28, v23
  s_nop 1
  v_cndmask_b32 v25, 0, v24, vcc
  v_add_u32 v23, v23, v25
  buffer_load_dword v21, v23, s[4:7], s29 offen sc1
  s_add_u32 s53, s53, 1
  s_cmp_gt_u32 s53, 1048576
  s_cbranch_scc1 q_fail_61
  s_waitcnt vmcnt(0)
  v_min_u32 v52, v20, v21
  v_max3_u32 v53, v20, v21, v53
  v_cmp_eq_u32 vcc, 0, v52
  s_cbranch_vccnz k_w_74
  s_add_u32 s26, s26, 16384
  s_cmp_lt_u32 s26, 262144
  s_cbranch_scc1 k_w_74
  v_max_u32_dpp v53, v53, v53 row_ror:8 row_mask:0xf bank_mask:0xf
  s_nop 1
  v_max_u32_dpp v53, v53, v53 row_ror:4 row_mask:0xf bank_mask:0xf
  s_nop 1
  v_max_u32_dpp v53, v53, v53 row_ror:2 row_mask:0xf bank_mask:0xf
  s_nop 1
  v_max_u32_dpp v53, v53, v53 row_ror:1 row_mask:0xf bank_mask:0xf
  v_mov_b32 v52, v53
  s_nop 0
  s_nop 0
  v_permlane16_swap_b32 v53, v52
  v_max_u32 v53, v53, v52
  v_mov_b32 v52, v53
  s_nop 0
  s_nop 0
  v_permlane32_swap_b32 v53, v52
  v_max_u32 v53, v53, v52
  s_nop 0
  v_readfirstlane_b32 s58, v53
  s_andn2_b32 s26, 0xfe0, s56
  s_andn2_b32 s27, 0xfe0, s58
  s_cmp_lt_u32 s27, s26
  s_cselect_b32 s61, 1, 2
  s_andn2_b32 s59, 0xfff, s58
  s_lshl_b32 s26, s61, 21
  s_lshl_b32 s27, s59, 10
  s_add_u32 s26, s26, s27
  s_lshl_b32 s27, s17, 8
  s_add_u32 s26, s26, s27
  s_add_u32 s26, s26, 27262976
  v_lshrrev_b32 v3, 8, v0
  v_lshlrev_b32 v3, 6, v3
  buffer_load_dwordx4 v[36:39], v3, s[4:7], s26 offen offset:0 sc1
  buffer_load_dwordx4 v[40:43], v3, s[4:7], s26 offen offset:16 sc1
  buffer_load_dwordx4 v[44:47], v3, s[4:7], s26 offen offset:32 sc1
  buffer_load_dwordx4 v[48:51], v3, s[4:7], s26 offen offset:48 sc1
  s_mov_b32 vcc_lo, 0xaaaaaaaa
  s_mov_b32 vcc_hi, 0xaaaaaaaa
  v_mov_b32 v3, 0xffff
  v_mov_b32 v28, 0xffff0000
  v_cndmask_b32 v3, v3, v28, vcc
  s_mov_b32 vcc_lo, 0x30003
  s_mov_b32 vcc_hi, 0x30003
  v_cndmask_b32 v28, 0, v3, vcc
  s_mov_b32 vcc_lo, 0xc000c
  s_mov_b32 vcc_hi, 0xc000c
  v_cndmask_b32 v29, 0, v3, vcc
  s_mov_b32 vcc_lo, 0x300030
  s_mov_b32 vcc_hi, 0x300030
  v_cndmask_b32 v30, 0, v3, vcc
  s_mov_b32 vcc_lo, 0xc000c0
  s_mov_b32 vcc_hi, 0xc000c0
  v_cndmask_b32 v31, 0, v3, vcc
  s_mov_b32 s30, 0x01000100
  s_mov_b32 s31, 0x03020302
  s_mul_i32 s26, s17, 23552
  s_add_u32 s26, s26, 65536
  v_add_u32 v5, s26, v0
  ds_read_b128 v[52:55], v5 offset:0
  ds_read_b128 v[56:59], v5 offset:1024
  ds_read_b128 v[60:63], v5 offset:2048
  s_waitcnt vmcnt(0)
  v_perm_b32 v3, v36, v36, s30
  v_and_b32 v20, v28, v3
  v_and_b32 v21, v29, v3
  v_and_b32 v22, v30, v3
  v_and_b32 v23, v31, v3
  s_waitcnt lgkmcnt(2)
  s_nop 0
  v_mfma_f32_16x16x32_bf16 v[32:35], v[20:23], v[52:55], 0
  ds_read_b128 v[52:55], v5 offset:3072
  v_perm_b32 v3, v36, v36, s31
  v_and_b32 v24, v28, v3
  v_and_b32 v25, v29, v3
  v_and_b32 v26, v30, v3
  v_and_b32 v27, v31, v3
  s_waitcnt lgkmcnt(2)
  s_nop 0
  v_mfma_f32_16x16x32_bf16 v[32:35], v[24:27], v[56:59], v[32:35]
  ds_read_b128 v[56:59], v5 offset:4096
  v_perm_b32 v3, v37, v37, s30
  v_and_b32 v20, v28, v3
  v_and_b32 v21, v29, v3
  v_and_b32 v22, v30, v3
  v_and_b32 v23, v31, v3
  s_waitcnt lgkmcnt(2)
  s_nop 0
  v_mfma_f32_16x16x32_bf16 v[32:35], v[20:23], v[60:63], v[32:35]
  ds_read_b128 v[60:63], v5 offset:5120
  v_perm_b32 v3, v37, v37, s31
  v_and_b32 v24, v28, v3
  v_and_b32 v25, v29, v3
  v_and_b32 v26, v30, v3
  v_and_b32 v27, v31, v3
  s_waitcnt lgkmcnt(2)
  s_nop 0
  v_mfma_f32_16x16x32_bf16 v[32:35], v[24:27], v[52:55], v[32:35]
  ds_read_b128 v[52:55], v5 offset:6144
  v_perm_b32 v3, v38, v38, s30
  v_and_b32 v20, v28, v3
  v_and_b32 v21, v29, v3
  v_and_b32 v22, v30, v3
  v_and_b32 v23, v31, v3
  s_waitcnt lgkmcnt(2)
  s_nop 0
  v_mfma_f32_16x16x32_bf16 v[32:35], v[20:23], v[56:59], v[32:35]
  ds_read_b128 v[56:59], v5 offset:7168
  v_perm_b32 v3, v38, v38, s31
  v_and_b32 v24, v28, v3
  v_and_b32 v25, v29, v3
  v_and_b32 v26, v30, v3
  v_and_b32 v27, v31, v3
  s_waitcnt lgkmcnt(2)
  s_nop 0
  v_mfma_f32_16x16x32_bf16 v[32:35], v[24:27], v[60:63], v[32:35]
  ds_read_b128 v[60:63], v5 offset:8192
  v_perm_b32 v3, v39, v39, s30
  v_and_b32 v20, v28, v3
  v_and_b32 v21, v29, v3
  v_and_b32 v22, v30, v3
  v_and_b32 v23, v31, v3
  s_waitcnt lgkmcnt(2)
  s_nop 0
  v_mfma_f32_16x16x32_bf16 v[32:35], v[20:23], v[52:55], v[32:35]
  ds_read_b128 v[52:55], v5 offset:9216
  v_perm_b32 v3, v39, v39, s31
  v_and_b32 v24, v28, v3
  v_and_b32 v25, v29, v3
  v_and_b32 v26, v30, v3
  v_and_b32 v27, v31, v3
  s_waitcnt lgkmcnt(2)
  s_nop 0
  v_mfma_f32_16x16x32_bf16 v[32:35], v[24:27], v[56:59], v[32:35]
  ds_read_b128 v[56:59], v5 offset:10240
  v_perm_b32 v3, v40, v40, s30
  v_and_b32 v20, v28, v3
  v_and_b32 v21, v29, v3
  v_and_b32 v22, v30, v3
  v_and_b32 v23, v31, v3
  s_waitcnt lgkmcnt(2)
  s_nop 0
  v_mfma_f32_16x16x32_bf16 v[32:35], v[20:23], v[60:63], v[32:35]
  ds_read_b128 v[60:63], v5 offset:11264
  v_perm_b32 v3, v40, v40, s31
  v_and_b32 v24, v28, v3
  v_and_b32 v25, v29, v3
  v_and_b32 v26, v30, v3
  v_and_b32 v27, v31, v3
  s_waitcnt lgkmcnt(2)
  s_nop 0
  v_mfma_f32_16x16x32_bf16 v[32:35], v[24:27], v[52:55], v[32:35]
  ds_read_b128 v[52:55], v5 offset:12288
  v_perm_b32 v3, v41, v41, s30
  v_and_b32 v20, v28, v3
  v_and_b32 v21, v29, v3
  v_and_b32 v22, v30, v3
  v_and_b32 v23, v31, v3
  s_waitcnt lgkmcnt(2)
  s_nop 0
  v_mfma_f32_16x16x32_bf16 v[32:35], v[20:23], v[56:59], v[32:35]
  ds_read_b128 v[56:59], v5 offset:13312
  v_perm_b32 v3, v41, v41, s31
  v_and_b32 v24, v28, v3
  v_and_b32 v25, v29, v3
  v_and_b32 v26, v30, v3
  v_and_b32 v27, v31, v3
  s_waitcnt lgkmcnt(2)
  s_nop 0
  v_mfma_f32_16x16x32_bf16 v[32:35], v[24:27], v[60:63], v[32:35]
  ds_read_b128 v[60:63], v5 offset:14336
  v_perm_b32 v3, v42, v42, s30
  v_and_b32 v20, v28, v3
  v_and_b32 v21, v29, v3
  v_and_b32 v22, v30, v3
  v_and_b32 v23, v31, v3
  s_waitcnt lgkmcnt(2)
  s_nop 0
  v_mfma_f32_16x16x32_bf16 v[32:35], v[20:23], v[52:55], v[32:35]
  ds_read_b128 v[52:55], v5 offset:15360
  v_perm_b32 v3, v42, v42, s31
  v_and_b32 v24, v28, v3
  v_and_b32 v25, v29, v3
  v_and_b32 v26, v30, v3
  v_and_b32 v27, v31, v3
  s_waitcnt lgkmcnt(2)
  s_nop 0
  v_mfma_f32_16x16x32_bf16 v[32:35], v[24:27], v[56:59], v[32:35]
  ds_read_b128 v[56:59], v5 offset:16384
  v_perm_b32 v3, v43, v43, s30
  v_and_b32 v20, v28, v3
  v_and_b32 v21, v29, v3
  v_and_b32 v22, v30, v3
  v_and_b32 v23, v31, v3
  s_waitcnt lgkmcnt(2)
  s_nop 0
  v_mfma_f32_16x16x32_bf16 v[32:35], v[20:23], v[60:63], v[32:35]
  ds_read_b128 v[60:63], v5 offset:17408
  v_perm_b32 v3, v43, v43, s31
  v_and_b32 v24, v28, v3
  v_and_b32 v25, v29, v3
  v_and_b32 v26, v30, v3
  v_and_b32 v27, v31, v3
  s_waitcnt lgkmcnt(2)
  s_nop 0
  v_mfma_f32_16x16x32_bf16 v[32:35], v[24:27], v[52:55], v[32:35]
  ds_read_b128 v[52:55], v5 offset:18432
  v_perm_b32 v3, v44, v44, s30
  v_and_b32 v20, v28, v3
  v_and_b32 v21, v29, v3
  v_and_b32 v22, v30, v3
  v_and_b32 v23, v31, v3
  s_waitcnt lgkmcnt(2)
  s_nop 0
  v_mfma_f32_16x16x32_bf16 v[32:35], v[20:23], v[56:59], v[32:35]
  ds_read_b128 v[56:59], v5 offset:19456
  v_perm_b32 v3, v44, v44, s31
  v_and_b32 v24, v28, v3
  v_and_b32 v25, v29, v3
  v_and_b32 v26, v30, v3
  v_and_b32 v27, v31, v3
  s_waitcnt lgkmcnt(2)
  s_nop 0
  v_mfma_f32_16x16x32_bf16 v[32:35], v[24:27], v[60:63], v[32:35]
  ds_read_b128 v[60:63], v5 offset:20480
  v_perm_b32 v3, v45, v45, s30
  v_and_b32 v20, v28, v3
  v_and_b32 v21, v29, v3
  v_and_b32 v22, v30, v3
  v_and_b32 v23, v31, v3
  s_waitcnt lgkmcnt(2)
  s_nop 0
  v_mfma_f32_16x16x32_bf16 v[32:35], v[20:23], v[52:55], v[32:35]
  ds_read_b128 v[52:55], v5 offset:21504
  v_perm_b32 v3, v45, v45, s31
  v_and_b32 v24, v28, v3
  v_and_b32 v25, v29, v3
  v_and_b32 v26, v30, v3
  v_and_b32 v27, v31, v3
  s_waitcnt lgkmcnt(2)
  s_nop 0
  v_mfma_f32_16x16x32_bf16 v[32:35], v[24:27], v[56:59], v[32:35]
  ds_read_b128 v[56:59], v5 offset:22528
  v_perm_b32 v3, v46, v46, s30
  v_and_b32 v20, v28, v3
  v_and_b32 v21, v29, v3
  v_and_b32 v22, v30, v3
  v_and_b32 v23, v31, v3
  s_waitcnt lgkmcnt(2)
  s_nop 0
  v_mfma_f32_16x16x32_bf16 v[32:35], v[20:23], v[60:63], v[32:35]
  v_perm_b32 v3, v46, v46, s31
  v_and_b32 v24, v28, v3
  v_and_b32 v25, v29, v3
  v_and_b32 v26, v30, v3
  v_and_b32 v27, v31, v3
  s_waitcnt lgkmcnt(1)
  s_nop 0
  v_mfma_f32_16x16x32_bf16 v[32:35], v[24:27], v[52:55], v[32:35]
  v_perm_b32 v3, v47, v47, s30
  v_and_b32 v20, v28, v3
  v_and_b32 v21, v29, v3
  v_and_b32 v22, v30, v3
  v_and_b32 v23, v31, v3
  s_waitcnt lgkmcnt(0)
  s_nop 0
  v_mfma_f32_16x16x32_bf16 v[32:35], v[20:23], v[56:59], v[32:35]
  v_perm_b32 v3, v47, v47, s31
  v_and_b32 v24, v28, v3
  v_and_b32 v25, v29, v3
  v_and_b32 v26, v30, v3
  v_and_b32 v27, v31, v3
  s_nop 0
  s_nop 0
  v_mfma_f32_16x16x32_bf16 v[32:35], v[24:27], a[0:3], v[32:35]
  v_perm_b32 v3, v48, v48, s30
  v_and_b32 v20, v28, v3
  v_and_b32 v21, v29, v3
  v_and_b32 v22, v30, v3
  v_and_b32 v23, v31, v3
  s_nop 0
  s_nop 0
  v_mfma_f32_16x16x32_bf16 v[32:35], v[20:23], a[4:7], v[32:35]
  v_perm_b32 v3, v48, v48, s31
  v_and_b32 v24, v28, v3
  v_and_b32 v25, v29, v3
  v_and_b32 v26, v30, v3
  v_and_b32 v27, v31, v3
  s_nop 0
  s_nop 0
  v_mfma_f32_16x16x32_bf16 v[32:35], v[24:27], a[8:11], v[32:35]
  v_perm_b32 v3, v49, v49, s30
  v_and_b32 v20, v28, v3
  v_and_b32 v21, v29, v3
  v_and_b32 v22, v30, v3
  v_and_b32 v23, v31, v3
  s_nop 0
  s_nop 0
  v_mfma_f32_16x16x32_bf16 v[32:35], v[20:23], a[12:15], v[32:35]
  v_perm_b32 v3, v49, v49, s31
  v_and_b32 v24, v28, v3
  v_and_b32 v25, v29, v3
  v_and_b32 v26, v30, v3
  v_and_b32 v27, v31, v3
  s_nop 0
  s_nop 0
  v_mfma_f32_16x16x32_bf16 v[32:35], v[24:27], a[16:19], v[32:35]
  v_perm_b32 v3, v50, v50, s30
  v_and_b32 v20, v28, v3
  v_and_b32 v21, v29, v3
  v_and_b32 v22, v30, v3
  v_and_b32 v23, v31, v3
  s_nop 0
  s_nop 0
  v_mfma_f32_16x16x32_bf16 v[32:35], v[20:23], a[20:23], v[32:35]
  v_perm_b32 v3, v50, v50, s31
  v_and_b32 v24, v28, v3
  v_and_b32 v25, v29, v3
  v_and_b32 v26, v30, v3
  v_and_b32 v27, v31, v3
  s_nop 0
  s_nop 0
  v_mfma_f32_16x16x32_bf16 v[32:35], v[24:27], a[24:27], v[32:35]
  v_perm_b32 v3, v51, v51, s30
  v_and_b32 v20, v28, v3
  v_and_b32 v21, v29, v3
  v_and_b32 v22, v30, v3
  v_and_b32 v23, v31, v3
  s_nop 0
  s_nop 0
  v_mfma_f32_16x16x32_bf16 v[32:35], v[20:23], a[28:31], v[32:35]
  v_perm_b32 v3, v51, v51, s31
  v_and_b32 v24, v28, v3
  v_and_b32 v25, v29, v3
  v_and_b32 v26, v30, v3
  v_and_b32 v27, v31, v3
  s_nop 0
  s_nop 0
  v_mfma_f32_16x16x32_bf16 v[32:35], v[24:27], a[32:35], v[32:35]
  v_lshrrev_b32 v2, 8, v0
  v_and_b32 v3, 0xf0, v0
  v_lshlrev_b32 v3, 1, v3
  v_lshl_add_u32 v3, v2, 4, v3
  s_lshl_b32 s26, s17, 9
  s_add_u32 s26, s26, 159744
  v_add_u32 v5, s26, v3
  s_mov_b32 exec_hi, 0
  ds_write_b128 v5, v[32:35]
  s_mov_b32 exec_hi, -1
  v_add_u32 v5, 159744, v1
  s_waitcnt lgkmcnt(0)
  s_barrier
  ds_read_b32 v36, v5 offset:0
  ds_read_b32 v37, v5 offset:256
  ds_read_b32 v38, v5 offset:512
  ds_read_b32 v39, v5 offset:768
  ds_read_b32 v40, v5 offset:1024
  ds_read_b32 v41, v5 offset:1280
  ds_read_b32 v42, v5 offset:1536
  ds_read_b32 v43, v5 offset:1792
  s_waitcnt lgkmcnt(0)
  v_add_f32 v36, v36, v38
  v_add_f32 v40, v40, v42
  v_add_f32 v36, v36, v40
  v_cvt_pk_bf16_f32 v36, 0, v36
  v_add_f32 v37, v37, v39
  v_add_f32 v41, v41, v43
  v_add_f32 v37, v37, v41
  v_cvt_pk_bf16_f32 v37, 0, v37
  v_mul_f32 v40, 0xbfb8aa3b, v36
  v_exp_f32 v40, v40
  s_nop 0
  v_add_f32 v40, 1.0, v40
  v_rcp_f32 v40, v40
  s_nop 0
  v_mul_f32 v36, v36, v40
  v_cvt_pk_bf16_f32 v36, 0, v36
  v_mul_f32 v36, v36, v37
  v_cvt_pk_bf16_f32 v36, v36, v36
  s_lshl_b32 s26, s17, 8
  s_add_u32 s26, s26, 161792
  v_add_u32 v5, s26, v1
  ds_write_b32 v5, v36
  v_mul_u32_u24 v5, 56, v2
  v_add_u32 v5, s26, v5
  ds_read_b64 v[36:37], v5 offset:0
  ds_read_b64 v[38:39], v5 offset:8
  ds_read_b64 v[40:41], v5 offset:16
  ds_read_b64 v[42:43], v5 offset:24
  ds_read_b64 v[44:45], v5 offset:32
  ds_read_b64 v[46:47], v5 offset:40
  ds_read_b64 v[48:49], v5 offset:48
  s_waitcnt lgkmcnt(0)
  v_and_b32 v20, v28, v36
  v_and_b32 v21, v29, v36
  v_and_b32 v22, v30, v36
  v_and_b32 v23, v31, v36
  s_nop 0
  s_nop 0
  v_mfma_f32_16x16x32_bf16 v[32:35], v[20:23], a[36:39], 0
  v_and_b32 v24, v28, v37
  v_and_b32 v25, v29, v37
  v_and_b32 v26, v30, v37
  v_and_b32 v27, v31, v37
  s_nop 0
  s_nop 0
  v_mfma_f32_16x16x32_bf16 v[32:35], v[24:27], a[40:43], v[32:35]
  v_and_b32 v20, v28, v38
  v_and_b32 v21, v29, v38
  v_and_b32 v22, v30, v38
  v_and_b32 v23, v31, v38
  s_nop 0
  s_nop 0
  v_mfma_f32_16x16x32_bf16 v[32:35], v[20:23], a[44:47], v[32:35]
  v_and_b32 v24, v28, v39
  v_and_b32 v25, v29, v39
  v_and_b32 v26, v30, v39
  v_and_b32 v27, v31, v39
  s_nop 0
  s_nop 0
  v_mfma_f32_16x16x32_bf16 v[32:35], v[24:27], a[48:51], v[32:35]
  v_and_b32 v20, v28, v40
  v_and_b32 v21, v29, v40
  v_and_b32 v22, v30, v40
  v_and_b32 v23, v31, v40
  s_nop 0
  s_nop 0
  v_mfma_f32_16x16x32_bf16 v[32:35], v[20:23], a[52:55], v[32:35]
  v_and_b32 v24, v28, v41
  v_and_b32 v25, v29, v41
  v_and_b32 v26, v30, v41
  v_and_b32 v27, v31, v41
  s_nop 0
  s_nop 0
  v_mfma_f32_16x16x32_bf16 v[32:35], v[24:27], a[56:59], v[32:35]
  v_and_b32 v20, v28, v42
  v_and_b32 v21, v29, v42
  v_and_b32 v22, v30, v42
  v_and_b32 v23, v31, v42
  s_nop 0
  s_nop 0
  v_mfma_f32_16x16x32_bf16 v[32:35], v[20:23], a[60:63], v[32:35]
  v_and_b32 v24, v28, v43
  v_and_b32 v25, v29, v43
  v_and_b32 v26, v30, v43
  v_and_b32 v27, v31, v43
  s_nop 0
  s_nop 0
  v_mfma_f32_16x16x32_bf16 v[32:35], v[24:27], a[64:67], v[32:35]
  v_and_b32 v20, v28, v44
  v_and_b32 v21, v29, v44
  v_and_b32 v22, v30, v44
  v_and_b32 v23, v31, v44
  s_nop 0
  s_nop 0
  v_mfma_f32_16x16x32_bf16 v[32:35], v[20:23], a[68:71], v[32:35]
  v_and_b32 v24, v28, v45
  v_and_b32 v25, v29, v45
  v_and_b32 v26, v30, v45
  v_and_b32 v27, v31, v45
  s_nop 0
  s_nop 0
  v_mfma_f32_16x16x32_bf16 v[32:35], v[24:27], a[72:75], v[32:35]
  v_and_b32 v20, v28, v46
  v_and_b32 v21, v29, v46
  v_and_b32 v22, v30, v46
  v_and_b32 v23, v31, v46
  s_nop 0
  s_nop 0
  v_mfma_f32_16x16x32_bf16 v[32:35], v[20:23], a[76:79], v[32:35]
  v_and_b32 v24, v28, v47
  v_and_b32 v25, v29, v47
  v_and_b32 v26, v30, v47
  v_and_b32 v27, v31, v47
  s_nop 0
  s_nop 0
  v_mfma_f32_16x16x32_bf16 v[32:35], v[24:27], a[80:83], v[32:35]
  v_and_b32 v20, v28, v48
  v_and_b32 v21, v29, v48
  v_and_b32 v22, v30, v48
  v_and_b32 v23, v31, v48
  s_nop 0
  s_nop 0
  v_mfma_f32_16x16x32_bf16 v[32:35], v[20:23], a[84:87], v[32:35]
  v_and_b32 v24, v28, v49
  v_and_b32 v25, v29, v49
  v_and_b32 v26, v30, v49
  v_and_b32 v27, v31, v49
  s_nop 0
  s_nop 0
  v_mfma_f32_16x16x32_bf16 v[32:35], v[24:27], a[88:91], v[32:35]
  v_lshrrev_b32 v3, 1, v3
  s_lshl_b32 s26, s47, 7
  s_add_u32 s26, s26, s57
  s_lshl_b32 s26, s26, 8
  s_add_u32 s26, s26, 244318208
  s_nop 2
  v_cvt_pk_bf16_f32 v32, v32, v33
  v_cvt_pk_bf16_f32 v33, v34, v35
  v_min_u32 v32, -2, v32
  v_min_u32 v33, -2, v33
  s_mov_b32 exec_hi, 0
  buffer_store_dwordx2 v[32:33], v3, s[4:7], s26 offen sc1
  s_mov_b32 exec_hi, -1
  s_cmp_lg_u32 s16, 0
  s_cbranch_scc1 q_fail_61
  s_barrier
  s_lshl_b32 s26, s61, 21
  s_lshl_b32 s27, s59, 10
  s_add_u32 s26, s26, s27
  s_add_u32 s27, s26, 20971520
  s_add_u32 s28, s26, 27262976
  s_lshl_b32 s26, s47, 7
  s_add_u32 s26, s26, s17
  s_lshl_b32 s26, s26, 8
  s_add_u32 s26, s26, 244318208
  v_lshrrev_b32 v2, 8, v0
  v_and_b32 v3, 0xf0, v0
  v_lshl_add_u32 v5, v2, 10, v3
  buffer_load_dwordx4 v[36:39], v0, s[4:7], s27 offen sc1
  buffer_load_dwordx4 v[40:43], v0, s[4:7], s28 offen sc1
  s_mov_b32 s53, 0
m_w_76:
  s_add_u32 s27, s26, 0
  buffer_load_dwordx4 v[60:63], v5, s[4:7], s27 offen sc1
  s_add_u32 s27, s26, 4096
  buffer_load_dwordx4 v[64:67], v5, s[4:7], s27 offen sc1
  s_add_u32 s27, s26, 8192
  buffer_load_dwordx4 v[68:71], v5, s[4:7], s27 offen sc1
  s_add_u32 s27, s26, 12288
  buffer_load_dwordx4 v[72:75], v5, s[4:7], s27 offen sc1
  s_add_u32 s27, s26, 16384
  buffer_load_dwordx4 v[76:79], v5, s[4:7], s27 offen sc1
  s_add_u32 s27, s26, 20480
  buffer_load_dwordx4 v[80:83], v5, s[4:7], s27 offen sc1
  s_add_u32 s27, s26, 24576
  buffer_load_dwordx4 v[84:87], v5, s[4:7], s27 offen sc1
  s_add_u32 s27, s26, 28672
  buffer_load_dwordx4 v[88:91], v5, s[4:7], s27 offen sc1
  s_add_u32 s53, s53, 1
  s_cmp_gt_u32 s53, 1048576
  s_cbranch_scc1 q_fail_61
  s_mov_b32 vcc_lo, 0xaaaaaaaa
  s_mov_b32 vcc_hi, 0xaaaaaaaa
  v_mov_b32 v28, 0x3f80
  v_mov_b32 v20, 1.0
  v_cndmask_b32 v28, v28, v20, vcc
  s_mov_b32 vcc_lo, 0x30003
  s_mov_b32 vcc_hi, 0x30003
  v_cndmask_b32 v20, 0, v28, vcc
  s_mov_b32 vcc_lo, 0xc000c
  s_mov_b32 vcc_hi, 0xc000c
  v_cndmask_b32 v21, 0, v28, vcc
  s_mov_b32 vcc_lo, 0x300030
  s_mov_b32 vcc_hi, 0x300030
  v_cndmask_b32 v22, 0, v28, vcc
  s_mov_b32 vcc_lo, 0xc000c0
  s_mov_b32 vcc_hi, 0xc000c0
  v_cndmask_b32 v23, 0, v28, vcc
  s_waitcnt vmcnt(7)
  s_nop 0
  v_mfma_f32_16x16x32_bf16 v[28:31], v[20:23], v[60:63], 0
  v_max3_u32 v44, v60, v61, 0
  v_max3_u32 v44, v62, v63, v44
  s_waitcnt vmcnt(6)
  v_mfma_f32_16x16x32_bf16 v[28:31], v[20:23], v[64:67], v[28:31]
  v_max3_u32 v44, v64, v65, v44
  v_max3_u32 v44, v66, v67, v44
  s_waitcnt vmcnt(5)
  v_mfma_f32_16x16x32_bf16 v[28:31], v[20:23], v[68:71], v[28:31]
  v_max3_u32 v44, v68, v69, v44
  v_max3_u32 v44, v70, v71, v44
  s_waitcnt vmcnt(4)
  v_mfma_f32_16x16x32_bf16 v[28:31], v[20:23], v[72:75], v[28:31]
  v_max3_u32 v44, v72, v73, v44
  v_max3_u32 v44, v74, v75, v44
  s_waitcnt vmcnt(3)
  v_mfma_f32_16x16x32_bf16 v[28:31], v[20:23], v[76:79], v[28:31]
  v_max3_u32 v44, v76, v77, v44
  v_max3_u32 v44, v78, v79, v44
  s_waitcnt vmcnt(2)
  v_mfma_f32_16x16x32_bf16 v[28:31], v[20:23], v[80:83], v[28:31]
  v_max3_u32 v44, v80, v81, v44
  v_max3_u32 v44, v82, v83, v44
  s_waitcnt vmcnt(1)
  v_mfma_f32_16x16x32_bf16 v[28:31], v[20:23], v[84:87], v[28:31]
  v_max3_u32 v44, v84, v85, v44
  v_max3_u32 v44, v86, v87, v44
  s_waitcnt vmcnt(0)
  v_mfma_f32_16x16x32_bf16 v[28:31], v[20:23], v[88:91], v[28:31]
  v_max3_u32 v44, v88, v89, v44
  v_max3_u32 v44, v90, v91, v44
  v_cmp_eq_u32 vcc, -1, v44
  s_cbranch_vccnz m_w_76
  v_lshlrev_b32 v3, 1, v3
  v_lshl_add_u32 v3, v2, 4, v3
  s_lshl_b32 s26, s17, 9
  s_add_u32 s26, s26, 159744
  v_add_u32 v3, s26, v3
  s_mov_b32 exec_hi, 0
  ds_write_b128 v3, v[28:31]
  s_mov_b32 exec_hi, -1
  v_lshlrev_b32 v3, 1, v0
  v_add_u32 v3, 159744, v3
  v_lshlrev_b32 v44, 16, v36
  v_and_b32 v45, 0xffff0000, v36
  v_lshlrev_b32 v46, 16, v37
  v_and_b32 v47, 0xffff0000, v37
  v_lshlrev_b32 v48, 16, v38
  v_and_b32 v49, 0xffff0000, v38
  v_lshlrev_b32 v50, 16, v39
  v_and_b32 v51, 0xffff0000, v39
  v_lshlrev_b32 v52, 16, v40
  v_and_b32 v53, 0xffff0000, v40
  v_lshlrev_b32 v54, 16, v41
  v_and_b32 v55, 0xffff0000, v41
  v_lshlrev_b32 v56, 16, v42
  v_and_b32 v57, 0xffff0000, v42
  v_lshlrev_b32 v58, 16, v43
  v_and_b32 v59, 0xffff0000, v43
  s_waitcnt lgkmcnt(0)
  s_barrier
  s_cmp_lg_u32 s17, 0
  s_cbranch_scc1 m_done_75
  ds_read_b128 v[28:31], v3
  ds_read_b128 v[32:35], v3 offset:16
  s_and_b32 s29, s58, 0xffff0000
  s_xor_b32 s27, s29, 0x80000000
  s_xor_b32 s28, s29, 0xffff0000
  s_bitcmp1_b32 s29, 31
  s_cselect_b32 s29, s27, s28
  v_mov_b32 v36, s29
  v_mul_f32 v36, 0xbfb8aa3b, v36
  v_exp_f32 v36, v36
  s_nop 0
  v_add_f32 v36, 1.0, v36
  v_rcp_f32 v36, v36
  s_nop 0
  v_cvt_pk_bf16_f32 v36, 0, v36
  s_waitcnt lgkmcnt(0)
  v_cvt_pk_bf16_f32 v28, 0, v28
  v_cvt_pk_bf16_f32 v29, 0, v29
  v_cvt_pk_bf16_f32 v30, 0, v30
  v_cvt_pk_bf16_f32 v31, 0, v31
  v_cvt_pk_bf16_f32 v32, 0, v32
  v_cvt_pk_bf16_f32 v33, 0, v33
  v_cvt_pk_bf16_f32 v34, 0, v34
  v_cvt_pk_bf16_f32 v35, 0, v35
  v_mul_f32 v28, v28, v36
  v_mul_f32 v29, v29, v36
  v_mul_f32 v30, v30, v36
  v_mul_f32 v31, v31, v36
  v_mul_f32 v32, v32, v36
  v_mul_f32 v33, v33, v36
  v_mul_f32 v34, v34, v36
  v_mul_f32 v35, v35, v36
  v_cvt_pk_bf16_f32 v28, 0, v28
  v_cvt_pk_bf16_f32 v29, 0, v29
  v_cvt_pk_bf16_f32 v30, 0, v30
  v_cvt_pk_bf16_f32 v31, 0, v31
  v_cvt_pk_bf16_f32 v32, 0, v32
  v_cvt_pk_bf16_f32 v33, 0, v33
  v_cvt_pk_bf16_f32 v34, 0, v34
  v_cvt_pk_bf16_f32 v35, 0, v35
  v_add_f32 v28, v28, v52
  v_add_f32 v29, v29, v53
  v_add_f32 v30, v30, v54
  v_add_f32 v31, v31, v55
  v_add_f32 v32, v32, v56
  v_add_f32 v33, v33, v57
  v_add_f32 v34, v34, v58
  v_add_f32 v35, v35, v59
  v_cvt_pk_bf16_f32 v28, 0, v28
  v_cvt_pk_bf16_f32 v29, 0, v29
  v_cvt_pk_bf16_f32 v30, 0, v30
  v_cvt_pk_bf16_f32 v31, 0, v31
  v_cvt_pk_bf16_f32 v32, 0, v32
  v_cvt_pk_bf16_f32 v33, 0, v33
  v_cvt_pk_bf16_f32 v34, 0, v34
  v_cvt_pk_bf16_f32 v35, 0, v35
  v_add_f32 v44, v44, v28
  v_add_f32 v45, v45, v29
  v_add_f32 v46, v46, v30
  v_add_f32 v47, v47, v31
  v_add_f32 v48, v48, v32
  v_add_f32 v49, v49, v33
  v_add_f32 v50, v50, v34
  v_add_f32 v51, v51, v35
  v_cvt_pk_bf16_f32 v40, v44, v45
  v_cvt_pk_bf16_f32 v41, v46, v47
  v_cvt_pk_bf16_f32 v42, v48, v49
  v_cvt_pk_bf16_f32 v43, v50, v51
  v_lshlrev_b32 v44, 16, v40
  v_and_b32 v45, 0xffff0000, v40
  v_lshlrev_b32 v46, 16, v41
  v_and_b32 v47, 0xffff0000, v41
  v_lshlrev_b32 v48, 16, v42
  v_and_b32 v49, 0xffff0000, v42
  v_lshlrev_b32 v50, 16, v43
  v_and_b32 v51, 0xffff0000, v43
  s_lshl_b32 s26, s59, 10
  buffer_store_dwordx4 v[40:43], v0, s[72:75], s26 offen sc1
m_done_75:
q_fail_61:
  s_endpgm
L_o:
  s_sub_u32 s60, s91, 3
  s_and_b32 s61, s90, 15
  s_load_dwordx2 s[80:81], s[0:1], 40
  s_load_dwordx2 s[72:73], s[0:1], 0
  s_mov_b32 s82, 4194304
  v_and_b32 v42, 63, v0
  v_and_b32 v40, 15, v42
  v_lshrrev_b32 v41, 4, v42
  v_lshlrev_b32 v1, 3, v42
  v_lshlrev_b32 v2, 2, v42
  v_lshlrev_b32 v0, 4, v42
  s_mov_b32 s24, 0x3e0293ee
  s_mov_b32 s44, 0x05040100
  s_mov_b32 s45, 0x07060302
  s_and_b32 s26, s17, 1
  s_lshl_b32 s26, s26, 4
  v_lshlrev_b32 v43, 2, v41
  v_sub_u32 v43, v40, v43
  v_add_u32 v43, s26, v43
  v_mov_b32 v7, 0xfe000000
  v_cmp_le_i32 vcc, 0, v43
  s_nop 1
  v_cndmask_b32 v24, v7, 0, vcc
  v_cmp_le_i32 vcc, 1, v43
  s_nop 1
  v_cndmask_b32 v25, v7, 0, vcc
  v_cmp_le_i32 vcc, 2, v43
  s_nop 1
  v_cndmask_b32 v26, v7, 0, vcc
  v_cmp_le_i32 vcc, 3, v43
  s_nop 1
  v_cndmask_b32 v27, v7, 0, vcc
  v_cmp_le_i32 vcc, 16, v43
  s_nop 1
  v_cndmask_b32 v28, v7, 0, vcc
  v_cmp_le_i32 vcc, 17, v43
  s_nop 1
  v_cndmask_b32 v29, v7, 0, vcc
  v_cmp_le_i32 vcc, 18, v43
  s_nop 1
  v_cndmask_b32 v30, v7, 0, vcc
  v_cmp_le_i32 vcc, 19, v43
  s_nop 1
  v_cndmask_b32 v31, v7, 0, vcc
  v_lshrrev_b32 v43, 5, v42
  v_lshlrev_b32 v43, 16, v43
  v_and_b32 v4, 1, v41
  v_lshl_add_u32 v43, v4, 14, v43
  v_lshl_add_u32 v43, v40, 4, v43
  s_lshl_b32 s26, s61, 10
  s_lshl_b32 s27, s17, 8
  s_add_u32 s26, s26, s27
  v_add_u32 v4, s26, v43
  v_lshlrev_b32 v43, 10, v41
  v_lshl_add_u32 v5, v40, 4, v43
  s_lshl_b32 s26, s17, 12
  v_add_u32 v6, s26, v0
  v_and_b32 v43, 1, v41
  v_lshlrev_b32 v43, 12, v43
  v_lshl_add_u32 v43, v40, 4, v43
  v_lshrrev_b32 v3, 1, v41
  v_lshl_add_u32 v3, v3, 8, v43
  s_lshr_b32 s26, s17, 1
  s_lshl_b32 s27, s26, 14
  s_add_u32 s27, s27, 16384
  v_add_u32 v32, s27, v0
  s_lshl_b32 s27, s26, 13
  s_and_b32 s28, s17, 1
  s_lshl_b32 s28, s28, 10
  s_add_u32 s28, s28, s27
  s_add_u32 s28, s28, 49152
  v_add_u32 v33, s28, v0
  s_add_u32 s27, s27, 65536
  v_add_u32 v34, s27, v0
  v_add_u32 v35, s27, v1
  v_and_b32 v36, 0xf0, v0
  v_and_b32 v252, 64, v0
  v_mov_b32 v248, 0
  v_lshlrev_b32 v255, 4, v0
  v_and_b32 v43, 1, v42
  v_xor_b32 v254, 1, v43
  s_lshl_b32 s26, s17, 3
  s_add_u32 s26, s26, 81920
  v_mov_b32 v39, s26
  s_mov_b32 vcc_lo, 0xaaaaaaaa
  s_mov_b32 vcc_hi, 0xaaaaaaaa
  v_mov_b32 v43, 0x3f80
  v_mov_b32 v16, 1.0
  v_cndmask_b32 v43, v43, v16, vcc
  s_mov_b32 vcc_lo, 0x30003
  s_mov_b32 vcc_hi, 0x30003
  v_cndmask_b32 v16, 0, v43, vcc
  s_mov_b32 vcc_lo, 0xc000c
  s_mov_b32 vcc_hi, 0xc000c
  v_cndmask_b32 v17, 0, v43, vcc
  s_mov_b32 vcc_lo, 0x300030
  s_mov_b32 vcc_hi, 0x300030
  v_cndmask_b32 v18, 0, v43, vcc
  s_mov_b32 vcc_lo, 0xc000c0
  s_mov_b32 vcc_hi, 0xc000c0
  v_cndmask_b32 v19, 0, v43, vcc
  s_mov_b32 vcc_lo, 0x3000300
  s_mov_b32 vcc_hi, 0x3000300
  v_cndmask_b32 v20, 0, v43, vcc
  s_mov_b32 vcc_lo, 0xc000c00
  s_mov_b32 vcc_hi, 0xc000c00
  v_cndmask_b32 v21, 0, v43, vcc
  s_mov_b32 vcc_lo, 0x30003000
  s_mov_b32 vcc_hi, 0x30003000
  v_cndmask_b32 v22, 0, v43, vcc
  s_mov_b32 vcc_lo, 0xc000c000
  s_mov_b32 vcc_hi, 0xc000c000
  v_cndmask_b32 v23, 0, v43, vcc
  s_mov_b32 s70, 2097152
  s_mov_b32 s71, 0x20000
  s_mov_b32 s74, 2097152
  s_mov_b32 s75, 0x20000
  s_mov_b32 s10, 1024
  s_mov_b32 s83, 0x20000
  s_lshr_b32 s85, s17, 1
  s_lshl_b32 s26, s61, 1
  s_add_u32 s85, s85, s26
  s_add_u32 s43, s26, s17
  s_lshl_b32 s14, s61, 8
  s_lshl_b32 s15, s61, 7
  s_add_u32 s15, s15, 245104640
  s_add_u32 s14, s14, 244318208
  s_lshl_b32 s26, s61, 2
  s_add_u32 s26, s26, s17
  s_lshl_b32 s18, s26, 13
  s_add_u32 s18, s18, 41943040
  s_lshl_b32 s19, s26, 12
  s_add_u32 s19, s19, 142606336
  s_lshl_b32 s20, s85, 13
  s_add_u32 s20, s20, 192937984
  s_and_b32 s26, s17, 1
  s_mul_i32 s26, s26, 3072
  s_add_u32 s21, s20, s26
  s_lshr_b32 s40, s17, 1
  s_lshl_b32 s40, s40, 13
  s_add_u32 s40, s40, s26
  s_add_u32 s40, s40, 65536
  s_lshl_b32 s22, s17, 12
  s_add_u32 s22, s22, 49152
  s_lshl_b32 s23, s17, 13
  s_add_u32 s23, s23, 16384
  s_lshl_b32 s41, s60, 20
  s_add_u32 s41, s41, 12582912
  v_lshlrev_b32 v246, 3, v0
  s_mov_b32 s11, 0x20000
  s_waitcnt lgkmcnt(0)
  s_lshl_b32 s77, s60, 4
  s_add_u32 s77, s77, s61
  s_lshl_b32 s77, s77, 2
  s_add_u32 s77, s77, s17
  s_lshl_b32 s26, s77, 10
  buffer_load_dwordx4 v[176:179], v0, s[72:75], s26 offen
  s_add_u32 s26, s26, 262144
  buffer_load_dwordx4 v[180:183], v0, s[72:75], s26 offen
  s_add_u32 s26, s26, 262144
  buffer_load_dwordx4 v[184:187], v0, s[72:75], s26 offen
  s_add_u32 s26, s26, 262144
  buffer_load_dwordx4 v[188:191], v0, s[72:75], s26 offen
  s_add_u32 s26, s26, 262144
  buffer_load_dwordx4 v[192:195], v0, s[72:75], s26 offen
  s_add_u32 s26, s26, 262144
  buffer_load_dwordx4 v[196:199], v0, s[72:75], s26 offen
  s_add_u32 s26, s26, 262144
  buffer_load_dwordx4 v[200:203], v0, s[72:75], s26 offen
  s_add_u32 s26, s26, 262144
  buffer_load_dwordx4 v[204:207], v0, s[72:75], s26 offen
  s_add_u32 s26, s26, 262144
  v_lshrrev_b32 v44, 9, v0
  v_lshlrev_b32 v44, 12, v44
  v_and_b32 v45, 0xf0, v0
  v_add_u32 v44, v44, v45
  v_bfe_u32 v45, v0, 8, 1
  v_lshl_add_u32 v44, v45, 3, v44
  s_lshl_b32 s30, s61, 18
  s_lshl_b32 s27, s17, 8
  s_add_u32 s30, s30, s27
  s_add_u32 s27, s30, 0
  buffer_load_dwordx2 v[64:65], v44, s[80:83], s27 offen
  s_add_u32 s27, s30, 1024
  buffer_load_dwordx2 v[66:67], v44, s[80:83], s27 offen
  s_add_u32 s27, s30, 2048
  buffer_load_dwordx2 v[68:69], v44, s[80:83], s27 offen
  s_add_u32 s27, s30, 3072
  buffer_load_dwordx2 v[70:71], v44, s[80:83], s27 offen
  s_add_u32 s27, s30, 16384
  buffer_load_dwordx2 v[72:73], v44, s[80:83], s27 offen
  s_add_u32 s27, s30, 17408
  buffer_load_dwordx2 v[74:75], v44, s[80:83], s27 offen
  s_add_u32 s27, s30, 18432
  buffer_load_dwordx2 v[76:77], v44, s[80:83], s27 offen
  s_add_u32 s27, s30, 19456
  buffer_load_dwordx2 v[78:79], v44, s[80:83], s27 offen
  s_add_u32 s27, s30, 8192
  buffer_load_dwordx2 v[80:81], v44, s[80:83], s27 offen
  s_add_u32 s27, s30, 9216
  buffer_load_dwordx2 v[82:83], v44, s[80:83], s27 offen
  s_add_u32 s27, s30, 10240
  buffer_load_dwordx2 v[84:85], v44, s[80:83], s27 offen
  s_add_u32 s27, s30, 11264
  buffer_load_dwordx2 v[86:87], v44, s[80:83], s27 offen
  s_add_u32 s27, s30, 24576
  buffer_load_dwordx2 v[88:89], v44, s[80:83], s27 offen
  s_add_u32 s27, s30, 25600
  buffer_load_dwordx2 v[90:91], v44, s[80:83], s27 offen
  s_add_u32 s27, s30, 26624
  buffer_load_dwordx2 v[92:93], v44, s[80:83], s27 offen
  s_add_u32 s27, s30, 27648
  buffer_load_dwordx2 v[94:95], v44, s[80:83], s27 offen
  s_add_u32 s27, s30, 32768
  buffer_load_dwordx2 v[96:97], v44, s[80:83], s27 offen
  s_add_u32 s27, s30, 33792
  buffer_load_dwordx2 v[98:99], v44, s[80:83], s27 offen
  s_add_u32 s27, s30, 34816
  buffer_load_dwordx2 v[100:101], v44, s[80:83], s27 offen
  s_add_u32 s27, s30, 35840
  buffer_load_dwordx2 v[102:103], v44, s[80:83], s27 offen
  s_add_u32 s27, s30, 49152
  buffer_load_dwordx2 v[104:105], v44, s[80:83], s27 offen
  s_add_u32 s27, s30, 50176
  buffer_load_dwordx2 v[106:107], v44, s[80:83], s27 offen
  s_add_u32 s27, s30, 51200
  buffer_load_dwordx2 v[108:109], v44, s[80:83], s27 offen
  s_add_u32 s27, s30, 52224
  buffer_load_dwordx2 v[110:111], v44, s[80:83], s27 offen
  s_add_u32 s27, s30, 40960
  buffer_load_dwordx2 v[112:113], v44, s[80:83], s27 offen
  s_add_u32 s27, s30, 41984
  buffer_load_dwordx2 v[114:115], v44, s[80:83], s27 offen
  s_add_u32 s27, s30, 43008
  buffer_load_dwordx2 v[116:117], v44, s[80:83], s27 offen
  s_add_u32 s27, s30, 44032
  buffer_load_dwordx2 v[118:119], v44, s[80:83], s27 offen
  s_add_u32 s27, s30, 57344
  buffer_load_dwordx2 v[120:121], v44, s[80:83], s27 offen
  s_add_u32 s27, s30, 58368
  buffer_load_dwordx2 v[122:123], v44, s[80:83], s27 offen
  s_add_u32 s27, s30, 59392
  buffer_load_dwordx2 v[124:125], v44, s[80:83], s27 offen
  s_add_u32 s27, s30, 60416
  buffer_load_dwordx2 v[126:127], v44, s[80:83], s27 offen
  s_load_dwordx2 s[4:5], s[0:1], 112
  s_load_dwordx2 s[12:13], s[0:1], 104
  s_load_dwordx2 s[68:69], s[0:1], 96
  s_load_dwordx2 s[8:9], s[0:1], 64
  s_waitcnt lgkmcnt(0)
  buffer_load_dwordx4 v[56:59], v0, s[8:11], 0 offen
  s_lshl_b32 s29, s77, 10
  s_add_u32 s29, s29, 6291456
  s_waitcnt vmcnt(40)
  v_lshlrev_b32 v212, 16, v176
  v_and_b32 v213, 0xffff0000, v176
  v_lshlrev_b32 v214, 16, v177
  v_and_b32 v215, 0xffff0000, v177
  v_lshlrev_b32 v216, 16, v178
  v_and_b32 v217, 0xffff0000, v178
  v_lshlrev_b32 v218, 16, v179
  v_and_b32 v219, 0xffff0000, v179
  v_add_f32 v220, v212, v213
  v_add_f32 v221, v214, v215
  v_add_f32 v222, v216, v217
  v_add_f32 v223, v218, v219
  v_add_f32 v220, v220, v221
  v_add_f32 v222, v222, v223
  v_add_f32 v220, v220, v222
  s_nop 1
  v_add_f32_dpp v220, v220, v220 row_ror:8 row_mask:0xf bank_mask:0xf
  s_nop 1
  v_add_f32_dpp v220, v220, v220 row_ror:4 row_mask:0xf bank_mask:0xf
  s_nop 1
  v_add_f32_dpp v220, v220, v220 row_ror:2 row_mask:0xf bank_mask:0xf
  s_nop 1
  v_add_f32_dpp v220, v220, v220 row_ror:1 row_mask:0xf bank_mask:0xf
  v_mov_b32 v222, v220
  s_nop 0
  s_nop 0
  v_permlane16_swap_b32 v220, v222
  v_add_f32 v220, v220, v222
  v_mov_b32 v222, v220
  s_nop 0
  s_nop 0
  v_permlane32_swap_b32 v220, v222
  v_add_f32 v220, v220, v222
  v_mul_f32 v220, 0x3b000000, v220
  v_sub_f32 v224, v212, v220
  v_sub_f32 v225, v213, v220
  v_sub_f32 v226, v214, v220
  v_sub_f32 v227, v215, v220
  v_sub_f32 v228, v216, v220
  v_sub_f32 v229, v217, v220
  v_sub_f32 v230, v218, v220
  v_sub_f32 v231, v219, v220
  v_mul_f32 v221, v224, v224
  v_mul_f32 v222, v225, v225
  v_fmac_f32 v221, v226, v226
  v_fmac_f32 v222, v227, v227
  v_fmac_f32 v221, v228, v228
  v_fmac_f32 v222, v229, v229
  v_fmac_f32 v221, v230, v230
  v_fmac_f32 v222, v231, v231
  v_add_f32 v221, v221, v222
  v_cvt_pk_bf16_f32 v220, 0, v220
  s_nop 0
  v_add_f32_dpp v221, v221, v221 row_ror:8 row_mask:0xf bank_mask:0xf
  v_sub_f32 v224, v212, v220
  v_sub_f32 v225, v213, v220
  v_add_f32_dpp v221, v221, v221 row_ror:4 row_mask:0xf bank_mask:0xf
  v_sub_f32 v226, v214, v220
  v_sub_f32 v227, v215, v220
  v_add_f32_dpp v221, v221, v221 row_ror:2 row_mask:0xf bank_mask:0xf
  v_sub_f32 v228, v216, v220
  v_sub_f32 v229, v217, v220
  v_add_f32_dpp v221, v221, v221 row_ror:1 row_mask:0xf bank_mask:0xf
  v_sub_f32 v230, v218, v220
  v_sub_f32 v231, v219, v220
  v_mov_b32 v222, v221
  v_cvt_pk_bf16_f32 v224, 0, v224
  v_cvt_pk_bf16_f32 v225, 0, v225
  v_permlane16_swap_b32 v221, v222
  v_cvt_pk_bf16_f32 v226, 0, v226
  v_cvt_pk_bf16_f32 v227, 0, v227
  v_add_f32 v221, v221, v222
  v_cvt_pk_bf16_f32 v228, 0, v228
  v_cvt_pk_bf16_f32 v229, 0, v229
  v_mov_b32 v222, v221
  v_cvt_pk_bf16_f32 v230, 0, v230
  v_cvt_pk_bf16_f32 v231, 0, v231
  v_permlane32_swap_b32 v221, v222
  v_add_f32 v221, v221, v222
  v_mul_f32 v221, 0x3b000000, v221
  v_cvt_pk_bf16_f32 v221, 0, v221
  v_add_f32 v221, 0x3727c5ac, v221
  v_cvt_pk_bf16_f32 v221, 0, v221
  v_sqrt_f32 v221, v221
  s_nop 0
  v_cvt_pk_bf16_f32 v221, 0, v221
  v_rcp_f32 v221, v221
  s_nop 0
  v_mul_f32 v224, v224, v221
  v_mul_f32 v225, v225, v221
  v_mul_f32 v226, v226, v221
  v_mul_f32 v227, v227, v221
  v_mul_f32 v228, v228, v221
  v_mul_f32 v229, v229, v221
  v_mul_f32 v230, v230, v221
  v_mul_f32 v231, v231, v221
  v_cvt_pk_bf16_f32 v176, v224, v225
  v_cvt_pk_bf16_f32 v177, v226, v227
  v_cvt_pk_bf16_f32 v178, v228, v229
  v_cvt_pk_bf16_f32 v179, v230, v231
  buffer_store_dwordx4 v[176:179], v0, s[4:7], s29 offen sc1
  s_add_u32 s29, s29, 262144
  s_waitcnt vmcnt(40)
  v_lshlrev_b32 v212, 16, v180
  v_and_b32 v213, 0xffff0000, v180
  v_lshlrev_b32 v214, 16, v181
  v_and_b32 v215, 0xffff0000, v181
  v_lshlrev_b32 v216, 16, v182
  v_and_b32 v217, 0xffff0000, v182
  v_lshlrev_b32 v218, 16, v183
  v_and_b32 v219, 0xffff0000, v183
  v_add_f32 v220, v212, v213
  v_add_f32 v221, v214, v215
  v_add_f32 v222, v216, v217
  v_add_f32 v223, v218, v219
  v_add_f32 v220, v220, v221
  v_add_f32 v222, v222, v223
  v_add_f32 v220, v220, v222
  s_nop 1
  v_add_f32_dpp v220, v220, v220 row_ror:8 row_mask:0xf bank_mask:0xf
  s_nop 1
  v_add_f32_dpp v220, v220, v220 row_ror:4 row_mask:0xf bank_mask:0xf
  s_nop 1
  v_add_f32_dpp v220, v220, v220 row_ror:2 row_mask:0xf bank_mask:0xf
  s_nop 1
  v_add_f32_dpp v220, v220, v220 row_ror:1 row_mask:0xf bank_mask:0xf
  v_mov_b32 v222, v220
  s_nop 0
  s_nop 0
  v_permlane16_swap_b32 v220, v222
  v_add_f32 v220, v220, v222
  v_mov_b32 v222, v220
  s_nop 0
  s_nop 0
  v_permlane32_swap_b32 v220, v222
  v_add_f32 v220, v220, v222
  v_mul_f32 v220, 0x3b000000, v220
  v_sub_f32 v224, v212, v220
  v_sub_f32 v225, v213, v220
  v_sub_f32 v226, v214, v220
  v_sub_f32 v227, v215, v220
  v_sub_f32 v228, v216, v220
  v_sub_f32 v229, v217, v220
  v_sub_f32 v230, v218, v220
  v_sub_f32 v231, v219, v220
  v_mul_f32 v221, v224, v224
  v_mul_f32 v222, v225, v225
  v_fmac_f32 v221, v226, v226
  v_fmac_f32 v222, v227, v227
  v_fmac_f32 v221, v228, v228
  v_fmac_f32 v222, v229, v229
  v_fmac_f32 v221, v230, v230
  v_fmac_f32 v222, v231, v231
  v_add_f32 v221, v221, v222
  v_cvt_pk_bf16_f32 v220, 0, v220
  s_nop 0
  v_add_f32_dpp v221, v221, v221 row_ror:8 row_mask:0xf bank_mask:0xf
  v_sub_f32 v224, v212, v220
  v_sub_f32 v225, v213, v220
  v_add_f32_dpp v221, v221, v221 row_ror:4 row_mask:0xf bank_mask:0xf
  v_sub_f32 v226, v214, v220
  v_sub_f32 v227, v215, v220
  v_add_f32_dpp v221, v221, v221 row_ror:2 row_mask:0xf bank_mask:0xf
  v_sub_f32 v228, v216, v220
  v_sub_f32 v229, v217, v220
  v_add_f32_dpp v221, v221, v221 row_ror:1 row_mask:0xf bank_mask:0xf
  v_sub_f32 v230, v218, v220
  v_sub_f32 v231, v219, v220
  v_mov_b32 v222, v221
  v_cvt_pk_bf16_f32 v224, 0, v224
  v_cvt_pk_bf16_f32 v225, 0, v225
  v_permlane16_swap_b32 v221, v222
  v_cvt_pk_bf16_f32 v226, 0, v226
  v_cvt_pk_bf16_f32 v227, 0, v227
  v_add_f32 v221, v221, v222
  v_cvt_pk_bf16_f32 v228, 0, v228
  v_cvt_pk_bf16_f32 v229, 0, v229
  v_mov_b32 v222, v221
  v_cvt_pk_bf16_f32 v230, 0, v230
  v_cvt_pk_bf16_f32 v231, 0, v231
  v_permlane32_swap_b32 v221, v222
  v_add_f32 v221, v221, v222
  v_mul_f32 v221, 0x3b000000, v221
  v_cvt_pk_bf16_f32 v221, 0, v221
  v_add_f32 v221, 0x3727c5ac, v221
  v_cvt_pk_bf16_f32 v221, 0, v221
  v_sqrt_f32 v221, v221
  s_nop 0
  v_cvt_pk_bf16_f32 v221, 0, v221
  v_rcp_f32 v221, v221
  s_nop 0
  v_mul_f32 v224, v224, v221
  v_mul_f32 v225, v225, v221
  v_mul_f32 v226, v226, v221
  v_mul_f32 v227, v227, v221
  v_mul_f32 v228, v228, v221
  v_mul_f32 v229, v229, v221
  v_mul_f32 v230, v230, v221
  v_mul_f32 v231, v231, v221
  v_cvt_pk_bf16_f32 v180, v224, v225
  v_cvt_pk_bf16_f32 v181, v226, v227
  v_cvt_pk_bf16_f32 v182, v228, v229
  v_cvt_pk_bf16_f32 v183, v230, v231
  buffer_store_dwordx4 v[180:183], v0, s[4:7], s29 offen sc1
  s_add_u32 s29, s29, 262144
  s_waitcnt vmcnt(40)
  v_lshlrev_b32 v212, 16, v184
  v_and_b32 v213, 0xffff0000, v184
  v_lshlrev_b32 v214, 16, v185
  v_and_b32 v215, 0xffff0000, v185
  v_lshlrev_b32 v216, 16, v186
  v_and_b32 v217, 0xffff0000, v186
  v_lshlrev_b32 v218, 16, v187
  v_and_b32 v219, 0xffff0000, v187
  v_add_f32 v220, v212, v213
  v_add_f32 v221, v214, v215
  v_add_f32 v222, v216, v217
  v_add_f32 v223, v218, v219
  v_add_f32 v220, v220, v221
  v_add_f32 v222, v222, v223
  v_add_f32 v220, v220, v222
  s_nop 1
  v_add_f32_dpp v220, v220, v220 row_ror:8 row_mask:0xf bank_mask:0xf
  s_nop 1
  v_add_f32_dpp v220, v220, v220 row_ror:4 row_mask:0xf bank_mask:0xf
  s_nop 1
  v_add_f32_dpp v220, v220, v220 row_ror:2 row_mask:0xf bank_mask:0xf
  s_nop 1
  v_add_f32_dpp v220, v220, v220 row_ror:1 row_mask:0xf bank_mask:0xf
  v_mov_b32 v222, v220
  s_nop 0
  s_nop 0
  v_permlane16_swap_b32 v220, v222
  v_add_f32 v220, v220, v222
  v_mov_b32 v222, v220
  s_nop 0
  s_nop 0
  v_permlane32_swap_b32 v220, v222
  v_add_f32 v220, v220, v222
  v_mul_f32 v220, 0x3b000000, v220
  v_sub_f32 v224, v212, v220
  v_sub_f32 v225, v213, v220
  v_sub_f32 v226, v214, v220
  v_sub_f32 v227, v215, v220
  v_sub_f32 v228, v216, v220
  v_sub_f32 v229, v217, v220
  v_sub_f32 v230, v218, v220
  v_sub_f32 v231, v219, v220
  v_mul_f32 v221, v224, v224
  v_mul_f32 v222, v225, v225
  v_fmac_f32 v221, v226, v226
  v_fmac_f32 v222, v227, v227
  v_fmac_f32 v221, v228, v228
  v_fmac_f32 v222, v229, v229
  v_fmac_f32 v221, v230, v230
  v_fmac_f32 v222, v231, v231
  v_add_f32 v221, v221, v222
  v_cvt_pk_bf16_f32 v220, 0, v220
  s_nop 0
  v_add_f32_dpp v221, v221, v221 row_ror:8 row_mask:0xf bank_mask:0xf
  v_sub_f32 v224, v212, v220
  v_sub_f32 v225, v213, v220
  v_add_f32_dpp v221, v221, v221 row_ror:4 row_mask:0xf bank_mask:0xf
  v_sub_f32 v226, v214, v220
  v_sub_f32 v227, v215, v220
  v_add_f32_dpp v221, v221, v221 row_ror:2 row_mask:0xf bank_mask:0xf
  v_sub_f32 v228, v216, v220
  v_sub_f32 v229, v217, v220
  v_add_f32_dpp v221, v221, v221 row_ror:1 row_mask:0xf bank_mask:0xf
  v_sub_f32 v230, v218, v220
  v_sub_f32 v231, v219, v220
  v_mov_b32 v222, v221
  v_cvt_pk_bf16_f32 v224, 0, v224
  v_cvt_pk_bf16_f32 v225, 0, v225
  v_permlane16_swap_b32 v221, v222
  v_cvt_pk_bf16_f32 v226, 0, v226
  v_cvt_pk_bf16_f32 v227, 0, v227
  v_add_f32 v221, v221, v222
  v_cvt_pk_bf16_f32 v228, 0, v228
  v_cvt_pk_bf16_f32 v229, 0, v229
  v_mov_b32 v222, v221
  v_cvt_pk_bf16_f32 v230, 0, v230
  v_cvt_pk_bf16_f32 v231, 0, v231
  v_permlane32_swap_b32 v221, v222
  v_add_f32 v221, v221, v222
  v_mul_f32 v221, 0x3b000000, v221
  v_cvt_pk_bf16_f32 v221, 0, v221
  v_add_f32 v221, 0x3727c5ac, v221
  v_cvt_pk_bf16_f32 v221, 0, v221
  v_sqrt_f32 v221, v221
  s_nop 0
  v_cvt_pk_bf16_f32 v221, 0, v221
  v_rcp_f32 v221, v221
  s_nop 0
  v_mul_f32 v224, v224, v221
  v_mul_f32 v225, v225, v221
  v_mul_f32 v226, v226, v221
  v_mul_f32 v227, v227, v221
  v_mul_f32 v228, v228, v221
  v_mul_f32 v229, v229, v221
  v_mul_f32 v230, v230, v221
  v_mul_f32 v231, v231, v221
  v_cvt_pk_bf16_f32 v184, v224, v225
  v_cvt_pk_bf16_f32 v185, v226, v227
  v_cvt_pk_bf16_f32 v186, v228, v229
  v_cvt_pk_bf16_f32 v187, v230, v231
  buffer_store_dwordx4 v[184:187], v0, s[4:7], s29 offen sc1
  s_add_u32 s29, s29, 262144
  s_waitcnt vmcnt(40)
  v_lshlrev_b32 v212, 16, v188
  v_and_b32 v213, 0xffff0000, v188
  v_lshlrev_b32 v214, 16, v189
  v_and_b32 v215, 0xffff0000, v189
  v_lshlrev_b32 v216, 16, v190
  v_and_b32 v217, 0xffff0000, v190
  v_lshlrev_b32 v218, 16, v191
  v_and_b32 v219, 0xffff0000, v191
  v_add_f32 v220, v212, v213
  v_add_f32 v221, v214, v215
  v_add_f32 v222, v216, v217
  v_add_f32 v223, v218, v219
  v_add_f32 v220, v220, v221
  v_add_f32 v222, v222, v223
  v_add_f32 v220, v220, v222
  s_nop 1
  v_add_f32_dpp v220, v220, v220 row_ror:8 row_mask:0xf bank_mask:0xf
  s_nop 1
  v_add_f32_dpp v220, v220, v220 row_ror:4 row_mask:0xf bank_mask:0xf
  s_nop 1
  v_add_f32_dpp v220, v220, v220 row_ror:2 row_mask:0xf bank_mask:0xf
  s_nop 1
  v_add_f32_dpp v220, v220, v220 row_ror:1 row_mask:0xf bank_mask:0xf
  v_mov_b32 v222, v220
  s_nop 0
  s_nop 0
  v_permlane16_swap_b32 v220, v222
  v_add_f32 v220, v220, v222
  v_mov_b32 v222, v220
  s_nop 0
  s_nop 0
  v_permlane32_swap_b32 v220, v222
  v_add_f32 v220, v220, v222
  v_mul_f32 v220, 0x3b000000, v220
  v_sub_f32 v224, v212, v220
  v_sub_f32 v225, v213, v220
  v_sub_f32 v226, v214, v220
  v_sub_f32 v227, v215, v220
  v_sub_f32 v228, v216, v220
  v_sub_f32 v229, v217, v220
  v_sub_f32 v230, v218, v220
  v_sub_f32 v231, v219, v220
  v_mul_f32 v221, v224, v224
  v_mul_f32 v222, v225, v225
  v_fmac_f32 v221, v226, v226
  v_fmac_f32 v222, v227, v227
  v_fmac_f32 v221, v228, v228
  v_fmac_f32 v222, v229, v229
  v_fmac_f32 v221, v230, v230
  v_fmac_f32 v222, v231, v231
  v_add_f32 v221, v221, v222
  v_cvt_pk_bf16_f32 v220, 0, v220
  s_nop 0
  v_add_f32_dpp v221, v221, v221 row_ror:8 row_mask:0xf bank_mask:0xf
  v_sub_f32 v224, v212, v220
  v_sub_f32 v225, v213, v220
  v_add_f32_dpp v221, v221, v221 row_ror:4 row_mask:0xf bank_mask:0xf
  v_sub_f32 v226, v214, v220
  v_sub_f32 v227, v215, v220
  v_add_f32_dpp v221, v221, v221 row_ror:2 row_mask:0xf bank_mask:0xf
  v_sub_f32 v228, v216, v220
  v_sub_f32 v229, v217, v220
  v_add_f32_dpp v221, v221, v221 row_ror:1 row_mask:0xf bank_mask:0xf
  v_sub_f32 v230, v218, v220
  v_sub_f32 v231, v219, v220
  v_mov_b32 v222, v221
  v_cvt_pk_bf16_f32 v224, 0, v224
  v_cvt_pk_bf16_f32 v225, 0, v225
  v_permlane16_swap_b32 v221, v222
  v_cvt_pk_bf16_f32 v226, 0, v226
  v_cvt_pk_bf16_f32 v227, 0, v227
  v_add_f32 v221, v221, v222
  v_cvt_pk_bf16_f32 v228, 0, v228
  v_cvt_pk_bf16_f32 v229, 0, v229
  v_mov_b32 v222, v221
  v_cvt_pk_bf16_f32 v230, 0, v230
  v_cvt_pk_bf16_f32 v231, 0, v231
  v_permlane32_swap_b32 v221, v222
  v_add_f32 v221, v221, v222
  v_mul_f32 v221, 0x3b000000, v221
  v_cvt_pk_bf16_f32 v221, 0, v221
  v_add_f32 v221, 0x3727c5ac, v221
  v_cvt_pk_bf16_f32 v221, 0, v221
  v_sqrt_f32 v221, v221
  s_nop 0
  v_cvt_pk_bf16_f32 v221, 0, v221
  v_rcp_f32 v221, v221
  s_nop 0
  v_mul_f32 v224, v224, v221
  v_mul_f32 v225, v225, v221
  v_mul_f32 v226, v226, v221
  v_mul_f32 v227, v227, v221
  v_mul_f32 v228, v228, v221
  v_mul_f32 v229, v229, v221
  v_mul_f32 v230, v230, v221
  v_mul_f32 v231, v231, v221
  v_cvt_pk_bf16_f32 v188, v224, v225
  v_cvt_pk_bf16_f32 v189, v226, v227
  v_cvt_pk_bf16_f32 v190, v228, v229
  v_cvt_pk_bf16_f32 v191, v230, v231
  buffer_store_dwordx4 v[188:191], v0, s[4:7], s29 offen sc1
  s_add_u32 s29, s29, 262144
  s_waitcnt vmcnt(40)
  v_lshlrev_b32 v212, 16, v192
  v_and_b32 v213, 0xffff0000, v192
  v_lshlrev_b32 v214, 16, v193
  v_and_b32 v215, 0xffff0000, v193
  v_lshlrev_b32 v216, 16, v194
  v_and_b32 v217, 0xffff0000, v194
  v_lshlrev_b32 v218, 16, v195
  v_and_b32 v219, 0xffff0000, v195
  v_add_f32 v220, v212, v213
  v_add_f32 v221, v214, v215
  v_add_f32 v222, v216, v217
  v_add_f32 v223, v218, v219
  v_add_f32 v220, v220, v221
  v_add_f32 v222, v222, v223
  v_add_f32 v220, v220, v222
  s_nop 1
  v_add_f32_dpp v220, v220, v220 row_ror:8 row_mask:0xf bank_mask:0xf
  s_nop 1
  v_add_f32_dpp v220, v220, v220 row_ror:4 row_mask:0xf bank_mask:0xf
  s_nop 1
  v_add_f32_dpp v220, v220, v220 row_ror:2 row_mask:0xf bank_mask:0xf
  s_nop 1
  v_add_f32_dpp v220, v220, v220 row_ror:1 row_mask:0xf bank_mask:0xf
  v_mov_b32 v222, v220
  s_nop 0
  s_nop 0
  v_permlane16_swap_b32 v220, v222
  v_add_f32 v220, v220, v222
  v_mov_b32 v222, v220
  s_nop 0
  s_nop 0
  v_permlane32_swap_b32 v220, v222
  v_add_f32 v220, v220, v222
  v_mul_f32 v220, 0x3b000000, v220
  v_sub_f32 v224, v212, v220
  v_sub_f32 v225, v213, v220
  v_sub_f32 v226, v214, v220
  v_sub_f32 v227, v215, v220
  v_sub_f32 v228, v216, v220
  v_sub_f32 v229, v217, v220
  v_sub_f32 v230, v218, v220
  v_sub_f32 v231, v219, v220
  v_mul_f32 v221, v224, v224
  v_mul_f32 v222, v225, v225
  v_fmac_f32 v221, v226, v226
  v_fmac_f32 v222, v227, v227
  v_fmac_f32 v221, v228, v228
  v_fmac_f32 v222, v229, v229
  v_fmac_f32 v221, v230, v230
  v_fmac_f32 v222, v231, v231
  v_add_f32 v221, v221, v222
  v_cvt_pk_bf16_f32 v220, 0, v220
  s_nop 0
  v_add_f32_dpp v221, v221, v221 row_ror:8 row_mask:0xf bank_mask:0xf
  v_sub_f32 v224, v212, v220
  v_sub_f32 v225, v213, v220
  v_add_f32_dpp v221, v221, v221 row_ror:4 row_mask:0xf bank_mask:0xf
  v_sub_f32 v226, v214, v220
  v_sub_f32 v227, v215, v220
  v_add_f32_dpp v221, v221, v221 row_ror:2 row_mask:0xf bank_mask:0xf
  v_sub_f32 v228, v216, v220
  v_sub_f32 v229, v217, v220
  v_add_f32_dpp v221, v221, v221 row_ror:1 row_mask:0xf bank_mask:0xf
  v_sub_f32 v230, v218, v220
  v_sub_f32 v231, v219, v220
  v_mov_b32 v222, v221
  v_cvt_pk_bf16_f32 v224, 0, v224
  v_cvt_pk_bf16_f32 v225, 0, v225
  v_permlane16_swap_b32 v221, v222
  v_cvt_pk_bf16_f32 v226, 0, v226
  v_cvt_pk_bf16_f32 v227, 0, v227
  v_add_f32 v221, v221, v222
  v_cvt_pk_bf16_f32 v228, 0, v228
  v_cvt_pk_bf16_f32 v229, 0, v229
  v_mov_b32 v222, v221
  v_cvt_pk_bf16_f32 v230, 0, v230
  v_cvt_pk_bf16_f32 v231, 0, v231
  v_permlane32_swap_b32 v221, v222
  v_add_f32 v221, v221, v222
  v_mul_f32 v221, 0x3b000000, v221
  v_cvt_pk_bf16_f32 v221, 0, v221
  v_add_f32 v221, 0x3727c5ac, v221
  v_cvt_pk_bf16_f32 v221, 0, v221
  v_sqrt_f32 v221, v221
  s_nop 0
  v_cvt_pk_bf16_f32 v221, 0, v221
  v_rcp_f32 v221, v221
  s_nop 0
  v_mul_f32 v224, v224, v221
  v_mul_f32 v225, v225, v221
  v_mul_f32 v226, v226, v221
  v_mul_f32 v227, v227, v221
  v_mul_f32 v228, v228, v221
  v_mul_f32 v229, v229, v221
  v_mul_f32 v230, v230, v221
  v_mul_f32 v231, v231, v221
  v_cvt_pk_bf16_f32 v192, v224, v225
  v_cvt_pk_bf16_f32 v193, v226, v227
  v_cvt_pk_bf16_f32 v194, v228, v229
  v_cvt_pk_bf16_f32 v195, v230, v231
  buffer_store_dwordx4 v[192:195], v0, s[4:7], s29 offen sc1
  s_add_u32 s29, s29, 262144
  s_waitcnt vmcnt(40)
  v_lshlrev_b32 v212, 16, v196
  v_and_b32 v213, 0xffff0000, v196
  v_lshlrev_b32 v214, 16, v197
  v_and_b32 v215, 0xffff0000, v197
  v_lshlrev_b32 v216, 16, v198
  v_and_b32 v217, 0xffff0000, v198
  v_lshlrev_b32 v218, 16, v199
  v_and_b32 v219, 0xffff0000, v199
  v_add_f32 v220, v212, v213
  v_add_f32 v221, v214, v215
  v_add_f32 v222, v216, v217
  v_add_f32 v223, v218, v219
  v_add_f32 v220, v220, v221
  v_add_f32 v222, v222, v223
  v_add_f32 v220, v220, v222
  s_nop 1
  v_add_f32_dpp v220, v220, v220 row_ror:8 row_mask:0xf bank_mask:0xf
  s_nop 1
  v_add_f32_dpp v220, v220, v220 row_ror:4 row_mask:0xf bank_mask:0xf
  s_nop 1
  v_add_f32_dpp v220, v220, v220 row_ror:2 row_mask:0xf bank_mask:0xf
  s_nop 1
  v_add_f32_dpp v220, v220, v220 row_ror:1 row_mask:0xf bank_mask:0xf
  v_mov_b32 v222, v220
  s_nop 0
  s_nop 0
  v_permlane16_swap_b32 v220, v222
  v_add_f32 v220, v220, v222
  v_mov_b32 v222, v220
  s_nop 0
  s_nop 0
  v_permlane32_swap_b32 v220, v222
  v_add_f32 v220, v220, v222
  v_mul_f32 v220, 0x3b000000, v220
  v_sub_f32 v224, v212, v220
  v_sub_f32 v225, v213, v220
  v_sub_f32 v226, v214, v220
  v_sub_f32 v227, v215, v220
  v_sub_f32 v228, v216, v220
  v_sub_f32 v229, v217, v220
  v_sub_f32 v230, v218, v220
  v_sub_f32 v231, v219, v220
  v_mul_f32 v221, v224, v224
  v_mul_f32 v222, v225, v225
  v_fmac_f32 v221, v226, v226
  v_fmac_f32 v222, v227, v227
  v_fmac_f32 v221, v228, v228
  v_fmac_f32 v222, v229, v229
  v_fmac_f32 v221, v230, v230
  v_fmac_f32 v222, v231, v231
  v_add_f32 v221, v221, v222
  v_cvt_pk_bf16_f32 v220, 0, v220
  s_nop 0
  v_add_f32_dpp v221, v221, v221 row_ror:8 row_mask:0xf bank_mask:0xf
  v_sub_f32 v224, v212, v220
  v_sub_f32 v225, v213, v220
  v_add_f32_dpp v221, v221, v221 row_ror:4 row_mask:0xf bank_mask:0xf
  v_sub_f32 v226, v214, v220
  v_sub_f32 v227, v215, v220
  v_add_f32_dpp v221, v221, v221 row_ror:2 row_mask:0xf bank_mask:0xf
  v_sub_f32 v228, v216, v220
  v_sub_f32 v229, v217, v220
  v_add_f32_dpp v221, v221, v221 row_ror:1 row_mask:0xf bank_mask:0xf
  v_sub_f32 v230, v218, v220
  v_sub_f32 v231, v219, v220
  v_mov_b32 v222, v221
  v_cvt_pk_bf16_f32 v224, 0, v224
  v_cvt_pk_bf16_f32 v225, 0, v225
  v_permlane16_swap_b32 v221, v222
  v_cvt_pk_bf16_f32 v226, 0, v226
  v_cvt_pk_bf16_f32 v227, 0, v227
  v_add_f32 v221, v221, v222
  v_cvt_pk_bf16_f32 v228, 0, v228
  v_cvt_pk_bf16_f32 v229, 0, v229
  v_mov_b32 v222, v221
  v_cvt_pk_bf16_f32 v230, 0, v230
  v_cvt_pk_bf16_f32 v231, 0, v231
  v_permlane32_swap_b32 v221, v222
  v_add_f32 v221, v221, v222
  v_mul_f32 v221, 0x3b000000, v221
  v_cvt_pk_bf16_f32 v221, 0, v221
  v_add_f32 v221, 0x3727c5ac, v221
  v_cvt_pk_bf16_f32 v221, 0, v221
  v_sqrt_f32 v221, v221
  s_nop 0
  v_cvt_pk_bf16_f32 v221, 0, v221
  v_rcp_f32 v221, v221
  s_nop 0
  v_mul_f32 v224, v224, v221
  v_mul_f32 v225, v225, v221
  v_mul_f32 v226, v226, v221
  v_mul_f32 v227, v227, v221
  v_mul_f32 v228, v228, v221
  v_mul_f32 v229, v229, v221
  v_mul_f32 v230, v230, v221
  v_mul_f32 v231, v231, v221
  v_cvt_pk_bf16_f32 v196, v224, v225
  v_cvt_pk_bf16_f32 v197, v226, v227
  v_cvt_pk_bf16_f32 v198, v228, v229
  v_cvt_pk_bf16_f32 v199, v230, v231
  buffer_store_dwordx4 v[196:199], v0, s[4:7], s29 offen sc1
  s_add_u32 s29, s29, 262144
  s_waitcnt vmcnt(40)
  v_lshlrev_b32 v212, 16, v200
  v_and_b32 v213, 0xffff0000, v200
  v_lshlrev_b32 v214, 16, v201
  v_and_b32 v215, 0xffff0000, v201
  v_lshlrev_b32 v216, 16, v202
  v_and_b32 v217, 0xffff0000, v202
  v_lshlrev_b32 v218, 16, v203
  v_and_b32 v219, 0xffff0000, v203
  v_add_f32 v220, v212, v213
  v_add_f32 v221, v214, v215
  v_add_f32 v222, v216, v217
  v_add_f32 v223, v218, v219
  v_add_f32 v220, v220, v221
  v_add_f32 v222, v222, v223
  v_add_f32 v220, v220, v222
  s_nop 1
  v_add_f32_dpp v220, v220, v220 row_ror:8 row_mask:0xf bank_mask:0xf
  s_nop 1
  v_add_f32_dpp v220, v220, v220 row_ror:4 row_mask:0xf bank_mask:0xf
  s_nop 1
  v_add_f32_dpp v220, v220, v220 row_ror:2 row_mask:0xf bank_mask:0xf
  s_nop 1
  v_add_f32_dpp v220, v220, v220 row_ror:1 row_mask:0xf bank_mask:0xf
  v_mov_b32 v222, v220
  s_nop 0
  s_nop 0
  v_permlane16_swap_b32 v220, v222
  v_add_f32 v220, v220, v222
  v_mov_b32 v222, v220
  s_nop 0
  s_nop 0
  v_permlane32_swap_b32 v220, v222
  v_add_f32 v220, v220, v222
  v_mul_f32 v220, 0x3b000000, v220
  v_sub_f32 v224, v212, v220
  v_sub_f32 v225, v213, v220
  v_sub_f32 v226, v214, v220
  v_sub_f32 v227, v215, v220
  v_sub_f32 v228, v216, v220
  v_sub_f32 v229, v217, v220
  v_sub_f32 v230, v218, v220
  v_sub_f32 v231, v219, v220
  v_mul_f32 v221, v224, v224
  v_mul_f32 v222, v225, v225
  v_fmac_f32 v221, v226, v226
  v_fmac_f32 v222, v227, v227
  v_fmac_f32 v221, v228, v228
  v_fmac_f32 v222, v229, v229
  v_fmac_f32 v221, v230, v230
  v_fmac_f32 v222, v231, v231
  v_add_f32 v221, v221, v222
  v_cvt_pk_bf16_f32 v220, 0, v220
  s_nop 0
  v_add_f32_dpp v221, v221, v221 row_ror:8 row_mask:0xf bank_mask:0xf
  v_sub_f32 v224, v212, v220
  v_sub_f32 v225, v213, v220
  v_add_f32_dpp v221, v221, v221 row_ror:4 row_mask:0xf bank_mask:0xf
  v_sub_f32 v226, v214, v220
  v_sub_f32 v227, v215, v220
  v_add_f32_dpp v221, v221, v221 row_ror:2 row_mask:0xf bank_mask:0xf
  v_sub_f32 v228, v216, v220
  v_sub_f32 v229, v217, v220
  v_add_f32_dpp v221, v221, v221 row_ror:1 row_mask:0xf bank_mask:0xf
  v_sub_f32 v230, v218, v220
  v_sub_f32 v231, v219, v220
  v_mov_b32 v222, v221
  v_cvt_pk_bf16_f32 v224, 0, v224
  v_cvt_pk_bf16_f32 v225, 0, v225
  v_permlane16_swap_b32 v221, v222
  v_cvt_pk_bf16_f32 v226, 0, v226
  v_cvt_pk_bf16_f32 v227, 0, v227
  v_add_f32 v221, v221, v222
  v_cvt_pk_bf16_f32 v228, 0, v228
  v_cvt_pk_bf16_f32 v229, 0, v229
  v_mov_b32 v222, v221
  v_cvt_pk_bf16_f32 v230, 0, v230
  v_cvt_pk_bf16_f32 v231, 0, v231
  v_permlane32_swap_b32 v221, v222
  v_add_f32 v221, v221, v222
  v_mul_f32 v221, 0x3b000000, v221
  v_cvt_pk_bf16_f32 v221, 0, v221
  v_add_f32 v221, 0x3727c5ac, v221
  v_cvt_pk_bf16_f32 v221, 0, v221
  v_sqrt_f32 v221, v221
  s_nop 0
  v_cvt_pk_bf16_f32 v221, 0, v221
  v_rcp_f32 v221, v221
  s_nop 0
  v_mul_f32 v224, v224, v221
  v_mul_f32 v225, v225, v221
  v_mul_f32 v226, v226, v221
  v_mul_f32 v227, v227, v221
  v_mul_f32 v228, v228, v221
  v_mul_f32 v229, v229, v221
  v_mul_f32 v230, v230, v221
  v_mul_f32 v231, v231, v221
  v_cvt_pk_bf16_f32 v200, v224, v225
  v_cvt_pk_bf16_f32 v201, v226, v227
  v_cvt_pk_bf16_f32 v202, v228, v229
  v_cvt_pk_bf16_f32 v203, v230, v231
  buffer_store_dwordx4 v[200:203], v0, s[4:7], s29 offen sc1
  s_add_u32 s29, s29, 262144
  s_waitcnt vmcnt(40)
  v_lshlrev_b32 v212, 16, v204
  v_and_b32 v213, 0xffff0000, v204
  v_lshlrev_b32 v214, 16, v205
  v_and_b32 v215, 0xffff0000, v205
  v_lshlrev_b32 v216, 16, v206
  v_and_b32 v217, 0xffff0000, v206
  v_lshlrev_b32 v218, 16, v207
  v_and_b32 v219, 0xffff0000, v207
  v_add_f32 v220, v212, v213
  v_add_f32 v221, v214, v215
  v_add_f32 v222, v216, v217
  v_add_f32 v223, v218, v219
  v_add_f32 v220, v220, v221
  v_add_f32 v222, v222, v223
  v_add_f32 v220, v220, v222
  s_nop 1
  v_add_f32_dpp v220, v220, v220 row_ror:8 row_mask:0xf bank_mask:0xf
  s_nop 1
  v_add_f32_dpp v220, v220, v220 row_ror:4 row_mask:0xf bank_mask:0xf
  s_nop 1
  v_add_f32_dpp v220, v220, v220 row_ror:2 row_mask:0xf bank_mask:0xf
  s_nop 1
  v_add_f32_dpp v220, v220, v220 row_ror:1 row_mask:0xf bank_mask:0xf
  v_mov_b32 v222, v220
  s_nop 0
  s_nop 0
  v_permlane16_swap_b32 v220, v222
  v_add_f32 v220, v220, v222
  v_mov_b32 v222, v220
  s_nop 0
  s_nop 0
  v_permlane32_swap_b32 v220, v222
  v_add_f32 v220, v220, v222
  v_mul_f32 v220, 0x3b000000, v220
  v_sub_f32 v224, v212, v220
  v_sub_f32 v225, v213, v220
  v_sub_f32 v226, v214, v220
  v_sub_f32 v227, v215, v220
  v_sub_f32 v228, v216, v220
  v_sub_f32 v229, v217, v220
  v_sub_f32 v230, v218, v220
  v_sub_f32 v231, v219, v220
  v_mul_f32 v221, v224, v224
  v_mul_f32 v222, v225, v225
  v_fmac_f32 v221, v226, v226
  v_fmac_f32 v222, v227, v227
  v_fmac_f32 v221, v228, v228
  v_fmac_f32 v222, v229, v229
  v_fmac_f32 v221, v230, v230
  v_fmac_f32 v222, v231, v231
  v_add_f32 v221, v221, v222
  v_cvt_pk_bf16_f32 v220, 0, v220
  s_nop 0
  v_add_f32_dpp v221, v221, v221 row_ror:8 row_mask:0xf bank_mask:0xf
  v_sub_f32 v224, v212, v220
  v_sub_f32 v225, v213, v220
  v_add_f32_dpp v221, v221, v221 row_ror:4 row_mask:0xf bank_mask:0xf
  v_sub_f32 v226, v214, v220
  v_sub_f32 v227, v215, v220
  v_add_f32_dpp v221, v221, v221 row_ror:2 row_mask:0xf bank_mask:0xf
  v_sub_f32 v228, v216, v220
  v_sub_f32 v229, v217, v220
  v_add_f32_dpp v221, v221, v221 row_ror:1 row_mask:0xf bank_mask:0xf
  v_sub_f32 v230, v218, v220
  v_sub_f32 v231, v219, v220
  v_mov_b32 v222, v221
  v_cvt_pk_bf16_f32 v224, 0, v224
  v_cvt_pk_bf16_f32 v225, 0, v225
  v_permlane16_swap_b32 v221, v222
  v_cvt_pk_bf16_f32 v226, 0, v226
  v_cvt_pk_bf16_f32 v227, 0, v227
  v_add_f32 v221, v221, v222
  v_cvt_pk_bf16_f32 v228, 0, v228
  v_cvt_pk_bf16_f32 v229, 0, v229
  v_mov_b32 v222, v221
  v_cvt_pk_bf16_f32 v230, 0, v230
  v_cvt_pk_bf16_f32 v231, 0, v231
  v_permlane32_swap_b32 v221, v222
  v_add_f32 v221, v221, v222
  v_mul_f32 v221, 0x3b000000, v221
  v_cvt_pk_bf16_f32 v221, 0, v221
  v_add_f32 v221, 0x3727c5ac, v221
  v_cvt_pk_bf16_f32 v221, 0, v221
  v_sqrt_f32 v221, v221
  s_nop 0
  v_cvt_pk_bf16_f32 v221, 0, v221
  v_rcp_f32 v221, v221
  s_nop 0
  v_mul_f32 v224, v224, v221
  v_mul_f32 v225, v225, v221
  v_mul_f32 v226, v226, v221
  v_mul_f32 v227, v227, v221
  v_mul_f32 v228, v228, v221
  v_mul_f32 v229, v229, v221
  v_mul_f32 v230, v230, v221
  v_mul_f32 v231, v231, v221
  v_cvt_pk_bf16_f32 v204, v224, v225
  v_cvt_pk_bf16_f32 v205, v226, v227
  v_cvt_pk_bf16_f32 v206, v228, v229
  v_cvt_pk_bf16_f32 v207, v230, v231
  buffer_store_dwordx4 v[204:207], v0, s[4:7], s29 offen sc1
  s_add_u32 s29, s29, 262144
  s_waitcnt vmcnt(33)
  v_perm_b32 v48, v66, v64, s44
  v_perm_b32 v49, v70, v68, s44
  v_perm_b32 v50, v74, v72, s44
  v_perm_b32 v51, v78, v76, s44
  v_accvgpr_write_b32 a0, v48
  v_accvgpr_write_b32 a1, v49
  v_accvgpr_write_b32 a2, v50
  v_accvgpr_write_b32 a3, v51
  v_perm_b32 v52, v66, v64, s45
  v_perm_b32 v53, v70, v68, s45
  v_perm_b32 v54, v74, v72, s45
  v_perm_b32 v55, v78, v76, s45
  v_accvgpr_write_b32 a4, v52
  v_accvgpr_write_b32 a5, v53
  v_accvgpr_write_b32 a6, v54
  v_accvgpr_write_b32 a7, v55
  v_perm_b32 v48, v67, v65, s44
  v_perm_b32 v49, v71, v69, s44
  v_perm_b32 v50, v75, v73, s44
  v_perm_b32 v51, v79, v77, s44
  v_accvgpr_write_b32 a8, v48
  v_accvgpr_write_b32 a9, v49
  v_accvgpr_write_b32 a10, v50
  v_accvgpr_write_b32 a11, v51
  v_perm_b32 v52, v67, v65, s45
  v_perm_b32 v53, v71, v69, s45
  v_perm_b32 v54, v75, v73, s45
  v_perm_b32 v55, v79, v77, s45
  v_accvgpr_write_b32 a12, v52
  v_accvgpr_write_b32 a13, v53
  v_accvgpr_write_b32 a14, v54
  v_accvgpr_write_b32 a15, v55
  s_waitcnt vmcnt(25)
  v_perm_b32 v48, v82, v80, s44
  v_perm_b32 v49, v86, v84, s44
  v_perm_b32 v50, v90, v88, s44
  v_perm_b32 v51, v94, v92, s44
  v_accvgpr_write_b32 a16, v48
  v_accvgpr_write_b32 a17, v49
  v_accvgpr_write_b32 a18, v50
  v_accvgpr_write_b32 a19, v51
  v_perm_b32 v52, v82, v80, s45
  v_perm_b32 v53, v86, v84, s45
  v_perm_b32 v54, v90, v88, s45
  v_perm_b32 v55, v94, v92, s45
  v_accvgpr_write_b32 a20, v52
  v_accvgpr_write_b32 a21, v53
  v_accvgpr_write_b32 a22, v54
  v_accvgpr_write_b32 a23, v55
  v_perm_b32 v48, v83, v81, s44
  v_perm_b32 v49, v87, v85, s44
  v_perm_b32 v50, v91, v89, s44
  v_perm_b32 v51, v95, v93, s44
  v_accvgpr_write_b32 a24, v48
  v_accvgpr_write_b32 a25, v49
  v_accvgpr_write_b32 a26, v50
  v_accvgpr_write_b32 a27, v51
  v_perm_b32 v52, v83, v81, s45
  v_perm_b32 v53, v87, v85, s45
  v_perm_b32 v54, v91, v89, s45
  v_perm_b32 v55, v95, v93, s45
  v_accvgpr_write_b32 a28, v52
  v_accvgpr_write_b32 a29, v53
  v_accvgpr_write_b32 a30, v54
  v_accvgpr_write_b32 a31, v55
  s_waitcnt vmcnt(17)
  v_perm_b32 v48, v98, v96, s44
  v_perm_b32 v49, v102, v100, s44
  v_perm_b32 v50, v106, v104, s44
  v_perm_b32 v51, v110, v108, s44
  v_accvgpr_write_b32 a32, v48
  v_accvgpr_write_b32 a33, v49
  v_accvgpr_write_b32 a34, v50
  v_accvgpr_write_b32 a35, v51
  v_perm_b32 v52, v98, v96, s45
  v_perm_b32 v53, v102, v100, s45
  v_perm_b32 v54, v106, v104, s45
  v_perm_b32 v55, v110, v108, s45
  v_accvgpr_write_b32 a36, v52
  v_accvgpr_write_b32 a37, v53
  v_accvgpr_write_b32 a38, v54
  v_accvgpr_write_b32 a39, v55
  v_perm_b32 v48, v99, v97, s44
  v_perm_b32 v49, v103, v101, s44
  v_perm_b32 v50, v107, v105, s44
  v_perm_b32 v51, v111, v109, s44
  v_accvgpr_write_b32 a40, v48
  v_accvgpr_write_b32 a41, v49
  v_accvgpr_write_b32 a42, v50
  v_accvgpr_write_b32 a43, v51
  v_perm_b32 v52, v99, v97, s45
  v_perm_b32 v53, v103, v101, s45
  v_perm_b32 v54, v107, v105, s45
  v_perm_b32 v55, v111, v109, s45
  v_accvgpr_write_b32 a44, v52
  v_accvgpr_write_b32 a45, v53
  v_accvgpr_write_b32 a46, v54
  v_accvgpr_write_b32 a47, v55
  s_waitcnt vmcnt(9)
  v_perm_b32 v48, v114, v112, s44
  v_perm_b32 v49, v118, v116, s44
  v_perm_b32 v50, v122, v120, s44
  v_perm_b32 v51, v126, v124, s44
  v_accvgpr_write_b32 a48, v48
  v_accvgpr_write_b32 a49, v49
  v_accvgpr_write_b32 a50, v50
  v_accvgpr_write_b32 a51, v51
  v_perm_b32 v52, v114, v112, s45
  v_perm_b32 v53, v118, v116, s45
  v_perm_b32 v54, v122, v120, s45
  v_perm_b32 v55, v126, v124, s45
  v_accvgpr_write_b32 a52, v52
  v_accvgpr_write_b32 a53, v53
  v_accvgpr_write_b32 a54, v54
  v_accvgpr_write_b32 a55, v55
  v_perm_b32 v48, v115, v113, s44
  v_perm_b32 v49, v119, v117, s44
  v_perm_b32 v50, v123, v121, s44
  v_perm_b32 v51, v127, v125, s44
  v_accvgpr_write_b32 a56, v48
  v_accvgpr_write_b32 a57, v49
  v_accvgpr_write_b32 a58, v50
  v_accvgpr_write_b32 a59, v51
  v_perm_b32 v52, v115, v113, s45
  v_perm_b32 v53, v119, v117, s45
  v_perm_b32 v54, v123, v121, s45
  v_perm_b32 v55, v127, v125, s45
  v_accvgpr_write_b32 a60, v52
  v_accvgpr_write_b32 a61, v53
  v_accvgpr_write_b32 a62, v54
  v_accvgpr_write_b32 a63, v55
  v_mbcnt_lo_u32_b32 v60, -1, 0
  v_and_b32 v60, 0, v60
  v_add_lshl_u32 v60, v60, 1, 2
  s_mov_b32 s26, 0
g_wt_77:
  global_load_dword v61, v60, s[12:13] offset:128 sc1
  s_add_u32 s26, s26, 1
  s_cmp_gt_u32 s26, 1048576
  s_cbranch_scc1 L_end
  s_waitcnt vmcnt(0)
  v_cmp_eq_u32 vcc, 0, v61
  v_readfirstlane_b32 s27, v61
  s_cbranch_vccnz g_wt_77
  s_lshl_b32 s27, s77, 7
  s_add_u32 s27, s27, 243269632
  v_lshlrev_b32 v61, 11, v0
  v_mov_b32 v60, 1
  s_mov_b64 exec, 255
  buffer_store_dword v60, v61, s[4:7], s27 offen sc1
  s_mov_b64 exec, -1
  s_add_u32 s27, s30, 65536
  buffer_load_dwordx2 v[128:129], v44, s[80:83], s27 offen
  s_add_u32 s27, s30, 66560
  buffer_load_dwordx2 v[130:131], v44, s[80:83], s27 offen
  s_add_u32 s27, s30, 67584
  buffer_load_dwordx2 v[132:133], v44, s[80:83], s27 offen
  s_add_u32 s27, s30, 68608
  buffer_load_dwordx2 v[134:135], v44, s[80:83], s27 offen
  s_add_u32 s27, s30, 81920
  buffer_load_dwordx2 v[136:137], v44, s[80:83], s27 offen
  s_add_u32 s27, s30, 82944
  buffer_load_dwordx2 v[138:139], v44, s[80:83], s27 offen
  s_add_u32 s27, s30, 83968
  buffer_load_dwordx2 v[140:141], v44, s[80:83], s27 offen
  s_add_u32 s27, s30, 84992
  buffer_load_dwordx2 v[142:143], v44, s[80:83], s27 offen
  s_add_u32 s27, s30, 73728
  buffer_load_dwordx2 v[144:145], v44, s[80:83], s27 offen
  s_add_u32 s27, s30, 74752
  buffer_load_dwordx2 v[146:147], v44, s[80:83], s27 offen
  s_add_u32 s27, s30, 75776
  buffer_load_dwordx2 v[148:149], v44, s[80:83], s27 offen
  s_add_u32 s27, s30, 76800
  buffer_load_dwordx2 v[150:151], v44, s[80:83], s27 offen
  s_add_u32 s27, s30, 90112
  buffer_load_dwordx2 v[152:153], v44, s[80:83], s27 offen
  s_add_u32 s27, s30, 91136
  buffer_load_dwordx2 v[154:155], v44, s[80:83], s27 offen
  s_add_u32 s27, s30, 92160
  buffer_load_dwordx2 v[156:157], v44, s[80:83], s27 offen
  s_add_u32 s27, s30, 93184
  buffer_load_dwordx2 v[158:159], v44, s[80:83], s27 offen
  s_add_u32 s27, s30, 98304
  buffer_load_dwordx2 v[160:161], v44, s[80:83], s27 offen
  s_add_u32 s27, s30, 99328
  buffer_load_dwordx2 v[162:163], v44, s[80:83], s27 offen
  s_add_u32 s27, s30, 100352
  buffer_load_dwordx2 v[164:165], v44, s[80:83], s27 offen
  s_add_u32 s27, s30, 101376
  buffer_load_dwordx2 v[166:167], v44, s[80:83], s27 offen
  s_add_u32 s27, s30, 114688
  buffer_load_dwordx2 v[168:169], v44, s[80:83], s27 offen
  s_add_u32 s27, s30, 115712
  buffer_load_dwordx2 v[170:171], v44, s[80:83], s27 offen
  s_add_u32 s27, s30, 116736
  buffer_load_dwordx2 v[172:173], v44, s[80:83], s27 offen
  s_add_u32 s27, s30, 117760
  buffer_load_dwordx2 v[174:175], v44, s[80:83], s27 offen
  s_add_u32 s27, s30, 106496
  buffer_load_dwordx2 v[64:65], v44, s[80:83], s27 offen
  s_add_u32 s27, s30, 107520
  buffer_load_dwordx2 v[66:67], v44, s[80:83], s27 offen
  s_add_u32 s27, s30, 108544
  buffer_load_dwordx2 v[68:69], v44, s[80:83], s27 offen
  s_add_u32 s27, s30, 109568
  buffer_load_dwordx2 v[70:71], v44, s[80:83], s27 offen
  s_add_u32 s27, s30, 122880
  buffer_load_dwordx2 v[72:73], v44, s[80:83], s27 offen
  s_add_u32 s27, s30, 123904
  buffer_load_dwordx2 v[74:75], v44, s[80:83], s27 offen
  s_add_u32 s27, s30, 124928
  buffer_load_dwordx2 v[76:77], v44, s[80:83], s27 offen
  s_add_u32 s27, s30, 125952
  buffer_load_dwordx2 v[78:79], v44, s[80:83], s27 offen
  s_add_u32 s27, s30, 131072
  buffer_load_dwordx2 v[80:81], v44, s[80:83], s27 offen
  s_add_u32 s27, s30, 132096
  buffer_load_dwordx2 v[82:83], v44, s[80:83], s27 offen
  s_add_u32 s27, s30, 133120
  buffer_load_dwordx2 v[84:85], v44, s[80:83], s27 offen
  s_add_u32 s27, s30, 134144
  buffer_load_dwordx2 v[86:87], v44, s[80:83], s27 offen
  s_add_u32 s27, s30, 147456
  buffer_load_dwordx2 v[88:89], v44, s[80:83], s27 offen
  s_add_u32 s27, s30, 148480
  buffer_load_dwordx2 v[90:91], v44, s[80:83], s27 offen
  s_add_u32 s27, s30, 149504
  buffer_load_dwordx2 v[92:93], v44, s[80:83], s27 offen
  s_add_u32 s27, s30, 150528
  buffer_load_dwordx2 v[94:95], v44, s[80:83], s27 offen
  s_add_u32 s27, s30, 139264
  buffer_load_dwordx2 v[96:97], v44, s[80:83], s27 offen
  s_add_u32 s27, s30, 140288
  buffer_load_dwordx2 v[98:99], v44, s[80:83], s27 offen
  s_add_u32 s27, s30, 141312
  buffer_load_dwordx2 v[100:101], v44, s[80:83], s27 offen
  s_add_u32 s27, s30, 142336
  buffer_load_dwordx2 v[102:103], v44, s[80:83], s27 offen
  s_add_u32 s27, s30, 155648
  buffer_load_dwordx2 v[104:105], v44, s[80:83], s27 offen
  s_add_u32 s27, s30, 156672
  buffer_load_dwordx2 v[106:107], v44, s[80:83], s27 offen
  s_add_u32 s27, s30, 157696
  buffer_load_dwordx2 v[108:109], v44, s[80:83], s27 offen
  s_add_u32 s27, s30, 158720
  buffer_load_dwordx2 v[110:111], v44, s[80:83], s27 offen
  s_add_u32 s27, s30, 163840
  buffer_load_dwordx2 v[112:113], v44, s[80:83], s27 offen
  s_add_u32 s27, s30, 164864
  buffer_load_dwordx2 v[114:115], v44, s[80:83], s27 offen
  s_add_u32 s27, s30, 165888
  buffer_load_dwordx2 v[116:117], v44, s[80:83], s27 offen
  s_add_u32 s27, s30, 166912
  buffer_load_dwordx2 v[118:119], v44, s[80:83], s27 offen
  s_add_u32 s27, s30, 180224
  buffer_load_dwordx2 v[120:121], v44, s[80:83], s27 offen
  s_add_u32 s27, s30, 181248
  buffer_load_dwordx2 v[122:123], v44, s[80:83], s27 offen
  s_add_u32 s27, s30, 182272
  buffer_load_dwordx2 v[124:125], v44, s[80:83], s27 offen
  s_add_u32 s27, s30, 183296
  buffer_load_dwordx2 v[126:127], v44, s[80:83], s27 offen
  v_lshlrev_b32 v8, 16, v56
  v_and_b32 v9, 0xffff0000, v56
  v_lshlrev_b32 v10, 16, v57
  v_and_b32 v11, 0xffff0000, v57
  v_lshlrev_b32 v12, 16, v58
  v_and_b32 v13, 0xffff0000, v58
  v_lshlrev_b32 v14, 16, v59
  v_and_b32 v15, 0xffff0000, v59
  v_mul_f32 v56, v8, v8
  v_fmac_f32 v56, v9, v9
  v_fmac_f32 v56, v10, v10
  v_fmac_f32 v56, v11, v11
  v_fmac_f32 v56, v12, v12
  v_fmac_f32 v56, v13, v13
  v_fmac_f32 v56, v14, v14
  v_fmac_f32 v56, v15, v15
  s_nop 0
  s_nop 0
  v_add_f32_dpp v56, v56, v56 row_ror:8 row_mask:0xf bank_mask:0xf
  s_nop 1
  v_add_f32_dpp v56, v56, v56 row_ror:4 row_mask:0xf bank_mask:0xf
  s_nop 1
  v_add_f32_dpp v56, v56, v56 row_ror:2 row_mask:0xf bank_mask:0xf
  s_nop 1
  v_add_f32_dpp v56, v56, v56 row_ror:1 row_mask:0xf bank_mask:0xf
  v_mov_b32 v57, v56
  s_nop 0
  s_nop 0
  v_permlane16_swap_b32 v56, v57
  v_add_f32 v56, v56, v57
  v_mov_b32 v57, v56
  s_nop 0
  s_nop 0
  v_permlane32_swap_b32 v56, v57
  v_add_f32 v56, v56, v57
  v_sqrt_f32 v56, v56
  s_mov_b32 s28, 0x40598569
  v_writelane_b32 v247, s28, 0
  s_mov_b32 s28, 0x40598569
  v_writelane_b32 v247, s28, 1
  s_mov_b32 s28, 0x4058ade7
  v_writelane_b32 v247, s28, 2
  s_mov_b32 s28, 0x40577c32
  v_writelane_b32 v247, s28, 3
  s_mov_b32 s28, 0x40563297
  v_writelane_b32 v247, s28, 4
  s_mov_b32 s28, 0x4054cd28
  v_writelane_b32 v247, s28, 5
  s_mov_b32 s28, 0x405346f2
  v_writelane_b32 v247, s28, 6
  s_mov_b32 s28, 0x40519992
  v_writelane_b32 v247, s28, 7
  s_mov_b32 s28, 0x404fbc99
  v_writelane_b32 v247, s28, 8
  s_mov_b32 s28, 0x404da49a
  v_writelane_b32 v247, s28, 9
  s_mov_b32 s28, 0x404b418a
  v_writelane_b32 v247, s28, 10
  s_mov_b32 s28, 0x40487bed
  v_writelane_b32 v247, s28, 11
  s_mov_b32 s28, 0x40452f68
  v_writelane_b32 v247, s28, 12
  s_mov_b32 s28, 0x40411f69
  v_writelane_b32 v247, s28, 13
  s_mov_b32 s28, 0x403bdbac
  v_writelane_b32 v247, s28, 14
  s_mov_b32 s28, 0x40346eae
  v_writelane_b32 v247, s28, 15
  s_mov_b32 s28, 0x4028005c
  v_writelane_b32 v247, s28, 16
  s_mov_b32 s28, 0x4001516e
  v_writelane_b32 v247, s28, 17
  s_mov_b32 s28, 0x4001516e
  v_writelane_b32 v247, s28, 18
  v_mul_f32 v247, v247, v56
  v_or_b32 v247, 0x80000000, v247
  s_lshl_b32 s29, s61, 2
  s_add_u32 s29, s29, s17
  s_lshl_b32 s29, s29, 13
  s_add_u32 s29, s29, s41
  v_mov_b64 v[208:209], 0
  v_mov_b64 v[210:211], 0
  s_waitcnt vmcnt(48)
  v_perm_b32 v48, v130, v128, s44
  v_perm_b32 v49, v134, v132, s44
  v_perm_b32 v50, v138, v136, s44
  v_perm_b32 v51, v142, v140, s44
  v_accvgpr_write_b32 a64, v48
  v_accvgpr_write_b32 a65, v49
  v_accvgpr_write_b32 a66, v50
  v_accvgpr_write_b32 a67, v51
  v_perm_b32 v52, v130, v128, s45
  v_perm_b32 v53, v134, v132, s45
  v_perm_b32 v54, v138, v136, s45
  v_perm_b32 v55, v142, v140, s45
  v_accvgpr_write_b32 a68, v52
  v_accvgpr_write_b32 a69, v53
  v_accvgpr_write_b32 a70, v54
  v_accvgpr_write_b32 a71, v55
  v_perm_b32 v48, v131, v129, s44
  v_perm_b32 v49, v135, v133, s44
  v_perm_b32 v50, v139, v137, s44
  v_perm_b32 v51, v143, v141, s44
  v_accvgpr_write_b32 a72, v48
  v_accvgpr_write_b32 a73, v49
  v_accvgpr_write_b32 a74, v50
  v_accvgpr_write_b32 a75, v51
  v_perm_b32 v52, v131, v129, s45
  v_perm_b32 v53, v135, v133, s45
  v_perm_b32 v54, v139, v137, s45
  v_perm_b32 v55, v143, v141, s45
  v_accvgpr_write_b32 a76, v52
  v_accvgpr_write_b32 a77, v53
  v_accvgpr_write_b32 a78, v54
  v_accvgpr_write_b32 a79, v55
  s_add_u32 s27, s30, 172032
  buffer_load_dwordx2 v[128:129], v44, s[80:83], s27 offen
  s_add_u32 s27, s30, 173056
  buffer_load_dwordx2 v[130:131], v44, s[80:83], s27 offen
  s_add_u32 s27, s30, 174080
  buffer_load_dwordx2 v[132:133], v44, s[80:83], s27 offen
  s_add_u32 s27, s30, 175104
  buffer_load_dwordx2 v[134:135], v44, s[80:83], s27 offen
  s_add_u32 s27, s30, 188416
  buffer_load_dwordx2 v[136:137], v44, s[80:83], s27 offen
  s_add_u32 s27, s30, 189440
  buffer_load_dwordx2 v[138:139], v44, s[80:83], s27 offen
  s_add_u32 s27, s30, 190464
  buffer_load_dwordx2 v[140:141], v44, s[80:83], s27 offen
  s_add_u32 s27, s30, 191488
  buffer_load_dwordx2 v[142:143], v44, s[80:83], s27 offen
  s_waitcnt vmcnt(48)
  v_perm_b32 v48, v146, v144, s44
  v_perm_b32 v49, v150, v148, s44
  v_perm_b32 v50, v154, v152, s44
  v_perm_b32 v51, v158, v156, s44
  v_accvgpr_write_b32 a80, v48
  v_accvgpr_write_b32 a81, v49
  v_accvgpr_write_b32 a82, v50
  v_accvgpr_write_b32 a83, v51
  v_perm_b32 v52, v146, v144, s45
  v_perm_b32 v53, v150, v148, s45
  v_perm_b32 v54, v154, v152, s45
  v_perm_b32 v55, v158, v156, s45
  v_accvgpr_write_b32 a84, v52
  v_accvgpr_write_b32 a85, v53
  v_accvgpr_write_b32 a86, v54
  v_accvgpr_write_b32 a87, v55
  v_perm_b32 v48, v147, v145, s44
  v_perm_b32 v49, v151, v149, s44
  v_perm_b32 v50, v155, v153, s44
  v_perm_b32 v51, v159, v157, s44
  v_accvgpr_write_b32 a88, v48
  v_accvgpr_write_b32 a89, v49
  v_accvgpr_write_b32 a90, v50
  v_accvgpr_write_b32 a91, v51
  v_perm_b32 v52, v147, v145, s45
  v_perm_b32 v53, v151, v149, s45
  v_perm_b32 v54, v155, v153, s45
  v_perm_b32 v55, v159, v157, s45
  v_accvgpr_write_b32 a92, v52
  v_accvgpr_write_b32 a93, v53
  v_accvgpr_write_b32 a94, v54
  v_accvgpr_write_b32 a95, v55
  s_add_u32 s27, s30, 196608
  buffer_load_dwordx2 v[144:145], v44, s[80:83], s27 offen
  s_add_u32 s27, s30, 197632
  buffer_load_dwordx2 v[146:147], v44, s[80:83], s27 offen
  s_add_u32 s27, s30, 198656
  buffer_load_dwordx2 v[148:149], v44, s[80:83], s27 offen
  s_add_u32 s27, s30, 199680
  buffer_load_dwordx2 v[150:151], v44, s[80:83], s27 offen
  s_add_u32 s27, s30, 212992
  buffer_load_dwordx2 v[152:153], v44, s[80:83], s27 offen
  s_add_u32 s27, s30, 214016
  buffer_load_dwordx2 v[154:155], v44, s[80:83], s27 offen
  s_add_u32 s27, s30, 215040
  buffer_load_dwordx2 v[156:157], v44, s[80:83], s27 offen
  s_add_u32 s27, s30, 216064
  buffer_load_dwordx2 v[158:159], v44, s[80:83], s27 offen
  s_waitcnt vmcnt(48)
  v_perm_b32 v48, v162, v160, s44
  v_perm_b32 v49, v166, v164, s44
  v_perm_b32 v50, v170, v168, s44
  v_perm_b32 v51, v174, v172, s44
  v_accvgpr_write_b32 a96, v48
  v_accvgpr_write_b32 a97, v49
  v_accvgpr_write_b32 a98, v50
  v_accvgpr_write_b32 a99, v51
  v_perm_b32 v52, v162, v160, s45
  v_perm_b32 v53, v166, v164, s45
  v_perm_b32 v54, v170, v168, s45
  v_perm_b32 v55, v174, v172, s45
  v_accvgpr_write_b32 a100, v52
  v_accvgpr_write_b32 a101, v53
  v_accvgpr_write_b32 a102, v54
  v_accvgpr_write_b32 a103, v55
  v_perm_b32 v48, v163, v161, s44
  v_perm_b32 v49, v167, v165, s44
  v_perm_b32 v50, v171, v169, s44
  v_perm_b32 v51, v175, v173, s44
  v_accvgpr_write_b32 a104, v48
  v_accvgpr_write_b32 a105, v49
  v_accvgpr_write_b32 a106, v50
  v_accvgpr_write_b32 a107, v51
  v_perm_b32 v52, v163, v161, s45
  v_perm_b32 v53, v167, v165, s45
  v_perm_b32 v54, v171, v169, s45
  v_perm_b32 v55, v175, v173, s45
  v_accvgpr_write_b32 a108, v52
  v_accvgpr_write_b32 a109, v53
  v_accvgpr_write_b32 a110, v54
  v_accvgpr_write_b32 a111, v55
  s_add_u32 s27, s30, 204800
  buffer_load_dwordx2 v[160:161], v44, s[80:83], s27 offen
  s_add_u32 s27, s30, 205824
  buffer_load_dwordx2 v[162:163], v44, s[80:83], s27 offen
  s_add_u32 s27, s30, 206848
  buffer_load_dwordx2 v[164:165], v44, s[80:83], s27 offen
  s_add_u32 s27, s30, 207872
  buffer_load_dwordx2 v[166:167], v44, s[80:83], s27 offen
  s_add_u32 s27, s30, 221184
  buffer_load_dwordx2 v[168:169], v44, s[80:83], s27 offen
  s_add_u32 s27, s30, 222208
  buffer_load_dwordx2 v[170:171], v44, s[80:83], s27 offen
  s_add_u32 s27, s30, 223232
  buffer_load_dwordx2 v[172:173], v44, s[80:83], s27 offen
  s_add_u32 s27, s30, 224256
  buffer_load_dwordx2 v[174:175], v44, s[80:83], s27 offen
  s_waitcnt vmcnt(48)
  v_perm_b32 v48, v66, v64, s44
  v_perm_b32 v49, v70, v68, s44
  v_perm_b32 v50, v74, v72, s44
  v_perm_b32 v51, v78, v76, s44
  v_accvgpr_write_b32 a112, v48
  v_accvgpr_write_b32 a113, v49
  v_accvgpr_write_b32 a114, v50
  v_accvgpr_write_b32 a115, v51
  v_perm_b32 v52, v66, v64, s45
  v_perm_b32 v53, v70, v68, s45
  v_perm_b32 v54, v74, v72, s45
  v_perm_b32 v55, v78, v76, s45
  v_accvgpr_write_b32 a116, v52
  v_accvgpr_write_b32 a117, v53
  v_accvgpr_write_b32 a118, v54
  v_accvgpr_write_b32 a119, v55
  v_perm_b32 v48, v67, v65, s44
  v_perm_b32 v49, v71, v69, s44
  v_perm_b32 v50, v75, v73, s44
  v_perm_b32 v51, v79, v77, s44
  v_accvgpr_write_b32 a120, v48
  v_accvgpr_write_b32 a121, v49
  v_accvgpr_write_b32 a122, v50
  v_accvgpr_write_b32 a123, v51
  v_perm_b32 v52, v67, v65, s45
  v_perm_b32 v53, v71, v69, s45
  v_perm_b32 v54, v75, v73, s45
  v_perm_b32 v55, v79, v77, s45
  v_accvgpr_write_b32 a124, v52
  v_accvgpr_write_b32 a125, v53
  v_accvgpr_write_b32 a126, v54
  v_accvgpr_write_b32 a127, v55
  s_add_u32 s27, s30, 229376
  buffer_load_dwordx2 v[64:65], v44, s[80:83], s27 offen
  s_add_u32 s27, s30, 230400
  buffer_load_dwordx2 v[66:67], v44, s[80:83], s27 offen
  s_add_u32 s27, s30, 231424
  buffer_load_dwordx2 v[68:69], v44, s[80:83], s27 offen
  s_add_u32 s27, s30, 232448
  buffer_load_dwordx2 v[70:71], v44, s[80:83], s27 offen
  s_add_u32 s27, s30, 245760
  buffer_load_dwordx2 v[72:73], v44, s[80:83], s27 offen
  s_add_u32 s27, s30, 246784
  buffer_load_dwordx2 v[74:75], v44, s[80:83], s27 offen
  s_add_u32 s27, s30, 247808
  buffer_load_dwordx2 v[76:77], v44, s[80:83], s27 offen
  s_add_u32 s27, s30, 248832
  buffer_load_dwordx2 v[78:79], v44, s[80:83], s27 offen
  s_waitcnt vmcnt(48)
  v_perm_b32 v48, v82, v80, s44
  v_perm_b32 v49, v86, v84, s44
  v_perm_b32 v50, v90, v88, s44
  v_perm_b32 v51, v94, v92, s44
  v_accvgpr_write_b32 a128, v48
  v_accvgpr_write_b32 a129, v49
  v_accvgpr_write_b32 a130, v50
  v_accvgpr_write_b32 a131, v51
  v_perm_b32 v52, v82, v80, s45
  v_perm_b32 v53, v86, v84, s45
  v_perm_b32 v54, v90, v88, s45
  v_perm_b32 v55, v94, v92, s45
  v_accvgpr_write_b32 a132, v52
  v_accvgpr_write_b32 a133, v53
  v_accvgpr_write_b32 a134, v54
  v_accvgpr_write_b32 a135, v55
  v_perm_b32 v48, v83, v81, s44
  v_perm_b32 v49, v87, v85, s44
  v_perm_b32 v50, v91, v89, s44
  v_perm_b32 v51, v95, v93, s44
  v_accvgpr_write_b32 a136, v48
  v_accvgpr_write_b32 a137, v49
  v_accvgpr_write_b32 a138, v50
  v_accvgpr_write_b32 a139, v51
  v_perm_b32 v52, v83, v81, s45
  v_perm_b32 v53, v87, v85, s45
  v_perm_b32 v54, v91, v89, s45
  v_perm_b32 v55, v95, v93, s45
  v_accvgpr_write_b32 a140, v52
  v_accvgpr_write_b32 a141, v53
  v_accvgpr_write_b32 a142, v54
  v_accvgpr_write_b32 a143, v55
  s_add_u32 s27, s30, 237568
  buffer_load_dwordx2 v[80:81], v44, s[80:83], s27 offen
  s_add_u32 s27, s30, 238592
  buffer_load_dwordx2 v[82:83], v44, s[80:83], s27 offen
  s_add_u32 s27, s30, 239616
  buffer_load_dwordx2 v[84:85], v44, s[80:83], s27 offen
  s_add_u32 s27, s30, 240640
  buffer_load_dwordx2 v[86:87], v44, s[80:83], s27 offen
  s_add_u32 s27, s30, 253952
  buffer_load_dwordx2 v[88:89], v44, s[80:83], s27 offen
  s_add_u32 s27, s30, 254976
  buffer_load_dwordx2 v[90:91], v44, s[80:83], s27 offen
  s_add_u32 s27, s30, 256000
  buffer_load_dwordx2 v[92:93], v44, s[80:83], s27 offen
  s_add_u32 s27, s30, 257024
  buffer_load_dwordx2 v[94:95], v44, s[80:83], s27 offen
  s_waitcnt vmcnt(48)
  v_perm_b32 v48, v98, v96, s44
  v_perm_b32 v49, v102, v100, s44
  v_perm_b32 v50, v106, v104, s44
  v_perm_b32 v51, v110, v108, s44
  v_accvgpr_write_b32 a144, v48
  v_accvgpr_write_b32 a145, v49
  v_accvgpr_write_b32 a146, v50
  v_accvgpr_write_b32 a147, v51
  v_perm_b32 v52, v98, v96, s45
  v_perm_b32 v53, v102, v100, s45
  v_perm_b32 v54, v106, v104, s45
  v_perm_b32 v55, v110, v108, s45
  v_accvgpr_write_b32 a148, v52
  v_accvgpr_write_b32 a149, v53
  v_accvgpr_write_b32 a150, v54
  v_accvgpr_write_b32 a151, v55
  v_perm_b32 v48, v99, v97, s44
  v_perm_b32 v49, v103, v101, s44
  v_perm_b32 v50, v107, v105, s44
  v_perm_b32 v51, v111, v109, s44
  v_accvgpr_write_b32 a152, v48
  v_accvgpr_write_b32 a153, v49
  v_accvgpr_write_b32 a154, v50
  v_accvgpr_write_b32 a155, v51
  v_perm_b32 v52, v99, v97, s45
  v_perm_b32 v53, v103, v101, s45
  v_perm_b32 v54, v107, v105, s45
  v_perm_b32 v55, v111, v109, s45
  v_accvgpr_write_b32 a156, v52
  v_accvgpr_write_b32 a157, v53
  v_accvgpr_write_b32 a158, v54
  v_accvgpr_write_b32 a159, v55
  buffer_store_dwordx4 v[208:211], v0, s[4:7], s29 offen offset:0 sc1
  buffer_store_dwordx4 v[208:211], v0, s[4:7], s29 offen offset:1024 sc1
  buffer_store_dwordx4 v[208:211], v0, s[4:7], s29 offen offset:2048 sc1
  buffer_store_dwordx4 v[208:211], v0, s[4:7], s29 offen offset:3072 sc1
  s_add_u32 s29, s29, 4096
  s_waitcnt vmcnt(44)
  v_perm_b32 v48, v114, v112, s44
  v_perm_b32 v49, v118, v116, s44
  v_perm_b32 v50, v122, v120, s44
  v_perm_b32 v51, v126, v124, s44
  v_accvgpr_write_b32 a160, v48
  v_accvgpr_write_b32 a161, v49
  v_accvgpr_write_b32 a162, v50
  v_accvgpr_write_b32 a163, v51
  v_perm_b32 v52, v114, v112, s45
  v_perm_b32 v53, v118, v116, s45
  v_perm_b32 v54, v122, v120, s45
  v_perm_b32 v55, v126, v124, s45
  v_accvgpr_write_b32 a164, v52
  v_accvgpr_write_b32 a165, v53
  v_accvgpr_write_b32 a166, v54
  v_accvgpr_write_b32 a167, v55
  v_perm_b32 v48, v115, v113, s44
  v_perm_b32 v49, v119, v117, s44
  v_perm_b32 v50, v123, v121, s44
  v_perm_b32 v51, v127, v125, s44
  v_accvgpr_write_b32 a168, v48
  v_accvgpr_write_b32 a169, v49
  v_accvgpr_write_b32 a170, v50
  v_accvgpr_write_b32 a171, v51
  v_perm_b32 v52, v115, v113, s45
  v_perm_b32 v53, v119, v117, s45
  v_perm_b32 v54, v123, v121, s45
  v_perm_b32 v55, v127, v125, s45
  v_accvgpr_write_b32 a172, v52
  v_accvgpr_write_b32 a173, v53
  v_accvgpr_write_b32 a174, v54
  v_accvgpr_write_b32 a175, v55
  buffer_store_dwordx4 v[208:211], v0, s[4:7], s29 offen offset:0 sc1
  buffer_store_dwordx4 v[208:211], v0, s[4:7], s29 offen offset:1024 sc1
  buffer_store_dwordx4 v[208:211], v0, s[4:7], s29 offen offset:2048 sc1
  buffer_store_dwordx4 v[208:211], v0, s[4:7], s29 offen offset:3072 sc1
  s_add_u32 s29, s29, 520192
  s_waitcnt vmcnt(40)
  v_perm_b32 v48, v130, v128, s44
  v_perm_b32 v49, v134, v132, s44
  v_perm_b32 v50, v138, v136, s44
  v_perm_b32 v51, v142, v140, s44
  v_accvgpr_write_b32 a176, v48
  v_accvgpr_write_b32 a177, v49
  v_accvgpr_write_b32 a178, v50
  v_accvgpr_write_b32 a179, v51
  v_perm_b32 v52, v130, v128, s45
  v_perm_b32 v53, v134, v132, s45
  v_perm_b32 v54, v138, v136, s45
  v_perm_b32 v55, v142, v140, s45
  v_accvgpr_write_b32 a180, v52
  v_accvgpr_write_b32 a181, v53
  v_accvgpr_write_b32 a182, v54
  v_accvgpr_write_b32 a183, v55
  v_perm_b32 v48, v131, v129, s44
  v_perm_b32 v49, v135, v133, s44
  v_perm_b32 v50, v139, v137, s44
  v_perm_b32 v51, v143, v141, s44
  v_accvgpr_write_b32 a184, v48
  v_accvgpr_write_b32 a185, v49
  v_accvgpr_write_b32 a186, v50
  v_accvgpr_write_b32 a187, v51
  v_perm_b32 v52, v131, v129, s45
  v_perm_b32 v53, v135, v133, s45
  v_perm_b32 v54, v139, v137, s45
  v_perm_b32 v55, v143, v141, s45
  v_accvgpr_write_b32 a188, v52
  v_accvgpr_write_b32 a189, v53
  v_accvgpr_write_b32 a190, v54
  v_accvgpr_write_b32 a191, v55
  buffer_store_dwordx4 v[208:211], v0, s[4:7], s29 offen offset:0 sc1
  buffer_store_dwordx4 v[208:211], v0, s[4:7], s29 offen offset:1024 sc1
  buffer_store_dwordx4 v[208:211], v0, s[4:7], s29 offen offset:2048 sc1
  buffer_store_dwordx4 v[208:211], v0, s[4:7], s29 offen offset:3072 sc1
  s_add_u32 s29, s29, 4096
  s_waitcnt vmcnt(36)
  v_perm_b32 v48, v146, v144, s44
  v_perm_b32 v49, v150, v148, s44
  v_perm_b32 v50, v154, v152, s44
  v_perm_b32 v51, v158, v156, s44
  v_accvgpr_write_b32 a192, v48
  v_accvgpr_write_b32 a193, v49
  v_accvgpr_write_b32 a194, v50
  v_accvgpr_write_b32 a195, v51
  v_perm_b32 v52, v146, v144, s45
  v_perm_b32 v53, v150, v148, s45
  v_perm_b32 v54, v154, v152, s45
  v_perm_b32 v55, v158, v156, s45
  v_accvgpr_write_b32 a196, v52
  v_accvgpr_write_b32 a197, v53
  v_accvgpr_write_b32 a198, v54
  v_accvgpr_write_b32 a199, v55
  v_perm_b32 v48, v147, v145, s44
  v_perm_b32 v49, v151, v149, s44
  v_perm_b32 v50, v155, v153, s44
  v_perm_b32 v51, v159, v157, s44
  v_accvgpr_write_b32 a200, v48
  v_accvgpr_write_b32 a201, v49
  v_accvgpr_write_b32 a202, v50
  v_accvgpr_write_b32 a203, v51
  v_perm_b32 v52, v147, v145, s45
  v_perm_b32 v53, v151, v149, s45
  v_perm_b32 v54, v155, v153, s45
  v_perm_b32 v55, v159, v157, s45
  v_accvgpr_write_b32 a204, v52
  v_accvgpr_write_b32 a205, v53
  v_accvgpr_write_b32 a206, v54
  v_accvgpr_write_b32 a207, v55
  buffer_store_dwordx4 v[208:211], v0, s[4:7], s29 offen offset:0 sc1
  buffer_store_dwordx4 v[208:211], v0, s[4:7], s29 offen offset:1024 sc1
  buffer_store_dwordx4 v[208:211], v0, s[4:7], s29 offen offset:2048 sc1
  buffer_store_dwordx4 v[208:211], v0, s[4:7], s29 offen offset:3072 sc1
  s_add_u32 s29, s29, 4096
  s_waitcnt vmcnt(32)
  v_perm_b32 v48, v162, v160, s44
  v_perm_b32 v49, v166, v164, s44
  v_perm_b32 v50, v170, v168, s44
  v_perm_b32 v51, v174, v172, s44
  v_accvgpr_write_b32 a208, v48
  v_accvgpr_write_b32 a209, v49
  v_accvgpr_write_b32 a210, v50
  v_accvgpr_write_b32 a211, v51
  v_perm_b32 v52, v162, v160, s45
  v_perm_b32 v53, v166, v164, s45
  v_perm_b32 v54, v170, v168, s45
  v_perm_b32 v55, v174, v172, s45
  v_accvgpr_write_b32 a212, v52
  v_accvgpr_write_b32 a213, v53
  v_accvgpr_write_b32 a214, v54
  v_accvgpr_write_b32 a215, v55
  v_perm_b32 v48, v163, v161, s44
  v_perm_b32 v49, v167, v165, s44
  v_perm_b32 v50, v171, v169, s44
  v_perm_b32 v51, v175, v173, s44
  v_accvgpr_write_b32 a216, v48
  v_accvgpr_write_b32 a217, v49
  v_accvgpr_write_b32 a218, v50
  v_accvgpr_write_b32 a219, v51
  v_perm_b32 v52, v163, v161, s45
  v_perm_b32 v53, v167, v165, s45
  v_perm_b32 v54, v171, v169, s45
  v_perm_b32 v55, v175, v173, s45
  v_accvgpr_write_b32 a220, v52
  v_accvgpr_write_b32 a221, v53
  v_accvgpr_write_b32 a222, v54
  v_accvgpr_write_b32 a223, v55
  s_waitcnt vmcnt(24)
  v_perm_b32 v48, v66, v64, s44
  v_perm_b32 v49, v70, v68, s44
  v_perm_b32 v50, v74, v72, s44
  v_perm_b32 v51, v78, v76, s44
  v_accvgpr_write_b32 a224, v48
  v_accvgpr_write_b32 a225, v49
  v_accvgpr_write_b32 a226, v50
  v_accvgpr_write_b32 a227, v51
  v_perm_b32 v52, v66, v64, s45
  v_perm_b32 v53, v70, v68, s45
  v_perm_b32 v54, v74, v72, s45
  v_perm_b32 v55, v78, v76, s45
  v_accvgpr_write_b32 a228, v52
  v_accvgpr_write_b32 a229, v53
  v_accvgpr_write_b32 a230, v54
  v_accvgpr_write_b32 a231, v55
  v_perm_b32 v48, v67, v65, s44
  v_perm_b32 v49, v71, v69, s44
  v_perm_b32 v50, v75, v73, s44
  v_perm_b32 v51, v79, v77, s44
  v_accvgpr_write_b32 a232, v48
  v_accvgpr_write_b32 a233, v49
  v_accvgpr_write_b32 a234, v50
  v_accvgpr_write_b32 a235, v51
  v_perm_b32 v52, v67, v65, s45
  v_perm_b32 v53, v71, v69, s45
  v_perm_b32 v54, v75, v73, s45
  v_perm_b32 v55, v79, v77, s45
  v_accvgpr_write_b32 a236, v52
  v_accvgpr_write_b32 a237, v53
  v_accvgpr_write_b32 a238, v54
  v_accvgpr_write_b32 a239, v55
  s_waitcnt vmcnt(16)
  v_perm_b32 v48, v82, v80, s44
  v_perm_b32 v49, v86, v84, s44
  v_perm_b32 v50, v90, v88, s44
  v_perm_b32 v51, v94, v92, s44
  v_accvgpr_write_b32 a240, v48
  v_accvgpr_write_b32 a241, v49
  v_accvgpr_write_b32 a242, v50
  v_accvgpr_write_b32 a243, v51
  v_perm_b32 v52, v82, v80, s45
  v_perm_b32 v53, v86, v84, s45
  v_perm_b32 v54, v90, v88, s45
  v_perm_b32 v55, v94, v92, s45
  v_accvgpr_write_b32 a244, v52
  v_accvgpr_write_b32 a245, v53
  v_accvgpr_write_b32 a246, v54
  v_accvgpr_write_b32 a247, v55
  v_perm_b32 v48, v83, v81, s44
  v_perm_b32 v49, v87, v85, s44
  v_perm_b32 v50, v91, v89, s44
  v_perm_b32 v51, v95, v93, s44
  v_accvgpr_write_b32 a248, v48
  v_accvgpr_write_b32 a249, v49
  v_accvgpr_write_b32 a250, v50
  v_accvgpr_write_b32 a251, v51
  v_perm_b32 v52, v83, v81, s45
  v_perm_b32 v53, v87, v85, s45
  v_perm_b32 v54, v91, v89, s45
  v_perm_b32 v55, v95, v93, s45
  v_accvgpr_write_b32 a252, v52
  v_accvgpr_write_b32 a253, v53
  v_accvgpr_write_b32 a254, v54
  v_accvgpr_write_b32 a255, v55
  s_waitcnt vmcnt(0)
  s_barrier
  s_cmp_lg_u32 s17, 0
  s_cbranch_scc1 g_ar_78
  s_lshl_b32 s36, s89, 3
  s_lshl_b64 s[36:37], 1, s36
  v_lshlrev_b32 v52, 3, s91
  v_mov_b32 v48, s36
  v_mov_b32 v49, s37
  s_mov_b64 exec, 1
  global_atomic_add_x2 v[50:51], v52, v[48:49], s[12:13] sc0
  s_mov_b64 exec, -1
g_ar_78:
  s_waitcnt vmcnt(0)
  s_cmp_lg_u32 s17, 0
  s_cbranch_scc1 g_af_79
  v_readfirstlane_b32 s36, v50
  v_readfirstlane_b32 s37, v51
  s_add_u32 s38, s36, s37
  s_mul_i32 s38, s38, 0x01010101
  s_lshr_b32 s38, s38, 24
  s_cmp_lg_u32 s38, 15
  s_cbranch_scc1 g_af_79
  s_lshl_b32 s38, s89, 3
  s_lshr_b64 s[36:37], s[36:37], s38
  s_and_b32 s36, s36, 0xff
  s_cmp_eq_u32 s36, 15
  s_cselect_b32 s36, 1, 2
  v_mov_b32 v48, s36
  v_lshrrev_b32 v52, 1, v52
  s_mov_b64 exec, 1
  global_store_dword v52, v48, s[12:13] offset:128 sc1
  s_mov_b64 exec, -1
g_af_79:
  v_mbcnt_lo_u32_b32 v60, -1, 0
  v_and_b32 v60, 0, v60
  v_add_lshl_u32 v60, v60, s91, 2
  s_mov_b32 s26, 0
g_wt_80:
  global_load_dword v61, v60, s[12:13] offset:128 sc1
  s_add_u32 s26, s26, 1
  s_cmp_gt_u32 s26, 1048576
  s_cbranch_scc1 L_end
  s_waitcnt vmcnt(0)
  v_cmp_eq_u32 vcc, 0, v61
  v_readfirstlane_b32 s27, v61
  s_cbranch_vccnz g_wt_80
  s_cmp_lg_u32 s27, 1
  s_cbranch_scc1 L_o_x
  s_mov_b32 s62, 1
  s_mov_b32 s42, 0
  s_mov_b32 s3, 0
  s_mov_b32 s46, 0
  s_mov_b32 s65, 0
  s_mov_b32 s66, 0
  s_mov_b32 s76, 0
  s_mov_b32 s55, 0
  s_mov_b32 s56, 0
  s_mov_b32 s84, 268435456
  s_mov_b32 s86, s41
  s_mov_b32 s49, s60
  s_mul_i32 s63, s49, 257
  s_or_b32 s63, s63, 1179648
o_round_81:
  s_max_u32 s46, s46, s3
  s_cmp_lg_u32 s3, 0
  s_mov_b32 s3, 0
  s_cbranch_scc1 d_g_93
  s_mov_b32 s67, 0
d_w_92:
  s_min_u32 s26, s49, 71
  s_lshl_b32 s26, s26, 12
  s_add_u32 s27, s26, 243494912
  s_add_u32 s26, s26, 243486720
  buffer_load_dword v248, v246, s[4:7], s26 offen sc1
  buffer_load_dword v249, v246, s[4:7], s27 offen sc1
  s_add_u32 s67, s67, 1
  s_cmp_gt_u32 s67, 1048576
  s_cbranch_scc1 L_end
  s_waitcnt vmcnt(0)
  s_mov_b64 exec, 1
  buffer_store_dword v38, off, s[4:7], s84 sc1
  s_mov_b64 exec, -1
  s_mov_b32 s84, 268435456
  v_min_u32 v162, v248, v249
  v_max_u32 v163, v248, v249
  v_cmp_eq_u32 vcc, 0, v162
  s_cbranch_vccnz d_w_92
  v_max_u32_dpp v163, v163, v163 row_ror:8 row_mask:0xf bank_mask:0xf
  s_nop 1
  v_max_u32_dpp v163, v163, v163 row_ror:4 row_mask:0xf bank_mask:0xf
  s_nop 1
  v_max_u32_dpp v163, v163, v163 row_ror:2 row_mask:0xf bank_mask:0xf
  s_nop 1
  v_max_u32_dpp v163, v163, v163 row_ror:1 row_mask:0xf bank_mask:0xf
  s_nop 0
  v_readlane_b32 s28, v163, 0
  v_readlane_b32 s29, v163, 16
  v_readlane_b32 s30, v163, 32
  v_readlane_b32 s31, v163, 48
  s_max_u32 s28, s28, s29
  s_max_u32 s30, s30, s31
  s_max_u32 s46, s46, s28
  s_max_u32 s46, s46, s30
d_g_93:
  s_lshr_b32 s27, s49, 2
  s_andn2_b32 s52, 0xfff, s46
  s_lshr_b32 s52, s52, 5
  s_min_u32 s52, s52, 64
  s_add_u32 s26, s52, 3
  v_readlane_b32 s89, v247, s27
  s_sub_u32 s26, s26, s60
  s_lshr_b32 s26, s26, 2
  s_bfm_b32 s54, s26, 0
  s_add_u32 s53, s63, 1028
  s_cmp_lt_u32 s49, 60
  s_cselect_b32 s53, s53, 0
  s_cmp_lt_u32 s49, 64
  s_cselect_b32 s26, 3, 1
  s_sub_i32 s26, s27, s26
  s_max_i32 s26, s26, 0
  s_min_u32 s26, s26, 16
  s_bfm_b32 s58, s26, 0
  s_cmp_eq_u32 s27, 16
  s_cselect_b32 s59, 2, 1
  s_cmp_eq_u32 s27, 18
  s_cselect_b32 s59, 64, s59
  s_cselect_b32 s50, 0, -1
  s_cselect_b32 s89, 0, s89
o_pick_85:
  s_cmp_eq_u32 s59, 0
  s_cbranch_scc1 o_none_89
  s_sub_u32 s59, s59, 1
  s_andn2_b32 s26, s58, s55
  s_and_b32 s26, s26, s54
  s_cbranch_scc1 o_ga_86
  s_and_b32 s26, s55, s50
  s_or_b32 s26, s26, s56
  s_or_b32 s26, s26, s54
  s_andn2_b32 s26, s58, s26
  s_cbranch_scc0 o_none_89
  s_cmp_ge_u32 s46, s89
  s_cbranch_scc1 o_gb_87
o_ga_86:
  s_ff1_i32_b32 s26, s26
  s_bitset1_b32 s55, s26
  s_mov_b32 s64, 1327168
  s_branch o_gd_88
o_none_89:
  s_cmp_lt_u32 s49, 60
  s_cbranch_scc1 o_nn_90
  s_cmp_eq_u32 s50, 0
  s_cbranch_scc1 o_nn_90
  s_and_b32 s26, s63, 1097728
  s_cmp_eq_u32 s26, 1048576
  s_cbranch_scc1 o_nn_90
  s_cmp_lt_u32 s49, 64
  s_cbranch_scc1 o_adv_91
  s_and_b32 s26, s65, 1097728
  s_cmp_lg_u32 s26, 1048576
  s_cbranch_scc1 o_adv_91
o_nn_90:
  s_mov_b32 s64, s53
  s_mov_b32 s51, 0
  s_branch o_task_82
o_gb_87:
  s_ff1_i32_b32 s26, s26
  s_bitset1_b32 s56, s26
  s_andn2_b32 s27, 31, s46
  s_or_b32 s27, s27, 32
  s_lshl_b32 s27, s27, 22
  s_or_b32 s27, s27, 1474688
  s_lshl_b32 s28, s26, 2
  s_add_u32 s28, s28, s60
  s_cmp_eq_u32 s28, s52
  s_cselect_b32 s64, s27, 1474624
o_gd_88:
  s_lshl_b32 s26, s26, 2
  s_add_u32 s26, s26, s60
  s_mul_i32 s26, s26, 257
  s_or_b32 s64, s64, s26
  s_mov_b32 s51, 1
o_task_82:
  s_cmp_eq_u32 s63, 0
  s_cbranch_scc1 o_nofl_83
  s_cmp_lg_u32 s66, 0
  s_cbranch_scc1 o_have_95
  s_mov_b32 s67, 0
o_w1_94:
  s_and_b32 s32, s63, 0xff
  s_lshl_b32 s32, s32, 12
  s_add_u32 s32, s32, s14
  buffer_load_dword v37, v36, s[4:7], s32 offen sc1
  s_add_u32 s67, s67, 1
  s_cmp_gt_u32 s67, 1048576
  s_cbranch_scc1 L_end
  s_waitcnt vmcnt(0)
  s_mov_b64 exec, 1
  buffer_store_dword v38, off, s[4:7], s84 sc1
  s_mov_b64 exec, -1
  s_mov_b32 s84, 268435456
  v_cmp_eq_u32 vcc, 0, v37
  s_cbranch_vccnz o_w1_94
  s_and_b32 s87, s63, 0xff
  s_lshl_b32 s33, s87, 18
  s_lshl_b32 s32, s87, 19
  s_add_u32 m0, s22, 0
  s_add_u32 s33, s33, s19
  buffer_load_dwordx4 v0, s[4:7], s33 offen offset:0 sc1 lds
  buffer_load_dwordx4 v0, s[4:7], s33 offen offset:1024 sc1 lds
  buffer_load_dwordx4 v0, s[4:7], s33 offen offset:2048 sc1 lds
  buffer_load_dwordx4 v0, s[4:7], s33 offen offset:3072 sc1 lds
  s_add_u32 m0, s23, 0
  s_add_u32 s32, s32, s18
  buffer_load_dwordx4 v0, s[4:7], s32 offen offset:0 sc1 lds
  buffer_load_dwordx4 v0, s[4:7], s32 offen offset:1024 sc1 lds
  buffer_load_dwordx4 v0, s[4:7], s32 offen offset:2048 sc1 lds
  buffer_load_dwordx4 v0, s[4:7], s32 offen offset:3072 sc1 lds
  s_add_u32 m0, m0, 4096
  s_add_u32 s32, s32, 4096
  buffer_load_dwordx4 v0, s[4:7], s32 offen offset:0 sc1 lds
  buffer_load_dwordx4 v0, s[4:7], s32 offen offset:1024 sc1 lds
  buffer_load_dwordx4 v0, s[4:7], s32 offen offset:2048 sc1 lds
  buffer_load_dwordx4 v0, s[4:7], s32 offen offset:3072 sc1 lds
  s_waitcnt vmcnt(0)
  s_barrier
o_have_95:
  ds_read_b128 v[120:123], v33 offset:0
  ds_read_b128 v[40:43], v32 offset:0
  ds_read_b128 v[56:59], v32 offset:1024
  ds_read_b128 v[124:127], v33 offset:2048
  ds_read_b128 v[44:47], v32 offset:4096
  ds_read_b128 v[60:63], v32 offset:5120
  ds_read_b128 v[128:131], v33 offset:4096
  ds_read_b128 v[48:51], v32 offset:8192
  ds_read_b128 v[64:67], v32 offset:9216
  ds_read_b128 v[132:135], v33 offset:6144
  ds_read_b128 v[52:55], v32 offset:12288
  ds_read_b128 v[68:71], v32 offset:13312
  s_cmp_lt_u32 s17, 2
  s_cselect_b32 s65, s65, 0
  s_cmp_lg_u32 s65, 0
  s_cselect_b64 s[44:45], -1, 0
  s_mov_b32 s95, s86
  s_mov_b32 s96, s42
  s_lshl_b32 s97, s43, 14
  s_add_u32 s97, s97, s95
  s_and_b32 s87, s64, 0xff
  s_lshl_b32 s87, s87, 12
  s_add_u32 s87, s87, s14
  s_and_b32 s88, s64, 0xff00
  s_lshl_b32 s88, s88, 3
  s_add_u32 s88, s88, s15
  s_waitcnt lgkmcnt(9)
  v_mfma_f32_16x16x32_bf16 v[104:107], v[40:43], v[120:123], v[24:27]
  ds_read_b128 v[136:139], v34 offset:0
  v_mfma_f32_16x16x32_bf16 v[108:111], v[56:59], v[120:123], v[28:31]
  ds_read_b64 v[200:201], v35 offset:4096
  s_waitcnt lgkmcnt(8)
  v_mfma_f32_16x16x32_bf16 v[104:107], v[44:47], v[124:127], v[104:107]
  ds_read_b128 v[140:143], v34 offset:1024
  v_mfma_f32_16x16x32_bf16 v[108:111], v[60:63], v[124:127], v[108:111]
  ds_read_b64 v[202:203], v35 offset:4608
  s_mov_b64 exec, s[44:45]
  buffer_load_dword v7, v255, s[4:7], s97 offen sc1
  s_not_b64 exec, exec
  buffer_load_dword v37, v36, s[4:7], s87 offen sc1
  buffer_load_dword v245, v252, s[4:7], s88 offen sc1
  s_mov_b64 exec, -1
  s_waitcnt lgkmcnt(7)
  v_mfma_f32_16x16x32_bf16 v[104:107], v[48:51], v[128:131], v[104:107]
  ds_read_b128 v[144:147], v34 offset:2048
  v_mfma_f32_16x16x32_bf16 v[108:111], v[64:67], v[128:131], v[108:111]
  ds_read_b64 v[204:205], v35 offset:5120
  s_waitcnt lgkmcnt(6)
  v_mfma_f32_16x16x32_bf16 v[104:107], v[52:55], v[132:135], v[104:107]
  ds_read_b128 v[148:151], v34 offset:3072
  v_mfma_f32_16x16x32_bf16 v[108:111], v[68:71], v[132:135], v[108:111]
  ds_read_b64 v[206:207], v35 offset:5632
  s_cmp_lg_u32 s76, 0
  s_cbranch_scc1 o_klds_98
  ds_read_b128 v[152:155], v32 offset:2048
  ds_read_b128 v[156:159], v32 offset:3072
  ds_read_b128 v[160:163], v32 offset:6144
  ds_read_b128 v[164:167], v32 offset:7168
  ds_read_b128 v[168:171], v32 offset:10240
  ds_read_b128 v[172:175], v32 offset:11264
  ds_read_b128 v[176:179], v32 offset:14336
  ds_read_b128 v[180:183], v32 offset:15360
  v_mov_b32 v196, 0
  v_mov_b32 v199, 0
  v_exp_f32 v56, v104
  v_exp_f32 v57, v105
  v_exp_f32 v58, v106
  v_exp_f32 v59, v107
  v_exp_f32 v60, v108
  v_exp_f32 v61, v109
  v_exp_f32 v62, v110
  v_exp_f32 v63, v111
  v_max3_f32 v116, v104, v105, v106
  v_max3_f32 v116, v107, v108, v116
  v_max3_f32 v116, v109, v110, v116
  v_add_f32 v117, v56, v57
  v_add_f32 v118, v58, v59
  v_add_f32 v117, v117, v60
  v_add_f32 v118, v118, v61
  v_add_f32 v117, v117, v62
  v_add_f32 v118, v118, v63
  s_waitcnt vmcnt(0) lgkmcnt(0)
  s_mov_b64 exec, 1
  buffer_store_dword v38, off, s[4:7], s84 sc1
  s_mov_b64 exec, -1
  s_mov_b32 s84, 268435456
  s_mov_b32 s67, 0
  s_and_b32 s32, s63, 0xff00
  s_lshl_b32 s32, s32, 3
  s_add_u32 s32, s32, s15
  s_lshl_b32 s33, s17, 5
  s_and_b32 s33, s33, 64
  s_add_u32 s33, s32, s33
  s_and_b32 s32, s63, 0xff00
  s_lshl_b32 s32, s32, 10
  s_add_u32 s32, s32, s20
o_w2_96:
  buffer_load_dword v244, off, s[4:7], s33 sc1
  s_add_u32 s67, s67, 1
  s_cmp_gt_u32 s67, 1048576
  s_cbranch_scc1 L_end
  s_waitcnt vmcnt(0)
  v_cmp_eq_u32 vcc, 0, v244
  s_cbranch_vccnz o_w2_96
  buffer_load_dwordx4 v[136:139], v0, s[4:7], s32 offen offset:0 sc1
  buffer_load_dwordx4 v[140:143], v0, s[4:7], s32 offen offset:1024 sc1
  buffer_load_dwordx4 v[144:147], v0, s[4:7], s32 offen offset:2048 sc1
  buffer_load_dwordx4 v[148:151], v0, s[4:7], s32 offen offset:3072 sc1
  s_add_u32 s32, s32, 4096
  buffer_load_dwordx2 v[200:201], v1, s[4:7], s32 offen offset:0 sc1
  buffer_load_dwordx2 v[202:203], v1, s[4:7], s32 offen offset:512 sc1
  buffer_load_dwordx2 v[204:205], v1, s[4:7], s32 offen offset:1024 sc1
  buffer_load_dwordx2 v[206:207], v1, s[4:7], s32 offen offset:1536 sc1
  buffer_load_dword v37, v36, s[4:7], s87 offen sc1
  buffer_load_dword v245, v252, s[4:7], s88 offen sc1
  s_waitcnt vmcnt(9)
  v_mfma_f32_16x16x32_bf16 v[112:115], v[136:139], v[120:123], 0
  s_waitcnt vmcnt(8)
  v_mfma_f32_16x16x32_bf16 v[112:115], v[140:143], v[124:127], v[112:115]
  s_waitcnt vmcnt(7)
  v_mfma_f32_16x16x32_bf16 v[112:115], v[144:147], v[128:131], v[112:115]
  s_waitcnt vmcnt(6)
  v_mfma_f32_16x16x32_bf16 v[112:115], v[148:151], v[132:135], v[112:115]
  s_branch o_havek_97
o_klds_98:
  s_waitcnt lgkmcnt(1)
  v_mfma_f32_16x16x32_bf16 v[112:115], v[136:139], v[120:123], 0
  ds_read_b128 v[152:155], v32 offset:2048
  ds_read_b128 v[156:159], v32 offset:3072
  v_mfma_f32_16x16x32_bf16 v[112:115], v[140:143], v[124:127], v[112:115]
  ds_read_b128 v[160:163], v32 offset:6144
  ds_read_b128 v[164:167], v32 offset:7168
  v_mfma_f32_16x16x32_bf16 v[112:115], v[144:147], v[128:131], v[112:115]
  ds_read_b128 v[168:171], v32 offset:10240
  ds_read_b128 v[172:175], v32 offset:11264
  v_mfma_f32_16x16x32_bf16 v[112:115], v[148:151], v[132:135], v[112:115]
  ds_read_b128 v[176:179], v32 offset:14336
  ds_read_b128 v[180:183], v32 offset:15360
  v_mov_b32 v196, 0
  v_mov_b32 v199, 0
  v_exp_f32 v56, v104
  v_exp_f32 v57, v105
  v_exp_f32 v58, v106
  v_exp_f32 v59, v107
  v_exp_f32 v60, v108
  v_exp_f32 v61, v109
  v_exp_f32 v62, v110
  v_exp_f32 v63, v111
  v_max3_f32 v116, v104, v105, v106
  v_max3_f32 v116, v107, v108, v116
  v_max3_f32 v116, v109, v110, v116
  v_add_f32 v117, v56, v57
  v_add_f32 v118, v58, v59
  v_add_f32 v117, v117, v60
  v_add_f32 v118, v118, v61
  v_add_f32 v117, v117, v62
  v_add_f32 v118, v118, v63
o_havek_97:
  s_cmp_lg_u32 s65, 0
  s_cbranch_scc1 o_wr1_103
  s_nop 0
  s_nop 1
  s_nop 1
  v_mul_f32 v112, s24, v112
  v_mul_f32 v113, s24, v113
  v_exp_f32 v64, v112
  v_exp_f32 v65, v113
  v_max_f32 v116, v111, v116
  v_max3_f32 v116, v112, v113, v116
  v_add_f32 v117, v117, v64
  v_add_f32 v118, v118, v65
  v_add_f32 v117, v117, v118
  s_mov_b32 s28, 0x21800000
  v_mov_b32 v118, v117
  s_nop 1
  v_permlane16_swap_b32 v117, v118
  v_add_f32 v117, v117, v118
  v_mov_b32 v118, v117
  s_nop 0
  s_nop 0
  v_permlane32_swap_b32 v117, v118
  v_add_f32 v117, v117, v118
  s_waitcnt vmcnt(2)
  v_cmp_lt_f32 vcc, 0x42700000, v116
  v_cmp_gt_f32 s[30:31], s28, v117
  v_rcp_f32 v117, v117
  s_or_b64 vcc, vcc, s[30:31]
  s_cbranch_vccnz o_fb_106
o_fbr_107:
  v_pk_mul_f32 v[56:57], v[56:57], v[116:117] op_sel:[0,1] op_sel_hi:[1,1]
  v_pk_mul_f32 v[58:59], v[58:59], v[116:117] op_sel:[0,1] op_sel_hi:[1,1]
  v_pk_mul_f32 v[60:61], v[60:61], v[116:117] op_sel:[0,1] op_sel_hi:[1,1]
  v_pk_mul_f32 v[62:63], v[62:63], v[116:117] op_sel:[0,1] op_sel_hi:[1,1]
  v_pk_mul_f32 v[64:65], v[64:65], v[116:117] op_sel:[0,1] op_sel_hi:[1,1]
  v_cvt_pk_bf16_f32 v116, v56, v57
  v_cvt_pk_bf16_f32 v117, v58, v59
  v_cvt_pk_bf16_f32 v118, v60, v61
  v_cvt_pk_bf16_f32 v119, v62, v63
  s_waitcnt lgkmcnt(0)
  s_nop 0
  v_mfma_f32_16x16x32_bf16 v[72:75], v[152:155], v[116:119], 0
  s_add_u32 s62, s62, 1
  v_cvt_pk_bf16_f32 v197, v64, v65
  v_cvt_pk_bf16_f32 v198, v64, v65
  v_mfma_f32_16x16x32_bf16 v[76:79], v[156:159], v[116:119], 0
  s_xor_b32 s86, s86, 524288
  v_mfma_f32_16x16x32_bf16 v[80:83], v[160:163], v[116:119], 0
  s_bfe_u32 s42, s62, 0x10001
  v_mfma_f32_16x16x32_bf16 v[84:87], v[164:167], v[116:119], 0
  s_bfe_u32 s26, s64, 65556
  v_mfma_f32_16x16x32_bf16 v[88:91], v[168:171], v[116:119], 0
  s_and_b32 s87, s64, 0xff
  v_mfma_f32_16x16x32_bf16 v[92:95], v[172:175], v[116:119], 0
  s_bfe_u32 s88, s64, 0x80008
  v_mfma_f32_16x16x32_bf16 v[96:99], v[176:179], v[116:119], 0
  s_nop 0
  v_mfma_f32_16x16x32_bf16 v[100:103], v[180:183], v[116:119], 0
  s_nop 0
  v_mfma_f32_16x16x16_bf16 v[72:75], v[200:201], v[198:199], v[72:75]
  s_nop 1
  v_mfma_f32_16x16x16_bf16 v[76:79], v[200:201], v[196:197], v[76:79]
  s_nop 1
  v_mfma_f32_16x16x16_bf16 v[80:83], v[202:203], v[198:199], v[80:83]
  s_nop 1
  v_mfma_f32_16x16x16_bf16 v[84:87], v[202:203], v[196:197], v[84:87]
  s_nop 1
  v_mfma_f32_16x16x16_bf16 v[88:91], v[204:205], v[198:199], v[88:91]
  s_nop 0
  v_cvt_pk_bf16_f32 v40, v72, v73
  v_cvt_pk_bf16_f32 v41, v74, v75
  v_mfma_f32_16x16x16_bf16 v[92:95], v[204:205], v[196:197], v[92:95]
  s_nop 0
  v_cvt_pk_bf16_f32 v42, v76, v77
  v_cvt_pk_bf16_f32 v43, v78, v79
  v_mfma_f32_16x16x16_bf16 v[96:99], v[206:207], v[198:199], v[96:99]
  s_nop 0
  ds_write_b128 v6, v[40:43] offset:0
  v_cvt_pk_bf16_f32 v44, v80, v81
  v_mfma_f32_16x16x16_bf16 v[100:103], v[206:207], v[196:197], v[100:103]
  s_nop 0
  v_cvt_pk_bf16_f32 v45, v82, v83
  v_cvt_pk_bf16_f32 v46, v84, v85
  v_cvt_pk_bf16_f32 v47, v86, v87
  ds_write_b128 v6, v[44:47] offset:1024
  v_cvt_pk_bf16_f32 v48, v88, v89
  v_cvt_pk_bf16_f32 v49, v90, v91
  v_cvt_pk_bf16_f32 v50, v92, v93
  v_cvt_pk_bf16_f32 v51, v94, v95
  ds_write_b128 v6, v[48:51] offset:2048
  v_cvt_pk_bf16_f32 v52, v96, v97
  v_cvt_pk_bf16_f32 v53, v98, v99
  v_cvt_pk_bf16_f32 v54, v100, v101
  v_cvt_pk_bf16_f32 v55, v102, v103
  ds_write_b128 v6, v[52:55] offset:3072
  s_cmp_lt_u32 s17, 2
  s_cbranch_scc1 o_wr0_102
  s_waitcnt lgkmcnt(0)
  s_barrier
  ds_read_b128 v[104:107], v3 offset:0
  ds_read_b128 v[108:111], v3 offset:512
  ds_read_b128 v[112:115], v3 offset:1024
  s_waitcnt lgkmcnt(2)
  v_mfma_f32_32x32x16_bf16 v[40:55], v[104:107], a[0:3], 0
  s_waitcnt vmcnt(0)
  v_cmp_eq_u32 vcc, 0, v37
  s_cmp_eq_u64 vcc, 0
  s_cselect_b32 s66, s26, 0
  s_cmp_eq_u32 s66, 1
  s_cselect_b32 s87, s87, 1024
  s_cselect_b32 s34, 0, 0x28000
  v_mfma_f32_32x32x16_bf16 v[56:71], v[104:107], a[4:7], 0
  ds_read_b128 v[116:119], v3 offset:1536
  v_cmp_eq_u32 vcc, 0, v245
  s_cmp_eq_u64 vcc, 0
  s_cselect_b32 s76, s26, 0
  s_and_b32 s76, s76, 1
  s_cselect_b32 s88, s88, 1024
  v_mfma_f32_32x32x16_bf16 v[72:87], v[104:107], a[8:11], 0
  s_lshl_b32 s33, s87, 18
  s_lshl_b32 s32, s87, 19
  s_add_u32 m0, s22, s34
  s_add_u32 s33, s33, s19
  s_min_u32 s28, s49, 67
  s_lshl1_add_u32 s28, s17, s28
  v_mfma_f32_32x32x16_bf16 v[88:103], v[104:107], a[12:15], 0
  s_lshl_b32 s28, s28, 12
  s_add_u32 s28, s28, 243486720
  buffer_load_dword v249, v246, s[4:7], s28 offen sc1
  s_waitcnt lgkmcnt(2)
  v_mfma_f32_32x32x16_bf16 v[40:55], v[108:111], a[16:19], v[40:55]
  buffer_load_dwordx4 v0, s[4:7], s33 offen offset:0 sc1 lds
  v_mfma_f32_32x32x16_bf16 v[56:71], v[108:111], a[20:23], v[56:71]
  ds_read_b128 v[104:107], v3 offset:2048
  buffer_load_dwordx4 v0, s[4:7], s33 offen offset:1024 sc1 lds
  v_mfma_f32_32x32x16_bf16 v[72:87], v[108:111], a[24:27], v[72:87]
  buffer_load_dwordx4 v0, s[4:7], s33 offen offset:2048 sc1 lds
  v_mfma_f32_32x32x16_bf16 v[88:103], v[108:111], a[28:31], v[88:103]
  buffer_load_dwordx4 v0, s[4:7], s33 offen offset:3072 sc1 lds
  s_sub_u32 m0, m0, 8192
  s_sub_u32 s33, s33, 8192
  s_waitcnt lgkmcnt(2)
  v_mfma_f32_32x32x16_bf16 v[40:55], v[112:115], a[32:35], v[40:55]
  buffer_load_dwordx4 v0, s[4:7], s33 offen offset:0 sc1 lds
  v_mfma_f32_32x32x16_bf16 v[56:71], v[112:115], a[36:39], v[56:71]
  ds_read_b128 v[108:111], v3 offset:2560
  buffer_load_dwordx4 v0, s[4:7], s33 offen offset:1024 sc1 lds
  v_mfma_f32_32x32x16_bf16 v[72:87], v[112:115], a[40:43], v[72:87]
  buffer_load_dwordx4 v0, s[4:7], s33 offen offset:2048 sc1 lds
  v_mfma_f32_32x32x16_bf16 v[88:103], v[112:115], a[44:47], v[88:103]
  buffer_load_dwordx4 v0, s[4:7], s33 offen offset:3072 sc1 lds
  s_add_u32 m0, s23, s34
  s_add_u32 s32, s32, s18
  s_waitcnt lgkmcnt(2)
  v_mfma_f32_32x32x16_bf16 v[40:55], v[116:119], a[48:51], v[40:55]
  buffer_load_dwordx4 v0, s[4:7], s32 offen offset:0 sc1 lds
  v_mfma_f32_32x32x16_bf16 v[56:71], v[116:119], a[52:55], v[56:71]
  ds_read_b128 v[112:115], v3 offset:3072
  buffer_load_dwordx4 v0, s[4:7], s32 offen offset:1024 sc1 lds
  v_mfma_f32_32x32x16_bf16 v[72:87], v[116:119], a[56:59], v[72:87]
  buffer_load_dwordx4 v0, s[4:7], s32 offen offset:2048 sc1 lds
  v_mfma_f32_32x32x16_bf16 v[88:103], v[116:119], a[60:63], v[88:103]
  buffer_load_dwordx4 v0, s[4:7], s32 offen offset:3072 sc1 lds
  s_add_u32 m0, m0, 4096
  s_add_u32 s32, s32, 4096
  s_waitcnt lgkmcnt(2)
  v_mfma_f32_32x32x16_bf16 v[40:55], v[104:107], a[64:67], v[40:55]
  buffer_load_dwordx4 v0, s[4:7], s32 offen offset:0 sc1 lds
  v_mfma_f32_32x32x16_bf16 v[56:71], v[104:107], a[68:71], v[56:71]
  ds_read_b128 v[116:119], v3 offset:3584
  buffer_load_dwordx4 v0, s[4:7], s32 offen offset:1024 sc1 lds
  v_mfma_f32_32x32x16_bf16 v[72:87], v[104:107], a[72:75], v[72:87]
  buffer_load_dwordx4 v0, s[4:7], s32 offen offset:2048 sc1 lds
  v_mfma_f32_32x32x16_bf16 v[88:103], v[104:107], a[76:79], v[88:103]
  buffer_load_dwordx4 v0, s[4:7], s32 offen offset:3072 sc1 lds
  s_sub_u32 m0, m0, 20480
  s_sub_u32 s32, s32, 20480
  s_waitcnt lgkmcnt(2)
  v_mfma_f32_32x32x16_bf16 v[40:55], v[108:111], a[80:83], v[40:55]
  buffer_load_dwordx4 v0, s[4:7], s32 offen offset:0 sc1 lds
  v_mfma_f32_32x32x16_bf16 v[56:71], v[108:111], a[84:87], v[56:71]
  ds_read_b128 v[104:107], v3 offset:8192
  buffer_load_dwordx4 v0, s[4:7], s32 offen offset:1024 sc1 lds
  v_mfma_f32_32x32x16_bf16 v[72:87], v[108:111], a[88:91], v[72:87]
  buffer_load_dwordx4 v0, s[4:7], s32 offen offset:2048 sc1 lds
  v_mfma_f32_32x32x16_bf16 v[88:103], v[108:111], a[92:95], v[88:103]
  buffer_load_dwordx4 v0, s[4:7], s32 offen offset:3072 sc1 lds
  s_add_u32 m0, m0, 4096
  s_add_u32 s32, s32, 4096
  s_waitcnt lgkmcnt(2)
  v_mfma_f32_32x32x16_bf16 v[40:55], v[112:115], a[96:99], v[40:55]
  buffer_load_dwordx4 v0, s[4:7], s32 offen offset:0 sc1 lds
  v_mfma_f32_32x32x16_bf16 v[56:71], v[112:115], a[100:103], v[56:71]
  ds_read_b128 v[108:111], v3 offset:8704
  buffer_load_dwordx4 v0, s[4:7], s32 offen offset:1024 sc1 lds
  v_mfma_f32_32x32x16_bf16 v[72:87], v[112:115], a[104:107], v[72:87]
  buffer_load_dwordx4 v0, s[4:7], s32 offen offset:2048 sc1 lds
  v_mfma_f32_32x32x16_bf16 v[88:103], v[112:115], a[108:111], v[88:103]
  buffer_load_dwordx4 v0, s[4:7], s32 offen offset:3072 sc1 lds
  s_lshl_b32 s32, s88, 18
  s_mov_b32 m0, s40
  s_waitcnt lgkmcnt(2)
  v_mfma_f32_32x32x16_bf16 v[40:55], v[116:119], a[112:115], v[40:55]
  s_add_u32 s32, s32, s21
  buffer_load_dwordx4 v0, s[4:7], s32 offen offset:0 sc1 lds
  v_mfma_f32_32x32x16_bf16 v[56:71], v[116:119], a[116:119], v[56:71]
  ds_read_b128 v[112:115], v3 offset:9216
  buffer_load_dwordx4 v0, s[4:7], s32 offen offset:1024 sc1 lds
  v_mfma_f32_32x32x16_bf16 v[72:87], v[116:119], a[120:123], v[72:87]
  buffer_load_dwordx4 v0, s[4:7], s32 offen offset:2048 sc1 lds
  s_sub_u32 m0, m0, 8192
  s_sub_u32 s32, s32, 8192
  v_mfma_f32_32x32x16_bf16 v[88:103], v[116:119], a[124:127], v[88:103]
  buffer_load_dwordx4 v0, s[4:7], s32 offen offset:0 sc1 lds
  s_waitcnt lgkmcnt(2)
  v_mfma_f32_32x32x16_bf16 v[40:55], v[104:107], a[128:131], v[40:55]
  buffer_load_dwordx4 v0, s[4:7], s32 offen offset:1024 sc1 lds
  v_mfma_f32_32x32x16_bf16 v[56:71], v[104:107], a[132:135], v[56:71]
  ds_read_b128 v[116:119], v3 offset:9728
  buffer_load_dwordx4 v0, s[4:7], s32 offen offset:2048 sc1 lds
  v_mfma_f32_32x32x16_bf16 v[72:87], v[104:107], a[136:139], v[72:87]
  v_mfma_f32_32x32x16_bf16 v[88:103], v[104:107], a[140:143], v[88:103]
  s_waitcnt lgkmcnt(2)
  v_mfma_f32_32x32x16_bf16 v[40:55], v[108:111], a[144:147], v[40:55]
  v_mfma_f32_32x32x16_bf16 v[56:71], v[108:111], a[148:151], v[56:71]
  ds_read_b128 v[104:107], v3 offset:10240
  v_mfma_f32_32x32x16_bf16 v[72:87], v[108:111], a[152:155], v[72:87]
  v_mfma_f32_32x32x16_bf16 v[88:103], v[108:111], a[156:159], v[88:103]
  s_waitcnt lgkmcnt(2)
  v_mfma_f32_32x32x16_bf16 v[40:55], v[112:115], a[160:163], v[40:55]
  v_mfma_f32_32x32x16_bf16 v[56:71], v[112:115], a[164:167], v[56:71]
  ds_read_b128 v[108:111], v3 offset:10752
  v_mfma_f32_32x32x16_bf16 v[72:87], v[112:115], a[168:171], v[72:87]
  v_mfma_f32_32x32x16_bf16 v[88:103], v[112:115], a[172:175], v[88:103]
  s_waitcnt lgkmcnt(2)
  v_mfma_f32_32x32x16_bf16 v[40:55], v[116:119], a[176:179], v[40:55]
  v_mfma_f32_32x32x16_bf16 v[56:71], v[116:119], a[180:183], v[56:71]
  ds_read_b128 v[112:115], v3 offset:11264
  v_mfma_f32_32x32x16_bf16 v[72:87], v[116:119], a[184:187], v[72:87]
  v_mfma_f32_32x32x16_bf16 v[88:103], v[116:119], a[188:191], v[88:103]
  s_waitcnt lgkmcnt(2)
  v_mfma_f32_32x32x16_bf16 v[40:55], v[104:107], a[192:195], v[40:55]
  v_mfma_f32_32x32x16_bf16 v[56:71], v[104:107], a[196:199], v[56:71]
  ds_read_b128 v[116:119], v3 offset:11776
  s_waitcnt vmcnt(30)
  v_cmp_eq_u32 vcc, 0, v249
  v_max_u32_dpp v249, v249, v249 row_ror:8 row_mask:0xf bank_mask:0xf
  s_nop 0
  s_nop 0
  v_max_u32_dpp v249, v249, v249 row_ror:4 row_mask:0xf bank_mask:0xf
  v_mfma_f32_32x32x16_bf16 v[72:87], v[104:107], a[200:203], v[72:87]
  s_nop 0
  v_max_u32_dpp v249, v249, v249 row_ror:2 row_mask:0xf bank_mask:0xf
  s_nop 0
  s_nop 0
  v_max_u32_dpp v249, v249, v249 row_ror:1 row_mask:0xf bank_mask:0xf
  s_nop 0
  v_mov_b32 v248, v249
  v_mfma_f32_32x32x16_bf16 v[88:103], v[104:107], a[204:207], v[88:103]
  s_nop 0
  v_permlane16_swap_b32 v249, v248
  v_max_u32 v249, v249, v248
  v_mov_b32 v248, v249
  s_waitcnt lgkmcnt(2)
  v_mfma_f32_32x32x16_bf16 v[40:55], v[108:111], a[208:211], v[40:55]
  s_nop 0
  v_permlane32_swap_b32 v249, v248
  v_max_u32 v249, v249, v248
  s_cmp_eq_u64 vcc, 0
  s_cselect_b32 s28, 4, 0
  v_mfma_f32_32x32x16_bf16 v[56:71], v[108:111], a[212:215], v[56:71]
  s_lshl_b32 s26, s76, 1
  s_or_b32 s26, s26, s66
  s_or_b32 s26, s26, s28
  v_mov_b32 v248, s26
  ds_write_b64 v39, v[248:249]
  v_mfma_f32_32x32x16_bf16 v[72:87], v[108:111], a[216:219], v[72:87]
  v_mfma_f32_32x32x16_bf16 v[88:103], v[108:111], a[220:223], v[88:103]
  s_waitcnt lgkmcnt(2)
  v_mfma_f32_32x32x16_bf16 v[40:55], v[112:115], a[224:227], v[40:55]
  v_mfma_f32_32x32x16_bf16 v[56:71], v[112:115], a[228:231], v[56:71]
  v_mfma_f32_32x32x16_bf16 v[72:87], v[112:115], a[232:235], v[72:87]
  v_mfma_f32_32x32x16_bf16 v[88:103], v[112:115], a[236:239], v[88:103]
  s_waitcnt lgkmcnt(1)
  v_mfma_f32_32x32x16_bf16 v[40:55], v[116:119], a[240:243], v[40:55]
  v_mfma_f32_32x32x16_bf16 v[56:71], v[116:119], a[244:247], v[56:71]
  v_mfma_f32_32x32x16_bf16 v[72:87], v[116:119], a[248:251], v[72:87]
  v_mfma_f32_32x32x16_bf16 v[88:103], v[116:119], a[252:255], v[88:103]
  s_nop 3
  s_nop 0
  s_nop 3
  s_nop 0
  v_cvt_pk_bf16_f32 v212, v40, v56
  s_nop 0
  v_cvt_pk_bf16_f32 v213, v72, v88
  v_cvt_pk_bf16_f32 v214, v41, v57
  v_cvt_pk_bf16_f32 v215, v73, v89
  v_cvt_pk_bf16_f32 v216, v42, v58
  v_cvt_pk_bf16_f32 v217, v74, v90
  v_cvt_pk_bf16_f32 v218, v43, v59
  v_cvt_pk_bf16_f32 v219, v75, v91
  v_permlane16_swap_b32 v212, v214
  v_permlane16_swap_b32 v213, v215
  s_add_u32 s78, s86, 0
  v_bfi_b32 v212, v254, s42, v212
  buffer_store_dwordx4 v[212:215], v4, s[4:7], s78 offen
  v_cvt_pk_bf16_f32 v220, v44, v60
  v_cvt_pk_bf16_f32 v221, v76, v92
  v_cvt_pk_bf16_f32 v222, v45, v61
  v_cvt_pk_bf16_f32 v223, v77, v93
  v_permlane16_swap_b32 v216, v218
  v_permlane16_swap_b32 v217, v219
  s_add_u32 s78, s86, 32768
  v_bfi_b32 v216, v254, s42, v216
  buffer_store_dwordx4 v[216:219], v4, s[4:7], s78 offen
  v_cvt_pk_bf16_f32 v224, v46, v62
  v_cvt_pk_bf16_f32 v225, v78, v94
  v_cvt_pk_bf16_f32 v226, v47, v63
  v_cvt_pk_bf16_f32 v227, v79, v95
  v_permlane16_swap_b32 v220, v222
  v_permlane16_swap_b32 v221, v223
  s_add_u32 s78, s86, 131072
  v_bfi_b32 v220, v254, s42, v220
  buffer_store_dwordx4 v[220:223], v4, s[4:7], s78 offen
  v_cvt_pk_bf16_f32 v228, v48, v64
  v_cvt_pk_bf16_f32 v229, v80, v96
  v_cvt_pk_bf16_f32 v230, v49, v65
  v_cvt_pk_bf16_f32 v231, v81, v97
  v_permlane16_swap_b32 v224, v226
  v_permlane16_swap_b32 v225, v227
  s_add_u32 s78, s86, 163840
  v_bfi_b32 v224, v254, s42, v224
  buffer_store_dwordx4 v[224:227], v4, s[4:7], s78 offen
  v_cvt_pk_bf16_f32 v232, v50, v66
  v_cvt_pk_bf16_f32 v233, v82, v98
  v_cvt_pk_bf16_f32 v234, v51, v67
  v_cvt_pk_bf16_f32 v235, v83, v99
  v_permlane16_swap_b32 v228, v230
  v_permlane16_swap_b32 v229, v231
  s_add_u32 s78, s86, 262144
  v_bfi_b32 v228, v254, s42, v228
  buffer_store_dwordx4 v[228:231], v4, s[4:7], s78 offen
  v_cvt_pk_bf16_f32 v236, v52, v68
  v_cvt_pk_bf16_f32 v237, v84, v100
  v_cvt_pk_bf16_f32 v238, v53, v69
  v_cvt_pk_bf16_f32 v239, v85, v101
  v_permlane16_swap_b32 v232, v234
  v_permlane16_swap_b32 v233, v235
  s_add_u32 s78, s86, 294912
  v_bfi_b32 v232, v254, s42, v232
  buffer_store_dwordx4 v[232:235], v4, s[4:7], s78 offen
  v_cvt_pk_bf16_f32 v240, v54, v70
  v_cvt_pk_bf16_f32 v241, v86, v102
  v_cvt_pk_bf16_f32 v242, v55, v71
  v_cvt_pk_bf16_f32 v243, v87, v103
  v_permlane16_swap_b32 v236, v238
  v_permlane16_swap_b32 v237, v239
  s_add_u32 s78, s86, 393216
  v_bfi_b32 v236, v254, s42, v236
  buffer_store_dwordx4 v[236:239], v4, s[4:7], s78 offen
  v_permlane16_swap_b32 v240, v242
  v_permlane16_swap_b32 v241, v243
  s_add_u32 s78, s86, 425984
  v_bfi_b32 v240, v254, s42, v240
  buffer_store_dwordx4 v[240:243], v4, s[4:7], s78 offen
  s_waitcnt vmcnt(8)
  s_branch o_we_105
o_wr0_102:
  s_waitcnt lgkmcnt(0)
  s_barrier
  ds_read_b128 v[104:107], v3 offset:0
  ds_read_b128 v[108:111], v3 offset:512
  ds_read_b128 v[112:115], v3 offset:1024
  s_waitcnt lgkmcnt(2)
  v_mfma_f32_32x32x16_bf16 v[40:55], v[104:107], a[0:3], 0
  v_mfma_f32_32x32x16_bf16 v[56:71], v[104:107], a[4:7], 0
  ds_read_b128 v[116:119], v3 offset:1536
  v_mfma_f32_32x32x16_bf16 v[72:87], v[104:107], a[8:11], 0
  v_mfma_f32_32x32x16_bf16 v[88:103], v[104:107], a[12:15], 0
  s_waitcnt lgkmcnt(2)
  v_mfma_f32_32x32x16_bf16 v[40:55], v[108:111], a[16:19], v[40:55]
  v_mfma_f32_32x32x16_bf16 v[56:71], v[108:111], a[20:23], v[56:71]
  ds_read_b128 v[104:107], v3 offset:2048
  v_mfma_f32_32x32x16_bf16 v[72:87], v[108:111], a[24:27], v[72:87]
  v_mfma_f32_32x32x16_bf16 v[88:103], v[108:111], a[28:31], v[88:103]
  s_waitcnt lgkmcnt(2)
  v_mfma_f32_32x32x16_bf16 v[40:55], v[112:115], a[32:35], v[40:55]
  v_mfma_f32_32x32x16_bf16 v[56:71], v[112:115], a[36:39], v[56:71]
  ds_read_b128 v[108:111], v3 offset:2560
  v_mfma_f32_32x32x16_bf16 v[72:87], v[112:115], a[40:43], v[72:87]
  v_mfma_f32_32x32x16_bf16 v[88:103], v[112:115], a[44:47], v[88:103]
  s_waitcnt lgkmcnt(2)
  v_mfma_f32_32x32x16_bf16 v[40:55], v[116:119], a[48:51], v[40:55]
  v_mfma_f32_32x32x16_bf16 v[56:71], v[116:119], a[52:55], v[56:71]
  ds_read_b128 v[112:115], v3 offset:3072
  v_mfma_f32_32x32x16_bf16 v[72:87], v[116:119], a[56:59], v[72:87]
  v_mfma_f32_32x32x16_bf16 v[88:103], v[116:119], a[60:63], v[88:103]
  s_waitcnt lgkmcnt(2)
  v_mfma_f32_32x32x16_bf16 v[40:55], v[104:107], a[64:67], v[40:55]
  v_mfma_f32_32x32x16_bf16 v[56:71], v[104:107], a[68:71], v[56:71]
  ds_read_b128 v[116:119], v3 offset:3584
  v_mfma_f32_32x32x16_bf16 v[72:87], v[104:107], a[72:75], v[72:87]
  v_mfma_f32_32x32x16_bf16 v[88:103], v[104:107], a[76:79], v[88:103]
  s_waitcnt lgkmcnt(2)
  v_mfma_f32_32x32x16_bf16 v[40:55], v[108:111], a[80:83], v[40:55]
  v_mfma_f32_32x32x16_bf16 v[56:71], v[108:111], a[84:87], v[56:71]
  ds_read_b128 v[104:107], v3 offset:8192
  v_mfma_f32_32x32x16_bf16 v[72:87], v[108:111], a[88:91], v[72:87]
  v_mfma_f32_32x32x16_bf16 v[88:103], v[108:111], a[92:95], v[88:103]
  s_waitcnt lgkmcnt(2)
  v_mfma_f32_32x32x16_bf16 v[40:55], v[112:115], a[96:99], v[40:55]
  v_mfma_f32_32x32x16_bf16 v[56:71], v[112:115], a[100:103], v[56:71]
  ds_read_b128 v[108:111], v3 offset:8704
  v_mfma_f32_32x32x16_bf16 v[72:87], v[112:115], a[104:107], v[72:87]
  v_mfma_f32_32x32x16_bf16 v[88:103], v[112:115], a[108:111], v[88:103]
  s_waitcnt lgkmcnt(2)
  v_mfma_f32_32x32x16_bf16 v[40:55], v[116:119], a[112:115], v[40:55]
  v_mfma_f32_32x32x16_bf16 v[56:71], v[116:119], a[116:119], v[56:71]
  ds_read_b128 v[112:115], v3 offset:9216
  v_mfma_f32_32x32x16_bf16 v[72:87], v[116:119], a[120:123], v[72:87]
  v_mfma_f32_32x32x16_bf16 v[88:103], v[116:119], a[124:127], v[88:103]
  s_waitcnt lgkmcnt(2)
  v_mfma_f32_32x32x16_bf16 v[40:55], v[104:107], a[128:131], v[40:55]
  v_mfma_f32_32x32x16_bf16 v[56:71], v[104:107], a[132:135], v[56:71]
  ds_read_b128 v[116:119], v3 offset:9728
  v_mfma_f32_32x32x16_bf16 v[72:87], v[104:107], a[136:139], v[72:87]
  v_mfma_f32_32x32x16_bf16 v[88:103], v[104:107], a[140:143], v[88:103]
  s_waitcnt lgkmcnt(2)
  v_mfma_f32_32x32x16_bf16 v[40:55], v[108:111], a[144:147], v[40:55]
  v_mfma_f32_32x32x16_bf16 v[56:71], v[108:111], a[148:151], v[56:71]
  ds_read_b128 v[104:107], v3 offset:10240
  v_mfma_f32_32x32x16_bf16 v[72:87], v[108:111], a[152:155], v[72:87]
  v_mfma_f32_32x32x16_bf16 v[88:103], v[108:111], a[156:159], v[88:103]
  s_waitcnt lgkmcnt(2)
  v_mfma_f32_32x32x16_bf16 v[40:55], v[112:115], a[160:163], v[40:55]
  v_mfma_f32_32x32x16_bf16 v[56:71], v[112:115], a[164:167], v[56:71]
  ds_read_b128 v[108:111], v3 offset:10752
  v_mfma_f32_32x32x16_bf16 v[72:87], v[112:115], a[168:171], v[72:87]
  v_mfma_f32_32x32x16_bf16 v[88:103], v[112:115], a[172:175], v[88:103]
  s_waitcnt lgkmcnt(2)
  v_mfma_f32_32x32x16_bf16 v[40:55], v[116:119], a[176:179], v[40:55]
  v_mfma_f32_32x32x16_bf16 v[56:71], v[116:119], a[180:183], v[56:71]
  ds_read_b128 v[112:115], v3 offset:11264
  v_mfma_f32_32x32x16_bf16 v[72:87], v[116:119], a[184:187], v[72:87]
  v_mfma_f32_32x32x16_bf16 v[88:103], v[116:119], a[188:191], v[88:103]
  s_waitcnt lgkmcnt(2)
  v_mfma_f32_32x32x16_bf16 v[40:55], v[104:107], a[192:195], v[40:55]
  v_mfma_f32_32x32x16_bf16 v[56:71], v[104:107], a[196:199], v[56:71]
  ds_read_b128 v[116:119], v3 offset:11776
  v_mfma_f32_32x32x16_bf16 v[72:87], v[104:107], a[200:203], v[72:87]
  v_mfma_f32_32x32x16_bf16 v[88:103], v[104:107], a[204:207], v[88:103]
  s_waitcnt lgkmcnt(2)
  v_mfma_f32_32x32x16_bf16 v[40:55], v[108:111], a[208:211], v[40:55]
  v_mfma_f32_32x32x16_bf16 v[56:71], v[108:111], a[212:215], v[56:71]
  v_mfma_f32_32x32x16_bf16 v[72:87], v[108:111], a[216:219], v[72:87]
  v_mfma_f32_32x32x16_bf16 v[88:103], v[108:111], a[220:223], v[88:103]
  s_waitcnt lgkmcnt(1)
  v_mfma_f32_32x32x16_bf16 v[40:55], v[112:115], a[224:227], v[40:55]
  v_mfma_f32_32x32x16_bf16 v[56:71], v[112:115], a[228:231], v[56:71]
  v_mfma_f32_32x32x16_bf16 v[72:87], v[112:115], a[232:235], v[72:87]
  v_mfma_f32_32x32x16_bf16 v[88:103], v[112:115], a[236:239], v[88:103]
  s_waitcnt lgkmcnt(0)
  v_mfma_f32_32x32x16_bf16 v[40:55], v[116:119], a[240:243], v[40:55]
  v_mfma_f32_32x32x16_bf16 v[56:71], v[116:119], a[244:247], v[56:71]
  v_mfma_f32_32x32x16_bf16 v[72:87], v[116:119], a[248:251], v[72:87]
  v_mfma_f32_32x32x16_bf16 v[88:103], v[116:119], a[252:255], v[88:103]
  s_nop 3
  s_nop 0
  s_nop 3
  s_nop 0
  v_cvt_pk_bf16_f32 v212, v40, v56
  s_nop 0
  v_cvt_pk_bf16_f32 v213, v72, v88
  v_cvt_pk_bf16_f32 v214, v41, v57
  v_cvt_pk_bf16_f32 v215, v73, v89
  v_cvt_pk_bf16_f32 v216, v42, v58
  v_cvt_pk_bf16_f32 v217, v74, v90
  v_cvt_pk_bf16_f32 v218, v43, v59
  v_cvt_pk_bf16_f32 v219, v75, v91
  v_permlane16_swap_b32 v212, v214
  v_permlane16_swap_b32 v213, v215
  s_add_u32 s78, s86, 0
  v_bfi_b32 v212, v254, s42, v212
  buffer_store_dwordx4 v[212:215], v4, s[4:7], s78 offen
  v_cvt_pk_bf16_f32 v220, v44, v60
  v_cvt_pk_bf16_f32 v221, v76, v92
  v_cvt_pk_bf16_f32 v222, v45, v61
  v_cvt_pk_bf16_f32 v223, v77, v93
  v_permlane16_swap_b32 v216, v218
  v_permlane16_swap_b32 v217, v219
  s_add_u32 s78, s86, 32768
  v_bfi_b32 v216, v254, s42, v216
  buffer_store_dwordx4 v[216:219], v4, s[4:7], s78 offen
  v_cvt_pk_bf16_f32 v224, v46, v62
  v_cvt_pk_bf16_f32 v225, v78, v94
  v_cvt_pk_bf16_f32 v226, v47, v63
  v_cvt_pk_bf16_f32 v227, v79, v95
  v_permlane16_swap_b32 v220, v222
  v_permlane16_swap_b32 v221, v223
  s_add_u32 s78, s86, 131072
  v_bfi_b32 v220, v254, s42, v220
  buffer_store_dwordx4 v[220:223], v4, s[4:7], s78 offen
  v_cvt_pk_bf16_f32 v228, v48, v64
  v_cvt_pk_bf16_f32 v229, v80, v96
  v_cvt_pk_bf16_f32 v230, v49, v65
  v_cvt_pk_bf16_f32 v231, v81, v97
  v_permlane16_swap_b32 v224, v226
  v_permlane16_swap_b32 v225, v227
  s_add_u32 s78, s86, 163840
  v_bfi_b32 v224, v254, s42, v224
  buffer_store_dwordx4 v[224:227], v4, s[4:7], s78 offen
  v_cvt_pk_bf16_f32 v232, v50, v66
  v_cvt_pk_bf16_f32 v233, v82, v98
  v_cvt_pk_bf16_f32 v234, v51, v67
  v_cvt_pk_bf16_f32 v235, v83, v99
  v_permlane16_swap_b32 v228, v230
  v_permlane16_swap_b32 v229, v231
  s_add_u32 s78, s86, 262144
  v_bfi_b32 v228, v254, s42, v228
  buffer_store_dwordx4 v[228:231], v4, s[4:7], s78 offen
  v_cvt_pk_bf16_f32 v236, v52, v68
  v_cvt_pk_bf16_f32 v237, v84, v100
  v_cvt_pk_bf16_f32 v238, v53, v69
  v_cvt_pk_bf16_f32 v239, v85, v101
  v_permlane16_swap_b32 v232, v234
  v_permlane16_swap_b32 v233, v235
  s_add_u32 s78, s86, 294912
  v_bfi_b32 v232, v254, s42, v232
  buffer_store_dwordx4 v[232:235], v4, s[4:7], s78 offen
  v_cvt_pk_bf16_f32 v240, v54, v70
  v_cvt_pk_bf16_f32 v241, v86, v102
  v_cvt_pk_bf16_f32 v242, v55, v71
  v_cvt_pk_bf16_f32 v243, v87, v103
  v_permlane16_swap_b32 v236, v238
  v_permlane16_swap_b32 v237, v239
  s_add_u32 s78, s86, 393216
  v_bfi_b32 v236, v254, s42, v236
  buffer_store_dwordx4 v[236:239], v4, s[4:7], s78 offen
  v_permlane16_swap_b32 v240, v242
  v_permlane16_swap_b32 v241, v243
  s_add_u32 s78, s86, 425984
  v_bfi_b32 v240, v254, s42, v240
  buffer_store_dwordx4 v[240:243], v4, s[4:7], s78 offen
  s_branch o_we_105
o_wr1_103:
  s_nop 0
  s_nop 1
  s_nop 1
  v_mul_f32 v112, s24, v112
  v_mul_f32 v113, s24, v113
  v_exp_f32 v64, v112
  v_exp_f32 v65, v113
  v_max_f32 v116, v111, v116
  v_max3_f32 v116, v112, v113, v116
  v_add_f32 v117, v117, v64
  v_add_f32 v118, v118, v65
  v_add_f32 v117, v117, v118
  s_mov_b32 s28, 0x21800000
  v_mov_b32 v118, v117
  s_nop 1
  v_permlane16_swap_b32 v117, v118
  v_add_f32 v117, v117, v118
  v_mov_b32 v118, v117
  s_nop 0
  s_nop 0
  v_permlane32_swap_b32 v117, v118
  v_add_f32 v117, v117, v118
  s_mov_b32 s67, 0
  s_mov_b64 vcc, 0
  s_waitcnt vmcnt(2)
o_pl_110:
  v_and_b32 v7, 1, v7
  v_cmp_ne_u32 vcc, s96, v7
  s_cbranch_vccz o_pk_111
  buffer_load_dword v7, v255, s[4:7], s97 offen sc1
  s_add_u32 s67, s67, 1
  s_cmp_gt_u32 s67, 1048576
  s_cbranch_scc1 L_end
  s_waitcnt vmcnt(0)
  s_branch o_pl_110
o_pk_111:
  s_lshl_b32 s94, s43, 14
  s_add_u32 s94, s94, s95
  buffer_load_dwordx4 v[120:123], v5, s[4:7], s94 offen offset:0 sc1
  v_cmp_lt_f32 vcc, 0x42700000, v116
  v_cmp_gt_f32 s[30:31], s28, v117
  v_rcp_f32 v117, v117
  buffer_load_dwordx4 v[124:127], v5, s[4:7], s94 offen offset:256 sc1
  s_or_b64 vcc, vcc, s[30:31]
  s_cbranch_vccnz o_fb_108
o_fbr_109:
  buffer_load_dwordx4 v[128:131], v5, s[4:7], s94 offen offset:512 sc1
  v_pk_mul_f32 v[56:57], v[56:57], v[116:117] op_sel:[0,1] op_sel_hi:[1,1]
  v_pk_mul_f32 v[58:59], v[58:59], v[116:117] op_sel:[0,1] op_sel_hi:[1,1]
  v_pk_mul_f32 v[60:61], v[60:61], v[116:117] op_sel:[0,1] op_sel_hi:[1,1]
  v_pk_mul_f32 v[62:63], v[62:63], v[116:117] op_sel:[0,1] op_sel_hi:[1,1]
  v_pk_mul_f32 v[64:65], v[64:65], v[116:117] op_sel:[0,1] op_sel_hi:[1,1]
  buffer_load_dwordx4 v[132:135], v5, s[4:7], s94 offen offset:768 sc1
  v_cvt_pk_bf16_f32 v116, v56, v57
  v_cvt_pk_bf16_f32 v117, v58, v59
  v_cvt_pk_bf16_f32 v118, v60, v61
  v_cvt_pk_bf16_f32 v119, v62, v63
  s_waitcnt lgkmcnt(0)
  s_nop 0
  v_mfma_f32_16x16x32_bf16 v[72:75], v[152:155], v[116:119], 0
  s_add_u32 s62, s62, 1
  v_cvt_pk_bf16_f32 v197, v64, v65
  v_cvt_pk_bf16_f32 v198, v64, v65
  v_mfma_f32_16x16x32_bf16 v[76:79], v[156:159], v[116:119], 0
  s_add_u32 s94, s94, 4096
  buffer_load_dwordx4 v[136:139], v5, s[4:7], s94 offen offset:0 sc1
  s_xor_b32 s86, s86, 524288
  v_mfma_f32_16x16x32_bf16 v[80:83], v[160:163], v[116:119], 0
  s_bfe_u32 s42, s62, 0x10001
  v_mfma_f32_16x16x32_bf16 v[84:87], v[164:167], v[116:119], 0
  buffer_load_dwordx4 v[140:143], v5, s[4:7], s94 offen offset:256 sc1
  v_mfma_f32_16x16x32_bf16 v[88:91], v[168:171], v[116:119], 0
  v_mfma_f32_16x16x32_bf16 v[92:95], v[172:175], v[116:119], 0
  buffer_load_dwordx4 v[144:147], v5, s[4:7], s94 offen offset:512 sc1
  v_mfma_f32_16x16x32_bf16 v[96:99], v[176:179], v[116:119], 0
  v_mfma_f32_16x16x32_bf16 v[100:103], v[180:183], v[116:119], 0
  buffer_load_dwordx4 v[148:151], v5, s[4:7], s94 offen offset:768 sc1
  v_mfma_f32_16x16x16_bf16 v[72:75], v[200:201], v[198:199], v[72:75]
  s_nop 1
  v_mfma_f32_16x16x16_bf16 v[76:79], v[200:201], v[196:197], v[76:79]
  s_add_u32 s94, s94, 4096
  buffer_load_dwordx4 v[152:155], v5, s[4:7], s94 offen offset:0 sc1
  v_mfma_f32_16x16x16_bf16 v[80:83], v[202:203], v[198:199], v[80:83]
  s_nop 1
  v_mfma_f32_16x16x16_bf16 v[84:87], v[202:203], v[196:197], v[84:87]
  buffer_load_dwordx4 v[156:159], v5, s[4:7], s94 offen offset:256 sc1
  v_mfma_f32_16x16x16_bf16 v[88:91], v[204:205], v[198:199], v[88:91]
  s_nop 0
  v_cvt_pk_bf16_f32 v40, v72, v73
  v_cvt_pk_bf16_f32 v41, v74, v75
  v_mfma_f32_16x16x16_bf16 v[92:95], v[204:205], v[196:197], v[92:95]
  buffer_load_dwordx4 v[160:163], v5, s[4:7], s94 offen offset:512 sc1
  v_cvt_pk_bf16_f32 v42, v76, v77
  v_cvt_pk_bf16_f32 v43, v78, v79
  v_mfma_f32_16x16x16_bf16 v[96:99], v[206:207], v[198:199], v[96:99]
  s_nop 0
  ds_write_b128 v6, v[40:43] offset:0
  v_cvt_pk_bf16_f32 v44, v80, v81
  v_mfma_f32_16x16x16_bf16 v[100:103], v[206:207], v[196:197], v[100:103]
  buffer_load_dwordx4 v[164:167], v5, s[4:7], s94 offen offset:768 sc1
  v_cvt_pk_bf16_f32 v45, v82, v83
  v_cvt_pk_bf16_f32 v46, v84, v85
  v_cvt_pk_bf16_f32 v47, v86, v87
  ds_write_b128 v6, v[44:47] offset:1024
  v_cvt_pk_bf16_f32 v48, v88, v89
  v_cvt_pk_bf16_f32 v49, v90, v91
  v_cvt_pk_bf16_f32 v50, v92, v93
  v_cvt_pk_bf16_f32 v51, v94, v95
  s_add_u32 s94, s94, 4096
  buffer_load_dwordx4 v[168:171], v5, s[4:7], s94 offen offset:0 sc1
  ds_write_b128 v6, v[48:51] offset:2048
  v_cvt_pk_bf16_f32 v52, v96, v97
  v_cvt_pk_bf16_f32 v53, v98, v99
  v_cvt_pk_bf16_f32 v54, v100, v101
  v_cvt_pk_bf16_f32 v55, v102, v103
  ds_write_b128 v6, v[52:55] offset:3072
  buffer_load_dwordx4 v[172:175], v5, s[4:7], s94 offen offset:256 sc1
  s_and_b32 s26, s65, 49152
  s_cbranch_scc1 o_wr2_104
  s_waitcnt lgkmcnt(0)
  s_barrier
  ds_read_b128 v[104:107], v3 offset:0
  ds_read_b128 v[108:111], v3 offset:512
  ds_read_b128 v[112:115], v3 offset:1024
  buffer_load_dwordx4 v[176:179], v5, s[4:7], s94 offen offset:512 sc1
  buffer_load_dwordx4 v[180:183], v5, s[4:7], s94 offen offset:768 sc1
  s_waitcnt lgkmcnt(2)
  v_mfma_f32_32x32x16_bf16 v[40:55], v[104:107], a[0:3], 0
  s_and_b32 s91, s65, 63
  s_lshl_b32 s90, s91, 5
  s_add_u32 s90, s90, s43
  s_lshl_b32 s91, s90, 10
  buffer_load_dwordx4 v[184:187], v0, s[72:75], s91 offen
  v_mfma_f32_32x32x16_bf16 v[56:71], v[104:107], a[4:7], 0
  ds_read_b128 v[116:119], v3 offset:1536
  s_mov_b64 exec, 1
  buffer_store_dword v38, off, s[4:7], s84 sc1
  s_mov_b64 exec, -1
  s_mov_b32 s84, 268435456
  v_mfma_f32_32x32x16_bf16 v[72:87], v[104:107], a[8:11], 0
  v_mfma_f32_32x32x16_bf16 v[88:103], v[104:107], a[12:15], 0
  s_waitcnt vmcnt(14)
  v_xor_b32 v7, s96, v120
  v_bitop3_b32 v7, v7, v124, s96 bitop3:0xf6
  v_bitop3_b32 v7, v7, v128, s96 bitop3:0xf6
  v_bitop3_b32 v7, v7, v132, s96 bitop3:0xf6
  s_waitcnt lgkmcnt(2)
  v_mfma_f32_32x32x16_bf16 v[40:55], v[108:111], a[16:19], v[40:55]
  s_waitcnt vmcnt(10)
  v_bitop3_b32 v7, v7, v136, s96 bitop3:0xf6
  v_bitop3_b32 v7, v7, v140, s96 bitop3:0xf6
  v_bitop3_b32 v7, v7, v144, s96 bitop3:0xf6
  v_bitop3_b32 v7, v7, v148, s96 bitop3:0xf6
  s_waitcnt vmcnt(6)
  v_mfma_f32_32x32x16_bf16 v[56:71], v[108:111], a[20:23], v[56:71]
  ds_read_b128 v[104:107], v3 offset:2048
  v_bitop3_b32 v7, v7, v152, s96 bitop3:0xf6
  v_bitop3_b32 v7, v7, v156, s96 bitop3:0xf6
  v_bitop3_b32 v7, v7, v160, s96 bitop3:0xf6
  v_bitop3_b32 v7, v7, v164, s96 bitop3:0xf6
  s_waitcnt vmcnt(2)
  v_mfma_f32_32x32x16_bf16 v[72:87], v[108:111], a[24:27], v[72:87]
  v_bitop3_b32 v7, v7, v168, s96 bitop3:0xf6
  v_bitop3_b32 v7, v7, v172, s96 bitop3:0xf6
  v_bitop3_b32 v7, v7, v176, s96 bitop3:0xf6
  v_bitop3_b32 v7, v7, v180, s96 bitop3:0xf6
  v_and_b32 v7, v254, v7
  v_cmp_ne_u32 vcc, 0, v7
  s_cbranch_vccnz o_rt_112
o_bk_113:
  v_mfma_f32_32x32x16_bf16 v[88:103], v[108:111], a[28:31], v[88:103]
  v_mfma_f32_16x16x32_bf16 v[188:191], v[16:19], v[120:123], 0
  v_mfma_f32_16x16x32_bf16 v[192:195], v[16:19], v[124:127], 0
  v_mfma_f32_16x16x32_bf16 v[188:191], v[20:23], v[128:131], v[188:191]
  s_waitcnt lgkmcnt(2)
  v_mfma_f32_32x32x16_bf16 v[40:55], v[112:115], a[32:35], v[40:55]
  v_mfma_f32_16x16x32_bf16 v[192:195], v[20:23], v[132:135], v[192:195]
  v_mfma_f32_16x16x32_bf16 v[188:191], v[16:19], v[136:139], v[188:191]
  v_mfma_f32_16x16x32_bf16 v[192:195], v[16:19], v[140:143], v[192:195]
  v_mfma_f32_32x32x16_bf16 v[56:71], v[112:115], a[36:39], v[56:71]
  ds_read_b128 v[108:111], v3 offset:2560
  v_mfma_f32_16x16x32_bf16 v[188:191], v[20:23], v[144:147], v[188:191]
  v_mfma_f32_16x16x32_bf16 v[192:195], v[20:23], v[148:151], v[192:195]
  v_mfma_f32_16x16x32_bf16 v[188:191], v[16:19], v[152:155], v[188:191]
  v_mfma_f32_32x32x16_bf16 v[72:87], v[112:115], a[40:43], v[72:87]
  v_mfma_f32_16x16x32_bf16 v[192:195], v[16:19], v[156:159], v[192:195]
  v_mfma_f32_16x16x32_bf16 v[188:191], v[20:23], v[160:163], v[188:191]
  v_mfma_f32_16x16x32_bf16 v[192:195], v[20:23], v[164:167], v[192:195]
  v_mfma_f32_32x32x16_bf16 v[88:103], v[112:115], a[44:47], v[88:103]
  v_mfma_f32_16x16x32_bf16 v[188:191], v[16:19], v[168:171], v[188:191]
  v_mfma_f32_16x16x32_bf16 v[192:195], v[16:19], v[172:175], v[192:195]
  v_mfma_f32_16x16x32_bf16 v[188:191], v[20:23], v[176:179], v[188:191]
  s_waitcnt lgkmcnt(2)
  v_mfma_f32_32x32x16_bf16 v[40:55], v[116:119], a[48:51], v[40:55]
  v_mfma_f32_16x16x32_bf16 v[192:195], v[20:23], v[180:183], v[192:195]
  s_bfe_u32 s92, s65, 131086
  s_lshl_b32 s92, s92, 21
  s_add_u32 s92, s92, s91
  s_add_u32 s93, s92, 27262976
  v_mfma_f32_32x32x16_bf16 v[56:71], v[116:119], a[52:55], v[56:71]
  ds_read_b128 v[112:115], v3 offset:3072
  s_add_u32 s92, s92, 20971520
  s_waitcnt vmcnt(1)
  v_lshlrev_b32 v196, 16, v184
  v_and_b32 v197, 0xffff0000, v184
  v_lshlrev_b32 v198, 16, v185
  v_mfma_f32_32x32x16_bf16 v[72:87], v[116:119], a[56:59], v[72:87]
  v_and_b32 v199, 0xffff0000, v185
  v_lshlrev_b32 v200, 16, v186
  v_and_b32 v201, 0xffff0000, v186
  v_lshlrev_b32 v202, 16, v187
  v_and_b32 v203, 0xffff0000, v187
  v_permlane16_swap_b32 v188, v192
  v_mfma_f32_32x32x16_bf16 v[88:103], v[116:119], a[60:63], v[88:103]
  v_permlane16_swap_b32 v189, v193
  v_permlane16_swap_b32 v190, v194
  v_permlane16_swap_b32 v191, v195
  s_waitcnt lgkmcnt(2)
  v_mfma_f32_32x32x16_bf16 v[40:55], v[104:107], a[64:67], v[40:55]
  v_cvt_pk_bf16_f32 v188, 0, v188
  v_cvt_pk_bf16_f32 v189, 0, v189
  v_cvt_pk_bf16_f32 v190, 0, v190
  v_cvt_pk_bf16_f32 v191, 0, v191
  v_cvt_pk_bf16_f32 v192, 0, v192
  v_cvt_pk_bf16_f32 v193, 0, v193
  v_mfma_f32_32x32x16_bf16 v[56:71], v[104:107], a[68:71], v[56:71]
  ds_read_b128 v[116:119], v3 offset:3584
  v_cvt_pk_bf16_f32 v194, 0, v194
  v_cvt_pk_bf16_f32 v195, 0, v195
  v_add_f32 v196, v196, v188
  v_add_f32 v197, v197, v189
  v_add_f32 v198, v198, v190
  v_mfma_f32_32x32x16_bf16 v[72:87], v[104:107], a[72:75], v[72:87]
  v_add_f32 v199, v199, v191
  v_add_f32 v200, v200, v192
  v_add_f32 v201, v201, v193
  v_add_f32 v202, v202, v194
  v_add_f32 v203, v203, v195
  v_cvt_pk_bf16_f32 v120, v196, v197
  v_mfma_f32_32x32x16_bf16 v[88:103], v[104:107], a[76:79], v[88:103]
  v_cvt_pk_bf16_f32 v121, v198, v199
  v_cvt_pk_bf16_f32 v122, v200, v201
  v_cvt_pk_bf16_f32 v123, v202, v203
  v_lshlrev_b32 v196, 16, v120
  v_and_b32 v197, 0xffff0000, v120
  s_waitcnt lgkmcnt(2)
  v_mfma_f32_32x32x16_bf16 v[40:55], v[108:111], a[80:83], v[40:55]
  v_lshlrev_b32 v198, 16, v121
  v_and_b32 v199, 0xffff0000, v121
  v_lshlrev_b32 v200, 16, v122
  v_and_b32 v201, 0xffff0000, v122
  v_lshlrev_b32 v202, 16, v123
  v_and_b32 v203, 0xffff0000, v123
  v_mfma_f32_32x32x16_bf16 v[56:71], v[108:111], a[84:87], v[56:71]
  ds_read_b128 v[104:107], v3 offset:8192
  buffer_store_dwordx4 v[120:123], v0, s[4:7], s92 offen sc1
  v_add_f32 v136, v196, v197
  v_mul_f32 v137, v196, v196
  v_mfma_f32_32x32x16_bf16 v[72:87], v[108:111], a[88:91], v[72:87]
  v_add_f32 v138, v198, v199
  v_mul_f32 v139, v197, v197
  v_fmac_f32 v137, v198, v198
  v_fmac_f32 v139, v199, v199
  v_add_f32 v136, v136, v200
  v_fmac_f32 v137, v200, v200
  v_mfma_f32_32x32x16_bf16 v[88:103], v[108:111], a[92:95], v[88:103]
  v_add_f32 v138, v138, v201
  v_fmac_f32 v139, v201, v201
  v_add_f32 v136, v136, v202
  v_fmac_f32 v137, v202, v202
  v_add_f32 v138, v138, v203
  s_waitcnt lgkmcnt(2)
  v_mfma_f32_32x32x16_bf16 v[40:55], v[112:115], a[96:99], v[40:55]
  v_fmac_f32 v139, v203, v203
  v_add_f32 v136, v136, v138
  v_add_f32 v137, v137, v139
  s_nop 0
  v_add_f32_dpp v136, v136, v136 row_ror:8 row_mask:0xf bank_mask:0xf
  v_add_f32_dpp v137, v137, v137 row_ror:8 row_mask:0xf bank_mask:0xf
  s_nop 0
  v_add_f32_dpp v136, v136, v136 row_ror:4 row_mask:0xf bank_mask:0xf
  v_mfma_f32_32x32x16_bf16 v[56:71], v[112:115], a[100:103], v[56:71]
  ds_read_b128 v[108:111], v3 offset:8704
  v_add_f32_dpp v137, v137, v137 row_ror:4 row_mask:0xf bank_mask:0xf
  v_add_f32_dpp v136, v136, v136 row_ror:2 row_mask:0xf bank_mask:0xf
  s_nop 0
  v_add_f32_dpp v137, v137, v137 row_ror:2 row_mask:0xf bank_mask:0xf
  v_add_f32_dpp v136, v136, v136 row_ror:1 row_mask:0xf bank_mask:0xf
  s_nop 0
  v_add_f32_dpp v137, v137, v137 row_ror:1 row_mask:0xf bank_mask:0xf
  v_mfma_f32_32x32x16_bf16 v[72:87], v[112:115], a[104:107], v[72:87]
  v_mov_b32 v140, v136
  v_mov_b32 v141, v137
  s_nop 0
  v_permlane16_swap_b32 v136, v140
  v_permlane16_swap_b32 v137, v141
  v_mfma_f32_32x32x16_bf16 v[88:103], v[112:115], a[108:111], v[88:103]
  v_add_f32 v136, v136, v140
  v_add_f32 v137, v137, v141
  v_mov_b32 v140, v136
  v_mov_b32 v141, v137
  s_nop 0
  v_permlane32_swap_b32 v136, v140
  s_waitcnt lgkmcnt(2)
  v_mfma_f32_32x32x16_bf16 v[40:55], v[116:119], a[112:115], v[40:55]
  v_permlane32_swap_b32 v137, v141
  v_add_f32 v136, v136, v140
  v_add_f32 v137, v137, v141
  v_mul_f32 v136, 0x3b000000, v136
  v_mul_f32 v137, 0x3b000000, v137
  v_mfma_f32_32x32x16_bf16 v[56:71], v[116:119], a[116:119], v[56:71]
  ds_read_b128 v[112:115], v3 offset:9216
  v_fma_f32 v137, -v136, v136, v137
  v_cvt_pk_bf16_f32 v136, 0, v136
  v_max_f32 v137, 0, v137
  v_sub_f32 v140, v196, v136
  v_sub_f32 v141, v197, v136
  v_mfma_f32_32x32x16_bf16 v[72:87], v[116:119], a[120:123], v[72:87]
  v_cvt_pk_bf16_f32 v137, 0, v137
  v_sub_f32 v142, v198, v136
  v_sub_f32 v143, v199, v136
  v_add_f32 v137, 0x3727c5ac, v137
  v_sub_f32 v144, v200, v136
  v_sub_f32 v145, v201, v136
  v_mfma_f32_32x32x16_bf16 v[88:103], v[116:119], a[124:127], v[88:103]
  v_cvt_pk_bf16_f32 v137, 0, v137
  v_sub_f32 v146, v202, v136
  v_sub_f32 v147, v203, v136
  v_sqrt_f32 v137, v137
  s_waitcnt lgkmcnt(2)
  v_mfma_f32_32x32x16_bf16 v[40:55], v[104:107], a[128:131], v[40:55]
  v_cvt_pk_bf16_f32 v140, 0, v140
  v_cvt_pk_bf16_f32 v141, 0, v141
  v_cvt_pk_bf16_f32 v137, 0, v137
  v_cvt_pk_bf16_f32 v142, 0, v142
  v_cvt_pk_bf16_f32 v143, 0, v143
  v_rcp_f32 v137, v137
  v_mfma_f32_32x32x16_bf16 v[56:71], v[104:107], a[132:135], v[56:71]
  ds_read_b128 v[116:119], v3 offset:9728
  v_cvt_pk_bf16_f32 v144, 0, v144
  v_cvt_pk_bf16_f32 v145, 0, v145
  v_cvt_pk_bf16_f32 v146, 0, v146
  v_cvt_pk_bf16_f32 v147, 0, v147
  v_mul_f32 v140, v140, v137
  v_mfma_f32_32x32x16_bf16 v[72:87], v[104:107], a[136:139], v[72:87]
  v_mul_f32 v141, v141, v137
  v_mul_f32 v142, v142, v137
  v_mul_f32 v143, v143, v137
  v_mul_f32 v144, v144, v137
  v_mul_f32 v145, v145, v137
  v_mul_f32 v146, v146, v137
  v_mfma_f32_32x32x16_bf16 v[88:103], v[104:107], a[140:143], v[88:103]
  v_mul_f32 v147, v147, v137
  v_cvt_pk_bf16_f32 v124, v140, v141
  v_cvt_pk_bf16_f32 v125, v142, v143
  v_cvt_pk_bf16_f32 v126, v144, v145
  v_cvt_pk_bf16_f32 v127, v146, v147
  s_waitcnt lgkmcnt(2)
  v_mfma_f32_32x32x16_bf16 v[40:55], v[108:111], a[144:147], v[40:55]
  v_lshlrev_b32 v204, 16, v124
  v_and_b32 v205, 0xffff0000, v124
  v_lshlrev_b32 v206, 16, v125
  v_and_b32 v207, 0xffff0000, v125
  v_lshlrev_b32 v208, 16, v126
  v_and_b32 v209, 0xffff0000, v126
  v_mfma_f32_32x32x16_bf16 v[56:71], v[108:111], a[148:151], v[56:71]
  ds_read_b128 v[104:107], v3 offset:10240
  v_lshlrev_b32 v210, 16, v127
  v_and_b32 v211, 0xffff0000, v127
  buffer_store_dwordx4 v[124:127], v0, s[4:7], s93 offen sc1
  v_mfma_f32_32x32x16_bf16 v[72:87], v[108:111], a[152:155], v[72:87]
  v_add_f32 v196, v196, v204
  v_add_f32 v197, v197, v205
  v_add_f32 v198, v198, v206
  v_add_f32 v199, v199, v207
  v_add_f32 v200, v200, v208
  v_add_f32 v201, v201, v209
  v_mfma_f32_32x32x16_bf16 v[88:103], v[108:111], a[156:159], v[88:103]
  v_add_f32 v202, v202, v210
  v_add_f32 v203, v203, v211
  v_cvt_pk_bf16_f32 v128, v196, v197
  v_cvt_pk_bf16_f32 v129, v198, v199
  v_cvt_pk_bf16_f32 v130, v200, v201
  s_waitcnt lgkmcnt(2)
  v_mfma_f32_32x32x16_bf16 v[40:55], v[112:115], a[160:163], v[40:55]
  v_cvt_pk_bf16_f32 v131, v202, v203
  v_mul_f32 v188, v204, v8
  v_mul_f32 v189, v205, v9
  v_fmac_f32 v188, v206, v10
  v_fmac_f32 v189, v207, v11
  v_fmac_f32 v188, v208, v12
  v_mfma_f32_32x32x16_bf16 v[56:71], v[112:115], a[164:167], v[56:71]
  ds_read_b128 v[108:111], v3 offset:10752
  v_fmac_f32 v189, v209, v13
  v_fmac_f32 v188, v210, v14
  v_fmac_f32 v189, v211, v15
  v_add_f32 v188, v188, v189
  s_add_u32 s92, s91, 10485760
  v_mfma_f32_32x32x16_bf16 v[72:87], v[112:115], a[168:171], v[72:87]
  s_add_u32 s93, s91, 8388608
  buffer_store_dwordx4 v[128:131], v0, s[4:7], s92 offen sc1
  v_lshlrev_b32 v196, 16, v128
  v_and_b32 v197, 0xffff0000, v128
  v_mfma_f32_32x32x16_bf16 v[88:103], v[112:115], a[172:175], v[88:103]
  v_lshlrev_b32 v198, 16, v129
  v_and_b32 v199, 0xffff0000, v129
  v_lshlrev_b32 v200, 16, v130
  v_and_b32 v201, 0xffff0000, v130
  v_lshlrev_b32 v202, 16, v131
  s_waitcnt lgkmcnt(2)
  v_mfma_f32_32x32x16_bf16 v[40:55], v[116:119], a[176:179], v[40:55]
  v_and_b32 v203, 0xffff0000, v131
  v_add_f32 v136, v196, v197
  v_mul_f32 v137, v196, v196
  v_add_f32 v138, v198, v199
  v_mul_f32 v139, v197, v197
  v_fmac_f32 v137, v198, v198
  v_mfma_f32_32x32x16_bf16 v[56:71], v[116:119], a[180:183], v[56:71]
  ds_read_b128 v[112:115], v3 offset:11264
  v_fmac_f32 v139, v199, v199
  v_add_f32 v136, v136, v200
  v_fmac_f32 v137, v200, v200
  v_add_f32 v138, v138, v201
  v_fmac_f32 v139, v201, v201
  v_mfma_f32_32x32x16_bf16 v[72:87], v[116:119], a[184:187], v[72:87]
  v_add_f32 v136, v136, v202
  v_fmac_f32 v137, v202, v202
  v_add_f32 v138, v138, v203
  v_fmac_f32 v139, v203, v203
  v_add_f32 v136, v136, v138
  v_add_f32 v137, v137, v139
  v_mfma_f32_32x32x16_bf16 v[88:103], v[116:119], a[188:191], v[88:103]
  v_add_f32_dpp v136, v136, v136 row_ror:8 row_mask:0xf bank_mask:0xf
  v_add_f32_dpp v137, v137, v137 row_ror:8 row_mask:0xf bank_mask:0xf
  v_add_f32_dpp v188, v188, v188 row_ror:8 row_mask:0xf bank_mask:0xf
  v_add_f32_dpp v136, v136, v136 row_ror:4 row_mask:0xf bank_mask:0xf
  v_add_f32_dpp v137, v137, v137 row_ror:4 row_mask:0xf bank_mask:0xf
  s_waitcnt lgkmcnt(2)
  v_mfma_f32_32x32x16_bf16 v[40:55], v[104:107], a[192:195], v[40:55]
  v_add_f32_dpp v188, v188, v188 row_ror:4 row_mask:0xf bank_mask:0xf
  v_add_f32_dpp v136, v136, v136 row_ror:2 row_mask:0xf bank_mask:0xf
  v_add_f32_dpp v137, v137, v137 row_ror:2 row_mask:0xf bank_mask:0xf
  v_add_f32_dpp v188, v188, v188 row_ror:2 row_mask:0xf bank_mask:0xf
  v_add_f32_dpp v136, v136, v136 row_ror:1 row_mask:0xf bank_mask:0xf
  v_add_f32_dpp v137, v137, v137 row_ror:1 row_mask:0xf bank_mask:0xf
  v_mfma_f32_32x32x16_bf16 v[56:71], v[104:107], a[196:199], v[56:71]
  ds_read_b128 v[116:119], v3 offset:11776
  v_add_f32_dpp v188, v188, v188 row_ror:1 row_mask:0xf bank_mask:0xf
  v_mov_b32 v140, v136
  v_mov_b32 v141, v137
  v_mov_b32 v142, v188
  v_permlane16_swap_b32 v136, v140
  v_mfma_f32_32x32x16_bf16 v[72:87], v[104:107], a[200:203], v[72:87]
  v_permlane16_swap_b32 v137, v141
  v_permlane16_swap_b32 v188, v142
  v_add_f32 v136, v136, v140
  v_add_f32 v137, v137, v141
  v_mfma_f32_32x32x16_bf16 v[88:103], v[104:107], a[204:207], v[88:103]
  v_add_f32 v188, v188, v142
  v_mov_b32 v140, v136
  v_mov_b32 v141, v137
  v_mov_b32 v142, v188
  v_permlane32_swap_b32 v136, v140
  s_waitcnt lgkmcnt(2)
  v_mfma_f32_32x32x16_bf16 v[40:55], v[108:111], a[208:211], v[40:55]
  v_permlane32_swap_b32 v137, v141
  v_permlane32_swap_b32 v188, v142
  v_add_f32 v136, v136, v140
  v_add_f32 v137, v137, v141
  v_mfma_f32_32x32x16_bf16 v[56:71], v[108:111], a[212:215], v[56:71]
  v_add_f32 v188, v188, v142
  v_mul_f32 v136, 0x3b000000, v136
  v_mul_f32 v137, 0x3b000000, v137
  v_fma_f32 v137, -v136, v136, v137
  v_cvt_pk_bf16_f32 v136, 0, v136
  v_max_f32 v137, 0, v137
  v_mfma_f32_32x32x16_bf16 v[72:87], v[108:111], a[216:219], v[72:87]
  v_sub_f32 v140, v196, v136
  v_sub_f32 v141, v197, v136
  v_cvt_pk_bf16_f32 v137, 0, v137
  v_sub_f32 v142, v198, v136
  v_sub_f32 v143, v199, v136
  v_add_f32 v137, 0x3727c5ac, v137
  v_mfma_f32_32x32x16_bf16 v[88:103], v[108:111], a[220:223], v[88:103]
  v_sub_f32 v144, v200, v136
  v_sub_f32 v145, v201, v136
  v_cvt_pk_bf16_f32 v137, 0, v137
  v_sub_f32 v146, v202, v136
  v_sub_f32 v147, v203, v136
  s_waitcnt lgkmcnt(1)
  v_mfma_f32_32x32x16_bf16 v[40:55], v[112:115], a[224:227], v[40:55]
  v_sqrt_f32 v137, v137
  v_cvt_pk_bf16_f32 v140, 0, v140
  v_cvt_pk_bf16_f32 v141, 0, v141
  v_cvt_pk_bf16_f32 v137, 0, v137
  v_cvt_pk_bf16_f32 v142, 0, v142
  v_mfma_f32_32x32x16_bf16 v[56:71], v[112:115], a[228:231], v[56:71]
  v_cvt_pk_bf16_f32 v143, 0, v143
  v_rcp_f32 v137, v137
  v_cvt_pk_bf16_f32 v144, 0, v144
  v_cvt_pk_bf16_f32 v145, 0, v145
  v_cvt_pk_bf16_f32 v146, 0, v146
  v_mfma_f32_32x32x16_bf16 v[72:87], v[112:115], a[232:235], v[72:87]
  v_cvt_pk_bf16_f32 v147, 0, v147
  v_mul_f32 v140, v140, v137
  v_mul_f32 v141, v141, v137
  v_mul_f32 v142, v142, v137
  v_mul_f32 v143, v143, v137
  v_mul_f32 v144, v144, v137
  v_mfma_f32_32x32x16_bf16 v[88:103], v[112:115], a[236:239], v[88:103]
  v_mul_f32 v145, v145, v137
  v_mul_f32 v146, v146, v137
  v_mul_f32 v147, v147, v137
  v_cvt_pk_bf16_f32 v132, v140, v141
  v_cvt_pk_bf16_f32 v133, v142, v143
  s_waitcnt lgkmcnt(0)
  v_mfma_f32_32x32x16_bf16 v[40:55], v[116:119], a[240:243], v[40:55]
  v_cvt_pk_bf16_f32 v134, v144, v145
  v_cvt_pk_bf16_f32 v135, v146, v147
  buffer_store_dwordx4 v[132:135], v0, s[4:7], s93 offen sc1
  v_cvt_pk_bf16_f32 v188, 0, v188
  v_mfma_f32_32x32x16_bf16 v[56:71], v[116:119], a[244:247], v[56:71]
  v_ashrrev_i32 v189, 31, v188
  v_or_b32 v189, 0x80000000, v189
  v_xor_b32 v188, v188, v189
  s_sub_u32 s92, 4095, s90
  v_and_b32 v188, 0xffff0000, v188
  v_or_b32 v38, s92, v188
  v_mfma_f32_32x32x16_bf16 v[72:87], v[116:119], a[248:251], v[72:87]
  s_bfe_u32 s92, s65, 196625
  s_lshl_b32 s92, s92, 18
  s_lshl_b32 s93, s90, 7
  s_add_u32 s92, s92, s93
  s_add_u32 s84, s92, 243269632
  v_mfma_f32_32x32x16_bf16 v[88:103], v[116:119], a[252:255], v[88:103]
  v_cvt_pk_bf16_f32 v212, v40, v56
  s_nop 4
  s_nop 5
  v_cvt_pk_bf16_f32 v213, v72, v88
  v_cvt_pk_bf16_f32 v214, v41, v57
  v_cvt_pk_bf16_f32 v215, v73, v89
  v_cvt_pk_bf16_f32 v216, v42, v58
  v_cvt_pk_bf16_f32 v217, v74, v90
  v_cvt_pk_bf16_f32 v218, v43, v59
  v_cvt_pk_bf16_f32 v219, v75, v91
  v_permlane16_swap_b32 v212, v214
  v_permlane16_swap_b32 v213, v215
  s_add_u32 s78, s86, 0
  v_bfi_b32 v212, v254, s42, v212
  buffer_store_dwordx4 v[212:215], v4, s[4:7], s78 offen
  v_cvt_pk_bf16_f32 v220, v44, v60
  v_cvt_pk_bf16_f32 v221, v76, v92
  v_cvt_pk_bf16_f32 v222, v45, v61
  v_cvt_pk_bf16_f32 v223, v77, v93
  v_permlane16_swap_b32 v216, v218
  v_permlane16_swap_b32 v217, v219
  s_add_u32 s78, s86, 32768
  v_bfi_b32 v216, v254, s42, v216
  buffer_store_dwordx4 v[216:219], v4, s[4:7], s78 offen
  v_cvt_pk_bf16_f32 v224, v46, v62
  v_cvt_pk_bf16_f32 v225, v78, v94
  v_cvt_pk_bf16_f32 v226, v47, v63
  v_cvt_pk_bf16_f32 v227, v79, v95
  v_permlane16_swap_b32 v220, v222
  v_permlane16_swap_b32 v221, v223
  s_add_u32 s78, s86, 131072
  v_bfi_b32 v220, v254, s42, v220
  buffer_store_dwordx4 v[220:223], v4, s[4:7], s78 offen
  v_cvt_pk_bf16_f32 v228, v48, v64
  v_cvt_pk_bf16_f32 v229, v80, v96
  v_cvt_pk_bf16_f32 v230, v49, v65
  v_cvt_pk_bf16_f32 v231, v81, v97
  v_permlane16_swap_b32 v224, v226
  v_permlane16_swap_b32 v225, v227
  s_add_u32 s78, s86, 163840
  v_bfi_b32 v224, v254, s42, v224
  buffer_store_dwordx4 v[224:227], v4, s[4:7], s78 offen
  v_cvt_pk_bf16_f32 v232, v50, v66
  v_cvt_pk_bf16_f32 v233, v82, v98
  v_cvt_pk_bf16_f32 v234, v51, v67
  v_cvt_pk_bf16_f32 v235, v83, v99
  v_permlane16_swap_b32 v228, v230
  v_permlane16_swap_b32 v229, v231
  s_add_u32 s78, s86, 262144
  v_bfi_b32 v228, v254, s42, v228
  buffer_store_dwordx4 v[228:231], v4, s[4:7], s78 offen
  v_cvt_pk_bf16_f32 v236, v52, v68
  v_cvt_pk_bf16_f32 v237, v84, v100
  v_cvt_pk_bf16_f32 v238, v53, v69
  v_cvt_pk_bf16_f32 v239, v85, v101
  v_permlane16_swap_b32 v232, v234
  v_permlane16_swap_b32 v233, v235
  s_add_u32 s78, s86, 294912
  v_bfi_b32 v232, v254, s42, v232
  buffer_store_dwordx4 v[232:235], v4, s[4:7], s78 offen
  v_cvt_pk_bf16_f32 v240, v54, v70
  v_cvt_pk_bf16_f32 v241, v86, v102
  v_cvt_pk_bf16_f32 v242, v55, v71
  v_cvt_pk_bf16_f32 v243, v87, v103
  v_permlane16_swap_b32 v236, v238
  v_permlane16_swap_b32 v237, v239
  s_add_u32 s78, s86, 393216
  v_bfi_b32 v236, v254, s42, v236
  buffer_store_dwordx4 v[236:239], v4, s[4:7], s78 offen
  v_permlane16_swap_b32 v240, v242
  v_permlane16_swap_b32 v241, v243
  s_add_u32 s78, s86, 425984
  v_bfi_b32 v240, v254, s42, v240
  buffer_store_dwordx4 v[240:243], v4, s[4:7], s78 offen
  s_waitcnt vmcnt(8)
  s_mov_b64 exec, 1
  buffer_store_dword v38, off, s[4:7], s84 sc1
  s_mov_b64 exec, -1
  s_mov_b32 s84, 268435456
  s_branch o_we_105
o_rt_112:
  s_mov_b32 s67, 0
o_rl_116:
  s_lshl_b32 s94, s43, 14
  s_add_u32 s94, s94, s95
  buffer_load_dwordx4 v[120:123], v5, s[4:7], s94 offen offset:0 sc1
  buffer_load_dwordx4 v[124:127], v5, s[4:7], s94 offen offset:256 sc1
  buffer_load_dwordx4 v[128:131], v5, s[4:7], s94 offen offset:512 sc1
  buffer_load_dwordx4 v[132:135], v5, s[4:7], s94 offen offset:768 sc1
  s_add_u32 s94, s94, 4096
  buffer_load_dwordx4 v[136:139], v5, s[4:7], s94 offen offset:0 sc1
  buffer_load_dwordx4 v[140:143], v5, s[4:7], s94 offen offset:256 sc1
  buffer_load_dwordx4 v[144:147], v5, s[4:7], s94 offen offset:512 sc1
  buffer_load_dwordx4 v[148:151], v5, s[4:7], s94 offen offset:768 sc1
  s_add_u32 s94, s94, 4096
  buffer_load_dwordx4 v[152:155], v5, s[4:7], s94 offen offset:0 sc1
  buffer_load_dwordx4 v[156:159], v5, s[4:7], s94 offen offset:256 sc1
  buffer_load_dwordx4 v[160:163], v5, s[4:7], s94 offen offset:512 sc1
  buffer_load_dwordx4 v[164:167], v5, s[4:7], s94 offen offset:768 sc1
  s_add_u32 s94, s94, 4096
  buffer_load_dwordx4 v[168:171], v5, s[4:7], s94 offen offset:0 sc1
  buffer_load_dwordx4 v[172:175], v5, s[4:7], s94 offen offset:256 sc1
  buffer_load_dwordx4 v[176:179], v5, s[4:7], s94 offen offset:512 sc1
  buffer_load_dwordx4 v[180:183], v5, s[4:7], s94 offen offset:768 sc1
  s_add_u32 s67, s67, 1
  s_cmp_gt_u32 s67, 1048576
  s_cbranch_scc1 L_end
  s_waitcnt vmcnt(0)
  v_xor_b32 v7, s96, v120
  v_bitop3_b32 v7, v7, v124, s96 bitop3:0xf6
  v_bitop3_b32 v7, v7, v128, s96 bitop3:0xf6
  v_bitop3_b32 v7, v7, v132, s96 bitop3:0xf6
  v_bitop3_b32 v7, v7, v136, s96 bitop3:0xf6
  v_bitop3_b32 v7, v7, v140, s96 bitop3:0xf6
  v_bitop3_b32 v7, v7, v144, s96 bitop3:0xf6
  v_bitop3_b32 v7, v7, v148, s96 bitop3:0xf6
  v_bitop3_b32 v7, v7, v152, s96 bitop3:0xf6
  v_bitop3_b32 v7, v7, v156, s96 bitop3:0xf6
  v_bitop3_b32 v7, v7, v160, s96 bitop3:0xf6
  v_bitop3_b32 v7, v7, v164, s96 bitop3:0xf6
  v_bitop3_b32 v7, v7, v168, s96 bitop3:0xf6
  v_bitop3_b32 v7, v7, v172, s96 bitop3:0xf6
  v_bitop3_b32 v7, v7, v176, s96 bitop3:0xf6
  v_bitop3_b32 v7, v7, v180, s96 bitop3:0xf6
  v_and_b32 v7, v254, v7
  v_cmp_ne_u32 vcc, 0, v7
  s_cbranch_vccnz o_rl_116
  s_branch o_bk_113
o_rt_114:
  s_mov_b32 s67, 0
o_rl_117:
  s_lshl_b32 s94, s43, 14
  s_add_u32 s94, s94, s95
  buffer_load_dwordx4 v[120:123], v5, s[4:7], s94 offen offset:0 sc1
  buffer_load_dwordx4 v[124:127], v5, s[4:7], s94 offen offset:256 sc1
  buffer_load_dwordx4 v[128:131], v5, s[4:7], s94 offen offset:512 sc1
  buffer_load_dwordx4 v[132:135], v5, s[4:7], s94 offen offset:768 sc1
  s_add_u32 s94, s94, 4096
  buffer_load_dwordx4 v[136:139], v5, s[4:7], s94 offen offset:0 sc1
  buffer_load_dwordx4 v[140:143], v5, s[4:7], s94 offen offset:256 sc1
  buffer_load_dwordx4 v[144:147], v5, s[4:7], s94 offen offset:512 sc1
  buffer_load_dwordx4 v[148:151], v5, s[4:7], s94 offen offset:768 sc1
  s_add_u32 s94, s94, 4096
  buffer_load_dwordx4 v[152:155], v5, s[4:7], s94 offen offset:0 sc1
  buffer_load_dwordx4 v[156:159], v5, s[4:7], s94 offen offset:256 sc1
  buffer_load_dwordx4 v[160:163], v5, s[4:7], s94 offen offset:512 sc1
  buffer_load_dwordx4 v[164:167], v5, s[4:7], s94 offen offset:768 sc1
  s_add_u32 s94, s94, 4096
  buffer_load_dwordx4 v[168:171], v5, s[4:7], s94 offen offset:0 sc1
  buffer_load_dwordx4 v[172:175], v5, s[4:7], s94 offen offset:256 sc1
  buffer_load_dwordx4 v[176:179], v5, s[4:7], s94 offen offset:512 sc1
  buffer_load_dwordx4 v[180:183], v5, s[4:7], s94 offen offset:768 sc1
  s_add_u32 s67, s67, 1
  s_cmp_gt_u32 s67, 1048576
  s_cbranch_scc1 L_end
  s_waitcnt vmcnt(0)
  v_xor_b32 v7, s96, v120
  v_bitop3_b32 v7, v7, v124, s96 bitop3:0xf6
  v_bitop3_b32 v7, v7, v128, s96 bitop3:0xf6
  v_bitop3_b32 v7, v7, v132, s96 bitop3:0xf6
  v_bitop3_b32 v7, v7, v136, s96 bitop3:0xf6
  v_bitop3_b32 v7, v7, v140, s96 bitop3:0xf6
  v_bitop3_b32 v7, v7, v144, s96 bitop3:0xf6
  v_bitop3_b32 v7, v7, v148, s96 bitop3:0xf6
  v_bitop3_b32 v7, v7, v152, s96 bitop3:0xf6
  v_bitop3_b32 v7, v7, v156, s96 bitop3:0xf6
  v_bitop3_b32 v7, v7, v160, s96 bitop3:0xf6
  v_bitop3_b32 v7, v7, v164, s96 bitop3:0xf6
  v_bitop3_b32 v7, v7, v168, s96 bitop3:0xf6
  v_bitop3_b32 v7, v7, v172, s96 bitop3:0xf6
  v_bitop3_b32 v7, v7, v176, s96 bitop3:0xf6
  v_bitop3_b32 v7, v7, v180, s96 bitop3:0xf6
  v_and_b32 v7, v254, v7
  v_cmp_ne_u32 vcc, 0, v7
  s_cbranch_vccnz o_rl_117
  s_branch o_bk_115
o_fb_106:
  v_mov_b32 v118, v116
  s_nop 1
  v_permlane16_swap_b32 v116, v118
  v_max_f32 v116, v116, v118
  v_mov_b32 v118, v116
  s_nop 0
  s_nop 0
  v_permlane32_swap_b32 v116, v118
  v_max_f32 v116, v116, v118
  v_sub_f32 v56, v104, v116
  v_sub_f32 v57, v105, v116
  v_sub_f32 v58, v106, v116
  v_sub_f32 v59, v107, v116
  v_sub_f32 v60, v108, v116
  v_sub_f32 v61, v109, v116
  v_sub_f32 v62, v110, v116
  v_sub_f32 v63, v111, v116
  v_sub_f32 v64, v112, v116
  v_sub_f32 v65, v113, v116
  v_exp_f32 v56, v56
  v_exp_f32 v57, v57
  v_exp_f32 v58, v58
  v_exp_f32 v59, v59
  v_exp_f32 v60, v60
  v_exp_f32 v61, v61
  v_exp_f32 v62, v62
  v_exp_f32 v63, v63
  v_exp_f32 v64, v64
  v_exp_f32 v65, v65
  v_add_f32 v117, v56, v57
  v_add_f32 v117, v117, v58
  v_add_f32 v117, v117, v59
  v_add_f32 v117, v117, v60
  v_add_f32 v117, v117, v61
  v_add_f32 v117, v117, v62
  v_add_f32 v117, v117, v63
  v_add_f32 v117, v117, v64
  v_add_f32 v117, v117, v65
  v_mov_b32 v118, v117
  s_nop 0
  s_nop 0
  v_permlane16_swap_b32 v117, v118
  v_add_f32 v117, v117, v118
  v_mov_b32 v118, v117
  s_nop 0
  s_nop 0
  v_permlane32_swap_b32 v117, v118
  v_add_f32 v117, v117, v118
  v_rcp_f32 v117, v117
  s_branch o_fbr_107
o_fb_108:
  v_mov_b32 v118, v116
  s_nop 1
  v_permlane16_swap_b32 v116, v118
  v_max_f32 v116, v116, v118
  v_mov_b32 v118, v116
  s_nop 0
  s_nop 0
  v_permlane32_swap_b32 v116, v118
  v_max_f32 v116, v116, v118
  v_sub_f32 v56, v104, v116
  v_sub_f32 v57, v105, v116
  v_sub_f32 v58, v106, v116
  v_sub_f32 v59, v107, v116
  v_sub_f32 v60, v108, v116
  v_sub_f32 v61, v109, v116
  v_sub_f32 v62, v110, v116
  v_sub_f32 v63, v111, v116
  v_sub_f32 v64, v112, v116
  v_sub_f32 v65, v113, v116
  v_exp_f32 v56, v56
  v_exp_f32 v57, v57
  v_exp_f32 v58, v58
  v_exp_f32 v59, v59
  v_exp_f32 v60, v60
  v_exp_f32 v61, v61
  v_exp_f32 v62, v62
  v_exp_f32 v63, v63
  v_exp_f32 v64, v64
  v_exp_f32 v65, v65
  v_add_f32 v117, v56, v57
  v_add_f32 v117, v117, v58
  v_add_f32 v117, v117, v59
  v_add_f32 v117, v117, v60
  v_add_f32 v117, v117, v61
  v_add_f32 v117, v117, v62
  v_add_f32 v117, v117, v63
  v_add_f32 v117, v117, v64
  v_add_f32 v117, v117, v65
  v_mov_b32 v118, v117
  s_nop 0
  s_nop 0
  v_permlane16_swap_b32 v117, v118
  v_add_f32 v117, v117, v118
  v_mov_b32 v118, v117
  s_nop 0
  s_nop 0
  v_permlane32_swap_b32 v117, v118
  v_add_f32 v117, v117, v118
  v_rcp_f32 v117, v117
  s_branch o_fbr_109
o_wr2_104:
  s_waitcnt lgkmcnt(0)
  s_barrier
  ds_read_b128 v[104:107], v3 offset:0
  ds_read_b128 v[108:111], v3 offset:512
  ds_read_b128 v[112:115], v3 offset:1024
  buffer_load_dwordx4 v[176:179], v5, s[4:7], s94 offen offset:512 sc1
  buffer_load_dwordx4 v[180:183], v5, s[4:7], s94 offen offset:768 sc1
  s_waitcnt lgkmcnt(2)
  v_mfma_f32_32x32x16_bf16 v[40:55], v[104:107], a[0:3], 0
  s_and_b32 s91, s65, 63
  s_lshl_b32 s90, s91, 5
  s_add_u32 s90, s90, s43
  s_lshl_b32 s94, s91, 5
  s_add_u32 s94, s94, s85
  s_lshl_b32 s94, s94, 10
  v_mfma_f32_32x32x16_bf16 v[56:71], v[104:107], a[4:7], 0
  ds_read_b128 v[116:119], v3 offset:1536
  s_lshr_b32 s92, s65, 22
  s_xor_b32 s93, s43, 32
  s_lshl_b32 s91, s90, 10
  s_add_u32 s94, s94, 25165824
  s_cmp_eq_u32 s92, s93
  s_cselect_b32 s92, s94, s91
  v_mfma_f32_32x32x16_bf16 v[72:87], v[104:107], a[8:11], 0
  s_add_u32 s92, s92, 10485760
  buffer_load_dwordx4 v[184:187], v0, s[4:7], s92 offen sc1
  s_mov_b64 exec, 1
  buffer_store_dword v38, off, s[4:7], s84 sc1
  s_mov_b64 exec, -1
  s_mov_b32 s84, 268435456
  v_mfma_f32_32x32x16_bf16 v[88:103], v[104:107], a[12:15], 0
  s_waitcnt vmcnt(14)
  v_xor_b32 v7, s96, v120
  v_bitop3_b32 v7, v7, v124, s96 bitop3:0xf6
  v_bitop3_b32 v7, v7, v128, s96 bitop3:0xf6
  v_bitop3_b32 v7, v7, v132, s96 bitop3:0xf6
  s_waitcnt lgkmcnt(2)
  v_mfma_f32_32x32x16_bf16 v[40:55], v[108:111], a[16:19], v[40:55]
  s_waitcnt vmcnt(10)
  v_bitop3_b32 v7, v7, v136, s96 bitop3:0xf6
  v_bitop3_b32 v7, v7, v140, s96 bitop3:0xf6
  v_bitop3_b32 v7, v7, v144, s96 bitop3:0xf6
  v_bitop3_b32 v7, v7, v148, s96 bitop3:0xf6
  s_waitcnt vmcnt(6)
  v_mfma_f32_32x32x16_bf16 v[56:71], v[108:111], a[20:23], v[56:71]
  ds_read_b128 v[104:107], v3 offset:2048
  v_bitop3_b32 v7, v7, v152, s96 bitop3:0xf6
  v_bitop3_b32 v7, v7, v156, s96 bitop3:0xf6
  v_bitop3_b32 v7, v7, v160, s96 bitop3:0xf6
  v_bitop3_b32 v7, v7, v164, s96 bitop3:0xf6
  s_waitcnt vmcnt(2)
  v_mfma_f32_32x32x16_bf16 v[72:87], v[108:111], a[24:27], v[72:87]
  v_bitop3_b32 v7, v7, v168, s96 bitop3:0xf6
  v_bitop3_b32 v7, v7, v172, s96 bitop3:0xf6
  v_bitop3_b32 v7, v7, v176, s96 bitop3:0xf6
  v_bitop3_b32 v7, v7, v180, s96 bitop3:0xf6
  v_and_b32 v7, v254, v7
  v_cmp_ne_u32 vcc, 0, v7
  s_cbranch_vccnz o_rt_114
o_bk_115:
  v_mfma_f32_32x32x16_bf16 v[88:103], v[108:111], a[28:31], v[88:103]
  v_mfma_f32_16x16x32_bf16 v[188:191], v[16:19], v[120:123], 0
  v_mfma_f32_16x16x32_bf16 v[192:195], v[16:19], v[124:127], 0
  v_mfma_f32_16x16x32_bf16 v[188:191], v[20:23], v[128:131], v[188:191]
  s_waitcnt lgkmcnt(2)
  v_mfma_f32_32x32x16_bf16 v[40:55], v[112:115], a[32:35], v[40:55]
  v_mfma_f32_16x16x32_bf16 v[192:195], v[20:23], v[132:135], v[192:195]
  v_mfma_f32_16x16x32_bf16 v[188:191], v[16:19], v[136:139], v[188:191]
  v_mfma_f32_16x16x32_bf16 v[192:195], v[16:19], v[140:143], v[192:195]
  v_mfma_f32_32x32x16_bf16 v[56:71], v[112:115], a[36:39], v[56:71]
  ds_read_b128 v[108:111], v3 offset:2560
  v_mfma_f32_16x16x32_bf16 v[188:191], v[20:23], v[144:147], v[188:191]
  v_mfma_f32_16x16x32_bf16 v[192:195], v[20:23], v[148:151], v[192:195]
  v_mfma_f32_16x16x32_bf16 v[188:191], v[16:19], v[152:155], v[188:191]
  v_mfma_f32_32x32x16_bf16 v[72:87], v[112:115], a[40:43], v[72:87]
  v_mfma_f32_16x16x32_bf16 v[192:195], v[16:19], v[156:159], v[192:195]
  v_mfma_f32_16x16x32_bf16 v[188:191], v[20:23], v[160:163], v[188:191]
  v_mfma_f32_16x16x32_bf16 v[192:195], v[20:23], v[164:167], v[192:195]
  v_mfma_f32_32x32x16_bf16 v[88:103], v[112:115], a[44:47], v[88:103]
  v_mfma_f32_16x16x32_bf16 v[188:191], v[16:19], v[168:171], v[188:191]
  v_mfma_f32_16x16x32_bf16 v[192:195], v[16:19], v[172:175], v[192:195]
  v_mfma_f32_16x16x32_bf16 v[188:191], v[20:23], v[176:179], v[188:191]
  s_waitcnt lgkmcnt(2)
  v_mfma_f32_32x32x16_bf16 v[40:55], v[116:119], a[48:51], v[40:55]
  v_mfma_f32_16x16x32_bf16 v[192:195], v[20:23], v[180:183], v[192:195]
  s_bfe_u32 s92, s65, 131086
  s_lshl_b32 s92, s92, 21
  s_add_u32 s92, s92, s91
  s_add_u32 s93, s92, 27262976
  v_mfma_f32_32x32x16_bf16 v[56:71], v[116:119], a[52:55], v[56:71]
  ds_read_b128 v[112:115], v3 offset:3072
  s_add_u32 s92, s92, 20971520
  s_waitcnt vmcnt(1)
  v_lshlrev_b32 v196, 16, v184
  v_and_b32 v197, 0xffff0000, v184
  v_lshlrev_b32 v198, 16, v185
  v_mfma_f32_32x32x16_bf16 v[72:87], v[116:119], a[56:59], v[72:87]
  v_and_b32 v199, 0xffff0000, v185
  v_lshlrev_b32 v200, 16, v186
  v_and_b32 v201, 0xffff0000, v186
  v_lshlrev_b32 v202, 16, v187
  v_and_b32 v203, 0xffff0000, v187
  v_permlane16_swap_b32 v188, v192
  v_mfma_f32_32x32x16_bf16 v[88:103], v[116:119], a[60:63], v[88:103]
  v_permlane16_swap_b32 v189, v193
  v_permlane16_swap_b32 v190, v194
  v_permlane16_swap_b32 v191, v195
  s_waitcnt lgkmcnt(2)
  v_mfma_f32_32x32x16_bf16 v[40:55], v[104:107], a[64:67], v[40:55]
  v_cvt_pk_bf16_f32 v188, 0, v188
  v_cvt_pk_bf16_f32 v189, 0, v189
  v_cvt_pk_bf16_f32 v190, 0, v190
  v_cvt_pk_bf16_f32 v191, 0, v191
  v_cvt_pk_bf16_f32 v192, 0, v192
  v_cvt_pk_bf16_f32 v193, 0, v193
  v_mfma_f32_32x32x16_bf16 v[56:71], v[104:107], a[68:71], v[56:71]
  ds_read_b128 v[116:119], v3 offset:3584
  v_cvt_pk_bf16_f32 v194, 0, v194
  v_cvt_pk_bf16_f32 v195, 0, v195
  v_add_f32 v196, v196, v188
  v_add_f32 v197, v197, v189
  v_add_f32 v198, v198, v190
  v_mfma_f32_32x32x16_bf16 v[72:87], v[104:107], a[72:75], v[72:87]
  v_add_f32 v199, v199, v191
  v_add_f32 v200, v200, v192
  v_add_f32 v201, v201, v193
  v_add_f32 v202, v202, v194
  v_add_f32 v203, v203, v195
  v_cvt_pk_bf16_f32 v120, v196, v197
  v_mfma_f32_32x32x16_bf16 v[88:103], v[104:107], a[76:79], v[88:103]
  v_cvt_pk_bf16_f32 v121, v198, v199
  v_cvt_pk_bf16_f32 v122, v200, v201
  v_cvt_pk_bf16_f32 v123, v202, v203
  v_lshlrev_b32 v196, 16, v120
  v_and_b32 v197, 0xffff0000, v120
  s_waitcnt lgkmcnt(2)
  v_mfma_f32_32x32x16_bf16 v[40:55], v[108:111], a[80:83], v[40:55]
  v_lshlrev_b32 v198, 16, v121
  v_and_b32 v199, 0xffff0000, v121
  v_lshlrev_b32 v200, 16, v122
  v_and_b32 v201, 0xffff0000, v122
  v_lshlrev_b32 v202, 16, v123
  v_and_b32 v203, 0xffff0000, v123
  v_mfma_f32_32x32x16_bf16 v[56:71], v[108:111], a[84:87], v[56:71]
  ds_read_b128 v[104:107], v3 offset:8192
  buffer_store_dwordx4 v[120:123], v0, s[4:7], s92 offen sc1
  v_add_f32 v136, v196, v197
  v_mul_f32 v137, v196, v196
  v_mfma_f32_32x32x16_bf16 v[72:87], v[108:111], a[88:91], v[72:87]
  v_add_f32 v138, v198, v199
  v_mul_f32 v139, v197, v197
  v_fmac_f32 v137, v198, v198
  v_fmac_f32 v139, v199, v199
  v_add_f32 v136, v136, v200
  v_fmac_f32 v137, v200, v200
  v_mfma_f32_32x32x16_bf16 v[88:103], v[108:111], a[92:95], v[88:103]
  v_add_f32 v138, v138, v201
  v_fmac_f32 v139, v201, v201
  v_add_f32 v136, v136, v202
  v_fmac_f32 v137, v202, v202
  v_add_f32 v138, v138, v203
  s_waitcnt lgkmcnt(2)
  v_mfma_f32_32x32x16_bf16 v[40:55], v[112:115], a[96:99], v[40:55]
  v_fmac_f32 v139, v203, v203
  v_add_f32 v136, v136, v138
  v_add_f32 v137, v137, v139
  s_nop 0
  v_add_f32_dpp v136, v136, v136 row_ror:8 row_mask:0xf bank_mask:0xf
  v_add_f32_dpp v137, v137, v137 row_ror:8 row_mask:0xf bank_mask:0xf
  s_nop 0
  v_add_f32_dpp v136, v136, v136 row_ror:4 row_mask:0xf bank_mask:0xf
  v_mfma_f32_32x32x16_bf16 v[56:71], v[112:115], a[100:103], v[56:71]
  ds_read_b128 v[108:111], v3 offset:8704
  v_add_f32_dpp v137, v137, v137 row_ror:4 row_mask:0xf bank_mask:0xf
  v_add_f32_dpp v136, v136, v136 row_ror:2 row_mask:0xf bank_mask:0xf
  s_nop 0
  v_add_f32_dpp v137, v137, v137 row_ror:2 row_mask:0xf bank_mask:0xf
  v_add_f32_dpp v136, v136, v136 row_ror:1 row_mask:0xf bank_mask:0xf
  s_nop 0
  v_add_f32_dpp v137, v137, v137 row_ror:1 row_mask:0xf bank_mask:0xf
  v_mfma_f32_32x32x16_bf16 v[72:87], v[112:115], a[104:107], v[72:87]
  v_mov_b32 v140, v136
  v_mov_b32 v141, v137
  s_nop 0
  v_permlane16_swap_b32 v136, v140
  v_permlane16_swap_b32 v137, v141
  v_mfma_f32_32x32x16_bf16 v[88:103], v[112:115], a[108:111], v[88:103]
  v_add_f32 v136, v136, v140
  v_add_f32 v137, v137, v141
  v_mov_b32 v140, v136
  v_mov_b32 v141, v137
  s_nop 0
  v_permlane32_swap_b32 v136, v140
  s_waitcnt lgkmcnt(2)
  v_mfma_f32_32x32x16_bf16 v[40:55], v[116:119], a[112:115], v[40:55]
  v_permlane32_swap_b32 v137, v141
  v_add_f32 v136, v136, v140
  v_add_f32 v137, v137, v141
  v_mul_f32 v136, 0x3b000000, v136
  v_mul_f32 v137, 0x3b000000, v137
  v_mfma_f32_32x32x16_bf16 v[56:71], v[116:119], a[116:119], v[56:71]
  ds_read_b128 v[112:115], v3 offset:9216
  v_fma_f32 v137, -v136, v136, v137
  v_cvt_pk_bf16_f32 v136, 0, v136
  v_max_f32 v137, 0, v137
  v_sub_f32 v140, v196, v136
  v_sub_f32 v141, v197, v136
  v_mfma_f32_32x32x16_bf16 v[72:87], v[116:119], a[120:123], v[72:87]
  v_cvt_pk_bf16_f32 v137, 0, v137
  v_sub_f32 v142, v198, v136
  v_sub_f32 v143, v199, v136
  v_add_f32 v137, 0x3727c5ac, v137
  v_sub_f32 v144, v200, v136
  v_sub_f32 v145, v201, v136
  v_mfma_f32_32x32x16_bf16 v[88:103], v[116:119], a[124:127], v[88:103]
  v_cvt_pk_bf16_f32 v137, 0, v137
  v_sub_f32 v146, v202, v136
  v_sub_f32 v147, v203, v136
  v_sqrt_f32 v137, v137
  s_waitcnt lgkmcnt(2)
  v_mfma_f32_32x32x16_bf16 v[40:55], v[104:107], a[128:131], v[40:55]
  v_cvt_pk_bf16_f32 v140, 0, v140
  v_cvt_pk_bf16_f32 v141, 0, v141
  v_cvt_pk_bf16_f32 v137, 0, v137
  v_cvt_pk_bf16_f32 v142, 0, v142
  v_cvt_pk_bf16_f32 v143, 0, v143
  v_rcp_f32 v137, v137
  v_mfma_f32_32x32x16_bf16 v[56:71], v[104:107], a[132:135], v[56:71]
  ds_read_b128 v[116:119], v3 offset:9728
  v_cvt_pk_bf16_f32 v144, 0, v144
  v_cvt_pk_bf16_f32 v145, 0, v145
  v_cvt_pk_bf16_f32 v146, 0, v146
  v_cvt_pk_bf16_f32 v147, 0, v147
  v_mul_f32 v140, v140, v137
  v_mfma_f32_32x32x16_bf16 v[72:87], v[104:107], a[136:139], v[72:87]
  v_mul_f32 v141, v141, v137
  v_mul_f32 v142, v142, v137
  v_mul_f32 v143, v143, v137
  v_mul_f32 v144, v144, v137
  v_mul_f32 v145, v145, v137
  v_mul_f32 v146, v146, v137
  v_mfma_f32_32x32x16_bf16 v[88:103], v[104:107], a[140:143], v[88:103]
  v_mul_f32 v147, v147, v137
  v_cvt_pk_bf16_f32 v124, v140, v141
  v_cvt_pk_bf16_f32 v125, v142, v143
  v_cvt_pk_bf16_f32 v126, v144, v145
  v_cvt_pk_bf16_f32 v127, v146, v147
  s_waitcnt lgkmcnt(2)
  v_mfma_f32_32x32x16_bf16 v[40:55], v[108:111], a[144:147], v[40:55]
  v_lshlrev_b32 v204, 16, v124
  v_and_b32 v205, 0xffff0000, v124
  v_lshlrev_b32 v206, 16, v125
  v_and_b32 v207, 0xffff0000, v125
  v_lshlrev_b32 v208, 16, v126
  v_and_b32 v209, 0xffff0000, v126
  v_mfma_f32_32x32x16_bf16 v[56:71], v[108:111], a[148:151], v[56:71]
  ds_read_b128 v[104:107], v3 offset:10240
  v_lshlrev_b32 v210, 16, v127
  v_and_b32 v211, 0xffff0000, v127
  buffer_store_dwordx4 v[124:127], v0, s[4:7], s93 offen sc1
  v_mfma_f32_32x32x16_bf16 v[72:87], v[108:111], a[152:155], v[72:87]
  v_add_f32 v196, v196, v204
  v_add_f32 v197, v197, v205
  v_add_f32 v198, v198, v206
  v_add_f32 v199, v199, v207
  v_add_f32 v200, v200, v208
  v_add_f32 v201, v201, v209
  v_mfma_f32_32x32x16_bf16 v[88:103], v[108:111], a[156:159], v[88:103]
  v_add_f32 v202, v202, v210
  v_add_f32 v203, v203, v211
  v_cvt_pk_bf16_f32 v128, v196, v197
  v_cvt_pk_bf16_f32 v129, v198, v199
  v_cvt_pk_bf16_f32 v130, v200, v201
  s_waitcnt lgkmcnt(2)
  v_mfma_f32_32x32x16_bf16 v[40:55], v[112:115], a[160:163], v[40:55]
  v_cvt_pk_bf16_f32 v131, v202, v203
  v_mul_f32 v188, v204, v8
  v_mul_f32 v189, v205, v9
  v_fmac_f32 v188, v206, v10
  v_fmac_f32 v189, v207, v11
  v_fmac_f32 v188, v208, v12
  v_mfma_f32_32x32x16_bf16 v[56:71], v[112:115], a[164:167], v[56:71]
  ds_read_b128 v[108:111], v3 offset:10752
  v_fmac_f32 v189, v209, v13
  v_fmac_f32 v188, v210, v14
  v_fmac_f32 v189, v211, v15
  v_add_f32 v188, v188, v189
  buffer_store_dwordx4 v[128:131], v0, s[68:71], s91 offen sc1
  v_mfma_f32_32x32x16_bf16 v[72:87], v[112:115], a[168:171], v[72:87]
  v_add_f32_dpp v188, v188, v188 row_ror:8 row_mask:0xf bank_mask:0xf
  s_nop 1
  v_add_f32_dpp v188, v188, v188 row_ror:4 row_mask:0xf bank_mask:0xf
  s_nop 1
  v_add_f32_dpp v188, v188, v188 row_ror:2 row_mask:0xf bank_mask:0xf
  s_nop 1
  v_add_f32_dpp v188, v188, v188 row_ror:1 row_mask:0xf bank_mask:0xf
  v_mov_b32 v189, v188
  s_nop 0
  s_nop 0
  v_permlane16_swap_b32 v188, v189
  v_mfma_f32_32x32x16_bf16 v[88:103], v[112:115], a[172:175], v[88:103]
  v_add_f32 v188, v188, v189
  v_mov_b32 v189, v188
  s_nop 0
  s_nop 0
  v_permlane32_swap_b32 v188, v189
  v_add_f32 v188, v188, v189
  s_waitcnt lgkmcnt(2)
  v_mfma_f32_32x32x16_bf16 v[40:55], v[116:119], a[176:179], v[40:55]
  v_cvt_pk_bf16_f32 v188, 0, v188
  v_ashrrev_i32 v189, 31, v188
  v_or_b32 v189, 0x80000000, v189
  v_xor_b32 v188, v188, v189
  s_sub_u32 s92, 4095, s90
  v_and_b32 v188, 0xffff0000, v188
  v_mfma_f32_32x32x16_bf16 v[56:71], v[116:119], a[180:183], v[56:71]
  ds_read_b128 v[112:115], v3 offset:11264
  v_or_b32 v38, s92, v188
  s_bfe_u32 s92, s65, 196625
  s_lshl_b32 s92, s92, 18
  s_lshl_b32 s93, s90, 7
  s_add_u32 s92, s92, s93
  v_mfma_f32_32x32x16_bf16 v[72:87], v[116:119], a[184:187], v[72:87]
  s_add_u32 s84, s92, 243269632
  v_mfma_f32_32x32x16_bf16 v[88:103], v[116:119], a[188:191], v[88:103]
  s_waitcnt lgkmcnt(2)
  v_mfma_f32_32x32x16_bf16 v[40:55], v[104:107], a[192:195], v[40:55]
  v_mfma_f32_32x32x16_bf16 v[56:71], v[104:107], a[196:199], v[56:71]
  ds_read_b128 v[116:119], v3 offset:11776
  v_mfma_f32_32x32x16_bf16 v[72:87], v[104:107], a[200:203], v[72:87]
  v_mfma_f32_32x32x16_bf16 v[88:103], v[104:107], a[204:207], v[88:103]
  s_waitcnt lgkmcnt(2)
  v_mfma_f32_32x32x16_bf16 v[40:55], v[108:111], a[208:211], v[40:55]
  v_mfma_f32_32x32x16_bf16 v[56:71], v[108:111], a[212:215], v[56:71]
  v_mfma_f32_32x32x16_bf16 v[72:87], v[108:111], a[216:219], v[72:87]
  v_mfma_f32_32x32x16_bf16 v[88:103], v[108:111], a[220:223], v[88:103]
  s_waitcnt lgkmcnt(1)
  v_mfma_f32_32x32x16_bf16 v[40:55], v[112:115], a[224:227], v[40:55]
  v_mfma_f32_32x32x16_bf16 v[56:71], v[112:115], a[228:231], v[56:71]
  v_mfma_f32_32x32x16_bf16 v[72:87], v[112:115], a[232:235], v[72:87]
  v_mfma_f32_32x32x16_bf16 v[88:103], v[112:115], a[236:239], v[88:103]
  s_waitcnt lgkmcnt(0)
  v_mfma_f32_32x32x16_bf16 v[40:55], v[116:119], a[240:243], v[40:55]
  v_mfma_f32_32x32x16_bf16 v[56:71], v[116:119], a[244:247], v[56:71]
  v_mfma_f32_32x32x16_bf16 v[72:87], v[116:119], a[248:251], v[72:87]
  v_mfma_f32_32x32x16_bf16 v[88:103], v[116:119], a[252:255], v[88:103]
  s_nop 3
  s_nop 0
  s_nop 3
  s_nop 0
  v_cvt_pk_bf16_f32 v212, v40, v56
  s_nop 0
  v_cvt_pk_bf16_f32 v213, v72, v88
  v_cvt_pk_bf16_f32 v214, v41, v57
  v_cvt_pk_bf16_f32 v215, v73, v89
  v_cvt_pk_bf16_f32 v216, v42, v58
  v_cvt_pk_bf16_f32 v217, v74, v90
  v_cvt_pk_bf16_f32 v218, v43, v59
  v_cvt_pk_bf16_f32 v219, v75, v91
  v_permlane16_swap_b32 v212, v214
  v_permlane16_swap_b32 v213, v215
  s_add_u32 s78, s86, 0
  v_bfi_b32 v212, v254, s42, v212
  buffer_store_dwordx4 v[212:215], v4, s[4:7], s78 offen
  v_cvt_pk_bf16_f32 v220, v44, v60
  v_cvt_pk_bf16_f32 v221, v76, v92
  v_cvt_pk_bf16_f32 v222, v45, v61
  v_cvt_pk_bf16_f32 v223, v77, v93
  v_permlane16_swap_b32 v216, v218
  v_permlane16_swap_b32 v217, v219
  s_add_u32 s78, s86, 32768
  v_bfi_b32 v216, v254, s42, v216
  buffer_store_dwordx4 v[216:219], v4, s[4:7], s78 offen
  v_cvt_pk_bf16_f32 v224, v46, v62
  v_cvt_pk_bf16_f32 v225, v78, v94
  v_cvt_pk_bf16_f32 v226, v47, v63
  v_cvt_pk_bf16_f32 v227, v79, v95
  v_permlane16_swap_b32 v220, v222
  v_permlane16_swap_b32 v221, v223
  s_add_u32 s78, s86, 131072
  v_bfi_b32 v220, v254, s42, v220
  buffer_store_dwordx4 v[220:223], v4, s[4:7], s78 offen
  v_cvt_pk_bf16_f32 v228, v48, v64
  v_cvt_pk_bf16_f32 v229, v80, v96
  v_cvt_pk_bf16_f32 v230, v49, v65
  v_cvt_pk_bf16_f32 v231, v81, v97
  v_permlane16_swap_b32 v224, v226
  v_permlane16_swap_b32 v225, v227
  s_add_u32 s78, s86, 163840
  v_bfi_b32 v224, v254, s42, v224
  buffer_store_dwordx4 v[224:227], v4, s[4:7], s78 offen
  v_cvt_pk_bf16_f32 v232, v50, v66
  v_cvt_pk_bf16_f32 v233, v82, v98
  v_cvt_pk_bf16_f32 v234, v51, v67
  v_cvt_pk_bf16_f32 v235, v83, v99
  v_permlane16_swap_b32 v228, v230
  v_permlane16_swap_b32 v229, v231
  s_add_u32 s78, s86, 262144
  v_bfi_b32 v228, v254, s42, v228
  buffer_store_dwordx4 v[228:231], v4, s[4:7], s78 offen
  v_cvt_pk_bf16_f32 v236, v52, v68
  v_cvt_pk_bf16_f32 v237, v84, v100
  v_cvt_pk_bf16_f32 v238, v53, v69
  v_cvt_pk_bf16_f32 v239, v85, v101
  v_permlane16_swap_b32 v232, v234
  v_permlane16_swap_b32 v233, v235
  s_add_u32 s78, s86, 294912
  v_bfi_b32 v232, v254, s42, v232
  buffer_store_dwordx4 v[232:235], v4, s[4:7], s78 offen
  v_cvt_pk_bf16_f32 v240, v54, v70
  v_cvt_pk_bf16_f32 v241, v86, v102
  v_cvt_pk_bf16_f32 v242, v55, v71
  v_cvt_pk_bf16_f32 v243, v87, v103
  v_permlane16_swap_b32 v236, v238
  v_permlane16_swap_b32 v237, v239
  s_add_u32 s78, s86, 393216
  v_bfi_b32 v236, v254, s42, v236
  buffer_store_dwordx4 v[236:239], v4, s[4:7], s78 offen
  v_permlane16_swap_b32 v240, v242
  v_permlane16_swap_b32 v241, v243
  s_add_u32 s78, s86, 425984
  v_bfi_b32 v240, v254, s42, v240
  buffer_store_dwordx4 v[240:243], v4, s[4:7], s78 offen
o_we_105:
  v_and_b32 v37, -32, v39
  s_waitcnt lgkmcnt(0)
  s_barrier
  ds_read_b128 v[104:107], v37 offset:16
  s_mov_b32 s65, s63
  s_waitcnt lgkmcnt(0)
  v_and_b32 v104, v104, v106
  v_max_u32 v105, v105, v107
  v_readfirstlane_b32 s26, v104
  v_readfirstlane_b32 s3, v105
  s_and_b32 s66, s26, 1
  s_and_b32 s76, s26, 2
  s_bitcmp1_b32 s26, 2
  s_cselect_b32 s3, s3, 0
  s_cmp_lg_u32 s76, 0
  s_cbranch_scc1 o_nofl_83
  s_and_b32 s26, s63, 49152
  s_cbranch_scc0 o_fl_84
  s_cmp_lg_u32 s64, 0
  s_cbranch_scc1 o_nofl_83
o_fl_84:
  s_cmp_ge_u32 s17, 2
  s_cbranch_scc1 o_fd_118
  s_cmp_eq_u32 s65, 0
  s_cbranch_scc1 o_fd_118
  s_mov_b32 s96, s42
  s_waitcnt vmcnt(0)
  s_mov_b64 exec, 1
  buffer_store_dword v38, off, s[4:7], s84 sc1
  s_mov_b64 exec, -1
  s_mov_b32 s84, 268435456
  s_lshl_b32 s97, s43, 14
  s_add_u32 s97, s97, s86
  buffer_load_dword v7, v255, s[4:7], s97 offen sc1
  s_mov_b32 s67, 0
  s_mov_b64 vcc, 0
  s_waitcnt vmcnt(0)
o_pl_120:
  v_and_b32 v7, 1, v7
  v_cmp_ne_u32 vcc, s96, v7
  s_cbranch_vccz o_pk_121
  buffer_load_dword v7, v255, s[4:7], s97 offen sc1
  s_add_u32 s67, s67, 1
  s_cmp_gt_u32 s67, 1048576
  s_cbranch_scc1 L_end
  s_waitcnt vmcnt(0)
  s_branch o_pl_120
o_pk_121:
  s_and_b32 s26, s65, 49152
  s_cbranch_scc1 o_f2_119
  s_lshl_b32 s94, s43, 14
  s_add_u32 s94, s94, s86
  buffer_load_dwordx4 v[120:123], v5, s[4:7], s94 offen offset:0 sc1
  buffer_load_dwordx4 v[124:127], v5, s[4:7], s94 offen offset:256 sc1
  buffer_load_dwordx4 v[128:131], v5, s[4:7], s94 offen offset:512 sc1
  buffer_load_dwordx4 v[132:135], v5, s[4:7], s94 offen offset:768 sc1
  s_add_u32 s94, s94, 4096
  buffer_load_dwordx4 v[136:139], v5, s[4:7], s94 offen offset:0 sc1
  buffer_load_dwordx4 v[140:143], v5, s[4:7], s94 offen offset:256 sc1
  buffer_load_dwordx4 v[144:147], v5, s[4:7], s94 offen offset:512 sc1
  buffer_load_dwordx4 v[148:151], v5, s[4:7], s94 offen offset:768 sc1
  s_add_u32 s94, s94, 4096
  buffer_load_dwordx4 v[152:155], v5, s[4:7], s94 offen offset:0 sc1
  buffer_load_dwordx4 v[156:159], v5, s[4:7], s94 offen offset:256 sc1
  buffer_load_dwordx4 v[160:163], v5, s[4:7], s94 offen offset:512 sc1
  buffer_load_dwordx4 v[164:167], v5, s[4:7], s94 offen offset:768 sc1
  s_add_u32 s94, s94, 4096
  buffer_load_dwordx4 v[168:171], v5, s[4:7], s94 offen offset:0 sc1
  buffer_load_dwordx4 v[172:175], v5, s[4:7], s94 offen offset:256 sc1
  buffer_load_dwordx4 v[176:179], v5, s[4:7], s94 offen offset:512 sc1
  buffer_load_dwordx4 v[180:183], v5, s[4:7], s94 offen offset:768 sc1
  s_and_b32 s91, s65, 63
  s_lshl_b32 s90, s91, 5
  s_add_u32 s90, s90, s43
  s_lshl_b32 s91, s90, 10
  buffer_load_dwordx4 v[184:187], v0, s[72:75], s91 offen
  s_waitcnt vmcnt(13)
  v_xor_b32 v7, s96, v120
  v_bitop3_b32 v7, v7, v124, s96 bitop3:0xf6
  v_bitop3_b32 v7, v7, v128, s96 bitop3:0xf6
  v_bitop3_b32 v7, v7, v132, s96 bitop3:0xf6
  s_waitcnt vmcnt(9)
  v_bitop3_b32 v7, v7, v136, s96 bitop3:0xf6
  v_bitop3_b32 v7, v7, v140, s96 bitop3:0xf6
  v_bitop3_b32 v7, v7, v144, s96 bitop3:0xf6
  v_bitop3_b32 v7, v7, v148, s96 bitop3:0xf6
  s_waitcnt vmcnt(5)
  v_bitop3_b32 v7, v7, v152, s96 bitop3:0xf6
  v_bitop3_b32 v7, v7, v156, s96 bitop3:0xf6
  v_bitop3_b32 v7, v7, v160, s96 bitop3:0xf6
  v_bitop3_b32 v7, v7, v164, s96 bitop3:0xf6
  s_waitcnt vmcnt(1)
  v_bitop3_b32 v7, v7, v168, s96 bitop3:0xf6
  v_bitop3_b32 v7, v7, v172, s96 bitop3:0xf6
  v_bitop3_b32 v7, v7, v176, s96 bitop3:0xf6
  v_bitop3_b32 v7, v7, v180, s96 bitop3:0xf6
  v_and_b32 v7, v254, v7
  v_cmp_ne_u32 vcc, 0, v7
  s_cbranch_vccnz o_rt_122
o_bk_123:
  v_mfma_f32_16x16x32_bf16 v[188:191], v[16:19], v[120:123], 0
  v_mfma_f32_16x16x32_bf16 v[192:195], v[16:19], v[124:127], 0
  v_mfma_f32_16x16x32_bf16 v[188:191], v[20:23], v[128:131], v[188:191]
  v_mfma_f32_16x16x32_bf16 v[192:195], v[20:23], v[132:135], v[192:195]
  v_mfma_f32_16x16x32_bf16 v[188:191], v[16:19], v[136:139], v[188:191]
  v_mfma_f32_16x16x32_bf16 v[192:195], v[16:19], v[140:143], v[192:195]
  v_mfma_f32_16x16x32_bf16 v[188:191], v[20:23], v[144:147], v[188:191]
  v_mfma_f32_16x16x32_bf16 v[192:195], v[20:23], v[148:151], v[192:195]
  v_mfma_f32_16x16x32_bf16 v[188:191], v[16:19], v[152:155], v[188:191]
  v_mfma_f32_16x16x32_bf16 v[192:195], v[16:19], v[156:159], v[192:195]
  v_mfma_f32_16x16x32_bf16 v[188:191], v[20:23], v[160:163], v[188:191]
  v_mfma_f32_16x16x32_bf16 v[192:195], v[20:23], v[164:167], v[192:195]
  v_mfma_f32_16x16x32_bf16 v[188:191], v[16:19], v[168:171], v[188:191]
  v_mfma_f32_16x16x32_bf16 v[192:195], v[16:19], v[172:175], v[192:195]
  v_mfma_f32_16x16x32_bf16 v[188:191], v[20:23], v[176:179], v[188:191]
  v_mfma_f32_16x16x32_bf16 v[192:195], v[20:23], v[180:183], v[192:195]
  s_bfe_u32 s92, s65, 131086
  s_lshl_b32 s92, s92, 21
  s_add_u32 s92, s92, s91
  s_add_u32 s93, s92, 27262976
  s_add_u32 s92, s92, 20971520
  s_waitcnt vmcnt(0)
  v_lshlrev_b32 v196, 16, v184
  v_and_b32 v197, 0xffff0000, v184
  v_lshlrev_b32 v198, 16, v185
  v_and_b32 v199, 0xffff0000, v185
  v_lshlrev_b32 v200, 16, v186
  v_and_b32 v201, 0xffff0000, v186
  v_lshlrev_b32 v202, 16, v187
  v_and_b32 v203, 0xffff0000, v187
  v_permlane16_swap_b32 v188, v192
  v_permlane16_swap_b32 v189, v193
  v_permlane16_swap_b32 v190, v194
  v_permlane16_swap_b32 v191, v195
  v_cvt_pk_bf16_f32 v188, 0, v188
  v_cvt_pk_bf16_f32 v189, 0, v189
  v_cvt_pk_bf16_f32 v190, 0, v190
  v_cvt_pk_bf16_f32 v191, 0, v191
  v_cvt_pk_bf16_f32 v192, 0, v192
  v_cvt_pk_bf16_f32 v193, 0, v193
  v_cvt_pk_bf16_f32 v194, 0, v194
  v_cvt_pk_bf16_f32 v195, 0, v195
  v_add_f32 v196, v196, v188
  v_add_f32 v197, v197, v189
  v_add_f32 v198, v198, v190
  v_add_f32 v199, v199, v191
  v_add_f32 v200, v200, v192
  v_add_f32 v201, v201, v193
  v_add_f32 v202, v202, v194
  v_add_f32 v203, v203, v195
  v_cvt_pk_bf16_f32 v120, v196, v197
  v_cvt_pk_bf16_f32 v121, v198, v199
  v_cvt_pk_bf16_f32 v122, v200, v201
  v_cvt_pk_bf16_f32 v123, v202, v203
  v_lshlrev_b32 v196, 16, v120
  v_and_b32 v197, 0xffff0000, v120
  v_lshlrev_b32 v198, 16, v121
  v_and_b32 v199, 0xffff0000, v121
  v_lshlrev_b32 v200, 16, v122
  v_and_b32 v201, 0xffff0000, v122
  v_lshlrev_b32 v202, 16, v123
  v_and_b32 v203, 0xffff0000, v123
  buffer_store_dwordx4 v[120:123], v0, s[4:7], s92 offen sc1
  v_add_f32 v136, v196, v197
  v_mul_f32 v137, v196, v196
  v_add_f32 v138, v198, v199
  v_mul_f32 v139, v197, v197
  v_fmac_f32 v137, v198, v198
  v_fmac_f32 v139, v199, v199
  v_add_f32 v136, v136, v200
  v_fmac_f32 v137, v200, v200
  v_add_f32 v138, v138, v201
  v_fmac_f32 v139, v201, v201
  v_add_f32 v136, v136, v202
  v_fmac_f32 v137, v202, v202
  v_add_f32 v138, v138, v203
  v_fmac_f32 v139, v203, v203
  v_add_f32 v136, v136, v138
  v_add_f32 v137, v137, v139
  s_nop 0
  v_add_f32_dpp v136, v136, v136 row_ror:8 row_mask:0xf bank_mask:0xf
  v_add_f32_dpp v137, v137, v137 row_ror:8 row_mask:0xf bank_mask:0xf
  s_nop 0
  v_add_f32_dpp v136, v136, v136 row_ror:4 row_mask:0xf bank_mask:0xf
  v_add_f32_dpp v137, v137, v137 row_ror:4 row_mask:0xf bank_mask:0xf
  s_nop 0
  v_add_f32_dpp v136, v136, v136 row_ror:2 row_mask:0xf bank_mask:0xf
  v_add_f32_dpp v137, v137, v137 row_ror:2 row_mask:0xf bank_mask:0xf
  s_nop 0
  v_add_f32_dpp v136, v136, v136 row_ror:1 row_mask:0xf bank_mask:0xf
  v_add_f32_dpp v137, v137, v137 row_ror:1 row_mask:0xf bank_mask:0xf
  v_mov_b32 v140, v136
  v_mov_b32 v141, v137
  s_nop 0
  v_permlane16_swap_b32 v136, v140
  v_permlane16_swap_b32 v137, v141
  v_add_f32 v136, v136, v140
  v_add_f32 v137, v137, v141
  v_mov_b32 v140, v136
  v_mov_b32 v141, v137
  s_nop 0
  v_permlane32_swap_b32 v136, v140
  v_permlane32_swap_b32 v137, v141
  v_add_f32 v136, v136, v140
  v_add_f32 v137, v137, v141
  v_mul_f32 v136, 0x3b000000, v136
  v_mul_f32 v137, 0x3b000000, v137
  v_fma_f32 v137, -v136, v136, v137
  v_cvt_pk_bf16_f32 v136, 0, v136
  v_max_f32 v137, 0, v137
  v_sub_f32 v140, v196, v136
  v_sub_f32 v141, v197, v136
  v_cvt_pk_bf16_f32 v137, 0, v137
  v_sub_f32 v142, v198, v136
  v_sub_f32 v143, v199, v136
  v_add_f32 v137, 0x3727c5ac, v137
  v_sub_f32 v144, v200, v136
  v_sub_f32 v145, v201, v136
  v_cvt_pk_bf16_f32 v137, 0, v137
  v_sub_f32 v146, v202, v136
  v_sub_f32 v147, v203, v136
  v_sqrt_f32 v137, v137
  v_cvt_pk_bf16_f32 v140, 0, v140
  v_cvt_pk_bf16_f32 v141, 0, v141
  v_cvt_pk_bf16_f32 v137, 0, v137
  v_cvt_pk_bf16_f32 v142, 0, v142
  v_cvt_pk_bf16_f32 v143, 0, v143
  v_rcp_f32 v137, v137
  v_cvt_pk_bf16_f32 v144, 0, v144
  v_cvt_pk_bf16_f32 v145, 0, v145
  v_cvt_pk_bf16_f32 v146, 0, v146
  v_cvt_pk_bf16_f32 v147, 0, v147
  v_mul_f32 v140, v140, v137
  v_mul_f32 v141, v141, v137
  v_mul_f32 v142, v142, v137
  v_mul_f32 v143, v143, v137
  v_mul_f32 v144, v144, v137
  v_mul_f32 v145, v145, v137
  v_mul_f32 v146, v146, v137
  v_mul_f32 v147, v147, v137
  v_cvt_pk_bf16_f32 v124, v140, v141
  v_cvt_pk_bf16_f32 v125, v142, v143
  v_cvt_pk_bf16_f32 v126, v144, v145
  v_cvt_pk_bf16_f32 v127, v146, v147
  v_lshlrev_b32 v204, 16, v124
  v_and_b32 v205, 0xffff0000, v124
  v_lshlrev_b32 v206, 16, v125
  v_and_b32 v207, 0xffff0000, v125
  v_lshlrev_b32 v208, 16, v126
  v_and_b32 v209, 0xffff0000, v126
  v_lshlrev_b32 v210, 16, v127
  v_and_b32 v211, 0xffff0000, v127
  buffer_store_dwordx4 v[124:127], v0, s[4:7], s93 offen sc1
  v_add_f32 v196, v196, v204
  v_add_f32 v197, v197, v205
  v_add_f32 v198, v198, v206
  v_add_f32 v199, v199, v207
  v_add_f32 v200, v200, v208
  v_add_f32 v201, v201, v209
  v_add_f32 v202, v202, v210
  v_add_f32 v203, v203, v211
  v_cvt_pk_bf16_f32 v128, v196, v197
  v_cvt_pk_bf16_f32 v129, v198, v199
  v_cvt_pk_bf16_f32 v130, v200, v201
  v_cvt_pk_bf16_f32 v131, v202, v203
  v_mul_f32 v188, v204, v8
  v_mul_f32 v189, v205, v9
  v_fmac_f32 v188, v206, v10
  v_fmac_f32 v189, v207, v11
  v_fmac_f32 v188, v208, v12
  v_fmac_f32 v189, v209, v13
  v_fmac_f32 v188, v210, v14
  v_fmac_f32 v189, v211, v15
  v_add_f32 v188, v188, v189
  s_add_u32 s92, s91, 10485760
  s_add_u32 s93, s91, 8388608
  buffer_store_dwordx4 v[128:131], v0, s[4:7], s92 offen sc1
  v_lshlrev_b32 v196, 16, v128
  v_and_b32 v197, 0xffff0000, v128
  v_lshlrev_b32 v198, 16, v129
  v_and_b32 v199, 0xffff0000, v129
  v_lshlrev_b32 v200, 16, v130
  v_and_b32 v201, 0xffff0000, v130
  v_lshlrev_b32 v202, 16, v131
  v_and_b32 v203, 0xffff0000, v131
  v_add_f32 v136, v196, v197
  v_mul_f32 v137, v196, v196
  v_add_f32 v138, v198, v199
  v_mul_f32 v139, v197, v197
  v_fmac_f32 v137, v198, v198
  v_fmac_f32 v139, v199, v199
  v_add_f32 v136, v136, v200
  v_fmac_f32 v137, v200, v200
  v_add_f32 v138, v138, v201
  v_fmac_f32 v139, v201, v201
  v_add_f32 v136, v136, v202
  v_fmac_f32 v137, v202, v202
  v_add_f32 v138, v138, v203
  v_fmac_f32 v139, v203, v203
  v_add_f32 v136, v136, v138
  v_add_f32 v137, v137, v139
  s_nop 0
  v_add_f32_dpp v136, v136, v136 row_ror:8 row_mask:0xf bank_mask:0xf
  v_add_f32_dpp v137, v137, v137 row_ror:8 row_mask:0xf bank_mask:0xf
  v_add_f32_dpp v188, v188, v188 row_ror:8 row_mask:0xf bank_mask:0xf
  v_add_f32_dpp v136, v136, v136 row_ror:4 row_mask:0xf bank_mask:0xf
  v_add_f32_dpp v137, v137, v137 row_ror:4 row_mask:0xf bank_mask:0xf
  v_add_f32_dpp v188, v188, v188 row_ror:4 row_mask:0xf bank_mask:0xf
  v_add_f32_dpp v136, v136, v136 row_ror:2 row_mask:0xf bank_mask:0xf
  v_add_f32_dpp v137, v137, v137 row_ror:2 row_mask:0xf bank_mask:0xf
  v_add_f32_dpp v188, v188, v188 row_ror:2 row_mask:0xf bank_mask:0xf
  v_add_f32_dpp v136, v136, v136 row_ror:1 row_mask:0xf bank_mask:0xf
  v_add_f32_dpp v137, v137, v137 row_ror:1 row_mask:0xf bank_mask:0xf
  v_add_f32_dpp v188, v188, v188 row_ror:1 row_mask:0xf bank_mask:0xf
  v_mov_b32 v140, v136
  v_mov_b32 v141, v137
  v_mov_b32 v142, v188
  v_permlane16_swap_b32 v136, v140
  v_permlane16_swap_b32 v137, v141
  v_permlane16_swap_b32 v188, v142
  v_add_f32 v136, v136, v140
  v_add_f32 v137, v137, v141
  v_add_f32 v188, v188, v142
  v_mov_b32 v140, v136
  v_mov_b32 v141, v137
  v_mov_b32 v142, v188
  v_permlane32_swap_b32 v136, v140
  v_permlane32_swap_b32 v137, v141
  v_permlane32_swap_b32 v188, v142
  v_add_f32 v136, v136, v140
  v_add_f32 v137, v137, v141
  v_add_f32 v188, v188, v142
  v_mul_f32 v136, 0x3b000000, v136
  v_mul_f32 v137, 0x3b000000, v137
  v_fma_f32 v137, -v136, v136, v137
  v_cvt_pk_bf16_f32 v136, 0, v136
  v_max_f32 v137, 0, v137
  v_sub_f32 v140, v196, v136
  v_sub_f32 v141, v197, v136
  v_cvt_pk_bf16_f32 v137, 0, v137
  v_sub_f32 v142, v198, v136
  v_sub_f32 v143, v199, v136
  v_add_f32 v137, 0x3727c5ac, v137
  v_sub_f32 v144, v200, v136
  v_sub_f32 v145, v201, v136
  v_cvt_pk_bf16_f32 v137, 0, v137
  v_sub_f32 v146, v202, v136
  v_sub_f32 v147, v203, v136
  v_sqrt_f32 v137, v137
  v_cvt_pk_bf16_f32 v140, 0, v140
  v_cvt_pk_bf16_f32 v141, 0, v141
  v_cvt_pk_bf16_f32 v137, 0, v137
  v_cvt_pk_bf16_f32 v142, 0, v142
  v_cvt_pk_bf16_f32 v143, 0, v143
  v_rcp_f32 v137, v137
  v_cvt_pk_bf16_f32 v144, 0, v144
  v_cvt_pk_bf16_f32 v145, 0, v145
  v_cvt_pk_bf16_f32 v146, 0, v146
  v_cvt_pk_bf16_f32 v147, 0, v147
  v_mul_f32 v140, v140, v137
  v_mul_f32 v141, v141, v137
  v_mul_f32 v142, v142, v137
  v_mul_f32 v143, v143, v137
  v_mul_f32 v144, v144, v137
  v_mul_f32 v145, v145, v137
  v_mul_f32 v146, v146, v137
  v_mul_f32 v147, v147, v137
  v_cvt_pk_bf16_f32 v132, v140, v141
  v_cvt_pk_bf16_f32 v133, v142, v143
  v_cvt_pk_bf16_f32 v134, v144, v145
  v_cvt_pk_bf16_f32 v135, v146, v147
  buffer_store_dwordx4 v[132:135], v0, s[4:7], s93 offen sc1
  v_cvt_pk_bf16_f32 v188, 0, v188
  v_ashrrev_i32 v189, 31, v188
  v_or_b32 v189, 0x80000000, v189
  v_xor_b32 v188, v188, v189
  s_sub_u32 s92, 4095, s90
  v_and_b32 v188, 0xffff0000, v188
  v_or_b32 v38, s92, v188
  s_bfe_u32 s92, s65, 196625
  s_lshl_b32 s92, s92, 18
  s_lshl_b32 s93, s90, 7
  s_add_u32 s92, s92, s93
  s_add_u32 s84, s92, 243269632
  s_waitcnt vmcnt(0)
  s_mov_b64 exec, 1
  buffer_store_dword v38, off, s[4:7], s84 sc1
  s_mov_b64 exec, -1
  s_mov_b32 s84, 268435456
  s_branch o_fd_118
o_rt_122:
  s_mov_b32 s67, 0
o_rl_124:
  s_lshl_b32 s94, s43, 14
  s_add_u32 s94, s94, s86
  buffer_load_dwordx4 v[120:123], v5, s[4:7], s94 offen offset:0 sc1
  buffer_load_dwordx4 v[124:127], v5, s[4:7], s94 offen offset:256 sc1
  buffer_load_dwordx4 v[128:131], v5, s[4:7], s94 offen offset:512 sc1
  buffer_load_dwordx4 v[132:135], v5, s[4:7], s94 offen offset:768 sc1
  s_add_u32 s94, s94, 4096
  buffer_load_dwordx4 v[136:139], v5, s[4:7], s94 offen offset:0 sc1
  buffer_load_dwordx4 v[140:143], v5, s[4:7], s94 offen offset:256 sc1
  buffer_load_dwordx4 v[144:147], v5, s[4:7], s94 offen offset:512 sc1
  buffer_load_dwordx4 v[148:151], v5, s[4:7], s94 offen offset:768 sc1
  s_add_u32 s94, s94, 4096
  buffer_load_dwordx4 v[152:155], v5, s[4:7], s94 offen offset:0 sc1
  buffer_load_dwordx4 v[156:159], v5, s[4:7], s94 offen offset:256 sc1
  buffer_load_dwordx4 v[160:163], v5, s[4:7], s94 offen offset:512 sc1
  buffer_load_dwordx4 v[164:167], v5, s[4:7], s94 offen offset:768 sc1
  s_add_u32 s94, s94, 4096
  buffer_load_dwordx4 v[168:171], v5, s[4:7], s94 offen offset:0 sc1
  buffer_load_dwordx4 v[172:175], v5, s[4:7], s94 offen offset:256 sc1
  buffer_load_dwordx4 v[176:179], v5, s[4:7], s94 offen offset:512 sc1
  buffer_load_dwordx4 v[180:183], v5, s[4:7], s94 offen offset:768 sc1
  s_add_u32 s67, s67, 1
  s_cmp_gt_u32 s67, 1048576
  s_cbranch_scc1 L_end
  s_waitcnt vmcnt(0)
  v_xor_b32 v7, s96, v120
  v_bitop3_b32 v7, v7, v124, s96 bitop3:0xf6
  v_bitop3_b32 v7, v7, v128, s96 bitop3:0xf6
  v_bitop3_b32 v7, v7, v132, s96 bitop3:0xf6
  v_bitop3_b32 v7, v7, v136, s96 bitop3:0xf6
  v_bitop3_b32 v7, v7, v140, s96 bitop3:0xf6
  v_bitop3_b32 v7, v7, v144, s96 bitop3:0xf6
  v_bitop3_b32 v7, v7, v148, s96 bitop3:0xf6
  v_bitop3_b32 v7, v7, v152, s96 bitop3:0xf6
  v_bitop3_b32 v7, v7, v156, s96 bitop3:0xf6
  v_bitop3_b32 v7, v7, v160, s96 bitop3:0xf6
  v_bitop3_b32 v7, v7, v164, s96 bitop3:0xf6
  v_bitop3_b32 v7, v7, v168, s96 bitop3:0xf6
  v_bitop3_b32 v7, v7, v172, s96 bitop3:0xf6
  v_bitop3_b32 v7, v7, v176, s96 bitop3:0xf6
  v_bitop3_b32 v7, v7, v180, s96 bitop3:0xf6
  v_and_b32 v7, v254, v7
  v_cmp_ne_u32 vcc, 0, v7
  s_cbranch_vccnz o_rl_124
  s_branch o_bk_123
o_f2_119:
  s_lshl_b32 s94, s43, 14
  s_add_u32 s94, s94, s86
  buffer_load_dwordx4 v[120:123], v5, s[4:7], s94 offen offset:0 sc1
  buffer_load_dwordx4 v[124:127], v5, s[4:7], s94 offen offset:256 sc1
  buffer_load_dwordx4 v[128:131], v5, s[4:7], s94 offen offset:512 sc1
  buffer_load_dwordx4 v[132:135], v5, s[4:7], s94 offen offset:768 sc1
  s_add_u32 s94, s94, 4096
  buffer_load_dwordx4 v[136:139], v5, s[4:7], s94 offen offset:0 sc1
  buffer_load_dwordx4 v[140:143], v5, s[4:7], s94 offen offset:256 sc1
  buffer_load_dwordx4 v[144:147], v5, s[4:7], s94 offen offset:512 sc1
  buffer_load_dwordx4 v[148:151], v5, s[4:7], s94 offen offset:768 sc1
  s_add_u32 s94, s94, 4096
  buffer_load_dwordx4 v[152:155], v5, s[4:7], s94 offen offset:0 sc1
  buffer_load_dwordx4 v[156:159], v5, s[4:7], s94 offen offset:256 sc1
  buffer_load_dwordx4 v[160:163], v5, s[4:7], s94 offen offset:512 sc1
  buffer_load_dwordx4 v[164:167], v5, s[4:7], s94 offen offset:768 sc1
  s_add_u32 s94, s94, 4096
  buffer_load_dwordx4 v[168:171], v5, s[4:7], s94 offen offset:0 sc1
  buffer_load_dwordx4 v[172:175], v5, s[4:7], s94 offen offset:256 sc1
  buffer_load_dwordx4 v[176:179], v5, s[4:7], s94 offen offset:512 sc1
  buffer_load_dwordx4 v[180:183], v5, s[4:7], s94 offen offset:768 sc1
  s_and_b32 s91, s65, 63
  s_lshl_b32 s90, s91, 5
  s_add_u32 s90, s90, s43
  s_lshl_b32 s94, s91, 5
  s_add_u32 s94, s94, s85
  s_lshl_b32 s94, s94, 10
  s_lshr_b32 s92, s65, 22
  s_xor_b32 s93, s43, 32
  s_lshl_b32 s91, s90, 10
  s_add_u32 s94, s94, 25165824
  s_cmp_eq_u32 s92, s93
  s_cselect_b32 s92, s94, s91
  s_add_u32 s92, s92, 10485760
  buffer_load_dwordx4 v[184:187], v0, s[4:7], s92 offen sc1
  s_waitcnt vmcnt(13)
  v_xor_b32 v7, s96, v120
  v_bitop3_b32 v7, v7, v124, s96 bitop3:0xf6
  v_bitop3_b32 v7, v7, v128, s96 bitop3:0xf6
  v_bitop3_b32 v7, v7, v132, s96 bitop3:0xf6
  s_waitcnt vmcnt(9)
  v_bitop3_b32 v7, v7, v136, s96 bitop3:0xf6
  v_bitop3_b32 v7, v7, v140, s96 bitop3:0xf6
  v_bitop3_b32 v7, v7, v144, s96 bitop3:0xf6
  v_bitop3_b32 v7, v7, v148, s96 bitop3:0xf6
  s_waitcnt vmcnt(5)
  v_bitop3_b32 v7, v7, v152, s96 bitop3:0xf6
  v_bitop3_b32 v7, v7, v156, s96 bitop3:0xf6
  v_bitop3_b32 v7, v7, v160, s96 bitop3:0xf6
  v_bitop3_b32 v7, v7, v164, s96 bitop3:0xf6
  s_waitcnt vmcnt(1)
  v_bitop3_b32 v7, v7, v168, s96 bitop3:0xf6
  v_bitop3_b32 v7, v7, v172, s96 bitop3:0xf6
  v_bitop3_b32 v7, v7, v176, s96 bitop3:0xf6
  v_bitop3_b32 v7, v7, v180, s96 bitop3:0xf6
  v_and_b32 v7, v254, v7
  v_cmp_ne_u32 vcc, 0, v7
  s_cbranch_vccnz o_rt_125
o_bk_126:
  v_mfma_f32_16x16x32_bf16 v[188:191], v[16:19], v[120:123], 0
  v_mfma_f32_16x16x32_bf16 v[192:195], v[16:19], v[124:127], 0
  v_mfma_f32_16x16x32_bf16 v[188:191], v[20:23], v[128:131], v[188:191]
  v_mfma_f32_16x16x32_bf16 v[192:195], v[20:23], v[132:135], v[192:195]
  v_mfma_f32_16x16x32_bf16 v[188:191], v[16:19], v[136:139], v[188:191]
  v_mfma_f32_16x16x32_bf16 v[192:195], v[16:19], v[140:143], v[192:195]
  v_mfma_f32_16x16x32_bf16 v[188:191], v[20:23], v[144:147], v[188:191]
  v_mfma_f32_16x16x32_bf16 v[192:195], v[20:23], v[148:151], v[192:195]
  v_mfma_f32_16x16x32_bf16 v[188:191], v[16:19], v[152:155], v[188:191]
  v_mfma_f32_16x16x32_bf16 v[192:195], v[16:19], v[156:159], v[192:195]
  v_mfma_f32_16x16x32_bf16 v[188:191], v[20:23], v[160:163], v[188:191]
  v_mfma_f32_16x16x32_bf16 v[192:195], v[20:23], v[164:167], v[192:195]
  v_mfma_f32_16x16x32_bf16 v[188:191], v[16:19], v[168:171], v[188:191]
  v_mfma_f32_16x16x32_bf16 v[192:195], v[16:19], v[172:175], v[192:195]
  v_mfma_f32_16x16x32_bf16 v[188:191], v[20:23], v[176:179], v[188:191]
  v_mfma_f32_16x16x32_bf16 v[192:195], v[20:23], v[180:183], v[192:195]
  s_bfe_u32 s92, s65, 131086
  s_lshl_b32 s92, s92, 21
  s_add_u32 s92, s92, s91
  s_add_u32 s93, s92, 27262976
  s_add_u32 s92, s92, 20971520
  s_waitcnt vmcnt(0)
  v_lshlrev_b32 v196, 16, v184
  v_and_b32 v197, 0xffff0000, v184
  v_lshlrev_b32 v198, 16, v185
  v_and_b32 v199, 0xffff0000, v185
  v_lshlrev_b32 v200, 16, v186
  v_and_b32 v201, 0xffff0000, v186
  v_lshlrev_b32 v202, 16, v187
  v_and_b32 v203, 0xffff0000, v187
  v_permlane16_swap_b32 v188, v192
  v_permlane16_swap_b32 v189, v193
  v_permlane16_swap_b32 v190, v194
  v_permlane16_swap_b32 v191, v195
  v_cvt_pk_bf16_f32 v188, 0, v188
  v_cvt_pk_bf16_f32 v189, 0, v189
  v_cvt_pk_bf16_f32 v190, 0, v190
  v_cvt_pk_bf16_f32 v191, 0, v191
  v_cvt_pk_bf16_f32 v192, 0, v192
  v_cvt_pk_bf16_f32 v193, 0, v193
  v_cvt_pk_bf16_f32 v194, 0, v194
  v_cvt_pk_bf16_f32 v195, 0, v195
  v_add_f32 v196, v196, v188
  v_add_f32 v197, v197, v189
  v_add_f32 v198, v198, v190
  v_add_f32 v199, v199, v191
  v_add_f32 v200, v200, v192
  v_add_f32 v201, v201, v193
  v_add_f32 v202, v202, v194
  v_add_f32 v203, v203, v195
  v_cvt_pk_bf16_f32 v120, v196, v197
  v_cvt_pk_bf16_f32 v121, v198, v199
  v_cvt_pk_bf16_f32 v122, v200, v201
  v_cvt_pk_bf16_f32 v123, v202, v203
  v_lshlrev_b32 v196, 16, v120
  v_and_b32 v197, 0xffff0000, v120
  v_lshlrev_b32 v198, 16, v121
  v_and_b32 v199, 0xffff0000, v121
  v_lshlrev_b32 v200, 16, v122
  v_and_b32 v201, 0xffff0000, v122
  v_lshlrev_b32 v202, 16, v123
  v_and_b32 v203, 0xffff0000, v123
  buffer_store_dwordx4 v[120:123], v0, s[4:7], s92 offen sc1
  v_add_f32 v136, v196, v197
  v_mul_f32 v137, v196, v196
  v_add_f32 v138, v198, v199
  v_mul_f32 v139, v197, v197
  v_fmac_f32 v137, v198, v198
  v_fmac_f32 v139, v199, v199
  v_add_f32 v136, v136, v200
  v_fmac_f32 v137, v200, v200
  v_add_f32 v138, v138, v201
  v_fmac_f32 v139, v201, v201
  v_add_f32 v136, v136, v202
  v_fmac_f32 v137, v202, v202
  v_add_f32 v138, v138, v203
  v_fmac_f32 v139, v203, v203
  v_add_f32 v136, v136, v138
  v_add_f32 v137, v137, v139
  s_nop 0
  v_add_f32_dpp v136, v136, v136 row_ror:8 row_mask:0xf bank_mask:0xf
  v_add_f32_dpp v137, v137, v137 row_ror:8 row_mask:0xf bank_mask:0xf
  s_nop 0
  v_add_f32_dpp v136, v136, v136 row_ror:4 row_mask:0xf bank_mask:0xf
  v_add_f32_dpp v137, v137, v137 row_ror:4 row_mask:0xf bank_mask:0xf
  s_nop 0
  v_add_f32_dpp v136, v136, v136 row_ror:2 row_mask:0xf bank_mask:0xf
  v_add_f32_dpp v137, v137, v137 row_ror:2 row_mask:0xf bank_mask:0xf
  s_nop 0
  v_add_f32_dpp v136, v136, v136 row_ror:1 row_mask:0xf bank_mask:0xf
  v_add_f32_dpp v137, v137, v137 row_ror:1 row_mask:0xf bank_mask:0xf
  v_mov_b32 v140, v136
  v_mov_b32 v141, v137
  s_nop 0
  v_permlane16_swap_b32 v136, v140
  v_permlane16_swap_b32 v137, v141
  v_add_f32 v136, v136, v140
  v_add_f32 v137, v137, v141
  v_mov_b32 v140, v136
  v_mov_b32 v141, v137
  s_nop 0
  v_permlane32_swap_b32 v136, v140
  v_permlane32_swap_b32 v137, v141
  v_add_f32 v136, v136, v140
  v_add_f32 v137, v137, v141
  v_mul_f32 v136, 0x3b000000, v136
  v_mul_f32 v137, 0x3b000000, v137
  v_fma_f32 v137, -v136, v136, v137
  v_cvt_pk_bf16_f32 v136, 0, v136
  v_max_f32 v137, 0, v137
  v_sub_f32 v140, v196, v136
  v_sub_f32 v141, v197, v136
  v_cvt_pk_bf16_f32 v137, 0, v137
  v_sub_f32 v142, v198, v136
  v_sub_f32 v143, v199, v136
  v_add_f32 v137, 0x3727c5ac, v137
  v_sub_f32 v144, v200, v136
  v_sub_f32 v145, v201, v136
  v_cvt_pk_bf16_f32 v137, 0, v137
  v_sub_f32 v146, v202, v136
  v_sub_f32 v147, v203, v136
  v_sqrt_f32 v137, v137
  v_cvt_pk_bf16_f32 v140, 0, v140
  v_cvt_pk_bf16_f32 v141, 0, v141
  v_cvt_pk_bf16_f32 v137, 0, v137
  v_cvt_pk_bf16_f32 v142, 0, v142
  v_cvt_pk_bf16_f32 v143, 0, v143
  v_rcp_f32 v137, v137
  v_cvt_pk_bf16_f32 v144, 0, v144
  v_cvt_pk_bf16_f32 v145, 0, v145
  v_cvt_pk_bf16_f32 v146, 0, v146
  v_cvt_pk_bf16_f32 v147, 0, v147
  v_mul_f32 v140, v140, v137
  v_mul_f32 v141, v141, v137
  v_mul_f32 v142, v142, v137
  v_mul_f32 v143, v143, v137
  v_mul_f32 v144, v144, v137
  v_mul_f32 v145, v145, v137
  v_mul_f32 v146, v146, v137
  v_mul_f32 v147, v147, v137
  v_cvt_pk_bf16_f32 v124, v140, v141
  v_cvt_pk_bf16_f32 v125, v142, v143
  v_cvt_pk_bf16_f32 v126, v144, v145
  v_cvt_pk_bf16_f32 v127, v146, v147
  v_lshlrev_b32 v204, 16, v124
  v_and_b32 v205, 0xffff0000, v124
  v_lshlrev_b32 v206, 16, v125
  v_and_b32 v207, 0xffff0000, v125
  v_lshlrev_b32 v208, 16, v126
  v_and_b32 v209, 0xffff0000, v126
  v_lshlrev_b32 v210, 16, v127
  v_and_b32 v211, 0xffff0000, v127
  buffer_store_dwordx4 v[124:127], v0, s[4:7], s93 offen sc1
  v_add_f32 v196, v196, v204
  v_add_f32 v197, v197, v205
  v_add_f32 v198, v198, v206
  v_add_f32 v199, v199, v207
  v_add_f32 v200, v200, v208
  v_add_f32 v201, v201, v209
  v_add_f32 v202, v202, v210
  v_add_f32 v203, v203, v211
  v_cvt_pk_bf16_f32 v128, v196, v197
  v_cvt_pk_bf16_f32 v129, v198, v199
  v_cvt_pk_bf16_f32 v130, v200, v201
  v_cvt_pk_bf16_f32 v131, v202, v203
  v_mul_f32 v188, v204, v8
  v_mul_f32 v189, v205, v9
  v_fmac_f32 v188, v206, v10
  v_fmac_f32 v189, v207, v11
  v_fmac_f32 v188, v208, v12
  v_fmac_f32 v189, v209, v13
  v_fmac_f32 v188, v210, v14
  v_fmac_f32 v189, v211, v15
  v_add_f32 v188, v188, v189
  buffer_store_dwordx4 v[128:131], v0, s[68:71], s91 offen sc1
  s_nop 0
  v_add_f32_dpp v188, v188, v188 row_ror:8 row_mask:0xf bank_mask:0xf
  s_nop 1
  v_add_f32_dpp v188, v188, v188 row_ror:4 row_mask:0xf bank_mask:0xf
  s_nop 1
  v_add_f32_dpp v188, v188, v188 row_ror:2 row_mask:0xf bank_mask:0xf
  s_nop 1
  v_add_f32_dpp v188, v188, v188 row_ror:1 row_mask:0xf bank_mask:0xf
  v_mov_b32 v189, v188
  s_nop 0
  s_nop 0
  v_permlane16_swap_b32 v188, v189
  v_add_f32 v188, v188, v189
  v_mov_b32 v189, v188
  s_nop 0
  s_nop 0
  v_permlane32_swap_b32 v188, v189
  v_add_f32 v188, v188, v189
  v_cvt_pk_bf16_f32 v188, 0, v188
  v_ashrrev_i32 v189, 31, v188
  v_or_b32 v189, 0x80000000, v189
  v_xor_b32 v188, v188, v189
  s_sub_u32 s92, 4095, s90
  v_and_b32 v188, 0xffff0000, v188
  v_or_b32 v38, s92, v188
  s_bfe_u32 s92, s65, 196625
  s_lshl_b32 s92, s92, 18
  s_lshl_b32 s93, s90, 7
  s_add_u32 s92, s92, s93
  s_add_u32 s84, s92, 243269632
  s_waitcnt vmcnt(0)
  s_mov_b64 exec, 1
  buffer_store_dword v38, off, s[4:7], s84 sc1
  s_mov_b64 exec, -1
  s_mov_b32 s84, 268435456
  s_branch o_fd_118
o_rt_125:
  s_mov_b32 s67, 0
o_rl_127:
  s_lshl_b32 s94, s43, 14
  s_add_u32 s94, s94, s86
  buffer_load_dwordx4 v[120:123], v5, s[4:7], s94 offen offset:0 sc1
  buffer_load_dwordx4 v[124:127], v5, s[4:7], s94 offen offset:256 sc1
  buffer_load_dwordx4 v[128:131], v5, s[4:7], s94 offen offset:512 sc1
  buffer_load_dwordx4 v[132:135], v5, s[4:7], s94 offen offset:768 sc1
  s_add_u32 s94, s94, 4096
  buffer_load_dwordx4 v[136:139], v5, s[4:7], s94 offen offset:0 sc1
  buffer_load_dwordx4 v[140:143], v5, s[4:7], s94 offen offset:256 sc1
  buffer_load_dwordx4 v[144:147], v5, s[4:7], s94 offen offset:512 sc1
  buffer_load_dwordx4 v[148:151], v5, s[4:7], s94 offen offset:768 sc1
  s_add_u32 s94, s94, 4096
  buffer_load_dwordx4 v[152:155], v5, s[4:7], s94 offen offset:0 sc1
  buffer_load_dwordx4 v[156:159], v5, s[4:7], s94 offen offset:256 sc1
  buffer_load_dwordx4 v[160:163], v5, s[4:7], s94 offen offset:512 sc1
  buffer_load_dwordx4 v[164:167], v5, s[4:7], s94 offen offset:768 sc1
  s_add_u32 s94, s94, 4096
  buffer_load_dwordx4 v[168:171], v5, s[4:7], s94 offen offset:0 sc1
  buffer_load_dwordx4 v[172:175], v5, s[4:7], s94 offen offset:256 sc1
  buffer_load_dwordx4 v[176:179], v5, s[4:7], s94 offen offset:512 sc1
  buffer_load_dwordx4 v[180:183], v5, s[4:7], s94 offen offset:768 sc1
  s_add_u32 s67, s67, 1
  s_cmp_gt_u32 s67, 1048576
  s_cbranch_scc1 L_end
  s_waitcnt vmcnt(0)
  v_xor_b32 v7, s96, v120
  v_bitop3_b32 v7, v7, v124, s96 bitop3:0xf6
  v_bitop3_b32 v7, v7, v128, s96 bitop3:0xf6
  v_bitop3_b32 v7, v7, v132, s96 bitop3:0xf6
  v_bitop3_b32 v7, v7, v136, s96 bitop3:0xf6
  v_bitop3_b32 v7, v7, v140, s96 bitop3:0xf6
  v_bitop3_b32 v7, v7, v144, s96 bitop3:0xf6
  v_bitop3_b32 v7, v7, v148, s96 bitop3:0xf6
  v_bitop3_b32 v7, v7, v152, s96 bitop3:0xf6
  v_bitop3_b32 v7, v7, v156, s96 bitop3:0xf6
  v_bitop3_b32 v7, v7, v160, s96 bitop3:0xf6
  v_bitop3_b32 v7, v7, v164, s96 bitop3:0xf6
  v_bitop3_b32 v7, v7, v168, s96 bitop3:0xf6
  v_bitop3_b32 v7, v7, v172, s96 bitop3:0xf6
  v_bitop3_b32 v7, v7, v176, s96 bitop3:0xf6
  v_bitop3_b32 v7, v7, v180, s96 bitop3:0xf6
  v_and_b32 v7, v254, v7
  v_cmp_ne_u32 vcc, 0, v7
  s_cbranch_vccnz o_rl_127
  s_branch o_bk_126
o_fd_118:
  s_mov_b32 s65, 0
o_nofl_83:
  s_mov_b32 s63, s64
  s_cmp_lg_u32 s51, 0
  s_cbranch_scc1 o_pick_85
  s_cmp_eq_u32 s50, 0
  s_cbranch_scc1 L_end
o_adv_91:
  s_add_u32 s49, s49, 4
  s_branch o_round_81
L_o_x:
  s_mov_b32 s62, 1
  s_mov_b32 s42, 0
  s_mov_b32 s3, 0
  s_mov_b32 s46, 0
  s_mov_b32 s65, 0
  s_mov_b32 s66, 0
  s_mov_b32 s76, 0
  s_mov_b32 s55, 0
  s_mov_b32 s56, 0
  s_mov_b32 s84, 268435456
  s_mov_b32 s86, s41
  s_mov_b32 s49, s60
  s_mul_i32 s63, s49, 257
  s_or_b32 s63, s63, 1179648
o_round_128:
  s_max_u32 s46, s46, s3
  s_cmp_lg_u32 s3, 0
  s_mov_b32 s3, 0
  s_cbranch_scc1 d_g_140
  s_mov_b32 s67, 0
d_w_139:
  s_min_u32 s26, s49, 71
  s_lshl_b32 s26, s26, 12
  s_add_u32 s27, s26, 243494912
  s_add_u32 s26, s26, 243486720
  buffer_load_dword v248, v246, s[4:7], s26 offen sc1
  buffer_load_dword v249, v246, s[4:7], s27 offen sc1
  s_add_u32 s67, s67, 1
  s_cmp_gt_u32 s67, 1048576
  s_cbranch_scc1 L_end
  s_waitcnt vmcnt(0)
  s_mov_b64 exec, 1
  buffer_store_dword v38, off, s[4:7], s84 sc1
  s_mov_b64 exec, -1
  s_mov_b32 s84, 268435456
  v_min_u32 v162, v248, v249
  v_max_u32 v163, v248, v249
  v_cmp_eq_u32 vcc, 0, v162
  s_cbranch_vccnz d_w_139
  v_max_u32_dpp v163, v163, v163 row_ror:8 row_mask:0xf bank_mask:0xf
  s_nop 1
  v_max_u32_dpp v163, v163, v163 row_ror:4 row_mask:0xf bank_mask:0xf
  s_nop 1
  v_max_u32_dpp v163, v163, v163 row_ror:2 row_mask:0xf bank_mask:0xf
  s_nop 1
  v_max_u32_dpp v163, v163, v163 row_ror:1 row_mask:0xf bank_mask:0xf
  s_nop 0
  v_readlane_b32 s28, v163, 0
  v_readlane_b32 s29, v163, 16
  v_readlane_b32 s30, v163, 32
  v_readlane_b32 s31, v163, 48
  s_max_u32 s28, s28, s29
  s_max_u32 s30, s30, s31
  s_max_u32 s46, s46, s28
  s_max_u32 s46, s46, s30
d_g_140:
  s_lshr_b32 s27, s49, 2
  s_andn2_b32 s52, 0xfff, s46
  s_lshr_b32 s52, s52, 5
  s_min_u32 s52, s52, 64
  s_add_u32 s26, s52, 3
  v_readlane_b32 s89, v247, s27
  s_sub_u32 s26, s26, s60
  s_lshr_b32 s26, s26, 2
  s_bfm_b32 s54, s26, 0
  s_add_u32 s53, s63, 1028
  s_cmp_lt_u32 s49, 60
  s_cselect_b32 s53, s53, 0
  s_cmp_lt_u32 s49, 64
  s_cselect_b32 s26, 3, 1
  s_sub_i32 s26, s27, s26
  s_max_i32 s26, s26, 0
  s_min_u32 s26, s26, 16
  s_bfm_b32 s58, s26, 0
  s_cmp_eq_u32 s27, 16
  s_cselect_b32 s59, 2, 1
  s_cmp_eq_u32 s27, 18
  s_cselect_b32 s59, 64, s59
  s_cselect_b32 s50, 0, -1
  s_cselect_b32 s89, 0, s89
o_pick_132:
  s_cmp_eq_u32 s59, 0
  s_cbranch_scc1 o_none_136
  s_sub_u32 s59, s59, 1
  s_andn2_b32 s26, s58, s55
  s_and_b32 s26, s26, s54
  s_cbranch_scc1 o_ga_133
  s_and_b32 s26, s55, s50
  s_or_b32 s26, s26, s56
  s_or_b32 s26, s26, s54
  s_andn2_b32 s26, s58, s26
  s_cbranch_scc0 o_none_136
  s_cmp_ge_u32 s46, s89
  s_cbranch_scc1 o_gb_134
o_ga_133:
  s_ff1_i32_b32 s26, s26
  s_bitset1_b32 s55, s26
  s_mov_b32 s64, 1327168
  s_branch o_gd_135
o_none_136:
  s_cmp_lt_u32 s49, 60
  s_cbranch_scc1 o_nn_137
  s_cmp_eq_u32 s50, 0
  s_cbranch_scc1 o_nn_137
  s_and_b32 s26, s63, 1097728
  s_cmp_eq_u32 s26, 1048576
  s_cbranch_scc1 o_nn_137
  s_cmp_lt_u32 s49, 64
  s_cbranch_scc1 o_adv_138
  s_and_b32 s26, s65, 1097728
  s_cmp_lg_u32 s26, 1048576
  s_cbranch_scc1 o_adv_138
o_nn_137:
  s_mov_b32 s64, s53
  s_mov_b32 s51, 0
  s_branch o_task_129
o_gb_134:
  s_ff1_i32_b32 s26, s26
  s_bitset1_b32 s56, s26
  s_andn2_b32 s27, 31, s46
  s_or_b32 s27, s27, 32
  s_lshl_b32 s27, s27, 22
  s_or_b32 s27, s27, 1474688
  s_lshl_b32 s28, s26, 2
  s_add_u32 s28, s28, s60
  s_cmp_eq_u32 s28, s52
  s_cselect_b32 s64, s27, 1474624
o_gd_135:
  s_lshl_b32 s26, s26, 2
  s_add_u32 s26, s26, s60
  s_mul_i32 s26, s26, 257
  s_or_b32 s64, s64, s26
  s_mov_b32 s51, 1
o_task_129:
  s_cmp_eq_u32 s63, 0
  s_cbranch_scc1 o_nofl_130
  s_cmp_lg_u32 s66, 0
  s_cbranch_scc1 o_have_142
  s_mov_b32 s67, 0
o_w1_141:
  s_and_b32 s32, s63, 0xff
  s_lshl_b32 s32, s32, 12
  s_add_u32 s32, s32, s14
  buffer_load_dword v37, v36, s[4:7], s32 offen sc1
  s_add_u32 s67, s67, 1
  s_cmp_gt_u32 s67, 1048576
  s_cbranch_scc1 L_end
  s_waitcnt vmcnt(0)
  s_mov_b64 exec, 1
  buffer_store_dword v38, off, s[4:7], s84 sc1
  s_mov_b64 exec, -1
  s_mov_b32 s84, 268435456
  v_cmp_eq_u32 vcc, 0, v37
  s_cbranch_vccnz o_w1_141
  s_and_b32 s87, s63, 0xff
  s_lshl_b32 s33, s87, 18
  s_lshl_b32 s32, s87, 19
  s_add_u32 m0, s22, 0
  s_add_u32 s33, s33, s19
  buffer_load_dwordx4 v0, s[4:7], s33 offen offset:0 sc1 lds
  buffer_load_dwordx4 v0, s[4:7], s33 offen offset:1024 sc1 lds
  buffer_load_dwordx4 v0, s[4:7], s33 offen offset:2048 sc1 lds
  buffer_load_dwordx4 v0, s[4:7], s33 offen offset:3072 sc1 lds
  s_add_u32 m0, s23, 0
  s_add_u32 s32, s32, s18
  buffer_load_dwordx4 v0, s[4:7], s32 offen offset:0 sc1 lds
  buffer_load_dwordx4 v0, s[4:7], s32 offen offset:1024 sc1 lds
  buffer_load_dwordx4 v0, s[4:7], s32 offen offset:2048 sc1 lds
  buffer_load_dwordx4 v0, s[4:7], s32 offen offset:3072 sc1 lds
  s_add_u32 m0, m0, 4096
  s_add_u32 s32, s32, 4096
  buffer_load_dwordx4 v0, s[4:7], s32 offen offset:0 sc1 lds
  buffer_load_dwordx4 v0, s[4:7], s32 offen offset:1024 sc1 lds
  buffer_load_dwordx4 v0, s[4:7], s32 offen offset:2048 sc1 lds
  buffer_load_dwordx4 v0, s[4:7], s32 offen offset:3072 sc1 lds
  s_waitcnt vmcnt(0)
  s_barrier
o_have_142:
  ds_read_b128 v[120:123], v33 offset:0
  ds_read_b128 v[40:43], v32 offset:0
  ds_read_b128 v[56:59], v32 offset:1024
  ds_read_b128 v[124:127], v33 offset:2048
  ds_read_b128 v[44:47], v32 offset:4096
  ds_read_b128 v[60:63], v32 offset:5120
  ds_read_b128 v[128:131], v33 offset:4096
  ds_read_b128 v[48:51], v32 offset:8192
  ds_read_b128 v[64:67], v32 offset:9216
  ds_read_b128 v[132:135], v33 offset:6144
  ds_read_b128 v[52:55], v32 offset:12288
  ds_read_b128 v[68:71], v32 offset:13312
  s_cmp_lt_u32 s17, 2
  s_cselect_b32 s65, s65, 0
  s_cmp_lg_u32 s65, 0
  s_cselect_b64 s[44:45], -1, 0
  s_mov_b32 s95, s86
  s_mov_b32 s96, s42
  s_lshl_b32 s97, s43, 14
  s_add_u32 s97, s97, s95
  s_and_b32 s87, s64, 0xff
  s_lshl_b32 s87, s87, 12
  s_add_u32 s87, s87, s14
  s_and_b32 s88, s64, 0xff00
  s_lshl_b32 s88, s88, 3
  s_add_u32 s88, s88, s15
  s_waitcnt lgkmcnt(9)
  v_mfma_f32_16x16x32_bf16 v[104:107], v[40:43], v[120:123], v[24:27]
  ds_read_b128 v[136:139], v34 offset:0
  v_mfma_f32_16x16x32_bf16 v[108:111], v[56:59], v[120:123], v[28:31]
  ds_read_b64 v[200:201], v35 offset:4096
  s_waitcnt lgkmcnt(8)
  v_mfma_f32_16x16x32_bf16 v[104:107], v[44:47], v[124:127], v[104:107]
  ds_read_b128 v[140:143], v34 offset:1024
  v_mfma_f32_16x16x32_bf16 v[108:111], v[60:63], v[124:127], v[108:111]
  ds_read_b64 v[202:203], v35 offset:4608
  s_mov_b64 exec, s[44:45]
  buffer_load_dword v7, v255, s[4:7], s97 offen sc1
  s_not_b64 exec, exec
  buffer_load_dword v37, v36, s[4:7], s87 offen sc1
  buffer_load_dword v245, v252, s[4:7], s88 offen sc1
  s_mov_b64 exec, -1
  s_waitcnt lgkmcnt(7)
  v_mfma_f32_16x16x32_bf16 v[104:107], v[48:51], v[128:131], v[104:107]
  ds_read_b128 v[144:147], v34 offset:2048
  v_mfma_f32_16x16x32_bf16 v[108:111], v[64:67], v[128:131], v[108:111]
  ds_read_b64 v[204:205], v35 offset:5120
  s_waitcnt lgkmcnt(6)
  v_mfma_f32_16x16x32_bf16 v[104:107], v[52:55], v[132:135], v[104:107]
  ds_read_b128 v[148:151], v34 offset:3072
  v_mfma_f32_16x16x32_bf16 v[108:111], v[68:71], v[132:135], v[108:111]
  ds_read_b64 v[206:207], v35 offset:5632
  s_cmp_lg_u32 s76, 0
  s_cbranch_scc1 o_klds_145
  ds_read_b128 v[152:155], v32 offset:2048
  ds_read_b128 v[156:159], v32 offset:3072
  ds_read_b128 v[160:163], v32 offset:6144
  ds_read_b128 v[164:167], v32 offset:7168
  ds_read_b128 v[168:171], v32 offset:10240
  ds_read_b128 v[172:175], v32 offset:11264
  ds_read_b128 v[176:179], v32 offset:14336
  ds_read_b128 v[180:183], v32 offset:15360
  v_mov_b32 v196, 0
  v_mov_b32 v199, 0
  v_exp_f32 v56, v104
  v_exp_f32 v57, v105
  v_exp_f32 v58, v106
  v_exp_f32 v59, v107
  v_exp_f32 v60, v108
  v_exp_f32 v61, v109
  v_exp_f32 v62, v110
  v_exp_f32 v63, v111
  v_max3_f32 v116, v104, v105, v106
  v_max3_f32 v116, v107, v108, v116
  v_max3_f32 v116, v109, v110, v116
  v_add_f32 v117, v56, v57
  v_add_f32 v118, v58, v59
  v_add_f32 v117, v117, v60
  v_add_f32 v118, v118, v61
  v_add_f32 v117, v117, v62
  v_add_f32 v118, v118, v63
  s_waitcnt vmcnt(0) lgkmcnt(0)
  s_mov_b64 exec, 1
  buffer_store_dword v38, off, s[4:7], s84 sc1
  s_mov_b64 exec, -1
  s_mov_b32 s84, 268435456
  s_mov_b32 s67, 0
  s_and_b32 s32, s63, 0xff00
  s_lshl_b32 s32, s32, 3
  s_add_u32 s32, s32, s15
  s_lshl_b32 s33, s17, 5
  s_and_b32 s33, s33, 64
  s_add_u32 s33, s32, s33
  s_and_b32 s32, s63, 0xff00
  s_lshl_b32 s32, s32, 10
  s_add_u32 s32, s32, s20
o_w2_143:
  buffer_load_dword v244, off, s[4:7], s33 sc1
  s_add_u32 s67, s67, 1
  s_cmp_gt_u32 s67, 1048576
  s_cbranch_scc1 L_end
  s_waitcnt vmcnt(0)
  v_cmp_eq_u32 vcc, 0, v244
  s_cbranch_vccnz o_w2_143
  buffer_load_dwordx4 v[136:139], v0, s[4:7], s32 offen offset:0 sc1
  buffer_load_dwordx4 v[140:143], v0, s[4:7], s32 offen offset:1024 sc1
  buffer_load_dwordx4 v[144:147], v0, s[4:7], s32 offen offset:2048 sc1
  buffer_load_dwordx4 v[148:151], v0, s[4:7], s32 offen offset:3072 sc1
  s_add_u32 s32, s32, 4096
  buffer_load_dwordx2 v[200:201], v1, s[4:7], s32 offen offset:0 sc1
  buffer_load_dwordx2 v[202:203], v1, s[4:7], s32 offen offset:512 sc1
  buffer_load_dwordx2 v[204:205], v1, s[4:7], s32 offen offset:1024 sc1
  buffer_load_dwordx2 v[206:207], v1, s[4:7], s32 offen offset:1536 sc1
  buffer_load_dword v37, v36, s[4:7], s87 offen sc1
  buffer_load_dword v245, v252, s[4:7], s88 offen sc1
  s_waitcnt vmcnt(9)
  v_mfma_f32_16x16x32_bf16 v[112:115], v[136:139], v[120:123], 0
  s_waitcnt vmcnt(8)
  v_mfma_f32_16x16x32_bf16 v[112:115], v[140:143], v[124:127], v[112:115]
  s_waitcnt vmcnt(7)
  v_mfma_f32_16x16x32_bf16 v[112:115], v[144:147], v[128:131], v[112:115]
  s_waitcnt vmcnt(6)
  v_mfma_f32_16x16x32_bf16 v[112:115], v[148:151], v[132:135], v[112:115]
  s_branch o_havek_144
o_klds_145:
  s_waitcnt lgkmcnt(1)
  v_mfma_f32_16x16x32_bf16 v[112:115], v[136:139], v[120:123], 0
  ds_read_b128 v[152:155], v32 offset:2048
  ds_read_b128 v[156:159], v32 offset:3072
  v_mfma_f32_16x16x32_bf16 v[112:115], v[140:143], v[124:127], v[112:115]
  ds_read_b128 v[160:163], v32 offset:6144
  ds_read_b128 v[164:167], v32 offset:7168
  v_mfma_f32_16x16x32_bf16 v[112:115], v[144:147], v[128:131], v[112:115]
  ds_read_b128 v[168:171], v32 offset:10240
  ds_read_b128 v[172:175], v32 offset:11264
  v_mfma_f32_16x16x32_bf16 v[112:115], v[148:151], v[132:135], v[112:115]
  ds_read_b128 v[176:179], v32 offset:14336
  ds_read_b128 v[180:183], v32 offset:15360
  v_mov_b32 v196, 0
  v_mov_b32 v199, 0
  v_exp_f32 v56, v104
  v_exp_f32 v57, v105
  v_exp_f32 v58, v106
  v_exp_f32 v59, v107
  v_exp_f32 v60, v108
  v_exp_f32 v61, v109
  v_exp_f32 v62, v110
  v_exp_f32 v63, v111
  v_max3_f32 v116, v104, v105, v106
  v_max3_f32 v116, v107, v108, v116
  v_max3_f32 v116, v109, v110, v116
  v_add_f32 v117, v56, v57
  v_add_f32 v118, v58, v59
  v_add_f32 v117, v117, v60
  v_add_f32 v118, v118, v61
  v_add_f32 v117, v117, v62
  v_add_f32 v118, v118, v63
o_havek_144:
  s_cmp_lg_u32 s65, 0
  s_cbranch_scc1 o_wr1_150
  s_nop 0
  s_nop 1
  s_nop 1
  v_mul_f32 v112, s24, v112
  v_mul_f32 v113, s24, v113
  v_exp_f32 v64, v112
  v_exp_f32 v65, v113
  v_max_f32 v116, v111, v116
  v_max3_f32 v116, v112, v113, v116
  v_add_f32 v117, v117, v64
  v_add_f32 v118, v118, v65
  v_add_f32 v117, v117, v118
  s_mov_b32 s28, 0x21800000
  v_mov_b32 v118, v117
  s_nop 1
  v_permlane16_swap_b32 v117, v118
  v_add_f32 v117, v117, v118
  v_mov_b32 v118, v117
  s_nop 0
  s_nop 0
  v_permlane32_swap_b32 v117, v118
  v_add_f32 v117, v117, v118
  s_waitcnt vmcnt(2)
  v_cmp_lt_f32 vcc, 0x42700000, v116
  v_cmp_gt_f32 s[30:31], s28, v117
  v_rcp_f32 v117, v117
  s_or_b64 vcc, vcc, s[30:31]
  s_cbranch_vccnz o_fb_153
o_fbr_154:
  v_pk_mul_f32 v[56:57], v[56:57], v[116:117] op_sel:[0,1] op_sel_hi:[1,1]
  v_pk_mul_f32 v[58:59], v[58:59], v[116:117] op_sel:[0,1] op_sel_hi:[1,1]
  v_pk_mul_f32 v[60:61], v[60:61], v[116:117] op_sel:[0,1] op_sel_hi:[1,1]
  v_pk_mul_f32 v[62:63], v[62:63], v[116:117] op_sel:[0,1] op_sel_hi:[1,1]
  v_pk_mul_f32 v[64:65], v[64:65], v[116:117] op_sel:[0,1] op_sel_hi:[1,1]
  v_cvt_pk_bf16_f32 v116, v56, v57
  v_cvt_pk_bf16_f32 v117, v58, v59
  v_cvt_pk_bf16_f32 v118, v60, v61
  v_cvt_pk_bf16_f32 v119, v62, v63
  s_waitcnt lgkmcnt(0)
  s_nop 0
  v_mfma_f32_16x16x32_bf16 v[72:75], v[152:155], v[116:119], 0
  s_add_u32 s62, s62, 1
  v_cvt_pk_bf16_f32 v197, v64, v65
  v_cvt_pk_bf16_f32 v198, v64, v65
  v_mfma_f32_16x16x32_bf16 v[76:79], v[156:159], v[116:119], 0
  s_xor_b32 s86, s86, 524288
  v_mfma_f32_16x16x32_bf16 v[80:83], v[160:163], v[116:119], 0
  s_bfe_u32 s42, s62, 0x10001
  v_mfma_f32_16x16x32_bf16 v[84:87], v[164:167], v[116:119], 0
  s_bfe_u32 s26, s64, 65556
  v_mfma_f32_16x16x32_bf16 v[88:91], v[168:171], v[116:119], 0
  s_and_b32 s87, s64, 0xff
  v_mfma_f32_16x16x32_bf16 v[92:95], v[172:175], v[116:119], 0
  s_bfe_u32 s88, s64, 0x80008
  v_mfma_f32_16x16x32_bf16 v[96:99], v[176:179], v[116:119], 0
  s_nop 0
  v_mfma_f32_16x16x32_bf16 v[100:103], v[180:183], v[116:119], 0
  s_nop 0
  v_mfma_f32_16x16x16_bf16 v[72:75], v[200:201], v[198:199], v[72:75]
  s_nop 1
  v_mfma_f32_16x16x16_bf16 v[76:79], v[200:201], v[196:197], v[76:79]
  s_nop 1
  v_mfma_f32_16x16x16_bf16 v[80:83], v[202:203], v[198:199], v[80:83]
  s_nop 1
  v_mfma_f32_16x16x16_bf16 v[84:87], v[202:203], v[196:197], v[84:87]
  s_nop 1
  v_mfma_f32_16x16x16_bf16 v[88:91], v[204:205], v[198:199], v[88:91]
  s_nop 0
  v_cvt_pk_bf16_f32 v40, v72, v73
  v_cvt_pk_bf16_f32 v41, v74, v75
  v_mfma_f32_16x16x16_bf16 v[92:95], v[204:205], v[196:197], v[92:95]
  s_nop 0
  v_cvt_pk_bf16_f32 v42, v76, v77
  v_cvt_pk_bf16_f32 v43, v78, v79
  v_mfma_f32_16x16x16_bf16 v[96:99], v[206:207], v[198:199], v[96:99]
  s_nop 0
  ds_write_b128 v6, v[40:43] offset:0
  v_cvt_pk_bf16_f32 v44, v80, v81
  v_mfma_f32_16x16x16_bf16 v[100:103], v[206:207], v[196:197], v[100:103]
  s_nop 0
  v_cvt_pk_bf16_f32 v45, v82, v83
  v_cvt_pk_bf16_f32 v46, v84, v85
  v_cvt_pk_bf16_f32 v47, v86, v87
  ds_write_b128 v6, v[44:47] offset:1024
  v_cvt_pk_bf16_f32 v48, v88, v89
  v_cvt_pk_bf16_f32 v49, v90, v91
  v_cvt_pk_bf16_f32 v50, v92, v93
  v_cvt_pk_bf16_f32 v51, v94, v95
  ds_write_b128 v6, v[48:51] offset:2048
  v_cvt_pk_bf16_f32 v52, v96, v97
  v_cvt_pk_bf16_f32 v53, v98, v99
  v_cvt_pk_bf16_f32 v54, v100, v101
  v_cvt_pk_bf16_f32 v55, v102, v103
  ds_write_b128 v6, v[52:55] offset:3072
  s_cmp_lt_u32 s17, 2
  s_cbranch_scc1 o_wr0_149
  s_waitcnt lgkmcnt(0)
  s_barrier
  ds_read_b128 v[104:107], v3 offset:0
  ds_read_b128 v[108:111], v3 offset:512
  ds_read_b128 v[112:115], v3 offset:1024
  s_waitcnt lgkmcnt(2)
  v_mfma_f32_32x32x16_bf16 v[40:55], v[104:107], a[0:3], 0
  s_waitcnt vmcnt(0)
  v_cmp_eq_u32 vcc, 0, v37
  s_cmp_eq_u64 vcc, 0
  s_cselect_b32 s66, s26, 0
  s_cmp_eq_u32 s66, 1
  s_cselect_b32 s87, s87, 1024
  s_cselect_b32 s34, 0, 0x28000
  v_mfma_f32_32x32x16_bf16 v[56:71], v[104:107], a[4:7], 0
  ds_read_b128 v[116:119], v3 offset:1536
  v_cmp_eq_u32 vcc, 0, v245
  s_cmp_eq_u64 vcc, 0
  s_cselect_b32 s76, s26, 0
  s_and_b32 s76, s76, 1
  s_cselect_b32 s88, s88, 1024
  v_mfma_f32_32x32x16_bf16 v[72:87], v[104:107], a[8:11], 0
  s_lshl_b32 s33, s87, 18
  s_lshl_b32 s32, s87, 19
  s_add_u32 m0, s22, s34
  s_add_u32 s33, s33, s19
  s_min_u32 s28, s49, 67
  s_lshl1_add_u32 s28, s17, s28
  v_mfma_f32_32x32x16_bf16 v[88:103], v[104:107], a[12:15], 0
  s_lshl_b32 s28, s28, 12
  s_add_u32 s28, s28, 243486720
  buffer_load_dword v249, v246, s[4:7], s28 offen sc1
  s_waitcnt lgkmcnt(2)
  v_mfma_f32_32x32x16_bf16 v[40:55], v[108:111], a[16:19], v[40:55]
  buffer_load_dwordx4 v0, s[4:7], s33 offen offset:0 sc1 lds
  v_mfma_f32_32x32x16_bf16 v[56:71], v[108:111], a[20:23], v[56:71]
  ds_read_b128 v[104:107], v3 offset:2048
  buffer_load_dwordx4 v0, s[4:7], s33 offen offset:1024 sc1 lds
  v_mfma_f32_32x32x16_bf16 v[72:87], v[108:111], a[24:27], v[72:87]
  buffer_load_dwordx4 v0, s[4:7], s33 offen offset:2048 sc1 lds
  v_mfma_f32_32x32x16_bf16 v[88:103], v[108:111], a[28:31], v[88:103]
  buffer_load_dwordx4 v0, s[4:7], s33 offen offset:3072 sc1 lds
  s_sub_u32 m0, m0, 8192
  s_sub_u32 s33, s33, 8192
  s_waitcnt lgkmcnt(2)
  v_mfma_f32_32x32x16_bf16 v[40:55], v[112:115], a[32:35], v[40:55]
  buffer_load_dwordx4 v0, s[4:7], s33 offen offset:0 sc1 lds
  v_mfma_f32_32x32x16_bf16 v[56:71], v[112:115], a[36:39], v[56:71]
  ds_read_b128 v[108:111], v3 offset:2560
  buffer_load_dwordx4 v0, s[4:7], s33 offen offset:1024 sc1 lds
  v_mfma_f32_32x32x16_bf16 v[72:87], v[112:115], a[40:43], v[72:87]
  buffer_load_dwordx4 v0, s[4:7], s33 offen offset:2048 sc1 lds
  v_mfma_f32_32x32x16_bf16 v[88:103], v[112:115], a[44:47], v[88:103]
  buffer_load_dwordx4 v0, s[4:7], s33 offen offset:3072 sc1 lds
  s_add_u32 m0, s23, s34
  s_add_u32 s32, s32, s18
  s_waitcnt lgkmcnt(2)
  v_mfma_f32_32x32x16_bf16 v[40:55], v[116:119], a[48:51], v[40:55]
  buffer_load_dwordx4 v0, s[4:7], s32 offen offset:0 sc1 lds
  v_mfma_f32_32x32x16_bf16 v[56:71], v[116:119], a[52:55], v[56:71]
  ds_read_b128 v[112:115], v3 offset:3072
  buffer_load_dwordx4 v0, s[4:7], s32 offen offset:1024 sc1 lds
  v_mfma_f32_32x32x16_bf16 v[72:87], v[116:119], a[56:59], v[72:87]
  buffer_load_dwordx4 v0, s[4:7], s32 offen offset:2048 sc1 lds
  v_mfma_f32_32x32x16_bf16 v[88:103], v[116:119], a[60:63], v[88:103]
  buffer_load_dwordx4 v0, s[4:7], s32 offen offset:3072 sc1 lds
  s_add_u32 m0, m0, 4096
  s_add_u32 s32, s32, 4096
  s_waitcnt lgkmcnt(2)
  v_mfma_f32_32x32x16_bf16 v[40:55], v[104:107], a[64:67], v[40:55]
  buffer_load_dwordx4 v0, s[4:7], s32 offen offset:0 sc1 lds
  v_mfma_f32_32x32x16_bf16 v[56:71], v[104:107], a[68:71], v[56:71]
  ds_read_b128 v[116:119], v3 offset:3584
  buffer_load_dwordx4 v0, s[4:7], s32 offen offset:1024 sc1 lds
  v_mfma_f32_32x32x16_bf16 v[72:87], v[104:107], a[72:75], v[72:87]
  buffer_load_dwordx4 v0, s[4:7], s32 offen offset:2048 sc1 lds
  v_mfma_f32_32x32x16_bf16 v[88:103], v[104:107], a[76:79], v[88:103]
  buffer_load_dwordx4 v0, s[4:7], s32 offen offset:3072 sc1 lds
  s_sub_u32 m0, m0, 20480
  s_sub_u32 s32, s32, 20480
  s_waitcnt lgkmcnt(2)
  v_mfma_f32_32x32x16_bf16 v[40:55], v[108:111], a[80:83], v[40:55]
  buffer_load_dwordx4 v0, s[4:7], s32 offen offset:0 sc1 lds
  v_mfma_f32_32x32x16_bf16 v[56:71], v[108:111], a[84:87], v[56:71]
  ds_read_b128 v[104:107], v3 offset:8192
  buffer_load_dwordx4 v0, s[4:7], s32 offen offset:1024 sc1 lds
  v_mfma_f32_32x32x16_bf16 v[72:87], v[108:111], a[88:91], v[72:87]
  buffer_load_dwordx4 v0, s[4:7], s32 offen offset:2048 sc1 lds
  v_mfma_f32_32x32x16_bf16 v[88:103], v[108:111], a[92:95], v[88:103]
  buffer_load_dwordx4 v0, s[4:7], s32 offen offset:3072 sc1 lds
  s_add_u32 m0, m0, 4096
  s_add_u32 s32, s32, 4096
  s_waitcnt lgkmcnt(2)
  v_mfma_f32_32x32x16_bf16 v[40:55], v[112:115], a[96:99], v[40:55]
  buffer_load_dwordx4 v0, s[4:7], s32 offen offset:0 sc1 lds
  v_mfma_f32_32x32x16_bf16 v[56:71], v[112:115], a[100:103], v[56:71]
  ds_read_b128 v[108:111], v3 offset:8704
  buffer_load_dwordx4 v0, s[4:7], s32 offen offset:1024 sc1 lds
  v_mfma_f32_32x32x16_bf16 v[72:87], v[112:115], a[104:107], v[72:87]
  buffer_load_dwordx4 v0, s[4:7], s32 offen offset:2048 sc1 lds
  v_mfma_f32_32x32x16_bf16 v[88:103], v[112:115], a[108:111], v[88:103]
  buffer_load_dwordx4 v0, s[4:7], s32 offen offset:3072 sc1 lds
  s_lshl_b32 s32, s88, 18
  s_mov_b32 m0, s40
  s_waitcnt lgkmcnt(2)
  v_mfma_f32_32x32x16_bf16 v[40:55], v[116:119], a[112:115], v[40:55]
  s_add_u32 s32, s32, s21
  buffer_load_dwordx4 v0, s[4:7], s32 offen offset:0 sc1 lds
  v_mfma_f32_32x32x16_bf16 v[56:71], v[116:119], a[116:119], v[56:71]
  ds_read_b128 v[112:115], v3 offset:9216
  buffer_load_dwordx4 v0, s[4:7], s32 offen offset:1024 sc1 lds
  v_mfma_f32_32x32x16_bf16 v[72:87], v[116:119], a[120:123], v[72:87]
  buffer_load_dwordx4 v0, s[4:7], s32 offen offset:2048 sc1 lds
  s_sub_u32 m0, m0, 8192
  s_sub_u32 s32, s32, 8192
  v_mfma_f32_32x32x16_bf16 v[88:103], v[116:119], a[124:127], v[88:103]
  buffer_load_dwordx4 v0, s[4:7], s32 offen offset:0 sc1 lds
  s_waitcnt lgkmcnt(2)
  v_mfma_f32_32x32x16_bf16 v[40:55], v[104:107], a[128:131], v[40:55]
  buffer_load_dwordx4 v0, s[4:7], s32 offen offset:1024 sc1 lds
  v_mfma_f32_32x32x16_bf16 v[56:71], v[104:107], a[132:135], v[56:71]
  ds_read_b128 v[116:119], v3 offset:9728
  buffer_load_dwordx4 v0, s[4:7], s32 offen offset:2048 sc1 lds
  v_mfma_f32_32x32x16_bf16 v[72:87], v[104:107], a[136:139], v[72:87]
  v_mfma_f32_32x32x16_bf16 v[88:103], v[104:107], a[140:143], v[88:103]
  s_waitcnt lgkmcnt(2)
  v_mfma_f32_32x32x16_bf16 v[40:55], v[108:111], a[144:147], v[40:55]
  v_mfma_f32_32x32x16_bf16 v[56:71], v[108:111], a[148:151], v[56:71]
  ds_read_b128 v[104:107], v3 offset:10240
  v_mfma_f32_32x32x16_bf16 v[72:87], v[108:111], a[152:155], v[72:87]
  v_mfma_f32_32x32x16_bf16 v[88:103], v[108:111], a[156:159], v[88:103]
  s_waitcnt lgkmcnt(2)
  v_mfma_f32_32x32x16_bf16 v[40:55], v[112:115], a[160:163], v[40:55]
  v_mfma_f32_32x32x16_bf16 v[56:71], v[112:115], a[164:167], v[56:71]
  ds_read_b128 v[108:111], v3 offset:10752
  v_mfma_f32_32x32x16_bf16 v[72:87], v[112:115], a[168:171], v[72:87]
  v_mfma_f32_32x32x16_bf16 v[88:103], v[112:115], a[172:175], v[88:103]
  s_waitcnt lgkmcnt(2)
  v_mfma_f32_32x32x16_bf16 v[40:55], v[116:119], a[176:179], v[40:55]
  v_mfma_f32_32x32x16_bf16 v[56:71], v[116:119], a[180:183], v[56:71]
  ds_read_b128 v[112:115], v3 offset:11264
  v_mfma_f32_32x32x16_bf16 v[72:87], v[116:119], a[184:187], v[72:87]
  v_mfma_f32_32x32x16_bf16 v[88:103], v[116:119], a[188:191], v[88:103]
  s_waitcnt lgkmcnt(2)
  v_mfma_f32_32x32x16_bf16 v[40:55], v[104:107], a[192:195], v[40:55]
  v_mfma_f32_32x32x16_bf16 v[56:71], v[104:107], a[196:199], v[56:71]
  ds_read_b128 v[116:119], v3 offset:11776
  s_waitcnt vmcnt(30)
  v_cmp_eq_u32 vcc, 0, v249
  v_max_u32_dpp v249, v249, v249 row_ror:8 row_mask:0xf bank_mask:0xf
  s_nop 0
  s_nop 0
  v_max_u32_dpp v249, v249, v249 row_ror:4 row_mask:0xf bank_mask:0xf
  v_mfma_f32_32x32x16_bf16 v[72:87], v[104:107], a[200:203], v[72:87]
  s_nop 0
  v_max_u32_dpp v249, v249, v249 row_ror:2 row_mask:0xf bank_mask:0xf
  s_nop 0
  s_nop 0
  v_max_u32_dpp v249, v249, v249 row_ror:1 row_mask:0xf bank_mask:0xf
  s_nop 0
  v_mov_b32 v248, v249
  v_mfma_f32_32x32x16_bf16 v[88:103], v[104:107], a[204:207], v[88:103]
  s_nop 0
  v_permlane16_swap_b32 v249, v248
  v_max_u32 v249, v249, v248
  v_mov_b32 v248, v249
  s_waitcnt lgkmcnt(2)
  v_mfma_f32_32x32x16_bf16 v[40:55], v[108:111], a[208:211], v[40:55]
  s_nop 0
  v_permlane32_swap_b32 v249, v248
  v_max_u32 v249, v249, v248
  s_cmp_eq_u64 vcc, 0
  s_cselect_b32 s28, 4, 0
  v_mfma_f32_32x32x16_bf16 v[56:71], v[108:111], a[212:215], v[56:71]
  s_lshl_b32 s26, s76, 1
  s_or_b32 s26, s26, s66
  s_or_b32 s26, s26, s28
  v_mov_b32 v248, s26
  ds_write_b64 v39, v[248:249]
  v_mfma_f32_32x32x16_bf16 v[72:87], v[108:111], a[216:219], v[72:87]
  v_mfma_f32_32x32x16_bf16 v[88:103], v[108:111], a[220:223], v[88:103]
  s_waitcnt lgkmcnt(2)
  v_mfma_f32_32x32x16_bf16 v[40:55], v[112:115], a[224:227], v[40:55]
  v_mfma_f32_32x32x16_bf16 v[56:71], v[112:115], a[228:231], v[56:71]
  v_mfma_f32_32x32x16_bf16 v[72:87], v[112:115], a[232:235], v[72:87]
  v_mfma_f32_32x32x16_bf16 v[88:103], v[112:115], a[236:239], v[88:103]
  s_waitcnt lgkmcnt(1)
  v_mfma_f32_32x32x16_bf16 v[40:55], v[116:119], a[240:243], v[40:55]
  v_mfma_f32_32x32x16_bf16 v[56:71], v[116:119], a[244:247], v[56:71]
  v_mfma_f32_32x32x16_bf16 v[72:87], v[116:119], a[248:251], v[72:87]
  v_mfma_f32_32x32x16_bf16 v[88:103], v[116:119], a[252:255], v[88:103]
  s_nop 3
  s_nop 0
  s_nop 3
  s_nop 0
  v_cvt_pk_bf16_f32 v212, v40, v56
  s_nop 0
  v_cvt_pk_bf16_f32 v213, v72, v88
  v_cvt_pk_bf16_f32 v214, v41, v57
  v_cvt_pk_bf16_f32 v215, v73, v89
  v_cvt_pk_bf16_f32 v216, v42, v58
  v_cvt_pk_bf16_f32 v217, v74, v90
  v_cvt_pk_bf16_f32 v218, v43, v59
  v_cvt_pk_bf16_f32 v219, v75, v91
  v_permlane16_swap_b32 v212, v214
  v_permlane16_swap_b32 v213, v215
  s_add_u32 s78, s86, 0
  v_bfi_b32 v212, v254, s42, v212
  buffer_store_dwordx4 v[212:215], v4, s[4:7], s78 offen sc1
  v_cvt_pk_bf16_f32 v220, v44, v60
  v_cvt_pk_bf16_f32 v221, v76, v92
  v_cvt_pk_bf16_f32 v222, v45, v61
  v_cvt_pk_bf16_f32 v223, v77, v93
  v_permlane16_swap_b32 v216, v218
  v_permlane16_swap_b32 v217, v219
  s_add_u32 s78, s86, 32768
  v_bfi_b32 v216, v254, s42, v216
  buffer_store_dwordx4 v[216:219], v4, s[4:7], s78 offen sc1
  v_cvt_pk_bf16_f32 v224, v46, v62
  v_cvt_pk_bf16_f32 v225, v78, v94
  v_cvt_pk_bf16_f32 v226, v47, v63
  v_cvt_pk_bf16_f32 v227, v79, v95
  v_permlane16_swap_b32 v220, v222
  v_permlane16_swap_b32 v221, v223
  s_add_u32 s78, s86, 131072
  v_bfi_b32 v220, v254, s42, v220
  buffer_store_dwordx4 v[220:223], v4, s[4:7], s78 offen sc1
  v_cvt_pk_bf16_f32 v228, v48, v64
  v_cvt_pk_bf16_f32 v229, v80, v96
  v_cvt_pk_bf16_f32 v230, v49, v65
  v_cvt_pk_bf16_f32 v231, v81, v97
  v_permlane16_swap_b32 v224, v226
  v_permlane16_swap_b32 v225, v227
  s_add_u32 s78, s86, 163840
  v_bfi_b32 v224, v254, s42, v224
  buffer_store_dwordx4 v[224:227], v4, s[4:7], s78 offen sc1
  v_cvt_pk_bf16_f32 v232, v50, v66
  v_cvt_pk_bf16_f32 v233, v82, v98
  v_cvt_pk_bf16_f32 v234, v51, v67
  v_cvt_pk_bf16_f32 v235, v83, v99
  v_permlane16_swap_b32 v228, v230
  v_permlane16_swap_b32 v229, v231
  s_add_u32 s78, s86, 262144
  v_bfi_b32 v228, v254, s42, v228
  buffer_store_dwordx4 v[228:231], v4, s[4:7], s78 offen sc1
  v_cvt_pk_bf16_f32 v236, v52, v68
  v_cvt_pk_bf16_f32 v237, v84, v100
  v_cvt_pk_bf16_f32 v238, v53, v69
  v_cvt_pk_bf16_f32 v239, v85, v101
  v_permlane16_swap_b32 v232, v234
  v_permlane16_swap_b32 v233, v235
  s_add_u32 s78, s86, 294912
  v_bfi_b32 v232, v254, s42, v232
  buffer_store_dwordx4 v[232:235], v4, s[4:7], s78 offen sc1
  v_cvt_pk_bf16_f32 v240, v54, v70
  v_cvt_pk_bf16_f32 v241, v86, v102
  v_cvt_pk_bf16_f32 v242, v55, v71
  v_cvt_pk_bf16_f32 v243, v87, v103
  v_permlane16_swap_b32 v236, v238
  v_permlane16_swap_b32 v237, v239
  s_add_u32 s78, s86, 393216
  v_bfi_b32 v236, v254, s42, v236
  buffer_store_dwordx4 v[236:239], v4, s[4:7], s78 offen sc1
  v_permlane16_swap_b32 v240, v242
  v_permlane16_swap_b32 v241, v243
  s_add_u32 s78, s86, 425984
  v_bfi_b32 v240, v254, s42, v240
  buffer_store_dwordx4 v[240:243], v4, s[4:7], s78 offen sc1
  s_waitcnt vmcnt(8)
  s_branch o_we_152
o_wr0_149:
  s_waitcnt lgkmcnt(0)
  s_barrier
  ds_read_b128 v[104:107], v3 offset:0
  ds_read_b128 v[108:111], v3 offset:512
  ds_read_b128 v[112:115], v3 offset:1024
  s_waitcnt lgkmcnt(2)
  v_mfma_f32_32x32x16_bf16 v[40:55], v[104:107], a[0:3], 0
  v_mfma_f32_32x32x16_bf16 v[56:71], v[104:107], a[4:7], 0
  ds_read_b128 v[116:119], v3 offset:1536
  v_mfma_f32_32x32x16_bf16 v[72:87], v[104:107], a[8:11], 0
  v_mfma_f32_32x32x16_bf16 v[88:103], v[104:107], a[12:15], 0
  s_waitcnt lgkmcnt(2)
  v_mfma_f32_32x32x16_bf16 v[40:55], v[108:111], a[16:19], v[40:55]
  v_mfma_f32_32x32x16_bf16 v[56:71], v[108:111], a[20:23], v[56:71]
  ds_read_b128 v[104:107], v3 offset:2048
  v_mfma_f32_32x32x16_bf16 v[72:87], v[108:111], a[24:27], v[72:87]
  v_mfma_f32_32x32x16_bf16 v[88:103], v[108:111], a[28:31], v[88:103]
  s_waitcnt lgkmcnt(2)
  v_mfma_f32_32x32x16_bf16 v[40:55], v[112:115], a[32:35], v[40:55]
  v_mfma_f32_32x32x16_bf16 v[56:71], v[112:115], a[36:39], v[56:71]
  ds_read_b128 v[108:111], v3 offset:2560
  v_mfma_f32_32x32x16_bf16 v[72:87], v[112:115], a[40:43], v[72:87]
  v_mfma_f32_32x32x16_bf16 v[88:103], v[112:115], a[44:47], v[88:103]
  s_waitcnt lgkmcnt(2)
  v_mfma_f32_32x32x16_bf16 v[40:55], v[116:119], a[48:51], v[40:55]
  v_mfma_f32_32x32x16_bf16 v[56:71], v[116:119], a[52:55], v[56:71]
  ds_read_b128 v[112:115], v3 offset:3072
  v_mfma_f32_32x32x16_bf16 v[72:87], v[116:119], a[56:59], v[72:87]
  v_mfma_f32_32x32x16_bf16 v[88:103], v[116:119], a[60:63], v[88:103]
  s_waitcnt lgkmcnt(2)
  v_mfma_f32_32x32x16_bf16 v[40:55], v[104:107], a[64:67], v[40:55]
  v_mfma_f32_32x32x16_bf16 v[56:71], v[104:107], a[68:71], v[56:71]
  ds_read_b128 v[116:119], v3 offset:3584
  v_mfma_f32_32x32x16_bf16 v[72:87], v[104:107], a[72:75], v[72:87]
  v_mfma_f32_32x32x16_bf16 v[88:103], v[104:107], a[76:79], v[88:103]
  s_waitcnt lgkmcnt(2)
  v_mfma_f32_32x32x16_bf16 v[40:55], v[108:111], a[80:83], v[40:55]
  v_mfma_f32_32x32x16_bf16 v[56:71], v[108:111], a[84:87], v[56:71]
  ds_read_b128 v[104:107], v3 offset:8192
  v_mfma_f32_32x32x16_bf16 v[72:87], v[108:111], a[88:91], v[72:87]
  v_mfma_f32_32x32x16_bf16 v[88:103], v[108:111], a[92:95], v[88:103]
  s_waitcnt lgkmcnt(2)
  v_mfma_f32_32x32x16_bf16 v[40:55], v[112:115], a[96:99], v[40:55]
  v_mfma_f32_32x32x16_bf16 v[56:71], v[112:115], a[100:103], v[56:71]
  ds_read_b128 v[108:111], v3 offset:8704
  v_mfma_f32_32x32x16_bf16 v[72:87], v[112:115], a[104:107], v[72:87]
  v_mfma_f32_32x32x16_bf16 v[88:103], v[112:115], a[108:111], v[88:103]
  s_waitcnt lgkmcnt(2)
  v_mfma_f32_32x32x16_bf16 v[40:55], v[116:119], a[112:115], v[40:55]
  v_mfma_f32_32x32x16_bf16 v[56:71], v[116:119], a[116:119], v[56:71]
  ds_read_b128 v[112:115], v3 offset:9216
  v_mfma_f32_32x32x16_bf16 v[72:87], v[116:119], a[120:123], v[72:87]
  v_mfma_f32_32x32x16_bf16 v[88:103], v[116:119], a[124:127], v[88:103]
  s_waitcnt lgkmcnt(2)
  v_mfma_f32_32x32x16_bf16 v[40:55], v[104:107], a[128:131], v[40:55]
  v_mfma_f32_32x32x16_bf16 v[56:71], v[104:107], a[132:135], v[56:71]
  ds_read_b128 v[116:119], v3 offset:9728
  v_mfma_f32_32x32x16_bf16 v[72:87], v[104:107], a[136:139], v[72:87]
  v_mfma_f32_32x32x16_bf16 v[88:103], v[104:107], a[140:143], v[88:103]
  s_waitcnt lgkmcnt(2)
  v_mfma_f32_32x32x16_bf16 v[40:55], v[108:111], a[144:147], v[40:55]
  v_mfma_f32_32x32x16_bf16 v[56:71], v[108:111], a[148:151], v[56:71]
  ds_read_b128 v[104:107], v3 offset:10240
  v_mfma_f32_32x32x16_bf16 v[72:87], v[108:111], a[152:155], v[72:87]
  v_mfma_f32_32x32x16_bf16 v[88:103], v[108:111], a[156:159], v[88:103]
  s_waitcnt lgkmcnt(2)
  v_mfma_f32_32x32x16_bf16 v[40:55], v[112:115], a[160:163], v[40:55]
  v_mfma_f32_32x32x16_bf16 v[56:71], v[112:115], a[164:167], v[56:71]
  ds_read_b128 v[108:111], v3 offset:10752
  v_mfma_f32_32x32x16_bf16 v[72:87], v[112:115], a[168:171], v[72:87]
  v_mfma_f32_32x32x16_bf16 v[88:103], v[112:115], a[172:175], v[88:103]
  s_waitcnt lgkmcnt(2)
  v_mfma_f32_32x32x16_bf16 v[40:55], v[116:119], a[176:179], v[40:55]
  v_mfma_f32_32x32x16_bf16 v[56:71], v[116:119], a[180:183], v[56:71]
  ds_read_b128 v[112:115], v3 offset:11264
  v_mfma_f32_32x32x16_bf16 v[72:87], v[116:119], a[184:187], v[72:87]
  v_mfma_f32_32x32x16_bf16 v[88:103], v[116:119], a[188:191], v[88:103]
  s_waitcnt lgkmcnt(2)
  v_mfma_f32_32x32x16_bf16 v[40:55], v[104:107], a[192:195], v[40:55]
  v_mfma_f32_32x32x16_bf16 v[56:71], v[104:107], a[196:199], v[56:71]
  ds_read_b128 v[116:119], v3 offset:11776
  v_mfma_f32_32x32x16_bf16 v[72:87], v[104:107], a[200:203], v[72:87]
  v_mfma_f32_32x32x16_bf16 v[88:103], v[104:107], a[204:207], v[88:103]
  s_waitcnt lgkmcnt(2)
  v_mfma_f32_32x32x16_bf16 v[40:55], v[108:111], a[208:211], v[40:55]
  v_mfma_f32_32x32x16_bf16 v[56:71], v[108:111], a[212:215], v[56:71]
  v_mfma_f32_32x32x16_bf16 v[72:87], v[108:111], a[216:219], v[72:87]
  v_mfma_f32_32x32x16_bf16 v[88:103], v[108:111], a[220:223], v[88:103]
  s_waitcnt lgkmcnt(1)
  v_mfma_f32_32x32x16_bf16 v[40:55], v[112:115], a[224:227], v[40:55]
  v_mfma_f32_32x32x16_bf16 v[56:71], v[112:115], a[228:231], v[56:71]
  v_mfma_f32_32x32x16_bf16 v[72:87], v[112:115], a[232:235], v[72:87]
  v_mfma_f32_32x32x16_bf16 v[88:103], v[112:115], a[236:239], v[88:103]
  s_waitcnt lgkmcnt(0)
  v_mfma_f32_32x32x16_bf16 v[40:55], v[116:119], a[240:243], v[40:55]
  v_mfma_f32_32x32x16_bf16 v[56:71], v[116:119], a[244:247], v[56:71]
  v_mfma_f32_32x32x16_bf16 v[72:87], v[116:119], a[248:251], v[72:87]
  v_mfma_f32_32x32x16_bf16 v[88:103], v[116:119], a[252:255], v[88:103]
  s_nop 3
  s_nop 0
  s_nop 3
  s_nop 0
  v_cvt_pk_bf16_f32 v212, v40, v56
  s_nop 0
  v_cvt_pk_bf16_f32 v213, v72, v88
  v_cvt_pk_bf16_f32 v214, v41, v57
  v_cvt_pk_bf16_f32 v215, v73, v89
  v_cvt_pk_bf16_f32 v216, v42, v58
  v_cvt_pk_bf16_f32 v217, v74, v90
  v_cvt_pk_bf16_f32 v218, v43, v59
  v_cvt_pk_bf16_f32 v219, v75, v91
  v_permlane16_swap_b32 v212, v214
  v_permlane16_swap_b32 v213, v215
  s_add_u32 s78, s86, 0
  v_bfi_b32 v212, v254, s42, v212
  buffer_store_dwordx4 v[212:215], v4, s[4:7], s78 offen sc1
  v_cvt_pk_bf16_f32 v220, v44, v60
  v_cvt_pk_bf16_f32 v221, v76, v92
  v_cvt_pk_bf16_f32 v222, v45, v61
  v_cvt_pk_bf16_f32 v223, v77, v93
  v_permlane16_swap_b32 v216, v218
  v_permlane16_swap_b32 v217, v219
  s_add_u32 s78, s86, 32768
  v_bfi_b32 v216, v254, s42, v216
  buffer_store_dwordx4 v[216:219], v4, s[4:7], s78 offen sc1
  v_cvt_pk_bf16_f32 v224, v46, v62
  v_cvt_pk_bf16_f32 v225, v78, v94
  v_cvt_pk_bf16_f32 v226, v47, v63
  v_cvt_pk_bf16_f32 v227, v79, v95
  v_permlane16_swap_b32 v220, v222
  v_permlane16_swap_b32 v221, v223
  s_add_u32 s78, s86, 131072
  v_bfi_b32 v220, v254, s42, v220
  buffer_store_dwordx4 v[220:223], v4, s[4:7], s78 offen sc1
  v_cvt_pk_bf16_f32 v228, v48, v64
  v_cvt_pk_bf16_f32 v229, v80, v96
  v_cvt_pk_bf16_f32 v230, v49, v65
  v_cvt_pk_bf16_f32 v231, v81, v97
  v_permlane16_swap_b32 v224, v226
  v_permlane16_swap_b32 v225, v227
  s_add_u32 s78, s86, 163840
  v_bfi_b32 v224, v254, s42, v224
  buffer_store_dwordx4 v[224:227], v4, s[4:7], s78 offen sc1
  v_cvt_pk_bf16_f32 v232, v50, v66
  v_cvt_pk_bf16_f32 v233, v82, v98
  v_cvt_pk_bf16_f32 v234, v51, v67
  v_cvt_pk_bf16_f32 v235, v83, v99
  v_permlane16_swap_b32 v228, v230
  v_permlane16_swap_b32 v229, v231
  s_add_u32 s78, s86, 262144
  v_bfi_b32 v228, v254, s42, v228
  buffer_store_dwordx4 v[228:231], v4, s[4:7], s78 offen sc1
  v_cvt_pk_bf16_f32 v236, v52, v68
  v_cvt_pk_bf16_f32 v237, v84, v100
  v_cvt_pk_bf16_f32 v238, v53, v69
  v_cvt_pk_bf16_f32 v239, v85, v101
  v_permlane16_swap_b32 v232, v234
  v_permlane16_swap_b32 v233, v235
  s_add_u32 s78, s86, 294912
  v_bfi_b32 v232, v254, s42, v232
  buffer_store_dwordx4 v[232:235], v4, s[4:7], s78 offen sc1
  v_cvt_pk_bf16_f32 v240, v54, v70
  v_cvt_pk_bf16_f32 v241, v86, v102
  v_cvt_pk_bf16_f32 v242, v55, v71
  v_cvt_pk_bf16_f32 v243, v87, v103
  v_permlane16_swap_b32 v236, v238
  v_permlane16_swap_b32 v237, v239
  s_add_u32 s78, s86, 393216
  v_bfi_b32 v236, v254, s42, v236
  buffer_store_dwordx4 v[236:239], v4, s[4:7], s78 offen sc1
  v_permlane16_swap_b32 v240, v242
  v_permlane16_swap_b32 v241, v243
  s_add_u32 s78, s86, 425984
  v_bfi_b32 v240, v254, s42, v240
  buffer_store_dwordx4 v[240:243], v4, s[4:7], s78 offen sc1
  s_branch o_we_152
o_wr1_150:
  s_nop 0
  s_nop 1
  s_nop 1
  v_mul_f32 v112, s24, v112
  v_mul_f32 v113, s24, v113
  v_exp_f32 v64, v112
  v_exp_f32 v65, v113
  v_max_f32 v116, v111, v116
  v_max3_f32 v116, v112, v113, v116
  v_add_f32 v117, v117, v64
  v_add_f32 v118, v118, v65
  v_add_f32 v117, v117, v118
  s_mov_b32 s28, 0x21800000
  v_mov_b32 v118, v117
  s_nop 1
  v_permlane16_swap_b32 v117, v118
  v_add_f32 v117, v117, v118
  v_mov_b32 v118, v117
  s_nop 0
  s_nop 0
  v_permlane32_swap_b32 v117, v118
  v_add_f32 v117, v117, v118
  s_mov_b32 s67, 0
  s_mov_b64 vcc, 0
  s_waitcnt vmcnt(2)
o_pl_157:
  v_and_b32 v7, 1, v7
  v_cmp_ne_u32 vcc, s96, v7
  s_cbranch_vccz o_pk_158
  buffer_load_dword v7, v255, s[4:7], s97 offen sc1
  s_add_u32 s67, s67, 1
  s_cmp_gt_u32 s67, 1048576
  s_cbranch_scc1 L_end
  s_waitcnt vmcnt(0)
  s_branch o_pl_157
o_pk_158:
  s_lshl_b32 s94, s43, 14
  s_add_u32 s94, s94, s95
  buffer_load_dwordx4 v[120:123], v5, s[4:7], s94 offen offset:0 sc1
  v_cmp_lt_f32 vcc, 0x42700000, v116
  v_cmp_gt_f32 s[30:31], s28, v117
  v_rcp_f32 v117, v117
  buffer_load_dwordx4 v[124:127], v5, s[4:7], s94 offen offset:256 sc1
  s_or_b64 vcc, vcc, s[30:31]
  s_cbranch_vccnz o_fb_155
o_fbr_156:
  buffer_load_dwordx4 v[128:131], v5, s[4:7], s94 offen offset:512 sc1
  v_pk_mul_f32 v[56:57], v[56:57], v[116:117] op_sel:[0,1] op_sel_hi:[1,1]
  v_pk_mul_f32 v[58:59], v[58:59], v[116:117] op_sel:[0,1] op_sel_hi:[1,1]
  v_pk_mul_f32 v[60:61], v[60:61], v[116:117] op_sel:[0,1] op_sel_hi:[1,1]
  v_pk_mul_f32 v[62:63], v[62:63], v[116:117] op_sel:[0,1] op_sel_hi:[1,1]
  v_pk_mul_f32 v[64:65], v[64:65], v[116:117] op_sel:[0,1] op_sel_hi:[1,1]
  buffer_load_dwordx4 v[132:135], v5, s[4:7], s94 offen offset:768 sc1
  v_cvt_pk_bf16_f32 v116, v56, v57
  v_cvt_pk_bf16_f32 v117, v58, v59
  v_cvt_pk_bf16_f32 v118, v60, v61
  v_cvt_pk_bf16_f32 v119, v62, v63
  s_waitcnt lgkmcnt(0)
  s_nop 0
  v_mfma_f32_16x16x32_bf16 v[72:75], v[152:155], v[116:119], 0
  s_add_u32 s62, s62, 1
  v_cvt_pk_bf16_f32 v197, v64, v65
  v_cvt_pk_bf16_f32 v198, v64, v65
  v_mfma_f32_16x16x32_bf16 v[76:79], v[156:159], v[116:119], 0
  s_add_u32 s94, s94, 4096
  buffer_load_dwordx4 v[136:139], v5, s[4:7], s94 offen offset:0 sc1
  s_xor_b32 s86, s86, 524288
  v_mfma_f32_16x16x32_bf16 v[80:83], v[160:163], v[116:119], 0
  s_bfe_u32 s42, s62, 0x10001
  v_mfma_f32_16x16x32_bf16 v[84:87], v[164:167], v[116:119], 0
  buffer_load_dwordx4 v[140:143], v5, s[4:7], s94 offen offset:256 sc1
  v_mfma_f32_16x16x32_bf16 v[88:91], v[168:171], v[116:119], 0
  v_mfma_f32_16x16x32_bf16 v[92:95], v[172:175], v[116:119], 0
  buffer_load_dwordx4 v[144:147], v5, s[4:7], s94 offen offset:512 sc1
  v_mfma_f32_16x16x32_bf16 v[96:99], v[176:179], v[116:119], 0
  v_mfma_f32_16x16x32_bf16 v[100:103], v[180:183], v[116:119], 0
  buffer_load_dwordx4 v[148:151], v5, s[4:7], s94 offen offset:768 sc1
  v_mfma_f32_16x16x16_bf16 v[72:75], v[200:201], v[198:199], v[72:75]
  s_nop 1
  v_mfma_f32_16x16x16_bf16 v[76:79], v[200:201], v[196:197], v[76:79]
  s_add_u32 s94, s94, 4096
  buffer_load_dwordx4 v[152:155], v5, s[4:7], s94 offen offset:0 sc1
  v_mfma_f32_16x16x16_bf16 v[80:83], v[202:203], v[198:199], v[80:83]
  s_nop 1
  v_mfma_f32_16x16x16_bf16 v[84:87], v[202:203], v[196:197], v[84:87]
  buffer_load_dwordx4 v[156:159], v5, s[4:7], s94 offen offset:256 sc1
  v_mfma_f32_16x16x16_bf16 v[88:91], v[204:205], v[198:199], v[88:91]
  s_nop 0
  v_cvt_pk_bf16_f32 v40, v72, v73
  v_cvt_pk_bf16_f32 v41, v74, v75
  v_mfma_f32_16x16x16_bf16 v[92:95], v[204:205], v[196:197], v[92:95]
  buffer_load_dwordx4 v[160:163], v5, s[4:7], s94 offen offset:512 sc1
  v_cvt_pk_bf16_f32 v42, v76, v77
  v_cvt_pk_bf16_f32 v43, v78, v79
  v_mfma_f32_16x16x16_bf16 v[96:99], v[206:207], v[198:199], v[96:99]
  s_nop 0
  ds_write_b128 v6, v[40:43] offset:0
  v_cvt_pk_bf16_f32 v44, v80, v81
  v_mfma_f32_16x16x16_bf16 v[100:103], v[206:207], v[196:197], v[100:103]
  buffer_load_dwordx4 v[164:167], v5, s[4:7], s94 offen offset:768 sc1
  v_cvt_pk_bf16_f32 v45, v82, v83
  v_cvt_pk_bf16_f32 v46, v84, v85
  v_cvt_pk_bf16_f32 v47, v86, v87
  ds_write_b128 v6, v[44:47] offset:1024
  v_cvt_pk_bf16_f32 v48, v88, v89
  v_cvt_pk_bf16_f32 v49, v90, v91
  v_cvt_pk_bf16_f32 v50, v92, v93
  v_cvt_pk_bf16_f32 v51, v94, v95
  s_add_u32 s94, s94, 4096
  buffer_load_dwordx4 v[168:171], v5, s[4:7], s94 offen offset:0 sc1
  ds_write_b128 v6, v[48:51] offset:2048
  v_cvt_pk_bf16_f32 v52, v96, v97
  v_cvt_pk_bf16_f32 v53, v98, v99
  v_cvt_pk_bf16_f32 v54, v100, v101
  v_cvt_pk_bf16_f32 v55, v102, v103
  ds_write_b128 v6, v[52:55] offset:3072
  buffer_load_dwordx4 v[172:175], v5, s[4:7], s94 offen offset:256 sc1
  s_and_b32 s26, s65, 49152
  s_cbranch_scc1 o_wr2_151
  s_waitcnt lgkmcnt(0)
  s_barrier
  ds_read_b128 v[104:107], v3 offset:0
  ds_read_b128 v[108:111], v3 offset:512
  ds_read_b128 v[112:115], v3 offset:1024
  buffer_load_dwordx4 v[176:179], v5, s[4:7], s94 offen offset:512 sc1
  buffer_load_dwordx4 v[180:183], v5, s[4:7], s94 offen offset:768 sc1
  s_waitcnt lgkmcnt(2)
  v_mfma_f32_32x32x16_bf16 v[40:55], v[104:107], a[0:3], 0
  s_and_b32 s91, s65, 63
  s_lshl_b32 s90, s91, 5
  s_add_u32 s90, s90, s43
  s_lshl_b32 s91, s90, 10
  buffer_load_dwordx4 v[184:187], v0, s[72:75], s91 offen
  v_mfma_f32_32x32x16_bf16 v[56:71], v[104:107], a[4:7], 0
  ds_read_b128 v[116:119], v3 offset:1536
  s_mov_b64 exec, 1
  buffer_store_dword v38, off, s[4:7], s84 sc1
  s_mov_b64 exec, -1
  s_mov_b32 s84, 268435456
  v_mfma_f32_32x32x16_bf16 v[72:87], v[104:107], a[8:11], 0
  v_mfma_f32_32x32x16_bf16 v[88:103], v[104:107], a[12:15], 0
  s_waitcnt vmcnt(14)
  v_xor_b32 v7, s96, v120
  v_bitop3_b32 v7, v7, v124, s96 bitop3:0xf6
  v_bitop3_b32 v7, v7, v128, s96 bitop3:0xf6
  v_bitop3_b32 v7, v7, v132, s96 bitop3:0xf6
  s_waitcnt lgkmcnt(2)
  v_mfma_f32_32x32x16_bf16 v[40:55], v[108:111], a[16:19], v[40:55]
  s_waitcnt vmcnt(10)
  v_bitop3_b32 v7, v7, v136, s96 bitop3:0xf6
  v_bitop3_b32 v7, v7, v140, s96 bitop3:0xf6
  v_bitop3_b32 v7, v7, v144, s96 bitop3:0xf6
  v_bitop3_b32 v7, v7, v148, s96 bitop3:0xf6
  s_waitcnt vmcnt(6)
  v_mfma_f32_32x32x16_bf16 v[56:71], v[108:111], a[20:23], v[56:71]
  ds_read_b128 v[104:107], v3 offset:2048
  v_bitop3_b32 v7, v7, v152, s96 bitop3:0xf6
  v_bitop3_b32 v7, v7, v156, s96 bitop3:0xf6
  v_bitop3_b32 v7, v7, v160, s96 bitop3:0xf6
  v_bitop3_b32 v7, v7, v164, s96 bitop3:0xf6
  s_waitcnt vmcnt(2)
  v_mfma_f32_32x32x16_bf16 v[72:87], v[108:111], a[24:27], v[72:87]
  v_bitop3_b32 v7, v7, v168, s96 bitop3:0xf6
  v_bitop3_b32 v7, v7, v172, s96 bitop3:0xf6
  v_bitop3_b32 v7, v7, v176, s96 bitop3:0xf6
  v_bitop3_b32 v7, v7, v180, s96 bitop3:0xf6
  v_and_b32 v7, v254, v7
  v_cmp_ne_u32 vcc, 0, v7
  s_cbranch_vccnz o_rt_159
o_bk_160:
  v_mfma_f32_32x32x16_bf16 v[88:103], v[108:111], a[28:31], v[88:103]
  v_mfma_f32_16x16x32_bf16 v[188:191], v[16:19], v[120:123], 0
  v_mfma_f32_16x16x32_bf16 v[192:195], v[16:19], v[124:127], 0
  v_mfma_f32_16x16x32_bf16 v[188:191], v[20:23], v[128:131], v[188:191]
  s_waitcnt lgkmcnt(2)
  v_mfma_f32_32x32x16_bf16 v[40:55], v[112:115], a[32:35], v[40:55]
  v_mfma_f32_16x16x32_bf16 v[192:195], v[20:23], v[132:135], v[192:195]
  v_mfma_f32_16x16x32_bf16 v[188:191], v[16:19], v[136:139], v[188:191]
  v_mfma_f32_16x16x32_bf16 v[192:195], v[16:19], v[140:143], v[192:195]
  v_mfma_f32_32x32x16_bf16 v[56:71], v[112:115], a[36:39], v[56:71]
  ds_read_b128 v[108:111], v3 offset:2560
  v_mfma_f32_16x16x32_bf16 v[188:191], v[20:23], v[144:147], v[188:191]
  v_mfma_f32_16x16x32_bf16 v[192:195], v[20:23], v[148:151], v[192:195]
  v_mfma_f32_16x16x32_bf16 v[188:191], v[16:19], v[152:155], v[188:191]
  v_mfma_f32_32x32x16_bf16 v[72:87], v[112:115], a[40:43], v[72:87]
  v_mfma_f32_16x16x32_bf16 v[192:195], v[16:19], v[156:159], v[192:195]
  v_mfma_f32_16x16x32_bf16 v[188:191], v[20:23], v[160:163], v[188:191]
  v_mfma_f32_16x16x32_bf16 v[192:195], v[20:23], v[164:167], v[192:195]
  v_mfma_f32_32x32x16_bf16 v[88:103], v[112:115], a[44:47], v[88:103]
  v_mfma_f32_16x16x32_bf16 v[188:191], v[16:19], v[168:171], v[188:191]
  v_mfma_f32_16x16x32_bf16 v[192:195], v[16:19], v[172:175], v[192:195]
  v_mfma_f32_16x16x32_bf16 v[188:191], v[20:23], v[176:179], v[188:191]
  s_waitcnt lgkmcnt(2)
  v_mfma_f32_32x32x16_bf16 v[40:55], v[116:119], a[48:51], v[40:55]
  v_mfma_f32_16x16x32_bf16 v[192:195], v[20:23], v[180:183], v[192:195]
  s_bfe_u32 s92, s65, 131086
  s_lshl_b32 s92, s92, 21
  s_add_u32 s92, s92, s91
  s_add_u32 s93, s92, 27262976
  v_mfma_f32_32x32x16_bf16 v[56:71], v[116:119], a[52:55], v[56:71]
  ds_read_b128 v[112:115], v3 offset:3072
  s_add_u32 s92, s92, 20971520
  s_waitcnt vmcnt(1)
  v_lshlrev_b32 v196, 16, v184
  v_and_b32 v197, 0xffff0000, v184
  v_lshlrev_b32 v198, 16, v185
  v_mfma_f32_32x32x16_bf16 v[72:87], v[116:119], a[56:59], v[72:87]
  v_and_b32 v199, 0xffff0000, v185
  v_lshlrev_b32 v200, 16, v186
  v_and_b32 v201, 0xffff0000, v186
  v_lshlrev_b32 v202, 16, v187
  v_and_b32 v203, 0xffff0000, v187
  v_permlane16_swap_b32 v188, v192
  v_mfma_f32_32x32x16_bf16 v[88:103], v[116:119], a[60:63], v[88:103]
  v_permlane16_swap_b32 v189, v193
  v_permlane16_swap_b32 v190, v194
  v_permlane16_swap_b32 v191, v195
  s_waitcnt lgkmcnt(2)
  v_mfma_f32_32x32x16_bf16 v[40:55], v[104:107], a[64:67], v[40:55]
  v_cvt_pk_bf16_f32 v188, 0, v188
  v_cvt_pk_bf16_f32 v189, 0, v189
  v_cvt_pk_bf16_f32 v190, 0, v190
  v_cvt_pk_bf16_f32 v191, 0, v191
  v_cvt_pk_bf16_f32 v192, 0, v192
  v_cvt_pk_bf16_f32 v193, 0, v193
  v_mfma_f32_32x32x16_bf16 v[56:71], v[104:107], a[68:71], v[56:71]
  ds_read_b128 v[116:119], v3 offset:3584
  v_cvt_pk_bf16_f32 v194, 0, v194
  v_cvt_pk_bf16_f32 v195, 0, v195
  v_add_f32 v196, v196, v188
  v_add_f32 v197, v197, v189
  v_add_f32 v198, v198, v190
  v_mfma_f32_32x32x16_bf16 v[72:87], v[104:107], a[72:75], v[72:87]
  v_add_f32 v199, v199, v191
  v_add_f32 v200, v200, v192
  v_add_f32 v201, v201, v193
  v_add_f32 v202, v202, v194
  v_add_f32 v203, v203, v195
  v_cvt_pk_bf16_f32 v120, v196, v197
  v_mfma_f32_32x32x16_bf16 v[88:103], v[104:107], a[76:79], v[88:103]
  v_cvt_pk_bf16_f32 v121, v198, v199
  v_cvt_pk_bf16_f32 v122, v200, v201
  v_cvt_pk_bf16_f32 v123, v202, v203
  v_lshlrev_b32 v196, 16, v120
  v_and_b32 v197, 0xffff0000, v120
  s_waitcnt lgkmcnt(2)
  v_mfma_f32_32x32x16_bf16 v[40:55], v[108:111], a[80:83], v[40:55]
  v_lshlrev_b32 v198, 16, v121
  v_and_b32 v199, 0xffff0000, v121
  v_lshlrev_b32 v200, 16, v122
  v_and_b32 v201, 0xffff0000, v122
  v_lshlrev_b32 v202, 16, v123
  v_and_b32 v203, 0xffff0000, v123
  v_mfma_f32_32x32x16_bf16 v[56:71], v[108:111], a[84:87], v[56:71]
  ds_read_b128 v[104:107], v3 offset:8192
  buffer_store_dwordx4 v[120:123], v0, s[4:7], s92 offen sc1
  v_add_f32 v136, v196, v197
  v_mul_f32 v137, v196, v196
  v_mfma_f32_32x32x16_bf16 v[72:87], v[108:111], a[88:91], v[72:87]
  v_add_f32 v138, v198, v199
  v_mul_f32 v139, v197, v197
  v_fmac_f32 v137, v198, v198
  v_fmac_f32 v139, v199, v199
  v_add_f32 v136, v136, v200
  v_fmac_f32 v137, v200, v200
  v_mfma_f32_32x32x16_bf16 v[88:103], v[108:111], a[92:95], v[88:103]
  v_add_f32 v138, v138, v201
  v_fmac_f32 v139, v201, v201
  v_add_f32 v136, v136, v202
  v_fmac_f32 v137, v202, v202
  v_add_f32 v138, v138, v203
  s_waitcnt lgkmcnt(2)
  v_mfma_f32_32x32x16_bf16 v[40:55], v[112:115], a[96:99], v[40:55]
  v_fmac_f32 v139, v203, v203
  v_add_f32 v136, v136, v138
  v_add_f32 v137, v137, v139
  s_nop 0
  v_add_f32_dpp v136, v136, v136 row_ror:8 row_mask:0xf bank_mask:0xf
  v_add_f32_dpp v137, v137, v137 row_ror:8 row_mask:0xf bank_mask:0xf
  s_nop 0
  v_add_f32_dpp v136, v136, v136 row_ror:4 row_mask:0xf bank_mask:0xf
  v_mfma_f32_32x32x16_bf16 v[56:71], v[112:115], a[100:103], v[56:71]
  ds_read_b128 v[108:111], v3 offset:8704
  v_add_f32_dpp v137, v137, v137 row_ror:4 row_mask:0xf bank_mask:0xf
  v_add_f32_dpp v136, v136, v136 row_ror:2 row_mask:0xf bank_mask:0xf
  s_nop 0
  v_add_f32_dpp v137, v137, v137 row_ror:2 row_mask:0xf bank_mask:0xf
  v_add_f32_dpp v136, v136, v136 row_ror:1 row_mask:0xf bank_mask:0xf
  s_nop 0
  v_add_f32_dpp v137, v137, v137 row_ror:1 row_mask:0xf bank_mask:0xf
  v_mfma_f32_32x32x16_bf16 v[72:87], v[112:115], a[104:107], v[72:87]
  v_mov_b32 v140, v136
  v_mov_b32 v141, v137
  s_nop 0
  v_permlane16_swap_b32 v136, v140
  v_permlane16_swap_b32 v137, v141
  v_mfma_f32_32x32x16_bf16 v[88:103], v[112:115], a[108:111], v[88:103]
  v_add_f32 v136, v136, v140
  v_add_f32 v137, v137, v141
  v_mov_b32 v140, v136
  v_mov_b32 v141, v137
  s_nop 0
  v_permlane32_swap_b32 v136, v140
  s_waitcnt lgkmcnt(2)
  v_mfma_f32_32x32x16_bf16 v[40:55], v[116:119], a[112:115], v[40:55]
  v_permlane32_swap_b32 v137, v141
  v_add_f32 v136, v136, v140
  v_add_f32 v137, v137, v141
  v_mul_f32 v136, 0x3b000000, v136
  v_mul_f32 v137, 0x3b000000, v137
  v_mfma_f32_32x32x16_bf16 v[56:71], v[116:119], a[116:119], v[56:71]
  ds_read_b128 v[112:115], v3 offset:9216
  v_fma_f32 v137, -v136, v136, v137
  v_cvt_pk_bf16_f32 v136, 0, v136
  v_max_f32 v137, 0, v137
  v_sub_f32 v140, v196, v136
  v_sub_f32 v141, v197, v136
  v_mfma_f32_32x32x16_bf16 v[72:87], v[116:119], a[120:123], v[72:87]
  v_cvt_pk_bf16_f32 v137, 0, v137
  v_sub_f32 v142, v198, v136
  v_sub_f32 v143, v199, v136
  v_add_f32 v137, 0x3727c5ac, v137
  v_sub_f32 v144, v200, v136
  v_sub_f32 v145, v201, v136
  v_mfma_f32_32x32x16_bf16 v[88:103], v[116:119], a[124:127], v[88:103]
  v_cvt_pk_bf16_f32 v137, 0, v137
  v_sub_f32 v146, v202, v136
  v_sub_f32 v147, v203, v136
  v_sqrt_f32 v137, v137
  s_waitcnt lgkmcnt(2)
  v_mfma_f32_32x32x16_bf16 v[40:55], v[104:107], a[128:131], v[40:55]
  v_cvt_pk_bf16_f32 v140, 0, v140
  v_cvt_pk_bf16_f32 v141, 0, v141
  v_cvt_pk_bf16_f32 v137, 0, v137
  v_cvt_pk_bf16_f32 v142, 0, v142
  v_cvt_pk_bf16_f32 v143, 0, v143
  v_rcp_f32 v137, v137
  v_mfma_f32_32x32x16_bf16 v[56:71], v[104:107], a[132:135], v[56:71]
  ds_read_b128 v[116:119], v3 offset:9728
  v_cvt_pk_bf16_f32 v144, 0, v144
  v_cvt_pk_bf16_f32 v145, 0, v145
  v_cvt_pk_bf16_f32 v146, 0, v146
  v_cvt_pk_bf16_f32 v147, 0, v147
  v_mul_f32 v140, v140, v137
  v_mfma_f32_32x32x16_bf16 v[72:87], v[104:107], a[136:139], v[72:87]
  v_mul_f32 v141, v141, v137
  v_mul_f32 v142, v142, v137
  v_mul_f32 v143, v143, v137
  v_mul_f32 v144, v144, v137
  v_mul_f32 v145, v145, v137
  v_mul_f32 v146, v146, v137
  v_mfma_f32_32x32x16_bf16 v[88:103], v[104:107], a[140:143], v[88:103]
  v_mul_f32 v147, v147, v137
  v_cvt_pk_bf16_f32 v124, v140, v141
  v_cvt_pk_bf16_f32 v125, v142, v143
  v_cvt_pk_bf16_f32 v126, v144, v145
  v_cvt_pk_bf16_f32 v127, v146, v147
  s_waitcnt lgkmcnt(2)
  v_mfma_f32_32x32x16_bf16 v[40:55], v[108:111], a[144:147], v[40:55]
  v_lshlrev_b32 v204, 16, v124
  v_and_b32 v205, 0xffff0000, v124
  v_lshlrev_b32 v206, 16, v125
  v_and_b32 v207, 0xffff0000, v125
  v_lshlrev_b32 v208, 16, v126
  v_and_b32 v209, 0xffff0000, v126
  v_mfma_f32_32x32x16_bf16 v[56:71], v[108:111], a[148:151], v[56:71]
  ds_read_b128 v[104:107], v3 offset:10240
  v_lshlrev_b32 v210, 16, v127
  v_and_b32 v211, 0xffff0000, v127
  buffer_store_dwordx4 v[124:127], v0, s[4:7], s93 offen sc1
  v_mfma_f32_32x32x16_bf16 v[72:87], v[108:111], a[152:155], v[72:87]
  v_add_f32 v196, v196, v204
  v_add_f32 v197, v197, v205
  v_add_f32 v198, v198, v206
  v_add_f32 v199, v199, v207
  v_add_f32 v200, v200, v208
  v_add_f32 v201, v201, v209
  v_mfma_f32_32x32x16_bf16 v[88:103], v[108:111], a[156:159], v[88:103]
  v_add_f32 v202, v202, v210
  v_add_f32 v203, v203, v211
  v_cvt_pk_bf16_f32 v128, v196, v197
  v_cvt_pk_bf16_f32 v129, v198, v199
  v_cvt_pk_bf16_f32 v130, v200, v201
  s_waitcnt lgkmcnt(2)
  v_mfma_f32_32x32x16_bf16 v[40:55], v[112:115], a[160:163], v[40:55]
  v_cvt_pk_bf16_f32 v131, v202, v203
  v_mul_f32 v188, v204, v8
  v_mul_f32 v189, v205, v9
  v_fmac_f32 v188, v206, v10
  v_fmac_f32 v189, v207, v11
  v_fmac_f32 v188, v208, v12
  v_mfma_f32_32x32x16_bf16 v[56:71], v[112:115], a[164:167], v[56:71]
  ds_read_b128 v[108:111], v3 offset:10752
  v_fmac_f32 v189, v209, v13
  v_fmac_f32 v188, v210, v14
  v_fmac_f32 v189, v211, v15
  v_add_f32 v188, v188, v189
  s_add_u32 s92, s91, 10485760
  v_mfma_f32_32x32x16_bf16 v[72:87], v[112:115], a[168:171], v[72:87]
  s_add_u32 s93, s91, 8388608
  buffer_store_dwordx4 v[128:131], v0, s[4:7], s92 offen sc1
  v_lshlrev_b32 v196, 16, v128
  v_and_b32 v197, 0xffff0000, v128
  v_mfma_f32_32x32x16_bf16 v[88:103], v[112:115], a[172:175], v[88:103]
  v_lshlrev_b32 v198, 16, v129
  v_and_b32 v199, 0xffff0000, v129
  v_lshlrev_b32 v200, 16, v130
  v_and_b32 v201, 0xffff0000, v130
  v_lshlrev_b32 v202, 16, v131
  s_waitcnt lgkmcnt(2)
  v_mfma_f32_32x32x16_bf16 v[40:55], v[116:119], a[176:179], v[40:55]
  v_and_b32 v203, 0xffff0000, v131
  v_add_f32 v136, v196, v197
  v_mul_f32 v137, v196, v196
  v_add_f32 v138, v198, v199
  v_mul_f32 v139, v197, v197
  v_fmac_f32 v137, v198, v198
  v_mfma_f32_32x32x16_bf16 v[56:71], v[116:119], a[180:183], v[56:71]
  ds_read_b128 v[112:115], v3 offset:11264
  v_fmac_f32 v139, v199, v199
  v_add_f32 v136, v136, v200
  v_fmac_f32 v137, v200, v200
  v_add_f32 v138, v138, v201
  v_fmac_f32 v139, v201, v201
  v_mfma_f32_32x32x16_bf16 v[72:87], v[116:119], a[184:187], v[72:87]
  v_add_f32 v136, v136, v202
  v_fmac_f32 v137, v202, v202
  v_add_f32 v138, v138, v203
  v_fmac_f32 v139, v203, v203
  v_add_f32 v136, v136, v138
  v_add_f32 v137, v137, v139
  v_mfma_f32_32x32x16_bf16 v[88:103], v[116:119], a[188:191], v[88:103]
  v_add_f32_dpp v136, v136, v136 row_ror:8 row_mask:0xf bank_mask:0xf
  v_add_f32_dpp v137, v137, v137 row_ror:8 row_mask:0xf bank_mask:0xf
  v_add_f32_dpp v188, v188, v188 row_ror:8 row_mask:0xf bank_mask:0xf
  v_add_f32_dpp v136, v136, v136 row_ror:4 row_mask:0xf bank_mask:0xf
  v_add_f32_dpp v137, v137, v137 row_ror:4 row_mask:0xf bank_mask:0xf
  s_waitcnt lgkmcnt(2)
  v_mfma_f32_32x32x16_bf16 v[40:55], v[104:107], a[192:195], v[40:55]
  v_add_f32_dpp v188, v188, v188 row_ror:4 row_mask:0xf bank_mask:0xf
  v_add_f32_dpp v136, v136, v136 row_ror:2 row_mask:0xf bank_mask:0xf
  v_add_f32_dpp v137, v137, v137 row_ror:2 row_mask:0xf bank_mask:0xf
  v_add_f32_dpp v188, v188, v188 row_ror:2 row_mask:0xf bank_mask:0xf
  v_add_f32_dpp v136, v136, v136 row_ror:1 row_mask:0xf bank_mask:0xf
  v_add_f32_dpp v137, v137, v137 row_ror:1 row_mask:0xf bank_mask:0xf
  v_mfma_f32_32x32x16_bf16 v[56:71], v[104:107], a[196:199], v[56:71]
  ds_read_b128 v[116:119], v3 offset:11776
  v_add_f32_dpp v188, v188, v188 row_ror:1 row_mask:0xf bank_mask:0xf
  v_mov_b32 v140, v136
  v_mov_b32 v141, v137
  v_mov_b32 v142, v188
  v_permlane16_swap_b32 v136, v140
  v_mfma_f32_32x32x16_bf16 v[72:87], v[104:107], a[200:203], v[72:87]
  v_permlane16_swap_b32 v137, v141
  v_permlane16_swap_b32 v188, v142
  v_add_f32 v136, v136, v140
  v_add_f32 v137, v137, v141
  v_mfma_f32_32x32x16_bf16 v[88:103], v[104:107], a[204:207], v[88:103]
  v_add_f32 v188, v188, v142
  v_mov_b32 v140, v136
  v_mov_b32 v141, v137
  v_mov_b32 v142, v188
  v_permlane32_swap_b32 v136, v140
  s_waitcnt lgkmcnt(2)
  v_mfma_f32_32x32x16_bf16 v[40:55], v[108:111], a[208:211], v[40:55]
  v_permlane32_swap_b32 v137, v141
  v_permlane32_swap_b32 v188, v142
  v_add_f32 v136, v136, v140
  v_add_f32 v137, v137, v141
  v_mfma_f32_32x32x16_bf16 v[56:71], v[108:111], a[212:215], v[56:71]
  v_add_f32 v188, v188, v142
  v_mul_f32 v136, 0x3b000000, v136
  v_mul_f32 v137, 0x3b000000, v137
  v_fma_f32 v137, -v136, v136, v137
  v_cvt_pk_bf16_f32 v136, 0, v136
  v_max_f32 v137, 0, v137
  v_mfma_f32_32x32x16_bf16 v[72:87], v[108:111], a[216:219], v[72:87]
  v_sub_f32 v140, v196, v136
  v_sub_f32 v141, v197, v136
  v_cvt_pk_bf16_f32 v137, 0, v137
  v_sub_f32 v142, v198, v136
  v_sub_f32 v143, v199, v136
  v_add_f32 v137, 0x3727c5ac, v137
  v_mfma_f32_32x32x16_bf16 v[88:103], v[108:111], a[220:223], v[88:103]
  v_sub_f32 v144, v200, v136
  v_sub_f32 v145, v201, v136
  v_cvt_pk_bf16_f32 v137, 0, v137
  v_sub_f32 v146, v202, v136
  v_sub_f32 v147, v203, v136
  s_waitcnt lgkmcnt(1)
  v_mfma_f32_32x32x16_bf16 v[40:55], v[112:115], a[224:227], v[40:55]
  v_sqrt_f32 v137, v137
  v_cvt_pk_bf16_f32 v140, 0, v140
  v_cvt_pk_bf16_f32 v141, 0, v141
  v_cvt_pk_bf16_f32 v137, 0, v137
  v_cvt_pk_bf16_f32 v142, 0, v142
  v_mfma_f32_32x32x16_bf16 v[56:71], v[112:115], a[228:231], v[56:71]
  v_cvt_pk_bf16_f32 v143, 0, v143
  v_rcp_f32 v137, v137
  v_cvt_pk_bf16_f32 v144, 0, v144
  v_cvt_pk_bf16_f32 v145, 0, v145
  v_cvt_pk_bf16_f32 v146, 0, v146
  v_mfma_f32_32x32x16_bf16 v[72:87], v[112:115], a[232:235], v[72:87]
  v_cvt_pk_bf16_f32 v147, 0, v147
  v_mul_f32 v140, v140, v137
  v_mul_f32 v141, v141, v137
  v_mul_f32 v142, v142, v137
  v_mul_f32 v143, v143, v137
  v_mul_f32 v144, v144, v137
  v_mfma_f32_32x32x16_bf16 v[88:103], v[112:115], a[236:239], v[88:103]
  v_mul_f32 v145, v145, v137
  v_mul_f32 v146, v146, v137
  v_mul_f32 v147, v147, v137
  v_cvt_pk_bf16_f32 v132, v140, v141
  v_cvt_pk_bf16_f32 v133, v142, v143
  s_waitcnt lgkmcnt(0)
  v_mfma_f32_32x32x16_bf16 v[40:55], v[116:119], a[240:243], v[40:55]
  v_cvt_pk_bf16_f32 v134, v144, v145
  v_cvt_pk_bf16_f32 v135, v146, v147
  buffer_store_dwordx4 v[132:135], v0, s[4:7], s93 offen sc1
  v_cvt_pk_bf16_f32 v188, 0, v188
  v_mfma_f32_32x32x16_bf16 v[56:71], v[116:119], a[244:247], v[56:71]
  v_ashrrev_i32 v189, 31, v188
  v_or_b32 v189, 0x80000000, v189
  v_xor_b32 v188, v188, v189
  s_sub_u32 s92, 4095, s90
  v_and_b32 v188, 0xffff0000, v188
  v_or_b32 v38, s92, v188
  v_mfma_f32_32x32x16_bf16 v[72:87], v[116:119], a[248:251], v[72:87]
  s_bfe_u32 s92, s65, 196625
  s_lshl_b32 s92, s92, 18
  s_lshl_b32 s93, s90, 7
  s_add_u32 s92, s92, s93
  s_add_u32 s84, s92, 243269632
  v_mfma_f32_32x32x16_bf16 v[88:103], v[116:119], a[252:255], v[88:103]
  v_cvt_pk_bf16_f32 v212, v40, v56
  s_nop 4
  s_nop 5
  v_cvt_pk_bf16_f32 v213, v72, v88
  v_cvt_pk_bf16_f32 v214, v41, v57
  v_cvt_pk_bf16_f32 v215, v73, v89
  v_cvt_pk_bf16_f32 v216, v42, v58
  v_cvt_pk_bf16_f32 v217, v74, v90
  v_cvt_pk_bf16_f32 v218, v43, v59
  v_cvt_pk_bf16_f32 v219, v75, v91
  v_permlane16_swap_b32 v212, v214
  v_permlane16_swap_b32 v213, v215
  s_add_u32 s78, s86, 0
  v_bfi_b32 v212, v254, s42, v212
  buffer_store_dwordx4 v[212:215], v4, s[4:7], s78 offen sc1
  v_cvt_pk_bf16_f32 v220, v44, v60
  v_cvt_pk_bf16_f32 v221, v76, v92
  v_cvt_pk_bf16_f32 v222, v45, v61
  v_cvt_pk_bf16_f32 v223, v77, v93
  v_permlane16_swap_b32 v216, v218
  v_permlane16_swap_b32 v217, v219
  s_add_u32 s78, s86, 32768
  v_bfi_b32 v216, v254, s42, v216
  buffer_store_dwordx4 v[216:219], v4, s[4:7], s78 offen sc1
  v_cvt_pk_bf16_f32 v224, v46, v62
  v_cvt_pk_bf16_f32 v225, v78, v94
  v_cvt_pk_bf16_f32 v226, v47, v63
  v_cvt_pk_bf16_f32 v227, v79, v95
  v_permlane16_swap_b32 v220, v222
  v_permlane16_swap_b32 v221, v223
  s_add_u32 s78, s86, 131072
  v_bfi_b32 v220, v254, s42, v220
  buffer_store_dwordx4 v[220:223], v4, s[4:7], s78 offen sc1
  v_cvt_pk_bf16_f32 v228, v48, v64
  v_cvt_pk_bf16_f32 v229, v80, v96
  v_cvt_pk_bf16_f32 v230, v49, v65
  v_cvt_pk_bf16_f32 v231, v81, v97
  v_permlane16_swap_b32 v224, v226
  v_permlane16_swap_b32 v225, v227
  s_add_u32 s78, s86, 163840
  v_bfi_b32 v224, v254, s42, v224
  buffer_store_dwordx4 v[224:227], v4, s[4:7], s78 offen sc1
  v_cvt_pk_bf16_f32 v232, v50, v66
  v_cvt_pk_bf16_f32 v233, v82, v98
  v_cvt_pk_bf16_f32 v234, v51, v67
  v_cvt_pk_bf16_f32 v235, v83, v99
  v_permlane16_swap_b32 v228, v230
  v_permlane16_swap_b32 v229, v231
  s_add_u32 s78, s86, 262144
  v_bfi_b32 v228, v254, s42, v228
  buffer_store_dwordx4 v[228:231], v4, s[4:7], s78 offen sc1
  v_cvt_pk_bf16_f32 v236, v52, v68
  v_cvt_pk_bf16_f32 v237, v84, v100
  v_cvt_pk_bf16_f32 v238, v53, v69
  v_cvt_pk_bf16_f32 v239, v85, v101
  v_permlane16_swap_b32 v232, v234
  v_permlane16_swap_b32 v233, v235
  s_add_u32 s78, s86, 294912
  v_bfi_b32 v232, v254, s42, v232
  buffer_store_dwordx4 v[232:235], v4, s[4:7], s78 offen sc1
  v_cvt_pk_bf16_f32 v240, v54, v70
  v_cvt_pk_bf16_f32 v241, v86, v102
  v_cvt_pk_bf16_f32 v242, v55, v71
  v_cvt_pk_bf16_f32 v243, v87, v103
  v_permlane16_swap_b32 v236, v238
  v_permlane16_swap_b32 v237, v239
  s_add_u32 s78, s86, 393216
  v_bfi_b32 v236, v254, s42, v236
  buffer_store_dwordx4 v[236:239], v4, s[4:7], s78 offen sc1
  v_permlane16_swap_b32 v240, v242
  v_permlane16_swap_b32 v241, v243
  s_add_u32 s78, s86, 425984
  v_bfi_b32 v240, v254, s42, v240
  buffer_store_dwordx4 v[240:243], v4, s[4:7], s78 offen sc1
  s_waitcnt vmcnt(8)
  s_mov_b64 exec, 1
  buffer_store_dword v38, off, s[4:7], s84 sc1
  s_mov_b64 exec, -1
  s_mov_b32 s84, 268435456
  s_branch o_we_152
o_rt_159:
  s_mov_b32 s67, 0
o_rl_163:
  s_lshl_b32 s94, s43, 14
  s_add_u32 s94, s94, s95
  buffer_load_dwordx4 v[120:123], v5, s[4:7], s94 offen offset:0 sc1
  buffer_load_dwordx4 v[124:127], v5, s[4:7], s94 offen offset:256 sc1
  buffer_load_dwordx4 v[128:131], v5, s[4:7], s94 offen offset:512 sc1
  buffer_load_dwordx4 v[132:135], v5, s[4:7], s94 offen offset:768 sc1
  s_add_u32 s94, s94, 4096
  buffer_load_dwordx4 v[136:139], v5, s[4:7], s94 offen offset:0 sc1
  buffer_load_dwordx4 v[140:143], v5, s[4:7], s94 offen offset:256 sc1
  buffer_load_dwordx4 v[144:147], v5, s[4:7], s94 offen offset:512 sc1
  buffer_load_dwordx4 v[148:151], v5, s[4:7], s94 offen offset:768 sc1
  s_add_u32 s94, s94, 4096
  buffer_load_dwordx4 v[152:155], v5, s[4:7], s94 offen offset:0 sc1
  buffer_load_dwordx4 v[156:159], v5, s[4:7], s94 offen offset:256 sc1
  buffer_load_dwordx4 v[160:163], v5, s[4:7], s94 offen offset:512 sc1
  buffer_load_dwordx4 v[164:167], v5, s[4:7], s94 offen offset:768 sc1
  s_add_u32 s94, s94, 4096
  buffer_load_dwordx4 v[168:171], v5, s[4:7], s94 offen offset:0 sc1
  buffer_load_dwordx4 v[172:175], v5, s[4:7], s94 offen offset:256 sc1
  buffer_load_dwordx4 v[176:179], v5, s[4:7], s94 offen offset:512 sc1
  buffer_load_dwordx4 v[180:183], v5, s[4:7], s94 offen offset:768 sc1
  s_add_u32 s67, s67, 1
  s_cmp_gt_u32 s67, 1048576
  s_cbranch_scc1 L_end
  s_waitcnt vmcnt(0)
  v_xor_b32 v7, s96, v120
  v_bitop3_b32 v7, v7, v124, s96 bitop3:0xf6
  v_bitop3_b32 v7, v7, v128, s96 bitop3:0xf6
  v_bitop3_b32 v7, v7, v132, s96 bitop3:0xf6
  v_bitop3_b32 v7, v7, v136, s96 bitop3:0xf6
  v_bitop3_b32 v7, v7, v140, s96 bitop3:0xf6
  v_bitop3_b32 v7, v7, v144, s96 bitop3:0xf6
  v_bitop3_b32 v7, v7, v148, s96 bitop3:0xf6
  v_bitop3_b32 v7, v7, v152, s96 bitop3:0xf6
  v_bitop3_b32 v7, v7, v156, s96 bitop3:0xf6
  v_bitop3_b32 v7, v7, v160, s96 bitop3:0xf6
  v_bitop3_b32 v7, v7, v164, s96 bitop3:0xf6
  v_bitop3_b32 v7, v7, v168, s96 bitop3:0xf6
  v_bitop3_b32 v7, v7, v172, s96 bitop3:0xf6
  v_bitop3_b32 v7, v7, v176, s96 bitop3:0xf6
  v_bitop3_b32 v7, v7, v180, s96 bitop3:0xf6
  v_and_b32 v7, v254, v7
  v_cmp_ne_u32 vcc, 0, v7
  s_cbranch_vccnz o_rl_163
  s_branch o_bk_160
o_rt_161:
  s_mov_b32 s67, 0
o_rl_164:
  s_lshl_b32 s94, s43, 14
  s_add_u32 s94, s94, s95
  buffer_load_dwordx4 v[120:123], v5, s[4:7], s94 offen offset:0 sc1
  buffer_load_dwordx4 v[124:127], v5, s[4:7], s94 offen offset:256 sc1
  buffer_load_dwordx4 v[128:131], v5, s[4:7], s94 offen offset:512 sc1
  buffer_load_dwordx4 v[132:135], v5, s[4:7], s94 offen offset:768 sc1
  s_add_u32 s94, s94, 4096
  buffer_load_dwordx4 v[136:139], v5, s[4:7], s94 offen offset:0 sc1
  buffer_load_dwordx4 v[140:143], v5, s[4:7], s94 offen offset:256 sc1
  buffer_load_dwordx4 v[144:147], v5, s[4:7], s94 offen offset:512 sc1
  buffer_load_dwordx4 v[148:151], v5, s[4:7], s94 offen offset:768 sc1
  s_add_u32 s94, s94, 4096
  buffer_load_dwordx4 v[152:155], v5, s[4:7], s94 offen offset:0 sc1
  buffer_load_dwordx4 v[156:159], v5, s[4:7], s94 offen offset:256 sc1
  buffer_load_dwordx4 v[160:163], v5, s[4:7], s94 offen offset:512 sc1
  buffer_load_dwordx4 v[164:167], v5, s[4:7], s94 offen offset:768 sc1
  s_add_u32 s94, s94, 4096
  buffer_load_dwordx4 v[168:171], v5, s[4:7], s94 offen offset:0 sc1
  buffer_load_dwordx4 v[172:175], v5, s[4:7], s94 offen offset:256 sc1
  buffer_load_dwordx4 v[176:179], v5, s[4:7], s94 offen offset:512 sc1
  buffer_load_dwordx4 v[180:183], v5, s[4:7], s94 offen offset:768 sc1
  s_add_u32 s67, s67, 1
  s_cmp_gt_u32 s67, 1048576
  s_cbranch_scc1 L_end
  s_waitcnt vmcnt(0)
  v_xor_b32 v7, s96, v120
  v_bitop3_b32 v7, v7, v124, s96 bitop3:0xf6
  v_bitop3_b32 v7, v7, v128, s96 bitop3:0xf6
  v_bitop3_b32 v7, v7, v132, s96 bitop3:0xf6
  v_bitop3_b32 v7, v7, v136, s96 bitop3:0xf6
  v_bitop3_b32 v7, v7, v140, s96 bitop3:0xf6
  v_bitop3_b32 v7, v7, v144, s96 bitop3:0xf6
  v_bitop3_b32 v7, v7, v148, s96 bitop3:0xf6
  v_bitop3_b32 v7, v7, v152, s96 bitop3:0xf6
  v_bitop3_b32 v7, v7, v156, s96 bitop3:0xf6
  v_bitop3_b32 v7, v7, v160, s96 bitop3:0xf6
  v_bitop3_b32 v7, v7, v164, s96 bitop3:0xf6
  v_bitop3_b32 v7, v7, v168, s96 bitop3:0xf6
  v_bitop3_b32 v7, v7, v172, s96 bitop3:0xf6
  v_bitop3_b32 v7, v7, v176, s96 bitop3:0xf6
  v_bitop3_b32 v7, v7, v180, s96 bitop3:0xf6
  v_and_b32 v7, v254, v7
  v_cmp_ne_u32 vcc, 0, v7
  s_cbranch_vccnz o_rl_164
  s_branch o_bk_162
o_fb_153:
  v_mov_b32 v118, v116
  s_nop 1
  v_permlane16_swap_b32 v116, v118
  v_max_f32 v116, v116, v118
  v_mov_b32 v118, v116
  s_nop 0
  s_nop 0
  v_permlane32_swap_b32 v116, v118
  v_max_f32 v116, v116, v118
  v_sub_f32 v56, v104, v116
  v_sub_f32 v57, v105, v116
  v_sub_f32 v58, v106, v116
  v_sub_f32 v59, v107, v116
  v_sub_f32 v60, v108, v116
  v_sub_f32 v61, v109, v116
  v_sub_f32 v62, v110, v116
  v_sub_f32 v63, v111, v116
  v_sub_f32 v64, v112, v116
  v_sub_f32 v65, v113, v116
  v_exp_f32 v56, v56
  v_exp_f32 v57, v57
  v_exp_f32 v58, v58
  v_exp_f32 v59, v59
  v_exp_f32 v60, v60
  v_exp_f32 v61, v61
  v_exp_f32 v62, v62
  v_exp_f32 v63, v63
  v_exp_f32 v64, v64
  v_exp_f32 v65, v65
  v_add_f32 v117, v56, v57
  v_add_f32 v117, v117, v58
  v_add_f32 v117, v117, v59
  v_add_f32 v117, v117, v60
  v_add_f32 v117, v117, v61
  v_add_f32 v117, v117, v62
  v_add_f32 v117, v117, v63
  v_add_f32 v117, v117, v64
  v_add_f32 v117, v117, v65
  v_mov_b32 v118, v117
  s_nop 0
  s_nop 0
  v_permlane16_swap_b32 v117, v118
  v_add_f32 v117, v117, v118
  v_mov_b32 v118, v117
  s_nop 0
  s_nop 0
  v_permlane32_swap_b32 v117, v118
  v_add_f32 v117, v117, v118
  v_rcp_f32 v117, v117
  s_branch o_fbr_154
o_fb_155:
  v_mov_b32 v118, v116
  s_nop 1
  v_permlane16_swap_b32 v116, v118
  v_max_f32 v116, v116, v118
  v_mov_b32 v118, v116
  s_nop 0
  s_nop 0
  v_permlane32_swap_b32 v116, v118
  v_max_f32 v116, v116, v118
  v_sub_f32 v56, v104, v116
  v_sub_f32 v57, v105, v116
  v_sub_f32 v58, v106, v116
  v_sub_f32 v59, v107, v116
  v_sub_f32 v60, v108, v116
  v_sub_f32 v61, v109, v116
  v_sub_f32 v62, v110, v116
  v_sub_f32 v63, v111, v116
  v_sub_f32 v64, v112, v116
  v_sub_f32 v65, v113, v116
  v_exp_f32 v56, v56
  v_exp_f32 v57, v57
  v_exp_f32 v58, v58
  v_exp_f32 v59, v59
  v_exp_f32 v60, v60
  v_exp_f32 v61, v61
  v_exp_f32 v62, v62
  v_exp_f32 v63, v63
  v_exp_f32 v64, v64
  v_exp_f32 v65, v65
  v_add_f32 v117, v56, v57
  v_add_f32 v117, v117, v58
  v_add_f32 v117, v117, v59
  v_add_f32 v117, v117, v60
  v_add_f32 v117, v117, v61
  v_add_f32 v117, v117, v62
  v_add_f32 v117, v117, v63
  v_add_f32 v117, v117, v64
  v_add_f32 v117, v117, v65
  v_mov_b32 v118, v117
  s_nop 0
  s_nop 0
  v_permlane16_swap_b32 v117, v118
  v_add_f32 v117, v117, v118
  v_mov_b32 v118, v117
  s_nop 0
  s_nop 0
  v_permlane32_swap_b32 v117, v118
  v_add_f32 v117, v117, v118
  v_rcp_f32 v117, v117
  s_branch o_fbr_156
o_wr2_151:
  s_waitcnt lgkmcnt(0)
  s_barrier
  ds_read_b128 v[104:107], v3 offset:0
  ds_read_b128 v[108:111], v3 offset:512
  ds_read_b128 v[112:115], v3 offset:1024
  buffer_load_dwordx4 v[176:179], v5, s[4:7], s94 offen offset:512 sc1
  buffer_load_dwordx4 v[180:183], v5, s[4:7], s94 offen offset:768 sc1
  s_waitcnt lgkmcnt(2)
  v_mfma_f32_32x32x16_bf16 v[40:55], v[104:107], a[0:3], 0
  s_and_b32 s91, s65, 63
  s_lshl_b32 s90, s91, 5
  s_add_u32 s90, s90, s43
  s_lshl_b32 s94, s91, 5
  s_add_u32 s94, s94, s85
  s_lshl_b32 s94, s94, 10
  v_mfma_f32_32x32x16_bf16 v[56:71], v[104:107], a[4:7], 0
  ds_read_b128 v[116:119], v3 offset:1536
  s_lshr_b32 s92, s65, 22
  s_xor_b32 s93, s43, 32
  s_lshl_b32 s91, s90, 10
  s_add_u32 s94, s94, 25165824
  s_cmp_eq_u32 s92, s93
  s_cselect_b32 s92, s94, s91
  v_mfma_f32_32x32x16_bf16 v[72:87], v[104:107], a[8:11], 0
  s_add_u32 s92, s92, 10485760
  buffer_load_dwordx4 v[184:187], v0, s[4:7], s92 offen sc1
  s_mov_b64 exec, 1
  buffer_store_dword v38, off, s[4:7], s84 sc1
  s_mov_b64 exec, -1
  s_mov_b32 s84, 268435456
  v_mfma_f32_32x32x16_bf16 v[88:103], v[104:107], a[12:15], 0
  s_waitcnt vmcnt(14)
  v_xor_b32 v7, s96, v120
  v_bitop3_b32 v7, v7, v124, s96 bitop3:0xf6
  v_bitop3_b32 v7, v7, v128, s96 bitop3:0xf6
  v_bitop3_b32 v7, v7, v132, s96 bitop3:0xf6
  s_waitcnt lgkmcnt(2)
  v_mfma_f32_32x32x16_bf16 v[40:55], v[108:111], a[16:19], v[40:55]
  s_waitcnt vmcnt(10)
  v_bitop3_b32 v7, v7, v136, s96 bitop3:0xf6
  v_bitop3_b32 v7, v7, v140, s96 bitop3:0xf6
  v_bitop3_b32 v7, v7, v144, s96 bitop3:0xf6
  v_bitop3_b32 v7, v7, v148, s96 bitop3:0xf6
  s_waitcnt vmcnt(6)
  v_mfma_f32_32x32x16_bf16 v[56:71], v[108:111], a[20:23], v[56:71]
  ds_read_b128 v[104:107], v3 offset:2048
  v_bitop3_b32 v7, v7, v152, s96 bitop3:0xf6
  v_bitop3_b32 v7, v7, v156, s96 bitop3:0xf6
  v_bitop3_b32 v7, v7, v160, s96 bitop3:0xf6
  v_bitop3_b32 v7, v7, v164, s96 bitop3:0xf6
  s_waitcnt vmcnt(2)
  v_mfma_f32_32x32x16_bf16 v[72:87], v[108:111], a[24:27], v[72:87]
  v_bitop3_b32 v7, v7, v168, s96 bitop3:0xf6
  v_bitop3_b32 v7, v7, v172, s96 bitop3:0xf6
  v_bitop3_b32 v7, v7, v176, s96 bitop3:0xf6
  v_bitop3_b32 v7, v7, v180, s96 bitop3:0xf6
  v_and_b32 v7, v254, v7
  v_cmp_ne_u32 vcc, 0, v7
  s_cbranch_vccnz o_rt_161
o_bk_162:
  v_mfma_f32_32x32x16_bf16 v[88:103], v[108:111], a[28:31], v[88:103]
  v_mfma_f32_16x16x32_bf16 v[188:191], v[16:19], v[120:123], 0
  v_mfma_f32_16x16x32_bf16 v[192:195], v[16:19], v[124:127], 0
  v_mfma_f32_16x16x32_bf16 v[188:191], v[20:23], v[128:131], v[188:191]
  s_waitcnt lgkmcnt(2)
  v_mfma_f32_32x32x16_bf16 v[40:55], v[112:115], a[32:35], v[40:55]
  v_mfma_f32_16x16x32_bf16 v[192:195], v[20:23], v[132:135], v[192:195]
  v_mfma_f32_16x16x32_bf16 v[188:191], v[16:19], v[136:139], v[188:191]
  v_mfma_f32_16x16x32_bf16 v[192:195], v[16:19], v[140:143], v[192:195]
  v_mfma_f32_32x32x16_bf16 v[56:71], v[112:115], a[36:39], v[56:71]
  ds_read_b128 v[108:111], v3 offset:2560
  v_mfma_f32_16x16x32_bf16 v[188:191], v[20:23], v[144:147], v[188:191]
  v_mfma_f32_16x16x32_bf16 v[192:195], v[20:23], v[148:151], v[192:195]
  v_mfma_f32_16x16x32_bf16 v[188:191], v[16:19], v[152:155], v[188:191]
  v_mfma_f32_32x32x16_bf16 v[72:87], v[112:115], a[40:43], v[72:87]
  v_mfma_f32_16x16x32_bf16 v[192:195], v[16:19], v[156:159], v[192:195]
  v_mfma_f32_16x16x32_bf16 v[188:191], v[20:23], v[160:163], v[188:191]
  v_mfma_f32_16x16x32_bf16 v[192:195], v[20:23], v[164:167], v[192:195]
  v_mfma_f32_32x32x16_bf16 v[88:103], v[112:115], a[44:47], v[88:103]
  v_mfma_f32_16x16x32_bf16 v[188:191], v[16:19], v[168:171], v[188:191]
  v_mfma_f32_16x16x32_bf16 v[192:195], v[16:19], v[172:175], v[192:195]
  v_mfma_f32_16x16x32_bf16 v[188:191], v[20:23], v[176:179], v[188:191]
  s_waitcnt lgkmcnt(2)
  v_mfma_f32_32x32x16_bf16 v[40:55], v[116:119], a[48:51], v[40:55]
  v_mfma_f32_16x16x32_bf16 v[192:195], v[20:23], v[180:183], v[192:195]
  s_bfe_u32 s92, s65, 131086
  s_lshl_b32 s92, s92, 21
  s_add_u32 s92, s92, s91
  s_add_u32 s93, s92, 27262976
  v_mfma_f32_32x32x16_bf16 v[56:71], v[116:119], a[52:55], v[56:71]
  ds_read_b128 v[112:115], v3 offset:3072
  s_add_u32 s92, s92, 20971520
  s_waitcnt vmcnt(1)
  v_lshlrev_b32 v196, 16, v184
  v_and_b32 v197, 0xffff0000, v184
  v_lshlrev_b32 v198, 16, v185
  v_mfma_f32_32x32x16_bf16 v[72:87], v[116:119], a[56:59], v[72:87]
  v_and_b32 v199, 0xffff0000, v185
  v_lshlrev_b32 v200, 16, v186
  v_and_b32 v201, 0xffff0000, v186
  v_lshlrev_b32 v202, 16, v187
  v_and_b32 v203, 0xffff0000, v187
  v_permlane16_swap_b32 v188, v192
  v_mfma_f32_32x32x16_bf16 v[88:103], v[116:119], a[60:63], v[88:103]
  v_permlane16_swap_b32 v189, v193
  v_permlane16_swap_b32 v190, v194
  v_permlane16_swap_b32 v191, v195
  s_waitcnt lgkmcnt(2)
  v_mfma_f32_32x32x16_bf16 v[40:55], v[104:107], a[64:67], v[40:55]
  v_cvt_pk_bf16_f32 v188, 0, v188
  v_cvt_pk_bf16_f32 v189, 0, v189
  v_cvt_pk_bf16_f32 v190, 0, v190
  v_cvt_pk_bf16_f32 v191, 0, v191
  v_cvt_pk_bf16_f32 v192, 0, v192
  v_cvt_pk_bf16_f32 v193, 0, v193
  v_mfma_f32_32x32x16_bf16 v[56:71], v[104:107], a[68:71], v[56:71]
  ds_read_b128 v[116:119], v3 offset:3584
  v_cvt_pk_bf16_f32 v194, 0, v194
  v_cvt_pk_bf16_f32 v195, 0, v195
  v_add_f32 v196, v196, v188
  v_add_f32 v197, v197, v189
  v_add_f32 v198, v198, v190
  v_mfma_f32_32x32x16_bf16 v[72:87], v[104:107], a[72:75], v[72:87]
  v_add_f32 v199, v199, v191
  v_add_f32 v200, v200, v192
  v_add_f32 v201, v201, v193
  v_add_f32 v202, v202, v194
  v_add_f32 v203, v203, v195
  v_cvt_pk_bf16_f32 v120, v196, v197
  v_mfma_f32_32x32x16_bf16 v[88:103], v[104:107], a[76:79], v[88:103]
  v_cvt_pk_bf16_f32 v121, v198, v199
  v_cvt_pk_bf16_f32 v122, v200, v201
  v_cvt_pk_bf16_f32 v123, v202, v203
  v_lshlrev_b32 v196, 16, v120
  v_and_b32 v197, 0xffff0000, v120
  s_waitcnt lgkmcnt(2)
  v_mfma_f32_32x32x16_bf16 v[40:55], v[108:111], a[80:83], v[40:55]
  v_lshlrev_b32 v198, 16, v121
  v_and_b32 v199, 0xffff0000, v121
  v_lshlrev_b32 v200, 16, v122
  v_and_b32 v201, 0xffff0000, v122
  v_lshlrev_b32 v202, 16, v123
  v_and_b32 v203, 0xffff0000, v123
  v_mfma_f32_32x32x16_bf16 v[56:71], v[108:111], a[84:87], v[56:71]
  ds_read_b128 v[104:107], v3 offset:8192
  buffer_store_dwordx4 v[120:123], v0, s[4:7], s92 offen sc1
  v_add_f32 v136, v196, v197
  v_mul_f32 v137, v196, v196
  v_mfma_f32_32x32x16_bf16 v[72:87], v[108:111], a[88:91], v[72:87]
  v_add_f32 v138, v198, v199
  v_mul_f32 v139, v197, v197
  v_fmac_f32 v137, v198, v198
  v_fmac_f32 v139, v199, v199
  v_add_f32 v136, v136, v200
  v_fmac_f32 v137, v200, v200
  v_mfma_f32_32x32x16_bf16 v[88:103], v[108:111], a[92:95], v[88:103]
  v_add_f32 v138, v138, v201
  v_fmac_f32 v139, v201, v201
  v_add_f32 v136, v136, v202
  v_fmac_f32 v137, v202, v202
  v_add_f32 v138, v138, v203
  s_waitcnt lgkmcnt(2)
  v_mfma_f32_32x32x16_bf16 v[40:55], v[112:115], a[96:99], v[40:55]
  v_fmac_f32 v139, v203, v203
  v_add_f32 v136, v136, v138
  v_add_f32 v137, v137, v139
  s_nop 0
  v_add_f32_dpp v136, v136, v136 row_ror:8 row_mask:0xf bank_mask:0xf
  v_add_f32_dpp v137, v137, v137 row_ror:8 row_mask:0xf bank_mask:0xf
  s_nop 0
  v_add_f32_dpp v136, v136, v136 row_ror:4 row_mask:0xf bank_mask:0xf
  v_mfma_f32_32x32x16_bf16 v[56:71], v[112:115], a[100:103], v[56:71]
  ds_read_b128 v[108:111], v3 offset:8704
  v_add_f32_dpp v137, v137, v137 row_ror:4 row_mask:0xf bank_mask:0xf
  v_add_f32_dpp v136, v136, v136 row_ror:2 row_mask:0xf bank_mask:0xf
  s_nop 0
  v_add_f32_dpp v137, v137, v137 row_ror:2 row_mask:0xf bank_mask:0xf
  v_add_f32_dpp v136, v136, v136 row_ror:1 row_mask:0xf bank_mask:0xf
  s_nop 0
  v_add_f32_dpp v137, v137, v137 row_ror:1 row_mask:0xf bank_mask:0xf
  v_mfma_f32_32x32x16_bf16 v[72:87], v[112:115], a[104:107], v[72:87]
  v_mov_b32 v140, v136
  v_mov_b32 v141, v137
  s_nop 0
  v_permlane16_swap_b32 v136, v140
  v_permlane16_swap_b32 v137, v141
  v_mfma_f32_32x32x16_bf16 v[88:103], v[112:115], a[108:111], v[88:103]
  v_add_f32 v136, v136, v140
  v_add_f32 v137, v137, v141
  v_mov_b32 v140, v136
  v_mov_b32 v141, v137
  s_nop 0
  v_permlane32_swap_b32 v136, v140
  s_waitcnt lgkmcnt(2)
  v_mfma_f32_32x32x16_bf16 v[40:55], v[116:119], a[112:115], v[40:55]
  v_permlane32_swap_b32 v137, v141
  v_add_f32 v136, v136, v140
  v_add_f32 v137, v137, v141
  v_mul_f32 v136, 0x3b000000, v136
  v_mul_f32 v137, 0x3b000000, v137
  v_mfma_f32_32x32x16_bf16 v[56:71], v[116:119], a[116:119], v[56:71]
  ds_read_b128 v[112:115], v3 offset:9216
  v_fma_f32 v137, -v136, v136, v137
  v_cvt_pk_bf16_f32 v136, 0, v136
  v_max_f32 v137, 0, v137
  v_sub_f32 v140, v196, v136
  v_sub_f32 v141, v197, v136
  v_mfma_f32_32x32x16_bf16 v[72:87], v[116:119], a[120:123], v[72:87]
  v_cvt_pk_bf16_f32 v137, 0, v137
  v_sub_f32 v142, v198, v136
  v_sub_f32 v143, v199, v136
  v_add_f32 v137, 0x3727c5ac, v137
  v_sub_f32 v144, v200, v136
  v_sub_f32 v145, v201, v136
  v_mfma_f32_32x32x16_bf16 v[88:103], v[116:119], a[124:127], v[88:103]
  v_cvt_pk_bf16_f32 v137, 0, v137
  v_sub_f32 v146, v202, v136
  v_sub_f32 v147, v203, v136
  v_sqrt_f32 v137, v137
  s_waitcnt lgkmcnt(2)
  v_mfma_f32_32x32x16_bf16 v[40:55], v[104:107], a[128:131], v[40:55]
  v_cvt_pk_bf16_f32 v140, 0, v140
  v_cvt_pk_bf16_f32 v141, 0, v141
  v_cvt_pk_bf16_f32 v137, 0, v137
  v_cvt_pk_bf16_f32 v142, 0, v142
  v_cvt_pk_bf16_f32 v143, 0, v143
  v_rcp_f32 v137, v137
  v_mfma_f32_32x32x16_bf16 v[56:71], v[104:107], a[132:135], v[56:71]
  ds_read_b128 v[116:119], v3 offset:9728
  v_cvt_pk_bf16_f32 v144, 0, v144
  v_cvt_pk_bf16_f32 v145, 0, v145
  v_cvt_pk_bf16_f32 v146, 0, v146
  v_cvt_pk_bf16_f32 v147, 0, v147
  v_mul_f32 v140, v140, v137
  v_mfma_f32_32x32x16_bf16 v[72:87], v[104:107], a[136:139], v[72:87]
  v_mul_f32 v141, v141, v137
  v_mul_f32 v142, v142, v137
  v_mul_f32 v143, v143, v137
  v_mul_f32 v144, v144, v137
  v_mul_f32 v145, v145, v137
  v_mul_f32 v146, v146, v137
  v_mfma_f32_32x32x16_bf16 v[88:103], v[104:107], a[140:143], v[88:103]
  v_mul_f32 v147, v147, v137
  v_cvt_pk_bf16_f32 v124, v140, v141
  v_cvt_pk_bf16_f32 v125, v142, v143
  v_cvt_pk_bf16_f32 v126, v144, v145
  v_cvt_pk_bf16_f32 v127, v146, v147
  s_waitcnt lgkmcnt(2)
  v_mfma_f32_32x32x16_bf16 v[40:55], v[108:111], a[144:147], v[40:55]
  v_lshlrev_b32 v204, 16, v124
  v_and_b32 v205, 0xffff0000, v124
  v_lshlrev_b32 v206, 16, v125
  v_and_b32 v207, 0xffff0000, v125
  v_lshlrev_b32 v208, 16, v126
  v_and_b32 v209, 0xffff0000, v126
  v_mfma_f32_32x32x16_bf16 v[56:71], v[108:111], a[148:151], v[56:71]
  ds_read_b128 v[104:107], v3 offset:10240
  v_lshlrev_b32 v210, 16, v127
  v_and_b32 v211, 0xffff0000, v127
  buffer_store_dwordx4 v[124:127], v0, s[4:7], s93 offen sc1
  v_mfma_f32_32x32x16_bf16 v[72:87], v[108:111], a[152:155], v[72:87]
  v_add_f32 v196, v196, v204
  v_add_f32 v197, v197, v205
  v_add_f32 v198, v198, v206
  v_add_f32 v199, v199, v207
  v_add_f32 v200, v200, v208
  v_add_f32 v201, v201, v209
  v_mfma_f32_32x32x16_bf16 v[88:103], v[108:111], a[156:159], v[88:103]
  v_add_f32 v202, v202, v210
  v_add_f32 v203, v203, v211
  v_cvt_pk_bf16_f32 v128, v196, v197
  v_cvt_pk_bf16_f32 v129, v198, v199
  v_cvt_pk_bf16_f32 v130, v200, v201
  s_waitcnt lgkmcnt(2)
  v_mfma_f32_32x32x16_bf16 v[40:55], v[112:115], a[160:163], v[40:55]
  v_cvt_pk_bf16_f32 v131, v202, v203
  v_mul_f32 v188, v204, v8
  v_mul_f32 v189, v205, v9
  v_fmac_f32 v188, v206, v10
  v_fmac_f32 v189, v207, v11
  v_fmac_f32 v188, v208, v12
  v_mfma_f32_32x32x16_bf16 v[56:71], v[112:115], a[164:167], v[56:71]
  ds_read_b128 v[108:111], v3 offset:10752
  v_fmac_f32 v189, v209, v13
  v_fmac_f32 v188, v210, v14
  v_fmac_f32 v189, v211, v15
  v_add_f32 v188, v188, v189
  buffer_store_dwordx4 v[128:131], v0, s[68:71], s91 offen sc1
  v_mfma_f32_32x32x16_bf16 v[72:87], v[112:115], a[168:171], v[72:87]
  v_add_f32_dpp v188, v188, v188 row_ror:8 row_mask:0xf bank_mask:0xf
  s_nop 1
  v_add_f32_dpp v188, v188, v188 row_ror:4 row_mask:0xf bank_mask:0xf
  s_nop 1
  v_add_f32_dpp v188, v188, v188 row_ror:2 row_mask:0xf bank_mask:0xf
  s_nop 1
  v_add_f32_dpp v188, v188, v188 row_ror:1 row_mask:0xf bank_mask:0xf
  v_mov_b32 v189, v188
  s_nop 0
  s_nop 0
  v_permlane16_swap_b32 v188, v189
  v_mfma_f32_32x32x16_bf16 v[88:103], v[112:115], a[172:175], v[88:103]
  v_add_f32 v188, v188, v189
  v_mov_b32 v189, v188
  s_nop 0
  s_nop 0
  v_permlane32_swap_b32 v188, v189
  v_add_f32 v188, v188, v189
  s_waitcnt lgkmcnt(2)
  v_mfma_f32_32x32x16_bf16 v[40:55], v[116:119], a[176:179], v[40:55]
  v_cvt_pk_bf16_f32 v188, 0, v188
  v_ashrrev_i32 v189, 31, v188
  v_or_b32 v189, 0x80000000, v189
  v_xor_b32 v188, v188, v189
  s_sub_u32 s92, 4095, s90
  v_and_b32 v188, 0xffff0000, v188
  v_mfma_f32_32x32x16_bf16 v[56:71], v[116:119], a[180:183], v[56:71]
  ds_read_b128 v[112:115], v3 offset:11264
  v_or_b32 v38, s92, v188
  s_bfe_u32 s92, s65, 196625
  s_lshl_b32 s92, s92, 18
  s_lshl_b32 s93, s90, 7
  s_add_u32 s92, s92, s93
  v_mfma_f32_32x32x16_bf16 v[72:87], v[116:119], a[184:187], v[72:87]
  s_add_u32 s84, s92, 243269632
  v_mfma_f32_32x32x16_bf16 v[88:103], v[116:119], a[188:191], v[88:103]
  s_waitcnt lgkmcnt(2)
  v_mfma_f32_32x32x16_bf16 v[40:55], v[104:107], a[192:195], v[40:55]
  v_mfma_f32_32x32x16_bf16 v[56:71], v[104:107], a[196:199], v[56:71]
  ds_read_b128 v[116:119], v3 offset:11776
  v_mfma_f32_32x32x16_bf16 v[72:87], v[104:107], a[200:203], v[72:87]
  v_mfma_f32_32x32x16_bf16 v[88:103], v[104:107], a[204:207], v[88:103]
  s_waitcnt lgkmcnt(2)
  v_mfma_f32_32x32x16_bf16 v[40:55], v[108:111], a[208:211], v[40:55]
  v_mfma_f32_32x32x16_bf16 v[56:71], v[108:111], a[212:215], v[56:71]
  v_mfma_f32_32x32x16_bf16 v[72:87], v[108:111], a[216:219], v[72:87]
  v_mfma_f32_32x32x16_bf16 v[88:103], v[108:111], a[220:223], v[88:103]
  s_waitcnt lgkmcnt(1)
  v_mfma_f32_32x32x16_bf16 v[40:55], v[112:115], a[224:227], v[40:55]
  v_mfma_f32_32x32x16_bf16 v[56:71], v[112:115], a[228:231], v[56:71]
  v_mfma_f32_32x32x16_bf16 v[72:87], v[112:115], a[232:235], v[72:87]
  v_mfma_f32_32x32x16_bf16 v[88:103], v[112:115], a[236:239], v[88:103]
  s_waitcnt lgkmcnt(0)
  v_mfma_f32_32x32x16_bf16 v[40:55], v[116:119], a[240:243], v[40:55]
  v_mfma_f32_32x32x16_bf16 v[56:71], v[116:119], a[244:247], v[56:71]
  v_mfma_f32_32x32x16_bf16 v[72:87], v[116:119], a[248:251], v[72:87]
  v_mfma_f32_32x32x16_bf16 v[88:103], v[116:119], a[252:255], v[88:103]
  s_nop 3
  s_nop 0
  s_nop 3
  s_nop 0
  v_cvt_pk_bf16_f32 v212, v40, v56
  s_nop 0
  v_cvt_pk_bf16_f32 v213, v72, v88
  v_cvt_pk_bf16_f32 v214, v41, v57
  v_cvt_pk_bf16_f32 v215, v73, v89
  v_cvt_pk_bf16_f32 v216, v42, v58
  v_cvt_pk_bf16_f32 v217, v74, v90
  v_cvt_pk_bf16_f32 v218, v43, v59
  v_cvt_pk_bf16_f32 v219, v75, v91
  v_permlane16_swap_b32 v212, v214
  v_permlane16_swap_b32 v213, v215
  s_add_u32 s78, s86, 0
  v_bfi_b32 v212, v254, s42, v212
  buffer_store_dwordx4 v[212:215], v4, s[4:7], s78 offen sc1
  v_cvt_pk_bf16_f32 v220, v44, v60
  v_cvt_pk_bf16_f32 v221, v76, v92
  v_cvt_pk_bf16_f32 v222, v45, v61
  v_cvt_pk_bf16_f32 v223, v77, v93
  v_permlane16_swap_b32 v216, v218
  v_permlane16_swap_b32 v217, v219
  s_add_u32 s78, s86, 32768
  v_bfi_b32 v216, v254, s42, v216
  buffer_store_dwordx4 v[216:219], v4, s[4:7], s78 offen sc1
  v_cvt_pk_bf16_f32 v224, v46, v62
  v_cvt_pk_bf16_f32 v225, v78, v94
  v_cvt_pk_bf16_f32 v226, v47, v63
  v_cvt_pk_bf16_f32 v227, v79, v95
  v_permlane16_swap_b32 v220, v222
  v_permlane16_swap_b32 v221, v223
  s_add_u32 s78, s86, 131072
  v_bfi_b32 v220, v254, s42, v220
  buffer_store_dwordx4 v[220:223], v4, s[4:7], s78 offen sc1
  v_cvt_pk_bf16_f32 v228, v48, v64
  v_cvt_pk_bf16_f32 v229, v80, v96
  v_cvt_pk_bf16_f32 v230, v49, v65
  v_cvt_pk_bf16_f32 v231, v81, v97
  v_permlane16_swap_b32 v224, v226
  v_permlane16_swap_b32 v225, v227
  s_add_u32 s78, s86, 163840
  v_bfi_b32 v224, v254, s42, v224
  buffer_store_dwordx4 v[224:227], v4, s[4:7], s78 offen sc1
  v_cvt_pk_bf16_f32 v232, v50, v66
  v_cvt_pk_bf16_f32 v233, v82, v98
  v_cvt_pk_bf16_f32 v234, v51, v67
  v_cvt_pk_bf16_f32 v235, v83, v99
  v_permlane16_swap_b32 v228, v230
  v_permlane16_swap_b32 v229, v231
  s_add_u32 s78, s86, 262144
  v_bfi_b32 v228, v254, s42, v228
  buffer_store_dwordx4 v[228:231], v4, s[4:7], s78 offen sc1
  v_cvt_pk_bf16_f32 v236, v52, v68
  v_cvt_pk_bf16_f32 v237, v84, v100
  v_cvt_pk_bf16_f32 v238, v53, v69
  v_cvt_pk_bf16_f32 v239, v85, v101
  v_permlane16_swap_b32 v232, v234
  v_permlane16_swap_b32 v233, v235
  s_add_u32 s78, s86, 294912
  v_bfi_b32 v232, v254, s42, v232
  buffer_store_dwordx4 v[232:235], v4, s[4:7], s78 offen sc1
  v_cvt_pk_bf16_f32 v240, v54, v70
  v_cvt_pk_bf16_f32 v241, v86, v102
  v_cvt_pk_bf16_f32 v242, v55, v71
  v_cvt_pk_bf16_f32 v243, v87, v103
  v_permlane16_swap_b32 v236, v238
  v_permlane16_swap_b32 v237, v239
  s_add_u32 s78, s86, 393216
  v_bfi_b32 v236, v254, s42, v236
  buffer_store_dwordx4 v[236:239], v4, s[4:7], s78 offen sc1
  v_permlane16_swap_b32 v240, v242
  v_permlane16_swap_b32 v241, v243
  s_add_u32 s78, s86, 425984
  v_bfi_b32 v240, v254, s42, v240
  buffer_store_dwordx4 v[240:243], v4, s[4:7], s78 offen sc1
o_we_152:
  v_and_b32 v37, -32, v39
  s_waitcnt lgkmcnt(0)
  s_barrier
  ds_read_b128 v[104:107], v37 offset:16
  s_mov_b32 s65, s63
  s_waitcnt lgkmcnt(0)
  v_and_b32 v104, v104, v106
  v_max_u32 v105, v105, v107
  v_readfirstlane_b32 s26, v104
  v_readfirstlane_b32 s3, v105
  s_and_b32 s66, s26, 1
  s_and_b32 s76, s26, 2
  s_bitcmp1_b32 s26, 2
  s_cselect_b32 s3, s3, 0
  s_cmp_lg_u32 s76, 0
  s_cbranch_scc1 o_nofl_130
  s_and_b32 s26, s63, 49152
  s_cbranch_scc0 o_fl_131
  s_cmp_lg_u32 s64, 0
  s_cbranch_scc1 o_nofl_130
o_fl_131:
  s_cmp_ge_u32 s17, 2
  s_cbranch_scc1 o_fd_165
  s_cmp_eq_u32 s65, 0
  s_cbranch_scc1 o_fd_165
  s_mov_b32 s96, s42
  s_waitcnt vmcnt(0)
  s_mov_b64 exec, 1
  buffer_store_dword v38, off, s[4:7], s84 sc1
  s_mov_b64 exec, -1
  s_mov_b32 s84, 268435456
  s_lshl_b32 s97, s43, 14
  s_add_u32 s97, s97, s86
  buffer_load_dword v7, v255, s[4:7], s97 offen sc1
  s_mov_b32 s67, 0
  s_mov_b64 vcc, 0
  s_waitcnt vmcnt(0)
o_pl_167:
  v_and_b32 v7, 1, v7
  v_cmp_ne_u32 vcc, s96, v7
  s_cbranch_vccz o_pk_168
  buffer_load_dword v7, v255, s[4:7], s97 offen sc1
  s_add_u32 s67, s67, 1
  s_cmp_gt_u32 s67, 1048576
  s_cbranch_scc1 L_end
  s_waitcnt vmcnt(0)
  s_branch o_pl_167
o_pk_168:
  s_and_b32 s26, s65, 49152
  s_cbranch_scc1 o_f2_166
  s_lshl_b32 s94, s43, 14
  s_add_u32 s94, s94, s86
  buffer_load_dwordx4 v[120:123], v5, s[4:7], s94 offen offset:0 sc1
  buffer_load_dwordx4 v[124:127], v5, s[4:7], s94 offen offset:256 sc1
  buffer_load_dwordx4 v[128:131], v5, s[4:7], s94 offen offset:512 sc1
  buffer_load_dwordx4 v[132:135], v5, s[4:7], s94 offen offset:768 sc1
  s_add_u32 s94, s94, 4096
  buffer_load_dwordx4 v[136:139], v5, s[4:7], s94 offen offset:0 sc1
  buffer_load_dwordx4 v[140:143], v5, s[4:7], s94 offen offset:256 sc1
  buffer_load_dwordx4 v[144:147], v5, s[4:7], s94 offen offset:512 sc1
  buffer_load_dwordx4 v[148:151], v5, s[4:7], s94 offen offset:768 sc1
  s_add_u32 s94, s94, 4096
  buffer_load_dwordx4 v[152:155], v5, s[4:7], s94 offen offset:0 sc1
  buffer_load_dwordx4 v[156:159], v5, s[4:7], s94 offen offset:256 sc1
  buffer_load_dwordx4 v[160:163], v5, s[4:7], s94 offen offset:512 sc1
  buffer_load_dwordx4 v[164:167], v5, s[4:7], s94 offen offset:768 sc1
  s_add_u32 s94, s94, 4096
  buffer_load_dwordx4 v[168:171], v5, s[4:7], s94 offen offset:0 sc1
  buffer_load_dwordx4 v[172:175], v5, s[4:7], s94 offen offset:256 sc1
  buffer_load_dwordx4 v[176:179], v5, s[4:7], s94 offen offset:512 sc1
  buffer_load_dwordx4 v[180:183], v5, s[4:7], s94 offen offset:768 sc1
  s_and_b32 s91, s65, 63
  s_lshl_b32 s90, s91, 5
  s_add_u32 s90, s90, s43
  s_lshl_b32 s91, s90, 10
  buffer_load_dwordx4 v[184:187], v0, s[72:75], s91 offen
  s_waitcnt vmcnt(13)
  v_xor_b32 v7, s96, v120
  v_bitop3_b32 v7, v7, v124, s96 bitop3:0xf6
  v_bitop3_b32 v7, v7, v128, s96 bitop3:0xf6
  v_bitop3_b32 v7, v7, v132, s96 bitop3:0xf6
  s_waitcnt vmcnt(9)
  v_bitop3_b32 v7, v7, v136, s96 bitop3:0xf6
  v_bitop3_b32 v7, v7, v140, s96 bitop3:0xf6
  v_bitop3_b32 v7, v7, v144, s96 bitop3:0xf6
  v_bitop3_b32 v7, v7, v148, s96 bitop3:0xf6
  s_waitcnt vmcnt(5)
  v_bitop3_b32 v7, v7, v152, s96 bitop3:0xf6
  v_bitop3_b32 v7, v7, v156, s96 bitop3:0xf6
  v_bitop3_b32 v7, v7, v160, s96 bitop3:0xf6
  v_bitop3_b32 v7, v7, v164, s96 bitop3:0xf6
  s_waitcnt vmcnt(1)
  v_bitop3_b32 v7, v7, v168, s96 bitop3:0xf6
  v_bitop3_b32 v7, v7, v172, s96 bitop3:0xf6
  v_bitop3_b32 v7, v7, v176, s96 bitop3:0xf6
  v_bitop3_b32 v7, v7, v180, s96 bitop3:0xf6
  v_and_b32 v7, v254, v7
  v_cmp_ne_u32 vcc, 0, v7
  s_cbranch_vccnz o_rt_169
o_bk_170:
  v_mfma_f32_16x16x32_bf16 v[188:191], v[16:19], v[120:123], 0
  v_mfma_f32_16x16x32_bf16 v[192:195], v[16:19], v[124:127], 0
  v_mfma_f32_16x16x32_bf16 v[188:191], v[20:23], v[128:131], v[188:191]
  v_mfma_f32_16x16x32_bf16 v[192:195], v[20:23], v[132:135], v[192:195]
  v_mfma_f32_16x16x32_bf16 v[188:191], v[16:19], v[136:139], v[188:191]
  v_mfma_f32_16x16x32_bf16 v[192:195], v[16:19], v[140:143], v[192:195]
  v_mfma_f32_16x16x32_bf16 v[188:191], v[20:23], v[144:147], v[188:191]
  v_mfma_f32_16x16x32_bf16 v[192:195], v[20:23], v[148:151], v[192:195]
  v_mfma_f32_16x16x32_bf16 v[188:191], v[16:19], v[152:155], v[188:191]
  v_mfma_f32_16x16x32_bf16 v[192:195], v[16:19], v[156:159], v[192:195]
  v_mfma_f32_16x16x32_bf16 v[188:191], v[20:23], v[160:163], v[188:191]
  v_mfma_f32_16x16x32_bf16 v[192:195], v[20:23], v[164:167], v[192:195]
  v_mfma_f32_16x16x32_bf16 v[188:191], v[16:19], v[168:171], v[188:191]
  v_mfma_f32_16x16x32_bf16 v[192:195], v[16:19], v[172:175], v[192:195]
  v_mfma_f32_16x16x32_bf16 v[188:191], v[20:23], v[176:179], v[188:191]
  v_mfma_f32_16x16x32_bf16 v[192:195], v[20:23], v[180:183], v[192:195]
  s_bfe_u32 s92, s65, 131086
  s_lshl_b32 s92, s92, 21
  s_add_u32 s92, s92, s91
  s_add_u32 s93, s92, 27262976
  s_add_u32 s92, s92, 20971520
  s_waitcnt vmcnt(0)
  v_lshlrev_b32 v196, 16, v184
  v_and_b32 v197, 0xffff0000, v184
  v_lshlrev_b32 v198, 16, v185
  v_and_b32 v199, 0xffff0000, v185
  v_lshlrev_b32 v200, 16, v186
  v_and_b32 v201, 0xffff0000, v186
  v_lshlrev_b32 v202, 16, v187
  v_and_b32 v203, 0xffff0000, v187
  v_permlane16_swap_b32 v188, v192
  v_permlane16_swap_b32 v189, v193
  v_permlane16_swap_b32 v190, v194
  v_permlane16_swap_b32 v191, v195
  v_cvt_pk_bf16_f32 v188, 0, v188
  v_cvt_pk_bf16_f32 v189, 0, v189
  v_cvt_pk_bf16_f32 v190, 0, v190
  v_cvt_pk_bf16_f32 v191, 0, v191
  v_cvt_pk_bf16_f32 v192, 0, v192
  v_cvt_pk_bf16_f32 v193, 0, v193
  v_cvt_pk_bf16_f32 v194, 0, v194
  v_cvt_pk_bf16_f32 v195, 0, v195
  v_add_f32 v196, v196, v188
  v_add_f32 v197, v197, v189
  v_add_f32 v198, v198, v190
  v_add_f32 v199, v199, v191
  v_add_f32 v200, v200, v192
  v_add_f32 v201, v201, v193
  v_add_f32 v202, v202, v194
  v_add_f32 v203, v203, v195
  v_cvt_pk_bf16_f32 v120, v196, v197
  v_cvt_pk_bf16_f32 v121, v198, v199
  v_cvt_pk_bf16_f32 v122, v200, v201
  v_cvt_pk_bf16_f32 v123, v202, v203
  v_lshlrev_b32 v196, 16, v120
  v_and_b32 v197, 0xffff0000, v120
  v_lshlrev_b32 v198, 16, v121
  v_and_b32 v199, 0xffff0000, v121
  v_lshlrev_b32 v200, 16, v122
  v_and_b32 v201, 0xffff0000, v122
  v_lshlrev_b32 v202, 16, v123
  v_and_b32 v203, 0xffff0000, v123
  buffer_store_dwordx4 v[120:123], v0, s[4:7], s92 offen sc1
  v_add_f32 v136, v196, v197
  v_mul_f32 v137, v196, v196
  v_add_f32 v138, v198, v199
  v_mul_f32 v139, v197, v197
  v_fmac_f32 v137, v198, v198
  v_fmac_f32 v139, v199, v199
  v_add_f32 v136, v136, v200
  v_fmac_f32 v137, v200, v200
  v_add_f32 v138, v138, v201
  v_fmac_f32 v139, v201, v201
  v_add_f32 v136, v136, v202
  v_fmac_f32 v137, v202, v202
  v_add_f32 v138, v138, v203
  v_fmac_f32 v139, v203, v203
  v_add_f32 v136, v136, v138
  v_add_f32 v137, v137, v139
  s_nop 0
  v_add_f32_dpp v136, v136, v136 row_ror:8 row_mask:0xf bank_mask:0xf
  v_add_f32_dpp v137, v137, v137 row_ror:8 row_mask:0xf bank_mask:0xf
  s_nop 0
  v_add_f32_dpp v136, v136, v136 row_ror:4 row_mask:0xf bank_mask:0xf
  v_add_f32_dpp v137, v137, v137 row_ror:4 row_mask:0xf bank_mask:0xf
  s_nop 0
  v_add_f32_dpp v136, v136, v136 row_ror:2 row_mask:0xf bank_mask:0xf
  v_add_f32_dpp v137, v137, v137 row_ror:2 row_mask:0xf bank_mask:0xf
  s_nop 0
  v_add_f32_dpp v136, v136, v136 row_ror:1 row_mask:0xf bank_mask:0xf
  v_add_f32_dpp v137, v137, v137 row_ror:1 row_mask:0xf bank_mask:0xf
  v_mov_b32 v140, v136
  v_mov_b32 v141, v137
  s_nop 0
  v_permlane16_swap_b32 v136, v140
  v_permlane16_swap_b32 v137, v141
  v_add_f32 v136, v136, v140
  v_add_f32 v137, v137, v141
  v_mov_b32 v140, v136
  v_mov_b32 v141, v137
  s_nop 0
  v_permlane32_swap_b32 v136, v140
  v_permlane32_swap_b32 v137, v141
  v_add_f32 v136, v136, v140
  v_add_f32 v137, v137, v141
  v_mul_f32 v136, 0x3b000000, v136
  v_mul_f32 v137, 0x3b000000, v137
  v_fma_f32 v137, -v136, v136, v137
  v_cvt_pk_bf16_f32 v136, 0, v136
  v_max_f32 v137, 0, v137
  v_sub_f32 v140, v196, v136
  v_sub_f32 v141, v197, v136
  v_cvt_pk_bf16_f32 v137, 0, v137
  v_sub_f32 v142, v198, v136
  v_sub_f32 v143, v199, v136
  v_add_f32 v137, 0x3727c5ac, v137
  v_sub_f32 v144, v200, v136
  v_sub_f32 v145, v201, v136
  v_cvt_pk_bf16_f32 v137, 0, v137
  v_sub_f32 v146, v202, v136
  v_sub_f32 v147, v203, v136
  v_sqrt_f32 v137, v137
  v_cvt_pk_bf16_f32 v140, 0, v140
  v_cvt_pk_bf16_f32 v141, 0, v141
  v_cvt_pk_bf16_f32 v137, 0, v137
  v_cvt_pk_bf16_f32 v142, 0, v142
  v_cvt_pk_bf16_f32 v143, 0, v143
  v_rcp_f32 v137, v137
  v_cvt_pk_bf16_f32 v144, 0, v144
  v_cvt_pk_bf16_f32 v145, 0, v145
  v_cvt_pk_bf16_f32 v146, 0, v146
  v_cvt_pk_bf16_f32 v147, 0, v147
  v_mul_f32 v140, v140, v137
  v_mul_f32 v141, v141, v137
  v_mul_f32 v142, v142, v137
  v_mul_f32 v143, v143, v137
  v_mul_f32 v144, v144, v137
  v_mul_f32 v145, v145, v137
  v_mul_f32 v146, v146, v137
  v_mul_f32 v147, v147, v137
  v_cvt_pk_bf16_f32 v124, v140, v141
  v_cvt_pk_bf16_f32 v125, v142, v143
  v_cvt_pk_bf16_f32 v126, v144, v145
  v_cvt_pk_bf16_f32 v127, v146, v147
  v_lshlrev_b32 v204, 16, v124
  v_and_b32 v205, 0xffff0000, v124
  v_lshlrev_b32 v206, 16, v125
  v_and_b32 v207, 0xffff0000, v125
  v_lshlrev_b32 v208, 16, v126
  v_and_b32 v209, 0xffff0000, v126
  v_lshlrev_b32 v210, 16, v127
  v_and_b32 v211, 0xffff0000, v127
  buffer_store_dwordx4 v[124:127], v0, s[4:7], s93 offen sc1
  v_add_f32 v196, v196, v204
  v_add_f32 v197, v197, v205
  v_add_f32 v198, v198, v206
  v_add_f32 v199, v199, v207
  v_add_f32 v200, v200, v208
  v_add_f32 v201, v201, v209
  v_add_f32 v202, v202, v210
  v_add_f32 v203, v203, v211
  v_cvt_pk_bf16_f32 v128, v196, v197
  v_cvt_pk_bf16_f32 v129, v198, v199
  v_cvt_pk_bf16_f32 v130, v200, v201
  v_cvt_pk_bf16_f32 v131, v202, v203
  v_mul_f32 v188, v204, v8
  v_mul_f32 v189, v205, v9
  v_fmac_f32 v188, v206, v10
  v_fmac_f32 v189, v207, v11
  v_fmac_f32 v188, v208, v12
  v_fmac_f32 v189, v209, v13
  v_fmac_f32 v188, v210, v14
  v_fmac_f32 v189, v211, v15
  v_add_f32 v188, v188, v189
  s_add_u32 s92, s91, 10485760
  s_add_u32 s93, s91, 8388608
  buffer_store_dwordx4 v[128:131], v0, s[4:7], s92 offen sc1
  v_lshlrev_b32 v196, 16, v128
  v_and_b32 v197, 0xffff0000, v128
  v_lshlrev_b32 v198, 16, v129
  v_and_b32 v199, 0xffff0000, v129
  v_lshlrev_b32 v200, 16, v130
  v_and_b32 v201, 0xffff0000, v130
  v_lshlrev_b32 v202, 16, v131
  v_and_b32 v203, 0xffff0000, v131
  v_add_f32 v136, v196, v197
  v_mul_f32 v137, v196, v196
  v_add_f32 v138, v198, v199
  v_mul_f32 v139, v197, v197
  v_fmac_f32 v137, v198, v198
  v_fmac_f32 v139, v199, v199
  v_add_f32 v136, v136, v200
  v_fmac_f32 v137, v200, v200
  v_add_f32 v138, v138, v201
  v_fmac_f32 v139, v201, v201
  v_add_f32 v136, v136, v202
  v_fmac_f32 v137, v202, v202
  v_add_f32 v138, v138, v203
  v_fmac_f32 v139, v203, v203
  v_add_f32 v136, v136, v138
  v_add_f32 v137, v137, v139
  s_nop 0
  v_add_f32_dpp v136, v136, v136 row_ror:8 row_mask:0xf bank_mask:0xf
  v_add_f32_dpp v137, v137, v137 row_ror:8 row_mask:0xf bank_mask:0xf
  v_add_f32_dpp v188, v188, v188 row_ror:8 row_mask:0xf bank_mask:0xf
  v_add_f32_dpp v136, v136, v136 row_ror:4 row_mask:0xf bank_mask:0xf
  v_add_f32_dpp v137, v137, v137 row_ror:4 row_mask:0xf bank_mask:0xf
  v_add_f32_dpp v188, v188, v188 row_ror:4 row_mask:0xf bank_mask:0xf
  v_add_f32_dpp v136, v136, v136 row_ror:2 row_mask:0xf bank_mask:0xf
  v_add_f32_dpp v137, v137, v137 row_ror:2 row_mask:0xf bank_mask:0xf
  v_add_f32_dpp v188, v188, v188 row_ror:2 row_mask:0xf bank_mask:0xf
  v_add_f32_dpp v136, v136, v136 row_ror:1 row_mask:0xf bank_mask:0xf
  v_add_f32_dpp v137, v137, v137 row_ror:1 row_mask:0xf bank_mask:0xf
  v_add_f32_dpp v188, v188, v188 row_ror:1 row_mask:0xf bank_mask:0xf
  v_mov_b32 v140, v136
  v_mov_b32 v141, v137
  v_mov_b32 v142, v188
  v_permlane16_swap_b32 v136, v140
  v_permlane16_swap_b32 v137, v141
  v_permlane16_swap_b32 v188, v142
  v_add_f32 v136, v136, v140
  v_add_f32 v137, v137, v141
  v_add_f32 v188, v188, v142
  v_mov_b32 v140, v136
  v_mov_b32 v141, v137
  v_mov_b32 v142, v188
  v_permlane32_swap_b32 v136, v140
  v_permlane32_swap_b32 v137, v141
  v_permlane32_swap_b32 v188, v142
  v_add_f32 v136, v136, v140
  v_add_f32 v137, v137, v141
  v_add_f32 v188, v188, v142
  v_mul_f32 v136, 0x3b000000, v136
  v_mul_f32 v137, 0x3b000000, v137
  v_fma_f32 v137, -v136, v136, v137
  v_cvt_pk_bf16_f32 v136, 0, v136
  v_max_f32 v137, 0, v137
  v_sub_f32 v140, v196, v136
  v_sub_f32 v141, v197, v136
  v_cvt_pk_bf16_f32 v137, 0, v137
  v_sub_f32 v142, v198, v136
  v_sub_f32 v143, v199, v136
  v_add_f32 v137, 0x3727c5ac, v137
  v_sub_f32 v144, v200, v136
  v_sub_f32 v145, v201, v136
  v_cvt_pk_bf16_f32 v137, 0, v137
  v_sub_f32 v146, v202, v136
  v_sub_f32 v147, v203, v136
  v_sqrt_f32 v137, v137
  v_cvt_pk_bf16_f32 v140, 0, v140
  v_cvt_pk_bf16_f32 v141, 0, v141
  v_cvt_pk_bf16_f32 v137, 0, v137
  v_cvt_pk_bf16_f32 v142, 0, v142
  v_cvt_pk_bf16_f32 v143, 0, v143
  v_rcp_f32 v137, v137
  v_cvt_pk_bf16_f32 v144, 0, v144
  v_cvt_pk_bf16_f32 v145, 0, v145
  v_cvt_pk_bf16_f32 v146, 0, v146
  v_cvt_pk_bf16_f32 v147, 0, v147
  v_mul_f32 v140, v140, v137
  v_mul_f32 v141, v141, v137
  v_mul_f32 v142, v142, v137
  v_mul_f32 v143, v143, v137
  v_mul_f32 v144, v144, v137
  v_mul_f32 v145, v145, v137
  v_mul_f32 v146, v146, v137
  v_mul_f32 v147, v147, v137
  v_cvt_pk_bf16_f32 v132, v140, v141
  v_cvt_pk_bf16_f32 v133, v142, v143
  v_cvt_pk_bf16_f32 v134, v144, v145
  v_cvt_pk_bf16_f32 v135, v146, v147
  buffer_store_dwordx4 v[132:135], v0, s[4:7], s93 offen sc1
  v_cvt_pk_bf16_f32 v188, 0, v188
  v_ashrrev_i32 v189, 31, v188
  v_or_b32 v189, 0x80000000, v189
  v_xor_b32 v188, v188, v189
  s_sub_u32 s92, 4095, s90
  v_and_b32 v188, 0xffff0000, v188
  v_or_b32 v38, s92, v188
  s_bfe_u32 s92, s65, 196625
  s_lshl_b32 s92, s92, 18
  s_lshl_b32 s93, s90, 7
  s_add_u32 s92, s92, s93
  s_add_u32 s84, s92, 243269632
  s_waitcnt vmcnt(0)
  s_mov_b64 exec, 1
  buffer_store_dword v38, off, s[4:7], s84 sc1
  s_mov_b64 exec, -1
  s_mov_b32 s84, 268435456
  s_branch o_fd_165
o_rt_169:
  s_mov_b32 s67, 0
o_rl_171:
  s_lshl_b32 s94, s43, 14
  s_add_u32 s94, s94, s86
  buffer_load_dwordx4 v[120:123], v5, s[4:7], s94 offen offset:0 sc1
  buffer_load_dwordx4 v[124:127], v5, s[4:7], s94 offen offset:256 sc1
  buffer_load_dwordx4 v[128:131], v5, s[4:7], s94 offen offset:512 sc1
  buffer_load_dwordx4 v[132:135], v5, s[4:7], s94 offen offset:768 sc1
  s_add_u32 s94, s94, 4096
  buffer_load_dwordx4 v[136:139], v5, s[4:7], s94 offen offset:0 sc1
  buffer_load_dwordx4 v[140:143], v5, s[4:7], s94 offen offset:256 sc1
  buffer_load_dwordx4 v[144:147], v5, s[4:7], s94 offen offset:512 sc1
  buffer_load_dwordx4 v[148:151], v5, s[4:7], s94 offen offset:768 sc1
  s_add_u32 s94, s94, 4096
  buffer_load_dwordx4 v[152:155], v5, s[4:7], s94 offen offset:0 sc1
  buffer_load_dwordx4 v[156:159], v5, s[4:7], s94 offen offset:256 sc1
  buffer_load_dwordx4 v[160:163], v5, s[4:7], s94 offen offset:512 sc1
  buffer_load_dwordx4 v[164:167], v5, s[4:7], s94 offen offset:768 sc1
  s_add_u32 s94, s94, 4096
  buffer_load_dwordx4 v[168:171], v5, s[4:7], s94 offen offset:0 sc1
  buffer_load_dwordx4 v[172:175], v5, s[4:7], s94 offen offset:256 sc1
  buffer_load_dwordx4 v[176:179], v5, s[4:7], s94 offen offset:512 sc1
  buffer_load_dwordx4 v[180:183], v5, s[4:7], s94 offen offset:768 sc1
  s_add_u32 s67, s67, 1
  s_cmp_gt_u32 s67, 1048576
  s_cbranch_scc1 L_end
  s_waitcnt vmcnt(0)
  v_xor_b32 v7, s96, v120
  v_bitop3_b32 v7, v7, v124, s96 bitop3:0xf6
  v_bitop3_b32 v7, v7, v128, s96 bitop3:0xf6
  v_bitop3_b32 v7, v7, v132, s96 bitop3:0xf6
  v_bitop3_b32 v7, v7, v136, s96 bitop3:0xf6
  v_bitop3_b32 v7, v7, v140, s96 bitop3:0xf6
  v_bitop3_b32 v7, v7, v144, s96 bitop3:0xf6
  v_bitop3_b32 v7, v7, v148, s96 bitop3:0xf6
  v_bitop3_b32 v7, v7, v152, s96 bitop3:0xf6
  v_bitop3_b32 v7, v7, v156, s96 bitop3:0xf6
  v_bitop3_b32 v7, v7, v160, s96 bitop3:0xf6
  v_bitop3_b32 v7, v7, v164, s96 bitop3:0xf6
  v_bitop3_b32 v7, v7, v168, s96 bitop3:0xf6
  v_bitop3_b32 v7, v7, v172, s96 bitop3:0xf6
  v_bitop3_b32 v7, v7, v176, s96 bitop3:0xf6
  v_bitop3_b32 v7, v7, v180, s96 bitop3:0xf6
  v_and_b32 v7, v254, v7
  v_cmp_ne_u32 vcc, 0, v7
  s_cbranch_vccnz o_rl_171
  s_branch o_bk_170
o_f2_166:
  s_lshl_b32 s94, s43, 14
  s_add_u32 s94, s94, s86
  buffer_load_dwordx4 v[120:123], v5, s[4:7], s94 offen offset:0 sc1
  buffer_load_dwordx4 v[124:127], v5, s[4:7], s94 offen offset:256 sc1
  buffer_load_dwordx4 v[128:131], v5, s[4:7], s94 offen offset:512 sc1
  buffer_load_dwordx4 v[132:135], v5, s[4:7], s94 offen offset:768 sc1
  s_add_u32 s94, s94, 4096
  buffer_load_dwordx4 v[136:139], v5, s[4:7], s94 offen offset:0 sc1
  buffer_load_dwordx4 v[140:143], v5, s[4:7], s94 offen offset:256 sc1
  buffer_load_dwordx4 v[144:147], v5, s[4:7], s94 offen offset:512 sc1
  buffer_load_dwordx4 v[148:151], v5, s[4:7], s94 offen offset:768 sc1
  s_add_u32 s94, s94, 4096
  buffer_load_dwordx4 v[152:155], v5, s[4:7], s94 offen offset:0 sc1
  buffer_load_dwordx4 v[156:159], v5, s[4:7], s94 offen offset:256 sc1
  buffer_load_dwordx4 v[160:163], v5, s[4:7], s94 offen offset:512 sc1
  buffer_load_dwordx4 v[164:167], v5, s[4:7], s94 offen offset:768 sc1
  s_add_u32 s94, s94, 4096
  buffer_load_dwordx4 v[168:171], v5, s[4:7], s94 offen offset:0 sc1
  buffer_load_dwordx4 v[172:175], v5, s[4:7], s94 offen offset:256 sc1
  buffer_load_dwordx4 v[176:179], v5, s[4:7], s94 offen offset:512 sc1
  buffer_load_dwordx4 v[180:183], v5, s[4:7], s94 offen offset:768 sc1
  s_and_b32 s91, s65, 63
  s_lshl_b32 s90, s91, 5
  s_add_u32 s90, s90, s43
  s_lshl_b32 s94, s91, 5
  s_add_u32 s94, s94, s85
  s_lshl_b32 s94, s94, 10
  s_lshr_b32 s92, s65, 22
  s_xor_b32 s93, s43, 32
  s_lshl_b32 s91, s90, 10
  s_add_u32 s94, s94, 25165824
  s_cmp_eq_u32 s92, s93
  s_cselect_b32 s92, s94, s91
  s_add_u32 s92, s92, 10485760
  buffer_load_dwordx4 v[184:187], v0, s[4:7], s92 offen sc1
  s_waitcnt vmcnt(13)
  v_xor_b32 v7, s96, v120
  v_bitop3_b32 v7, v7, v124, s96 bitop3:0xf6
  v_bitop3_b32 v7, v7, v128, s96 bitop3:0xf6
  v_bitop3_b32 v7, v7, v132, s96 bitop3:0xf6
  s_waitcnt vmcnt(9)
  v_bitop3_b32 v7, v7, v136, s96 bitop3:0xf6
  v_bitop3_b32 v7, v7, v140, s96 bitop3:0xf6
  v_bitop3_b32 v7, v7, v144, s96 bitop3:0xf6
  v_bitop3_b32 v7, v7, v148, s96 bitop3:0xf6
  s_waitcnt vmcnt(5)
  v_bitop3_b32 v7, v7, v152, s96 bitop3:0xf6
  v_bitop3_b32 v7, v7, v156, s96 bitop3:0xf6
  v_bitop3_b32 v7, v7, v160, s96 bitop3:0xf6
  v_bitop3_b32 v7, v7, v164, s96 bitop3:0xf6
  s_waitcnt vmcnt(1)
  v_bitop3_b32 v7, v7, v168, s96 bitop3:0xf6
  v_bitop3_b32 v7, v7, v172, s96 bitop3:0xf6
  v_bitop3_b32 v7, v7, v176, s96 bitop3:0xf6
  v_bitop3_b32 v7, v7, v180, s96 bitop3:0xf6
  v_and_b32 v7, v254, v7
  v_cmp_ne_u32 vcc, 0, v7
  s_cbranch_vccnz o_rt_172
o_bk_173:
  v_mfma_f32_16x16x32_bf16 v[188:191], v[16:19], v[120:123], 0
  v_mfma_f32_16x16x32_bf16 v[192:195], v[16:19], v[124:127], 0
  v_mfma_f32_16x16x32_bf16 v[188:191], v[20:23], v[128:131], v[188:191]
  v_mfma_f32_16x16x32_bf16 v[192:195], v[20:23], v[132:135], v[192:195]
  v_mfma_f32_16x16x32_bf16 v[188:191], v[16:19], v[136:139], v[188:191]
  v_mfma_f32_16x16x32_bf16 v[192:195], v[16:19], v[140:143], v[192:195]
  v_mfma_f32_16x16x32_bf16 v[188:191], v[20:23], v[144:147], v[188:191]
  v_mfma_f32_16x16x32_bf16 v[192:195], v[20:23], v[148:151], v[192:195]
  v_mfma_f32_16x16x32_bf16 v[188:191], v[16:19], v[152:155], v[188:191]
  v_mfma_f32_16x16x32_bf16 v[192:195], v[16:19], v[156:159], v[192:195]
  v_mfma_f32_16x16x32_bf16 v[188:191], v[20:23], v[160:163], v[188:191]
  v_mfma_f32_16x16x32_bf16 v[192:195], v[20:23], v[164:167], v[192:195]
  v_mfma_f32_16x16x32_bf16 v[188:191], v[16:19], v[168:171], v[188:191]
  v_mfma_f32_16x16x32_bf16 v[192:195], v[16:19], v[172:175], v[192:195]
  v_mfma_f32_16x16x32_bf16 v[188:191], v[20:23], v[176:179], v[188:191]
  v_mfma_f32_16x16x32_bf16 v[192:195], v[20:23], v[180:183], v[192:195]
  s_bfe_u32 s92, s65, 131086
  s_lshl_b32 s92, s92, 21
  s_add_u32 s92, s92, s91
  s_add_u32 s93, s92, 27262976
  s_add_u32 s92, s92, 20971520
  s_waitcnt vmcnt(0)
  v_lshlrev_b32 v196, 16, v184
  v_and_b32 v197, 0xffff0000, v184
  v_lshlrev_b32 v198, 16, v185
  v_and_b32 v199, 0xffff0000, v185
  v_lshlrev_b32 v200, 16, v186
  v_and_b32 v201, 0xffff0000, v186
  v_lshlrev_b32 v202, 16, v187
  v_and_b32 v203, 0xffff0000, v187
  v_permlane16_swap_b32 v188, v192
  v_permlane16_swap_b32 v189, v193
  v_permlane16_swap_b32 v190, v194
  v_permlane16_swap_b32 v191, v195
  v_cvt_pk_bf16_f32 v188, 0, v188
  v_cvt_pk_bf16_f32 v189, 0, v189
  v_cvt_pk_bf16_f32 v190, 0, v190
  v_cvt_pk_bf16_f32 v191, 0, v191
  v_cvt_pk_bf16_f32 v192, 0, v192
  v_cvt_pk_bf16_f32 v193, 0, v193
  v_cvt_pk_bf16_f32 v194, 0, v194
  v_cvt_pk_bf16_f32 v195, 0, v195
  v_add_f32 v196, v196, v188
  v_add_f32 v197, v197, v189
  v_add_f32 v198, v198, v190
  v_add_f32 v199, v199, v191
  v_add_f32 v200, v200, v192
  v_add_f32 v201, v201, v193
  v_add_f32 v202, v202, v194
  v_add_f32 v203, v203, v195
  v_cvt_pk_bf16_f32 v120, v196, v197
  v_cvt_pk_bf16_f32 v121, v198, v199
  v_cvt_pk_bf16_f32 v122, v200, v201
  v_cvt_pk_bf16_f32 v123, v202, v203
  v_lshlrev_b32 v196, 16, v120
  v_and_b32 v197, 0xffff0000, v120
  v_lshlrev_b32 v198, 16, v121
  v_and_b32 v199, 0xffff0000, v121
  v_lshlrev_b32 v200, 16, v122
  v_and_b32 v201, 0xffff0000, v122
  v_lshlrev_b32 v202, 16, v123
  v_and_b32 v203, 0xffff0000, v123
  buffer_store_dwordx4 v[120:123], v0, s[4:7], s92 offen sc1
  v_add_f32 v136, v196, v197
  v_mul_f32 v137, v196, v196
  v_add_f32 v138, v198, v199
  v_mul_f32 v139, v197, v197
  v_fmac_f32 v137, v198, v198
  v_fmac_f32 v139, v199, v199
  v_add_f32 v136, v136, v200
  v_fmac_f32 v137, v200, v200
  v_add_f32 v138, v138, v201
  v_fmac_f32 v139, v201, v201
  v_add_f32 v136, v136, v202
  v_fmac_f32 v137, v202, v202
  v_add_f32 v138, v138, v203
  v_fmac_f32 v139, v203, v203
  v_add_f32 v136, v136, v138
  v_add_f32 v137, v137, v139
  s_nop 0
  v_add_f32_dpp v136, v136, v136 row_ror:8 row_mask:0xf bank_mask:0xf
  v_add_f32_dpp v137, v137, v137 row_ror:8 row_mask:0xf bank_mask:0xf
  s_nop 0
  v_add_f32_dpp v136, v136, v136 row_ror:4 row_mask:0xf bank_mask:0xf
  v_add_f32_dpp v137, v137, v137 row_ror:4 row_mask:0xf bank_mask:0xf
  s_nop 0
  v_add_f32_dpp v136, v136, v136 row_ror:2 row_mask:0xf bank_mask:0xf
  v_add_f32_dpp v137, v137, v137 row_ror:2 row_mask:0xf bank_mask:0xf
  s_nop 0
  v_add_f32_dpp v136, v136, v136 row_ror:1 row_mask:0xf bank_mask:0xf
  v_add_f32_dpp v137, v137, v137 row_ror:1 row_mask:0xf bank_mask:0xf
  v_mov_b32 v140, v136
  v_mov_b32 v141, v137
  s_nop 0
  v_permlane16_swap_b32 v136, v140
  v_permlane16_swap_b32 v137, v141
  v_add_f32 v136, v136, v140
  v_add_f32 v137, v137, v141
  v_mov_b32 v140, v136
  v_mov_b32 v141, v137
  s_nop 0
  v_permlane32_swap_b32 v136, v140
  v_permlane32_swap_b32 v137, v141
  v_add_f32 v136, v136, v140
  v_add_f32 v137, v137, v141
  v_mul_f32 v136, 0x3b000000, v136
  v_mul_f32 v137, 0x3b000000, v137
  v_fma_f32 v137, -v136, v136, v137
  v_cvt_pk_bf16_f32 v136, 0, v136
  v_max_f32 v137, 0, v137
  v_sub_f32 v140, v196, v136
  v_sub_f32 v141, v197, v136
  v_cvt_pk_bf16_f32 v137, 0, v137
  v_sub_f32 v142, v198, v136
  v_sub_f32 v143, v199, v136
  v_add_f32 v137, 0x3727c5ac, v137
  v_sub_f32 v144, v200, v136
  v_sub_f32 v145, v201, v136
  v_cvt_pk_bf16_f32 v137, 0, v137
  v_sub_f32 v146, v202, v136
  v_sub_f32 v147, v203, v136
  v_sqrt_f32 v137, v137
  v_cvt_pk_bf16_f32 v140, 0, v140
  v_cvt_pk_bf16_f32 v141, 0, v141
  v_cvt_pk_bf16_f32 v137, 0, v137
  v_cvt_pk_bf16_f32 v142, 0, v142
  v_cvt_pk_bf16_f32 v143, 0, v143
  v_rcp_f32 v137, v137
  v_cvt_pk_bf16_f32 v144, 0, v144
  v_cvt_pk_bf16_f32 v145, 0, v145
  v_cvt_pk_bf16_f32 v146, 0, v146
  v_cvt_pk_bf16_f32 v147, 0, v147
  v_mul_f32 v140, v140, v137
  v_mul_f32 v141, v141, v137
  v_mul_f32 v142, v142, v137
  v_mul_f32 v143, v143, v137
  v_mul_f32 v144, v144, v137
  v_mul_f32 v145, v145, v137
  v_mul_f32 v146, v146, v137
  v_mul_f32 v147, v147, v137
  v_cvt_pk_bf16_f32 v124, v140, v141
  v_cvt_pk_bf16_f32 v125, v142, v143
  v_cvt_pk_bf16_f32 v126, v144, v145
  v_cvt_pk_bf16_f32 v127, v146, v147
  v_lshlrev_b32 v204, 16, v124
  v_and_b32 v205, 0xffff0000, v124
  v_lshlrev_b32 v206, 16, v125
  v_and_b32 v207, 0xffff0000, v125
  v_lshlrev_b32 v208, 16, v126
  v_and_b32 v209, 0xffff0000, v126
  v_lshlrev_b32 v210, 16, v127
  v_and_b32 v211, 0xffff0000, v127
  buffer_store_dwordx4 v[124:127], v0, s[4:7], s93 offen sc1
  v_add_f32 v196, v196, v204
  v_add_f32 v197, v197, v205
  v_add_f32 v198, v198, v206
  v_add_f32 v199, v199, v207
  v_add_f32 v200, v200, v208
  v_add_f32 v201, v201, v209
  v_add_f32 v202, v202, v210
  v_add_f32 v203, v203, v211
  v_cvt_pk_bf16_f32 v128, v196, v197
  v_cvt_pk_bf16_f32 v129, v198, v199
  v_cvt_pk_bf16_f32 v130, v200, v201
  v_cvt_pk_bf16_f32 v131, v202, v203
  v_mul_f32 v188, v204, v8
  v_mul_f32 v189, v205, v9
  v_fmac_f32 v188, v206, v10
  v_fmac_f32 v189, v207, v11
  v_fmac_f32 v188, v208, v12
  v_fmac_f32 v189, v209, v13
  v_fmac_f32 v188, v210, v14
  v_fmac_f32 v189, v211, v15
  v_add_f32 v188, v188, v189
  buffer_store_dwordx4 v[128:131], v0, s[68:71], s91 offen sc1
  s_nop 0
  v_add_f32_dpp v188, v188, v188 row_ror:8 row_mask:0xf bank_mask:0xf
  s_nop 1
  v_add_f32_dpp v188, v188, v188 row_ror:4 row_mask:0xf bank_mask:0xf
  s_nop 1
  v_add_f32_dpp v188, v188, v188 row_ror:2 row_mask:0xf bank_mask:0xf
  s_nop 1
  v_add_f32_dpp v188, v188, v188 row_ror:1 row_mask:0xf bank_mask:0xf
  v_mov_b32 v189, v188
  s_nop 0
  s_nop 0
  v_permlane16_swap_b32 v188, v189
  v_add_f32 v188, v188, v189
  v_mov_b32 v189, v188
  s_nop 0
  s_nop 0
  v_permlane32_swap_b32 v188, v189
  v_add_f32 v188, v188, v189
  v_cvt_pk_bf16_f32 v188, 0, v188
  v_ashrrev_i32 v189, 31, v188
  v_or_b32 v189, 0x80000000, v189
  v_xor_b32 v188, v188, v189
  s_sub_u32 s92, 4095, s90
  v_and_b32 v188, 0xffff0000, v188
  v_or_b32 v38, s92, v188
  s_bfe_u32 s92, s65, 196625
  s_lshl_b32 s92, s92, 18
  s_lshl_b32 s93, s90, 7
  s_add_u32 s92, s92, s93
  s_add_u32 s84, s92, 243269632
  s_waitcnt vmcnt(0)
  s_mov_b64 exec, 1
  buffer_store_dword v38, off, s[4:7], s84 sc1
  s_mov_b64 exec, -1
  s_mov_b32 s84, 268435456
  s_branch o_fd_165
o_rt_172:
  s_mov_b32 s67, 0
o_rl_174:
  s_lshl_b32 s94, s43, 14
  s_add_u32 s94, s94, s86
  buffer_load_dwordx4 v[120:123], v5, s[4:7], s94 offen offset:0 sc1
  buffer_load_dwordx4 v[124:127], v5, s[4:7], s94 offen offset:256 sc1
  buffer_load_dwordx4 v[128:131], v5, s[4:7], s94 offen offset:512 sc1
  buffer_load_dwordx4 v[132:135], v5, s[4:7], s94 offen offset:768 sc1
  s_add_u32 s94, s94, 4096
  buffer_load_dwordx4 v[136:139], v5, s[4:7], s94 offen offset:0 sc1
  buffer_load_dwordx4 v[140:143], v5, s[4:7], s94 offen offset:256 sc1
  buffer_load_dwordx4 v[144:147], v5, s[4:7], s94 offen offset:512 sc1
  buffer_load_dwordx4 v[148:151], v5, s[4:7], s94 offen offset:768 sc1
  s_add_u32 s94, s94, 4096
  buffer_load_dwordx4 v[152:155], v5, s[4:7], s94 offen offset:0 sc1
  buffer_load_dwordx4 v[156:159], v5, s[4:7], s94 offen offset:256 sc1
  buffer_load_dwordx4 v[160:163], v5, s[4:7], s94 offen offset:512 sc1
  buffer_load_dwordx4 v[164:167], v5, s[4:7], s94 offen offset:768 sc1
  s_add_u32 s94, s94, 4096
  buffer_load_dwordx4 v[168:171], v5, s[4:7], s94 offen offset:0 sc1
  buffer_load_dwordx4 v[172:175], v5, s[4:7], s94 offen offset:256 sc1
  buffer_load_dwordx4 v[176:179], v5, s[4:7], s94 offen offset:512 sc1
  buffer_load_dwordx4 v[180:183], v5, s[4:7], s94 offen offset:768 sc1
  s_add_u32 s67, s67, 1
  s_cmp_gt_u32 s67, 1048576
  s_cbranch_scc1 L_end
  s_waitcnt vmcnt(0)
  v_xor_b32 v7, s96, v120
  v_bitop3_b32 v7, v7, v124, s96 bitop3:0xf6
  v_bitop3_b32 v7, v7, v128, s96 bitop3:0xf6
  v_bitop3_b32 v7, v7, v132, s96 bitop3:0xf6
  v_bitop3_b32 v7, v7, v136, s96 bitop3:0xf6
  v_bitop3_b32 v7, v7, v140, s96 bitop3:0xf6
  v_bitop3_b32 v7, v7, v144, s96 bitop3:0xf6
  v_bitop3_b32 v7, v7, v148, s96 bitop3:0xf6
  v_bitop3_b32 v7, v7, v152, s96 bitop3:0xf6
  v_bitop3_b32 v7, v7, v156, s96 bitop3:0xf6
  v_bitop3_b32 v7, v7, v160, s96 bitop3:0xf6
  v_bitop3_b32 v7, v7, v164, s96 bitop3:0xf6
  v_bitop3_b32 v7, v7, v168, s96 bitop3:0xf6
  v_bitop3_b32 v7, v7, v172, s96 bitop3:0xf6
  v_bitop3_b32 v7, v7, v176, s96 bitop3:0xf6
  v_bitop3_b32 v7, v7, v180, s96 bitop3:0xf6
  v_and_b32 v7, v254, v7
  v_cmp_ne_u32 vcc, 0, v7
  s_cbranch_vccnz o_rl_174
  s_branch o_bk_173
o_fd_165:
  s_mov_b32 s65, 0
o_nofl_130:
  s_mov_b32 s63, s64
  s_cmp_lg_u32 s51, 0
  s_cbranch_scc1 o_pick_132
  s_cmp_eq_u32 s50, 0
  s_cbranch_scc1 L_end
o_adv_138:
  s_add_u32 s49, s49, 4
  s_branch o_round_128

.section .rodata,"a"
.p2align 6
.amdhsa_kernel interleave_layers__memory_aug_recurrent_mem_tr__moe_arch_mod__prompt_kernel
  .amdhsa_next_free_vgpr 512
  .amdhsa_next_free_sgpr 102
  .amdhsa_accum_offset 256
  .amdhsa_group_segment_fixed_size 0
  .amdhsa_kernarg_size 120
  .amdhsa_user_sgpr_count 2
  .amdhsa_user_sgpr_kernarg_segment_ptr 1
  .amdhsa_system_sgpr_workgroup_id_x 1
  .amdhsa_float_denorm_mode_32 3
.end_amdhsa_kernel
```

```asm
; @launch grid=(256,1,1) block=(256,1,1) lds=163840
.amdgcn_target "amdgcn-amd-amdhsa--gfx950"
.text
.globl interleave_layers__memory_aug_recurrent_mem_tr__moe_arch_mod__prompt_kernel
.p2align 8
.type interleave_layers__memory_aug_recurrent_mem_tr__moe_arch_mod__prompt_kernel,@function
interleave_layers__memory_aug_recurrent_mem_tr__moe_arch_mod__prompt_kernel:
  s_cmp_ge_u32 s2, 256
  s_cbranch_scc1 L_end
  s_mov_b32 s6, 268435456
  s_mov_b32 s7, 0x20000
  s_mov_b32 s11, 0x20000
  s_getreg_b32 s89, hwreg(HW_REG_XCC_ID)
  s_and_b32 s89, s89, 7
  v_lshrrev_b32 v1, 6, v0
  s_and_b32 s91, s2, 7
  s_lshr_b32 s90, s2, 3
  v_readfirstlane_b32 s17, v1
  s_lshl_b32 s100, s91, 5
  s_add_u32 s100, s100, s90
  s_lshl_b32 s100, s100, 2
  s_add_u32 s100, s100, s17
  s_lshl_b32 s100, s100, 12
  s_add_u32 s100, s100, 37748736
  s_cmp_lt_u32 s91, 3
  s_cbranch_scc1 L_chain
  s_cmp_eq_u32 s91, 7
  s_cbranch_scc1 L_qkv
  s_bitcmp1_b32 s90, 4
  s_cbranch_scc1 L_qkv
  s_branch L_o
L_end:
  s_endpgm
L_chain:
  s_load_dwordx2 s[4:5], s[0:1], 112
  s_load_dwordx2 s[12:13], s[0:1], 104
  s_mov_b32 s16, s90
  s_mov_b32 s60, s91
  s_min_u32 s61, s91, 1
  v_lshrrev_b32 v18, 6, v0
  v_and_b32 v19, 63, v0
  v_readfirstlane_b32 s17, v18
  v_and_b32 v7, 15, v19
  v_lshrrev_b32 v17, 4, v19
  v_lshlrev_b32 v0, 4, v19
  s_load_dwordx2 s[56:57], s[0:1], 8
  s_mov_b32 s44, 0x05040100
  s_mov_b32 s45, 0x07060302
  s_mov_b32 s18, 0xcccccccc
  s_mov_b32 s19, 0xcccccccc
  s_mov_b32 s24, 0x3e0293ee
  s_lshl_b32 s26, s17, 10
  v_add_u32 v8, s26, v0
  v_xor_b32 v9, 1024, v8
  v_xor_b32 v10, 2048, v8
  v_xor_b32 v11, 3072, v8
  s_mov_b32 s14, 0x3f803f80
  s_mov_b32 s15, 0x3f803f80
  s_mul_i32 s27, s17, 24576
  s_add_u32 s27, s27, 65536
  v_add_u32 v1, s27, v0
  v_lshrrev_b32 v20, 2, v7
  v_xor_b32 v21, v17, v20
  v_lshlrev_b32 v22, 5, v7
  v_add_u32 v22, s26, v22
  v_lshl_add_u32 v2, v21, 3, v22
  v_and_b32 v21, 3, v7
  v_xor_b32 v21, v21, v17
  v_lshl_add_u32 v22, v17, 2, v20
  v_lshlrev_b32 v22, 5, v22
  v_lshl_add_u32 v3, v21, 3, v22
  v_add_u32 v12, s26, v3
  v_xor_b32 v13, 1024, v12
  v_xor_b32 v14, 2048, v12
  v_xor_b32 v15, 3072, v12
  v_lshlrev_b32 v21, 13, v20
  v_and_b32 v22, 3, v7
  v_lshl_add_u32 v22, v17, 2, v22
  v_lshl_add_u32 v21, v22, 4, v21
  s_lshl_b32 s27, s17, 16
  s_lshl_b32 s28, s16, 8
  s_add_u32 s27, s27, s28
  v_add_u32 v4, s27, v21
  v_and_b32 v21, 1, v7
  v_lshl_add_u32 v21, v17, 2, v21
  v_bfe_u32 v22, v7, 2, 1
  v_lshl_add_u32 v21, v22, 1, v21
  v_lshlrev_b32 v21, 4, v21
  v_bfe_u32 v22, v7, 1, 1
  v_lshl_add_u32 v21, v22, 3, v21
  v_add_u32 v5, s28, v21
  v_cmp_lt_u32 vcc, 7, v7
  v_mov_b32 v22, 0x7ff00000
  s_nop 0
  v_cndmask_b32 v5, v5, v22, vcc
  v_mov_b32 v21, 0x4444
  v_mov_b32 v22, 0xeeee
  v_cndmask_b32 v6, v21, v22, s[18:19]
  s_lshl_b32 s40, s60, 20
  s_add_u32 s40, s40, 0
  s_add_u32 s41, s40, 32768
  s_lshl_b32 s62, s60, 16
  s_add_u32 s62, s62, 4194304
  v_mov_b32 v24, -1
  v_mov_b32 v25, -1
  v_mov_b32 v26, -1
  v_mov_b32 v27, -1
  s_waitcnt lgkmcnt(0)
  buffer_store_dwordx4 v[24:27], v4, s[4:7], s40 offen sc1
  buffer_store_dwordx4 v[24:27], v4, s[4:7], s41 offen sc1
  s_add_u32 s27, s62, 0
  buffer_store_dwordx2 v[24:25], v5, s[4:7], s27 offen sc1
  s_add_u32 s27, s62, 8192
  buffer_store_dwordx2 v[24:25], v5, s[4:7], s27 offen sc1
  s_add_u32 s27, s62, 16384
  buffer_store_dwordx2 v[24:25], v5, s[4:7], s27 offen sc1
  s_lshl_b32 s26, s16, 12
  s_cmp_eq_u32 s91, 0
  s_cbranch_scc1 L_ch0
  s_cmp_eq_u32 s91, 2
  s_cbranch_scc1 L_ch2
  v_mov_b64 v[28:29], 0
  v_mov_b64 v[30:31], 0
  s_add_u32 s27, s26, 243269632
  buffer_store_dwordx4 v[28:31], v8, s[4:7], s27 offen sc1
  s_add_u32 s27, s26, 243400704
  buffer_store_dwordx4 v[28:31], v8, s[4:7], s27 offen sc1
  s_add_u32 s27, s26, 243531776
  buffer_store_dwordx4 v[28:31], v8, s[4:7], s27 offen sc1
  s_add_u32 s27, s26, 243662848
  buffer_store_dwordx4 v[28:31], v8, s[4:7], s27 offen sc1
  s_add_u32 s27, s26, 243793920
  buffer_store_dwordx4 v[28:31], v8, s[4:7], s27 offen sc1
  s_add_u32 s27, s26, 243924992
  buffer_store_dwordx4 v[28:31], v8, s[4:7], s27 offen sc1
  s_add_u32 s27, s26, 244056064
  buffer_store_dwordx4 v[28:31], v8, s[4:7], s27 offen sc1
  s_add_u32 s27, s26, 244187136
  buffer_store_dwordx4 v[28:31], v8, s[4:7], s27 offen sc1
  s_add_u32 s27, s26, 244318208
  buffer_store_dwordx4 v[28:31], v8, s[4:7], s27 offen sc1
  s_add_u32 s27, s26, 244449280
  buffer_store_dwordx4 v[28:31], v8, s[4:7], s27 offen sc1
  s_add_u32 s27, s26, 244580352
  buffer_store_dwordx4 v[28:31], v8, s[4:7], s27 offen sc1
  s_add_u32 s27, s26, 244711424
  buffer_store_dwordx4 v[28:31], v8, s[4:7], s27 offen sc1
  s_add_u32 s27, s26, 244842496
  buffer_store_dwordx4 v[28:31], v8, s[4:7], s27 offen sc1
  s_add_u32 s27, s26, 244973568
  buffer_store_dwordx4 v[28:31], v8, s[4:7], s27 offen sc1
  s_add_u32 s27, s26, 245104640
  buffer_store_dwordx4 v[28:31], v8, s[4:7], s27 offen sc1
  s_add_u32 s27, s26, 245235712
  buffer_store_dwordx4 v[28:31], v8, s[4:7], s27 offen sc1
  s_add_u32 s27, s26, 245366784
  buffer_store_dwordx4 v[28:31], v8, s[4:7], s27 offen sc1
  s_branch L_ch0
L_ch2:
  s_add_u32 s27, s26, 245891072
  buffer_store_dwordx4 v[24:27], v8, s[4:7], s27 offen sc1
  s_add_u32 s27, s26, 246022144
  buffer_store_dwordx4 v[24:27], v8, s[4:7], s27 offen sc1
  s_add_u32 s27, s26, 246153216
  buffer_store_dwordx4 v[24:27], v8, s[4:7], s27 offen sc1
  s_add_u32 s27, s26, 246284288
  buffer_store_dwordx4 v[24:27], v8, s[4:7], s27 offen sc1
  s_add_u32 s27, s26, 246415360
  buffer_store_dwordx4 v[24:27], v8, s[4:7], s27 offen sc1
  s_add_u32 s27, s26, 246546432
  buffer_store_dwordx4 v[24:27], v8, s[4:7], s27 offen sc1
  s_add_u32 s27, s26, 246677504
  buffer_store_dwordx4 v[24:27], v8, s[4:7], s27 offen sc1
  s_add_u32 s27, s26, 246808576
  buffer_store_dwordx4 v[24:27], v8, s[4:7], s27 offen sc1
  s_add_u32 s27, s26, 246939648
  buffer_store_dwordx4 v[24:27], v8, s[4:7], s27 offen sc1
  s_add_u32 s27, s26, 247070720
  buffer_store_dwordx4 v[24:27], v8, s[4:7], s27 offen sc1
  s_add_u32 s27, s26, 247201792
  buffer_store_dwordx4 v[24:27], v8, s[4:7], s27 offen sc1
  s_add_u32 s27, s26, 247332864
  buffer_store_dwordx4 v[24:27], v8, s[4:7], s27 offen sc1
  s_add_u32 s27, s26, 247463936
  buffer_store_dwordx4 v[24:27], v8, s[4:7], s27 offen sc1
  s_add_u32 s27, s26, 247595008
  buffer_store_dwordx4 v[24:27], v8, s[4:7], s27 offen sc1
  s_add_u32 s27, s26, 247726080
  buffer_store_dwordx4 v[24:27], v8, s[4:7], s27 offen sc1
  s_add_u32 s27, s26, 247857152
  buffer_store_dwordx4 v[24:27], v8, s[4:7], s27 offen sc1
  s_add_u32 s27, s26, 247988224
  buffer_store_dwordx4 v[24:27], v8, s[4:7], s27 offen sc1
  s_add_u32 s27, s26, 248119296
  buffer_store_dwordx4 v[24:27], v8, s[4:7], s27 offen sc1
  s_add_u32 s27, s26, 248250368
  buffer_store_dwordx4 v[24:27], v8, s[4:7], s27 offen sc1
  s_add_u32 s27, s26, 248381440
  buffer_store_dwordx4 v[24:27], v8, s[4:7], s27 offen sc1
  s_add_u32 s27, s26, 248512512
  buffer_store_dwordx4 v[24:27], v8, s[4:7], s27 offen sc1
  s_add_u32 s27, s26, 248643584
  buffer_store_dwordx4 v[24:27], v8, s[4:7], s27 offen sc1
L_ch0:
  s_waitcnt vmcnt(0)
  s_barrier
  s_cmp_lg_u32 s17, 0
  s_cbranch_scc1 g_ar_1
  s_lshl_b32 s36, s89, 3
  s_lshl_b64 s[36:37], 1, s36
  v_lshlrev_b32 v124, 3, s91
  v_mov_b32 v120, s36
  v_mov_b32 v121, s37
  s_mov_b64 exec, 1
  global_atomic_add_x2 v[122:123], v124, v[120:121], s[12:13] sc0
  s_mov_b64 exec, -1
g_ar_1:
  s_cmp_lg_u32 s91, 1
  s_cbranch_scc1 L_ch1
  s_waitcnt vmcnt(0)
  s_cmp_lg_u32 s17, 0
  s_cbranch_scc1 g_af_2
  v_readfirstlane_b32 s36, v122
  v_readfirstlane_b32 s37, v123
  s_add_u32 s38, s36, s37
  s_mul_i32 s38, s38, 0x01010101
  s_lshr_b32 s38, s38, 24
  s_cmp_lg_u32 s38, 31
  s_cbranch_scc1 g_af_2
  s_lshl_b32 s38, s89, 3
  s_lshr_b64 s[36:37], s[36:37], s38
  s_and_b32 s36, s36, 0xff
  s_cmp_eq_u32 s36, 31
  s_cselect_b32 s36, 1, 2
  v_mov_b32 v120, s36
  v_lshrrev_b32 v124, 1, v124
  s_mov_b64 exec, 1
  global_store_dword v124, v120, s[12:13] offset:128 sc1
  s_mov_b64 exec, -1
g_af_2:
  v_mov_b64 v[122:123], 0
L_ch1:
  s_mov_b32 s58, 8192
  s_mov_b32 s59, 0x20000
  v_and_b32 v21, 1, v7
  v_lshl_add_u32 v21, v17, 1, v21
  v_lshlrev_b32 v21, 10, v21
  v_bfe_u32 v22, v7, 1, 2
  v_lshl_add_u32 v21, v22, 1, v21
  s_lshr_b32 s27, s16, 3
  s_lshl_b32 s27, s27, 8
  s_and_b32 s28, s16, 3
  s_lshl_b32 s28, s28, 6
  s_add_u32 s27, s27, s28
  s_and_b32 s28, s16, 4
  s_lshl_b32 s28, s28, 1
  s_add_u32 s27, s27, s28
  s_waitcnt lgkmcnt(0)
  buffer_load_ushort v28, v21, s[56:59], s27 offen offset:0
  buffer_load_ushort v29, v21, s[56:59], s27 offen offset:16
  buffer_load_ushort v30, v21, s[56:59], s27 offen offset:32
  buffer_load_ushort v31, v21, s[56:59], s27 offen offset:48
  s_load_dwordx2 s[8:9], s[0:1], 40
  s_load_dwordx2 s[52:53], s[0:1], 16
  s_load_dwordx2 s[32:33], s[0:1], 24
  s_load_dwordx2 s[48:49], s[0:1], 32
  s_mov_b32 s10, 4194304
  s_mov_b32 s11, 0x20000
  s_mov_b32 s54, 4194304
  s_mov_b32 s55, 0x20000
  s_mov_b32 s34, 4194304
  s_mov_b32 s35, 0x20000
  s_mov_b32 s50, 4194304
  s_mov_b32 s51, 0x20000
  v_and_b32 v20, 1, v17
  v_lshlrev_b32 v20, 5, v20
  v_lshrrev_b32 v21, 1, v17
  v_lshl_add_u32 v20, v21, 2, v20
  v_lshlrev_b32 v20, 10, v20
  v_lshl_add_u32 v20, v7, 4, v20
  s_lshl_b32 s26, s16, 17
  s_lshl_b32 s27, s17, 8
  s_add_u32 s26, s26, s27
  s_waitcnt lgkmcnt(0)
  s_add_u32 s27, s26, 0
  buffer_load_dwordx4 v[128:131], v20, s[8:11], s27 offen
  s_add_u32 s27, s26, 1024
  buffer_load_dwordx4 v[132:135], v20, s[8:11], s27 offen
  s_add_u32 s27, s26, 16384
  buffer_load_dwordx4 v[136:139], v20, s[8:11], s27 offen
  s_add_u32 s27, s26, 17408
  buffer_load_dwordx4 v[140:143], v20, s[8:11], s27 offen
  s_add_u32 s27, s26, 2048
  buffer_load_dwordx4 v[144:147], v20, s[8:11], s27 offen
  s_add_u32 s27, s26, 3072
  buffer_load_dwordx4 v[148:151], v20, s[8:11], s27 offen
  s_add_u32 s27, s26, 18432
  buffer_load_dwordx4 v[152:155], v20, s[8:11], s27 offen
  s_add_u32 s27, s26, 19456
  buffer_load_dwordx4 v[156:159], v20, s[8:11], s27 offen
  s_add_u32 s27, s26, 8192
  buffer_load_dwordx4 v[160:163], v20, s[8:11], s27 offen
  s_add_u32 s27, s26, 9216
  buffer_load_dwordx4 v[164:167], v20, s[8:11], s27 offen
  s_add_u32 s27, s26, 24576
  buffer_load_dwordx4 v[168:171], v20, s[8:11], s27 offen
  s_add_u32 s27, s26, 25600
  buffer_load_dwordx4 v[172:175], v20, s[8:11], s27 offen
  s_add_u32 s27, s26, 10240
  buffer_load_dwordx4 v[176:179], v20, s[8:11], s27 offen
  s_add_u32 s27, s26, 11264
  buffer_load_dwordx4 v[180:183], v20, s[8:11], s27 offen
  s_add_u32 s27, s26, 26624
  buffer_load_dwordx4 v[184:187], v20, s[8:11], s27 offen
  s_add_u32 s27, s26, 27648
  buffer_load_dwordx4 v[188:191], v20, s[8:11], s27 offen
  s_add_u32 s27, s26, 65536
  buffer_load_dwordx4 v[192:195], v20, s[8:11], s27 offen
  s_add_u32 s27, s26, 66560
  buffer_load_dwordx4 v[196:199], v20, s[8:11], s27 offen
  s_add_u32 s27, s26, 81920
  buffer_load_dwordx4 v[200:203], v20, s[8:11], s27 offen
  s_add_u32 s27, s26, 82944
  buffer_load_dwordx4 v[204:207], v20, s[8:11], s27 offen
  s_add_u32 s27, s26, 67584
  buffer_load_dwordx4 v[208:211], v20, s[8:11], s27 offen
  s_add_u32 s27, s26, 68608
  buffer_load_dwordx4 v[212:215], v20, s[8:11], s27 offen
  s_add_u32 s27, s26, 83968
  buffer_load_dwordx4 v[216:219], v20, s[8:11], s27 offen
  s_add_u32 s27, s26, 84992
  buffer_load_dwordx4 v[220:223], v20, s[8:11], s27 offen
  s_add_u32 s27, s26, 73728
  buffer_load_dwordx4 v[224:227], v20, s[8:11], s27 offen
  s_add_u32 s27, s26, 74752
  buffer_load_dwordx4 v[228:231], v20, s[8:11], s27 offen
  s_add_u32 s27, s26, 90112
  buffer_load_dwordx4 v[232:235], v20, s[8:11], s27 offen
  s_add_u32 s27, s26, 91136
  buffer_load_dwordx4 v[236:239], v20, s[8:11], s27 offen
  s_add_u32 s27, s26, 75776
  buffer_load_dwordx4 v[240:243], v20, s[8:11], s27 offen
  s_add_u32 s27, s26, 76800
  buffer_load_dwordx4 v[244:247], v20, s[8:11], s27 offen
  s_add_u32 s27, s26, 92160
  buffer_load_dwordx4 v[248:251], v20, s[8:11], s27 offen
  s_add_u32 s27, s26, 93184
  buffer_load_dwordx4 v[252:255], v20, s[8:11], s27 offen
  s_waitcnt vmcnt(36)
  s_cmp_lg_u32 s17, 0
  s_cbranch_scc1 g_af_3
  v_readfirstlane_b32 s36, v122
  v_readfirstlane_b32 s37, v123
  s_add_u32 s38, s36, s37
  s_mul_i32 s38, s38, 0x01010101
  s_lshr_b32 s38, s38, 24
  s_cmp_lg_u32 s38, 31
  s_cbranch_scc1 g_af_3
  s_lshl_b32 s38, s89, 3
  s_lshr_b64 s[36:37], s[36:37], s38
  s_and_b32 s36, s36, 0xff
  s_cmp_eq_u32 s36, 31
  s_cselect_b32 s36, 1, 2
  v_mov_b32 v120, s36
  v_lshrrev_b32 v124, 1, v124
  s_mov_b64 exec, 1
  global_store_dword v124, v120, s[12:13] offset:128 sc1
  s_mov_b64 exec, -1
g_af_3:
  v_lshrrev_b32 v20, 8, v0
  v_and_b32 v22, 0xf0, v0
  v_lshlrev_b32 v23, 6, v20
  v_xor_b32 v22, v22, v23
  v_lshl_add_u32 v22, v20, 13, v22
  v_xor_b32 v23, 32, v22
  s_lshr_b32 s26, s17, 1
  s_lshl_b32 s26, s26, 20
  s_and_b32 s27, s17, 1
  s_lshl_b32 s27, s27, 18
  s_add_u32 s26, s26, s27
  s_lshl_b32 s27, s16, 8
  s_add_u32 s26, s26, s27
  s_lshl_b32 s28, s17, 13
  s_add_u32 s27, s26, 0
  s_add_u32 m0, s28, 65536
  s_nop 0
  buffer_load_dwordx4 v22, s[32:35], s27 offen lds
  s_add_u32 m0, s28, 66560
  s_add_u32 s27, s27, 32768
  buffer_load_dwordx4 v22, s[32:35], s27 offen lds
  s_add_u32 m0, s28, 67584
  s_add_u32 s27, s27, 32768
  buffer_load_dwordx4 v23, s[32:35], s27 offen lds
  s_add_u32 m0, s28, 68608
  s_add_u32 s27, s27, 32768
  buffer_load_dwordx4 v23, s[32:35], s27 offen lds
  s_add_u32 m0, s28, 69632
  s_add_u32 s27, s27, 32768
  buffer_load_dwordx4 v22, s[32:35], s27 offen lds
  s_add_u32 m0, s28, 70656
  s_add_u32 s27, s27, 32768
  buffer_load_dwordx4 v22, s[32:35], s27 offen lds
  s_add_u32 m0, s28, 71680
  s_add_u32 s27, s27, 32768
  buffer_load_dwordx4 v23, s[32:35], s27 offen lds
  s_add_u32 m0, s28, 72704
  s_add_u32 s27, s27, 32768
  buffer_load_dwordx4 v23, s[32:35], s27 offen lds
  s_add_u32 s27, s26, 524288
  s_add_u32 m0, s28, 98304
  s_nop 0
  buffer_load_dwordx4 v22, s[32:35], s27 offen lds
  s_add_u32 m0, s28, 99328
  s_add_u32 s27, s27, 32768
  buffer_load_dwordx4 v22, s[32:35], s27 offen lds
  s_add_u32 m0, s28, 100352
  s_add_u32 s27, s27, 32768
  buffer_load_dwordx4 v23, s[32:35], s27 offen lds
  s_add_u32 m0, s28, 101376
  s_add_u32 s27, s27, 32768
  buffer_load_dwordx4 v23, s[32:35], s27 offen lds
  s_add_u32 m0, s28, 102400
  s_add_u32 s27, s27, 32768
  buffer_load_dwordx4 v22, s[32:35], s27 offen lds
  s_add_u32 m0, s28, 103424
  s_add_u32 s27, s27, 32768
  buffer_load_dwordx4 v22, s[32:35], s27 offen lds
  s_add_u32 m0, s28, 104448
  s_add_u32 s27, s27, 32768
  buffer_load_dwordx4 v23, s[32:35], s27 offen lds
  s_add_u32 m0, s28, 105472
  s_add_u32 s27, s27, 32768
  buffer_load_dwordx4 v23, s[32:35], s27 offen lds
  s_waitcnt vmcnt(48)
  v_lshl_or_b32 v28, v29, 16, v28
  v_lshl_or_b32 v29, v31, 16, v30
  v_min_u32 v28, -2, v28
  v_min_u32 v29, -2, v29
  buffer_store_dwordx2 v[28:29], v5, s[4:7], s62 offen sc1
  s_add_u32 s27, s26, 2097152
  s_add_u32 m0, s28, 131072
  s_nop 0
  buffer_load_dwordx4 v22, s[32:35], s27 offen lds
  s_add_u32 m0, s28, 132096
  s_add_u32 s27, s27, 32768
  buffer_load_dwordx4 v22, s[32:35], s27 offen lds
  s_add_u32 m0, s28, 133120
  s_add_u32 s27, s27, 32768
  buffer_load_dwordx4 v23, s[32:35], s27 offen lds
  s_add_u32 m0, s28, 134144
  s_add_u32 s27, s27, 32768
  buffer_load_dwordx4 v23, s[32:35], s27 offen lds
  s_add_u32 m0, s28, 135168
  s_add_u32 s27, s27, 32768
  buffer_load_dwordx4 v22, s[32:35], s27 offen lds
  s_add_u32 m0, s28, 136192
  s_add_u32 s27, s27, 32768
  buffer_load_dwordx4 v22, s[32:35], s27 offen lds
  s_add_u32 m0, s28, 137216
  s_add_u32 s27, s27, 32768
  buffer_load_dwordx4 v23, s[32:35], s27 offen lds
  s_add_u32 m0, s28, 138240
  s_add_u32 s27, s27, 32768
  buffer_load_dwordx4 v23, s[32:35], s27 offen lds
  v_bfe_u32 v20, v7, 2, 1
  v_lshrrev_b32 v21, 3, v7
  v_and_b32 v104, 1, v17
  v_lshl_add_u32 v21, v21, 1, v104
  v_lshl_add_u32 v104, v20, 3, v21
  v_lshrrev_b32 v105, 1, v17
  v_lshl_add_u32 v104, v105, 5, v104
  v_lshl_add_u32 v20, v21, 1, v20
  s_lshl_b32 s29, s17, 1
  v_xor_b32 v20, s29, v20
  v_lshlrev_b32 v20, 5, v20
  v_lshl_add_u32 v20, v104, 8, v20
  v_and_b32 v21, 3, v7
  v_lshl_add_u32 v20, v21, 3, v20
  s_lshr_b32 s29, s17, 1
  s_lshl_b32 s29, s29, 14
  s_and_b32 s30, s17, 1
  s_lshl_b32 s30, s30, 10
  s_add_u32 s29, s29, s30
  s_add_u32 s29, s29, 65536
  v_add_u32 v20, s29, v20
  v_xor_b32 v104, 0, v20
  v_xor_b32 v105, 32, v20
  v_xor_b32 v106, 1024, v20
  v_xor_b32 v107, 1056, v20
  v_xor_b32 v108, 16384, v20
  v_xor_b32 v109, 16416, v20
  v_xor_b32 v110, 17408, v20
  v_xor_b32 v111, 17440, v20
  s_waitcnt vmcnt(49)
  v_perm_b32 v120, v132, v128, s44
  v_perm_b32 v121, v140, v136, s44
  v_perm_b32 v122, v148, v144, s44
  v_perm_b32 v123, v156, v152, s44
  v_accvgpr_write_b32 a248, v120
  v_accvgpr_write_b32 a249, v121
  v_accvgpr_write_b32 a250, v122
  v_accvgpr_write_b32 a251, v123
  v_perm_b32 v124, v132, v128, s45
  v_perm_b32 v125, v140, v136, s45
  v_perm_b32 v126, v148, v144, s45
  v_perm_b32 v127, v156, v152, s45
  v_accvgpr_write_b32 a232, v124
  v_accvgpr_write_b32 a233, v125
  v_accvgpr_write_b32 a234, v126
  v_accvgpr_write_b32 a235, v127
  v_perm_b32 v120, v133, v129, s44
  v_perm_b32 v121, v141, v137, s44
  v_perm_b32 v122, v149, v145, s44
  v_perm_b32 v123, v157, v153, s44
  v_accvgpr_write_b32 a216, v120
  v_accvgpr_write_b32 a217, v121
  v_accvgpr_write_b32 a218, v122
  v_accvgpr_write_b32 a219, v123
  v_perm_b32 v124, v133, v129, s45
  v_perm_b32 v125, v141, v137, s45
  v_perm_b32 v126, v149, v145, s45
  v_perm_b32 v127, v157, v153, s45
  v_accvgpr_write_b32 a200, v124
  v_accvgpr_write_b32 a201, v125
  v_accvgpr_write_b32 a202, v126
  v_accvgpr_write_b32 a203, v127
  v_perm_b32 v120, v134, v130, s44
  v_perm_b32 v121, v142, v138, s44
  v_perm_b32 v122, v150, v146, s44
  v_perm_b32 v123, v158, v154, s44
  v_accvgpr_write_b32 a184, v120
  v_accvgpr_write_b32 a185, v121
  v_accvgpr_write_b32 a186, v122
  v_accvgpr_write_b32 a187, v123
  v_perm_b32 v24, v134, v130, s45
  v_perm_b32 v25, v142, v138, s45
  v_perm_b32 v26, v150, v146, s45
  v_perm_b32 v27, v158, v154, s45
  v_perm_b32 v40, v135, v131, s44
  v_perm_b32 v41, v143, v139, s44
  v_perm_b32 v42, v151, v147, s44
  v_perm_b32 v43, v159, v155, s44
  v_perm_b32 v56, v135, v131, s45
  v_perm_b32 v57, v143, v139, s45
  v_perm_b32 v58, v151, v147, s45
  v_perm_b32 v59, v159, v155, s45
  s_waitcnt vmcnt(41)
  v_perm_b32 v120, v164, v160, s44
  v_perm_b32 v121, v172, v168, s44
  v_perm_b32 v122, v180, v176, s44
  v_perm_b32 v123, v188, v184, s44
  v_accvgpr_write_b32 a252, v120
  v_accvgpr_write_b32 a253, v121
  v_accvgpr_write_b32 a254, v122
  v_accvgpr_write_b32 a255, v123
  v_perm_b32 v124, v164, v160, s45
  v_perm_b32 v125, v172, v168, s45
  v_perm_b32 v126, v180, v176, s45
  v_perm_b32 v127, v188, v184, s45
  v_accvgpr_write_b32 a236, v124
  v_accvgpr_write_b32 a237, v125
  v_accvgpr_write_b32 a238, v126
  v_accvgpr_write_b32 a239, v127
  v_perm_b32 v120, v165, v161, s44
  v_perm_b32 v121, v173, v169, s44
  v_perm_b32 v122, v181, v177, s44
  v_perm_b32 v123, v189, v185, s44
  v_accvgpr_write_b32 a220, v120
  v_accvgpr_write_b32 a221, v121
  v_accvgpr_write_b32 a222, v122
  v_accvgpr_write_b32 a223, v123
  v_perm_b32 v124, v165, v161, s45
  v_perm_b32 v125, v173, v169, s45
  v_perm_b32 v126, v181, v177, s45
  v_perm_b32 v127, v189, v185, s45
  v_accvgpr_write_b32 a204, v124
  v_accvgpr_write_b32 a205, v125
  v_accvgpr_write_b32 a206, v126
  v_accvgpr_write_b32 a207, v127
  v_perm_b32 v120, v166, v162, s44
  v_perm_b32 v121, v174, v170, s44
  v_perm_b32 v122, v182, v178, s44
  v_perm_b32 v123, v190, v186, s44
  v_accvgpr_write_b32 a188, v120
  v_accvgpr_write_b32 a189, v121
  v_accvgpr_write_b32 a190, v122
  v_accvgpr_write_b32 a191, v123
  v_perm_b32 v28, v166, v162, s45
  v_perm_b32 v29, v174, v170, s45
  v_perm_b32 v30, v182, v178, s45
  v_perm_b32 v31, v190, v186, s45
  v_perm_b32 v44, v167, v163, s44
  v_perm_b32 v45, v175, v171, s44
  v_perm_b32 v46, v183, v179, s44
  v_perm_b32 v47, v191, v187, s44
  v_perm_b32 v60, v167, v163, s45
  v_perm_b32 v61, v175, v171, s45
  v_perm_b32 v62, v183, v179, s45
  v_perm_b32 v63, v191, v187, s45
  s_waitcnt vmcnt(33)
  v_perm_b32 v120, v196, v192, s44
  v_perm_b32 v121, v204, v200, s44
  v_perm_b32 v122, v212, v208, s44
  v_perm_b32 v123, v220, v216, s44
  v_accvgpr_write_b32 a240, v120
  v_accvgpr_write_b32 a241, v121
  v_accvgpr_write_b32 a242, v122
  v_accvgpr_write_b32 a243, v123
  v_perm_b32 v124, v196, v192, s45
  v_perm_b32 v125, v204, v200, s45
  v_perm_b32 v126, v212, v208, s45
  v_perm_b32 v127, v220, v216, s45
  v_accvgpr_write_b32 a224, v124
  v_accvgpr_write_b32 a225, v125
  v_accvgpr_write_b32 a226, v126
  v_accvgpr_write_b32 a227, v127
  v_perm_b32 v120, v197, v193, s44
  v_perm_b32 v121, v205, v201, s44
  v_perm_b32 v122, v213, v209, s44
  v_perm_b32 v123, v221, v217, s44
  v_accvgpr_write_b32 a208, v120
  v_accvgpr_write_b32 a209, v121
  v_accvgpr_write_b32 a210, v122
  v_accvgpr_write_b32 a211, v123
  v_perm_b32 v124, v197, v193, s45
  v_perm_b32 v125, v205, v201, s45
  v_perm_b32 v126, v213, v209, s45
  v_perm_b32 v127, v221, v217, s45
  v_accvgpr_write_b32 a192, v124
  v_accvgpr_write_b32 a193, v125
  v_accvgpr_write_b32 a194, v126
  v_accvgpr_write_b32 a195, v127
  v_perm_b32 v120, v198, v194, s44
  v_perm_b32 v121, v206, v202, s44
  v_perm_b32 v122, v214, v210, s44
  v_perm_b32 v123, v222, v218, s44
  v_accvgpr_write_b32 a176, v120
  v_accvgpr_write_b32 a177, v121
  v_accvgpr_write_b32 a178, v122
  v_accvgpr_write_b32 a179, v123
  v_perm_b32 v32, v198, v194, s45
  v_perm_b32 v33, v206, v202, s45
  v_perm_b32 v34, v214, v210, s45
  v_perm_b32 v35, v222, v218, s45
  v_perm_b32 v48, v199, v195, s44
  v_perm_b32 v49, v207, v203, s44
  v_perm_b32 v50, v215, v211, s44
  v_perm_b32 v51, v223, v219, s44
  v_perm_b32 v64, v199, v195, s45
  v_perm_b32 v65, v207, v203, s45
  v_perm_b32 v66, v215, v211, s45
  v_perm_b32 v67, v223, v219, s45
  s_waitcnt vmcnt(25)
  v_perm_b32 v120, v228, v224, s44
  v_perm_b32 v121, v236, v232, s44
  v_perm_b32 v122, v244, v240, s44
  v_perm_b32 v123, v252, v248, s44
  v_accvgpr_write_b32 a244, v120
  v_accvgpr_write_b32 a245, v121
  v_accvgpr_write_b32 a246, v122
  v_accvgpr_write_b32 a247, v123
  v_perm_b32 v124, v228, v224, s45
  v_perm_b32 v125, v236, v232, s45
  v_perm_b32 v126, v244, v240, s45
  v_perm_b32 v127, v252, v248, s45
  v_accvgpr_write_b32 a228, v124
  v_accvgpr_write_b32 a229, v125
  v_accvgpr_write_b32 a230, v126
  v_accvgpr_write_b32 a231, v127
  v_perm_b32 v120, v229, v225, s44
  v_perm_b32 v121, v237, v233, s44
  v_perm_b32 v122, v245, v241, s44
  v_perm_b32 v123, v253, v249, s44
  v_accvgpr_write_b32 a212, v120
  v_accvgpr_write_b32 a213, v121
  v_accvgpr_write_b32 a214, v122
  v_accvgpr_write_b32 a215, v123
  v_perm_b32 v124, v229, v225, s45
  v_perm_b32 v125, v237, v233, s45
  v_perm_b32 v126, v245, v241, s45
  v_perm_b32 v127, v253, v249, s45
  v_accvgpr_write_b32 a196, v124
  v_accvgpr_write_b32 a197, v125
  v_accvgpr_write_b32 a198, v126
  v_accvgpr_write_b32 a199, v127
  v_perm_b32 v120, v230, v226, s44
  v_perm_b32 v121, v238, v234, s44
  v_perm_b32 v122, v246, v242, s44
  v_perm_b32 v123, v254, v250, s44
  v_accvgpr_write_b32 a180, v120
  v_accvgpr_write_b32 a181, v121
  v_accvgpr_write_b32 a182, v122
  v_accvgpr_write_b32 a183, v123
  v_perm_b32 v36, v230, v226, s45
  v_perm_b32 v37, v238, v234, s45
  v_perm_b32 v38, v246, v242, s45
  v_perm_b32 v39, v254, v250, s45
  v_perm_b32 v52, v231, v227, s44
  v_perm_b32 v53, v239, v235, s44
  v_perm_b32 v54, v247, v243, s44
  v_perm_b32 v55, v255, v251, s44
  v_perm_b32 v68, v231, v227, s45
  v_perm_b32 v69, v239, v235, s45
  v_perm_b32 v70, v247, v243, s45
  v_perm_b32 v71, v255, v251, s45
  v_mov_b64 v[128:129], v[24:25]
  v_mov_b64 v[130:131], v[26:27]
  v_mov_b64 v[132:133], v[28:29]
  v_mov_b64 v[134:135], v[30:31]
  v_mov_b64 v[136:137], v[32:33]
  v_mov_b64 v[138:139], v[34:35]
  v_mov_b64 v[140:141], v[36:37]
  v_mov_b64 v[142:143], v[38:39]
  v_mov_b64 v[144:145], v[40:41]
  v_mov_b64 v[146:147], v[42:43]
  v_mov_b64 v[148:149], v[44:45]
  v_mov_b64 v[150:151], v[46:47]
  v_mov_b64 v[152:153], v[48:49]
  v_mov_b64 v[154:155], v[50:51]
  v_mov_b64 v[156:157], v[52:53]
  v_mov_b64 v[158:159], v[54:55]
  v_mov_b64 v[184:185], v[56:57]
  v_mov_b64 v[186:187], v[58:59]
  v_mov_b64 v[188:189], v[60:61]
  v_mov_b64 v[190:191], v[62:63]
  v_mov_b64 v[192:193], v[64:65]
  v_mov_b64 v[194:195], v[66:67]
  v_mov_b64 v[196:197], v[68:69]
  v_mov_b64 v[198:199], v[70:71]
  s_waitcnt vmcnt(17)
  s_barrier
  s_add_u32 s27, s26, 2621440
  s_add_u32 m0, s28, 0
  s_nop 0
  buffer_load_dwordx4 v22, s[32:35], s27 offen lds
  s_add_u32 m0, s28, 1024
  s_add_u32 s27, s27, 32768
  buffer_load_dwordx4 v22, s[32:35], s27 offen lds
  s_add_u32 m0, s28, 2048
  s_add_u32 s27, s27, 32768
  buffer_load_dwordx4 v23, s[32:35], s27 offen lds
  s_add_u32 m0, s28, 3072
  s_add_u32 s27, s27, 32768
  buffer_load_dwordx4 v23, s[32:35], s27 offen lds
  s_add_u32 m0, s28, 4096
  s_add_u32 s27, s27, 32768
  buffer_load_dwordx4 v22, s[32:35], s27 offen lds
  s_add_u32 m0, s28, 5120
  s_add_u32 s27, s27, 32768
  buffer_load_dwordx4 v22, s[32:35], s27 offen lds
  s_add_u32 m0, s28, 6144
  s_add_u32 s27, s27, 32768
  buffer_load_dwordx4 v23, s[32:35], s27 offen lds
  s_add_u32 m0, s28, 7168
  s_add_u32 s27, s27, 32768
  buffer_load_dwordx4 v23, s[32:35], s27 offen lds
  ds_read_b64_tr_b16 v[40:41], v104 offset:0
  ds_read_b64_tr_b16 v[42:43], v104 offset:4096
  ds_read_b64_tr_b16 v[48:49], v105 offset:0
  ds_read_b64_tr_b16 v[50:51], v105 offset:4096
  ds_read_b64_tr_b16 a[72:73], v106 offset:0
  ds_read_b64_tr_b16 a[74:75], v106 offset:4096
  ds_read_b64_tr_b16 a[24:25], v107 offset:0
  ds_read_b64_tr_b16 a[26:27], v107 offset:4096
  ds_read_b64_tr_b16 a[64:65], v108 offset:0
  ds_read_b64_tr_b16 a[66:67], v108 offset:4096
  ds_read_b64_tr_b16 a[16:17], v109 offset:0
  ds_read_b64_tr_b16 a[18:19], v109 offset:4096
  ds_read_b64_tr_b16 a[56:57], v110 offset:0
  ds_read_b64_tr_b16 a[58:59], v110 offset:4096
  ds_read_b64_tr_b16 a[8:9], v111 offset:0
  ds_read_b64_tr_b16 a[10:11], v111 offset:4096
  s_waitcnt lgkmcnt(0)
  s_waitcnt vmcnt(17)
  s_barrier
  s_add_u32 s27, s26, 0
  s_add_u32 m0, s28, 32768
  s_nop 0
  buffer_load_dwordx4 v22, s[52:55], s27 offen lds
  s_add_u32 m0, s28, 33792
  s_add_u32 s27, s27, 32768
  buffer_load_dwordx4 v22, s[52:55], s27 offen lds
  s_add_u32 m0, s28, 34816
  s_add_u32 s27, s27, 32768
  buffer_load_dwordx4 v23, s[52:55], s27 offen lds
  s_add_u32 m0, s28, 35840
  s_add_u32 s27, s27, 32768
  buffer_load_dwordx4 v23, s[52:55], s27 offen lds
  s_add_u32 m0, s28, 36864
  s_add_u32 s27, s27, 32768
  buffer_load_dwordx4 v22, s[52:55], s27 offen lds
  s_add_u32 m0, s28, 37888
  s_add_u32 s27, s27, 32768
  buffer_load_dwordx4 v22, s[52:55], s27 offen lds
  s_add_u32 m0, s28, 38912
  s_add_u32 s27, s27, 32768
  buffer_load_dwordx4 v23, s[52:55], s27 offen lds
  s_add_u32 m0, s28, 39936
  s_add_u32 s27, s27, 32768
  buffer_load_dwordx4 v23, s[52:55], s27 offen lds
  ds_read_b64_tr_b16 v[44:45], v104 offset:32768
  ds_read_b64_tr_b16 v[46:47], v104 offset:36864
  ds_read_b64_tr_b16 v[52:53], v105 offset:32768
  ds_read_b64_tr_b16 v[54:55], v105 offset:36864
  ds_read_b64_tr_b16 a[76:77], v106 offset:32768
  ds_read_b64_tr_b16 a[78:79], v106 offset:36864
  ds_read_b64_tr_b16 a[28:29], v107 offset:32768
  ds_read_b64_tr_b16 a[30:31], v107 offset:36864
  ds_read_b64_tr_b16 a[68:69], v108 offset:32768
  ds_read_b64_tr_b16 a[70:71], v108 offset:36864
  ds_read_b64_tr_b16 a[20:21], v109 offset:32768
  ds_read_b64_tr_b16 a[22:23], v109 offset:36864
  ds_read_b64_tr_b16 a[60:61], v110 offset:32768
  ds_read_b64_tr_b16 a[62:63], v110 offset:36864
  ds_read_b64_tr_b16 a[12:13], v111 offset:32768
  ds_read_b64_tr_b16 a[14:15], v111 offset:36864
  s_waitcnt lgkmcnt(0)
  v_add_u32 v104, 65536, v104
  v_add_u32 v105, 65536, v105
  v_add_u32 v106, 65536, v106
  v_add_u32 v107, 65536, v107
  v_add_u32 v108, 65536, v108
  v_add_u32 v109, 65536, v109
  v_add_u32 v110, 65536, v110
  v_add_u32 v111, 65536, v111
  s_waitcnt vmcnt(16)
  s_barrier
  s_add_u32 s27, s26, 524288
  s_add_u32 m0, s28, 65536
  s_nop 0
  buffer_load_dwordx4 v22, s[52:55], s27 offen lds
  s_add_u32 m0, s28, 66560
  s_add_u32 s27, s27, 32768
  buffer_load_dwordx4 v22, s[52:55], s27 offen lds
  s_add_u32 m0, s28, 67584
  s_add_u32 s27, s27, 32768
  buffer_load_dwordx4 v23, s[52:55], s27 offen lds
  s_add_u32 m0, s28, 68608
  s_add_u32 s27, s27, 32768
  buffer_load_dwordx4 v23, s[52:55], s27 offen lds
  s_add_u32 m0, s28, 69632
  s_add_u32 s27, s27, 32768
  buffer_load_dwordx4 v22, s[52:55], s27 offen lds
  s_add_u32 m0, s28, 70656
  s_add_u32 s27, s27, 32768
  buffer_load_dwordx4 v22, s[52:55], s27 offen lds
  s_add_u32 m0, s28, 71680
  s_add_u32 s27, s27, 32768
  buffer_load_dwordx4 v23, s[52:55], s27 offen lds
  s_add_u32 m0, s28, 72704
  s_add_u32 s27, s27, 32768
  buffer_load_dwordx4 v23, s[52:55], s27 offen lds
  ds_read_b64_tr_b16 v[72:73], v104 offset:0
  ds_read_b64_tr_b16 v[74:75], v104 offset:4096
  ds_read_b64_tr_b16 v[80:81], v105 offset:0
  ds_read_b64_tr_b16 v[82:83], v105 offset:4096
  ds_read_b64_tr_b16 a[48:49], v106 offset:0
  ds_read_b64_tr_b16 a[50:51], v106 offset:4096
  ds_read_b64_tr_b16 a[0:1], v107 offset:0
  ds_read_b64_tr_b16 a[2:3], v107 offset:4096
  ds_read_b64_tr_b16 a[40:41], v108 offset:0
  ds_read_b64_tr_b16 a[42:43], v108 offset:4096
  ds_read_b64_tr_b16 v[248:249], v109 offset:0
  ds_read_b64_tr_b16 v[250:251], v109 offset:4096
  ds_read_b64_tr_b16 a[32:33], v110 offset:0
  ds_read_b64_tr_b16 a[34:35], v110 offset:4096
  ds_read_b64_tr_b16 v[240:241], v111 offset:0
  ds_read_b64_tr_b16 v[242:243], v111 offset:4096
  s_waitcnt lgkmcnt(0)
  v_add_u32 v104, -131072, v104
  v_add_u32 v105, -131072, v105
  v_add_u32 v106, -131072, v106
  v_add_u32 v107, -131072, v107
  v_add_u32 v108, -131072, v108
  v_add_u32 v109, -131072, v109
  v_add_u32 v110, -131072, v110
  v_add_u32 v111, -131072, v111
  s_waitcnt vmcnt(16)
  s_barrier
  s_add_u32 s27, s26, 2097152
  s_add_u32 m0, s28, 98304
  s_nop 0
  buffer_load_dwordx4 v22, s[52:55], s27 offen lds
  s_add_u32 m0, s28, 99328
  s_add_u32 s27, s27, 32768
  buffer_load_dwordx4 v22, s[52:55], s27 offen lds
  s_add_u32 m0, s28, 100352
  s_add_u32 s27, s27, 32768
  buffer_load_dwordx4 v23, s[52:55], s27 offen lds
  s_add_u32 m0, s28, 101376
  s_add_u32 s27, s27, 32768
  buffer_load_dwordx4 v23, s[52:55], s27 offen lds
  s_add_u32 m0, s28, 102400
  s_add_u32 s27, s27, 32768
  buffer_load_dwordx4 v22, s[52:55], s27 offen lds
  s_add_u32 m0, s28, 103424
  s_add_u32 s27, s27, 32768
  buffer_load_dwordx4 v22, s[52:55], s27 offen lds
  s_add_u32 m0, s28, 104448
  s_add_u32 s27, s27, 32768
  buffer_load_dwordx4 v23, s[52:55], s27 offen lds
  s_add_u32 m0, s28, 105472
  s_add_u32 s27, s27, 32768
  buffer_load_dwordx4 v23, s[52:55], s27 offen lds
  ds_read_b64_tr_b16 v[76:77], v104 offset:0
  ds_read_b64_tr_b16 v[78:79], v104 offset:4096
  ds_read_b64_tr_b16 v[84:85], v105 offset:0
  ds_read_b64_tr_b16 v[86:87], v105 offset:4096
  ds_read_b64_tr_b16 a[52:53], v106 offset:0
  ds_read_b64_tr_b16 a[54:55], v106 offset:4096
  ds_read_b64_tr_b16 a[4:5], v107 offset:0
  ds_read_b64_tr_b16 a[6:7], v107 offset:4096
  ds_read_b64_tr_b16 a[44:45], v108 offset:0
  ds_read_b64_tr_b16 a[46:47], v108 offset:4096
  ds_read_b64_tr_b16 v[252:253], v109 offset:0
  ds_read_b64_tr_b16 v[254:255], v109 offset:4096
  ds_read_b64_tr_b16 a[36:37], v110 offset:0
  ds_read_b64_tr_b16 a[38:39], v110 offset:4096
  ds_read_b64_tr_b16 v[244:245], v111 offset:0
  ds_read_b64_tr_b16 v[246:247], v111 offset:4096
  s_waitcnt lgkmcnt(0)
  s_waitcnt vmcnt(16)
  s_barrier
  s_add_u32 s27, s26, 2621440
  s_add_u32 m0, s28, 131072
  s_nop 0
  buffer_load_dwordx4 v22, s[52:55], s27 offen lds
  s_add_u32 m0, s28, 132096
  s_add_u32 s27, s27, 32768
  buffer_load_dwordx4 v22, s[52:55], s27 offen lds
  s_add_u32 m0, s28, 133120
  s_add_u32 s27, s27, 32768
  buffer_load_dwordx4 v23, s[52:55], s27 offen lds
  s_add_u32 m0, s28, 134144
  s_add_u32 s27, s27, 32768
  buffer_load_dwordx4 v23, s[52:55], s27 offen lds
  s_add_u32 m0, s28, 135168
  s_add_u32 s27, s27, 32768
  buffer_load_dwordx4 v22, s[52:55], s27 offen lds
  s_add_u32 m0, s28, 136192
  s_add_u32 s27, s27, 32768
  buffer_load_dwordx4 v22, s[52:55], s27 offen lds
  s_add_u32 m0, s28, 137216
  s_add_u32 s27, s27, 32768
  buffer_load_dwordx4 v23, s[52:55], s27 offen lds
  s_add_u32 m0, s28, 138240
  s_add_u32 s27, s27, 32768
  buffer_load_dwordx4 v23, s[52:55], s27 offen lds
  ds_read_b64_tr_b16 v[24:25], v104 offset:32768
  ds_read_b64_tr_b16 v[26:27], v104 offset:36864
  ds_read_b64_tr_b16 v[32:33], v105 offset:32768
  ds_read_b64_tr_b16 v[34:35], v105 offset:36864
  ds_read_b64_tr_b16 a[168:169], v106 offset:32768
  ds_read_b64_tr_b16 a[170:171], v106 offset:36864
  ds_read_b64_tr_b16 a[120:121], v107 offset:32768
  ds_read_b64_tr_b16 a[122:123], v107 offset:36864
  ds_read_b64_tr_b16 a[160:161], v108 offset:32768
  ds_read_b64_tr_b16 a[162:163], v108 offset:36864
  ds_read_b64_tr_b16 a[112:113], v109 offset:32768
  ds_read_b64_tr_b16 a[114:115], v109 offset:36864
  ds_read_b64_tr_b16 a[152:153], v110 offset:32768
  ds_read_b64_tr_b16 a[154:155], v110 offset:36864
  ds_read_b64_tr_b16 a[104:105], v111 offset:32768
  ds_read_b64_tr_b16 a[106:107], v111 offset:36864
  s_waitcnt lgkmcnt(0)
  v_add_u32 v104, 65536, v104
  v_add_u32 v105, 65536, v105
  v_add_u32 v106, 65536, v106
  v_add_u32 v107, 65536, v107
  v_add_u32 v108, 65536, v108
  v_add_u32 v109, 65536, v109
  v_add_u32 v110, 65536, v110
  v_add_u32 v111, 65536, v111
  s_waitcnt vmcnt(16)
  s_barrier
  s_add_u32 s27, s26, 0
  s_add_u32 m0, s28, 0
  s_nop 0
  buffer_load_dwordx4 v22, s[48:51], s27 offen lds
  s_add_u32 m0, s28, 1024
  s_add_u32 s27, s27, 32768
  buffer_load_dwordx4 v22, s[48:51], s27 offen lds
  s_add_u32 m0, s28, 2048
  s_add_u32 s27, s27, 32768
  buffer_load_dwordx4 v23, s[48:51], s27 offen lds
  s_add_u32 m0, s28, 3072
  s_add_u32 s27, s27, 32768
  buffer_load_dwordx4 v23, s[48:51], s27 offen lds
  s_add_u32 m0, s28, 4096
  s_add_u32 s27, s27, 32768
  buffer_load_dwordx4 v22, s[48:51], s27 offen lds
  s_add_u32 m0, s28, 5120
  s_add_u32 s27, s27, 32768
  buffer_load_dwordx4 v22, s[48:51], s27 offen lds
  s_add_u32 m0, s28, 6144
  s_add_u32 s27, s27, 32768
  buffer_load_dwordx4 v23, s[48:51], s27 offen lds
  s_add_u32 m0, s28, 7168
  s_add_u32 s27, s27, 32768
  buffer_load_dwordx4 v23, s[48:51], s27 offen lds
  ds_read_b64_tr_b16 v[28:29], v104 offset:0
  ds_read_b64_tr_b16 v[30:31], v104 offset:4096
  ds_read_b64_tr_b16 v[36:37], v105 offset:0
  ds_read_b64_tr_b16 v[38:39], v105 offset:4096
  ds_read_b64_tr_b16 a[172:173], v106 offset:0
  ds_read_b64_tr_b16 a[174:175], v106 offset:4096
  ds_read_b64_tr_b16 a[124:125], v107 offset:0
  ds_read_b64_tr_b16 a[126:127], v107 offset:4096
  ds_read_b64_tr_b16 a[164:165], v108 offset:0
  ds_read_b64_tr_b16 a[166:167], v108 offset:4096
  ds_read_b64_tr_b16 a[116:117], v109 offset:0
  ds_read_b64_tr_b16 a[118:119], v109 offset:4096
  ds_read_b64_tr_b16 a[156:157], v110 offset:0
  ds_read_b64_tr_b16 a[158:159], v110 offset:4096
  ds_read_b64_tr_b16 a[108:109], v111 offset:0
  ds_read_b64_tr_b16 a[110:111], v111 offset:4096
  s_waitcnt lgkmcnt(0)
  s_waitcnt vmcnt(16)
  s_barrier
  s_add_u32 s27, s26, 524288
  s_add_u32 m0, s28, 32768
  s_nop 0
  buffer_load_dwordx4 v22, s[48:51], s27 offen lds
  s_add_u32 m0, s28, 33792
  s_add_u32 s27, s27, 32768
  buffer_load_dwordx4 v22, s[48:51], s27 offen lds
  s_add_u32 m0, s28, 34816
  s_add_u32 s27, s27, 32768
  buffer_load_dwordx4 v23, s[48:51], s27 offen lds
  s_add_u32 m0, s28, 35840
  s_add_u32 s27, s27, 32768
  buffer_load_dwordx4 v23, s[48:51], s27 offen lds
  s_add_u32 m0, s28, 36864
  s_add_u32 s27, s27, 32768
  buffer_load_dwordx4 v22, s[48:51], s27 offen lds
  s_add_u32 m0, s28, 37888
  s_add_u32 s27, s27, 32768
  buffer_load_dwordx4 v22, s[48:51], s27 offen lds
  s_add_u32 m0, s28, 38912
  s_add_u32 s27, s27, 32768
  buffer_load_dwordx4 v23, s[48:51], s27 offen lds
  s_add_u32 m0, s28, 39936
  s_add_u32 s27, s27, 32768
  buffer_load_dwordx4 v23, s[48:51], s27 offen lds
  ds_read_b64_tr_b16 v[56:57], v104 offset:32768
  ds_read_b64_tr_b16 v[58:59], v104 offset:36864
  ds_read_b64_tr_b16 v[64:65], v105 offset:32768
  ds_read_b64_tr_b16 v[66:67], v105 offset:36864
  ds_read_b64_tr_b16 a[144:145], v106 offset:32768
  ds_read_b64_tr_b16 a[146:147], v106 offset:36864
  ds_read_b64_tr_b16 a[96:97], v107 offset:32768
  ds_read_b64_tr_b16 a[98:99], v107 offset:36864
  ds_read_b64_tr_b16 a[136:137], v108 offset:32768
  ds_read_b64_tr_b16 a[138:139], v108 offset:36864
  ds_read_b64_tr_b16 a[88:89], v109 offset:32768
  ds_read_b64_tr_b16 a[90:91], v109 offset:36864
  ds_read_b64_tr_b16 a[128:129], v110 offset:32768
  ds_read_b64_tr_b16 a[130:131], v110 offset:36864
  ds_read_b64_tr_b16 a[80:81], v111 offset:32768
  ds_read_b64_tr_b16 a[82:83], v111 offset:36864
  s_waitcnt lgkmcnt(0)
  v_add_u32 v104, 65536, v104
  v_add_u32 v105, 65536, v105
  v_add_u32 v106, 65536, v106
  v_add_u32 v107, 65536, v107
  v_add_u32 v108, 65536, v108
  v_add_u32 v109, 65536, v109
  v_add_u32 v110, 65536, v110
  v_add_u32 v111, 65536, v111
  s_waitcnt vmcnt(16)
  s_barrier
  s_add_u32 s27, s26, 2097152
  s_add_u32 m0, s28, 65536
  s_nop 0
  buffer_load_dwordx4 v22, s[48:51], s27 offen lds
  s_add_u32 m0, s28, 66560
  s_add_u32 s27, s27, 32768
  buffer_load_dwordx4 v22, s[48:51], s27 offen lds
  s_add_u32 m0, s28, 67584
  s_add_u32 s27, s27, 32768
  buffer_load_dwordx4 v23, s[48:51], s27 offen lds
  s_add_u32 m0, s28, 68608
  s_add_u32 s27, s27, 32768
  buffer_load_dwordx4 v23, s[48:51], s27 offen lds
  s_add_u32 m0, s28, 69632
  s_add_u32 s27, s27, 32768
  buffer_load_dwordx4 v22, s[48:51], s27 offen lds
  s_add_u32 m0, s28, 70656
  s_add_u32 s27, s27, 32768
  buffer_load_dwordx4 v22, s[48:51], s27 offen lds
  s_add_u32 m0, s28, 71680
  s_add_u32 s27, s27, 32768
  buffer_load_dwordx4 v23, s[48:51], s27 offen lds
  s_add_u32 m0, s28, 72704
  s_add_u32 s27, s27, 32768
  buffer_load_dwordx4 v23, s[48:51], s27 offen lds
  ds_read_b64_tr_b16 v[60:61], v104 offset:0
  ds_read_b64_tr_b16 v[62:63], v104 offset:4096
  ds_read_b64_tr_b16 v[68:69], v105 offset:0
  ds_read_b64_tr_b16 v[70:71], v105 offset:4096
  ds_read_b64_tr_b16 a[148:149], v106 offset:0
  ds_read_b64_tr_b16 a[150:151], v106 offset:4096
  ds_read_b64_tr_b16 a[100:101], v107 offset:0
  ds_read_b64_tr_b16 a[102:103], v107 offset:4096
  ds_read_b64_tr_b16 a[140:141], v108 offset:0
  ds_read_b64_tr_b16 a[142:143], v108 offset:4096
  ds_read_b64_tr_b16 a[92:93], v109 offset:0
  ds_read_b64_tr_b16 a[94:95], v109 offset:4096
  ds_read_b64_tr_b16 a[132:133], v110 offset:0
  ds_read_b64_tr_b16 a[134:135], v110 offset:4096
  ds_read_b64_tr_b16 a[84:85], v111 offset:0
  ds_read_b64_tr_b16 a[86:87], v111 offset:4096
  s_waitcnt lgkmcnt(0)
  v_add_u32 v104, -131072, v104
  v_add_u32 v105, -131072, v105
  v_add_u32 v106, -131072, v106
  v_add_u32 v107, -131072, v107
  v_add_u32 v108, -131072, v108
  v_add_u32 v109, -131072, v109
  v_add_u32 v110, -131072, v110
  v_add_u32 v111, -131072, v111
  s_waitcnt vmcnt(16)
  s_barrier
  s_add_u32 s27, s26, 2621440
  s_add_u32 m0, s28, 98304
  s_nop 0
  buffer_load_dwordx4 v22, s[48:51], s27 offen lds
  s_add_u32 m0, s28, 99328
  s_add_u32 s27, s27, 32768
  buffer_load_dwordx4 v22, s[48:51], s27 offen lds
  s_add_u32 m0, s28, 100352
  s_add_u32 s27, s27, 32768
  buffer_load_dwordx4 v23, s[48:51], s27 offen lds
  s_add_u32 m0, s28, 101376
  s_add_u32 s27, s27, 32768
  buffer_load_dwordx4 v23, s[48:51], s27 offen lds
  s_add_u32 m0, s28, 102400
  s_add_u32 s27, s27, 32768
  buffer_load_dwordx4 v22, s[48:51], s27 offen lds
  s_add_u32 m0, s28, 103424
  s_add_u32 s27, s27, 32768
  buffer_load_dwordx4 v22, s[48:51], s27 offen lds
  s_add_u32 m0, s28, 104448
  s_add_u32 s27, s27, 32768
  buffer_load_dwordx4 v23, s[48:51], s27 offen lds
  s_add_u32 m0, s28, 105472
  s_add_u32 s27, s27, 32768
  buffer_load_dwordx4 v23, s[48:51], s27 offen lds
  ds_read_b64_tr_b16 v[88:89], v104 offset:0
  ds_read_b64_tr_b16 v[90:91], v104 offset:4096
  ds_read_b64_tr_b16 v[96:97], v105 offset:0
  ds_read_b64_tr_b16 v[98:99], v105 offset:4096
  ds_read_b64_tr_b16 v[232:233], v106 offset:0
  ds_read_b64_tr_b16 v[234:235], v106 offset:4096
  ds_read_b64_tr_b16 v[176:177], v107 offset:0
  ds_read_b64_tr_b16 v[178:179], v107 offset:4096
  ds_read_b64_tr_b16 v[224:225], v108 offset:0
  ds_read_b64_tr_b16 v[226:227], v108 offset:4096
  ds_read_b64_tr_b16 v[168:169], v109 offset:0
  ds_read_b64_tr_b16 v[170:171], v109 offset:4096
  ds_read_b64_tr_b16 v[216:217], v110 offset:0
  ds_read_b64_tr_b16 v[218:219], v110 offset:4096
  ds_read_b64_tr_b16 v[160:161], v111 offset:0
  ds_read_b64_tr_b16 v[162:163], v111 offset:4096
  s_waitcnt lgkmcnt(0)
  s_waitcnt vmcnt(16)
  s_barrier
  ds_read_b64_tr_b16 v[92:93], v104 offset:32768
  ds_read_b64_tr_b16 v[94:95], v104 offset:36864
  ds_read_b64_tr_b16 v[100:101], v105 offset:32768
  ds_read_b64_tr_b16 v[102:103], v105 offset:36864
  ds_read_b64_tr_b16 v[236:237], v106 offset:32768
  ds_read_b64_tr_b16 v[238:239], v106 offset:36864
  ds_read_b64_tr_b16 v[180:181], v107 offset:32768
  ds_read_b64_tr_b16 v[182:183], v107 offset:36864
  ds_read_b64_tr_b16 v[228:229], v108 offset:32768
  ds_read_b64_tr_b16 v[230:231], v108 offset:36864
  ds_read_b64_tr_b16 v[172:173], v109 offset:32768
  ds_read_b64_tr_b16 v[174:175], v109 offset:36864
  ds_read_b64_tr_b16 v[220:221], v110 offset:32768
  ds_read_b64_tr_b16 v[222:223], v110 offset:36864
  ds_read_b64_tr_b16 v[164:165], v111 offset:32768
  ds_read_b64_tr_b16 v[166:167], v111 offset:36864
  s_waitcnt lgkmcnt(0)
  s_barrier
  v_add_u32 v104, 65536, v104
  v_add_u32 v105, 65536, v105
  v_add_u32 v106, 65536, v106
  v_add_u32 v107, 65536, v107
  v_add_u32 v108, 65536, v108
  v_add_u32 v109, 65536, v109
  v_add_u32 v110, 65536, v110
  v_add_u32 v111, 65536, v111
  ds_write_b128 v8, v[128:131] offset:16384
  ds_write_b128 v8, v[132:135] offset:20480
  ds_write_b128 v8, v[136:139] offset:24576
  ds_write_b128 v8, v[140:143] offset:28672
  ds_write_b128 v8, v[144:147] offset:32768
  ds_write_b128 v8, v[148:151] offset:36864
  ds_write_b128 v8, v[152:155] offset:40960
  ds_write_b128 v8, v[156:159] offset:45056
  ds_write_b128 v8, v[184:187] offset:49152
  ds_write_b128 v8, v[188:191] offset:53248
  ds_write_b128 v8, v[192:195] offset:57344
  ds_write_b128 v8, v[196:199] offset:61440
  s_waitcnt lgkmcnt(0)
  s_waitcnt vmcnt(8)
  s_barrier
  ds_read_b64_tr_b16 v[208:209], v104 offset:0
  ds_read_b64_tr_b16 v[210:211], v104 offset:4096
  ds_read_b64_tr_b16 v[152:153], v105 offset:0
  ds_read_b64_tr_b16 v[154:155], v105 offset:4096
  ds_read_b64_tr_b16 v[200:201], v106 offset:0
  ds_read_b64_tr_b16 v[202:203], v106 offset:4096
  ds_read_b64_tr_b16 v[144:145], v107 offset:0
  ds_read_b64_tr_b16 v[146:147], v107 offset:4096
  ds_read_b64_tr_b16 v[192:193], v108 offset:0
  ds_read_b64_tr_b16 v[194:195], v108 offset:4096
  ds_read_b64_tr_b16 v[136:137], v109 offset:0
  ds_read_b64_tr_b16 v[138:139], v109 offset:4096
  ds_read_b64_tr_b16 v[184:185], v110 offset:0
  ds_read_b64_tr_b16 v[186:187], v110 offset:4096
  ds_read_b64_tr_b16 v[128:129], v111 offset:0
  ds_read_b64_tr_b16 v[130:131], v111 offset:4096
  s_waitcnt lgkmcnt(0)
  s_waitcnt vmcnt(0)
  s_barrier
  ds_read_b64_tr_b16 v[212:213], v104 offset:32768
  ds_read_b64_tr_b16 v[214:215], v104 offset:36864
  ds_read_b64_tr_b16 v[156:157], v105 offset:32768
  ds_read_b64_tr_b16 v[158:159], v105 offset:36864
  ds_read_b64_tr_b16 v[204:205], v106 offset:32768
  ds_read_b64_tr_b16 v[206:207], v106 offset:36864
  ds_read_b64_tr_b16 v[148:149], v107 offset:32768
  ds_read_b64_tr_b16 v[150:151], v107 offset:36864
  ds_read_b64_tr_b16 v[196:197], v108 offset:32768
  ds_read_b64_tr_b16 v[198:199], v108 offset:36864
  ds_read_b64_tr_b16 v[140:141], v109 offset:32768
  ds_read_b64_tr_b16 v[142:143], v109 offset:36864
  ds_read_b64_tr_b16 v[188:189], v110 offset:32768
  ds_read_b64_tr_b16 v[190:191], v110 offset:36864
  ds_read_b64_tr_b16 v[132:133], v111 offset:32768
  ds_read_b64_tr_b16 v[134:135], v111 offset:36864
  s_waitcnt lgkmcnt(0)
  s_barrier
  s_cmp_eq_u32 s60, 0
  s_cbranch_scc1 c_nw_4
  s_lshl_b32 s26, s60, 5
  s_add_u32 s26, s26, s16
  s_lshl_b32 s26, s26, 2
  s_add_u32 s26, s26, s17
  s_mul_i32 s26, s26, 7168
  s_sub_u32 s26, s26, 917504
  s_add_u32 s27, s26, 4096
  s_mov_b32 s10, 1835008
  s_load_dwordx2 s[8:9], s[0:1], 72
  s_waitcnt lgkmcnt(0)
  buffer_load_dwordx4 v[116:119], v0, s[8:11], s26 offen offset:0
  buffer_load_dwordx4 v[116:119], v0, s[8:11], s26 offen offset:1024
  buffer_load_dwordx4 v[116:119], v0, s[8:11], s26 offen offset:2048
  buffer_load_dwordx4 v[116:119], v0, s[8:11], s26 offen offset:3072
  buffer_load_dwordx4 v[116:119], v0, s[8:11], s27 offen offset:0
  buffer_load_dwordx4 v[116:119], v0, s[8:11], s27 offen offset:1024
  buffer_load_dwordx4 v[116:119], v0, s[8:11], s27 offen offset:2048
  s_load_dwordx2 s[8:9], s[0:1], 80
  s_waitcnt lgkmcnt(0)
  buffer_load_dwordx4 v[116:119], v0, s[8:11], s26 offen offset:0
  buffer_load_dwordx4 v[116:119], v0, s[8:11], s26 offen offset:1024
  buffer_load_dwordx4 v[116:119], v0, s[8:11], s26 offen offset:2048
  buffer_load_dwordx4 v[116:119], v0, s[8:11], s26 offen offset:3072
  buffer_load_dwordx4 v[116:119], v0, s[8:11], s27 offen offset:0
  buffer_load_dwordx4 v[116:119], v0, s[8:11], s27 offen offset:1024
  buffer_load_dwordx4 v[116:119], v0, s[8:11], s27 offen offset:2048
  s_load_dwordx2 s[8:9], s[0:1], 88
  s_waitcnt lgkmcnt(0)
  buffer_load_dwordx4 v[116:119], v0, s[8:11], s26 offen offset:0
  buffer_load_dwordx4 v[116:119], v0, s[8:11], s26 offen offset:1024
  buffer_load_dwordx4 v[116:119], v0, s[8:11], s26 offen offset:2048
  buffer_load_dwordx4 v[116:119], v0, s[8:11], s26 offen offset:3072
  buffer_load_dwordx4 v[116:119], v0, s[8:11], s27 offen offset:0
  buffer_load_dwordx4 v[116:119], v0, s[8:11], s27 offen offset:1024
  buffer_load_dwordx4 v[116:119], v0, s[8:11], s27 offen offset:2048
c_nw_4:
  ds_write_b128 v1, v[24:27] offset:0
  ds_write_b128 v1, v[28:31] offset:1024
  ds_write_b128 v1, v[32:35] offset:2048
  ds_write_b128 v1, v[36:39] offset:3072
  ds_write_b128 v1, v[40:43] offset:4096
  ds_write_b128 v1, v[44:47] offset:5120
  ds_write_b128 v1, v[48:51] offset:6144
  ds_write_b128 v1, v[52:55] offset:7168
  ds_write_b128 v1, v[56:59] offset:8192
  ds_write_b128 v1, v[60:63] offset:9216
  ds_write_b128 v1, v[64:67] offset:10240
  ds_write_b128 v1, v[68:71] offset:11264
  ds_write_b128 v1, v[72:75] offset:12288
  ds_write_b128 v1, v[76:79] offset:13312
  ds_write_b128 v1, v[80:83] offset:14336
  ds_write_b128 v1, v[84:87] offset:15360
  ds_write_b128 v1, v[88:91] offset:16384
  ds_write_b128 v1, v[92:95] offset:17408
  ds_write_b128 v1, v[96:99] offset:18432
  ds_write_b128 v1, v[100:103] offset:19456
  s_mul_i32 s27, s17, 24576
  s_add_u32 m0, s27, 86016
  s_waitcnt lgkmcnt(0)
  v_mbcnt_lo_u32_b32 v20, -1, 0
  v_and_b32 v20, 1, v20
  v_add_lshl_u32 v20, v20, s61, 2
  s_mov_b32 s26, 0
g_wt_5:
  global_load_dword v21, v20, s[12:13] offset:128 sc1
  s_add_u32 s26, s26, 1
  s_cmp_gt_u32 s26, 1048576
  s_cbranch_scc1 L_end
  s_waitcnt vmcnt(0)
  v_cmp_eq_u32 vcc, 0, v21
  v_readfirstlane_b32 s27, v21
  s_cbranch_vccnz g_wt_5
  s_lshr_b32 s26, s91, 1
  s_nop 3
  v_readlane_b32 s27, v21, s26
  s_cmp_lg_u32 s27, 1
  s_cbranch_scc1 L_chain_x
  s_mov_b32 s22, 0
  s_mov_b32 s42, s62
  s_add_u32 s43, s62, 4096
  s_mov_b32 s46, 0
  s_mov_b32 s47, 0
  s_lshl_b32 s26, s16, 2
  s_add_u32 s26, s26, s17
  s_lshl_b32 s27, s60, 13
  s_add_u32 s27, s27, s26
  s_lshr_b32 s25, s27, 2
  s_lshl_b32 s25, s25, 13
  s_add_u32 s25, s25, 192937984
  s_lshr_b32 s64, s27, 2
  s_lshl_b32 s64, s64, 6
  s_add_u32 s64, s64, 513538048
  s_cmp_eq_u32 s17, 3
  s_cselect_b32 s2, 268435456, 0
  s_lshl_b32 s27, s61, 13
  s_add_u32 s27, s27, s26
  s_lshl_b32 s23, s27, 12
  s_add_u32 s23, s23, 41943040
  s_lshl_b32 s63, s27, 5
  s_add_u32 s63, s63, 244318208
  s_mov_b32 s97, 268435456
  s_cmp_eq_u32 s60, 2
  s_cselect_b32 s93, 1, 3
  s_lshl_b32 s26, s17, 2
  s_add_u32 s26, s26, s60
  s_cmp_eq_u32 s26, 1
  s_cselect_b32 s97, 245891072, s97
  s_mov_b32 s95, 0
  s_mov_b32 s96, s23
  s_add_u32 s23, s23, 524288
  s_add_u32 s63, s63, 4096
  s_mov_b32 s29, 0
  s_sub_u32 s92, s63, 4096
  s_sub_u32 s96, s23, 524288
  s_mov_b32 s95, 0
c_gw_14:
  buffer_load_dword v7, off, s[4:7], s92 sc1
  s_add_u32 s29, s29, 1
  s_cmp_gt_u32 s29, 1048576
  s_cbranch_scc1 c_fail_12
  s_waitcnt vmcnt(0) lgkmcnt(0)
  v_readfirstlane_b32 s65, v7
  s_cmp_eq_u32 s65, 0
  s_cbranch_scc1 c_gw_14
  s_and_b32 s65, s65, s93
  s_cbranch_scc1 c_kvx_16
  s_mov_b32 s95, 1
  s_add_u32 s96, s96, 33554432
  s_add_u32 s92, s92, 262144
c_kvw_15:
  buffer_load_dword v7, off, s[4:7], s92 sc1
  s_add_u32 s29, s29, 1
  s_cmp_gt_u32 s29, 1048576
  s_cbranch_scc1 c_fail_12
  s_waitcnt vmcnt(0) lgkmcnt(0)
  v_readfirstlane_b32 s65, v7
  s_cmp_eq_u32 s65, 0
  s_cbranch_scc1 c_kvw_15
c_kvx_16:
  buffer_load_dword v7, off, s[4:7], s63 sc1
  buffer_load_dwordx4 v0, s[4:7], s96 offen offset:0  lds
  buffer_load_dwordx4 v0, s[4:7], s96 offen offset:1024  lds
  buffer_load_dwordx4 v0, s[4:7], s96 offen offset:2048  lds
  buffer_load_dwordx4 v0, s[4:7], s96 offen offset:3072  lds
  s_waitcnt vmcnt(4)
  v_readfirstlane_b32 s65, v7
  ds_read_b128 v[72:75], v1 offset:6144
  ds_read_b128 v[76:79], v1 offset:7168
  ds_read_b128 v[80:83], v1 offset:8192
  ds_read_b128 v[84:87], v1 offset:9216
  ds_read_b128 v[88:91], v1 offset:10240
  ds_read_b128 v[92:95], v1 offset:11264
  ds_read_b128 v[96:99], v1 offset:12288
  ds_read_b128 v[100:103], v1 offset:13312
  ds_read_b128 v[104:107], v1 offset:14336
  ds_read_b128 v[108:111], v1 offset:15360
  ds_read_b128 v[112:115], v1 offset:16384
  ds_read_b128 v[116:119], v1 offset:17408
  ds_read_b128 v[120:123], v1 offset:18432
  ds_read_b128 v[124:127], v1 offset:19456
  v_mov_b64 v[48:49], 0
  v_mov_b64 v[50:51], 0
  v_mov_b64 v[52:53], 0
  v_mov_b64 v[54:55], 0
  v_mov_b64 v[56:57], 0
  v_mov_b64 v[58:59], 0
  v_mov_b64 v[60:61], 0
  v_mov_b64 v[62:63], 0
  v_mov_b64 v[64:65], 0
  v_mov_b64 v[66:67], 0
  v_mov_b64 v[68:69], 0
  v_mov_b64 v[70:71], 0
  s_lshl_b32 s38, s16, 13
  s_add_u32 s38, s38, s40
  s_add_u32 s39, s38, 4096
  ds_read_b128 v[24:27], v1 offset:0
  ds_read_b128 v[28:31], v1 offset:1024
  ds_read_b128 v[32:35], v1 offset:2048
  ds_read_b128 v[36:39], v1 offset:3072
  ds_read_b128 v[40:43], v1 offset:4096
  ds_read_b128 v[44:47], v1 offset:5120
  s_waitcnt lgkmcnt(0)
c_loop_6:
  buffer_load_dwordx4 v[16:19], v8, s[4:7], s42 offen sc1
  buffer_load_dwordx4 v[20:23], v8, s[4:7], s43 offen sc1
  s_mov_b32 s28, 0
  v_mov_b64 v[48:49], 0
  v_mov_b64 v[50:51], 0
  v_mov_b64 v[52:53], 0
  v_mov_b64 v[54:55], 0
  v_mov_b64 v[56:57], 0
  v_mov_b64 v[58:59], 0
  v_mov_b64 v[60:61], 0
  v_mov_b64 v[62:63], 0
  v_mov_b64 v[64:65], 0
  v_mov_b64 v[66:67], 0
  v_mov_b64 v[68:69], 0
  v_mov_b64 v[70:71], 0
  buffer_load_dwordx4 v[16:19], v8, s[4:7], s42 offen sc1
  buffer_load_dwordx4 v[20:23], v8, s[4:7], s43 offen sc1
  s_waitcnt lgkmcnt(0)
  s_waitcnt vmcnt(3)
  v_max3_u32 v7, v16, v17, v18
  v_max_u32 v7, v7, v19
  ds_write_b128 v8, v[16:19] offset:4096
  v_smfmac_f32_16x16x64_bf16 v[48:51], v[16:19], v[24:31], v6
  s_waitcnt vmcnt(2)
  v_max3_u32 v7, v20, v21, v7
  v_max3_u32 v7, v22, v23, v7
  ds_write_b128 v8, v[20:23] offset:8192
  v_smfmac_f32_16x16x64_bf16 v[52:55], v[16:19], v[32:39], v6
  v_cmp_eq_u32 vcc, -1, v7
  v_smfmac_f32_16x16x64_bf16 v[56:59], v[16:19], v[40:47], v6
  s_cbranch_vccnz c_retry_7
c_got_8:
  v_smfmac_f32_16x16x64_bf16 v[60:63], v[16:19], v[72:79], v6
  ds_read_b128 v[72:75], v1 offset:20480
  s_and_b32 s65, s65, s93
  s_cselect_b32 s96, s23, 268435456
  v_smfmac_f32_16x16x64_bf16 v[48:51], v[20:23], v[80:87], v6
  ds_read_b128 v[76:79], v1 offset:21504
  v_mov_b32 v7, 1
  v_smfmac_f32_16x16x64_bf16 v[52:55], v[20:23], v[88:95], v6
  ds_read_b128 v[80:83], v1 offset:22528
  v_smfmac_f32_16x16x64_bf16 v[56:59], v[20:23], v[96:103], v6
  ds_read_b128 v[84:87], v1 offset:23552
  s_waitcnt lgkmcnt(4)
  s_barrier
  ds_read_b128 v[24:27], v9 offset:4096
  ds_read_b128 v[28:31], v10 offset:4096
  v_smfmac_f32_16x16x64_bf16 v[60:63], v[20:23], v[104:111], v6
  ds_read_b128 v[32:35], v11 offset:4096
  v_smfmac_f32_16x16x64_bf16 v[64:67], v[16:19], v[112:119], v6
  ds_read_b128 v[36:39], v9 offset:8192
  v_smfmac_f32_16x16x64_bf16 v[68:71], v[16:19], v[120:127], v6
  ds_read_b128 v[40:43], v10 offset:8192
  v_smfmac_f32_16x16x64_bf16 v[64:67], v[20:23], v[208:215], v6
  ds_read_b128 v[44:47], v11 offset:8192
  s_waitcnt lgkmcnt(5)
  v_smfmac_f32_16x16x64_bf16 v[48:51], v[24:27], a[168:175], v6
  buffer_load_dwordx4 v0, s[4:7], s96 offen offset:0  lds
  s_waitcnt lgkmcnt(4)
  v_smfmac_f32_16x16x64_bf16 v[48:51], v[28:31], a[160:167], v6
  ds_read_b128 v[104:107], v8 offset:16384
  s_waitcnt lgkmcnt(4)
  v_smfmac_f32_16x16x64_bf16 v[48:51], v[32:35], a[152:159], v6
  buffer_load_dwordx4 v0, s[4:7], s96 offen offset:1024  lds
  s_waitcnt lgkmcnt(3)
  v_smfmac_f32_16x16x64_bf16 v[48:51], v[36:39], a[144:151], v6
  ds_read_b128 v[108:111], v8 offset:20480
  s_waitcnt lgkmcnt(3)
  v_smfmac_f32_16x16x64_bf16 v[48:51], v[40:43], a[136:143], v6
  buffer_load_dwordx4 v0, s[4:7], s96 offen offset:2048  lds
  s_waitcnt lgkmcnt(2)
  v_smfmac_f32_16x16x64_bf16 v[48:51], v[44:47], a[128:135], v6
  v_smfmac_f32_16x16x64_bf16 v[52:55], v[24:27], a[120:127], v6
  buffer_load_dwordx4 v0, s[4:7], s96 offen offset:3072  lds
  v_smfmac_f32_16x16x64_bf16 v[52:55], v[28:31], a[112:119], v6
  ds_read_b64 v[100:101], v5 offset:4096
  v_add_f32 v48, v48, v50
  v_smfmac_f32_16x16x64_bf16 v[52:55], v[32:35], a[104:111], v6
  ds_read_b128 v[112:115], v8 offset:24576
  v_add_f32 v49, v49, v51
  v_smfmac_f32_16x16x64_bf16 v[52:55], v[36:39], a[96:103], v6
  ds_read_b128 v[116:119], v8 offset:28672
  v_cvt_pk_bf16_f32 v50, v48, v49
  v_smfmac_f32_16x16x64_bf16 v[52:55], v[40:43], a[88:95], v6
  ds_write2_b32 v2, v50, v50 offset0:0 offset1:1
  v_smfmac_f32_16x16x64_bf16 v[52:55], v[44:47], a[80:87], v6
  ds_read_b64_tr_b16 v[88:89], v12 offset:0
  v_smfmac_f32_16x16x64_bf16 v[56:59], v[24:27], a[72:79], v6
  s_mov_b64 exec, 1
  buffer_store_dword v7, off, s[4:7], s64 sc1
  s_mov_b64 exec, -1
  v_smfmac_f32_16x16x64_bf16 v[56:59], v[28:31], a[64:71], v6
  ds_read_b128 v[120:123], v8 offset:32768
  v_add_f32 v52, v52, v54
  v_smfmac_f32_16x16x64_bf16 v[56:59], v[32:35], a[56:63], v6
  ds_read_b128 v[124:127], v8 offset:36864
  v_add_f32 v53, v53, v55
  v_cvt_pk_bf16_f32 v54, v52, v53
  v_smfmac_f32_16x16x64_bf16 v[56:59], v[36:39], a[48:55], v6
  ds_write2_b32 v2, v54, v54 offset0:128 offset1:129
  ds_read_b64_tr_b16 v[90:91], v12 offset:512
  v_smfmac_f32_16x16x64_bf16 v[56:59], v[40:43], a[40:47], v6
  v_smfmac_f32_16x16x64_bf16 v[56:59], v[44:47], a[32:39], v6
  v_smfmac_f32_16x16x64_bf16 v[60:63], v[24:27], a[24:31], v6
  v_smfmac_f32_16x16x64_bf16 v[60:63], v[28:31], a[16:23], v6
  s_waitcnt lgkmcnt(0)
  v_add_f32 v56, v56, v58
  v_mfma_f32_16x16x32_bf16 v[92:95], v[72:75], v[88:91], 0
  buffer_store_dwordx2 v[100:101], v5, s[4:7], s97 offen sc1
  v_add_f32 v57, v57, v59
  v_cvt_pk_bf16_f32 v58, v56, v57
  v_mfma_f32_16x16x32_bf16 v[96:99], v[76:79], v[88:91], 0
  ds_write_b32 v2, v58
  v_smfmac_f32_16x16x64_bf16 v[60:63], v[32:35], a[8:15], v6
  v_mov_b32 v76, 0
  v_smfmac_f32_16x16x64_bf16 v[60:63], v[36:39], a[0:7], v6
  v_cndmask_b32 v48, v92, v96, s[18:19]
  v_smfmac_f32_16x16x64_bf16 v[60:63], v[40:43], v[248:255], v6
  v_cndmask_b32 v49, v93, v97, s[18:19]
  v_smfmac_f32_16x16x64_bf16 v[60:63], v[44:47], v[240:247], v6
  v_cndmask_b32 v50, v94, v98, s[18:19]
  v_smfmac_f32_16x16x64_bf16 v[68:71], v[20:23], v[152:159], v6
  v_cndmask_b32 v51, v95, v99, s[18:19]
  v_smfmac_f32_16x16x64_bf16 v[64:67], v[24:27], v[232:239], v6
  ds_write_b128 v8, v[48:51] offset:12288
  v_add_f32 v60, v60, v62
  v_add_f32 v61, v61, v63
  v_cvt_pk_bf16_f32 v62, v60, v61
  v_smfmac_f32_16x16x64_bf16 v[64:67], v[28:31], v[224:231], v6
  ds_write_b32 v2, v62 offset:512
  s_waitcnt vmcnt(6)
  v_mov_b32 v79, 0
  v_smfmac_f32_16x16x64_bf16 v[64:67], v[32:35], v[216:223], v6
  v_mov_b64 v[20:21], s[14:15]
  v_smfmac_f32_16x16x64_bf16 v[64:67], v[36:39], v[200:207], v6
  v_mov_b64 v[22:23], s[14:15]
  v_smfmac_f32_16x16x64_bf16 v[64:67], v[40:43], v[192:199], v6
  s_waitcnt lgkmcnt(0)
  s_barrier
  ds_read_b128 v[52:55], v9 offset:12288
  ds_read_b128 v[56:59], v10 offset:12288
  v_smfmac_f32_16x16x64_bf16 v[64:67], v[44:47], v[184:191], v6
  ds_read_b128 v[60:63], v11 offset:12288
  v_smfmac_f32_16x16x64_bf16 v[68:71], v[24:27], v[176:183], v6
  ds_read_b64_tr_b16 v[88:89], v12 offset:0
  ds_read_b64_tr_b16 v[90:91], v12 offset:512
  v_smfmac_f32_16x16x64_bf16 v[68:71], v[28:31], v[168:175], v6
  ds_read_b64_tr_b16 v[92:93], v13 offset:0
  ds_read_b64_tr_b16 v[94:95], v13 offset:512
  v_add_f32 v64, v64, v66
  v_smfmac_f32_16x16x64_bf16 v[68:71], v[32:35], v[160:167], v6
  ds_read_b64_tr_b16 v[96:97], v14 offset:0
  ds_read_b64_tr_b16 v[98:99], v14 offset:512
  v_add_f32 v65, v65, v67
  v_smfmac_f32_16x16x64_bf16 v[68:71], v[36:39], v[144:151], v6
  ds_read_b64_tr_b16 v[100:101], v15 offset:0
  ds_read_b64_tr_b16 v[102:103], v15 offset:512
  s_waitcnt lgkmcnt(8)
  v_cvt_pk_bf16_f32 v66, v64, v65
  v_smfmac_f32_16x16x64_bf16 v[68:71], v[40:43], v[136:143], v6
  v_add_f32 v48, v48, v52
  v_smfmac_f32_16x16x64_bf16 v[68:71], v[44:47], v[128:135], v6
  s_waitcnt lgkmcnt(4)
  v_add_f32 v49, v49, v53
  v_mfma_f32_16x16x32_bf16 v[16:19], v[88:91], v[88:91], 0
  buffer_store_dwordx4 v[88:91], v8, s[4:7], s25 offen sc1
  v_add_f32 v50, v50, v54
  v_add_f32 v51, v51, v55
  v_mfma_f32_16x16x32_bf16 v[16:19], v[92:95], v[92:95], v[16:19]
  s_waitcnt lgkmcnt(0)
  v_add_f32 v56, v56, v60
  v_add_f32 v57, v57, v61
  v_mfma_f32_16x16x32_bf16 v[16:19], v[96:99], v[96:99], v[16:19]
  v_add_f32 v58, v58, v62
  v_add_f32 v59, v59, v63
  v_mfma_f32_16x16x32_bf16 v[16:19], v[100:103], v[100:103], v[16:19]
  v_add_f32 v48, v48, v56
  v_add_f32 v49, v49, v57
  v_add_f32 v50, v50, v58
  v_add_f32 v51, v51, v59
  v_exp_f32 v24, v48
  v_exp_f32 v25, v49
  v_exp_f32 v26, v50
  v_exp_f32 v27, v51
  v_cvt_pk_bf16_f32 v24, v24, v25
  v_mul_f32 v16, s24, v16
  v_cvt_pk_bf16_f32 v25, v26, v27
  v_cndmask_b32 v72, v24, 0, s[18:19]
  v_cndmask_b32 v73, v25, 0, s[18:19]
  v_cndmask_b32 v74, 0, v24, s[18:19]
  v_cndmask_b32 v75, 0, v25, s[18:19]
  v_mul_f32 v17, s24, v17
  v_exp_f32 v28, v16
  v_mfma_f32_16x16x32_bf16 v[60:63], v[72:75], v[20:23], 0
  v_exp_f32 v29, v17
  v_add_f32 v68, v68, v70
  v_mfma_f32_16x16x32_bf16 v[52:55], v[72:75], v[80:83], 0
  s_add_u32 s30, s25, 4096
  v_cvt_pk_bf16_f32 v28, v28, v29
  v_add_f32 v69, v69, v71
  v_mfma_f32_16x16x32_bf16 v[56:59], v[72:75], v[84:87], 0
  v_cndmask_b32 v77, 0, v28, s[18:19]
  v_cndmask_b32 v78, 0, v28, s[18:19]
  v_cvt_pk_bf16_f32 v67, v68, v69
  v_lshrrev_b32 v92, 1, v8
  v_mfma_f32_16x16x16_bf16 v[60:63], v[76:77], v[20:21], v[60:63]
  buffer_store_dwordx2 v[66:67], v92, s[4:7], s30 offen sc1
  v_max3_f32 v7, |v48|, |v49|, |v50|
  v_max_f32 v26, |v16|, |v17|
  v_mfma_f32_16x16x16_bf16 v[52:55], v[78:79], v[66:67], v[52:55]
  v_cndmask_b32 v26, 0, v26, s[18:19]
  v_max3_f32 v7, |v51|, v26, v7
  v_mfma_f32_16x16x16_bf16 v[56:59], v[76:77], v[66:67], v[56:59]
  v_cmp_lt_f32 vcc, 0x42700000, v7
  v_mov_b64 v[44:45], 0
  v_add_f32 v60, v60, v62
  v_add_f32 v61, v61, v63
  s_cbranch_vccnz c_fb_10
c_fbr_11:
  v_rcp_f32 v60, v60
  v_rcp_f32 v61, v61
  v_pk_add_f32 v[52:53], v[52:53], v[54:55]
  v_pk_add_f32 v[56:57], v[56:57], v[58:59]
  v_pk_mul_f32 v[52:53], v[52:53], v[60:61]
  v_pk_mul_f32 v[56:57], v[56:57], v[60:61]
  v_cvt_pk_bf16_f32 v54, v52, v53
  v_cvt_pk_bf16_f32 v55, v56, v57
  ds_write_b64 v2, v[54:55] offset:4096
  v_mov_b64 v[46:47], 0
  v_mov_b64 v[40:41], 0
  v_mov_b64 v[42:43], 0
  v_mov_b64 v[36:37], 0
  v_mov_b64 v[38:39], 0
  v_mov_b64 v[32:33], 0
  v_mov_b64 v[34:35], 0
  v_mov_b64 v[28:29], 0
  v_mov_b64 v[30:31], 0
  v_mov_b64 v[24:25], 0
  v_mov_b64 v[26:27], 0
  v_mov_b64 v[80:81], 0
  s_waitcnt lgkmcnt(0)
  s_barrier
  ds_read_b64_tr_b16 v[72:73], v3 offset:4096
  ds_read_b64_tr_b16 v[74:75], v3 offset:5120
  ds_read_b64_tr_b16 v[76:77], v3 offset:6144
  ds_read_b64_tr_b16 v[78:79], v3 offset:7168
  s_and_b32 s3, s22, 1
  s_add_u32 s22, s22, 1
  s_and_b32 s42, s22, 3
  s_lshl_b32 s42, s42, 13
  s_cmp_eq_u32 s22, 64
  s_cbranch_scc1 c_last_13
  s_waitcnt lgkmcnt(2)
  v_smfmac_f32_16x16x64_bf16 v[44:47], v[72:75], a[248:255], v6
  s_waitcnt lgkmcnt(0)
  ds_read_b128 v[16:19], v8 offset:40960
  v_mov_b64 v[82:83], 0
  v_smfmac_f32_16x16x64_bf16 v[44:47], v[76:79], a[240:247], v6
  ds_read_b128 v[20:23], v8 offset:45056
  v_mov_b64 v[84:85], 0
  v_smfmac_f32_16x16x64_bf16 v[40:43], v[72:75], a[232:239], v6
  ds_read_b128 v[88:91], v8 offset:49152
  v_mov_b64 v[86:87], 0
  v_smfmac_f32_16x16x64_bf16 v[40:43], v[76:79], a[224:231], v6
  ds_read_b128 v[92:95], v8 offset:53248
  v_add_f32 v44, v44, v46
  v_add_f32 v45, v45, v47
  v_smfmac_f32_16x16x64_bf16 v[36:39], v[72:75], a[216:223], v6
  ds_read_b128 v[96:99], v8 offset:57344
  v_cvt_pk_bf16_f32 v48, v44, v45
  v_and_or_b32 v48, v48, -2, s3
  v_smfmac_f32_16x16x64_bf16 v[36:39], v[76:79], a[208:215], v6
  ds_read_b128 v[100:103], v8 offset:61440
  v_add_f32 v40, v40, v42
  v_add_f32 v41, v41, v43
  v_smfmac_f32_16x16x64_bf16 v[32:35], v[72:75], a[200:207], v6
  v_cvt_pk_bf16_f32 v49, v40, v41
  v_smfmac_f32_16x16x64_bf16 v[32:35], v[76:79], a[192:199], v6
  v_add_f32 v36, v36, v38
  v_add_f32 v37, v37, v39
  v_smfmac_f32_16x16x64_bf16 v[28:31], v[72:75], a[184:191], v6
  v_cvt_pk_bf16_f32 v50, v36, v37
  v_smfmac_f32_16x16x64_bf16 v[28:31], v[76:79], a[176:183], v6
  v_add_f32 v32, v32, v34
  v_add_f32 v33, v33, v35
  v_smfmac_f32_16x16x64_bf16 v[24:27], v[72:75], v[104:111], v6
  v_cvt_pk_bf16_f32 v51, v32, v33
  v_smfmac_f32_16x16x64_bf16 v[24:27], v[76:79], v[112:119], v6
  buffer_store_dwordx4 v[48:51], v4, s[4:7], s40 offen
  v_add_f32 v28, v28, v30
  v_add_f32 v29, v29, v31
  v_smfmac_f32_16x16x64_bf16 v[80:83], v[72:75], v[120:127], v6
  s_waitcnt lgkmcnt(0)
  v_cvt_pk_bf16_f32 v52, v28, v29
  v_and_or_b32 v52, v52, -2, s3
  v_smfmac_f32_16x16x64_bf16 v[80:83], v[76:79], v[16:23], v6
  v_add_f32 v24, v24, v26
  v_add_f32 v25, v25, v27
  v_smfmac_f32_16x16x64_bf16 v[84:87], v[72:75], v[88:95], v6
  v_cvt_pk_bf16_f32 v53, v24, v25
  v_smfmac_f32_16x16x64_bf16 v[84:87], v[76:79], v[96:103], v6
  v_add_f32 v80, v80, v82
  v_add_f32 v81, v81, v83
  v_cvt_pk_bf16_f32 v54, v80, v81
  s_nop 0
  s_nop 3
  v_pk_add_f32 v[84:85], v[84:85], v[86:87]
  v_cvt_pk_bf16_f32 v55, v84, v85
  buffer_store_dwordx4 v[52:55], v4, s[4:7], s41 offen
  s_add_u32 s42, s42, s62
  s_add_u32 s43, s42, 4096
  s_add_u32 s23, s23, 524288
  s_add_u32 s25, s25, 262144
  s_add_u32 s63, s63, 4096
  s_add_u32 s64, s64, 2048
  s_andn2_b32 s64, s64, s2
  s_add_u32 s97, s97, 8192
  s_cmp_lg_u32 s17, 0
  s_cbranch_scc1 c_oth_21
  s_mov_b32 s28, 0
  s_add_u32 s46, s46, 1
  v_mov_b64 v[64:65], -1
  s_xor_b32 s34, s42, 16384
  buffer_store_dwordx2 v[64:65], v5, s[4:7], s34 offen
  s_mov_b32 vcc_lo, 0xaaaaaaaa
  s_mov_b32 vcc_hi, 0xaaaaaaaa
  v_mov_b32 v7, 0x3f80
  v_cndmask_b32 v7, v7, 1.0, vcc
  s_mov_b32 vcc_lo, 0x30003
  s_mov_b32 vcc_hi, 0x30003
  v_cndmask_b32 v68, 0, v7, vcc
  s_mov_b32 vcc_lo, 0xc000c
  s_mov_b32 vcc_hi, 0xc000c
  v_cndmask_b32 v69, 0, v7, vcc
  s_mov_b32 vcc_lo, 0x300030
  s_mov_b32 vcc_hi, 0x300030
  v_cndmask_b32 v70, 0, v7, vcc
  s_mov_b32 vcc_lo, 0xc000c0
  s_mov_b32 vcc_hi, 0xc000c0
  v_cndmask_b32 v71, 0, v7, vcc
  ds_read_b128 v[104:107], v1 offset:14336
  ds_read_b128 v[108:111], v1 offset:15360
  s_waitcnt lgkmcnt(0)
  ds_read_b128 v[112:115], v1 offset:16384
  ds_read_b128 v[116:119], v1 offset:17408
  ds_read_b128 v[120:123], v1 offset:18432
  ds_read_b128 v[124:127], v1 offset:19456
  s_waitcnt lgkmcnt(0)
  buffer_load_dwordx4 v[16:19], v0, s[4:7], s38 offen offset:0 sc1
  buffer_load_dwordx4 v[20:23], v0, s[4:7], s38 offen offset:1024 sc1
  buffer_load_dwordx4 v[24:27], v0, s[4:7], s38 offen offset:2048 sc1
  buffer_load_dwordx4 v[28:31], v0, s[4:7], s38 offen offset:3072 sc1
  buffer_load_dwordx4 v[32:35], v0, s[4:7], s39 offen offset:0 sc1
  buffer_load_dwordx4 v[36:39], v0, s[4:7], s39 offen offset:1024 sc1
  buffer_load_dwordx4 v[40:43], v0, s[4:7], s39 offen offset:2048 sc1
  buffer_load_dwordx4 v[44:47], v0, s[4:7], s39 offen offset:3072 sc1
  buffer_load_dwordx4 v[72:75], v0, s[4:7], s38 offen offset:0 sc1
  buffer_load_dwordx4 v[76:79], v0, s[4:7], s38 offen offset:1024 sc1
  buffer_load_dwordx4 v[80:83], v0, s[4:7], s38 offen offset:2048 sc1
  buffer_load_dwordx4 v[84:87], v0, s[4:7], s38 offen offset:3072 sc1
  buffer_load_dwordx4 v[88:91], v0, s[4:7], s39 offen offset:0 sc1
  buffer_load_dwordx4 v[92:95], v0, s[4:7], s39 offen offset:1024 sc1
  buffer_load_dwordx4 v[96:99], v0, s[4:7], s39 offen offset:2048 sc1
  buffer_load_dwordx4 v[100:103], v0, s[4:7], s39 offen offset:3072 sc1
  s_buffer_load_dword s65, s[4:7], s63
  s_waitcnt vmcnt(15)
  v_mfma_f32_16x16x32_bf16 v[64:67], v[16:19], v[68:71], 0
  v_xor_b32 v7, s3, v16
  s_waitcnt vmcnt(14)
  v_mfma_f32_16x16x32_bf16 v[64:67], v[20:23], v[68:71], v[64:67]
  v_bitop3_b32 v7, v7, v20, s3 bitop3:0xf6
  s_waitcnt vmcnt(13)
  v_mfma_f32_16x16x32_bf16 v[64:67], v[24:27], v[68:71], v[64:67]
  v_bitop3_b32 v7, v7, v24, s3 bitop3:0xf6
  s_waitcnt vmcnt(12)
  v_mfma_f32_16x16x32_bf16 v[64:67], v[28:31], v[68:71], v[64:67]
  v_bitop3_b32 v7, v7, v28, s3 bitop3:0xf6
  s_waitcnt vmcnt(11)
  v_mfma_f32_16x16x32_bf16 v[64:67], v[32:35], v[68:71], v[64:67]
  v_bitop3_b32 v7, v7, v32, s3 bitop3:0xf6
  s_waitcnt vmcnt(10)
  v_mfma_f32_16x16x32_bf16 v[64:67], v[36:39], v[68:71], v[64:67]
  v_bitop3_b32 v7, v7, v36, s3 bitop3:0xf6
  s_waitcnt vmcnt(9)
  v_mfma_f32_16x16x32_bf16 v[64:67], v[40:43], v[68:71], v[64:67]
  v_bitop3_b32 v7, v7, v40, s3 bitop3:0xf6
  s_waitcnt vmcnt(8)
  v_mfma_f32_16x16x32_bf16 v[64:67], v[44:47], v[68:71], v[64:67]
  v_bitop3_b32 v7, v7, v44, s3 bitop3:0xf6
  v_and_b32 v7, 1, v7
  v_cmp_ne_u32 vcc, 0, v7
  v_mov_b32 v7, 0
  v_mov_b32 v7, 0
  s_cbranch_vccnz c_p1r_22
c_publ_23:
  s_nop 1
  s_nop 0
  v_cvt_pk_bf16_f32 v64, v64, v65
  v_cvt_pk_bf16_f32 v65, v66, v67
  v_min_u32 v64, -2, v64
  v_min_u32 v65, -2, v65
  buffer_store_dwordx2 v[64:65], v5, s[4:7], s42 offen
  s_waitcnt vmcnt(1)
  ds_read_b128 v[24:27], v1 offset:0
  ds_read_b128 v[28:31], v1 offset:1024
  ds_read_b128 v[32:35], v1 offset:2048
  ds_read_b128 v[36:39], v1 offset:3072
  ds_read_b128 v[40:43], v1 offset:4096
  ds_read_b128 v[44:47], v1 offset:5120
  ds_read_b128 v[72:75], v1 offset:6144
  ds_read_b128 v[76:79], v1 offset:7168
  ds_read_b128 v[80:83], v1 offset:8192
  ds_read_b128 v[84:87], v1 offset:9216
  ds_read_b128 v[88:91], v1 offset:10240
  ds_read_b128 v[92:95], v1 offset:11264
  ds_read_b128 v[96:99], v1 offset:12288
  ds_read_b128 v[100:103], v1 offset:13312
c_hop2_9:
  s_barrier
  s_cmp_lg_u32 s96, 268435456
  s_cbranch_scc1 c_loop_6
  buffer_store_dwordx2 v[64:65], v5, s[4:7], s97 offen sc1
  s_mov_b32 s29, 0
  s_sub_u32 s92, s63, 4096
  s_sub_u32 s96, s23, 524288
  s_mov_b32 s95, 0
c_gw_24:
  buffer_load_dword v7, off, s[4:7], s92 sc1
  s_add_u32 s29, s29, 1
  s_cmp_gt_u32 s29, 1048576
  s_cbranch_scc1 c_fail_12
  s_waitcnt vmcnt(0) lgkmcnt(0)
  v_readfirstlane_b32 s65, v7
  s_cmp_eq_u32 s65, 0
  s_cbranch_scc1 c_gw_24
  s_and_b32 s65, s65, s93
  s_cbranch_scc1 c_kvx_26
  s_mov_b32 s95, 1
  s_add_u32 s96, s96, 33554432
  s_add_u32 s92, s92, 262144
c_kvw_25:
  buffer_load_dword v7, off, s[4:7], s92 sc1
  s_add_u32 s29, s29, 1
  s_cmp_gt_u32 s29, 1048576
  s_cbranch_scc1 c_fail_12
  s_waitcnt vmcnt(0) lgkmcnt(0)
  v_readfirstlane_b32 s65, v7
  s_cmp_eq_u32 s65, 0
  s_cbranch_scc1 c_kvw_25
c_kvx_26:
  buffer_load_dword v7, off, s[4:7], s63 sc1
  buffer_load_dwordx4 v0, s[4:7], s96 offen offset:0  lds
  buffer_load_dwordx4 v0, s[4:7], s96 offen offset:1024  lds
  buffer_load_dwordx4 v0, s[4:7], s96 offen offset:2048  lds
  buffer_load_dwordx4 v0, s[4:7], s96 offen offset:3072  lds
  s_waitcnt vmcnt(4)
  v_readfirstlane_b32 s65, v7
  s_cmp_eq_u32 s95, 0
  s_cbranch_scc1 c_loop_6
  s_mov_b32 s29, 0
c_fk_27:
  buffer_load_dwordx4 v[16:19], v8, s[4:7], s42 offen sc1
  buffer_load_dwordx4 v[20:23], v8, s[4:7], s43 offen sc1
  s_add_u32 s29, s29, 1
  s_cmp_gt_u32 s29, 1048576
  s_cbranch_scc1 c_fail_12
  s_waitcnt vmcnt(0)
  v_max3_u32 v7, v16, v17, v18
  v_max3_u32 v7, v19, v20, v7
  v_max3_u32 v7, v21, v22, v7
  v_max_u32 v7, v7, v23
  v_cmp_eq_u32 vcc, -1, v7
  s_cbranch_vccnz c_fk_27
  s_lshl_b32 s42, s22, 13
  s_add_u32 s42, s42, 245891072
  s_add_u32 s43, s42, 4096
  s_mov_b32 s95, 0
  s_branch c_loop_6
c_last_13:
  s_add_u32 s64, s64, 2048
  v_mov_b32 v7, 1
  s_waitcnt vmcnt(0)
  s_barrier
  s_mov_b64 exec, 1
  buffer_store_dword v7, off, s[4:7], s64 sc1
  s_mov_b64 exec, -1
  s_branch c_fail_12
c_oth_21:
  s_buffer_load_dword s65, s[4:7], s63
  ds_read_b128 v[24:27], v1 offset:0
  ds_read_b128 v[28:31], v1 offset:1024
  ds_read_b128 v[32:35], v1 offset:2048
  ds_read_b128 v[36:39], v1 offset:3072
  ds_read_b128 v[40:43], v1 offset:4096
  ds_read_b128 v[44:47], v1 offset:5120
  ds_read_b128 v[72:75], v1 offset:6144
  ds_read_b128 v[76:79], v1 offset:7168
  ds_read_b128 v[80:83], v1 offset:8192
  ds_read_b128 v[84:87], v1 offset:9216
  ds_read_b128 v[88:91], v1 offset:10240
  ds_read_b128 v[92:95], v1 offset:11264
  ds_read_b128 v[96:99], v1 offset:12288
  ds_read_b128 v[100:103], v1 offset:13312
  ds_read_b128 v[104:107], v1 offset:14336
  ds_read_b128 v[108:111], v1 offset:15360
  ds_read_b128 v[112:115], v1 offset:16384
  ds_read_b128 v[116:119], v1 offset:17408
  ds_read_b128 v[120:123], v1 offset:18432
  ds_read_b128 v[124:127], v1 offset:19456
  s_branch c_hop2_9
c_p1r_22:
  s_waitcnt vmcnt(7)
  s_nop 0
  v_mfma_f32_16x16x32_bf16 v[64:67], v[72:75], v[68:71], 0
  v_xor_b32 v7, s3, v72
  s_waitcnt vmcnt(6)
  v_mfma_f32_16x16x32_bf16 v[64:67], v[76:79], v[68:71], v[64:67]
  v_bitop3_b32 v7, v7, v76, s3 bitop3:0xf6
  s_waitcnt vmcnt(5)
  v_mfma_f32_16x16x32_bf16 v[64:67], v[80:83], v[68:71], v[64:67]
  v_bitop3_b32 v7, v7, v80, s3 bitop3:0xf6
  s_waitcnt vmcnt(4)
  v_mfma_f32_16x16x32_bf16 v[64:67], v[84:87], v[68:71], v[64:67]
  v_bitop3_b32 v7, v7, v84, s3 bitop3:0xf6
  s_waitcnt vmcnt(3)
  v_mfma_f32_16x16x32_bf16 v[64:67], v[88:91], v[68:71], v[64:67]
  v_bitop3_b32 v7, v7, v88, s3 bitop3:0xf6
  s_waitcnt vmcnt(2)
  v_mfma_f32_16x16x32_bf16 v[64:67], v[92:95], v[68:71], v[64:67]
  v_bitop3_b32 v7, v7, v92, s3 bitop3:0xf6
  s_waitcnt vmcnt(1)
  v_mfma_f32_16x16x32_bf16 v[64:67], v[96:99], v[68:71], v[64:67]
  v_bitop3_b32 v7, v7, v96, s3 bitop3:0xf6
  s_waitcnt vmcnt(0)
  v_mfma_f32_16x16x32_bf16 v[64:67], v[100:103], v[68:71], v[64:67]
  v_bitop3_b32 v7, v7, v100, s3 bitop3:0xf6
  v_and_b32 v7, 1, v7
  v_cmp_ne_u32 vcc, 0, v7
  s_add_u32 s46, s46, 1
  s_cbranch_vccz c_publ_23
  buffer_load_dwordx4 v[72:75], v0, s[4:7], s38 offen offset:0 sc1
  buffer_load_dwordx4 v[76:79], v0, s[4:7], s38 offen offset:1024 sc1
  buffer_load_dwordx4 v[80:83], v0, s[4:7], s38 offen offset:2048 sc1
  buffer_load_dwordx4 v[84:87], v0, s[4:7], s38 offen offset:3072 sc1
  buffer_load_dwordx4 v[88:91], v0, s[4:7], s39 offen offset:0 sc1
  buffer_load_dwordx4 v[92:95], v0, s[4:7], s39 offen offset:1024 sc1
  buffer_load_dwordx4 v[96:99], v0, s[4:7], s39 offen offset:2048 sc1
  buffer_load_dwordx4 v[100:103], v0, s[4:7], s39 offen offset:3072 sc1
  s_add_u32 s28, s28, 1
  s_cmp_gt_u32 s28, 1048576
  s_cbranch_scc0 c_p1r_22
  s_branch c_fail_12
c_retry_7:
  v_mov_b64 v[48:49], 0
  v_mov_b64 v[50:51], 0
  s_nop 0
  v_mov_b64 v[52:53], 0
  v_mov_b64 v[54:55], 0
  s_nop 1
  v_mov_b64 v[56:57], 0
  v_mov_b64 v[58:59], 0
c_rl_28:
  buffer_load_dwordx4 v[16:19], v8, s[4:7], s42 offen sc1
  buffer_load_dwordx4 v[20:23], v8, s[4:7], s43 offen sc1
  s_add_u32 s28, s28, 1
  s_add_u32 s47, s47, 1
  s_cmp_gt_u32 s28, 1048576
  s_cbranch_scc1 c_fail_12
  s_waitcnt vmcnt(2)
  v_max3_u32 v7, v16, v17, v18
  v_max3_u32 v7, v19, v20, v7
  v_max3_u32 v7, v21, v22, v7
  v_max_u32 v7, v7, v23
  v_cmp_eq_u32 vcc, -1, v7
  s_cbranch_vccnz c_rl_28
  ds_write_b128 v8, v[16:19] offset:4096
  v_smfmac_f32_16x16x64_bf16 v[48:51], v[16:19], v[24:31], v6
  ds_write_b128 v8, v[20:23] offset:8192
  v_smfmac_f32_16x16x64_bf16 v[52:55], v[16:19], v[32:39], v6
  v_smfmac_f32_16x16x64_bf16 v[56:59], v[16:19], v[40:47], v6
  s_branch c_got_8
c_fb_10:
  v_max3_f32 v7, v48, v49, v50
  v_max_f32 v7, v51, v7
  s_mov_b64 exec, s[18:19]
  v_max3_f32 v7, v16, v17, v7
  s_mov_b64 exec, -1
  s_nop 0
  v_max_f32_dpp v7, v7, v7 quad_perm:[2,3,0,1] row_mask:0xf bank_mask:0xf
  v_mov_b32 v24, v7
  s_nop 0
  s_nop 0
  v_permlane16_swap_b32 v7, v24
  v_max_f32 v7, v7, v24
  v_mov_b32 v24, v7
  s_nop 0
  s_nop 0
  v_permlane32_swap_b32 v7, v24
  v_max_f32 v7, v7, v24
  v_sub_f32 v24, v48, v7
  v_sub_f32 v25, v49, v7
  v_sub_f32 v26, v50, v7
  v_sub_f32 v27, v51, v7
  v_sub_f32 v28, v16, v7
  v_sub_f32 v29, v17, v7
  v_exp_f32 v24, v24
  v_exp_f32 v25, v25
  v_exp_f32 v26, v26
  v_exp_f32 v27, v27
  v_exp_f32 v28, v28
  v_exp_f32 v29, v29
  v_cvt_pk_bf16_f32 v24, v24, v25
  v_cvt_pk_bf16_f32 v25, v26, v27
  v_cvt_pk_bf16_f32 v28, v28, v29
  v_cndmask_b32 v72, v24, 0, s[18:19]
  v_cndmask_b32 v73, v25, 0, s[18:19]
  v_cndmask_b32 v74, 0, v24, s[18:19]
  v_cndmask_b32 v75, 0, v25, s[18:19]
  v_cndmask_b32 v77, 0, v28, s[18:19]
  v_cndmask_b32 v78, 0, v28, s[18:19]
  v_mfma_f32_16x16x32_bf16 v[60:63], v[72:75], v[20:23], 0
  v_mfma_f32_16x16x32_bf16 v[52:55], v[72:75], v[80:83], 0
  v_mfma_f32_16x16x32_bf16 v[56:59], v[72:75], v[84:87], 0
  v_mfma_f32_16x16x16_bf16 v[60:63], v[76:77], v[20:21], v[60:63]
  v_mfma_f32_16x16x16_bf16 v[52:55], v[78:79], v[66:67], v[52:55]
  s_nop 2
  v_mfma_f32_16x16x16_bf16 v[56:59], v[76:77], v[66:67], v[56:59]
  s_nop 7
  v_add_f32 v60, v60, v62
  v_add_f32 v61, v61, v63
  s_branch c_fbr_11
c_fail_12:
  s_endpgm
L_chain_x:
  s_mov_b32 s22, 0
  s_mov_b32 s42, s62
  s_add_u32 s43, s62, 4096
  s_mov_b32 s46, 0
  s_mov_b32 s47, 0
  s_lshl_b32 s26, s16, 2
  s_add_u32 s26, s26, s17
  s_lshl_b32 s27, s60, 13
  s_add_u32 s27, s27, s26
  s_lshr_b32 s25, s27, 2
  s_lshl_b32 s25, s25, 13
  s_add_u32 s25, s25, 192937984
  s_lshr_b32 s64, s27, 2
  s_lshl_b32 s64, s64, 6
  s_add_u32 s64, s64, 513538048
  s_cmp_eq_u32 s17, 3
  s_cselect_b32 s2, 268435456, 0
  s_lshl_b32 s27, s61, 13
  s_add_u32 s27, s27, s26
  s_lshl_b32 s23, s27, 12
  s_add_u32 s23, s23, 41943040
  s_lshl_b32 s63, s27, 5
  s_add_u32 s63, s63, 244318208
  s_mov_b32 s97, 268435456
  s_cmp_eq_u32 s60, 2
  s_cselect_b32 s93, 1, 3
  s_lshl_b32 s26, s17, 2
  s_add_u32 s26, s26, s60
  s_cmp_eq_u32 s26, 1
  s_cselect_b32 s97, 245891072, s97
  s_mov_b32 s95, 0
  s_mov_b32 s96, s23
  s_add_u32 s23, s23, 524288
  s_add_u32 s63, s63, 4096
  s_mov_b32 s29, 0
  s_sub_u32 s92, s63, 4096
  s_sub_u32 s96, s23, 524288
  s_mov_b32 s95, 0
c_gw_37:
  buffer_load_dword v7, off, s[4:7], s92 sc1
  s_add_u32 s29, s29, 1
  s_cmp_gt_u32 s29, 1048576
  s_cbranch_scc1 c_fail_35
  s_waitcnt vmcnt(0) lgkmcnt(0)
  v_readfirstlane_b32 s65, v7
  s_cmp_eq_u32 s65, 0
  s_cbranch_scc1 c_gw_37
  s_and_b32 s65, s65, s93
  s_cbranch_scc1 c_kvx_39
  s_mov_b32 s95, 1
  s_add_u32 s96, s96, 33554432
  s_add_u32 s92, s92, 262144
c_kvw_38:
  buffer_load_dword v7, off, s[4:7], s92 sc1
  s_add_u32 s29, s29, 1
  s_cmp_gt_u32 s29, 1048576
  s_cbranch_scc1 c_fail_35
  s_waitcnt vmcnt(0) lgkmcnt(0)
  v_readfirstlane_b32 s65, v7
  s_cmp_eq_u32 s65, 0
  s_cbranch_scc1 c_kvw_38
c_kvx_39:
  buffer_load_dword v7, off, s[4:7], s63 sc1
  buffer_load_dwordx4 v0, s[4:7], s96 offen offset:0  lds
  buffer_load_dwordx4 v0, s[4:7], s96 offen offset:1024  lds
  buffer_load_dwordx4 v0, s[4:7], s96 offen offset:2048  lds
  buffer_load_dwordx4 v0, s[4:7], s96 offen offset:3072  lds
  s_waitcnt vmcnt(4)
  v_readfirstlane_b32 s65, v7
  ds_read_b128 v[72:75], v1 offset:6144
  ds_read_b128 v[76:79], v1 offset:7168
  ds_read_b128 v[80:83], v1 offset:8192
  ds_read_b128 v[84:87], v1 offset:9216
  ds_read_b128 v[88:91], v1 offset:10240
  ds_read_b128 v[92:95], v1 offset:11264
  ds_read_b128 v[96:99], v1 offset:12288
  ds_read_b128 v[100:103], v1 offset:13312
  ds_read_b128 v[104:107], v1 offset:14336
  ds_read_b128 v[108:111], v1 offset:15360
  ds_read_b128 v[112:115], v1 offset:16384
  ds_read_b128 v[116:119], v1 offset:17408
  ds_read_b128 v[120:123], v1 offset:18432
  ds_read_b128 v[124:127], v1 offset:19456
  v_mov_b64 v[48:49], 0
  v_mov_b64 v[50:51], 0
  v_mov_b64 v[52:53], 0
  v_mov_b64 v[54:55], 0
  v_mov_b64 v[56:57], 0
  v_mov_b64 v[58:59], 0
  v_mov_b64 v[60:61], 0
  v_mov_b64 v[62:63], 0
  v_mov_b64 v[64:65], 0
  v_mov_b64 v[66:67], 0
  v_mov_b64 v[68:69], 0
  v_mov_b64 v[70:71], 0
  s_lshl_b32 s38, s16, 13
  s_add_u32 s38, s38, s40
  s_add_u32 s39, s38, 4096
  ds_read_b128 v[24:27], v1 offset:0
  ds_read_b128 v[28:31], v1 offset:1024
  ds_read_b128 v[32:35], v1 offset:2048
  ds_read_b128 v[36:39], v1 offset:3072
  ds_read_b128 v[40:43], v1 offset:4096
  ds_read_b128 v[44:47], v1 offset:5120
  s_waitcnt lgkmcnt(0)
c_loop_29:
  buffer_load_dwordx4 v[16:19], v8, s[4:7], s42 offen sc1
  buffer_load_dwordx4 v[20:23], v8, s[4:7], s43 offen sc1
  s_mov_b32 s28, 0
  v_mov_b64 v[48:49], 0
  v_mov_b64 v[50:51], 0
  v_mov_b64 v[52:53], 0
  v_mov_b64 v[54:55], 0
  v_mov_b64 v[56:57], 0
  v_mov_b64 v[58:59], 0
  v_mov_b64 v[60:61], 0
  v_mov_b64 v[62:63], 0
  v_mov_b64 v[64:65], 0
  v_mov_b64 v[66:67], 0
  v_mov_b64 v[68:69], 0
  v_mov_b64 v[70:71], 0
  buffer_load_dwordx4 v[16:19], v8, s[4:7], s42 offen sc1
  buffer_load_dwordx4 v[20:23], v8, s[4:7], s43 offen sc1
  s_waitcnt lgkmcnt(0)
  s_waitcnt vmcnt(3)
  v_max3_u32 v7, v16, v17, v18
  v_max_u32 v7, v7, v19
  ds_write_b128 v8, v[16:19] offset:4096
  v_smfmac_f32_16x16x64_bf16 v[48:51], v[16:19], v[24:31], v6
  s_waitcnt vmcnt(2)
  v_max3_u32 v7, v20, v21, v7
  v_max3_u32 v7, v22, v23, v7
  ds_write_b128 v8, v[20:23] offset:8192
  v_smfmac_f32_16x16x64_bf16 v[52:55], v[16:19], v[32:39], v6
  v_cmp_eq_u32 vcc, -1, v7
  v_smfmac_f32_16x16x64_bf16 v[56:59], v[16:19], v[40:47], v6
  s_cbranch_vccnz c_retry_30
c_got_31:
  v_smfmac_f32_16x16x64_bf16 v[60:63], v[16:19], v[72:79], v6
  ds_read_b128 v[72:75], v1 offset:20480
  s_and_b32 s65, s65, s93
  s_cselect_b32 s96, s23, 268435456
  v_smfmac_f32_16x16x64_bf16 v[48:51], v[20:23], v[80:87], v6
  ds_read_b128 v[76:79], v1 offset:21504
  v_mov_b32 v7, 1
  v_smfmac_f32_16x16x64_bf16 v[52:55], v[20:23], v[88:95], v6
  ds_read_b128 v[80:83], v1 offset:22528
  v_smfmac_f32_16x16x64_bf16 v[56:59], v[20:23], v[96:103], v6
  ds_read_b128 v[84:87], v1 offset:23552
  s_waitcnt lgkmcnt(4)
  s_barrier
  ds_read_b128 v[24:27], v9 offset:4096
  ds_read_b128 v[28:31], v10 offset:4096
  v_smfmac_f32_16x16x64_bf16 v[60:63], v[20:23], v[104:111], v6
  ds_read_b128 v[32:35], v11 offset:4096
  v_smfmac_f32_16x16x64_bf16 v[64:67], v[16:19], v[112:119], v6
  ds_read_b128 v[36:39], v9 offset:8192
  v_smfmac_f32_16x16x64_bf16 v[68:71], v[16:19], v[120:127], v6
  ds_read_b128 v[40:43], v10 offset:8192
  v_smfmac_f32_16x16x64_bf16 v[64:67], v[20:23], v[208:215], v6
  ds_read_b128 v[44:47], v11 offset:8192
  s_waitcnt lgkmcnt(5)
  v_smfmac_f32_16x16x64_bf16 v[48:51], v[24:27], a[168:175], v6
  buffer_load_dwordx4 v0, s[4:7], s96 offen offset:0  lds
  s_waitcnt lgkmcnt(4)
  v_smfmac_f32_16x16x64_bf16 v[48:51], v[28:31], a[160:167], v6
  ds_read_b128 v[104:107], v8 offset:16384
  s_waitcnt lgkmcnt(4)
  v_smfmac_f32_16x16x64_bf16 v[48:51], v[32:35], a[152:159], v6
  buffer_load_dwordx4 v0, s[4:7], s96 offen offset:1024  lds
  s_waitcnt lgkmcnt(3)
  v_smfmac_f32_16x16x64_bf16 v[48:51], v[36:39], a[144:151], v6
  ds_read_b128 v[108:111], v8 offset:20480
  s_waitcnt lgkmcnt(3)
  v_smfmac_f32_16x16x64_bf16 v[48:51], v[40:43], a[136:143], v6
  buffer_load_dwordx4 v0, s[4:7], s96 offen offset:2048  lds
  s_waitcnt lgkmcnt(2)
  v_smfmac_f32_16x16x64_bf16 v[48:51], v[44:47], a[128:135], v6
  v_smfmac_f32_16x16x64_bf16 v[52:55], v[24:27], a[120:127], v6
  buffer_load_dwordx4 v0, s[4:7], s96 offen offset:3072  lds
  v_smfmac_f32_16x16x64_bf16 v[52:55], v[28:31], a[112:119], v6
  ds_read_b64 v[100:101], v5 offset:4096
  v_add_f32 v48, v48, v50
  v_smfmac_f32_16x16x64_bf16 v[52:55], v[32:35], a[104:111], v6
  ds_read_b128 v[112:115], v8 offset:24576
  v_add_f32 v49, v49, v51
  v_smfmac_f32_16x16x64_bf16 v[52:55], v[36:39], a[96:103], v6
  ds_read_b128 v[116:119], v8 offset:28672
  v_cvt_pk_bf16_f32 v50, v48, v49
  v_smfmac_f32_16x16x64_bf16 v[52:55], v[40:43], a[88:95], v6
  ds_write2_b32 v2, v50, v50 offset0:0 offset1:1
  v_smfmac_f32_16x16x64_bf16 v[52:55], v[44:47], a[80:87], v6
  ds_read_b64_tr_b16 v[88:89], v12 offset:0
  v_smfmac_f32_16x16x64_bf16 v[56:59], v[24:27], a[72:79], v6
  s_mov_b64 exec, 1
  buffer_store_dword v7, off, s[4:7], s64 sc1
  s_mov_b64 exec, -1
  v_smfmac_f32_16x16x64_bf16 v[56:59], v[28:31], a[64:71], v6
  ds_read_b128 v[120:123], v8 offset:32768
  v_add_f32 v52, v52, v54
  v_smfmac_f32_16x16x64_bf16 v[56:59], v[32:35], a[56:63], v6
  ds_read_b128 v[124:127], v8 offset:36864
  v_add_f32 v53, v53, v55
  v_cvt_pk_bf16_f32 v54, v52, v53
  v_smfmac_f32_16x16x64_bf16 v[56:59], v[36:39], a[48:55], v6
  ds_write2_b32 v2, v54, v54 offset0:128 offset1:129
  ds_read_b64_tr_b16 v[90:91], v12 offset:512
  v_smfmac_f32_16x16x64_bf16 v[56:59], v[40:43], a[40:47], v6
  v_smfmac_f32_16x16x64_bf16 v[56:59], v[44:47], a[32:39], v6
  v_smfmac_f32_16x16x64_bf16 v[60:63], v[24:27], a[24:31], v6
  v_smfmac_f32_16x16x64_bf16 v[60:63], v[28:31], a[16:23], v6
  s_waitcnt lgkmcnt(0)
  v_add_f32 v56, v56, v58
  v_mfma_f32_16x16x32_bf16 v[92:95], v[72:75], v[88:91], 0
  buffer_store_dwordx2 v[100:101], v5, s[4:7], s97 offen sc1
  v_add_f32 v57, v57, v59
  v_cvt_pk_bf16_f32 v58, v56, v57
  v_mfma_f32_16x16x32_bf16 v[96:99], v[76:79], v[88:91], 0
  ds_write_b32 v2, v58
  v_smfmac_f32_16x16x64_bf16 v[60:63], v[32:35], a[8:15], v6
  v_mov_b32 v76, 0
  v_smfmac_f32_16x16x64_bf16 v[60:63], v[36:39], a[0:7], v6
  v_cndmask_b32 v48, v92, v96, s[18:19]
  v_smfmac_f32_16x16x64_bf16 v[60:63], v[40:43], v[248:255], v6
  v_cndmask_b32 v49, v93, v97, s[18:19]
  v_smfmac_f32_16x16x64_bf16 v[60:63], v[44:47], v[240:247], v6
  v_cndmask_b32 v50, v94, v98, s[18:19]
  v_smfmac_f32_16x16x64_bf16 v[68:71], v[20:23], v[152:159], v6
  v_cndmask_b32 v51, v95, v99, s[18:19]
  v_smfmac_f32_16x16x64_bf16 v[64:67], v[24:27], v[232:239], v6
  ds_write_b128 v8, v[48:51] offset:12288
  v_add_f32 v60, v60, v62
  v_add_f32 v61, v61, v63
  v_cvt_pk_bf16_f32 v62, v60, v61
  v_smfmac_f32_16x16x64_bf16 v[64:67], v[28:31], v[224:231], v6
  ds_write_b32 v2, v62 offset:512
  s_waitcnt vmcnt(6)
  v_mov_b32 v79, 0
  v_smfmac_f32_16x16x64_bf16 v[64:67], v[32:35], v[216:223], v6
  v_mov_b64 v[20:21], s[14:15]
  v_smfmac_f32_16x16x64_bf16 v[64:67], v[36:39], v[200:207], v6
  v_mov_b64 v[22:23], s[14:15]
  v_smfmac_f32_16x16x64_bf16 v[64:67], v[40:43], v[192:199], v6
  s_waitcnt lgkmcnt(0)
  s_barrier
  ds_read_b128 v[52:55], v9 offset:12288
  ds_read_b128 v[56:59], v10 offset:12288
  v_smfmac_f32_16x16x64_bf16 v[64:67], v[44:47], v[184:191], v6
  ds_read_b128 v[60:63], v11 offset:12288
  v_smfmac_f32_16x16x64_bf16 v[68:71], v[24:27], v[176:183], v6
  ds_read_b64_tr_b16 v[88:89], v12 offset:0
  ds_read_b64_tr_b16 v[90:91], v12 offset:512
  v_smfmac_f32_16x16x64_bf16 v[68:71], v[28:31], v[168:175], v6
  ds_read_b64_tr_b16 v[92:93], v13 offset:0
  ds_read_b64_tr_b16 v[94:95], v13 offset:512
  v_add_f32 v64, v64, v66
  v_smfmac_f32_16x16x64_bf16 v[68:71], v[32:35], v[160:167], v6
  ds_read_b64_tr_b16 v[96:97], v14 offset:0
  ds_read_b64_tr_b16 v[98:99], v14 offset:512
  v_add_f32 v65, v65, v67
  v_smfmac_f32_16x16x64_bf16 v[68:71], v[36:39], v[144:151], v6
  ds_read_b64_tr_b16 v[100:101], v15 offset:0
  ds_read_b64_tr_b16 v[102:103], v15 offset:512
  s_waitcnt lgkmcnt(8)
  v_cvt_pk_bf16_f32 v66, v64, v65
  v_smfmac_f32_16x16x64_bf16 v[68:71], v[40:43], v[136:143], v6
  v_add_f32 v48, v48, v52
  v_smfmac_f32_16x16x64_bf16 v[68:71], v[44:47], v[128:135], v6
  s_waitcnt lgkmcnt(4)
  v_add_f32 v49, v49, v53
  v_mfma_f32_16x16x32_bf16 v[16:19], v[88:91], v[88:91], 0
  buffer_store_dwordx4 v[88:91], v8, s[4:7], s25 offen sc1
  v_add_f32 v50, v50, v54
  v_add_f32 v51, v51, v55
  v_mfma_f32_16x16x32_bf16 v[16:19], v[92:95], v[92:95], v[16:19]
  s_waitcnt lgkmcnt(0)
  v_add_f32 v56, v56, v60
  v_add_f32 v57, v57, v61
  v_mfma_f32_16x16x32_bf16 v[16:19], v[96:99], v[96:99], v[16:19]
  v_add_f32 v58, v58, v62
  v_add_f32 v59, v59, v63
  v_mfma_f32_16x16x32_bf16 v[16:19], v[100:103], v[100:103], v[16:19]
  v_add_f32 v48, v48, v56
  v_add_f32 v49, v49, v57
  v_add_f32 v50, v50, v58
  v_add_f32 v51, v51, v59
  v_exp_f32 v24, v48
  v_exp_f32 v25, v49
  v_exp_f32 v26, v50
  v_exp_f32 v27, v51
  v_cvt_pk_bf16_f32 v24, v24, v25
  v_mul_f32 v16, s24, v16
  v_cvt_pk_bf16_f32 v25, v26, v27
  v_cndmask_b32 v72, v24, 0, s[18:19]
  v_cndmask_b32 v73, v25, 0, s[18:19]
  v_cndmask_b32 v74, 0, v24, s[18:19]
  v_cndmask_b32 v75, 0, v25, s[18:19]
  v_mul_f32 v17, s24, v17
  v_exp_f32 v28, v16
  v_mfma_f32_16x16x32_bf16 v[60:63], v[72:75], v[20:23], 0
  v_exp_f32 v29, v17
  v_add_f32 v68, v68, v70
  v_mfma_f32_16x16x32_bf16 v[52:55], v[72:75], v[80:83], 0
  s_add_u32 s30, s25, 4096
  v_cvt_pk_bf16_f32 v28, v28, v29
  v_add_f32 v69, v69, v71
  v_mfma_f32_16x16x32_bf16 v[56:59], v[72:75], v[84:87], 0
  v_cndmask_b32 v77, 0, v28, s[18:19]
  v_cndmask_b32 v78, 0, v28, s[18:19]
  v_cvt_pk_bf16_f32 v67, v68, v69
  v_lshrrev_b32 v92, 1, v8
  v_mfma_f32_16x16x16_bf16 v[60:63], v[76:77], v[20:21], v[60:63]
  buffer_store_dwordx2 v[66:67], v92, s[4:7], s30 offen sc1
  v_max3_f32 v7, |v48|, |v49|, |v50|
  v_max_f32 v26, |v16|, |v17|
  v_mfma_f32_16x16x16_bf16 v[52:55], v[78:79], v[66:67], v[52:55]
  v_cndmask_b32 v26, 0, v26, s[18:19]
  v_max3_f32 v7, |v51|, v26, v7
  v_mfma_f32_16x16x16_bf16 v[56:59], v[76:77], v[66:67], v[56:59]
  v_cmp_lt_f32 vcc, 0x42700000, v7
  v_mov_b64 v[44:45], 0
  v_add_f32 v60, v60, v62
  v_add_f32 v61, v61, v63
  s_cbranch_vccnz c_fb_33
c_fbr_34:
  v_rcp_f32 v60, v60
  v_rcp_f32 v61, v61
  v_pk_add_f32 v[52:53], v[52:53], v[54:55]
  v_pk_add_f32 v[56:57], v[56:57], v[58:59]
  v_pk_mul_f32 v[52:53], v[52:53], v[60:61]
  v_pk_mul_f32 v[56:57], v[56:57], v[60:61]
  v_cvt_pk_bf16_f32 v54, v52, v53
  v_cvt_pk_bf16_f32 v55, v56, v57
  ds_write_b64 v2, v[54:55] offset:4096
  v_mov_b64 v[46:47], 0
  v_mov_b64 v[40:41], 0
  v_mov_b64 v[42:43], 0
  v_mov_b64 v[36:37], 0
  v_mov_b64 v[38:39], 0
  v_mov_b64 v[32:33], 0
  v_mov_b64 v[34:35], 0
  v_mov_b64 v[28:29], 0
  v_mov_b64 v[30:31], 0
  v_mov_b64 v[24:25], 0
  v_mov_b64 v[26:27], 0
  v_mov_b64 v[80:81], 0
  s_waitcnt lgkmcnt(0)
  s_barrier
  ds_read_b64_tr_b16 v[72:73], v3 offset:4096
  ds_read_b64_tr_b16 v[74:75], v3 offset:5120
  ds_read_b64_tr_b16 v[76:77], v3 offset:6144
  ds_read_b64_tr_b16 v[78:79], v3 offset:7168
  s_and_b32 s3, s22, 1
  s_add_u32 s22, s22, 1
  s_and_b32 s42, s22, 3
  s_lshl_b32 s42, s42, 13
  s_cmp_eq_u32 s22, 64
  s_cbranch_scc1 c_last_36
  s_waitcnt lgkmcnt(2)
  v_smfmac_f32_16x16x64_bf16 v[44:47], v[72:75], a[248:255], v6
  s_waitcnt lgkmcnt(0)
  ds_read_b128 v[16:19], v8 offset:40960
  v_mov_b64 v[82:83], 0
  v_smfmac_f32_16x16x64_bf16 v[44:47], v[76:79], a[240:247], v6
  ds_read_b128 v[20:23], v8 offset:45056
  v_mov_b64 v[84:85], 0
  v_smfmac_f32_16x16x64_bf16 v[40:43], v[72:75], a[232:239], v6
  ds_read_b128 v[88:91], v8 offset:49152
  v_mov_b64 v[86:87], 0
  v_smfmac_f32_16x16x64_bf16 v[40:43], v[76:79], a[224:231], v6
  ds_read_b128 v[92:95], v8 offset:53248
  v_add_f32 v44, v44, v46
  v_add_f32 v45, v45, v47
  v_smfmac_f32_16x16x64_bf16 v[36:39], v[72:75], a[216:223], v6
  ds_read_b128 v[96:99], v8 offset:57344
  v_cvt_pk_bf16_f32 v48, v44, v45
  v_and_or_b32 v48, v48, -2, s3
  v_smfmac_f32_16x16x64_bf16 v[36:39], v[76:79], a[208:215], v6
  ds_read_b128 v[100:103], v8 offset:61440
  v_add_f32 v40, v40, v42
  v_add_f32 v41, v41, v43
  v_smfmac_f32_16x16x64_bf16 v[32:35], v[72:75], a[200:207], v6
  v_cvt_pk_bf16_f32 v49, v40, v41
  v_smfmac_f32_16x16x64_bf16 v[32:35], v[76:79], a[192:199], v6
  v_add_f32 v36, v36, v38
  v_add_f32 v37, v37, v39
  v_smfmac_f32_16x16x64_bf16 v[28:31], v[72:75], a[184:191], v6
  v_cvt_pk_bf16_f32 v50, v36, v37
  v_smfmac_f32_16x16x64_bf16 v[28:31], v[76:79], a[176:183], v6
  v_add_f32 v32, v32, v34
  v_add_f32 v33, v33, v35
  v_smfmac_f32_16x16x64_bf16 v[24:27], v[72:75], v[104:111], v6
  v_cvt_pk_bf16_f32 v51, v32, v33
  v_smfmac_f32_16x16x64_bf16 v[24:27], v[76:79], v[112:119], v6
  buffer_store_dwordx4 v[48:51], v4, s[4:7], s40 offen sc1
  v_add_f32 v28, v28, v30
  v_add_f32 v29, v29, v31
  v_smfmac_f32_16x16x64_bf16 v[80:83], v[72:75], v[120:127], v6
  s_waitcnt lgkmcnt(0)
  v_cvt_pk_bf16_f32 v52, v28, v29
  v_and_or_b32 v52, v52, -2, s3
  v_smfmac_f32_16x16x64_bf16 v[80:83], v[76:79], v[16:23], v6
  v_add_f32 v24, v24, v26
  v_add_f32 v25, v25, v27
  v_smfmac_f32_16x16x64_bf16 v[84:87], v[72:75], v[88:95], v6
  v_cvt_pk_bf16_f32 v53, v24, v25
  v_smfmac_f32_16x16x64_bf16 v[84:87], v[76:79], v[96:103], v6
  v_add_f32 v80, v80, v82
  v_add_f32 v81, v81, v83
  v_cvt_pk_bf16_f32 v54, v80, v81
  s_nop 0
  s_nop 3
  v_pk_add_f32 v[84:85], v[84:85], v[86:87]
  v_cvt_pk_bf16_f32 v55, v84, v85
  buffer_store_dwordx4 v[52:55], v4, s[4:7], s41 offen sc1
  s_add_u32 s42, s42, s62
  s_add_u32 s43, s42, 4096
  s_add_u32 s23, s23, 524288
  s_add_u32 s25, s25, 262144
  s_add_u32 s63, s63, 4096
  s_add_u32 s64, s64, 2048
  s_andn2_b32 s64, s64, s2
  s_add_u32 s97, s97, 8192
  s_cmp_lg_u32 s17, 0
  s_cbranch_scc1 c_oth_44
  s_mov_b32 s28, 0
  s_add_u32 s46, s46, 1
  v_mov_b64 v[64:65], -1
  s_xor_b32 s34, s42, 16384
  buffer_store_dwordx2 v[64:65], v5, s[4:7], s34 offen sc1
  s_mov_b32 vcc_lo, 0xaaaaaaaa
  s_mov_b32 vcc_hi, 0xaaaaaaaa
  v_mov_b32 v7, 0x3f80
  v_cndmask_b32 v7, v7, 1.0, vcc
  s_mov_b32 vcc_lo, 0x30003
  s_mov_b32 vcc_hi, 0x30003
  v_cndmask_b32 v68, 0, v7, vcc
  s_mov_b32 vcc_lo, 0xc000c
  s_mov_b32 vcc_hi, 0xc000c
  v_cndmask_b32 v69, 0, v7, vcc
  s_mov_b32 vcc_lo, 0x300030
  s_mov_b32 vcc_hi, 0x300030
  v_cndmask_b32 v70, 0, v7, vcc
  s_mov_b32 vcc_lo, 0xc000c0
  s_mov_b32 vcc_hi, 0xc000c0
  v_cndmask_b32 v71, 0, v7, vcc
  ds_read_b128 v[104:107], v1 offset:14336
  ds_read_b128 v[108:111], v1 offset:15360
  s_waitcnt lgkmcnt(0)
  ds_read_b128 v[112:115], v1 offset:16384
  ds_read_b128 v[116:119], v1 offset:17408
  ds_read_b128 v[120:123], v1 offset:18432
  ds_read_b128 v[124:127], v1 offset:19456
  s_waitcnt lgkmcnt(0)
  buffer_load_dwordx4 v[16:19], v0, s[4:7], s38 offen offset:0 sc1
  buffer_load_dwordx4 v[20:23], v0, s[4:7], s38 offen offset:1024 sc1
  buffer_load_dwordx4 v[24:27], v0, s[4:7], s38 offen offset:2048 sc1
  buffer_load_dwordx4 v[28:31], v0, s[4:7], s38 offen offset:3072 sc1
  buffer_load_dwordx4 v[32:35], v0, s[4:7], s39 offen offset:0 sc1
  buffer_load_dwordx4 v[36:39], v0, s[4:7], s39 offen offset:1024 sc1
  buffer_load_dwordx4 v[40:43], v0, s[4:7], s39 offen offset:2048 sc1
  buffer_load_dwordx4 v[44:47], v0, s[4:7], s39 offen offset:3072 sc1
  buffer_load_dwordx4 v[72:75], v0, s[4:7], s38 offen offset:0 sc1
  buffer_load_dwordx4 v[76:79], v0, s[4:7], s38 offen offset:1024 sc1
  buffer_load_dwordx4 v[80:83], v0, s[4:7], s38 offen offset:2048 sc1
  buffer_load_dwordx4 v[84:87], v0, s[4:7], s38 offen offset:3072 sc1
  buffer_load_dwordx4 v[88:91], v0, s[4:7], s39 offen offset:0 sc1
  buffer_load_dwordx4 v[92:95], v0, s[4:7], s39 offen offset:1024 sc1
  buffer_load_dwordx4 v[96:99], v0, s[4:7], s39 offen offset:2048 sc1
  buffer_load_dwordx4 v[100:103], v0, s[4:7], s39 offen offset:3072 sc1
  s_buffer_load_dword s65, s[4:7], s63
  s_waitcnt vmcnt(15)
  v_mfma_f32_16x16x32_bf16 v[64:67], v[16:19], v[68:71], 0
  v_xor_b32 v7, s3, v16
  s_waitcnt vmcnt(14)
  v_mfma_f32_16x16x32_bf16 v[64:67], v[20:23], v[68:71], v[64:67]
  v_bitop3_b32 v7, v7, v20, s3 bitop3:0xf6
  s_waitcnt vmcnt(13)
  v_mfma_f32_16x16x32_bf16 v[64:67], v[24:27], v[68:71], v[64:67]
  v_bitop3_b32 v7, v7, v24, s3 bitop3:0xf6
  s_waitcnt vmcnt(12)
  v_mfma_f32_16x16x32_bf16 v[64:67], v[28:31], v[68:71], v[64:67]
  v_bitop3_b32 v7, v7, v28, s3 bitop3:0xf6
  s_waitcnt vmcnt(11)
  v_mfma_f32_16x16x32_bf16 v[64:67], v[32:35], v[68:71], v[64:67]
  v_bitop3_b32 v7, v7, v32, s3 bitop3:0xf6
  s_waitcnt vmcnt(10)
  v_mfma_f32_16x16x32_bf16 v[64:67], v[36:39], v[68:71], v[64:67]
  v_bitop3_b32 v7, v7, v36, s3 bitop3:0xf6
  s_waitcnt vmcnt(9)
  v_mfma_f32_16x16x32_bf16 v[64:67], v[40:43], v[68:71], v[64:67]
  v_bitop3_b32 v7, v7, v40, s3 bitop3:0xf6
  s_waitcnt vmcnt(8)
  v_mfma_f32_16x16x32_bf16 v[64:67], v[44:47], v[68:71], v[64:67]
  v_bitop3_b32 v7, v7, v44, s3 bitop3:0xf6
  v_and_b32 v7, 1, v7
  v_cmp_ne_u32 vcc, 0, v7
  v_mov_b32 v7, 0
  v_mov_b32 v7, 0
  s_cbranch_vccnz c_p1r_45
c_publ_46:
  s_nop 1
  s_nop 0
  v_cvt_pk_bf16_f32 v64, v64, v65
  v_cvt_pk_bf16_f32 v65, v66, v67
  v_min_u32 v64, -2, v64
  v_min_u32 v65, -2, v65
  buffer_store_dwordx2 v[64:65], v5, s[4:7], s42 offen sc1
  s_waitcnt vmcnt(1)
  ds_read_b128 v[24:27], v1 offset:0
  ds_read_b128 v[28:31], v1 offset:1024
  ds_read_b128 v[32:35], v1 offset:2048
  ds_read_b128 v[36:39], v1 offset:3072
  ds_read_b128 v[40:43], v1 offset:4096
  ds_read_b128 v[44:47], v1 offset:5120
  ds_read_b128 v[72:75], v1 offset:6144
  ds_read_b128 v[76:79], v1 offset:7168
  ds_read_b128 v[80:83], v1 offset:8192
  ds_read_b128 v[84:87], v1 offset:9216
  ds_read_b128 v[88:91], v1 offset:10240
  ds_read_b128 v[92:95], v1 offset:11264
  ds_read_b128 v[96:99], v1 offset:12288
  ds_read_b128 v[100:103], v1 offset:13312
c_hop2_32:
  s_barrier
  s_cmp_lg_u32 s96, 268435456
  s_cbranch_scc1 c_loop_29
  buffer_store_dwordx2 v[64:65], v5, s[4:7], s97 offen sc1
  s_mov_b32 s29, 0
  s_sub_u32 s92, s63, 4096
  s_sub_u32 s96, s23, 524288
  s_mov_b32 s95, 0
c_gw_47:
  buffer_load_dword v7, off, s[4:7], s92 sc1
  s_add_u32 s29, s29, 1
  s_cmp_gt_u32 s29, 1048576
  s_cbranch_scc1 c_fail_35
  s_waitcnt vmcnt(0) lgkmcnt(0)
  v_readfirstlane_b32 s65, v7
  s_cmp_eq_u32 s65, 0
  s_cbranch_scc1 c_gw_47
  s_and_b32 s65, s65, s93
  s_cbranch_scc1 c_kvx_49
  s_mov_b32 s95, 1
  s_add_u32 s96, s96, 33554432
  s_add_u32 s92, s92, 262144
c_kvw_48:
  buffer_load_dword v7, off, s[4:7], s92 sc1
  s_add_u32 s29, s29, 1
  s_cmp_gt_u32 s29, 1048576
  s_cbranch_scc1 c_fail_35
  s_waitcnt vmcnt(0) lgkmcnt(0)
  v_readfirstlane_b32 s65, v7
  s_cmp_eq_u32 s65, 0
  s_cbranch_scc1 c_kvw_48
c_kvx_49:
  buffer_load_dword v7, off, s[4:7], s63 sc1
  buffer_load_dwordx4 v0, s[4:7], s96 offen offset:0  lds
  buffer_load_dwordx4 v0, s[4:7], s96 offen offset:1024  lds
  buffer_load_dwordx4 v0, s[4:7], s96 offen offset:2048  lds
  buffer_load_dwordx4 v0, s[4:7], s96 offen offset:3072  lds
  s_waitcnt vmcnt(4)
  v_readfirstlane_b32 s65, v7
  s_cmp_eq_u32 s95, 0
  s_cbranch_scc1 c_loop_29
  s_mov_b32 s29, 0
c_fk_50:
  buffer_load_dwordx4 v[16:19], v8, s[4:7], s42 offen sc1
  buffer_load_dwordx4 v[20:23], v8, s[4:7], s43 offen sc1
  s_add_u32 s29, s29, 1
  s_cmp_gt_u32 s29, 1048576
  s_cbranch_scc1 c_fail_35
  s_waitcnt vmcnt(0)
  v_max3_u32 v7, v16, v17, v18
  v_max3_u32 v7, v19, v20, v7
  v_max3_u32 v7, v21, v22, v7
  v_max_u32 v7, v7, v23
  v_cmp_eq_u32 vcc, -1, v7
  s_cbranch_vccnz c_fk_50
  s_lshl_b32 s42, s22, 13
  s_add_u32 s42, s42, 245891072
  s_add_u32 s43, s42, 4096
  s_mov_b32 s95, 0
  s_branch c_loop_29
c_last_36:
  s_add_u32 s64, s64, 2048
  v_mov_b32 v7, 1
  s_waitcnt vmcnt(0)
  s_barrier
  s_mov_b64 exec, 1
  buffer_store_dword v7, off, s[4:7], s64 sc1
  s_mov_b64 exec, -1
  s_branch c_fail_35
c_oth_44:
  s_buffer_load_dword s65, s[4:7], s63
  ds_read_b128 v[24:27], v1 offset:0
  ds_read_b128 v[28:31], v1 offset:1024
  ds_read_b128 v[32:35], v1 offset:2048
  ds_read_b128 v[36:39], v1 offset:3072
  ds_read_b128 v[40:43], v1 offset:4096
  ds_read_b128 v[44:47], v1 offset:5120
  ds_read_b128 v[72:75], v1 offset:6144
  ds_read_b128 v[76:79], v1 offset:7168
  ds_read_b128 v[80:83], v1 offset:8192
  ds_read_b128 v[84:87], v1 offset:9216
  ds_read_b128 v[88:91], v1 offset:10240
  ds_read_b128 v[92:95], v1 offset:11264
  ds_read_b128 v[96:99], v1 offset:12288
  ds_read_b128 v[100:103], v1 offset:13312
  ds_read_b128 v[104:107], v1 offset:14336
  ds_read_b128 v[108:111], v1 offset:15360
  ds_read_b128 v[112:115], v1 offset:16384
  ds_read_b128 v[116:119], v1 offset:17408
  ds_read_b128 v[120:123], v1 offset:18432
  ds_read_b128 v[124:127], v1 offset:19456
  s_branch c_hop2_32
c_p1r_45:
  s_waitcnt vmcnt(7)
  s_nop 0
  v_mfma_f32_16x16x32_bf16 v[64:67], v[72:75], v[68:71], 0
  v_xor_b32 v7, s3, v72
  s_waitcnt vmcnt(6)
  v_mfma_f32_16x16x32_bf16 v[64:67], v[76:79], v[68:71], v[64:67]
  v_bitop3_b32 v7, v7, v76, s3 bitop3:0xf6
  s_waitcnt vmcnt(5)
  v_mfma_f32_16x16x32_bf16 v[64:67], v[80:83], v[68:71], v[64:67]
  v_bitop3_b32 v7, v7, v80, s3 bitop3:0xf6
  s_waitcnt vmcnt(4)
  v_mfma_f32_16x16x32_bf16 v[64:67], v[84:87], v[68:71], v[64:67]
  v_bitop3_b32 v7, v7, v84, s3 bitop3:0xf6
  s_waitcnt vmcnt(3)
  v_mfma_f32_16x16x32_bf16 v[64:67], v[88:91], v[68:71], v[64:67]
  v_bitop3_b32 v7, v7, v88, s3 bitop3:0xf6
  s_waitcnt vmcnt(2)
  v_mfma_f32_16x16x32_bf16 v[64:67], v[92:95], v[68:71], v[64:67]
  v_bitop3_b32 v7, v7, v92, s3 bitop3:0xf6
  s_waitcnt vmcnt(1)
  v_mfma_f32_16x16x32_bf16 v[64:67], v[96:99], v[68:71], v[64:67]
  v_bitop3_b32 v7, v7, v96, s3 bitop3:0xf6
  s_waitcnt vmcnt(0)
  v_mfma_f32_16x16x32_bf16 v[64:67], v[100:103], v[68:71], v[64:67]
  v_bitop3_b32 v7, v7, v100, s3 bitop3:0xf6
  v_and_b32 v7, 1, v7
  v_cmp_ne_u32 vcc, 0, v7
  s_add_u32 s46, s46, 1
  s_cbranch_vccz c_publ_46
  buffer_load_dwordx4 v[72:75], v0, s[4:7], s38 offen offset:0 sc1
  buffer_load_dwordx4 v[76:79], v0, s[4:7], s38 offen offset:1024 sc1
  buffer_load_dwordx4 v[80:83], v0, s[4:7], s38 offen offset:2048 sc1
  buffer_load_dwordx4 v[84:87], v0, s[4:7], s38 offen offset:3072 sc1
  buffer_load_dwordx4 v[88:91], v0, s[4:7], s39 offen offset:0 sc1
  buffer_load_dwordx4 v[92:95], v0, s[4:7], s39 offen offset:1024 sc1
  buffer_load_dwordx4 v[96:99], v0, s[4:7], s39 offen offset:2048 sc1
  buffer_load_dwordx4 v[100:103], v0, s[4:7], s39 offen offset:3072 sc1
  s_add_u32 s28, s28, 1
  s_cmp_gt_u32 s28, 1048576
  s_cbranch_scc0 c_p1r_45
  s_branch c_fail_35
c_retry_30:
  v_mov_b64 v[48:49], 0
  v_mov_b64 v[50:51], 0
  s_nop 0
  v_mov_b64 v[52:53], 0
  v_mov_b64 v[54:55], 0
  s_nop 1
  v_mov_b64 v[56:57], 0
  v_mov_b64 v[58:59], 0
c_rl_51:
  buffer_load_dwordx4 v[16:19], v8, s[4:7], s42 offen sc1
  buffer_load_dwordx4 v[20:23], v8, s[4:7], s43 offen sc1
  s_add_u32 s28, s28, 1
  s_add_u32 s47, s47, 1
  s_cmp_gt_u32 s28, 1048576
  s_cbranch_scc1 c_fail_35
  s_waitcnt vmcnt(2)
  v_max3_u32 v7, v16, v17, v18
  v_max3_u32 v7, v19, v20, v7
  v_max3_u32 v7, v21, v22, v7
  v_max_u32 v7, v7, v23
  v_cmp_eq_u32 vcc, -1, v7
  s_cbranch_vccnz c_rl_51
  ds_write_b128 v8, v[16:19] offset:4096
  v_smfmac_f32_16x16x64_bf16 v[48:51], v[16:19], v[24:31], v6
  ds_write_b128 v8, v[20:23] offset:8192
  v_smfmac_f32_16x16x64_bf16 v[52:55], v[16:19], v[32:39], v6
  v_smfmac_f32_16x16x64_bf16 v[56:59], v[16:19], v[40:47], v6
  s_branch c_got_31
c_fb_33:
  v_max3_f32 v7, v48, v49, v50
  v_max_f32 v7, v51, v7
  s_mov_b64 exec, s[18:19]
  v_max3_f32 v7, v16, v17, v7
  s_mov_b64 exec, -1
  s_nop 0
  v_max_f32_dpp v7, v7, v7 quad_perm:[2,3,0,1] row_mask:0xf bank_mask:0xf
  v_mov_b32 v24, v7
  s_nop 0
  s_nop 0
  v_permlane16_swap_b32 v7, v24
  v_max_f32 v7, v7, v24
  v_mov_b32 v24, v7
  s_nop 0
  s_nop 0
  v_permlane32_swap_b32 v7, v24
  v_max_f32 v7, v7, v24
  v_sub_f32 v24, v48, v7
  v_sub_f32 v25, v49, v7
  v_sub_f32 v26, v50, v7
  v_sub_f32 v27, v51, v7
  v_sub_f32 v28, v16, v7
  v_sub_f32 v29, v17, v7
  v_exp_f32 v24, v24
  v_exp_f32 v25, v25
  v_exp_f32 v26, v26
  v_exp_f32 v27, v27
  v_exp_f32 v28, v28
  v_exp_f32 v29, v29
  v_cvt_pk_bf16_f32 v24, v24, v25
  v_cvt_pk_bf16_f32 v25, v26, v27
  v_cvt_pk_bf16_f32 v28, v28, v29
  v_cndmask_b32 v72, v24, 0, s[18:19]
  v_cndmask_b32 v73, v25, 0, s[18:19]
  v_cndmask_b32 v74, 0, v24, s[18:19]
  v_cndmask_b32 v75, 0, v25, s[18:19]
  v_cndmask_b32 v77, 0, v28, s[18:19]
  v_cndmask_b32 v78, 0, v28, s[18:19]
  v_mfma_f32_16x16x32_bf16 v[60:63], v[72:75], v[20:23], 0
  v_mfma_f32_16x16x32_bf16 v[52:55], v[72:75], v[80:83], 0
  v_mfma_f32_16x16x32_bf16 v[56:59], v[72:75], v[84:87], 0
  v_mfma_f32_16x16x16_bf16 v[60:63], v[76:77], v[20:21], v[60:63]
  v_mfma_f32_16x16x16_bf16 v[52:55], v[78:79], v[66:67], v[52:55]
  s_nop 2
  v_mfma_f32_16x16x16_bf16 v[56:59], v[76:77], v[66:67], v[56:59]
  s_nop 7
  v_add_f32 v60, v60, v62
  v_add_f32 v61, v61, v63
  s_branch c_fbr_34
c_fail_35:
  s_endpgm
L_qkv:
  s_mul_i32 s26, s91, 15
  s_add_u32 s26, s26, s90
  s_sub_u32 s26, s26, 61
  s_add_u32 s27, s91, 89
  s_cmp_eq_u32 s90, 31
  s_cselect_b32 s26, s27, s26
  s_add_u32 s27, s90, 60
  s_cmp_eq_u32 s91, 7
  s_cselect_b32 s26, s27, s26
  s_mul_i32 s16, s26, 171
  s_lshr_b32 s16, s16, 9
  s_mul_i32 s27, s16, 3
  s_sub_u32 s60, s26, s27
  s_add_u32 s16, s16, 4
  s_and_b32 s16, s16, 31
  v_and_b32 v19, 63, v0
  v_and_b32 v6, 15, v19
  v_lshrrev_b32 v7, 4, v19
  v_lshlrev_b32 v1, 2, v19
  v_lshlrev_b32 v0, 4, v19
  v_lshlrev_b32 v9, 7, v19
  s_mov_b32 s24, 0x3e0293ee
  s_lshl_b32 s57, s16, 2
  s_add_u32 s57, s57, s17
  v_lshrrev_b32 v24, 1, v7
  v_xor_b32 v24, v24, v6
  v_lshlrev_b32 v24, 4, v24
  v_and_b32 v25, 31, v19
  v_lshl_add_u32 v24, v25, 10, v24
  v_xor_b32 v120, 0, v24
  v_xor_b32 v121, 32, v24
  v_xor_b32 v122, 64, v24
  v_xor_b32 v123, 96, v24
  v_xor_b32 v124, 128, v24
  v_xor_b32 v125, 160, v24
  v_xor_b32 v126, 192, v24
  v_xor_b32 v127, 224, v24
  v_and_b32 v24, 1, v7
  v_lshlrev_b32 v24, 10, v24
  v_lshl_add_u32 v24, v6, 4, v24
  v_lshrrev_b32 v25, 1, v7
  v_lshl_add_u32 v8, v25, 8, v24
  s_and_b32 s26, s17, 1
  s_lshl_b32 s26, s26, 7
  v_xor_b32 v24, s26, v0
  v_xor_b32 v12, 0, v24
  v_xor_b32 v13, 16, v24
  v_xor_b32 v14, 32, v24
  v_xor_b32 v15, 48, v24
  v_xor_b32 v16, 64, v24
  v_xor_b32 v17, 80, v24
  v_xor_b32 v18, 96, v24
  v_xor_b32 v19, 112, v24
  s_lshl_b32 s26, s17, 2
  s_add_u32 s26, s26, 162816
  v_mov_b32 v118, s26
  v_mov_b32 v119, 162816
  v_lshrrev_b32 v25, 8, v0
  v_and_b32 v20, 0xf0, v0
  v_lshlrev_b32 v21, 6, v25
  v_xor_b32 v20, v20, v21
  v_lshl_add_u32 v20, v25, 13, v20
  v_xor_b32 v21, 32, v20
  s_load_dwordx2 s[64:65], s[0:1], 24
  s_load_dwordx2 s[68:69], s[0:1], 32
  s_load_dwordx2 s[8:9], s[0:1], 16
  s_mov_b32 s10, 4194304
  s_mov_b32 s11, 0x20000
  s_mov_b32 s66, 4194304
  s_mov_b32 s67, 0x20000
  s_mov_b32 s70, 4194304
  s_mov_b32 s71, 0x20000
  v_lshrrev_b32 v25, 2, v6
  v_lshrrev_b32 v26, 1, v7
  v_lshl_add_u32 v27, v26, 3, v25
  v_lshlrev_b32 v27, 8, v27
  v_lshl_add_u32 v26, v25, 1, v26
  v_and_b32 v25, 1, v7
  v_xor_b32 v26, v26, v25
  s_lshl_b32 s26, s17, 1
  v_xor_b32 v26, s26, v26
  v_lshl_add_u32 v27, v26, 5, v27
  v_and_b32 v25, 3, v6
  v_lshl_add_u32 v22, v25, 3, v27
  v_add_u32 v23, 65536, v22
  v_add_u32 v24, 131072, v22
  s_lshl_b32 s28, s17, 13
  s_lshl_b32 s26, s17, 18
  s_lshl_b32 s27, s16, 8
  s_add_u32 s26, s26, s27
  s_waitcnt lgkmcnt(0)
  s_cmp_eq_u32 s60, 1
  s_cbranch_scc1 q_ld_53
  s_cmp_eq_u32 s60, 2
  s_cbranch_scc1 q_ld_54
q_ld_52:
  s_add_u32 s27, s26, 0
  s_add_u32 m0, s28, 0
  s_nop 0
  buffer_load_dwordx4 v20, s[64:67], s27 offen lds
  s_add_u32 m0, s28, 1024
  s_add_u32 s27, s27, 32768
  buffer_load_dwordx4 v20, s[64:67], s27 offen lds
  s_add_u32 m0, s28, 2048
  s_add_u32 s27, s27, 32768
  buffer_load_dwordx4 v21, s[64:67], s27 offen lds
  s_add_u32 m0, s28, 3072
  s_add_u32 s27, s27, 32768
  buffer_load_dwordx4 v21, s[64:67], s27 offen lds
  s_add_u32 m0, s28, 4096
  s_add_u32 s27, s27, 32768
  buffer_load_dwordx4 v20, s[64:67], s27 offen lds
  s_add_u32 m0, s28, 5120
  s_add_u32 s27, s27, 32768
  buffer_load_dwordx4 v20, s[64:67], s27 offen lds
  s_add_u32 m0, s28, 6144
  s_add_u32 s27, s27, 32768
  buffer_load_dwordx4 v21, s[64:67], s27 offen lds
  s_add_u32 m0, s28, 7168
  s_add_u32 s27, s27, 32768
  buffer_load_dwordx4 v21, s[64:67], s27 offen lds
  s_add_u32 s27, s26, 1048576
  s_add_u32 m0, s28, 32768
  s_nop 0
  buffer_load_dwordx4 v20, s[64:67], s27 offen lds
  s_add_u32 m0, s28, 33792
  s_add_u32 s27, s27, 32768
  buffer_load_dwordx4 v20, s[64:67], s27 offen lds
  s_add_u32 m0, s28, 34816
  s_add_u32 s27, s27, 32768
  buffer_load_dwordx4 v21, s[64:67], s27 offen lds
  s_add_u32 m0, s28, 35840
  s_add_u32 s27, s27, 32768
  buffer_load_dwordx4 v21, s[64:67], s27 offen lds
  s_add_u32 m0, s28, 36864
  s_add_u32 s27, s27, 32768
  buffer_load_dwordx4 v20, s[64:67], s27 offen lds
  s_add_u32 m0, s28, 37888
  s_add_u32 s27, s27, 32768
  buffer_load_dwordx4 v20, s[64:67], s27 offen lds
  s_add_u32 m0, s28, 38912
  s_add_u32 s27, s27, 32768
  buffer_load_dwordx4 v21, s[64:67], s27 offen lds
  s_add_u32 m0, s28, 39936
  s_add_u32 s27, s27, 32768
  buffer_load_dwordx4 v21, s[64:67], s27 offen lds
  s_add_u32 s27, s26, 2097152
  s_add_u32 m0, s28, 65536
  s_nop 0
  buffer_load_dwordx4 v20, s[64:67], s27 offen lds
  s_add_u32 m0, s28, 66560
  s_add_u32 s27, s27, 32768
  buffer_load_dwordx4 v20, s[64:67], s27 offen lds
  s_add_u32 m0, s28, 67584
  s_add_u32 s27, s27, 32768
  buffer_load_dwordx4 v21, s[64:67], s27 offen lds
  s_add_u32 m0, s28, 68608
  s_add_u32 s27, s27, 32768
  buffer_load_dwordx4 v21, s[64:67], s27 offen lds
  s_add_u32 m0, s28, 69632
  s_add_u32 s27, s27, 32768
  buffer_load_dwordx4 v20, s[64:67], s27 offen lds
  s_add_u32 m0, s28, 70656
  s_add_u32 s27, s27, 32768
  buffer_load_dwordx4 v20, s[64:67], s27 offen lds
  s_add_u32 m0, s28, 71680
  s_add_u32 s27, s27, 32768
  buffer_load_dwordx4 v21, s[64:67], s27 offen lds
  s_add_u32 m0, s28, 72704
  s_add_u32 s27, s27, 32768
  buffer_load_dwordx4 v21, s[64:67], s27 offen lds
  s_load_dwordx2 s[4:5], s[0:1], 112
  s_load_dwordx2 s[12:13], s[0:1], 104
  s_waitcnt vmcnt(16)
  s_barrier
  s_add_u32 s27, s26, 3145728
  s_add_u32 m0, s28, 98304
  s_nop 0
  buffer_load_dwordx4 v20, s[64:67], s27 offen lds
  s_add_u32 m0, s28, 99328
  s_add_u32 s27, s27, 32768
  buffer_load_dwordx4 v20, s[64:67], s27 offen lds
  s_add_u32 m0, s28, 100352
  s_add_u32 s27, s27, 32768
  buffer_load_dwordx4 v21, s[64:67], s27 offen lds
  s_add_u32 m0, s28, 101376
  s_add_u32 s27, s27, 32768
  buffer_load_dwordx4 v21, s[64:67], s27 offen lds
  s_add_u32 m0, s28, 102400
  s_add_u32 s27, s27, 32768
  buffer_load_dwordx4 v20, s[64:67], s27 offen lds
  s_add_u32 m0, s28, 103424
  s_add_u32 s27, s27, 32768
  buffer_load_dwordx4 v20, s[64:67], s27 offen lds
  s_add_u32 m0, s28, 104448
  s_add_u32 s27, s27, 32768
  buffer_load_dwordx4 v21, s[64:67], s27 offen lds
  s_add_u32 m0, s28, 105472
  s_add_u32 s27, s27, 32768
  buffer_load_dwordx4 v21, s[64:67], s27 offen lds
  ds_read_b64_tr_b16 v[128:129], v22 offset:0
  ds_read_b64_tr_b16 v[130:131], v22 offset:1024
  ds_read_b64_tr_b16 v[132:133], v22 offset:4096
  ds_read_b64_tr_b16 v[134:135], v22 offset:5120
  ds_read_b64_tr_b16 v[136:137], v22 offset:8192
  ds_read_b64_tr_b16 v[138:139], v22 offset:9216
  ds_read_b64_tr_b16 v[140:141], v22 offset:12288
  ds_read_b64_tr_b16 v[142:143], v22 offset:13312
  ds_read_b64_tr_b16 v[144:145], v22 offset:16384
  ds_read_b64_tr_b16 v[146:147], v22 offset:17408
  ds_read_b64_tr_b16 v[148:149], v22 offset:20480
  ds_read_b64_tr_b16 v[150:151], v22 offset:21504
  ds_read_b64_tr_b16 v[152:153], v22 offset:24576
  ds_read_b64_tr_b16 v[154:155], v22 offset:25600
  ds_read_b64_tr_b16 v[156:157], v22 offset:28672
  ds_read_b64_tr_b16 v[158:159], v22 offset:29696
  s_waitcnt lgkmcnt(0)
  s_waitcnt vmcnt(16)
  s_barrier
  s_add_u32 s27, s26, 0
  s_add_u32 m0, s28, 131072
  s_nop 0
  buffer_load_dwordx4 v20, s[68:71], s27 offen lds
  s_add_u32 m0, s28, 132096
  s_add_u32 s27, s27, 32768
  buffer_load_dwordx4 v20, s[68:71], s27 offen lds
  s_add_u32 m0, s28, 133120
  s_add_u32 s27, s27, 32768
  buffer_load_dwordx4 v21, s[68:71], s27 offen lds
  s_add_u32 m0, s28, 134144
  s_add_u32 s27, s27, 32768
  buffer_load_dwordx4 v21, s[68:71], s27 offen lds
  s_add_u32 m0, s28, 135168
  s_add_u32 s27, s27, 32768
  buffer_load_dwordx4 v20, s[68:71], s27 offen lds
  s_add_u32 m0, s28, 136192
  s_add_u32 s27, s27, 32768
  buffer_load_dwordx4 v20, s[68:71], s27 offen lds
  s_add_u32 m0, s28, 137216
  s_add_u32 s27, s27, 32768
  buffer_load_dwordx4 v21, s[68:71], s27 offen lds
  s_add_u32 m0, s28, 138240
  s_add_u32 s27, s27, 32768
  buffer_load_dwordx4 v21, s[68:71], s27 offen lds
  ds_read_b64_tr_b16 v[160:161], v22 offset:32768
  ds_read_b64_tr_b16 v[162:163], v22 offset:33792
  ds_read_b64_tr_b16 v[164:165], v22 offset:36864
  ds_read_b64_tr_b16 v[166:167], v22 offset:37888
  ds_read_b64_tr_b16 v[168:169], v22 offset:40960
  ds_read_b64_tr_b16 v[170:171], v22 offset:41984
  ds_read_b64_tr_b16 v[172:173], v22 offset:45056
  ds_read_b64_tr_b16 v[174:175], v22 offset:46080
  ds_read_b64_tr_b16 v[176:177], v22 offset:49152
  ds_read_b64_tr_b16 v[178:179], v22 offset:50176
  ds_read_b64_tr_b16 v[180:181], v22 offset:53248
  ds_read_b64_tr_b16 v[182:183], v22 offset:54272
  ds_read_b64_tr_b16 v[184:185], v22 offset:57344
  ds_read_b64_tr_b16 v[186:187], v22 offset:58368
  ds_read_b64_tr_b16 v[188:189], v22 offset:61440
  ds_read_b64_tr_b16 v[190:191], v22 offset:62464
  s_waitcnt lgkmcnt(0)
  s_waitcnt vmcnt(16)
  s_barrier
  s_add_u32 s27, s26, 1048576
  s_add_u32 m0, s28, 0
  s_nop 0
  buffer_load_dwordx4 v20, s[68:71], s27 offen lds
  s_add_u32 m0, s28, 1024
  s_add_u32 s27, s27, 32768
  buffer_load_dwordx4 v20, s[68:71], s27 offen lds
  s_add_u32 m0, s28, 2048
  s_add_u32 s27, s27, 32768
  buffer_load_dwordx4 v21, s[68:71], s27 offen lds
  s_add_u32 m0, s28, 3072
  s_add_u32 s27, s27, 32768
  buffer_load_dwordx4 v21, s[68:71], s27 offen lds
  s_add_u32 m0, s28, 4096
  s_add_u32 s27, s27, 32768
  buffer_load_dwordx4 v20, s[68:71], s27 offen lds
  s_add_u32 m0, s28, 5120
  s_add_u32 s27, s27, 32768
  buffer_load_dwordx4 v20, s[68:71], s27 offen lds
  s_add_u32 m0, s28, 6144
  s_add_u32 s27, s27, 32768
  buffer_load_dwordx4 v21, s[68:71], s27 offen lds
  s_add_u32 m0, s28, 7168
  s_add_u32 s27, s27, 32768
  buffer_load_dwordx4 v21, s[68:71], s27 offen lds
  ds_read_b64_tr_b16 v[192:193], v23 offset:0
  ds_read_b64_tr_b16 v[194:195], v23 offset:1024
  ds_read_b64_tr_b16 v[196:197], v23 offset:4096
  ds_read_b64_tr_b16 v[198:199], v23 offset:5120
  ds_read_b64_tr_b16 v[200:201], v23 offset:8192
  ds_read_b64_tr_b16 v[202:203], v23 offset:9216
  ds_read_b64_tr_b16 v[204:205], v23 offset:12288
  ds_read_b64_tr_b16 v[206:207], v23 offset:13312
  ds_read_b64_tr_b16 v[208:209], v23 offset:16384
  ds_read_b64_tr_b16 v[210:211], v23 offset:17408
  ds_read_b64_tr_b16 v[212:213], v23 offset:20480
  ds_read_b64_tr_b16 v[214:215], v23 offset:21504
  ds_read_b64_tr_b16 v[216:217], v23 offset:24576
  ds_read_b64_tr_b16 v[218:219], v23 offset:25600
  ds_read_b64_tr_b16 v[220:221], v23 offset:28672
  ds_read_b64_tr_b16 v[222:223], v23 offset:29696
  s_waitcnt lgkmcnt(0)
  s_waitcnt vmcnt(16)
  s_barrier
  s_add_u32 s27, s26, 2097152
  s_add_u32 m0, s28, 32768
  s_nop 0
  buffer_load_dwordx4 v20, s[68:71], s27 offen lds
  s_add_u32 m0, s28, 33792
  s_add_u32 s27, s27, 32768
  buffer_load_dwordx4 v20, s[68:71], s27 offen lds
  s_add_u32 m0, s28, 34816
  s_add_u32 s27, s27, 32768
  buffer_load_dwordx4 v21, s[68:71], s27 offen lds
  s_add_u32 m0, s28, 35840
  s_add_u32 s27, s27, 32768
  buffer_load_dwordx4 v21, s[68:71], s27 offen lds
  s_add_u32 m0, s28, 36864
  s_add_u32 s27, s27, 32768
  buffer_load_dwordx4 v20, s[68:71], s27 offen lds
  s_add_u32 m0, s28, 37888
  s_add_u32 s27, s27, 32768
  buffer_load_dwordx4 v20, s[68:71], s27 offen lds
  s_add_u32 m0, s28, 38912
  s_add_u32 s27, s27, 32768
  buffer_load_dwordx4 v21, s[68:71], s27 offen lds
  s_add_u32 m0, s28, 39936
  s_add_u32 s27, s27, 32768
  buffer_load_dwordx4 v21, s[68:71], s27 offen lds
  ds_read_b64_tr_b16 v[224:225], v23 offset:32768
  ds_read_b64_tr_b16 v[226:227], v23 offset:33792
  ds_read_b64_tr_b16 v[228:229], v23 offset:36864
  ds_read_b64_tr_b16 v[230:231], v23 offset:37888
  ds_read_b64_tr_b16 v[232:233], v23 offset:40960
  ds_read_b64_tr_b16 v[234:235], v23 offset:41984
  ds_read_b64_tr_b16 v[236:237], v23 offset:45056
  ds_read_b64_tr_b16 v[238:239], v23 offset:46080
  ds_read_b64_tr_b16 v[240:241], v23 offset:49152
  ds_read_b64_tr_b16 v[242:243], v23 offset:50176
  ds_read_b64_tr_b16 v[244:245], v23 offset:53248
  ds_read_b64_tr_b16 v[246:247], v23 offset:54272
  ds_read_b64_tr_b16 v[248:249], v23 offset:57344
  ds_read_b64_tr_b16 v[250:251], v23 offset:58368
  ds_read_b64_tr_b16 v[252:253], v23 offset:61440
  ds_read_b64_tr_b16 v[254:255], v23 offset:62464
  s_waitcnt lgkmcnt(0)
  s_waitcnt vmcnt(16)
  s_barrier
  s_add_u32 s27, s26, 3145728
  s_add_u32 m0, s28, 65536
  s_nop 0
  buffer_load_dwordx4 v20, s[68:71], s27 offen lds
  s_add_u32 m0, s28, 66560
  s_add_u32 s27, s27, 32768
  buffer_load_dwordx4 v20, s[68:71], s27 offen lds
  s_add_u32 m0, s28, 67584
  s_add_u32 s27, s27, 32768
  buffer_load_dwordx4 v21, s[68:71], s27 offen lds
  s_add_u32 m0, s28, 68608
  s_add_u32 s27, s27, 32768
  buffer_load_dwordx4 v21, s[68:71], s27 offen lds
  s_add_u32 m0, s28, 69632
  s_add_u32 s27, s27, 32768
  buffer_load_dwordx4 v20, s[68:71], s27 offen lds
  s_add_u32 m0, s28, 70656
  s_add_u32 s27, s27, 32768
  buffer_load_dwordx4 v20, s[68:71], s27 offen lds
  s_add_u32 m0, s28, 71680
  s_add_u32 s27, s27, 32768
  buffer_load_dwordx4 v21, s[68:71], s27 offen lds
  s_add_u32 m0, s28, 72704
  s_add_u32 s27, s27, 32768
  buffer_load_dwordx4 v21, s[68:71], s27 offen lds
  ds_read_b64_tr_b16 a[0:1], v24 offset:0
  ds_read_b64_tr_b16 a[2:3], v24 offset:1024
  ds_read_b64_tr_b16 a[4:5], v24 offset:4096
  ds_read_b64_tr_b16 a[6:7], v24 offset:5120
  ds_read_b64_tr_b16 a[8:9], v24 offset:8192
  ds_read_b64_tr_b16 a[10:11], v24 offset:9216
  ds_read_b64_tr_b16 a[12:13], v24 offset:12288
  ds_read_b64_tr_b16 a[14:15], v24 offset:13312
  ds_read_b64_tr_b16 a[16:17], v24 offset:16384
  ds_read_b64_tr_b16 a[18:19], v24 offset:17408
  ds_read_b64_tr_b16 a[20:21], v24 offset:20480
  ds_read_b64_tr_b16 a[22:23], v24 offset:21504
  ds_read_b64_tr_b16 a[24:25], v24 offset:24576
  ds_read_b64_tr_b16 a[26:27], v24 offset:25600
  ds_read_b64_tr_b16 a[28:29], v24 offset:28672
  ds_read_b64_tr_b16 a[30:31], v24 offset:29696
  s_waitcnt lgkmcnt(0)
  s_waitcnt vmcnt(16)
  s_barrier
  s_add_u32 s27, s26, 0
  s_add_u32 m0, s28, 98304
  s_nop 0
  buffer_load_dwordx4 v20, s[8:11], s27 offen lds
  s_add_u32 m0, s28, 99328
  s_add_u32 s27, s27, 32768
  buffer_load_dwordx4 v20, s[8:11], s27 offen lds
  s_add_u32 m0, s28, 100352
  s_add_u32 s27, s27, 32768
  buffer_load_dwordx4 v21, s[8:11], s27 offen lds
  s_add_u32 m0, s28, 101376
  s_add_u32 s27, s27, 32768
  buffer_load_dwordx4 v21, s[8:11], s27 offen lds
  s_add_u32 m0, s28, 102400
  s_add_u32 s27, s27, 32768
  buffer_load_dwordx4 v20, s[8:11], s27 offen lds
  s_add_u32 m0, s28, 103424
  s_add_u32 s27, s27, 32768
  buffer_load_dwordx4 v20, s[8:11], s27 offen lds
  s_add_u32 m0, s28, 104448
  s_add_u32 s27, s27, 32768
  buffer_load_dwordx4 v21, s[8:11], s27 offen lds
  s_add_u32 m0, s28, 105472
  s_add_u32 s27, s27, 32768
  buffer_load_dwordx4 v21, s[8:11], s27 offen lds
  ds_read_b64_tr_b16 a[32:33], v22 offset:0
  ds_read_b64_tr_b16 a[34:35], v22 offset:1024
  ds_read_b64_tr_b16 a[36:37], v22 offset:4096
  ds_read_b64_tr_b16 a[38:39], v22 offset:5120
  ds_read_b64_tr_b16 a[40:41], v22 offset:8192
  ds_read_b64_tr_b16 a[42:43], v22 offset:9216
  ds_read_b64_tr_b16 a[44:45], v22 offset:12288
  ds_read_b64_tr_b16 a[46:47], v22 offset:13312
  ds_read_b64_tr_b16 a[48:49], v22 offset:16384
  ds_read_b64_tr_b16 a[50:51], v22 offset:17408
  ds_read_b64_tr_b16 a[52:53], v22 offset:20480
  ds_read_b64_tr_b16 a[54:55], v22 offset:21504
  ds_read_b64_tr_b16 a[56:57], v22 offset:24576
  ds_read_b64_tr_b16 a[58:59], v22 offset:25600
  ds_read_b64_tr_b16 a[60:61], v22 offset:28672
  ds_read_b64_tr_b16 a[62:63], v22 offset:29696
  s_waitcnt lgkmcnt(0)
  s_waitcnt vmcnt(16)
  s_barrier
  s_add_u32 s27, s26, 1048576
  s_add_u32 m0, s28, 131072
  s_nop 0
  buffer_load_dwordx4 v20, s[8:11], s27 offen lds
  s_add_u32 m0, s28, 132096
  s_add_u32 s27, s27, 32768
  buffer_load_dwordx4 v20, s[8:11], s27 offen lds
  s_add_u32 m0, s28, 133120
  s_add_u32 s27, s27, 32768
  buffer_load_dwordx4 v21, s[8:11], s27 offen lds
  s_add_u32 m0, s28, 134144
  s_add_u32 s27, s27, 32768
  buffer_load_dwordx4 v21, s[8:11], s27 offen lds
  s_add_u32 m0, s28, 135168
  s_add_u32 s27, s27, 32768
  buffer_load_dwordx4 v20, s[8:11], s27 offen lds
  s_add_u32 m0, s28, 136192
  s_add_u32 s27, s27, 32768
  buffer_load_dwordx4 v20, s[8:11], s27 offen lds
  s_add_u32 m0, s28, 137216
  s_add_u32 s27, s27, 32768
  buffer_load_dwordx4 v21, s[8:11], s27 offen lds
  s_add_u32 m0, s28, 138240
  s_add_u32 s27, s27, 32768
  buffer_load_dwordx4 v21, s[8:11], s27 offen lds
  ds_read_b64_tr_b16 a[64:65], v22 offset:32768
  ds_read_b64_tr_b16 a[66:67], v22 offset:33792
  ds_read_b64_tr_b16 a[68:69], v22 offset:36864
  ds_read_b64_tr_b16 a[70:71], v22 offset:37888
  ds_read_b64_tr_b16 a[72:73], v22 offset:40960
  ds_read_b64_tr_b16 a[74:75], v22 offset:41984
  ds_read_b64_tr_b16 a[76:77], v22 offset:45056
  ds_read_b64_tr_b16 a[78:79], v22 offset:46080
  ds_read_b64_tr_b16 a[80:81], v22 offset:49152
  ds_read_b64_tr_b16 a[82:83], v22 offset:50176
  ds_read_b64_tr_b16 a[84:85], v22 offset:53248
  ds_read_b64_tr_b16 a[86:87], v22 offset:54272
  ds_read_b64_tr_b16 a[88:89], v22 offset:57344
  ds_read_b64_tr_b16 a[90:91], v22 offset:58368
  ds_read_b64_tr_b16 a[92:93], v22 offset:61440
  ds_read_b64_tr_b16 a[94:95], v22 offset:62464
  s_waitcnt lgkmcnt(0)
  s_waitcnt vmcnt(16)
  s_barrier
  s_add_u32 s27, s26, 2097152
  s_add_u32 m0, s28, 0
  s_nop 0
  buffer_load_dwordx4 v20, s[8:11], s27 offen lds
  s_add_u32 m0, s28, 1024
  s_add_u32 s27, s27, 32768
  buffer_load_dwordx4 v20, s[8:11], s27 offen lds
  s_add_u32 m0, s28, 2048
  s_add_u32 s27, s27, 32768
  buffer_load_dwordx4 v21, s[8:11], s27 offen lds
  s_add_u32 m0, s28, 3072
  s_add_u32 s27, s27, 32768
  buffer_load_dwordx4 v21, s[8:11], s27 offen lds
  s_add_u32 m0, s28, 4096
  s_add_u32 s27, s27, 32768
  buffer_load_dwordx4 v20, s[8:11], s27 offen lds
  s_add_u32 m0, s28, 5120
  s_add_u32 s27, s27, 32768
  buffer_load_dwordx4 v20, s[8:11], s27 offen lds
  s_add_u32 m0, s28, 6144
  s_add_u32 s27, s27, 32768
  buffer_load_dwordx4 v21, s[8:11], s27 offen lds
  s_add_u32 m0, s28, 7168
  s_add_u32 s27, s27, 32768
  buffer_load_dwordx4 v21, s[8:11], s27 offen lds
  ds_read_b64_tr_b16 a[96:97], v23 offset:0
  ds_read_b64_tr_b16 a[98:99], v23 offset:1024
  ds_read_b64_tr_b16 a[100:101], v23 offset:4096
  ds_read_b64_tr_b16 a[102:103], v23 offset:5120
  ds_read_b64_tr_b16 a[104:105], v23 offset:8192
  ds_read_b64_tr_b16 a[106:107], v23 offset:9216
  ds_read_b64_tr_b16 a[108:109], v23 offset:12288
  ds_read_b64_tr_b16 a[110:111], v23 offset:13312
  ds_read_b64_tr_b16 a[112:113], v23 offset:16384
  ds_read_b64_tr_b16 a[114:115], v23 offset:17408
  ds_read_b64_tr_b16 a[116:117], v23 offset:20480
  ds_read_b64_tr_b16 a[118:119], v23 offset:21504
  ds_read_b64_tr_b16 a[120:121], v23 offset:24576
  ds_read_b64_tr_b16 a[122:123], v23 offset:25600
  ds_read_b64_tr_b16 a[124:125], v23 offset:28672
  ds_read_b64_tr_b16 a[126:127], v23 offset:29696
  s_waitcnt lgkmcnt(0)
  s_waitcnt vmcnt(16)
  s_barrier
  s_add_u32 s27, s26, 3145728
  s_add_u32 m0, s28, 32768
  s_nop 0
  buffer_load_dwordx4 v20, s[8:11], s27 offen lds
  s_add_u32 m0, s28, 33792
  s_add_u32 s27, s27, 32768
  buffer_load_dwordx4 v20, s[8:11], s27 offen lds
  s_add_u32 m0, s28, 34816
  s_add_u32 s27, s27, 32768
  buffer_load_dwordx4 v21, s[8:11], s27 offen lds
  s_add_u32 m0, s28, 35840
  s_add_u32 s27, s27, 32768
  buffer_load_dwordx4 v21, s[8:11], s27 offen lds
  s_add_u32 m0, s28, 36864
  s_add_u32 s27, s27, 32768
  buffer_load_dwordx4 v20, s[8:11], s27 offen lds
  s_add_u32 m0, s28, 37888
  s_add_u32 s27, s27, 32768
  buffer_load_dwordx4 v20, s[8:11], s27 offen lds
  s_add_u32 m0, s28, 38912
  s_add_u32 s27, s27, 32768
  buffer_load_dwordx4 v21, s[8:11], s27 offen lds
  s_add_u32 m0, s28, 39936
  s_add_u32 s27, s27, 32768
  buffer_load_dwordx4 v21, s[8:11], s27 offen lds
  ds_read_b64_tr_b16 a[128:129], v23 offset:32768
  ds_read_b64_tr_b16 a[130:131], v23 offset:33792
  ds_read_b64_tr_b16 a[132:133], v23 offset:36864
  ds_read_b64_tr_b16 a[134:135], v23 offset:37888
  ds_read_b64_tr_b16 a[136:137], v23 offset:40960
  ds_read_b64_tr_b16 a[138:139], v23 offset:41984
  ds_read_b64_tr_b16 a[140:141], v23 offset:45056
  ds_read_b64_tr_b16 a[142:143], v23 offset:46080
  ds_read_b64_tr_b16 a[144:145], v23 offset:49152
  ds_read_b64_tr_b16 a[146:147], v23 offset:50176
  ds_read_b64_tr_b16 a[148:149], v23 offset:53248
  ds_read_b64_tr_b16 a[150:151], v23 offset:54272
  ds_read_b64_tr_b16 a[152:153], v23 offset:57344
  ds_read_b64_tr_b16 a[154:155], v23 offset:58368
  ds_read_b64_tr_b16 a[156:157], v23 offset:61440
  ds_read_b64_tr_b16 a[158:159], v23 offset:62464
  s_waitcnt lgkmcnt(0)
  s_waitcnt vmcnt(16)
  s_barrier
  ds_read_b64_tr_b16 a[160:161], v24 offset:0
  ds_read_b64_tr_b16 a[162:163], v24 offset:1024
  ds_read_b64_tr_b16 a[164:165], v24 offset:4096
  ds_read_b64_tr_b16 a[166:167], v24 offset:5120
  ds_read_b64_tr_b16 a[168:169], v24 offset:8192
  ds_read_b64_tr_b16 a[170:171], v24 offset:9216
  ds_read_b64_tr_b16 a[172:173], v24 offset:12288
  ds_read_b64_tr_b16 a[174:175], v24 offset:13312
  ds_read_b64_tr_b16 a[176:177], v24 offset:16384
  ds_read_b64_tr_b16 a[178:179], v24 offset:17408
  ds_read_b64_tr_b16 a[180:181], v24 offset:20480
  ds_read_b64_tr_b16 a[182:183], v24 offset:21504
  ds_read_b64_tr_b16 a[184:185], v24 offset:24576
  ds_read_b64_tr_b16 a[186:187], v24 offset:25600
  ds_read_b64_tr_b16 a[188:189], v24 offset:28672
  ds_read_b64_tr_b16 a[190:191], v24 offset:29696
  s_waitcnt lgkmcnt(0)
  s_waitcnt vmcnt(8)
  s_barrier
  ds_read_b64_tr_b16 a[192:193], v22 offset:0
  ds_read_b64_tr_b16 a[194:195], v22 offset:1024
  ds_read_b64_tr_b16 a[196:197], v22 offset:4096
  ds_read_b64_tr_b16 a[198:199], v22 offset:5120
  ds_read_b64_tr_b16 a[200:201], v22 offset:8192
  ds_read_b64_tr_b16 a[202:203], v22 offset:9216
  ds_read_b64_tr_b16 a[204:205], v22 offset:12288
  ds_read_b64_tr_b16 a[206:207], v22 offset:13312
  ds_read_b64_tr_b16 a[208:209], v22 offset:16384
  ds_read_b64_tr_b16 a[210:211], v22 offset:17408
  ds_read_b64_tr_b16 a[212:213], v22 offset:20480
  ds_read_b64_tr_b16 a[214:215], v22 offset:21504
  ds_read_b64_tr_b16 a[216:217], v22 offset:24576
  ds_read_b64_tr_b16 a[218:219], v22 offset:25600
  ds_read_b64_tr_b16 a[220:221], v22 offset:28672
  ds_read_b64_tr_b16 a[222:223], v22 offset:29696
  s_waitcnt lgkmcnt(0)
  s_waitcnt vmcnt(0)
  s_barrier
  ds_read_b64_tr_b16 a[224:225], v22 offset:32768
  ds_read_b64_tr_b16 a[226:227], v22 offset:33792
  ds_read_b64_tr_b16 a[228:229], v22 offset:36864
  ds_read_b64_tr_b16 a[230:231], v22 offset:37888
  ds_read_b64_tr_b16 a[232:233], v22 offset:40960
  ds_read_b64_tr_b16 a[234:235], v22 offset:41984
  ds_read_b64_tr_b16 a[236:237], v22 offset:45056
  ds_read_b64_tr_b16 a[238:239], v22 offset:46080
  ds_read_b64_tr_b16 a[240:241], v22 offset:49152
  ds_read_b64_tr_b16 a[242:243], v22 offset:50176
  ds_read_b64_tr_b16 a[244:245], v22 offset:53248
  ds_read_b64_tr_b16 a[246:247], v22 offset:54272
  ds_read_b64_tr_b16 a[248:249], v22 offset:57344
  ds_read_b64_tr_b16 a[250:251], v22 offset:58368
  ds_read_b64_tr_b16 a[252:253], v22 offset:61440
  ds_read_b64_tr_b16 a[254:255], v22 offset:62464
  s_waitcnt lgkmcnt(0)
  s_branch q_ld_55
q_ld_53:
  s_add_u32 s27, s26, 0
  s_add_u32 m0, s28, 0
  s_nop 0
  buffer_load_dwordx4 v20, s[68:71], s27 offen lds
  s_add_u32 m0, s28, 1024
  s_add_u32 s27, s27, 32768
  buffer_load_dwordx4 v20, s[68:71], s27 offen lds
  s_add_u32 m0, s28, 2048
  s_add_u32 s27, s27, 32768
  buffer_load_dwordx4 v21, s[68:71], s27 offen lds
  s_add_u32 m0, s28, 3072
  s_add_u32 s27, s27, 32768
  buffer_load_dwordx4 v21, s[68:71], s27 offen lds
  s_add_u32 m0, s28, 4096
  s_add_u32 s27, s27, 32768
  buffer_load_dwordx4 v20, s[68:71], s27 offen lds
  s_add_u32 m0, s28, 5120
  s_add_u32 s27, s27, 32768
  buffer_load_dwordx4 v20, s[68:71], s27 offen lds
  s_add_u32 m0, s28, 6144
  s_add_u32 s27, s27, 32768
  buffer_load_dwordx4 v21, s[68:71], s27 offen lds
  s_add_u32 m0, s28, 7168
  s_add_u32 s27, s27, 32768
  buffer_load_dwordx4 v21, s[68:71], s27 offen lds
  s_add_u32 s27, s26, 1048576
  s_add_u32 m0, s28, 32768
  s_nop 0
  buffer_load_dwordx4 v20, s[68:71], s27 offen lds
  s_add_u32 m0, s28, 33792
  s_add_u32 s27, s27, 32768
  buffer_load_dwordx4 v20, s[68:71], s27 offen lds
  s_add_u32 m0, s28, 34816
  s_add_u32 s27, s27, 32768
  buffer_load_dwordx4 v21, s[68:71], s27 offen lds
  s_add_u32 m0, s28, 35840
  s_add_u32 s27, s27, 32768
  buffer_load_dwordx4 v21, s[68:71], s27 offen lds
  s_add_u32 m0, s28, 36864
  s_add_u32 s27, s27, 32768
  buffer_load_dwordx4 v20, s[68:71], s27 offen lds
  s_add_u32 m0, s28, 37888
  s_add_u32 s27, s27, 32768
  buffer_load_dwordx4 v20, s[68:71], s27 offen lds
  s_add_u32 m0, s28, 38912
  s_add_u32 s27, s27, 32768
  buffer_load_dwordx4 v21, s[68:71], s27 offen lds
  s_add_u32 m0, s28, 39936
  s_add_u32 s27, s27, 32768
  buffer_load_dwordx4 v21, s[68:71], s27 offen lds
  s_add_u32 s27, s26, 2097152
  s_add_u32 m0, s28, 65536
  s_nop 0
  buffer_load_dwordx4 v20, s[68:71], s27 offen lds
  s_add_u32 m0, s28, 66560
  s_add_u32 s27, s27, 32768
  buffer_load_dwordx4 v20, s[68:71], s27 offen lds
  s_add_u32 m0, s28, 67584
  s_add_u32 s27, s27, 32768
  buffer_load_dwordx4 v21, s[68:71], s27 offen lds
  s_add_u32 m0, s28, 68608
  s_add_u32 s27, s27, 32768
  buffer_load_dwordx4 v21, s[68:71], s27 offen lds
  s_add_u32 m0, s28, 69632
  s_add_u32 s27, s27, 32768
  buffer_load_dwordx4 v20, s[68:71], s27 offen lds
  s_add_u32 m0, s28, 70656
  s_add_u32 s27, s27, 32768
  buffer_load_dwordx4 v20, s[68:71], s27 offen lds
  s_add_u32 m0, s28, 71680
  s_add_u32 s27, s27, 32768
  buffer_load_dwordx4 v21, s[68:71], s27 offen lds
  s_add_u32 m0, s28, 72704
  s_add_u32 s27, s27, 32768
  buffer_load_dwordx4 v21, s[68:71], s27 offen lds
  s_load_dwordx2 s[4:5], s[0:1], 112
  s_load_dwordx2 s[12:13], s[0:1], 104
  s_waitcnt vmcnt(16)
  s_barrier
  s_add_u32 s27, s26, 3145728
  s_add_u32 m0, s28, 98304
  s_nop 0
  buffer_load_dwordx4 v20, s[68:71], s27 offen lds
  s_add_u32 m0, s28, 99328
  s_add_u32 s27, s27, 32768
  buffer_load_dwordx4 v20, s[68:71], s27 offen lds
  s_add_u32 m0, s28, 100352
  s_add_u32 s27, s27, 32768
  buffer_load_dwordx4 v21, s[68:71], s27 offen lds
  s_add_u32 m0, s28, 101376
  s_add_u32 s27, s27, 32768
  buffer_load_dwordx4 v21, s[68:71], s27 offen lds
  s_add_u32 m0, s28, 102400
  s_add_u32 s27, s27, 32768
  buffer_load_dwordx4 v20, s[68:71], s27 offen lds
  s_add_u32 m0, s28, 103424
  s_add_u32 s27, s27, 32768
  buffer_load_dwordx4 v20, s[68:71], s27 offen lds
  s_add_u32 m0, s28, 104448
  s_add_u32 s27, s27, 32768
  buffer_load_dwordx4 v21, s[68:71], s27 offen lds
  s_add_u32 m0, s28, 105472
  s_add_u32 s27, s27, 32768
  buffer_load_dwordx4 v21, s[68:71], s27 offen lds
  ds_read_b64_tr_b16 a[0:1], v22 offset:0
  ds_read_b64_tr_b16 a[2:3], v22 offset:1024
  ds_read_b64_tr_b16 a[4:5], v22 offset:4096
  ds_read_b64_tr_b16 a[6:7], v22 offset:5120
  ds_read_b64_tr_b16 a[8:9], v22 offset:8192
  ds_read_b64_tr_b16 a[10:11], v22 offset:9216
  ds_read_b64_tr_b16 a[12:13], v22 offset:12288
  ds_read_b64_tr_b16 a[14:15], v22 offset:13312
  ds_read_b64_tr_b16 a[16:17], v22 offset:16384
  ds_read_b64_tr_b16 a[18:19], v22 offset:17408
  ds_read_b64_tr_b16 a[20:21], v22 offset:20480
  ds_read_b64_tr_b16 a[22:23], v22 offset:21504
  ds_read_b64_tr_b16 a[24:25], v22 offset:24576
  ds_read_b64_tr_b16 a[26:27], v22 offset:25600
  ds_read_b64_tr_b16 a[28:29], v22 offset:28672
  ds_read_b64_tr_b16 a[30:31], v22 offset:29696
  s_waitcnt lgkmcnt(0)
  s_waitcnt vmcnt(16)
  s_barrier
  s_add_u32 s27, s26, 0
  s_add_u32 m0, s28, 131072
  s_nop 0
  buffer_load_dwordx4 v20, s[8:11], s27 offen lds
  s_add_u32 m0, s28, 132096
  s_add_u32 s27, s27, 32768
  buffer_load_dwordx4 v20, s[8:11], s27 offen lds
  s_add_u32 m0, s28, 133120
  s_add_u32 s27, s27, 32768
  buffer_load_dwordx4 v21, s[8:11], s27 offen lds
  s_add_u32 m0, s28, 134144
  s_add_u32 s27, s27, 32768
  buffer_load_dwordx4 v21, s[8:11], s27 offen lds
  s_add_u32 m0, s28, 135168
  s_add_u32 s27, s27, 32768
  buffer_load_dwordx4 v20, s[8:11], s27 offen lds
  s_add_u32 m0, s28, 136192
  s_add_u32 s27, s27, 32768
  buffer_load_dwordx4 v20, s[8:11], s27 offen lds
  s_add_u32 m0, s28, 137216
  s_add_u32 s27, s27, 32768
  buffer_load_dwordx4 v21, s[8:11], s27 offen lds
  s_add_u32 m0, s28, 138240
  s_add_u32 s27, s27, 32768
  buffer_load_dwordx4 v21, s[8:11], s27 offen lds
  ds_read_b64_tr_b16 a[32:33], v22 offset:32768
  ds_read_b64_tr_b16 a[34:35], v22 offset:33792
  ds_read_b64_tr_b16 a[36:37], v22 offset:36864
  ds_read_b64_tr_b16 a[38:39], v22 offset:37888
  ds_read_b64_tr_b16 a[40:41], v22 offset:40960
  ds_read_b64_tr_b16 a[42:43], v22 offset:41984
  ds_read_b64_tr_b16 a[44:45], v22 offset:45056
  ds_read_b64_tr_b16 a[46:47], v22 offset:46080
  ds_read_b64_tr_b16 a[48:49], v22 offset:49152
  ds_read_b64_tr_b16 a[50:51], v22 offset:50176
  ds_read_b64_tr_b16 a[52:53], v22 offset:53248
  ds_read_b64_tr_b16 a[54:55], v22 offset:54272
  ds_read_b64_tr_b16 a[56:57], v22 offset:57344
  ds_read_b64_tr_b16 a[58:59], v22 offset:58368
  ds_read_b64_tr_b16 a[60:61], v22 offset:61440
  ds_read_b64_tr_b16 a[62:63], v22 offset:62464
  s_waitcnt lgkmcnt(0)
  s_waitcnt vmcnt(16)
  s_barrier
  s_add_u32 s27, s26, 1048576
  s_add_u32 m0, s28, 0
  s_nop 0
  buffer_load_dwordx4 v20, s[8:11], s27 offen lds
  s_add_u32 m0, s28, 1024
  s_add_u32 s27, s27, 32768
  buffer_load_dwordx4 v20, s[8:11], s27 offen lds
  s_add_u32 m0, s28, 2048
  s_add_u32 s27, s27, 32768
  buffer_load_dwordx4 v21, s[8:11], s27 offen lds
  s_add_u32 m0, s28, 3072
  s_add_u32 s27, s27, 32768
  buffer_load_dwordx4 v21, s[8:11], s27 offen lds
  s_add_u32 m0, s28, 4096
  s_add_u32 s27, s27, 32768
  buffer_load_dwordx4 v20, s[8:11], s27 offen lds
  s_add_u32 m0, s28, 5120
  s_add_u32 s27, s27, 32768
  buffer_load_dwordx4 v20, s[8:11], s27 offen lds
  s_add_u32 m0, s28, 6144
  s_add_u32 s27, s27, 32768
  buffer_load_dwordx4 v21, s[8:11], s27 offen lds
  s_add_u32 m0, s28, 7168
  s_add_u32 s27, s27, 32768
  buffer_load_dwordx4 v21, s[8:11], s27 offen lds
  ds_read_b64_tr_b16 a[64:65], v23 offset:0
  ds_read_b64_tr_b16 a[66:67], v23 offset:1024
  ds_read_b64_tr_b16 a[68:69], v23 offset:4096
  ds_read_b64_tr_b16 a[70:71], v23 offset:5120
  ds_read_b64_tr_b16 a[72:73], v23 offset:8192
  ds_read_b64_tr_b16 a[74:75], v23 offset:9216
  ds_read_b64_tr_b16 a[76:77], v23 offset:12288
  ds_read_b64_tr_b16 a[78:79], v23 offset:13312
  ds_read_b64_tr_b16 a[80:81], v23 offset:16384
  ds_read_b64_tr_b16 a[82:83], v23 offset:17408
  ds_read_b64_tr_b16 a[84:85], v23 offset:20480
  ds_read_b64_tr_b16 a[86:87], v23 offset:21504
  ds_read_b64_tr_b16 a[88:89], v23 offset:24576
  ds_read_b64_tr_b16 a[90:91], v23 offset:25600
  ds_read_b64_tr_b16 a[92:93], v23 offset:28672
  ds_read_b64_tr_b16 a[94:95], v23 offset:29696
  s_waitcnt lgkmcnt(0)
  s_waitcnt vmcnt(16)
  s_barrier
  s_add_u32 s27, s26, 2097152
  s_add_u32 m0, s28, 32768
  s_nop 0
  buffer_load_dwordx4 v20, s[8:11], s27 offen lds
  s_add_u32 m0, s28, 33792
  s_add_u32 s27, s27, 32768
  buffer_load_dwordx4 v20, s[8:11], s27 offen lds
  s_add_u32 m0, s28, 34816
  s_add_u32 s27, s27, 32768
  buffer_load_dwordx4 v21, s[8:11], s27 offen lds
  s_add_u32 m0, s28, 35840
  s_add_u32 s27, s27, 32768
  buffer_load_dwordx4 v21, s[8:11], s27 offen lds
  s_add_u32 m0, s28, 36864
  s_add_u32 s27, s27, 32768
  buffer_load_dwordx4 v20, s[8:11], s27 offen lds
  s_add_u32 m0, s28, 37888
  s_add_u32 s27, s27, 32768
  buffer_load_dwordx4 v20, s[8:11], s27 offen lds
  s_add_u32 m0, s28, 38912
  s_add_u32 s27, s27, 32768
  buffer_load_dwordx4 v21, s[8:11], s27 offen lds
  s_add_u32 m0, s28, 39936
  s_add_u32 s27, s27, 32768
  buffer_load_dwordx4 v21, s[8:11], s27 offen lds
  ds_read_b64_tr_b16 a[96:97], v23 offset:32768
  ds_read_b64_tr_b16 a[98:99], v23 offset:33792
  ds_read_b64_tr_b16 a[100:101], v23 offset:36864
  ds_read_b64_tr_b16 a[102:103], v23 offset:37888
  ds_read_b64_tr_b16 a[104:105], v23 offset:40960
  ds_read_b64_tr_b16 a[106:107], v23 offset:41984
  ds_read_b64_tr_b16 a[108:109], v23 offset:45056
  ds_read_b64_tr_b16 a[110:111], v23 offset:46080
  ds_read_b64_tr_b16 a[112:113], v23 offset:49152
  ds_read_b64_tr_b16 a[114:115], v23 offset:50176
  ds_read_b64_tr_b16 a[116:117], v23 offset:53248
  ds_read_b64_tr_b16 a[118:119], v23 offset:54272
  ds_read_b64_tr_b16 a[120:121], v23 offset:57344
  ds_read_b64_tr_b16 a[122:123], v23 offset:58368
  ds_read_b64_tr_b16 a[124:125], v23 offset:61440
  ds_read_b64_tr_b16 a[126:127], v23 offset:62464
  s_waitcnt lgkmcnt(0)
  s_waitcnt vmcnt(16)
  s_barrier
  s_add_u32 s27, s26, 3145728
  s_add_u32 m0, s28, 65536
  s_nop 0
  buffer_load_dwordx4 v20, s[8:11], s27 offen lds
  s_add_u32 m0, s28, 66560
  s_add_u32 s27, s27, 32768
  buffer_load_dwordx4 v20, s[8:11], s27 offen lds
  s_add_u32 m0, s28, 67584
  s_add_u32 s27, s27, 32768
  buffer_load_dwordx4 v21, s[8:11], s27 offen lds
  s_add_u32 m0, s28, 68608
  s_add_u32 s27, s27, 32768
  buffer_load_dwordx4 v21, s[8:11], s27 offen lds
  s_add_u32 m0, s28, 69632
  s_add_u32 s27, s27, 32768
  buffer_load_dwordx4 v20, s[8:11], s27 offen lds
  s_add_u32 m0, s28, 70656
  s_add_u32 s27, s27, 32768
  buffer_load_dwordx4 v20, s[8:11], s27 offen lds
  s_add_u32 m0, s28, 71680
  s_add_u32 s27, s27, 32768
  buffer_load_dwordx4 v21, s[8:11], s27 offen lds
  s_add_u32 m0, s28, 72704
  s_add_u32 s27, s27, 32768
  buffer_load_dwordx4 v21, s[8:11], s27 offen lds
  ds_read_b64_tr_b16 a[128:129], v24 offset:0
  ds_read_b64_tr_b16 a[130:131], v24 offset:1024
  ds_read_b64_tr_b16 a[132:133], v24 offset:4096
  ds_read_b64_tr_b16 a[134:135], v24 offset:5120
  ds_read_b64_tr_b16 a[136:137], v24 offset:8192
  ds_read_b64_tr_b16 a[138:139], v24 offset:9216
  ds_read_b64_tr_b16 a[140:141], v24 offset:12288
  ds_read_b64_tr_b16 a[142:143], v24 offset:13312
  ds_read_b64_tr_b16 a[144:145], v24 offset:16384
  ds_read_b64_tr_b16 a[146:147], v24 offset:17408
  ds_read_b64_tr_b16 a[148:149], v24 offset:20480
  ds_read_b64_tr_b16 a[150:151], v24 offset:21504
  ds_read_b64_tr_b16 a[152:153], v24 offset:24576
  ds_read_b64_tr_b16 a[154:155], v24 offset:25600
  ds_read_b64_tr_b16 a[156:157], v24 offset:28672
  ds_read_b64_tr_b16 a[158:159], v24 offset:29696
  s_waitcnt lgkmcnt(0)
  s_waitcnt vmcnt(16)
  s_barrier
  s_add_u32 s27, s26, 0
  s_add_u32 m0, s28, 98304
  s_nop 0
  buffer_load_dwordx4 v20, s[64:67], s27 offen lds
  s_add_u32 m0, s28, 99328
  s_add_u32 s27, s27, 32768
  buffer_load_dwordx4 v20, s[64:67], s27 offen lds
  s_add_u32 m0, s28, 100352
  s_add_u32 s27, s27, 32768
  buffer_load_dwordx4 v21, s[64:67], s27 offen lds
  s_add_u32 m0, s28, 101376
  s_add_u32 s27, s27, 32768
  buffer_load_dwordx4 v21, s[64:67], s27 offen lds
  s_add_u32 m0, s28, 102400
  s_add_u32 s27, s27, 32768
  buffer_load_dwordx4 v20, s[64:67], s27 offen lds
  s_add_u32 m0, s28, 103424
  s_add_u32 s27, s27, 32768
  buffer_load_dwordx4 v20, s[64:67], s27 offen lds
  s_add_u32 m0, s28, 104448
  s_add_u32 s27, s27, 32768
  buffer_load_dwordx4 v21, s[64:67], s27 offen lds
  s_add_u32 m0, s28, 105472
  s_add_u32 s27, s27, 32768
  buffer_load_dwordx4 v21, s[64:67], s27 offen lds
  ds_read_b64_tr_b16 a[160:161], v22 offset:0
  ds_read_b64_tr_b16 a[162:163], v22 offset:1024
  ds_read_b64_tr_b16 a[164:165], v22 offset:4096
  ds_read_b64_tr_b16 a[166:167], v22 offset:5120
  ds_read_b64_tr_b16 a[168:169], v22 offset:8192
  ds_read_b64_tr_b16 a[170:171], v22 offset:9216
  ds_read_b64_tr_b16 a[172:173], v22 offset:12288
  ds_read_b64_tr_b16 a[174:175], v22 offset:13312
  ds_read_b64_tr_b16 a[176:177], v22 offset:16384
  ds_read_b64_tr_b16 a[178:179], v22 offset:17408
  ds_read_b64_tr_b16 a[180:181], v22 offset:20480
  ds_read_b64_tr_b16 a[182:183], v22 offset:21504
  ds_read_b64_tr_b16 a[184:185], v22 offset:24576
  ds_read_b64_tr_b16 a[186:187], v22 offset:25600
  ds_read_b64_tr_b16 a[188:189], v22 offset:28672
  ds_read_b64_tr_b16 a[190:191], v22 offset:29696
  s_waitcnt lgkmcnt(0)
  s_waitcnt vmcnt(16)
  s_barrier
  s_add_u32 s27, s26, 1048576
  s_add_u32 m0, s28, 131072
  s_nop 0
  buffer_load_dwordx4 v20, s[64:67], s27 offen lds
  s_add_u32 m0, s28, 132096
  s_add_u32 s27, s27, 32768
  buffer_load_dwordx4 v20, s[64:67], s27 offen lds
  s_add_u32 m0, s28, 133120
  s_add_u32 s27, s27, 32768
  buffer_load_dwordx4 v21, s[64:67], s27 offen lds
  s_add_u32 m0, s28, 134144
  s_add_u32 s27, s27, 32768
  buffer_load_dwordx4 v21, s[64:67], s27 offen lds
  s_add_u32 m0, s28, 135168
  s_add_u32 s27, s27, 32768
  buffer_load_dwordx4 v20, s[64:67], s27 offen lds
  s_add_u32 m0, s28, 136192
  s_add_u32 s27, s27, 32768
  buffer_load_dwordx4 v20, s[64:67], s27 offen lds
  s_add_u32 m0, s28, 137216
  s_add_u32 s27, s27, 32768
  buffer_load_dwordx4 v21, s[64:67], s27 offen lds
  s_add_u32 m0, s28, 138240
  s_add_u32 s27, s27, 32768
  buffer_load_dwordx4 v21, s[64:67], s27 offen lds
  ds_read_b64_tr_b16 a[192:193], v22 offset:32768
  ds_read_b64_tr_b16 a[194:195], v22 offset:33792
  ds_read_b64_tr_b16 a[196:197], v22 offset:36864
  ds_read_b64_tr_b16 a[198:199], v22 offset:37888
  ds_read_b64_tr_b16 a[200:201], v22 offset:40960
  ds_read_b64_tr_b16 a[202:203], v22 offset:41984
  ds_read_b64_tr_b16 a[204:205], v22 offset:45056
  ds_read_b64_tr_b16 a[206:207], v22 offset:46080
  ds_read_b64_tr_b16 a[208:209], v22 offset:49152
  ds_read_b64_tr_b16 a[210:211], v22 offset:50176
  ds_read_b64_tr_b16 a[212:213], v22 offset:53248
  ds_read_b64_tr_b16 a[214:215], v22 offset:54272
  ds_read_b64_tr_b16 a[216:217], v22 offset:57344
  ds_read_b64_tr_b16 a[218:219], v22 offset:58368
  ds_read_b64_tr_b16 a[220:221], v22 offset:61440
  ds_read_b64_tr_b16 a[222:223], v22 offset:62464
  s_waitcnt lgkmcnt(0)
  s_waitcnt vmcnt(16)
  s_barrier
  s_add_u32 s27, s26, 2097152
  s_add_u32 m0, s28, 0
  s_nop 0
  buffer_load_dwordx4 v20, s[64:67], s27 offen lds
  s_add_u32 m0, s28, 1024
  s_add_u32 s27, s27, 32768
  buffer_load_dwordx4 v20, s[64:67], s27 offen lds
  s_add_u32 m0, s28, 2048
  s_add_u32 s27, s27, 32768
  buffer_load_dwordx4 v21, s[64:67], s27 offen lds
  s_add_u32 m0, s28, 3072
  s_add_u32 s27, s27, 32768
  buffer_load_dwordx4 v21, s[64:67], s27 offen lds
  s_add_u32 m0, s28, 4096
  s_add_u32 s27, s27, 32768
  buffer_load_dwordx4 v20, s[64:67], s27 offen lds
  s_add_u32 m0, s28, 5120
  s_add_u32 s27, s27, 32768
  buffer_load_dwordx4 v20, s[64:67], s27 offen lds
  s_add_u32 m0, s28, 6144
  s_add_u32 s27, s27, 32768
  buffer_load_dwordx4 v21, s[64:67], s27 offen lds
  s_add_u32 m0, s28, 7168
  s_add_u32 s27, s27, 32768
  buffer_load_dwordx4 v21, s[64:67], s27 offen lds
  ds_read_b64_tr_b16 a[224:225], v23 offset:0
  ds_read_b64_tr_b16 a[226:227], v23 offset:1024
  ds_read_b64_tr_b16 a[228:229], v23 offset:4096
  ds_read_b64_tr_b16 a[230:231], v23 offset:5120
  ds_read_b64_tr_b16 a[232:233], v23 offset:8192
  ds_read_b64_tr_b16 a[234:235], v23 offset:9216
  ds_read_b64_tr_b16 a[236:237], v23 offset:12288
  ds_read_b64_tr_b16 a[238:239], v23 offset:13312
  ds_read_b64_tr_b16 a[240:241], v23 offset:16384
  ds_read_b64_tr_b16 a[242:243], v23 offset:17408
  ds_read_b64_tr_b16 a[244:245], v23 offset:20480
  ds_read_b64_tr_b16 a[246:247], v23 offset:21504
  ds_read_b64_tr_b16 a[248:249], v23 offset:24576
  ds_read_b64_tr_b16 a[250:251], v23 offset:25600
  ds_read_b64_tr_b16 a[252:253], v23 offset:28672
  ds_read_b64_tr_b16 a[254:255], v23 offset:29696
  s_waitcnt lgkmcnt(0)
  s_waitcnt vmcnt(16)
  s_barrier
  s_add_u32 s27, s26, 3145728
  s_add_u32 m0, s28, 32768
  s_nop 0
  buffer_load_dwordx4 v20, s[64:67], s27 offen lds
  s_add_u32 m0, s28, 33792
  s_add_u32 s27, s27, 32768
  buffer_load_dwordx4 v20, s[64:67], s27 offen lds
  s_add_u32 m0, s28, 34816
  s_add_u32 s27, s27, 32768
  buffer_load_dwordx4 v21, s[64:67], s27 offen lds
  s_add_u32 m0, s28, 35840
  s_add_u32 s27, s27, 32768
  buffer_load_dwordx4 v21, s[64:67], s27 offen lds
  s_add_u32 m0, s28, 36864
  s_add_u32 s27, s27, 32768
  buffer_load_dwordx4 v20, s[64:67], s27 offen lds
  s_add_u32 m0, s28, 37888
  s_add_u32 s27, s27, 32768
  buffer_load_dwordx4 v20, s[64:67], s27 offen lds
  s_add_u32 m0, s28, 38912
  s_add_u32 s27, s27, 32768
  buffer_load_dwordx4 v21, s[64:67], s27 offen lds
  s_add_u32 m0, s28, 39936
  s_add_u32 s27, s27, 32768
  buffer_load_dwordx4 v21, s[64:67], s27 offen lds
  ds_read_b64_tr_b16 v[128:129], v23 offset:32768
  ds_read_b64_tr_b16 v[130:131], v23 offset:33792
  ds_read_b64_tr_b16 v[132:133], v23 offset:36864
  ds_read_b64_tr_b16 v[134:135], v23 offset:37888
  ds_read_b64_tr_b16 v[136:137], v23 offset:40960
  ds_read_b64_tr_b16 v[138:139], v23 offset:41984
  ds_read_b64_tr_b16 v[140:141], v23 offset:45056
  ds_read_b64_tr_b16 v[142:143], v23 offset:46080
  ds_read_b64_tr_b16 v[144:145], v23 offset:49152
  ds_read_b64_tr_b16 v[146:147], v23 offset:50176
  ds_read_b64_tr_b16 v[148:149], v23 offset:53248
  ds_read_b64_tr_b16 v[150:151], v23 offset:54272
  ds_read_b64_tr_b16 v[152:153], v23 offset:57344
  ds_read_b64_tr_b16 v[154:155], v23 offset:58368
  ds_read_b64_tr_b16 v[156:157], v23 offset:61440
  ds_read_b64_tr_b16 v[158:159], v23 offset:62464
  s_waitcnt lgkmcnt(0)
  s_waitcnt vmcnt(16)
  s_barrier
  ds_read_b64_tr_b16 v[160:161], v24 offset:0
  ds_read_b64_tr_b16 v[162:163], v24 offset:1024
  ds_read_b64_tr_b16 v[164:165], v24 offset:4096
  ds_read_b64_tr_b16 v[166:167], v24 offset:5120
  ds_read_b64_tr_b16 v[168:169], v24 offset:8192
  ds_read_b64_tr_b16 v[170:171], v24 offset:9216
  ds_read_b64_tr_b16 v[172:173], v24 offset:12288
  ds_read_b64_tr_b16 v[174:175], v24 offset:13312
  ds_read_b64_tr_b16 v[176:177], v24 offset:16384
  ds_read_b64_tr_b16 v[178:179], v24 offset:17408
  ds_read_b64_tr_b16 v[180:181], v24 offset:20480
  ds_read_b64_tr_b16 v[182:183], v24 offset:21504
  ds_read_b64_tr_b16 v[184:185], v24 offset:24576
  ds_read_b64_tr_b16 v[186:187], v24 offset:25600
  ds_read_b64_tr_b16 v[188:189], v24 offset:28672
  ds_read_b64_tr_b16 v[190:191], v24 offset:29696
  s_waitcnt lgkmcnt(0)
  s_waitcnt vmcnt(8)
  s_barrier
  ds_read_b64_tr_b16 v[192:193], v22 offset:0
  ds_read_b64_tr_b16 v[194:195], v22 offset:1024
  ds_read_b64_tr_b16 v[196:197], v22 offset:4096
  ds_read_b64_tr_b16 v[198:199], v22 offset:5120
  ds_read_b64_tr_b16 v[200:201], v22 offset:8192
  ds_read_b64_tr_b16 v[202:203], v22 offset:9216
  ds_read_b64_tr_b16 v[204:205], v22 offset:12288
  ds_read_b64_tr_b16 v[206:207], v22 offset:13312
  ds_read_b64_tr_b16 v[208:209], v22 offset:16384
  ds_read_b64_tr_b16 v[210:211], v22 offset:17408
  ds_read_b64_tr_b16 v[212:213], v22 offset:20480
  ds_read_b64_tr_b16 v[214:215], v22 offset:21504
  ds_read_b64_tr_b16 v[216:217], v22 offset:24576
  ds_read_b64_tr_b16 v[218:219], v22 offset:25600
  ds_read_b64_tr_b16 v[220:221], v22 offset:28672
  ds_read_b64_tr_b16 v[222:223], v22 offset:29696
  s_waitcnt lgkmcnt(0)
  s_waitcnt vmcnt(0)
  s_barrier
  ds_read_b64_tr_b16 v[224:225], v22 offset:32768
  ds_read_b64_tr_b16 v[226:227], v22 offset:33792
  ds_read_b64_tr_b16 v[228:229], v22 offset:36864
  ds_read_b64_tr_b16 v[230:231], v22 offset:37888
  ds_read_b64_tr_b16 v[232:233], v22 offset:40960
  ds_read_b64_tr_b16 v[234:235], v22 offset:41984
  ds_read_b64_tr_b16 v[236:237], v22 offset:45056
  ds_read_b64_tr_b16 v[238:239], v22 offset:46080
  ds_read_b64_tr_b16 v[240:241], v22 offset:49152
  ds_read_b64_tr_b16 v[242:243], v22 offset:50176
  ds_read_b64_tr_b16 v[244:245], v22 offset:53248
  ds_read_b64_tr_b16 v[246:247], v22 offset:54272
  ds_read_b64_tr_b16 v[248:249], v22 offset:57344
  ds_read_b64_tr_b16 v[250:251], v22 offset:58368
  ds_read_b64_tr_b16 v[252:253], v22 offset:61440
  ds_read_b64_tr_b16 v[254:255], v22 offset:62464
  s_waitcnt lgkmcnt(0)
  s_branch q_ld_55
q_ld_54:
  s_add_u32 s27, s26, 0
  s_add_u32 m0, s28, 0
  s_nop 0
  buffer_load_dwordx4 v20, s[8:11], s27 offen lds
  s_add_u32 m0, s28, 1024
  s_add_u32 s27, s27, 32768
  buffer_load_dwordx4 v20, s[8:11], s27 offen lds
  s_add_u32 m0, s28, 2048
  s_add_u32 s27, s27, 32768
  buffer_load_dwordx4 v21, s[8:11], s27 offen lds
  s_add_u32 m0, s28, 3072
  s_add_u32 s27, s27, 32768
  buffer_load_dwordx4 v21, s[8:11], s27 offen lds
  s_add_u32 m0, s28, 4096
  s_add_u32 s27, s27, 32768
  buffer_load_dwordx4 v20, s[8:11], s27 offen lds
  s_add_u32 m0, s28, 5120
  s_add_u32 s27, s27, 32768
  buffer_load_dwordx4 v20, s[8:11], s27 offen lds
  s_add_u32 m0, s28, 6144
  s_add_u32 s27, s27, 32768
  buffer_load_dwordx4 v21, s[8:11], s27 offen lds
  s_add_u32 m0, s28, 7168
  s_add_u32 s27, s27, 32768
  buffer_load_dwordx4 v21, s[8:11], s27 offen lds
  s_add_u32 s27, s26, 1048576
  s_add_u32 m0, s28, 32768
  s_nop 0
  buffer_load_dwordx4 v20, s[8:11], s27 offen lds
  s_add_u32 m0, s28, 33792
  s_add_u32 s27, s27, 32768
  buffer_load_dwordx4 v20, s[8:11], s27 offen lds
  s_add_u32 m0, s28, 34816
  s_add_u32 s27, s27, 32768
  buffer_load_dwordx4 v21, s[8:11], s27 offen lds
  s_add_u32 m0, s28, 35840
  s_add_u32 s27, s27, 32768
  buffer_load_dwordx4 v21, s[8:11], s27 offen lds
  s_add_u32 m0, s28, 36864
  s_add_u32 s27, s27, 32768
  buffer_load_dwordx4 v20, s[8:11], s27 offen lds
  s_add_u32 m0, s28, 37888
  s_add_u32 s27, s27, 32768
  buffer_load_dwordx4 v20, s[8:11], s27 offen lds
  s_add_u32 m0, s28, 38912
  s_add_u32 s27, s27, 32768
  buffer_load_dwordx4 v21, s[8:11], s27 offen lds
  s_add_u32 m0, s28, 39936
  s_add_u32 s27, s27, 32768
  buffer_load_dwordx4 v21, s[8:11], s27 offen lds
  s_add_u32 s27, s26, 2097152
  s_add_u32 m0, s28, 65536
  s_nop 0
  buffer_load_dwordx4 v20, s[8:11], s27 offen lds
  s_add_u32 m0, s28, 66560
  s_add_u32 s27, s27, 32768
  buffer_load_dwordx4 v20, s[8:11], s27 offen lds
  s_add_u32 m0, s28, 67584
  s_add_u32 s27, s27, 32768
  buffer_load_dwordx4 v21, s[8:11], s27 offen lds
  s_add_u32 m0, s28, 68608
  s_add_u32 s27, s27, 32768
  buffer_load_dwordx4 v21, s[8:11], s27 offen lds
  s_add_u32 m0, s28, 69632
  s_add_u32 s27, s27, 32768
  buffer_load_dwordx4 v20, s[8:11], s27 offen lds
  s_add_u32 m0, s28, 70656
  s_add_u32 s27, s27, 32768
  buffer_load_dwordx4 v20, s[8:11], s27 offen lds
  s_add_u32 m0, s28, 71680
  s_add_u32 s27, s27, 32768
  buffer_load_dwordx4 v21, s[8:11], s27 offen lds
  s_add_u32 m0, s28, 72704
  s_add_u32 s27, s27, 32768
  buffer_load_dwordx4 v21, s[8:11], s27 offen lds
  s_load_dwordx2 s[4:5], s[0:1], 112
  s_load_dwordx2 s[12:13], s[0:1], 104
  s_waitcnt vmcnt(16)
  s_barrier
  s_add_u32 s27, s26, 3145728
  s_add_u32 m0, s28, 98304
  s_nop 0
  buffer_load_dwordx4 v20, s[8:11], s27 offen lds
  s_add_u32 m0, s28, 99328
  s_add_u32 s27, s27, 32768
  buffer_load_dwordx4 v20, s[8:11], s27 offen lds
  s_add_u32 m0, s28, 100352
  s_add_u32 s27, s27, 32768
  buffer_load_dwordx4 v21, s[8:11], s27 offen lds
  s_add_u32 m0, s28, 101376
  s_add_u32 s27, s27, 32768
  buffer_load_dwordx4 v21, s[8:11], s27 offen lds
  s_add_u32 m0, s28, 102400
  s_add_u32 s27, s27, 32768
  buffer_load_dwordx4 v20, s[8:11], s27 offen lds
  s_add_u32 m0, s28, 103424
  s_add_u32 s27, s27, 32768
  buffer_load_dwordx4 v20, s[8:11], s27 offen lds
  s_add_u32 m0, s28, 104448
  s_add_u32 s27, s27, 32768
  buffer_load_dwordx4 v21, s[8:11], s27 offen lds
  s_add_u32 m0, s28, 105472
  s_add_u32 s27, s27, 32768
  buffer_load_dwordx4 v21, s[8:11], s27 offen lds
  ds_read_b64_tr_b16 a[128:129], v22 offset:0
  ds_read_b64_tr_b16 a[130:131], v22 offset:1024
  ds_read_b64_tr_b16 a[132:133], v22 offset:4096
  ds_read_b64_tr_b16 a[134:135], v22 offset:5120
  ds_read_b64_tr_b16 a[136:137], v22 offset:8192
  ds_read_b64_tr_b16 a[138:139], v22 offset:9216
  ds_read_b64_tr_b16 a[140:141], v22 offset:12288
  ds_read_b64_tr_b16 a[142:143], v22 offset:13312
  ds_read_b64_tr_b16 a[144:145], v22 offset:16384
  ds_read_b64_tr_b16 a[146:147], v22 offset:17408
  ds_read_b64_tr_b16 a[148:149], v22 offset:20480
  ds_read_b64_tr_b16 a[150:151], v22 offset:21504
  ds_read_b64_tr_b16 a[152:153], v22 offset:24576
  ds_read_b64_tr_b16 a[154:155], v22 offset:25600
  ds_read_b64_tr_b16 a[156:157], v22 offset:28672
  ds_read_b64_tr_b16 a[158:159], v22 offset:29696
  s_waitcnt lgkmcnt(0)
  s_waitcnt vmcnt(16)
  s_barrier
  s_add_u32 s27, s26, 0
  s_add_u32 m0, s28, 131072
  s_nop 0
  buffer_load_dwordx4 v20, s[64:67], s27 offen lds
  s_add_u32 m0, s28, 132096
  s_add_u32 s27, s27, 32768
  buffer_load_dwordx4 v20, s[64:67], s27 offen lds
  s_add_u32 m0, s28, 133120
  s_add_u32 s27, s27, 32768
  buffer_load_dwordx4 v21, s[64:67], s27 offen lds
  s_add_u32 m0, s28, 134144
  s_add_u32 s27, s27, 32768
  buffer_load_dwordx4 v21, s[64:67], s27 offen lds
  s_add_u32 m0, s28, 135168
  s_add_u32 s27, s27, 32768
  buffer_load_dwordx4 v20, s[64:67], s27 offen lds
  s_add_u32 m0, s28, 136192
  s_add_u32 s27, s27, 32768
  buffer_load_dwordx4 v20, s[64:67], s27 offen lds
  s_add_u32 m0, s28, 137216
  s_add_u32 s27, s27, 32768
  buffer_load_dwordx4 v21, s[64:67], s27 offen lds
  s_add_u32 m0, s28, 138240
  s_add_u32 s27, s27, 32768
  buffer_load_dwordx4 v21, s[64:67], s27 offen lds
  ds_read_b64_tr_b16 a[160:161], v22 offset:32768
  ds_read_b64_tr_b16 a[162:163], v22 offset:33792
  ds_read_b64_tr_b16 a[164:165], v22 offset:36864
  ds_read_b64_tr_b16 a[166:167], v22 offset:37888
  ds_read_b64_tr_b16 a[168:169], v22 offset:40960
  ds_read_b64_tr_b16 a[170:171], v22 offset:41984
  ds_read_b64_tr_b16 a[172:173], v22 offset:45056
  ds_read_b64_tr_b16 a[174:175], v22 offset:46080
  ds_read_b64_tr_b16 a[176:177], v22 offset:49152
  ds_read_b64_tr_b16 a[178:179], v22 offset:50176
  ds_read_b64_tr_b16 a[180:181], v22 offset:53248
  ds_read_b64_tr_b16 a[182:183], v22 offset:54272
  ds_read_b64_tr_b16 a[184:185], v22 offset:57344
  ds_read_b64_tr_b16 a[186:187], v22 offset:58368
  ds_read_b64_tr_b16 a[188:189], v22 offset:61440
  ds_read_b64_tr_b16 a[190:191], v22 offset:62464
  s_waitcnt lgkmcnt(0)
  s_waitcnt vmcnt(16)
  s_barrier
  s_add_u32 s27, s26, 1048576
  s_add_u32 m0, s28, 0
  s_nop 0
  buffer_load_dwordx4 v20, s[64:67], s27 offen lds
  s_add_u32 m0, s28, 1024
  s_add_u32 s27, s27, 32768
  buffer_load_dwordx4 v20, s[64:67], s27 offen lds
  s_add_u32 m0, s28, 2048
  s_add_u32 s27, s27, 32768
  buffer_load_dwordx4 v21, s[64:67], s27 offen lds
  s_add_u32 m0, s28, 3072
  s_add_u32 s27, s27, 32768
  buffer_load_dwordx4 v21, s[64:67], s27 offen lds
  s_add_u32 m0, s28, 4096
  s_add_u32 s27, s27, 32768
  buffer_load_dwordx4 v20, s[64:67], s27 offen lds
  s_add_u32 m0, s28, 5120
  s_add_u32 s27, s27, 32768
  buffer_load_dwordx4 v20, s[64:67], s27 offen lds
  s_add_u32 m0, s28, 6144
  s_add_u32 s27, s27, 32768
  buffer_load_dwordx4 v21, s[64:67], s27 offen lds
  s_add_u32 m0, s28, 7168
  s_add_u32 s27, s27, 32768
  buffer_load_dwordx4 v21, s[64:67], s27 offen lds
  ds_read_b64_tr_b16 a[192:193], v23 offset:0
  ds_read_b64_tr_b16 a[194:195], v23 offset:1024
  ds_read_b64_tr_b16 a[196:197], v23 offset:4096
  ds_read_b64_tr_b16 a[198:199], v23 offset:5120
  ds_read_b64_tr_b16 a[200:201], v23 offset:8192
  ds_read_b64_tr_b16 a[202:203], v23 offset:9216
  ds_read_b64_tr_b16 a[204:205], v23 offset:12288
  ds_read_b64_tr_b16 a[206:207], v23 offset:13312
  ds_read_b64_tr_b16 a[208:209], v23 offset:16384
  ds_read_b64_tr_b16 a[210:211], v23 offset:17408
  ds_read_b64_tr_b16 a[212:213], v23 offset:20480
  ds_read_b64_tr_b16 a[214:215], v23 offset:21504
  ds_read_b64_tr_b16 a[216:217], v23 offset:24576
  ds_read_b64_tr_b16 a[218:219], v23 offset:25600
  ds_read_b64_tr_b16 a[220:221], v23 offset:28672
  ds_read_b64_tr_b16 a[222:223], v23 offset:29696
  s_waitcnt lgkmcnt(0)
  s_waitcnt vmcnt(16)
  s_barrier
  s_add_u32 s27, s26, 2097152
  s_add_u32 m0, s28, 32768
  s_nop 0
  buffer_load_dwordx4 v20, s[64:67], s27 offen lds
  s_add_u32 m0, s28, 33792
  s_add_u32 s27, s27, 32768
  buffer_load_dwordx4 v20, s[64:67], s27 offen lds
  s_add_u32 m0, s28, 34816
  s_add_u32 s27, s27, 32768
  buffer_load_dwordx4 v21, s[64:67], s27 offen lds
  s_add_u32 m0, s28, 35840
  s_add_u32 s27, s27, 32768
  buffer_load_dwordx4 v21, s[64:67], s27 offen lds
  s_add_u32 m0, s28, 36864
  s_add_u32 s27, s27, 32768
  buffer_load_dwordx4 v20, s[64:67], s27 offen lds
  s_add_u32 m0, s28, 37888
  s_add_u32 s27, s27, 32768
  buffer_load_dwordx4 v20, s[64:67], s27 offen lds
  s_add_u32 m0, s28, 38912
  s_add_u32 s27, s27, 32768
  buffer_load_dwordx4 v21, s[64:67], s27 offen lds
  s_add_u32 m0, s28, 39936
  s_add_u32 s27, s27, 32768
  buffer_load_dwordx4 v21, s[64:67], s27 offen lds
  ds_read_b64_tr_b16 a[224:225], v23 offset:32768
  ds_read_b64_tr_b16 a[226:227], v23 offset:33792
  ds_read_b64_tr_b16 a[228:229], v23 offset:36864
  ds_read_b64_tr_b16 a[230:231], v23 offset:37888
  ds_read_b64_tr_b16 a[232:233], v23 offset:40960
  ds_read_b64_tr_b16 a[234:235], v23 offset:41984
  ds_read_b64_tr_b16 a[236:237], v23 offset:45056
  ds_read_b64_tr_b16 a[238:239], v23 offset:46080
  ds_read_b64_tr_b16 a[240:241], v23 offset:49152
  ds_read_b64_tr_b16 a[242:243], v23 offset:50176
  ds_read_b64_tr_b16 a[244:245], v23 offset:53248
  ds_read_b64_tr_b16 a[246:247], v23 offset:54272
  ds_read_b64_tr_b16 a[248:249], v23 offset:57344
  ds_read_b64_tr_b16 a[250:251], v23 offset:58368
  ds_read_b64_tr_b16 a[252:253], v23 offset:61440
  ds_read_b64_tr_b16 a[254:255], v23 offset:62464
  s_waitcnt lgkmcnt(0)
  s_waitcnt vmcnt(16)
  s_barrier
  s_add_u32 s27, s26, 3145728
  s_add_u32 m0, s28, 65536
  s_nop 0
  buffer_load_dwordx4 v20, s[64:67], s27 offen lds
  s_add_u32 m0, s28, 66560
  s_add_u32 s27, s27, 32768
  buffer_load_dwordx4 v20, s[64:67], s27 offen lds
  s_add_u32 m0, s28, 67584
  s_add_u32 s27, s27, 32768
  buffer_load_dwordx4 v21, s[64:67], s27 offen lds
  s_add_u32 m0, s28, 68608
  s_add_u32 s27, s27, 32768
  buffer_load_dwordx4 v21, s[64:67], s27 offen lds
  s_add_u32 m0, s28, 69632
  s_add_u32 s27, s27, 32768
  buffer_load_dwordx4 v20, s[64:67], s27 offen lds
  s_add_u32 m0, s28, 70656
  s_add_u32 s27, s27, 32768
  buffer_load_dwordx4 v20, s[64:67], s27 offen lds
  s_add_u32 m0, s28, 71680
  s_add_u32 s27, s27, 32768
  buffer_load_dwordx4 v21, s[64:67], s27 offen lds
  s_add_u32 m0, s28, 72704
  s_add_u32 s27, s27, 32768
  buffer_load_dwordx4 v21, s[64:67], s27 offen lds
  ds_read_b64_tr_b16 v[128:129], v24 offset:0
  ds_read_b64_tr_b16 v[130:131], v24 offset:1024
  ds_read_b64_tr_b16 v[132:133], v24 offset:4096
  ds_read_b64_tr_b16 v[134:135], v24 offset:5120
  ds_read_b64_tr_b16 v[136:137], v24 offset:8192
  ds_read_b64_tr_b16 v[138:139], v24 offset:9216
  ds_read_b64_tr_b16 v[140:141], v24 offset:12288
  ds_read_b64_tr_b16 v[142:143], v24 offset:13312
  ds_read_b64_tr_b16 v[144:145], v24 offset:16384
  ds_read_b64_tr_b16 v[146:147], v24 offset:17408
  ds_read_b64_tr_b16 v[148:149], v24 offset:20480
  ds_read_b64_tr_b16 v[150:151], v24 offset:21504
  ds_read_b64_tr_b16 v[152:153], v24 offset:24576
  ds_read_b64_tr_b16 v[154:155], v24 offset:25600
  ds_read_b64_tr_b16 v[156:157], v24 offset:28672
  ds_read_b64_tr_b16 v[158:159], v24 offset:29696
  s_waitcnt lgkmcnt(0)
  s_waitcnt vmcnt(16)
  s_barrier
  s_add_u32 s27, s26, 0
  s_add_u32 m0, s28, 98304
  s_nop 0
  buffer_load_dwordx4 v20, s[68:71], s27 offen lds
  s_add_u32 m0, s28, 99328
  s_add_u32 s27, s27, 32768
  buffer_load_dwordx4 v20, s[68:71], s27 offen lds
  s_add_u32 m0, s28, 100352
  s_add_u32 s27, s27, 32768
  buffer_load_dwordx4 v21, s[68:71], s27 offen lds
  s_add_u32 m0, s28, 101376
  s_add_u32 s27, s27, 32768
  buffer_load_dwordx4 v21, s[68:71], s27 offen lds
  s_add_u32 m0, s28, 102400
  s_add_u32 s27, s27, 32768
  buffer_load_dwordx4 v20, s[68:71], s27 offen lds
  s_add_u32 m0, s28, 103424
  s_add_u32 s27, s27, 32768
  buffer_load_dwordx4 v20, s[68:71], s27 offen lds
  s_add_u32 m0, s28, 104448
  s_add_u32 s27, s27, 32768
  buffer_load_dwordx4 v21, s[68:71], s27 offen lds
  s_add_u32 m0, s28, 105472
  s_add_u32 s27, s27, 32768
  buffer_load_dwordx4 v21, s[68:71], s27 offen lds
  ds_read_b64_tr_b16 v[160:161], v22 offset:0
  ds_read_b64_tr_b16 v[162:163], v22 offset:1024
  ds_read_b64_tr_b16 v[164:165], v22 offset:4096
  ds_read_b64_tr_b16 v[166:167], v22 offset:5120
  ds_read_b64_tr_b16 v[168:169], v22 offset:8192
  ds_read_b64_tr_b16 v[170:171], v22 offset:9216
  ds_read_b64_tr_b16 v[172:173], v22 offset:12288
  ds_read_b64_tr_b16 v[174:175], v22 offset:13312
  ds_read_b64_tr_b16 v[176:177], v22 offset:16384
  ds_read_b64_tr_b16 v[178:179], v22 offset:17408
  ds_read_b64_tr_b16 v[180:181], v22 offset:20480
  ds_read_b64_tr_b16 v[182:183], v22 offset:21504
  ds_read_b64_tr_b16 v[184:185], v22 offset:24576
  ds_read_b64_tr_b16 v[186:187], v22 offset:25600
  ds_read_b64_tr_b16 v[188:189], v22 offset:28672
  ds_read_b64_tr_b16 v[190:191], v22 offset:29696
  s_waitcnt lgkmcnt(0)
  s_waitcnt vmcnt(16)
  s_barrier
  s_add_u32 s27, s26, 1048576
  s_add_u32 m0, s28, 131072
  s_nop 0
  buffer_load_dwordx4 v20, s[68:71], s27 offen lds
  s_add_u32 m0, s28, 132096
  s_add_u32 s27, s27, 32768
  buffer_load_dwordx4 v20, s[68:71], s27 offen lds
  s_add_u32 m0, s28, 133120
  s_add_u32 s27, s27, 32768
  buffer_load_dwordx4 v21, s[68:71], s27 offen lds
  s_add_u32 m0, s28, 134144
  s_add_u32 s27, s27, 32768
  buffer_load_dwordx4 v21, s[68:71], s27 offen lds
  s_add_u32 m0, s28, 135168
  s_add_u32 s27, s27, 32768
  buffer_load_dwordx4 v20, s[68:71], s27 offen lds
  s_add_u32 m0, s28, 136192
  s_add_u32 s27, s27, 32768
  buffer_load_dwordx4 v20, s[68:71], s27 offen lds
  s_add_u32 m0, s28, 137216
  s_add_u32 s27, s27, 32768
  buffer_load_dwordx4 v21, s[68:71], s27 offen lds
  s_add_u32 m0, s28, 138240
  s_add_u32 s27, s27, 32768
  buffer_load_dwordx4 v21, s[68:71], s27 offen lds
  ds_read_b64_tr_b16 v[192:193], v22 offset:32768
  ds_read_b64_tr_b16 v[194:195], v22 offset:33792
  ds_read_b64_tr_b16 v[196:197], v22 offset:36864
  ds_read_b64_tr_b16 v[198:199], v22 offset:37888
  ds_read_b64_tr_b16 v[200:201], v22 offset:40960
  ds_read_b64_tr_b16 v[202:203], v22 offset:41984
  ds_read_b64_tr_b16 v[204:205], v22 offset:45056
  ds_read_b64_tr_b16 v[206:207], v22 offset:46080
  ds_read_b64_tr_b16 v[208:209], v22 offset:49152
  ds_read_b64_tr_b16 v[210:211], v22 offset:50176
  ds_read_b64_tr_b16 v[212:213], v22 offset:53248
  ds_read_b64_tr_b16 v[214:215], v22 offset:54272
  ds_read_b64_tr_b16 v[216:217], v22 offset:57344
  ds_read_b64_tr_b16 v[218:219], v22 offset:58368
  ds_read_b64_tr_b16 v[220:221], v22 offset:61440
  ds_read_b64_tr_b16 v[222:223], v22 offset:62464
  s_waitcnt lgkmcnt(0)
  s_waitcnt vmcnt(16)
  s_barrier
  s_add_u32 s27, s26, 2097152
  s_add_u32 m0, s28, 0
  s_nop 0
  buffer_load_dwordx4 v20, s[68:71], s27 offen lds
  s_add_u32 m0, s28, 1024
  s_add_u32 s27, s27, 32768
  buffer_load_dwordx4 v20, s[68:71], s27 offen lds
  s_add_u32 m0, s28, 2048
  s_add_u32 s27, s27, 32768
  buffer_load_dwordx4 v21, s[68:71], s27 offen lds
  s_add_u32 m0, s28, 3072
  s_add_u32 s27, s27, 32768
  buffer_load_dwordx4 v21, s[68:71], s27 offen lds
  s_add_u32 m0, s28, 4096
  s_add_u32 s27, s27, 32768
  buffer_load_dwordx4 v20, s[68:71], s27 offen lds
  s_add_u32 m0, s28, 5120
  s_add_u32 s27, s27, 32768
  buffer_load_dwordx4 v20, s[68:71], s27 offen lds
  s_add_u32 m0, s28, 6144
  s_add_u32 s27, s27, 32768
  buffer_load_dwordx4 v21, s[68:71], s27 offen lds
  s_add_u32 m0, s28, 7168
  s_add_u32 s27, s27, 32768
  buffer_load_dwordx4 v21, s[68:71], s27 offen lds
  ds_read_b64_tr_b16 v[224:225], v23 offset:0
  ds_read_b64_tr_b16 v[226:227], v23 offset:1024
  ds_read_b64_tr_b16 v[228:229], v23 offset:4096
  ds_read_b64_tr_b16 v[230:231], v23 offset:5120
  ds_read_b64_tr_b16 v[232:233], v23 offset:8192
  ds_read_b64_tr_b16 v[234:235], v23 offset:9216
  ds_read_b64_tr_b16 v[236:237], v23 offset:12288
  ds_read_b64_tr_b16 v[238:239], v23 offset:13312
  ds_read_b64_tr_b16 v[240:241], v23 offset:16384
  ds_read_b64_tr_b16 v[242:243], v23 offset:17408
  ds_read_b64_tr_b16 v[244:245], v23 offset:20480
  ds_read_b64_tr_b16 v[246:247], v23 offset:21504
  ds_read_b64_tr_b16 v[248:249], v23 offset:24576
  ds_read_b64_tr_b16 v[250:251], v23 offset:25600
  ds_read_b64_tr_b16 v[252:253], v23 offset:28672
  ds_read_b64_tr_b16 v[254:255], v23 offset:29696
  s_waitcnt lgkmcnt(0)
  s_waitcnt vmcnt(16)
  s_barrier
  s_add_u32 s27, s26, 3145728
  s_add_u32 m0, s28, 32768
  s_nop 0
  buffer_load_dwordx4 v20, s[68:71], s27 offen lds
  s_add_u32 m0, s28, 33792
  s_add_u32 s27, s27, 32768
  buffer_load_dwordx4 v20, s[68:71], s27 offen lds
  s_add_u32 m0, s28, 34816
  s_add_u32 s27, s27, 32768
  buffer_load_dwordx4 v21, s[68:71], s27 offen lds
  s_add_u32 m0, s28, 35840
  s_add_u32 s27, s27, 32768
  buffer_load_dwordx4 v21, s[68:71], s27 offen lds
  s_add_u32 m0, s28, 36864
  s_add_u32 s27, s27, 32768
  buffer_load_dwordx4 v20, s[68:71], s27 offen lds
  s_add_u32 m0, s28, 37888
  s_add_u32 s27, s27, 32768
  buffer_load_dwordx4 v20, s[68:71], s27 offen lds
  s_add_u32 m0, s28, 38912
  s_add_u32 s27, s27, 32768
  buffer_load_dwordx4 v21, s[68:71], s27 offen lds
  s_add_u32 m0, s28, 39936
  s_add_u32 s27, s27, 32768
  buffer_load_dwordx4 v21, s[68:71], s27 offen lds
  ds_read_b64_tr_b16 a[0:1], v23 offset:32768
  ds_read_b64_tr_b16 a[2:3], v23 offset:33792
  ds_read_b64_tr_b16 a[4:5], v23 offset:36864
  ds_read_b64_tr_b16 a[6:7], v23 offset:37888
  ds_read_b64_tr_b16 a[8:9], v23 offset:40960
  ds_read_b64_tr_b16 a[10:11], v23 offset:41984
  ds_read_b64_tr_b16 a[12:13], v23 offset:45056
  ds_read_b64_tr_b16 a[14:15], v23 offset:46080
  ds_read_b64_tr_b16 a[16:17], v23 offset:49152
  ds_read_b64_tr_b16 a[18:19], v23 offset:50176
  ds_read_b64_tr_b16 a[20:21], v23 offset:53248
  ds_read_b64_tr_b16 a[22:23], v23 offset:54272
  ds_read_b64_tr_b16 a[24:25], v23 offset:57344
  ds_read_b64_tr_b16 a[26:27], v23 offset:58368
  ds_read_b64_tr_b16 a[28:29], v23 offset:61440
  ds_read_b64_tr_b16 a[30:31], v23 offset:62464
  s_waitcnt lgkmcnt(0)
  s_waitcnt vmcnt(16)
  s_barrier
  ds_read_b64_tr_b16 a[32:33], v24 offset:0
  ds_read_b64_tr_b16 a[34:35], v24 offset:1024
  ds_read_b64_tr_b16 a[36:37], v24 offset:4096
  ds_read_b64_tr_b16 a[38:39], v24 offset:5120
  ds_read_b64_tr_b16 a[40:41], v24 offset:8192
  ds_read_b64_tr_b16 a[42:43], v24 offset:9216
  ds_read_b64_tr_b16 a[44:45], v24 offset:12288
  ds_read_b64_tr_b16 a[46:47], v24 offset:13312
  ds_read_b64_tr_b16 a[48:49], v24 offset:16384
  ds_read_b64_tr_b16 a[50:51], v24 offset:17408
  ds_read_b64_tr_b16 a[52:53], v24 offset:20480
  ds_read_b64_tr_b16 a[54:55], v24 offset:21504
  ds_read_b64_tr_b16 a[56:57], v24 offset:24576
  ds_read_b64_tr_b16 a[58:59], v24 offset:25600
  ds_read_b64_tr_b16 a[60:61], v24 offset:28672
  ds_read_b64_tr_b16 a[62:63], v24 offset:29696
  s_waitcnt lgkmcnt(0)
  s_waitcnt vmcnt(8)
  s_barrier
  ds_read_b64_tr_b16 a[64:65], v22 offset:0
  ds_read_b64_tr_b16 a[66:67], v22 offset:1024
  ds_read_b64_tr_b16 a[68:69], v22 offset:4096
  ds_read_b64_tr_b16 a[70:71], v22 offset:5120
  ds_read_b64_tr_b16 a[72:73], v22 offset:8192
  ds_read_b64_tr_b16 a[74:75], v22 offset:9216
  ds_read_b64_tr_b16 a[76:77], v22 offset:12288
  ds_read_b64_tr_b16 a[78:79], v22 offset:13312
  ds_read_b64_tr_b16 a[80:81], v22 offset:16384
  ds_read_b64_tr_b16 a[82:83], v22 offset:17408
  ds_read_b64_tr_b16 a[84:85], v22 offset:20480
  ds_read_b64_tr_b16 a[86:87], v22 offset:21504
  ds_read_b64_tr_b16 a[88:89], v22 offset:24576
  ds_read_b64_tr_b16 a[90:91], v22 offset:25600
  ds_read_b64_tr_b16 a[92:93], v22 offset:28672
  ds_read_b64_tr_b16 a[94:95], v22 offset:29696
  s_waitcnt lgkmcnt(0)
  s_waitcnt vmcnt(0)
  s_barrier
  ds_read_b64_tr_b16 a[96:97], v22 offset:32768
  ds_read_b64_tr_b16 a[98:99], v22 offset:33792
  ds_read_b64_tr_b16 a[100:101], v22 offset:36864
  ds_read_b64_tr_b16 a[102:103], v22 offset:37888
  ds_read_b64_tr_b16 a[104:105], v22 offset:40960
  ds_read_b64_tr_b16 a[106:107], v22 offset:41984
  ds_read_b64_tr_b16 a[108:109], v22 offset:45056
  ds_read_b64_tr_b16 a[110:111], v22 offset:46080
  ds_read_b64_tr_b16 a[112:113], v22 offset:49152
  ds_read_b64_tr_b16 a[114:115], v22 offset:50176
  ds_read_b64_tr_b16 a[116:117], v22 offset:53248
  ds_read_b64_tr_b16 a[118:119], v22 offset:54272
  ds_read_b64_tr_b16 a[120:121], v22 offset:57344
  ds_read_b64_tr_b16 a[122:123], v22 offset:58368
  ds_read_b64_tr_b16 a[124:125], v22 offset:61440
  ds_read_b64_tr_b16 a[126:127], v22 offset:62464
  s_waitcnt lgkmcnt(0)
q_ld_55:
  s_waitcnt lgkmcnt(0)
  s_barrier
  v_mbcnt_lo_u32_b32 v20, -1, 0
  v_and_b32 v20, 0, v20
  v_add_lshl_u32 v20, v20, 1, 2
  s_mov_b32 s26, 0
g_wt_56:
  global_load_dword v21, v20, s[12:13] offset:128 sc1
  s_add_u32 s26, s26, 1
  s_cmp_gt_u32 s26, 1048576
  s_cbranch_scc1 L_end
  s_waitcnt vmcnt(0)
  v_cmp_eq_u32 vcc, 0, v21
  v_readfirstlane_b32 s27, v21
  s_cbranch_vccnz g_wt_56
  v_lshrrev_b32 v7, 7, v0
  v_lshlrev_b32 v7, 12, v7
  v_and_b32 v2, 1023, v9
  s_lshl_b32 s26, s17, 10
  v_add3_u32 v7, v7, v2, s26
  v_mov_b32 v116, 0
  s_mov_b32 s47, s60
  s_add_u32 s40, s60, 3
  s_add_u32 s41, s60, 64
  s_mov_b32 s42, 5
  s_mov_b32 s48, 0
  s_mov_b32 s49, 268435456
  s_mov_b32 s43, 268435456
  s_mov_b32 s50, 32768
  s_mov_b32 s56, 0
  s_mov_b32 s61, 0
  s_mov_b32 s62, 0
  s_lshl_b32 s54, s17, 13
  s_mov_b32 s50, 0
  v_mov_b32 v4, 1
  s_cmp_lt_u32 s40, 64
  s_cselect_b32 s42, s42, 0
  s_cmp_lg_u32 s42, 0
  s_cselect_b32 s76, s40, s41
  s_cselect_b32 s26, 3, 0
  s_cselect_b32 s42, s42, 2
  s_sub_u32 s42, s42, 1
  s_add_u32 s40, s40, s26
  s_xor_b32 s26, s26, 3
  s_add_u32 s41, s41, s26
q_slow_57:
  s_nop 6
  v_cvt_pk_bf16_f32 v100, v52, v53
  v_cvt_pk_bf16_f32 v101, v54, v55
  v_cvt_pk_bf16_f32 v102, v60, v61
  v_cvt_pk_bf16_f32 v103, v62, v63
  buffer_store_dwordx4 v[100:103], v8, s[4:7], s43 offen offset:0 sc1
  v_cvt_pk_bf16_f32 v104, v56, v57
  v_cvt_pk_bf16_f32 v105, v58, v59
  v_cvt_pk_bf16_f32 v106, v64, v65
  v_cvt_pk_bf16_f32 v107, v66, v67
  buffer_store_dwordx4 v[104:107], v8, s[4:7], s43 offen offset:512 sc1
  s_mov_b32 s43, 268435456
  s_xor_b32 s50, s50, 32768
  s_cmp_lg_u32 s62, 0
  s_cbranch_scc1 q_patch_62
  s_cmp_ge_u32 s47, 128
  s_cbranch_scc1 q_end_58
  s_cmp_lg_u32 s48, 0
  s_cbranch_scc1 q_have_59
  s_mov_b32 s53, 0
q_poll_60:
  s_cmp_lt_u32 s47, 64
  s_cselect_b32 s26, 2, 0
  s_add_u32 s26, s26, s47
  s_lshl_b32 s26, s26, 12
  s_add_u32 s26, s26, 243261440
  s_mov_b64 exec, 0xffffff
  buffer_load_dword v116, v7, s[4:7], s26 offen sc1
  s_mov_b64 exec, -1
  s_add_u32 s53, s53, 1
  s_cmp_gt_u32 s53, 1048576
  s_cbranch_scc1 q_fail_61
  s_waitcnt vmcnt(0)
  s_mov_b64 exec, 1
  buffer_store_dword v4, off, s[4:7], s49 sc1
  s_mov_b64 exec, -1
  s_mov_b32 s49, 268435456
  v_cmp_eq_u32 vcc, 0, v116
  s_nop 0
  s_and_b32 s26, vcc_lo, 0xffffff
  s_cbranch_scc1 q_poll_60
  s_and_b32 s63, s47, 127
  s_lshl_b32 s63, s63, 15
  s_xor_b32 s27, s50, 32768
  s_add_u32 m0, s27, s54
  s_add_u32 s63, s63, s54
  s_add_u32 s63, s63, 6291456
  buffer_load_dwordx4 v12, s[4:7], s63 offen offset:0 sc1 lds
  buffer_load_dwordx4 v13, s[4:7], s63 offen offset:1024 sc1 lds
  buffer_load_dwordx4 v14, s[4:7], s63 offen offset:2048 sc1 lds
  buffer_load_dwordx4 v15, s[4:7], s63 offen offset:3072 sc1 lds
  s_add_u32 m0, m0, 4096
  s_add_u32 s63, s63, 4096
  buffer_load_dwordx4 v16, s[4:7], s63 offen offset:0 sc1 lds
  buffer_load_dwordx4 v17, s[4:7], s63 offen offset:1024 sc1 lds
  buffer_load_dwordx4 v18, s[4:7], s63 offen offset:2048 sc1 lds
  buffer_load_dwordx4 v19, s[4:7], s63 offen offset:3072 sc1 lds
  v_cmp_eq_u32 vcc, 0, v116
  v_max_u32_dpp v117, v116, v116 row_ror:8 row_mask:0xf bank_mask:0xf
  s_nop 0
  s_nop 0
  v_max_u32_dpp v117, v117, v117 row_ror:4 row_mask:0xf bank_mask:0xf
  s_nop 0
  s_nop 0
  v_max_u32_dpp v117, v117, v117 row_ror:2 row_mask:0xf bank_mask:0xf
  s_nop 0
  s_nop 0
  v_max_u32_dpp v117, v117, v117 row_ror:1 row_mask:0xf bank_mask:0xf
  s_nop 0
  v_readlane_b32 s48, v117, 0
  v_readlane_b32 s28, v117, 16
  s_max_u32 s48, s48, s28
  s_and_b32 s28, vcc_lo, 0xffffff
  s_cselect_b32 s48, 0, s48
q_have_59:
  v_mov_b32 v2, s48
  ds_write_b32 v118, v2 offset:32
  s_xor_b32 s50, s50, 32768
  s_waitcnt lgkmcnt(0)
  s_barrier
  ds_read_b128 v[108:111], v119 offset:32
  s_waitcnt lgkmcnt(0)
  v_min3_u32 v112, v108, v109, v110
  v_max3_u32 v108, v108, v109, v110
  v_min_u32 v112, v112, v111
  v_max_u32 v108, v108, v111
  v_readfirstlane_b32 s45, v112
  v_readfirstlane_b32 s28, v108
  s_max_u32 s56, s56, s28
  s_bfe_u32 s28, s56, 0x70005
  s_xor_b32 s28, s28, 63
  s_cmp_eq_u32 s28, s47
  s_cbranch_scc1 q_fork_64
  s_waitcnt vmcnt(0)
  s_sub_u32 s26, s47, s60
  s_cmp_lg_u32 s26, 9
  s_cbranch_scc1 q_cold_65
  v_mbcnt_lo_u32_b32 v20, -1, 0
  v_and_b32 v20, 0, v20
  v_add_lshl_u32 v20, v20, 2, 2
  s_mov_b32 s26, 0
g_wt_70:
  global_load_dword v21, v20, s[12:13] offset:128 sc1
  s_add_u32 s26, s26, 1
  s_cmp_gt_u32 s26, 1048576
  s_cbranch_scc1 L_end
  s_waitcnt vmcnt(0)
  v_cmp_eq_u32 vcc, 0, v21
  v_readfirstlane_b32 s27, v21
  s_cbranch_vccnz g_wt_70
  s_load_dwordx2 s[64:65], s[0:1], 72
  s_load_dwordx2 s[68:69], s[0:1], 80
  s_load_dwordx2 s[8:9], s[0:1], 88
  s_mov_b32 s66, 1835008
  s_mov_b32 s70, 1835008
  s_mov_b32 s10, 1835008
  v_lshrrev_b32 v2, 8, v0
  v_and_b32 v3, 0x70, v0
  s_mov_b32 s26, 114688
  v_mul_lo_u32 v6, v2, s26
  v_add_u32 v6, v6, v3
  v_cmp_eq_u32 vcc, 0x70, v3
  v_mov_b32 v3, 0x7ff00000
  s_nop 0
  v_cndmask_b32 v6, v6, v3, vcc
  v_mul_u32_u24 v7, 14336, v2
  v_and_b32 v3, 0xf0, v0
  v_add_u32 v7, v7, v3
  s_mul_i32 s34, s17, 458752
  s_mul_i32 s27, s16, 112
  s_add_u32 s34, s34, s27
  s_add_u32 s34, s34, 0
  s_mul_i32 s35, s16, 57344
  s_lshl_b32 s27, s17, 8
  s_add_u32 s35, s35, s27
  s_mov_b32 s36, 0x00ff00ff
  s_mov_b32 s37, 0x00ff00ff
  s_waitcnt lgkmcnt(0)
  s_mul_i32 s26, s17, 23552
  s_add_u32 m0, s26, 65536
  s_mov_b64 exec, s[36:37]
  buffer_load_dwordx4 v6, s[64:67], s34 offen lds
  s_not_b64 exec, exec
  buffer_load_dwordx4 v6, s[68:71], s34 offen lds
  s_add_u32 s34, s34, 3584
  s_add_u32 m0, m0, 1024
  s_mov_b64 exec, s[36:37]
  buffer_load_dwordx4 v6, s[64:67], s34 offen lds
  s_not_b64 exec, exec
  buffer_load_dwordx4 v6, s[68:71], s34 offen lds
  s_add_u32 s34, s34, 3584
  s_add_u32 m0, m0, 1024
  s_mov_b64 exec, s[36:37]
  buffer_load_dwordx4 v6, s[64:67], s34 offen lds
  s_not_b64 exec, exec
  buffer_load_dwordx4 v6, s[68:71], s34 offen lds
  s_add_u32 s34, s34, 3584
  s_add_u32 m0, m0, 1024
  s_mov_b64 exec, s[36:37]
  buffer_load_dwordx4 v6, s[64:67], s34 offen lds
  s_not_b64 exec, exec
  buffer_load_dwordx4 v6, s[68:71], s34 offen lds
  s_add_u32 s34, s34, 3584
  s_add_u32 m0, m0, 1024
  s_mov_b64 exec, s[36:37]
  buffer_load_dwordx4 v6, s[64:67], s34 offen lds
  s_not_b64 exec, exec
  buffer_load_dwordx4 v6, s[68:71], s34 offen lds
  s_add_u32 s34, s34, 3584
  s_add_u32 m0, m0, 1024
  s_mov_b64 exec, s[36:37]
  buffer_load_dwordx4 v6, s[64:67], s34 offen lds
  s_not_b64 exec, exec
  buffer_load_dwordx4 v6, s[68:71], s34 offen lds
  s_add_u32 s34, s34, 3584
  s_add_u32 m0, m0, 1024
  s_mov_b64 exec, s[36:37]
  buffer_load_dwordx4 v6, s[64:67], s34 offen lds
  s_not_b64 exec, exec
  buffer_load_dwordx4 v6, s[68:71], s34 offen lds
  s_add_u32 s34, s34, 3584
  s_add_u32 m0, m0, 1024
  s_mov_b64 exec, s[36:37]
  buffer_load_dwordx4 v6, s[64:67], s34 offen lds
  s_not_b64 exec, exec
  buffer_load_dwordx4 v6, s[68:71], s34 offen lds
  s_add_u32 s34, s34, 3584
  s_add_u32 m0, m0, 1024
  s_mov_b64 exec, s[36:37]
  buffer_load_dwordx4 v6, s[64:67], s34 offen lds
  s_not_b64 exec, exec
  buffer_load_dwordx4 v6, s[68:71], s34 offen lds
  s_add_u32 s34, s34, 3584
  s_add_u32 m0, m0, 1024
  s_mov_b64 exec, s[36:37]
  buffer_load_dwordx4 v6, s[64:67], s34 offen lds
  s_not_b64 exec, exec
  buffer_load_dwordx4 v6, s[68:71], s34 offen lds
  s_add_u32 s34, s34, 3584
  s_add_u32 m0, m0, 1024
  s_mov_b64 exec, s[36:37]
  buffer_load_dwordx4 v6, s[64:67], s34 offen lds
  s_not_b64 exec, exec
  buffer_load_dwordx4 v6, s[68:71], s34 offen lds
  s_add_u32 s34, s34, 3584
  s_add_u32 m0, m0, 1024
  s_mov_b64 exec, s[36:37]
  buffer_load_dwordx4 v6, s[64:67], s34 offen lds
  s_not_b64 exec, exec
  buffer_load_dwordx4 v6, s[68:71], s34 offen lds
  s_add_u32 s34, s34, 3584
  s_add_u32 m0, m0, 1024
  s_mov_b64 exec, s[36:37]
  buffer_load_dwordx4 v6, s[64:67], s34 offen lds
  s_not_b64 exec, exec
  buffer_load_dwordx4 v6, s[68:71], s34 offen lds
  s_add_u32 s34, s34, 3584
  s_add_u32 m0, m0, 1024
  s_mov_b64 exec, s[36:37]
  buffer_load_dwordx4 v6, s[64:67], s34 offen lds
  s_not_b64 exec, exec
  buffer_load_dwordx4 v6, s[68:71], s34 offen lds
  s_add_u32 s34, s34, 3584
  s_add_u32 m0, m0, 1024
  s_mov_b64 exec, s[36:37]
  buffer_load_dwordx4 v6, s[64:67], s34 offen lds
  s_not_b64 exec, exec
  buffer_load_dwordx4 v6, s[68:71], s34 offen lds
  s_add_u32 s34, s34, 3584
  s_add_u32 m0, m0, 1024
  s_mov_b64 exec, s[36:37]
  buffer_load_dwordx4 v6, s[64:67], s34 offen lds
  s_not_b64 exec, exec
  buffer_load_dwordx4 v6, s[68:71], s34 offen lds
  s_add_u32 s34, s34, 3584
  s_add_u32 m0, m0, 1024
  s_mov_b64 exec, s[36:37]
  buffer_load_dwordx4 v6, s[64:67], s34 offen lds
  s_not_b64 exec, exec
  buffer_load_dwordx4 v6, s[68:71], s34 offen lds
  s_add_u32 s34, s34, 3584
  s_add_u32 m0, m0, 1024
  s_mov_b64 exec, s[36:37]
  buffer_load_dwordx4 v6, s[64:67], s34 offen lds
  s_not_b64 exec, exec
  buffer_load_dwordx4 v6, s[68:71], s34 offen lds
  s_add_u32 s34, s34, 3584
  s_add_u32 m0, m0, 1024
  s_mov_b64 exec, s[36:37]
  buffer_load_dwordx4 v6, s[64:67], s34 offen lds
  s_not_b64 exec, exec
  buffer_load_dwordx4 v6, s[68:71], s34 offen lds
  s_add_u32 s34, s34, 3584
  s_add_u32 m0, m0, 1024
  s_mov_b64 exec, s[36:37]
  buffer_load_dwordx4 v6, s[64:67], s34 offen lds
  s_not_b64 exec, exec
  buffer_load_dwordx4 v6, s[68:71], s34 offen lds
  s_add_u32 s34, s34, 3584
  s_add_u32 m0, m0, 1024
  s_mov_b64 exec, s[36:37]
  buffer_load_dwordx4 v6, s[64:67], s34 offen lds
  s_not_b64 exec, exec
  buffer_load_dwordx4 v6, s[68:71], s34 offen lds
  s_add_u32 s34, s34, 3584
  s_add_u32 m0, m0, 1024
  s_mov_b64 exec, s[36:37]
  buffer_load_dwordx4 v6, s[64:67], s34 offen lds
  s_not_b64 exec, exec
  buffer_load_dwordx4 v6, s[68:71], s34 offen lds
  s_add_u32 s34, s34, 3584
  s_add_u32 m0, m0, 1024
  s_mov_b64 exec, s[36:37]
  buffer_load_dwordx4 v6, s[64:67], s34 offen lds
  s_not_b64 exec, exec
  buffer_load_dwordx4 v6, s[68:71], s34 offen lds
  s_add_u32 s34, s34, 3584
  s_add_u32 m0, m0, 1024
  s_mov_b64 exec, -1
  v_lshrrev_b32 v7, 7, v0
  v_lshlrev_b32 v7, 12, v7
  v_and_b32 v2, 1023, v9
  s_lshl_b32 s26, s17, 10
  v_add3_u32 v7, v7, v2, s26
  v_mov_b32 v116, 0
q_cold_65:
  s_waitcnt lgkmcnt(0)
  s_barrier
  s_cmp_lg_u32 s50, 0
  s_cbranch_scc1 q_c1_67
q_c0_66:
  ds_read_b128 v[68:71], v120 offset:0
  ds_read_b128 v[72:75], v121 offset:0
  ds_read_b128 v[76:79], v122 offset:0
q_w0_68:
  s_waitcnt lgkmcnt(2)
  v_mfma_f32_32x32x16_bf16 v[20:35], v[128:131], v[68:71], 0
  ds_read_b128 v[80:83], v123 offset:0
  s_mov_b32 s46, s47
  s_mov_b32 s47, s76
  s_lshl_b32 s52, s46, 7
  s_add_u32 s52, s52, s57
  s_lshl_b32 s44, s52, 12
  v_mfma_f32_32x32x16_bf16 v[36:51], v[68:71], a[0:3], 0
  s_add_u32 s44, s44, 41943040
  v_cvt_pk_bf16_f32 v100, v52, v53
  v_cvt_pk_bf16_f32 v101, v54, v55
  v_cvt_pk_bf16_f32 v102, v60, v61
  v_cvt_pk_bf16_f32 v103, v62, v63
  s_waitcnt lgkmcnt(2)
  v_mfma_f32_32x32x16_bf16 v[20:35], v[132:135], v[72:75], v[20:35]
  ds_read_b128 v[84:87], v124 offset:0
  buffer_store_dwordx4 v[100:103], v8, s[4:7], s43 offen offset:0 sc1
  v_cvt_pk_bf16_f32 v104, v56, v57
  v_cvt_pk_bf16_f32 v105, v58, v59
  v_mfma_f32_32x32x16_bf16 v[36:51], v[72:75], a[4:7], v[36:51]
  v_cvt_pk_bf16_f32 v106, v64, v65
  v_cvt_pk_bf16_f32 v107, v66, v67
  s_waitcnt lgkmcnt(2)
  v_mfma_f32_32x32x16_bf16 v[20:35], v[136:139], v[76:79], v[20:35]
  ds_read_b128 v[88:91], v125 offset:0
  buffer_store_dwordx4 v[104:107], v8, s[4:7], s43 offen offset:512 sc1
  s_lshl_b32 s43, s52, 11
  s_add_u32 s43, s43, 142606336
  v_mfma_f32_32x32x16_bf16 v[36:51], v[76:79], a[8:11], v[36:51]
  s_lshl_b32 s51, s52, 5
  s_add_u32 s51, s51, 244318208
  s_lshr_b32 s55, s47, 7
  s_or_b32 s55, s55, s62
  s_sub_u32 s27, s47, s60
  s_cmp_eq_u32 s27, 9
  s_cselect_b32 s55, 1, s55
  s_waitcnt lgkmcnt(2)
  v_mfma_f32_32x32x16_bf16 v[20:35], v[140:143], v[80:83], v[20:35]
  ds_read_b128 v[92:95], v126 offset:0
  s_cmp_lt_u32 s40, 64
  s_cselect_b32 s42, s42, 0
  s_cmp_lg_u32 s42, 0
  s_cselect_b32 s76, s40, s41
  s_cselect_b32 s26, 3, 0
  s_cselect_b32 s42, s42, 2
  v_mfma_f32_32x32x16_bf16 v[36:51], v[80:83], a[12:15], v[36:51]
  s_sub_u32 s42, s42, 1
  s_add_u32 s40, s40, s26
  s_xor_b32 s26, s26, 3
  s_add_u32 s41, s41, s26
  s_waitcnt lgkmcnt(2)
  v_mfma_f32_32x32x16_bf16 v[20:35], v[144:147], v[84:87], v[20:35]
  ds_read_b128 v[96:99], v127 offset:0
  v_mfma_f32_32x32x16_bf16 v[36:51], v[84:87], a[16:19], v[36:51]
  s_waitcnt lgkmcnt(2)
  v_mfma_f32_32x32x16_bf16 v[20:35], v[148:151], v[88:91], v[20:35]
  ds_read_b128 v[68:71], v120 offset:256
  v_mfma_f32_32x32x16_bf16 v[36:51], v[88:91], a[20:23], v[36:51]
  s_waitcnt lgkmcnt(2)
  v_mfma_f32_32x32x16_bf16 v[20:35], v[152:155], v[92:95], v[20:35]
  ds_read_b128 v[72:75], v121 offset:256
  s_cmp_lt_u32 s47, 64
  s_cselect_b32 s26, 2, 0
  s_add_u32 s26, s26, s47
  s_lshl_b32 s26, s26, 12
  s_add_u32 s26, s26, 243261440
  v_mfma_f32_32x32x16_bf16 v[36:51], v[92:95], a[24:27], v[36:51]
  s_mov_b64 exec, 0xffffff
  buffer_load_dword v116, v7, s[4:7], s26 offen sc1
  s_mov_b64 exec, -1
  s_waitcnt lgkmcnt(2)
  v_mfma_f32_32x32x16_bf16 v[20:35], v[156:159], v[96:99], v[20:35]
  ds_read_b128 v[76:79], v122 offset:256
  v_mfma_f32_32x32x16_bf16 v[36:51], v[96:99], a[28:31], v[36:51]
  s_waitcnt lgkmcnt(2)
  v_mfma_f32_32x32x16_bf16 v[20:35], v[160:163], v[68:71], v[20:35]
  ds_read_b128 v[80:83], v123 offset:256
  v_mfma_f32_32x32x16_bf16 v[36:51], v[68:71], a[32:35], v[36:51]
  s_waitcnt lgkmcnt(2)
  v_mfma_f32_32x32x16_bf16 v[20:35], v[164:167], v[72:75], v[20:35]
  ds_read_b128 v[84:87], v124 offset:256
  v_mfma_f32_32x32x16_bf16 v[36:51], v[72:75], a[36:39], v[36:51]
  s_waitcnt lgkmcnt(2)
  v_mfma_f32_32x32x16_bf16 v[20:35], v[168:171], v[76:79], v[20:35]
  ds_read_b128 v[88:91], v125 offset:256
  v_mfma_f32_32x32x16_bf16 v[36:51], v[76:79], a[40:43], v[36:51]
  s_waitcnt lgkmcnt(2)
  v_mfma_f32_32x32x16_bf16 v[20:35], v[172:175], v[80:83], v[20:35]
  ds_read_b128 v[92:95], v126 offset:256
  v_mfma_f32_32x32x16_bf16 v[36:51], v[80:83], a[44:47], v[36:51]
  s_waitcnt lgkmcnt(2)
  v_mfma_f32_32x32x16_bf16 v[20:35], v[176:179], v[84:87], v[20:35]
  ds_read_b128 v[96:99], v127 offset:256
  v_mfma_f32_32x32x16_bf16 v[36:51], v[84:87], a[48:51], v[36:51]
  s_waitcnt lgkmcnt(2)
  v_mfma_f32_32x32x16_bf16 v[20:35], v[180:183], v[88:91], v[20:35]
  ds_read_b128 v[68:71], v120 offset:512
  v_mfma_f32_32x32x16_bf16 v[36:51], v[88:91], a[52:55], v[36:51]
  s_waitcnt lgkmcnt(2)
  v_mfma_f32_32x32x16_bf16 v[20:35], v[184:187], v[92:95], v[20:35]
  ds_read_b128 v[72:75], v121 offset:512
  v_mfma_f32_32x32x16_bf16 v[36:51], v[92:95], a[56:59], v[36:51]
  s_waitcnt lgkmcnt(2)
  v_mfma_f32_32x32x16_bf16 v[20:35], v[188:191], v[96:99], v[20:35]
  ds_read_b128 v[76:79], v122 offset:512
  v_mfma_f32_32x32x16_bf16 v[36:51], v[96:99], a[60:63], v[36:51]
  s_waitcnt lgkmcnt(2)
  v_mfma_f32_32x32x16_bf16 v[20:35], v[192:195], v[68:71], v[20:35]
  ds_read_b128 v[80:83], v123 offset:512
  v_mfma_f32_32x32x16_bf16 v[36:51], v[68:71], a[64:67], v[36:51]
  s_waitcnt lgkmcnt(2)
  v_mfma_f32_32x32x16_bf16 v[20:35], v[196:199], v[72:75], v[20:35]
  ds_read_b128 v[84:87], v124 offset:512
  v_mfma_f32_32x32x16_bf16 v[36:51], v[72:75], a[68:71], v[36:51]
  s_waitcnt lgkmcnt(2)
  v_mfma_f32_32x32x16_bf16 v[20:35], v[200:203], v[76:79], v[20:35]
  ds_read_b128 v[88:91], v125 offset:512
  v_mfma_f32_32x32x16_bf16 v[36:51], v[76:79], a[72:75], v[36:51]
  s_waitcnt lgkmcnt(2)
  v_mfma_f32_32x32x16_bf16 v[20:35], v[204:207], v[80:83], v[20:35]
  ds_read_b128 v[92:95], v126 offset:512
  s_waitcnt vmcnt(0)
  s_mov_b64 exec, 1
  buffer_store_dword v4, off, s[4:7], s49 sc1
  s_mov_b64 exec, -1
  v_mfma_f32_32x32x16_bf16 v[36:51], v[80:83], a[76:79], v[36:51]
  v_cmp_eq_u32 vcc, 0, v116
  v_max_u32_dpp v117, v116, v116 row_ror:8 row_mask:0xf bank_mask:0xf
  s_nop 0
  s_nop 0
  v_max_u32_dpp v117, v117, v117 row_ror:4 row_mask:0xf bank_mask:0xf
  s_nop 0
  s_waitcnt lgkmcnt(2)
  v_mfma_f32_32x32x16_bf16 v[20:35], v[208:211], v[84:87], v[20:35]
  ds_read_b128 v[96:99], v127 offset:512
  s_nop 0
  v_max_u32_dpp v117, v117, v117 row_ror:2 row_mask:0xf bank_mask:0xf
  s_nop 0
  s_nop 0
  v_max_u32_dpp v117, v117, v117 row_ror:1 row_mask:0xf bank_mask:0xf
  v_mfma_f32_32x32x16_bf16 v[36:51], v[84:87], a[80:83], v[36:51]
  s_nop 0
  v_readlane_b32 s48, v117, 0
  v_readlane_b32 s28, v117, 16
  s_max_u32 s48, s48, s28
  s_and_b32 s28, vcc_lo, 0xffffff
  s_cselect_b32 s48, 0, s48
  s_waitcnt lgkmcnt(2)
  v_mfma_f32_32x32x16_bf16 v[20:35], v[212:215], v[88:91], v[20:35]
  ds_read_b128 v[68:71], v120 offset:768
  s_cmp_lg_u32 s48, 0
  s_cselect_b32 s28, s47, s46
  s_and_b32 s63, s28, 127
  s_lshl_b32 s63, s63, 15
  s_xor_b32 s27, s50, 32768
  v_mfma_f32_32x32x16_bf16 v[36:51], v[88:91], a[84:87], v[36:51]
  s_add_u32 m0, s27, s54
  s_add_u32 s63, s63, s54
  s_add_u32 s63, s63, 6291456
  s_waitcnt lgkmcnt(2)
  v_mfma_f32_32x32x16_bf16 v[20:35], v[216:219], v[92:95], v[20:35]
  ds_read_b128 v[72:75], v121 offset:768
  buffer_load_dwordx4 v12, s[4:7], s63 offen offset:0 sc1 lds
  v_mfma_f32_32x32x16_bf16 v[36:51], v[92:95], a[88:91], v[36:51]
  s_waitcnt lgkmcnt(2)
  v_mfma_f32_32x32x16_bf16 v[20:35], v[220:223], v[96:99], v[20:35]
  ds_read_b128 v[76:79], v122 offset:768
  buffer_load_dwordx4 v13, s[4:7], s63 offen offset:1024 sc1 lds
  v_mfma_f32_32x32x16_bf16 v[36:51], v[96:99], a[92:95], v[36:51]
  s_waitcnt lgkmcnt(2)
  v_mfma_f32_32x32x16_bf16 v[20:35], v[224:227], v[68:71], v[20:35]
  ds_read_b128 v[80:83], v123 offset:768
  buffer_load_dwordx4 v14, s[4:7], s63 offen offset:2048 sc1 lds
  v_mfma_f32_32x32x16_bf16 v[36:51], v[68:71], a[96:99], v[36:51]
  s_waitcnt lgkmcnt(2)
  v_mfma_f32_32x32x16_bf16 v[20:35], v[228:231], v[72:75], v[20:35]
  ds_read_b128 v[84:87], v124 offset:768
  buffer_load_dwordx4 v15, s[4:7], s63 offen offset:3072 sc1 lds
  s_add_u32 m0, m0, 4096
  s_add_u32 s63, s63, 4096
  v_mfma_f32_32x32x16_bf16 v[36:51], v[72:75], a[100:103], v[36:51]
  s_waitcnt lgkmcnt(2)
  v_mfma_f32_32x32x16_bf16 v[20:35], v[232:235], v[76:79], v[20:35]
  ds_read_b128 v[88:91], v125 offset:768
  buffer_load_dwordx4 v16, s[4:7], s63 offen offset:0 sc1 lds
  v_mfma_f32_32x32x16_bf16 v[36:51], v[76:79], a[104:107], v[36:51]
  s_waitcnt lgkmcnt(2)
  v_mfma_f32_32x32x16_bf16 v[20:35], v[236:239], v[80:83], v[20:35]
  ds_read_b128 v[92:95], v126 offset:768
  buffer_load_dwordx4 v17, s[4:7], s63 offen offset:1024 sc1 lds
  v_mfma_f32_32x32x16_bf16 v[36:51], v[80:83], a[108:111], v[36:51]
  s_waitcnt lgkmcnt(2)
  v_mfma_f32_32x32x16_bf16 v[20:35], v[240:243], v[84:87], v[20:35]
  ds_read_b128 v[96:99], v127 offset:768
  buffer_load_dwordx4 v18, s[4:7], s63 offen offset:2048 sc1 lds
  v_mfma_f32_32x32x16_bf16 v[36:51], v[84:87], a[112:115], v[36:51]
  s_waitcnt lgkmcnt(2)
  v_mfma_f32_32x32x16_bf16 v[20:35], v[244:247], v[88:91], v[20:35]
  ds_read_b128 v[68:71], v120 offset:0
  buffer_load_dwordx4 v19, s[4:7], s63 offen offset:3072 sc1 lds
  s_add_u32 s49, s51, 16
  s_add_u32 s26, s62, 1
  v_mfma_f32_32x32x16_bf16 v[36:51], v[88:91], a[116:119], v[36:51]
  ds_read_b128 v[72:75], v121 offset:0
  v_mov_b32 v4, s26
  s_cmp_lt_u32 s47, 128
  s_cselect_b32 s26, s48, 0
  v_mov_b32 v2, s26
  ds_write_b32 v118, v2 offset:0
  s_waitcnt lgkmcnt(4)
  v_mfma_f32_32x32x16_bf16 v[20:35], v[248:251], v[92:95], v[20:35]
  ds_read_b128 v[76:79], v122 offset:0
  v_mfma_f32_32x32x16_bf16 v[36:51], v[92:95], a[120:123], v[36:51]
  ds_read_b128 v[80:83], v123 offset:0
  s_waitcnt lgkmcnt(5)
  v_mfma_f32_32x32x16_bf16 v[20:35], v[252:255], v[96:99], v[20:35]
  ds_read_b128 v[84:87], v124 offset:0
  v_mfma_f32_32x32x16_bf16 v[36:51], v[96:99], a[124:127], v[36:51]
  ds_read_b128 v[88:91], v125 offset:0
  s_waitcnt lgkmcnt(5)
  v_mfma_f32_32x32x16_bf16 v[52:67], a[128:131], v[68:71], 0
  ds_read_b128 v[92:95], v126 offset:0
  v_mfma_f32_32x32x16_bf16 v[52:67], a[132:135], v[72:75], v[52:67]
  ds_read_b128 v[96:99], v127 offset:0
  v_mul_f32 v20, s24, v20
  v_mul_f32 v21, s24, v21
  v_mul_f32 v22, s24, v22
  v_mul_f32 v23, s24, v23
  v_mul_f32 v24, s24, v24
  s_waitcnt lgkmcnt(4)
  v_mfma_f32_32x32x16_bf16 v[52:67], a[136:139], v[76:79], v[52:67]
  ds_read_b128 v[68:71], v120 offset:256
  v_mul_f32 v25, s24, v25
  v_cvt_pk_bf16_f32 v100, v36, v37
  v_cvt_pk_bf16_f32 v101, v38, v39
  v_cvt_pk_bf16_f32 v102, v44, v45
  v_cvt_pk_bf16_f32 v103, v46, v47
  v_mfma_f32_32x32x16_bf16 v[52:67], a[140:143], v[80:83], v[52:67]
  ds_read_b128 v[72:75], v121 offset:256
  buffer_store_dwordx4 v[100:103], v8, s[4:7], s44 offen offset:2048 sc1
  v_cvt_pk_bf16_f32 v104, v40, v41
  v_cvt_pk_bf16_f32 v105, v42, v43
  s_waitcnt lgkmcnt(4)
  v_mfma_f32_32x32x16_bf16 v[52:67], a[144:147], v[84:87], v[52:67]
  ds_read_b128 v[76:79], v122 offset:256
  v_cvt_pk_bf16_f32 v106, v48, v49
  v_cvt_pk_bf16_f32 v107, v50, v51
  buffer_store_dwordx4 v[104:107], v8, s[4:7], s44 offen offset:2560 sc1
  v_mfma_f32_32x32x16_bf16 v[52:67], a[148:151], v[88:91], v[52:67]
  ds_read_b128 v[80:83], v123 offset:256
  v_mul_f32 v26, s24, v26
  v_mul_f32 v27, s24, v27
  v_mul_f32 v28, s24, v28
  v_mul_f32 v29, s24, v29
  v_mul_f32 v30, s24, v30
  s_waitcnt lgkmcnt(4)
  v_mfma_f32_32x32x16_bf16 v[52:67], a[152:155], v[92:95], v[52:67]
  ds_read_b128 v[84:87], v124 offset:256
  v_mul_f32 v31, s24, v31
  v_mul_f32 v32, s24, v32
  v_mul_f32 v33, s24, v33
  v_mul_f32 v34, s24, v34
  v_mul_f32 v35, s24, v35
  v_mfma_f32_32x32x16_bf16 v[52:67], a[156:159], v[96:99], v[52:67]
  ds_read_b128 v[88:91], v125 offset:256
  v_cvt_pk_bf16_f32 v108, v20, v21
  v_cvt_pk_bf16_f32 v109, v22, v23
  v_cvt_pk_bf16_f32 v110, v28, v29
  v_cvt_pk_bf16_f32 v111, v30, v31
  buffer_store_dwordx4 v[108:111], v8, s[4:7], s44 offen offset:0 sc1
  s_waitcnt lgkmcnt(4)
  v_mfma_f32_32x32x16_bf16 v[52:67], a[160:163], v[68:71], v[52:67]
  ds_read_b128 v[92:95], v126 offset:256
  v_cvt_pk_bf16_f32 v112, v24, v25
  v_cvt_pk_bf16_f32 v113, v26, v27
  v_cvt_pk_bf16_f32 v114, v32, v33
  v_cvt_pk_bf16_f32 v115, v34, v35
  buffer_store_dwordx4 v[112:115], v8, s[4:7], s44 offen offset:512 sc1
  v_mfma_f32_32x32x16_bf16 v[52:67], a[164:167], v[72:75], v[52:67]
  ds_read_b128 v[96:99], v127 offset:256
  s_waitcnt lgkmcnt(4)
  v_mfma_f32_32x32x16_bf16 v[52:67], a[168:171], v[76:79], v[52:67]
  ds_read_b128 v[68:71], v120 offset:512
  v_mfma_f32_32x32x16_bf16 v[52:67], a[172:175], v[80:83], v[52:67]
  ds_read_b128 v[72:75], v121 offset:512
  s_waitcnt lgkmcnt(4)
  v_mfma_f32_32x32x16_bf16 v[52:67], a[176:179], v[84:87], v[52:67]
  ds_read_b128 v[76:79], v122 offset:512
  v_mfma_f32_32x32x16_bf16 v[52:67], a[180:183], v[88:91], v[52:67]
  ds_read_b128 v[80:83], v123 offset:512
  s_waitcnt lgkmcnt(4)
  v_mfma_f32_32x32x16_bf16 v[52:67], a[184:187], v[92:95], v[52:67]
  ds_read_b128 v[84:87], v124 offset:512
  v_mfma_f32_32x32x16_bf16 v[52:67], a[188:191], v[96:99], v[52:67]
  ds_read_b128 v[88:91], v125 offset:512
  s_waitcnt lgkmcnt(4)
  v_mfma_f32_32x32x16_bf16 v[52:67], a[192:195], v[68:71], v[52:67]
  ds_read_b128 v[92:95], v126 offset:512
  v_mfma_f32_32x32x16_bf16 v[52:67], a[196:199], v[72:75], v[52:67]
  ds_read_b128 v[96:99], v127 offset:512
  s_waitcnt lgkmcnt(4)
  v_mfma_f32_32x32x16_bf16 v[52:67], a[200:203], v[76:79], v[52:67]
  ds_read_b128 v[68:71], v120 offset:768
  v_mfma_f32_32x32x16_bf16 v[52:67], a[204:207], v[80:83], v[52:67]
  ds_read_b128 v[72:75], v121 offset:768
  s_waitcnt lgkmcnt(4)
  v_mfma_f32_32x32x16_bf16 v[52:67], a[208:211], v[84:87], v[52:67]
  ds_read_b128 v[76:79], v122 offset:768
  ds_read_b128 v[80:83], v123 offset:768
  v_mfma_f32_32x32x16_bf16 v[52:67], a[212:215], v[88:91], v[52:67]
  ds_read_b128 v[84:87], v124 offset:768
  ds_read_b128 v[88:91], v125 offset:768
  s_waitcnt lgkmcnt(6)
  v_mfma_f32_32x32x16_bf16 v[52:67], a[216:219], v[92:95], v[52:67]
  ds_read_b128 v[92:95], v126 offset:768
  v_mfma_f32_32x32x16_bf16 v[52:67], a[220:223], v[96:99], v[52:67]
  ds_read_b128 v[96:99], v127 offset:768
  s_waitcnt lgkmcnt(6)
  v_mfma_f32_32x32x16_bf16 v[52:67], a[224:227], v[68:71], v[52:67]
  v_mfma_f32_32x32x16_bf16 v[52:67], a[228:231], v[72:75], v[52:67]
  s_waitcnt vmcnt(4) lgkmcnt(0)
  s_barrier
  ds_read_b128 v[100:103], v119 offset:0
  v_mfma_f32_32x32x16_bf16 v[52:67], a[232:235], v[76:79], v[52:67]
  ds_read_b128 v[68:71], v120 offset:32768
  v_mfma_f32_32x32x16_bf16 v[52:67], a[236:239], v[80:83], v[52:67]
  ds_read_b128 v[72:75], v121 offset:32768
  s_xor_b32 s50, s50, 32768
  v_mfma_f32_32x32x16_bf16 v[52:67], a[240:243], v[84:87], v[52:67]
  ds_read_b128 v[76:79], v122 offset:32768
  s_waitcnt vmcnt(0)
  s_mov_b64 exec, 1
  buffer_store_dword v4, off, s[4:7], s51 sc1
  s_mov_b64 exec, -1
  v_mfma_f32_32x32x16_bf16 v[52:67], a[244:247], v[88:91], v[52:67]
  s_waitcnt lgkmcnt(3)
  v_min3_u32 v104, v100, v101, v102
  v_max3_u32 v100, v100, v101, v102
  v_min_u32 v104, v104, v103
  v_max_u32 v100, v100, v103
  v_readfirstlane_b32 s45, v104
  v_readfirstlane_b32 s28, v100
  v_mfma_f32_32x32x16_bf16 v[52:67], a[248:251], v[92:95], v[52:67]
  s_max_u32 s56, s56, s28
  s_bfe_u32 s28, s56, 0x70005
  s_xor_b32 s28, s28, 63
  s_cmp_eq_u32 s28, s47
  s_cselect_b32 s55, 1, s55
  v_mfma_f32_32x32x16_bf16 v[52:67], a[252:255], v[96:99], v[52:67]
  s_cmp_gt_u32 s55, 0
  s_cselect_b32 s45, 0, s45
  s_cmp_lg_u32 s45, 0
  s_cbranch_scc1 q_w1_69
  s_branch q_slow_57
q_c1_67:
  ds_read_b128 v[68:71], v120 offset:32768
  ds_read_b128 v[72:75], v121 offset:32768
  ds_read_b128 v[76:79], v122 offset:32768
q_w1_69:
  s_waitcnt lgkmcnt(2)
  v_mfma_f32_32x32x16_bf16 v[20:35], v[128:131], v[68:71], 0
  ds_read_b128 v[80:83], v123 offset:32768
  s_mov_b32 s46, s47
  s_mov_b32 s47, s76
  s_lshl_b32 s52, s46, 7
  s_add_u32 s52, s52, s57
  s_lshl_b32 s44, s52, 12
  v_mfma_f32_32x32x16_bf16 v[36:51], v[68:71], a[0:3], 0
  s_add_u32 s44, s44, 41943040
  v_cvt_pk_bf16_f32 v100, v52, v53
  v_cvt_pk_bf16_f32 v101, v54, v55
  v_cvt_pk_bf16_f32 v102, v60, v61
  v_cvt_pk_bf16_f32 v103, v62, v63
  s_waitcnt lgkmcnt(2)
  v_mfma_f32_32x32x16_bf16 v[20:35], v[132:135], v[72:75], v[20:35]
  ds_read_b128 v[84:87], v124 offset:32768
  buffer_store_dwordx4 v[100:103], v8, s[4:7], s43 offen offset:0 sc1
  v_cvt_pk_bf16_f32 v104, v56, v57
  v_cvt_pk_bf16_f32 v105, v58, v59
  v_mfma_f32_32x32x16_bf16 v[36:51], v[72:75], a[4:7], v[36:51]
  v_cvt_pk_bf16_f32 v106, v64, v65
  v_cvt_pk_bf16_f32 v107, v66, v67
  s_waitcnt lgkmcnt(2)
  v_mfma_f32_32x32x16_bf16 v[20:35], v[136:139], v[76:79], v[20:35]
  ds_read_b128 v[88:91], v125 offset:32768
  buffer_store_dwordx4 v[104:107], v8, s[4:7], s43 offen offset:512 sc1
  s_lshl_b32 s43, s52, 11
  s_add_u32 s43, s43, 142606336
  v_mfma_f32_32x32x16_bf16 v[36:51], v[76:79], a[8:11], v[36:51]
  s_lshl_b32 s51, s52, 5
  s_add_u32 s51, s51, 244318208
  s_lshr_b32 s55, s47, 7
  s_or_b32 s55, s55, s62
  s_sub_u32 s27, s47, s60
  s_cmp_eq_u32 s27, 9
  s_cselect_b32 s55, 1, s55
  s_waitcnt lgkmcnt(2)
  v_mfma_f32_32x32x16_bf16 v[20:35], v[140:143], v[80:83], v[20:35]
  ds_read_b128 v[92:95], v126 offset:32768
  s_cmp_lt_u32 s40, 64
  s_cselect_b32 s42, s42, 0
  s_cmp_lg_u32 s42, 0
  s_cselect_b32 s76, s40, s41
  s_cselect_b32 s26, 3, 0
  s_cselect_b32 s42, s42, 2
  v_mfma_f32_32x32x16_bf16 v[36:51], v[80:83], a[12:15], v[36:51]
  s_sub_u32 s42, s42, 1
  s_add_u32 s40, s40, s26
  s_xor_b32 s26, s26, 3
  s_add_u32 s41, s41, s26
  s_waitcnt lgkmcnt(2)
  v_mfma_f32_32x32x16_bf16 v[20:35], v[144:147], v[84:87], v[20:35]
  ds_read_b128 v[96:99], v127 offset:32768
  v_mfma_f32_32x32x16_bf16 v[36:51], v[84:87], a[16:19], v[36:51]
  s_waitcnt lgkmcnt(2)
  v_mfma_f32_32x32x16_bf16 v[20:35], v[148:151], v[88:91], v[20:35]
  ds_read_b128 v[68:71], v120 offset:33024
  v_mfma_f32_32x32x16_bf16 v[36:51], v[88:91], a[20:23], v[36:51]
  s_waitcnt lgkmcnt(2)
  v_mfma_f32_32x32x16_bf16 v[20:35], v[152:155], v[92:95], v[20:35]
  ds_read_b128 v[72:75], v121 offset:33024
  s_cmp_lt_u32 s47, 64
  s_cselect_b32 s26, 2, 0
  s_add_u32 s26, s26, s47
  s_lshl_b32 s26, s26, 12
  s_add_u32 s26, s26, 243261440
  v_mfma_f32_32x32x16_bf16 v[36:51], v[92:95], a[24:27], v[36:51]
  s_mov_b64 exec, 0xffffff
  buffer_load_dword v116, v7, s[4:7], s26 offen sc1
  s_mov_b64 exec, -1
  s_waitcnt lgkmcnt(2)
  v_mfma_f32_32x32x16_bf16 v[20:35], v[156:159], v[96:99], v[20:35]
  ds_read_b128 v[76:79], v122 offset:33024
  v_mfma_f32_32x32x16_bf16 v[36:51], v[96:99], a[28:31], v[36:51]
  s_waitcnt lgkmcnt(2)
  v_mfma_f32_32x32x16_bf16 v[20:35], v[160:163], v[68:71], v[20:35]
  ds_read_b128 v[80:83], v123 offset:33024
  v_mfma_f32_32x32x16_bf16 v[36:51], v[68:71], a[32:35], v[36:51]
  s_waitcnt lgkmcnt(2)
  v_mfma_f32_32x32x16_bf16 v[20:35], v[164:167], v[72:75], v[20:35]
  ds_read_b128 v[84:87], v124 offset:33024
  v_mfma_f32_32x32x16_bf16 v[36:51], v[72:75], a[36:39], v[36:51]
  s_waitcnt lgkmcnt(2)
  v_mfma_f32_32x32x16_bf16 v[20:35], v[168:171], v[76:79], v[20:35]
  ds_read_b128 v[88:91], v125 offset:33024
  v_mfma_f32_32x32x16_bf16 v[36:51], v[76:79], a[40:43], v[36:51]
  s_waitcnt lgkmcnt(2)
  v_mfma_f32_32x32x16_bf16 v[20:35], v[172:175], v[80:83], v[20:35]
  ds_read_b128 v[92:95], v126 offset:33024
  v_mfma_f32_32x32x16_bf16 v[36:51], v[80:83], a[44:47], v[36:51]
  s_waitcnt lgkmcnt(2)
  v_mfma_f32_32x32x16_bf16 v[20:35], v[176:179], v[84:87], v[20:35]
  ds_read_b128 v[96:99], v127 offset:33024
  v_mfma_f32_32x32x16_bf16 v[36:51], v[84:87], a[48:51], v[36:51]
  s_waitcnt lgkmcnt(2)
  v_mfma_f32_32x32x16_bf16 v[20:35], v[180:183], v[88:91], v[20:35]
  ds_read_b128 v[68:71], v120 offset:33280
  v_mfma_f32_32x32x16_bf16 v[36:51], v[88:91], a[52:55], v[36:51]
  s_waitcnt lgkmcnt(2)
  v_mfma_f32_32x32x16_bf16 v[20:35], v[184:187], v[92:95], v[20:35]
  ds_read_b128 v[72:75], v121 offset:33280
  v_mfma_f32_32x32x16_bf16 v[36:51], v[92:95], a[56:59], v[36:51]
  s_waitcnt lgkmcnt(2)
  v_mfma_f32_32x32x16_bf16 v[20:35], v[188:191], v[96:99], v[20:35]
  ds_read_b128 v[76:79], v122 offset:33280
  v_mfma_f32_32x32x16_bf16 v[36:51], v[96:99], a[60:63], v[36:51]
  s_waitcnt lgkmcnt(2)
  v_mfma_f32_32x32x16_bf16 v[20:35], v[192:195], v[68:71], v[20:35]
  ds_read_b128 v[80:83], v123 offset:33280
  v_mfma_f32_32x32x16_bf16 v[36:51], v[68:71], a[64:67], v[36:51]
  s_waitcnt lgkmcnt(2)
  v_mfma_f32_32x32x16_bf16 v[20:35], v[196:199], v[72:75], v[20:35]
  ds_read_b128 v[84:87], v124 offset:33280
  v_mfma_f32_32x32x16_bf16 v[36:51], v[72:75], a[68:71], v[36:51]
  s_waitcnt lgkmcnt(2)
  v_mfma_f32_32x32x16_bf16 v[20:35], v[200:203], v[76:79], v[20:35]
  ds_read_b128 v[88:91], v125 offset:33280
  v_mfma_f32_32x32x16_bf16 v[36:51], v[76:79], a[72:75], v[36:51]
  s_waitcnt lgkmcnt(2)
  v_mfma_f32_32x32x16_bf16 v[20:35], v[204:207], v[80:83], v[20:35]
  ds_read_b128 v[92:95], v126 offset:33280
  s_waitcnt vmcnt(0)
  s_mov_b64 exec, 1
  buffer_store_dword v4, off, s[4:7], s49 sc1
  s_mov_b64 exec, -1
  v_mfma_f32_32x32x16_bf16 v[36:51], v[80:83], a[76:79], v[36:51]
  v_cmp_eq_u32 vcc, 0, v116
  v_max_u32_dpp v117, v116, v116 row_ror:8 row_mask:0xf bank_mask:0xf
  s_nop 0
  s_nop 0
  v_max_u32_dpp v117, v117, v117 row_ror:4 row_mask:0xf bank_mask:0xf
  s_nop 0
  s_waitcnt lgkmcnt(2)
  v_mfma_f32_32x32x16_bf16 v[20:35], v[208:211], v[84:87], v[20:35]
  ds_read_b128 v[96:99], v127 offset:33280
  s_nop 0
  v_max_u32_dpp v117, v117, v117 row_ror:2 row_mask:0xf bank_mask:0xf
  s_nop 0
  s_nop 0
  v_max_u32_dpp v117, v117, v117 row_ror:1 row_mask:0xf bank_mask:0xf
  v_mfma_f32_32x32x16_bf16 v[36:51], v[84:87], a[80:83], v[36:51]
  s_nop 0
  v_readlane_b32 s48, v117, 0
  v_readlane_b32 s28, v117, 16
  s_max_u32 s48, s48, s28
  s_and_b32 s28, vcc_lo, 0xffffff
  s_cselect_b32 s48, 0, s48
  s_waitcnt lgkmcnt(2)
  v_mfma_f32_32x32x16_bf16 v[20:35], v[212:215], v[88:91], v[20:35]
  ds_read_b128 v[68:71], v120 offset:33536
  s_cmp_lg_u32 s48, 0
  s_cselect_b32 s28, s47, s46
  s_and_b32 s63, s28, 127
  s_lshl_b32 s63, s63, 15
  s_xor_b32 s27, s50, 32768
  v_mfma_f32_32x32x16_bf16 v[36:51], v[88:91], a[84:87], v[36:51]
  s_add_u32 m0, s27, s54
  s_add_u32 s63, s63, s54
  s_add_u32 s63, s63, 6291456
  s_waitcnt lgkmcnt(2)
  v_mfma_f32_32x32x16_bf16 v[20:35], v[216:219], v[92:95], v[20:35]
  ds_read_b128 v[72:75], v121 offset:33536
  buffer_load_dwordx4 v12, s[4:7], s63 offen offset:0 sc1 lds
  v_mfma_f32_32x32x16_bf16 v[36:51], v[92:95], a[88:91], v[36:51]
  s_waitcnt lgkmcnt(2)
  v_mfma_f32_32x32x16_bf16 v[20:35], v[220:223], v[96:99], v[20:35]
  ds_read_b128 v[76:79], v122 offset:33536
  buffer_load_dwordx4 v13, s[4:7], s63 offen offset:1024 sc1 lds
  v_mfma_f32_32x32x16_bf16 v[36:51], v[96:99], a[92:95], v[36:51]
  s_waitcnt lgkmcnt(2)
  v_mfma_f32_32x32x16_bf16 v[20:35], v[224:227], v[68:71], v[20:35]
  ds_read_b128 v[80:83], v123 offset:33536
  buffer_load_dwordx4 v14, s[4:7], s63 offen offset:2048 sc1 lds
  v_mfma_f32_32x32x16_bf16 v[36:51], v[68:71], a[96:99], v[36:51]
  s_waitcnt lgkmcnt(2)
  v_mfma_f32_32x32x16_bf16 v[20:35], v[228:231], v[72:75], v[20:35]
  ds_read_b128 v[84:87], v124 offset:33536
  buffer_load_dwordx4 v15, s[4:7], s63 offen offset:3072 sc1 lds
  s_add_u32 m0, m0, 4096
  s_add_u32 s63, s63, 4096
  v_mfma_f32_32x32x16_bf16 v[36:51], v[72:75], a[100:103], v[36:51]
  s_waitcnt lgkmcnt(2)
  v_mfma_f32_32x32x16_bf16 v[20:35], v[232:235], v[76:79], v[20:35]
  ds_read_b128 v[88:91], v125 offset:33536
  buffer_load_dwordx4 v16, s[4:7], s63 offen offset:0 sc1 lds
  v_mfma_f32_32x32x16_bf16 v[36:51], v[76:79], a[104:107], v[36:51]
  s_waitcnt lgkmcnt(2)
  v_mfma_f32_32x32x16_bf16 v[20:35], v[236:239], v[80:83], v[20:35]
  ds_read_b128 v[92:95], v126 offset:33536
  buffer_load_dwordx4 v17, s[4:7], s63 offen offset:1024 sc1 lds
  v_mfma_f32_32x32x16_bf16 v[36:51], v[80:83], a[108:111], v[36:51]
  s_waitcnt lgkmcnt(2)
  v_mfma_f32_32x32x16_bf16 v[20:35], v[240:243], v[84:87], v[20:35]
  ds_read_b128 v[96:99], v127 offset:33536
  buffer_load_dwordx4 v18, s[4:7], s63 offen offset:2048 sc1 lds
  v_mfma_f32_32x32x16_bf16 v[36:51], v[84:87], a[112:115], v[36:51]
  s_waitcnt lgkmcnt(2)
  v_mfma_f32_32x32x16_bf16 v[20:35], v[244:247], v[88:91], v[20:35]
  ds_read_b128 v[68:71], v120 offset:32768
  buffer_load_dwordx4 v19, s[4:7], s63 offen offset:3072 sc1 lds
  s_add_u32 s49, s51, 16
  s_add_u32 s26, s62, 1
  v_mfma_f32_32x32x16_bf16 v[36:51], v[88:91], a[116:119], v[36:51]
  ds_read_b128 v[72:75], v121 offset:32768
  v_mov_b32 v4, s26
  s_cmp_lt_u32 s47, 128
  s_cselect_b32 s26, s48, 0
  v_mov_b32 v2, s26
  ds_write_b32 v118, v2 offset:16
  s_waitcnt lgkmcnt(4)
  v_mfma_f32_32x32x16_bf16 v[20:35], v[248:251], v[92:95], v[20:35]
  ds_read_b128 v[76:79], v122 offset:32768
  v_mfma_f32_32x32x16_bf16 v[36:51], v[92:95], a[120:123], v[36:51]
  ds_read_b128 v[80:83], v123 offset:32768
  s_waitcnt lgkmcnt(5)
  v_mfma_f32_32x32x16_bf16 v[20:35], v[252:255], v[96:99], v[20:35]
  ds_read_b128 v[84:87], v124 offset:32768
  v_mfma_f32_32x32x16_bf16 v[36:51], v[96:99], a[124:127], v[36:51]
  ds_read_b128 v[88:91], v125 offset:32768
  s_waitcnt lgkmcnt(5)
  v_mfma_f32_32x32x16_bf16 v[52:67], a[128:131], v[68:71], 0
  ds_read_b128 v[92:95], v126 offset:32768
  v_mfma_f32_32x32x16_bf16 v[52:67], a[132:135], v[72:75], v[52:67]
  ds_read_b128 v[96:99], v127 offset:32768
  v_mul_f32 v20, s24, v20
  v_mul_f32 v21, s24, v21
  v_mul_f32 v22, s24, v22
  v_mul_f32 v23, s24, v23
  v_mul_f32 v24, s24, v24
  s_waitcnt lgkmcnt(4)
  v_mfma_f32_32x32x16_bf16 v[52:67], a[136:139], v[76:79], v[52:67]
  ds_read_b128 v[68:71], v120 offset:33024
  v_mul_f32 v25, s24, v25
  v_cvt_pk_bf16_f32 v100, v36, v37
  v_cvt_pk_bf16_f32 v101, v38, v39
  v_cvt_pk_bf16_f32 v102, v44, v45
  v_cvt_pk_bf16_f32 v103, v46, v47
  v_mfma_f32_32x32x16_bf16 v[52:67], a[140:143], v[80:83], v[52:67]
  ds_read_b128 v[72:75], v121 offset:33024
  buffer_store_dwordx4 v[100:103], v8, s[4:7], s44 offen offset:2048 sc1
  v_cvt_pk_bf16_f32 v104, v40, v41
  v_cvt_pk_bf16_f32 v105, v42, v43
  s_waitcnt lgkmcnt(4)
  v_mfma_f32_32x32x16_bf16 v[52:67], a[144:147], v[84:87], v[52:67]
  ds_read_b128 v[76:79], v122 offset:33024
  v_cvt_pk_bf16_f32 v106, v48, v49
  v_cvt_pk_bf16_f32 v107, v50, v51
  buffer_store_dwordx4 v[104:107], v8, s[4:7], s44 offen offset:2560 sc1
  v_mfma_f32_32x32x16_bf16 v[52:67], a[148:151], v[88:91], v[52:67]
  ds_read_b128 v[80:83], v123 offset:33024
  v_mul_f32 v26, s24, v26
  v_mul_f32 v27, s24, v27
  v_mul_f32 v28, s24, v28
  v_mul_f32 v29, s24, v29
  v_mul_f32 v30, s24, v30
  s_waitcnt lgkmcnt(4)
  v_mfma_f32_32x32x16_bf16 v[52:67], a[152:155], v[92:95], v[52:67]
  ds_read_b128 v[84:87], v124 offset:33024
  v_mul_f32 v31, s24, v31
  v_mul_f32 v32, s24, v32
  v_mul_f32 v33, s24, v33
  v_mul_f32 v34, s24, v34
  v_mul_f32 v35, s24, v35
  v_mfma_f32_32x32x16_bf16 v[52:67], a[156:159], v[96:99], v[52:67]
  ds_read_b128 v[88:91], v125 offset:33024
  v_cvt_pk_bf16_f32 v108, v20, v21
  v_cvt_pk_bf16_f32 v109, v22, v23
  v_cvt_pk_bf16_f32 v110, v28, v29
  v_cvt_pk_bf16_f32 v111, v30, v31
  buffer_store_dwordx4 v[108:111], v8, s[4:7], s44 offen offset:0 sc1
  s_waitcnt lgkmcnt(4)
  v_mfma_f32_32x32x16_bf16 v[52:67], a[160:163], v[68:71], v[52:67]
  ds_read_b128 v[92:95], v126 offset:33024
  v_cvt_pk_bf16_f32 v112, v24, v25
  v_cvt_pk_bf16_f32 v113, v26, v27
  v_cvt_pk_bf16_f32 v114, v32, v33
  v_cvt_pk_bf16_f32 v115, v34, v35
  buffer_store_dwordx4 v[112:115], v8, s[4:7], s44 offen offset:512 sc1
  v_mfma_f32_32x32x16_bf16 v[52:67], a[164:167], v[72:75], v[52:67]
  ds_read_b128 v[96:99], v127 offset:33024
  s_waitcnt lgkmcnt(4)
  v_mfma_f32_32x32x16_bf16 v[52:67], a[168:171], v[76:79], v[52:67]
  ds_read_b128 v[68:71], v120 offset:33280
  v_mfma_f32_32x32x16_bf16 v[52:67], a[172:175], v[80:83], v[52:67]
  ds_read_b128 v[72:75], v121 offset:33280
  s_waitcnt lgkmcnt(4)
  v_mfma_f32_32x32x16_bf16 v[52:67], a[176:179], v[84:87], v[52:67]
  ds_read_b128 v[76:79], v122 offset:33280
  v_mfma_f32_32x32x16_bf16 v[52:67], a[180:183], v[88:91], v[52:67]
  ds_read_b128 v[80:83], v123 offset:33280
  s_waitcnt lgkmcnt(4)
  v_mfma_f32_32x32x16_bf16 v[52:67], a[184:187], v[92:95], v[52:67]
  ds_read_b128 v[84:87], v124 offset:33280
  v_mfma_f32_32x32x16_bf16 v[52:67], a[188:191], v[96:99], v[52:67]
  ds_read_b128 v[88:91], v125 offset:33280
  s_waitcnt lgkmcnt(4)
  v_mfma_f32_32x32x16_bf16 v[52:67], a[192:195], v[68:71], v[52:67]
  ds_read_b128 v[92:95], v126 offset:33280
  v_mfma_f32_32x32x16_bf16 v[52:67], a[196:199], v[72:75], v[52:67]
  ds_read_b128 v[96:99], v127 offset:33280
  s_waitcnt lgkmcnt(4)
  v_mfma_f32_32x32x16_bf16 v[52:67], a[200:203], v[76:79], v[52:67]
  ds_read_b128 v[68:71], v120 offset:33536
  v_mfma_f32_32x32x16_bf16 v[52:67], a[204:207], v[80:83], v[52:67]
  ds_read_b128 v[72:75], v121 offset:33536
  s_waitcnt lgkmcnt(4)
  v_mfma_f32_32x32x16_bf16 v[52:67], a[208:211], v[84:87], v[52:67]
  ds_read_b128 v[76:79], v122 offset:33536
  ds_read_b128 v[80:83], v123 offset:33536
  v_mfma_f32_32x32x16_bf16 v[52:67], a[212:215], v[88:91], v[52:67]
  ds_read_b128 v[84:87], v124 offset:33536
  ds_read_b128 v[88:91], v125 offset:33536
  s_waitcnt lgkmcnt(6)
  v_mfma_f32_32x32x16_bf16 v[52:67], a[216:219], v[92:95], v[52:67]
  ds_read_b128 v[92:95], v126 offset:33536
  v_mfma_f32_32x32x16_bf16 v[52:67], a[220:223], v[96:99], v[52:67]
  ds_read_b128 v[96:99], v127 offset:33536
  s_waitcnt lgkmcnt(6)
  v_mfma_f32_32x32x16_bf16 v[52:67], a[224:227], v[68:71], v[52:67]
  v_mfma_f32_32x32x16_bf16 v[52:67], a[228:231], v[72:75], v[52:67]
  s_waitcnt vmcnt(4) lgkmcnt(0)
  s_barrier
  ds_read_b128 v[100:103], v119 offset:16
  v_mfma_f32_32x32x16_bf16 v[52:67], a[232:235], v[76:79], v[52:67]
  ds_read_b128 v[68:71], v120 offset:0
  v_mfma_f32_32x32x16_bf16 v[52:67], a[236:239], v[80:83], v[52:67]
  ds_read_b128 v[72:75], v121 offset:0
  s_xor_b32 s50, s50, 32768
  v_mfma_f32_32x32x16_bf16 v[52:67], a[240:243], v[84:87], v[52:67]
  ds_read_b128 v[76:79], v122 offset:0
  s_waitcnt vmcnt(0)
  s_mov_b64 exec, 1
  buffer_store_dword v4, off, s[4:7], s51 sc1
  s_mov_b64 exec, -1
  v_mfma_f32_32x32x16_bf16 v[52:67], a[244:247], v[88:91], v[52:67]
  s_waitcnt lgkmcnt(3)
  v_min3_u32 v104, v100, v101, v102
  v_max3_u32 v100, v100, v101, v102
  v_min_u32 v104, v104, v103
  v_max_u32 v100, v100, v103
  v_readfirstlane_b32 s45, v104
  v_readfirstlane_b32 s28, v100
  v_mfma_f32_32x32x16_bf16 v[52:67], a[248:251], v[92:95], v[52:67]
  s_max_u32 s56, s56, s28
  s_bfe_u32 s28, s56, 0x70005
  s_xor_b32 s28, s28, 63
  s_cmp_eq_u32 s28, s47
  s_cselect_b32 s55, 1, s55
  v_mfma_f32_32x32x16_bf16 v[52:67], a[252:255], v[96:99], v[52:67]
  s_cmp_gt_u32 s55, 0
  s_cselect_b32 s45, 0, s45
  s_cmp_lg_u32 s45, 0
  s_cbranch_scc1 q_w0_68
  s_branch q_slow_57
q_fork_64:
  s_mov_b32 s58, s56
  s_mov_b32 s62, 1
  s_mov_b32 s77, s40
  s_mov_b32 s78, s41
  s_mov_b32 s79, s42
  s_load_dwordx2 s[64:65], s[0:1], 72
  s_load_dwordx2 s[68:69], s[0:1], 80
  s_load_dwordx2 s[8:9], s[0:1], 88
  s_mov_b32 s66, 1835008
  s_mov_b32 s70, 1835008
  s_mov_b32 s10, 1835008
  v_lshrrev_b32 v2, 8, v0
  v_and_b32 v3, 0x70, v0
  s_mov_b32 s26, 114688
  v_mul_lo_u32 v6, v2, s26
  v_add_u32 v6, v6, v3
  v_cmp_eq_u32 vcc, 0x70, v3
  v_mov_b32 v3, 0x7ff00000
  s_nop 0
  v_cndmask_b32 v6, v6, v3, vcc
  v_mul_u32_u24 v7, 14336, v2
  v_and_b32 v3, 0xf0, v0
  v_add_u32 v7, v7, v3
  s_mul_i32 s34, s17, 458752
  s_mul_i32 s27, s16, 112
  s_add_u32 s34, s34, s27
  s_add_u32 s34, s34, 82432
  s_mul_i32 s35, s16, 57344
  s_lshl_b32 s27, s17, 8
  s_add_u32 s35, s35, s27
  s_mov_b32 s36, 0x00ff00ff
  s_mov_b32 s37, 0x00ff00ff
  s_waitcnt lgkmcnt(0)
  s_andn2_b32 s59, 0xfff, s58
  s_lshl_b32 s26, s61, 21
  s_lshl_b32 s27, s59, 10
  s_add_u32 s26, s26, s27
  s_lshl_b32 s27, s17, 8
  s_add_u32 s26, s26, s27
  s_add_u32 s26, s26, 27262976
  v_lshrrev_b32 v3, 8, v0
  v_lshlrev_b32 v3, 6, v3
  buffer_load_dwordx4 v[36:39], v3, s[4:7], s26 offen offset:0 sc1
  buffer_load_dwordx4 v[40:43], v3, s[4:7], s26 offen offset:16 sc1
  buffer_load_dwordx4 v[44:47], v3, s[4:7], s26 offen offset:32 sc1
  buffer_load_dwordx4 v[48:51], v3, s[4:7], s26 offen offset:48 sc1
  s_mov_b64 exec, s[36:37]
  buffer_load_dwordx4 v[64:67], v6, s[64:67], s34 offen
  s_not_b64 exec, exec
  buffer_load_dwordx4 v[64:67], v6, s[68:71], s34 offen
  s_mov_b64 exec, -1
  s_add_u32 s34, s34, 3584
  s_mov_b64 exec, s[36:37]
  buffer_load_dwordx4 v[68:71], v6, s[64:67], s34 offen
  s_not_b64 exec, exec
  buffer_load_dwordx4 v[68:71], v6, s[68:71], s34 offen
  s_mov_b64 exec, -1
  s_add_u32 s34, s34, 3584
  s_mov_b64 exec, s[36:37]
  buffer_load_dwordx4 v[72:75], v6, s[64:67], s34 offen
  s_not_b64 exec, exec
  buffer_load_dwordx4 v[72:75], v6, s[68:71], s34 offen
  s_mov_b64 exec, -1
  s_add_u32 s34, s34, 3584
  s_mov_b64 exec, s[36:37]
  buffer_load_dwordx4 v[76:79], v6, s[64:67], s34 offen
  s_not_b64 exec, exec
  buffer_load_dwordx4 v[76:79], v6, s[68:71], s34 offen
  s_mov_b64 exec, -1
  s_add_u32 s34, s34, 3584
  s_mov_b64 exec, s[36:37]
  buffer_load_dwordx4 v[80:83], v6, s[64:67], s34 offen
  s_not_b64 exec, exec
  buffer_load_dwordx4 v[80:83], v6, s[68:71], s34 offen
  s_mov_b64 exec, -1
  s_add_u32 s34, s34, 3584
  s_mov_b64 exec, s[36:37]
  buffer_load_dwordx4 v[84:87], v6, s[64:67], s34 offen
  s_not_b64 exec, exec
  buffer_load_dwordx4 v[84:87], v6, s[68:71], s34 offen
  s_mov_b64 exec, -1
  s_add_u32 s34, s34, 3584
  s_mov_b64 exec, s[36:37]
  buffer_load_dwordx4 v[88:91], v6, s[64:67], s34 offen
  s_not_b64 exec, exec
  buffer_load_dwordx4 v[88:91], v6, s[68:71], s34 offen
  s_mov_b64 exec, -1
  s_add_u32 s34, s34, 3584
  s_mov_b64 exec, s[36:37]
  buffer_load_dwordx4 v[92:95], v6, s[64:67], s34 offen
  s_not_b64 exec, exec
  buffer_load_dwordx4 v[92:95], v6, s[68:71], s34 offen
  s_mov_b64 exec, -1
  s_add_u32 s34, s34, 3584
  s_mov_b64 exec, s[36:37]
  buffer_load_dwordx4 v[96:99], v6, s[64:67], s34 offen
  s_not_b64 exec, exec
  buffer_load_dwordx4 v[96:99], v6, s[68:71], s34 offen
  s_mov_b64 exec, -1
  s_add_u32 s34, s34, 3584
  buffer_load_dwordx4 v[100:103], v7, s[8:11], s35 offen offset:0
  buffer_load_dwordx4 v[104:107], v7, s[8:11], s35 offen offset:1024
  buffer_load_dwordx4 v[108:111], v7, s[8:11], s35 offen offset:2048
  buffer_load_dwordx4 v[112:115], v7, s[8:11], s35 offen offset:3072
  s_add_u32 s35, s35, 4096
  s_mov_b32 vcc_lo, 0xaaaaaaaa
  s_mov_b32 vcc_hi, 0xaaaaaaaa
  v_mov_b32 v3, 0xffff
  v_mov_b32 v28, 0xffff0000
  v_cndmask_b32 v3, v3, v28, vcc
  s_mov_b32 vcc_lo, 0x30003
  s_mov_b32 vcc_hi, 0x30003
  v_cndmask_b32 v28, 0, v3, vcc
  s_mov_b32 vcc_lo, 0xc000c
  s_mov_b32 vcc_hi, 0xc000c
  v_cndmask_b32 v29, 0, v3, vcc
  s_mov_b32 vcc_lo, 0x300030
  s_mov_b32 vcc_hi, 0x300030
  v_cndmask_b32 v30, 0, v3, vcc
  s_mov_b32 vcc_lo, 0xc000c0
  s_mov_b32 vcc_hi, 0xc000c0
  v_cndmask_b32 v31, 0, v3, vcc
  s_mov_b32 s30, 0x01000100
  s_mov_b32 s31, 0x03020302
  s_mul_i32 s26, s17, 23552
  s_add_u32 s26, s26, 65536
  v_add_u32 v5, s26, v0
  ds_read_b128 v[52:55], v5 offset:0
  ds_read_b128 v[56:59], v5 offset:1024
  ds_read_b128 v[60:63], v5 offset:2048
  s_waitcnt vmcnt(22)
  v_perm_b32 v3, v36, v36, s30
  v_and_b32 v20, v28, v3
  v_and_b32 v21, v29, v3
  v_and_b32 v22, v30, v3
  v_and_b32 v23, v31, v3
  s_waitcnt lgkmcnt(2)
  s_nop 0
  v_mfma_f32_16x16x32_bf16 v[32:35], v[20:23], v[52:55], 0
  ds_read_b128 v[52:55], v5 offset:3072
  v_perm_b32 v3, v36, v36, s31
  v_and_b32 v24, v28, v3
  v_and_b32 v25, v29, v3
  v_and_b32 v26, v30, v3
  v_and_b32 v27, v31, v3
  s_waitcnt lgkmcnt(2)
  s_nop 0
  v_mfma_f32_16x16x32_bf16 v[32:35], v[24:27], v[56:59], v[32:35]
  ds_read_b128 v[56:59], v5 offset:4096
  v_perm_b32 v3, v37, v37, s30
  v_and_b32 v20, v28, v3
  v_and_b32 v21, v29, v3
  v_and_b32 v22, v30, v3
  v_and_b32 v23, v31, v3
  s_waitcnt lgkmcnt(2)
  s_nop 0
  v_mfma_f32_16x16x32_bf16 v[32:35], v[20:23], v[60:63], v[32:35]
  ds_read_b128 v[60:63], v5 offset:5120
  v_perm_b32 v3, v37, v37, s31
  v_and_b32 v24, v28, v3
  v_and_b32 v25, v29, v3
  v_and_b32 v26, v30, v3
  v_and_b32 v27, v31, v3
  s_waitcnt lgkmcnt(2)
  s_nop 0
  v_mfma_f32_16x16x32_bf16 v[32:35], v[24:27], v[52:55], v[32:35]
  ds_read_b128 v[52:55], v5 offset:6144
  v_perm_b32 v3, v38, v38, s30
  v_and_b32 v20, v28, v3
  v_and_b32 v21, v29, v3
  v_and_b32 v22, v30, v3
  v_and_b32 v23, v31, v3
  s_waitcnt lgkmcnt(2)
  s_nop 0
  v_mfma_f32_16x16x32_bf16 v[32:35], v[20:23], v[56:59], v[32:35]
  ds_read_b128 v[56:59], v5 offset:7168
  v_perm_b32 v3, v38, v38, s31
  v_and_b32 v24, v28, v3
  v_and_b32 v25, v29, v3
  v_and_b32 v26, v30, v3
  v_and_b32 v27, v31, v3
  s_waitcnt lgkmcnt(2)
  s_nop 0
  v_mfma_f32_16x16x32_bf16 v[32:35], v[24:27], v[60:63], v[32:35]
  ds_read_b128 v[60:63], v5 offset:8192
  v_perm_b32 v3, v39, v39, s30
  v_and_b32 v20, v28, v3
  v_and_b32 v21, v29, v3
  v_and_b32 v22, v30, v3
  v_and_b32 v23, v31, v3
  s_waitcnt lgkmcnt(2)
  s_nop 0
  v_mfma_f32_16x16x32_bf16 v[32:35], v[20:23], v[52:55], v[32:35]
  ds_read_b128 v[52:55], v5 offset:9216
  v_perm_b32 v3, v39, v39, s31
  v_and_b32 v24, v28, v3
  v_and_b32 v25, v29, v3
  v_and_b32 v26, v30, v3
  v_and_b32 v27, v31, v3
  s_waitcnt lgkmcnt(2)
  s_nop 0
  v_mfma_f32_16x16x32_bf16 v[32:35], v[24:27], v[56:59], v[32:35]
  ds_read_b128 v[56:59], v5 offset:10240
  v_perm_b32 v3, v40, v40, s30
  v_and_b32 v20, v28, v3
  v_and_b32 v21, v29, v3
  v_and_b32 v22, v30, v3
  v_and_b32 v23, v31, v3
  s_waitcnt lgkmcnt(2)
  s_nop 0
  v_mfma_f32_16x16x32_bf16 v[32:35], v[20:23], v[60:63], v[32:35]
  ds_read_b128 v[60:63], v5 offset:11264
  v_perm_b32 v3, v40, v40, s31
  v_and_b32 v24, v28, v3
  v_and_b32 v25, v29, v3
  v_and_b32 v26, v30, v3
  v_and_b32 v27, v31, v3
  s_waitcnt lgkmcnt(2)
  s_nop 0
  v_mfma_f32_16x16x32_bf16 v[32:35], v[24:27], v[52:55], v[32:35]
  ds_read_b128 v[52:55], v5 offset:12288
  v_perm_b32 v3, v41, v41, s30
  v_and_b32 v20, v28, v3
  v_and_b32 v21, v29, v3
  v_and_b32 v22, v30, v3
  v_and_b32 v23, v31, v3
  s_waitcnt lgkmcnt(2)
  s_nop 0
  v_mfma_f32_16x16x32_bf16 v[32:35], v[20:23], v[56:59], v[32:35]
  ds_read_b128 v[56:59], v5 offset:13312
  v_perm_b32 v3, v41, v41, s31
  v_and_b32 v24, v28, v3
  v_and_b32 v25, v29, v3
  v_and_b32 v26, v30, v3
  v_and_b32 v27, v31, v3
  s_waitcnt lgkmcnt(2)
  s_nop 0
  v_mfma_f32_16x16x32_bf16 v[32:35], v[24:27], v[60:63], v[32:35]
  ds_read_b128 v[60:63], v5 offset:14336
  v_perm_b32 v3, v42, v42, s30
  v_and_b32 v20, v28, v3
  v_and_b32 v21, v29, v3
  v_and_b32 v22, v30, v3
  v_and_b32 v23, v31, v3
  s_waitcnt lgkmcnt(2)
  s_nop 0
  v_mfma_f32_16x16x32_bf16 v[32:35], v[20:23], v[52:55], v[32:35]
  ds_read_b128 v[52:55], v5 offset:15360
  v_perm_b32 v3, v42, v42, s31
  v_and_b32 v24, v28, v3
  v_and_b32 v25, v29, v3
  v_and_b32 v26, v30, v3
  v_and_b32 v27, v31, v3
  s_waitcnt lgkmcnt(2)
  s_nop 0
  v_mfma_f32_16x16x32_bf16 v[32:35], v[24:27], v[56:59], v[32:35]
  ds_read_b128 v[56:59], v5 offset:16384
  v_perm_b32 v3, v43, v43, s30
  v_and_b32 v20, v28, v3
  v_and_b32 v21, v29, v3
  v_and_b32 v22, v30, v3
  v_and_b32 v23, v31, v3
  s_waitcnt lgkmcnt(2)
  s_nop 0
  v_mfma_f32_16x16x32_bf16 v[32:35], v[20:23], v[60:63], v[32:35]
  ds_read_b128 v[60:63], v5 offset:17408
  v_perm_b32 v3, v43, v43, s31
  v_and_b32 v24, v28, v3
  v_and_b32 v25, v29, v3
  v_and_b32 v26, v30, v3
  v_and_b32 v27, v31, v3
  s_waitcnt lgkmcnt(2)
  s_nop 0
  v_mfma_f32_16x16x32_bf16 v[32:35], v[24:27], v[52:55], v[32:35]
  ds_read_b128 v[52:55], v5 offset:18432
  v_perm_b32 v3, v44, v44, s30
  v_and_b32 v20, v28, v3
  v_and_b32 v21, v29, v3
  v_and_b32 v22, v30, v3
  v_and_b32 v23, v31, v3
  s_waitcnt lgkmcnt(2)
  s_nop 0
  v_mfma_f32_16x16x32_bf16 v[32:35], v[20:23], v[56:59], v[32:35]
  ds_read_b128 v[56:59], v5 offset:19456
  v_perm_b32 v3, v44, v44, s31
  v_and_b32 v24, v28, v3
  v_and_b32 v25, v29, v3
  v_and_b32 v26, v30, v3
  v_and_b32 v27, v31, v3
  s_waitcnt lgkmcnt(2)
  s_nop 0
  v_mfma_f32_16x16x32_bf16 v[32:35], v[24:27], v[60:63], v[32:35]
  ds_read_b128 v[60:63], v5 offset:20480
  v_perm_b32 v3, v45, v45, s30
  v_and_b32 v20, v28, v3
  v_and_b32 v21, v29, v3
  v_and_b32 v22, v30, v3
  v_and_b32 v23, v31, v3
  s_waitcnt lgkmcnt(2)
  s_nop 0
  v_mfma_f32_16x16x32_bf16 v[32:35], v[20:23], v[52:55], v[32:35]
  ds_read_b128 v[52:55], v5 offset:21504
  v_perm_b32 v3, v45, v45, s31
  v_and_b32 v24, v28, v3
  v_and_b32 v25, v29, v3
  v_and_b32 v26, v30, v3
  v_and_b32 v27, v31, v3
  s_waitcnt lgkmcnt(2)
  s_nop 0
  v_mfma_f32_16x16x32_bf16 v[32:35], v[24:27], v[56:59], v[32:35]
  ds_read_b128 v[56:59], v5 offset:22528
  v_perm_b32 v3, v46, v46, s30
  v_and_b32 v20, v28, v3
  v_and_b32 v21, v29, v3
  v_and_b32 v22, v30, v3
  v_and_b32 v23, v31, v3
  s_waitcnt lgkmcnt(2)
  s_nop 0
  v_mfma_f32_16x16x32_bf16 v[32:35], v[20:23], v[60:63], v[32:35]
  buffer_load_dwordx4 v[60:63], v7, s[8:11], s35 offen offset:0
  v_perm_b32 v3, v46, v46, s31
  v_and_b32 v24, v28, v3
  v_and_b32 v25, v29, v3
  v_and_b32 v26, v30, v3
  v_and_b32 v27, v31, v3
  s_waitcnt lgkmcnt(1)
  s_nop 0
  v_mfma_f32_16x16x32_bf16 v[32:35], v[24:27], v[52:55], v[32:35]
  buffer_load_dwordx4 v[52:55], v7, s[8:11], s35 offen offset:1024
  v_perm_b32 v3, v47, v47, s30
  v_and_b32 v20, v28, v3
  v_and_b32 v21, v29, v3
  v_and_b32 v22, v30, v3
  v_and_b32 v23, v31, v3
  s_waitcnt lgkmcnt(0)
  s_nop 0
  v_mfma_f32_16x16x32_bf16 v[32:35], v[20:23], v[56:59], v[32:35]
  buffer_load_dwordx4 v[56:59], v7, s[8:11], s35 offen offset:2048
  v_perm_b32 v3, v47, v47, s31
  v_and_b32 v24, v28, v3
  v_and_b32 v25, v29, v3
  v_and_b32 v26, v30, v3
  v_and_b32 v27, v31, v3
  s_waitcnt vmcnt(23)
  s_nop 0
  v_mfma_f32_16x16x32_bf16 v[32:35], v[24:27], v[64:67], v[32:35]
  buffer_load_dwordx4 v[64:67], v7, s[8:11], s35 offen offset:3072
  s_add_u32 s35, s35, 4096
  v_perm_b32 v3, v48, v48, s30
  v_and_b32 v20, v28, v3
  v_and_b32 v21, v29, v3
  v_and_b32 v22, v30, v3
  v_and_b32 v23, v31, v3
  s_waitcnt vmcnt(22)
  s_nop 0
  v_mfma_f32_16x16x32_bf16 v[32:35], v[20:23], v[68:71], v[32:35]
  buffer_load_dwordx4 v[68:71], v7, s[8:11], s35 offen offset:0
  v_perm_b32 v3, v48, v48, s31
  v_and_b32 v24, v28, v3
  v_and_b32 v25, v29, v3
  v_and_b32 v26, v30, v3
  v_and_b32 v27, v31, v3
  s_waitcnt vmcnt(21)
  s_nop 0
  v_mfma_f32_16x16x32_bf16 v[32:35], v[24:27], v[72:75], v[32:35]
  buffer_load_dwordx4 v[72:75], v7, s[8:11], s35 offen offset:1024
  v_perm_b32 v3, v49, v49, s30
  v_and_b32 v20, v28, v3
  v_and_b32 v21, v29, v3
  v_and_b32 v22, v30, v3
  v_and_b32 v23, v31, v3
  s_waitcnt vmcnt(20)
  s_nop 0
  v_mfma_f32_16x16x32_bf16 v[32:35], v[20:23], v[76:79], v[32:35]
  buffer_load_dwordx4 v[76:79], v7, s[8:11], s35 offen offset:2048
  v_perm_b32 v3, v49, v49, s31
  v_and_b32 v24, v28, v3
  v_and_b32 v25, v29, v3
  v_and_b32 v26, v30, v3
  v_and_b32 v27, v31, v3
  s_waitcnt vmcnt(19)
  s_nop 0
  v_mfma_f32_16x16x32_bf16 v[32:35], v[24:27], v[80:83], v[32:35]
  buffer_load_dwordx4 v[80:83], v7, s[8:11], s35 offen offset:3072
  s_add_u32 s35, s35, 4096
  v_perm_b32 v3, v50, v50, s30
  v_and_b32 v20, v28, v3
  v_and_b32 v21, v29, v3
  v_and_b32 v22, v30, v3
  v_and_b32 v23, v31, v3
  s_waitcnt vmcnt(18)
  s_nop 0
  v_mfma_f32_16x16x32_bf16 v[32:35], v[20:23], v[84:87], v[32:35]
  buffer_load_dwordx4 v[84:87], v7, s[8:11], s35 offen offset:0
  v_perm_b32 v3, v50, v50, s31
  v_and_b32 v24, v28, v3
  v_and_b32 v25, v29, v3
  v_and_b32 v26, v30, v3
  v_and_b32 v27, v31, v3
  s_waitcnt vmcnt(17)
  s_nop 0
  v_mfma_f32_16x16x32_bf16 v[32:35], v[24:27], v[88:91], v[32:35]
  buffer_load_dwordx4 v[88:91], v7, s[8:11], s35 offen offset:1024
  v_perm_b32 v3, v51, v51, s30
  v_and_b32 v20, v28, v3
  v_and_b32 v21, v29, v3
  v_and_b32 v22, v30, v3
  v_and_b32 v23, v31, v3
  s_waitcnt vmcnt(16)
  s_nop 0
  v_mfma_f32_16x16x32_bf16 v[32:35], v[20:23], v[92:95], v[32:35]
  v_perm_b32 v3, v51, v51, s31
  v_and_b32 v24, v28, v3
  v_and_b32 v25, v29, v3
  v_and_b32 v26, v30, v3
  v_and_b32 v27, v31, v3
  s_waitcnt vmcnt(14)
  s_nop 0
  v_mfma_f32_16x16x32_bf16 v[32:35], v[24:27], v[96:99], v[32:35]
  v_lshrrev_b32 v2, 8, v0
  v_and_b32 v3, 0xf0, v0
  v_lshlrev_b32 v3, 1, v3
  v_lshl_add_u32 v3, v2, 4, v3
  s_lshl_b32 s26, s17, 9
  s_add_u32 s26, s26, 159744
  v_add_u32 v5, s26, v3
  s_mov_b32 exec_hi, 0
  ds_write_b128 v5, v[32:35]
  s_mov_b32 exec_hi, -1
  v_add_u32 v5, 159744, v1
  s_waitcnt lgkmcnt(0)
  s_barrier
  ds_read_b32 v36, v5 offset:0
  ds_read_b32 v37, v5 offset:256
  ds_read_b32 v38, v5 offset:512
  ds_read_b32 v39, v5 offset:768
  ds_read_b32 v40, v5 offset:1024
  ds_read_b32 v41, v5 offset:1280
  ds_read_b32 v42, v5 offset:1536
  ds_read_b32 v43, v5 offset:1792
  s_waitcnt lgkmcnt(0)
  v_add_f32 v36, v36, v38
  v_add_f32 v40, v40, v42
  v_add_f32 v36, v36, v40
  v_cvt_pk_bf16_f32 v36, 0, v36
  v_add_f32 v37, v37, v39
  v_add_f32 v41, v41, v43
  v_add_f32 v37, v37, v41
  v_cvt_pk_bf16_f32 v37, 0, v37
  v_mul_f32 v40, 0xbfb8aa3b, v36
  v_exp_f32 v40, v40
  s_nop 0
  v_add_f32 v40, 1.0, v40
  v_rcp_f32 v40, v40
  s_nop 0
  v_mul_f32 v36, v36, v40
  v_cvt_pk_bf16_f32 v36, 0, v36
  v_mul_f32 v36, v36, v37
  v_cvt_pk_bf16_f32 v36, v36, v36
  s_lshl_b32 s26, s17, 8
  s_add_u32 s26, s26, 161792
  v_add_u32 v5, s26, v1
  ds_write_b32 v5, v36
  v_mul_u32_u24 v5, 56, v2
  v_add_u32 v5, s26, v5
  ds_read_b64 v[36:37], v5 offset:0
  ds_read_b64 v[38:39], v5 offset:8
  ds_read_b64 v[40:41], v5 offset:16
  ds_read_b64 v[42:43], v5 offset:24
  ds_read_b64 v[44:45], v5 offset:32
  ds_read_b64 v[46:47], v5 offset:40
  ds_read_b64 v[48:49], v5 offset:48
  s_waitcnt lgkmcnt(0)
  v_and_b32 v20, v28, v36
  v_and_b32 v21, v29, v36
  v_and_b32 v22, v30, v36
  v_and_b32 v23, v31, v36
  s_waitcnt vmcnt(13)
  s_nop 0
  v_mfma_f32_16x16x32_bf16 v[32:35], v[20:23], v[100:103], 0
  v_and_b32 v24, v28, v37
  v_and_b32 v25, v29, v37
  v_and_b32 v26, v30, v37
  v_and_b32 v27, v31, v37
  s_waitcnt vmcnt(12)
  s_nop 0
  v_mfma_f32_16x16x32_bf16 v[32:35], v[24:27], v[104:107], v[32:35]
  v_and_b32 v20, v28, v38
  v_and_b32 v21, v29, v38
  v_and_b32 v22, v30, v38
  v_and_b32 v23, v31, v38
  s_waitcnt vmcnt(11)
  s_nop 0
  v_mfma_f32_16x16x32_bf16 v[32:35], v[20:23], v[108:111], v[32:35]
  v_and_b32 v24, v28, v39
  v_and_b32 v25, v29, v39
  v_and_b32 v26, v30, v39
  v_and_b32 v27, v31, v39
  s_waitcnt vmcnt(10)
  s_nop 0
  v_mfma_f32_16x16x32_bf16 v[32:35], v[24:27], v[112:115], v[32:35]
  v_and_b32 v20, v28, v40
  v_and_b32 v21, v29, v40
  v_and_b32 v22, v30, v40
  v_and_b32 v23, v31, v40
  s_waitcnt vmcnt(9)
  s_nop 0
  v_mfma_f32_16x16x32_bf16 v[32:35], v[20:23], v[60:63], v[32:35]
  v_and_b32 v24, v28, v41
  v_and_b32 v25, v29, v41
  v_and_b32 v26, v30, v41
  v_and_b32 v27, v31, v41
  s_waitcnt vmcnt(8)
  s_nop 0
  v_mfma_f32_16x16x32_bf16 v[32:35], v[24:27], v[52:55], v[32:35]
  v_and_b32 v20, v28, v42
  v_and_b32 v21, v29, v42
  v_and_b32 v22, v30, v42
  v_and_b32 v23, v31, v42
  s_waitcnt vmcnt(7)
  s_nop 0
  v_mfma_f32_16x16x32_bf16 v[32:35], v[20:23], v[56:59], v[32:35]
  v_and_b32 v24, v28, v43
  v_and_b32 v25, v29, v43
  v_and_b32 v26, v30, v43
  v_and_b32 v27, v31, v43
  s_waitcnt vmcnt(6)
  s_nop 0
  v_mfma_f32_16x16x32_bf16 v[32:35], v[24:27], v[64:67], v[32:35]
  v_and_b32 v20, v28, v44
  v_and_b32 v21, v29, v44
  v_and_b32 v22, v30, v44
  v_and_b32 v23, v31, v44
  s_waitcnt vmcnt(5)
  s_nop 0
  v_mfma_f32_16x16x32_bf16 v[32:35], v[20:23], v[68:71], v[32:35]
  v_and_b32 v24, v28, v45
  v_and_b32 v25, v29, v45
  v_and_b32 v26, v30, v45
  v_and_b32 v27, v31, v45
  s_waitcnt vmcnt(4)
  s_nop 0
  v_mfma_f32_16x16x32_bf16 v[32:35], v[24:27], v[72:75], v[32:35]
  v_and_b32 v20, v28, v46
  v_and_b32 v21, v29, v46
  v_and_b32 v22, v30, v46
  v_and_b32 v23, v31, v46
  s_waitcnt vmcnt(3)
  s_nop 0
  v_mfma_f32_16x16x32_bf16 v[32:35], v[20:23], v[76:79], v[32:35]
  v_and_b32 v24, v28, v47
  v_and_b32 v25, v29, v47
  v_and_b32 v26, v30, v47
  v_and_b32 v27, v31, v47
  s_waitcnt vmcnt(2)
  s_nop 0
  v_mfma_f32_16x16x32_bf16 v[32:35], v[24:27], v[80:83], v[32:35]
  v_and_b32 v20, v28, v48
  v_and_b32 v21, v29, v48
  v_and_b32 v22, v30, v48
  v_and_b32 v23, v31, v48
  s_waitcnt vmcnt(1)
  s_nop 0
  v_mfma_f32_16x16x32_bf16 v[32:35], v[20:23], v[84:87], v[32:35]
  v_and_b32 v24, v28, v49
  v_and_b32 v25, v29, v49
  v_and_b32 v26, v30, v49
  v_and_b32 v27, v31, v49
  s_waitcnt vmcnt(0)
  s_nop 0
  v_mfma_f32_16x16x32_bf16 v[32:35], v[24:27], v[88:91], v[32:35]
  v_lshrrev_b32 v3, 1, v3
  s_lshl_b32 s26, s47, 7
  s_add_u32 s26, s26, s57
  s_lshl_b32 s26, s26, 8
  s_add_u32 s26, s26, 244318208
  s_nop 2
  v_cvt_pk_bf16_f32 v32, v32, v33
  v_cvt_pk_bf16_f32 v33, v34, v35
  v_min_u32 v32, -2, v32
  v_min_u32 v33, -2, v33
  s_mov_b32 exec_hi, 0
  buffer_store_dwordx2 v[32:33], v3, s[4:7], s26 offen sc1
  s_mov_b32 exec_hi, -1
  v_lshrrev_b32 v7, 7, v0
  v_lshlrev_b32 v7, 12, v7
  v_and_b32 v2, 1023, v9
  s_lshl_b32 s26, s17, 10
  v_add3_u32 v7, v7, v2, s26
  v_mov_b32 v116, 0
  s_branch q_cold_65
q_patch_62:
  s_lshl_b32 s26, s61, 21
  s_lshl_b32 s27, s59, 10
  s_add_u32 s26, s26, s27
  s_add_u32 s27, s26, 20971520
  s_add_u32 s28, s26, 27262976
  s_lshl_b32 s26, s46, 7
  s_add_u32 s26, s26, s17
  s_lshl_b32 s26, s26, 8
  s_add_u32 s26, s26, 244318208
  v_lshrrev_b32 v2, 8, v0
  v_and_b32 v3, 0xf0, v0
  v_lshl_add_u32 v5, v2, 10, v3
  buffer_load_dwordx4 v[36:39], v0, s[4:7], s27 offen sc1
  buffer_load_dwordx4 v[40:43], v0, s[4:7], s28 offen sc1
  s_mov_b32 s53, 0
m_w_72:
  s_add_u32 s27, s26, 0
  buffer_load_dwordx4 v[60:63], v5, s[4:7], s27 offen sc1
  s_add_u32 s27, s26, 4096
  buffer_load_dwordx4 v[64:67], v5, s[4:7], s27 offen sc1
  s_add_u32 s27, s26, 8192
  buffer_load_dwordx4 v[68:71], v5, s[4:7], s27 offen sc1
  s_add_u32 s27, s26, 12288
  buffer_load_dwordx4 v[72:75], v5, s[4:7], s27 offen sc1
  s_add_u32 s27, s26, 16384
  buffer_load_dwordx4 v[76:79], v5, s[4:7], s27 offen sc1
  s_add_u32 s27, s26, 20480
  buffer_load_dwordx4 v[80:83], v5, s[4:7], s27 offen sc1
  s_add_u32 s27, s26, 24576
  buffer_load_dwordx4 v[84:87], v5, s[4:7], s27 offen sc1
  s_add_u32 s27, s26, 28672
  buffer_load_dwordx4 v[88:91], v5, s[4:7], s27 offen sc1
  s_add_u32 s53, s53, 1
  s_cmp_gt_u32 s53, 1048576
  s_cbranch_scc1 q_fail_61
  s_mov_b32 vcc_lo, 0xaaaaaaaa
  s_mov_b32 vcc_hi, 0xaaaaaaaa
  v_mov_b32 v28, 0x3f80
  v_mov_b32 v20, 1.0
  v_cndmask_b32 v28, v28, v20, vcc
  s_mov_b32 vcc_lo, 0x30003
  s_mov_b32 vcc_hi, 0x30003
  v_cndmask_b32 v20, 0, v28, vcc
  s_mov_b32 vcc_lo, 0xc000c
  s_mov_b32 vcc_hi, 0xc000c
  v_cndmask_b32 v21, 0, v28, vcc
  s_mov_b32 vcc_lo, 0x300030
  s_mov_b32 vcc_hi, 0x300030
  v_cndmask_b32 v22, 0, v28, vcc
  s_mov_b32 vcc_lo, 0xc000c0
  s_mov_b32 vcc_hi, 0xc000c0
  v_cndmask_b32 v23, 0, v28, vcc
  s_waitcnt vmcnt(7)
  s_nop 0
  v_mfma_f32_16x16x32_bf16 v[28:31], v[20:23], v[60:63], 0
  v_max3_u32 v44, v60, v61, 0
  v_max3_u32 v44, v62, v63, v44
  s_waitcnt vmcnt(6)
  v_mfma_f32_16x16x32_bf16 v[28:31], v[20:23], v[64:67], v[28:31]
  v_max3_u32 v44, v64, v65, v44
  v_max3_u32 v44, v66, v67, v44
  s_waitcnt vmcnt(5)
  v_mfma_f32_16x16x32_bf16 v[28:31], v[20:23], v[68:71], v[28:31]
  v_max3_u32 v44, v68, v69, v44
  v_max3_u32 v44, v70, v71, v44
  s_waitcnt vmcnt(4)
  v_mfma_f32_16x16x32_bf16 v[28:31], v[20:23], v[72:75], v[28:31]
  v_max3_u32 v44, v72, v73, v44
  v_max3_u32 v44, v74, v75, v44
  s_waitcnt vmcnt(3)
  v_mfma_f32_16x16x32_bf16 v[28:31], v[20:23], v[76:79], v[28:31]
  v_max3_u32 v44, v76, v77, v44
  v_max3_u32 v44, v78, v79, v44
  s_waitcnt vmcnt(2)
  v_mfma_f32_16x16x32_bf16 v[28:31], v[20:23], v[80:83], v[28:31]
  v_max3_u32 v44, v80, v81, v44
  v_max3_u32 v44, v82, v83, v44
  s_waitcnt vmcnt(1)
  v_mfma_f32_16x16x32_bf16 v[28:31], v[20:23], v[84:87], v[28:31]
  v_max3_u32 v44, v84, v85, v44
  v_max3_u32 v44, v86, v87, v44
  s_waitcnt vmcnt(0)
  v_mfma_f32_16x16x32_bf16 v[28:31], v[20:23], v[88:91], v[28:31]
  v_max3_u32 v44, v88, v89, v44
  v_max3_u32 v44, v90, v91, v44
  v_cmp_eq_u32 vcc, -1, v44
  s_cbranch_vccnz m_w_72
  v_lshlrev_b32 v3, 1, v3
  v_lshl_add_u32 v3, v2, 4, v3
  s_lshl_b32 s26, s17, 9
  s_add_u32 s26, s26, 159744
  v_add_u32 v3, s26, v3
  s_mov_b32 exec_hi, 0
  ds_write_b128 v3, v[28:31]
  s_mov_b32 exec_hi, -1
  v_lshlrev_b32 v3, 1, v0
  v_add_u32 v3, 159744, v3
  v_lshlrev_b32 v44, 16, v36
  v_and_b32 v45, 0xffff0000, v36
  v_lshlrev_b32 v46, 16, v37
  v_and_b32 v47, 0xffff0000, v37
  v_lshlrev_b32 v48, 16, v38
  v_and_b32 v49, 0xffff0000, v38
  v_lshlrev_b32 v50, 16, v39
  v_and_b32 v51, 0xffff0000, v39
  v_lshlrev_b32 v52, 16, v40
  v_and_b32 v53, 0xffff0000, v40
  v_lshlrev_b32 v54, 16, v41
  v_and_b32 v55, 0xffff0000, v41
  v_lshlrev_b32 v56, 16, v42
  v_and_b32 v57, 0xffff0000, v42
  v_lshlrev_b32 v58, 16, v43
  v_and_b32 v59, 0xffff0000, v43
  s_waitcnt lgkmcnt(0)
  s_barrier
  s_cmp_lg_u32 s17, 0
  s_cbranch_scc1 m_done_71
  ds_read_b128 v[28:31], v3
  ds_read_b128 v[32:35], v3 offset:16
  s_and_b32 s29, s58, 0xffff0000
  s_xor_b32 s27, s29, 0x80000000
  s_xor_b32 s28, s29, 0xffff0000
  s_bitcmp1_b32 s29, 31
  s_cselect_b32 s29, s27, s28
  v_mov_b32 v36, s29
  v_mul_f32 v36, 0xbfb8aa3b, v36
  v_exp_f32 v36, v36
  s_nop 0
  v_add_f32 v36, 1.0, v36
  v_rcp_f32 v36, v36
  s_nop 0
  v_cvt_pk_bf16_f32 v36, 0, v36
  s_waitcnt lgkmcnt(0)
  v_cvt_pk_bf16_f32 v28, 0, v28
  v_cvt_pk_bf16_f32 v29, 0, v29
  v_cvt_pk_bf16_f32 v30, 0, v30
  v_cvt_pk_bf16_f32 v31, 0, v31
  v_cvt_pk_bf16_f32 v32, 0, v32
  v_cvt_pk_bf16_f32 v33, 0, v33
  v_cvt_pk_bf16_f32 v34, 0, v34
  v_cvt_pk_bf16_f32 v35, 0, v35
  v_mul_f32 v28, v28, v36
  v_mul_f32 v29, v29, v36
  v_mul_f32 v30, v30, v36
  v_mul_f32 v31, v31, v36
  v_mul_f32 v32, v32, v36
  v_mul_f32 v33, v33, v36
  v_mul_f32 v34, v34, v36
  v_mul_f32 v35, v35, v36
  v_cvt_pk_bf16_f32 v28, 0, v28
  v_cvt_pk_bf16_f32 v29, 0, v29
  v_cvt_pk_bf16_f32 v30, 0, v30
  v_cvt_pk_bf16_f32 v31, 0, v31
  v_cvt_pk_bf16_f32 v32, 0, v32
  v_cvt_pk_bf16_f32 v33, 0, v33
  v_cvt_pk_bf16_f32 v34, 0, v34
  v_cvt_pk_bf16_f32 v35, 0, v35
  v_add_f32 v28, v28, v52
  v_add_f32 v29, v29, v53
  v_add_f32 v30, v30, v54
  v_add_f32 v31, v31, v55
  v_add_f32 v32, v32, v56
  v_add_f32 v33, v33, v57
  v_add_f32 v34, v34, v58
  v_add_f32 v35, v35, v59
  v_cvt_pk_bf16_f32 v28, 0, v28
  v_cvt_pk_bf16_f32 v29, 0, v29
  v_cvt_pk_bf16_f32 v30, 0, v30
  v_cvt_pk_bf16_f32 v31, 0, v31
  v_cvt_pk_bf16_f32 v32, 0, v32
  v_cvt_pk_bf16_f32 v33, 0, v33
  v_cvt_pk_bf16_f32 v34, 0, v34
  v_cvt_pk_bf16_f32 v35, 0, v35
  v_add_f32 v44, v44, v28
  v_add_f32 v45, v45, v29
  v_add_f32 v46, v46, v30
  v_add_f32 v47, v47, v31
  v_add_f32 v48, v48, v32
  v_add_f32 v49, v49, v33
  v_add_f32 v50, v50, v34
  v_add_f32 v51, v51, v35
  v_cvt_pk_bf16_f32 v40, v44, v45
  v_cvt_pk_bf16_f32 v41, v46, v47
  v_cvt_pk_bf16_f32 v42, v48, v49
  v_cvt_pk_bf16_f32 v43, v50, v51
  v_lshlrev_b32 v44, 16, v40
  v_and_b32 v45, 0xffff0000, v40
  v_lshlrev_b32 v46, 16, v41
  v_and_b32 v47, 0xffff0000, v41
  v_lshlrev_b32 v48, 16, v42
  v_and_b32 v49, 0xffff0000, v42
  v_lshlrev_b32 v50, 16, v43
  v_and_b32 v51, 0xffff0000, v43
  s_lshl_b32 s27, s46, 5
  s_add_u32 s27, s27, s16
  s_lshl_b32 s27, s27, 10
  s_add_u32 s27, s27, 33554432
  buffer_store_dwordx4 v[40:43], v0, s[4:7], s27 offen sc1
  v_add_f32 v60, v44, v45
  v_mul_f32 v61, v44, v44
  v_add_f32 v62, v46, v47
  v_mul_f32 v63, v45, v45
  v_fmac_f32 v61, v46, v46
  v_fmac_f32 v63, v47, v47
  v_add_f32 v60, v60, v48
  v_fmac_f32 v61, v48, v48
  v_add_f32 v62, v62, v49
  v_fmac_f32 v63, v49, v49
  v_add_f32 v60, v60, v50
  v_fmac_f32 v61, v50, v50
  v_add_f32 v62, v62, v51
  v_fmac_f32 v63, v51, v51
  v_add_f32 v60, v60, v62
  v_add_f32 v61, v61, v63
  s_nop 0
  v_add_f32_dpp v60, v60, v60 row_ror:8 row_mask:0xf bank_mask:0xf
  v_add_f32_dpp v61, v61, v61 row_ror:8 row_mask:0xf bank_mask:0xf
  s_nop 0
  v_add_f32_dpp v60, v60, v60 row_ror:4 row_mask:0xf bank_mask:0xf
  v_add_f32_dpp v61, v61, v61 row_ror:4 row_mask:0xf bank_mask:0xf
  s_nop 0
  v_add_f32_dpp v60, v60, v60 row_ror:2 row_mask:0xf bank_mask:0xf
  v_add_f32_dpp v61, v61, v61 row_ror:2 row_mask:0xf bank_mask:0xf
  s_nop 0
  v_add_f32_dpp v60, v60, v60 row_ror:1 row_mask:0xf bank_mask:0xf
  v_add_f32_dpp v61, v61, v61 row_ror:1 row_mask:0xf bank_mask:0xf
  v_mov_b32 v64, v60
  v_mov_b32 v65, v61
  s_nop 0
  v_permlane16_swap_b32 v60, v64
  v_permlane16_swap_b32 v61, v65
  v_add_f32 v60, v60, v64
  v_add_f32 v61, v61, v65
  v_mov_b32 v64, v60
  v_mov_b32 v65, v61
  s_nop 0
  v_permlane32_swap_b32 v60, v64
  v_permlane32_swap_b32 v61, v65
  v_add_f32 v60, v60, v64
  v_add_f32 v61, v61, v65
  v_mul_f32 v60, 0x3b000000, v60
  v_mul_f32 v61, 0x3b000000, v61
  v_fma_f32 v61, -v60, v60, v61
  v_cvt_pk_bf16_f32 v60, 0, v60
  v_max_f32 v61, 0, v61
  v_sub_f32 v64, v44, v60
  v_sub_f32 v65, v45, v60
  v_cvt_pk_bf16_f32 v61, 0, v61
  v_sub_f32 v66, v46, v60
  v_sub_f32 v67, v47, v60
  v_add_f32 v61, 0x3727c5ac, v61
  v_sub_f32 v68, v48, v60
  v_sub_f32 v69, v49, v60
  v_cvt_pk_bf16_f32 v61, 0, v61
  v_sub_f32 v70, v50, v60
  v_sub_f32 v71, v51, v60
  v_sqrt_f32 v61, v61
  v_cvt_pk_bf16_f32 v64, 0, v64
  v_cvt_pk_bf16_f32 v65, 0, v65
  v_cvt_pk_bf16_f32 v61, 0, v61
  v_cvt_pk_bf16_f32 v66, 0, v66
  v_cvt_pk_bf16_f32 v67, 0, v67
  v_rcp_f32 v61, v61
  v_cvt_pk_bf16_f32 v68, 0, v68
  v_cvt_pk_bf16_f32 v69, 0, v69
  v_cvt_pk_bf16_f32 v70, 0, v70
  v_cvt_pk_bf16_f32 v71, 0, v71
  v_mul_f32 v64, v64, v61
  v_mul_f32 v65, v65, v61
  v_mul_f32 v66, v66, v61
  v_mul_f32 v67, v67, v61
  v_mul_f32 v68, v68, v61
  v_mul_f32 v69, v69, v61
  v_mul_f32 v70, v70, v61
  v_mul_f32 v71, v71, v61
  v_cvt_pk_bf16_f32 v72, v64, v65
  v_cvt_pk_bf16_f32 v73, v66, v67
  v_cvt_pk_bf16_f32 v74, v68, v69
  v_cvt_pk_bf16_f32 v75, v70, v71
  s_and_b32 s26, s59, 31
  s_lshl_b32 s27, s26, 10
  s_add_u32 s27, s27, s50
  s_and_b32 s26, s26, 15
  s_lshl_b32 s26, s26, 4
  s_or_b32 s26, s26, s27
  v_xor_b32 v3, s26, v0
  ds_write_b128 v3, v[72:75]
m_done_71:
  s_mov_b32 s62, 0
  s_mov_b32 s40, s47
  s_add_u32 s47, s46, 64
  s_sub_u32 s26, s76, 55
  s_cmp_lt_u32 s40, 64
  s_cselect_b32 s26, s26, 255
  s_cmp_ge_u32 s40, s26
  s_cbranch_scc1 q_cold_65
  s_mov_b32 s76, s40
  s_mov_b32 s40, s77
  s_mov_b32 s41, s78
  s_mov_b32 s42, s79
  s_branch q_cold_65
q_end_58:
  s_waitcnt vmcnt(0)
  s_mov_b64 exec, 1
  buffer_store_dword v4, off, s[4:7], s49 sc1
  s_mov_b64 exec, -1
  s_cmp_lg_u32 s60, 0
  s_cbranch_scc1 q_fail_61
  s_load_dwordx2 s[72:73], s[0:1], 96
  s_mov_b32 s74, 2097152
  s_mov_b32 s75, 0x20000
  s_load_dwordx2 s[64:65], s[0:1], 72
  s_load_dwordx2 s[68:69], s[0:1], 80
  s_load_dwordx2 s[8:9], s[0:1], 88
  s_mov_b32 s66, 1835008
  s_mov_b32 s70, 1835008
  s_mov_b32 s10, 1835008
  v_lshrrev_b32 v2, 8, v0
  v_and_b32 v3, 0x70, v0
  s_mov_b32 s26, 114688
  v_mul_lo_u32 v6, v2, s26
  v_add_u32 v6, v6, v3
  v_cmp_eq_u32 vcc, 0x70, v3
  v_mov_b32 v3, 0x7ff00000
  s_nop 0
  v_cndmask_b32 v6, v6, v3, vcc
  v_mul_u32_u24 v7, 14336, v2
  v_and_b32 v3, 0xf0, v0
  v_add_u32 v7, v7, v3
  s_mul_i32 s34, s17, 458752
  s_mul_i32 s27, s16, 112
  s_add_u32 s34, s34, s27
  s_add_u32 s34, s34, 82432
  s_mul_i32 s35, s16, 57344
  s_lshl_b32 s27, s17, 8
  s_add_u32 s35, s35, s27
  s_mov_b32 s36, 0x00ff00ff
  s_mov_b32 s37, 0x00ff00ff
  s_waitcnt lgkmcnt(0)
  s_mov_b64 exec, s[36:37]
  buffer_load_dwordx4 a[0:3], v6, s[64:67], s34 offen
  s_not_b64 exec, exec
  buffer_load_dwordx4 a[0:3], v6, s[68:71], s34 offen
  s_mov_b64 exec, -1
  s_add_u32 s34, s34, 3584
  s_mov_b64 exec, s[36:37]
  buffer_load_dwordx4 a[4:7], v6, s[64:67], s34 offen
  s_not_b64 exec, exec
  buffer_load_dwordx4 a[4:7], v6, s[68:71], s34 offen
  s_mov_b64 exec, -1
  s_add_u32 s34, s34, 3584
  s_mov_b64 exec, s[36:37]
  buffer_load_dwordx4 a[8:11], v6, s[64:67], s34 offen
  s_not_b64 exec, exec
  buffer_load_dwordx4 a[8:11], v6, s[68:71], s34 offen
  s_mov_b64 exec, -1
  s_add_u32 s34, s34, 3584
  s_mov_b64 exec, s[36:37]
  buffer_load_dwordx4 a[12:15], v6, s[64:67], s34 offen
  s_not_b64 exec, exec
  buffer_load_dwordx4 a[12:15], v6, s[68:71], s34 offen
  s_mov_b64 exec, -1
  s_add_u32 s34, s34, 3584
  s_mov_b64 exec, s[36:37]
  buffer_load_dwordx4 a[16:19], v6, s[64:67], s34 offen
  s_not_b64 exec, exec
  buffer_load_dwordx4 a[16:19], v6, s[68:71], s34 offen
  s_mov_b64 exec, -1
  s_add_u32 s34, s34, 3584
  s_mov_b64 exec, s[36:37]
  buffer_load_dwordx4 a[20:23], v6, s[64:67], s34 offen
  s_not_b64 exec, exec
  buffer_load_dwordx4 a[20:23], v6, s[68:71], s34 offen
  s_mov_b64 exec, -1
  s_add_u32 s34, s34, 3584
  s_mov_b64 exec, s[36:37]
  buffer_load_dwordx4 a[24:27], v6, s[64:67], s34 offen
  s_not_b64 exec, exec
  buffer_load_dwordx4 a[24:27], v6, s[68:71], s34 offen
  s_mov_b64 exec, -1
  s_add_u32 s34, s34, 3584
  s_mov_b64 exec, s[36:37]
  buffer_load_dwordx4 a[28:31], v6, s[64:67], s34 offen
  s_not_b64 exec, exec
  buffer_load_dwordx4 a[28:31], v6, s[68:71], s34 offen
  s_mov_b64 exec, -1
  s_add_u32 s34, s34, 3584
  s_mov_b64 exec, s[36:37]
  buffer_load_dwordx4 a[32:35], v6, s[64:67], s34 offen
  s_not_b64 exec, exec
  buffer_load_dwordx4 a[32:35], v6, s[68:71], s34 offen
  s_mov_b64 exec, -1
  s_add_u32 s34, s34, 3584
  buffer_load_dwordx4 a[36:39], v7, s[8:11], s35 offen offset:0
  buffer_load_dwordx4 a[40:43], v7, s[8:11], s35 offen offset:1024
  buffer_load_dwordx4 a[44:47], v7, s[8:11], s35 offen offset:2048
  buffer_load_dwordx4 a[48:51], v7, s[8:11], s35 offen offset:3072
  s_add_u32 s35, s35, 4096
  buffer_load_dwordx4 a[52:55], v7, s[8:11], s35 offen offset:0
  buffer_load_dwordx4 a[56:59], v7, s[8:11], s35 offen offset:1024
  buffer_load_dwordx4 a[60:63], v7, s[8:11], s35 offen offset:2048
  buffer_load_dwordx4 a[64:67], v7, s[8:11], s35 offen offset:3072
  s_add_u32 s35, s35, 4096
  buffer_load_dwordx4 a[68:71], v7, s[8:11], s35 offen offset:0
  buffer_load_dwordx4 a[72:75], v7, s[8:11], s35 offen offset:1024
  buffer_load_dwordx4 a[76:79], v7, s[8:11], s35 offen offset:2048
  buffer_load_dwordx4 a[80:83], v7, s[8:11], s35 offen offset:3072
  s_add_u32 s35, s35, 4096
  buffer_load_dwordx4 a[84:87], v7, s[8:11], s35 offen offset:0
  buffer_load_dwordx4 a[88:91], v7, s[8:11], s35 offen offset:1024
  s_andn2_b32 s28, 0xfe0, s56
  s_lshl_b32 s28, s28, 7
  s_mov_b32 s29, 243793920
  v_mov_b32 v24, 262144
  s_mov_b32 s53, 0
  s_mov_b32 s26, 0
  v_mov_b32 v53, 0
k_w_74:
  s_add_u32 s27, s26, 8192
  v_add_u32 v22, s26, v9
  v_cmp_le_u32 vcc, s28, v22
  s_nop 1
  v_cndmask_b32 v25, 0, v24, vcc
  v_add_u32 v22, v22, v25
  buffer_load_dword v20, v22, s[4:7], s29 offen sc1
  v_add_u32 v23, s27, v9
  v_cmp_le_u32 vcc, s28, v23
  s_nop 1
  v_cndmask_b32 v25, 0, v24, vcc
  v_add_u32 v23, v23, v25
  buffer_load_dword v21, v23, s[4:7], s29 offen sc1
  s_add_u32 s53, s53, 1
  s_cmp_gt_u32 s53, 1048576
  s_cbranch_scc1 q_fail_61
  s_waitcnt vmcnt(0)
  v_min_u32 v52, v20, v21
  v_max3_u32 v53, v20, v21, v53
  v_cmp_eq_u32 vcc, 0, v52
  s_cbranch_vccnz k_w_74
  s_add_u32 s26, s26, 16384
  s_cmp_lt_u32 s26, 262144
  s_cbranch_scc1 k_w_74
  v_max_u32_dpp v53, v53, v53 row_ror:8 row_mask:0xf bank_mask:0xf
  s_nop 1
  v_max_u32_dpp v53, v53, v53 row_ror:4 row_mask:0xf bank_mask:0xf
  s_nop 1
  v_max_u32_dpp v53, v53, v53 row_ror:2 row_mask:0xf bank_mask:0xf
  s_nop 1
  v_max_u32_dpp v53, v53, v53 row_ror:1 row_mask:0xf bank_mask:0xf
  v_mov_b32 v52, v53
  s_nop 0
  s_nop 0
  v_permlane16_swap_b32 v53, v52
  v_max_u32 v53, v53, v52
  v_mov_b32 v52, v53
  s_nop 0
  s_nop 0
  v_permlane32_swap_b32 v53, v52
  v_max_u32 v53, v53, v52
  s_nop 0
  v_readfirstlane_b32 s58, v53
  s_andn2_b32 s26, 0xfe0, s56
  s_andn2_b32 s27, 0xfe0, s58
  s_cmp_lt_u32 s27, s26
  s_cselect_b32 s61, 1, 2
  s_andn2_b32 s59, 0xfff, s58
  s_lshl_b32 s26, s61, 21
  s_lshl_b32 s27, s59, 10
  s_add_u32 s26, s26, s27
  s_lshl_b32 s27, s17, 8
  s_add_u32 s26, s26, s27
  s_add_u32 s26, s26, 27262976
  v_lshrrev_b32 v3, 8, v0
  v_lshlrev_b32 v3, 6, v3
  buffer_load_dwordx4 v[36:39], v3, s[4:7], s26 offen offset:0 sc1
  buffer_load_dwordx4 v[40:43], v3, s[4:7], s26 offen offset:16 sc1
  buffer_load_dwordx4 v[44:47], v3, s[4:7], s26 offen offset:32 sc1
  buffer_load_dwordx4 v[48:51], v3, s[4:7], s26 offen offset:48 sc1
  s_mov_b32 vcc_lo, 0xaaaaaaaa
  s_mov_b32 vcc_hi, 0xaaaaaaaa
  v_mov_b32 v3, 0xffff
  v_mov_b32 v28, 0xffff0000
  v_cndmask_b32 v3, v3, v28, vcc
  s_mov_b32 vcc_lo, 0x30003
  s_mov_b32 vcc_hi, 0x30003
  v_cndmask_b32 v28, 0, v3, vcc
  s_mov_b32 vcc_lo, 0xc000c
  s_mov_b32 vcc_hi, 0xc000c
  v_cndmask_b32 v29, 0, v3, vcc
  s_mov_b32 vcc_lo, 0x300030
  s_mov_b32 vcc_hi, 0x300030
  v_cndmask_b32 v30, 0, v3, vcc
  s_mov_b32 vcc_lo, 0xc000c0
  s_mov_b32 vcc_hi, 0xc000c0
  v_cndmask_b32 v31, 0, v3, vcc
  s_mov_b32 s30, 0x01000100
  s_mov_b32 s31, 0x03020302
  s_mul_i32 s26, s17, 23552
  s_add_u32 s26, s26, 65536
  v_add_u32 v5, s26, v0
  ds_read_b128 v[52:55], v5 offset:0
  ds_read_b128 v[56:59], v5 offset:1024
  ds_read_b128 v[60:63], v5 offset:2048
  s_waitcnt vmcnt(0)
  v_perm_b32 v3, v36, v36, s30
  v_and_b32 v20, v28, v3
  v_and_b32 v21, v29, v3
  v_and_b32 v22, v30, v3
  v_and_b32 v23, v31, v3
  s_waitcnt lgkmcnt(2)
  s_nop 0
  v_mfma_f32_16x16x32_bf16 v[32:35], v[20:23], v[52:55], 0
  ds_read_b128 v[52:55], v5 offset:3072
  v_perm_b32 v3, v36, v36, s31
  v_and_b32 v24, v28, v3
  v_and_b32 v25, v29, v3
  v_and_b32 v26, v30, v3
  v_and_b32 v27, v31, v3
  s_waitcnt lgkmcnt(2)
  s_nop 0
  v_mfma_f32_16x16x32_bf16 v[32:35], v[24:27], v[56:59], v[32:35]
  ds_read_b128 v[56:59], v5 offset:4096
  v_perm_b32 v3, v37, v37, s30
  v_and_b32 v20, v28, v3
  v_and_b32 v21, v29, v3
  v_and_b32 v22, v30, v3
  v_and_b32 v23, v31, v3
  s_waitcnt lgkmcnt(2)
  s_nop 0
  v_mfma_f32_16x16x32_bf16 v[32:35], v[20:23], v[60:63], v[32:35]
  ds_read_b128 v[60:63], v5 offset:5120
  v_perm_b32 v3, v37, v37, s31
  v_and_b32 v24, v28, v3
  v_and_b32 v25, v29, v3
  v_and_b32 v26, v30, v3
  v_and_b32 v27, v31, v3
  s_waitcnt lgkmcnt(2)
  s_nop 0
  v_mfma_f32_16x16x32_bf16 v[32:35], v[24:27], v[52:55], v[32:35]
  ds_read_b128 v[52:55], v5 offset:6144
  v_perm_b32 v3, v38, v38, s30
  v_and_b32 v20, v28, v3
  v_and_b32 v21, v29, v3
  v_and_b32 v22, v30, v3
  v_and_b32 v23, v31, v3
  s_waitcnt lgkmcnt(2)
  s_nop 0
  v_mfma_f32_16x16x32_bf16 v[32:35], v[20:23], v[56:59], v[32:35]
  ds_read_b128 v[56:59], v5 offset:7168
  v_perm_b32 v3, v38, v38, s31
  v_and_b32 v24, v28, v3
  v_and_b32 v25, v29, v3
  v_and_b32 v26, v30, v3
  v_and_b32 v27, v31, v3
  s_waitcnt lgkmcnt(2)
  s_nop 0
  v_mfma_f32_16x16x32_bf16 v[32:35], v[24:27], v[60:63], v[32:35]
  ds_read_b128 v[60:63], v5 offset:8192
  v_perm_b32 v3, v39, v39, s30
  v_and_b32 v20, v28, v3
  v_and_b32 v21, v29, v3
  v_and_b32 v22, v30, v3
  v_and_b32 v23, v31, v3
  s_waitcnt lgkmcnt(2)
  s_nop 0
  v_mfma_f32_16x16x32_bf16 v[32:35], v[20:23], v[52:55], v[32:35]
  ds_read_b128 v[52:55], v5 offset:9216
  v_perm_b32 v3, v39, v39, s31
  v_and_b32 v24, v28, v3
  v_and_b32 v25, v29, v3
  v_and_b32 v26, v30, v3
  v_and_b32 v27, v31, v3
  s_waitcnt lgkmcnt(2)
  s_nop 0
  v_mfma_f32_16x16x32_bf16 v[32:35], v[24:27], v[56:59], v[32:35]
  ds_read_b128 v[56:59], v5 offset:10240
  v_perm_b32 v3, v40, v40, s30
  v_and_b32 v20, v28, v3
  v_and_b32 v21, v29, v3
  v_and_b32 v22, v30, v3
  v_and_b32 v23, v31, v3
  s_waitcnt lgkmcnt(2)
  s_nop 0
  v_mfma_f32_16x16x32_bf16 v[32:35], v[20:23], v[60:63], v[32:35]
  ds_read_b128 v[60:63], v5 offset:11264
  v_perm_b32 v3, v40, v40, s31
  v_and_b32 v24, v28, v3
  v_and_b32 v25, v29, v3
  v_and_b32 v26, v30, v3
  v_and_b32 v27, v31, v3
  s_waitcnt lgkmcnt(2)
  s_nop 0
  v_mfma_f32_16x16x32_bf16 v[32:35], v[24:27], v[52:55], v[32:35]
  ds_read_b128 v[52:55], v5 offset:12288
  v_perm_b32 v3, v41, v41, s30
  v_and_b32 v20, v28, v3
  v_and_b32 v21, v29, v3
  v_and_b32 v22, v30, v3
  v_and_b32 v23, v31, v3
  s_waitcnt lgkmcnt(2)
  s_nop 0
  v_mfma_f32_16x16x32_bf16 v[32:35], v[20:23], v[56:59], v[32:35]
  ds_read_b128 v[56:59], v5 offset:13312
  v_perm_b32 v3, v41, v41, s31
  v_and_b32 v24, v28, v3
  v_and_b32 v25, v29, v3
  v_and_b32 v26, v30, v3
  v_and_b32 v27, v31, v3
  s_waitcnt lgkmcnt(2)
  s_nop 0
  v_mfma_f32_16x16x32_bf16 v[32:35], v[24:27], v[60:63], v[32:35]
  ds_read_b128 v[60:63], v5 offset:14336
  v_perm_b32 v3, v42, v42, s30
  v_and_b32 v20, v28, v3
  v_and_b32 v21, v29, v3
  v_and_b32 v22, v30, v3
  v_and_b32 v23, v31, v3
  s_waitcnt lgkmcnt(2)
  s_nop 0
  v_mfma_f32_16x16x32_bf16 v[32:35], v[20:23], v[52:55], v[32:35]
  ds_read_b128 v[52:55], v5 offset:15360
  v_perm_b32 v3, v42, v42, s31
  v_and_b32 v24, v28, v3
  v_and_b32 v25, v29, v3
  v_and_b32 v26, v30, v3
  v_and_b32 v27, v31, v3
  s_waitcnt lgkmcnt(2)
  s_nop 0
  v_mfma_f32_16x16x32_bf16 v[32:35], v[24:27], v[56:59], v[32:35]
  ds_read_b128 v[56:59], v5 offset:16384
  v_perm_b32 v3, v43, v43, s30
  v_and_b32 v20, v28, v3
  v_and_b32 v21, v29, v3
  v_and_b32 v22, v30, v3
  v_and_b32 v23, v31, v3
  s_waitcnt lgkmcnt(2)
  s_nop 0
  v_mfma_f32_16x16x32_bf16 v[32:35], v[20:23], v[60:63], v[32:35]
  ds_read_b128 v[60:63], v5 offset:17408
  v_perm_b32 v3, v43, v43, s31
  v_and_b32 v24, v28, v3
  v_and_b32 v25, v29, v3
  v_and_b32 v26, v30, v3
  v_and_b32 v27, v31, v3
  s_waitcnt lgkmcnt(2)
  s_nop 0
  v_mfma_f32_16x16x32_bf16 v[32:35], v[24:27], v[52:55], v[32:35]
  ds_read_b128 v[52:55], v5 offset:18432
  v_perm_b32 v3, v44, v44, s30
  v_and_b32 v20, v28, v3
  v_and_b32 v21, v29, v3
  v_and_b32 v22, v30, v3
  v_and_b32 v23, v31, v3
  s_waitcnt lgkmcnt(2)
  s_nop 0
  v_mfma_f32_16x16x32_bf16 v[32:35], v[20:23], v[56:59], v[32:35]
  ds_read_b128 v[56:59], v5 offset:19456
  v_perm_b32 v3, v44, v44, s31
  v_and_b32 v24, v28, v3
  v_and_b32 v25, v29, v3
  v_and_b32 v26, v30, v3
  v_and_b32 v27, v31, v3
  s_waitcnt lgkmcnt(2)
  s_nop 0
  v_mfma_f32_16x16x32_bf16 v[32:35], v[24:27], v[60:63], v[32:35]
  ds_read_b128 v[60:63], v5 offset:20480
  v_perm_b32 v3, v45, v45, s30
  v_and_b32 v20, v28, v3
  v_and_b32 v21, v29, v3
  v_and_b32 v22, v30, v3
  v_and_b32 v23, v31, v3
  s_waitcnt lgkmcnt(2)
  s_nop 0
  v_mfma_f32_16x16x32_bf16 v[32:35], v[20:23], v[52:55], v[32:35]
  ds_read_b128 v[52:55], v5 offset:21504
  v_perm_b32 v3, v45, v45, s31
  v_and_b32 v24, v28, v3
  v_and_b32 v25, v29, v3
  v_and_b32 v26, v30, v3
  v_and_b32 v27, v31, v3
  s_waitcnt lgkmcnt(2)
  s_nop 0
  v_mfma_f32_16x16x32_bf16 v[32:35], v[24:27], v[56:59], v[32:35]
  ds_read_b128 v[56:59], v5 offset:22528
  v_perm_b32 v3, v46, v46, s30
  v_and_b32 v20, v28, v3
  v_and_b32 v21, v29, v3
  v_and_b32 v22, v30, v3
  v_and_b32 v23, v31, v3
  s_waitcnt lgkmcnt(2)
  s_nop 0
  v_mfma_f32_16x16x32_bf16 v[32:35], v[20:23], v[60:63], v[32:35]
  v_perm_b32 v3, v46, v46, s31
  v_and_b32 v24, v28, v3
  v_and_b32 v25, v29, v3
  v_and_b32 v26, v30, v3
  v_and_b32 v27, v31, v3
  s_waitcnt lgkmcnt(1)
  s_nop 0
  v_mfma_f32_16x16x32_bf16 v[32:35], v[24:27], v[52:55], v[32:35]
  v_perm_b32 v3, v47, v47, s30
  v_and_b32 v20, v28, v3
  v_and_b32 v21, v29, v3
  v_and_b32 v22, v30, v3
  v_and_b32 v23, v31, v3
  s_waitcnt lgkmcnt(0)
  s_nop 0
  v_mfma_f32_16x16x32_bf16 v[32:35], v[20:23], v[56:59], v[32:35]
  v_perm_b32 v3, v47, v47, s31
  v_and_b32 v24, v28, v3
  v_and_b32 v25, v29, v3
  v_and_b32 v26, v30, v3
  v_and_b32 v27, v31, v3
  s_nop 0
  s_nop 0
  v_mfma_f32_16x16x32_bf16 v[32:35], v[24:27], a[0:3], v[32:35]
  v_perm_b32 v3, v48, v48, s30
  v_and_b32 v20, v28, v3
  v_and_b32 v21, v29, v3
  v_and_b32 v22, v30, v3
  v_and_b32 v23, v31, v3
  s_nop 0
  s_nop 0
  v_mfma_f32_16x16x32_bf16 v[32:35], v[20:23], a[4:7], v[32:35]
  v_perm_b32 v3, v48, v48, s31
  v_and_b32 v24, v28, v3
  v_and_b32 v25, v29, v3
  v_and_b32 v26, v30, v3
  v_and_b32 v27, v31, v3
  s_nop 0
  s_nop 0
  v_mfma_f32_16x16x32_bf16 v[32:35], v[24:27], a[8:11], v[32:35]
  v_perm_b32 v3, v49, v49, s30
  v_and_b32 v20, v28, v3
  v_and_b32 v21, v29, v3
  v_and_b32 v22, v30, v3
  v_and_b32 v23, v31, v3
  s_nop 0
  s_nop 0
  v_mfma_f32_16x16x32_bf16 v[32:35], v[20:23], a[12:15], v[32:35]
  v_perm_b32 v3, v49, v49, s31
  v_and_b32 v24, v28, v3
  v_and_b32 v25, v29, v3
  v_and_b32 v26, v30, v3
  v_and_b32 v27, v31, v3
  s_nop 0
  s_nop 0
  v_mfma_f32_16x16x32_bf16 v[32:35], v[24:27], a[16:19], v[32:35]
  v_perm_b32 v3, v50, v50, s30
  v_and_b32 v20, v28, v3
  v_and_b32 v21, v29, v3
  v_and_b32 v22, v30, v3
  v_and_b32 v23, v31, v3
  s_nop 0
  s_nop 0
  v_mfma_f32_16x16x32_bf16 v[32:35], v[20:23], a[20:23], v[32:35]
  v_perm_b32 v3, v50, v50, s31
  v_and_b32 v24, v28, v3
  v_and_b32 v25, v29, v3
  v_and_b32 v26, v30, v3
  v_and_b32 v27, v31, v3
  s_nop 0
  s_nop 0
  v_mfma_f32_16x16x32_bf16 v[32:35], v[24:27], a[24:27], v[32:35]
  v_perm_b32 v3, v51, v51, s30
  v_and_b32 v20, v28, v3
  v_and_b32 v21, v29, v3
  v_and_b32 v22, v30, v3
  v_and_b32 v23, v31, v3
  s_nop 0
  s_nop 0
  v_mfma_f32_16x16x32_bf16 v[32:35], v[20:23], a[28:31], v[32:35]
  v_perm_b32 v3, v51, v51, s31
  v_and_b32 v24, v28, v3
  v_and_b32 v25, v29, v3
  v_and_b32 v26, v30, v3
  v_and_b32 v27, v31, v3
  s_nop 0
  s_nop 0
  v_mfma_f32_16x16x32_bf16 v[32:35], v[24:27], a[32:35], v[32:35]
  v_lshrrev_b32 v2, 8, v0
  v_and_b32 v3, 0xf0, v0
  v_lshlrev_b32 v3, 1, v3
  v_lshl_add_u32 v3, v2, 4, v3
  s_lshl_b32 s26, s17, 9
  s_add_u32 s26, s26, 159744
  v_add_u32 v5, s26, v3
  s_mov_b32 exec_hi, 0
  ds_write_b128 v5, v[32:35]
  s_mov_b32 exec_hi, -1
  v_add_u32 v5, 159744, v1
  s_waitcnt lgkmcnt(0)
  s_barrier
  ds_read_b32 v36, v5 offset:0
  ds_read_b32 v37, v5 offset:256
  ds_read_b32 v38, v5 offset:512
  ds_read_b32 v39, v5 offset:768
  ds_read_b32 v40, v5 offset:1024
  ds_read_b32 v41, v5 offset:1280
  ds_read_b32 v42, v5 offset:1536
  ds_read_b32 v43, v5 offset:1792
  s_waitcnt lgkmcnt(0)
  v_add_f32 v36, v36, v38
  v_add_f32 v40, v40, v42
  v_add_f32 v36, v36, v40
  v_cvt_pk_bf16_f32 v36, 0, v36
  v_add_f32 v37, v37, v39
  v_add_f32 v41, v41, v43
  v_add_f32 v37, v37, v41
  v_cvt_pk_bf16_f32 v37, 0, v37
  v_mul_f32 v40, 0xbfb8aa3b, v36
  v_exp_f32 v40, v40
  s_nop 0
  v_add_f32 v40, 1.0, v40
  v_rcp_f32 v40, v40
  s_nop 0
  v_mul_f32 v36, v36, v40
  v_cvt_pk_bf16_f32 v36, 0, v36
  v_mul_f32 v36, v36, v37
  v_cvt_pk_bf16_f32 v36, v36, v36
  s_lshl_b32 s26, s17, 8
  s_add_u32 s26, s26, 161792
  v_add_u32 v5, s26, v1
  ds_write_b32 v5, v36
  v_mul_u32_u24 v5, 56, v2
  v_add_u32 v5, s26, v5
  ds_read_b64 v[36:37], v5 offset:0
  ds_read_b64 v[38:39], v5 offset:8
  ds_read_b64 v[40:41], v5 offset:16
  ds_read_b64 v[42:43], v5 offset:24
  ds_read_b64 v[44:45], v5 offset:32
  ds_read_b64 v[46:47], v5 offset:40
  ds_read_b64 v[48:49], v5 offset:48
  s_waitcnt lgkmcnt(0)
  v_and_b32 v20, v28, v36
  v_and_b32 v21, v29, v36
  v_and_b32 v22, v30, v36
  v_and_b32 v23, v31, v36
  s_nop 0
  s_nop 0
  v_mfma_f32_16x16x32_bf16 v[32:35], v[20:23], a[36:39], 0
  v_and_b32 v24, v28, v37
  v_and_b32 v25, v29, v37
  v_and_b32 v26, v30, v37
  v_and_b32 v27, v31, v37
  s_nop 0
  s_nop 0
  v_mfma_f32_16x16x32_bf16 v[32:35], v[24:27], a[40:43], v[32:35]
  v_and_b32 v20, v28, v38
  v_and_b32 v21, v29, v38
  v_and_b32 v22, v30, v38
  v_and_b32 v23, v31, v38
  s_nop 0
  s_nop 0
  v_mfma_f32_16x16x32_bf16 v[32:35], v[20:23], a[44:47], v[32:35]
  v_and_b32 v24, v28, v39
  v_and_b32 v25, v29, v39
  v_and_b32 v26, v30, v39
  v_and_b32 v27, v31, v39
  s_nop 0
  s_nop 0
  v_mfma_f32_16x16x32_bf16 v[32:35], v[24:27], a[48:51], v[32:35]
  v_and_b32 v20, v28, v40
  v_and_b32 v21, v29, v40
  v_and_b32 v22, v30, v40
  v_and_b32 v23, v31, v40
  s_nop 0
  s_nop 0
  v_mfma_f32_16x16x32_bf16 v[32:35], v[20:23], a[52:55], v[32:35]
  v_and_b32 v24, v28, v41
  v_and_b32 v25, v29, v41
  v_and_b32 v26, v30, v41
  v_and_b32 v27, v31, v41
  s_nop 0
  s_nop 0
  v_mfma_f32_16x16x32_bf16 v[32:35], v[24:27], a[56:59], v[32:35]
  v_and_b32 v20, v28, v42
  v_and_b32 v21, v29, v42
  v_and_b32 v22, v30, v42
  v_and_b32 v23, v31, v42
  s_nop 0
  s_nop 0
  v_mfma_f32_16x16x32_bf16 v[32:35], v[20:23], a[60:63], v[32:35]
  v_and_b32 v24, v28, v43
  v_and_b32 v25, v29, v43
  v_and_b32 v26, v30, v43
  v_and_b32 v27, v31, v43
  s_nop 0
  s_nop 0
  v_mfma_f32_16x16x32_bf16 v[32:35], v[24:27], a[64:67], v[32:35]
  v_and_b32 v20, v28, v44
  v_and_b32 v21, v29, v44
  v_and_b32 v22, v30, v44
  v_and_b32 v23, v31, v44
  s_nop 0
  s_nop 0
  v_mfma_f32_16x16x32_bf16 v[32:35], v[20:23], a[68:71], v[32:35]
  v_and_b32 v24, v28, v45
  v_and_b32 v25, v29, v45
  v_and_b32 v26, v30, v45
  v_and_b32 v27, v31, v45
  s_nop 0
  s_nop 0
  v_mfma_f32_16x16x32_bf16 v[32:35], v[24:27], a[72:75], v[32:35]
  v_and_b32 v20, v28, v46
  v_and_b32 v21, v29, v46
  v_and_b32 v22, v30, v46
  v_and_b32 v23, v31, v46
  s_nop 0
  s_nop 0
  v_mfma_f32_16x16x32_bf16 v[32:35], v[20:23], a[76:79], v[32:35]
  v_and_b32 v24, v28, v47
  v_and_b32 v25, v29, v47
  v_and_b32 v26, v30, v47
  v_and_b32 v27, v31, v47
  s_nop 0
  s_nop 0
  v_mfma_f32_16x16x32_bf16 v[32:35], v[24:27], a[80:83], v[32:35]
  v_and_b32 v20, v28, v48
  v_and_b32 v21, v29, v48
  v_and_b32 v22, v30, v48
  v_and_b32 v23, v31, v48
  s_nop 0
  s_nop 0
  v_mfma_f32_16x16x32_bf16 v[32:35], v[20:23], a[84:87], v[32:35]
  v_and_b32 v24, v28, v49
  v_and_b32 v25, v29, v49
  v_and_b32 v26, v30, v49
  v_and_b32 v27, v31, v49
  s_nop 0
  s_nop 0
  v_mfma_f32_16x16x32_bf16 v[32:35], v[24:27], a[88:91], v[32:35]
  v_lshrrev_b32 v3, 1, v3
  s_lshl_b32 s26, s47, 7
  s_add_u32 s26, s26, s57
  s_lshl_b32 s26, s26, 8
  s_add_u32 s26, s26, 244318208
  s_nop 2
  v_cvt_pk_bf16_f32 v32, v32, v33
  v_cvt_pk_bf16_f32 v33, v34, v35
  v_min_u32 v32, -2, v32
  v_min_u32 v33, -2, v33
  s_mov_b32 exec_hi, 0
  buffer_store_dwordx2 v[32:33], v3, s[4:7], s26 offen sc1
  s_mov_b32 exec_hi, -1
  s_cmp_lg_u32 s16, 0
  s_cbranch_scc1 q_fail_61
  s_barrier
  s_lshl_b32 s26, s61, 21
  s_lshl_b32 s27, s59, 10
  s_add_u32 s26, s26, s27
  s_add_u32 s27, s26, 20971520
  s_add_u32 s28, s26, 27262976
  s_lshl_b32 s26, s47, 7
  s_add_u32 s26, s26, s17
  s_lshl_b32 s26, s26, 8
  s_add_u32 s26, s26, 244318208
  v_lshrrev_b32 v2, 8, v0
  v_and_b32 v3, 0xf0, v0
  v_lshl_add_u32 v5, v2, 10, v3
  buffer_load_dwordx4 v[36:39], v0, s[4:7], s27 offen sc1
  buffer_load_dwordx4 v[40:43], v0, s[4:7], s28 offen sc1
  s_mov_b32 s53, 0
m_w_76:
  s_add_u32 s27, s26, 0
  buffer_load_dwordx4 v[60:63], v5, s[4:7], s27 offen sc1
  s_add_u32 s27, s26, 4096
  buffer_load_dwordx4 v[64:67], v5, s[4:7], s27 offen sc1
  s_add_u32 s27, s26, 8192
  buffer_load_dwordx4 v[68:71], v5, s[4:7], s27 offen sc1
  s_add_u32 s27, s26, 12288
  buffer_load_dwordx4 v[72:75], v5, s[4:7], s27 offen sc1
  s_add_u32 s27, s26, 16384
  buffer_load_dwordx4 v[76:79], v5, s[4:7], s27 offen sc1
  s_add_u32 s27, s26, 20480
  buffer_load_dwordx4 v[80:83], v5, s[4:7], s27 offen sc1
  s_add_u32 s27, s26, 24576
  buffer_load_dwordx4 v[84:87], v5, s[4:7], s27 offen sc1
  s_add_u32 s27, s26, 28672
  buffer_load_dwordx4 v[88:91], v5, s[4:7], s27 offen sc1
  s_add_u32 s53, s53, 1
  s_cmp_gt_u32 s53, 1048576
  s_cbranch_scc1 q_fail_61
  s_mov_b32 vcc_lo, 0xaaaaaaaa
  s_mov_b32 vcc_hi, 0xaaaaaaaa
  v_mov_b32 v28, 0x3f80
  v_mov_b32 v20, 1.0
  v_cndmask_b32 v28, v28, v20, vcc
  s_mov_b32 vcc_lo, 0x30003
  s_mov_b32 vcc_hi, 0x30003
  v_cndmask_b32 v20, 0, v28, vcc
  s_mov_b32 vcc_lo, 0xc000c
  s_mov_b32 vcc_hi, 0xc000c
  v_cndmask_b32 v21, 0, v28, vcc
  s_mov_b32 vcc_lo, 0x300030
  s_mov_b32 vcc_hi, 0x300030
  v_cndmask_b32 v22, 0, v28, vcc
  s_mov_b32 vcc_lo, 0xc000c0
  s_mov_b32 vcc_hi, 0xc000c0
  v_cndmask_b32 v23, 0, v28, vcc
  s_waitcnt vmcnt(7)
  s_nop 0
  v_mfma_f32_16x16x32_bf16 v[28:31], v[20:23], v[60:63], 0
  v_max3_u32 v44, v60, v61, 0
  v_max3_u32 v44, v62, v63, v44
  s_waitcnt vmcnt(6)
  v_mfma_f32_16x16x32_bf16 v[28:31], v[20:23], v[64:67], v[28:31]
  v_max3_u32 v44, v64, v65, v44
  v_max3_u32 v44, v66, v67, v44
  s_waitcnt vmcnt(5)
  v_mfma_f32_16x16x32_bf16 v[28:31], v[20:23], v[68:71], v[28:31]
  v_max3_u32 v44, v68, v69, v44
  v_max3_u32 v44, v70, v71, v44
  s_waitcnt vmcnt(4)
  v_mfma_f32_16x16x32_bf16 v[28:31], v[20:23], v[72:75], v[28:31]
  v_max3_u32 v44, v72, v73, v44
  v_max3_u32 v44, v74, v75, v44
  s_waitcnt vmcnt(3)
  v_mfma_f32_16x16x32_bf16 v[28:31], v[20:23], v[76:79], v[28:31]
  v_max3_u32 v44, v76, v77, v44
  v_max3_u32 v44, v78, v79, v44
  s_waitcnt vmcnt(2)
  v_mfma_f32_16x16x32_bf16 v[28:31], v[20:23], v[80:83], v[28:31]
  v_max3_u32 v44, v80, v81, v44
  v_max3_u32 v44, v82, v83, v44
  s_waitcnt vmcnt(1)
  v_mfma_f32_16x16x32_bf16 v[28:31], v[20:23], v[84:87], v[28:31]
  v_max3_u32 v44, v84, v85, v44
  v_max3_u32 v44, v86, v87, v44
  s_waitcnt vmcnt(0)
  v_mfma_f32_16x16x32_bf16 v[28:31], v[20:23], v[88:91], v[28:31]
  v_max3_u32 v44, v88, v89, v44
  v_max3_u32 v44, v90, v91, v44
  v_cmp_eq_u32 vcc, -1, v44
  s_cbranch_vccnz m_w_76
  v_lshlrev_b32 v3, 1, v3
  v_lshl_add_u32 v3, v2, 4, v3
  s_lshl_b32 s26, s17, 9
  s_add_u32 s26, s26, 159744
  v_add_u32 v3, s26, v3
  s_mov_b32 exec_hi, 0
  ds_write_b128 v3, v[28:31]
  s_mov_b32 exec_hi, -1
  v_lshlrev_b32 v3, 1, v0
  v_add_u32 v3, 159744, v3
  v_lshlrev_b32 v44, 16, v36
  v_and_b32 v45, 0xffff0000, v36
  v_lshlrev_b32 v46, 16, v37
  v_and_b32 v47, 0xffff0000, v37
  v_lshlrev_b32 v48, 16, v38
  v_and_b32 v49, 0xffff0000, v38
  v_lshlrev_b32 v50, 16, v39
  v_and_b32 v51, 0xffff0000, v39
  v_lshlrev_b32 v52, 16, v40
  v_and_b32 v53, 0xffff0000, v40
  v_lshlrev_b32 v54, 16, v41
  v_and_b32 v55, 0xffff0000, v41
  v_lshlrev_b32 v56, 16, v42
  v_and_b32 v57, 0xffff0000, v42
  v_lshlrev_b32 v58, 16, v43
  v_and_b32 v59, 0xffff0000, v43
  s_waitcnt lgkmcnt(0)
  s_barrier
  s_cmp_lg_u32 s17, 0
  s_cbranch_scc1 m_done_75
  ds_read_b128 v[28:31], v3
  ds_read_b128 v[32:35], v3 offset:16
  s_and_b32 s29, s58, 0xffff0000
  s_xor_b32 s27, s29, 0x80000000
  s_xor_b32 s28, s29, 0xffff0000
  s_bitcmp1_b32 s29, 31
  s_cselect_b32 s29, s27, s28
  v_mov_b32 v36, s29
  v_mul_f32 v36, 0xbfb8aa3b, v36
  v_exp_f32 v36, v36
  s_nop 0
  v_add_f32 v36, 1.0, v36
  v_rcp_f32 v36, v36
  s_nop 0
  v_cvt_pk_bf16_f32 v36, 0, v36
  s_waitcnt lgkmcnt(0)
  v_cvt_pk_bf16_f32 v28, 0, v28
  v_cvt_pk_bf16_f32 v29, 0, v29
  v_cvt_pk_bf16_f32 v30, 0, v30
  v_cvt_pk_bf16_f32 v31, 0, v31
  v_cvt_pk_bf16_f32 v32, 0, v32
  v_cvt_pk_bf16_f32 v33, 0, v33
  v_cvt_pk_bf16_f32 v34, 0, v34
  v_cvt_pk_bf16_f32 v35, 0, v35
  v_mul_f32 v28, v28, v36
  v_mul_f32 v29, v29, v36
  v_mul_f32 v30, v30, v36
  v_mul_f32 v31, v31, v36
  v_mul_f32 v32, v32, v36
  v_mul_f32 v33, v33, v36
  v_mul_f32 v34, v34, v36
  v_mul_f32 v35, v35, v36
  v_cvt_pk_bf16_f32 v28, 0, v28
  v_cvt_pk_bf16_f32 v29, 0, v29
  v_cvt_pk_bf16_f32 v30, 0, v30
  v_cvt_pk_bf16_f32 v31, 0, v31
  v_cvt_pk_bf16_f32 v32, 0, v32
  v_cvt_pk_bf16_f32 v33, 0, v33
  v_cvt_pk_bf16_f32 v34, 0, v34
  v_cvt_pk_bf16_f32 v35, 0, v35
  v_add_f32 v28, v28, v52
  v_add_f32 v29, v29, v53
  v_add_f32 v30, v30, v54
  v_add_f32 v31, v31, v55
  v_add_f32 v32, v32, v56
  v_add_f32 v33, v33, v57
  v_add_f32 v34, v34, v58
  v_add_f32 v35, v35, v59
  v_cvt_pk_bf16_f32 v28, 0, v28
  v_cvt_pk_bf16_f32 v29, 0, v29
  v_cvt_pk_bf16_f32 v30, 0, v30
  v_cvt_pk_bf16_f32 v31, 0, v31
  v_cvt_pk_bf16_f32 v32, 0, v32
  v_cvt_pk_bf16_f32 v33, 0, v33
  v_cvt_pk_bf16_f32 v34, 0, v34
  v_cvt_pk_bf16_f32 v35, 0, v35
  v_add_f32 v44, v44, v28
  v_add_f32 v45, v45, v29
  v_add_f32 v46, v46, v30
  v_add_f32 v47, v47, v31
  v_add_f32 v48, v48, v32
  v_add_f32 v49, v49, v33
  v_add_f32 v50, v50, v34
  v_add_f32 v51, v51, v35
  v_cvt_pk_bf16_f32 v40, v44, v45
  v_cvt_pk_bf16_f32 v41, v46, v47
  v_cvt_pk_bf16_f32 v42, v48, v49
  v_cvt_pk_bf16_f32 v43, v50, v51
  v_lshlrev_b32 v44, 16, v40
  v_and_b32 v45, 0xffff0000, v40
  v_lshlrev_b32 v46, 16, v41
  v_and_b32 v47, 0xffff0000, v41
  v_lshlrev_b32 v48, 16, v42
  v_and_b32 v49, 0xffff0000, v42
  v_lshlrev_b32 v50, 16, v43
  v_and_b32 v51, 0xffff0000, v43
  s_lshl_b32 s26, s59, 10
  buffer_store_dwordx4 v[40:43], v0, s[72:75], s26 offen sc1
m_done_75:
q_fail_61:
  s_endpgm
L_o:
  s_sub_u32 s60, s91, 3
  s_and_b32 s61, s90, 15
  s_load_dwordx2 s[80:81], s[0:1], 40
  s_load_dwordx2 s[72:73], s[0:1], 0
  s_mov_b32 s82, 4194304
  v_and_b32 v42, 63, v0
  v_and_b32 v40, 15, v42
  v_lshrrev_b32 v41, 4, v42
  v_lshlrev_b32 v1, 3, v42
  v_lshlrev_b32 v2, 2, v42
  v_lshlrev_b32 v0, 4, v42
  s_mov_b32 s24, 0x3e0293ee
  s_mov_b32 s44, 0x05040100
  s_mov_b32 s45, 0x07060302
  s_and_b32 s26, s17, 1
  s_lshl_b32 s26, s26, 4
  v_lshlrev_b32 v43, 2, v41
  v_sub_u32 v43, v40, v43
  v_add_u32 v43, s26, v43
  v_mov_b32 v7, 0xfe000000
  v_cmp_le_i32 vcc, 0, v43
  s_nop 1
  v_cndmask_b32 v24, v7, 0, vcc
  v_cmp_le_i32 vcc, 1, v43
  s_nop 1
  v_cndmask_b32 v25, v7, 0, vcc
  v_cmp_le_i32 vcc, 2, v43
  s_nop 1
  v_cndmask_b32 v26, v7, 0, vcc
  v_cmp_le_i32 vcc, 3, v43
  s_nop 1
  v_cndmask_b32 v27, v7, 0, vcc
  v_cmp_le_i32 vcc, 16, v43
  s_nop 1
  v_cndmask_b32 v28, v7, 0, vcc
  v_cmp_le_i32 vcc, 17, v43
  s_nop 1
  v_cndmask_b32 v29, v7, 0, vcc
  v_cmp_le_i32 vcc, 18, v43
  s_nop 1
  v_cndmask_b32 v30, v7, 0, vcc
  v_cmp_le_i32 vcc, 19, v43
  s_nop 1
  v_cndmask_b32 v31, v7, 0, vcc
  v_lshrrev_b32 v43, 5, v42
  v_lshlrev_b32 v43, 16, v43
  v_and_b32 v4, 1, v41
  v_lshl_add_u32 v43, v4, 14, v43
  v_lshl_add_u32 v43, v40, 4, v43
  s_lshl_b32 s26, s61, 10
  s_lshl_b32 s27, s17, 8
  s_add_u32 s26, s26, s27
  v_add_u32 v4, s26, v43
  v_lshlrev_b32 v43, 10, v41
  v_lshl_add_u32 v5, v40, 4, v43
  s_lshl_b32 s26, s17, 12
  v_add_u32 v6, s26, v0
  v_and_b32 v43, 1, v41
  v_lshlrev_b32 v43, 12, v43
  v_lshl_add_u32 v43, v40, 4, v43
  v_lshrrev_b32 v3, 1, v41
  v_lshl_add_u32 v3, v3, 8, v43
  s_lshr_b32 s26, s17, 1
  s_lshl_b32 s27, s26, 14
  s_add_u32 s27, s27, 16384
  v_add_u32 v32, s27, v0
  s_lshl_b32 s27, s26, 13
  s_and_b32 s28, s17, 1
  s_lshl_b32 s28, s28, 10
  s_add_u32 s28, s28, s27
  s_add_u32 s28, s28, 49152
  v_add_u32 v33, s28, v0
  s_add_u32 s27, s27, 65536
  v_add_u32 v34, s27, v0
  v_add_u32 v35, s27, v1
  v_and_b32 v36, 0xf0, v0
  v_and_b32 v252, 64, v0
  v_mov_b32 v248, 0
  v_lshlrev_b32 v255, 4, v0
  v_and_b32 v43, 1, v42
  v_xor_b32 v254, 1, v43
  s_lshl_b32 s26, s17, 3
  s_add_u32 s26, s26, 81920
  v_mov_b32 v39, s26
  s_mov_b32 vcc_lo, 0xaaaaaaaa
  s_mov_b32 vcc_hi, 0xaaaaaaaa
  v_mov_b32 v43, 0x3f80
  v_cndmask_b32 v43, v43, 1.0, vcc
  s_mov_b32 vcc_lo, 0xf000f
  s_mov_b32 vcc_hi, 0xf000f00
  v_cndmask_b32 v16, 0, v43, vcc
  v_cndmask_b32 v18, 0, v43, vcc
  s_mov_b32 vcc_lo, 0xf000f0
  s_mov_b32 vcc_hi, 0xf000f000
  v_cndmask_b32 v17, 0, v43, vcc
  v_cndmask_b32 v19, 0, v43, vcc
  s_mov_b32 vcc_lo, 0xcccccccc
  s_mov_b32 vcc_hi, 0xcccccccc
  v_mov_b32 v43, 0x4444
  v_mov_b32 v20, 0xeeee
  v_cndmask_b32 v20, v43, v20, vcc
  s_mov_b32 s70, 2097152
  s_mov_b32 s71, 0x20000
  s_mov_b32 s74, 2097152
  s_mov_b32 s75, 0x20000
  s_mov_b32 s10, 1024
  s_mov_b32 s83, 0x20000
  s_lshr_b32 s85, s17, 1
  s_lshl_b32 s26, s61, 1
  s_add_u32 s85, s85, s26
  s_add_u32 s43, s26, s17
  s_lshl_b32 s14, s61, 8
  s_lshl_b32 s15, s61, 7
  s_add_u32 s15, s15, 245104640
  s_add_u32 s14, s14, 244318208
  s_lshl_b32 s26, s61, 2
  s_add_u32 s26, s26, s17
  s_lshl_b32 s18, s26, 13
  s_add_u32 s18, s18, 41943040
  s_lshl_b32 s19, s26, 12
  s_add_u32 s19, s19, 142606336
  s_lshl_b32 s20, s85, 13
  s_add_u32 s20, s20, 192937984
  s_and_b32 s26, s17, 1
  s_mul_i32 s26, s26, 3072
  s_add_u32 s21, s20, s26
  s_lshr_b32 s40, s17, 1
  s_lshl_b32 s40, s40, 13
  s_add_u32 s40, s40, s26
  s_add_u32 s40, s40, 65536
  s_lshl_b32 s22, s17, 12
  s_add_u32 s22, s22, 49152
  s_lshl_b32 s23, s17, 13
  s_add_u32 s23, s23, 16384
  s_lshl_b32 s41, s60, 20
  s_add_u32 s41, s41, 12582912
  v_lshlrev_b32 v246, 3, v0
  s_mov_b32 s11, 0x20000
  s_waitcnt lgkmcnt(0)
  s_lshl_b32 s77, s60, 4
  s_add_u32 s77, s77, s61
  s_lshl_b32 s77, s77, 2
  s_add_u32 s77, s77, s17
  s_lshl_b32 s26, s77, 10
  buffer_load_dwordx4 v[176:179], v0, s[72:75], s26 offen
  s_add_u32 s26, s26, 262144
  buffer_load_dwordx4 v[180:183], v0, s[72:75], s26 offen
  s_add_u32 s26, s26, 262144
  buffer_load_dwordx4 v[184:187], v0, s[72:75], s26 offen
  s_add_u32 s26, s26, 262144
  buffer_load_dwordx4 v[188:191], v0, s[72:75], s26 offen
  s_add_u32 s26, s26, 262144
  buffer_load_dwordx4 v[192:195], v0, s[72:75], s26 offen
  s_add_u32 s26, s26, 262144
  buffer_load_dwordx4 v[196:199], v0, s[72:75], s26 offen
  s_add_u32 s26, s26, 262144
  buffer_load_dwordx4 v[200:203], v0, s[72:75], s26 offen
  s_add_u32 s26, s26, 262144
  buffer_load_dwordx4 v[204:207], v0, s[72:75], s26 offen
  s_add_u32 s26, s26, 262144
  v_lshrrev_b32 v44, 9, v0
  v_lshlrev_b32 v44, 12, v44
  v_and_b32 v45, 0xf0, v0
  v_add_u32 v44, v44, v45
  v_bfe_u32 v45, v0, 8, 1
  v_lshl_add_u32 v44, v45, 3, v44
  s_lshl_b32 s30, s61, 18
  s_lshl_b32 s27, s17, 8
  s_add_u32 s30, s30, s27
  s_add_u32 s27, s30, 0
  buffer_load_dwordx2 v[64:65], v44, s[80:83], s27 offen
  s_add_u32 s27, s30, 1024
  buffer_load_dwordx2 v[66:67], v44, s[80:83], s27 offen
  s_add_u32 s27, s30, 2048
  buffer_load_dwordx2 v[68:69], v44, s[80:83], s27 offen
  s_add_u32 s27, s30, 3072
  buffer_load_dwordx2 v[70:71], v44, s[80:83], s27 offen
  s_add_u32 s27, s30, 16384
  buffer_load_dwordx2 v[72:73], v44, s[80:83], s27 offen
  s_add_u32 s27, s30, 17408
  buffer_load_dwordx2 v[74:75], v44, s[80:83], s27 offen
  s_add_u32 s27, s30, 18432
  buffer_load_dwordx2 v[76:77], v44, s[80:83], s27 offen
  s_add_u32 s27, s30, 19456
  buffer_load_dwordx2 v[78:79], v44, s[80:83], s27 offen
  s_add_u32 s27, s30, 8192
  buffer_load_dwordx2 v[80:81], v44, s[80:83], s27 offen
  s_add_u32 s27, s30, 9216
  buffer_load_dwordx2 v[82:83], v44, s[80:83], s27 offen
  s_add_u32 s27, s30, 10240
  buffer_load_dwordx2 v[84:85], v44, s[80:83], s27 offen
  s_add_u32 s27, s30, 11264
  buffer_load_dwordx2 v[86:87], v44, s[80:83], s27 offen
  s_add_u32 s27, s30, 24576
  buffer_load_dwordx2 v[88:89], v44, s[80:83], s27 offen
  s_add_u32 s27, s30, 25600
  buffer_load_dwordx2 v[90:91], v44, s[80:83], s27 offen
  s_add_u32 s27, s30, 26624
  buffer_load_dwordx2 v[92:93], v44, s[80:83], s27 offen
  s_add_u32 s27, s30, 27648
  buffer_load_dwordx2 v[94:95], v44, s[80:83], s27 offen
  s_add_u32 s27, s30, 32768
  buffer_load_dwordx2 v[96:97], v44, s[80:83], s27 offen
  s_add_u32 s27, s30, 33792
  buffer_load_dwordx2 v[98:99], v44, s[80:83], s27 offen
  s_add_u32 s27, s30, 34816
  buffer_load_dwordx2 v[100:101], v44, s[80:83], s27 offen
  s_add_u32 s27, s30, 35840
  buffer_load_dwordx2 v[102:103], v44, s[80:83], s27 offen
  s_add_u32 s27, s30, 49152
  buffer_load_dwordx2 v[104:105], v44, s[80:83], s27 offen
  s_add_u32 s27, s30, 50176
  buffer_load_dwordx2 v[106:107], v44, s[80:83], s27 offen
  s_add_u32 s27, s30, 51200
  buffer_load_dwordx2 v[108:109], v44, s[80:83], s27 offen
  s_add_u32 s27, s30, 52224
  buffer_load_dwordx2 v[110:111], v44, s[80:83], s27 offen
  s_add_u32 s27, s30, 40960
  buffer_load_dwordx2 v[112:113], v44, s[80:83], s27 offen
  s_add_u32 s27, s30, 41984
  buffer_load_dwordx2 v[114:115], v44, s[80:83], s27 offen
  s_add_u32 s27, s30, 43008
  buffer_load_dwordx2 v[116:117], v44, s[80:83], s27 offen
  s_add_u32 s27, s30, 44032
  buffer_load_dwordx2 v[118:119], v44, s[80:83], s27 offen
  s_add_u32 s27, s30, 57344
  buffer_load_dwordx2 v[120:121], v44, s[80:83], s27 offen
  s_add_u32 s27, s30, 58368
  buffer_load_dwordx2 v[122:123], v44, s[80:83], s27 offen
  s_add_u32 s27, s30, 59392
  buffer_load_dwordx2 v[124:125], v44, s[80:83], s27 offen
  s_add_u32 s27, s30, 60416
  buffer_load_dwordx2 v[126:127], v44, s[80:83], s27 offen
  s_load_dwordx2 s[4:5], s[0:1], 112
  s_load_dwordx2 s[12:13], s[0:1], 104
  s_load_dwordx2 s[68:69], s[0:1], 96
  s_load_dwordx2 s[8:9], s[0:1], 64
  s_waitcnt lgkmcnt(0)
  buffer_load_dwordx4 v[56:59], v0, s[8:11], 0 offen
  s_lshl_b32 s29, s77, 10
  s_add_u32 s29, s29, 6291456
  s_waitcnt vmcnt(40)
  v_lshlrev_b32 v212, 16, v176
  v_and_b32 v213, 0xffff0000, v176
  v_lshlrev_b32 v214, 16, v177
  v_and_b32 v215, 0xffff0000, v177
  v_lshlrev_b32 v216, 16, v178
  v_and_b32 v217, 0xffff0000, v178
  v_lshlrev_b32 v218, 16, v179
  v_and_b32 v219, 0xffff0000, v179
  v_add_f32 v220, v212, v213
  v_add_f32 v221, v214, v215
  v_add_f32 v222, v216, v217
  v_add_f32 v223, v218, v219
  v_add_f32 v220, v220, v221
  v_add_f32 v222, v222, v223
  v_add_f32 v220, v220, v222
  s_nop 1
  v_add_f32_dpp v220, v220, v220 row_ror:8 row_mask:0xf bank_mask:0xf
  s_nop 1
  v_add_f32_dpp v220, v220, v220 row_ror:4 row_mask:0xf bank_mask:0xf
  s_nop 1
  v_add_f32_dpp v220, v220, v220 row_ror:2 row_mask:0xf bank_mask:0xf
  s_nop 1
  v_add_f32_dpp v220, v220, v220 row_ror:1 row_mask:0xf bank_mask:0xf
  v_mov_b32 v222, v220
  s_nop 0
  s_nop 0
  v_permlane16_swap_b32 v220, v222
  v_add_f32 v220, v220, v222
  v_mov_b32 v222, v220
  s_nop 0
  s_nop 0
  v_permlane32_swap_b32 v220, v222
  v_add_f32 v220, v220, v222
  v_mul_f32 v220, 0x3b000000, v220
  v_sub_f32 v224, v212, v220
  v_sub_f32 v225, v213, v220
  v_sub_f32 v226, v214, v220
  v_sub_f32 v227, v215, v220
  v_sub_f32 v228, v216, v220
  v_sub_f32 v229, v217, v220
  v_sub_f32 v230, v218, v220
  v_sub_f32 v231, v219, v220
  v_mul_f32 v221, v224, v224
  v_mul_f32 v222, v225, v225
  v_fmac_f32 v221, v226, v226
  v_fmac_f32 v222, v227, v227
  v_fmac_f32 v221, v228, v228
  v_fmac_f32 v222, v229, v229
  v_fmac_f32 v221, v230, v230
  v_fmac_f32 v222, v231, v231
  v_add_f32 v221, v221, v222
  v_cvt_pk_bf16_f32 v220, 0, v220
  s_nop 0
  v_add_f32_dpp v221, v221, v221 row_ror:8 row_mask:0xf bank_mask:0xf
  v_sub_f32 v224, v212, v220
  v_sub_f32 v225, v213, v220
  v_add_f32_dpp v221, v221, v221 row_ror:4 row_mask:0xf bank_mask:0xf
  v_sub_f32 v226, v214, v220
  v_sub_f32 v227, v215, v220
  v_add_f32_dpp v221, v221, v221 row_ror:2 row_mask:0xf bank_mask:0xf
  v_sub_f32 v228, v216, v220
  v_sub_f32 v229, v217, v220
  v_add_f32_dpp v221, v221, v221 row_ror:1 row_mask:0xf bank_mask:0xf
  v_sub_f32 v230, v218, v220
  v_sub_f32 v231, v219, v220
  v_mov_b32 v222, v221
  v_cvt_pk_bf16_f32 v224, 0, v224
  v_cvt_pk_bf16_f32 v225, 0, v225
  v_permlane16_swap_b32 v221, v222
  v_cvt_pk_bf16_f32 v226, 0, v226
  v_cvt_pk_bf16_f32 v227, 0, v227
  v_add_f32 v221, v221, v222
  v_cvt_pk_bf16_f32 v228, 0, v228
  v_cvt_pk_bf16_f32 v229, 0, v229
  v_mov_b32 v222, v221
  v_cvt_pk_bf16_f32 v230, 0, v230
  v_cvt_pk_bf16_f32 v231, 0, v231
  v_permlane32_swap_b32 v221, v222
  v_add_f32 v221, v221, v222
  v_mul_f32 v221, 0x3b000000, v221
  v_cvt_pk_bf16_f32 v221, 0, v221
  v_add_f32 v221, 0x3727c5ac, v221
  v_cvt_pk_bf16_f32 v221, 0, v221
  v_sqrt_f32 v221, v221
  s_nop 0
  v_cvt_pk_bf16_f32 v221, 0, v221
  v_rcp_f32 v221, v221
  s_nop 0
  v_mul_f32 v224, v224, v221
  v_mul_f32 v225, v225, v221
  v_mul_f32 v226, v226, v221
  v_mul_f32 v227, v227, v221
  v_mul_f32 v228, v228, v221
  v_mul_f32 v229, v229, v221
  v_mul_f32 v230, v230, v221
  v_mul_f32 v231, v231, v221
  v_cvt_pk_bf16_f32 v176, v224, v225
  v_cvt_pk_bf16_f32 v177, v226, v227
  v_cvt_pk_bf16_f32 v178, v228, v229
  v_cvt_pk_bf16_f32 v179, v230, v231
  buffer_store_dwordx4 v[176:179], v0, s[4:7], s29 offen sc1
  s_add_u32 s29, s29, 262144
  s_waitcnt vmcnt(40)
  v_lshlrev_b32 v212, 16, v180
  v_and_b32 v213, 0xffff0000, v180
  v_lshlrev_b32 v214, 16, v181
  v_and_b32 v215, 0xffff0000, v181
  v_lshlrev_b32 v216, 16, v182
  v_and_b32 v217, 0xffff0000, v182
  v_lshlrev_b32 v218, 16, v183
  v_and_b32 v219, 0xffff0000, v183
  v_add_f32 v220, v212, v213
  v_add_f32 v221, v214, v215
  v_add_f32 v222, v216, v217
  v_add_f32 v223, v218, v219
  v_add_f32 v220, v220, v221
  v_add_f32 v222, v222, v223
  v_add_f32 v220, v220, v222
  s_nop 1
  v_add_f32_dpp v220, v220, v220 row_ror:8 row_mask:0xf bank_mask:0xf
  s_nop 1
  v_add_f32_dpp v220, v220, v220 row_ror:4 row_mask:0xf bank_mask:0xf
  s_nop 1
  v_add_f32_dpp v220, v220, v220 row_ror:2 row_mask:0xf bank_mask:0xf
  s_nop 1
  v_add_f32_dpp v220, v220, v220 row_ror:1 row_mask:0xf bank_mask:0xf
  v_mov_b32 v222, v220
  s_nop 0
  s_nop 0
  v_permlane16_swap_b32 v220, v222
  v_add_f32 v220, v220, v222
  v_mov_b32 v222, v220
  s_nop 0
  s_nop 0
  v_permlane32_swap_b32 v220, v222
  v_add_f32 v220, v220, v222
  v_mul_f32 v220, 0x3b000000, v220
  v_sub_f32 v224, v212, v220
  v_sub_f32 v225, v213, v220
  v_sub_f32 v226, v214, v220
  v_sub_f32 v227, v215, v220
  v_sub_f32 v228, v216, v220
  v_sub_f32 v229, v217, v220
  v_sub_f32 v230, v218, v220
  v_sub_f32 v231, v219, v220
  v_mul_f32 v221, v224, v224
  v_mul_f32 v222, v225, v225
  v_fmac_f32 v221, v226, v226
  v_fmac_f32 v222, v227, v227
  v_fmac_f32 v221, v228, v228
  v_fmac_f32 v222, v229, v229
  v_fmac_f32 v221, v230, v230
  v_fmac_f32 v222, v231, v231
  v_add_f32 v221, v221, v222
  v_cvt_pk_bf16_f32 v220, 0, v220
  s_nop 0
  v_add_f32_dpp v221, v221, v221 row_ror:8 row_mask:0xf bank_mask:0xf
  v_sub_f32 v224, v212, v220
  v_sub_f32 v225, v213, v220
  v_add_f32_dpp v221, v221, v221 row_ror:4 row_mask:0xf bank_mask:0xf
  v_sub_f32 v226, v214, v220
  v_sub_f32 v227, v215, v220
  v_add_f32_dpp v221, v221, v221 row_ror:2 row_mask:0xf bank_mask:0xf
  v_sub_f32 v228, v216, v220
  v_sub_f32 v229, v217, v220
  v_add_f32_dpp v221, v221, v221 row_ror:1 row_mask:0xf bank_mask:0xf
  v_sub_f32 v230, v218, v220
  v_sub_f32 v231, v219, v220
  v_mov_b32 v222, v221
  v_cvt_pk_bf16_f32 v224, 0, v224
  v_cvt_pk_bf16_f32 v225, 0, v225
  v_permlane16_swap_b32 v221, v222
  v_cvt_pk_bf16_f32 v226, 0, v226
  v_cvt_pk_bf16_f32 v227, 0, v227
  v_add_f32 v221, v221, v222
  v_cvt_pk_bf16_f32 v228, 0, v228
  v_cvt_pk_bf16_f32 v229, 0, v229
  v_mov_b32 v222, v221
  v_cvt_pk_bf16_f32 v230, 0, v230
  v_cvt_pk_bf16_f32 v231, 0, v231
  v_permlane32_swap_b32 v221, v222
  v_add_f32 v221, v221, v222
  v_mul_f32 v221, 0x3b000000, v221
  v_cvt_pk_bf16_f32 v221, 0, v221
  v_add_f32 v221, 0x3727c5ac, v221
  v_cvt_pk_bf16_f32 v221, 0, v221
  v_sqrt_f32 v221, v221
  s_nop 0
  v_cvt_pk_bf16_f32 v221, 0, v221
  v_rcp_f32 v221, v221
  s_nop 0
  v_mul_f32 v224, v224, v221
  v_mul_f32 v225, v225, v221
  v_mul_f32 v226, v226, v221
  v_mul_f32 v227, v227, v221
  v_mul_f32 v228, v228, v221
  v_mul_f32 v229, v229, v221
  v_mul_f32 v230, v230, v221
  v_mul_f32 v231, v231, v221
  v_cvt_pk_bf16_f32 v180, v224, v225
  v_cvt_pk_bf16_f32 v181, v226, v227
  v_cvt_pk_bf16_f32 v182, v228, v229
  v_cvt_pk_bf16_f32 v183, v230, v231
  buffer_store_dwordx4 v[180:183], v0, s[4:7], s29 offen sc1
  s_add_u32 s29, s29, 262144
  s_waitcnt vmcnt(40)
  v_lshlrev_b32 v212, 16, v184
  v_and_b32 v213, 0xffff0000, v184
  v_lshlrev_b32 v214, 16, v185
  v_and_b32 v215, 0xffff0000, v185
  v_lshlrev_b32 v216, 16, v186
  v_and_b32 v217, 0xffff0000, v186
  v_lshlrev_b32 v218, 16, v187
  v_and_b32 v219, 0xffff0000, v187
  v_add_f32 v220, v212, v213
  v_add_f32 v221, v214, v215
  v_add_f32 v222, v216, v217
  v_add_f32 v223, v218, v219
  v_add_f32 v220, v220, v221
  v_add_f32 v222, v222, v223
  v_add_f32 v220, v220, v222
  s_nop 1
  v_add_f32_dpp v220, v220, v220 row_ror:8 row_mask:0xf bank_mask:0xf
  s_nop 1
  v_add_f32_dpp v220, v220, v220 row_ror:4 row_mask:0xf bank_mask:0xf
  s_nop 1
  v_add_f32_dpp v220, v220, v220 row_ror:2 row_mask:0xf bank_mask:0xf
  s_nop 1
  v_add_f32_dpp v220, v220, v220 row_ror:1 row_mask:0xf bank_mask:0xf
  v_mov_b32 v222, v220
  s_nop 0
  s_nop 0
  v_permlane16_swap_b32 v220, v222
  v_add_f32 v220, v220, v222
  v_mov_b32 v222, v220
  s_nop 0
  s_nop 0
  v_permlane32_swap_b32 v220, v222
  v_add_f32 v220, v220, v222
  v_mul_f32 v220, 0x3b000000, v220
  v_sub_f32 v224, v212, v220
  v_sub_f32 v225, v213, v220
  v_sub_f32 v226, v214, v220
  v_sub_f32 v227, v215, v220
  v_sub_f32 v228, v216, v220
  v_sub_f32 v229, v217, v220
  v_sub_f32 v230, v218, v220
  v_sub_f32 v231, v219, v220
  v_mul_f32 v221, v224, v224
  v_mul_f32 v222, v225, v225
  v_fmac_f32 v221, v226, v226
  v_fmac_f32 v222, v227, v227
  v_fmac_f32 v221, v228, v228
  v_fmac_f32 v222, v229, v229
  v_fmac_f32 v221, v230, v230
  v_fmac_f32 v222, v231, v231
  v_add_f32 v221, v221, v222
  v_cvt_pk_bf16_f32 v220, 0, v220
  s_nop 0
  v_add_f32_dpp v221, v221, v221 row_ror:8 row_mask:0xf bank_mask:0xf
  v_sub_f32 v224, v212, v220
  v_sub_f32 v225, v213, v220
  v_add_f32_dpp v221, v221, v221 row_ror:4 row_mask:0xf bank_mask:0xf
  v_sub_f32 v226, v214, v220
  v_sub_f32 v227, v215, v220
  v_add_f32_dpp v221, v221, v221 row_ror:2 row_mask:0xf bank_mask:0xf
  v_sub_f32 v228, v216, v220
  v_sub_f32 v229, v217, v220
  v_add_f32_dpp v221, v221, v221 row_ror:1 row_mask:0xf bank_mask:0xf
  v_sub_f32 v230, v218, v220
  v_sub_f32 v231, v219, v220
  v_mov_b32 v222, v221
  v_cvt_pk_bf16_f32 v224, 0, v224
  v_cvt_pk_bf16_f32 v225, 0, v225
  v_permlane16_swap_b32 v221, v222
  v_cvt_pk_bf16_f32 v226, 0, v226
  v_cvt_pk_bf16_f32 v227, 0, v227
  v_add_f32 v221, v221, v222
  v_cvt_pk_bf16_f32 v228, 0, v228
  v_cvt_pk_bf16_f32 v229, 0, v229
  v_mov_b32 v222, v221
  v_cvt_pk_bf16_f32 v230, 0, v230
  v_cvt_pk_bf16_f32 v231, 0, v231
  v_permlane32_swap_b32 v221, v222
  v_add_f32 v221, v221, v222
  v_mul_f32 v221, 0x3b000000, v221
  v_cvt_pk_bf16_f32 v221, 0, v221
  v_add_f32 v221, 0x3727c5ac, v221
  v_cvt_pk_bf16_f32 v221, 0, v221
  v_sqrt_f32 v221, v221
  s_nop 0
  v_cvt_pk_bf16_f32 v221, 0, v221
  v_rcp_f32 v221, v221
  s_nop 0
  v_mul_f32 v224, v224, v221
  v_mul_f32 v225, v225, v221
  v_mul_f32 v226, v226, v221
  v_mul_f32 v227, v227, v221
  v_mul_f32 v228, v228, v221
  v_mul_f32 v229, v229, v221
  v_mul_f32 v230, v230, v221
  v_mul_f32 v231, v231, v221
  v_cvt_pk_bf16_f32 v184, v224, v225
  v_cvt_pk_bf16_f32 v185, v226, v227
  v_cvt_pk_bf16_f32 v186, v228, v229
  v_cvt_pk_bf16_f32 v187, v230, v231
  buffer_store_dwordx4 v[184:187], v0, s[4:7], s29 offen sc1
  s_add_u32 s29, s29, 262144
  s_waitcnt vmcnt(40)
  v_lshlrev_b32 v212, 16, v188
  v_and_b32 v213, 0xffff0000, v188
  v_lshlrev_b32 v214, 16, v189
  v_and_b32 v215, 0xffff0000, v189
  v_lshlrev_b32 v216, 16, v190
  v_and_b32 v217, 0xffff0000, v190
  v_lshlrev_b32 v218, 16, v191
  v_and_b32 v219, 0xffff0000, v191
  v_add_f32 v220, v212, v213
  v_add_f32 v221, v214, v215
  v_add_f32 v222, v216, v217
  v_add_f32 v223, v218, v219
  v_add_f32 v220, v220, v221
  v_add_f32 v222, v222, v223
  v_add_f32 v220, v220, v222
  s_nop 1
  v_add_f32_dpp v220, v220, v220 row_ror:8 row_mask:0xf bank_mask:0xf
  s_nop 1
  v_add_f32_dpp v220, v220, v220 row_ror:4 row_mask:0xf bank_mask:0xf
  s_nop 1
  v_add_f32_dpp v220, v220, v220 row_ror:2 row_mask:0xf bank_mask:0xf
  s_nop 1
  v_add_f32_dpp v220, v220, v220 row_ror:1 row_mask:0xf bank_mask:0xf
  v_mov_b32 v222, v220
  s_nop 0
  s_nop 0
  v_permlane16_swap_b32 v220, v222
  v_add_f32 v220, v220, v222
  v_mov_b32 v222, v220
  s_nop 0
  s_nop 0
  v_permlane32_swap_b32 v220, v222
  v_add_f32 v220, v220, v222
  v_mul_f32 v220, 0x3b000000, v220
  v_sub_f32 v224, v212, v220
  v_sub_f32 v225, v213, v220
  v_sub_f32 v226, v214, v220
  v_sub_f32 v227, v215, v220
  v_sub_f32 v228, v216, v220
  v_sub_f32 v229, v217, v220
  v_sub_f32 v230, v218, v220
  v_sub_f32 v231, v219, v220
  v_mul_f32 v221, v224, v224
  v_mul_f32 v222, v225, v225
  v_fmac_f32 v221, v226, v226
  v_fmac_f32 v222, v227, v227
  v_fmac_f32 v221, v228, v228
  v_fmac_f32 v222, v229, v229
  v_fmac_f32 v221, v230, v230
  v_fmac_f32 v222, v231, v231
  v_add_f32 v221, v221, v222
  v_cvt_pk_bf16_f32 v220, 0, v220
  s_nop 0
  v_add_f32_dpp v221, v221, v221 row_ror:8 row_mask:0xf bank_mask:0xf
  v_sub_f32 v224, v212, v220
  v_sub_f32 v225, v213, v220
  v_add_f32_dpp v221, v221, v221 row_ror:4 row_mask:0xf bank_mask:0xf
  v_sub_f32 v226, v214, v220
  v_sub_f32 v227, v215, v220
  v_add_f32_dpp v221, v221, v221 row_ror:2 row_mask:0xf bank_mask:0xf
  v_sub_f32 v228, v216, v220
  v_sub_f32 v229, v217, v220
  v_add_f32_dpp v221, v221, v221 row_ror:1 row_mask:0xf bank_mask:0xf
  v_sub_f32 v230, v218, v220
  v_sub_f32 v231, v219, v220
  v_mov_b32 v222, v221
  v_cvt_pk_bf16_f32 v224, 0, v224
  v_cvt_pk_bf16_f32 v225, 0, v225
  v_permlane16_swap_b32 v221, v222
  v_cvt_pk_bf16_f32 v226, 0, v226
  v_cvt_pk_bf16_f32 v227, 0, v227
  v_add_f32 v221, v221, v222
  v_cvt_pk_bf16_f32 v228, 0, v228
  v_cvt_pk_bf16_f32 v229, 0, v229
  v_mov_b32 v222, v221
  v_cvt_pk_bf16_f32 v230, 0, v230
  v_cvt_pk_bf16_f32 v231, 0, v231
  v_permlane32_swap_b32 v221, v222
  v_add_f32 v221, v221, v222
  v_mul_f32 v221, 0x3b000000, v221
  v_cvt_pk_bf16_f32 v221, 0, v221
  v_add_f32 v221, 0x3727c5ac, v221
  v_cvt_pk_bf16_f32 v221, 0, v221
  v_sqrt_f32 v221, v221
  s_nop 0
  v_cvt_pk_bf16_f32 v221, 0, v221
  v_rcp_f32 v221, v221
  s_nop 0
  v_mul_f32 v224, v224, v221
  v_mul_f32 v225, v225, v221
  v_mul_f32 v226, v226, v221
  v_mul_f32 v227, v227, v221
  v_mul_f32 v228, v228, v221
  v_mul_f32 v229, v229, v221
  v_mul_f32 v230, v230, v221
  v_mul_f32 v231, v231, v221
  v_cvt_pk_bf16_f32 v188, v224, v225
  v_cvt_pk_bf16_f32 v189, v226, v227
  v_cvt_pk_bf16_f32 v190, v228, v229
  v_cvt_pk_bf16_f32 v191, v230, v231
  buffer_store_dwordx4 v[188:191], v0, s[4:7], s29 offen sc1
  s_add_u32 s29, s29, 262144
  s_waitcnt vmcnt(40)
  v_lshlrev_b32 v212, 16, v192
  v_and_b32 v213, 0xffff0000, v192
  v_lshlrev_b32 v214, 16, v193
  v_and_b32 v215, 0xffff0000, v193
  v_lshlrev_b32 v216, 16, v194
  v_and_b32 v217, 0xffff0000, v194
  v_lshlrev_b32 v218, 16, v195
  v_and_b32 v219, 0xffff0000, v195
  v_add_f32 v220, v212, v213
  v_add_f32 v221, v214, v215
  v_add_f32 v222, v216, v217
  v_add_f32 v223, v218, v219
  v_add_f32 v220, v220, v221
  v_add_f32 v222, v222, v223
  v_add_f32 v220, v220, v222
  s_nop 1
  v_add_f32_dpp v220, v220, v220 row_ror:8 row_mask:0xf bank_mask:0xf
  s_nop 1
  v_add_f32_dpp v220, v220, v220 row_ror:4 row_mask:0xf bank_mask:0xf
  s_nop 1
  v_add_f32_dpp v220, v220, v220 row_ror:2 row_mask:0xf bank_mask:0xf
  s_nop 1
  v_add_f32_dpp v220, v220, v220 row_ror:1 row_mask:0xf bank_mask:0xf
  v_mov_b32 v222, v220
  s_nop 0
  s_nop 0
  v_permlane16_swap_b32 v220, v222
  v_add_f32 v220, v220, v222
  v_mov_b32 v222, v220
  s_nop 0
  s_nop 0
  v_permlane32_swap_b32 v220, v222
  v_add_f32 v220, v220, v222
  v_mul_f32 v220, 0x3b000000, v220
  v_sub_f32 v224, v212, v220
  v_sub_f32 v225, v213, v220
  v_sub_f32 v226, v214, v220
  v_sub_f32 v227, v215, v220
  v_sub_f32 v228, v216, v220
  v_sub_f32 v229, v217, v220
  v_sub_f32 v230, v218, v220
  v_sub_f32 v231, v219, v220
  v_mul_f32 v221, v224, v224
  v_mul_f32 v222, v225, v225
  v_fmac_f32 v221, v226, v226
  v_fmac_f32 v222, v227, v227
  v_fmac_f32 v221, v228, v228
  v_fmac_f32 v222, v229, v229
  v_fmac_f32 v221, v230, v230
  v_fmac_f32 v222, v231, v231
  v_add_f32 v221, v221, v222
  v_cvt_pk_bf16_f32 v220, 0, v220
  s_nop 0
  v_add_f32_dpp v221, v221, v221 row_ror:8 row_mask:0xf bank_mask:0xf
  v_sub_f32 v224, v212, v220
  v_sub_f32 v225, v213, v220
  v_add_f32_dpp v221, v221, v221 row_ror:4 row_mask:0xf bank_mask:0xf
  v_sub_f32 v226, v214, v220
  v_sub_f32 v227, v215, v220
  v_add_f32_dpp v221, v221, v221 row_ror:2 row_mask:0xf bank_mask:0xf
  v_sub_f32 v228, v216, v220
  v_sub_f32 v229, v217, v220
  v_add_f32_dpp v221, v221, v221 row_ror:1 row_mask:0xf bank_mask:0xf
  v_sub_f32 v230, v218, v220
  v_sub_f32 v231, v219, v220
  v_mov_b32 v222, v221
  v_cvt_pk_bf16_f32 v224, 0, v224
  v_cvt_pk_bf16_f32 v225, 0, v225
  v_permlane16_swap_b32 v221, v222
  v_cvt_pk_bf16_f32 v226, 0, v226
  v_cvt_pk_bf16_f32 v227, 0, v227
  v_add_f32 v221, v221, v222
  v_cvt_pk_bf16_f32 v228, 0, v228
  v_cvt_pk_bf16_f32 v229, 0, v229
  v_mov_b32 v222, v221
  v_cvt_pk_bf16_f32 v230, 0, v230
  v_cvt_pk_bf16_f32 v231, 0, v231
  v_permlane32_swap_b32 v221, v222
  v_add_f32 v221, v221, v222
  v_mul_f32 v221, 0x3b000000, v221
  v_cvt_pk_bf16_f32 v221, 0, v221
  v_add_f32 v221, 0x3727c5ac, v221
  v_cvt_pk_bf16_f32 v221, 0, v221
  v_sqrt_f32 v221, v221
  s_nop 0
  v_cvt_pk_bf16_f32 v221, 0, v221
  v_rcp_f32 v221, v221
  s_nop 0
  v_mul_f32 v224, v224, v221
  v_mul_f32 v225, v225, v221
  v_mul_f32 v226, v226, v221
  v_mul_f32 v227, v227, v221
  v_mul_f32 v228, v228, v221
  v_mul_f32 v229, v229, v221
  v_mul_f32 v230, v230, v221
  v_mul_f32 v231, v231, v221
  v_cvt_pk_bf16_f32 v192, v224, v225
  v_cvt_pk_bf16_f32 v193, v226, v227
  v_cvt_pk_bf16_f32 v194, v228, v229
  v_cvt_pk_bf16_f32 v195, v230, v231
  buffer_store_dwordx4 v[192:195], v0, s[4:7], s29 offen sc1
  s_add_u32 s29, s29, 262144
  s_waitcnt vmcnt(40)
  v_lshlrev_b32 v212, 16, v196
  v_and_b32 v213, 0xffff0000, v196
  v_lshlrev_b32 v214, 16, v197
  v_and_b32 v215, 0xffff0000, v197
  v_lshlrev_b32 v216, 16, v198
  v_and_b32 v217, 0xffff0000, v198
  v_lshlrev_b32 v218, 16, v199
  v_and_b32 v219, 0xffff0000, v199
  v_add_f32 v220, v212, v213
  v_add_f32 v221, v214, v215
  v_add_f32 v222, v216, v217
  v_add_f32 v223, v218, v219
  v_add_f32 v220, v220, v221
  v_add_f32 v222, v222, v223
  v_add_f32 v220, v220, v222
  s_nop 1
  v_add_f32_dpp v220, v220, v220 row_ror:8 row_mask:0xf bank_mask:0xf
  s_nop 1
  v_add_f32_dpp v220, v220, v220 row_ror:4 row_mask:0xf bank_mask:0xf
  s_nop 1
  v_add_f32_dpp v220, v220, v220 row_ror:2 row_mask:0xf bank_mask:0xf
  s_nop 1
  v_add_f32_dpp v220, v220, v220 row_ror:1 row_mask:0xf bank_mask:0xf
  v_mov_b32 v222, v220
  s_nop 0
  s_nop 0
  v_permlane16_swap_b32 v220, v222
  v_add_f32 v220, v220, v222
  v_mov_b32 v222, v220
  s_nop 0
  s_nop 0
  v_permlane32_swap_b32 v220, v222
  v_add_f32 v220, v220, v222
  v_mul_f32 v220, 0x3b000000, v220
  v_sub_f32 v224, v212, v220
  v_sub_f32 v225, v213, v220
  v_sub_f32 v226, v214, v220
  v_sub_f32 v227, v215, v220
  v_sub_f32 v228, v216, v220
  v_sub_f32 v229, v217, v220
  v_sub_f32 v230, v218, v220
  v_sub_f32 v231, v219, v220
  v_mul_f32 v221, v224, v224
  v_mul_f32 v222, v225, v225
  v_fmac_f32 v221, v226, v226
  v_fmac_f32 v222, v227, v227
  v_fmac_f32 v221, v228, v228
  v_fmac_f32 v222, v229, v229
  v_fmac_f32 v221, v230, v230
  v_fmac_f32 v222, v231, v231
  v_add_f32 v221, v221, v222
  v_cvt_pk_bf16_f32 v220, 0, v220
  s_nop 0
  v_add_f32_dpp v221, v221, v221 row_ror:8 row_mask:0xf bank_mask:0xf
  v_sub_f32 v224, v212, v220
  v_sub_f32 v225, v213, v220
  v_add_f32_dpp v221, v221, v221 row_ror:4 row_mask:0xf bank_mask:0xf
  v_sub_f32 v226, v214, v220
  v_sub_f32 v227, v215, v220
  v_add_f32_dpp v221, v221, v221 row_ror:2 row_mask:0xf bank_mask:0xf
  v_sub_f32 v228, v216, v220
  v_sub_f32 v229, v217, v220
  v_add_f32_dpp v221, v221, v221 row_ror:1 row_mask:0xf bank_mask:0xf
  v_sub_f32 v230, v218, v220
  v_sub_f32 v231, v219, v220
  v_mov_b32 v222, v221
  v_cvt_pk_bf16_f32 v224, 0, v224
  v_cvt_pk_bf16_f32 v225, 0, v225
  v_permlane16_swap_b32 v221, v222
  v_cvt_pk_bf16_f32 v226, 0, v226
  v_cvt_pk_bf16_f32 v227, 0, v227
  v_add_f32 v221, v221, v222
  v_cvt_pk_bf16_f32 v228, 0, v228
  v_cvt_pk_bf16_f32 v229, 0, v229
  v_mov_b32 v222, v221
  v_cvt_pk_bf16_f32 v230, 0, v230
  v_cvt_pk_bf16_f32 v231, 0, v231
  v_permlane32_swap_b32 v221, v222
  v_add_f32 v221, v221, v222
  v_mul_f32 v221, 0x3b000000, v221
  v_cvt_pk_bf16_f32 v221, 0, v221
  v_add_f32 v221, 0x3727c5ac, v221
  v_cvt_pk_bf16_f32 v221, 0, v221
  v_sqrt_f32 v221, v221
  s_nop 0
  v_cvt_pk_bf16_f32 v221, 0, v221
  v_rcp_f32 v221, v221
  s_nop 0
  v_mul_f32 v224, v224, v221
  v_mul_f32 v225, v225, v221
  v_mul_f32 v226, v226, v221
  v_mul_f32 v227, v227, v221
  v_mul_f32 v228, v228, v221
  v_mul_f32 v229, v229, v221
  v_mul_f32 v230, v230, v221
  v_mul_f32 v231, v231, v221
  v_cvt_pk_bf16_f32 v196, v224, v225
  v_cvt_pk_bf16_f32 v197, v226, v227
  v_cvt_pk_bf16_f32 v198, v228, v229
  v_cvt_pk_bf16_f32 v199, v230, v231
  buffer_store_dwordx4 v[196:199], v0, s[4:7], s29 offen sc1
  s_add_u32 s29, s29, 262144
  s_waitcnt vmcnt(40)
  v_lshlrev_b32 v212, 16, v200
  v_and_b32 v213, 0xffff0000, v200
  v_lshlrev_b32 v214, 16, v201
  v_and_b32 v215, 0xffff0000, v201
  v_lshlrev_b32 v216, 16, v202
  v_and_b32 v217, 0xffff0000, v202
  v_lshlrev_b32 v218, 16, v203
  v_and_b32 v219, 0xffff0000, v203
  v_add_f32 v220, v212, v213
  v_add_f32 v221, v214, v215
  v_add_f32 v222, v216, v217
  v_add_f32 v223, v218, v219
  v_add_f32 v220, v220, v221
  v_add_f32 v222, v222, v223
  v_add_f32 v220, v220, v222
  s_nop 1
  v_add_f32_dpp v220, v220, v220 row_ror:8 row_mask:0xf bank_mask:0xf
  s_nop 1
  v_add_f32_dpp v220, v220, v220 row_ror:4 row_mask:0xf bank_mask:0xf
  s_nop 1
  v_add_f32_dpp v220, v220, v220 row_ror:2 row_mask:0xf bank_mask:0xf
  s_nop 1
  v_add_f32_dpp v220, v220, v220 row_ror:1 row_mask:0xf bank_mask:0xf
  v_mov_b32 v222, v220
  s_nop 0
  s_nop 0
  v_permlane16_swap_b32 v220, v222
  v_add_f32 v220, v220, v222
  v_mov_b32 v222, v220
  s_nop 0
  s_nop 0
  v_permlane32_swap_b32 v220, v222
  v_add_f32 v220, v220, v222
  v_mul_f32 v220, 0x3b000000, v220
  v_sub_f32 v224, v212, v220
  v_sub_f32 v225, v213, v220
  v_sub_f32 v226, v214, v220
  v_sub_f32 v227, v215, v220
  v_sub_f32 v228, v216, v220
  v_sub_f32 v229, v217, v220
  v_sub_f32 v230, v218, v220
  v_sub_f32 v231, v219, v220
  v_mul_f32 v221, v224, v224
  v_mul_f32 v222, v225, v225
  v_fmac_f32 v221, v226, v226
  v_fmac_f32 v222, v227, v227
  v_fmac_f32 v221, v228, v228
  v_fmac_f32 v222, v229, v229
  v_fmac_f32 v221, v230, v230
  v_fmac_f32 v222, v231, v231
  v_add_f32 v221, v221, v222
  v_cvt_pk_bf16_f32 v220, 0, v220
  s_nop 0
  v_add_f32_dpp v221, v221, v221 row_ror:8 row_mask:0xf bank_mask:0xf
  v_sub_f32 v224, v212, v220
  v_sub_f32 v225, v213, v220
  v_add_f32_dpp v221, v221, v221 row_ror:4 row_mask:0xf bank_mask:0xf
  v_sub_f32 v226, v214, v220
  v_sub_f32 v227, v215, v220
  v_add_f32_dpp v221, v221, v221 row_ror:2 row_mask:0xf bank_mask:0xf
  v_sub_f32 v228, v216, v220
  v_sub_f32 v229, v217, v220
  v_add_f32_dpp v221, v221, v221 row_ror:1 row_mask:0xf bank_mask:0xf
  v_sub_f32 v230, v218, v220
  v_sub_f32 v231, v219, v220
  v_mov_b32 v222, v221
  v_cvt_pk_bf16_f32 v224, 0, v224
  v_cvt_pk_bf16_f32 v225, 0, v225
  v_permlane16_swap_b32 v221, v222
  v_cvt_pk_bf16_f32 v226, 0, v226
  v_cvt_pk_bf16_f32 v227, 0, v227
  v_add_f32 v221, v221, v222
  v_cvt_pk_bf16_f32 v228, 0, v228
  v_cvt_pk_bf16_f32 v229, 0, v229
  v_mov_b32 v222, v221
  v_cvt_pk_bf16_f32 v230, 0, v230
  v_cvt_pk_bf16_f32 v231, 0, v231
  v_permlane32_swap_b32 v221, v222
  v_add_f32 v221, v221, v222
  v_mul_f32 v221, 0x3b000000, v221
  v_cvt_pk_bf16_f32 v221, 0, v221
  v_add_f32 v221, 0x3727c5ac, v221
  v_cvt_pk_bf16_f32 v221, 0, v221
  v_sqrt_f32 v221, v221
  s_nop 0
  v_cvt_pk_bf16_f32 v221, 0, v221
  v_rcp_f32 v221, v221
  s_nop 0
  v_mul_f32 v224, v224, v221
  v_mul_f32 v225, v225, v221
  v_mul_f32 v226, v226, v221
  v_mul_f32 v227, v227, v221
  v_mul_f32 v228, v228, v221
  v_mul_f32 v229, v229, v221
  v_mul_f32 v230, v230, v221
  v_mul_f32 v231, v231, v221
  v_cvt_pk_bf16_f32 v200, v224, v225
  v_cvt_pk_bf16_f32 v201, v226, v227
  v_cvt_pk_bf16_f32 v202, v228, v229
  v_cvt_pk_bf16_f32 v203, v230, v231
  buffer_store_dwordx4 v[200:203], v0, s[4:7], s29 offen sc1
  s_add_u32 s29, s29, 262144
  s_waitcnt vmcnt(40)
  v_lshlrev_b32 v212, 16, v204
  v_and_b32 v213, 0xffff0000, v204
  v_lshlrev_b32 v214, 16, v205
  v_and_b32 v215, 0xffff0000, v205
  v_lshlrev_b32 v216, 16, v206
  v_and_b32 v217, 0xffff0000, v206
  v_lshlrev_b32 v218, 16, v207
  v_and_b32 v219, 0xffff0000, v207
  v_add_f32 v220, v212, v213
  v_add_f32 v221, v214, v215
  v_add_f32 v222, v216, v217
  v_add_f32 v223, v218, v219
  v_add_f32 v220, v220, v221
  v_add_f32 v222, v222, v223
  v_add_f32 v220, v220, v222
  s_nop 1
  v_add_f32_dpp v220, v220, v220 row_ror:8 row_mask:0xf bank_mask:0xf
  s_nop 1
  v_add_f32_dpp v220, v220, v220 row_ror:4 row_mask:0xf bank_mask:0xf
  s_nop 1
  v_add_f32_dpp v220, v220, v220 row_ror:2 row_mask:0xf bank_mask:0xf
  s_nop 1
  v_add_f32_dpp v220, v220, v220 row_ror:1 row_mask:0xf bank_mask:0xf
  v_mov_b32 v222, v220
  s_nop 0
  s_nop 0
  v_permlane16_swap_b32 v220, v222
  v_add_f32 v220, v220, v222
  v_mov_b32 v222, v220
  s_nop 0
  s_nop 0
  v_permlane32_swap_b32 v220, v222
  v_add_f32 v220, v220, v222
  v_mul_f32 v220, 0x3b000000, v220
  v_sub_f32 v224, v212, v220
  v_sub_f32 v225, v213, v220
  v_sub_f32 v226, v214, v220
  v_sub_f32 v227, v215, v220
  v_sub_f32 v228, v216, v220
  v_sub_f32 v229, v217, v220
  v_sub_f32 v230, v218, v220
  v_sub_f32 v231, v219, v220
  v_mul_f32 v221, v224, v224
  v_mul_f32 v222, v225, v225
  v_fmac_f32 v221, v226, v226
  v_fmac_f32 v222, v227, v227
  v_fmac_f32 v221, v228, v228
  v_fmac_f32 v222, v229, v229
  v_fmac_f32 v221, v230, v230
  v_fmac_f32 v222, v231, v231
  v_add_f32 v221, v221, v222
  v_cvt_pk_bf16_f32 v220, 0, v220
  s_nop 0
  v_add_f32_dpp v221, v221, v221 row_ror:8 row_mask:0xf bank_mask:0xf
  v_sub_f32 v224, v212, v220
  v_sub_f32 v225, v213, v220
  v_add_f32_dpp v221, v221, v221 row_ror:4 row_mask:0xf bank_mask:0xf
  v_sub_f32 v226, v214, v220
  v_sub_f32 v227, v215, v220
  v_add_f32_dpp v221, v221, v221 row_ror:2 row_mask:0xf bank_mask:0xf
  v_sub_f32 v228, v216, v220
  v_sub_f32 v229, v217, v220
  v_add_f32_dpp v221, v221, v221 row_ror:1 row_mask:0xf bank_mask:0xf
  v_sub_f32 v230, v218, v220
  v_sub_f32 v231, v219, v220
  v_mov_b32 v222, v221
  v_cvt_pk_bf16_f32 v224, 0, v224
  v_cvt_pk_bf16_f32 v225, 0, v225
  v_permlane16_swap_b32 v221, v222
  v_cvt_pk_bf16_f32 v226, 0, v226
  v_cvt_pk_bf16_f32 v227, 0, v227
  v_add_f32 v221, v221, v222
  v_cvt_pk_bf16_f32 v228, 0, v228
  v_cvt_pk_bf16_f32 v229, 0, v229
  v_mov_b32 v222, v221
  v_cvt_pk_bf16_f32 v230, 0, v230
  v_cvt_pk_bf16_f32 v231, 0, v231
  v_permlane32_swap_b32 v221, v222
  v_add_f32 v221, v221, v222
  v_mul_f32 v221, 0x3b000000, v221
  v_cvt_pk_bf16_f32 v221, 0, v221
  v_add_f32 v221, 0x3727c5ac, v221
  v_cvt_pk_bf16_f32 v221, 0, v221
  v_sqrt_f32 v221, v221
  s_nop 0
  v_cvt_pk_bf16_f32 v221, 0, v221
  v_rcp_f32 v221, v221
  s_nop 0
  v_mul_f32 v224, v224, v221
  v_mul_f32 v225, v225, v221
  v_mul_f32 v226, v226, v221
  v_mul_f32 v227, v227, v221
  v_mul_f32 v228, v228, v221
  v_mul_f32 v229, v229, v221
  v_mul_f32 v230, v230, v221
  v_mul_f32 v231, v231, v221
  v_cvt_pk_bf16_f32 v204, v224, v225
  v_cvt_pk_bf16_f32 v205, v226, v227
  v_cvt_pk_bf16_f32 v206, v228, v229
  v_cvt_pk_bf16_f32 v207, v230, v231
  buffer_store_dwordx4 v[204:207], v0, s[4:7], s29 offen sc1
  s_add_u32 s29, s29, 262144
  s_waitcnt vmcnt(33)
  v_perm_b32 v48, v66, v64, s44
  v_perm_b32 v49, v70, v68, s44
  v_perm_b32 v50, v74, v72, s44
  v_perm_b32 v51, v78, v76, s44
  v_accvgpr_write_b32 a0, v48
  v_accvgpr_write_b32 a1, v49
  v_accvgpr_write_b32 a2, v50
  v_accvgpr_write_b32 a3, v51
  v_perm_b32 v52, v66, v64, s45
  v_perm_b32 v53, v70, v68, s45
  v_perm_b32 v54, v74, v72, s45
  v_perm_b32 v55, v78, v76, s45
  v_accvgpr_write_b32 a4, v52
  v_accvgpr_write_b32 a5, v53
  v_accvgpr_write_b32 a6, v54
  v_accvgpr_write_b32 a7, v55
  v_perm_b32 v48, v67, v65, s44
  v_perm_b32 v49, v71, v69, s44
  v_perm_b32 v50, v75, v73, s44
  v_perm_b32 v51, v79, v77, s44
  v_accvgpr_write_b32 a8, v48
  v_accvgpr_write_b32 a9, v49
  v_accvgpr_write_b32 a10, v50
  v_accvgpr_write_b32 a11, v51
  v_perm_b32 v52, v67, v65, s45
  v_perm_b32 v53, v71, v69, s45
  v_perm_b32 v54, v75, v73, s45
  v_perm_b32 v55, v79, v77, s45
  v_accvgpr_write_b32 a12, v52
  v_accvgpr_write_b32 a13, v53
  v_accvgpr_write_b32 a14, v54
  v_accvgpr_write_b32 a15, v55
  s_waitcnt vmcnt(25)
  v_perm_b32 v48, v82, v80, s44
  v_perm_b32 v49, v86, v84, s44
  v_perm_b32 v50, v90, v88, s44
  v_perm_b32 v51, v94, v92, s44
  v_accvgpr_write_b32 a16, v48
  v_accvgpr_write_b32 a17, v49
  v_accvgpr_write_b32 a18, v50
  v_accvgpr_write_b32 a19, v51
  v_perm_b32 v52, v82, v80, s45
  v_perm_b32 v53, v86, v84, s45
  v_perm_b32 v54, v90, v88, s45
  v_perm_b32 v55, v94, v92, s45
  v_accvgpr_write_b32 a20, v52
  v_accvgpr_write_b32 a21, v53
  v_accvgpr_write_b32 a22, v54
  v_accvgpr_write_b32 a23, v55
  v_perm_b32 v48, v83, v81, s44
  v_perm_b32 v49, v87, v85, s44
  v_perm_b32 v50, v91, v89, s44
  v_perm_b32 v51, v95, v93, s44
  v_accvgpr_write_b32 a24, v48
  v_accvgpr_write_b32 a25, v49
  v_accvgpr_write_b32 a26, v50
  v_accvgpr_write_b32 a27, v51
  v_perm_b32 v52, v83, v81, s45
  v_perm_b32 v53, v87, v85, s45
  v_perm_b32 v54, v91, v89, s45
  v_perm_b32 v55, v95, v93, s45
  v_accvgpr_write_b32 a28, v52
  v_accvgpr_write_b32 a29, v53
  v_accvgpr_write_b32 a30, v54
  v_accvgpr_write_b32 a31, v55
  s_waitcnt vmcnt(17)
  v_perm_b32 v48, v98, v96, s44
  v_perm_b32 v49, v102, v100, s44
  v_perm_b32 v50, v106, v104, s44
  v_perm_b32 v51, v110, v108, s44
  v_accvgpr_write_b32 a32, v48
  v_accvgpr_write_b32 a33, v49
  v_accvgpr_write_b32 a34, v50
  v_accvgpr_write_b32 a35, v51
  v_perm_b32 v52, v98, v96, s45
  v_perm_b32 v53, v102, v100, s45
  v_perm_b32 v54, v106, v104, s45
  v_perm_b32 v55, v110, v108, s45
  v_accvgpr_write_b32 a36, v52
  v_accvgpr_write_b32 a37, v53
  v_accvgpr_write_b32 a38, v54
  v_accvgpr_write_b32 a39, v55
  v_perm_b32 v48, v99, v97, s44
  v_perm_b32 v49, v103, v101, s44
  v_perm_b32 v50, v107, v105, s44
  v_perm_b32 v51, v111, v109, s44
  v_accvgpr_write_b32 a40, v48
  v_accvgpr_write_b32 a41, v49
  v_accvgpr_write_b32 a42, v50
  v_accvgpr_write_b32 a43, v51
  v_perm_b32 v52, v99, v97, s45
  v_perm_b32 v53, v103, v101, s45
  v_perm_b32 v54, v107, v105, s45
  v_perm_b32 v55, v111, v109, s45
  v_accvgpr_write_b32 a44, v52
  v_accvgpr_write_b32 a45, v53
  v_accvgpr_write_b32 a46, v54
  v_accvgpr_write_b32 a47, v55
  s_waitcnt vmcnt(9)
  v_perm_b32 v48, v114, v112, s44
  v_perm_b32 v49, v118, v116, s44
  v_perm_b32 v50, v122, v120, s44
  v_perm_b32 v51, v126, v124, s44
  v_accvgpr_write_b32 a48, v48
  v_accvgpr_write_b32 a49, v49
  v_accvgpr_write_b32 a50, v50
  v_accvgpr_write_b32 a51, v51
  v_perm_b32 v52, v114, v112, s45
  v_perm_b32 v53, v118, v116, s45
  v_perm_b32 v54, v122, v120, s45
  v_perm_b32 v55, v126, v124, s45
  v_accvgpr_write_b32 a52, v52
  v_accvgpr_write_b32 a53, v53
  v_accvgpr_write_b32 a54, v54
  v_accvgpr_write_b32 a55, v55
  v_perm_b32 v48, v115, v113, s44
  v_perm_b32 v49, v119, v117, s44
  v_perm_b32 v50, v123, v121, s44
  v_perm_b32 v51, v127, v125, s44
  v_accvgpr_write_b32 a56, v48
  v_accvgpr_write_b32 a57, v49
  v_accvgpr_write_b32 a58, v50
  v_accvgpr_write_b32 a59, v51
  v_perm_b32 v52, v115, v113, s45
  v_perm_b32 v53, v119, v117, s45
  v_perm_b32 v54, v123, v121, s45
  v_perm_b32 v55, v127, v125, s45
  v_accvgpr_write_b32 a60, v52
  v_accvgpr_write_b32 a61, v53
  v_accvgpr_write_b32 a62, v54
  v_accvgpr_write_b32 a63, v55
  v_mbcnt_lo_u32_b32 v60, -1, 0
  v_and_b32 v60, 0, v60
  v_add_lshl_u32 v60, v60, 1, 2
  s_mov_b32 s26, 0
g_wt_77:
  global_load_dword v61, v60, s[12:13] offset:128 sc1
  s_add_u32 s26, s26, 1
  s_cmp_gt_u32 s26, 1048576
  s_cbranch_scc1 L_end
  s_waitcnt vmcnt(0)
  v_cmp_eq_u32 vcc, 0, v61
  v_readfirstlane_b32 s27, v61
  s_cbranch_vccnz g_wt_77
  s_lshl_b32 s27, s77, 7
  s_add_u32 s27, s27, 243269632
  v_lshlrev_b32 v61, 11, v0
  v_mov_b32 v60, 1
  s_mov_b64 exec, 255
  buffer_store_dword v60, v61, s[4:7], s27 offen sc1
  s_mov_b64 exec, -1
  s_add_u32 s27, s30, 65536
  buffer_load_dwordx2 v[128:129], v44, s[80:83], s27 offen
  s_add_u32 s27, s30, 66560
  buffer_load_dwordx2 v[130:131], v44, s[80:83], s27 offen
  s_add_u32 s27, s30, 67584
  buffer_load_dwordx2 v[132:133], v44, s[80:83], s27 offen
  s_add_u32 s27, s30, 68608
  buffer_load_dwordx2 v[134:135], v44, s[80:83], s27 offen
  s_add_u32 s27, s30, 81920
  buffer_load_dwordx2 v[136:137], v44, s[80:83], s27 offen
  s_add_u32 s27, s30, 82944
  buffer_load_dwordx2 v[138:139], v44, s[80:83], s27 offen
  s_add_u32 s27, s30, 83968
  buffer_load_dwordx2 v[140:141], v44, s[80:83], s27 offen
  s_add_u32 s27, s30, 84992
  buffer_load_dwordx2 v[142:143], v44, s[80:83], s27 offen
  s_add_u32 s27, s30, 73728
  buffer_load_dwordx2 v[144:145], v44, s[80:83], s27 offen
  s_add_u32 s27, s30, 74752
  buffer_load_dwordx2 v[146:147], v44, s[80:83], s27 offen
  s_add_u32 s27, s30, 75776
  buffer_load_dwordx2 v[148:149], v44, s[80:83], s27 offen
  s_add_u32 s27, s30, 76800
  buffer_load_dwordx2 v[150:151], v44, s[80:83], s27 offen
  s_add_u32 s27, s30, 90112
  buffer_load_dwordx2 v[152:153], v44, s[80:83], s27 offen
  s_add_u32 s27, s30, 91136
  buffer_load_dwordx2 v[154:155], v44, s[80:83], s27 offen
  s_add_u32 s27, s30, 92160
  buffer_load_dwordx2 v[156:157], v44, s[80:83], s27 offen
  s_add_u32 s27, s30, 93184
  buffer_load_dwordx2 v[158:159], v44, s[80:83], s27 offen
  s_add_u32 s27, s30, 98304
  buffer_load_dwordx2 v[160:161], v44, s[80:83], s27 offen
  s_add_u32 s27, s30, 99328
  buffer_load_dwordx2 v[162:163], v44, s[80:83], s27 offen
  s_add_u32 s27, s30, 100352
  buffer_load_dwordx2 v[164:165], v44, s[80:83], s27 offen
  s_add_u32 s27, s30, 101376
  buffer_load_dwordx2 v[166:167], v44, s[80:83], s27 offen
  s_add_u32 s27, s30, 114688
  buffer_load_dwordx2 v[168:169], v44, s[80:83], s27 offen
  s_add_u32 s27, s30, 115712
  buffer_load_dwordx2 v[170:171], v44, s[80:83], s27 offen
  s_add_u32 s27, s30, 116736
  buffer_load_dwordx2 v[172:173], v44, s[80:83], s27 offen
  s_add_u32 s27, s30, 117760
  buffer_load_dwordx2 v[174:175], v44, s[80:83], s27 offen
  s_add_u32 s27, s30, 106496
  buffer_load_dwordx2 v[64:65], v44, s[80:83], s27 offen
  s_add_u32 s27, s30, 107520
  buffer_load_dwordx2 v[66:67], v44, s[80:83], s27 offen
  s_add_u32 s27, s30, 108544
  buffer_load_dwordx2 v[68:69], v44, s[80:83], s27 offen
  s_add_u32 s27, s30, 109568
  buffer_load_dwordx2 v[70:71], v44, s[80:83], s27 offen
  s_add_u32 s27, s30, 122880
  buffer_load_dwordx2 v[72:73], v44, s[80:83], s27 offen
  s_add_u32 s27, s30, 123904
  buffer_load_dwordx2 v[74:75], v44, s[80:83], s27 offen
  s_add_u32 s27, s30, 124928
  buffer_load_dwordx2 v[76:77], v44, s[80:83], s27 offen
  s_add_u32 s27, s30, 125952
  buffer_load_dwordx2 v[78:79], v44, s[80:83], s27 offen
  s_add_u32 s27, s30, 131072
  buffer_load_dwordx2 v[80:81], v44, s[80:83], s27 offen
  s_add_u32 s27, s30, 132096
  buffer_load_dwordx2 v[82:83], v44, s[80:83], s27 offen
  s_add_u32 s27, s30, 133120
  buffer_load_dwordx2 v[84:85], v44, s[80:83], s27 offen
  s_add_u32 s27, s30, 134144
  buffer_load_dwordx2 v[86:87], v44, s[80:83], s27 offen
  s_add_u32 s27, s30, 147456
  buffer_load_dwordx2 v[88:89], v44, s[80:83], s27 offen
  s_add_u32 s27, s30, 148480
  buffer_load_dwordx2 v[90:91], v44, s[80:83], s27 offen
  s_add_u32 s27, s30, 149504
  buffer_load_dwordx2 v[92:93], v44, s[80:83], s27 offen
  s_add_u32 s27, s30, 150528
  buffer_load_dwordx2 v[94:95], v44, s[80:83], s27 offen
  s_add_u32 s27, s30, 139264
  buffer_load_dwordx2 v[96:97], v44, s[80:83], s27 offen
  s_add_u32 s27, s30, 140288
  buffer_load_dwordx2 v[98:99], v44, s[80:83], s27 offen
  s_add_u32 s27, s30, 141312
  buffer_load_dwordx2 v[100:101], v44, s[80:83], s27 offen
  s_add_u32 s27, s30, 142336
  buffer_load_dwordx2 v[102:103], v44, s[80:83], s27 offen
  s_add_u32 s27, s30, 155648
  buffer_load_dwordx2 v[104:105], v44, s[80:83], s27 offen
  s_add_u32 s27, s30, 156672
  buffer_load_dwordx2 v[106:107], v44, s[80:83], s27 offen
  s_add_u32 s27, s30, 157696
  buffer_load_dwordx2 v[108:109], v44, s[80:83], s27 offen
  s_add_u32 s27, s30, 158720
  buffer_load_dwordx2 v[110:111], v44, s[80:83], s27 offen
  s_add_u32 s27, s30, 163840
  buffer_load_dwordx2 v[112:113], v44, s[80:83], s27 offen
  s_add_u32 s27, s30, 164864
  buffer_load_dwordx2 v[114:115], v44, s[80:83], s27 offen
  s_add_u32 s27, s30, 165888
  buffer_load_dwordx2 v[116:117], v44, s[80:83], s27 offen
  s_add_u32 s27, s30, 166912
  buffer_load_dwordx2 v[118:119], v44, s[80:83], s27 offen
  s_add_u32 s27, s30, 180224
  buffer_load_dwordx2 v[120:121], v44, s[80:83], s27 offen
  s_add_u32 s27, s30, 181248
  buffer_load_dwordx2 v[122:123], v44, s[80:83], s27 offen
  s_add_u32 s27, s30, 182272
  buffer_load_dwordx2 v[124:125], v44, s[80:83], s27 offen
  s_add_u32 s27, s30, 183296
  buffer_load_dwordx2 v[126:127], v44, s[80:83], s27 offen
  v_lshlrev_b32 v8, 16, v56
  v_and_b32 v9, 0xffff0000, v56
  v_lshlrev_b32 v10, 16, v57
  v_and_b32 v11, 0xffff0000, v57
  v_lshlrev_b32 v12, 16, v58
  v_and_b32 v13, 0xffff0000, v58
  v_lshlrev_b32 v14, 16, v59
  v_and_b32 v15, 0xffff0000, v59
  v_mul_f32 v56, v8, v8
  v_fmac_f32 v56, v9, v9
  v_fmac_f32 v56, v10, v10
  v_fmac_f32 v56, v11, v11
  v_fmac_f32 v56, v12, v12
  v_fmac_f32 v56, v13, v13
  v_fmac_f32 v56, v14, v14
  v_fmac_f32 v56, v15, v15
  s_nop 0
  s_nop 0
  v_add_f32_dpp v56, v56, v56 row_ror:8 row_mask:0xf bank_mask:0xf
  s_nop 1
  v_add_f32_dpp v56, v56, v56 row_ror:4 row_mask:0xf bank_mask:0xf
  s_nop 1
  v_add_f32_dpp v56, v56, v56 row_ror:2 row_mask:0xf bank_mask:0xf
  s_nop 1
  v_add_f32_dpp v56, v56, v56 row_ror:1 row_mask:0xf bank_mask:0xf
  v_mov_b32 v57, v56
  s_nop 0
  s_nop 0
  v_permlane16_swap_b32 v56, v57
  v_add_f32 v56, v56, v57
  v_mov_b32 v57, v56
  s_nop 0
  s_nop 0
  v_permlane32_swap_b32 v56, v57
  v_add_f32 v56, v56, v57
  v_sqrt_f32 v56, v56
  s_mov_b32 s28, 0x40598569
  v_writelane_b32 v247, s28, 0
  s_mov_b32 s28, 0x40598569
  v_writelane_b32 v247, s28, 1
  s_mov_b32 s28, 0x4058ade7
  v_writelane_b32 v247, s28, 2
  s_mov_b32 s28, 0x40577c32
  v_writelane_b32 v247, s28, 3
  s_mov_b32 s28, 0x40563297
  v_writelane_b32 v247, s28, 4
  s_mov_b32 s28, 0x4054cd28
  v_writelane_b32 v247, s28, 5
  s_mov_b32 s28, 0x405346f2
  v_writelane_b32 v247, s28, 6
  s_mov_b32 s28, 0x40519992
  v_writelane_b32 v247, s28, 7
  s_mov_b32 s28, 0x404fbc99
  v_writelane_b32 v247, s28, 8
  s_mov_b32 s28, 0x404da49a
  v_writelane_b32 v247, s28, 9
  s_mov_b32 s28, 0x404b418a
  v_writelane_b32 v247, s28, 10
  s_mov_b32 s28, 0x40487bed
  v_writelane_b32 v247, s28, 11
  s_mov_b32 s28, 0x40452f68
  v_writelane_b32 v247, s28, 12
  s_mov_b32 s28, 0x40411f69
  v_writelane_b32 v247, s28, 13
  s_mov_b32 s28, 0x403bdbac
  v_writelane_b32 v247, s28, 14
  s_mov_b32 s28, 0x40346eae
  v_writelane_b32 v247, s28, 15
  s_mov_b32 s28, 0x4028005c
  v_writelane_b32 v247, s28, 16
  s_mov_b32 s28, 0x4001516e
  v_writelane_b32 v247, s28, 17
  s_mov_b32 s28, 0x4001516e
  v_writelane_b32 v247, s28, 18
  v_mul_f32 v247, v247, v56
  v_or_b32 v247, 0x80000000, v247
  s_lshl_b32 s29, s61, 2
  s_add_u32 s29, s29, s17
  s_lshl_b32 s29, s29, 13
  s_add_u32 s29, s29, s41
  v_mov_b64 v[208:209], 0
  v_mov_b64 v[210:211], 0
  s_waitcnt vmcnt(48)
  v_perm_b32 v48, v130, v128, s44
  v_perm_b32 v49, v134, v132, s44
  v_perm_b32 v50, v138, v136, s44
  v_perm_b32 v51, v142, v140, s44
  v_accvgpr_write_b32 a64, v48
  v_accvgpr_write_b32 a65, v49
  v_accvgpr_write_b32 a66, v50
  v_accvgpr_write_b32 a67, v51
  v_perm_b32 v52, v130, v128, s45
  v_perm_b32 v53, v134, v132, s45
  v_perm_b32 v54, v138, v136, s45
  v_perm_b32 v55, v142, v140, s45
  v_accvgpr_write_b32 a68, v52
  v_accvgpr_write_b32 a69, v53
  v_accvgpr_write_b32 a70, v54
  v_accvgpr_write_b32 a71, v55
  v_perm_b32 v48, v131, v129, s44
  v_perm_b32 v49, v135, v133, s44
  v_perm_b32 v50, v139, v137, s44
  v_perm_b32 v51, v143, v141, s44
  v_accvgpr_write_b32 a72, v48
  v_accvgpr_write_b32 a73, v49
  v_accvgpr_write_b32 a74, v50
  v_accvgpr_write_b32 a75, v51
  v_perm_b32 v52, v131, v129, s45
  v_perm_b32 v53, v135, v133, s45
  v_perm_b32 v54, v139, v137, s45
  v_perm_b32 v55, v143, v141, s45
  v_accvgpr_write_b32 a76, v52
  v_accvgpr_write_b32 a77, v53
  v_accvgpr_write_b32 a78, v54
  v_accvgpr_write_b32 a79, v55
  s_add_u32 s27, s30, 172032
  buffer_load_dwordx2 v[128:129], v44, s[80:83], s27 offen
  s_add_u32 s27, s30, 173056
  buffer_load_dwordx2 v[130:131], v44, s[80:83], s27 offen
  s_add_u32 s27, s30, 174080
  buffer_load_dwordx2 v[132:133], v44, s[80:83], s27 offen
  s_add_u32 s27, s30, 175104
  buffer_load_dwordx2 v[134:135], v44, s[80:83], s27 offen
  s_add_u32 s27, s30, 188416
  buffer_load_dwordx2 v[136:137], v44, s[80:83], s27 offen
  s_add_u32 s27, s30, 189440
  buffer_load_dwordx2 v[138:139], v44, s[80:83], s27 offen
  s_add_u32 s27, s30, 190464
  buffer_load_dwordx2 v[140:141], v44, s[80:83], s27 offen
  s_add_u32 s27, s30, 191488
  buffer_load_dwordx2 v[142:143], v44, s[80:83], s27 offen
  s_waitcnt vmcnt(48)
  v_perm_b32 v48, v146, v144, s44
  v_perm_b32 v49, v150, v148, s44
  v_perm_b32 v50, v154, v152, s44
  v_perm_b32 v51, v158, v156, s44
  v_accvgpr_write_b32 a80, v48
  v_accvgpr_write_b32 a81, v49
  v_accvgpr_write_b32 a82, v50
  v_accvgpr_write_b32 a83, v51
  v_perm_b32 v52, v146, v144, s45
  v_perm_b32 v53, v150, v148, s45
  v_perm_b32 v54, v154, v152, s45
  v_perm_b32 v55, v158, v156, s45
  v_accvgpr_write_b32 a84, v52
  v_accvgpr_write_b32 a85, v53
  v_accvgpr_write_b32 a86, v54
  v_accvgpr_write_b32 a87, v55
  v_perm_b32 v48, v147, v145, s44
  v_perm_b32 v49, v151, v149, s44
  v_perm_b32 v50, v155, v153, s44
  v_perm_b32 v51, v159, v157, s44
  v_accvgpr_write_b32 a88, v48
  v_accvgpr_write_b32 a89, v49
  v_accvgpr_write_b32 a90, v50
  v_accvgpr_write_b32 a91, v51
  v_perm_b32 v52, v147, v145, s45
  v_perm_b32 v53, v151, v149, s45
  v_perm_b32 v54, v155, v153, s45
  v_perm_b32 v55, v159, v157, s45
  v_accvgpr_write_b32 a92, v52
  v_accvgpr_write_b32 a93, v53
  v_accvgpr_write_b32 a94, v54
  v_accvgpr_write_b32 a95, v55
  s_add_u32 s27, s30, 196608
  buffer_load_dwordx2 v[144:145], v44, s[80:83], s27 offen
  s_add_u32 s27, s30, 197632
  buffer_load_dwordx2 v[146:147], v44, s[80:83], s27 offen
  s_add_u32 s27, s30, 198656
  buffer_load_dwordx2 v[148:149], v44, s[80:83], s27 offen
  s_add_u32 s27, s30, 199680
  buffer_load_dwordx2 v[150:151], v44, s[80:83], s27 offen
  s_add_u32 s27, s30, 212992
  buffer_load_dwordx2 v[152:153], v44, s[80:83], s27 offen
  s_add_u32 s27, s30, 214016
  buffer_load_dwordx2 v[154:155], v44, s[80:83], s27 offen
  s_add_u32 s27, s30, 215040
  buffer_load_dwordx2 v[156:157], v44, s[80:83], s27 offen
  s_add_u32 s27, s30, 216064
  buffer_load_dwordx2 v[158:159], v44, s[80:83], s27 offen
  s_waitcnt vmcnt(48)
  v_perm_b32 v48, v162, v160, s44
  v_perm_b32 v49, v166, v164, s44
  v_perm_b32 v50, v170, v168, s44
  v_perm_b32 v51, v174, v172, s44
  v_accvgpr_write_b32 a96, v48
  v_accvgpr_write_b32 a97, v49
  v_accvgpr_write_b32 a98, v50
  v_accvgpr_write_b32 a99, v51
  v_perm_b32 v52, v162, v160, s45
  v_perm_b32 v53, v166, v164, s45
  v_perm_b32 v54, v170, v168, s45
  v_perm_b32 v55, v174, v172, s45
  v_accvgpr_write_b32 a100, v52
  v_accvgpr_write_b32 a101, v53
  v_accvgpr_write_b32 a102, v54
  v_accvgpr_write_b32 a103, v55
  v_perm_b32 v48, v163, v161, s44
  v_perm_b32 v49, v167, v165, s44
  v_perm_b32 v50, v171, v169, s44
  v_perm_b32 v51, v175, v173, s44
  v_accvgpr_write_b32 a104, v48
  v_accvgpr_write_b32 a105, v49
  v_accvgpr_write_b32 a106, v50
  v_accvgpr_write_b32 a107, v51
  v_perm_b32 v52, v163, v161, s45
  v_perm_b32 v53, v167, v165, s45
  v_perm_b32 v54, v171, v169, s45
  v_perm_b32 v55, v175, v173, s45
  v_accvgpr_write_b32 a108, v52
  v_accvgpr_write_b32 a109, v53
  v_accvgpr_write_b32 a110, v54
  v_accvgpr_write_b32 a111, v55
  s_add_u32 s27, s30, 204800
  buffer_load_dwordx2 v[160:161], v44, s[80:83], s27 offen
  s_add_u32 s27, s30, 205824
  buffer_load_dwordx2 v[162:163], v44, s[80:83], s27 offen
  s_add_u32 s27, s30, 206848
  buffer_load_dwordx2 v[164:165], v44, s[80:83], s27 offen
  s_add_u32 s27, s30, 207872
  buffer_load_dwordx2 v[166:167], v44, s[80:83], s27 offen
  s_add_u32 s27, s30, 221184
  buffer_load_dwordx2 v[168:169], v44, s[80:83], s27 offen
  s_add_u32 s27, s30, 222208
  buffer_load_dwordx2 v[170:171], v44, s[80:83], s27 offen
  s_add_u32 s27, s30, 223232
  buffer_load_dwordx2 v[172:173], v44, s[80:83], s27 offen
  s_add_u32 s27, s30, 224256
  buffer_load_dwordx2 v[174:175], v44, s[80:83], s27 offen
  s_waitcnt vmcnt(48)
  v_perm_b32 v48, v66, v64, s44
  v_perm_b32 v49, v70, v68, s44
  v_perm_b32 v50, v74, v72, s44
  v_perm_b32 v51, v78, v76, s44
  v_accvgpr_write_b32 a112, v48
  v_accvgpr_write_b32 a113, v49
  v_accvgpr_write_b32 a114, v50
  v_accvgpr_write_b32 a115, v51
  v_perm_b32 v52, v66, v64, s45
  v_perm_b32 v53, v70, v68, s45
  v_perm_b32 v54, v74, v72, s45
  v_perm_b32 v55, v78, v76, s45
  v_accvgpr_write_b32 a116, v52
  v_accvgpr_write_b32 a117, v53
  v_accvgpr_write_b32 a118, v54
  v_accvgpr_write_b32 a119, v55
  v_perm_b32 v48, v67, v65, s44
  v_perm_b32 v49, v71, v69, s44
  v_perm_b32 v50, v75, v73, s44
  v_perm_b32 v51, v79, v77, s44
  v_accvgpr_write_b32 a120, v48
  v_accvgpr_write_b32 a121, v49
  v_accvgpr_write_b32 a122, v50
  v_accvgpr_write_b32 a123, v51
  v_perm_b32 v52, v67, v65, s45
  v_perm_b32 v53, v71, v69, s45
  v_perm_b32 v54, v75, v73, s45
  v_perm_b32 v55, v79, v77, s45
  v_accvgpr_write_b32 a124, v52
  v_accvgpr_write_b32 a125, v53
  v_accvgpr_write_b32 a126, v54
  v_accvgpr_write_b32 a127, v55
  s_add_u32 s27, s30, 229376
  buffer_load_dwordx2 v[64:65], v44, s[80:83], s27 offen
  s_add_u32 s27, s30, 230400
  buffer_load_dwordx2 v[66:67], v44, s[80:83], s27 offen
  s_add_u32 s27, s30, 231424
  buffer_load_dwordx2 v[68:69], v44, s[80:83], s27 offen
  s_add_u32 s27, s30, 232448
  buffer_load_dwordx2 v[70:71], v44, s[80:83], s27 offen
  s_add_u32 s27, s30, 245760
  buffer_load_dwordx2 v[72:73], v44, s[80:83], s27 offen
  s_add_u32 s27, s30, 246784
  buffer_load_dwordx2 v[74:75], v44, s[80:83], s27 offen
  s_add_u32 s27, s30, 247808
  buffer_load_dwordx2 v[76:77], v44, s[80:83], s27 offen
  s_add_u32 s27, s30, 248832
  buffer_load_dwordx2 v[78:79], v44, s[80:83], s27 offen
  s_waitcnt vmcnt(48)
  v_perm_b32 v48, v82, v80, s44
  v_perm_b32 v49, v86, v84, s44
  v_perm_b32 v50, v90, v88, s44
  v_perm_b32 v51, v94, v92, s44
  v_accvgpr_write_b32 a128, v48
  v_accvgpr_write_b32 a129, v49
  v_accvgpr_write_b32 a130, v50
  v_accvgpr_write_b32 a131, v51
  v_perm_b32 v52, v82, v80, s45
  v_perm_b32 v53, v86, v84, s45
  v_perm_b32 v54, v90, v88, s45
  v_perm_b32 v55, v94, v92, s45
  v_accvgpr_write_b32 a132, v52
  v_accvgpr_write_b32 a133, v53
  v_accvgpr_write_b32 a134, v54
  v_accvgpr_write_b32 a135, v55
  v_perm_b32 v48, v83, v81, s44
  v_perm_b32 v49, v87, v85, s44
  v_perm_b32 v50, v91, v89, s44
  v_perm_b32 v51, v95, v93, s44
  v_accvgpr_write_b32 a136, v48
  v_accvgpr_write_b32 a137, v49
  v_accvgpr_write_b32 a138, v50
  v_accvgpr_write_b32 a139, v51
  v_perm_b32 v52, v83, v81, s45
  v_perm_b32 v53, v87, v85, s45
  v_perm_b32 v54, v91, v89, s45
  v_perm_b32 v55, v95, v93, s45
  v_accvgpr_write_b32 a140, v52
  v_accvgpr_write_b32 a141, v53
  v_accvgpr_write_b32 a142, v54
  v_accvgpr_write_b32 a143, v55
  s_add_u32 s27, s30, 237568
  buffer_load_dwordx2 v[80:81], v44, s[80:83], s27 offen
  s_add_u32 s27, s30, 238592
  buffer_load_dwordx2 v[82:83], v44, s[80:83], s27 offen
  s_add_u32 s27, s30, 239616
  buffer_load_dwordx2 v[84:85], v44, s[80:83], s27 offen
  s_add_u32 s27, s30, 240640
  buffer_load_dwordx2 v[86:87], v44, s[80:83], s27 offen
  s_add_u32 s27, s30, 253952
  buffer_load_dwordx2 v[88:89], v44, s[80:83], s27 offen
  s_add_u32 s27, s30, 254976
  buffer_load_dwordx2 v[90:91], v44, s[80:83], s27 offen
  s_add_u32 s27, s30, 256000
  buffer_load_dwordx2 v[92:93], v44, s[80:83], s27 offen
  s_add_u32 s27, s30, 257024
  buffer_load_dwordx2 v[94:95], v44, s[80:83], s27 offen
  s_waitcnt vmcnt(48)
  v_perm_b32 v48, v98, v96, s44
  v_perm_b32 v49, v102, v100, s44
  v_perm_b32 v50, v106, v104, s44
  v_perm_b32 v51, v110, v108, s44
  v_accvgpr_write_b32 a144, v48
  v_accvgpr_write_b32 a145, v49
  v_accvgpr_write_b32 a146, v50
  v_accvgpr_write_b32 a147, v51
  v_perm_b32 v52, v98, v96, s45
  v_perm_b32 v53, v102, v100, s45
  v_perm_b32 v54, v106, v104, s45
  v_perm_b32 v55, v110, v108, s45
  v_accvgpr_write_b32 a148, v52
  v_accvgpr_write_b32 a149, v53
  v_accvgpr_write_b32 a150, v54
  v_accvgpr_write_b32 a151, v55
  v_perm_b32 v48, v99, v97, s44
  v_perm_b32 v49, v103, v101, s44
  v_perm_b32 v50, v107, v105, s44
  v_perm_b32 v51, v111, v109, s44
  v_accvgpr_write_b32 a152, v48
  v_accvgpr_write_b32 a153, v49
  v_accvgpr_write_b32 a154, v50
  v_accvgpr_write_b32 a155, v51
  v_perm_b32 v52, v99, v97, s45
  v_perm_b32 v53, v103, v101, s45
  v_perm_b32 v54, v107, v105, s45
  v_perm_b32 v55, v111, v109, s45
  v_accvgpr_write_b32 a156, v52
  v_accvgpr_write_b32 a157, v53
  v_accvgpr_write_b32 a158, v54
  v_accvgpr_write_b32 a159, v55
  buffer_store_dwordx4 v[208:211], v0, s[4:7], s29 offen offset:0 sc1
  buffer_store_dwordx4 v[208:211], v0, s[4:7], s29 offen offset:1024 sc1
  buffer_store_dwordx4 v[208:211], v0, s[4:7], s29 offen offset:2048 sc1
  buffer_store_dwordx4 v[208:211], v0, s[4:7], s29 offen offset:3072 sc1
  s_add_u32 s29, s29, 4096
  s_waitcnt vmcnt(44)
  v_perm_b32 v48, v114, v112, s44
  v_perm_b32 v49, v118, v116, s44
  v_perm_b32 v50, v122, v120, s44
  v_perm_b32 v51, v126, v124, s44
  v_accvgpr_write_b32 a160, v48
  v_accvgpr_write_b32 a161, v49
  v_accvgpr_write_b32 a162, v50
  v_accvgpr_write_b32 a163, v51
  v_perm_b32 v52, v114, v112, s45
  v_perm_b32 v53, v118, v116, s45
  v_perm_b32 v54, v122, v120, s45
  v_perm_b32 v55, v126, v124, s45
  v_accvgpr_write_b32 a164, v52
  v_accvgpr_write_b32 a165, v53
  v_accvgpr_write_b32 a166, v54
  v_accvgpr_write_b32 a167, v55
  v_perm_b32 v48, v115, v113, s44
  v_perm_b32 v49, v119, v117, s44
  v_perm_b32 v50, v123, v121, s44
  v_perm_b32 v51, v127, v125, s44
  v_accvgpr_write_b32 a168, v48
  v_accvgpr_write_b32 a169, v49
  v_accvgpr_write_b32 a170, v50
  v_accvgpr_write_b32 a171, v51
  v_perm_b32 v52, v115, v113, s45
  v_perm_b32 v53, v119, v117, s45
  v_perm_b32 v54, v123, v121, s45
  v_perm_b32 v55, v127, v125, s45
  v_accvgpr_write_b32 a172, v52
  v_accvgpr_write_b32 a173, v53
  v_accvgpr_write_b32 a174, v54
  v_accvgpr_write_b32 a175, v55
  buffer_store_dwordx4 v[208:211], v0, s[4:7], s29 offen offset:0 sc1
  buffer_store_dwordx4 v[208:211], v0, s[4:7], s29 offen offset:1024 sc1
  buffer_store_dwordx4 v[208:211], v0, s[4:7], s29 offen offset:2048 sc1
  buffer_store_dwordx4 v[208:211], v0, s[4:7], s29 offen offset:3072 sc1
  s_add_u32 s29, s29, 520192
  s_waitcnt vmcnt(40)
  v_perm_b32 v48, v130, v128, s44
  v_perm_b32 v49, v134, v132, s44
  v_perm_b32 v50, v138, v136, s44
  v_perm_b32 v51, v142, v140, s44
  v_accvgpr_write_b32 a176, v48
  v_accvgpr_write_b32 a177, v49
  v_accvgpr_write_b32 a178, v50
  v_accvgpr_write_b32 a179, v51
  v_perm_b32 v52, v130, v128, s45
  v_perm_b32 v53, v134, v132, s45
  v_perm_b32 v54, v138, v136, s45
  v_perm_b32 v55, v142, v140, s45
  v_accvgpr_write_b32 a180, v52
  v_accvgpr_write_b32 a181, v53
  v_accvgpr_write_b32 a182, v54
  v_accvgpr_write_b32 a183, v55
  v_perm_b32 v48, v131, v129, s44
  v_perm_b32 v49, v135, v133, s44
  v_perm_b32 v50, v139, v137, s44
  v_perm_b32 v51, v143, v141, s44
  v_accvgpr_write_b32 a184, v48
  v_accvgpr_write_b32 a185, v49
  v_accvgpr_write_b32 a186, v50
  v_accvgpr_write_b32 a187, v51
  v_perm_b32 v52, v131, v129, s45
  v_perm_b32 v53, v135, v133, s45
  v_perm_b32 v54, v139, v137, s45
  v_perm_b32 v55, v143, v141, s45
  v_accvgpr_write_b32 a188, v52
  v_accvgpr_write_b32 a189, v53
  v_accvgpr_write_b32 a190, v54
  v_accvgpr_write_b32 a191, v55
  buffer_store_dwordx4 v[208:211], v0, s[4:7], s29 offen offset:0 sc1
  buffer_store_dwordx4 v[208:211], v0, s[4:7], s29 offen offset:1024 sc1
  buffer_store_dwordx4 v[208:211], v0, s[4:7], s29 offen offset:2048 sc1
  buffer_store_dwordx4 v[208:211], v0, s[4:7], s29 offen offset:3072 sc1
  s_add_u32 s29, s29, 4096
  s_waitcnt vmcnt(36)
  v_perm_b32 v48, v146, v144, s44
  v_perm_b32 v49, v150, v148, s44
  v_perm_b32 v50, v154, v152, s44
  v_perm_b32 v51, v158, v156, s44
  v_accvgpr_write_b32 a192, v48
  v_accvgpr_write_b32 a193, v49
  v_accvgpr_write_b32 a194, v50
  v_accvgpr_write_b32 a195, v51
  v_perm_b32 v52, v146, v144, s45
  v_perm_b32 v53, v150, v148, s45
  v_perm_b32 v54, v154, v152, s45
  v_perm_b32 v55, v158, v156, s45
  v_accvgpr_write_b32 a196, v52
  v_accvgpr_write_b32 a197, v53
  v_accvgpr_write_b32 a198, v54
  v_accvgpr_write_b32 a199, v55
  v_perm_b32 v48, v147, v145, s44
  v_perm_b32 v49, v151, v149, s44
  v_perm_b32 v50, v155, v153, s44
  v_perm_b32 v51, v159, v157, s44
  v_accvgpr_write_b32 a200, v48
  v_accvgpr_write_b32 a201, v49
  v_accvgpr_write_b32 a202, v50
  v_accvgpr_write_b32 a203, v51
  v_perm_b32 v52, v147, v145, s45
  v_perm_b32 v53, v151, v149, s45
  v_perm_b32 v54, v155, v153, s45
  v_perm_b32 v55, v159, v157, s45
  v_accvgpr_write_b32 a204, v52
  v_accvgpr_write_b32 a205, v53
  v_accvgpr_write_b32 a206, v54
  v_accvgpr_write_b32 a207, v55
  buffer_store_dwordx4 v[208:211], v0, s[4:7], s29 offen offset:0 sc1
  buffer_store_dwordx4 v[208:211], v0, s[4:7], s29 offen offset:1024 sc1
  buffer_store_dwordx4 v[208:211], v0, s[4:7], s29 offen offset:2048 sc1
  buffer_store_dwordx4 v[208:211], v0, s[4:7], s29 offen offset:3072 sc1
  s_add_u32 s29, s29, 4096
  s_waitcnt vmcnt(32)
  v_perm_b32 v48, v162, v160, s44
  v_perm_b32 v49, v166, v164, s44
  v_perm_b32 v50, v170, v168, s44
  v_perm_b32 v51, v174, v172, s44
  v_accvgpr_write_b32 a208, v48
  v_accvgpr_write_b32 a209, v49
  v_accvgpr_write_b32 a210, v50
  v_accvgpr_write_b32 a211, v51
  v_perm_b32 v52, v162, v160, s45
  v_perm_b32 v53, v166, v164, s45
  v_perm_b32 v54, v170, v168, s45
  v_perm_b32 v55, v174, v172, s45
  v_accvgpr_write_b32 a212, v52
  v_accvgpr_write_b32 a213, v53
  v_accvgpr_write_b32 a214, v54
  v_accvgpr_write_b32 a215, v55
  v_perm_b32 v48, v163, v161, s44
  v_perm_b32 v49, v167, v165, s44
  v_perm_b32 v50, v171, v169, s44
  v_perm_b32 v51, v175, v173, s44
  v_accvgpr_write_b32 a216, v48
  v_accvgpr_write_b32 a217, v49
  v_accvgpr_write_b32 a218, v50
  v_accvgpr_write_b32 a219, v51
  v_perm_b32 v52, v163, v161, s45
  v_perm_b32 v53, v167, v165, s45
  v_perm_b32 v54, v171, v169, s45
  v_perm_b32 v55, v175, v173, s45
  v_accvgpr_write_b32 a220, v52
  v_accvgpr_write_b32 a221, v53
  v_accvgpr_write_b32 a222, v54
  v_accvgpr_write_b32 a223, v55
  s_waitcnt vmcnt(24)
  v_perm_b32 v48, v66, v64, s44
  v_perm_b32 v49, v70, v68, s44
  v_perm_b32 v50, v74, v72, s44
  v_perm_b32 v51, v78, v76, s44
  v_accvgpr_write_b32 a224, v48
  v_accvgpr_write_b32 a225, v49
  v_accvgpr_write_b32 a226, v50
  v_accvgpr_write_b32 a227, v51
  v_perm_b32 v52, v66, v64, s45
  v_perm_b32 v53, v70, v68, s45
  v_perm_b32 v54, v74, v72, s45
  v_perm_b32 v55, v78, v76, s45
  v_accvgpr_write_b32 a228, v52
  v_accvgpr_write_b32 a229, v53
  v_accvgpr_write_b32 a230, v54
  v_accvgpr_write_b32 a231, v55
  v_perm_b32 v48, v67, v65, s44
  v_perm_b32 v49, v71, v69, s44
  v_perm_b32 v50, v75, v73, s44
  v_perm_b32 v51, v79, v77, s44
  v_accvgpr_write_b32 a232, v48
  v_accvgpr_write_b32 a233, v49
  v_accvgpr_write_b32 a234, v50
  v_accvgpr_write_b32 a235, v51
  v_perm_b32 v52, v67, v65, s45
  v_perm_b32 v53, v71, v69, s45
  v_perm_b32 v54, v75, v73, s45
  v_perm_b32 v55, v79, v77, s45
  v_accvgpr_write_b32 a236, v52
  v_accvgpr_write_b32 a237, v53
  v_accvgpr_write_b32 a238, v54
  v_accvgpr_write_b32 a239, v55
  s_waitcnt vmcnt(16)
  v_perm_b32 v48, v82, v80, s44
  v_perm_b32 v49, v86, v84, s44
  v_perm_b32 v50, v90, v88, s44
  v_perm_b32 v51, v94, v92, s44
  v_accvgpr_write_b32 a240, v48
  v_accvgpr_write_b32 a241, v49
  v_accvgpr_write_b32 a242, v50
  v_accvgpr_write_b32 a243, v51
  v_perm_b32 v52, v82, v80, s45
  v_perm_b32 v53, v86, v84, s45
  v_perm_b32 v54, v90, v88, s45
  v_perm_b32 v55, v94, v92, s45
  v_accvgpr_write_b32 a244, v52
  v_accvgpr_write_b32 a245, v53
  v_accvgpr_write_b32 a246, v54
  v_accvgpr_write_b32 a247, v55
  v_perm_b32 v48, v83, v81, s44
  v_perm_b32 v49, v87, v85, s44
  v_perm_b32 v50, v91, v89, s44
  v_perm_b32 v51, v95, v93, s44
  v_accvgpr_write_b32 a248, v48
  v_accvgpr_write_b32 a249, v49
  v_accvgpr_write_b32 a250, v50
  v_accvgpr_write_b32 a251, v51
  v_perm_b32 v52, v83, v81, s45
  v_perm_b32 v53, v87, v85, s45
  v_perm_b32 v54, v91, v89, s45
  v_perm_b32 v55, v95, v93, s45
  v_accvgpr_write_b32 a252, v52
  v_accvgpr_write_b32 a253, v53
  v_accvgpr_write_b32 a254, v54
  v_accvgpr_write_b32 a255, v55
  s_waitcnt vmcnt(0)
  s_barrier
  s_cmp_lg_u32 s17, 0
  s_cbranch_scc1 g_ar_78
  s_lshl_b32 s36, s89, 3
  s_lshl_b64 s[36:37], 1, s36
  v_lshlrev_b32 v52, 3, s91
  v_mov_b32 v48, s36
  v_mov_b32 v49, s37
  s_mov_b64 exec, 1
  global_atomic_add_x2 v[50:51], v52, v[48:49], s[12:13] sc0
  s_mov_b64 exec, -1
g_ar_78:
  s_waitcnt vmcnt(0)
  s_cmp_lg_u32 s17, 0
  s_cbranch_scc1 g_af_79
  v_readfirstlane_b32 s36, v50
  v_readfirstlane_b32 s37, v51
  s_add_u32 s38, s36, s37
  s_mul_i32 s38, s38, 0x01010101
  s_lshr_b32 s38, s38, 24
  s_cmp_lg_u32 s38, 15
  s_cbranch_scc1 g_af_79
  s_lshl_b32 s38, s89, 3
  s_lshr_b64 s[36:37], s[36:37], s38
  s_and_b32 s36, s36, 0xff
  s_cmp_eq_u32 s36, 15
  s_cselect_b32 s36, 1, 2
  v_mov_b32 v48, s36
  v_lshrrev_b32 v52, 1, v52
  s_mov_b64 exec, 1
  global_store_dword v52, v48, s[12:13] offset:128 sc1
  s_mov_b64 exec, -1
g_af_79:
  v_mbcnt_lo_u32_b32 v60, -1, 0
  v_and_b32 v60, 0, v60
  v_add_lshl_u32 v60, v60, s91, 2
  s_mov_b32 s26, 0
g_wt_80:
  global_load_dword v61, v60, s[12:13] offset:128 sc1
  s_add_u32 s26, s26, 1
  s_cmp_gt_u32 s26, 1048576
  s_cbranch_scc1 L_end
  s_waitcnt vmcnt(0)
  v_cmp_eq_u32 vcc, 0, v61
  v_readfirstlane_b32 s27, v61
  s_cbranch_vccnz g_wt_80
  s_cmp_lg_u32 s27, 1
  s_cbranch_scc1 L_o_x
  s_mov_b32 s62, 1
  s_mov_b32 s42, 0
  s_mov_b32 s3, 0
  s_mov_b32 s46, 0
  s_mov_b32 s65, 0
  s_mov_b32 s66, 0
  s_mov_b32 s76, 0
  s_mov_b32 s55, 0
  s_mov_b32 s56, 0
  s_mov_b32 s84, 268435456
  s_mov_b32 s86, s41
  s_mov_b32 s49, s60
  s_mul_i32 s63, s49, 257
  s_or_b32 s63, s63, 1179648
o_round_81:
  s_max_u32 s46, s46, s3
  s_cmp_lg_u32 s3, 0
  s_mov_b32 s3, 0
  s_cbranch_scc1 d_g_93
  s_mov_b32 s67, 0
d_w_92:
  s_min_u32 s26, s49, 71
  s_lshl_b32 s26, s26, 12
  s_add_u32 s27, s26, 243494912
  s_add_u32 s26, s26, 243486720
  buffer_load_dword v248, v246, s[4:7], s26 offen sc1
  buffer_load_dword v249, v246, s[4:7], s27 offen sc1
  s_add_u32 s67, s67, 1
  s_cmp_gt_u32 s67, 1048576
  s_cbranch_scc1 L_end
  s_waitcnt vmcnt(0)
  s_mov_b64 exec, 1
  buffer_store_dword v38, off, s[4:7], s84 sc1
  s_mov_b64 exec, -1
  s_mov_b32 s84, 268435456
  v_min_u32 v162, v248, v249
  v_max_u32 v163, v248, v249
  v_cmp_eq_u32 vcc, 0, v162
  s_cbranch_vccnz d_w_92
  v_max_u32_dpp v163, v163, v163 row_ror:8 row_mask:0xf bank_mask:0xf
  s_nop 1
  v_max_u32_dpp v163, v163, v163 row_ror:4 row_mask:0xf bank_mask:0xf
  s_nop 1
  v_max_u32_dpp v163, v163, v163 row_ror:2 row_mask:0xf bank_mask:0xf
  s_nop 1
  v_max_u32_dpp v163, v163, v163 row_ror:1 row_mask:0xf bank_mask:0xf
  s_nop 0
  v_readlane_b32 s28, v163, 0
  v_readlane_b32 s29, v163, 16
  v_readlane_b32 s30, v163, 32
  v_readlane_b32 s31, v163, 48
  s_max_u32 s28, s28, s29
  s_max_u32 s30, s30, s31
  s_max_u32 s46, s46, s28
  s_max_u32 s46, s46, s30
d_g_93:
  s_lshr_b32 s27, s49, 2
  s_andn2_b32 s52, 0xfff, s46
  s_lshr_b32 s52, s52, 5
  s_min_u32 s52, s52, 64
  s_add_u32 s26, s52, 3
  v_readlane_b32 s89, v247, s27
  s_sub_u32 s26, s26, s60
  s_lshr_b32 s26, s26, 2
  s_bfm_b32 s54, s26, 0
  s_add_u32 s53, s63, 1028
  s_cmp_lt_u32 s49, 60
  s_cselect_b32 s53, s53, 0
  s_cmp_lt_u32 s49, 64
  s_cselect_b32 s26, 3, 1
  s_sub_i32 s26, s27, s26
  s_max_i32 s26, s26, 0
  s_min_u32 s26, s26, 16
  s_bfm_b32 s58, s26, 0
  s_cmp_eq_u32 s27, 16
  s_cselect_b32 s59, 2, 1
  s_cmp_eq_u32 s27, 18
  s_cselect_b32 s59, 64, s59
  s_cselect_b32 s50, 0, -1
  s_cselect_b32 s89, 0, s89
o_pick_85:
  s_cmp_eq_u32 s59, 0
  s_cbranch_scc1 o_none_89
  s_sub_u32 s59, s59, 1
  s_andn2_b32 s26, s58, s55
  s_and_b32 s26, s26, s54
  s_cbranch_scc1 o_ga_86
  s_and_b32 s26, s55, s50
  s_or_b32 s26, s26, s56
  s_or_b32 s26, s26, s54
  s_andn2_b32 s26, s58, s26
  s_cbranch_scc0 o_none_89
  s_cmp_ge_u32 s46, s89
  s_cbranch_scc1 o_gb_87
o_ga_86:
  s_ff1_i32_b32 s26, s26
  s_bitset1_b32 s55, s26
  s_mov_b32 s64, 1327168
  s_branch o_gd_88
o_none_89:
  s_cmp_lt_u32 s49, 60
  s_cbranch_scc1 o_nn_90
  s_cmp_eq_u32 s50, 0
  s_cbranch_scc1 o_nn_90
  s_and_b32 s26, s63, 1097728
  s_cmp_eq_u32 s26, 1048576
  s_cbranch_scc1 o_nn_90
  s_cmp_lt_u32 s49, 64
  s_cbranch_scc1 o_adv_91
  s_and_b32 s26, s65, 1097728
  s_cmp_lg_u32 s26, 1048576
  s_cbranch_scc1 o_adv_91
o_nn_90:
  s_mov_b32 s64, s53
  s_mov_b32 s51, 0
  s_branch o_task_82
o_gb_87:
  s_ff1_i32_b32 s26, s26
  s_bitset1_b32 s56, s26
  s_andn2_b32 s27, 31, s46
  s_or_b32 s27, s27, 32
  s_lshl_b32 s27, s27, 22
  s_or_b32 s27, s27, 1474688
  s_lshl_b32 s28, s26, 2
  s_add_u32 s28, s28, s60
  s_cmp_eq_u32 s28, s52
  s_cselect_b32 s64, s27, 1474624
o_gd_88:
  s_lshl_b32 s26, s26, 2
  s_add_u32 s26, s26, s60
  s_mul_i32 s26, s26, 257
  s_or_b32 s64, s64, s26
  s_mov_b32 s51, 1
o_task_82:
  s_cmp_eq_u32 s63, 0
  s_cbranch_scc1 o_nofl_83
  s_cmp_lg_u32 s66, 0
  s_cbranch_scc1 o_have_95
  s_mov_b32 s67, 0
o_w1_94:
  s_and_b32 s32, s63, 0xff
  s_lshl_b32 s32, s32, 12
  s_add_u32 s32, s32, s14
  buffer_load_dword v37, v36, s[4:7], s32 offen sc1
  s_add_u32 s67, s67, 1
  s_cmp_gt_u32 s67, 1048576
  s_cbranch_scc1 L_end
  s_waitcnt vmcnt(0)
  s_mov_b64 exec, 1
  buffer_store_dword v38, off, s[4:7], s84 sc1
  s_mov_b64 exec, -1
  s_mov_b32 s84, 268435456
  v_cmp_eq_u32 vcc, 0, v37
  s_cbranch_vccnz o_w1_94
  s_and_b32 s87, s63, 0xff
  s_lshl_b32 s33, s87, 18
  s_lshl_b32 s32, s87, 19
  s_add_u32 m0, s22, 0
  s_add_u32 s33, s33, s19
  buffer_load_dwordx4 v0, s[4:7], s33 offen offset:0 sc1 lds
  buffer_load_dwordx4 v0, s[4:7], s33 offen offset:1024 sc1 lds
  buffer_load_dwordx4 v0, s[4:7], s33 offen offset:2048 sc1 lds
  buffer_load_dwordx4 v0, s[4:7], s33 offen offset:3072 sc1 lds
  s_add_u32 m0, s23, 0
  s_add_u32 s32, s32, s18
  buffer_load_dwordx4 v0, s[4:7], s32 offen offset:0 sc1 lds
  buffer_load_dwordx4 v0, s[4:7], s32 offen offset:1024 sc1 lds
  buffer_load_dwordx4 v0, s[4:7], s32 offen offset:2048 sc1 lds
  buffer_load_dwordx4 v0, s[4:7], s32 offen offset:3072 sc1 lds
  s_add_u32 m0, m0, 4096
  s_add_u32 s32, s32, 4096
  buffer_load_dwordx4 v0, s[4:7], s32 offen offset:0 sc1 lds
  buffer_load_dwordx4 v0, s[4:7], s32 offen offset:1024 sc1 lds
  buffer_load_dwordx4 v0, s[4:7], s32 offen offset:2048 sc1 lds
  buffer_load_dwordx4 v0, s[4:7], s32 offen offset:3072 sc1 lds
  s_waitcnt vmcnt(0)
  s_barrier
o_have_95:
  ds_read_b128 v[120:123], v33 offset:0
  ds_read_b128 v[40:43], v32 offset:0
  ds_read_b128 v[56:59], v32 offset:1024
  ds_read_b128 v[124:127], v33 offset:2048
  ds_read_b128 v[44:47], v32 offset:4096
  ds_read_b128 v[60:63], v32 offset:5120
  ds_read_b128 v[128:131], v33 offset:4096
  ds_read_b128 v[48:51], v32 offset:8192
  ds_read_b128 v[64:67], v32 offset:9216
  ds_read_b128 v[132:135], v33 offset:6144
  ds_read_b128 v[52:55], v32 offset:12288
  ds_read_b128 v[68:71], v32 offset:13312
  s_cmp_lt_u32 s17, 2
  s_cselect_b32 s65, s65, 0
  s_cmp_lg_u32 s65, 0
  s_cselect_b64 s[44:45], -1, 0
  s_mov_b32 s95, s86
  s_mov_b32 s96, s42
  s_lshl_b32 s97, s43, 14
  s_add_u32 s97, s97, s95
  s_and_b32 s87, s64, 0xff
  s_lshl_b32 s87, s87, 12
  s_add_u32 s87, s87, s14
  s_and_b32 s88, s63, 0xff00
  s_lshl_b32 s88, s88, 3
  s_add_u32 s88, s88, s15
  s_and_b32 s91, s65, 63
  s_lshl_b32 s90, s91, 5
  s_add_u32 s94, s90, s85
  s_add_u32 s90, s90, s43
  s_lshl_b32 s94, s94, 10
  s_lshr_b32 s92, s65, 22
  s_xor_b32 s93, s43, 32
  s_lshl_b32 s91, s90, 10
  s_add_u32 s94, s94, 25165824
  s_cmp_eq_u32 s92, s93
  s_cselect_b32 s92, s94, s91
  s_add_u32 s92, s92, 10485760
  s_and_b32 s93, s65, 49152
  s_cselect_b32 s92, s92, s91
  s_cselect_b64 s[80:81], s[4:5], s[72:73]
  s_cselect_b32 s82, s6, s74
  s_waitcnt lgkmcnt(9)
  v_mfma_f32_16x16x32_bf16 v[104:107], v[40:43], v[120:123], v[24:27]
  v_mfma_f32_16x16x32_bf16 v[108:111], v[56:59], v[120:123], v[28:31]
  s_mov_b64 exec, s[44:45]
  buffer_load_dword v7, v255, s[4:7], s97 offen sc1
  buffer_load_dwordx4 v[184:187], v0, s[80:83], s92 offen sc1
  s_not_b64 exec, exec
  buffer_load_dword v37, v36, s[4:7], s87 offen sc1
  s_mov_b64 exec, -1
  buffer_load_dword v244, v252, s[4:7], s88 offen sc1
  s_waitcnt lgkmcnt(6)
  v_mfma_f32_16x16x32_bf16 v[104:107], v[44:47], v[124:127], v[104:107]
  v_mfma_f32_16x16x32_bf16 v[108:111], v[60:63], v[124:127], v[108:111]
  s_waitcnt lgkmcnt(3)
  v_mfma_f32_16x16x32_bf16 v[104:107], v[48:51], v[128:131], v[104:107]
  v_mfma_f32_16x16x32_bf16 v[108:111], v[64:67], v[128:131], v[108:111]
  s_waitcnt lgkmcnt(0)
  v_mfma_f32_16x16x32_bf16 v[104:107], v[52:55], v[132:135], v[104:107]
  v_mfma_f32_16x16x32_bf16 v[108:111], v[68:71], v[132:135], v[108:111]
  s_cmp_lg_u32 s76, 0
  s_cbranch_scc1 o_klds_98
  v_mov_b32 v196, 0
  v_mov_b32 v199, 0
  v_exp_f32 v56, v104
  v_exp_f32 v57, v105
  v_exp_f32 v58, v106
  v_exp_f32 v59, v107
  v_exp_f32 v60, v108
  v_exp_f32 v61, v109
  v_exp_f32 v62, v110
  v_exp_f32 v63, v111
  v_max3_f32 v116, v104, v105, v106
  v_max3_f32 v116, v107, v108, v116
  v_max3_f32 v116, v109, v110, v116
  v_add_f32 v117, v56, v57
  v_add_f32 v118, v58, v59
  v_add_f32 v117, v117, v60
  v_add_f32 v118, v118, v61
  v_add_f32 v117, v117, v62
  v_add_f32 v118, v118, v63
  s_mov_b32 s67, 0
  s_and_b32 s32, s63, 0xff00
  s_lshl_b32 s32, s32, 10
  s_add_u32 s32, s32, s20
  s_add_u32 s33, s32, 4096
o_w2_96:
  s_waitcnt vmcnt(0)
  v_cmp_eq_u32 vcc, 0, v244
  s_cbranch_vccz o_kgo_106
  s_mov_b64 exec, 1
  buffer_store_dword v38, off, s[4:7], s84 sc1
  s_mov_b64 exec, -1
  s_mov_b32 s84, 268435456
  buffer_load_dword v244, v252, s[4:7], s88 offen sc1
  s_add_u32 s67, s67, 1
  s_cmp_gt_u32 s67, 1048576
  s_cbranch_scc1 L_end
  s_branch o_w2_96
o_kgo_106:
  buffer_load_dwordx4 v[136:139], v0, s[4:7], s32 offen offset:0 sc1
  buffer_load_dwordx4 v[140:143], v0, s[4:7], s32 offen offset:1024 sc1
  buffer_load_dwordx4 v[144:147], v0, s[4:7], s32 offen offset:2048 sc1
  buffer_load_dwordx4 v[148:151], v0, s[4:7], s32 offen offset:3072 sc1
  buffer_load_dwordx2 v[200:201], v1, s[4:7], s33 offen offset:0 sc1
  buffer_load_dwordx2 v[202:203], v1, s[4:7], s33 offen offset:512 sc1
  buffer_load_dwordx2 v[204:205], v1, s[4:7], s33 offen offset:1024 sc1
  buffer_load_dwordx2 v[206:207], v1, s[4:7], s33 offen offset:1536 sc1
  buffer_load_dword v37, v36, s[4:7], s87 offen sc1
  buffer_load_dword v244, v252, s[4:7], s88 offen sc1
  s_barrier
  ds_read_b128 v[152:155], v32 offset:2048
  ds_read_b128 v[156:159], v32 offset:3072
  ds_read_b128 v[160:163], v32 offset:6144
  ds_read_b128 v[164:167], v32 offset:7168
  ds_read_b128 v[168:171], v32 offset:10240
  ds_read_b128 v[172:175], v32 offset:11264
  ds_read_b128 v[176:179], v32 offset:14336
  ds_read_b128 v[180:183], v32 offset:15360
  s_waitcnt vmcnt(9)
  v_mfma_f32_16x16x32_bf16 v[112:115], v[136:139], v[120:123], 0
  s_waitcnt vmcnt(8)
  v_mfma_f32_16x16x32_bf16 v[112:115], v[140:143], v[124:127], v[112:115]
  s_waitcnt vmcnt(7)
  v_mfma_f32_16x16x32_bf16 v[112:115], v[144:147], v[128:131], v[112:115]
  s_waitcnt vmcnt(6)
  v_mfma_f32_16x16x32_bf16 v[112:115], v[148:151], v[132:135], v[112:115]
  s_waitcnt vmcnt(2)
  s_branch o_havek_97
o_klds_98:
  s_waitcnt vmcnt(12)
  s_barrier
  ds_read_b128 v[136:139], v34 offset:0
  ds_read_b128 v[140:143], v34 offset:1024
  ds_read_b128 v[144:147], v34 offset:2048
  ds_read_b128 v[148:151], v34 offset:3072
  ds_read_b64 v[200:201], v35 offset:4096
  ds_read_b64 v[202:203], v35 offset:4608
  ds_read_b64 v[204:205], v35 offset:5120
  ds_read_b64 v[206:207], v35 offset:5632
  v_mov_b32 v196, 0
  v_mov_b32 v199, 0
  v_exp_f32 v56, v104
  v_exp_f32 v57, v105
  v_exp_f32 v58, v106
  v_exp_f32 v59, v107
  v_exp_f32 v60, v108
  v_exp_f32 v61, v109
  v_exp_f32 v62, v110
  v_exp_f32 v63, v111
  v_max3_f32 v116, v104, v105, v106
  v_max3_f32 v116, v107, v108, v116
  v_max3_f32 v116, v109, v110, v116
  s_waitcnt lgkmcnt(4)
  v_mfma_f32_16x16x32_bf16 v[112:115], v[136:139], v[120:123], 0
  ds_read_b128 v[152:155], v32 offset:2048
  ds_read_b128 v[156:159], v32 offset:3072
  v_mfma_f32_16x16x32_bf16 v[112:115], v[140:143], v[124:127], v[112:115]
  ds_read_b128 v[160:163], v32 offset:6144
  ds_read_b128 v[164:167], v32 offset:7168
  v_mfma_f32_16x16x32_bf16 v[112:115], v[144:147], v[128:131], v[112:115]
  ds_read_b128 v[168:171], v32 offset:10240
  ds_read_b128 v[172:175], v32 offset:11264
  v_mfma_f32_16x16x32_bf16 v[112:115], v[148:151], v[132:135], v[112:115]
  ds_read_b128 v[176:179], v32 offset:14336
  ds_read_b128 v[180:183], v32 offset:15360
  v_add_f32 v117, v56, v57
  v_add_f32 v118, v58, v59
  v_add_f32 v117, v117, v60
  v_add_f32 v118, v118, v61
  v_add_f32 v117, v117, v62
  v_add_f32 v118, v118, v63
o_havek_97:
  s_cmp_lg_u32 s65, 0
  s_cbranch_scc1 o_wr1_103
  s_nop 3
  v_mul_f32 v112, s24, v112
  v_mul_f32 v113, s24, v113
  v_exp_f32 v64, v112
  v_exp_f32 v65, v113
  v_max_f32 v116, v111, v116
  v_max3_f32 v116, v112, v113, v116
  v_add_f32 v117, v117, v64
  v_add_f32 v118, v118, v65
  v_add_f32 v117, v117, v118
  s_mov_b32 s28, 0x21800000
  v_mov_b32 v118, v117
  s_nop 1
  v_permlane16_swap_b32 v117, v118
  v_add_f32 v117, v117, v118
  v_mov_b32 v118, v117
  s_nop 0
  s_nop 0
  v_permlane32_swap_b32 v117, v118
  v_add_f32 v117, v117, v118
  v_cmp_lt_f32 vcc, 0x42700000, v116
  v_cmp_gt_f32 s[30:31], s28, v117
  v_rcp_f32 v117, v117
  s_or_b64 vcc, vcc, s[30:31]
  s_cbranch_vccnz o_fb_107
o_fbr_108:
  v_pk_mul_f32 v[56:57], v[56:57], v[116:117] op_sel:[0,1] op_sel_hi:[1,1]
  v_pk_mul_f32 v[58:59], v[58:59], v[116:117] op_sel:[0,1] op_sel_hi:[1,1]
  v_pk_mul_f32 v[60:61], v[60:61], v[116:117] op_sel:[0,1] op_sel_hi:[1,1]
  v_pk_mul_f32 v[62:63], v[62:63], v[116:117] op_sel:[0,1] op_sel_hi:[1,1]
  v_pk_mul_f32 v[64:65], v[64:65], v[116:117] op_sel:[0,1] op_sel_hi:[1,1]
  v_cvt_pk_bf16_f32 v116, v56, v57
  v_cvt_pk_bf16_f32 v117, v58, v59
  v_cvt_pk_bf16_f32 v118, v60, v61
  v_cvt_pk_bf16_f32 v119, v62, v63
  s_waitcnt lgkmcnt(0)
  s_nop 0
  v_mfma_f32_16x16x32_bf16 v[72:75], v[152:155], v[116:119], 0
  s_add_u32 s62, s62, 1
  v_cvt_pk_bf16_f32 v197, v64, v65
  v_cvt_pk_bf16_f32 v198, v64, v65
  v_mfma_f32_16x16x32_bf16 v[76:79], v[156:159], v[116:119], 0
  s_xor_b32 s86, s86, 524288
  v_mfma_f32_16x16x32_bf16 v[80:83], v[160:163], v[116:119], 0
  s_bfe_u32 s42, s62, 0x10001
  v_mfma_f32_16x16x32_bf16 v[84:87], v[164:167], v[116:119], 0
  s_bfe_u32 s26, s64, 65556
  v_mfma_f32_16x16x32_bf16 v[88:91], v[168:171], v[116:119], 0
  s_and_b32 s87, s64, 0xff
  v_mfma_f32_16x16x32_bf16 v[92:95], v[172:175], v[116:119], 0
  s_bfe_u32 s88, s64, 0x80008
  v_mfma_f32_16x16x32_bf16 v[96:99], v[176:179], v[116:119], 0
  s_nop 0
  v_mfma_f32_16x16x32_bf16 v[100:103], v[180:183], v[116:119], 0
  s_nop 0
  v_mfma_f32_16x16x16_bf16 v[72:75], v[200:201], v[198:199], v[72:75]
  s_nop 1
  v_mfma_f32_16x16x16_bf16 v[76:79], v[200:201], v[196:197], v[76:79]
  s_nop 1
  v_mfma_f32_16x16x16_bf16 v[80:83], v[202:203], v[198:199], v[80:83]
  s_nop 1
  v_mfma_f32_16x16x16_bf16 v[84:87], v[202:203], v[196:197], v[84:87]
  s_nop 1
  v_mfma_f32_16x16x16_bf16 v[88:91], v[204:205], v[198:199], v[88:91]
  s_nop 0
  v_cvt_pk_bf16_f32 v40, v72, v73
  v_cvt_pk_bf16_f32 v41, v74, v75
  v_mfma_f32_16x16x16_bf16 v[92:95], v[204:205], v[196:197], v[92:95]
  s_nop 0
  v_cvt_pk_bf16_f32 v42, v76, v77
  v_cvt_pk_bf16_f32 v43, v78, v79
  v_mfma_f32_16x16x16_bf16 v[96:99], v[206:207], v[198:199], v[96:99]
  s_nop 0
  ds_write_b128 v6, v[40:43] offset:0
  v_cvt_pk_bf16_f32 v44, v80, v81
  v_mfma_f32_16x16x16_bf16 v[100:103], v[206:207], v[196:197], v[100:103]
  s_nop 0
  v_cvt_pk_bf16_f32 v45, v82, v83
  v_cvt_pk_bf16_f32 v46, v84, v85
  v_cvt_pk_bf16_f32 v47, v86, v87
  ds_write_b128 v6, v[44:47] offset:1024
  v_cvt_pk_bf16_f32 v48, v88, v89
  v_cvt_pk_bf16_f32 v49, v90, v91
  v_cvt_pk_bf16_f32 v50, v92, v93
  v_cvt_pk_bf16_f32 v51, v94, v95
  ds_write_b128 v6, v[48:51] offset:2048
  v_cvt_pk_bf16_f32 v52, v96, v97
  v_cvt_pk_bf16_f32 v53, v98, v99
  v_cvt_pk_bf16_f32 v54, v100, v101
  v_cvt_pk_bf16_f32 v55, v102, v103
  ds_write_b128 v6, v[52:55] offset:3072
  s_cmp_lt_u32 s17, 2
  s_cbranch_scc1 o_wr0_102
  s_waitcnt lgkmcnt(0)
  s_barrier
  ds_read_b128 v[104:107], v3 offset:0
  ds_read_b128 v[108:111], v3 offset:512
  ds_read_b128 v[112:115], v3 offset:1024
  s_waitcnt lgkmcnt(2)
  v_mfma_f32_32x32x16_bf16 v[40:55], v[104:107], a[0:3], 0
  s_waitcnt vmcnt(0)
  v_cmp_eq_u32 vcc, 0, v37
  s_cmp_eq_u64 vcc, 0
  s_cselect_b32 s66, s26, 0
  s_cmp_eq_u32 s66, 1
  s_cselect_b32 s87, s87, 1024
  s_cselect_b32 s34, 0, 0x28000
  v_mfma_f32_32x32x16_bf16 v[56:71], v[104:107], a[4:7], 0
  ds_read_b128 v[116:119], v3 offset:1536
  s_lshl_b32 s33, s87, 18
  s_lshl_b32 s32, s87, 19
  s_add_u32 m0, s22, s34
  s_add_u32 s33, s33, s19
  s_min_u32 s28, s49, 67
  v_mfma_f32_32x32x16_bf16 v[72:87], v[104:107], a[8:11], 0
  s_lshl1_add_u32 s28, s17, s28
  s_lshl_b32 s28, s28, 12
  s_add_u32 s28, s28, 243486720
  v_mfma_f32_32x32x16_bf16 v[88:103], v[104:107], a[12:15], 0
  buffer_load_dword v249, v246, s[4:7], s28 offen sc1
  s_waitcnt lgkmcnt(2)
  v_mfma_f32_32x32x16_bf16 v[40:55], v[108:111], a[16:19], v[40:55]
  buffer_load_dwordx4 v0, s[4:7], s33 offen offset:0 sc1 lds
  v_mfma_f32_32x32x16_bf16 v[56:71], v[108:111], a[20:23], v[56:71]
  ds_read_b128 v[104:107], v3 offset:2048
  v_mfma_f32_32x32x16_bf16 v[72:87], v[108:111], a[24:27], v[72:87]
  buffer_load_dwordx4 v0, s[4:7], s33 offen offset:1024 sc1 lds
  v_mfma_f32_32x32x16_bf16 v[88:103], v[108:111], a[28:31], v[88:103]
  buffer_load_dwordx4 v0, s[4:7], s33 offen offset:2048 sc1 lds
  s_waitcnt lgkmcnt(2)
  v_mfma_f32_32x32x16_bf16 v[40:55], v[112:115], a[32:35], v[40:55]
  v_mfma_f32_32x32x16_bf16 v[56:71], v[112:115], a[36:39], v[56:71]
  ds_read_b128 v[108:111], v3 offset:2560
  buffer_load_dwordx4 v0, s[4:7], s33 offen offset:3072 sc1 lds
  s_sub_u32 m0, m0, 8192
  s_sub_u32 s33, s33, 8192
  v_mfma_f32_32x32x16_bf16 v[72:87], v[112:115], a[40:43], v[72:87]
  buffer_load_dwordx4 v0, s[4:7], s33 offen offset:0 sc1 lds
  v_mfma_f32_32x32x16_bf16 v[88:103], v[112:115], a[44:47], v[88:103]
  s_waitcnt lgkmcnt(2)
  v_mfma_f32_32x32x16_bf16 v[40:55], v[116:119], a[48:51], v[40:55]
  buffer_load_dwordx4 v0, s[4:7], s33 offen offset:1024 sc1 lds
  v_mfma_f32_32x32x16_bf16 v[56:71], v[116:119], a[52:55], v[56:71]
  ds_read_b128 v[112:115], v3 offset:3072
  buffer_load_dwordx4 v0, s[4:7], s33 offen offset:2048 sc1 lds
  v_mfma_f32_32x32x16_bf16 v[72:87], v[116:119], a[56:59], v[72:87]
  v_mfma_f32_32x32x16_bf16 v[88:103], v[116:119], a[60:63], v[88:103]
  buffer_load_dwordx4 v0, s[4:7], s33 offen offset:3072 sc1 lds
  s_add_u32 m0, s23, s34
  s_add_u32 s32, s32, s18
  s_waitcnt lgkmcnt(2)
  v_mfma_f32_32x32x16_bf16 v[40:55], v[104:107], a[64:67], v[40:55]
  buffer_load_dwordx4 v0, s[4:7], s32 offen offset:0 sc1 lds
  v_mfma_f32_32x32x16_bf16 v[56:71], v[104:107], a[68:71], v[56:71]
  ds_read_b128 v[116:119], v3 offset:3584
  v_mfma_f32_32x32x16_bf16 v[72:87], v[104:107], a[72:75], v[72:87]
  buffer_load_dwordx4 v0, s[4:7], s32 offen offset:1024 sc1 lds
  s_add_i32 m0, m0, 4096
  s_add_i32 s32, s32, 4096
  v_mfma_f32_32x32x16_bf16 v[88:103], v[104:107], a[76:79], v[88:103]
  buffer_load_dwordx4 v0, s[4:7], s32 offen offset:0 sc1 lds
  s_waitcnt lgkmcnt(2)
  v_mfma_f32_32x32x16_bf16 v[40:55], v[108:111], a[80:83], v[40:55]
  v_mfma_f32_32x32x16_bf16 v[56:71], v[108:111], a[84:87], v[56:71]
  ds_read_b128 v[104:107], v3 offset:8192
  buffer_load_dwordx4 v0, s[4:7], s32 offen offset:1024 sc1 lds
  s_add_i32 m0, m0, -16384
  s_add_i32 s32, s32, -16384
  v_mfma_f32_32x32x16_bf16 v[72:87], v[108:111], a[88:91], v[72:87]
  s_and_b32 s29, s64, 0xff00
  s_lshl_b32 s29, s29, 3
  s_add_u32 s29, s29, s15
  buffer_load_dword v245, v252, s[4:7], s29 offen sc1
  v_mfma_f32_32x32x16_bf16 v[88:103], v[108:111], a[92:95], v[88:103]
  s_waitcnt lgkmcnt(2)
  v_mfma_f32_32x32x16_bf16 v[40:55], v[112:115], a[96:99], v[40:55]
  buffer_load_dwordx4 v0, s[4:7], s32 offen offset:0 sc1 lds
  v_mfma_f32_32x32x16_bf16 v[56:71], v[112:115], a[100:103], v[56:71]
  ds_read_b128 v[108:111], v3 offset:8704
  buffer_load_dwordx4 v0, s[4:7], s32 offen offset:1024 sc1 lds
  s_add_i32 m0, m0, -4096
  s_add_i32 s32, s32, -4096
  v_mfma_f32_32x32x16_bf16 v[72:87], v[112:115], a[104:107], v[72:87]
  v_mfma_f32_32x32x16_bf16 v[88:103], v[112:115], a[108:111], v[88:103]
  buffer_load_dwordx4 v0, s[4:7], s32 offen offset:0 sc1 lds
  s_waitcnt lgkmcnt(2)
  v_mfma_f32_32x32x16_bf16 v[40:55], v[116:119], a[112:115], v[40:55]
  buffer_load_dwordx4 v0, s[4:7], s32 offen offset:1024 sc1 lds
  v_mfma_f32_32x32x16_bf16 v[56:71], v[116:119], a[116:119], v[56:71]
  ds_read_b128 v[112:115], v3 offset:9216
  v_mfma_f32_32x32x16_bf16 v[72:87], v[116:119], a[120:123], v[72:87]
  buffer_load_dwordx4 v0, s[4:7], s32 offen offset:2048 sc1 lds
  v_mfma_f32_32x32x16_bf16 v[88:103], v[116:119], a[124:127], v[88:103]
  buffer_load_dwordx4 v0, s[4:7], s32 offen offset:3072 sc1 lds
  s_add_i32 m0, m0, 4096
  s_add_i32 s32, s32, 4096
  s_waitcnt lgkmcnt(2)
  v_mfma_f32_32x32x16_bf16 v[40:55], v[104:107], a[128:131], v[40:55]
  v_mfma_f32_32x32x16_bf16 v[56:71], v[104:107], a[132:135], v[56:71]
  ds_read_b128 v[116:119], v3 offset:9728
  buffer_load_dwordx4 v0, s[4:7], s32 offen offset:2048 sc1 lds
  v_mfma_f32_32x32x16_bf16 v[72:87], v[104:107], a[136:139], v[72:87]
  buffer_load_dwordx4 v0, s[4:7], s32 offen offset:3072 sc1 lds
  s_add_i32 m0, m0, 16384
  s_add_i32 s32, s32, 16384
  v_mfma_f32_32x32x16_bf16 v[88:103], v[104:107], a[140:143], v[88:103]
  s_waitcnt lgkmcnt(2)
  v_mfma_f32_32x32x16_bf16 v[40:55], v[108:111], a[144:147], v[40:55]
  buffer_load_dwordx4 v0, s[4:7], s32 offen offset:2048 sc1 lds
  v_mfma_f32_32x32x16_bf16 v[56:71], v[108:111], a[148:151], v[56:71]
  ds_read_b128 v[104:107], v3 offset:10240
  buffer_load_dwordx4 v0, s[4:7], s32 offen offset:3072 sc1 lds
  s_add_i32 m0, m0, -4096
  s_add_i32 s32, s32, -4096
  v_mfma_f32_32x32x16_bf16 v[72:87], v[108:111], a[152:155], v[72:87]
  v_mfma_f32_32x32x16_bf16 v[88:103], v[108:111], a[156:159], v[88:103]
  buffer_load_dwordx4 v0, s[4:7], s32 offen offset:2048 sc1 lds
  s_waitcnt lgkmcnt(2)
  v_mfma_f32_32x32x16_bf16 v[40:55], v[112:115], a[160:163], v[40:55]
  buffer_load_dwordx4 v0, s[4:7], s32 offen offset:3072 sc1 lds
  v_mfma_f32_32x32x16_bf16 v[56:71], v[112:115], a[164:167], v[56:71]
  ds_read_b128 v[108:111], v3 offset:10752
  v_mfma_f32_32x32x16_bf16 v[72:87], v[112:115], a[168:171], v[72:87]
  v_mfma_f32_32x32x16_bf16 v[88:103], v[112:115], a[172:175], v[88:103]
  s_waitcnt lgkmcnt(2)
  v_mfma_f32_32x32x16_bf16 v[40:55], v[116:119], a[176:179], v[40:55]
  v_mfma_f32_32x32x16_bf16 v[56:71], v[116:119], a[180:183], v[56:71]
  ds_read_b128 v[112:115], v3 offset:11264
  v_mfma_f32_32x32x16_bf16 v[72:87], v[116:119], a[184:187], v[72:87]
  v_mfma_f32_32x32x16_bf16 v[88:103], v[116:119], a[188:191], v[88:103]
  s_waitcnt lgkmcnt(2)
  v_mfma_f32_32x32x16_bf16 v[40:55], v[104:107], a[192:195], v[40:55]
  v_mfma_f32_32x32x16_bf16 v[56:71], v[104:107], a[196:199], v[56:71]
  ds_read_b128 v[116:119], v3 offset:11776
  s_waitcnt vmcnt(12)
  v_cmp_eq_u32 vcc, 0, v245
  s_cmp_eq_u64 vcc, 0
  s_cselect_b32 s76, s26, 0
  s_and_b32 s76, s76, 1
  s_cselect_b32 s88, s88, 1024
  s_waitcnt lgkmcnt(2)
  v_mfma_f32_32x32x16_bf16 v[40:55], v[108:111], a[208:211], v[40:55]
  s_lshl_b32 s32, s88, 18
  s_mov_b32 m0, s40
  s_add_u32 s32, s32, s21
  buffer_load_dwordx4 v0, s[4:7], s32 offen offset:0 sc1 lds
  v_mfma_f32_32x32x16_bf16 v[56:71], v[108:111], a[212:215], v[56:71]
  buffer_load_dwordx4 v0, s[4:7], s32 offen offset:1024 sc1 lds
  s_waitcnt lgkmcnt(1)
  v_mfma_f32_32x32x16_bf16 v[40:55], v[112:115], a[224:227], v[40:55]
  buffer_load_dwordx4 v0, s[4:7], s32 offen offset:2048 sc1 lds
  s_sub_u32 m0, m0, 8192
  s_sub_u32 s32, s32, 8192
  v_mfma_f32_32x32x16_bf16 v[56:71], v[112:115], a[228:231], v[56:71]
  buffer_load_dwordx4 v0, s[4:7], s32 offen offset:0 sc1 lds
  s_waitcnt lgkmcnt(0)
  v_mfma_f32_32x32x16_bf16 v[40:55], v[116:119], a[240:243], v[40:55]
  buffer_load_dwordx4 v0, s[4:7], s32 offen offset:1024 sc1 lds
  v_mfma_f32_32x32x16_bf16 v[56:71], v[116:119], a[244:247], v[56:71]
  buffer_load_dwordx4 v0, s[4:7], s32 offen offset:2048 sc1 lds
  v_cmp_eq_u32 vcc, 0, v249
  v_max_u32_dpp v249, v249, v249 row_ror:8 row_mask:0xf bank_mask:0xf
  s_nop 0
  v_mfma_f32_32x32x16_bf16 v[72:87], v[104:107], a[200:203], v[72:87]
  v_max_u32_dpp v249, v249, v249 row_ror:4 row_mask:0xf bank_mask:0xf
  s_nop 0
  s_nop 0
  v_max_u32_dpp v249, v249, v249 row_ror:2 row_mask:0xf bank_mask:0xf
  s_nop 0
  s_nop 0
  v_max_u32_dpp v249, v249, v249 row_ror:1 row_mask:0xf bank_mask:0xf
  s_nop 0
  v_mfma_f32_32x32x16_bf16 v[88:103], v[104:107], a[204:207], v[88:103]
  v_mov_b32 v248, v249
  s_nop 0
  s_nop 0
  v_permlane16_swap_b32 v249, v248
  v_max_u32 v249, v249, v248
  v_mfma_f32_32x32x16_bf16 v[72:87], v[108:111], a[216:219], v[72:87]
  v_mov_b32 v248, v249
  s_nop 0
  s_nop 0
  v_permlane32_swap_b32 v249, v248
  v_max_u32 v249, v249, v248
  s_cmp_eq_u64 vcc, 0
  s_cselect_b32 s28, 4, 0
  v_mfma_f32_32x32x16_bf16 v[88:103], v[108:111], a[220:223], v[88:103]
  s_lshl_b32 s26, s76, 1
  s_or_b32 s26, s26, s66
  s_or_b32 s26, s26, s28
  v_mov_b32 v248, s26
  ds_write_b64 v39, v[248:249]
  v_mfma_f32_32x32x16_bf16 v[72:87], v[112:115], a[232:235], v[72:87]
  v_cvt_pk_bf16_f32 v212, v40, v56
  v_cvt_pk_bf16_f32 v214, v41, v57
  v_cvt_pk_bf16_f32 v216, v42, v58
  v_cvt_pk_bf16_f32 v218, v43, v59
  v_permlane16_swap_b32 v212, v214
  v_mfma_f32_32x32x16_bf16 v[88:103], v[112:115], a[236:239], v[88:103]
  v_cvt_pk_bf16_f32 v220, v44, v60
  v_cvt_pk_bf16_f32 v222, v45, v61
  v_permlane16_swap_b32 v216, v218
  v_bfi_b32 v212, v254, s42, v212
  v_mfma_f32_32x32x16_bf16 v[72:87], v[116:119], a[248:251], v[72:87]
  v_cvt_pk_bf16_f32 v224, v46, v62
  v_cvt_pk_bf16_f32 v226, v47, v63
  v_permlane16_swap_b32 v220, v222
  v_bfi_b32 v216, v254, s42, v216
  v_cvt_pk_bf16_f32 v228, v48, v64
  v_mfma_f32_32x32x16_bf16 v[88:103], v[116:119], a[252:255], v[88:103]
  v_cvt_pk_bf16_f32 v230, v49, v65
  v_permlane16_swap_b32 v224, v226
  v_bfi_b32 v220, v254, s42, v220
  v_cvt_pk_bf16_f32 v232, v50, v66
  v_cvt_pk_bf16_f32 v234, v51, v67
  v_permlane16_swap_b32 v228, v230
  v_bfi_b32 v224, v254, s42, v224
  v_cvt_pk_bf16_f32 v236, v52, v68
  v_cvt_pk_bf16_f32 v238, v53, v69
  v_permlane16_swap_b32 v232, v234
  v_bfi_b32 v228, v254, s42, v228
  v_cvt_pk_bf16_f32 v240, v54, v70
  v_cvt_pk_bf16_f32 v242, v55, v71
  v_permlane16_swap_b32 v236, v238
  v_bfi_b32 v232, v254, s42, v232
  v_permlane16_swap_b32 v240, v242
  v_bfi_b32 v236, v254, s42, v236
  v_bfi_b32 v240, v254, s42, v240
  v_cvt_pk_bf16_f32 v213, v72, v88
  v_cvt_pk_bf16_f32 v215, v73, v89
  v_cvt_pk_bf16_f32 v217, v74, v90
  v_cvt_pk_bf16_f32 v219, v75, v91
  s_add_u32 s78, s86, 0
  v_permlane16_swap_b32 v213, v215
  buffer_store_dwordx4 v[212:215], v4, s[4:7], s78 offen
  v_cvt_pk_bf16_f32 v221, v76, v92
  v_cvt_pk_bf16_f32 v223, v77, v93
  s_add_u32 s78, s86, 32768
  v_permlane16_swap_b32 v217, v219
  buffer_store_dwordx4 v[216:219], v4, s[4:7], s78 offen
  v_cvt_pk_bf16_f32 v225, v78, v94
  v_cvt_pk_bf16_f32 v227, v79, v95
  s_add_u32 s78, s86, 131072
  v_permlane16_swap_b32 v221, v223
  buffer_store_dwordx4 v[220:223], v4, s[4:7], s78 offen
  v_cvt_pk_bf16_f32 v229, v80, v96
  v_cvt_pk_bf16_f32 v231, v81, v97
  s_add_u32 s78, s86, 163840
  v_permlane16_swap_b32 v225, v227
  buffer_store_dwordx4 v[224:227], v4, s[4:7], s78 offen
  v_cvt_pk_bf16_f32 v233, v82, v98
  v_cvt_pk_bf16_f32 v235, v83, v99
  s_add_u32 s78, s86, 262144
  v_permlane16_swap_b32 v229, v231
  buffer_store_dwordx4 v[228:231], v4, s[4:7], s78 offen
  v_cvt_pk_bf16_f32 v237, v84, v100
  v_cvt_pk_bf16_f32 v239, v85, v101
  s_add_u32 s78, s86, 294912
  v_permlane16_swap_b32 v233, v235
  buffer_store_dwordx4 v[232:235], v4, s[4:7], s78 offen
  v_cvt_pk_bf16_f32 v241, v86, v102
  v_cvt_pk_bf16_f32 v243, v87, v103
  s_add_u32 s78, s86, 393216
  v_permlane16_swap_b32 v237, v239
  buffer_store_dwordx4 v[236:239], v4, s[4:7], s78 offen
  s_add_u32 s78, s86, 425984
  v_permlane16_swap_b32 v241, v243
  buffer_store_dwordx4 v[240:243], v4, s[4:7], s78 offen
  s_waitcnt vmcnt(22)
  s_branch o_we_105
o_wr0_102:
  s_waitcnt lgkmcnt(0)
  s_barrier
  ds_read_b128 v[104:107], v3 offset:0
  ds_read_b128 v[108:111], v3 offset:512
  ds_read_b128 v[112:115], v3 offset:1024
  s_waitcnt lgkmcnt(2)
  v_mfma_f32_32x32x16_bf16 v[40:55], v[104:107], a[0:3], 0
  v_mfma_f32_32x32x16_bf16 v[56:71], v[104:107], a[4:7], 0
  ds_read_b128 v[116:119], v3 offset:1536
  v_mfma_f32_32x32x16_bf16 v[72:87], v[104:107], a[8:11], 0
  v_mfma_f32_32x32x16_bf16 v[88:103], v[104:107], a[12:15], 0
  s_waitcnt lgkmcnt(2)
  v_mfma_f32_32x32x16_bf16 v[40:55], v[108:111], a[16:19], v[40:55]
  v_mfma_f32_32x32x16_bf16 v[56:71], v[108:111], a[20:23], v[56:71]
  ds_read_b128 v[104:107], v3 offset:2048
  v_mfma_f32_32x32x16_bf16 v[72:87], v[108:111], a[24:27], v[72:87]
  v_mfma_f32_32x32x16_bf16 v[88:103], v[108:111], a[28:31], v[88:103]
  s_waitcnt lgkmcnt(2)
  v_mfma_f32_32x32x16_bf16 v[40:55], v[112:115], a[32:35], v[40:55]
  v_mfma_f32_32x32x16_bf16 v[56:71], v[112:115], a[36:39], v[56:71]
  ds_read_b128 v[108:111], v3 offset:2560
  v_mfma_f32_32x32x16_bf16 v[72:87], v[112:115], a[40:43], v[72:87]
  v_mfma_f32_32x32x16_bf16 v[88:103], v[112:115], a[44:47], v[88:103]
  s_waitcnt lgkmcnt(2)
  v_mfma_f32_32x32x16_bf16 v[40:55], v[116:119], a[48:51], v[40:55]
  v_mfma_f32_32x32x16_bf16 v[56:71], v[116:119], a[52:55], v[56:71]
  ds_read_b128 v[112:115], v3 offset:3072
  v_mfma_f32_32x32x16_bf16 v[72:87], v[116:119], a[56:59], v[72:87]
  v_mfma_f32_32x32x16_bf16 v[88:103], v[116:119], a[60:63], v[88:103]
  s_waitcnt lgkmcnt(2)
  v_mfma_f32_32x32x16_bf16 v[40:55], v[104:107], a[64:67], v[40:55]
  v_mfma_f32_32x32x16_bf16 v[56:71], v[104:107], a[68:71], v[56:71]
  ds_read_b128 v[116:119], v3 offset:3584
  v_mfma_f32_32x32x16_bf16 v[72:87], v[104:107], a[72:75], v[72:87]
  v_mfma_f32_32x32x16_bf16 v[88:103], v[104:107], a[76:79], v[88:103]
  s_waitcnt lgkmcnt(2)
  v_mfma_f32_32x32x16_bf16 v[40:55], v[108:111], a[80:83], v[40:55]
  v_mfma_f32_32x32x16_bf16 v[56:71], v[108:111], a[84:87], v[56:71]
  ds_read_b128 v[104:107], v3 offset:8192
  v_mfma_f32_32x32x16_bf16 v[72:87], v[108:111], a[88:91], v[72:87]
  v_mfma_f32_32x32x16_bf16 v[88:103], v[108:111], a[92:95], v[88:103]
  s_waitcnt lgkmcnt(2)
  v_mfma_f32_32x32x16_bf16 v[40:55], v[112:115], a[96:99], v[40:55]
  v_mfma_f32_32x32x16_bf16 v[56:71], v[112:115], a[100:103], v[56:71]
  ds_read_b128 v[108:111], v3 offset:8704
  v_mfma_f32_32x32x16_bf16 v[72:87], v[112:115], a[104:107], v[72:87]
  v_mfma_f32_32x32x16_bf16 v[88:103], v[112:115], a[108:111], v[88:103]
  s_waitcnt lgkmcnt(2)
  v_mfma_f32_32x32x16_bf16 v[40:55], v[116:119], a[112:115], v[40:55]
  v_mfma_f32_32x32x16_bf16 v[56:71], v[116:119], a[116:119], v[56:71]
  ds_read_b128 v[112:115], v3 offset:9216
  v_mfma_f32_32x32x16_bf16 v[72:87], v[116:119], a[120:123], v[72:87]
  v_mfma_f32_32x32x16_bf16 v[88:103], v[116:119], a[124:127], v[88:103]
  s_waitcnt lgkmcnt(2)
  v_mfma_f32_32x32x16_bf16 v[40:55], v[104:107], a[128:131], v[40:55]
  v_mfma_f32_32x32x16_bf16 v[56:71], v[104:107], a[132:135], v[56:71]
  ds_read_b128 v[116:119], v3 offset:9728
  v_mfma_f32_32x32x16_bf16 v[72:87], v[104:107], a[136:139], v[72:87]
  v_mfma_f32_32x32x16_bf16 v[88:103], v[104:107], a[140:143], v[88:103]
  s_waitcnt lgkmcnt(2)
  v_mfma_f32_32x32x16_bf16 v[40:55], v[108:111], a[144:147], v[40:55]
  v_mfma_f32_32x32x16_bf16 v[56:71], v[108:111], a[148:151], v[56:71]
  ds_read_b128 v[104:107], v3 offset:10240
  v_mfma_f32_32x32x16_bf16 v[72:87], v[108:111], a[152:155], v[72:87]
  v_mfma_f32_32x32x16_bf16 v[88:103], v[108:111], a[156:159], v[88:103]
  s_waitcnt lgkmcnt(2)
  v_mfma_f32_32x32x16_bf16 v[40:55], v[112:115], a[160:163], v[40:55]
  v_mfma_f32_32x32x16_bf16 v[56:71], v[112:115], a[164:167], v[56:71]
  ds_read_b128 v[108:111], v3 offset:10752
  v_mfma_f32_32x32x16_bf16 v[72:87], v[112:115], a[168:171], v[72:87]
  v_mfma_f32_32x32x16_bf16 v[88:103], v[112:115], a[172:175], v[88:103]
  s_waitcnt lgkmcnt(2)
  v_mfma_f32_32x32x16_bf16 v[40:55], v[116:119], a[176:179], v[40:55]
  v_mfma_f32_32x32x16_bf16 v[56:71], v[116:119], a[180:183], v[56:71]
  ds_read_b128 v[112:115], v3 offset:11264
  v_mfma_f32_32x32x16_bf16 v[72:87], v[116:119], a[184:187], v[72:87]
  v_mfma_f32_32x32x16_bf16 v[88:103], v[116:119], a[188:191], v[88:103]
  s_waitcnt lgkmcnt(2)
  v_mfma_f32_32x32x16_bf16 v[40:55], v[104:107], a[192:195], v[40:55]
  v_mfma_f32_32x32x16_bf16 v[56:71], v[104:107], a[196:199], v[56:71]
  ds_read_b128 v[116:119], v3 offset:11776
  s_waitcnt lgkmcnt(2)
  v_mfma_f32_32x32x16_bf16 v[40:55], v[108:111], a[208:211], v[40:55]
  v_mfma_f32_32x32x16_bf16 v[56:71], v[108:111], a[212:215], v[56:71]
  s_waitcnt lgkmcnt(1)
  v_mfma_f32_32x32x16_bf16 v[40:55], v[112:115], a[224:227], v[40:55]
  v_mfma_f32_32x32x16_bf16 v[56:71], v[112:115], a[228:231], v[56:71]
  s_waitcnt lgkmcnt(0)
  v_mfma_f32_32x32x16_bf16 v[40:55], v[116:119], a[240:243], v[40:55]
  v_mfma_f32_32x32x16_bf16 v[56:71], v[116:119], a[244:247], v[56:71]
  v_mfma_f32_32x32x16_bf16 v[72:87], v[104:107], a[200:203], v[72:87]
  v_mfma_f32_32x32x16_bf16 v[88:103], v[104:107], a[204:207], v[88:103]
  v_cvt_pk_bf16_f32 v212, v40, v56
  v_cvt_pk_bf16_f32 v214, v41, v57
  v_cvt_pk_bf16_f32 v216, v42, v58
  v_cvt_pk_bf16_f32 v218, v43, v59
  v_permlane16_swap_b32 v212, v214
  v_mfma_f32_32x32x16_bf16 v[72:87], v[108:111], a[216:219], v[72:87]
  v_cvt_pk_bf16_f32 v220, v44, v60
  v_cvt_pk_bf16_f32 v222, v45, v61
  v_permlane16_swap_b32 v216, v218
  v_bfi_b32 v212, v254, s42, v212
  v_cvt_pk_bf16_f32 v224, v46, v62
  v_mfma_f32_32x32x16_bf16 v[88:103], v[108:111], a[220:223], v[88:103]
  v_cvt_pk_bf16_f32 v226, v47, v63
  v_permlane16_swap_b32 v220, v222
  v_bfi_b32 v216, v254, s42, v216
  v_cvt_pk_bf16_f32 v228, v48, v64
  v_mfma_f32_32x32x16_bf16 v[72:87], v[112:115], a[232:235], v[72:87]
  v_cvt_pk_bf16_f32 v230, v49, v65
  v_permlane16_swap_b32 v224, v226
  v_bfi_b32 v220, v254, s42, v220
  v_cvt_pk_bf16_f32 v232, v50, v66
  v_cvt_pk_bf16_f32 v234, v51, v67
  v_mfma_f32_32x32x16_bf16 v[88:103], v[112:115], a[236:239], v[88:103]
  v_permlane16_swap_b32 v228, v230
  v_bfi_b32 v224, v254, s42, v224
  v_cvt_pk_bf16_f32 v236, v52, v68
  v_cvt_pk_bf16_f32 v238, v53, v69
  v_mfma_f32_32x32x16_bf16 v[72:87], v[116:119], a[248:251], v[72:87]
  v_permlane16_swap_b32 v232, v234
  v_bfi_b32 v228, v254, s42, v228
  v_cvt_pk_bf16_f32 v240, v54, v70
  v_cvt_pk_bf16_f32 v242, v55, v71
  v_permlane16_swap_b32 v236, v238
  v_mfma_f32_32x32x16_bf16 v[88:103], v[116:119], a[252:255], v[88:103]
  v_bfi_b32 v232, v254, s42, v232
  v_permlane16_swap_b32 v240, v242
  v_bfi_b32 v236, v254, s42, v236
  v_bfi_b32 v240, v254, s42, v240
  s_nop 7
  v_cvt_pk_bf16_f32 v213, v72, v88
  v_cvt_pk_bf16_f32 v215, v73, v89
  v_cvt_pk_bf16_f32 v217, v74, v90
  v_cvt_pk_bf16_f32 v219, v75, v91
  s_add_u32 s78, s86, 0
  v_permlane16_swap_b32 v213, v215
  buffer_store_dwordx4 v[212:215], v4, s[4:7], s78 offen
  v_cvt_pk_bf16_f32 v221, v76, v92
  v_cvt_pk_bf16_f32 v223, v77, v93
  s_add_u32 s78, s86, 32768
  v_permlane16_swap_b32 v217, v219
  buffer_store_dwordx4 v[216:219], v4, s[4:7], s78 offen
  v_cvt_pk_bf16_f32 v225, v78, v94
  v_cvt_pk_bf16_f32 v227, v79, v95
  s_add_u32 s78, s86, 131072
  v_permlane16_swap_b32 v221, v223
  buffer_store_dwordx4 v[220:223], v4, s[4:7], s78 offen
  v_cvt_pk_bf16_f32 v229, v80, v96
  v_cvt_pk_bf16_f32 v231, v81, v97
  s_add_u32 s78, s86, 163840
  v_permlane16_swap_b32 v225, v227
  buffer_store_dwordx4 v[224:227], v4, s[4:7], s78 offen
  v_cvt_pk_bf16_f32 v233, v82, v98
  v_cvt_pk_bf16_f32 v235, v83, v99
  s_add_u32 s78, s86, 262144
  v_permlane16_swap_b32 v229, v231
  buffer_store_dwordx4 v[228:231], v4, s[4:7], s78 offen
  v_cvt_pk_bf16_f32 v237, v84, v100
  v_cvt_pk_bf16_f32 v239, v85, v101
  s_add_u32 s78, s86, 294912
  v_permlane16_swap_b32 v233, v235
  buffer_store_dwordx4 v[232:235], v4, s[4:7], s78 offen
  v_cvt_pk_bf16_f32 v241, v86, v102
  v_cvt_pk_bf16_f32 v243, v87, v103
  s_add_u32 s78, s86, 393216
  v_permlane16_swap_b32 v237, v239
  buffer_store_dwordx4 v[236:239], v4, s[4:7], s78 offen
  s_add_u32 s78, s86, 425984
  v_permlane16_swap_b32 v241, v243
  buffer_store_dwordx4 v[240:243], v4, s[4:7], s78 offen
  s_branch o_we_105
o_wr1_103:
  s_nop 3
  v_mul_f32 v112, s24, v112
  v_mul_f32 v113, s24, v113
  v_exp_f32 v64, v112
  v_exp_f32 v65, v113
  v_max_f32 v116, v111, v116
  v_max3_f32 v116, v112, v113, v116
  v_add_f32 v117, v117, v64
  v_add_f32 v118, v118, v65
  v_add_f32 v117, v117, v118
  s_mov_b32 s28, 0x21800000
  v_mov_b32 v118, v117
  s_nop 1
  v_permlane16_swap_b32 v117, v118
  v_add_f32 v117, v117, v118
  v_mov_b32 v118, v117
  s_nop 0
  s_nop 0
  v_permlane32_swap_b32 v117, v118
  v_add_f32 v117, v117, v118
  s_mov_b32 s67, 0
  s_mov_b64 vcc, 0
  s_waitcnt vmcnt(3)
o_pl_111:
  v_and_b32 v7, 1, v7
  v_cmp_ne_u32 vcc, s96, v7
  s_cbranch_vccz o_pk_112
  buffer_load_dword v7, v255, s[4:7], s97 offen sc1
  s_add_u32 s67, s67, 1
  s_cmp_gt_u32 s67, 1048576
  s_cbranch_scc1 L_end
  s_waitcnt vmcnt(0)
  s_branch o_pl_111
o_pk_112:
  s_lshl_b32 s94, s43, 14
  s_add_u32 s94, s94, s95
  buffer_load_dwordx4 v[120:123], v5, s[4:7], s94 offen offset:0 sc1
  v_cmp_lt_f32 vcc, 0x42700000, v116
  v_cmp_gt_f32 s[30:31], s28, v117
  v_rcp_f32 v117, v117
  buffer_load_dwordx4 v[124:127], v5, s[4:7], s94 offen offset:512 sc1
  s_or_b64 vcc, vcc, s[30:31]
  s_cbranch_vccnz o_fb_109
o_fbr_110:
  buffer_load_dwordx4 v[128:131], v5, s[4:7], s94 offen offset:256 sc1
  v_pk_mul_f32 v[56:57], v[56:57], v[116:117] op_sel:[0,1] op_sel_hi:[1,1]
  v_pk_mul_f32 v[58:59], v[58:59], v[116:117] op_sel:[0,1] op_sel_hi:[1,1]
  v_pk_mul_f32 v[60:61], v[60:61], v[116:117] op_sel:[0,1] op_sel_hi:[1,1]
  v_pk_mul_f32 v[62:63], v[62:63], v[116:117] op_sel:[0,1] op_sel_hi:[1,1]
  v_pk_mul_f32 v[64:65], v[64:65], v[116:117] op_sel:[0,1] op_sel_hi:[1,1]
  buffer_load_dwordx4 v[132:135], v5, s[4:7], s94 offen offset:768 sc1
  v_cvt_pk_bf16_f32 v116, v56, v57
  v_cvt_pk_bf16_f32 v117, v58, v59
  v_cvt_pk_bf16_f32 v118, v60, v61
  v_cvt_pk_bf16_f32 v119, v62, v63
  s_waitcnt lgkmcnt(0)
  s_nop 0
  v_mfma_f32_16x16x32_bf16 v[72:75], v[152:155], v[116:119], 0
  s_add_u32 s62, s62, 1
  v_cvt_pk_bf16_f32 v197, v64, v65
  v_cvt_pk_bf16_f32 v198, v64, v65
  v_mfma_f32_16x16x32_bf16 v[76:79], v[156:159], v[116:119], 0
  s_add_u32 s94, s94, 4096
  buffer_load_dwordx4 v[136:139], v5, s[4:7], s94 offen offset:0 sc1
  s_xor_b32 s86, s86, 524288
  v_mfma_f32_16x16x32_bf16 v[80:83], v[160:163], v[116:119], 0
  s_bfe_u32 s42, s62, 0x10001
  v_mfma_f32_16x16x32_bf16 v[84:87], v[164:167], v[116:119], 0
  buffer_load_dwordx4 v[140:143], v5, s[4:7], s94 offen offset:512 sc1
  v_mfma_f32_16x16x32_bf16 v[88:91], v[168:171], v[116:119], 0
  v_mfma_f32_16x16x32_bf16 v[92:95], v[172:175], v[116:119], 0
  buffer_load_dwordx4 v[144:147], v5, s[4:7], s94 offen offset:256 sc1
  v_mfma_f32_16x16x32_bf16 v[96:99], v[176:179], v[116:119], 0
  v_mfma_f32_16x16x32_bf16 v[100:103], v[180:183], v[116:119], 0
  buffer_load_dwordx4 v[148:151], v5, s[4:7], s94 offen offset:768 sc1
  v_mfma_f32_16x16x16_bf16 v[72:75], v[200:201], v[198:199], v[72:75]
  s_nop 1
  v_mfma_f32_16x16x16_bf16 v[76:79], v[200:201], v[196:197], v[76:79]
  s_add_u32 s94, s94, 4096
  buffer_load_dwordx4 v[152:155], v5, s[4:7], s94 offen offset:0 sc1
  v_mfma_f32_16x16x16_bf16 v[80:83], v[202:203], v[198:199], v[80:83]
  s_nop 1
  v_mfma_f32_16x16x16_bf16 v[84:87], v[202:203], v[196:197], v[84:87]
  buffer_load_dwordx4 v[156:159], v5, s[4:7], s94 offen offset:512 sc1
  v_mfma_f32_16x16x16_bf16 v[88:91], v[204:205], v[198:199], v[88:91]
  s_nop 0
  v_cvt_pk_bf16_f32 v40, v72, v73
  v_cvt_pk_bf16_f32 v41, v74, v75
  v_mfma_f32_16x16x16_bf16 v[92:95], v[204:205], v[196:197], v[92:95]
  buffer_load_dwordx4 v[160:163], v5, s[4:7], s94 offen offset:256 sc1
  v_cvt_pk_bf16_f32 v42, v76, v77
  v_cvt_pk_bf16_f32 v43, v78, v79
  v_mfma_f32_16x16x16_bf16 v[96:99], v[206:207], v[198:199], v[96:99]
  s_nop 0
  ds_write_b128 v6, v[40:43] offset:0
  v_cvt_pk_bf16_f32 v44, v80, v81
  v_mfma_f32_16x16x16_bf16 v[100:103], v[206:207], v[196:197], v[100:103]
  buffer_load_dwordx4 v[164:167], v5, s[4:7], s94 offen offset:768 sc1
  v_cvt_pk_bf16_f32 v45, v82, v83
  v_cvt_pk_bf16_f32 v46, v84, v85
  v_cvt_pk_bf16_f32 v47, v86, v87
  ds_write_b128 v6, v[44:47] offset:1024
  v_cvt_pk_bf16_f32 v48, v88, v89
  v_cvt_pk_bf16_f32 v49, v90, v91
  v_cvt_pk_bf16_f32 v50, v92, v93
  v_cvt_pk_bf16_f32 v51, v94, v95
  s_add_u32 s94, s94, 4096
  buffer_load_dwordx4 v[168:171], v5, s[4:7], s94 offen offset:0 sc1
  ds_write_b128 v6, v[48:51] offset:2048
  v_cvt_pk_bf16_f32 v52, v96, v97
  v_cvt_pk_bf16_f32 v53, v98, v99
  v_cvt_pk_bf16_f32 v54, v100, v101
  v_cvt_pk_bf16_f32 v55, v102, v103
  ds_write_b128 v6, v[52:55] offset:3072
  buffer_load_dwordx4 v[172:175], v5, s[4:7], s94 offen offset:512 sc1
  s_and_b32 s26, s65, 49152
  s_cbranch_scc1 o_wr2_104
  s_waitcnt lgkmcnt(0)
  s_barrier
  ds_read_b128 v[104:107], v3 offset:0
  ds_read_b128 v[108:111], v3 offset:512
  ds_read_b128 v[112:115], v3 offset:1024
  buffer_load_dwordx4 v[176:179], v5, s[4:7], s94 offen offset:256 sc1
  buffer_load_dwordx4 v[180:183], v5, s[4:7], s94 offen offset:768 sc1
  s_waitcnt lgkmcnt(2)
  v_mfma_f32_32x32x16_bf16 v[40:55], v[104:107], a[0:3], 0
  v_mov_b64 v[188:189], 0
  v_mov_b64 v[190:191], 0
  v_mov_b64 v[192:193], 0
  v_mov_b64 v[194:195], 0
  s_mov_b64 exec, 1
  buffer_store_dword v38, off, s[4:7], s84 sc1
  s_mov_b64 exec, -1
  s_mov_b32 s84, 268435456
  v_mfma_f32_32x32x16_bf16 v[56:71], v[104:107], a[4:7], 0
  ds_read_b128 v[116:119], v3 offset:1536
  v_mfma_f32_32x32x16_bf16 v[72:87], v[104:107], a[8:11], 0
  v_mfma_f32_32x32x16_bf16 v[88:103], v[104:107], a[12:15], 0
  s_waitcnt vmcnt(13)
  v_xor_b32 v7, s96, v120
  v_bitop3_b32 v7, v7, v124, s96 bitop3:0xf6
  v_bitop3_b32 v7, v7, v128, s96 bitop3:0xf6
  v_bitop3_b32 v7, v7, v132, s96 bitop3:0xf6
  s_waitcnt lgkmcnt(2)
  v_mfma_f32_32x32x16_bf16 v[40:55], v[108:111], a[16:19], v[40:55]
  s_waitcnt vmcnt(9)
  v_bitop3_b32 v7, v7, v136, s96 bitop3:0xf6
  v_bitop3_b32 v7, v7, v140, s96 bitop3:0xf6
  v_bitop3_b32 v7, v7, v144, s96 bitop3:0xf6
  v_bitop3_b32 v7, v7, v148, s96 bitop3:0xf6
  s_waitcnt vmcnt(5)
  v_mfma_f32_32x32x16_bf16 v[56:71], v[108:111], a[20:23], v[56:71]
  ds_read_b128 v[104:107], v3 offset:2048
  v_bitop3_b32 v7, v7, v152, s96 bitop3:0xf6
  v_bitop3_b32 v7, v7, v156, s96 bitop3:0xf6
  v_bitop3_b32 v7, v7, v160, s96 bitop3:0xf6
  v_bitop3_b32 v7, v7, v164, s96 bitop3:0xf6
  s_waitcnt vmcnt(1)
  v_mfma_f32_32x32x16_bf16 v[72:87], v[108:111], a[24:27], v[72:87]
  v_bitop3_b32 v7, v7, v168, s96 bitop3:0xf6
  v_bitop3_b32 v7, v7, v172, s96 bitop3:0xf6
  v_bitop3_b32 v7, v7, v176, s96 bitop3:0xf6
  v_bitop3_b32 v7, v7, v180, s96 bitop3:0xf6
  v_and_b32 v7, v254, v7
  v_cmp_ne_u32 vcc, 0, v7
  s_cbranch_vccnz o_rt_113
o_bk_114:
  v_mfma_f32_32x32x16_bf16 v[88:103], v[108:111], a[28:31], v[88:103]
  v_smfmac_f32_16x16x64_bf16 v[188:191], v[16:19], v[120:127], v20
  v_lshlrev_b32 v196, 16, v184
  v_smfmac_f32_16x16x64_bf16 v[192:195], v[16:19], v[128:135], v20
  v_and_b32 v197, 0xffff0000, v184
  v_smfmac_f32_16x16x64_bf16 v[188:191], v[16:19], v[136:143], v20
  v_lshlrev_b32 v198, 16, v185
  s_waitcnt lgkmcnt(2)
  v_mfma_f32_32x32x16_bf16 v[40:55], v[112:115], a[32:35], v[40:55]
  v_smfmac_f32_16x16x64_bf16 v[192:195], v[16:19], v[144:151], v20
  v_and_b32 v199, 0xffff0000, v185
  v_smfmac_f32_16x16x64_bf16 v[188:191], v[16:19], v[152:159], v20
  v_lshlrev_b32 v200, 16, v186
  v_smfmac_f32_16x16x64_bf16 v[192:195], v[16:19], v[160:167], v20
  v_and_b32 v201, 0xffff0000, v186
  v_mfma_f32_32x32x16_bf16 v[56:71], v[112:115], a[36:39], v[56:71]
  ds_read_b128 v[108:111], v3 offset:2560
  v_smfmac_f32_16x16x64_bf16 v[188:191], v[16:19], v[168:175], v20
  v_lshlrev_b32 v202, 16, v187
  v_smfmac_f32_16x16x64_bf16 v[192:195], v[16:19], v[176:183], v20
  v_and_b32 v203, 0xffff0000, v187
  s_bfe_u32 s92, s65, 131086
  v_mfma_f32_32x32x16_bf16 v[72:87], v[112:115], a[40:43], v[72:87]
  s_lshl_b32 s92, s92, 21
  s_add_u32 s92, s92, s91
  s_add_u32 s93, s92, 27262976
  s_add_u32 s92, s92, 20971520
  v_permlane16_swap_b32 v188, v192
  v_mfma_f32_32x32x16_bf16 v[88:103], v[112:115], a[44:47], v[88:103]
  v_permlane16_swap_b32 v189, v193
  v_permlane16_swap_b32 v190, v194
  v_permlane16_swap_b32 v191, v195
  s_waitcnt lgkmcnt(2)
  v_mfma_f32_32x32x16_bf16 v[40:55], v[116:119], a[48:51], v[40:55]
  v_cvt_pk_bf16_f32 v188, 0, v188
  v_cvt_pk_bf16_f32 v189, 0, v189
  v_cvt_pk_bf16_f32 v190, 0, v190
  v_cvt_pk_bf16_f32 v191, 0, v191
  v_cvt_pk_bf16_f32 v192, 0, v192
  v_cvt_pk_bf16_f32 v193, 0, v193
  v_mfma_f32_32x32x16_bf16 v[56:71], v[116:119], a[52:55], v[56:71]
  ds_read_b128 v[112:115], v3 offset:3072
  v_cvt_pk_bf16_f32 v194, 0, v194
  v_cvt_pk_bf16_f32 v195, 0, v195
  v_add_f32 v196, v196, v188
  v_add_f32 v197, v197, v189
  v_add_f32 v198, v198, v190
  v_mfma_f32_32x32x16_bf16 v[72:87], v[116:119], a[56:59], v[72:87]
  v_add_f32 v199, v199, v191
  v_add_f32 v200, v200, v192
  v_add_f32 v201, v201, v193
  v_add_f32 v202, v202, v194
  v_add_f32 v203, v203, v195
  v_cvt_pk_bf16_f32 v120, v196, v197
  v_mfma_f32_32x32x16_bf16 v[88:103], v[116:119], a[60:63], v[88:103]
  v_cvt_pk_bf16_f32 v121, v198, v199
  v_cvt_pk_bf16_f32 v122, v200, v201
  v_cvt_pk_bf16_f32 v123, v202, v203
  v_lshlrev_b32 v196, 16, v120
  v_and_b32 v197, 0xffff0000, v120
  s_waitcnt lgkmcnt(2)
  v_mfma_f32_32x32x16_bf16 v[40:55], v[104:107], a[64:67], v[40:55]
  v_lshlrev_b32 v198, 16, v121
  v_and_b32 v199, 0xffff0000, v121
  v_lshlrev_b32 v200, 16, v122
  v_and_b32 v201, 0xffff0000, v122
  v_lshlrev_b32 v202, 16, v123
  v_and_b32 v203, 0xffff0000, v123
  v_mfma_f32_32x32x16_bf16 v[56:71], v[104:107], a[68:71], v[56:71]
  ds_read_b128 v[116:119], v3 offset:3584
  buffer_store_dwordx4 v[120:123], v0, s[4:7], s92 offen sc1
  v_add_f32 v136, v196, v197
  v_mul_f32 v137, v196, v196
  v_mfma_f32_32x32x16_bf16 v[72:87], v[104:107], a[72:75], v[72:87]
  v_add_f32 v138, v198, v199
  v_mul_f32 v139, v197, v197
  v_fmac_f32 v137, v198, v198
  v_fmac_f32 v139, v199, v199
  v_add_f32 v136, v136, v200
  v_fmac_f32 v137, v200, v200
  v_mfma_f32_32x32x16_bf16 v[88:103], v[104:107], a[76:79], v[88:103]
  v_add_f32 v138, v138, v201
  v_fmac_f32 v139, v201, v201
  v_add_f32 v136, v136, v202
  v_fmac_f32 v137, v202, v202
  v_add_f32 v138, v138, v203
  s_waitcnt lgkmcnt(2)
  v_mfma_f32_32x32x16_bf16 v[40:55], v[108:111], a[80:83], v[40:55]
  v_fmac_f32 v139, v203, v203
  v_add_f32 v136, v136, v138
  v_add_f32 v137, v137, v139
  s_nop 0
  v_add_f32_dpp v136, v136, v136 row_ror:8 row_mask:0xf bank_mask:0xf
  v_add_f32_dpp v137, v137, v137 row_ror:8 row_mask:0xf bank_mask:0xf
  s_nop 0
  v_add_f32_dpp v136, v136, v136 row_ror:4 row_mask:0xf bank_mask:0xf
  v_mfma_f32_32x32x16_bf16 v[56:71], v[108:111], a[84:87], v[56:71]
  ds_read_b128 v[104:107], v3 offset:8192
  v_add_f32_dpp v137, v137, v137 row_ror:4 row_mask:0xf bank_mask:0xf
  v_add_f32_dpp v136, v136, v136 row_ror:2 row_mask:0xf bank_mask:0xf
  s_nop 0
  v_add_f32_dpp v137, v137, v137 row_ror:2 row_mask:0xf bank_mask:0xf
  v_add_f32_dpp v136, v136, v136 row_ror:1 row_mask:0xf bank_mask:0xf
  s_nop 0
  v_add_f32_dpp v137, v137, v137 row_ror:1 row_mask:0xf bank_mask:0xf
  v_mfma_f32_32x32x16_bf16 v[72:87], v[108:111], a[88:91], v[72:87]
  v_mov_b32 v140, v136
  v_mov_b32 v141, v137
  s_nop 0
  v_permlane16_swap_b32 v136, v140
  v_permlane16_swap_b32 v137, v141
  v_mfma_f32_32x32x16_bf16 v[88:103], v[108:111], a[92:95], v[88:103]
  v_add_f32 v136, v136, v140
  v_add_f32 v137, v137, v141
  v_mov_b32 v140, v136
  v_mov_b32 v141, v137
  s_nop 0
  v_permlane32_swap_b32 v136, v140
  s_waitcnt lgkmcnt(2)
  v_mfma_f32_32x32x16_bf16 v[40:55], v[112:115], a[96:99], v[40:55]
  v_permlane32_swap_b32 v137, v141
  v_add_f32 v136, v136, v140
  v_add_f32 v137, v137, v141
  v_mul_f32 v136, 0x3b000000, v136
  v_mul_f32 v137, 0x3b000000, v137
  v_mfma_f32_32x32x16_bf16 v[56:71], v[112:115], a[100:103], v[56:71]
  ds_read_b128 v[108:111], v3 offset:8704
  v_fma_f32 v137, -v136, v136, v137
  v_cvt_pk_bf16_f32 v136, 0, v136
  v_max_f32 v137, 0, v137
  v_sub_f32 v140, v196, v136
  v_sub_f32 v141, v197, v136
  v_mfma_f32_32x32x16_bf16 v[72:87], v[112:115], a[104:107], v[72:87]
  v_cvt_pk_bf16_f32 v137, 0, v137
  v_sub_f32 v142, v198, v136
  v_sub_f32 v143, v199, v136
  v_add_f32 v137, 0x3727c5ac, v137
  v_sub_f32 v144, v200, v136
  v_sub_f32 v145, v201, v136
  v_mfma_f32_32x32x16_bf16 v[88:103], v[112:115], a[108:111], v[88:103]
  v_cvt_pk_bf16_f32 v137, 0, v137
  v_sub_f32 v146, v202, v136
  v_sub_f32 v147, v203, v136
  v_sqrt_f32 v137, v137
  s_waitcnt lgkmcnt(2)
  v_mfma_f32_32x32x16_bf16 v[40:55], v[116:119], a[112:115], v[40:55]
  v_cvt_pk_bf16_f32 v140, 0, v140
  v_cvt_pk_bf16_f32 v141, 0, v141
  v_cvt_pk_bf16_f32 v137, 0, v137
  v_cvt_pk_bf16_f32 v142, 0, v142
  v_cvt_pk_bf16_f32 v143, 0, v143
  v_rcp_f32 v137, v137
  v_mfma_f32_32x32x16_bf16 v[56:71], v[116:119], a[116:119], v[56:71]
  ds_read_b128 v[112:115], v3 offset:9216
  v_cvt_pk_bf16_f32 v144, 0, v144
  v_cvt_pk_bf16_f32 v145, 0, v145
  v_cvt_pk_bf16_f32 v146, 0, v146
  v_cvt_pk_bf16_f32 v147, 0, v147
  v_mul_f32 v140, v140, v137
  v_mfma_f32_32x32x16_bf16 v[72:87], v[116:119], a[120:123], v[72:87]
  v_mul_f32 v141, v141, v137
  v_mul_f32 v142, v142, v137
  v_mul_f32 v143, v143, v137
  v_mul_f32 v144, v144, v137
  v_mul_f32 v145, v145, v137
  v_mul_f32 v146, v146, v137
  v_mfma_f32_32x32x16_bf16 v[88:103], v[116:119], a[124:127], v[88:103]
  v_mul_f32 v147, v147, v137
  v_cvt_pk_bf16_f32 v124, v140, v141
  v_cvt_pk_bf16_f32 v125, v142, v143
  v_cvt_pk_bf16_f32 v126, v144, v145
  v_cvt_pk_bf16_f32 v127, v146, v147
  s_waitcnt lgkmcnt(2)
  v_mfma_f32_32x32x16_bf16 v[40:55], v[104:107], a[128:131], v[40:55]
  v_lshlrev_b32 v204, 16, v124
  v_and_b32 v205, 0xffff0000, v124
  v_lshlrev_b32 v206, 16, v125
  v_and_b32 v207, 0xffff0000, v125
  v_lshlrev_b32 v208, 16, v126
  v_and_b32 v209, 0xffff0000, v126
  v_mfma_f32_32x32x16_bf16 v[56:71], v[104:107], a[132:135], v[56:71]
  ds_read_b128 v[116:119], v3 offset:9728
  v_lshlrev_b32 v210, 16, v127
  v_and_b32 v211, 0xffff0000, v127
  buffer_store_dwordx4 v[124:127], v0, s[4:7], s93 offen sc1
  v_mfma_f32_32x32x16_bf16 v[72:87], v[104:107], a[136:139], v[72:87]
  v_add_f32 v196, v196, v204
  v_add_f32 v197, v197, v205
  v_add_f32 v198, v198, v206
  v_add_f32 v199, v199, v207
  v_add_f32 v200, v200, v208
  v_add_f32 v201, v201, v209
  v_mfma_f32_32x32x16_bf16 v[88:103], v[104:107], a[140:143], v[88:103]
  v_add_f32 v202, v202, v210
  v_add_f32 v203, v203, v211
  v_cvt_pk_bf16_f32 v128, v196, v197
  v_cvt_pk_bf16_f32 v129, v198, v199
  v_cvt_pk_bf16_f32 v130, v200, v201
  s_waitcnt lgkmcnt(2)
  v_mfma_f32_32x32x16_bf16 v[40:55], v[108:111], a[144:147], v[40:55]
  v_cvt_pk_bf16_f32 v131, v202, v203
  v_mul_f32 v188, v204, v8
  v_mul_f32 v189, v205, v9
  v_fmac_f32 v188, v206, v10
  v_fmac_f32 v189, v207, v11
  v_fmac_f32 v188, v208, v12
  v_mfma_f32_32x32x16_bf16 v[56:71], v[108:111], a[148:151], v[56:71]
  ds_read_b128 v[104:107], v3 offset:10240
  v_fmac_f32 v189, v209, v13
  v_fmac_f32 v188, v210, v14
  v_fmac_f32 v189, v211, v15
  v_add_f32 v188, v188, v189
  s_add_u32 s92, s91, 10485760
  v_mfma_f32_32x32x16_bf16 v[72:87], v[108:111], a[152:155], v[72:87]
  s_add_u32 s93, s91, 8388608
  buffer_store_dwordx4 v[128:131], v0, s[4:7], s92 offen sc1
  v_lshlrev_b32 v196, 16, v128
  v_and_b32 v197, 0xffff0000, v128
  v_mfma_f32_32x32x16_bf16 v[88:103], v[108:111], a[156:159], v[88:103]
  v_lshlrev_b32 v198, 16, v129
  v_and_b32 v199, 0xffff0000, v129
  v_lshlrev_b32 v200, 16, v130
  v_and_b32 v201, 0xffff0000, v130
  v_lshlrev_b32 v202, 16, v131
  s_waitcnt lgkmcnt(2)
  v_mfma_f32_32x32x16_bf16 v[40:55], v[112:115], a[160:163], v[40:55]
  v_and_b32 v203, 0xffff0000, v131
  v_add_f32 v136, v196, v197
  v_mul_f32 v137, v196, v196
  v_add_f32 v138, v198, v199
  v_mul_f32 v139, v197, v197
  v_fmac_f32 v137, v198, v198
  v_mfma_f32_32x32x16_bf16 v[56:71], v[112:115], a[164:167], v[56:71]
  ds_read_b128 v[108:111], v3 offset:10752
  v_fmac_f32 v139, v199, v199
  v_add_f32 v136, v136, v200
  v_fmac_f32 v137, v200, v200
  v_add_f32 v138, v138, v201
  v_fmac_f32 v139, v201, v201
  v_mfma_f32_32x32x16_bf16 v[72:87], v[112:115], a[168:171], v[72:87]
  v_add_f32 v136, v136, v202
  v_fmac_f32 v137, v202, v202
  v_add_f32 v138, v138, v203
  v_fmac_f32 v139, v203, v203
  v_add_f32 v136, v136, v138
  v_add_f32 v137, v137, v139
  v_mfma_f32_32x32x16_bf16 v[88:103], v[112:115], a[172:175], v[88:103]
  v_add_f32_dpp v136, v136, v136 row_ror:8 row_mask:0xf bank_mask:0xf
  v_add_f32_dpp v137, v137, v137 row_ror:8 row_mask:0xf bank_mask:0xf
  v_add_f32_dpp v188, v188, v188 row_ror:8 row_mask:0xf bank_mask:0xf
  v_add_f32_dpp v136, v136, v136 row_ror:4 row_mask:0xf bank_mask:0xf
  v_add_f32_dpp v137, v137, v137 row_ror:4 row_mask:0xf bank_mask:0xf
  s_waitcnt lgkmcnt(2)
  v_mfma_f32_32x32x16_bf16 v[40:55], v[116:119], a[176:179], v[40:55]
  v_add_f32_dpp v188, v188, v188 row_ror:4 row_mask:0xf bank_mask:0xf
  v_add_f32_dpp v136, v136, v136 row_ror:2 row_mask:0xf bank_mask:0xf
  v_add_f32_dpp v137, v137, v137 row_ror:2 row_mask:0xf bank_mask:0xf
  v_add_f32_dpp v188, v188, v188 row_ror:2 row_mask:0xf bank_mask:0xf
  v_add_f32_dpp v136, v136, v136 row_ror:1 row_mask:0xf bank_mask:0xf
  v_add_f32_dpp v137, v137, v137 row_ror:1 row_mask:0xf bank_mask:0xf
  v_mfma_f32_32x32x16_bf16 v[56:71], v[116:119], a[180:183], v[56:71]
  ds_read_b128 v[112:115], v3 offset:11264
  v_add_f32_dpp v188, v188, v188 row_ror:1 row_mask:0xf bank_mask:0xf
  v_mov_b32 v140, v136
  v_mov_b32 v141, v137
  v_mov_b32 v142, v188
  v_permlane16_swap_b32 v136, v140
  v_mfma_f32_32x32x16_bf16 v[72:87], v[116:119], a[184:187], v[72:87]
  v_permlane16_swap_b32 v137, v141
  v_permlane16_swap_b32 v188, v142
  v_add_f32 v136, v136, v140
  v_add_f32 v137, v137, v141
  v_mfma_f32_32x32x16_bf16 v[88:103], v[116:119], a[188:191], v[88:103]
  v_add_f32 v188, v188, v142
  v_mov_b32 v140, v136
  v_mov_b32 v141, v137
  v_mov_b32 v142, v188
  v_permlane32_swap_b32 v136, v140
  s_waitcnt lgkmcnt(2)
  v_mfma_f32_32x32x16_bf16 v[40:55], v[104:107], a[192:195], v[40:55]
  v_permlane32_swap_b32 v137, v141
  v_permlane32_swap_b32 v188, v142
  v_add_f32 v136, v136, v140
  v_add_f32 v137, v137, v141
  v_mfma_f32_32x32x16_bf16 v[56:71], v[104:107], a[196:199], v[56:71]
  ds_read_b128 v[116:119], v3 offset:11776
  v_add_f32 v188, v188, v142
  v_mul_f32 v136, 0x3b000000, v136
  v_mul_f32 v137, 0x3b000000, v137
  v_fma_f32 v137, -v136, v136, v137
  v_cvt_pk_bf16_f32 v136, 0, v136
  s_waitcnt lgkmcnt(2)
  v_mfma_f32_32x32x16_bf16 v[40:55], v[108:111], a[208:211], v[40:55]
  v_max_f32 v137, 0, v137
  v_sub_f32 v140, v196, v136
  v_sub_f32 v141, v197, v136
  v_cvt_pk_bf16_f32 v137, 0, v137
  v_sub_f32 v142, v198, v136
  v_sub_f32 v143, v199, v136
  v_mfma_f32_32x32x16_bf16 v[56:71], v[108:111], a[212:215], v[56:71]
  v_add_f32 v137, 0x3727c5ac, v137
  v_sub_f32 v144, v200, v136
  v_sub_f32 v145, v201, v136
  v_cvt_pk_bf16_f32 v137, 0, v137
  v_sub_f32 v146, v202, v136
  v_sub_f32 v147, v203, v136
  s_waitcnt lgkmcnt(1)
  v_mfma_f32_32x32x16_bf16 v[40:55], v[112:115], a[224:227], v[40:55]
  v_sqrt_f32 v137, v137
  v_cvt_pk_bf16_f32 v140, 0, v140
  v_cvt_pk_bf16_f32 v141, 0, v141
  v_cvt_pk_bf16_f32 v137, 0, v137
  v_cvt_pk_bf16_f32 v142, 0, v142
  v_mfma_f32_32x32x16_bf16 v[56:71], v[112:115], a[228:231], v[56:71]
  v_cvt_pk_bf16_f32 v143, 0, v143
  v_rcp_f32 v137, v137
  v_cvt_pk_bf16_f32 v144, 0, v144
  v_cvt_pk_bf16_f32 v145, 0, v145
  v_cvt_pk_bf16_f32 v146, 0, v146
  s_waitcnt lgkmcnt(0)
  v_mfma_f32_32x32x16_bf16 v[40:55], v[116:119], a[240:243], v[40:55]
  v_cvt_pk_bf16_f32 v147, 0, v147
  v_mul_f32 v140, v140, v137
  v_mul_f32 v141, v141, v137
  v_mul_f32 v142, v142, v137
  v_mul_f32 v143, v143, v137
  v_mul_f32 v144, v144, v137
  v_mfma_f32_32x32x16_bf16 v[56:71], v[116:119], a[244:247], v[56:71]
  v_mul_f32 v145, v145, v137
  v_mul_f32 v146, v146, v137
  v_mul_f32 v147, v147, v137
  v_cvt_pk_bf16_f32 v132, v140, v141
  v_cvt_pk_bf16_f32 v133, v142, v143
  v_cvt_pk_bf16_f32 v134, v144, v145
  v_mfma_f32_32x32x16_bf16 v[72:87], v[104:107], a[200:203], v[72:87]
  v_cvt_pk_bf16_f32 v135, v146, v147
  buffer_store_dwordx4 v[132:135], v0, s[4:7], s93 offen sc1
  v_cvt_pk_bf16_f32 v188, 0, v188
  v_ashrrev_i32 v189, 31, v188
  v_mfma_f32_32x32x16_bf16 v[88:103], v[104:107], a[204:207], v[88:103]
  v_or_b32 v189, 0x80000000, v189
  v_xor_b32 v188, v188, v189
  s_sub_u32 s92, 4095, s90
  v_and_b32 v188, 0xffff0000, v188
  v_or_b32 v38, s92, v188
  v_mfma_f32_32x32x16_bf16 v[72:87], v[108:111], a[216:219], v[72:87]
  s_bfe_u32 s92, s65, 196625
  s_lshl_b32 s92, s92, 18
  s_lshl_b32 s93, s90, 7
  s_add_u32 s92, s92, s93
  s_add_u32 s84, s92, 243269632
  v_cvt_pk_bf16_f32 v212, v40, v56
  v_mfma_f32_32x32x16_bf16 v[88:103], v[108:111], a[220:223], v[88:103]
  v_cvt_pk_bf16_f32 v214, v41, v57
  v_cvt_pk_bf16_f32 v216, v42, v58
  v_cvt_pk_bf16_f32 v218, v43, v59
  v_permlane16_swap_b32 v212, v214
  v_mfma_f32_32x32x16_bf16 v[72:87], v[112:115], a[232:235], v[72:87]
  v_cvt_pk_bf16_f32 v220, v44, v60
  v_cvt_pk_bf16_f32 v222, v45, v61
  v_permlane16_swap_b32 v216, v218
  v_bfi_b32 v212, v254, s42, v212
  v_cvt_pk_bf16_f32 v224, v46, v62
  v_mfma_f32_32x32x16_bf16 v[88:103], v[112:115], a[236:239], v[88:103]
  v_cvt_pk_bf16_f32 v226, v47, v63
  v_permlane16_swap_b32 v220, v222
  v_bfi_b32 v216, v254, s42, v216
  v_cvt_pk_bf16_f32 v228, v48, v64
  v_mfma_f32_32x32x16_bf16 v[72:87], v[116:119], a[248:251], v[72:87]
  v_cvt_pk_bf16_f32 v230, v49, v65
  v_permlane16_swap_b32 v224, v226
  v_bfi_b32 v220, v254, s42, v220
  v_cvt_pk_bf16_f32 v232, v50, v66
  v_cvt_pk_bf16_f32 v234, v51, v67
  v_mfma_f32_32x32x16_bf16 v[88:103], v[116:119], a[252:255], v[88:103]
  v_permlane16_swap_b32 v228, v230
  v_bfi_b32 v224, v254, s42, v224
  v_cvt_pk_bf16_f32 v236, v52, v68
  v_cvt_pk_bf16_f32 v238, v53, v69
  v_permlane16_swap_b32 v232, v234
  v_bfi_b32 v228, v254, s42, v228
  v_cvt_pk_bf16_f32 v240, v54, v70
  v_cvt_pk_bf16_f32 v242, v55, v71
  v_permlane16_swap_b32 v236, v238
  v_bfi_b32 v232, v254, s42, v232
  v_permlane16_swap_b32 v240, v242
  v_bfi_b32 v236, v254, s42, v236
  v_bfi_b32 v240, v254, s42, v240
  v_cvt_pk_bf16_f32 v213, v72, v88
  v_cvt_pk_bf16_f32 v215, v73, v89
  v_cvt_pk_bf16_f32 v217, v74, v90
  v_cvt_pk_bf16_f32 v219, v75, v91
  s_add_u32 s78, s86, 0
  v_permlane16_swap_b32 v213, v215
  buffer_store_dwordx4 v[212:215], v4, s[4:7], s78 offen
  v_cvt_pk_bf16_f32 v221, v76, v92
  v_cvt_pk_bf16_f32 v223, v77, v93
  s_add_u32 s78, s86, 32768
  v_permlane16_swap_b32 v217, v219
  buffer_store_dwordx4 v[216:219], v4, s[4:7], s78 offen
  v_cvt_pk_bf16_f32 v225, v78, v94
  v_cvt_pk_bf16_f32 v227, v79, v95
  s_add_u32 s78, s86, 131072
  v_permlane16_swap_b32 v221, v223
  buffer_store_dwordx4 v[220:223], v4, s[4:7], s78 offen
  v_cvt_pk_bf16_f32 v229, v80, v96
  v_cvt_pk_bf16_f32 v231, v81, v97
  s_add_u32 s78, s86, 163840
  v_permlane16_swap_b32 v225, v227
  buffer_store_dwordx4 v[224:227], v4, s[4:7], s78 offen
  v_cvt_pk_bf16_f32 v233, v82, v98
  v_cvt_pk_bf16_f32 v235, v83, v99
  s_add_u32 s78, s86, 262144
  v_permlane16_swap_b32 v229, v231
  buffer_store_dwordx4 v[228:231], v4, s[4:7], s78 offen
  v_cvt_pk_bf16_f32 v237, v84, v100
  v_cvt_pk_bf16_f32 v239, v85, v101
  s_add_u32 s78, s86, 294912
  v_permlane16_swap_b32 v233, v235
  buffer_store_dwordx4 v[232:235], v4, s[4:7], s78 offen
  v_cvt_pk_bf16_f32 v241, v86, v102
  v_cvt_pk_bf16_f32 v243, v87, v103
  s_add_u32 s78, s86, 393216
  v_permlane16_swap_b32 v237, v239
  buffer_store_dwordx4 v[236:239], v4, s[4:7], s78 offen
  s_add_u32 s78, s86, 425984
  v_permlane16_swap_b32 v241, v243
  buffer_store_dwordx4 v[240:243], v4, s[4:7], s78 offen
  s_waitcnt vmcnt(8)
  s_mov_b64 exec, 1
  buffer_store_dword v38, off, s[4:7], s84 sc1
  s_mov_b64 exec, -1
  s_mov_b32 s84, 268435456
  s_branch o_we_105
o_rt_113:
  s_mov_b32 s67, 0
o_rl_117:
  s_lshl_b32 s94, s43, 14
  s_add_u32 s94, s94, s95
  buffer_load_dwordx4 v[120:123], v5, s[4:7], s94 offen offset:0 sc1
  buffer_load_dwordx4 v[124:127], v5, s[4:7], s94 offen offset:512 sc1
  buffer_load_dwordx4 v[128:131], v5, s[4:7], s94 offen offset:256 sc1
  buffer_load_dwordx4 v[132:135], v5, s[4:7], s94 offen offset:768 sc1
  s_add_u32 s94, s94, 4096
  buffer_load_dwordx4 v[136:139], v5, s[4:7], s94 offen offset:0 sc1
  buffer_load_dwordx4 v[140:143], v5, s[4:7], s94 offen offset:512 sc1
  buffer_load_dwordx4 v[144:147], v5, s[4:7], s94 offen offset:256 sc1
  buffer_load_dwordx4 v[148:151], v5, s[4:7], s94 offen offset:768 sc1
  s_add_u32 s94, s94, 4096
  buffer_load_dwordx4 v[152:155], v5, s[4:7], s94 offen offset:0 sc1
  buffer_load_dwordx4 v[156:159], v5, s[4:7], s94 offen offset:512 sc1
  buffer_load_dwordx4 v[160:163], v5, s[4:7], s94 offen offset:256 sc1
  buffer_load_dwordx4 v[164:167], v5, s[4:7], s94 offen offset:768 sc1
  s_add_u32 s94, s94, 4096
  buffer_load_dwordx4 v[168:171], v5, s[4:7], s94 offen offset:0 sc1
  buffer_load_dwordx4 v[172:175], v5, s[4:7], s94 offen offset:512 sc1
  buffer_load_dwordx4 v[176:179], v5, s[4:7], s94 offen offset:256 sc1
  buffer_load_dwordx4 v[180:183], v5, s[4:7], s94 offen offset:768 sc1
  s_add_u32 s67, s67, 1
  s_cmp_gt_u32 s67, 1048576
  s_cbranch_scc1 L_end
  s_waitcnt vmcnt(0)
  v_xor_b32 v7, s96, v120
  v_bitop3_b32 v7, v7, v124, s96 bitop3:0xf6
  v_bitop3_b32 v7, v7, v128, s96 bitop3:0xf6
  v_bitop3_b32 v7, v7, v132, s96 bitop3:0xf6
  v_bitop3_b32 v7, v7, v136, s96 bitop3:0xf6
  v_bitop3_b32 v7, v7, v140, s96 bitop3:0xf6
  v_bitop3_b32 v7, v7, v144, s96 bitop3:0xf6
  v_bitop3_b32 v7, v7, v148, s96 bitop3:0xf6
  v_bitop3_b32 v7, v7, v152, s96 bitop3:0xf6
  v_bitop3_b32 v7, v7, v156, s96 bitop3:0xf6
  v_bitop3_b32 v7, v7, v160, s96 bitop3:0xf6
  v_bitop3_b32 v7, v7, v164, s96 bitop3:0xf6
  v_bitop3_b32 v7, v7, v168, s96 bitop3:0xf6
  v_bitop3_b32 v7, v7, v172, s96 bitop3:0xf6
  v_bitop3_b32 v7, v7, v176, s96 bitop3:0xf6
  v_bitop3_b32 v7, v7, v180, s96 bitop3:0xf6
  v_and_b32 v7, v254, v7
  v_cmp_ne_u32 vcc, 0, v7
  s_cbranch_vccnz o_rl_117
  s_branch o_bk_114
o_rt_115:
  s_mov_b32 s67, 0
o_rl_118:
  s_lshl_b32 s94, s43, 14
  s_add_u32 s94, s94, s95
  buffer_load_dwordx4 v[120:123], v5, s[4:7], s94 offen offset:0 sc1
  buffer_load_dwordx4 v[124:127], v5, s[4:7], s94 offen offset:512 sc1
  buffer_load_dwordx4 v[128:131], v5, s[4:7], s94 offen offset:256 sc1
  buffer_load_dwordx4 v[132:135], v5, s[4:7], s94 offen offset:768 sc1
  s_add_u32 s94, s94, 4096
  buffer_load_dwordx4 v[136:139], v5, s[4:7], s94 offen offset:0 sc1
  buffer_load_dwordx4 v[140:143], v5, s[4:7], s94 offen offset:512 sc1
  buffer_load_dwordx4 v[144:147], v5, s[4:7], s94 offen offset:256 sc1
  buffer_load_dwordx4 v[148:151], v5, s[4:7], s94 offen offset:768 sc1
  s_add_u32 s94, s94, 4096
  buffer_load_dwordx4 v[152:155], v5, s[4:7], s94 offen offset:0 sc1
  buffer_load_dwordx4 v[156:159], v5, s[4:7], s94 offen offset:512 sc1
  buffer_load_dwordx4 v[160:163], v5, s[4:7], s94 offen offset:256 sc1
  buffer_load_dwordx4 v[164:167], v5, s[4:7], s94 offen offset:768 sc1
  s_add_u32 s94, s94, 4096
  buffer_load_dwordx4 v[168:171], v5, s[4:7], s94 offen offset:0 sc1
  buffer_load_dwordx4 v[172:175], v5, s[4:7], s94 offen offset:512 sc1
  buffer_load_dwordx4 v[176:179], v5, s[4:7], s94 offen offset:256 sc1
  buffer_load_dwordx4 v[180:183], v5, s[4:7], s94 offen offset:768 sc1
  s_add_u32 s67, s67, 1
  s_cmp_gt_u32 s67, 1048576
  s_cbranch_scc1 L_end
  s_waitcnt vmcnt(0)
  v_xor_b32 v7, s96, v120
  v_bitop3_b32 v7, v7, v124, s96 bitop3:0xf6
  v_bitop3_b32 v7, v7, v128, s96 bitop3:0xf6
  v_bitop3_b32 v7, v7, v132, s96 bitop3:0xf6
  v_bitop3_b32 v7, v7, v136, s96 bitop3:0xf6
  v_bitop3_b32 v7, v7, v140, s96 bitop3:0xf6
  v_bitop3_b32 v7, v7, v144, s96 bitop3:0xf6
  v_bitop3_b32 v7, v7, v148, s96 bitop3:0xf6
  v_bitop3_b32 v7, v7, v152, s96 bitop3:0xf6
  v_bitop3_b32 v7, v7, v156, s96 bitop3:0xf6
  v_bitop3_b32 v7, v7, v160, s96 bitop3:0xf6
  v_bitop3_b32 v7, v7, v164, s96 bitop3:0xf6
  v_bitop3_b32 v7, v7, v168, s96 bitop3:0xf6
  v_bitop3_b32 v7, v7, v172, s96 bitop3:0xf6
  v_bitop3_b32 v7, v7, v176, s96 bitop3:0xf6
  v_bitop3_b32 v7, v7, v180, s96 bitop3:0xf6
  v_and_b32 v7, v254, v7
  v_cmp_ne_u32 vcc, 0, v7
  s_cbranch_vccnz o_rl_118
  s_branch o_bk_116
o_fb_107:
  v_mov_b32 v118, v116
  s_nop 1
  v_permlane16_swap_b32 v116, v118
  v_max_f32 v116, v116, v118
  v_mov_b32 v118, v116
  s_nop 0
  s_nop 0
  v_permlane32_swap_b32 v116, v118
  v_max_f32 v116, v116, v118
  v_sub_f32 v56, v104, v116
  v_sub_f32 v57, v105, v116
  v_sub_f32 v58, v106, v116
  v_sub_f32 v59, v107, v116
  v_sub_f32 v60, v108, v116
  v_sub_f32 v61, v109, v116
  v_sub_f32 v62, v110, v116
  v_sub_f32 v63, v111, v116
  v_sub_f32 v64, v112, v116
  v_sub_f32 v65, v113, v116
  v_exp_f32 v56, v56
  v_exp_f32 v57, v57
  v_exp_f32 v58, v58
  v_exp_f32 v59, v59
  v_exp_f32 v60, v60
  v_exp_f32 v61, v61
  v_exp_f32 v62, v62
  v_exp_f32 v63, v63
  v_exp_f32 v64, v64
  v_exp_f32 v65, v65
  v_add_f32 v117, v56, v57
  v_add_f32 v117, v117, v58
  v_add_f32 v117, v117, v59
  v_add_f32 v117, v117, v60
  v_add_f32 v117, v117, v61
  v_add_f32 v117, v117, v62
  v_add_f32 v117, v117, v63
  v_add_f32 v117, v117, v64
  v_add_f32 v117, v117, v65
  v_mov_b32 v118, v117
  s_nop 0
  s_nop 0
  v_permlane16_swap_b32 v117, v118
  v_add_f32 v117, v117, v118
  v_mov_b32 v118, v117
  s_nop 0
  s_nop 0
  v_permlane32_swap_b32 v117, v118
  v_add_f32 v117, v117, v118
  v_rcp_f32 v117, v117
  s_branch o_fbr_108
o_fb_109:
  v_mov_b32 v118, v116
  s_nop 1
  v_permlane16_swap_b32 v116, v118
  v_max_f32 v116, v116, v118
  v_mov_b32 v118, v116
  s_nop 0
  s_nop 0
  v_permlane32_swap_b32 v116, v118
  v_max_f32 v116, v116, v118
  v_sub_f32 v56, v104, v116
  v_sub_f32 v57, v105, v116
  v_sub_f32 v58, v106, v116
  v_sub_f32 v59, v107, v116
  v_sub_f32 v60, v108, v116
  v_sub_f32 v61, v109, v116
  v_sub_f32 v62, v110, v116
  v_sub_f32 v63, v111, v116
  v_sub_f32 v64, v112, v116
  v_sub_f32 v65, v113, v116
  v_exp_f32 v56, v56
  v_exp_f32 v57, v57
  v_exp_f32 v58, v58
  v_exp_f32 v59, v59
  v_exp_f32 v60, v60
  v_exp_f32 v61, v61
  v_exp_f32 v62, v62
  v_exp_f32 v63, v63
  v_exp_f32 v64, v64
  v_exp_f32 v65, v65
  v_add_f32 v117, v56, v57
  v_add_f32 v117, v117, v58
  v_add_f32 v117, v117, v59
  v_add_f32 v117, v117, v60
  v_add_f32 v117, v117, v61
  v_add_f32 v117, v117, v62
  v_add_f32 v117, v117, v63
  v_add_f32 v117, v117, v64
  v_add_f32 v117, v117, v65
  v_mov_b32 v118, v117
  s_nop 0
  s_nop 0
  v_permlane16_swap_b32 v117, v118
  v_add_f32 v117, v117, v118
  v_mov_b32 v118, v117
  s_nop 0
  s_nop 0
  v_permlane32_swap_b32 v117, v118
  v_add_f32 v117, v117, v118
  v_rcp_f32 v117, v117
  s_branch o_fbr_110
o_wr2_104:
  s_waitcnt lgkmcnt(0)
  s_barrier
  ds_read_b128 v[104:107], v3 offset:0
  ds_read_b128 v[108:111], v3 offset:512
  ds_read_b128 v[112:115], v3 offset:1024
  buffer_load_dwordx4 v[176:179], v5, s[4:7], s94 offen offset:256 sc1
  buffer_load_dwordx4 v[180:183], v5, s[4:7], s94 offen offset:768 sc1
  s_waitcnt lgkmcnt(2)
  v_mfma_f32_32x32x16_bf16 v[40:55], v[104:107], a[0:3], 0
  v_mov_b64 v[188:189], 0
  v_mov_b64 v[190:191], 0
  v_mov_b64 v[192:193], 0
  v_mov_b64 v[194:195], 0
  s_mov_b64 exec, 1
  buffer_store_dword v38, off, s[4:7], s84 sc1
  s_mov_b64 exec, -1
  s_mov_b32 s84, 268435456
  v_mfma_f32_32x32x16_bf16 v[56:71], v[104:107], a[4:7], 0
  ds_read_b128 v[116:119], v3 offset:1536
  v_mfma_f32_32x32x16_bf16 v[72:87], v[104:107], a[8:11], 0
  v_mfma_f32_32x32x16_bf16 v[88:103], v[104:107], a[12:15], 0
  s_waitcnt vmcnt(13)
  v_xor_b32 v7, s96, v120
  v_bitop3_b32 v7, v7, v124, s96 bitop3:0xf6
  v_bitop3_b32 v7, v7, v128, s96 bitop3:0xf6
  v_bitop3_b32 v7, v7, v132, s96 bitop3:0xf6
  s_waitcnt lgkmcnt(2)
  v_mfma_f32_32x32x16_bf16 v[40:55], v[108:111], a[16:19], v[40:55]
  s_waitcnt vmcnt(9)
  v_bitop3_b32 v7, v7, v136, s96 bitop3:0xf6
  v_bitop3_b32 v7, v7, v140, s96 bitop3:0xf6
  v_bitop3_b32 v7, v7, v144, s96 bitop3:0xf6
  v_bitop3_b32 v7, v7, v148, s96 bitop3:0xf6
  s_waitcnt vmcnt(5)
  v_mfma_f32_32x32x16_bf16 v[56:71], v[108:111], a[20:23], v[56:71]
  ds_read_b128 v[104:107], v3 offset:2048
  v_bitop3_b32 v7, v7, v152, s96 bitop3:0xf6
  v_bitop3_b32 v7, v7, v156, s96 bitop3:0xf6
  v_bitop3_b32 v7, v7, v160, s96 bitop3:0xf6
  v_bitop3_b32 v7, v7, v164, s96 bitop3:0xf6
  s_waitcnt vmcnt(1)
  v_mfma_f32_32x32x16_bf16 v[72:87], v[108:111], a[24:27], v[72:87]
  v_bitop3_b32 v7, v7, v168, s96 bitop3:0xf6
  v_bitop3_b32 v7, v7, v172, s96 bitop3:0xf6
  v_bitop3_b32 v7, v7, v176, s96 bitop3:0xf6
  v_bitop3_b32 v7, v7, v180, s96 bitop3:0xf6
  v_and_b32 v7, v254, v7
  v_cmp_ne_u32 vcc, 0, v7
  s_cbranch_vccnz o_rt_115
o_bk_116:
  v_mfma_f32_32x32x16_bf16 v[88:103], v[108:111], a[28:31], v[88:103]
  v_smfmac_f32_16x16x64_bf16 v[188:191], v[16:19], v[120:127], v20
  v_lshlrev_b32 v196, 16, v184
  v_smfmac_f32_16x16x64_bf16 v[192:195], v[16:19], v[128:135], v20
  v_and_b32 v197, 0xffff0000, v184
  v_smfmac_f32_16x16x64_bf16 v[188:191], v[16:19], v[136:143], v20
  v_lshlrev_b32 v198, 16, v185
  s_waitcnt lgkmcnt(2)
  v_mfma_f32_32x32x16_bf16 v[40:55], v[112:115], a[32:35], v[40:55]
  v_smfmac_f32_16x16x64_bf16 v[192:195], v[16:19], v[144:151], v20
  v_and_b32 v199, 0xffff0000, v185
  v_smfmac_f32_16x16x64_bf16 v[188:191], v[16:19], v[152:159], v20
  v_lshlrev_b32 v200, 16, v186
  v_smfmac_f32_16x16x64_bf16 v[192:195], v[16:19], v[160:167], v20
  v_and_b32 v201, 0xffff0000, v186
  v_mfma_f32_32x32x16_bf16 v[56:71], v[112:115], a[36:39], v[56:71]
  ds_read_b128 v[108:111], v3 offset:2560
  v_smfmac_f32_16x16x64_bf16 v[188:191], v[16:19], v[168:175], v20
  v_lshlrev_b32 v202, 16, v187
  v_smfmac_f32_16x16x64_bf16 v[192:195], v[16:19], v[176:183], v20
  v_and_b32 v203, 0xffff0000, v187
  s_bfe_u32 s92, s65, 131086
  v_mfma_f32_32x32x16_bf16 v[72:87], v[112:115], a[40:43], v[72:87]
  s_lshl_b32 s92, s92, 21
  s_add_u32 s92, s92, s91
  s_add_u32 s93, s92, 27262976
  s_add_u32 s92, s92, 20971520
  v_permlane16_swap_b32 v188, v192
  v_mfma_f32_32x32x16_bf16 v[88:103], v[112:115], a[44:47], v[88:103]
  v_permlane16_swap_b32 v189, v193
  v_permlane16_swap_b32 v190, v194
  v_permlane16_swap_b32 v191, v195
  s_waitcnt lgkmcnt(2)
  v_mfma_f32_32x32x16_bf16 v[40:55], v[116:119], a[48:51], v[40:55]
  v_cvt_pk_bf16_f32 v188, 0, v188
  v_cvt_pk_bf16_f32 v189, 0, v189
  v_cvt_pk_bf16_f32 v190, 0, v190
  v_cvt_pk_bf16_f32 v191, 0, v191
  v_cvt_pk_bf16_f32 v192, 0, v192
  v_cvt_pk_bf16_f32 v193, 0, v193
  v_mfma_f32_32x32x16_bf16 v[56:71], v[116:119], a[52:55], v[56:71]
  ds_read_b128 v[112:115], v3 offset:3072
  v_cvt_pk_bf16_f32 v194, 0, v194
  v_cvt_pk_bf16_f32 v195, 0, v195
  v_add_f32 v196, v196, v188
  v_add_f32 v197, v197, v189
  v_add_f32 v198, v198, v190
  v_mfma_f32_32x32x16_bf16 v[72:87], v[116:119], a[56:59], v[72:87]
  v_add_f32 v199, v199, v191
  v_add_f32 v200, v200, v192
  v_add_f32 v201, v201, v193
  v_add_f32 v202, v202, v194
  v_add_f32 v203, v203, v195
  v_cvt_pk_bf16_f32 v120, v196, v197
  v_mfma_f32_32x32x16_bf16 v[88:103], v[116:119], a[60:63], v[88:103]
  v_cvt_pk_bf16_f32 v121, v198, v199
  v_cvt_pk_bf16_f32 v122, v200, v201
  v_cvt_pk_bf16_f32 v123, v202, v203
  v_lshlrev_b32 v196, 16, v120
  v_and_b32 v197, 0xffff0000, v120
  s_waitcnt lgkmcnt(2)
  v_mfma_f32_32x32x16_bf16 v[40:55], v[104:107], a[64:67], v[40:55]
  v_lshlrev_b32 v198, 16, v121
  v_and_b32 v199, 0xffff0000, v121
  v_lshlrev_b32 v200, 16, v122
  v_and_b32 v201, 0xffff0000, v122
  v_lshlrev_b32 v202, 16, v123
  v_and_b32 v203, 0xffff0000, v123
  v_mfma_f32_32x32x16_bf16 v[56:71], v[104:107], a[68:71], v[56:71]
  ds_read_b128 v[116:119], v3 offset:3584
  buffer_store_dwordx4 v[120:123], v0, s[4:7], s92 offen sc1
  v_add_f32 v136, v196, v197
  v_mul_f32 v137, v196, v196
  v_mfma_f32_32x32x16_bf16 v[72:87], v[104:107], a[72:75], v[72:87]
  v_add_f32 v138, v198, v199
  v_mul_f32 v139, v197, v197
  v_fmac_f32 v137, v198, v198
  v_fmac_f32 v139, v199, v199
  v_add_f32 v136, v136, v200
  v_fmac_f32 v137, v200, v200
  v_mfma_f32_32x32x16_bf16 v[88:103], v[104:107], a[76:79], v[88:103]
  v_add_f32 v138, v138, v201
  v_fmac_f32 v139, v201, v201
  v_add_f32 v136, v136, v202
  v_fmac_f32 v137, v202, v202
  v_add_f32 v138, v138, v203
  s_waitcnt lgkmcnt(2)
  v_mfma_f32_32x32x16_bf16 v[40:55], v[108:111], a[80:83], v[40:55]
  v_fmac_f32 v139, v203, v203
  v_add_f32 v136, v136, v138
  v_add_f32 v137, v137, v139
  s_nop 0
  v_add_f32_dpp v136, v136, v136 row_ror:8 row_mask:0xf bank_mask:0xf
  v_add_f32_dpp v137, v137, v137 row_ror:8 row_mask:0xf bank_mask:0xf
  s_nop 0
  v_add_f32_dpp v136, v136, v136 row_ror:4 row_mask:0xf bank_mask:0xf
  v_mfma_f32_32x32x16_bf16 v[56:71], v[108:111], a[84:87], v[56:71]
  ds_read_b128 v[104:107], v3 offset:8192
  v_add_f32_dpp v137, v137, v137 row_ror:4 row_mask:0xf bank_mask:0xf
  v_add_f32_dpp v136, v136, v136 row_ror:2 row_mask:0xf bank_mask:0xf
  s_nop 0
  v_add_f32_dpp v137, v137, v137 row_ror:2 row_mask:0xf bank_mask:0xf
  v_add_f32_dpp v136, v136, v136 row_ror:1 row_mask:0xf bank_mask:0xf
  s_nop 0
  v_add_f32_dpp v137, v137, v137 row_ror:1 row_mask:0xf bank_mask:0xf
  v_mfma_f32_32x32x16_bf16 v[72:87], v[108:111], a[88:91], v[72:87]
  v_mov_b32 v140, v136
  v_mov_b32 v141, v137
  s_nop 0
  v_permlane16_swap_b32 v136, v140
  v_permlane16_swap_b32 v137, v141
  v_mfma_f32_32x32x16_bf16 v[88:103], v[108:111], a[92:95], v[88:103]
  v_add_f32 v136, v136, v140
  v_add_f32 v137, v137, v141
  v_mov_b32 v140, v136
  v_mov_b32 v141, v137
  s_nop 0
  v_permlane32_swap_b32 v136, v140
  s_waitcnt lgkmcnt(2)
  v_mfma_f32_32x32x16_bf16 v[40:55], v[112:115], a[96:99], v[40:55]
  v_permlane32_swap_b32 v137, v141
  v_add_f32 v136, v136, v140
  v_add_f32 v137, v137, v141
  v_mul_f32 v136, 0x3b000000, v136
  v_mul_f32 v137, 0x3b000000, v137
  v_mfma_f32_32x32x16_bf16 v[56:71], v[112:115], a[100:103], v[56:71]
  ds_read_b128 v[108:111], v3 offset:8704
  v_fma_f32 v137, -v136, v136, v137
  v_cvt_pk_bf16_f32 v136, 0, v136
  v_max_f32 v137, 0, v137
  v_sub_f32 v140, v196, v136
  v_sub_f32 v141, v197, v136
  v_mfma_f32_32x32x16_bf16 v[72:87], v[112:115], a[104:107], v[72:87]
  v_cvt_pk_bf16_f32 v137, 0, v137
  v_sub_f32 v142, v198, v136
  v_sub_f32 v143, v199, v136
  v_add_f32 v137, 0x3727c5ac, v137
  v_sub_f32 v144, v200, v136
  v_sub_f32 v145, v201, v136
  v_mfma_f32_32x32x16_bf16 v[88:103], v[112:115], a[108:111], v[88:103]
  v_cvt_pk_bf16_f32 v137, 0, v137
  v_sub_f32 v146, v202, v136
  v_sub_f32 v147, v203, v136
  v_sqrt_f32 v137, v137
  s_waitcnt lgkmcnt(2)
  v_mfma_f32_32x32x16_bf16 v[40:55], v[116:119], a[112:115], v[40:55]
  v_cvt_pk_bf16_f32 v140, 0, v140
  v_cvt_pk_bf16_f32 v141, 0, v141
  v_cvt_pk_bf16_f32 v137, 0, v137
  v_cvt_pk_bf16_f32 v142, 0, v142
  v_cvt_pk_bf16_f32 v143, 0, v143
  v_rcp_f32 v137, v137
  v_mfma_f32_32x32x16_bf16 v[56:71], v[116:119], a[116:119], v[56:71]
  ds_read_b128 v[112:115], v3 offset:9216
  v_cvt_pk_bf16_f32 v144, 0, v144
  v_cvt_pk_bf16_f32 v145, 0, v145
  v_cvt_pk_bf16_f32 v146, 0, v146
  v_cvt_pk_bf16_f32 v147, 0, v147
  v_mul_f32 v140, v140, v137
  v_mfma_f32_32x32x16_bf16 v[72:87], v[116:119], a[120:123], v[72:87]
  v_mul_f32 v141, v141, v137
  v_mul_f32 v142, v142, v137
  v_mul_f32 v143, v143, v137
  v_mul_f32 v144, v144, v137
  v_mul_f32 v145, v145, v137
  v_mul_f32 v146, v146, v137
  v_mfma_f32_32x32x16_bf16 v[88:103], v[116:119], a[124:127], v[88:103]
  v_mul_f32 v147, v147, v137
  v_cvt_pk_bf16_f32 v124, v140, v141
  v_cvt_pk_bf16_f32 v125, v142, v143
  v_cvt_pk_bf16_f32 v126, v144, v145
  v_cvt_pk_bf16_f32 v127, v146, v147
  s_waitcnt lgkmcnt(2)
  v_mfma_f32_32x32x16_bf16 v[40:55], v[104:107], a[128:131], v[40:55]
  v_lshlrev_b32 v204, 16, v124
  v_and_b32 v205, 0xffff0000, v124
  v_lshlrev_b32 v206, 16, v125
  v_and_b32 v207, 0xffff0000, v125
  v_lshlrev_b32 v208, 16, v126
  v_and_b32 v209, 0xffff0000, v126
  v_mfma_f32_32x32x16_bf16 v[56:71], v[104:107], a[132:135], v[56:71]
  ds_read_b128 v[116:119], v3 offset:9728
  v_lshlrev_b32 v210, 16, v127
  v_and_b32 v211, 0xffff0000, v127
  buffer_store_dwordx4 v[124:127], v0, s[4:7], s93 offen sc1
  v_mfma_f32_32x32x16_bf16 v[72:87], v[104:107], a[136:139], v[72:87]
  v_add_f32 v196, v196, v204
  v_add_f32 v197, v197, v205
  v_add_f32 v198, v198, v206
  v_add_f32 v199, v199, v207
  v_add_f32 v200, v200, v208
  v_add_f32 v201, v201, v209
  v_mfma_f32_32x32x16_bf16 v[88:103], v[104:107], a[140:143], v[88:103]
  v_add_f32 v202, v202, v210
  v_add_f32 v203, v203, v211
  v_cvt_pk_bf16_f32 v128, v196, v197
  v_cvt_pk_bf16_f32 v129, v198, v199
  v_cvt_pk_bf16_f32 v130, v200, v201
  s_waitcnt lgkmcnt(2)
  v_mfma_f32_32x32x16_bf16 v[40:55], v[108:111], a[144:147], v[40:55]
  v_cvt_pk_bf16_f32 v131, v202, v203
  v_mul_f32 v188, v204, v8
  v_mul_f32 v189, v205, v9
  v_fmac_f32 v188, v206, v10
  v_fmac_f32 v189, v207, v11
  v_fmac_f32 v188, v208, v12
  v_mfma_f32_32x32x16_bf16 v[56:71], v[108:111], a[148:151], v[56:71]
  ds_read_b128 v[104:107], v3 offset:10240
  v_fmac_f32 v189, v209, v13
  v_fmac_f32 v188, v210, v14
  v_fmac_f32 v189, v211, v15
  v_add_f32 v188, v188, v189
  buffer_store_dwordx4 v[128:131], v0, s[68:71], s91 offen sc1
  v_mfma_f32_32x32x16_bf16 v[72:87], v[108:111], a[152:155], v[72:87]
  v_add_f32_dpp v188, v188, v188 row_ror:8 row_mask:0xf bank_mask:0xf
  s_nop 1
  v_add_f32_dpp v188, v188, v188 row_ror:4 row_mask:0xf bank_mask:0xf
  s_nop 1
  v_add_f32_dpp v188, v188, v188 row_ror:2 row_mask:0xf bank_mask:0xf
  s_nop 1
  v_add_f32_dpp v188, v188, v188 row_ror:1 row_mask:0xf bank_mask:0xf
  v_mov_b32 v189, v188
  s_nop 0
  s_nop 0
  v_permlane16_swap_b32 v188, v189
  v_mfma_f32_32x32x16_bf16 v[88:103], v[108:111], a[156:159], v[88:103]
  v_add_f32 v188, v188, v189
  v_mov_b32 v189, v188
  s_nop 0
  s_nop 0
  v_permlane32_swap_b32 v188, v189
  v_add_f32 v188, v188, v189
  s_waitcnt lgkmcnt(2)
  v_mfma_f32_32x32x16_bf16 v[40:55], v[112:115], a[160:163], v[40:55]
  v_cvt_pk_bf16_f32 v188, 0, v188
  v_ashrrev_i32 v189, 31, v188
  v_or_b32 v189, 0x80000000, v189
  v_xor_b32 v188, v188, v189
  s_sub_u32 s92, 4095, s90
  v_and_b32 v188, 0xffff0000, v188
  v_mfma_f32_32x32x16_bf16 v[56:71], v[112:115], a[164:167], v[56:71]
  ds_read_b128 v[108:111], v3 offset:10752
  v_or_b32 v38, s92, v188
  s_bfe_u32 s92, s65, 196625
  s_lshl_b32 s92, s92, 18
  s_lshl_b32 s93, s90, 7
  s_add_u32 s92, s92, s93
  v_mfma_f32_32x32x16_bf16 v[72:87], v[112:115], a[168:171], v[72:87]
  s_add_u32 s84, s92, 243269632
  v_mfma_f32_32x32x16_bf16 v[88:103], v[112:115], a[172:175], v[88:103]
  s_waitcnt lgkmcnt(2)
  v_mfma_f32_32x32x16_bf16 v[40:55], v[116:119], a[176:179], v[40:55]
  v_mfma_f32_32x32x16_bf16 v[56:71], v[116:119], a[180:183], v[56:71]
  ds_read_b128 v[112:115], v3 offset:11264
  v_mfma_f32_32x32x16_bf16 v[72:87], v[116:119], a[184:187], v[72:87]
  v_mfma_f32_32x32x16_bf16 v[88:103], v[116:119], a[188:191], v[88:103]
  s_waitcnt lgkmcnt(2)
  v_mfma_f32_32x32x16_bf16 v[40:55], v[104:107], a[192:195], v[40:55]
  v_mfma_f32_32x32x16_bf16 v[56:71], v[104:107], a[196:199], v[56:71]
  ds_read_b128 v[116:119], v3 offset:11776
  s_waitcnt lgkmcnt(2)
  v_mfma_f32_32x32x16_bf16 v[40:55], v[108:111], a[208:211], v[40:55]
  v_mfma_f32_32x32x16_bf16 v[56:71], v[108:111], a[212:215], v[56:71]
  s_waitcnt lgkmcnt(1)
  v_mfma_f32_32x32x16_bf16 v[40:55], v[112:115], a[224:227], v[40:55]
  v_mfma_f32_32x32x16_bf16 v[56:71], v[112:115], a[228:231], v[56:71]
  s_waitcnt lgkmcnt(0)
  v_mfma_f32_32x32x16_bf16 v[40:55], v[116:119], a[240:243], v[40:55]
  v_mfma_f32_32x32x16_bf16 v[56:71], v[116:119], a[244:247], v[56:71]
  v_mfma_f32_32x32x16_bf16 v[72:87], v[104:107], a[200:203], v[72:87]
  v_mfma_f32_32x32x16_bf16 v[88:103], v[104:107], a[204:207], v[88:103]
  v_cvt_pk_bf16_f32 v212, v40, v56
  v_cvt_pk_bf16_f32 v214, v41, v57
  v_cvt_pk_bf16_f32 v216, v42, v58
  v_cvt_pk_bf16_f32 v218, v43, v59
  v_permlane16_swap_b32 v212, v214
  v_mfma_f32_32x32x16_bf16 v[72:87], v[108:111], a[216:219], v[72:87]
  v_cvt_pk_bf16_f32 v220, v44, v60
  v_cvt_pk_bf16_f32 v222, v45, v61
  v_permlane16_swap_b32 v216, v218
  v_bfi_b32 v212, v254, s42, v212
  v_cvt_pk_bf16_f32 v224, v46, v62
  v_mfma_f32_32x32x16_bf16 v[88:103], v[108:111], a[220:223], v[88:103]
  v_cvt_pk_bf16_f32 v226, v47, v63
  v_permlane16_swap_b32 v220, v222
  v_bfi_b32 v216, v254, s42, v216
  v_cvt_pk_bf16_f32 v228, v48, v64
  v_mfma_f32_32x32x16_bf16 v[72:87], v[112:115], a[232:235], v[72:87]
  v_cvt_pk_bf16_f32 v230, v49, v65
  v_permlane16_swap_b32 v224, v226
  v_bfi_b32 v220, v254, s42, v220
  v_cvt_pk_bf16_f32 v232, v50, v66
  v_cvt_pk_bf16_f32 v234, v51, v67
  v_mfma_f32_32x32x16_bf16 v[88:103], v[112:115], a[236:239], v[88:103]
  v_permlane16_swap_b32 v228, v230
  v_bfi_b32 v224, v254, s42, v224
  v_cvt_pk_bf16_f32 v236, v52, v68
  v_cvt_pk_bf16_f32 v238, v53, v69
  v_mfma_f32_32x32x16_bf16 v[72:87], v[116:119], a[248:251], v[72:87]
  v_permlane16_swap_b32 v232, v234
  v_bfi_b32 v228, v254, s42, v228
  v_cvt_pk_bf16_f32 v240, v54, v70
  v_cvt_pk_bf16_f32 v242, v55, v71
  v_permlane16_swap_b32 v236, v238
  v_mfma_f32_32x32x16_bf16 v[88:103], v[116:119], a[252:255], v[88:103]
  v_bfi_b32 v232, v254, s42, v232
  v_permlane16_swap_b32 v240, v242
  v_bfi_b32 v236, v254, s42, v236
  v_bfi_b32 v240, v254, s42, v240
  s_nop 7
  v_cvt_pk_bf16_f32 v213, v72, v88
  v_cvt_pk_bf16_f32 v215, v73, v89
  v_cvt_pk_bf16_f32 v217, v74, v90
  v_cvt_pk_bf16_f32 v219, v75, v91
  s_add_u32 s78, s86, 0
  v_permlane16_swap_b32 v213, v215
  buffer_store_dwordx4 v[212:215], v4, s[4:7], s78 offen
  v_cvt_pk_bf16_f32 v221, v76, v92
  v_cvt_pk_bf16_f32 v223, v77, v93
  s_add_u32 s78, s86, 32768
  v_permlane16_swap_b32 v217, v219
  buffer_store_dwordx4 v[216:219], v4, s[4:7], s78 offen
  v_cvt_pk_bf16_f32 v225, v78, v94
  v_cvt_pk_bf16_f32 v227, v79, v95
  s_add_u32 s78, s86, 131072
  v_permlane16_swap_b32 v221, v223
  buffer_store_dwordx4 v[220:223], v4, s[4:7], s78 offen
  v_cvt_pk_bf16_f32 v229, v80, v96
  v_cvt_pk_bf16_f32 v231, v81, v97
  s_add_u32 s78, s86, 163840
  v_permlane16_swap_b32 v225, v227
  buffer_store_dwordx4 v[224:227], v4, s[4:7], s78 offen
  v_cvt_pk_bf16_f32 v233, v82, v98
  v_cvt_pk_bf16_f32 v235, v83, v99
  s_add_u32 s78, s86, 262144
  v_permlane16_swap_b32 v229, v231
  buffer_store_dwordx4 v[228:231], v4, s[4:7], s78 offen
  v_cvt_pk_bf16_f32 v237, v84, v100
  v_cvt_pk_bf16_f32 v239, v85, v101
  s_add_u32 s78, s86, 294912
  v_permlane16_swap_b32 v233, v235
  buffer_store_dwordx4 v[232:235], v4, s[4:7], s78 offen
  v_cvt_pk_bf16_f32 v241, v86, v102
  v_cvt_pk_bf16_f32 v243, v87, v103
  s_add_u32 s78, s86, 393216
  v_permlane16_swap_b32 v237, v239
  buffer_store_dwordx4 v[236:239], v4, s[4:7], s78 offen
  s_add_u32 s78, s86, 425984
  v_permlane16_swap_b32 v241, v243
  buffer_store_dwordx4 v[240:243], v4, s[4:7], s78 offen
o_we_105:
  v_and_b32 v37, -32, v39
  s_waitcnt lgkmcnt(0)
  s_barrier
  ds_read_b128 v[104:107], v37 offset:16
  s_mov_b32 s65, s63
  s_waitcnt lgkmcnt(0)
  v_and_b32 v104, v104, v106
  v_max_u32 v105, v105, v107
  v_readfirstlane_b32 s26, v104
  v_readfirstlane_b32 s3, v105
  s_and_b32 s66, s26, 1
  s_and_b32 s76, s26, 2
  s_bitcmp1_b32 s26, 2
  s_cselect_b32 s3, s3, 0
  s_cmp_lg_u32 s76, 0
  s_cbranch_scc1 o_nofl_83
  s_and_b32 s26, s63, 49152
  s_cbranch_scc0 o_fl_84
  s_cmp_lg_u32 s64, 0
  s_cbranch_scc1 o_nofl_83
o_fl_84:
  s_cmp_ge_u32 s17, 2
  s_cbranch_scc1 o_fd_119
  s_cmp_eq_u32 s65, 0
  s_cbranch_scc1 o_fd_119
  s_mov_b32 s96, s42
  s_waitcnt vmcnt(0)
  s_mov_b64 exec, 1
  buffer_store_dword v38, off, s[4:7], s84 sc1
  s_mov_b64 exec, -1
  s_mov_b32 s84, 268435456
  s_lshl_b32 s97, s43, 14
  s_add_u32 s97, s97, s86
  buffer_load_dword v7, v255, s[4:7], s97 offen sc1
  s_and_b32 s91, s65, 63
  s_lshl_b32 s90, s91, 5
  s_add_u32 s94, s90, s85
  s_add_u32 s90, s90, s43
  s_lshl_b32 s94, s94, 10
  s_lshr_b32 s92, s65, 22
  s_xor_b32 s93, s43, 32
  s_lshl_b32 s91, s90, 10
  s_add_u32 s94, s94, 25165824
  s_cmp_eq_u32 s92, s93
  s_cselect_b32 s92, s94, s91
  s_add_u32 s92, s92, 10485760
  s_and_b32 s93, s65, 49152
  s_cselect_b32 s92, s92, s91
  s_cselect_b64 s[80:81], s[4:5], s[72:73]
  s_cselect_b32 s82, s6, s74
  buffer_load_dwordx4 v[184:187], v0, s[80:83], s92 offen sc1
  s_mov_b32 s67, 0
  s_mov_b64 vcc, 0
  s_waitcnt vmcnt(1)
o_pl_121:
  v_and_b32 v7, 1, v7
  v_cmp_ne_u32 vcc, s96, v7
  s_cbranch_vccz o_pk_122
  buffer_load_dword v7, v255, s[4:7], s97 offen sc1
  s_add_u32 s67, s67, 1
  s_cmp_gt_u32 s67, 1048576
  s_cbranch_scc1 L_end
  s_waitcnt vmcnt(0)
  s_branch o_pl_121
o_pk_122:
  s_and_b32 s26, s65, 49152
  s_cbranch_scc1 o_f2_120
  s_lshl_b32 s94, s43, 14
  s_add_u32 s94, s94, s86
  buffer_load_dwordx4 v[120:123], v5, s[4:7], s94 offen offset:0 sc1
  buffer_load_dwordx4 v[124:127], v5, s[4:7], s94 offen offset:512 sc1
  buffer_load_dwordx4 v[128:131], v5, s[4:7], s94 offen offset:256 sc1
  buffer_load_dwordx4 v[132:135], v5, s[4:7], s94 offen offset:768 sc1
  s_add_u32 s94, s94, 4096
  buffer_load_dwordx4 v[136:139], v5, s[4:7], s94 offen offset:0 sc1
  buffer_load_dwordx4 v[140:143], v5, s[4:7], s94 offen offset:512 sc1
  buffer_load_dwordx4 v[144:147], v5, s[4:7], s94 offen offset:256 sc1
  buffer_load_dwordx4 v[148:151], v5, s[4:7], s94 offen offset:768 sc1
  s_add_u32 s94, s94, 4096
  buffer_load_dwordx4 v[152:155], v5, s[4:7], s94 offen offset:0 sc1
  buffer_load_dwordx4 v[156:159], v5, s[4:7], s94 offen offset:512 sc1
  buffer_load_dwordx4 v[160:163], v5, s[4:7], s94 offen offset:256 sc1
  buffer_load_dwordx4 v[164:167], v5, s[4:7], s94 offen offset:768 sc1
  s_add_u32 s94, s94, 4096
  buffer_load_dwordx4 v[168:171], v5, s[4:7], s94 offen offset:0 sc1
  buffer_load_dwordx4 v[172:175], v5, s[4:7], s94 offen offset:512 sc1
  buffer_load_dwordx4 v[176:179], v5, s[4:7], s94 offen offset:256 sc1
  buffer_load_dwordx4 v[180:183], v5, s[4:7], s94 offen offset:768 sc1
  v_mov_b64 v[188:189], 0
  v_mov_b64 v[190:191], 0
  v_mov_b64 v[192:193], 0
  v_mov_b64 v[194:195], 0
  s_waitcnt vmcnt(12)
  v_xor_b32 v7, s96, v120
  v_bitop3_b32 v7, v7, v124, s96 bitop3:0xf6
  v_bitop3_b32 v7, v7, v128, s96 bitop3:0xf6
  v_bitop3_b32 v7, v7, v132, s96 bitop3:0xf6
  s_waitcnt vmcnt(8)
  v_bitop3_b32 v7, v7, v136, s96 bitop3:0xf6
  v_bitop3_b32 v7, v7, v140, s96 bitop3:0xf6
  v_bitop3_b32 v7, v7, v144, s96 bitop3:0xf6
  v_bitop3_b32 v7, v7, v148, s96 bitop3:0xf6
  s_waitcnt vmcnt(4)
  v_bitop3_b32 v7, v7, v152, s96 bitop3:0xf6
  v_bitop3_b32 v7, v7, v156, s96 bitop3:0xf6
  v_bitop3_b32 v7, v7, v160, s96 bitop3:0xf6
  v_bitop3_b32 v7, v7, v164, s96 bitop3:0xf6
  s_waitcnt vmcnt(0)
  v_bitop3_b32 v7, v7, v168, s96 bitop3:0xf6
  v_bitop3_b32 v7, v7, v172, s96 bitop3:0xf6
  v_bitop3_b32 v7, v7, v176, s96 bitop3:0xf6
  v_bitop3_b32 v7, v7, v180, s96 bitop3:0xf6
  v_and_b32 v7, v254, v7
  v_cmp_ne_u32 vcc, 0, v7
  s_cbranch_vccnz o_rt_123
o_bk_124:
  v_smfmac_f32_16x16x64_bf16 v[188:191], v[16:19], v[120:127], v20
  v_lshlrev_b32 v196, 16, v184
  v_smfmac_f32_16x16x64_bf16 v[192:195], v[16:19], v[128:135], v20
  v_and_b32 v197, 0xffff0000, v184
  v_smfmac_f32_16x16x64_bf16 v[188:191], v[16:19], v[136:143], v20
  v_lshlrev_b32 v198, 16, v185
  v_smfmac_f32_16x16x64_bf16 v[192:195], v[16:19], v[144:151], v20
  v_and_b32 v199, 0xffff0000, v185
  v_smfmac_f32_16x16x64_bf16 v[188:191], v[16:19], v[152:159], v20
  v_lshlrev_b32 v200, 16, v186
  v_smfmac_f32_16x16x64_bf16 v[192:195], v[16:19], v[160:167], v20
  v_and_b32 v201, 0xffff0000, v186
  v_smfmac_f32_16x16x64_bf16 v[188:191], v[16:19], v[168:175], v20
  v_lshlrev_b32 v202, 16, v187
  v_smfmac_f32_16x16x64_bf16 v[192:195], v[16:19], v[176:183], v20
  v_and_b32 v203, 0xffff0000, v187
  s_bfe_u32 s92, s65, 131086
  s_lshl_b32 s92, s92, 21
  s_add_u32 s92, s92, s91
  s_add_u32 s93, s92, 27262976
  s_add_u32 s92, s92, 20971520
  s_nop 1
  v_permlane16_swap_b32 v188, v192
  v_permlane16_swap_b32 v189, v193
  v_permlane16_swap_b32 v190, v194
  v_permlane16_swap_b32 v191, v195
  v_cvt_pk_bf16_f32 v188, 0, v188
  v_cvt_pk_bf16_f32 v189, 0, v189
  v_cvt_pk_bf16_f32 v190, 0, v190
  v_cvt_pk_bf16_f32 v191, 0, v191
  v_cvt_pk_bf16_f32 v192, 0, v192
  v_cvt_pk_bf16_f32 v193, 0, v193
  v_cvt_pk_bf16_f32 v194, 0, v194
  v_cvt_pk_bf16_f32 v195, 0, v195
  v_add_f32 v196, v196, v188
  v_add_f32 v197, v197, v189
  v_add_f32 v198, v198, v190
  v_add_f32 v199, v199, v191
  v_add_f32 v200, v200, v192
  v_add_f32 v201, v201, v193
  v_add_f32 v202, v202, v194
  v_add_f32 v203, v203, v195
  v_cvt_pk_bf16_f32 v120, v196, v197
  v_cvt_pk_bf16_f32 v121, v198, v199
  v_cvt_pk_bf16_f32 v122, v200, v201
  v_cvt_pk_bf16_f32 v123, v202, v203
  v_lshlrev_b32 v196, 16, v120
  v_and_b32 v197, 0xffff0000, v120
  v_lshlrev_b32 v198, 16, v121
  v_and_b32 v199, 0xffff0000, v121
  v_lshlrev_b32 v200, 16, v122
  v_and_b32 v201, 0xffff0000, v122
  v_lshlrev_b32 v202, 16, v123
  v_and_b32 v203, 0xffff0000, v123
  buffer_store_dwordx4 v[120:123], v0, s[4:7], s92 offen sc1
  v_add_f32 v136, v196, v197
  v_mul_f32 v137, v196, v196
  v_add_f32 v138, v198, v199
  v_mul_f32 v139, v197, v197
  v_fmac_f32 v137, v198, v198
  v_fmac_f32 v139, v199, v199
  v_add_f32 v136, v136, v200
  v_fmac_f32 v137, v200, v200
  v_add_f32 v138, v138, v201
  v_fmac_f32 v139, v201, v201
  v_add_f32 v136, v136, v202
  v_fmac_f32 v137, v202, v202
  v_add_f32 v138, v138, v203
  v_fmac_f32 v139, v203, v203
  v_add_f32 v136, v136, v138
  v_add_f32 v137, v137, v139
  s_nop 0
  v_add_f32_dpp v136, v136, v136 row_ror:8 row_mask:0xf bank_mask:0xf
  v_add_f32_dpp v137, v137, v137 row_ror:8 row_mask:0xf bank_mask:0xf
  s_nop 0
  v_add_f32_dpp v136, v136, v136 row_ror:4 row_mask:0xf bank_mask:0xf
  v_add_f32_dpp v137, v137, v137 row_ror:4 row_mask:0xf bank_mask:0xf
  s_nop 0
  v_add_f32_dpp v136, v136, v136 row_ror:2 row_mask:0xf bank_mask:0xf
  v_add_f32_dpp v137, v137, v137 row_ror:2 row_mask:0xf bank_mask:0xf
  s_nop 0
  v_add_f32_dpp v136, v136, v136 row_ror:1 row_mask:0xf bank_mask:0xf
  v_add_f32_dpp v137, v137, v137 row_ror:1 row_mask:0xf bank_mask:0xf
  v_mov_b32 v140, v136
  v_mov_b32 v141, v137
  s_nop 0
  v_permlane16_swap_b32 v136, v140
  v_permlane16_swap_b32 v137, v141
  v_add_f32 v136, v136, v140
  v_add_f32 v137, v137, v141
  v_mov_b32 v140, v136
  v_mov_b32 v141, v137
  s_nop 0
  v_permlane32_swap_b32 v136, v140
  v_permlane32_swap_b32 v137, v141
  v_add_f32 v136, v136, v140
  v_add_f32 v137, v137, v141
  v_mul_f32 v136, 0x3b000000, v136
  v_mul_f32 v137, 0x3b000000, v137
  v_fma_f32 v137, -v136, v136, v137
  v_cvt_pk_bf16_f32 v136, 0, v136
  v_max_f32 v137, 0, v137
  v_sub_f32 v140, v196, v136
  v_sub_f32 v141, v197, v136
  v_cvt_pk_bf16_f32 v137, 0, v137
  v_sub_f32 v142, v198, v136
  v_sub_f32 v143, v199, v136
  v_add_f32 v137, 0x3727c5ac, v137
  v_sub_f32 v144, v200, v136
  v_sub_f32 v145, v201, v136
  v_cvt_pk_bf16_f32 v137, 0, v137
  v_sub_f32 v146, v202, v136
  v_sub_f32 v147, v203, v136
  v_sqrt_f32 v137, v137
  v_cvt_pk_bf16_f32 v140, 0, v140
  v_cvt_pk_bf16_f32 v141, 0, v141
  v_cvt_pk_bf16_f32 v137, 0, v137
  v_cvt_pk_bf16_f32 v142, 0, v142
  v_cvt_pk_bf16_f32 v143, 0, v143
  v_rcp_f32 v137, v137
  v_cvt_pk_bf16_f32 v144, 0, v144
  v_cvt_pk_bf16_f32 v145, 0, v145
  v_cvt_pk_bf16_f32 v146, 0, v146
  v_cvt_pk_bf16_f32 v147, 0, v147
  v_mul_f32 v140, v140, v137
  v_mul_f32 v141, v141, v137
  v_mul_f32 v142, v142, v137
  v_mul_f32 v143, v143, v137
  v_mul_f32 v144, v144, v137
  v_mul_f32 v145, v145, v137
  v_mul_f32 v146, v146, v137
  v_mul_f32 v147, v147, v137
  v_cvt_pk_bf16_f32 v124, v140, v141
  v_cvt_pk_bf16_f32 v125, v142, v143
  v_cvt_pk_bf16_f32 v126, v144, v145
  v_cvt_pk_bf16_f32 v127, v146, v147
  v_lshlrev_b32 v204, 16, v124
  v_and_b32 v205, 0xffff0000, v124
  v_lshlrev_b32 v206, 16, v125
  v_and_b32 v207, 0xffff0000, v125
  v_lshlrev_b32 v208, 16, v126
  v_and_b32 v209, 0xffff0000, v126
  v_lshlrev_b32 v210, 16, v127
  v_and_b32 v211, 0xffff0000, v127
  buffer_store_dwordx4 v[124:127], v0, s[4:7], s93 offen sc1
  v_add_f32 v196, v196, v204
  v_add_f32 v197, v197, v205
  v_add_f32 v198, v198, v206
  v_add_f32 v199, v199, v207
  v_add_f32 v200, v200, v208
  v_add_f32 v201, v201, v209
  v_add_f32 v202, v202, v210
  v_add_f32 v203, v203, v211
  v_cvt_pk_bf16_f32 v128, v196, v197
  v_cvt_pk_bf16_f32 v129, v198, v199
  v_cvt_pk_bf16_f32 v130, v200, v201
  v_cvt_pk_bf16_f32 v131, v202, v203
  v_mul_f32 v188, v204, v8
  v_mul_f32 v189, v205, v9
  v_fmac_f32 v188, v206, v10
  v_fmac_f32 v189, v207, v11
  v_fmac_f32 v188, v208, v12
  v_fmac_f32 v189, v209, v13
  v_fmac_f32 v188, v210, v14
  v_fmac_f32 v189, v211, v15
  v_add_f32 v188, v188, v189
  s_add_u32 s92, s91, 10485760
  s_add_u32 s93, s91, 8388608
  buffer_store_dwordx4 v[128:131], v0, s[4:7], s92 offen sc1
  v_lshlrev_b32 v196, 16, v128
  v_and_b32 v197, 0xffff0000, v128
  v_lshlrev_b32 v198, 16, v129
  v_and_b32 v199, 0xffff0000, v129
  v_lshlrev_b32 v200, 16, v130
  v_and_b32 v201, 0xffff0000, v130
  v_lshlrev_b32 v202, 16, v131
  v_and_b32 v203, 0xffff0000, v131
  v_add_f32 v136, v196, v197
  v_mul_f32 v137, v196, v196
  v_add_f32 v138, v198, v199
  v_mul_f32 v139, v197, v197
  v_fmac_f32 v137, v198, v198
  v_fmac_f32 v139, v199, v199
  v_add_f32 v136, v136, v200
  v_fmac_f32 v137, v200, v200
  v_add_f32 v138, v138, v201
  v_fmac_f32 v139, v201, v201
  v_add_f32 v136, v136, v202
  v_fmac_f32 v137, v202, v202
  v_add_f32 v138, v138, v203
  v_fmac_f32 v139, v203, v203
  v_add_f32 v136, v136, v138
  v_add_f32 v137, v137, v139
  s_nop 0
  v_add_f32_dpp v136, v136, v136 row_ror:8 row_mask:0xf bank_mask:0xf
  v_add_f32_dpp v137, v137, v137 row_ror:8 row_mask:0xf bank_mask:0xf
  v_add_f32_dpp v188, v188, v188 row_ror:8 row_mask:0xf bank_mask:0xf
  v_add_f32_dpp v136, v136, v136 row_ror:4 row_mask:0xf bank_mask:0xf
  v_add_f32_dpp v137, v137, v137 row_ror:4 row_mask:0xf bank_mask:0xf
  v_add_f32_dpp v188, v188, v188 row_ror:4 row_mask:0xf bank_mask:0xf
  v_add_f32_dpp v136, v136, v136 row_ror:2 row_mask:0xf bank_mask:0xf
  v_add_f32_dpp v137, v137, v137 row_ror:2 row_mask:0xf bank_mask:0xf
  v_add_f32_dpp v188, v188, v188 row_ror:2 row_mask:0xf bank_mask:0xf
  v_add_f32_dpp v136, v136, v136 row_ror:1 row_mask:0xf bank_mask:0xf
  v_add_f32_dpp v137, v137, v137 row_ror:1 row_mask:0xf bank_mask:0xf
  v_add_f32_dpp v188, v188, v188 row_ror:1 row_mask:0xf bank_mask:0xf
  v_mov_b32 v140, v136
  v_mov_b32 v141, v137
  v_mov_b32 v142, v188
  v_permlane16_swap_b32 v136, v140
  v_permlane16_swap_b32 v137, v141
  v_permlane16_swap_b32 v188, v142
  v_add_f32 v136, v136, v140
  v_add_f32 v137, v137, v141
  v_add_f32 v188, v188, v142
  v_mov_b32 v140, v136
  v_mov_b32 v141, v137
  v_mov_b32 v142, v188
  v_permlane32_swap_b32 v136, v140
  v_permlane32_swap_b32 v137, v141
  v_permlane32_swap_b32 v188, v142
  v_add_f32 v136, v136, v140
  v_add_f32 v137, v137, v141
  v_add_f32 v188, v188, v142
  v_mul_f32 v136, 0x3b000000, v136
  v_mul_f32 v137, 0x3b000000, v137
  v_fma_f32 v137, -v136, v136, v137
  v_cvt_pk_bf16_f32 v136, 0, v136
  v_max_f32 v137, 0, v137
  v_sub_f32 v140, v196, v136
  v_sub_f32 v141, v197, v136
  v_cvt_pk_bf16_f32 v137, 0, v137
  v_sub_f32 v142, v198, v136
  v_sub_f32 v143, v199, v136
  v_add_f32 v137, 0x3727c5ac, v137
  v_sub_f32 v144, v200, v136
  v_sub_f32 v145, v201, v136
  v_cvt_pk_bf16_f32 v137, 0, v137
  v_sub_f32 v146, v202, v136
  v_sub_f32 v147, v203, v136
  v_sqrt_f32 v137, v137
  v_cvt_pk_bf16_f32 v140, 0, v140
  v_cvt_pk_bf16_f32 v141, 0, v141
  v_cvt_pk_bf16_f32 v137, 0, v137
  v_cvt_pk_bf16_f32 v142, 0, v142
  v_cvt_pk_bf16_f32 v143, 0, v143
  v_rcp_f32 v137, v137
  v_cvt_pk_bf16_f32 v144, 0, v144
  v_cvt_pk_bf16_f32 v145, 0, v145
  v_cvt_pk_bf16_f32 v146, 0, v146
  v_cvt_pk_bf16_f32 v147, 0, v147
  v_mul_f32 v140, v140, v137
  v_mul_f32 v141, v141, v137
  v_mul_f32 v142, v142, v137
  v_mul_f32 v143, v143, v137
  v_mul_f32 v144, v144, v137
  v_mul_f32 v145, v145, v137
  v_mul_f32 v146, v146, v137
  v_mul_f32 v147, v147, v137
  v_cvt_pk_bf16_f32 v132, v140, v141
  v_cvt_pk_bf16_f32 v133, v142, v143
  v_cvt_pk_bf16_f32 v134, v144, v145
  v_cvt_pk_bf16_f32 v135, v146, v147
  buffer_store_dwordx4 v[132:135], v0, s[4:7], s93 offen sc1
  v_cvt_pk_bf16_f32 v188, 0, v188
  v_ashrrev_i32 v189, 31, v188
  v_or_b32 v189, 0x80000000, v189
  v_xor_b32 v188, v188, v189
  s_sub_u32 s92, 4095, s90
  v_and_b32 v188, 0xffff0000, v188
  v_or_b32 v38, s92, v188
  s_bfe_u32 s92, s65, 196625
  s_lshl_b32 s92, s92, 18
  s_lshl_b32 s93, s90, 7
  s_add_u32 s92, s92, s93
  s_add_u32 s84, s92, 243269632
  s_waitcnt vmcnt(0)
  s_mov_b64 exec, 1
  buffer_store_dword v38, off, s[4:7], s84 sc1
  s_mov_b64 exec, -1
  s_mov_b32 s84, 268435456
  s_branch o_fd_119
o_rt_123:
  s_mov_b32 s67, 0
o_rl_125:
  s_lshl_b32 s94, s43, 14
  s_add_u32 s94, s94, s86
  buffer_load_dwordx4 v[120:123], v5, s[4:7], s94 offen offset:0 sc1
  buffer_load_dwordx4 v[124:127], v5, s[4:7], s94 offen offset:512 sc1
  buffer_load_dwordx4 v[128:131], v5, s[4:7], s94 offen offset:256 sc1
  buffer_load_dwordx4 v[132:135], v5, s[4:7], s94 offen offset:768 sc1
  s_add_u32 s94, s94, 4096
  buffer_load_dwordx4 v[136:139], v5, s[4:7], s94 offen offset:0 sc1
  buffer_load_dwordx4 v[140:143], v5, s[4:7], s94 offen offset:512 sc1
  buffer_load_dwordx4 v[144:147], v5, s[4:7], s94 offen offset:256 sc1
  buffer_load_dwordx4 v[148:151], v5, s[4:7], s94 offen offset:768 sc1
  s_add_u32 s94, s94, 4096
  buffer_load_dwordx4 v[152:155], v5, s[4:7], s94 offen offset:0 sc1
  buffer_load_dwordx4 v[156:159], v5, s[4:7], s94 offen offset:512 sc1
  buffer_load_dwordx4 v[160:163], v5, s[4:7], s94 offen offset:256 sc1
  buffer_load_dwordx4 v[164:167], v5, s[4:7], s94 offen offset:768 sc1
  s_add_u32 s94, s94, 4096
  buffer_load_dwordx4 v[168:171], v5, s[4:7], s94 offen offset:0 sc1
  buffer_load_dwordx4 v[172:175], v5, s[4:7], s94 offen offset:512 sc1
  buffer_load_dwordx4 v[176:179], v5, s[4:7], s94 offen offset:256 sc1
  buffer_load_dwordx4 v[180:183], v5, s[4:7], s94 offen offset:768 sc1
  s_add_u32 s67, s67, 1
  s_cmp_gt_u32 s67, 1048576
  s_cbranch_scc1 L_end
  s_waitcnt vmcnt(0)
  v_xor_b32 v7, s96, v120
  v_bitop3_b32 v7, v7, v124, s96 bitop3:0xf6
  v_bitop3_b32 v7, v7, v128, s96 bitop3:0xf6
  v_bitop3_b32 v7, v7, v132, s96 bitop3:0xf6
  v_bitop3_b32 v7, v7, v136, s96 bitop3:0xf6
  v_bitop3_b32 v7, v7, v140, s96 bitop3:0xf6
  v_bitop3_b32 v7, v7, v144, s96 bitop3:0xf6
  v_bitop3_b32 v7, v7, v148, s96 bitop3:0xf6
  v_bitop3_b32 v7, v7, v152, s96 bitop3:0xf6
  v_bitop3_b32 v7, v7, v156, s96 bitop3:0xf6
  v_bitop3_b32 v7, v7, v160, s96 bitop3:0xf6
  v_bitop3_b32 v7, v7, v164, s96 bitop3:0xf6
  v_bitop3_b32 v7, v7, v168, s96 bitop3:0xf6
  v_bitop3_b32 v7, v7, v172, s96 bitop3:0xf6
  v_bitop3_b32 v7, v7, v176, s96 bitop3:0xf6
  v_bitop3_b32 v7, v7, v180, s96 bitop3:0xf6
  v_and_b32 v7, v254, v7
  v_cmp_ne_u32 vcc, 0, v7
  s_cbranch_vccnz o_rl_125
  s_branch o_bk_124
o_f2_120:
  s_lshl_b32 s94, s43, 14
  s_add_u32 s94, s94, s86
  buffer_load_dwordx4 v[120:123], v5, s[4:7], s94 offen offset:0 sc1
  buffer_load_dwordx4 v[124:127], v5, s[4:7], s94 offen offset:512 sc1
  buffer_load_dwordx4 v[128:131], v5, s[4:7], s94 offen offset:256 sc1
  buffer_load_dwordx4 v[132:135], v5, s[4:7], s94 offen offset:768 sc1
  s_add_u32 s94, s94, 4096
  buffer_load_dwordx4 v[136:139], v5, s[4:7], s94 offen offset:0 sc1
  buffer_load_dwordx4 v[140:143], v5, s[4:7], s94 offen offset:512 sc1
  buffer_load_dwordx4 v[144:147], v5, s[4:7], s94 offen offset:256 sc1
  buffer_load_dwordx4 v[148:151], v5, s[4:7], s94 offen offset:768 sc1
  s_add_u32 s94, s94, 4096
  buffer_load_dwordx4 v[152:155], v5, s[4:7], s94 offen offset:0 sc1
  buffer_load_dwordx4 v[156:159], v5, s[4:7], s94 offen offset:512 sc1
  buffer_load_dwordx4 v[160:163], v5, s[4:7], s94 offen offset:256 sc1
  buffer_load_dwordx4 v[164:167], v5, s[4:7], s94 offen offset:768 sc1
  s_add_u32 s94, s94, 4096
  buffer_load_dwordx4 v[168:171], v5, s[4:7], s94 offen offset:0 sc1
  buffer_load_dwordx4 v[172:175], v5, s[4:7], s94 offen offset:512 sc1
  buffer_load_dwordx4 v[176:179], v5, s[4:7], s94 offen offset:256 sc1
  buffer_load_dwordx4 v[180:183], v5, s[4:7], s94 offen offset:768 sc1
  v_mov_b64 v[188:189], 0
  v_mov_b64 v[190:191], 0
  v_mov_b64 v[192:193], 0
  v_mov_b64 v[194:195], 0
  s_waitcnt vmcnt(12)
  v_xor_b32 v7, s96, v120
  v_bitop3_b32 v7, v7, v124, s96 bitop3:0xf6
  v_bitop3_b32 v7, v7, v128, s96 bitop3:0xf6
  v_bitop3_b32 v7, v7, v132, s96 bitop3:0xf6
  s_waitcnt vmcnt(8)
  v_bitop3_b32 v7, v7, v136, s96 bitop3:0xf6
  v_bitop3_b32 v7, v7, v140, s96 bitop3:0xf6
  v_bitop3_b32 v7, v7, v144, s96 bitop3:0xf6
  v_bitop3_b32 v7, v7, v148, s96 bitop3:0xf6
  s_waitcnt vmcnt(4)
  v_bitop3_b32 v7, v7, v152, s96 bitop3:0xf6
  v_bitop3_b32 v7, v7, v156, s96 bitop3:0xf6
  v_bitop3_b32 v7, v7, v160, s96 bitop3:0xf6
  v_bitop3_b32 v7, v7, v164, s96 bitop3:0xf6
  s_waitcnt vmcnt(0)
  v_bitop3_b32 v7, v7, v168, s96 bitop3:0xf6
  v_bitop3_b32 v7, v7, v172, s96 bitop3:0xf6
  v_bitop3_b32 v7, v7, v176, s96 bitop3:0xf6
  v_bitop3_b32 v7, v7, v180, s96 bitop3:0xf6
  v_and_b32 v7, v254, v7
  v_cmp_ne_u32 vcc, 0, v7
  s_cbranch_vccnz o_rt_126
o_bk_127:
  v_smfmac_f32_16x16x64_bf16 v[188:191], v[16:19], v[120:127], v20
  v_lshlrev_b32 v196, 16, v184
  v_smfmac_f32_16x16x64_bf16 v[192:195], v[16:19], v[128:135], v20
  v_and_b32 v197, 0xffff0000, v184
  v_smfmac_f32_16x16x64_bf16 v[188:191], v[16:19], v[136:143], v20
  v_lshlrev_b32 v198, 16, v185
  v_smfmac_f32_16x16x64_bf16 v[192:195], v[16:19], v[144:151], v20
  v_and_b32 v199, 0xffff0000, v185
  v_smfmac_f32_16x16x64_bf16 v[188:191], v[16:19], v[152:159], v20
  v_lshlrev_b32 v200, 16, v186
  v_smfmac_f32_16x16x64_bf16 v[192:195], v[16:19], v[160:167], v20
  v_and_b32 v201, 0xffff0000, v186
  v_smfmac_f32_16x16x64_bf16 v[188:191], v[16:19], v[168:175], v20
  v_lshlrev_b32 v202, 16, v187
  v_smfmac_f32_16x16x64_bf16 v[192:195], v[16:19], v[176:183], v20
  v_and_b32 v203, 0xffff0000, v187
  s_bfe_u32 s92, s65, 131086
  s_lshl_b32 s92, s92, 21
  s_add_u32 s92, s92, s91
  s_add_u32 s93, s92, 27262976
  s_add_u32 s92, s92, 20971520
  s_nop 1
  v_permlane16_swap_b32 v188, v192
  v_permlane16_swap_b32 v189, v193
  v_permlane16_swap_b32 v190, v194
  v_permlane16_swap_b32 v191, v195
  v_cvt_pk_bf16_f32 v188, 0, v188
  v_cvt_pk_bf16_f32 v189, 0, v189
  v_cvt_pk_bf16_f32 v190, 0, v190
  v_cvt_pk_bf16_f32 v191, 0, v191
  v_cvt_pk_bf16_f32 v192, 0, v192
  v_cvt_pk_bf16_f32 v193, 0, v193
  v_cvt_pk_bf16_f32 v194, 0, v194
  v_cvt_pk_bf16_f32 v195, 0, v195
  v_add_f32 v196, v196, v188
  v_add_f32 v197, v197, v189
  v_add_f32 v198, v198, v190
  v_add_f32 v199, v199, v191
  v_add_f32 v200, v200, v192
  v_add_f32 v201, v201, v193
  v_add_f32 v202, v202, v194
  v_add_f32 v203, v203, v195
  v_cvt_pk_bf16_f32 v120, v196, v197
  v_cvt_pk_bf16_f32 v121, v198, v199
  v_cvt_pk_bf16_f32 v122, v200, v201
  v_cvt_pk_bf16_f32 v123, v202, v203
  v_lshlrev_b32 v196, 16, v120
  v_and_b32 v197, 0xffff0000, v120
  v_lshlrev_b32 v198, 16, v121
  v_and_b32 v199, 0xffff0000, v121
  v_lshlrev_b32 v200, 16, v122
  v_and_b32 v201, 0xffff0000, v122
  v_lshlrev_b32 v202, 16, v123
  v_and_b32 v203, 0xffff0000, v123
  buffer_store_dwordx4 v[120:123], v0, s[4:7], s92 offen sc1
  v_add_f32 v136, v196, v197
  v_mul_f32 v137, v196, v196
  v_add_f32 v138, v198, v199
  v_mul_f32 v139, v197, v197
  v_fmac_f32 v137, v198, v198
  v_fmac_f32 v139, v199, v199
  v_add_f32 v136, v136, v200
  v_fmac_f32 v137, v200, v200
  v_add_f32 v138, v138, v201
  v_fmac_f32 v139, v201, v201
  v_add_f32 v136, v136, v202
  v_fmac_f32 v137, v202, v202
  v_add_f32 v138, v138, v203
  v_fmac_f32 v139, v203, v203
  v_add_f32 v136, v136, v138
  v_add_f32 v137, v137, v139
  s_nop 0
  v_add_f32_dpp v136, v136, v136 row_ror:8 row_mask:0xf bank_mask:0xf
  v_add_f32_dpp v137, v137, v137 row_ror:8 row_mask:0xf bank_mask:0xf
  s_nop 0
  v_add_f32_dpp v136, v136, v136 row_ror:4 row_mask:0xf bank_mask:0xf
  v_add_f32_dpp v137, v137, v137 row_ror:4 row_mask:0xf bank_mask:0xf
  s_nop 0
  v_add_f32_dpp v136, v136, v136 row_ror:2 row_mask:0xf bank_mask:0xf
  v_add_f32_dpp v137, v137, v137 row_ror:2 row_mask:0xf bank_mask:0xf
  s_nop 0
  v_add_f32_dpp v136, v136, v136 row_ror:1 row_mask:0xf bank_mask:0xf
  v_add_f32_dpp v137, v137, v137 row_ror:1 row_mask:0xf bank_mask:0xf
  v_mov_b32 v140, v136
  v_mov_b32 v141, v137
  s_nop 0
  v_permlane16_swap_b32 v136, v140
  v_permlane16_swap_b32 v137, v141
  v_add_f32 v136, v136, v140
  v_add_f32 v137, v137, v141
  v_mov_b32 v140, v136
  v_mov_b32 v141, v137
  s_nop 0
  v_permlane32_swap_b32 v136, v140
  v_permlane32_swap_b32 v137, v141
  v_add_f32 v136, v136, v140
  v_add_f32 v137, v137, v141
  v_mul_f32 v136, 0x3b000000, v136
  v_mul_f32 v137, 0x3b000000, v137
  v_fma_f32 v137, -v136, v136, v137
  v_cvt_pk_bf16_f32 v136, 0, v136
  v_max_f32 v137, 0, v137
  v_sub_f32 v140, v196, v136
  v_sub_f32 v141, v197, v136
  v_cvt_pk_bf16_f32 v137, 0, v137
  v_sub_f32 v142, v198, v136
  v_sub_f32 v143, v199, v136
  v_add_f32 v137, 0x3727c5ac, v137
  v_sub_f32 v144, v200, v136
  v_sub_f32 v145, v201, v136
  v_cvt_pk_bf16_f32 v137, 0, v137
  v_sub_f32 v146, v202, v136
  v_sub_f32 v147, v203, v136
  v_sqrt_f32 v137, v137
  v_cvt_pk_bf16_f32 v140, 0, v140
  v_cvt_pk_bf16_f32 v141, 0, v141
  v_cvt_pk_bf16_f32 v137, 0, v137
  v_cvt_pk_bf16_f32 v142, 0, v142
  v_cvt_pk_bf16_f32 v143, 0, v143
  v_rcp_f32 v137, v137
  v_cvt_pk_bf16_f32 v144, 0, v144
  v_cvt_pk_bf16_f32 v145, 0, v145
  v_cvt_pk_bf16_f32 v146, 0, v146
  v_cvt_pk_bf16_f32 v147, 0, v147
  v_mul_f32 v140, v140, v137
  v_mul_f32 v141, v141, v137
  v_mul_f32 v142, v142, v137
  v_mul_f32 v143, v143, v137
  v_mul_f32 v144, v144, v137
  v_mul_f32 v145, v145, v137
  v_mul_f32 v146, v146, v137
  v_mul_f32 v147, v147, v137
  v_cvt_pk_bf16_f32 v124, v140, v141
  v_cvt_pk_bf16_f32 v125, v142, v143
  v_cvt_pk_bf16_f32 v126, v144, v145
  v_cvt_pk_bf16_f32 v127, v146, v147
  v_lshlrev_b32 v204, 16, v124
  v_and_b32 v205, 0xffff0000, v124
  v_lshlrev_b32 v206, 16, v125
  v_and_b32 v207, 0xffff0000, v125
  v_lshlrev_b32 v208, 16, v126
  v_and_b32 v209, 0xffff0000, v126
  v_lshlrev_b32 v210, 16, v127
  v_and_b32 v211, 0xffff0000, v127
  buffer_store_dwordx4 v[124:127], v0, s[4:7], s93 offen sc1
  v_add_f32 v196, v196, v204
  v_add_f32 v197, v197, v205
  v_add_f32 v198, v198, v206
  v_add_f32 v199, v199, v207
  v_add_f32 v200, v200, v208
  v_add_f32 v201, v201, v209
  v_add_f32 v202, v202, v210
  v_add_f32 v203, v203, v211
  v_cvt_pk_bf16_f32 v128, v196, v197
  v_cvt_pk_bf16_f32 v129, v198, v199
  v_cvt_pk_bf16_f32 v130, v200, v201
  v_cvt_pk_bf16_f32 v131, v202, v203
  v_mul_f32 v188, v204, v8
  v_mul_f32 v189, v205, v9
  v_fmac_f32 v188, v206, v10
  v_fmac_f32 v189, v207, v11
  v_fmac_f32 v188, v208, v12
  v_fmac_f32 v189, v209, v13
  v_fmac_f32 v188, v210, v14
  v_fmac_f32 v189, v211, v15
  v_add_f32 v188, v188, v189
  buffer_store_dwordx4 v[128:131], v0, s[68:71], s91 offen sc1
  s_nop 0
  v_add_f32_dpp v188, v188, v188 row_ror:8 row_mask:0xf bank_mask:0xf
  s_nop 1
  v_add_f32_dpp v188, v188, v188 row_ror:4 row_mask:0xf bank_mask:0xf
  s_nop 1
  v_add_f32_dpp v188, v188, v188 row_ror:2 row_mask:0xf bank_mask:0xf
  s_nop 1
  v_add_f32_dpp v188, v188, v188 row_ror:1 row_mask:0xf bank_mask:0xf
  v_mov_b32 v189, v188
  s_nop 0
  s_nop 0
  v_permlane16_swap_b32 v188, v189
  v_add_f32 v188, v188, v189
  v_mov_b32 v189, v188
  s_nop 0
  s_nop 0
  v_permlane32_swap_b32 v188, v189
  v_add_f32 v188, v188, v189
  v_cvt_pk_bf16_f32 v188, 0, v188
  v_ashrrev_i32 v189, 31, v188
  v_or_b32 v189, 0x80000000, v189
  v_xor_b32 v188, v188, v189
  s_sub_u32 s92, 4095, s90
  v_and_b32 v188, 0xffff0000, v188
  v_or_b32 v38, s92, v188
  s_bfe_u32 s92, s65, 196625
  s_lshl_b32 s92, s92, 18
  s_lshl_b32 s93, s90, 7
  s_add_u32 s92, s92, s93
  s_add_u32 s84, s92, 243269632
  s_waitcnt vmcnt(0)
  s_mov_b64 exec, 1
  buffer_store_dword v38, off, s[4:7], s84 sc1
  s_mov_b64 exec, -1
  s_mov_b32 s84, 268435456
  s_branch o_fd_119
o_rt_126:
  s_mov_b32 s67, 0
o_rl_128:
  s_lshl_b32 s94, s43, 14
  s_add_u32 s94, s94, s86
  buffer_load_dwordx4 v[120:123], v5, s[4:7], s94 offen offset:0 sc1
  buffer_load_dwordx4 v[124:127], v5, s[4:7], s94 offen offset:512 sc1
  buffer_load_dwordx4 v[128:131], v5, s[4:7], s94 offen offset:256 sc1
  buffer_load_dwordx4 v[132:135], v5, s[4:7], s94 offen offset:768 sc1
  s_add_u32 s94, s94, 4096
  buffer_load_dwordx4 v[136:139], v5, s[4:7], s94 offen offset:0 sc1
  buffer_load_dwordx4 v[140:143], v5, s[4:7], s94 offen offset:512 sc1
  buffer_load_dwordx4 v[144:147], v5, s[4:7], s94 offen offset:256 sc1
  buffer_load_dwordx4 v[148:151], v5, s[4:7], s94 offen offset:768 sc1
  s_add_u32 s94, s94, 4096
  buffer_load_dwordx4 v[152:155], v5, s[4:7], s94 offen offset:0 sc1
  buffer_load_dwordx4 v[156:159], v5, s[4:7], s94 offen offset:512 sc1
  buffer_load_dwordx4 v[160:163], v5, s[4:7], s94 offen offset:256 sc1
  buffer_load_dwordx4 v[164:167], v5, s[4:7], s94 offen offset:768 sc1
  s_add_u32 s94, s94, 4096
  buffer_load_dwordx4 v[168:171], v5, s[4:7], s94 offen offset:0 sc1
  buffer_load_dwordx4 v[172:175], v5, s[4:7], s94 offen offset:512 sc1
  buffer_load_dwordx4 v[176:179], v5, s[4:7], s94 offen offset:256 sc1
  buffer_load_dwordx4 v[180:183], v5, s[4:7], s94 offen offset:768 sc1
  s_add_u32 s67, s67, 1
  s_cmp_gt_u32 s67, 1048576
  s_cbranch_scc1 L_end
  s_waitcnt vmcnt(0)
  v_xor_b32 v7, s96, v120
  v_bitop3_b32 v7, v7, v124, s96 bitop3:0xf6
  v_bitop3_b32 v7, v7, v128, s96 bitop3:0xf6
  v_bitop3_b32 v7, v7, v132, s96 bitop3:0xf6
  v_bitop3_b32 v7, v7, v136, s96 bitop3:0xf6
  v_bitop3_b32 v7, v7, v140, s96 bitop3:0xf6
  v_bitop3_b32 v7, v7, v144, s96 bitop3:0xf6
  v_bitop3_b32 v7, v7, v148, s96 bitop3:0xf6
  v_bitop3_b32 v7, v7, v152, s96 bitop3:0xf6
  v_bitop3_b32 v7, v7, v156, s96 bitop3:0xf6
  v_bitop3_b32 v7, v7, v160, s96 bitop3:0xf6
  v_bitop3_b32 v7, v7, v164, s96 bitop3:0xf6
  v_bitop3_b32 v7, v7, v168, s96 bitop3:0xf6
  v_bitop3_b32 v7, v7, v172, s96 bitop3:0xf6
  v_bitop3_b32 v7, v7, v176, s96 bitop3:0xf6
  v_bitop3_b32 v7, v7, v180, s96 bitop3:0xf6
  v_and_b32 v7, v254, v7
  v_cmp_ne_u32 vcc, 0, v7
  s_cbranch_vccnz o_rl_128
  s_branch o_bk_127
o_fd_119:
  s_mov_b32 s65, 0
o_nofl_83:
  s_mov_b32 s63, s64
  s_cmp_lg_u32 s51, 0
  s_cbranch_scc1 o_pick_85
  s_cmp_eq_u32 s50, 0
  s_cbranch_scc1 L_end
o_adv_91:
  s_add_u32 s49, s49, 4
  s_branch o_round_81
L_o_x:
  s_mov_b32 s62, 1
  s_mov_b32 s42, 0
  s_mov_b32 s3, 0
  s_mov_b32 s46, 0
  s_mov_b32 s65, 0
  s_mov_b32 s66, 0
  s_mov_b32 s76, 0
  s_mov_b32 s55, 0
  s_mov_b32 s56, 0
  s_mov_b32 s84, 268435456
  s_mov_b32 s86, s41
  s_mov_b32 s49, s60
  s_mul_i32 s63, s49, 257
  s_or_b32 s63, s63, 1179648
o_round_129:
  s_max_u32 s46, s46, s3
  s_cmp_lg_u32 s3, 0
  s_mov_b32 s3, 0
  s_cbranch_scc1 d_g_141
  s_mov_b32 s67, 0
d_w_140:
  s_min_u32 s26, s49, 71
  s_lshl_b32 s26, s26, 12
  s_add_u32 s27, s26, 243494912
  s_add_u32 s26, s26, 243486720
  buffer_load_dword v248, v246, s[4:7], s26 offen sc1
  buffer_load_dword v249, v246, s[4:7], s27 offen sc1
  s_add_u32 s67, s67, 1
  s_cmp_gt_u32 s67, 1048576
  s_cbranch_scc1 L_end
  s_waitcnt vmcnt(0)
  s_mov_b64 exec, 1
  buffer_store_dword v38, off, s[4:7], s84 sc1
  s_mov_b64 exec, -1
  s_mov_b32 s84, 268435456
  v_min_u32 v162, v248, v249
  v_max_u32 v163, v248, v249
  v_cmp_eq_u32 vcc, 0, v162
  s_cbranch_vccnz d_w_140
  v_max_u32_dpp v163, v163, v163 row_ror:8 row_mask:0xf bank_mask:0xf
  s_nop 1
  v_max_u32_dpp v163, v163, v163 row_ror:4 row_mask:0xf bank_mask:0xf
  s_nop 1
  v_max_u32_dpp v163, v163, v163 row_ror:2 row_mask:0xf bank_mask:0xf
  s_nop 1
  v_max_u32_dpp v163, v163, v163 row_ror:1 row_mask:0xf bank_mask:0xf
  s_nop 0
  v_readlane_b32 s28, v163, 0
  v_readlane_b32 s29, v163, 16
  v_readlane_b32 s30, v163, 32
  v_readlane_b32 s31, v163, 48
  s_max_u32 s28, s28, s29
  s_max_u32 s30, s30, s31
  s_max_u32 s46, s46, s28
  s_max_u32 s46, s46, s30
d_g_141:
  s_lshr_b32 s27, s49, 2
  s_andn2_b32 s52, 0xfff, s46
  s_lshr_b32 s52, s52, 5
  s_min_u32 s52, s52, 64
  s_add_u32 s26, s52, 3
  v_readlane_b32 s89, v247, s27
  s_sub_u32 s26, s26, s60
  s_lshr_b32 s26, s26, 2
  s_bfm_b32 s54, s26, 0
  s_add_u32 s53, s63, 1028
  s_cmp_lt_u32 s49, 60
  s_cselect_b32 s53, s53, 0
  s_cmp_lt_u32 s49, 64
  s_cselect_b32 s26, 3, 1
  s_sub_i32 s26, s27, s26
  s_max_i32 s26, s26, 0
  s_min_u32 s26, s26, 16
  s_bfm_b32 s58, s26, 0
  s_cmp_eq_u32 s27, 16
  s_cselect_b32 s59, 2, 1
  s_cmp_eq_u32 s27, 18
  s_cselect_b32 s59, 64, s59
  s_cselect_b32 s50, 0, -1
  s_cselect_b32 s89, 0, s89
o_pick_133:
  s_cmp_eq_u32 s59, 0
  s_cbranch_scc1 o_none_137
  s_sub_u32 s59, s59, 1
  s_andn2_b32 s26, s58, s55
  s_and_b32 s26, s26, s54
  s_cbranch_scc1 o_ga_134
  s_and_b32 s26, s55, s50
  s_or_b32 s26, s26, s56
  s_or_b32 s26, s26, s54
  s_andn2_b32 s26, s58, s26
  s_cbranch_scc0 o_none_137
  s_cmp_ge_u32 s46, s89
  s_cbranch_scc1 o_gb_135
o_ga_134:
  s_ff1_i32_b32 s26, s26
  s_bitset1_b32 s55, s26
  s_mov_b32 s64, 1327168
  s_branch o_gd_136
o_none_137:
  s_cmp_lt_u32 s49, 60
  s_cbranch_scc1 o_nn_138
  s_cmp_eq_u32 s50, 0
  s_cbranch_scc1 o_nn_138
  s_and_b32 s26, s63, 1097728
  s_cmp_eq_u32 s26, 1048576
  s_cbranch_scc1 o_nn_138
  s_cmp_lt_u32 s49, 64
  s_cbranch_scc1 o_adv_139
  s_and_b32 s26, s65, 1097728
  s_cmp_lg_u32 s26, 1048576
  s_cbranch_scc1 o_adv_139
o_nn_138:
  s_mov_b32 s64, s53
  s_mov_b32 s51, 0
  s_branch o_task_130
o_gb_135:
  s_ff1_i32_b32 s26, s26
  s_bitset1_b32 s56, s26
  s_andn2_b32 s27, 31, s46
  s_or_b32 s27, s27, 32
  s_lshl_b32 s27, s27, 22
  s_or_b32 s27, s27, 1474688
  s_lshl_b32 s28, s26, 2
  s_add_u32 s28, s28, s60
  s_cmp_eq_u32 s28, s52
  s_cselect_b32 s64, s27, 1474624
o_gd_136:
  s_lshl_b32 s26, s26, 2
  s_add_u32 s26, s26, s60
  s_mul_i32 s26, s26, 257
  s_or_b32 s64, s64, s26
  s_mov_b32 s51, 1
o_task_130:
  s_cmp_eq_u32 s63, 0
  s_cbranch_scc1 o_nofl_131
  s_cmp_lg_u32 s66, 0
  s_cbranch_scc1 o_have_143
  s_mov_b32 s67, 0
o_w1_142:
  s_and_b32 s32, s63, 0xff
  s_lshl_b32 s32, s32, 12
  s_add_u32 s32, s32, s14
  buffer_load_dword v37, v36, s[4:7], s32 offen sc1
  s_add_u32 s67, s67, 1
  s_cmp_gt_u32 s67, 1048576
  s_cbranch_scc1 L_end
  s_waitcnt vmcnt(0)
  s_mov_b64 exec, 1
  buffer_store_dword v38, off, s[4:7], s84 sc1
  s_mov_b64 exec, -1
  s_mov_b32 s84, 268435456
  v_cmp_eq_u32 vcc, 0, v37
  s_cbranch_vccnz o_w1_142
  s_and_b32 s87, s63, 0xff
  s_lshl_b32 s33, s87, 18
  s_lshl_b32 s32, s87, 19
  s_add_u32 m0, s22, 0
  s_add_u32 s33, s33, s19
  buffer_load_dwordx4 v0, s[4:7], s33 offen offset:0 sc1 lds
  buffer_load_dwordx4 v0, s[4:7], s33 offen offset:1024 sc1 lds
  buffer_load_dwordx4 v0, s[4:7], s33 offen offset:2048 sc1 lds
  buffer_load_dwordx4 v0, s[4:7], s33 offen offset:3072 sc1 lds
  s_add_u32 m0, s23, 0
  s_add_u32 s32, s32, s18
  buffer_load_dwordx4 v0, s[4:7], s32 offen offset:0 sc1 lds
  buffer_load_dwordx4 v0, s[4:7], s32 offen offset:1024 sc1 lds
  buffer_load_dwordx4 v0, s[4:7], s32 offen offset:2048 sc1 lds
  buffer_load_dwordx4 v0, s[4:7], s32 offen offset:3072 sc1 lds
  s_add_u32 m0, m0, 4096
  s_add_u32 s32, s32, 4096
  buffer_load_dwordx4 v0, s[4:7], s32 offen offset:0 sc1 lds
  buffer_load_dwordx4 v0, s[4:7], s32 offen offset:1024 sc1 lds
  buffer_load_dwordx4 v0, s[4:7], s32 offen offset:2048 sc1 lds
  buffer_load_dwordx4 v0, s[4:7], s32 offen offset:3072 sc1 lds
  s_waitcnt vmcnt(0)
  s_barrier
o_have_143:
  ds_read_b128 v[120:123], v33 offset:0
  ds_read_b128 v[40:43], v32 offset:0
  ds_read_b128 v[56:59], v32 offset:1024
  ds_read_b128 v[124:127], v33 offset:2048
  ds_read_b128 v[44:47], v32 offset:4096
  ds_read_b128 v[60:63], v32 offset:5120
  ds_read_b128 v[128:131], v33 offset:4096
  ds_read_b128 v[48:51], v32 offset:8192
  ds_read_b128 v[64:67], v32 offset:9216
  ds_read_b128 v[132:135], v33 offset:6144
  ds_read_b128 v[52:55], v32 offset:12288
  ds_read_b128 v[68:71], v32 offset:13312
  s_cmp_lt_u32 s17, 2
  s_cselect_b32 s65, s65, 0
  s_cmp_lg_u32 s65, 0
  s_cselect_b64 s[44:45], -1, 0
  s_mov_b32 s95, s86
  s_mov_b32 s96, s42
  s_lshl_b32 s97, s43, 14
  s_add_u32 s97, s97, s95
  s_and_b32 s87, s64, 0xff
  s_lshl_b32 s87, s87, 12
  s_add_u32 s87, s87, s14
  s_and_b32 s88, s63, 0xff00
  s_lshl_b32 s88, s88, 3
  s_add_u32 s88, s88, s15
  s_and_b32 s91, s65, 63
  s_lshl_b32 s90, s91, 5
  s_add_u32 s94, s90, s85
  s_add_u32 s90, s90, s43
  s_lshl_b32 s94, s94, 10
  s_lshr_b32 s92, s65, 22
  s_xor_b32 s93, s43, 32
  s_lshl_b32 s91, s90, 10
  s_add_u32 s94, s94, 25165824
  s_cmp_eq_u32 s92, s93
  s_cselect_b32 s92, s94, s91
  s_add_u32 s92, s92, 10485760
  s_and_b32 s93, s65, 49152
  s_cselect_b32 s92, s92, s91
  s_cselect_b64 s[80:81], s[4:5], s[72:73]
  s_cselect_b32 s82, s6, s74
  s_waitcnt lgkmcnt(9)
  v_mfma_f32_16x16x32_bf16 v[104:107], v[40:43], v[120:123], v[24:27]
  v_mfma_f32_16x16x32_bf16 v[108:111], v[56:59], v[120:123], v[28:31]
  s_mov_b64 exec, s[44:45]
  buffer_load_dword v7, v255, s[4:7], s97 offen sc1
  buffer_load_dwordx4 v[184:187], v0, s[80:83], s92 offen sc1
  s_not_b64 exec, exec
  buffer_load_dword v37, v36, s[4:7], s87 offen sc1
  s_mov_b64 exec, -1
  buffer_load_dword v244, v252, s[4:7], s88 offen sc1
  s_waitcnt lgkmcnt(6)
  v_mfma_f32_16x16x32_bf16 v[104:107], v[44:47], v[124:127], v[104:107]
  v_mfma_f32_16x16x32_bf16 v[108:111], v[60:63], v[124:127], v[108:111]
  s_waitcnt lgkmcnt(3)
  v_mfma_f32_16x16x32_bf16 v[104:107], v[48:51], v[128:131], v[104:107]
  v_mfma_f32_16x16x32_bf16 v[108:111], v[64:67], v[128:131], v[108:111]
  s_waitcnt lgkmcnt(0)
  v_mfma_f32_16x16x32_bf16 v[104:107], v[52:55], v[132:135], v[104:107]
  v_mfma_f32_16x16x32_bf16 v[108:111], v[68:71], v[132:135], v[108:111]
  s_cmp_lg_u32 s76, 0
  s_cbranch_scc1 o_klds_146
  v_mov_b32 v196, 0
  v_mov_b32 v199, 0
  v_exp_f32 v56, v104
  v_exp_f32 v57, v105
  v_exp_f32 v58, v106
  v_exp_f32 v59, v107
  v_exp_f32 v60, v108
  v_exp_f32 v61, v109
  v_exp_f32 v62, v110
  v_exp_f32 v63, v111
  v_max3_f32 v116, v104, v105, v106
  v_max3_f32 v116, v107, v108, v116
  v_max3_f32 v116, v109, v110, v116
  v_add_f32 v117, v56, v57
  v_add_f32 v118, v58, v59
  v_add_f32 v117, v117, v60
  v_add_f32 v118, v118, v61
  v_add_f32 v117, v117, v62
  v_add_f32 v118, v118, v63
  s_mov_b32 s67, 0
  s_and_b32 s32, s63, 0xff00
  s_lshl_b32 s32, s32, 10
  s_add_u32 s32, s32, s20
  s_add_u32 s33, s32, 4096
o_w2_144:
  s_waitcnt vmcnt(0)
  v_cmp_eq_u32 vcc, 0, v244
  s_cbranch_vccz o_kgo_154
  s_mov_b64 exec, 1
  buffer_store_dword v38, off, s[4:7], s84 sc1
  s_mov_b64 exec, -1
  s_mov_b32 s84, 268435456
  buffer_load_dword v244, v252, s[4:7], s88 offen sc1
  s_add_u32 s67, s67, 1
  s_cmp_gt_u32 s67, 1048576
  s_cbranch_scc1 L_end
  s_branch o_w2_144
o_kgo_154:
  buffer_load_dwordx4 v[136:139], v0, s[4:7], s32 offen offset:0 sc1
  buffer_load_dwordx4 v[140:143], v0, s[4:7], s32 offen offset:1024 sc1
  buffer_load_dwordx4 v[144:147], v0, s[4:7], s32 offen offset:2048 sc1
  buffer_load_dwordx4 v[148:151], v0, s[4:7], s32 offen offset:3072 sc1
  buffer_load_dwordx2 v[200:201], v1, s[4:7], s33 offen offset:0 sc1
  buffer_load_dwordx2 v[202:203], v1, s[4:7], s33 offen offset:512 sc1
  buffer_load_dwordx2 v[204:205], v1, s[4:7], s33 offen offset:1024 sc1
  buffer_load_dwordx2 v[206:207], v1, s[4:7], s33 offen offset:1536 sc1
  buffer_load_dword v37, v36, s[4:7], s87 offen sc1
  buffer_load_dword v244, v252, s[4:7], s88 offen sc1
  s_barrier
  ds_read_b128 v[152:155], v32 offset:2048
  ds_read_b128 v[156:159], v32 offset:3072
  ds_read_b128 v[160:163], v32 offset:6144
  ds_read_b128 v[164:167], v32 offset:7168
  ds_read_b128 v[168:171], v32 offset:10240
  ds_read_b128 v[172:175], v32 offset:11264
  ds_read_b128 v[176:179], v32 offset:14336
  ds_read_b128 v[180:183], v32 offset:15360
  s_waitcnt vmcnt(9)
  v_mfma_f32_16x16x32_bf16 v[112:115], v[136:139], v[120:123], 0
  s_waitcnt vmcnt(8)
  v_mfma_f32_16x16x32_bf16 v[112:115], v[140:143], v[124:127], v[112:115]
  s_waitcnt vmcnt(7)
  v_mfma_f32_16x16x32_bf16 v[112:115], v[144:147], v[128:131], v[112:115]
  s_waitcnt vmcnt(6)
  v_mfma_f32_16x16x32_bf16 v[112:115], v[148:151], v[132:135], v[112:115]
  s_waitcnt vmcnt(2)
  s_branch o_havek_145
o_klds_146:
  s_waitcnt vmcnt(12)
  s_barrier
  ds_read_b128 v[136:139], v34 offset:0
  ds_read_b128 v[140:143], v34 offset:1024
  ds_read_b128 v[144:147], v34 offset:2048
  ds_read_b128 v[148:151], v34 offset:3072
  ds_read_b64 v[200:201], v35 offset:4096
  ds_read_b64 v[202:203], v35 offset:4608
  ds_read_b64 v[204:205], v35 offset:5120
  ds_read_b64 v[206:207], v35 offset:5632
  v_mov_b32 v196, 0
  v_mov_b32 v199, 0
  v_exp_f32 v56, v104
  v_exp_f32 v57, v105
  v_exp_f32 v58, v106
  v_exp_f32 v59, v107
  v_exp_f32 v60, v108
  v_exp_f32 v61, v109
  v_exp_f32 v62, v110
  v_exp_f32 v63, v111
  v_max3_f32 v116, v104, v105, v106
  v_max3_f32 v116, v107, v108, v116
  v_max3_f32 v116, v109, v110, v116
  s_waitcnt lgkmcnt(4)
  v_mfma_f32_16x16x32_bf16 v[112:115], v[136:139], v[120:123], 0
  ds_read_b128 v[152:155], v32 offset:2048
  ds_read_b128 v[156:159], v32 offset:3072
  v_mfma_f32_16x16x32_bf16 v[112:115], v[140:143], v[124:127], v[112:115]
  ds_read_b128 v[160:163], v32 offset:6144
  ds_read_b128 v[164:167], v32 offset:7168
  v_mfma_f32_16x16x32_bf16 v[112:115], v[144:147], v[128:131], v[112:115]
  ds_read_b128 v[168:171], v32 offset:10240
  ds_read_b128 v[172:175], v32 offset:11264
  v_mfma_f32_16x16x32_bf16 v[112:115], v[148:151], v[132:135], v[112:115]
  ds_read_b128 v[176:179], v32 offset:14336
  ds_read_b128 v[180:183], v32 offset:15360
  v_add_f32 v117, v56, v57
  v_add_f32 v118, v58, v59
  v_add_f32 v117, v117, v60
  v_add_f32 v118, v118, v61
  v_add_f32 v117, v117, v62
  v_add_f32 v118, v118, v63
o_havek_145:
  s_cmp_lg_u32 s65, 0
  s_cbranch_scc1 o_wr1_151
  s_nop 3
  v_mul_f32 v112, s24, v112
  v_mul_f32 v113, s24, v113
  v_exp_f32 v64, v112
  v_exp_f32 v65, v113
  v_max_f32 v116, v111, v116
  v_max3_f32 v116, v112, v113, v116
  v_add_f32 v117, v117, v64
  v_add_f32 v118, v118, v65
  v_add_f32 v117, v117, v118
  s_mov_b32 s28, 0x21800000
  v_mov_b32 v118, v117
  s_nop 1
  v_permlane16_swap_b32 v117, v118
  v_add_f32 v117, v117, v118
  v_mov_b32 v118, v117
  s_nop 0
  s_nop 0
  v_permlane32_swap_b32 v117, v118
  v_add_f32 v117, v117, v118
  v_cmp_lt_f32 vcc, 0x42700000, v116
  v_cmp_gt_f32 s[30:31], s28, v117
  v_rcp_f32 v117, v117
  s_or_b64 vcc, vcc, s[30:31]
  s_cbranch_vccnz o_fb_155
o_fbr_156:
  v_pk_mul_f32 v[56:57], v[56:57], v[116:117] op_sel:[0,1] op_sel_hi:[1,1]
  v_pk_mul_f32 v[58:59], v[58:59], v[116:117] op_sel:[0,1] op_sel_hi:[1,1]
  v_pk_mul_f32 v[60:61], v[60:61], v[116:117] op_sel:[0,1] op_sel_hi:[1,1]
  v_pk_mul_f32 v[62:63], v[62:63], v[116:117] op_sel:[0,1] op_sel_hi:[1,1]
  v_pk_mul_f32 v[64:65], v[64:65], v[116:117] op_sel:[0,1] op_sel_hi:[1,1]
  v_cvt_pk_bf16_f32 v116, v56, v57
  v_cvt_pk_bf16_f32 v117, v58, v59
  v_cvt_pk_bf16_f32 v118, v60, v61
  v_cvt_pk_bf16_f32 v119, v62, v63
  s_waitcnt lgkmcnt(0)
  s_nop 0
  v_mfma_f32_16x16x32_bf16 v[72:75], v[152:155], v[116:119], 0
  s_add_u32 s62, s62, 1
  v_cvt_pk_bf16_f32 v197, v64, v65
  v_cvt_pk_bf16_f32 v198, v64, v65
  v_mfma_f32_16x16x32_bf16 v[76:79], v[156:159], v[116:119], 0
  s_xor_b32 s86, s86, 524288
  v_mfma_f32_16x16x32_bf16 v[80:83], v[160:163], v[116:119], 0
  s_bfe_u32 s42, s62, 0x10001
  v_mfma_f32_16x16x32_bf16 v[84:87], v[164:167], v[116:119], 0
  s_bfe_u32 s26, s64, 65556
  v_mfma_f32_16x16x32_bf16 v[88:91], v[168:171], v[116:119], 0
  s_and_b32 s87, s64, 0xff
  v_mfma_f32_16x16x32_bf16 v[92:95], v[172:175], v[116:119], 0
  s_bfe_u32 s88, s64, 0x80008
  v_mfma_f32_16x16x32_bf16 v[96:99], v[176:179], v[116:119], 0
  s_nop 0
  v_mfma_f32_16x16x32_bf16 v[100:103], v[180:183], v[116:119], 0
  s_nop 0
  v_mfma_f32_16x16x16_bf16 v[72:75], v[200:201], v[198:199], v[72:75]
  s_nop 1
  v_mfma_f32_16x16x16_bf16 v[76:79], v[200:201], v[196:197], v[76:79]
  s_nop 1
  v_mfma_f32_16x16x16_bf16 v[80:83], v[202:203], v[198:199], v[80:83]
  s_nop 1
  v_mfma_f32_16x16x16_bf16 v[84:87], v[202:203], v[196:197], v[84:87]
  s_nop 1
  v_mfma_f32_16x16x16_bf16 v[88:91], v[204:205], v[198:199], v[88:91]
  s_nop 0
  v_cvt_pk_bf16_f32 v40, v72, v73
  v_cvt_pk_bf16_f32 v41, v74, v75
  v_mfma_f32_16x16x16_bf16 v[92:95], v[204:205], v[196:197], v[92:95]
  s_nop 0
  v_cvt_pk_bf16_f32 v42, v76, v77
  v_cvt_pk_bf16_f32 v43, v78, v79
  v_mfma_f32_16x16x16_bf16 v[96:99], v[206:207], v[198:199], v[96:99]
  s_nop 0
  ds_write_b128 v6, v[40:43] offset:0
  v_cvt_pk_bf16_f32 v44, v80, v81
  v_mfma_f32_16x16x16_bf16 v[100:103], v[206:207], v[196:197], v[100:103]
  s_nop 0
  v_cvt_pk_bf16_f32 v45, v82, v83
  v_cvt_pk_bf16_f32 v46, v84, v85
  v_cvt_pk_bf16_f32 v47, v86, v87
  ds_write_b128 v6, v[44:47] offset:1024
  v_cvt_pk_bf16_f32 v48, v88, v89
  v_cvt_pk_bf16_f32 v49, v90, v91
  v_cvt_pk_bf16_f32 v50, v92, v93
  v_cvt_pk_bf16_f32 v51, v94, v95
  ds_write_b128 v6, v[48:51] offset:2048
  v_cvt_pk_bf16_f32 v52, v96, v97
  v_cvt_pk_bf16_f32 v53, v98, v99
  v_cvt_pk_bf16_f32 v54, v100, v101
  v_cvt_pk_bf16_f32 v55, v102, v103
  ds_write_b128 v6, v[52:55] offset:3072
  s_cmp_lt_u32 s17, 2
  s_cbranch_scc1 o_wr0_150
  s_waitcnt lgkmcnt(0)
  s_barrier
  ds_read_b128 v[104:107], v3 offset:0
  ds_read_b128 v[108:111], v3 offset:512
  ds_read_b128 v[112:115], v3 offset:1024
  s_waitcnt lgkmcnt(2)
  v_mfma_f32_32x32x16_bf16 v[40:55], v[104:107], a[0:3], 0
  s_waitcnt vmcnt(0)
  v_cmp_eq_u32 vcc, 0, v37
  s_cmp_eq_u64 vcc, 0
  s_cselect_b32 s66, s26, 0
  s_cmp_eq_u32 s66, 1
  s_cselect_b32 s87, s87, 1024
  s_cselect_b32 s34, 0, 0x28000
  v_mfma_f32_32x32x16_bf16 v[56:71], v[104:107], a[4:7], 0
  ds_read_b128 v[116:119], v3 offset:1536
  s_lshl_b32 s33, s87, 18
  s_lshl_b32 s32, s87, 19
  s_add_u32 m0, s22, s34
  s_add_u32 s33, s33, s19
  s_min_u32 s28, s49, 67
  v_mfma_f32_32x32x16_bf16 v[72:87], v[104:107], a[8:11], 0
  s_lshl1_add_u32 s28, s17, s28
  s_lshl_b32 s28, s28, 12
  s_add_u32 s28, s28, 243486720
  v_mfma_f32_32x32x16_bf16 v[88:103], v[104:107], a[12:15], 0
  buffer_load_dword v249, v246, s[4:7], s28 offen sc1
  s_waitcnt lgkmcnt(2)
  v_mfma_f32_32x32x16_bf16 v[40:55], v[108:111], a[16:19], v[40:55]
  buffer_load_dwordx4 v0, s[4:7], s33 offen offset:0 sc1 lds
  v_mfma_f32_32x32x16_bf16 v[56:71], v[108:111], a[20:23], v[56:71]
  ds_read_b128 v[104:107], v3 offset:2048
  v_mfma_f32_32x32x16_bf16 v[72:87], v[108:111], a[24:27], v[72:87]
  buffer_load_dwordx4 v0, s[4:7], s33 offen offset:1024 sc1 lds
  v_mfma_f32_32x32x16_bf16 v[88:103], v[108:111], a[28:31], v[88:103]
  buffer_load_dwordx4 v0, s[4:7], s33 offen offset:2048 sc1 lds
  s_waitcnt lgkmcnt(2)
  v_mfma_f32_32x32x16_bf16 v[40:55], v[112:115], a[32:35], v[40:55]
  v_mfma_f32_32x32x16_bf16 v[56:71], v[112:115], a[36:39], v[56:71]
  ds_read_b128 v[108:111], v3 offset:2560
  buffer_load_dwordx4 v0, s[4:7], s33 offen offset:3072 sc1 lds
  s_sub_u32 m0, m0, 8192
  s_sub_u32 s33, s33, 8192
  v_mfma_f32_32x32x16_bf16 v[72:87], v[112:115], a[40:43], v[72:87]
  buffer_load_dwordx4 v0, s[4:7], s33 offen offset:0 sc1 lds
  v_mfma_f32_32x32x16_bf16 v[88:103], v[112:115], a[44:47], v[88:103]
  s_waitcnt lgkmcnt(2)
  v_mfma_f32_32x32x16_bf16 v[40:55], v[116:119], a[48:51], v[40:55]
  buffer_load_dwordx4 v0, s[4:7], s33 offen offset:1024 sc1 lds
  v_mfma_f32_32x32x16_bf16 v[56:71], v[116:119], a[52:55], v[56:71]
  ds_read_b128 v[112:115], v3 offset:3072
  buffer_load_dwordx4 v0, s[4:7], s33 offen offset:2048 sc1 lds
  v_mfma_f32_32x32x16_bf16 v[72:87], v[116:119], a[56:59], v[72:87]
  v_mfma_f32_32x32x16_bf16 v[88:103], v[116:119], a[60:63], v[88:103]
  buffer_load_dwordx4 v0, s[4:7], s33 offen offset:3072 sc1 lds
  s_add_u32 m0, s23, s34
  s_add_u32 s32, s32, s18
  s_waitcnt lgkmcnt(2)
  v_mfma_f32_32x32x16_bf16 v[40:55], v[104:107], a[64:67], v[40:55]
  buffer_load_dwordx4 v0, s[4:7], s32 offen offset:0 sc1 lds
  v_mfma_f32_32x32x16_bf16 v[56:71], v[104:107], a[68:71], v[56:71]
  ds_read_b128 v[116:119], v3 offset:3584
  v_mfma_f32_32x32x16_bf16 v[72:87], v[104:107], a[72:75], v[72:87]
  buffer_load_dwordx4 v0, s[4:7], s32 offen offset:1024 sc1 lds
  s_add_i32 m0, m0, 4096
  s_add_i32 s32, s32, 4096
  v_mfma_f32_32x32x16_bf16 v[88:103], v[104:107], a[76:79], v[88:103]
  buffer_load_dwordx4 v0, s[4:7], s32 offen offset:0 sc1 lds
  s_waitcnt lgkmcnt(2)
  v_mfma_f32_32x32x16_bf16 v[40:55], v[108:111], a[80:83], v[40:55]
  v_mfma_f32_32x32x16_bf16 v[56:71], v[108:111], a[84:87], v[56:71]
  ds_read_b128 v[104:107], v3 offset:8192
  buffer_load_dwordx4 v0, s[4:7], s32 offen offset:1024 sc1 lds
  s_add_i32 m0, m0, -16384
  s_add_i32 s32, s32, -16384
  v_mfma_f32_32x32x16_bf16 v[72:87], v[108:111], a[88:91], v[72:87]
  s_and_b32 s29, s64, 0xff00
  s_lshl_b32 s29, s29, 3
  s_add_u32 s29, s29, s15
  buffer_load_dword v245, v252, s[4:7], s29 offen sc1
  v_mfma_f32_32x32x16_bf16 v[88:103], v[108:111], a[92:95], v[88:103]
  s_waitcnt lgkmcnt(2)
  v_mfma_f32_32x32x16_bf16 v[40:55], v[112:115], a[96:99], v[40:55]
  buffer_load_dwordx4 v0, s[4:7], s32 offen offset:0 sc1 lds
  v_mfma_f32_32x32x16_bf16 v[56:71], v[112:115], a[100:103], v[56:71]
  ds_read_b128 v[108:111], v3 offset:8704
  buffer_load_dwordx4 v0, s[4:7], s32 offen offset:1024 sc1 lds
  s_add_i32 m0, m0, -4096
  s_add_i32 s32, s32, -4096
  v_mfma_f32_32x32x16_bf16 v[72:87], v[112:115], a[104:107], v[72:87]
  v_mfma_f32_32x32x16_bf16 v[88:103], v[112:115], a[108:111], v[88:103]
  buffer_load_dwordx4 v0, s[4:7], s32 offen offset:0 sc1 lds
  s_waitcnt lgkmcnt(2)
  v_mfma_f32_32x32x16_bf16 v[40:55], v[116:119], a[112:115], v[40:55]
  buffer_load_dwordx4 v0, s[4:7], s32 offen offset:1024 sc1 lds
  v_mfma_f32_32x32x16_bf16 v[56:71], v[116:119], a[116:119], v[56:71]
  ds_read_b128 v[112:115], v3 offset:9216
  v_mfma_f32_32x32x16_bf16 v[72:87], v[116:119], a[120:123], v[72:87]
  buffer_load_dwordx4 v0, s[4:7], s32 offen offset:2048 sc1 lds
  v_mfma_f32_32x32x16_bf16 v[88:103], v[116:119], a[124:127], v[88:103]
  buffer_load_dwordx4 v0, s[4:7], s32 offen offset:3072 sc1 lds
  s_add_i32 m0, m0, 4096
  s_add_i32 s32, s32, 4096
  s_waitcnt lgkmcnt(2)
  v_mfma_f32_32x32x16_bf16 v[40:55], v[104:107], a[128:131], v[40:55]
  v_mfma_f32_32x32x16_bf16 v[56:71], v[104:107], a[132:135], v[56:71]
  ds_read_b128 v[116:119], v3 offset:9728
  buffer_load_dwordx4 v0, s[4:7], s32 offen offset:2048 sc1 lds
  v_mfma_f32_32x32x16_bf16 v[72:87], v[104:107], a[136:139], v[72:87]
  buffer_load_dwordx4 v0, s[4:7], s32 offen offset:3072 sc1 lds
  s_add_i32 m0, m0, 16384
  s_add_i32 s32, s32, 16384
  v_mfma_f32_32x32x16_bf16 v[88:103], v[104:107], a[140:143], v[88:103]
  s_waitcnt lgkmcnt(2)
  v_mfma_f32_32x32x16_bf16 v[40:55], v[108:111], a[144:147], v[40:55]
  buffer_load_dwordx4 v0, s[4:7], s32 offen offset:2048 sc1 lds
  v_mfma_f32_32x32x16_bf16 v[56:71], v[108:111], a[148:151], v[56:71]
  ds_read_b128 v[104:107], v3 offset:10240
  buffer_load_dwordx4 v0, s[4:7], s32 offen offset:3072 sc1 lds
  s_add_i32 m0, m0, -4096
  s_add_i32 s32, s32, -4096
  v_mfma_f32_32x32x16_bf16 v[72:87], v[108:111], a[152:155], v[72:87]
  v_mfma_f32_32x32x16_bf16 v[88:103], v[108:111], a[156:159], v[88:103]
  buffer_load_dwordx4 v0, s[4:7], s32 offen offset:2048 sc1 lds
  s_waitcnt lgkmcnt(2)
  v_mfma_f32_32x32x16_bf16 v[40:55], v[112:115], a[160:163], v[40:55]
  buffer_load_dwordx4 v0, s[4:7], s32 offen offset:3072 sc1 lds
  v_mfma_f32_32x32x16_bf16 v[56:71], v[112:115], a[164:167], v[56:71]
  ds_read_b128 v[108:111], v3 offset:10752
  v_mfma_f32_32x32x16_bf16 v[72:87], v[112:115], a[168:171], v[72:87]
  v_mfma_f32_32x32x16_bf16 v[88:103], v[112:115], a[172:175], v[88:103]
  s_waitcnt lgkmcnt(2)
  v_mfma_f32_32x32x16_bf16 v[40:55], v[116:119], a[176:179], v[40:55]
  v_mfma_f32_32x32x16_bf16 v[56:71], v[116:119], a[180:183], v[56:71]
  ds_read_b128 v[112:115], v3 offset:11264
  v_mfma_f32_32x32x16_bf16 v[72:87], v[116:119], a[184:187], v[72:87]
  v_mfma_f32_32x32x16_bf16 v[88:103], v[116:119], a[188:191], v[88:103]
  s_waitcnt lgkmcnt(2)
  v_mfma_f32_32x32x16_bf16 v[40:55], v[104:107], a[192:195], v[40:55]
  v_mfma_f32_32x32x16_bf16 v[56:71], v[104:107], a[196:199], v[56:71]
  ds_read_b128 v[116:119], v3 offset:11776
  s_waitcnt vmcnt(12)
  v_cmp_eq_u32 vcc, 0, v245
  s_cmp_eq_u64 vcc, 0
  s_cselect_b32 s76, s26, 0
  s_and_b32 s76, s76, 1
  s_cselect_b32 s88, s88, 1024
  s_waitcnt lgkmcnt(2)
  v_mfma_f32_32x32x16_bf16 v[40:55], v[108:111], a[208:211], v[40:55]
  s_lshl_b32 s32, s88, 18
  s_mov_b32 m0, s40
  s_add_u32 s32, s32, s21
  buffer_load_dwordx4 v0, s[4:7], s32 offen offset:0 sc1 lds
  v_mfma_f32_32x32x16_bf16 v[56:71], v[108:111], a[212:215], v[56:71]
  buffer_load_dwordx4 v0, s[4:7], s32 offen offset:1024 sc1 lds
  s_waitcnt lgkmcnt(1)
  v_mfma_f32_32x32x16_bf16 v[40:55], v[112:115], a[224:227], v[40:55]
  buffer_load_dwordx4 v0, s[4:7], s32 offen offset:2048 sc1 lds
  s_sub_u32 m0, m0, 8192
  s_sub_u32 s32, s32, 8192
  v_mfma_f32_32x32x16_bf16 v[56:71], v[112:115], a[228:231], v[56:71]
  buffer_load_dwordx4 v0, s[4:7], s32 offen offset:0 sc1 lds
  s_waitcnt lgkmcnt(0)
  v_mfma_f32_32x32x16_bf16 v[40:55], v[116:119], a[240:243], v[40:55]
  buffer_load_dwordx4 v0, s[4:7], s32 offen offset:1024 sc1 lds
  v_mfma_f32_32x32x16_bf16 v[56:71], v[116:119], a[244:247], v[56:71]
  buffer_load_dwordx4 v0, s[4:7], s32 offen offset:2048 sc1 lds
  v_cmp_eq_u32 vcc, 0, v249
  v_max_u32_dpp v249, v249, v249 row_ror:8 row_mask:0xf bank_mask:0xf
  s_nop 0
  v_mfma_f32_32x32x16_bf16 v[72:87], v[104:107], a[200:203], v[72:87]
  v_max_u32_dpp v249, v249, v249 row_ror:4 row_mask:0xf bank_mask:0xf
  s_nop 0
  s_nop 0
  v_max_u32_dpp v249, v249, v249 row_ror:2 row_mask:0xf bank_mask:0xf
  s_nop 0
  s_nop 0
  v_max_u32_dpp v249, v249, v249 row_ror:1 row_mask:0xf bank_mask:0xf
  s_nop 0
  v_mfma_f32_32x32x16_bf16 v[88:103], v[104:107], a[204:207], v[88:103]
  v_mov_b32 v248, v249
  s_nop 0
  s_nop 0
  v_permlane16_swap_b32 v249, v248
  v_max_u32 v249, v249, v248
  v_mfma_f32_32x32x16_bf16 v[72:87], v[108:111], a[216:219], v[72:87]
  v_mov_b32 v248, v249
  s_nop 0
  s_nop 0
  v_permlane32_swap_b32 v249, v248
  v_max_u32 v249, v249, v248
  s_cmp_eq_u64 vcc, 0
  s_cselect_b32 s28, 4, 0
  v_mfma_f32_32x32x16_bf16 v[88:103], v[108:111], a[220:223], v[88:103]
  s_lshl_b32 s26, s76, 1
  s_or_b32 s26, s26, s66
  s_or_b32 s26, s26, s28
  v_mov_b32 v248, s26
  ds_write_b64 v39, v[248:249]
  v_mfma_f32_32x32x16_bf16 v[72:87], v[112:115], a[232:235], v[72:87]
  v_cvt_pk_bf16_f32 v212, v40, v56
  v_cvt_pk_bf16_f32 v214, v41, v57
  v_cvt_pk_bf16_f32 v216, v42, v58
  v_cvt_pk_bf16_f32 v218, v43, v59
  v_permlane16_swap_b32 v212, v214
  v_mfma_f32_32x32x16_bf16 v[88:103], v[112:115], a[236:239], v[88:103]
  v_cvt_pk_bf16_f32 v220, v44, v60
  v_cvt_pk_bf16_f32 v222, v45, v61
  v_permlane16_swap_b32 v216, v218
  v_bfi_b32 v212, v254, s42, v212
  v_mfma_f32_32x32x16_bf16 v[72:87], v[116:119], a[248:251], v[72:87]
  v_cvt_pk_bf16_f32 v224, v46, v62
  v_cvt_pk_bf16_f32 v226, v47, v63
  v_permlane16_swap_b32 v220, v222
  v_bfi_b32 v216, v254, s42, v216
  v_cvt_pk_bf16_f32 v228, v48, v64
  v_mfma_f32_32x32x16_bf16 v[88:103], v[116:119], a[252:255], v[88:103]
  v_cvt_pk_bf16_f32 v230, v49, v65
  v_permlane16_swap_b32 v224, v226
  v_bfi_b32 v220, v254, s42, v220
  v_cvt_pk_bf16_f32 v232, v50, v66
  v_cvt_pk_bf16_f32 v234, v51, v67
  v_permlane16_swap_b32 v228, v230
  v_bfi_b32 v224, v254, s42, v224
  v_cvt_pk_bf16_f32 v236, v52, v68
  v_cvt_pk_bf16_f32 v238, v53, v69
  v_permlane16_swap_b32 v232, v234
  v_bfi_b32 v228, v254, s42, v228
  v_cvt_pk_bf16_f32 v240, v54, v70
  v_cvt_pk_bf16_f32 v242, v55, v71
  v_permlane16_swap_b32 v236, v238
  v_bfi_b32 v232, v254, s42, v232
  v_permlane16_swap_b32 v240, v242
  v_bfi_b32 v236, v254, s42, v236
  v_bfi_b32 v240, v254, s42, v240
  v_cvt_pk_bf16_f32 v213, v72, v88
  v_cvt_pk_bf16_f32 v215, v73, v89
  v_cvt_pk_bf16_f32 v217, v74, v90
  v_cvt_pk_bf16_f32 v219, v75, v91
  s_add_u32 s78, s86, 0
  v_permlane16_swap_b32 v213, v215
  buffer_store_dwordx4 v[212:215], v4, s[4:7], s78 offen sc1
  v_cvt_pk_bf16_f32 v221, v76, v92
  v_cvt_pk_bf16_f32 v223, v77, v93
  s_add_u32 s78, s86, 32768
  v_permlane16_swap_b32 v217, v219
  buffer_store_dwordx4 v[216:219], v4, s[4:7], s78 offen sc1
  v_cvt_pk_bf16_f32 v225, v78, v94
  v_cvt_pk_bf16_f32 v227, v79, v95
  s_add_u32 s78, s86, 131072
  v_permlane16_swap_b32 v221, v223
  buffer_store_dwordx4 v[220:223], v4, s[4:7], s78 offen sc1
  v_cvt_pk_bf16_f32 v229, v80, v96
  v_cvt_pk_bf16_f32 v231, v81, v97
  s_add_u32 s78, s86, 163840
  v_permlane16_swap_b32 v225, v227
  buffer_store_dwordx4 v[224:227], v4, s[4:7], s78 offen sc1
  v_cvt_pk_bf16_f32 v233, v82, v98
  v_cvt_pk_bf16_f32 v235, v83, v99
  s_add_u32 s78, s86, 262144
  v_permlane16_swap_b32 v229, v231
  buffer_store_dwordx4 v[228:231], v4, s[4:7], s78 offen sc1
  v_cvt_pk_bf16_f32 v237, v84, v100
  v_cvt_pk_bf16_f32 v239, v85, v101
  s_add_u32 s78, s86, 294912
  v_permlane16_swap_b32 v233, v235
  buffer_store_dwordx4 v[232:235], v4, s[4:7], s78 offen sc1
  v_cvt_pk_bf16_f32 v241, v86, v102
  v_cvt_pk_bf16_f32 v243, v87, v103
  s_add_u32 s78, s86, 393216
  v_permlane16_swap_b32 v237, v239
  buffer_store_dwordx4 v[236:239], v4, s[4:7], s78 offen sc1
  s_add_u32 s78, s86, 425984
  v_permlane16_swap_b32 v241, v243
  buffer_store_dwordx4 v[240:243], v4, s[4:7], s78 offen sc1
  s_waitcnt vmcnt(22)
  s_branch o_we_153
o_wr0_150:
  s_waitcnt lgkmcnt(0)
  s_barrier
  ds_read_b128 v[104:107], v3 offset:0
  ds_read_b128 v[108:111], v3 offset:512
  ds_read_b128 v[112:115], v3 offset:1024
  s_waitcnt lgkmcnt(2)
  v_mfma_f32_32x32x16_bf16 v[40:55], v[104:107], a[0:3], 0
  v_mfma_f32_32x32x16_bf16 v[56:71], v[104:107], a[4:7], 0
  ds_read_b128 v[116:119], v3 offset:1536
  v_mfma_f32_32x32x16_bf16 v[72:87], v[104:107], a[8:11], 0
  v_mfma_f32_32x32x16_bf16 v[88:103], v[104:107], a[12:15], 0
  s_waitcnt lgkmcnt(2)
  v_mfma_f32_32x32x16_bf16 v[40:55], v[108:111], a[16:19], v[40:55]
  v_mfma_f32_32x32x16_bf16 v[56:71], v[108:111], a[20:23], v[56:71]
  ds_read_b128 v[104:107], v3 offset:2048
  v_mfma_f32_32x32x16_bf16 v[72:87], v[108:111], a[24:27], v[72:87]
  v_mfma_f32_32x32x16_bf16 v[88:103], v[108:111], a[28:31], v[88:103]
  s_waitcnt lgkmcnt(2)
  v_mfma_f32_32x32x16_bf16 v[40:55], v[112:115], a[32:35], v[40:55]
  v_mfma_f32_32x32x16_bf16 v[56:71], v[112:115], a[36:39], v[56:71]
  ds_read_b128 v[108:111], v3 offset:2560
  v_mfma_f32_32x32x16_bf16 v[72:87], v[112:115], a[40:43], v[72:87]
  v_mfma_f32_32x32x16_bf16 v[88:103], v[112:115], a[44:47], v[88:103]
  s_waitcnt lgkmcnt(2)
  v_mfma_f32_32x32x16_bf16 v[40:55], v[116:119], a[48:51], v[40:55]
  v_mfma_f32_32x32x16_bf16 v[56:71], v[116:119], a[52:55], v[56:71]
  ds_read_b128 v[112:115], v3 offset:3072
  v_mfma_f32_32x32x16_bf16 v[72:87], v[116:119], a[56:59], v[72:87]
  v_mfma_f32_32x32x16_bf16 v[88:103], v[116:119], a[60:63], v[88:103]
  s_waitcnt lgkmcnt(2)
  v_mfma_f32_32x32x16_bf16 v[40:55], v[104:107], a[64:67], v[40:55]
  v_mfma_f32_32x32x16_bf16 v[56:71], v[104:107], a[68:71], v[56:71]
  ds_read_b128 v[116:119], v3 offset:3584
  v_mfma_f32_32x32x16_bf16 v[72:87], v[104:107], a[72:75], v[72:87]
  v_mfma_f32_32x32x16_bf16 v[88:103], v[104:107], a[76:79], v[88:103]
  s_waitcnt lgkmcnt(2)
  v_mfma_f32_32x32x16_bf16 v[40:55], v[108:111], a[80:83], v[40:55]
  v_mfma_f32_32x32x16_bf16 v[56:71], v[108:111], a[84:87], v[56:71]
  ds_read_b128 v[104:107], v3 offset:8192
  v_mfma_f32_32x32x16_bf16 v[72:87], v[108:111], a[88:91], v[72:87]
  v_mfma_f32_32x32x16_bf16 v[88:103], v[108:111], a[92:95], v[88:103]
  s_waitcnt lgkmcnt(2)
  v_mfma_f32_32x32x16_bf16 v[40:55], v[112:115], a[96:99], v[40:55]
  v_mfma_f32_32x32x16_bf16 v[56:71], v[112:115], a[100:103], v[56:71]
  ds_read_b128 v[108:111], v3 offset:8704
  v_mfma_f32_32x32x16_bf16 v[72:87], v[112:115], a[104:107], v[72:87]
  v_mfma_f32_32x32x16_bf16 v[88:103], v[112:115], a[108:111], v[88:103]
  s_waitcnt lgkmcnt(2)
  v_mfma_f32_32x32x16_bf16 v[40:55], v[116:119], a[112:115], v[40:55]
  v_mfma_f32_32x32x16_bf16 v[56:71], v[116:119], a[116:119], v[56:71]
  ds_read_b128 v[112:115], v3 offset:9216
  v_mfma_f32_32x32x16_bf16 v[72:87], v[116:119], a[120:123], v[72:87]
  v_mfma_f32_32x32x16_bf16 v[88:103], v[116:119], a[124:127], v[88:103]
  s_waitcnt lgkmcnt(2)
  v_mfma_f32_32x32x16_bf16 v[40:55], v[104:107], a[128:131], v[40:55]
  v_mfma_f32_32x32x16_bf16 v[56:71], v[104:107], a[132:135], v[56:71]
  ds_read_b128 v[116:119], v3 offset:9728
  v_mfma_f32_32x32x16_bf16 v[72:87], v[104:107], a[136:139], v[72:87]
  v_mfma_f32_32x32x16_bf16 v[88:103], v[104:107], a[140:143], v[88:103]
  s_waitcnt lgkmcnt(2)
  v_mfma_f32_32x32x16_bf16 v[40:55], v[108:111], a[144:147], v[40:55]
  v_mfma_f32_32x32x16_bf16 v[56:71], v[108:111], a[148:151], v[56:71]
  ds_read_b128 v[104:107], v3 offset:10240
  v_mfma_f32_32x32x16_bf16 v[72:87], v[108:111], a[152:155], v[72:87]
  v_mfma_f32_32x32x16_bf16 v[88:103], v[108:111], a[156:159], v[88:103]
  s_waitcnt lgkmcnt(2)
  v_mfma_f32_32x32x16_bf16 v[40:55], v[112:115], a[160:163], v[40:55]
  v_mfma_f32_32x32x16_bf16 v[56:71], v[112:115], a[164:167], v[56:71]
  ds_read_b128 v[108:111], v3 offset:10752
  v_mfma_f32_32x32x16_bf16 v[72:87], v[112:115], a[168:171], v[72:87]
  v_mfma_f32_32x32x16_bf16 v[88:103], v[112:115], a[172:175], v[88:103]
  s_waitcnt lgkmcnt(2)
  v_mfma_f32_32x32x16_bf16 v[40:55], v[116:119], a[176:179], v[40:55]
  v_mfma_f32_32x32x16_bf16 v[56:71], v[116:119], a[180:183], v[56:71]
  ds_read_b128 v[112:115], v3 offset:11264
  v_mfma_f32_32x32x16_bf16 v[72:87], v[116:119], a[184:187], v[72:87]
  v_mfma_f32_32x32x16_bf16 v[88:103], v[116:119], a[188:191], v[88:103]
  s_waitcnt lgkmcnt(2)
  v_mfma_f32_32x32x16_bf16 v[40:55], v[104:107], a[192:195], v[40:55]
  v_mfma_f32_32x32x16_bf16 v[56:71], v[104:107], a[196:199], v[56:71]
  ds_read_b128 v[116:119], v3 offset:11776
  s_waitcnt lgkmcnt(2)
  v_mfma_f32_32x32x16_bf16 v[40:55], v[108:111], a[208:211], v[40:55]
  v_mfma_f32_32x32x16_bf16 v[56:71], v[108:111], a[212:215], v[56:71]
  s_waitcnt lgkmcnt(1)
  v_mfma_f32_32x32x16_bf16 v[40:55], v[112:115], a[224:227], v[40:55]
  v_mfma_f32_32x32x16_bf16 v[56:71], v[112:115], a[228:231], v[56:71]
  s_waitcnt lgkmcnt(0)
  v_mfma_f32_32x32x16_bf16 v[40:55], v[116:119], a[240:243], v[40:55]
  v_mfma_f32_32x32x16_bf16 v[56:71], v[116:119], a[244:247], v[56:71]
  v_mfma_f32_32x32x16_bf16 v[72:87], v[104:107], a[200:203], v[72:87]
  v_mfma_f32_32x32x16_bf16 v[88:103], v[104:107], a[204:207], v[88:103]
  v_cvt_pk_bf16_f32 v212, v40, v56
  v_cvt_pk_bf16_f32 v214, v41, v57
  v_cvt_pk_bf16_f32 v216, v42, v58
  v_cvt_pk_bf16_f32 v218, v43, v59
  v_permlane16_swap_b32 v212, v214
  v_mfma_f32_32x32x16_bf16 v[72:87], v[108:111], a[216:219], v[72:87]
  v_cvt_pk_bf16_f32 v220, v44, v60
  v_cvt_pk_bf16_f32 v222, v45, v61
  v_permlane16_swap_b32 v216, v218
  v_bfi_b32 v212, v254, s42, v212
  v_cvt_pk_bf16_f32 v224, v46, v62
  v_mfma_f32_32x32x16_bf16 v[88:103], v[108:111], a[220:223], v[88:103]
  v_cvt_pk_bf16_f32 v226, v47, v63
  v_permlane16_swap_b32 v220, v222
  v_bfi_b32 v216, v254, s42, v216
  v_cvt_pk_bf16_f32 v228, v48, v64
  v_mfma_f32_32x32x16_bf16 v[72:87], v[112:115], a[232:235], v[72:87]
  v_cvt_pk_bf16_f32 v230, v49, v65
  v_permlane16_swap_b32 v224, v226
  v_bfi_b32 v220, v254, s42, v220
  v_cvt_pk_bf16_f32 v232, v50, v66
  v_cvt_pk_bf16_f32 v234, v51, v67
  v_mfma_f32_32x32x16_bf16 v[88:103], v[112:115], a[236:239], v[88:103]
  v_permlane16_swap_b32 v228, v230
  v_bfi_b32 v224, v254, s42, v224
  v_cvt_pk_bf16_f32 v236, v52, v68
  v_cvt_pk_bf16_f32 v238, v53, v69
  v_mfma_f32_32x32x16_bf16 v[72:87], v[116:119], a[248:251], v[72:87]
  v_permlane16_swap_b32 v232, v234
  v_bfi_b32 v228, v254, s42, v228
  v_cvt_pk_bf16_f32 v240, v54, v70
  v_cvt_pk_bf16_f32 v242, v55, v71
  v_permlane16_swap_b32 v236, v238
  v_mfma_f32_32x32x16_bf16 v[88:103], v[116:119], a[252:255], v[88:103]
  v_bfi_b32 v232, v254, s42, v232
  v_permlane16_swap_b32 v240, v242
  v_bfi_b32 v236, v254, s42, v236
  v_bfi_b32 v240, v254, s42, v240
  s_nop 7
  v_cvt_pk_bf16_f32 v213, v72, v88
  v_cvt_pk_bf16_f32 v215, v73, v89
  v_cvt_pk_bf16_f32 v217, v74, v90
  v_cvt_pk_bf16_f32 v219, v75, v91
  s_add_u32 s78, s86, 0
  v_permlane16_swap_b32 v213, v215
  buffer_store_dwordx4 v[212:215], v4, s[4:7], s78 offen sc1
  v_cvt_pk_bf16_f32 v221, v76, v92
  v_cvt_pk_bf16_f32 v223, v77, v93
  s_add_u32 s78, s86, 32768
  v_permlane16_swap_b32 v217, v219
  buffer_store_dwordx4 v[216:219], v4, s[4:7], s78 offen sc1
  v_cvt_pk_bf16_f32 v225, v78, v94
  v_cvt_pk_bf16_f32 v227, v79, v95
  s_add_u32 s78, s86, 131072
  v_permlane16_swap_b32 v221, v223
  buffer_store_dwordx4 v[220:223], v4, s[4:7], s78 offen sc1
  v_cvt_pk_bf16_f32 v229, v80, v96
  v_cvt_pk_bf16_f32 v231, v81, v97
  s_add_u32 s78, s86, 163840
  v_permlane16_swap_b32 v225, v227
  buffer_store_dwordx4 v[224:227], v4, s[4:7], s78 offen sc1
  v_cvt_pk_bf16_f32 v233, v82, v98
  v_cvt_pk_bf16_f32 v235, v83, v99
  s_add_u32 s78, s86, 262144
  v_permlane16_swap_b32 v229, v231
  buffer_store_dwordx4 v[228:231], v4, s[4:7], s78 offen sc1
  v_cvt_pk_bf16_f32 v237, v84, v100
  v_cvt_pk_bf16_f32 v239, v85, v101
  s_add_u32 s78, s86, 294912
  v_permlane16_swap_b32 v233, v235
  buffer_store_dwordx4 v[232:235], v4, s[4:7], s78 offen sc1
  v_cvt_pk_bf16_f32 v241, v86, v102
  v_cvt_pk_bf16_f32 v243, v87, v103
  s_add_u32 s78, s86, 393216
  v_permlane16_swap_b32 v237, v239
  buffer_store_dwordx4 v[236:239], v4, s[4:7], s78 offen sc1
  s_add_u32 s78, s86, 425984
  v_permlane16_swap_b32 v241, v243
  buffer_store_dwordx4 v[240:243], v4, s[4:7], s78 offen sc1
  s_branch o_we_153
o_wr1_151:
  s_nop 3
  v_mul_f32 v112, s24, v112
  v_mul_f32 v113, s24, v113
  v_exp_f32 v64, v112
  v_exp_f32 v65, v113
  v_max_f32 v116, v111, v116
  v_max3_f32 v116, v112, v113, v116
  v_add_f32 v117, v117, v64
  v_add_f32 v118, v118, v65
  v_add_f32 v117, v117, v118
  s_mov_b32 s28, 0x21800000
  v_mov_b32 v118, v117
  s_nop 1
  v_permlane16_swap_b32 v117, v118
  v_add_f32 v117, v117, v118
  v_mov_b32 v118, v117
  s_nop 0
  s_nop 0
  v_permlane32_swap_b32 v117, v118
  v_add_f32 v117, v117, v118
  s_mov_b32 s67, 0
  s_mov_b64 vcc, 0
  s_waitcnt vmcnt(3)
o_pl_159:
  v_and_b32 v7, 1, v7
  v_cmp_ne_u32 vcc, s96, v7
  s_cbranch_vccz o_pk_160
  buffer_load_dword v7, v255, s[4:7], s97 offen sc1
  s_add_u32 s67, s67, 1
  s_cmp_gt_u32 s67, 1048576
  s_cbranch_scc1 L_end
  s_waitcnt vmcnt(0)
  s_branch o_pl_159
o_pk_160:
  s_lshl_b32 s94, s43, 14
  s_add_u32 s94, s94, s95
  buffer_load_dwordx4 v[120:123], v5, s[4:7], s94 offen offset:0 sc1
  v_cmp_lt_f32 vcc, 0x42700000, v116
  v_cmp_gt_f32 s[30:31], s28, v117
  v_rcp_f32 v117, v117
  buffer_load_dwordx4 v[124:127], v5, s[4:7], s94 offen offset:512 sc1
  s_or_b64 vcc, vcc, s[30:31]
  s_cbranch_vccnz o_fb_157
o_fbr_158:
  buffer_load_dwordx4 v[128:131], v5, s[4:7], s94 offen offset:256 sc1
  v_pk_mul_f32 v[56:57], v[56:57], v[116:117] op_sel:[0,1] op_sel_hi:[1,1]
  v_pk_mul_f32 v[58:59], v[58:59], v[116:117] op_sel:[0,1] op_sel_hi:[1,1]
  v_pk_mul_f32 v[60:61], v[60:61], v[116:117] op_sel:[0,1] op_sel_hi:[1,1]
  v_pk_mul_f32 v[62:63], v[62:63], v[116:117] op_sel:[0,1] op_sel_hi:[1,1]
  v_pk_mul_f32 v[64:65], v[64:65], v[116:117] op_sel:[0,1] op_sel_hi:[1,1]
  buffer_load_dwordx4 v[132:135], v5, s[4:7], s94 offen offset:768 sc1
  v_cvt_pk_bf16_f32 v116, v56, v57
  v_cvt_pk_bf16_f32 v117, v58, v59
  v_cvt_pk_bf16_f32 v118, v60, v61
  v_cvt_pk_bf16_f32 v119, v62, v63
  s_waitcnt lgkmcnt(0)
  s_nop 0
  v_mfma_f32_16x16x32_bf16 v[72:75], v[152:155], v[116:119], 0
  s_add_u32 s62, s62, 1
  v_cvt_pk_bf16_f32 v197, v64, v65
  v_cvt_pk_bf16_f32 v198, v64, v65
  v_mfma_f32_16x16x32_bf16 v[76:79], v[156:159], v[116:119], 0
  s_add_u32 s94, s94, 4096
  buffer_load_dwordx4 v[136:139], v5, s[4:7], s94 offen offset:0 sc1
  s_xor_b32 s86, s86, 524288
  v_mfma_f32_16x16x32_bf16 v[80:83], v[160:163], v[116:119], 0
  s_bfe_u32 s42, s62, 0x10001
  v_mfma_f32_16x16x32_bf16 v[84:87], v[164:167], v[116:119], 0
  buffer_load_dwordx4 v[140:143], v5, s[4:7], s94 offen offset:512 sc1
  v_mfma_f32_16x16x32_bf16 v[88:91], v[168:171], v[116:119], 0
  v_mfma_f32_16x16x32_bf16 v[92:95], v[172:175], v[116:119], 0
  buffer_load_dwordx4 v[144:147], v5, s[4:7], s94 offen offset:256 sc1
  v_mfma_f32_16x16x32_bf16 v[96:99], v[176:179], v[116:119], 0
  v_mfma_f32_16x16x32_bf16 v[100:103], v[180:183], v[116:119], 0
  buffer_load_dwordx4 v[148:151], v5, s[4:7], s94 offen offset:768 sc1
  v_mfma_f32_16x16x16_bf16 v[72:75], v[200:201], v[198:199], v[72:75]
  s_nop 1
  v_mfma_f32_16x16x16_bf16 v[76:79], v[200:201], v[196:197], v[76:79]
  s_add_u32 s94, s94, 4096
  buffer_load_dwordx4 v[152:155], v5, s[4:7], s94 offen offset:0 sc1
  v_mfma_f32_16x16x16_bf16 v[80:83], v[202:203], v[198:199], v[80:83]
  s_nop 1
  v_mfma_f32_16x16x16_bf16 v[84:87], v[202:203], v[196:197], v[84:87]
  buffer_load_dwordx4 v[156:159], v5, s[4:7], s94 offen offset:512 sc1
  v_mfma_f32_16x16x16_bf16 v[88:91], v[204:205], v[198:199], v[88:91]
  s_nop 0
  v_cvt_pk_bf16_f32 v40, v72, v73
  v_cvt_pk_bf16_f32 v41, v74, v75
  v_mfma_f32_16x16x16_bf16 v[92:95], v[204:205], v[196:197], v[92:95]
  buffer_load_dwordx4 v[160:163], v5, s[4:7], s94 offen offset:256 sc1
  v_cvt_pk_bf16_f32 v42, v76, v77
  v_cvt_pk_bf16_f32 v43, v78, v79
  v_mfma_f32_16x16x16_bf16 v[96:99], v[206:207], v[198:199], v[96:99]
  s_nop 0
  ds_write_b128 v6, v[40:43] offset:0
  v_cvt_pk_bf16_f32 v44, v80, v81
  v_mfma_f32_16x16x16_bf16 v[100:103], v[206:207], v[196:197], v[100:103]
  buffer_load_dwordx4 v[164:167], v5, s[4:7], s94 offen offset:768 sc1
  v_cvt_pk_bf16_f32 v45, v82, v83
  v_cvt_pk_bf16_f32 v46, v84, v85
  v_cvt_pk_bf16_f32 v47, v86, v87
  ds_write_b128 v6, v[44:47] offset:1024
  v_cvt_pk_bf16_f32 v48, v88, v89
  v_cvt_pk_bf16_f32 v49, v90, v91
  v_cvt_pk_bf16_f32 v50, v92, v93
  v_cvt_pk_bf16_f32 v51, v94, v95
  s_add_u32 s94, s94, 4096
  buffer_load_dwordx4 v[168:171], v5, s[4:7], s94 offen offset:0 sc1
  ds_write_b128 v6, v[48:51] offset:2048
  v_cvt_pk_bf16_f32 v52, v96, v97
  v_cvt_pk_bf16_f32 v53, v98, v99
  v_cvt_pk_bf16_f32 v54, v100, v101
  v_cvt_pk_bf16_f32 v55, v102, v103
  ds_write_b128 v6, v[52:55] offset:3072
  buffer_load_dwordx4 v[172:175], v5, s[4:7], s94 offen offset:512 sc1
  s_and_b32 s26, s65, 49152
  s_cbranch_scc1 o_wr2_152
  s_waitcnt lgkmcnt(0)
  s_barrier
  ds_read_b128 v[104:107], v3 offset:0
  ds_read_b128 v[108:111], v3 offset:512
  ds_read_b128 v[112:115], v3 offset:1024
  buffer_load_dwordx4 v[176:179], v5, s[4:7], s94 offen offset:256 sc1
  buffer_load_dwordx4 v[180:183], v5, s[4:7], s94 offen offset:768 sc1
  s_waitcnt lgkmcnt(2)
  v_mfma_f32_32x32x16_bf16 v[40:55], v[104:107], a[0:3], 0
  v_mov_b64 v[188:189], 0
  v_mov_b64 v[190:191], 0
  v_mov_b64 v[192:193], 0
  v_mov_b64 v[194:195], 0
  s_mov_b64 exec, 1
  buffer_store_dword v38, off, s[4:7], s84 sc1
  s_mov_b64 exec, -1
  s_mov_b32 s84, 268435456
  v_mfma_f32_32x32x16_bf16 v[56:71], v[104:107], a[4:7], 0
  ds_read_b128 v[116:119], v3 offset:1536
  v_mfma_f32_32x32x16_bf16 v[72:87], v[104:107], a[8:11], 0
  v_mfma_f32_32x32x16_bf16 v[88:103], v[104:107], a[12:15], 0
  s_waitcnt vmcnt(13)
  v_xor_b32 v7, s96, v120
  v_bitop3_b32 v7, v7, v124, s96 bitop3:0xf6
  v_bitop3_b32 v7, v7, v128, s96 bitop3:0xf6
  v_bitop3_b32 v7, v7, v132, s96 bitop3:0xf6
  s_waitcnt lgkmcnt(2)
  v_mfma_f32_32x32x16_bf16 v[40:55], v[108:111], a[16:19], v[40:55]
  s_waitcnt vmcnt(9)
  v_bitop3_b32 v7, v7, v136, s96 bitop3:0xf6
  v_bitop3_b32 v7, v7, v140, s96 bitop3:0xf6
  v_bitop3_b32 v7, v7, v144, s96 bitop3:0xf6
  v_bitop3_b32 v7, v7, v148, s96 bitop3:0xf6
  s_waitcnt vmcnt(5)
  v_mfma_f32_32x32x16_bf16 v[56:71], v[108:111], a[20:23], v[56:71]
  ds_read_b128 v[104:107], v3 offset:2048
  v_bitop3_b32 v7, v7, v152, s96 bitop3:0xf6
  v_bitop3_b32 v7, v7, v156, s96 bitop3:0xf6
  v_bitop3_b32 v7, v7, v160, s96 bitop3:0xf6
  v_bitop3_b32 v7, v7, v164, s96 bitop3:0xf6
  s_waitcnt vmcnt(1)
  v_mfma_f32_32x32x16_bf16 v[72:87], v[108:111], a[24:27], v[72:87]
  v_bitop3_b32 v7, v7, v168, s96 bitop3:0xf6
  v_bitop3_b32 v7, v7, v172, s96 bitop3:0xf6
  v_bitop3_b32 v7, v7, v176, s96 bitop3:0xf6
  v_bitop3_b32 v7, v7, v180, s96 bitop3:0xf6
  v_and_b32 v7, v254, v7
  v_cmp_ne_u32 vcc, 0, v7
  s_cbranch_vccnz o_rt_161
o_bk_162:
  v_mfma_f32_32x32x16_bf16 v[88:103], v[108:111], a[28:31], v[88:103]
  v_smfmac_f32_16x16x64_bf16 v[188:191], v[16:19], v[120:127], v20
  v_lshlrev_b32 v196, 16, v184
  v_smfmac_f32_16x16x64_bf16 v[192:195], v[16:19], v[128:135], v20
  v_and_b32 v197, 0xffff0000, v184
  v_smfmac_f32_16x16x64_bf16 v[188:191], v[16:19], v[136:143], v20
  v_lshlrev_b32 v198, 16, v185
  s_waitcnt lgkmcnt(2)
  v_mfma_f32_32x32x16_bf16 v[40:55], v[112:115], a[32:35], v[40:55]
  v_smfmac_f32_16x16x64_bf16 v[192:195], v[16:19], v[144:151], v20
  v_and_b32 v199, 0xffff0000, v185
  v_smfmac_f32_16x16x64_bf16 v[188:191], v[16:19], v[152:159], v20
  v_lshlrev_b32 v200, 16, v186
  v_smfmac_f32_16x16x64_bf16 v[192:195], v[16:19], v[160:167], v20
  v_and_b32 v201, 0xffff0000, v186
  v_mfma_f32_32x32x16_bf16 v[56:71], v[112:115], a[36:39], v[56:71]
  ds_read_b128 v[108:111], v3 offset:2560
  v_smfmac_f32_16x16x64_bf16 v[188:191], v[16:19], v[168:175], v20
  v_lshlrev_b32 v202, 16, v187
  v_smfmac_f32_16x16x64_bf16 v[192:195], v[16:19], v[176:183], v20
  v_and_b32 v203, 0xffff0000, v187
  s_bfe_u32 s92, s65, 131086
  v_mfma_f32_32x32x16_bf16 v[72:87], v[112:115], a[40:43], v[72:87]
  s_lshl_b32 s92, s92, 21
  s_add_u32 s92, s92, s91
  s_add_u32 s93, s92, 27262976
  s_add_u32 s92, s92, 20971520
  v_permlane16_swap_b32 v188, v192
  v_mfma_f32_32x32x16_bf16 v[88:103], v[112:115], a[44:47], v[88:103]
  v_permlane16_swap_b32 v189, v193
  v_permlane16_swap_b32 v190, v194
  v_permlane16_swap_b32 v191, v195
  s_waitcnt lgkmcnt(2)
  v_mfma_f32_32x32x16_bf16 v[40:55], v[116:119], a[48:51], v[40:55]
  v_cvt_pk_bf16_f32 v188, 0, v188
  v_cvt_pk_bf16_f32 v189, 0, v189
  v_cvt_pk_bf16_f32 v190, 0, v190
  v_cvt_pk_bf16_f32 v191, 0, v191
  v_cvt_pk_bf16_f32 v192, 0, v192
  v_cvt_pk_bf16_f32 v193, 0, v193
  v_mfma_f32_32x32x16_bf16 v[56:71], v[116:119], a[52:55], v[56:71]
  ds_read_b128 v[112:115], v3 offset:3072
  v_cvt_pk_bf16_f32 v194, 0, v194
  v_cvt_pk_bf16_f32 v195, 0, v195
  v_add_f32 v196, v196, v188
  v_add_f32 v197, v197, v189
  v_add_f32 v198, v198, v190
  v_mfma_f32_32x32x16_bf16 v[72:87], v[116:119], a[56:59], v[72:87]
  v_add_f32 v199, v199, v191
  v_add_f32 v200, v200, v192
  v_add_f32 v201, v201, v193
  v_add_f32 v202, v202, v194
  v_add_f32 v203, v203, v195
  v_cvt_pk_bf16_f32 v120, v196, v197
  v_mfma_f32_32x32x16_bf16 v[88:103], v[116:119], a[60:63], v[88:103]
  v_cvt_pk_bf16_f32 v121, v198, v199
  v_cvt_pk_bf16_f32 v122, v200, v201
  v_cvt_pk_bf16_f32 v123, v202, v203
  v_lshlrev_b32 v196, 16, v120
  v_and_b32 v197, 0xffff0000, v120
  s_waitcnt lgkmcnt(2)
  v_mfma_f32_32x32x16_bf16 v[40:55], v[104:107], a[64:67], v[40:55]
  v_lshlrev_b32 v198, 16, v121
  v_and_b32 v199, 0xffff0000, v121
  v_lshlrev_b32 v200, 16, v122
  v_and_b32 v201, 0xffff0000, v122
  v_lshlrev_b32 v202, 16, v123
  v_and_b32 v203, 0xffff0000, v123
  v_mfma_f32_32x32x16_bf16 v[56:71], v[104:107], a[68:71], v[56:71]
  ds_read_b128 v[116:119], v3 offset:3584
  buffer_store_dwordx4 v[120:123], v0, s[4:7], s92 offen sc1
  v_add_f32 v136, v196, v197
  v_mul_f32 v137, v196, v196
  v_mfma_f32_32x32x16_bf16 v[72:87], v[104:107], a[72:75], v[72:87]
  v_add_f32 v138, v198, v199
  v_mul_f32 v139, v197, v197
  v_fmac_f32 v137, v198, v198
  v_fmac_f32 v139, v199, v199
  v_add_f32 v136, v136, v200
  v_fmac_f32 v137, v200, v200
  v_mfma_f32_32x32x16_bf16 v[88:103], v[104:107], a[76:79], v[88:103]
  v_add_f32 v138, v138, v201
  v_fmac_f32 v139, v201, v201
  v_add_f32 v136, v136, v202
  v_fmac_f32 v137, v202, v202
  v_add_f32 v138, v138, v203
  s_waitcnt lgkmcnt(2)
  v_mfma_f32_32x32x16_bf16 v[40:55], v[108:111], a[80:83], v[40:55]
  v_fmac_f32 v139, v203, v203
  v_add_f32 v136, v136, v138
  v_add_f32 v137, v137, v139
  s_nop 0
  v_add_f32_dpp v136, v136, v136 row_ror:8 row_mask:0xf bank_mask:0xf
  v_add_f32_dpp v137, v137, v137 row_ror:8 row_mask:0xf bank_mask:0xf
  s_nop 0
  v_add_f32_dpp v136, v136, v136 row_ror:4 row_mask:0xf bank_mask:0xf
  v_mfma_f32_32x32x16_bf16 v[56:71], v[108:111], a[84:87], v[56:71]
  ds_read_b128 v[104:107], v3 offset:8192
  v_add_f32_dpp v137, v137, v137 row_ror:4 row_mask:0xf bank_mask:0xf
  v_add_f32_dpp v136, v136, v136 row_ror:2 row_mask:0xf bank_mask:0xf
  s_nop 0
  v_add_f32_dpp v137, v137, v137 row_ror:2 row_mask:0xf bank_mask:0xf
  v_add_f32_dpp v136, v136, v136 row_ror:1 row_mask:0xf bank_mask:0xf
  s_nop 0
  v_add_f32_dpp v137, v137, v137 row_ror:1 row_mask:0xf bank_mask:0xf
  v_mfma_f32_32x32x16_bf16 v[72:87], v[108:111], a[88:91], v[72:87]
  v_mov_b32 v140, v136
  v_mov_b32 v141, v137
  s_nop 0
  v_permlane16_swap_b32 v136, v140
  v_permlane16_swap_b32 v137, v141
  v_mfma_f32_32x32x16_bf16 v[88:103], v[108:111], a[92:95], v[88:103]
  v_add_f32 v136, v136, v140
  v_add_f32 v137, v137, v141
  v_mov_b32 v140, v136
  v_mov_b32 v141, v137
  s_nop 0
  v_permlane32_swap_b32 v136, v140
  s_waitcnt lgkmcnt(2)
  v_mfma_f32_32x32x16_bf16 v[40:55], v[112:115], a[96:99], v[40:55]
  v_permlane32_swap_b32 v137, v141
  v_add_f32 v136, v136, v140
  v_add_f32 v137, v137, v141
  v_mul_f32 v136, 0x3b000000, v136
  v_mul_f32 v137, 0x3b000000, v137
  v_mfma_f32_32x32x16_bf16 v[56:71], v[112:115], a[100:103], v[56:71]
  ds_read_b128 v[108:111], v3 offset:8704
  v_fma_f32 v137, -v136, v136, v137
  v_cvt_pk_bf16_f32 v136, 0, v136
  v_max_f32 v137, 0, v137
  v_sub_f32 v140, v196, v136
  v_sub_f32 v141, v197, v136
  v_mfma_f32_32x32x16_bf16 v[72:87], v[112:115], a[104:107], v[72:87]
  v_cvt_pk_bf16_f32 v137, 0, v137
  v_sub_f32 v142, v198, v136
  v_sub_f32 v143, v199, v136
  v_add_f32 v137, 0x3727c5ac, v137
  v_sub_f32 v144, v200, v136
  v_sub_f32 v145, v201, v136
  v_mfma_f32_32x32x16_bf16 v[88:103], v[112:115], a[108:111], v[88:103]
  v_cvt_pk_bf16_f32 v137, 0, v137
  v_sub_f32 v146, v202, v136
  v_sub_f32 v147, v203, v136
  v_sqrt_f32 v137, v137
  s_waitcnt lgkmcnt(2)
  v_mfma_f32_32x32x16_bf16 v[40:55], v[116:119], a[112:115], v[40:55]
  v_cvt_pk_bf16_f32 v140, 0, v140
  v_cvt_pk_bf16_f32 v141, 0, v141
  v_cvt_pk_bf16_f32 v137, 0, v137
  v_cvt_pk_bf16_f32 v142, 0, v142
  v_cvt_pk_bf16_f32 v143, 0, v143
  v_rcp_f32 v137, v137
  v_mfma_f32_32x32x16_bf16 v[56:71], v[116:119], a[116:119], v[56:71]
  ds_read_b128 v[112:115], v3 offset:9216
  v_cvt_pk_bf16_f32 v144, 0, v144
  v_cvt_pk_bf16_f32 v145, 0, v145
  v_cvt_pk_bf16_f32 v146, 0, v146
  v_cvt_pk_bf16_f32 v147, 0, v147
  v_mul_f32 v140, v140, v137
  v_mfma_f32_32x32x16_bf16 v[72:87], v[116:119], a[120:123], v[72:87]
  v_mul_f32 v141, v141, v137
  v_mul_f32 v142, v142, v137
  v_mul_f32 v143, v143, v137
  v_mul_f32 v144, v144, v137
  v_mul_f32 v145, v145, v137
  v_mul_f32 v146, v146, v137
  v_mfma_f32_32x32x16_bf16 v[88:103], v[116:119], a[124:127], v[88:103]
  v_mul_f32 v147, v147, v137
  v_cvt_pk_bf16_f32 v124, v140, v141
  v_cvt_pk_bf16_f32 v125, v142, v143
  v_cvt_pk_bf16_f32 v126, v144, v145
  v_cvt_pk_bf16_f32 v127, v146, v147
  s_waitcnt lgkmcnt(2)
  v_mfma_f32_32x32x16_bf16 v[40:55], v[104:107], a[128:131], v[40:55]
  v_lshlrev_b32 v204, 16, v124
  v_and_b32 v205, 0xffff0000, v124
  v_lshlrev_b32 v206, 16, v125
  v_and_b32 v207, 0xffff0000, v125
  v_lshlrev_b32 v208, 16, v126
  v_and_b32 v209, 0xffff0000, v126
  v_mfma_f32_32x32x16_bf16 v[56:71], v[104:107], a[132:135], v[56:71]
  ds_read_b128 v[116:119], v3 offset:9728
  v_lshlrev_b32 v210, 16, v127
  v_and_b32 v211, 0xffff0000, v127
  buffer_store_dwordx4 v[124:127], v0, s[4:7], s93 offen sc1
  v_mfma_f32_32x32x16_bf16 v[72:87], v[104:107], a[136:139], v[72:87]
  v_add_f32 v196, v196, v204
  v_add_f32 v197, v197, v205
  v_add_f32 v198, v198, v206
  v_add_f32 v199, v199, v207
  v_add_f32 v200, v200, v208
  v_add_f32 v201, v201, v209
  v_mfma_f32_32x32x16_bf16 v[88:103], v[104:107], a[140:143], v[88:103]
  v_add_f32 v202, v202, v210
  v_add_f32 v203, v203, v211
  v_cvt_pk_bf16_f32 v128, v196, v197
  v_cvt_pk_bf16_f32 v129, v198, v199
  v_cvt_pk_bf16_f32 v130, v200, v201
  s_waitcnt lgkmcnt(2)
  v_mfma_f32_32x32x16_bf16 v[40:55], v[108:111], a[144:147], v[40:55]
  v_cvt_pk_bf16_f32 v131, v202, v203
  v_mul_f32 v188, v204, v8
  v_mul_f32 v189, v205, v9
  v_fmac_f32 v188, v206, v10
  v_fmac_f32 v189, v207, v11
  v_fmac_f32 v188, v208, v12
  v_mfma_f32_32x32x16_bf16 v[56:71], v[108:111], a[148:151], v[56:71]
  ds_read_b128 v[104:107], v3 offset:10240
  v_fmac_f32 v189, v209, v13
  v_fmac_f32 v188, v210, v14
  v_fmac_f32 v189, v211, v15
  v_add_f32 v188, v188, v189
  s_add_u32 s92, s91, 10485760
  v_mfma_f32_32x32x16_bf16 v[72:87], v[108:111], a[152:155], v[72:87]
  s_add_u32 s93, s91, 8388608
  buffer_store_dwordx4 v[128:131], v0, s[4:7], s92 offen sc1
  v_lshlrev_b32 v196, 16, v128
  v_and_b32 v197, 0xffff0000, v128
  v_mfma_f32_32x32x16_bf16 v[88:103], v[108:111], a[156:159], v[88:103]
  v_lshlrev_b32 v198, 16, v129
  v_and_b32 v199, 0xffff0000, v129
  v_lshlrev_b32 v200, 16, v130
  v_and_b32 v201, 0xffff0000, v130
  v_lshlrev_b32 v202, 16, v131
  s_waitcnt lgkmcnt(2)
  v_mfma_f32_32x32x16_bf16 v[40:55], v[112:115], a[160:163], v[40:55]
  v_and_b32 v203, 0xffff0000, v131
  v_add_f32 v136, v196, v197
  v_mul_f32 v137, v196, v196
  v_add_f32 v138, v198, v199
  v_mul_f32 v139, v197, v197
  v_fmac_f32 v137, v198, v198
  v_mfma_f32_32x32x16_bf16 v[56:71], v[112:115], a[164:167], v[56:71]
  ds_read_b128 v[108:111], v3 offset:10752
  v_fmac_f32 v139, v199, v199
  v_add_f32 v136, v136, v200
  v_fmac_f32 v137, v200, v200
  v_add_f32 v138, v138, v201
  v_fmac_f32 v139, v201, v201
  v_mfma_f32_32x32x16_bf16 v[72:87], v[112:115], a[168:171], v[72:87]
  v_add_f32 v136, v136, v202
  v_fmac_f32 v137, v202, v202
  v_add_f32 v138, v138, v203
  v_fmac_f32 v139, v203, v203
  v_add_f32 v136, v136, v138
  v_add_f32 v137, v137, v139
  v_mfma_f32_32x32x16_bf16 v[88:103], v[112:115], a[172:175], v[88:103]
  v_add_f32_dpp v136, v136, v136 row_ror:8 row_mask:0xf bank_mask:0xf
  v_add_f32_dpp v137, v137, v137 row_ror:8 row_mask:0xf bank_mask:0xf
  v_add_f32_dpp v188, v188, v188 row_ror:8 row_mask:0xf bank_mask:0xf
  v_add_f32_dpp v136, v136, v136 row_ror:4 row_mask:0xf bank_mask:0xf
  v_add_f32_dpp v137, v137, v137 row_ror:4 row_mask:0xf bank_mask:0xf
  s_waitcnt lgkmcnt(2)
  v_mfma_f32_32x32x16_bf16 v[40:55], v[116:119], a[176:179], v[40:55]
  v_add_f32_dpp v188, v188, v188 row_ror:4 row_mask:0xf bank_mask:0xf
  v_add_f32_dpp v136, v136, v136 row_ror:2 row_mask:0xf bank_mask:0xf
  v_add_f32_dpp v137, v137, v137 row_ror:2 row_mask:0xf bank_mask:0xf
  v_add_f32_dpp v188, v188, v188 row_ror:2 row_mask:0xf bank_mask:0xf
  v_add_f32_dpp v136, v136, v136 row_ror:1 row_mask:0xf bank_mask:0xf
  v_add_f32_dpp v137, v137, v137 row_ror:1 row_mask:0xf bank_mask:0xf
  v_mfma_f32_32x32x16_bf16 v[56:71], v[116:119], a[180:183], v[56:71]
  ds_read_b128 v[112:115], v3 offset:11264
  v_add_f32_dpp v188, v188, v188 row_ror:1 row_mask:0xf bank_mask:0xf
  v_mov_b32 v140, v136
  v_mov_b32 v141, v137
  v_mov_b32 v142, v188
  v_permlane16_swap_b32 v136, v140
  v_mfma_f32_32x32x16_bf16 v[72:87], v[116:119], a[184:187], v[72:87]
  v_permlane16_swap_b32 v137, v141
  v_permlane16_swap_b32 v188, v142
  v_add_f32 v136, v136, v140
  v_add_f32 v137, v137, v141
  v_mfma_f32_32x32x16_bf16 v[88:103], v[116:119], a[188:191], v[88:103]
  v_add_f32 v188, v188, v142
  v_mov_b32 v140, v136
  v_mov_b32 v141, v137
  v_mov_b32 v142, v188
  v_permlane32_swap_b32 v136, v140
  s_waitcnt lgkmcnt(2)
  v_mfma_f32_32x32x16_bf16 v[40:55], v[104:107], a[192:195], v[40:55]
  v_permlane32_swap_b32 v137, v141
  v_permlane32_swap_b32 v188, v142
  v_add_f32 v136, v136, v140
  v_add_f32 v137, v137, v141
  v_mfma_f32_32x32x16_bf16 v[56:71], v[104:107], a[196:199], v[56:71]
  ds_read_b128 v[116:119], v3 offset:11776
  v_add_f32 v188, v188, v142
  v_mul_f32 v136, 0x3b000000, v136
  v_mul_f32 v137, 0x3b000000, v137
  v_fma_f32 v137, -v136, v136, v137
  v_cvt_pk_bf16_f32 v136, 0, v136
  s_waitcnt lgkmcnt(2)
  v_mfma_f32_32x32x16_bf16 v[40:55], v[108:111], a[208:211], v[40:55]
  v_max_f32 v137, 0, v137
  v_sub_f32 v140, v196, v136
  v_sub_f32 v141, v197, v136
  v_cvt_pk_bf16_f32 v137, 0, v137
  v_sub_f32 v142, v198, v136
  v_sub_f32 v143, v199, v136
  v_mfma_f32_32x32x16_bf16 v[56:71], v[108:111], a[212:215], v[56:71]
  v_add_f32 v137, 0x3727c5ac, v137
  v_sub_f32 v144, v200, v136
  v_sub_f32 v145, v201, v136
  v_cvt_pk_bf16_f32 v137, 0, v137
  v_sub_f32 v146, v202, v136
  v_sub_f32 v147, v203, v136
  s_waitcnt lgkmcnt(1)
  v_mfma_f32_32x32x16_bf16 v[40:55], v[112:115], a[224:227], v[40:55]
  v_sqrt_f32 v137, v137
  v_cvt_pk_bf16_f32 v140, 0, v140
  v_cvt_pk_bf16_f32 v141, 0, v141
  v_cvt_pk_bf16_f32 v137, 0, v137
  v_cvt_pk_bf16_f32 v142, 0, v142
  v_mfma_f32_32x32x16_bf16 v[56:71], v[112:115], a[228:231], v[56:71]
  v_cvt_pk_bf16_f32 v143, 0, v143
  v_rcp_f32 v137, v137
  v_cvt_pk_bf16_f32 v144, 0, v144
  v_cvt_pk_bf16_f32 v145, 0, v145
  v_cvt_pk_bf16_f32 v146, 0, v146
  s_waitcnt lgkmcnt(0)
  v_mfma_f32_32x32x16_bf16 v[40:55], v[116:119], a[240:243], v[40:55]
  v_cvt_pk_bf16_f32 v147, 0, v147
  v_mul_f32 v140, v140, v137
  v_mul_f32 v141, v141, v137
  v_mul_f32 v142, v142, v137
  v_mul_f32 v143, v143, v137
  v_mul_f32 v144, v144, v137
  v_mfma_f32_32x32x16_bf16 v[56:71], v[116:119], a[244:247], v[56:71]
  v_mul_f32 v145, v145, v137
  v_mul_f32 v146, v146, v137
  v_mul_f32 v147, v147, v137
  v_cvt_pk_bf16_f32 v132, v140, v141
  v_cvt_pk_bf16_f32 v133, v142, v143
  v_cvt_pk_bf16_f32 v134, v144, v145
  v_mfma_f32_32x32x16_bf16 v[72:87], v[104:107], a[200:203], v[72:87]
  v_cvt_pk_bf16_f32 v135, v146, v147
  buffer_store_dwordx4 v[132:135], v0, s[4:7], s93 offen sc1
  v_cvt_pk_bf16_f32 v188, 0, v188
  v_ashrrev_i32 v189, 31, v188
  v_mfma_f32_32x32x16_bf16 v[88:103], v[104:107], a[204:207], v[88:103]
  v_or_b32 v189, 0x80000000, v189
  v_xor_b32 v188, v188, v189
  s_sub_u32 s92, 4095, s90
  v_and_b32 v188, 0xffff0000, v188
  v_or_b32 v38, s92, v188
  v_mfma_f32_32x32x16_bf16 v[72:87], v[108:111], a[216:219], v[72:87]
  s_bfe_u32 s92, s65, 196625
  s_lshl_b32 s92, s92, 18
  s_lshl_b32 s93, s90, 7
  s_add_u32 s92, s92, s93
  s_add_u32 s84, s92, 243269632
  v_cvt_pk_bf16_f32 v212, v40, v56
  v_mfma_f32_32x32x16_bf16 v[88:103], v[108:111], a[220:223], v[88:103]
  v_cvt_pk_bf16_f32 v214, v41, v57
  v_cvt_pk_bf16_f32 v216, v42, v58
  v_cvt_pk_bf16_f32 v218, v43, v59
  v_permlane16_swap_b32 v212, v214
  v_mfma_f32_32x32x16_bf16 v[72:87], v[112:115], a[232:235], v[72:87]
  v_cvt_pk_bf16_f32 v220, v44, v60
  v_cvt_pk_bf16_f32 v222, v45, v61
  v_permlane16_swap_b32 v216, v218
  v_bfi_b32 v212, v254, s42, v212
  v_cvt_pk_bf16_f32 v224, v46, v62
  v_mfma_f32_32x32x16_bf16 v[88:103], v[112:115], a[236:239], v[88:103]
  v_cvt_pk_bf16_f32 v226, v47, v63
  v_permlane16_swap_b32 v220, v222
  v_bfi_b32 v216, v254, s42, v216
  v_cvt_pk_bf16_f32 v228, v48, v64
  v_mfma_f32_32x32x16_bf16 v[72:87], v[116:119], a[248:251], v[72:87]
  v_cvt_pk_bf16_f32 v230, v49, v65
  v_permlane16_swap_b32 v224, v226
  v_bfi_b32 v220, v254, s42, v220
  v_cvt_pk_bf16_f32 v232, v50, v66
  v_cvt_pk_bf16_f32 v234, v51, v67
  v_mfma_f32_32x32x16_bf16 v[88:103], v[116:119], a[252:255], v[88:103]
  v_permlane16_swap_b32 v228, v230
  v_bfi_b32 v224, v254, s42, v224
  v_cvt_pk_bf16_f32 v236, v52, v68
  v_cvt_pk_bf16_f32 v238, v53, v69
  v_permlane16_swap_b32 v232, v234
  v_bfi_b32 v228, v254, s42, v228
  v_cvt_pk_bf16_f32 v240, v54, v70
  v_cvt_pk_bf16_f32 v242, v55, v71
  v_permlane16_swap_b32 v236, v238
  v_bfi_b32 v232, v254, s42, v232
  v_permlane16_swap_b32 v240, v242
  v_bfi_b32 v236, v254, s42, v236
  v_bfi_b32 v240, v254, s42, v240
  v_cvt_pk_bf16_f32 v213, v72, v88
  v_cvt_pk_bf16_f32 v215, v73, v89
  v_cvt_pk_bf16_f32 v217, v74, v90
  v_cvt_pk_bf16_f32 v219, v75, v91
  s_add_u32 s78, s86, 0
  v_permlane16_swap_b32 v213, v215
  buffer_store_dwordx4 v[212:215], v4, s[4:7], s78 offen sc1
  v_cvt_pk_bf16_f32 v221, v76, v92
  v_cvt_pk_bf16_f32 v223, v77, v93
  s_add_u32 s78, s86, 32768
  v_permlane16_swap_b32 v217, v219
  buffer_store_dwordx4 v[216:219], v4, s[4:7], s78 offen sc1
  v_cvt_pk_bf16_f32 v225, v78, v94
  v_cvt_pk_bf16_f32 v227, v79, v95
  s_add_u32 s78, s86, 131072
  v_permlane16_swap_b32 v221, v223
  buffer_store_dwordx4 v[220:223], v4, s[4:7], s78 offen sc1
  v_cvt_pk_bf16_f32 v229, v80, v96
  v_cvt_pk_bf16_f32 v231, v81, v97
  s_add_u32 s78, s86, 163840
  v_permlane16_swap_b32 v225, v227
  buffer_store_dwordx4 v[224:227], v4, s[4:7], s78 offen sc1
  v_cvt_pk_bf16_f32 v233, v82, v98
  v_cvt_pk_bf16_f32 v235, v83, v99
  s_add_u32 s78, s86, 262144
  v_permlane16_swap_b32 v229, v231
  buffer_store_dwordx4 v[228:231], v4, s[4:7], s78 offen sc1
  v_cvt_pk_bf16_f32 v237, v84, v100
  v_cvt_pk_bf16_f32 v239, v85, v101
  s_add_u32 s78, s86, 294912
  v_permlane16_swap_b32 v233, v235
  buffer_store_dwordx4 v[232:235], v4, s[4:7], s78 offen sc1
  v_cvt_pk_bf16_f32 v241, v86, v102
  v_cvt_pk_bf16_f32 v243, v87, v103
  s_add_u32 s78, s86, 393216
  v_permlane16_swap_b32 v237, v239
  buffer_store_dwordx4 v[236:239], v4, s[4:7], s78 offen sc1
  s_add_u32 s78, s86, 425984
  v_permlane16_swap_b32 v241, v243
  buffer_store_dwordx4 v[240:243], v4, s[4:7], s78 offen sc1
  s_waitcnt vmcnt(8)
  s_mov_b64 exec, 1
  buffer_store_dword v38, off, s[4:7], s84 sc1
  s_mov_b64 exec, -1
  s_mov_b32 s84, 268435456
  s_branch o_we_153
o_rt_161:
  s_mov_b32 s67, 0
o_rl_165:
  s_lshl_b32 s94, s43, 14
  s_add_u32 s94, s94, s95
  buffer_load_dwordx4 v[120:123], v5, s[4:7], s94 offen offset:0 sc1
  buffer_load_dwordx4 v[124:127], v5, s[4:7], s94 offen offset:512 sc1
  buffer_load_dwordx4 v[128:131], v5, s[4:7], s94 offen offset:256 sc1
  buffer_load_dwordx4 v[132:135], v5, s[4:7], s94 offen offset:768 sc1
  s_add_u32 s94, s94, 4096
  buffer_load_dwordx4 v[136:139], v5, s[4:7], s94 offen offset:0 sc1
  buffer_load_dwordx4 v[140:143], v5, s[4:7], s94 offen offset:512 sc1
  buffer_load_dwordx4 v[144:147], v5, s[4:7], s94 offen offset:256 sc1
  buffer_load_dwordx4 v[148:151], v5, s[4:7], s94 offen offset:768 sc1
  s_add_u32 s94, s94, 4096
  buffer_load_dwordx4 v[152:155], v5, s[4:7], s94 offen offset:0 sc1
  buffer_load_dwordx4 v[156:159], v5, s[4:7], s94 offen offset:512 sc1
  buffer_load_dwordx4 v[160:163], v5, s[4:7], s94 offen offset:256 sc1
  buffer_load_dwordx4 v[164:167], v5, s[4:7], s94 offen offset:768 sc1
  s_add_u32 s94, s94, 4096
  buffer_load_dwordx4 v[168:171], v5, s[4:7], s94 offen offset:0 sc1
  buffer_load_dwordx4 v[172:175], v5, s[4:7], s94 offen offset:512 sc1
  buffer_load_dwordx4 v[176:179], v5, s[4:7], s94 offen offset:256 sc1
  buffer_load_dwordx4 v[180:183], v5, s[4:7], s94 offen offset:768 sc1
  s_add_u32 s67, s67, 1
  s_cmp_gt_u32 s67, 1048576
  s_cbranch_scc1 L_end
  s_waitcnt vmcnt(0)
  v_xor_b32 v7, s96, v120
  v_bitop3_b32 v7, v7, v124, s96 bitop3:0xf6
  v_bitop3_b32 v7, v7, v128, s96 bitop3:0xf6
  v_bitop3_b32 v7, v7, v132, s96 bitop3:0xf6
  v_bitop3_b32 v7, v7, v136, s96 bitop3:0xf6
  v_bitop3_b32 v7, v7, v140, s96 bitop3:0xf6
  v_bitop3_b32 v7, v7, v144, s96 bitop3:0xf6
  v_bitop3_b32 v7, v7, v148, s96 bitop3:0xf6
  v_bitop3_b32 v7, v7, v152, s96 bitop3:0xf6
  v_bitop3_b32 v7, v7, v156, s96 bitop3:0xf6
  v_bitop3_b32 v7, v7, v160, s96 bitop3:0xf6
  v_bitop3_b32 v7, v7, v164, s96 bitop3:0xf6
  v_bitop3_b32 v7, v7, v168, s96 bitop3:0xf6
  v_bitop3_b32 v7, v7, v172, s96 bitop3:0xf6
  v_bitop3_b32 v7, v7, v176, s96 bitop3:0xf6
  v_bitop3_b32 v7, v7, v180, s96 bitop3:0xf6
  v_and_b32 v7, v254, v7
  v_cmp_ne_u32 vcc, 0, v7
  s_cbranch_vccnz o_rl_165
  s_branch o_bk_162
o_rt_163:
  s_mov_b32 s67, 0
o_rl_166:
  s_lshl_b32 s94, s43, 14
  s_add_u32 s94, s94, s95
  buffer_load_dwordx4 v[120:123], v5, s[4:7], s94 offen offset:0 sc1
  buffer_load_dwordx4 v[124:127], v5, s[4:7], s94 offen offset:512 sc1
  buffer_load_dwordx4 v[128:131], v5, s[4:7], s94 offen offset:256 sc1
  buffer_load_dwordx4 v[132:135], v5, s[4:7], s94 offen offset:768 sc1
  s_add_u32 s94, s94, 4096
  buffer_load_dwordx4 v[136:139], v5, s[4:7], s94 offen offset:0 sc1
  buffer_load_dwordx4 v[140:143], v5, s[4:7], s94 offen offset:512 sc1
  buffer_load_dwordx4 v[144:147], v5, s[4:7], s94 offen offset:256 sc1
  buffer_load_dwordx4 v[148:151], v5, s[4:7], s94 offen offset:768 sc1
  s_add_u32 s94, s94, 4096
  buffer_load_dwordx4 v[152:155], v5, s[4:7], s94 offen offset:0 sc1
  buffer_load_dwordx4 v[156:159], v5, s[4:7], s94 offen offset:512 sc1
  buffer_load_dwordx4 v[160:163], v5, s[4:7], s94 offen offset:256 sc1
  buffer_load_dwordx4 v[164:167], v5, s[4:7], s94 offen offset:768 sc1
  s_add_u32 s94, s94, 4096
  buffer_load_dwordx4 v[168:171], v5, s[4:7], s94 offen offset:0 sc1
  buffer_load_dwordx4 v[172:175], v5, s[4:7], s94 offen offset:512 sc1
  buffer_load_dwordx4 v[176:179], v5, s[4:7], s94 offen offset:256 sc1
  buffer_load_dwordx4 v[180:183], v5, s[4:7], s94 offen offset:768 sc1
  s_add_u32 s67, s67, 1
  s_cmp_gt_u32 s67, 1048576
  s_cbranch_scc1 L_end
  s_waitcnt vmcnt(0)
  v_xor_b32 v7, s96, v120
  v_bitop3_b32 v7, v7, v124, s96 bitop3:0xf6
  v_bitop3_b32 v7, v7, v128, s96 bitop3:0xf6
  v_bitop3_b32 v7, v7, v132, s96 bitop3:0xf6
  v_bitop3_b32 v7, v7, v136, s96 bitop3:0xf6
  v_bitop3_b32 v7, v7, v140, s96 bitop3:0xf6
  v_bitop3_b32 v7, v7, v144, s96 bitop3:0xf6
  v_bitop3_b32 v7, v7, v148, s96 bitop3:0xf6
  v_bitop3_b32 v7, v7, v152, s96 bitop3:0xf6
  v_bitop3_b32 v7, v7, v156, s96 bitop3:0xf6
  v_bitop3_b32 v7, v7, v160, s96 bitop3:0xf6
  v_bitop3_b32 v7, v7, v164, s96 bitop3:0xf6
  v_bitop3_b32 v7, v7, v168, s96 bitop3:0xf6
  v_bitop3_b32 v7, v7, v172, s96 bitop3:0xf6
  v_bitop3_b32 v7, v7, v176, s96 bitop3:0xf6
  v_bitop3_b32 v7, v7, v180, s96 bitop3:0xf6
  v_and_b32 v7, v254, v7
  v_cmp_ne_u32 vcc, 0, v7
  s_cbranch_vccnz o_rl_166
  s_branch o_bk_164
o_fb_155:
  v_mov_b32 v118, v116
  s_nop 1
  v_permlane16_swap_b32 v116, v118
  v_max_f32 v116, v116, v118
  v_mov_b32 v118, v116
  s_nop 0
  s_nop 0
  v_permlane32_swap_b32 v116, v118
  v_max_f32 v116, v116, v118
  v_sub_f32 v56, v104, v116
  v_sub_f32 v57, v105, v116
  v_sub_f32 v58, v106, v116
  v_sub_f32 v59, v107, v116
  v_sub_f32 v60, v108, v116
  v_sub_f32 v61, v109, v116
  v_sub_f32 v62, v110, v116
  v_sub_f32 v63, v111, v116
  v_sub_f32 v64, v112, v116
  v_sub_f32 v65, v113, v116
  v_exp_f32 v56, v56
  v_exp_f32 v57, v57
  v_exp_f32 v58, v58
  v_exp_f32 v59, v59
  v_exp_f32 v60, v60
  v_exp_f32 v61, v61
  v_exp_f32 v62, v62
  v_exp_f32 v63, v63
  v_exp_f32 v64, v64
  v_exp_f32 v65, v65
  v_add_f32 v117, v56, v57
  v_add_f32 v117, v117, v58
  v_add_f32 v117, v117, v59
  v_add_f32 v117, v117, v60
  v_add_f32 v117, v117, v61
  v_add_f32 v117, v117, v62
  v_add_f32 v117, v117, v63
  v_add_f32 v117, v117, v64
  v_add_f32 v117, v117, v65
  v_mov_b32 v118, v117
  s_nop 0
  s_nop 0
  v_permlane16_swap_b32 v117, v118
  v_add_f32 v117, v117, v118
  v_mov_b32 v118, v117
  s_nop 0
  s_nop 0
  v_permlane32_swap_b32 v117, v118
  v_add_f32 v117, v117, v118
  v_rcp_f32 v117, v117
  s_branch o_fbr_156
o_fb_157:
  v_mov_b32 v118, v116
  s_nop 1
  v_permlane16_swap_b32 v116, v118
  v_max_f32 v116, v116, v118
  v_mov_b32 v118, v116
  s_nop 0
  s_nop 0
  v_permlane32_swap_b32 v116, v118
  v_max_f32 v116, v116, v118
  v_sub_f32 v56, v104, v116
  v_sub_f32 v57, v105, v116
  v_sub_f32 v58, v106, v116
  v_sub_f32 v59, v107, v116
  v_sub_f32 v60, v108, v116
  v_sub_f32 v61, v109, v116
  v_sub_f32 v62, v110, v116
  v_sub_f32 v63, v111, v116
  v_sub_f32 v64, v112, v116
  v_sub_f32 v65, v113, v116
  v_exp_f32 v56, v56
  v_exp_f32 v57, v57
  v_exp_f32 v58, v58
  v_exp_f32 v59, v59
  v_exp_f32 v60, v60
  v_exp_f32 v61, v61
  v_exp_f32 v62, v62
  v_exp_f32 v63, v63
  v_exp_f32 v64, v64
  v_exp_f32 v65, v65
  v_add_f32 v117, v56, v57
  v_add_f32 v117, v117, v58
  v_add_f32 v117, v117, v59
  v_add_f32 v117, v117, v60
  v_add_f32 v117, v117, v61
  v_add_f32 v117, v117, v62
  v_add_f32 v117, v117, v63
  v_add_f32 v117, v117, v64
  v_add_f32 v117, v117, v65
  v_mov_b32 v118, v117
  s_nop 0
  s_nop 0
  v_permlane16_swap_b32 v117, v118
  v_add_f32 v117, v117, v118
  v_mov_b32 v118, v117
  s_nop 0
  s_nop 0
  v_permlane32_swap_b32 v117, v118
  v_add_f32 v117, v117, v118
  v_rcp_f32 v117, v117
  s_branch o_fbr_158
o_wr2_152:
  s_waitcnt lgkmcnt(0)
  s_barrier
  ds_read_b128 v[104:107], v3 offset:0
  ds_read_b128 v[108:111], v3 offset:512
  ds_read_b128 v[112:115], v3 offset:1024
  buffer_load_dwordx4 v[176:179], v5, s[4:7], s94 offen offset:256 sc1
  buffer_load_dwordx4 v[180:183], v5, s[4:7], s94 offen offset:768 sc1
  s_waitcnt lgkmcnt(2)
  v_mfma_f32_32x32x16_bf16 v[40:55], v[104:107], a[0:3], 0
  v_mov_b64 v[188:189], 0
  v_mov_b64 v[190:191], 0
  v_mov_b64 v[192:193], 0
  v_mov_b64 v[194:195], 0
  s_mov_b64 exec, 1
  buffer_store_dword v38, off, s[4:7], s84 sc1
  s_mov_b64 exec, -1
  s_mov_b32 s84, 268435456
  v_mfma_f32_32x32x16_bf16 v[56:71], v[104:107], a[4:7], 0
  ds_read_b128 v[116:119], v3 offset:1536
  v_mfma_f32_32x32x16_bf16 v[72:87], v[104:107], a[8:11], 0
  v_mfma_f32_32x32x16_bf16 v[88:103], v[104:107], a[12:15], 0
  s_waitcnt vmcnt(13)
  v_xor_b32 v7, s96, v120
  v_bitop3_b32 v7, v7, v124, s96 bitop3:0xf6
  v_bitop3_b32 v7, v7, v128, s96 bitop3:0xf6
  v_bitop3_b32 v7, v7, v132, s96 bitop3:0xf6
  s_waitcnt lgkmcnt(2)
  v_mfma_f32_32x32x16_bf16 v[40:55], v[108:111], a[16:19], v[40:55]
  s_waitcnt vmcnt(9)
  v_bitop3_b32 v7, v7, v136, s96 bitop3:0xf6
  v_bitop3_b32 v7, v7, v140, s96 bitop3:0xf6
  v_bitop3_b32 v7, v7, v144, s96 bitop3:0xf6
  v_bitop3_b32 v7, v7, v148, s96 bitop3:0xf6
  s_waitcnt vmcnt(5)
  v_mfma_f32_32x32x16_bf16 v[56:71], v[108:111], a[20:23], v[56:71]
  ds_read_b128 v[104:107], v3 offset:2048
  v_bitop3_b32 v7, v7, v152, s96 bitop3:0xf6
  v_bitop3_b32 v7, v7, v156, s96 bitop3:0xf6
  v_bitop3_b32 v7, v7, v160, s96 bitop3:0xf6
  v_bitop3_b32 v7, v7, v164, s96 bitop3:0xf6
  s_waitcnt vmcnt(1)
  v_mfma_f32_32x32x16_bf16 v[72:87], v[108:111], a[24:27], v[72:87]
  v_bitop3_b32 v7, v7, v168, s96 bitop3:0xf6
  v_bitop3_b32 v7, v7, v172, s96 bitop3:0xf6
  v_bitop3_b32 v7, v7, v176, s96 bitop3:0xf6
  v_bitop3_b32 v7, v7, v180, s96 bitop3:0xf6
  v_and_b32 v7, v254, v7
  v_cmp_ne_u32 vcc, 0, v7
  s_cbranch_vccnz o_rt_163
o_bk_164:
  v_mfma_f32_32x32x16_bf16 v[88:103], v[108:111], a[28:31], v[88:103]
  v_smfmac_f32_16x16x64_bf16 v[188:191], v[16:19], v[120:127], v20
  v_lshlrev_b32 v196, 16, v184
  v_smfmac_f32_16x16x64_bf16 v[192:195], v[16:19], v[128:135], v20
  v_and_b32 v197, 0xffff0000, v184
  v_smfmac_f32_16x16x64_bf16 v[188:191], v[16:19], v[136:143], v20
  v_lshlrev_b32 v198, 16, v185
  s_waitcnt lgkmcnt(2)
  v_mfma_f32_32x32x16_bf16 v[40:55], v[112:115], a[32:35], v[40:55]
  v_smfmac_f32_16x16x64_bf16 v[192:195], v[16:19], v[144:151], v20
  v_and_b32 v199, 0xffff0000, v185
  v_smfmac_f32_16x16x64_bf16 v[188:191], v[16:19], v[152:159], v20
  v_lshlrev_b32 v200, 16, v186
  v_smfmac_f32_16x16x64_bf16 v[192:195], v[16:19], v[160:167], v20
  v_and_b32 v201, 0xffff0000, v186
  v_mfma_f32_32x32x16_bf16 v[56:71], v[112:115], a[36:39], v[56:71]
  ds_read_b128 v[108:111], v3 offset:2560
  v_smfmac_f32_16x16x64_bf16 v[188:191], v[16:19], v[168:175], v20
  v_lshlrev_b32 v202, 16, v187
  v_smfmac_f32_16x16x64_bf16 v[192:195], v[16:19], v[176:183], v20
  v_and_b32 v203, 0xffff0000, v187
  s_bfe_u32 s92, s65, 131086
  v_mfma_f32_32x32x16_bf16 v[72:87], v[112:115], a[40:43], v[72:87]
  s_lshl_b32 s92, s92, 21
  s_add_u32 s92, s92, s91
  s_add_u32 s93, s92, 27262976
  s_add_u32 s92, s92, 20971520
  v_permlane16_swap_b32 v188, v192
  v_mfma_f32_32x32x16_bf16 v[88:103], v[112:115], a[44:47], v[88:103]
  v_permlane16_swap_b32 v189, v193
  v_permlane16_swap_b32 v190, v194
  v_permlane16_swap_b32 v191, v195
  s_waitcnt lgkmcnt(2)
  v_mfma_f32_32x32x16_bf16 v[40:55], v[116:119], a[48:51], v[40:55]
  v_cvt_pk_bf16_f32 v188, 0, v188
  v_cvt_pk_bf16_f32 v189, 0, v189
  v_cvt_pk_bf16_f32 v190, 0, v190
  v_cvt_pk_bf16_f32 v191, 0, v191
  v_cvt_pk_bf16_f32 v192, 0, v192
  v_cvt_pk_bf16_f32 v193, 0, v193
  v_mfma_f32_32x32x16_bf16 v[56:71], v[116:119], a[52:55], v[56:71]
  ds_read_b128 v[112:115], v3 offset:3072
  v_cvt_pk_bf16_f32 v194, 0, v194
  v_cvt_pk_bf16_f32 v195, 0, v195
  v_add_f32 v196, v196, v188
  v_add_f32 v197, v197, v189
  v_add_f32 v198, v198, v190
  v_mfma_f32_32x32x16_bf16 v[72:87], v[116:119], a[56:59], v[72:87]
  v_add_f32 v199, v199, v191
  v_add_f32 v200, v200, v192
  v_add_f32 v201, v201, v193
  v_add_f32 v202, v202, v194
  v_add_f32 v203, v203, v195
  v_cvt_pk_bf16_f32 v120, v196, v197
  v_mfma_f32_32x32x16_bf16 v[88:103], v[116:119], a[60:63], v[88:103]
  v_cvt_pk_bf16_f32 v121, v198, v199
  v_cvt_pk_bf16_f32 v122, v200, v201
  v_cvt_pk_bf16_f32 v123, v202, v203
  v_lshlrev_b32 v196, 16, v120
  v_and_b32 v197, 0xffff0000, v120
  s_waitcnt lgkmcnt(2)
  v_mfma_f32_32x32x16_bf16 v[40:55], v[104:107], a[64:67], v[40:55]
  v_lshlrev_b32 v198, 16, v121
  v_and_b32 v199, 0xffff0000, v121
  v_lshlrev_b32 v200, 16, v122
  v_and_b32 v201, 0xffff0000, v122
  v_lshlrev_b32 v202, 16, v123
  v_and_b32 v203, 0xffff0000, v123
  v_mfma_f32_32x32x16_bf16 v[56:71], v[104:107], a[68:71], v[56:71]
  ds_read_b128 v[116:119], v3 offset:3584
  buffer_store_dwordx4 v[120:123], v0, s[4:7], s92 offen sc1
  v_add_f32 v136, v196, v197
  v_mul_f32 v137, v196, v196
  v_mfma_f32_32x32x16_bf16 v[72:87], v[104:107], a[72:75], v[72:87]
  v_add_f32 v138, v198, v199
  v_mul_f32 v139, v197, v197
  v_fmac_f32 v137, v198, v198
  v_fmac_f32 v139, v199, v199
  v_add_f32 v136, v136, v200
  v_fmac_f32 v137, v200, v200
  v_mfma_f32_32x32x16_bf16 v[88:103], v[104:107], a[76:79], v[88:103]
  v_add_f32 v138, v138, v201
  v_fmac_f32 v139, v201, v201
  v_add_f32 v136, v136, v202
  v_fmac_f32 v137, v202, v202
  v_add_f32 v138, v138, v203
  s_waitcnt lgkmcnt(2)
  v_mfma_f32_32x32x16_bf16 v[40:55], v[108:111], a[80:83], v[40:55]
  v_fmac_f32 v139, v203, v203
  v_add_f32 v136, v136, v138
  v_add_f32 v137, v137, v139
  s_nop 0
  v_add_f32_dpp v136, v136, v136 row_ror:8 row_mask:0xf bank_mask:0xf
  v_add_f32_dpp v137, v137, v137 row_ror:8 row_mask:0xf bank_mask:0xf
  s_nop 0
  v_add_f32_dpp v136, v136, v136 row_ror:4 row_mask:0xf bank_mask:0xf
  v_mfma_f32_32x32x16_bf16 v[56:71], v[108:111], a[84:87], v[56:71]
  ds_read_b128 v[104:107], v3 offset:8192
  v_add_f32_dpp v137, v137, v137 row_ror:4 row_mask:0xf bank_mask:0xf
  v_add_f32_dpp v136, v136, v136 row_ror:2 row_mask:0xf bank_mask:0xf
  s_nop 0
  v_add_f32_dpp v137, v137, v137 row_ror:2 row_mask:0xf bank_mask:0xf
  v_add_f32_dpp v136, v136, v136 row_ror:1 row_mask:0xf bank_mask:0xf
  s_nop 0
  v_add_f32_dpp v137, v137, v137 row_ror:1 row_mask:0xf bank_mask:0xf
  v_mfma_f32_32x32x16_bf16 v[72:87], v[108:111], a[88:91], v[72:87]
  v_mov_b32 v140, v136
  v_mov_b32 v141, v137
  s_nop 0
  v_permlane16_swap_b32 v136, v140
  v_permlane16_swap_b32 v137, v141
  v_mfma_f32_32x32x16_bf16 v[88:103], v[108:111], a[92:95], v[88:103]
  v_add_f32 v136, v136, v140
  v_add_f32 v137, v137, v141
  v_mov_b32 v140, v136
  v_mov_b32 v141, v137
  s_nop 0
  v_permlane32_swap_b32 v136, v140
  s_waitcnt lgkmcnt(2)
  v_mfma_f32_32x32x16_bf16 v[40:55], v[112:115], a[96:99], v[40:55]
  v_permlane32_swap_b32 v137, v141
  v_add_f32 v136, v136, v140
  v_add_f32 v137, v137, v141
  v_mul_f32 v136, 0x3b000000, v136
  v_mul_f32 v137, 0x3b000000, v137
  v_mfma_f32_32x32x16_bf16 v[56:71], v[112:115], a[100:103], v[56:71]
  ds_read_b128 v[108:111], v3 offset:8704
  v_fma_f32 v137, -v136, v136, v137
  v_cvt_pk_bf16_f32 v136, 0, v136
  v_max_f32 v137, 0, v137
  v_sub_f32 v140, v196, v136
  v_sub_f32 v141, v197, v136
  v_mfma_f32_32x32x16_bf16 v[72:87], v[112:115], a[104:107], v[72:87]
  v_cvt_pk_bf16_f32 v137, 0, v137
  v_sub_f32 v142, v198, v136
  v_sub_f32 v143, v199, v136
  v_add_f32 v137, 0x3727c5ac, v137
  v_sub_f32 v144, v200, v136
  v_sub_f32 v145, v201, v136
  v_mfma_f32_32x32x16_bf16 v[88:103], v[112:115], a[108:111], v[88:103]
  v_cvt_pk_bf16_f32 v137, 0, v137
  v_sub_f32 v146, v202, v136
  v_sub_f32 v147, v203, v136
  v_sqrt_f32 v137, v137
  s_waitcnt lgkmcnt(2)
  v_mfma_f32_32x32x16_bf16 v[40:55], v[116:119], a[112:115], v[40:55]
  v_cvt_pk_bf16_f32 v140, 0, v140
  v_cvt_pk_bf16_f32 v141, 0, v141
  v_cvt_pk_bf16_f32 v137, 0, v137
  v_cvt_pk_bf16_f32 v142, 0, v142
  v_cvt_pk_bf16_f32 v143, 0, v143
  v_rcp_f32 v137, v137
  v_mfma_f32_32x32x16_bf16 v[56:71], v[116:119], a[116:119], v[56:71]
  ds_read_b128 v[112:115], v3 offset:9216
  v_cvt_pk_bf16_f32 v144, 0, v144
  v_cvt_pk_bf16_f32 v145, 0, v145
  v_cvt_pk_bf16_f32 v146, 0, v146
  v_cvt_pk_bf16_f32 v147, 0, v147
  v_mul_f32 v140, v140, v137
  v_mfma_f32_32x32x16_bf16 v[72:87], v[116:119], a[120:123], v[72:87]
  v_mul_f32 v141, v141, v137
  v_mul_f32 v142, v142, v137
  v_mul_f32 v143, v143, v137
  v_mul_f32 v144, v144, v137
  v_mul_f32 v145, v145, v137
  v_mul_f32 v146, v146, v137
  v_mfma_f32_32x32x16_bf16 v[88:103], v[116:119], a[124:127], v[88:103]
  v_mul_f32 v147, v147, v137
  v_cvt_pk_bf16_f32 v124, v140, v141
  v_cvt_pk_bf16_f32 v125, v142, v143
  v_cvt_pk_bf16_f32 v126, v144, v145
  v_cvt_pk_bf16_f32 v127, v146, v147
  s_waitcnt lgkmcnt(2)
  v_mfma_f32_32x32x16_bf16 v[40:55], v[104:107], a[128:131], v[40:55]
  v_lshlrev_b32 v204, 16, v124
  v_and_b32 v205, 0xffff0000, v124
  v_lshlrev_b32 v206, 16, v125
  v_and_b32 v207, 0xffff0000, v125
  v_lshlrev_b32 v208, 16, v126
  v_and_b32 v209, 0xffff0000, v126
  v_mfma_f32_32x32x16_bf16 v[56:71], v[104:107], a[132:135], v[56:71]
  ds_read_b128 v[116:119], v3 offset:9728
  v_lshlrev_b32 v210, 16, v127
  v_and_b32 v211, 0xffff0000, v127
  buffer_store_dwordx4 v[124:127], v0, s[4:7], s93 offen sc1
  v_mfma_f32_32x32x16_bf16 v[72:87], v[104:107], a[136:139], v[72:87]
  v_add_f32 v196, v196, v204
  v_add_f32 v197, v197, v205
  v_add_f32 v198, v198, v206
  v_add_f32 v199, v199, v207
  v_add_f32 v200, v200, v208
  v_add_f32 v201, v201, v209
  v_mfma_f32_32x32x16_bf16 v[88:103], v[104:107], a[140:143], v[88:103]
  v_add_f32 v202, v202, v210
  v_add_f32 v203, v203, v211
  v_cvt_pk_bf16_f32 v128, v196, v197
  v_cvt_pk_bf16_f32 v129, v198, v199
  v_cvt_pk_bf16_f32 v130, v200, v201
  s_waitcnt lgkmcnt(2)
  v_mfma_f32_32x32x16_bf16 v[40:55], v[108:111], a[144:147], v[40:55]
  v_cvt_pk_bf16_f32 v131, v202, v203
  v_mul_f32 v188, v204, v8
  v_mul_f32 v189, v205, v9
  v_fmac_f32 v188, v206, v10
  v_fmac_f32 v189, v207, v11
  v_fmac_f32 v188, v208, v12
  v_mfma_f32_32x32x16_bf16 v[56:71], v[108:111], a[148:151], v[56:71]
  ds_read_b128 v[104:107], v3 offset:10240
  v_fmac_f32 v189, v209, v13
  v_fmac_f32 v188, v210, v14
  v_fmac_f32 v189, v211, v15
  v_add_f32 v188, v188, v189
  buffer_store_dwordx4 v[128:131], v0, s[68:71], s91 offen sc1
  v_mfma_f32_32x32x16_bf16 v[72:87], v[108:111], a[152:155], v[72:87]
  v_add_f32_dpp v188, v188, v188 row_ror:8 row_mask:0xf bank_mask:0xf
  s_nop 1
  v_add_f32_dpp v188, v188, v188 row_ror:4 row_mask:0xf bank_mask:0xf
  s_nop 1
  v_add_f32_dpp v188, v188, v188 row_ror:2 row_mask:0xf bank_mask:0xf
  s_nop 1
  v_add_f32_dpp v188, v188, v188 row_ror:1 row_mask:0xf bank_mask:0xf
  v_mov_b32 v189, v188
  s_nop 0
  s_nop 0
  v_permlane16_swap_b32 v188, v189
  v_mfma_f32_32x32x16_bf16 v[88:103], v[108:111], a[156:159], v[88:103]
  v_add_f32 v188, v188, v189
  v_mov_b32 v189, v188
  s_nop 0
  s_nop 0
  v_permlane32_swap_b32 v188, v189
  v_add_f32 v188, v188, v189
  s_waitcnt lgkmcnt(2)
  v_mfma_f32_32x32x16_bf16 v[40:55], v[112:115], a[160:163], v[40:55]
  v_cvt_pk_bf16_f32 v188, 0, v188
  v_ashrrev_i32 v189, 31, v188
  v_or_b32 v189, 0x80000000, v189
  v_xor_b32 v188, v188, v189
  s_sub_u32 s92, 4095, s90
  v_and_b32 v188, 0xffff0000, v188
  v_mfma_f32_32x32x16_bf16 v[56:71], v[112:115], a[164:167], v[56:71]
  ds_read_b128 v[108:111], v3 offset:10752
  v_or_b32 v38, s92, v188
  s_bfe_u32 s92, s65, 196625
  s_lshl_b32 s92, s92, 18
  s_lshl_b32 s93, s90, 7
  s_add_u32 s92, s92, s93
  v_mfma_f32_32x32x16_bf16 v[72:87], v[112:115], a[168:171], v[72:87]
  s_add_u32 s84, s92, 243269632
  v_mfma_f32_32x32x16_bf16 v[88:103], v[112:115], a[172:175], v[88:103]
  s_waitcnt lgkmcnt(2)
  v_mfma_f32_32x32x16_bf16 v[40:55], v[116:119], a[176:179], v[40:55]
  v_mfma_f32_32x32x16_bf16 v[56:71], v[116:119], a[180:183], v[56:71]
  ds_read_b128 v[112:115], v3 offset:11264
  v_mfma_f32_32x32x16_bf16 v[72:87], v[116:119], a[184:187], v[72:87]
  v_mfma_f32_32x32x16_bf16 v[88:103], v[116:119], a[188:191], v[88:103]
  s_waitcnt lgkmcnt(2)
  v_mfma_f32_32x32x16_bf16 v[40:55], v[104:107], a[192:195], v[40:55]
  v_mfma_f32_32x32x16_bf16 v[56:71], v[104:107], a[196:199], v[56:71]
  ds_read_b128 v[116:119], v3 offset:11776
  s_waitcnt lgkmcnt(2)
  v_mfma_f32_32x32x16_bf16 v[40:55], v[108:111], a[208:211], v[40:55]
  v_mfma_f32_32x32x16_bf16 v[56:71], v[108:111], a[212:215], v[56:71]
  s_waitcnt lgkmcnt(1)
  v_mfma_f32_32x32x16_bf16 v[40:55], v[112:115], a[224:227], v[40:55]
  v_mfma_f32_32x32x16_bf16 v[56:71], v[112:115], a[228:231], v[56:71]
  s_waitcnt lgkmcnt(0)
  v_mfma_f32_32x32x16_bf16 v[40:55], v[116:119], a[240:243], v[40:55]
  v_mfma_f32_32x32x16_bf16 v[56:71], v[116:119], a[244:247], v[56:71]
  v_mfma_f32_32x32x16_bf16 v[72:87], v[104:107], a[200:203], v[72:87]
  v_mfma_f32_32x32x16_bf16 v[88:103], v[104:107], a[204:207], v[88:103]
  v_cvt_pk_bf16_f32 v212, v40, v56
  v_cvt_pk_bf16_f32 v214, v41, v57
  v_cvt_pk_bf16_f32 v216, v42, v58
  v_cvt_pk_bf16_f32 v218, v43, v59
  v_permlane16_swap_b32 v212, v214
  v_mfma_f32_32x32x16_bf16 v[72:87], v[108:111], a[216:219], v[72:87]
  v_cvt_pk_bf16_f32 v220, v44, v60
  v_cvt_pk_bf16_f32 v222, v45, v61
  v_permlane16_swap_b32 v216, v218
  v_bfi_b32 v212, v254, s42, v212
  v_cvt_pk_bf16_f32 v224, v46, v62
  v_mfma_f32_32x32x16_bf16 v[88:103], v[108:111], a[220:223], v[88:103]
  v_cvt_pk_bf16_f32 v226, v47, v63
  v_permlane16_swap_b32 v220, v222
  v_bfi_b32 v216, v254, s42, v216
  v_cvt_pk_bf16_f32 v228, v48, v64
  v_mfma_f32_32x32x16_bf16 v[72:87], v[112:115], a[232:235], v[72:87]
  v_cvt_pk_bf16_f32 v230, v49, v65
  v_permlane16_swap_b32 v224, v226
  v_bfi_b32 v220, v254, s42, v220
  v_cvt_pk_bf16_f32 v232, v50, v66
  v_cvt_pk_bf16_f32 v234, v51, v67
  v_mfma_f32_32x32x16_bf16 v[88:103], v[112:115], a[236:239], v[88:103]
  v_permlane16_swap_b32 v228, v230
  v_bfi_b32 v224, v254, s42, v224
  v_cvt_pk_bf16_f32 v236, v52, v68
  v_cvt_pk_bf16_f32 v238, v53, v69
  v_mfma_f32_32x32x16_bf16 v[72:87], v[116:119], a[248:251], v[72:87]
  v_permlane16_swap_b32 v232, v234
  v_bfi_b32 v228, v254, s42, v228
  v_cvt_pk_bf16_f32 v240, v54, v70
  v_cvt_pk_bf16_f32 v242, v55, v71
  v_permlane16_swap_b32 v236, v238
  v_mfma_f32_32x32x16_bf16 v[88:103], v[116:119], a[252:255], v[88:103]
  v_bfi_b32 v232, v254, s42, v232
  v_permlane16_swap_b32 v240, v242
  v_bfi_b32 v236, v254, s42, v236
  v_bfi_b32 v240, v254, s42, v240
  s_nop 7
  v_cvt_pk_bf16_f32 v213, v72, v88
  v_cvt_pk_bf16_f32 v215, v73, v89
  v_cvt_pk_bf16_f32 v217, v74, v90
  v_cvt_pk_bf16_f32 v219, v75, v91
  s_add_u32 s78, s86, 0
  v_permlane16_swap_b32 v213, v215
  buffer_store_dwordx4 v[212:215], v4, s[4:7], s78 offen sc1
  v_cvt_pk_bf16_f32 v221, v76, v92
  v_cvt_pk_bf16_f32 v223, v77, v93
  s_add_u32 s78, s86, 32768
  v_permlane16_swap_b32 v217, v219
  buffer_store_dwordx4 v[216:219], v4, s[4:7], s78 offen sc1
  v_cvt_pk_bf16_f32 v225, v78, v94
  v_cvt_pk_bf16_f32 v227, v79, v95
  s_add_u32 s78, s86, 131072
  v_permlane16_swap_b32 v221, v223
  buffer_store_dwordx4 v[220:223], v4, s[4:7], s78 offen sc1
  v_cvt_pk_bf16_f32 v229, v80, v96
  v_cvt_pk_bf16_f32 v231, v81, v97
  s_add_u32 s78, s86, 163840
  v_permlane16_swap_b32 v225, v227
  buffer_store_dwordx4 v[224:227], v4, s[4:7], s78 offen sc1
  v_cvt_pk_bf16_f32 v233, v82, v98
  v_cvt_pk_bf16_f32 v235, v83, v99
  s_add_u32 s78, s86, 262144
  v_permlane16_swap_b32 v229, v231
  buffer_store_dwordx4 v[228:231], v4, s[4:7], s78 offen sc1
  v_cvt_pk_bf16_f32 v237, v84, v100
  v_cvt_pk_bf16_f32 v239, v85, v101
  s_add_u32 s78, s86, 294912
  v_permlane16_swap_b32 v233, v235
  buffer_store_dwordx4 v[232:235], v4, s[4:7], s78 offen sc1
  v_cvt_pk_bf16_f32 v241, v86, v102
  v_cvt_pk_bf16_f32 v243, v87, v103
  s_add_u32 s78, s86, 393216
  v_permlane16_swap_b32 v237, v239
  buffer_store_dwordx4 v[236:239], v4, s[4:7], s78 offen sc1
  s_add_u32 s78, s86, 425984
  v_permlane16_swap_b32 v241, v243
  buffer_store_dwordx4 v[240:243], v4, s[4:7], s78 offen sc1
o_we_153:
  v_and_b32 v37, -32, v39
  s_waitcnt lgkmcnt(0)
  s_barrier
  ds_read_b128 v[104:107], v37 offset:16
  s_mov_b32 s65, s63
  s_waitcnt lgkmcnt(0)
  v_and_b32 v104, v104, v106
  v_max_u32 v105, v105, v107
  v_readfirstlane_b32 s26, v104
  v_readfirstlane_b32 s3, v105
  s_and_b32 s66, s26, 1
  s_and_b32 s76, s26, 2
  s_bitcmp1_b32 s26, 2
  s_cselect_b32 s3, s3, 0
  s_cmp_lg_u32 s76, 0
  s_cbranch_scc1 o_nofl_131
  s_and_b32 s26, s63, 49152
  s_cbranch_scc0 o_fl_132
  s_cmp_lg_u32 s64, 0
  s_cbranch_scc1 o_nofl_131
o_fl_132:
  s_cmp_ge_u32 s17, 2
  s_cbranch_scc1 o_fd_167
  s_cmp_eq_u32 s65, 0
  s_cbranch_scc1 o_fd_167
  s_mov_b32 s96, s42
  s_waitcnt vmcnt(0)
  s_mov_b64 exec, 1
  buffer_store_dword v38, off, s[4:7], s84 sc1
  s_mov_b64 exec, -1
  s_mov_b32 s84, 268435456
  s_lshl_b32 s97, s43, 14
  s_add_u32 s97, s97, s86
  buffer_load_dword v7, v255, s[4:7], s97 offen sc1
  s_and_b32 s91, s65, 63
  s_lshl_b32 s90, s91, 5
  s_add_u32 s94, s90, s85
  s_add_u32 s90, s90, s43
  s_lshl_b32 s94, s94, 10
  s_lshr_b32 s92, s65, 22
  s_xor_b32 s93, s43, 32
  s_lshl_b32 s91, s90, 10
  s_add_u32 s94, s94, 25165824
  s_cmp_eq_u32 s92, s93
  s_cselect_b32 s92, s94, s91
  s_add_u32 s92, s92, 10485760
  s_and_b32 s93, s65, 49152
  s_cselect_b32 s92, s92, s91
  s_cselect_b64 s[80:81], s[4:5], s[72:73]
  s_cselect_b32 s82, s6, s74
  buffer_load_dwordx4 v[184:187], v0, s[80:83], s92 offen sc1
  s_mov_b32 s67, 0
  s_mov_b64 vcc, 0
  s_waitcnt vmcnt(1)
o_pl_169:
  v_and_b32 v7, 1, v7
  v_cmp_ne_u32 vcc, s96, v7
  s_cbranch_vccz o_pk_170
  buffer_load_dword v7, v255, s[4:7], s97 offen sc1
  s_add_u32 s67, s67, 1
  s_cmp_gt_u32 s67, 1048576
  s_cbranch_scc1 L_end
  s_waitcnt vmcnt(0)
  s_branch o_pl_169
o_pk_170:
  s_and_b32 s26, s65, 49152
  s_cbranch_scc1 o_f2_168
  s_lshl_b32 s94, s43, 14
  s_add_u32 s94, s94, s86
  buffer_load_dwordx4 v[120:123], v5, s[4:7], s94 offen offset:0 sc1
  buffer_load_dwordx4 v[124:127], v5, s[4:7], s94 offen offset:512 sc1
  buffer_load_dwordx4 v[128:131], v5, s[4:7], s94 offen offset:256 sc1
  buffer_load_dwordx4 v[132:135], v5, s[4:7], s94 offen offset:768 sc1
  s_add_u32 s94, s94, 4096
  buffer_load_dwordx4 v[136:139], v5, s[4:7], s94 offen offset:0 sc1
  buffer_load_dwordx4 v[140:143], v5, s[4:7], s94 offen offset:512 sc1
  buffer_load_dwordx4 v[144:147], v5, s[4:7], s94 offen offset:256 sc1
  buffer_load_dwordx4 v[148:151], v5, s[4:7], s94 offen offset:768 sc1
  s_add_u32 s94, s94, 4096
  buffer_load_dwordx4 v[152:155], v5, s[4:7], s94 offen offset:0 sc1
  buffer_load_dwordx4 v[156:159], v5, s[4:7], s94 offen offset:512 sc1
  buffer_load_dwordx4 v[160:163], v5, s[4:7], s94 offen offset:256 sc1
  buffer_load_dwordx4 v[164:167], v5, s[4:7], s94 offen offset:768 sc1
  s_add_u32 s94, s94, 4096
  buffer_load_dwordx4 v[168:171], v5, s[4:7], s94 offen offset:0 sc1
  buffer_load_dwordx4 v[172:175], v5, s[4:7], s94 offen offset:512 sc1
  buffer_load_dwordx4 v[176:179], v5, s[4:7], s94 offen offset:256 sc1
  buffer_load_dwordx4 v[180:183], v5, s[4:7], s94 offen offset:768 sc1
  v_mov_b64 v[188:189], 0
  v_mov_b64 v[190:191], 0
  v_mov_b64 v[192:193], 0
  v_mov_b64 v[194:195], 0
  s_waitcnt vmcnt(12)
  v_xor_b32 v7, s96, v120
  v_bitop3_b32 v7, v7, v124, s96 bitop3:0xf6
  v_bitop3_b32 v7, v7, v128, s96 bitop3:0xf6
  v_bitop3_b32 v7, v7, v132, s96 bitop3:0xf6
  s_waitcnt vmcnt(8)
  v_bitop3_b32 v7, v7, v136, s96 bitop3:0xf6
  v_bitop3_b32 v7, v7, v140, s96 bitop3:0xf6
  v_bitop3_b32 v7, v7, v144, s96 bitop3:0xf6
  v_bitop3_b32 v7, v7, v148, s96 bitop3:0xf6
  s_waitcnt vmcnt(4)
  v_bitop3_b32 v7, v7, v152, s96 bitop3:0xf6
  v_bitop3_b32 v7, v7, v156, s96 bitop3:0xf6
  v_bitop3_b32 v7, v7, v160, s96 bitop3:0xf6
  v_bitop3_b32 v7, v7, v164, s96 bitop3:0xf6
  s_waitcnt vmcnt(0)
  v_bitop3_b32 v7, v7, v168, s96 bitop3:0xf6
  v_bitop3_b32 v7, v7, v172, s96 bitop3:0xf6
  v_bitop3_b32 v7, v7, v176, s96 bitop3:0xf6
  v_bitop3_b32 v7, v7, v180, s96 bitop3:0xf6
  v_and_b32 v7, v254, v7
  v_cmp_ne_u32 vcc, 0, v7
  s_cbranch_vccnz o_rt_171
o_bk_172:
  v_smfmac_f32_16x16x64_bf16 v[188:191], v[16:19], v[120:127], v20
  v_lshlrev_b32 v196, 16, v184
  v_smfmac_f32_16x16x64_bf16 v[192:195], v[16:19], v[128:135], v20
  v_and_b32 v197, 0xffff0000, v184
  v_smfmac_f32_16x16x64_bf16 v[188:191], v[16:19], v[136:143], v20
  v_lshlrev_b32 v198, 16, v185
  v_smfmac_f32_16x16x64_bf16 v[192:195], v[16:19], v[144:151], v20
  v_and_b32 v199, 0xffff0000, v185
  v_smfmac_f32_16x16x64_bf16 v[188:191], v[16:19], v[152:159], v20
  v_lshlrev_b32 v200, 16, v186
  v_smfmac_f32_16x16x64_bf16 v[192:195], v[16:19], v[160:167], v20
  v_and_b32 v201, 0xffff0000, v186
  v_smfmac_f32_16x16x64_bf16 v[188:191], v[16:19], v[168:175], v20
  v_lshlrev_b32 v202, 16, v187
  v_smfmac_f32_16x16x64_bf16 v[192:195], v[16:19], v[176:183], v20
  v_and_b32 v203, 0xffff0000, v187
  s_bfe_u32 s92, s65, 131086
  s_lshl_b32 s92, s92, 21
  s_add_u32 s92, s92, s91
  s_add_u32 s93, s92, 27262976
  s_add_u32 s92, s92, 20971520
  s_nop 1
  v_permlane16_swap_b32 v188, v192
  v_permlane16_swap_b32 v189, v193
  v_permlane16_swap_b32 v190, v194
  v_permlane16_swap_b32 v191, v195
  v_cvt_pk_bf16_f32 v188, 0, v188
  v_cvt_pk_bf16_f32 v189, 0, v189
  v_cvt_pk_bf16_f32 v190, 0, v190
  v_cvt_pk_bf16_f32 v191, 0, v191
  v_cvt_pk_bf16_f32 v192, 0, v192
  v_cvt_pk_bf16_f32 v193, 0, v193
  v_cvt_pk_bf16_f32 v194, 0, v194
  v_cvt_pk_bf16_f32 v195, 0, v195
  v_add_f32 v196, v196, v188
  v_add_f32 v197, v197, v189
  v_add_f32 v198, v198, v190
  v_add_f32 v199, v199, v191
  v_add_f32 v200, v200, v192
  v_add_f32 v201, v201, v193
  v_add_f32 v202, v202, v194
  v_add_f32 v203, v203, v195
  v_cvt_pk_bf16_f32 v120, v196, v197
  v_cvt_pk_bf16_f32 v121, v198, v199
  v_cvt_pk_bf16_f32 v122, v200, v201
  v_cvt_pk_bf16_f32 v123, v202, v203
  v_lshlrev_b32 v196, 16, v120
  v_and_b32 v197, 0xffff0000, v120
  v_lshlrev_b32 v198, 16, v121
  v_and_b32 v199, 0xffff0000, v121
  v_lshlrev_b32 v200, 16, v122
  v_and_b32 v201, 0xffff0000, v122
  v_lshlrev_b32 v202, 16, v123
  v_and_b32 v203, 0xffff0000, v123
  buffer_store_dwordx4 v[120:123], v0, s[4:7], s92 offen sc1
  v_add_f32 v136, v196, v197
  v_mul_f32 v137, v196, v196
  v_add_f32 v138, v198, v199
  v_mul_f32 v139, v197, v197
  v_fmac_f32 v137, v198, v198
  v_fmac_f32 v139, v199, v199
  v_add_f32 v136, v136, v200
  v_fmac_f32 v137, v200, v200
  v_add_f32 v138, v138, v201
  v_fmac_f32 v139, v201, v201
  v_add_f32 v136, v136, v202
  v_fmac_f32 v137, v202, v202
  v_add_f32 v138, v138, v203
  v_fmac_f32 v139, v203, v203
  v_add_f32 v136, v136, v138
  v_add_f32 v137, v137, v139
  s_nop 0
  v_add_f32_dpp v136, v136, v136 row_ror:8 row_mask:0xf bank_mask:0xf
  v_add_f32_dpp v137, v137, v137 row_ror:8 row_mask:0xf bank_mask:0xf
  s_nop 0
  v_add_f32_dpp v136, v136, v136 row_ror:4 row_mask:0xf bank_mask:0xf
  v_add_f32_dpp v137, v137, v137 row_ror:4 row_mask:0xf bank_mask:0xf
  s_nop 0
  v_add_f32_dpp v136, v136, v136 row_ror:2 row_mask:0xf bank_mask:0xf
  v_add_f32_dpp v137, v137, v137 row_ror:2 row_mask:0xf bank_mask:0xf
  s_nop 0
  v_add_f32_dpp v136, v136, v136 row_ror:1 row_mask:0xf bank_mask:0xf
  v_add_f32_dpp v137, v137, v137 row_ror:1 row_mask:0xf bank_mask:0xf
  v_mov_b32 v140, v136
  v_mov_b32 v141, v137
  s_nop 0
  v_permlane16_swap_b32 v136, v140
  v_permlane16_swap_b32 v137, v141
  v_add_f32 v136, v136, v140
  v_add_f32 v137, v137, v141
  v_mov_b32 v140, v136
  v_mov_b32 v141, v137
  s_nop 0
  v_permlane32_swap_b32 v136, v140
  v_permlane32_swap_b32 v137, v141
  v_add_f32 v136, v136, v140
  v_add_f32 v137, v137, v141
  v_mul_f32 v136, 0x3b000000, v136
  v_mul_f32 v137, 0x3b000000, v137
  v_fma_f32 v137, -v136, v136, v137
  v_cvt_pk_bf16_f32 v136, 0, v136
  v_max_f32 v137, 0, v137
  v_sub_f32 v140, v196, v136
  v_sub_f32 v141, v197, v136
  v_cvt_pk_bf16_f32 v137, 0, v137
  v_sub_f32 v142, v198, v136
  v_sub_f32 v143, v199, v136
  v_add_f32 v137, 0x3727c5ac, v137
  v_sub_f32 v144, v200, v136
  v_sub_f32 v145, v201, v136
  v_cvt_pk_bf16_f32 v137, 0, v137
  v_sub_f32 v146, v202, v136
  v_sub_f32 v147, v203, v136
  v_sqrt_f32 v137, v137
  v_cvt_pk_bf16_f32 v140, 0, v140
  v_cvt_pk_bf16_f32 v141, 0, v141
  v_cvt_pk_bf16_f32 v137, 0, v137
  v_cvt_pk_bf16_f32 v142, 0, v142
  v_cvt_pk_bf16_f32 v143, 0, v143
  v_rcp_f32 v137, v137
  v_cvt_pk_bf16_f32 v144, 0, v144
  v_cvt_pk_bf16_f32 v145, 0, v145
  v_cvt_pk_bf16_f32 v146, 0, v146
  v_cvt_pk_bf16_f32 v147, 0, v147
  v_mul_f32 v140, v140, v137
  v_mul_f32 v141, v141, v137
  v_mul_f32 v142, v142, v137
  v_mul_f32 v143, v143, v137
  v_mul_f32 v144, v144, v137
  v_mul_f32 v145, v145, v137
  v_mul_f32 v146, v146, v137
  v_mul_f32 v147, v147, v137
  v_cvt_pk_bf16_f32 v124, v140, v141
  v_cvt_pk_bf16_f32 v125, v142, v143
  v_cvt_pk_bf16_f32 v126, v144, v145
  v_cvt_pk_bf16_f32 v127, v146, v147
  v_lshlrev_b32 v204, 16, v124
  v_and_b32 v205, 0xffff0000, v124
  v_lshlrev_b32 v206, 16, v125
  v_and_b32 v207, 0xffff0000, v125
  v_lshlrev_b32 v208, 16, v126
  v_and_b32 v209, 0xffff0000, v126
  v_lshlrev_b32 v210, 16, v127
  v_and_b32 v211, 0xffff0000, v127
  buffer_store_dwordx4 v[124:127], v0, s[4:7], s93 offen sc1
  v_add_f32 v196, v196, v204
  v_add_f32 v197, v197, v205
  v_add_f32 v198, v198, v206
  v_add_f32 v199, v199, v207
  v_add_f32 v200, v200, v208
  v_add_f32 v201, v201, v209
  v_add_f32 v202, v202, v210
  v_add_f32 v203, v203, v211
  v_cvt_pk_bf16_f32 v128, v196, v197
  v_cvt_pk_bf16_f32 v129, v198, v199
  v_cvt_pk_bf16_f32 v130, v200, v201
  v_cvt_pk_bf16_f32 v131, v202, v203
  v_mul_f32 v188, v204, v8
  v_mul_f32 v189, v205, v9
  v_fmac_f32 v188, v206, v10
  v_fmac_f32 v189, v207, v11
  v_fmac_f32 v188, v208, v12
  v_fmac_f32 v189, v209, v13
  v_fmac_f32 v188, v210, v14
  v_fmac_f32 v189, v211, v15
  v_add_f32 v188, v188, v189
  s_add_u32 s92, s91, 10485760
  s_add_u32 s93, s91, 8388608
  buffer_store_dwordx4 v[128:131], v0, s[4:7], s92 offen sc1
  v_lshlrev_b32 v196, 16, v128
  v_and_b32 v197, 0xffff0000, v128
  v_lshlrev_b32 v198, 16, v129
  v_and_b32 v199, 0xffff0000, v129
  v_lshlrev_b32 v200, 16, v130
  v_and_b32 v201, 0xffff0000, v130
  v_lshlrev_b32 v202, 16, v131
  v_and_b32 v203, 0xffff0000, v131
  v_add_f32 v136, v196, v197
  v_mul_f32 v137, v196, v196
  v_add_f32 v138, v198, v199
  v_mul_f32 v139, v197, v197
  v_fmac_f32 v137, v198, v198
  v_fmac_f32 v139, v199, v199
  v_add_f32 v136, v136, v200
  v_fmac_f32 v137, v200, v200
  v_add_f32 v138, v138, v201
  v_fmac_f32 v139, v201, v201
  v_add_f32 v136, v136, v202
  v_fmac_f32 v137, v202, v202
  v_add_f32 v138, v138, v203
  v_fmac_f32 v139, v203, v203
  v_add_f32 v136, v136, v138
  v_add_f32 v137, v137, v139
  s_nop 0
  v_add_f32_dpp v136, v136, v136 row_ror:8 row_mask:0xf bank_mask:0xf
  v_add_f32_dpp v137, v137, v137 row_ror:8 row_mask:0xf bank_mask:0xf
  v_add_f32_dpp v188, v188, v188 row_ror:8 row_mask:0xf bank_mask:0xf
  v_add_f32_dpp v136, v136, v136 row_ror:4 row_mask:0xf bank_mask:0xf
  v_add_f32_dpp v137, v137, v137 row_ror:4 row_mask:0xf bank_mask:0xf
  v_add_f32_dpp v188, v188, v188 row_ror:4 row_mask:0xf bank_mask:0xf
  v_add_f32_dpp v136, v136, v136 row_ror:2 row_mask:0xf bank_mask:0xf
  v_add_f32_dpp v137, v137, v137 row_ror:2 row_mask:0xf bank_mask:0xf
  v_add_f32_dpp v188, v188, v188 row_ror:2 row_mask:0xf bank_mask:0xf
  v_add_f32_dpp v136, v136, v136 row_ror:1 row_mask:0xf bank_mask:0xf
  v_add_f32_dpp v137, v137, v137 row_ror:1 row_mask:0xf bank_mask:0xf
  v_add_f32_dpp v188, v188, v188 row_ror:1 row_mask:0xf bank_mask:0xf
  v_mov_b32 v140, v136
  v_mov_b32 v141, v137
  v_mov_b32 v142, v188
  v_permlane16_swap_b32 v136, v140
  v_permlane16_swap_b32 v137, v141
  v_permlane16_swap_b32 v188, v142
  v_add_f32 v136, v136, v140
  v_add_f32 v137, v137, v141
  v_add_f32 v188, v188, v142
  v_mov_b32 v140, v136
  v_mov_b32 v141, v137
  v_mov_b32 v142, v188
  v_permlane32_swap_b32 v136, v140
  v_permlane32_swap_b32 v137, v141
  v_permlane32_swap_b32 v188, v142
  v_add_f32 v136, v136, v140
  v_add_f32 v137, v137, v141
  v_add_f32 v188, v188, v142
  v_mul_f32 v136, 0x3b000000, v136
  v_mul_f32 v137, 0x3b000000, v137
  v_fma_f32 v137, -v136, v136, v137
  v_cvt_pk_bf16_f32 v136, 0, v136
  v_max_f32 v137, 0, v137
  v_sub_f32 v140, v196, v136
  v_sub_f32 v141, v197, v136
  v_cvt_pk_bf16_f32 v137, 0, v137
  v_sub_f32 v142, v198, v136
  v_sub_f32 v143, v199, v136
  v_add_f32 v137, 0x3727c5ac, v137
  v_sub_f32 v144, v200, v136
  v_sub_f32 v145, v201, v136
  v_cvt_pk_bf16_f32 v137, 0, v137
  v_sub_f32 v146, v202, v136
  v_sub_f32 v147, v203, v136
  v_sqrt_f32 v137, v137
  v_cvt_pk_bf16_f32 v140, 0, v140
  v_cvt_pk_bf16_f32 v141, 0, v141
  v_cvt_pk_bf16_f32 v137, 0, v137
  v_cvt_pk_bf16_f32 v142, 0, v142
  v_cvt_pk_bf16_f32 v143, 0, v143
  v_rcp_f32 v137, v137
  v_cvt_pk_bf16_f32 v144, 0, v144
  v_cvt_pk_bf16_f32 v145, 0, v145
  v_cvt_pk_bf16_f32 v146, 0, v146
  v_cvt_pk_bf16_f32 v147, 0, v147
  v_mul_f32 v140, v140, v137
  v_mul_f32 v141, v141, v137
  v_mul_f32 v142, v142, v137
  v_mul_f32 v143, v143, v137
  v_mul_f32 v144, v144, v137
  v_mul_f32 v145, v145, v137
  v_mul_f32 v146, v146, v137
  v_mul_f32 v147, v147, v137
  v_cvt_pk_bf16_f32 v132, v140, v141
  v_cvt_pk_bf16_f32 v133, v142, v143
  v_cvt_pk_bf16_f32 v134, v144, v145
  v_cvt_pk_bf16_f32 v135, v146, v147
  buffer_store_dwordx4 v[132:135], v0, s[4:7], s93 offen sc1
  v_cvt_pk_bf16_f32 v188, 0, v188
  v_ashrrev_i32 v189, 31, v188
  v_or_b32 v189, 0x80000000, v189
  v_xor_b32 v188, v188, v189
  s_sub_u32 s92, 4095, s90
  v_and_b32 v188, 0xffff0000, v188
  v_or_b32 v38, s92, v188
  s_bfe_u32 s92, s65, 196625
  s_lshl_b32 s92, s92, 18
  s_lshl_b32 s93, s90, 7
  s_add_u32 s92, s92, s93
  s_add_u32 s84, s92, 243269632
  s_waitcnt vmcnt(0)
  s_mov_b64 exec, 1
  buffer_store_dword v38, off, s[4:7], s84 sc1
  s_mov_b64 exec, -1
  s_mov_b32 s84, 268435456
  s_branch o_fd_167
o_rt_171:
  s_mov_b32 s67, 0
o_rl_173:
  s_lshl_b32 s94, s43, 14
  s_add_u32 s94, s94, s86
  buffer_load_dwordx4 v[120:123], v5, s[4:7], s94 offen offset:0 sc1
  buffer_load_dwordx4 v[124:127], v5, s[4:7], s94 offen offset:512 sc1
  buffer_load_dwordx4 v[128:131], v5, s[4:7], s94 offen offset:256 sc1
  buffer_load_dwordx4 v[132:135], v5, s[4:7], s94 offen offset:768 sc1
  s_add_u32 s94, s94, 4096
  buffer_load_dwordx4 v[136:139], v5, s[4:7], s94 offen offset:0 sc1
  buffer_load_dwordx4 v[140:143], v5, s[4:7], s94 offen offset:512 sc1
  buffer_load_dwordx4 v[144:147], v5, s[4:7], s94 offen offset:256 sc1
  buffer_load_dwordx4 v[148:151], v5, s[4:7], s94 offen offset:768 sc1
  s_add_u32 s94, s94, 4096
  buffer_load_dwordx4 v[152:155], v5, s[4:7], s94 offen offset:0 sc1
  buffer_load_dwordx4 v[156:159], v5, s[4:7], s94 offen offset:512 sc1
  buffer_load_dwordx4 v[160:163], v5, s[4:7], s94 offen offset:256 sc1
  buffer_load_dwordx4 v[164:167], v5, s[4:7], s94 offen offset:768 sc1
  s_add_u32 s94, s94, 4096
  buffer_load_dwordx4 v[168:171], v5, s[4:7], s94 offen offset:0 sc1
  buffer_load_dwordx4 v[172:175], v5, s[4:7], s94 offen offset:512 sc1
  buffer_load_dwordx4 v[176:179], v5, s[4:7], s94 offen offset:256 sc1
  buffer_load_dwordx4 v[180:183], v5, s[4:7], s94 offen offset:768 sc1
  s_add_u32 s67, s67, 1
  s_cmp_gt_u32 s67, 1048576
  s_cbranch_scc1 L_end
  s_waitcnt vmcnt(0)
  v_xor_b32 v7, s96, v120
  v_bitop3_b32 v7, v7, v124, s96 bitop3:0xf6
  v_bitop3_b32 v7, v7, v128, s96 bitop3:0xf6
  v_bitop3_b32 v7, v7, v132, s96 bitop3:0xf6
  v_bitop3_b32 v7, v7, v136, s96 bitop3:0xf6
  v_bitop3_b32 v7, v7, v140, s96 bitop3:0xf6
  v_bitop3_b32 v7, v7, v144, s96 bitop3:0xf6
  v_bitop3_b32 v7, v7, v148, s96 bitop3:0xf6
  v_bitop3_b32 v7, v7, v152, s96 bitop3:0xf6
  v_bitop3_b32 v7, v7, v156, s96 bitop3:0xf6
  v_bitop3_b32 v7, v7, v160, s96 bitop3:0xf6
  v_bitop3_b32 v7, v7, v164, s96 bitop3:0xf6
  v_bitop3_b32 v7, v7, v168, s96 bitop3:0xf6
  v_bitop3_b32 v7, v7, v172, s96 bitop3:0xf6
  v_bitop3_b32 v7, v7, v176, s96 bitop3:0xf6
  v_bitop3_b32 v7, v7, v180, s96 bitop3:0xf6
  v_and_b32 v7, v254, v7
  v_cmp_ne_u32 vcc, 0, v7
  s_cbranch_vccnz o_rl_173
  s_branch o_bk_172
o_f2_168:
  s_lshl_b32 s94, s43, 14
  s_add_u32 s94, s94, s86
  buffer_load_dwordx4 v[120:123], v5, s[4:7], s94 offen offset:0 sc1
  buffer_load_dwordx4 v[124:127], v5, s[4:7], s94 offen offset:512 sc1
  buffer_load_dwordx4 v[128:131], v5, s[4:7], s94 offen offset:256 sc1
  buffer_load_dwordx4 v[132:135], v5, s[4:7], s94 offen offset:768 sc1
  s_add_u32 s94, s94, 4096
  buffer_load_dwordx4 v[136:139], v5, s[4:7], s94 offen offset:0 sc1
  buffer_load_dwordx4 v[140:143], v5, s[4:7], s94 offen offset:512 sc1
  buffer_load_dwordx4 v[144:147], v5, s[4:7], s94 offen offset:256 sc1
  buffer_load_dwordx4 v[148:151], v5, s[4:7], s94 offen offset:768 sc1
  s_add_u32 s94, s94, 4096
  buffer_load_dwordx4 v[152:155], v5, s[4:7], s94 offen offset:0 sc1
  buffer_load_dwordx4 v[156:159], v5, s[4:7], s94 offen offset:512 sc1
  buffer_load_dwordx4 v[160:163], v5, s[4:7], s94 offen offset:256 sc1
  buffer_load_dwordx4 v[164:167], v5, s[4:7], s94 offen offset:768 sc1
  s_add_u32 s94, s94, 4096
  buffer_load_dwordx4 v[168:171], v5, s[4:7], s94 offen offset:0 sc1
  buffer_load_dwordx4 v[172:175], v5, s[4:7], s94 offen offset:512 sc1
  buffer_load_dwordx4 v[176:179], v5, s[4:7], s94 offen offset:256 sc1
  buffer_load_dwordx4 v[180:183], v5, s[4:7], s94 offen offset:768 sc1
  v_mov_b64 v[188:189], 0
  v_mov_b64 v[190:191], 0
  v_mov_b64 v[192:193], 0
  v_mov_b64 v[194:195], 0
  s_waitcnt vmcnt(12)
  v_xor_b32 v7, s96, v120
  v_bitop3_b32 v7, v7, v124, s96 bitop3:0xf6
  v_bitop3_b32 v7, v7, v128, s96 bitop3:0xf6
  v_bitop3_b32 v7, v7, v132, s96 bitop3:0xf6
  s_waitcnt vmcnt(8)
  v_bitop3_b32 v7, v7, v136, s96 bitop3:0xf6
  v_bitop3_b32 v7, v7, v140, s96 bitop3:0xf6
  v_bitop3_b32 v7, v7, v144, s96 bitop3:0xf6
  v_bitop3_b32 v7, v7, v148, s96 bitop3:0xf6
  s_waitcnt vmcnt(4)
  v_bitop3_b32 v7, v7, v152, s96 bitop3:0xf6
  v_bitop3_b32 v7, v7, v156, s96 bitop3:0xf6
  v_bitop3_b32 v7, v7, v160, s96 bitop3:0xf6
  v_bitop3_b32 v7, v7, v164, s96 bitop3:0xf6
  s_waitcnt vmcnt(0)
  v_bitop3_b32 v7, v7, v168, s96 bitop3:0xf6
  v_bitop3_b32 v7, v7, v172, s96 bitop3:0xf6
  v_bitop3_b32 v7, v7, v176, s96 bitop3:0xf6
  v_bitop3_b32 v7, v7, v180, s96 bitop3:0xf6
  v_and_b32 v7, v254, v7
  v_cmp_ne_u32 vcc, 0, v7
  s_cbranch_vccnz o_rt_174
o_bk_175:
  v_smfmac_f32_16x16x64_bf16 v[188:191], v[16:19], v[120:127], v20
  v_lshlrev_b32 v196, 16, v184
  v_smfmac_f32_16x16x64_bf16 v[192:195], v[16:19], v[128:135], v20
  v_and_b32 v197, 0xffff0000, v184
  v_smfmac_f32_16x16x64_bf16 v[188:191], v[16:19], v[136:143], v20
  v_lshlrev_b32 v198, 16, v185
  v_smfmac_f32_16x16x64_bf16 v[192:195], v[16:19], v[144:151], v20
  v_and_b32 v199, 0xffff0000, v185
  v_smfmac_f32_16x16x64_bf16 v[188:191], v[16:19], v[152:159], v20
  v_lshlrev_b32 v200, 16, v186
  v_smfmac_f32_16x16x64_bf16 v[192:195], v[16:19], v[160:167], v20
  v_and_b32 v201, 0xffff0000, v186
  v_smfmac_f32_16x16x64_bf16 v[188:191], v[16:19], v[168:175], v20
  v_lshlrev_b32 v202, 16, v187
  v_smfmac_f32_16x16x64_bf16 v[192:195], v[16:19], v[176:183], v20
  v_and_b32 v203, 0xffff0000, v187
  s_bfe_u32 s92, s65, 131086
  s_lshl_b32 s92, s92, 21
  s_add_u32 s92, s92, s91
  s_add_u32 s93, s92, 27262976
  s_add_u32 s92, s92, 20971520
  s_nop 1
  v_permlane16_swap_b32 v188, v192
  v_permlane16_swap_b32 v189, v193
  v_permlane16_swap_b32 v190, v194
  v_permlane16_swap_b32 v191, v195
  v_cvt_pk_bf16_f32 v188, 0, v188
  v_cvt_pk_bf16_f32 v189, 0, v189
  v_cvt_pk_bf16_f32 v190, 0, v190
  v_cvt_pk_bf16_f32 v191, 0, v191
  v_cvt_pk_bf16_f32 v192, 0, v192
  v_cvt_pk_bf16_f32 v193, 0, v193
  v_cvt_pk_bf16_f32 v194, 0, v194
  v_cvt_pk_bf16_f32 v195, 0, v195
  v_add_f32 v196, v196, v188
  v_add_f32 v197, v197, v189
  v_add_f32 v198, v198, v190
  v_add_f32 v199, v199, v191
  v_add_f32 v200, v200, v192
  v_add_f32 v201, v201, v193
  v_add_f32 v202, v202, v194
  v_add_f32 v203, v203, v195
  v_cvt_pk_bf16_f32 v120, v196, v197
  v_cvt_pk_bf16_f32 v121, v198, v199
  v_cvt_pk_bf16_f32 v122, v200, v201
  v_cvt_pk_bf16_f32 v123, v202, v203
  v_lshlrev_b32 v196, 16, v120
  v_and_b32 v197, 0xffff0000, v120
  v_lshlrev_b32 v198, 16, v121
  v_and_b32 v199, 0xffff0000, v121
  v_lshlrev_b32 v200, 16, v122
  v_and_b32 v201, 0xffff0000, v122
  v_lshlrev_b32 v202, 16, v123
  v_and_b32 v203, 0xffff0000, v123
  buffer_store_dwordx4 v[120:123], v0, s[4:7], s92 offen sc1
  v_add_f32 v136, v196, v197
  v_mul_f32 v137, v196, v196
  v_add_f32 v138, v198, v199
  v_mul_f32 v139, v197, v197
  v_fmac_f32 v137, v198, v198
  v_fmac_f32 v139, v199, v199
  v_add_f32 v136, v136, v200
  v_fmac_f32 v137, v200, v200
  v_add_f32 v138, v138, v201
  v_fmac_f32 v139, v201, v201
  v_add_f32 v136, v136, v202
  v_fmac_f32 v137, v202, v202
  v_add_f32 v138, v138, v203
  v_fmac_f32 v139, v203, v203
  v_add_f32 v136, v136, v138
  v_add_f32 v137, v137, v139
  s_nop 0
  v_add_f32_dpp v136, v136, v136 row_ror:8 row_mask:0xf bank_mask:0xf
  v_add_f32_dpp v137, v137, v137 row_ror:8 row_mask:0xf bank_mask:0xf
  s_nop 0
  v_add_f32_dpp v136, v136, v136 row_ror:4 row_mask:0xf bank_mask:0xf
  v_add_f32_dpp v137, v137, v137 row_ror:4 row_mask:0xf bank_mask:0xf
  s_nop 0
  v_add_f32_dpp v136, v136, v136 row_ror:2 row_mask:0xf bank_mask:0xf
  v_add_f32_dpp v137, v137, v137 row_ror:2 row_mask:0xf bank_mask:0xf
  s_nop 0
  v_add_f32_dpp v136, v136, v136 row_ror:1 row_mask:0xf bank_mask:0xf
  v_add_f32_dpp v137, v137, v137 row_ror:1 row_mask:0xf bank_mask:0xf
  v_mov_b32 v140, v136
  v_mov_b32 v141, v137
  s_nop 0
  v_permlane16_swap_b32 v136, v140
  v_permlane16_swap_b32 v137, v141
  v_add_f32 v136, v136, v140
  v_add_f32 v137, v137, v141
  v_mov_b32 v140, v136
  v_mov_b32 v141, v137
  s_nop 0
  v_permlane32_swap_b32 v136, v140
  v_permlane32_swap_b32 v137, v141
  v_add_f32 v136, v136, v140
  v_add_f32 v137, v137, v141
  v_mul_f32 v136, 0x3b000000, v136
  v_mul_f32 v137, 0x3b000000, v137
  v_fma_f32 v137, -v136, v136, v137
  v_cvt_pk_bf16_f32 v136, 0, v136
  v_max_f32 v137, 0, v137
  v_sub_f32 v140, v196, v136
  v_sub_f32 v141, v197, v136
  v_cvt_pk_bf16_f32 v137, 0, v137
  v_sub_f32 v142, v198, v136
  v_sub_f32 v143, v199, v136
  v_add_f32 v137, 0x3727c5ac, v137
  v_sub_f32 v144, v200, v136
  v_sub_f32 v145, v201, v136
  v_cvt_pk_bf16_f32 v137, 0, v137
  v_sub_f32 v146, v202, v136
  v_sub_f32 v147, v203, v136
  v_sqrt_f32 v137, v137
  v_cvt_pk_bf16_f32 v140, 0, v140
  v_cvt_pk_bf16_f32 v141, 0, v141
  v_cvt_pk_bf16_f32 v137, 0, v137
  v_cvt_pk_bf16_f32 v142, 0, v142
  v_cvt_pk_bf16_f32 v143, 0, v143
  v_rcp_f32 v137, v137
  v_cvt_pk_bf16_f32 v144, 0, v144
  v_cvt_pk_bf16_f32 v145, 0, v145
  v_cvt_pk_bf16_f32 v146, 0, v146
  v_cvt_pk_bf16_f32 v147, 0, v147
  v_mul_f32 v140, v140, v137
  v_mul_f32 v141, v141, v137
  v_mul_f32 v142, v142, v137
  v_mul_f32 v143, v143, v137
  v_mul_f32 v144, v144, v137
  v_mul_f32 v145, v145, v137
  v_mul_f32 v146, v146, v137
  v_mul_f32 v147, v147, v137
  v_cvt_pk_bf16_f32 v124, v140, v141
  v_cvt_pk_bf16_f32 v125, v142, v143
  v_cvt_pk_bf16_f32 v126, v144, v145
  v_cvt_pk_bf16_f32 v127, v146, v147
  v_lshlrev_b32 v204, 16, v124
  v_and_b32 v205, 0xffff0000, v124
  v_lshlrev_b32 v206, 16, v125
  v_and_b32 v207, 0xffff0000, v125
  v_lshlrev_b32 v208, 16, v126
  v_and_b32 v209, 0xffff0000, v126
  v_lshlrev_b32 v210, 16, v127
  v_and_b32 v211, 0xffff0000, v127
  buffer_store_dwordx4 v[124:127], v0, s[4:7], s93 offen sc1
  v_add_f32 v196, v196, v204
  v_add_f32 v197, v197, v205
  v_add_f32 v198, v198, v206
  v_add_f32 v199, v199, v207
  v_add_f32 v200, v200, v208
  v_add_f32 v201, v201, v209
  v_add_f32 v202, v202, v210
  v_add_f32 v203, v203, v211
  v_cvt_pk_bf16_f32 v128, v196, v197
  v_cvt_pk_bf16_f32 v129, v198, v199
  v_cvt_pk_bf16_f32 v130, v200, v201
  v_cvt_pk_bf16_f32 v131, v202, v203
  v_mul_f32 v188, v204, v8
  v_mul_f32 v189, v205, v9
  v_fmac_f32 v188, v206, v10
  v_fmac_f32 v189, v207, v11
  v_fmac_f32 v188, v208, v12
  v_fmac_f32 v189, v209, v13
  v_fmac_f32 v188, v210, v14
  v_fmac_f32 v189, v211, v15
  v_add_f32 v188, v188, v189
  buffer_store_dwordx4 v[128:131], v0, s[68:71], s91 offen sc1
  s_nop 0
  v_add_f32_dpp v188, v188, v188 row_ror:8 row_mask:0xf bank_mask:0xf
  s_nop 1
  v_add_f32_dpp v188, v188, v188 row_ror:4 row_mask:0xf bank_mask:0xf
  s_nop 1
  v_add_f32_dpp v188, v188, v188 row_ror:2 row_mask:0xf bank_mask:0xf
  s_nop 1
  v_add_f32_dpp v188, v188, v188 row_ror:1 row_mask:0xf bank_mask:0xf
  v_mov_b32 v189, v188
  s_nop 0
  s_nop 0
  v_permlane16_swap_b32 v188, v189
  v_add_f32 v188, v188, v189
  v_mov_b32 v189, v188
  s_nop 0
  s_nop 0
  v_permlane32_swap_b32 v188, v189
  v_add_f32 v188, v188, v189
  v_cvt_pk_bf16_f32 v188, 0, v188
  v_ashrrev_i32 v189, 31, v188
  v_or_b32 v189, 0x80000000, v189
  v_xor_b32 v188, v188, v189
  s_sub_u32 s92, 4095, s90
  v_and_b32 v188, 0xffff0000, v188
  v_or_b32 v38, s92, v188
  s_bfe_u32 s92, s65, 196625
  s_lshl_b32 s92, s92, 18
  s_lshl_b32 s93, s90, 7
  s_add_u32 s92, s92, s93
  s_add_u32 s84, s92, 243269632
  s_waitcnt vmcnt(0)
  s_mov_b64 exec, 1
  buffer_store_dword v38, off, s[4:7], s84 sc1
  s_mov_b64 exec, -1
  s_mov_b32 s84, 268435456
  s_branch o_fd_167
o_rt_174:
  s_mov_b32 s67, 0
o_rl_176:
  s_lshl_b32 s94, s43, 14
  s_add_u32 s94, s94, s86
  buffer_load_dwordx4 v[120:123], v5, s[4:7], s94 offen offset:0 sc1
  buffer_load_dwordx4 v[124:127], v5, s[4:7], s94 offen offset:512 sc1
  buffer_load_dwordx4 v[128:131], v5, s[4:7], s94 offen offset:256 sc1
  buffer_load_dwordx4 v[132:135], v5, s[4:7], s94 offen offset:768 sc1
  s_add_u32 s94, s94, 4096
  buffer_load_dwordx4 v[136:139], v5, s[4:7], s94 offen offset:0 sc1
  buffer_load_dwordx4 v[140:143], v5, s[4:7], s94 offen offset:512 sc1
  buffer_load_dwordx4 v[144:147], v5, s[4:7], s94 offen offset:256 sc1
  buffer_load_dwordx4 v[148:151], v5, s[4:7], s94 offen offset:768 sc1
  s_add_u32 s94, s94, 4096
  buffer_load_dwordx4 v[152:155], v5, s[4:7], s94 offen offset:0 sc1
  buffer_load_dwordx4 v[156:159], v5, s[4:7], s94 offen offset:512 sc1
  buffer_load_dwordx4 v[160:163], v5, s[4:7], s94 offen offset:256 sc1
  buffer_load_dwordx4 v[164:167], v5, s[4:7], s94 offen offset:768 sc1
  s_add_u32 s94, s94, 4096
  buffer_load_dwordx4 v[168:171], v5, s[4:7], s94 offen offset:0 sc1
  buffer_load_dwordx4 v[172:175], v5, s[4:7], s94 offen offset:512 sc1
  buffer_load_dwordx4 v[176:179], v5, s[4:7], s94 offen offset:256 sc1
  buffer_load_dwordx4 v[180:183], v5, s[4:7], s94 offen offset:768 sc1
  s_add_u32 s67, s67, 1
  s_cmp_gt_u32 s67, 1048576
  s_cbranch_scc1 L_end
  s_waitcnt vmcnt(0)
  v_xor_b32 v7, s96, v120
  v_bitop3_b32 v7, v7, v124, s96 bitop3:0xf6
  v_bitop3_b32 v7, v7, v128, s96 bitop3:0xf6
  v_bitop3_b32 v7, v7, v132, s96 bitop3:0xf6
  v_bitop3_b32 v7, v7, v136, s96 bitop3:0xf6
  v_bitop3_b32 v7, v7, v140, s96 bitop3:0xf6
  v_bitop3_b32 v7, v7, v144, s96 bitop3:0xf6
  v_bitop3_b32 v7, v7, v148, s96 bitop3:0xf6
  v_bitop3_b32 v7, v7, v152, s96 bitop3:0xf6
  v_bitop3_b32 v7, v7, v156, s96 bitop3:0xf6
  v_bitop3_b32 v7, v7, v160, s96 bitop3:0xf6
  v_bitop3_b32 v7, v7, v164, s96 bitop3:0xf6
  v_bitop3_b32 v7, v7, v168, s96 bitop3:0xf6
  v_bitop3_b32 v7, v7, v172, s96 bitop3:0xf6
  v_bitop3_b32 v7, v7, v176, s96 bitop3:0xf6
  v_bitop3_b32 v7, v7, v180, s96 bitop3:0xf6
  v_and_b32 v7, v254, v7
  v_cmp_ne_u32 vcc, 0, v7
  s_cbranch_vccnz o_rl_176
  s_branch o_bk_175
o_fd_167:
  s_mov_b32 s65, 0
o_nofl_131:
  s_mov_b32 s63, s64
  s_cmp_lg_u32 s51, 0
  s_cbranch_scc1 o_pick_133
  s_cmp_eq_u32 s50, 0
  s_cbranch_scc1 L_end
o_adv_139:
  s_add_u32 s49, s49, 4
  s_branch o_round_129

.section .rodata,"a"
.p2align 6
.amdhsa_kernel interleave_layers__memory_aug_recurrent_mem_tr__moe_arch_mod__prompt_kernel
  .amdhsa_next_free_vgpr 512
  .amdhsa_next_free_sgpr 102
  .amdhsa_accum_offset 256
  .amdhsa_group_segment_fixed_size 0
  .amdhsa_kernarg_size 120
  .amdhsa_user_sgpr_count 2
  .amdhsa_user_sgpr_kernarg_segment_ptr 1
  .amdhsa_system_sgpr_workgroup_id_x 1
  .amdhsa_float_denorm_mode_32 3
.end_amdhsa_kernel
```

```asm
; @launch grid=(256,1,1) block=(256,1,1) lds=163840
.amdgcn_target "amdgcn-amd-amdhsa--gfx950"
.text
.globl interleave_layers__memory_aug_recurrent_mem_tr__moe_arch_mod__prompt_kernel
.p2align 8
.type interleave_layers__memory_aug_recurrent_mem_tr__moe_arch_mod__prompt_kernel,@function
interleave_layers__memory_aug_recurrent_mem_tr__moe_arch_mod__prompt_kernel:
  s_cmp_ge_u32 s2, 256
  s_cbranch_scc1 L_end
  s_mov_b32 s6, 268435456
  s_mov_b32 s7, 0x20000
  s_mov_b32 s11, 0x20000
  s_getreg_b32 s89, hwreg(HW_REG_XCC_ID)
  s_and_b32 s89, s89, 7
  v_lshrrev_b32 v1, 6, v0
  s_and_b32 s91, s2, 7
  s_lshr_b32 s90, s2, 3
  v_readfirstlane_b32 s17, v1
  s_lshl_b32 s100, s91, 5
  s_add_u32 s100, s100, s90
  s_lshl_b32 s100, s100, 2
  s_add_u32 s100, s100, s17
  s_lshl_b32 s100, s100, 12
  s_add_u32 s100, s100, 37748736
  s_cmp_lt_u32 s91, 3
  s_cbranch_scc1 L_chain
  s_cmp_eq_u32 s91, 7
  s_cbranch_scc1 L_qkv
  s_bitcmp1_b32 s90, 4
  s_cbranch_scc1 L_qkv
  s_branch L_o
L_end:
  s_endpgm
L_chain:
  s_load_dwordx2 s[4:5], s[0:1], 112
  s_load_dwordx2 s[12:13], s[0:1], 104
  s_mov_b32 s16, s90
  s_mov_b32 s60, s91
  s_min_u32 s61, s91, 1
  v_lshrrev_b32 v18, 6, v0
  v_and_b32 v19, 63, v0
  v_readfirstlane_b32 s17, v18
  v_and_b32 v7, 15, v19
  v_lshrrev_b32 v17, 4, v19
  v_lshlrev_b32 v0, 4, v19
  s_load_dwordx2 s[56:57], s[0:1], 8
  s_mov_b32 s44, 0x05040100
  s_mov_b32 s45, 0x07060302
  s_mov_b32 s18, 0xcccccccc
  s_mov_b32 s19, 0xcccccccc
  s_mov_b32 s24, 0x3e0293ee
  s_lshl_b32 s26, s17, 10
  v_add_u32 v8, s26, v0
  v_xor_b32 v9, 1024, v8
  v_xor_b32 v10, 2048, v8
  v_xor_b32 v11, 3072, v8
  s_mov_b32 s14, 0x3f803f80
  s_mov_b32 s15, 0x3f803f80
  s_mul_i32 s27, s17, 24576
  s_add_u32 s27, s27, 65536
  v_add_u32 v1, s27, v0
  v_lshrrev_b32 v20, 2, v7
  v_xor_b32 v21, v17, v20
  v_lshlrev_b32 v22, 5, v7
  v_add_u32 v22, s26, v22
  v_lshl_add_u32 v2, v21, 3, v22
  v_and_b32 v21, 3, v7
  v_xor_b32 v21, v21, v17
  v_lshl_add_u32 v22, v17, 2, v20
  v_lshlrev_b32 v22, 5, v22
  v_lshl_add_u32 v3, v21, 3, v22
  v_add_u32 v12, s26, v3
  v_xor_b32 v13, 1024, v12
  v_xor_b32 v14, 2048, v12
  v_xor_b32 v15, 3072, v12
  v_lshlrev_b32 v21, 13, v20
  v_and_b32 v22, 3, v7
  v_lshl_add_u32 v22, v17, 2, v22
  v_lshl_add_u32 v21, v22, 4, v21
  s_lshl_b32 s27, s17, 16
  s_lshl_b32 s28, s16, 8
  s_add_u32 s27, s27, s28
  v_add_u32 v4, s27, v21
  v_and_b32 v21, 1, v7
  v_lshl_add_u32 v21, v17, 2, v21
  v_bfe_u32 v22, v7, 2, 1
  v_lshl_add_u32 v21, v22, 1, v21
  v_lshlrev_b32 v21, 4, v21
  v_bfe_u32 v22, v7, 1, 1
  v_lshl_add_u32 v21, v22, 3, v21
  v_add_u32 v5, s28, v21
  v_cmp_lt_u32 vcc, 7, v7
  v_mov_b32 v22, 0x7ff00000
  s_nop 0
  v_cndmask_b32 v5, v5, v22, vcc
  v_mov_b32 v21, 0x4444
  v_mov_b32 v22, 0xeeee
  v_cndmask_b32 v6, v21, v22, s[18:19]
  s_lshl_b32 s40, s60, 20
  s_add_u32 s40, s40, 0
  s_add_u32 s41, s40, 32768
  s_lshl_b32 s62, s60, 16
  s_add_u32 s62, s62, 4194304
  v_mov_b32 v24, -1
  v_mov_b32 v25, -1
  v_mov_b32 v26, -1
  v_mov_b32 v27, -1
  s_waitcnt lgkmcnt(0)
  buffer_store_dwordx4 v[24:27], v4, s[4:7], s40 offen sc1
  buffer_store_dwordx4 v[24:27], v4, s[4:7], s41 offen sc1
  s_add_u32 s27, s62, 0
  buffer_store_dwordx2 v[24:25], v5, s[4:7], s27 offen sc1
  s_add_u32 s27, s62, 8192
  buffer_store_dwordx2 v[24:25], v5, s[4:7], s27 offen sc1
  s_add_u32 s27, s62, 16384
  buffer_store_dwordx2 v[24:25], v5, s[4:7], s27 offen sc1
  s_lshl_b32 s26, s16, 12
  s_cmp_eq_u32 s91, 0
  s_cbranch_scc1 L_ch0
  s_cmp_eq_u32 s91, 2
  s_cbranch_scc1 L_ch2
  v_mov_b64 v[28:29], 0
  v_mov_b64 v[30:31], 0
  s_add_u32 s27, s26, 243269632
  buffer_store_dwordx4 v[28:31], v8, s[4:7], s27 offen sc1
  s_add_u32 s27, s26, 243400704
  buffer_store_dwordx4 v[28:31], v8, s[4:7], s27 offen sc1
  s_add_u32 s27, s26, 243531776
  buffer_store_dwordx4 v[28:31], v8, s[4:7], s27 offen sc1
  s_add_u32 s27, s26, 243662848
  buffer_store_dwordx4 v[28:31], v8, s[4:7], s27 offen sc1
  s_add_u32 s27, s26, 243793920
  buffer_store_dwordx4 v[28:31], v8, s[4:7], s27 offen sc1
  s_add_u32 s27, s26, 243924992
  buffer_store_dwordx4 v[28:31], v8, s[4:7], s27 offen sc1
  s_add_u32 s27, s26, 244056064
  buffer_store_dwordx4 v[28:31], v8, s[4:7], s27 offen sc1
  s_add_u32 s27, s26, 244187136
  buffer_store_dwordx4 v[28:31], v8, s[4:7], s27 offen sc1
  s_add_u32 s27, s26, 244318208
  buffer_store_dwordx4 v[28:31], v8, s[4:7], s27 offen sc1
  s_add_u32 s27, s26, 244449280
  buffer_store_dwordx4 v[28:31], v8, s[4:7], s27 offen sc1
  s_add_u32 s27, s26, 244580352
  buffer_store_dwordx4 v[28:31], v8, s[4:7], s27 offen sc1
  s_add_u32 s27, s26, 244711424
  buffer_store_dwordx4 v[28:31], v8, s[4:7], s27 offen sc1
  s_add_u32 s27, s26, 244842496
  buffer_store_dwordx4 v[28:31], v8, s[4:7], s27 offen sc1
  s_add_u32 s27, s26, 244973568
  buffer_store_dwordx4 v[28:31], v8, s[4:7], s27 offen sc1
  s_add_u32 s27, s26, 245104640
  buffer_store_dwordx4 v[28:31], v8, s[4:7], s27 offen sc1
  s_add_u32 s27, s26, 245235712
  buffer_store_dwordx4 v[28:31], v8, s[4:7], s27 offen sc1
  s_add_u32 s27, s26, 245366784
  buffer_store_dwordx4 v[28:31], v8, s[4:7], s27 offen sc1
  s_branch L_ch0
L_ch2:
  s_add_u32 s27, s26, 245891072
  buffer_store_dwordx4 v[24:27], v8, s[4:7], s27 offen sc1
  s_add_u32 s27, s26, 246022144
  buffer_store_dwordx4 v[24:27], v8, s[4:7], s27 offen sc1
  s_add_u32 s27, s26, 246153216
  buffer_store_dwordx4 v[24:27], v8, s[4:7], s27 offen sc1
  s_add_u32 s27, s26, 246284288
  buffer_store_dwordx4 v[24:27], v8, s[4:7], s27 offen sc1
  s_add_u32 s27, s26, 246415360
  buffer_store_dwordx4 v[24:27], v8, s[4:7], s27 offen sc1
  s_add_u32 s27, s26, 246546432
  buffer_store_dwordx4 v[24:27], v8, s[4:7], s27 offen sc1
  s_add_u32 s27, s26, 246677504
  buffer_store_dwordx4 v[24:27], v8, s[4:7], s27 offen sc1
  s_add_u32 s27, s26, 246808576
  buffer_store_dwordx4 v[24:27], v8, s[4:7], s27 offen sc1
  s_add_u32 s27, s26, 246939648
  buffer_store_dwordx4 v[24:27], v8, s[4:7], s27 offen sc1
  s_add_u32 s27, s26, 247070720
  buffer_store_dwordx4 v[24:27], v8, s[4:7], s27 offen sc1
  s_add_u32 s27, s26, 247201792
  buffer_store_dwordx4 v[24:27], v8, s[4:7], s27 offen sc1
  s_add_u32 s27, s26, 247332864
  buffer_store_dwordx4 v[24:27], v8, s[4:7], s27 offen sc1
  s_add_u32 s27, s26, 247463936
  buffer_store_dwordx4 v[24:27], v8, s[4:7], s27 offen sc1
  s_add_u32 s27, s26, 247595008
  buffer_store_dwordx4 v[24:27], v8, s[4:7], s27 offen sc1
  s_add_u32 s27, s26, 247726080
  buffer_store_dwordx4 v[24:27], v8, s[4:7], s27 offen sc1
  s_add_u32 s27, s26, 247857152
  buffer_store_dwordx4 v[24:27], v8, s[4:7], s27 offen sc1
  s_add_u32 s27, s26, 247988224
  buffer_store_dwordx4 v[24:27], v8, s[4:7], s27 offen sc1
  s_add_u32 s27, s26, 248119296
  buffer_store_dwordx4 v[24:27], v8, s[4:7], s27 offen sc1
  s_add_u32 s27, s26, 248250368
  buffer_store_dwordx4 v[24:27], v8, s[4:7], s27 offen sc1
  s_add_u32 s27, s26, 248381440
  buffer_store_dwordx4 v[24:27], v8, s[4:7], s27 offen sc1
  s_add_u32 s27, s26, 248512512
  buffer_store_dwordx4 v[24:27], v8, s[4:7], s27 offen sc1
  s_add_u32 s27, s26, 248643584
  buffer_store_dwordx4 v[24:27], v8, s[4:7], s27 offen sc1
L_ch0:
  s_waitcnt vmcnt(0)
  s_barrier
  s_cmp_lg_u32 s17, 0
  s_cbranch_scc1 g_ar_1
  s_lshl_b32 s36, s89, 3
  s_lshl_b64 s[36:37], 1, s36
  v_lshlrev_b32 v124, 3, s91
  v_mov_b32 v120, s36
  v_mov_b32 v121, s37
  s_mov_b64 exec, 1
  global_atomic_add_x2 v[122:123], v124, v[120:121], s[12:13] sc0
  s_mov_b64 exec, -1
g_ar_1:
  s_cmp_lg_u32 s91, 1
  s_cbranch_scc1 L_ch1
  s_waitcnt vmcnt(0)
  s_cmp_lg_u32 s17, 0
  s_cbranch_scc1 g_af_2
  v_readfirstlane_b32 s36, v122
  v_readfirstlane_b32 s37, v123
  s_add_u32 s38, s36, s37
  s_mul_i32 s38, s38, 0x01010101
  s_lshr_b32 s38, s38, 24
  s_cmp_lg_u32 s38, 31
  s_cbranch_scc1 g_af_2
  s_lshl_b32 s38, s89, 3
  s_lshr_b64 s[36:37], s[36:37], s38
  s_and_b32 s36, s36, 0xff
  s_cmp_eq_u32 s36, 31
  s_cselect_b32 s36, 1, 2
  v_mov_b32 v120, s36
  v_lshrrev_b32 v124, 1, v124
  s_mov_b64 exec, 1
  global_store_dword v124, v120, s[12:13] offset:128 sc1
  s_mov_b64 exec, -1
g_af_2:
  v_mov_b64 v[122:123], 0
L_ch1:
  s_mov_b32 s58, 8192
  s_mov_b32 s59, 0x20000
  v_and_b32 v21, 1, v7
  v_lshl_add_u32 v21, v17, 1, v21
  v_lshlrev_b32 v21, 10, v21
  v_bfe_u32 v22, v7, 1, 2
  v_lshl_add_u32 v21, v22, 1, v21
  s_lshr_b32 s27, s16, 3
  s_lshl_b32 s27, s27, 8
  s_and_b32 s28, s16, 3
  s_lshl_b32 s28, s28, 6
  s_add_u32 s27, s27, s28
  s_and_b32 s28, s16, 4
  s_lshl_b32 s28, s28, 1
  s_add_u32 s27, s27, s28
  s_waitcnt lgkmcnt(0)
  buffer_load_ushort v28, v21, s[56:59], s27 offen offset:0
  buffer_load_ushort v29, v21, s[56:59], s27 offen offset:16
  buffer_load_ushort v30, v21, s[56:59], s27 offen offset:32
  buffer_load_ushort v31, v21, s[56:59], s27 offen offset:48
  s_load_dwordx2 s[8:9], s[0:1], 40
  s_load_dwordx2 s[52:53], s[0:1], 16
  s_load_dwordx2 s[32:33], s[0:1], 24
  s_load_dwordx2 s[48:49], s[0:1], 32
  s_mov_b32 s10, 4194304
  s_mov_b32 s11, 0x20000
  s_mov_b32 s54, 4194304
  s_mov_b32 s55, 0x20000
  s_mov_b32 s34, 4194304
  s_mov_b32 s35, 0x20000
  s_mov_b32 s50, 4194304
  s_mov_b32 s51, 0x20000
  v_and_b32 v20, 1, v17
  v_lshlrev_b32 v20, 5, v20
  v_lshrrev_b32 v21, 1, v17
  v_lshl_add_u32 v20, v21, 2, v20
  v_lshlrev_b32 v20, 10, v20
  v_lshl_add_u32 v20, v7, 4, v20
  s_lshl_b32 s26, s16, 17
  s_lshl_b32 s27, s17, 8
  s_add_u32 s26, s26, s27
  s_waitcnt lgkmcnt(0)
  s_add_u32 s27, s26, 0
  buffer_load_dwordx4 v[128:131], v20, s[8:11], s27 offen
  s_add_u32 s27, s26, 1024
  buffer_load_dwordx4 v[132:135], v20, s[8:11], s27 offen
  s_add_u32 s27, s26, 16384
  buffer_load_dwordx4 v[136:139], v20, s[8:11], s27 offen
  s_add_u32 s27, s26, 17408
  buffer_load_dwordx4 v[140:143], v20, s[8:11], s27 offen
  s_add_u32 s27, s26, 2048
  buffer_load_dwordx4 v[144:147], v20, s[8:11], s27 offen
  s_add_u32 s27, s26, 3072
  buffer_load_dwordx4 v[148:151], v20, s[8:11], s27 offen
  s_add_u32 s27, s26, 18432
  buffer_load_dwordx4 v[152:155], v20, s[8:11], s27 offen
  s_add_u32 s27, s26, 19456
  buffer_load_dwordx4 v[156:159], v20, s[8:11], s27 offen
  s_add_u32 s27, s26, 8192
  buffer_load_dwordx4 v[160:163], v20, s[8:11], s27 offen
  s_add_u32 s27, s26, 9216
  buffer_load_dwordx4 v[164:167], v20, s[8:11], s27 offen
  s_add_u32 s27, s26, 24576
  buffer_load_dwordx4 v[168:171], v20, s[8:11], s27 offen
  s_add_u32 s27, s26, 25600
  buffer_load_dwordx4 v[172:175], v20, s[8:11], s27 offen
  s_add_u32 s27, s26, 10240
  buffer_load_dwordx4 v[176:179], v20, s[8:11], s27 offen
  s_add_u32 s27, s26, 11264
  buffer_load_dwordx4 v[180:183], v20, s[8:11], s27 offen
  s_add_u32 s27, s26, 26624
  buffer_load_dwordx4 v[184:187], v20, s[8:11], s27 offen
  s_add_u32 s27, s26, 27648
  buffer_load_dwordx4 v[188:191], v20, s[8:11], s27 offen
  s_add_u32 s27, s26, 65536
  buffer_load_dwordx4 v[192:195], v20, s[8:11], s27 offen
  s_add_u32 s27, s26, 66560
  buffer_load_dwordx4 v[196:199], v20, s[8:11], s27 offen
  s_add_u32 s27, s26, 81920
  buffer_load_dwordx4 v[200:203], v20, s[8:11], s27 offen
  s_add_u32 s27, s26, 82944
  buffer_load_dwordx4 v[204:207], v20, s[8:11], s27 offen
  s_add_u32 s27, s26, 67584
  buffer_load_dwordx4 v[208:211], v20, s[8:11], s27 offen
  s_add_u32 s27, s26, 68608
  buffer_load_dwordx4 v[212:215], v20, s[8:11], s27 offen
  s_add_u32 s27, s26, 83968
  buffer_load_dwordx4 v[216:219], v20, s[8:11], s27 offen
  s_add_u32 s27, s26, 84992
  buffer_load_dwordx4 v[220:223], v20, s[8:11], s27 offen
  s_add_u32 s27, s26, 73728
  buffer_load_dwordx4 v[224:227], v20, s[8:11], s27 offen
  s_add_u32 s27, s26, 74752
  buffer_load_dwordx4 v[228:231], v20, s[8:11], s27 offen
  s_add_u32 s27, s26, 90112
  buffer_load_dwordx4 v[232:235], v20, s[8:11], s27 offen
  s_add_u32 s27, s26, 91136
  buffer_load_dwordx4 v[236:239], v20, s[8:11], s27 offen
  s_add_u32 s27, s26, 75776
  buffer_load_dwordx4 v[240:243], v20, s[8:11], s27 offen
  s_add_u32 s27, s26, 76800
  buffer_load_dwordx4 v[244:247], v20, s[8:11], s27 offen
  s_add_u32 s27, s26, 92160
  buffer_load_dwordx4 v[248:251], v20, s[8:11], s27 offen
  s_add_u32 s27, s26, 93184
  buffer_load_dwordx4 v[252:255], v20, s[8:11], s27 offen
  s_waitcnt vmcnt(36)
  s_cmp_lg_u32 s17, 0
  s_cbranch_scc1 g_af_3
  v_readfirstlane_b32 s36, v122
  v_readfirstlane_b32 s37, v123
  s_add_u32 s38, s36, s37
  s_mul_i32 s38, s38, 0x01010101
  s_lshr_b32 s38, s38, 24
  s_cmp_lg_u32 s38, 31
  s_cbranch_scc1 g_af_3
  s_lshl_b32 s38, s89, 3
  s_lshr_b64 s[36:37], s[36:37], s38
  s_and_b32 s36, s36, 0xff
  s_cmp_eq_u32 s36, 31
  s_cselect_b32 s36, 1, 2
  v_mov_b32 v120, s36
  v_lshrrev_b32 v124, 1, v124
  s_mov_b64 exec, 1
  global_store_dword v124, v120, s[12:13] offset:128 sc1
  s_mov_b64 exec, -1
g_af_3:
  v_lshrrev_b32 v20, 8, v0
  v_and_b32 v22, 0xf0, v0
  v_lshlrev_b32 v23, 6, v20
  v_xor_b32 v22, v22, v23
  v_lshl_add_u32 v22, v20, 13, v22
  v_xor_b32 v23, 32, v22
  s_lshr_b32 s26, s17, 1
  s_lshl_b32 s26, s26, 20
  s_and_b32 s27, s17, 1
  s_lshl_b32 s27, s27, 18
  s_add_u32 s26, s26, s27
  s_lshl_b32 s27, s16, 8
  s_add_u32 s26, s26, s27
  s_lshl_b32 s28, s17, 13
  s_add_u32 s27, s26, 0
  s_add_u32 m0, s28, 65536
  s_nop 0
  buffer_load_dwordx4 v22, s[32:35], s27 offen lds
  s_add_u32 m0, s28, 66560
  s_add_u32 s27, s27, 32768
  buffer_load_dwordx4 v22, s[32:35], s27 offen lds
  s_add_u32 m0, s28, 67584
  s_add_u32 s27, s27, 32768
  buffer_load_dwordx4 v23, s[32:35], s27 offen lds
  s_add_u32 m0, s28, 68608
  s_add_u32 s27, s27, 32768
  buffer_load_dwordx4 v23, s[32:35], s27 offen lds
  s_add_u32 m0, s28, 69632
  s_add_u32 s27, s27, 32768
  buffer_load_dwordx4 v22, s[32:35], s27 offen lds
  s_add_u32 m0, s28, 70656
  s_add_u32 s27, s27, 32768
  buffer_load_dwordx4 v22, s[32:35], s27 offen lds
  s_add_u32 m0, s28, 71680
  s_add_u32 s27, s27, 32768
  buffer_load_dwordx4 v23, s[32:35], s27 offen lds
  s_add_u32 m0, s28, 72704
  s_add_u32 s27, s27, 32768
  buffer_load_dwordx4 v23, s[32:35], s27 offen lds
  s_add_u32 s27, s26, 524288
  s_add_u32 m0, s28, 98304
  s_nop 0
  buffer_load_dwordx4 v22, s[32:35], s27 offen lds
  s_add_u32 m0, s28, 99328
  s_add_u32 s27, s27, 32768
  buffer_load_dwordx4 v22, s[32:35], s27 offen lds
  s_add_u32 m0, s28, 100352
  s_add_u32 s27, s27, 32768
  buffer_load_dwordx4 v23, s[32:35], s27 offen lds
  s_add_u32 m0, s28, 101376
  s_add_u32 s27, s27, 32768
  buffer_load_dwordx4 v23, s[32:35], s27 offen lds
  s_add_u32 m0, s28, 102400
  s_add_u32 s27, s27, 32768
  buffer_load_dwordx4 v22, s[32:35], s27 offen lds
  s_add_u32 m0, s28, 103424
  s_add_u32 s27, s27, 32768
  buffer_load_dwordx4 v22, s[32:35], s27 offen lds
  s_add_u32 m0, s28, 104448
  s_add_u32 s27, s27, 32768
  buffer_load_dwordx4 v23, s[32:35], s27 offen lds
  s_add_u32 m0, s28, 105472
  s_add_u32 s27, s27, 32768
  buffer_load_dwordx4 v23, s[32:35], s27 offen lds
  s_waitcnt vmcnt(48)
  v_lshl_or_b32 v28, v29, 16, v28
  v_lshl_or_b32 v29, v31, 16, v30
  v_min_u32 v28, -2, v28
  v_min_u32 v29, -2, v29
  buffer_store_dwordx2 v[28:29], v5, s[4:7], s62 offen sc1
  s_add_u32 s27, s26, 2097152
  s_add_u32 m0, s28, 131072
  s_nop 0
  buffer_load_dwordx4 v22, s[32:35], s27 offen lds
  s_add_u32 m0, s28, 132096
  s_add_u32 s27, s27, 32768
  buffer_load_dwordx4 v22, s[32:35], s27 offen lds
  s_add_u32 m0, s28, 133120
  s_add_u32 s27, s27, 32768
  buffer_load_dwordx4 v23, s[32:35], s27 offen lds
  s_add_u32 m0, s28, 134144
  s_add_u32 s27, s27, 32768
  buffer_load_dwordx4 v23, s[32:35], s27 offen lds
  s_add_u32 m0, s28, 135168
  s_add_u32 s27, s27, 32768
  buffer_load_dwordx4 v22, s[32:35], s27 offen lds
  s_add_u32 m0, s28, 136192
  s_add_u32 s27, s27, 32768
  buffer_load_dwordx4 v22, s[32:35], s27 offen lds
  s_add_u32 m0, s28, 137216
  s_add_u32 s27, s27, 32768
  buffer_load_dwordx4 v23, s[32:35], s27 offen lds
  s_add_u32 m0, s28, 138240
  s_add_u32 s27, s27, 32768
  buffer_load_dwordx4 v23, s[32:35], s27 offen lds
  v_bfe_u32 v20, v7, 2, 1
  v_lshrrev_b32 v21, 3, v7
  v_and_b32 v104, 1, v17
  v_lshl_add_u32 v21, v21, 1, v104
  v_lshl_add_u32 v104, v20, 3, v21
  v_lshrrev_b32 v105, 1, v17
  v_lshl_add_u32 v104, v105, 5, v104
  v_lshl_add_u32 v20, v21, 1, v20
  s_lshl_b32 s29, s17, 1
  v_xor_b32 v20, s29, v20
  v_lshlrev_b32 v20, 5, v20
  v_lshl_add_u32 v20, v104, 8, v20
  v_and_b32 v21, 3, v7
  v_lshl_add_u32 v20, v21, 3, v20
  s_lshr_b32 s29, s17, 1
  s_lshl_b32 s29, s29, 14
  s_and_b32 s30, s17, 1
  s_lshl_b32 s30, s30, 10
  s_add_u32 s29, s29, s30
  s_add_u32 s29, s29, 65536
  v_add_u32 v20, s29, v20
  v_xor_b32 v104, 0, v20
  v_xor_b32 v105, 32, v20
  v_xor_b32 v106, 1024, v20
  v_xor_b32 v107, 1056, v20
  v_xor_b32 v108, 16384, v20
  v_xor_b32 v109, 16416, v20
  v_xor_b32 v110, 17408, v20
  v_xor_b32 v111, 17440, v20
  s_waitcnt vmcnt(49)
  v_perm_b32 v120, v132, v128, s44
  v_perm_b32 v121, v140, v136, s44
  v_perm_b32 v122, v148, v144, s44
  v_perm_b32 v123, v156, v152, s44
  v_accvgpr_write_b32 a248, v120
  v_accvgpr_write_b32 a249, v121
  v_accvgpr_write_b32 a250, v122
  v_accvgpr_write_b32 a251, v123
  v_perm_b32 v124, v132, v128, s45
  v_perm_b32 v125, v140, v136, s45
  v_perm_b32 v126, v148, v144, s45
  v_perm_b32 v127, v156, v152, s45
  v_accvgpr_write_b32 a232, v124
  v_accvgpr_write_b32 a233, v125
  v_accvgpr_write_b32 a234, v126
  v_accvgpr_write_b32 a235, v127
  v_perm_b32 v120, v133, v129, s44
  v_perm_b32 v121, v141, v137, s44
  v_perm_b32 v122, v149, v145, s44
  v_perm_b32 v123, v157, v153, s44
  v_accvgpr_write_b32 a216, v120
  v_accvgpr_write_b32 a217, v121
  v_accvgpr_write_b32 a218, v122
  v_accvgpr_write_b32 a219, v123
  v_perm_b32 v124, v133, v129, s45
  v_perm_b32 v125, v141, v137, s45
  v_perm_b32 v126, v149, v145, s45
  v_perm_b32 v127, v157, v153, s45
  v_accvgpr_write_b32 a200, v124
  v_accvgpr_write_b32 a201, v125
  v_accvgpr_write_b32 a202, v126
  v_accvgpr_write_b32 a203, v127
  v_perm_b32 v120, v134, v130, s44
  v_perm_b32 v121, v142, v138, s44
  v_perm_b32 v122, v150, v146, s44
  v_perm_b32 v123, v158, v154, s44
  v_accvgpr_write_b32 a184, v120
  v_accvgpr_write_b32 a185, v121
  v_accvgpr_write_b32 a186, v122
  v_accvgpr_write_b32 a187, v123
  v_perm_b32 v24, v134, v130, s45
  v_perm_b32 v25, v142, v138, s45
  v_perm_b32 v26, v150, v146, s45
  v_perm_b32 v27, v158, v154, s45
  v_perm_b32 v40, v135, v131, s44
  v_perm_b32 v41, v143, v139, s44
  v_perm_b32 v42, v151, v147, s44
  v_perm_b32 v43, v159, v155, s44
  v_perm_b32 v56, v135, v131, s45
  v_perm_b32 v57, v143, v139, s45
  v_perm_b32 v58, v151, v147, s45
  v_perm_b32 v59, v159, v155, s45
  s_waitcnt vmcnt(41)
  v_perm_b32 v120, v164, v160, s44
  v_perm_b32 v121, v172, v168, s44
  v_perm_b32 v122, v180, v176, s44
  v_perm_b32 v123, v188, v184, s44
  v_accvgpr_write_b32 a252, v120
  v_accvgpr_write_b32 a253, v121
  v_accvgpr_write_b32 a254, v122
  v_accvgpr_write_b32 a255, v123
  v_perm_b32 v124, v164, v160, s45
  v_perm_b32 v125, v172, v168, s45
  v_perm_b32 v126, v180, v176, s45
  v_perm_b32 v127, v188, v184, s45
  v_accvgpr_write_b32 a236, v124
  v_accvgpr_write_b32 a237, v125
  v_accvgpr_write_b32 a238, v126
  v_accvgpr_write_b32 a239, v127
  v_perm_b32 v120, v165, v161, s44
  v_perm_b32 v121, v173, v169, s44
  v_perm_b32 v122, v181, v177, s44
  v_perm_b32 v123, v189, v185, s44
  v_accvgpr_write_b32 a220, v120
  v_accvgpr_write_b32 a221, v121
  v_accvgpr_write_b32 a222, v122
  v_accvgpr_write_b32 a223, v123
  v_perm_b32 v124, v165, v161, s45
  v_perm_b32 v125, v173, v169, s45
  v_perm_b32 v126, v181, v177, s45
  v_perm_b32 v127, v189, v185, s45
  v_accvgpr_write_b32 a204, v124
  v_accvgpr_write_b32 a205, v125
  v_accvgpr_write_b32 a206, v126
  v_accvgpr_write_b32 a207, v127
  v_perm_b32 v120, v166, v162, s44
  v_perm_b32 v121, v174, v170, s44
  v_perm_b32 v122, v182, v178, s44
  v_perm_b32 v123, v190, v186, s44
  v_accvgpr_write_b32 a188, v120
  v_accvgpr_write_b32 a189, v121
  v_accvgpr_write_b32 a190, v122
  v_accvgpr_write_b32 a191, v123
  v_perm_b32 v28, v166, v162, s45
  v_perm_b32 v29, v174, v170, s45
  v_perm_b32 v30, v182, v178, s45
  v_perm_b32 v31, v190, v186, s45
  v_perm_b32 v44, v167, v163, s44
  v_perm_b32 v45, v175, v171, s44
  v_perm_b32 v46, v183, v179, s44
  v_perm_b32 v47, v191, v187, s44
  v_perm_b32 v60, v167, v163, s45
  v_perm_b32 v61, v175, v171, s45
  v_perm_b32 v62, v183, v179, s45
  v_perm_b32 v63, v191, v187, s45
  s_waitcnt vmcnt(33)
  v_perm_b32 v120, v196, v192, s44
  v_perm_b32 v121, v204, v200, s44
  v_perm_b32 v122, v212, v208, s44
  v_perm_b32 v123, v220, v216, s44
  v_accvgpr_write_b32 a240, v120
  v_accvgpr_write_b32 a241, v121
  v_accvgpr_write_b32 a242, v122
  v_accvgpr_write_b32 a243, v123
  v_perm_b32 v124, v196, v192, s45
  v_perm_b32 v125, v204, v200, s45
  v_perm_b32 v126, v212, v208, s45
  v_perm_b32 v127, v220, v216, s45
  v_accvgpr_write_b32 a224, v124
  v_accvgpr_write_b32 a225, v125
  v_accvgpr_write_b32 a226, v126
  v_accvgpr_write_b32 a227, v127
  v_perm_b32 v120, v197, v193, s44
  v_perm_b32 v121, v205, v201, s44
  v_perm_b32 v122, v213, v209, s44
  v_perm_b32 v123, v221, v217, s44
  v_accvgpr_write_b32 a208, v120
  v_accvgpr_write_b32 a209, v121
  v_accvgpr_write_b32 a210, v122
  v_accvgpr_write_b32 a211, v123
  v_perm_b32 v124, v197, v193, s45
  v_perm_b32 v125, v205, v201, s45
  v_perm_b32 v126, v213, v209, s45
  v_perm_b32 v127, v221, v217, s45
  v_accvgpr_write_b32 a192, v124
  v_accvgpr_write_b32 a193, v125
  v_accvgpr_write_b32 a194, v126
  v_accvgpr_write_b32 a195, v127
  v_perm_b32 v120, v198, v194, s44
  v_perm_b32 v121, v206, v202, s44
  v_perm_b32 v122, v214, v210, s44
  v_perm_b32 v123, v222, v218, s44
  v_accvgpr_write_b32 a176, v120
  v_accvgpr_write_b32 a177, v121
  v_accvgpr_write_b32 a178, v122
  v_accvgpr_write_b32 a179, v123
  v_perm_b32 v32, v198, v194, s45
  v_perm_b32 v33, v206, v202, s45
  v_perm_b32 v34, v214, v210, s45
  v_perm_b32 v35, v222, v218, s45
  v_perm_b32 v48, v199, v195, s44
  v_perm_b32 v49, v207, v203, s44
  v_perm_b32 v50, v215, v211, s44
  v_perm_b32 v51, v223, v219, s44
  v_perm_b32 v64, v199, v195, s45
  v_perm_b32 v65, v207, v203, s45
  v_perm_b32 v66, v215, v211, s45
  v_perm_b32 v67, v223, v219, s45
  s_waitcnt vmcnt(25)
  v_perm_b32 v120, v228, v224, s44
  v_perm_b32 v121, v236, v232, s44
  v_perm_b32 v122, v244, v240, s44
  v_perm_b32 v123, v252, v248, s44
  v_accvgpr_write_b32 a244, v120
  v_accvgpr_write_b32 a245, v121
  v_accvgpr_write_b32 a246, v122
  v_accvgpr_write_b32 a247, v123
  v_perm_b32 v124, v228, v224, s45
  v_perm_b32 v125, v236, v232, s45
  v_perm_b32 v126, v244, v240, s45
  v_perm_b32 v127, v252, v248, s45
  v_accvgpr_write_b32 a228, v124
  v_accvgpr_write_b32 a229, v125
  v_accvgpr_write_b32 a230, v126
  v_accvgpr_write_b32 a231, v127
  v_perm_b32 v120, v229, v225, s44
  v_perm_b32 v121, v237, v233, s44
  v_perm_b32 v122, v245, v241, s44
  v_perm_b32 v123, v253, v249, s44
  v_accvgpr_write_b32 a212, v120
  v_accvgpr_write_b32 a213, v121
  v_accvgpr_write_b32 a214, v122
  v_accvgpr_write_b32 a215, v123
  v_perm_b32 v124, v229, v225, s45
  v_perm_b32 v125, v237, v233, s45
  v_perm_b32 v126, v245, v241, s45
  v_perm_b32 v127, v253, v249, s45
  v_accvgpr_write_b32 a196, v124
  v_accvgpr_write_b32 a197, v125
  v_accvgpr_write_b32 a198, v126
  v_accvgpr_write_b32 a199, v127
  v_perm_b32 v120, v230, v226, s44
  v_perm_b32 v121, v238, v234, s44
  v_perm_b32 v122, v246, v242, s44
  v_perm_b32 v123, v254, v250, s44
  v_accvgpr_write_b32 a180, v120
  v_accvgpr_write_b32 a181, v121
  v_accvgpr_write_b32 a182, v122
  v_accvgpr_write_b32 a183, v123
  v_perm_b32 v36, v230, v226, s45
  v_perm_b32 v37, v238, v234, s45
  v_perm_b32 v38, v246, v242, s45
  v_perm_b32 v39, v254, v250, s45
  v_perm_b32 v52, v231, v227, s44
  v_perm_b32 v53, v239, v235, s44
  v_perm_b32 v54, v247, v243, s44
  v_perm_b32 v55, v255, v251, s44
  v_perm_b32 v68, v231, v227, s45
  v_perm_b32 v69, v239, v235, s45
  v_perm_b32 v70, v247, v243, s45
  v_perm_b32 v71, v255, v251, s45
  v_mov_b64 v[128:129], v[24:25]
  v_mov_b64 v[130:131], v[26:27]
  v_mov_b64 v[132:133], v[28:29]
  v_mov_b64 v[134:135], v[30:31]
  v_mov_b64 v[136:137], v[32:33]
  v_mov_b64 v[138:139], v[34:35]
  v_mov_b64 v[140:141], v[36:37]
  v_mov_b64 v[142:143], v[38:39]
  v_mov_b64 v[144:145], v[40:41]
  v_mov_b64 v[146:147], v[42:43]
  v_mov_b64 v[148:149], v[44:45]
  v_mov_b64 v[150:151], v[46:47]
  v_mov_b64 v[152:153], v[48:49]
  v_mov_b64 v[154:155], v[50:51]
  v_mov_b64 v[156:157], v[52:53]
  v_mov_b64 v[158:159], v[54:55]
  v_mov_b64 v[184:185], v[56:57]
  v_mov_b64 v[186:187], v[58:59]
  v_mov_b64 v[188:189], v[60:61]
  v_mov_b64 v[190:191], v[62:63]
  v_mov_b64 v[192:193], v[64:65]
  v_mov_b64 v[194:195], v[66:67]
  v_mov_b64 v[196:197], v[68:69]
  v_mov_b64 v[198:199], v[70:71]
  s_waitcnt vmcnt(17)
  s_barrier
  s_add_u32 s27, s26, 2621440
  s_add_u32 m0, s28, 0
  s_nop 0
  buffer_load_dwordx4 v22, s[32:35], s27 offen lds
  s_add_u32 m0, s28, 1024
  s_add_u32 s27, s27, 32768
  buffer_load_dwordx4 v22, s[32:35], s27 offen lds
  s_add_u32 m0, s28, 2048
  s_add_u32 s27, s27, 32768
  buffer_load_dwordx4 v23, s[32:35], s27 offen lds
  s_add_u32 m0, s28, 3072
  s_add_u32 s27, s27, 32768
  buffer_load_dwordx4 v23, s[32:35], s27 offen lds
  s_add_u32 m0, s28, 4096
  s_add_u32 s27, s27, 32768
  buffer_load_dwordx4 v22, s[32:35], s27 offen lds
  s_add_u32 m0, s28, 5120
  s_add_u32 s27, s27, 32768
  buffer_load_dwordx4 v22, s[32:35], s27 offen lds
  s_add_u32 m0, s28, 6144
  s_add_u32 s27, s27, 32768
  buffer_load_dwordx4 v23, s[32:35], s27 offen lds
  s_add_u32 m0, s28, 7168
  s_add_u32 s27, s27, 32768
  buffer_load_dwordx4 v23, s[32:35], s27 offen lds
  ds_read_b64_tr_b16 v[40:41], v104 offset:0
  ds_read_b64_tr_b16 v[42:43], v104 offset:4096
  ds_read_b64_tr_b16 v[48:49], v105 offset:0
  ds_read_b64_tr_b16 v[50:51], v105 offset:4096
  ds_read_b64_tr_b16 a[72:73], v106 offset:0
  ds_read_b64_tr_b16 a[74:75], v106 offset:4096
  ds_read_b64_tr_b16 a[24:25], v107 offset:0
  ds_read_b64_tr_b16 a[26:27], v107 offset:4096
  ds_read_b64_tr_b16 a[64:65], v108 offset:0
  ds_read_b64_tr_b16 a[66:67], v108 offset:4096
  ds_read_b64_tr_b16 a[16:17], v109 offset:0
  ds_read_b64_tr_b16 a[18:19], v109 offset:4096
  ds_read_b64_tr_b16 a[56:57], v110 offset:0
  ds_read_b64_tr_b16 a[58:59], v110 offset:4096
  ds_read_b64_tr_b16 a[8:9], v111 offset:0
  ds_read_b64_tr_b16 a[10:11], v111 offset:4096
  s_waitcnt lgkmcnt(0)
  s_waitcnt vmcnt(17)
  s_barrier
  s_add_u32 s27, s26, 0
  s_add_u32 m0, s28, 32768
  s_nop 0
  buffer_load_dwordx4 v22, s[52:55], s27 offen lds
  s_add_u32 m0, s28, 33792
  s_add_u32 s27, s27, 32768
  buffer_load_dwordx4 v22, s[52:55], s27 offen lds
  s_add_u32 m0, s28, 34816
  s_add_u32 s27, s27, 32768
  buffer_load_dwordx4 v23, s[52:55], s27 offen lds
  s_add_u32 m0, s28, 35840
  s_add_u32 s27, s27, 32768
  buffer_load_dwordx4 v23, s[52:55], s27 offen lds
  s_add_u32 m0, s28, 36864
  s_add_u32 s27, s27, 32768
  buffer_load_dwordx4 v22, s[52:55], s27 offen lds
  s_add_u32 m0, s28, 37888
  s_add_u32 s27, s27, 32768
  buffer_load_dwordx4 v22, s[52:55], s27 offen lds
  s_add_u32 m0, s28, 38912
  s_add_u32 s27, s27, 32768
  buffer_load_dwordx4 v23, s[52:55], s27 offen lds
  s_add_u32 m0, s28, 39936
  s_add_u32 s27, s27, 32768
  buffer_load_dwordx4 v23, s[52:55], s27 offen lds
  ds_read_b64_tr_b16 v[44:45], v104 offset:32768
  ds_read_b64_tr_b16 v[46:47], v104 offset:36864
  ds_read_b64_tr_b16 v[52:53], v105 offset:32768
  ds_read_b64_tr_b16 v[54:55], v105 offset:36864
  ds_read_b64_tr_b16 a[76:77], v106 offset:32768
  ds_read_b64_tr_b16 a[78:79], v106 offset:36864
  ds_read_b64_tr_b16 a[28:29], v107 offset:32768
  ds_read_b64_tr_b16 a[30:31], v107 offset:36864
  ds_read_b64_tr_b16 a[68:69], v108 offset:32768
  ds_read_b64_tr_b16 a[70:71], v108 offset:36864
  ds_read_b64_tr_b16 a[20:21], v109 offset:32768
  ds_read_b64_tr_b16 a[22:23], v109 offset:36864
  ds_read_b64_tr_b16 a[60:61], v110 offset:32768
  ds_read_b64_tr_b16 a[62:63], v110 offset:36864
  ds_read_b64_tr_b16 a[12:13], v111 offset:32768
  ds_read_b64_tr_b16 a[14:15], v111 offset:36864
  s_waitcnt lgkmcnt(0)
  v_add_u32 v104, 65536, v104
  v_add_u32 v105, 65536, v105
  v_add_u32 v106, 65536, v106
  v_add_u32 v107, 65536, v107
  v_add_u32 v108, 65536, v108
  v_add_u32 v109, 65536, v109
  v_add_u32 v110, 65536, v110
  v_add_u32 v111, 65536, v111
  s_waitcnt vmcnt(16)
  s_barrier
  s_add_u32 s27, s26, 524288
  s_add_u32 m0, s28, 65536
  s_nop 0
  buffer_load_dwordx4 v22, s[52:55], s27 offen lds
  s_add_u32 m0, s28, 66560
  s_add_u32 s27, s27, 32768
  buffer_load_dwordx4 v22, s[52:55], s27 offen lds
  s_add_u32 m0, s28, 67584
  s_add_u32 s27, s27, 32768
  buffer_load_dwordx4 v23, s[52:55], s27 offen lds
  s_add_u32 m0, s28, 68608
  s_add_u32 s27, s27, 32768
  buffer_load_dwordx4 v23, s[52:55], s27 offen lds
  s_add_u32 m0, s28, 69632
  s_add_u32 s27, s27, 32768
  buffer_load_dwordx4 v22, s[52:55], s27 offen lds
  s_add_u32 m0, s28, 70656
  s_add_u32 s27, s27, 32768
  buffer_load_dwordx4 v22, s[52:55], s27 offen lds
  s_add_u32 m0, s28, 71680
  s_add_u32 s27, s27, 32768
  buffer_load_dwordx4 v23, s[52:55], s27 offen lds
  s_add_u32 m0, s28, 72704
  s_add_u32 s27, s27, 32768
  buffer_load_dwordx4 v23, s[52:55], s27 offen lds
  ds_read_b64_tr_b16 v[72:73], v104 offset:0
  ds_read_b64_tr_b16 v[74:75], v104 offset:4096
  ds_read_b64_tr_b16 v[80:81], v105 offset:0
  ds_read_b64_tr_b16 v[82:83], v105 offset:4096
  ds_read_b64_tr_b16 a[48:49], v106 offset:0
  ds_read_b64_tr_b16 a[50:51], v106 offset:4096
  ds_read_b64_tr_b16 a[0:1], v107 offset:0
  ds_read_b64_tr_b16 a[2:3], v107 offset:4096
  ds_read_b64_tr_b16 a[40:41], v108 offset:0
  ds_read_b64_tr_b16 a[42:43], v108 offset:4096
  ds_read_b64_tr_b16 v[248:249], v109 offset:0
  ds_read_b64_tr_b16 v[250:251], v109 offset:4096
  ds_read_b64_tr_b16 a[32:33], v110 offset:0
  ds_read_b64_tr_b16 a[34:35], v110 offset:4096
  ds_read_b64_tr_b16 v[240:241], v111 offset:0
  ds_read_b64_tr_b16 v[242:243], v111 offset:4096
  s_waitcnt lgkmcnt(0)
  v_add_u32 v104, -131072, v104
  v_add_u32 v105, -131072, v105
  v_add_u32 v106, -131072, v106
  v_add_u32 v107, -131072, v107
  v_add_u32 v108, -131072, v108
  v_add_u32 v109, -131072, v109
  v_add_u32 v110, -131072, v110
  v_add_u32 v111, -131072, v111
  s_waitcnt vmcnt(16)
  s_barrier
  s_add_u32 s27, s26, 2097152
  s_add_u32 m0, s28, 98304
  s_nop 0
  buffer_load_dwordx4 v22, s[52:55], s27 offen lds
  s_add_u32 m0, s28, 99328
  s_add_u32 s27, s27, 32768
  buffer_load_dwordx4 v22, s[52:55], s27 offen lds
  s_add_u32 m0, s28, 100352
  s_add_u32 s27, s27, 32768
  buffer_load_dwordx4 v23, s[52:55], s27 offen lds
  s_add_u32 m0, s28, 101376
  s_add_u32 s27, s27, 32768
  buffer_load_dwordx4 v23, s[52:55], s27 offen lds
  s_add_u32 m0, s28, 102400
  s_add_u32 s27, s27, 32768
  buffer_load_dwordx4 v22, s[52:55], s27 offen lds
  s_add_u32 m0, s28, 103424
  s_add_u32 s27, s27, 32768
  buffer_load_dwordx4 v22, s[52:55], s27 offen lds
  s_add_u32 m0, s28, 104448
  s_add_u32 s27, s27, 32768
  buffer_load_dwordx4 v23, s[52:55], s27 offen lds
  s_add_u32 m0, s28, 105472
  s_add_u32 s27, s27, 32768
  buffer_load_dwordx4 v23, s[52:55], s27 offen lds
  ds_read_b64_tr_b16 v[76:77], v104 offset:0
  ds_read_b64_tr_b16 v[78:79], v104 offset:4096
  ds_read_b64_tr_b16 v[84:85], v105 offset:0
  ds_read_b64_tr_b16 v[86:87], v105 offset:4096
  ds_read_b64_tr_b16 a[52:53], v106 offset:0
  ds_read_b64_tr_b16 a[54:55], v106 offset:4096
  ds_read_b64_tr_b16 a[4:5], v107 offset:0
  ds_read_b64_tr_b16 a[6:7], v107 offset:4096
  ds_read_b64_tr_b16 a[44:45], v108 offset:0
  ds_read_b64_tr_b16 a[46:47], v108 offset:4096
  ds_read_b64_tr_b16 v[252:253], v109 offset:0
  ds_read_b64_tr_b16 v[254:255], v109 offset:4096
  ds_read_b64_tr_b16 a[36:37], v110 offset:0
  ds_read_b64_tr_b16 a[38:39], v110 offset:4096
  ds_read_b64_tr_b16 v[244:245], v111 offset:0
  ds_read_b64_tr_b16 v[246:247], v111 offset:4096
  s_waitcnt lgkmcnt(0)
  s_waitcnt vmcnt(16)
  s_barrier
  s_add_u32 s27, s26, 2621440
  s_add_u32 m0, s28, 131072
  s_nop 0
  buffer_load_dwordx4 v22, s[52:55], s27 offen lds
  s_add_u32 m0, s28, 132096
  s_add_u32 s27, s27, 32768
  buffer_load_dwordx4 v22, s[52:55], s27 offen lds
  s_add_u32 m0, s28, 133120
  s_add_u32 s27, s27, 32768
  buffer_load_dwordx4 v23, s[52:55], s27 offen lds
  s_add_u32 m0, s28, 134144
  s_add_u32 s27, s27, 32768
  buffer_load_dwordx4 v23, s[52:55], s27 offen lds
  s_add_u32 m0, s28, 135168
  s_add_u32 s27, s27, 32768
  buffer_load_dwordx4 v22, s[52:55], s27 offen lds
  s_add_u32 m0, s28, 136192
  s_add_u32 s27, s27, 32768
  buffer_load_dwordx4 v22, s[52:55], s27 offen lds
  s_add_u32 m0, s28, 137216
  s_add_u32 s27, s27, 32768
  buffer_load_dwordx4 v23, s[52:55], s27 offen lds
  s_add_u32 m0, s28, 138240
  s_add_u32 s27, s27, 32768
  buffer_load_dwordx4 v23, s[52:55], s27 offen lds
  ds_read_b64_tr_b16 v[24:25], v104 offset:32768
  ds_read_b64_tr_b16 v[26:27], v104 offset:36864
  ds_read_b64_tr_b16 v[32:33], v105 offset:32768
  ds_read_b64_tr_b16 v[34:35], v105 offset:36864
  ds_read_b64_tr_b16 a[168:169], v106 offset:32768
  ds_read_b64_tr_b16 a[170:171], v106 offset:36864
  ds_read_b64_tr_b16 a[120:121], v107 offset:32768
  ds_read_b64_tr_b16 a[122:123], v107 offset:36864
  ds_read_b64_tr_b16 a[160:161], v108 offset:32768
  ds_read_b64_tr_b16 a[162:163], v108 offset:36864
  ds_read_b64_tr_b16 a[112:113], v109 offset:32768
  ds_read_b64_tr_b16 a[114:115], v109 offset:36864
  ds_read_b64_tr_b16 a[152:153], v110 offset:32768
  ds_read_b64_tr_b16 a[154:155], v110 offset:36864
  ds_read_b64_tr_b16 a[104:105], v111 offset:32768
  ds_read_b64_tr_b16 a[106:107], v111 offset:36864
  s_waitcnt lgkmcnt(0)
  v_add_u32 v104, 65536, v104
  v_add_u32 v105, 65536, v105
  v_add_u32 v106, 65536, v106
  v_add_u32 v107, 65536, v107
  v_add_u32 v108, 65536, v108
  v_add_u32 v109, 65536, v109
  v_add_u32 v110, 65536, v110
  v_add_u32 v111, 65536, v111
  s_waitcnt vmcnt(16)
  s_barrier
  s_add_u32 s27, s26, 0
  s_add_u32 m0, s28, 0
  s_nop 0
  buffer_load_dwordx4 v22, s[48:51], s27 offen lds
  s_add_u32 m0, s28, 1024
  s_add_u32 s27, s27, 32768
  buffer_load_dwordx4 v22, s[48:51], s27 offen lds
  s_add_u32 m0, s28, 2048
  s_add_u32 s27, s27, 32768
  buffer_load_dwordx4 v23, s[48:51], s27 offen lds
  s_add_u32 m0, s28, 3072
  s_add_u32 s27, s27, 32768
  buffer_load_dwordx4 v23, s[48:51], s27 offen lds
  s_add_u32 m0, s28, 4096
  s_add_u32 s27, s27, 32768
  buffer_load_dwordx4 v22, s[48:51], s27 offen lds
  s_add_u32 m0, s28, 5120
  s_add_u32 s27, s27, 32768
  buffer_load_dwordx4 v22, s[48:51], s27 offen lds
  s_add_u32 m0, s28, 6144
  s_add_u32 s27, s27, 32768
  buffer_load_dwordx4 v23, s[48:51], s27 offen lds
  s_add_u32 m0, s28, 7168
  s_add_u32 s27, s27, 32768
  buffer_load_dwordx4 v23, s[48:51], s27 offen lds
  ds_read_b64_tr_b16 v[28:29], v104 offset:0
  ds_read_b64_tr_b16 v[30:31], v104 offset:4096
  ds_read_b64_tr_b16 v[36:37], v105 offset:0
  ds_read_b64_tr_b16 v[38:39], v105 offset:4096
  ds_read_b64_tr_b16 a[172:173], v106 offset:0
  ds_read_b64_tr_b16 a[174:175], v106 offset:4096
  ds_read_b64_tr_b16 a[124:125], v107 offset:0
  ds_read_b64_tr_b16 a[126:127], v107 offset:4096
  ds_read_b64_tr_b16 a[164:165], v108 offset:0
  ds_read_b64_tr_b16 a[166:167], v108 offset:4096
  ds_read_b64_tr_b16 a[116:117], v109 offset:0
  ds_read_b64_tr_b16 a[118:119], v109 offset:4096
  ds_read_b64_tr_b16 a[156:157], v110 offset:0
  ds_read_b64_tr_b16 a[158:159], v110 offset:4096
  ds_read_b64_tr_b16 a[108:109], v111 offset:0
  ds_read_b64_tr_b16 a[110:111], v111 offset:4096
  s_waitcnt lgkmcnt(0)
  s_waitcnt vmcnt(16)
  s_barrier
  s_add_u32 s27, s26, 524288
  s_add_u32 m0, s28, 32768
  s_nop 0
  buffer_load_dwordx4 v22, s[48:51], s27 offen lds
  s_add_u32 m0, s28, 33792
  s_add_u32 s27, s27, 32768
  buffer_load_dwordx4 v22, s[48:51], s27 offen lds
  s_add_u32 m0, s28, 34816
  s_add_u32 s27, s27, 32768
  buffer_load_dwordx4 v23, s[48:51], s27 offen lds
  s_add_u32 m0, s28, 35840
  s_add_u32 s27, s27, 32768
  buffer_load_dwordx4 v23, s[48:51], s27 offen lds
  s_add_u32 m0, s28, 36864
  s_add_u32 s27, s27, 32768
  buffer_load_dwordx4 v22, s[48:51], s27 offen lds
  s_add_u32 m0, s28, 37888
  s_add_u32 s27, s27, 32768
  buffer_load_dwordx4 v22, s[48:51], s27 offen lds
  s_add_u32 m0, s28, 38912
  s_add_u32 s27, s27, 32768
  buffer_load_dwordx4 v23, s[48:51], s27 offen lds
  s_add_u32 m0, s28, 39936
  s_add_u32 s27, s27, 32768
  buffer_load_dwordx4 v23, s[48:51], s27 offen lds
  ds_read_b64_tr_b16 v[56:57], v104 offset:32768
  ds_read_b64_tr_b16 v[58:59], v104 offset:36864
  ds_read_b64_tr_b16 v[64:65], v105 offset:32768
  ds_read_b64_tr_b16 v[66:67], v105 offset:36864
  ds_read_b64_tr_b16 a[144:145], v106 offset:32768
  ds_read_b64_tr_b16 a[146:147], v106 offset:36864
  ds_read_b64_tr_b16 a[96:97], v107 offset:32768
  ds_read_b64_tr_b16 a[98:99], v107 offset:36864
  ds_read_b64_tr_b16 a[136:137], v108 offset:32768
  ds_read_b64_tr_b16 a[138:139], v108 offset:36864
  ds_read_b64_tr_b16 a[88:89], v109 offset:32768
  ds_read_b64_tr_b16 a[90:91], v109 offset:36864
  ds_read_b64_tr_b16 a[128:129], v110 offset:32768
  ds_read_b64_tr_b16 a[130:131], v110 offset:36864
  ds_read_b64_tr_b16 a[80:81], v111 offset:32768
  ds_read_b64_tr_b16 a[82:83], v111 offset:36864
  s_waitcnt lgkmcnt(0)
  v_add_u32 v104, 65536, v104
  v_add_u32 v105, 65536, v105
  v_add_u32 v106, 65536, v106
  v_add_u32 v107, 65536, v107
  v_add_u32 v108, 65536, v108
  v_add_u32 v109, 65536, v109
  v_add_u32 v110, 65536, v110
  v_add_u32 v111, 65536, v111
  s_waitcnt vmcnt(16)
  s_barrier
  s_add_u32 s27, s26, 2097152
  s_add_u32 m0, s28, 65536
  s_nop 0
  buffer_load_dwordx4 v22, s[48:51], s27 offen lds
  s_add_u32 m0, s28, 66560
  s_add_u32 s27, s27, 32768
  buffer_load_dwordx4 v22, s[48:51], s27 offen lds
  s_add_u32 m0, s28, 67584
  s_add_u32 s27, s27, 32768
  buffer_load_dwordx4 v23, s[48:51], s27 offen lds
  s_add_u32 m0, s28, 68608
  s_add_u32 s27, s27, 32768
  buffer_load_dwordx4 v23, s[48:51], s27 offen lds
  s_add_u32 m0, s28, 69632
  s_add_u32 s27, s27, 32768
  buffer_load_dwordx4 v22, s[48:51], s27 offen lds
  s_add_u32 m0, s28, 70656
  s_add_u32 s27, s27, 32768
  buffer_load_dwordx4 v22, s[48:51], s27 offen lds
  s_add_u32 m0, s28, 71680
  s_add_u32 s27, s27, 32768
  buffer_load_dwordx4 v23, s[48:51], s27 offen lds
  s_add_u32 m0, s28, 72704
  s_add_u32 s27, s27, 32768
  buffer_load_dwordx4 v23, s[48:51], s27 offen lds
  ds_read_b64_tr_b16 v[60:61], v104 offset:0
  ds_read_b64_tr_b16 v[62:63], v104 offset:4096
  ds_read_b64_tr_b16 v[68:69], v105 offset:0
  ds_read_b64_tr_b16 v[70:71], v105 offset:4096
  ds_read_b64_tr_b16 a[148:149], v106 offset:0
  ds_read_b64_tr_b16 a[150:151], v106 offset:4096
  ds_read_b64_tr_b16 a[100:101], v107 offset:0
  ds_read_b64_tr_b16 a[102:103], v107 offset:4096
  ds_read_b64_tr_b16 a[140:141], v108 offset:0
  ds_read_b64_tr_b16 a[142:143], v108 offset:4096
  ds_read_b64_tr_b16 a[92:93], v109 offset:0
  ds_read_b64_tr_b16 a[94:95], v109 offset:4096
  ds_read_b64_tr_b16 a[132:133], v110 offset:0
  ds_read_b64_tr_b16 a[134:135], v110 offset:4096
  ds_read_b64_tr_b16 a[84:85], v111 offset:0
  ds_read_b64_tr_b16 a[86:87], v111 offset:4096
  s_waitcnt lgkmcnt(0)
  v_add_u32 v104, -131072, v104
  v_add_u32 v105, -131072, v105
  v_add_u32 v106, -131072, v106
  v_add_u32 v107, -131072, v107
  v_add_u32 v108, -131072, v108
  v_add_u32 v109, -131072, v109
  v_add_u32 v110, -131072, v110
  v_add_u32 v111, -131072, v111
  s_waitcnt vmcnt(16)
  s_barrier
  s_add_u32 s27, s26, 2621440
  s_add_u32 m0, s28, 98304
  s_nop 0
  buffer_load_dwordx4 v22, s[48:51], s27 offen lds
  s_add_u32 m0, s28, 99328
  s_add_u32 s27, s27, 32768
  buffer_load_dwordx4 v22, s[48:51], s27 offen lds
  s_add_u32 m0, s28, 100352
  s_add_u32 s27, s27, 32768
  buffer_load_dwordx4 v23, s[48:51], s27 offen lds
  s_add_u32 m0, s28, 101376
  s_add_u32 s27, s27, 32768
  buffer_load_dwordx4 v23, s[48:51], s27 offen lds
  s_add_u32 m0, s28, 102400
  s_add_u32 s27, s27, 32768
  buffer_load_dwordx4 v22, s[48:51], s27 offen lds
  s_add_u32 m0, s28, 103424
  s_add_u32 s27, s27, 32768
  buffer_load_dwordx4 v22, s[48:51], s27 offen lds
  s_add_u32 m0, s28, 104448
  s_add_u32 s27, s27, 32768
  buffer_load_dwordx4 v23, s[48:51], s27 offen lds
  s_add_u32 m0, s28, 105472
  s_add_u32 s27, s27, 32768
  buffer_load_dwordx4 v23, s[48:51], s27 offen lds
  ds_read_b64_tr_b16 v[88:89], v104 offset:0
  ds_read_b64_tr_b16 v[90:91], v104 offset:4096
  ds_read_b64_tr_b16 v[96:97], v105 offset:0
  ds_read_b64_tr_b16 v[98:99], v105 offset:4096
  ds_read_b64_tr_b16 v[232:233], v106 offset:0
  ds_read_b64_tr_b16 v[234:235], v106 offset:4096
  ds_read_b64_tr_b16 v[176:177], v107 offset:0
  ds_read_b64_tr_b16 v[178:179], v107 offset:4096
  ds_read_b64_tr_b16 v[224:225], v108 offset:0
  ds_read_b64_tr_b16 v[226:227], v108 offset:4096
  ds_read_b64_tr_b16 v[168:169], v109 offset:0
  ds_read_b64_tr_b16 v[170:171], v109 offset:4096
  ds_read_b64_tr_b16 v[216:217], v110 offset:0
  ds_read_b64_tr_b16 v[218:219], v110 offset:4096
  ds_read_b64_tr_b16 v[160:161], v111 offset:0
  ds_read_b64_tr_b16 v[162:163], v111 offset:4096
  s_waitcnt lgkmcnt(0)
  s_waitcnt vmcnt(16)
  s_barrier
  ds_read_b64_tr_b16 v[92:93], v104 offset:32768
  ds_read_b64_tr_b16 v[94:95], v104 offset:36864
  ds_read_b64_tr_b16 v[100:101], v105 offset:32768
  ds_read_b64_tr_b16 v[102:103], v105 offset:36864
  ds_read_b64_tr_b16 v[236:237], v106 offset:32768
  ds_read_b64_tr_b16 v[238:239], v106 offset:36864
  ds_read_b64_tr_b16 v[180:181], v107 offset:32768
  ds_read_b64_tr_b16 v[182:183], v107 offset:36864
  ds_read_b64_tr_b16 v[228:229], v108 offset:32768
  ds_read_b64_tr_b16 v[230:231], v108 offset:36864
  ds_read_b64_tr_b16 v[172:173], v109 offset:32768
  ds_read_b64_tr_b16 v[174:175], v109 offset:36864
  ds_read_b64_tr_b16 v[220:221], v110 offset:32768
  ds_read_b64_tr_b16 v[222:223], v110 offset:36864
  ds_read_b64_tr_b16 v[164:165], v111 offset:32768
  ds_read_b64_tr_b16 v[166:167], v111 offset:36864
  s_waitcnt lgkmcnt(0)
  s_barrier
  v_add_u32 v104, 65536, v104
  v_add_u32 v105, 65536, v105
  v_add_u32 v106, 65536, v106
  v_add_u32 v107, 65536, v107
  v_add_u32 v108, 65536, v108
  v_add_u32 v109, 65536, v109
  v_add_u32 v110, 65536, v110
  v_add_u32 v111, 65536, v111
  ds_write_b128 v8, v[128:131] offset:16384
  ds_write_b128 v8, v[132:135] offset:20480
  ds_write_b128 v8, v[136:139] offset:24576
  ds_write_b128 v8, v[140:143] offset:28672
  ds_write_b128 v8, v[144:147] offset:32768
  ds_write_b128 v8, v[148:151] offset:36864
  ds_write_b128 v8, v[152:155] offset:40960
  ds_write_b128 v8, v[156:159] offset:45056
  ds_write_b128 v8, v[184:187] offset:49152
  ds_write_b128 v8, v[188:191] offset:53248
  ds_write_b128 v8, v[192:195] offset:57344
  ds_write_b128 v8, v[196:199] offset:61440
  s_waitcnt lgkmcnt(0)
  s_waitcnt vmcnt(8)
  s_barrier
  ds_read_b64_tr_b16 v[208:209], v104 offset:0
  ds_read_b64_tr_b16 v[210:211], v104 offset:4096
  ds_read_b64_tr_b16 v[152:153], v105 offset:0
  ds_read_b64_tr_b16 v[154:155], v105 offset:4096
  ds_read_b64_tr_b16 v[200:201], v106 offset:0
  ds_read_b64_tr_b16 v[202:203], v106 offset:4096
  ds_read_b64_tr_b16 v[144:145], v107 offset:0
  ds_read_b64_tr_b16 v[146:147], v107 offset:4096
  ds_read_b64_tr_b16 v[192:193], v108 offset:0
  ds_read_b64_tr_b16 v[194:195], v108 offset:4096
  ds_read_b64_tr_b16 v[136:137], v109 offset:0
  ds_read_b64_tr_b16 v[138:139], v109 offset:4096
  ds_read_b64_tr_b16 v[184:185], v110 offset:0
  ds_read_b64_tr_b16 v[186:187], v110 offset:4096
  ds_read_b64_tr_b16 v[128:129], v111 offset:0
  ds_read_b64_tr_b16 v[130:131], v111 offset:4096
  s_waitcnt lgkmcnt(0)
  s_waitcnt vmcnt(0)
  s_barrier
  ds_read_b64_tr_b16 v[212:213], v104 offset:32768
  ds_read_b64_tr_b16 v[214:215], v104 offset:36864
  ds_read_b64_tr_b16 v[156:157], v105 offset:32768
  ds_read_b64_tr_b16 v[158:159], v105 offset:36864
  ds_read_b64_tr_b16 v[204:205], v106 offset:32768
  ds_read_b64_tr_b16 v[206:207], v106 offset:36864
  ds_read_b64_tr_b16 v[148:149], v107 offset:32768
  ds_read_b64_tr_b16 v[150:151], v107 offset:36864
  ds_read_b64_tr_b16 v[196:197], v108 offset:32768
  ds_read_b64_tr_b16 v[198:199], v108 offset:36864
  ds_read_b64_tr_b16 v[140:141], v109 offset:32768
  ds_read_b64_tr_b16 v[142:143], v109 offset:36864
  ds_read_b64_tr_b16 v[188:189], v110 offset:32768
  ds_read_b64_tr_b16 v[190:191], v110 offset:36864
  ds_read_b64_tr_b16 v[132:133], v111 offset:32768
  ds_read_b64_tr_b16 v[134:135], v111 offset:36864
  s_waitcnt lgkmcnt(0)
  s_barrier
  s_cmp_eq_u32 s60, 0
  s_cbranch_scc1 c_nw_4
  s_lshl_b32 s26, s60, 5
  s_add_u32 s26, s26, s16
  s_lshl_b32 s26, s26, 2
  s_add_u32 s26, s26, s17
  s_mul_i32 s26, s26, 7168
  s_sub_u32 s26, s26, 917504
  s_add_u32 s27, s26, 4096
  s_mov_b32 s10, 1835008
  s_load_dwordx2 s[8:9], s[0:1], 72
  s_waitcnt lgkmcnt(0)
  buffer_load_dwordx4 v[116:119], v0, s[8:11], s26 offen offset:0
  buffer_load_dwordx4 v[116:119], v0, s[8:11], s26 offen offset:1024
  buffer_load_dwordx4 v[116:119], v0, s[8:11], s26 offen offset:2048
  buffer_load_dwordx4 v[116:119], v0, s[8:11], s26 offen offset:3072
  buffer_load_dwordx4 v[116:119], v0, s[8:11], s27 offen offset:0
  buffer_load_dwordx4 v[116:119], v0, s[8:11], s27 offen offset:1024
  buffer_load_dwordx4 v[116:119], v0, s[8:11], s27 offen offset:2048
  s_load_dwordx2 s[8:9], s[0:1], 80
  s_waitcnt lgkmcnt(0)
  buffer_load_dwordx4 v[116:119], v0, s[8:11], s26 offen offset:0
  buffer_load_dwordx4 v[116:119], v0, s[8:11], s26 offen offset:1024
  buffer_load_dwordx4 v[116:119], v0, s[8:11], s26 offen offset:2048
  buffer_load_dwordx4 v[116:119], v0, s[8:11], s26 offen offset:3072
  buffer_load_dwordx4 v[116:119], v0, s[8:11], s27 offen offset:0
  buffer_load_dwordx4 v[116:119], v0, s[8:11], s27 offen offset:1024
  buffer_load_dwordx4 v[116:119], v0, s[8:11], s27 offen offset:2048
  s_load_dwordx2 s[8:9], s[0:1], 88
  s_waitcnt lgkmcnt(0)
  buffer_load_dwordx4 v[116:119], v0, s[8:11], s26 offen offset:0
  buffer_load_dwordx4 v[116:119], v0, s[8:11], s26 offen offset:1024
  buffer_load_dwordx4 v[116:119], v0, s[8:11], s26 offen offset:2048
  buffer_load_dwordx4 v[116:119], v0, s[8:11], s26 offen offset:3072
  buffer_load_dwordx4 v[116:119], v0, s[8:11], s27 offen offset:0
  buffer_load_dwordx4 v[116:119], v0, s[8:11], s27 offen offset:1024
  buffer_load_dwordx4 v[116:119], v0, s[8:11], s27 offen offset:2048
c_nw_4:
  ds_write_b128 v1, v[24:27] offset:0
  ds_write_b128 v1, v[28:31] offset:1024
  ds_write_b128 v1, v[32:35] offset:2048
  ds_write_b128 v1, v[36:39] offset:3072
  ds_write_b128 v1, v[40:43] offset:4096
  ds_write_b128 v1, v[44:47] offset:5120
  ds_write_b128 v1, v[48:51] offset:6144
  ds_write_b128 v1, v[52:55] offset:7168
  ds_write_b128 v1, v[56:59] offset:8192
  ds_write_b128 v1, v[60:63] offset:9216
  ds_write_b128 v1, v[64:67] offset:10240
  ds_write_b128 v1, v[68:71] offset:11264
  ds_write_b128 v1, v[72:75] offset:12288
  ds_write_b128 v1, v[76:79] offset:13312
  ds_write_b128 v1, v[80:83] offset:14336
  ds_write_b128 v1, v[84:87] offset:15360
  ds_write_b128 v1, v[88:91] offset:16384
  ds_write_b128 v1, v[92:95] offset:17408
  ds_write_b128 v1, v[96:99] offset:18432
  ds_write_b128 v1, v[100:103] offset:19456
  s_mul_i32 s27, s17, 24576
  s_add_u32 m0, s27, 86016
  s_waitcnt lgkmcnt(0)
  v_mbcnt_lo_u32_b32 v20, -1, 0
  v_and_b32 v20, 1, v20
  v_add_lshl_u32 v20, v20, s61, 2
  s_mov_b32 s26, 0
g_wt_5:
  global_load_dword v21, v20, s[12:13] offset:128 sc1
  s_add_u32 s26, s26, 1
  s_cmp_gt_u32 s26, 1048576
  s_cbranch_scc1 L_end
  s_waitcnt vmcnt(0)
  v_cmp_eq_u32 vcc, 0, v21
  v_readfirstlane_b32 s27, v21
  s_cbranch_vccnz g_wt_5
  s_lshr_b32 s26, s91, 1
  s_nop 3
  v_readlane_b32 s27, v21, s26
  s_cmp_lg_u32 s27, 1
  s_cbranch_scc1 L_chain_x
  s_mov_b32 s22, 0
  s_mov_b32 s42, s62
  s_add_u32 s43, s62, 4096
  s_mov_b32 s46, 0
  s_mov_b32 s47, 0
  s_lshl_b32 s26, s16, 2
  s_add_u32 s26, s26, s17
  s_lshl_b32 s27, s60, 13
  s_add_u32 s27, s27, s26
  s_lshr_b32 s25, s27, 2
  s_lshl_b32 s25, s25, 13
  s_add_u32 s25, s25, 192937984
  s_lshr_b32 s64, s27, 2
  s_lshl_b32 s64, s64, 6
  s_add_u32 s64, s64, 513538048
  s_cmp_eq_u32 s17, 3
  s_cselect_b32 s2, 268435456, 0
  s_lshl_b32 s27, s61, 13
  s_add_u32 s27, s27, s26
  s_lshl_b32 s23, s27, 12
  s_add_u32 s23, s23, 41943040
  s_lshl_b32 s63, s27, 5
  s_add_u32 s63, s63, 244318208
  s_mov_b32 s97, 268435456
  s_cmp_eq_u32 s60, 2
  s_cselect_b32 s20, 262144, s97
  s_cselect_b32 s93, 1, 3
  s_lshl_b32 s26, s17, 2
  s_add_u32 s26, s26, s60
  s_cmp_eq_u32 s26, 1
  s_cselect_b32 s97, 245891072, s97
  s_mov_b32 s95, 0
  s_mov_b32 s96, s23
  s_add_u32 s23, s23, 524288
  s_add_u32 s63, s63, 4096
  s_mov_b32 s29, 0
  s_sub_u32 s92, s63, 4096
  s_sub_u32 s96, s23, 524288
  s_mov_b32 s95, 0
c_gw_14:
  buffer_load_dword v7, off, s[4:7], s92 sc1
  s_add_u32 s29, s29, 1
  s_cmp_gt_u32 s29, 1048576
  s_cbranch_scc1 c_fail_12
  s_waitcnt vmcnt(0) lgkmcnt(0)
  v_readfirstlane_b32 s65, v7
  s_cmp_eq_u32 s65, 0
  s_cbranch_scc1 c_gw_14
  s_and_b32 s65, s65, s93
  s_cbranch_scc1 c_kvx_16
  s_mov_b32 s95, 1
  s_add_u32 s96, s96, 33554432
  s_add_u32 s92, s92, 262144
c_kvw_15:
  buffer_load_dword v7, off, s[4:7], s92 sc1
  s_add_u32 s29, s29, 1
  s_cmp_gt_u32 s29, 1048576
  s_cbranch_scc1 c_fail_12
  s_waitcnt vmcnt(0) lgkmcnt(0)
  v_readfirstlane_b32 s65, v7
  s_cmp_eq_u32 s65, 0
  s_cbranch_scc1 c_kvw_15
c_kvx_16:
  buffer_load_dword v7, off, s[4:7], s63 sc1
  buffer_load_dwordx4 v0, s[4:7], s96 offen offset:0  lds
  buffer_load_dwordx4 v0, s[4:7], s96 offen offset:1024  lds
  buffer_load_dwordx4 v0, s[4:7], s96 offen offset:2048  lds
  buffer_load_dwordx4 v0, s[4:7], s96 offen offset:3072  lds
  s_waitcnt vmcnt(4)
  v_readfirstlane_b32 s65, v7
  s_mov_b32 s94, 0
  ds_read_b128 v[72:75], v1 offset:6144
  ds_read_b128 v[76:79], v1 offset:7168
  ds_read_b128 v[80:83], v1 offset:8192
  ds_read_b128 v[84:87], v1 offset:9216
  ds_read_b128 v[88:91], v1 offset:10240
  ds_read_b128 v[92:95], v1 offset:11264
  ds_read_b128 v[96:99], v1 offset:12288
  ds_read_b128 v[100:103], v1 offset:13312
  ds_read_b128 v[104:107], v1 offset:14336
  ds_read_b128 v[108:111], v1 offset:15360
  ds_read_b128 v[112:115], v1 offset:16384
  ds_read_b128 v[116:119], v1 offset:17408
  ds_read_b128 v[120:123], v1 offset:18432
  ds_read_b128 v[124:127], v1 offset:19456
  v_mov_b64 v[48:49], 0
  v_mov_b64 v[50:51], 0
  v_mov_b64 v[52:53], 0
  v_mov_b64 v[54:55], 0
  v_mov_b64 v[56:57], 0
  v_mov_b64 v[58:59], 0
  v_mov_b64 v[60:61], 0
  v_mov_b64 v[62:63], 0
  v_mov_b64 v[64:65], 0
  v_mov_b64 v[66:67], 0
  v_mov_b64 v[68:69], 0
  v_mov_b64 v[70:71], 0
  s_lshl_b32 s38, s16, 13
  s_add_u32 s38, s38, s40
  s_add_u32 s39, s38, 4096
  ds_read_b128 v[24:27], v1 offset:0
  ds_read_b128 v[28:31], v1 offset:1024
  ds_read_b128 v[32:35], v1 offset:2048
  ds_read_b128 v[36:39], v1 offset:3072
  ds_read_b128 v[40:43], v1 offset:4096
  ds_read_b128 v[44:47], v1 offset:5120
  s_waitcnt lgkmcnt(0)
c_loop_6:
  buffer_load_dwordx4 v[16:19], v8, s[4:7], s42 offen sc1
  buffer_load_dwordx4 v[20:23], v8, s[4:7], s43 offen sc1
  s_mov_b32 s28, 0
  v_mov_b64 v[48:49], 0
  v_mov_b64 v[50:51], 0
  v_mov_b64 v[52:53], 0
  v_mov_b64 v[54:55], 0
  v_mov_b64 v[56:57], 0
  v_mov_b64 v[58:59], 0
  v_mov_b64 v[60:61], 0
  v_mov_b64 v[62:63], 0
  v_mov_b64 v[64:65], 0
  v_mov_b64 v[66:67], 0
  v_mov_b64 v[68:69], 0
  v_mov_b64 v[70:71], 0
  buffer_load_dwordx4 v[16:19], v8, s[4:7], s42 offen sc1
  buffer_load_dwordx4 v[20:23], v8, s[4:7], s43 offen sc1
  s_waitcnt lgkmcnt(0)
  s_waitcnt vmcnt(3)
  v_max3_u32 v7, v16, v17, v18
  v_max_u32 v7, v7, v19
  ds_write_b128 v8, v[16:19] offset:4096
  v_smfmac_f32_16x16x64_bf16 v[48:51], v[16:19], v[24:31], v6
  s_waitcnt vmcnt(2)
  v_max3_u32 v7, v20, v21, v7
  v_max3_u32 v7, v22, v23, v7
  ds_write_b128 v8, v[20:23] offset:8192
  v_smfmac_f32_16x16x64_bf16 v[52:55], v[16:19], v[32:39], v6
  v_cmp_eq_u32 vcc, -1, v7
  v_smfmac_f32_16x16x64_bf16 v[56:59], v[16:19], v[40:47], v6
  s_cbranch_vccnz c_retry_7
c_got_8:
  v_smfmac_f32_16x16x64_bf16 v[60:63], v[16:19], v[72:79], v6
  ds_read_b128 v[72:75], v1 offset:20480
  s_and_b32 s65, s65, s93
  s_cselect_b32 s96, s23, 268435456
  v_smfmac_f32_16x16x64_bf16 v[48:51], v[20:23], v[80:87], v6
  ds_read_b128 v[76:79], v1 offset:21504
  s_cselect_b32 s95, 0, s94
  v_mov_b32 v7, 1
  v_smfmac_f32_16x16x64_bf16 v[52:55], v[20:23], v[88:95], v6
  ds_read_b128 v[80:83], v1 offset:22528
  s_add_u32 s31, s23, 33554432
  s_cmp_lg_u32 s95, 0
  v_smfmac_f32_16x16x64_bf16 v[56:59], v[20:23], v[96:103], v6
  ds_read_b128 v[84:87], v1 offset:23552
  s_cselect_b32 s96, s31, s96
  s_waitcnt lgkmcnt(4)
  s_barrier
  ds_read_b128 v[24:27], v9 offset:4096
  ds_read_b128 v[28:31], v10 offset:4096
  v_smfmac_f32_16x16x64_bf16 v[60:63], v[20:23], v[104:111], v6
  ds_read_b128 v[32:35], v11 offset:4096
  v_smfmac_f32_16x16x64_bf16 v[64:67], v[16:19], v[112:119], v6
  ds_read_b128 v[36:39], v9 offset:8192
  v_smfmac_f32_16x16x64_bf16 v[68:71], v[16:19], v[120:127], v6
  ds_read_b128 v[40:43], v10 offset:8192
  v_smfmac_f32_16x16x64_bf16 v[64:67], v[20:23], v[208:215], v6
  ds_read_b128 v[44:47], v11 offset:8192
  s_waitcnt lgkmcnt(5)
  v_smfmac_f32_16x16x64_bf16 v[48:51], v[24:27], a[168:175], v6
  s_mov_b64 exec, 1
  buffer_store_dword v7, off, s[4:7], s64 sc1
  s_mov_b64 exec, -1
  s_waitcnt lgkmcnt(4)
  v_smfmac_f32_16x16x64_bf16 v[48:51], v[28:31], a[160:167], v6
  buffer_load_dwordx4 v0, s[4:7], s96 offen offset:0  lds
  s_waitcnt lgkmcnt(3)
  v_smfmac_f32_16x16x64_bf16 v[48:51], v[32:35], a[152:159], v6
  ds_read_b128 v[104:107], v8 offset:16384
  s_waitcnt lgkmcnt(3)
  v_smfmac_f32_16x16x64_bf16 v[48:51], v[36:39], a[144:151], v6
  buffer_load_dwordx4 v0, s[4:7], s96 offen offset:1024  lds
  s_waitcnt lgkmcnt(2)
  v_smfmac_f32_16x16x64_bf16 v[48:51], v[40:43], a[136:143], v6
  ds_read_b128 v[108:111], v8 offset:20480
  s_waitcnt lgkmcnt(2)
  v_smfmac_f32_16x16x64_bf16 v[48:51], v[44:47], a[128:135], v6
  buffer_load_dwordx4 v0, s[4:7], s96 offen offset:2048  lds
  v_smfmac_f32_16x16x64_bf16 v[52:55], v[24:27], a[120:127], v6
  buffer_load_dwordx4 v0, s[4:7], s96 offen offset:3072  lds
  v_smfmac_f32_16x16x64_bf16 v[52:55], v[28:31], a[112:119], v6
  ds_read_b64 v[100:101], v5 offset:4096
  v_add_f32 v48, v48, v50
  v_smfmac_f32_16x16x64_bf16 v[52:55], v[32:35], a[104:111], v6
  ds_read_b128 v[112:115], v8 offset:24576
  v_add_f32 v49, v49, v51
  v_smfmac_f32_16x16x64_bf16 v[52:55], v[36:39], a[96:103], v6
  ds_read_b128 v[116:119], v8 offset:28672
  v_cvt_pk_bf16_f32 v50, v48, v49
  v_smfmac_f32_16x16x64_bf16 v[52:55], v[40:43], a[88:95], v6
  ds_write2_b32 v2, v50, v50 offset0:0 offset1:1
  v_smfmac_f32_16x16x64_bf16 v[52:55], v[44:47], a[80:87], v6
  ds_read_b64_tr_b16 v[88:89], v12 offset:0
  v_smfmac_f32_16x16x64_bf16 v[56:59], v[24:27], a[72:79], v6
  v_smfmac_f32_16x16x64_bf16 v[56:59], v[28:31], a[64:71], v6
  ds_read_b128 v[120:123], v8 offset:32768
  v_add_f32 v52, v52, v54
  v_smfmac_f32_16x16x64_bf16 v[56:59], v[32:35], a[56:63], v6
  ds_read_b128 v[124:127], v8 offset:36864
  v_add_f32 v53, v53, v55
  v_cvt_pk_bf16_f32 v54, v52, v53
  v_smfmac_f32_16x16x64_bf16 v[56:59], v[36:39], a[48:55], v6
  ds_write2_b32 v2, v54, v54 offset0:128 offset1:129
  ds_read_b64_tr_b16 v[90:91], v12 offset:512
  v_smfmac_f32_16x16x64_bf16 v[56:59], v[40:43], a[40:47], v6
  v_smfmac_f32_16x16x64_bf16 v[56:59], v[44:47], a[32:39], v6
  v_smfmac_f32_16x16x64_bf16 v[60:63], v[24:27], a[24:31], v6
  v_smfmac_f32_16x16x64_bf16 v[60:63], v[28:31], a[16:23], v6
  s_waitcnt lgkmcnt(0)
  v_add_f32 v56, v56, v58
  v_mfma_f32_16x16x32_bf16 v[92:95], v[72:75], v[88:91], 0
  buffer_store_dwordx2 v[100:101], v5, s[4:7], s97 offen sc1
  v_add_f32 v57, v57, v59
  v_cvt_pk_bf16_f32 v58, v56, v57
  v_mfma_f32_16x16x32_bf16 v[96:99], v[76:79], v[88:91], 0
  ds_write_b32 v2, v58
  v_smfmac_f32_16x16x64_bf16 v[60:63], v[32:35], a[8:15], v6
  v_mov_b32 v76, 0
  v_smfmac_f32_16x16x64_bf16 v[60:63], v[36:39], a[0:7], v6
  v_cndmask_b32 v48, v92, v96, s[18:19]
  v_smfmac_f32_16x16x64_bf16 v[60:63], v[40:43], v[248:255], v6
  v_cndmask_b32 v49, v93, v97, s[18:19]
  v_smfmac_f32_16x16x64_bf16 v[60:63], v[44:47], v[240:247], v6
  v_cndmask_b32 v50, v94, v98, s[18:19]
  v_smfmac_f32_16x16x64_bf16 v[68:71], v[20:23], v[152:159], v6
  v_cndmask_b32 v51, v95, v99, s[18:19]
  v_smfmac_f32_16x16x64_bf16 v[64:67], v[24:27], v[232:239], v6
  ds_write_b128 v8, v[48:51] offset:12288
  v_add_f32 v60, v60, v62
  v_add_f32 v61, v61, v63
  v_cvt_pk_bf16_f32 v62, v60, v61
  v_smfmac_f32_16x16x64_bf16 v[64:67], v[28:31], v[224:231], v6
  ds_write_b32 v2, v62 offset:512
  s_waitcnt vmcnt(6)
  v_mov_b32 v79, 0
  v_smfmac_f32_16x16x64_bf16 v[64:67], v[32:35], v[216:223], v6
  v_mov_b64 v[20:21], s[14:15]
  v_smfmac_f32_16x16x64_bf16 v[64:67], v[36:39], v[200:207], v6
  v_mov_b64 v[22:23], s[14:15]
  v_smfmac_f32_16x16x64_bf16 v[64:67], v[40:43], v[192:199], v6
  s_waitcnt lgkmcnt(0)
  s_barrier
  ds_read_b128 v[52:55], v9 offset:12288
  ds_read_b128 v[56:59], v10 offset:12288
  v_smfmac_f32_16x16x64_bf16 v[64:67], v[44:47], v[184:191], v6
  ds_read_b128 v[60:63], v11 offset:12288
  v_smfmac_f32_16x16x64_bf16 v[68:71], v[24:27], v[176:183], v6
  ds_read_b64_tr_b16 v[88:89], v12 offset:0
  ds_read_b64_tr_b16 v[90:91], v12 offset:512
  v_smfmac_f32_16x16x64_bf16 v[68:71], v[28:31], v[168:175], v6
  ds_read_b64_tr_b16 v[92:93], v13 offset:0
  ds_read_b64_tr_b16 v[94:95], v13 offset:512
  v_add_f32 v64, v64, v66
  v_smfmac_f32_16x16x64_bf16 v[68:71], v[32:35], v[160:167], v6
  ds_read_b64_tr_b16 v[96:97], v14 offset:0
  ds_read_b64_tr_b16 v[98:99], v14 offset:512
  v_add_f32 v65, v65, v67
  v_smfmac_f32_16x16x64_bf16 v[68:71], v[36:39], v[144:151], v6
  ds_read_b64_tr_b16 v[100:101], v15 offset:0
  ds_read_b64_tr_b16 v[102:103], v15 offset:512
  s_waitcnt lgkmcnt(8)
  v_cvt_pk_bf16_f32 v66, v64, v65
  v_smfmac_f32_16x16x64_bf16 v[68:71], v[40:43], v[136:143], v6
  v_add_f32 v48, v48, v52
  v_smfmac_f32_16x16x64_bf16 v[68:71], v[44:47], v[128:135], v6
  s_waitcnt lgkmcnt(4)
  v_add_f32 v49, v49, v53
  v_mfma_f32_16x16x32_bf16 v[16:19], v[88:91], v[88:91], 0
  buffer_store_dwordx4 v[88:91], v8, s[4:7], s25 offen sc1
  v_add_f32 v50, v50, v54
  v_add_f32 v51, v51, v55
  v_mfma_f32_16x16x32_bf16 v[16:19], v[92:95], v[92:95], v[16:19]
  s_waitcnt lgkmcnt(0)
  v_add_f32 v56, v56, v60
  v_add_f32 v57, v57, v61
  v_mfma_f32_16x16x32_bf16 v[16:19], v[96:99], v[96:99], v[16:19]
  v_add_f32 v58, v58, v62
  v_add_f32 v59, v59, v63
  v_mfma_f32_16x16x32_bf16 v[16:19], v[100:103], v[100:103], v[16:19]
  v_add_f32 v48, v48, v56
  v_add_f32 v49, v49, v57
  v_add_f32 v50, v50, v58
  v_add_f32 v51, v51, v59
  v_exp_f32 v24, v48
  v_exp_f32 v25, v49
  v_exp_f32 v26, v50
  v_exp_f32 v27, v51
  v_cvt_pk_bf16_f32 v24, v24, v25
  v_mul_f32 v16, s24, v16
  v_cvt_pk_bf16_f32 v25, v26, v27
  v_cndmask_b32 v72, v24, 0, s[18:19]
  v_cndmask_b32 v73, v25, 0, s[18:19]
  v_cndmask_b32 v74, 0, v24, s[18:19]
  v_cndmask_b32 v75, 0, v25, s[18:19]
  v_mul_f32 v17, s24, v17
  v_exp_f32 v28, v16
  v_mfma_f32_16x16x32_bf16 v[60:63], v[72:75], v[20:23], 0
  v_exp_f32 v29, v17
  v_add_f32 v68, v68, v70
  v_mfma_f32_16x16x32_bf16 v[52:55], v[72:75], v[80:83], 0
  s_add_u32 s30, s25, 4096
  v_cvt_pk_bf16_f32 v28, v28, v29
  v_add_f32 v69, v69, v71
  v_mfma_f32_16x16x32_bf16 v[56:59], v[72:75], v[84:87], 0
  v_cndmask_b32 v77, 0, v28, s[18:19]
  v_cndmask_b32 v78, 0, v28, s[18:19]
  v_cvt_pk_bf16_f32 v67, v68, v69
  v_lshrrev_b32 v92, 1, v8
  v_mfma_f32_16x16x16_bf16 v[60:63], v[76:77], v[20:21], v[60:63]
  buffer_store_dwordx2 v[66:67], v92, s[4:7], s30 offen sc1
  v_max3_f32 v7, |v48|, |v49|, |v50|
  v_max_f32 v26, |v16|, |v17|
  v_mfma_f32_16x16x16_bf16 v[52:55], v[78:79], v[66:67], v[52:55]
  v_cndmask_b32 v26, 0, v26, s[18:19]
  v_max3_f32 v7, |v51|, v26, v7
  v_mfma_f32_16x16x16_bf16 v[56:59], v[76:77], v[66:67], v[56:59]
  v_cmp_lt_f32 vcc, 0x42700000, v7
  v_mov_b64 v[44:45], 0
  v_add_f32 v60, v60, v62
  v_add_f32 v61, v61, v63
  s_cbranch_vccnz c_fb_10
c_fbr_11:
  v_rcp_f32 v60, v60
  v_rcp_f32 v61, v61
  v_pk_add_f32 v[52:53], v[52:53], v[54:55]
  v_pk_add_f32 v[56:57], v[56:57], v[58:59]
  v_pk_mul_f32 v[52:53], v[52:53], v[60:61]
  v_pk_mul_f32 v[56:57], v[56:57], v[60:61]
  v_cvt_pk_bf16_f32 v54, v52, v53
  v_cvt_pk_bf16_f32 v55, v56, v57
  ds_write_b64 v2, v[54:55] offset:4096
  v_mov_b64 v[46:47], 0
  v_mov_b64 v[40:41], 0
  v_mov_b64 v[42:43], 0
  v_mov_b64 v[36:37], 0
  v_mov_b64 v[38:39], 0
  v_mov_b64 v[32:33], 0
  v_mov_b64 v[34:35], 0
  v_mov_b64 v[28:29], 0
  v_mov_b64 v[30:31], 0
  v_mov_b64 v[24:25], 0
  v_mov_b64 v[26:27], 0
  v_mov_b64 v[80:81], 0
  s_waitcnt lgkmcnt(0)
  s_barrier
  ds_read_b64_tr_b16 v[72:73], v3 offset:4096
  ds_read_b64_tr_b16 v[74:75], v3 offset:5120
  ds_read_b64_tr_b16 v[76:77], v3 offset:6144
  ds_read_b64_tr_b16 v[78:79], v3 offset:7168
  s_and_b32 s3, s22, 1
  s_add_u32 s22, s22, 1
  s_and_b32 s42, s22, 3
  s_lshl_b32 s42, s42, 13
  s_cmp_eq_u32 s22, 64
  s_cbranch_scc1 c_last_13
  s_waitcnt lgkmcnt(2)
  v_smfmac_f32_16x16x64_bf16 v[44:47], v[72:75], a[248:255], v6
  s_waitcnt lgkmcnt(0)
  ds_read_b128 v[16:19], v8 offset:40960
  v_mov_b64 v[82:83], 0
  v_smfmac_f32_16x16x64_bf16 v[44:47], v[76:79], a[240:247], v6
  ds_read_b128 v[20:23], v8 offset:45056
  v_mov_b64 v[84:85], 0
  v_smfmac_f32_16x16x64_bf16 v[40:43], v[72:75], a[232:239], v6
  ds_read_b128 v[88:91], v8 offset:49152
  v_mov_b64 v[86:87], 0
  v_smfmac_f32_16x16x64_bf16 v[40:43], v[76:79], a[224:231], v6
  ds_read_b128 v[92:95], v8 offset:53248
  v_add_f32 v44, v44, v46
  v_add_f32 v45, v45, v47
  v_smfmac_f32_16x16x64_bf16 v[36:39], v[72:75], a[216:223], v6
  ds_read_b128 v[96:99], v8 offset:57344
  v_cvt_pk_bf16_f32 v48, v44, v45
  v_and_or_b32 v48, v48, -2, s3
  v_smfmac_f32_16x16x64_bf16 v[36:39], v[76:79], a[208:215], v6
  ds_read_b128 v[100:103], v8 offset:61440
  v_add_f32 v40, v40, v42
  v_add_f32 v41, v41, v43
  v_smfmac_f32_16x16x64_bf16 v[32:35], v[72:75], a[200:207], v6
  v_cvt_pk_bf16_f32 v49, v40, v41
  v_smfmac_f32_16x16x64_bf16 v[32:35], v[76:79], a[192:199], v6
  v_add_f32 v36, v36, v38
  v_add_f32 v37, v37, v39
  v_smfmac_f32_16x16x64_bf16 v[28:31], v[72:75], a[184:191], v6
  v_cvt_pk_bf16_f32 v50, v36, v37
  v_smfmac_f32_16x16x64_bf16 v[28:31], v[76:79], a[176:183], v6
  v_add_f32 v32, v32, v34
  v_add_f32 v33, v33, v35
  v_smfmac_f32_16x16x64_bf16 v[24:27], v[72:75], v[104:111], v6
  v_cvt_pk_bf16_f32 v51, v32, v33
  v_smfmac_f32_16x16x64_bf16 v[24:27], v[76:79], v[112:119], v6
  buffer_store_dwordx4 v[48:51], v4, s[4:7], s40 offen
  v_add_f32 v28, v28, v30
  v_add_f32 v29, v29, v31
  v_smfmac_f32_16x16x64_bf16 v[80:83], v[72:75], v[120:127], v6
  s_waitcnt lgkmcnt(0)
  v_cvt_pk_bf16_f32 v52, v28, v29
  v_and_or_b32 v52, v52, -2, s3
  v_smfmac_f32_16x16x64_bf16 v[80:83], v[76:79], v[16:23], v6
  v_add_f32 v24, v24, v26
  v_add_f32 v25, v25, v27
  v_smfmac_f32_16x16x64_bf16 v[84:87], v[72:75], v[88:95], v6
  v_cvt_pk_bf16_f32 v53, v24, v25
  v_smfmac_f32_16x16x64_bf16 v[84:87], v[76:79], v[96:103], v6
  v_add_f32 v80, v80, v82
  v_add_f32 v81, v81, v83
  v_cvt_pk_bf16_f32 v54, v80, v81
  s_nop 0
  s_nop 3
  v_pk_add_f32 v[84:85], v[84:85], v[86:87]
  v_cvt_pk_bf16_f32 v55, v84, v85
  buffer_store_dwordx4 v[52:55], v4, s[4:7], s41 offen
  s_add_u32 s42, s42, s62
  s_add_u32 s43, s42, 4096
  s_add_u32 s23, s23, 524288
  s_add_u32 s25, s25, 262144
  s_add_u32 s63, s63, 4096
  s_add_u32 s64, s64, 2048
  s_andn2_b32 s64, s64, s2
  s_add_u32 s97, s97, 8192
  s_add_u32 s92, s63, s20
  s_cmp_lg_u32 s17, 0
  s_cbranch_scc1 c_oth_21
  s_mov_b32 s28, 0
  s_add_u32 s46, s46, 1
  v_mov_b64 v[64:65], -1
  s_xor_b32 s34, s42, 16384
  buffer_store_dwordx2 v[64:65], v5, s[4:7], s34 offen
  s_mov_b32 vcc_lo, 0xaaaaaaaa
  s_mov_b32 vcc_hi, 0xaaaaaaaa
  v_mov_b32 v7, 0x3f80
  v_cndmask_b32 v7, v7, 1.0, vcc
  s_mov_b32 vcc_lo, 0x30003
  s_mov_b32 vcc_hi, 0x30003
  v_cndmask_b32 v68, 0, v7, vcc
  s_mov_b32 vcc_lo, 0xc000c
  s_mov_b32 vcc_hi, 0xc000c
  v_cndmask_b32 v69, 0, v7, vcc
  s_mov_b32 vcc_lo, 0x300030
  s_mov_b32 vcc_hi, 0x300030
  v_cndmask_b32 v70, 0, v7, vcc
  s_mov_b32 vcc_lo, 0xc000c0
  s_mov_b32 vcc_hi, 0xc000c0
  v_cndmask_b32 v71, 0, v7, vcc
  ds_read_b128 v[104:107], v1 offset:14336
  ds_read_b128 v[108:111], v1 offset:15360
  s_waitcnt lgkmcnt(0)
  ds_read_b128 v[112:115], v1 offset:16384
  ds_read_b128 v[116:119], v1 offset:17408
  ds_read_b128 v[120:123], v1 offset:18432
  ds_read_b128 v[124:127], v1 offset:19456
  s_waitcnt lgkmcnt(0)
  buffer_load_dwordx4 v[16:19], v0, s[4:7], s38 offen offset:0 sc1
  buffer_load_dwordx4 v[20:23], v0, s[4:7], s38 offen offset:1024 sc1
  buffer_load_dwordx4 v[24:27], v0, s[4:7], s38 offen offset:2048 sc1
  buffer_load_dwordx4 v[28:31], v0, s[4:7], s38 offen offset:3072 sc1
  buffer_load_dwordx4 v[32:35], v0, s[4:7], s39 offen offset:0 sc1
  buffer_load_dwordx4 v[36:39], v0, s[4:7], s39 offen offset:1024 sc1
  buffer_load_dwordx4 v[40:43], v0, s[4:7], s39 offen offset:2048 sc1
  buffer_load_dwordx4 v[44:47], v0, s[4:7], s39 offen offset:3072 sc1
  buffer_load_dwordx4 v[72:75], v0, s[4:7], s38 offen offset:0 sc1
  buffer_load_dwordx4 v[76:79], v0, s[4:7], s38 offen offset:1024 sc1
  buffer_load_dwordx4 v[80:83], v0, s[4:7], s38 offen offset:2048 sc1
  buffer_load_dwordx4 v[84:87], v0, s[4:7], s38 offen offset:3072 sc1
  buffer_load_dwordx4 v[88:91], v0, s[4:7], s39 offen offset:0 sc1
  buffer_load_dwordx4 v[92:95], v0, s[4:7], s39 offen offset:1024 sc1
  buffer_load_dwordx4 v[96:99], v0, s[4:7], s39 offen offset:2048 sc1
  buffer_load_dwordx4 v[100:103], v0, s[4:7], s39 offen offset:3072 sc1
  s_buffer_load_dword s65, s[4:7], s63
  s_buffer_load_dword s94, s[4:7], s92
  s_waitcnt vmcnt(15)
  v_mfma_f32_16x16x32_bf16 v[64:67], v[16:19], v[68:71], 0
  v_xor_b32 v7, s3, v16
  s_waitcnt vmcnt(14)
  v_mfma_f32_16x16x32_bf16 v[64:67], v[20:23], v[68:71], v[64:67]
  v_bitop3_b32 v7, v7, v20, s3 bitop3:0xf6
  s_waitcnt vmcnt(13)
  v_mfma_f32_16x16x32_bf16 v[64:67], v[24:27], v[68:71], v[64:67]
  v_bitop3_b32 v7, v7, v24, s3 bitop3:0xf6
  s_waitcnt vmcnt(12)
  v_mfma_f32_16x16x32_bf16 v[64:67], v[28:31], v[68:71], v[64:67]
  v_bitop3_b32 v7, v7, v28, s3 bitop3:0xf6
  s_waitcnt vmcnt(11)
  v_mfma_f32_16x16x32_bf16 v[64:67], v[32:35], v[68:71], v[64:67]
  v_bitop3_b32 v7, v7, v32, s3 bitop3:0xf6
  s_waitcnt vmcnt(10)
  v_mfma_f32_16x16x32_bf16 v[64:67], v[36:39], v[68:71], v[64:67]
  v_bitop3_b32 v7, v7, v36, s3 bitop3:0xf6
  s_waitcnt vmcnt(9)
  v_mfma_f32_16x16x32_bf16 v[64:67], v[40:43], v[68:71], v[64:67]
  v_bitop3_b32 v7, v7, v40, s3 bitop3:0xf6
  s_waitcnt vmcnt(8)
  v_mfma_f32_16x16x32_bf16 v[64:67], v[44:47], v[68:71], v[64:67]
  v_bitop3_b32 v7, v7, v44, s3 bitop3:0xf6
  v_and_b32 v7, 1, v7
  v_cmp_ne_u32 vcc, 0, v7
  v_mov_b32 v7, 0
  v_mov_b32 v7, 0
  s_cbranch_vccnz c_p1r_22
c_publ_23:
  s_nop 1
  s_nop 0
  v_cvt_pk_bf16_f32 v64, v64, v65
  v_cvt_pk_bf16_f32 v65, v66, v67
  v_min_u32 v64, -2, v64
  v_min_u32 v65, -2, v65
  buffer_store_dwordx2 v[64:65], v5, s[4:7], s42 offen
  s_waitcnt vmcnt(1)
  ds_read_b128 v[24:27], v1 offset:0
  ds_read_b128 v[28:31], v1 offset:1024
  ds_read_b128 v[32:35], v1 offset:2048
  ds_read_b128 v[36:39], v1 offset:3072
  ds_read_b128 v[40:43], v1 offset:4096
  ds_read_b128 v[44:47], v1 offset:5120
  ds_read_b128 v[72:75], v1 offset:6144
  ds_read_b128 v[76:79], v1 offset:7168
  ds_read_b128 v[80:83], v1 offset:8192
  ds_read_b128 v[84:87], v1 offset:9216
  ds_read_b128 v[88:91], v1 offset:10240
  ds_read_b128 v[92:95], v1 offset:11264
  ds_read_b128 v[96:99], v1 offset:12288
  ds_read_b128 v[100:103], v1 offset:13312
c_hop2_9:
  s_barrier
  s_cmp_le_u32 s96, s23
  s_cbranch_scc1 c_loop_6
  s_cmp_lg_u32 s96, 268435456
  s_cbranch_scc1 c_fk0_24
  buffer_store_dwordx2 v[64:65], v5, s[4:7], s97 offen sc1
  s_mov_b32 s29, 0
  s_sub_u32 s92, s63, 4096
  s_sub_u32 s96, s23, 524288
  s_mov_b32 s95, 0
c_gw_25:
  buffer_load_dword v7, off, s[4:7], s92 sc1
  s_add_u32 s29, s29, 1
  s_cmp_gt_u32 s29, 1048576
  s_cbranch_scc1 c_fail_12
  s_waitcnt vmcnt(0) lgkmcnt(0)
  v_readfirstlane_b32 s65, v7
  s_cmp_eq_u32 s65, 0
  s_cbranch_scc1 c_gw_25
  s_and_b32 s65, s65, s93
  s_cbranch_scc1 c_kvx_27
  s_mov_b32 s95, 1
  s_add_u32 s96, s96, 33554432
  s_add_u32 s92, s92, 262144
c_kvw_26:
  buffer_load_dword v7, off, s[4:7], s92 sc1
  s_add_u32 s29, s29, 1
  s_cmp_gt_u32 s29, 1048576
  s_cbranch_scc1 c_fail_12
  s_waitcnt vmcnt(0) lgkmcnt(0)
  v_readfirstlane_b32 s65, v7
  s_cmp_eq_u32 s65, 0
  s_cbranch_scc1 c_kvw_26
c_kvx_27:
  buffer_load_dword v7, off, s[4:7], s63 sc1
  buffer_load_dwordx4 v0, s[4:7], s96 offen offset:0  lds
  buffer_load_dwordx4 v0, s[4:7], s96 offen offset:1024  lds
  buffer_load_dwordx4 v0, s[4:7], s96 offen offset:2048  lds
  buffer_load_dwordx4 v0, s[4:7], s96 offen offset:3072  lds
  s_waitcnt vmcnt(4)
  v_readfirstlane_b32 s65, v7
  s_mov_b32 s94, 0
  s_cmp_eq_u32 s95, 0
  s_cbranch_scc1 c_loop_6
c_fk0_24:
  s_mov_b32 s29, 0
c_fk_28:
  buffer_load_dwordx4 v[16:19], v8, s[4:7], s42 offen sc1
  buffer_load_dwordx4 v[20:23], v8, s[4:7], s43 offen sc1
  s_add_u32 s29, s29, 1
  s_cmp_gt_u32 s29, 1048576
  s_cbranch_scc1 c_fail_12
  s_waitcnt vmcnt(0)
  v_max3_u32 v7, v16, v17, v18
  v_max3_u32 v7, v19, v20, v7
  v_max3_u32 v7, v21, v22, v7
  v_max_u32 v7, v7, v23
  v_cmp_eq_u32 vcc, -1, v7
  s_cbranch_vccnz c_fk_28
  s_lshl_b32 s42, s22, 13
  s_add_u32 s42, s42, 245891072
  s_add_u32 s43, s42, 4096
  s_mov_b32 s95, 0
  s_branch c_loop_6
c_last_13:
  s_add_u32 s64, s64, 2048
  v_mov_b32 v7, 1
  s_waitcnt vmcnt(0)
  s_barrier
  s_mov_b64 exec, 1
  buffer_store_dword v7, off, s[4:7], s64 sc1
  s_mov_b64 exec, -1
  s_branch L_chdone
c_oth_21:
  s_buffer_load_dword s65, s[4:7], s63
  s_buffer_load_dword s94, s[4:7], s92
  ds_read_b128 v[24:27], v1 offset:0
  ds_read_b128 v[28:31], v1 offset:1024
  ds_read_b128 v[32:35], v1 offset:2048
  ds_read_b128 v[36:39], v1 offset:3072
  ds_read_b128 v[40:43], v1 offset:4096
  ds_read_b128 v[44:47], v1 offset:5120
  ds_read_b128 v[72:75], v1 offset:6144
  ds_read_b128 v[76:79], v1 offset:7168
  ds_read_b128 v[80:83], v1 offset:8192
  ds_read_b128 v[84:87], v1 offset:9216
  ds_read_b128 v[88:91], v1 offset:10240
  ds_read_b128 v[92:95], v1 offset:11264
  ds_read_b128 v[96:99], v1 offset:12288
  ds_read_b128 v[100:103], v1 offset:13312
  ds_read_b128 v[104:107], v1 offset:14336
  ds_read_b128 v[108:111], v1 offset:15360
  ds_read_b128 v[112:115], v1 offset:16384
  ds_read_b128 v[116:119], v1 offset:17408
  ds_read_b128 v[120:123], v1 offset:18432
  ds_read_b128 v[124:127], v1 offset:19456
  s_branch c_hop2_9
c_p1r_22:
  s_waitcnt vmcnt(7)
  s_nop 0
  v_mfma_f32_16x16x32_bf16 v[64:67], v[72:75], v[68:71], 0
  v_xor_b32 v7, s3, v72
  s_waitcnt vmcnt(6)
  v_mfma_f32_16x16x32_bf16 v[64:67], v[76:79], v[68:71], v[64:67]
  v_bitop3_b32 v7, v7, v76, s3 bitop3:0xf6
  s_waitcnt vmcnt(5)
  v_mfma_f32_16x16x32_bf16 v[64:67], v[80:83], v[68:71], v[64:67]
  v_bitop3_b32 v7, v7, v80, s3 bitop3:0xf6
  s_waitcnt vmcnt(4)
  v_mfma_f32_16x16x32_bf16 v[64:67], v[84:87], v[68:71], v[64:67]
  v_bitop3_b32 v7, v7, v84, s3 bitop3:0xf6
  s_waitcnt vmcnt(3)
  v_mfma_f32_16x16x32_bf16 v[64:67], v[88:91], v[68:71], v[64:67]
  v_bitop3_b32 v7, v7, v88, s3 bitop3:0xf6
  s_waitcnt vmcnt(2)
  v_mfma_f32_16x16x32_bf16 v[64:67], v[92:95], v[68:71], v[64:67]
  v_bitop3_b32 v7, v7, v92, s3 bitop3:0xf6
  s_waitcnt vmcnt(1)
  v_mfma_f32_16x16x32_bf16 v[64:67], v[96:99], v[68:71], v[64:67]
  v_bitop3_b32 v7, v7, v96, s3 bitop3:0xf6
  s_waitcnt vmcnt(0)
  v_mfma_f32_16x16x32_bf16 v[64:67], v[100:103], v[68:71], v[64:67]
  v_bitop3_b32 v7, v7, v100, s3 bitop3:0xf6
  v_and_b32 v7, 1, v7
  v_cmp_ne_u32 vcc, 0, v7
  s_add_u32 s46, s46, 1
  s_cbranch_vccz c_publ_23
  buffer_load_dwordx4 v[72:75], v0, s[4:7], s38 offen offset:0 sc1
  buffer_load_dwordx4 v[76:79], v0, s[4:7], s38 offen offset:1024 sc1
  buffer_load_dwordx4 v[80:83], v0, s[4:7], s38 offen offset:2048 sc1
  buffer_load_dwordx4 v[84:87], v0, s[4:7], s38 offen offset:3072 sc1
  buffer_load_dwordx4 v[88:91], v0, s[4:7], s39 offen offset:0 sc1
  buffer_load_dwordx4 v[92:95], v0, s[4:7], s39 offen offset:1024 sc1
  buffer_load_dwordx4 v[96:99], v0, s[4:7], s39 offen offset:2048 sc1
  buffer_load_dwordx4 v[100:103], v0, s[4:7], s39 offen offset:3072 sc1
  s_add_u32 s28, s28, 1
  s_cmp_gt_u32 s28, 1048576
  s_cbranch_scc0 c_p1r_22
  s_branch c_fail_12
c_retry_7:
  v_mov_b64 v[48:49], 0
  v_mov_b64 v[50:51], 0
  s_nop 0
  v_mov_b64 v[52:53], 0
  v_mov_b64 v[54:55], 0
  s_nop 1
  v_mov_b64 v[56:57], 0
  v_mov_b64 v[58:59], 0
c_rl_29:
  buffer_load_dwordx4 v[16:19], v8, s[4:7], s42 offen sc1
  buffer_load_dwordx4 v[20:23], v8, s[4:7], s43 offen sc1
  s_add_u32 s28, s28, 1
  s_add_u32 s47, s47, 1
  s_cmp_gt_u32 s28, 1048576
  s_cbranch_scc1 c_fail_12
  s_waitcnt vmcnt(2)
  v_max3_u32 v7, v16, v17, v18
  v_max3_u32 v7, v19, v20, v7
  v_max3_u32 v7, v21, v22, v7
  v_max_u32 v7, v7, v23
  v_cmp_eq_u32 vcc, -1, v7
  s_cbranch_vccnz c_rl_29
  ds_write_b128 v8, v[16:19] offset:4096
  v_smfmac_f32_16x16x64_bf16 v[48:51], v[16:19], v[24:31], v6
  ds_write_b128 v8, v[20:23] offset:8192
  v_smfmac_f32_16x16x64_bf16 v[52:55], v[16:19], v[32:39], v6
  v_smfmac_f32_16x16x64_bf16 v[56:59], v[16:19], v[40:47], v6
  s_branch c_got_8
c_fb_10:
  v_max3_f32 v7, v48, v49, v50
  v_max_f32 v7, v51, v7
  s_mov_b64 exec, s[18:19]
  v_max3_f32 v7, v16, v17, v7
  s_mov_b64 exec, -1
  s_nop 0
  v_max_f32_dpp v7, v7, v7 quad_perm:[2,3,0,1] row_mask:0xf bank_mask:0xf
  v_mov_b32 v24, v7
  s_nop 0
  s_nop 0
  v_permlane16_swap_b32 v7, v24
  v_max_f32 v7, v7, v24
  v_mov_b32 v24, v7
  s_nop 0
  s_nop 0
  v_permlane32_swap_b32 v7, v24
  v_max_f32 v7, v7, v24
  v_sub_f32 v24, v48, v7
  v_sub_f32 v25, v49, v7
  v_sub_f32 v26, v50, v7
  v_sub_f32 v27, v51, v7
  v_sub_f32 v28, v16, v7
  v_sub_f32 v29, v17, v7
  v_exp_f32 v24, v24
  v_exp_f32 v25, v25
  v_exp_f32 v26, v26
  v_exp_f32 v27, v27
  v_exp_f32 v28, v28
  v_exp_f32 v29, v29
  v_cvt_pk_bf16_f32 v24, v24, v25
  v_cvt_pk_bf16_f32 v25, v26, v27
  v_cvt_pk_bf16_f32 v28, v28, v29
  v_cndmask_b32 v72, v24, 0, s[18:19]
  v_cndmask_b32 v73, v25, 0, s[18:19]
  v_cndmask_b32 v74, 0, v24, s[18:19]
  v_cndmask_b32 v75, 0, v25, s[18:19]
  v_cndmask_b32 v77, 0, v28, s[18:19]
  v_cndmask_b32 v78, 0, v28, s[18:19]
  v_mfma_f32_16x16x32_bf16 v[60:63], v[72:75], v[20:23], 0
  v_mfma_f32_16x16x32_bf16 v[52:55], v[72:75], v[80:83], 0
  v_mfma_f32_16x16x32_bf16 v[56:59], v[72:75], v[84:87], 0
  v_mfma_f32_16x16x16_bf16 v[60:63], v[76:77], v[20:21], v[60:63]
  v_mfma_f32_16x16x16_bf16 v[52:55], v[78:79], v[66:67], v[52:55]
  s_nop 2
  v_mfma_f32_16x16x16_bf16 v[56:59], v[76:77], v[66:67], v[56:59]
  s_nop 7
  v_add_f32 v60, v60, v62
  v_add_f32 v61, v61, v63
  s_branch c_fbr_11
c_fail_12:
  s_endpgm
L_chain_x:
  s_mov_b32 s22, 0
  s_mov_b32 s42, s62
  s_add_u32 s43, s62, 4096
  s_mov_b32 s46, 0
  s_mov_b32 s47, 0
  s_lshl_b32 s26, s16, 2
  s_add_u32 s26, s26, s17
  s_lshl_b32 s27, s60, 13
  s_add_u32 s27, s27, s26
  s_lshr_b32 s25, s27, 2
  s_lshl_b32 s25, s25, 13
  s_add_u32 s25, s25, 192937984
  s_lshr_b32 s64, s27, 2
  s_lshl_b32 s64, s64, 6
  s_add_u32 s64, s64, 513538048
  s_cmp_eq_u32 s17, 3
  s_cselect_b32 s2, 268435456, 0
  s_lshl_b32 s27, s61, 13
  s_add_u32 s27, s27, s26
  s_lshl_b32 s23, s27, 12
  s_add_u32 s23, s23, 41943040
  s_lshl_b32 s63, s27, 5
  s_add_u32 s63, s63, 244318208
  s_mov_b32 s97, 268435456
  s_cmp_eq_u32 s60, 2
  s_cselect_b32 s20, 262144, s97
  s_cselect_b32 s93, 1, 3
  s_lshl_b32 s26, s17, 2
  s_add_u32 s26, s26, s60
  s_cmp_eq_u32 s26, 1
  s_cselect_b32 s97, 245891072, s97
  s_mov_b32 s95, 0
  s_mov_b32 s96, s23
  s_add_u32 s23, s23, 524288
  s_add_u32 s63, s63, 4096
  s_mov_b32 s29, 0
  s_sub_u32 s92, s63, 4096
  s_sub_u32 s96, s23, 524288
  s_mov_b32 s95, 0
c_gw_38:
  buffer_load_dword v7, off, s[4:7], s92 sc1
  s_add_u32 s29, s29, 1
  s_cmp_gt_u32 s29, 1048576
  s_cbranch_scc1 c_fail_36
  s_waitcnt vmcnt(0) lgkmcnt(0)
  v_readfirstlane_b32 s65, v7
  s_cmp_eq_u32 s65, 0
  s_cbranch_scc1 c_gw_38
  s_and_b32 s65, s65, s93
  s_cbranch_scc1 c_kvx_40
  s_mov_b32 s95, 1
  s_add_u32 s96, s96, 33554432
  s_add_u32 s92, s92, 262144
c_kvw_39:
  buffer_load_dword v7, off, s[4:7], s92 sc1
  s_add_u32 s29, s29, 1
  s_cmp_gt_u32 s29, 1048576
  s_cbranch_scc1 c_fail_36
  s_waitcnt vmcnt(0) lgkmcnt(0)
  v_readfirstlane_b32 s65, v7
  s_cmp_eq_u32 s65, 0
  s_cbranch_scc1 c_kvw_39
c_kvx_40:
  buffer_load_dword v7, off, s[4:7], s63 sc1
  buffer_load_dwordx4 v0, s[4:7], s96 offen offset:0  lds
  buffer_load_dwordx4 v0, s[4:7], s96 offen offset:1024  lds
  buffer_load_dwordx4 v0, s[4:7], s96 offen offset:2048  lds
  buffer_load_dwordx4 v0, s[4:7], s96 offen offset:3072  lds
  s_waitcnt vmcnt(4)
  v_readfirstlane_b32 s65, v7
  s_mov_b32 s94, 0
  ds_read_b128 v[72:75], v1 offset:6144
  ds_read_b128 v[76:79], v1 offset:7168
  ds_read_b128 v[80:83], v1 offset:8192
  ds_read_b128 v[84:87], v1 offset:9216
  ds_read_b128 v[88:91], v1 offset:10240
  ds_read_b128 v[92:95], v1 offset:11264
  ds_read_b128 v[96:99], v1 offset:12288
  ds_read_b128 v[100:103], v1 offset:13312
  ds_read_b128 v[104:107], v1 offset:14336
  ds_read_b128 v[108:111], v1 offset:15360
  ds_read_b128 v[112:115], v1 offset:16384
  ds_read_b128 v[116:119], v1 offset:17408
  ds_read_b128 v[120:123], v1 offset:18432
  ds_read_b128 v[124:127], v1 offset:19456
  v_mov_b64 v[48:49], 0
  v_mov_b64 v[50:51], 0
  v_mov_b64 v[52:53], 0
  v_mov_b64 v[54:55], 0
  v_mov_b64 v[56:57], 0
  v_mov_b64 v[58:59], 0
  v_mov_b64 v[60:61], 0
  v_mov_b64 v[62:63], 0
  v_mov_b64 v[64:65], 0
  v_mov_b64 v[66:67], 0
  v_mov_b64 v[68:69], 0
  v_mov_b64 v[70:71], 0
  s_lshl_b32 s38, s16, 13
  s_add_u32 s38, s38, s40
  s_add_u32 s39, s38, 4096
  ds_read_b128 v[24:27], v1 offset:0
  ds_read_b128 v[28:31], v1 offset:1024
  ds_read_b128 v[32:35], v1 offset:2048
  ds_read_b128 v[36:39], v1 offset:3072
  ds_read_b128 v[40:43], v1 offset:4096
  ds_read_b128 v[44:47], v1 offset:5120
  s_waitcnt lgkmcnt(0)
c_loop_30:
  buffer_load_dwordx4 v[16:19], v8, s[4:7], s42 offen sc1
  buffer_load_dwordx4 v[20:23], v8, s[4:7], s43 offen sc1
  s_mov_b32 s28, 0
  v_mov_b64 v[48:49], 0
  v_mov_b64 v[50:51], 0
  v_mov_b64 v[52:53], 0
  v_mov_b64 v[54:55], 0
  v_mov_b64 v[56:57], 0
  v_mov_b64 v[58:59], 0
  v_mov_b64 v[60:61], 0
  v_mov_b64 v[62:63], 0
  v_mov_b64 v[64:65], 0
  v_mov_b64 v[66:67], 0
  v_mov_b64 v[68:69], 0
  v_mov_b64 v[70:71], 0
  buffer_load_dwordx4 v[16:19], v8, s[4:7], s42 offen sc1
  buffer_load_dwordx4 v[20:23], v8, s[4:7], s43 offen sc1
  s_waitcnt lgkmcnt(0)
  s_waitcnt vmcnt(3)
  v_max3_u32 v7, v16, v17, v18
  v_max_u32 v7, v7, v19
  ds_write_b128 v8, v[16:19] offset:4096
  v_smfmac_f32_16x16x64_bf16 v[48:51], v[16:19], v[24:31], v6
  s_waitcnt vmcnt(2)
  v_max3_u32 v7, v20, v21, v7
  v_max3_u32 v7, v22, v23, v7
  ds_write_b128 v8, v[20:23] offset:8192
  v_smfmac_f32_16x16x64_bf16 v[52:55], v[16:19], v[32:39], v6
  v_cmp_eq_u32 vcc, -1, v7
  v_smfmac_f32_16x16x64_bf16 v[56:59], v[16:19], v[40:47], v6
  s_cbranch_vccnz c_retry_31
c_got_32:
  v_smfmac_f32_16x16x64_bf16 v[60:63], v[16:19], v[72:79], v6
  ds_read_b128 v[72:75], v1 offset:20480
  s_and_b32 s65, s65, s93
  s_cselect_b32 s96, s23, 268435456
  v_smfmac_f32_16x16x64_bf16 v[48:51], v[20:23], v[80:87], v6
  ds_read_b128 v[76:79], v1 offset:21504
  s_cselect_b32 s95, 0, s94
  v_mov_b32 v7, 1
  v_smfmac_f32_16x16x64_bf16 v[52:55], v[20:23], v[88:95], v6
  ds_read_b128 v[80:83], v1 offset:22528
  s_add_u32 s31, s23, 33554432
  s_cmp_lg_u32 s95, 0
  v_smfmac_f32_16x16x64_bf16 v[56:59], v[20:23], v[96:103], v6
  ds_read_b128 v[84:87], v1 offset:23552
  s_cselect_b32 s96, s31, s96
  s_waitcnt lgkmcnt(4)
  s_barrier
  ds_read_b128 v[24:27], v9 offset:4096
  ds_read_b128 v[28:31], v10 offset:4096
  v_smfmac_f32_16x16x64_bf16 v[60:63], v[20:23], v[104:111], v6
  ds_read_b128 v[32:35], v11 offset:4096
  v_smfmac_f32_16x16x64_bf16 v[64:67], v[16:19], v[112:119], v6
  ds_read_b128 v[36:39], v9 offset:8192
  v_smfmac_f32_16x16x64_bf16 v[68:71], v[16:19], v[120:127], v6
  ds_read_b128 v[40:43], v10 offset:8192
  v_smfmac_f32_16x16x64_bf16 v[64:67], v[20:23], v[208:215], v6
  ds_read_b128 v[44:47], v11 offset:8192
  s_waitcnt lgkmcnt(5)
  v_smfmac_f32_16x16x64_bf16 v[48:51], v[24:27], a[168:175], v6
  s_mov_b64 exec, 1
  buffer_store_dword v7, off, s[4:7], s64 sc1
  s_mov_b64 exec, -1
  s_waitcnt lgkmcnt(4)
  v_smfmac_f32_16x16x64_bf16 v[48:51], v[28:31], a[160:167], v6
  buffer_load_dwordx4 v0, s[4:7], s96 offen offset:0  lds
  s_waitcnt lgkmcnt(3)
  v_smfmac_f32_16x16x64_bf16 v[48:51], v[32:35], a[152:159], v6
  ds_read_b128 v[104:107], v8 offset:16384
  s_waitcnt lgkmcnt(3)
  v_smfmac_f32_16x16x64_bf16 v[48:51], v[36:39], a[144:151], v6
  buffer_load_dwordx4 v0, s[4:7], s96 offen offset:1024  lds
  s_waitcnt lgkmcnt(2)
  v_smfmac_f32_16x16x64_bf16 v[48:51], v[40:43], a[136:143], v6
  ds_read_b128 v[108:111], v8 offset:20480
  s_waitcnt lgkmcnt(2)
  v_smfmac_f32_16x16x64_bf16 v[48:51], v[44:47], a[128:135], v6
  buffer_load_dwordx4 v0, s[4:7], s96 offen offset:2048  lds
  v_smfmac_f32_16x16x64_bf16 v[52:55], v[24:27], a[120:127], v6
  buffer_load_dwordx4 v0, s[4:7], s96 offen offset:3072  lds
  v_smfmac_f32_16x16x64_bf16 v[52:55], v[28:31], a[112:119], v6
  ds_read_b64 v[100:101], v5 offset:4096
  v_add_f32 v48, v48, v50
  v_smfmac_f32_16x16x64_bf16 v[52:55], v[32:35], a[104:111], v6
  ds_read_b128 v[112:115], v8 offset:24576
  v_add_f32 v49, v49, v51
  v_smfmac_f32_16x16x64_bf16 v[52:55], v[36:39], a[96:103], v6
  ds_read_b128 v[116:119], v8 offset:28672
  v_cvt_pk_bf16_f32 v50, v48, v49
  v_smfmac_f32_16x16x64_bf16 v[52:55], v[40:43], a[88:95], v6
  ds_write2_b32 v2, v50, v50 offset0:0 offset1:1
  v_smfmac_f32_16x16x64_bf16 v[52:55], v[44:47], a[80:87], v6
  ds_read_b64_tr_b16 v[88:89], v12 offset:0
  v_smfmac_f32_16x16x64_bf16 v[56:59], v[24:27], a[72:79], v6
  v_smfmac_f32_16x16x64_bf16 v[56:59], v[28:31], a[64:71], v6
  ds_read_b128 v[120:123], v8 offset:32768
  v_add_f32 v52, v52, v54
  v_smfmac_f32_16x16x64_bf16 v[56:59], v[32:35], a[56:63], v6
  ds_read_b128 v[124:127], v8 offset:36864
  v_add_f32 v53, v53, v55
  v_cvt_pk_bf16_f32 v54, v52, v53
  v_smfmac_f32_16x16x64_bf16 v[56:59], v[36:39], a[48:55], v6
  ds_write2_b32 v2, v54, v54 offset0:128 offset1:129
  ds_read_b64_tr_b16 v[90:91], v12 offset:512
  v_smfmac_f32_16x16x64_bf16 v[56:59], v[40:43], a[40:47], v6
  v_smfmac_f32_16x16x64_bf16 v[56:59], v[44:47], a[32:39], v6
  v_smfmac_f32_16x16x64_bf16 v[60:63], v[24:27], a[24:31], v6
  v_smfmac_f32_16x16x64_bf16 v[60:63], v[28:31], a[16:23], v6
  s_waitcnt lgkmcnt(0)
  v_add_f32 v56, v56, v58
  v_mfma_f32_16x16x32_bf16 v[92:95], v[72:75], v[88:91], 0
  buffer_store_dwordx2 v[100:101], v5, s[4:7], s97 offen sc1
  v_add_f32 v57, v57, v59
  v_cvt_pk_bf16_f32 v58, v56, v57
  v_mfma_f32_16x16x32_bf16 v[96:99], v[76:79], v[88:91], 0
  ds_write_b32 v2, v58
  v_smfmac_f32_16x16x64_bf16 v[60:63], v[32:35], a[8:15], v6
  v_mov_b32 v76, 0
  v_smfmac_f32_16x16x64_bf16 v[60:63], v[36:39], a[0:7], v6
  v_cndmask_b32 v48, v92, v96, s[18:19]
  v_smfmac_f32_16x16x64_bf16 v[60:63], v[40:43], v[248:255], v6
  v_cndmask_b32 v49, v93, v97, s[18:19]
  v_smfmac_f32_16x16x64_bf16 v[60:63], v[44:47], v[240:247], v6
  v_cndmask_b32 v50, v94, v98, s[18:19]
  v_smfmac_f32_16x16x64_bf16 v[68:71], v[20:23], v[152:159], v6
  v_cndmask_b32 v51, v95, v99, s[18:19]
  v_smfmac_f32_16x16x64_bf16 v[64:67], v[24:27], v[232:239], v6
  ds_write_b128 v8, v[48:51] offset:12288
  v_add_f32 v60, v60, v62
  v_add_f32 v61, v61, v63
  v_cvt_pk_bf16_f32 v62, v60, v61
  v_smfmac_f32_16x16x64_bf16 v[64:67], v[28:31], v[224:231], v6
  ds_write_b32 v2, v62 offset:512
  s_waitcnt vmcnt(6)
  v_mov_b32 v79, 0
  v_smfmac_f32_16x16x64_bf16 v[64:67], v[32:35], v[216:223], v6
  v_mov_b64 v[20:21], s[14:15]
  v_smfmac_f32_16x16x64_bf16 v[64:67], v[36:39], v[200:207], v6
  v_mov_b64 v[22:23], s[14:15]
  v_smfmac_f32_16x16x64_bf16 v[64:67], v[40:43], v[192:199], v6
  s_waitcnt lgkmcnt(0)
  s_barrier
  ds_read_b128 v[52:55], v9 offset:12288
  ds_read_b128 v[56:59], v10 offset:12288
  v_smfmac_f32_16x16x64_bf16 v[64:67], v[44:47], v[184:191], v6
  ds_read_b128 v[60:63], v11 offset:12288
  v_smfmac_f32_16x16x64_bf16 v[68:71], v[24:27], v[176:183], v6
  ds_read_b64_tr_b16 v[88:89], v12 offset:0
  ds_read_b64_tr_b16 v[90:91], v12 offset:512
  v_smfmac_f32_16x16x64_bf16 v[68:71], v[28:31], v[168:175], v6
  ds_read_b64_tr_b16 v[92:93], v13 offset:0
  ds_read_b64_tr_b16 v[94:95], v13 offset:512
  v_add_f32 v64, v64, v66
  v_smfmac_f32_16x16x64_bf16 v[68:71], v[32:35], v[160:167], v6
  ds_read_b64_tr_b16 v[96:97], v14 offset:0
  ds_read_b64_tr_b16 v[98:99], v14 offset:512
  v_add_f32 v65, v65, v67
  v_smfmac_f32_16x16x64_bf16 v[68:71], v[36:39], v[144:151], v6
  ds_read_b64_tr_b16 v[100:101], v15 offset:0
  ds_read_b64_tr_b16 v[102:103], v15 offset:512
  s_waitcnt lgkmcnt(8)
  v_cvt_pk_bf16_f32 v66, v64, v65
  v_smfmac_f32_16x16x64_bf16 v[68:71], v[40:43], v[136:143], v6
  v_add_f32 v48, v48, v52
  v_smfmac_f32_16x16x64_bf16 v[68:71], v[44:47], v[128:135], v6
  s_waitcnt lgkmcnt(4)
  v_add_f32 v49, v49, v53
  v_mfma_f32_16x16x32_bf16 v[16:19], v[88:91], v[88:91], 0
  buffer_store_dwordx4 v[88:91], v8, s[4:7], s25 offen sc1
  v_add_f32 v50, v50, v54
  v_add_f32 v51, v51, v55
  v_mfma_f32_16x16x32_bf16 v[16:19], v[92:95], v[92:95], v[16:19]
  s_waitcnt lgkmcnt(0)
  v_add_f32 v56, v56, v60
  v_add_f32 v57, v57, v61
  v_mfma_f32_16x16x32_bf16 v[16:19], v[96:99], v[96:99], v[16:19]
  v_add_f32 v58, v58, v62
  v_add_f32 v59, v59, v63
  v_mfma_f32_16x16x32_bf16 v[16:19], v[100:103], v[100:103], v[16:19]
  v_add_f32 v48, v48, v56
  v_add_f32 v49, v49, v57
  v_add_f32 v50, v50, v58
  v_add_f32 v51, v51, v59
  v_exp_f32 v24, v48
  v_exp_f32 v25, v49
  v_exp_f32 v26, v50
  v_exp_f32 v27, v51
  v_cvt_pk_bf16_f32 v24, v24, v25
  v_mul_f32 v16, s24, v16
  v_cvt_pk_bf16_f32 v25, v26, v27
  v_cndmask_b32 v72, v24, 0, s[18:19]
  v_cndmask_b32 v73, v25, 0, s[18:19]
  v_cndmask_b32 v74, 0, v24, s[18:19]
  v_cndmask_b32 v75, 0, v25, s[18:19]
  v_mul_f32 v17, s24, v17
  v_exp_f32 v28, v16
  v_mfma_f32_16x16x32_bf16 v[60:63], v[72:75], v[20:23], 0
  v_exp_f32 v29, v17
  v_add_f32 v68, v68, v70
  v_mfma_f32_16x16x32_bf16 v[52:55], v[72:75], v[80:83], 0
  s_add_u32 s30, s25, 4096
  v_cvt_pk_bf16_f32 v28, v28, v29
  v_add_f32 v69, v69, v71
  v_mfma_f32_16x16x32_bf16 v[56:59], v[72:75], v[84:87], 0
  v_cndmask_b32 v77, 0, v28, s[18:19]
  v_cndmask_b32 v78, 0, v28, s[18:19]
  v_cvt_pk_bf16_f32 v67, v68, v69
  v_lshrrev_b32 v92, 1, v8
  v_mfma_f32_16x16x16_bf16 v[60:63], v[76:77], v[20:21], v[60:63]
  buffer_store_dwordx2 v[66:67], v92, s[4:7], s30 offen sc1
  v_max3_f32 v7, |v48|, |v49|, |v50|
  v_max_f32 v26, |v16|, |v17|
  v_mfma_f32_16x16x16_bf16 v[52:55], v[78:79], v[66:67], v[52:55]
  v_cndmask_b32 v26, 0, v26, s[18:19]
  v_max3_f32 v7, |v51|, v26, v7
  v_mfma_f32_16x16x16_bf16 v[56:59], v[76:77], v[66:67], v[56:59]
  v_cmp_lt_f32 vcc, 0x42700000, v7
  v_mov_b64 v[44:45], 0
  v_add_f32 v60, v60, v62
  v_add_f32 v61, v61, v63
  s_cbranch_vccnz c_fb_34
c_fbr_35:
  v_rcp_f32 v60, v60
  v_rcp_f32 v61, v61
  v_pk_add_f32 v[52:53], v[52:53], v[54:55]
  v_pk_add_f32 v[56:57], v[56:57], v[58:59]
  v_pk_mul_f32 v[52:53], v[52:53], v[60:61]
  v_pk_mul_f32 v[56:57], v[56:57], v[60:61]
  v_cvt_pk_bf16_f32 v54, v52, v53
  v_cvt_pk_bf16_f32 v55, v56, v57
  ds_write_b64 v2, v[54:55] offset:4096
  v_mov_b64 v[46:47], 0
  v_mov_b64 v[40:41], 0
  v_mov_b64 v[42:43], 0
  v_mov_b64 v[36:37], 0
  v_mov_b64 v[38:39], 0
  v_mov_b64 v[32:33], 0
  v_mov_b64 v[34:35], 0
  v_mov_b64 v[28:29], 0
  v_mov_b64 v[30:31], 0
  v_mov_b64 v[24:25], 0
  v_mov_b64 v[26:27], 0
  v_mov_b64 v[80:81], 0
  s_waitcnt lgkmcnt(0)
  s_barrier
  ds_read_b64_tr_b16 v[72:73], v3 offset:4096
  ds_read_b64_tr_b16 v[74:75], v3 offset:5120
  ds_read_b64_tr_b16 v[76:77], v3 offset:6144
  ds_read_b64_tr_b16 v[78:79], v3 offset:7168
  s_and_b32 s3, s22, 1
  s_add_u32 s22, s22, 1
  s_and_b32 s42, s22, 3
  s_lshl_b32 s42, s42, 13
  s_cmp_eq_u32 s22, 64
  s_cbranch_scc1 c_last_37
  s_waitcnt lgkmcnt(2)
  v_smfmac_f32_16x16x64_bf16 v[44:47], v[72:75], a[248:255], v6
  s_waitcnt lgkmcnt(0)
  ds_read_b128 v[16:19], v8 offset:40960
  v_mov_b64 v[82:83], 0
  v_smfmac_f32_16x16x64_bf16 v[44:47], v[76:79], a[240:247], v6
  ds_read_b128 v[20:23], v8 offset:45056
  v_mov_b64 v[84:85], 0
  v_smfmac_f32_16x16x64_bf16 v[40:43], v[72:75], a[232:239], v6
  ds_read_b128 v[88:91], v8 offset:49152
  v_mov_b64 v[86:87], 0
  v_smfmac_f32_16x16x64_bf16 v[40:43], v[76:79], a[224:231], v6
  ds_read_b128 v[92:95], v8 offset:53248
  v_add_f32 v44, v44, v46
  v_add_f32 v45, v45, v47
  v_smfmac_f32_16x16x64_bf16 v[36:39], v[72:75], a[216:223], v6
  ds_read_b128 v[96:99], v8 offset:57344
  v_cvt_pk_bf16_f32 v48, v44, v45
  v_and_or_b32 v48, v48, -2, s3
  v_smfmac_f32_16x16x64_bf16 v[36:39], v[76:79], a[208:215], v6
  ds_read_b128 v[100:103], v8 offset:61440
  v_add_f32 v40, v40, v42
  v_add_f32 v41, v41, v43
  v_smfmac_f32_16x16x64_bf16 v[32:35], v[72:75], a[200:207], v6
  v_cvt_pk_bf16_f32 v49, v40, v41
  v_smfmac_f32_16x16x64_bf16 v[32:35], v[76:79], a[192:199], v6
  v_add_f32 v36, v36, v38
  v_add_f32 v37, v37, v39
  v_smfmac_f32_16x16x64_bf16 v[28:31], v[72:75], a[184:191], v6
  v_cvt_pk_bf16_f32 v50, v36, v37
  v_smfmac_f32_16x16x64_bf16 v[28:31], v[76:79], a[176:183], v6
  v_add_f32 v32, v32, v34
  v_add_f32 v33, v33, v35
  v_smfmac_f32_16x16x64_bf16 v[24:27], v[72:75], v[104:111], v6
  v_cvt_pk_bf16_f32 v51, v32, v33
  v_smfmac_f32_16x16x64_bf16 v[24:27], v[76:79], v[112:119], v6
  buffer_store_dwordx4 v[48:51], v4, s[4:7], s40 offen sc1
  v_add_f32 v28, v28, v30
  v_add_f32 v29, v29, v31
  v_smfmac_f32_16x16x64_bf16 v[80:83], v[72:75], v[120:127], v6
  s_waitcnt lgkmcnt(0)
  v_cvt_pk_bf16_f32 v52, v28, v29
  v_and_or_b32 v52, v52, -2, s3
  v_smfmac_f32_16x16x64_bf16 v[80:83], v[76:79], v[16:23], v6
  v_add_f32 v24, v24, v26
  v_add_f32 v25, v25, v27
  v_smfmac_f32_16x16x64_bf16 v[84:87], v[72:75], v[88:95], v6
  v_cvt_pk_bf16_f32 v53, v24, v25
  v_smfmac_f32_16x16x64_bf16 v[84:87], v[76:79], v[96:103], v6
  v_add_f32 v80, v80, v82
  v_add_f32 v81, v81, v83
  v_cvt_pk_bf16_f32 v54, v80, v81
  s_nop 0
  s_nop 3
  v_pk_add_f32 v[84:85], v[84:85], v[86:87]
  v_cvt_pk_bf16_f32 v55, v84, v85
  buffer_store_dwordx4 v[52:55], v4, s[4:7], s41 offen sc1
  s_add_u32 s42, s42, s62
  s_add_u32 s43, s42, 4096
  s_add_u32 s23, s23, 524288
  s_add_u32 s25, s25, 262144
  s_add_u32 s63, s63, 4096
  s_add_u32 s64, s64, 2048
  s_andn2_b32 s64, s64, s2
  s_add_u32 s97, s97, 8192
  s_add_u32 s92, s63, s20
  s_cmp_lg_u32 s17, 0
  s_cbranch_scc1 c_oth_45
  s_mov_b32 s28, 0
  s_add_u32 s46, s46, 1
  v_mov_b64 v[64:65], -1
  s_xor_b32 s34, s42, 16384
  buffer_store_dwordx2 v[64:65], v5, s[4:7], s34 offen sc1
  s_mov_b32 vcc_lo, 0xaaaaaaaa
  s_mov_b32 vcc_hi, 0xaaaaaaaa
  v_mov_b32 v7, 0x3f80
  v_cndmask_b32 v7, v7, 1.0, vcc
  s_mov_b32 vcc_lo, 0x30003
  s_mov_b32 vcc_hi, 0x30003
  v_cndmask_b32 v68, 0, v7, vcc
  s_mov_b32 vcc_lo, 0xc000c
  s_mov_b32 vcc_hi, 0xc000c
  v_cndmask_b32 v69, 0, v7, vcc
  s_mov_b32 vcc_lo, 0x300030
  s_mov_b32 vcc_hi, 0x300030
  v_cndmask_b32 v70, 0, v7, vcc
  s_mov_b32 vcc_lo, 0xc000c0
  s_mov_b32 vcc_hi, 0xc000c0
  v_cndmask_b32 v71, 0, v7, vcc
  ds_read_b128 v[104:107], v1 offset:14336
  ds_read_b128 v[108:111], v1 offset:15360
  s_waitcnt lgkmcnt(0)
  ds_read_b128 v[112:115], v1 offset:16384
  ds_read_b128 v[116:119], v1 offset:17408
  ds_read_b128 v[120:123], v1 offset:18432
  ds_read_b128 v[124:127], v1 offset:19456
  s_waitcnt lgkmcnt(0)
  buffer_load_dwordx4 v[16:19], v0, s[4:7], s38 offen offset:0 sc1
  buffer_load_dwordx4 v[20:23], v0, s[4:7], s38 offen offset:1024 sc1
  buffer_load_dwordx4 v[24:27], v0, s[4:7], s38 offen offset:2048 sc1
  buffer_load_dwordx4 v[28:31], v0, s[4:7], s38 offen offset:3072 sc1
  buffer_load_dwordx4 v[32:35], v0, s[4:7], s39 offen offset:0 sc1
  buffer_load_dwordx4 v[36:39], v0, s[4:7], s39 offen offset:1024 sc1
  buffer_load_dwordx4 v[40:43], v0, s[4:7], s39 offen offset:2048 sc1
  buffer_load_dwordx4 v[44:47], v0, s[4:7], s39 offen offset:3072 sc1
  buffer_load_dwordx4 v[72:75], v0, s[4:7], s38 offen offset:0 sc1
  buffer_load_dwordx4 v[76:79], v0, s[4:7], s38 offen offset:1024 sc1
  buffer_load_dwordx4 v[80:83], v0, s[4:7], s38 offen offset:2048 sc1
  buffer_load_dwordx4 v[84:87], v0, s[4:7], s38 offen offset:3072 sc1
  buffer_load_dwordx4 v[88:91], v0, s[4:7], s39 offen offset:0 sc1
  buffer_load_dwordx4 v[92:95], v0, s[4:7], s39 offen offset:1024 sc1
  buffer_load_dwordx4 v[96:99], v0, s[4:7], s39 offen offset:2048 sc1
  buffer_load_dwordx4 v[100:103], v0, s[4:7], s39 offen offset:3072 sc1
  s_buffer_load_dword s65, s[4:7], s63
  s_buffer_load_dword s94, s[4:7], s92
  s_waitcnt vmcnt(15)
  v_mfma_f32_16x16x32_bf16 v[64:67], v[16:19], v[68:71], 0
  v_xor_b32 v7, s3, v16
  s_waitcnt vmcnt(14)
  v_mfma_f32_16x16x32_bf16 v[64:67], v[20:23], v[68:71], v[64:67]
  v_bitop3_b32 v7, v7, v20, s3 bitop3:0xf6
  s_waitcnt vmcnt(13)
  v_mfma_f32_16x16x32_bf16 v[64:67], v[24:27], v[68:71], v[64:67]
  v_bitop3_b32 v7, v7, v24, s3 bitop3:0xf6
  s_waitcnt vmcnt(12)
  v_mfma_f32_16x16x32_bf16 v[64:67], v[28:31], v[68:71], v[64:67]
  v_bitop3_b32 v7, v7, v28, s3 bitop3:0xf6
  s_waitcnt vmcnt(11)
  v_mfma_f32_16x16x32_bf16 v[64:67], v[32:35], v[68:71], v[64:67]
  v_bitop3_b32 v7, v7, v32, s3 bitop3:0xf6
  s_waitcnt vmcnt(10)
  v_mfma_f32_16x16x32_bf16 v[64:67], v[36:39], v[68:71], v[64:67]
  v_bitop3_b32 v7, v7, v36, s3 bitop3:0xf6
  s_waitcnt vmcnt(9)
  v_mfma_f32_16x16x32_bf16 v[64:67], v[40:43], v[68:71], v[64:67]
  v_bitop3_b32 v7, v7, v40, s3 bitop3:0xf6
  s_waitcnt vmcnt(8)
  v_mfma_f32_16x16x32_bf16 v[64:67], v[44:47], v[68:71], v[64:67]
  v_bitop3_b32 v7, v7, v44, s3 bitop3:0xf6
  v_and_b32 v7, 1, v7
  v_cmp_ne_u32 vcc, 0, v7
  v_mov_b32 v7, 0
  v_mov_b32 v7, 0
  s_cbranch_vccnz c_p1r_46
c_publ_47:
  s_nop 1
  s_nop 0
  v_cvt_pk_bf16_f32 v64, v64, v65
  v_cvt_pk_bf16_f32 v65, v66, v67
  v_min_u32 v64, -2, v64
  v_min_u32 v65, -2, v65
  buffer_store_dwordx2 v[64:65], v5, s[4:7], s42 offen sc1
  s_waitcnt vmcnt(1)
  ds_read_b128 v[24:27], v1 offset:0
  ds_read_b128 v[28:31], v1 offset:1024
  ds_read_b128 v[32:35], v1 offset:2048
  ds_read_b128 v[36:39], v1 offset:3072
  ds_read_b128 v[40:43], v1 offset:4096
  ds_read_b128 v[44:47], v1 offset:5120
  ds_read_b128 v[72:75], v1 offset:6144
  ds_read_b128 v[76:79], v1 offset:7168
  ds_read_b128 v[80:83], v1 offset:8192
  ds_read_b128 v[84:87], v1 offset:9216
  ds_read_b128 v[88:91], v1 offset:10240
  ds_read_b128 v[92:95], v1 offset:11264
  ds_read_b128 v[96:99], v1 offset:12288
  ds_read_b128 v[100:103], v1 offset:13312
c_hop2_33:
  s_barrier
  s_cmp_le_u32 s96, s23
  s_cbranch_scc1 c_loop_30
  s_cmp_lg_u32 s96, 268435456
  s_cbranch_scc1 c_fk0_48
  buffer_store_dwordx2 v[64:65], v5, s[4:7], s97 offen sc1
  s_mov_b32 s29, 0
  s_sub_u32 s92, s63, 4096
  s_sub_u32 s96, s23, 524288
  s_mov_b32 s95, 0
c_gw_49:
  buffer_load_dword v7, off, s[4:7], s92 sc1
  s_add_u32 s29, s29, 1
  s_cmp_gt_u32 s29, 1048576
  s_cbranch_scc1 c_fail_36
  s_waitcnt vmcnt(0) lgkmcnt(0)
  v_readfirstlane_b32 s65, v7
  s_cmp_eq_u32 s65, 0
  s_cbranch_scc1 c_gw_49
  s_and_b32 s65, s65, s93
  s_cbranch_scc1 c_kvx_51
  s_mov_b32 s95, 1
  s_add_u32 s96, s96, 33554432
  s_add_u32 s92, s92, 262144
c_kvw_50:
  buffer_load_dword v7, off, s[4:7], s92 sc1
  s_add_u32 s29, s29, 1
  s_cmp_gt_u32 s29, 1048576
  s_cbranch_scc1 c_fail_36
  s_waitcnt vmcnt(0) lgkmcnt(0)
  v_readfirstlane_b32 s65, v7
  s_cmp_eq_u32 s65, 0
  s_cbranch_scc1 c_kvw_50
c_kvx_51:
  buffer_load_dword v7, off, s[4:7], s63 sc1
  buffer_load_dwordx4 v0, s[4:7], s96 offen offset:0  lds
  buffer_load_dwordx4 v0, s[4:7], s96 offen offset:1024  lds
  buffer_load_dwordx4 v0, s[4:7], s96 offen offset:2048  lds
  buffer_load_dwordx4 v0, s[4:7], s96 offen offset:3072  lds
  s_waitcnt vmcnt(4)
  v_readfirstlane_b32 s65, v7
  s_mov_b32 s94, 0
  s_cmp_eq_u32 s95, 0
  s_cbranch_scc1 c_loop_30
c_fk0_48:
  s_mov_b32 s29, 0
c_fk_52:
  buffer_load_dwordx4 v[16:19], v8, s[4:7], s42 offen sc1
  buffer_load_dwordx4 v[20:23], v8, s[4:7], s43 offen sc1
  s_add_u32 s29, s29, 1
  s_cmp_gt_u32 s29, 1048576
  s_cbranch_scc1 c_fail_36
  s_waitcnt vmcnt(0)
  v_max3_u32 v7, v16, v17, v18
  v_max3_u32 v7, v19, v20, v7
  v_max3_u32 v7, v21, v22, v7
  v_max_u32 v7, v7, v23
  v_cmp_eq_u32 vcc, -1, v7
  s_cbranch_vccnz c_fk_52
  s_lshl_b32 s42, s22, 13
  s_add_u32 s42, s42, 245891072
  s_add_u32 s43, s42, 4096
  s_mov_b32 s95, 0
  s_branch c_loop_30
c_last_37:
  s_add_u32 s64, s64, 2048
  v_mov_b32 v7, 1
  s_waitcnt vmcnt(0)
  s_barrier
  s_mov_b64 exec, 1
  buffer_store_dword v7, off, s[4:7], s64 sc1
  s_mov_b64 exec, -1
  s_branch L_chdone
c_oth_45:
  s_buffer_load_dword s65, s[4:7], s63
  s_buffer_load_dword s94, s[4:7], s92
  ds_read_b128 v[24:27], v1 offset:0
  ds_read_b128 v[28:31], v1 offset:1024
  ds_read_b128 v[32:35], v1 offset:2048
  ds_read_b128 v[36:39], v1 offset:3072
  ds_read_b128 v[40:43], v1 offset:4096
  ds_read_b128 v[44:47], v1 offset:5120
  ds_read_b128 v[72:75], v1 offset:6144
  ds_read_b128 v[76:79], v1 offset:7168
  ds_read_b128 v[80:83], v1 offset:8192
  ds_read_b128 v[84:87], v1 offset:9216
  ds_read_b128 v[88:91], v1 offset:10240
  ds_read_b128 v[92:95], v1 offset:11264
  ds_read_b128 v[96:99], v1 offset:12288
  ds_read_b128 v[100:103], v1 offset:13312
  ds_read_b128 v[104:107], v1 offset:14336
  ds_read_b128 v[108:111], v1 offset:15360
  ds_read_b128 v[112:115], v1 offset:16384
  ds_read_b128 v[116:119], v1 offset:17408
  ds_read_b128 v[120:123], v1 offset:18432
  ds_read_b128 v[124:127], v1 offset:19456
  s_branch c_hop2_33
c_p1r_46:
  s_waitcnt vmcnt(7)
  s_nop 0
  v_mfma_f32_16x16x32_bf16 v[64:67], v[72:75], v[68:71], 0
  v_xor_b32 v7, s3, v72
  s_waitcnt vmcnt(6)
  v_mfma_f32_16x16x32_bf16 v[64:67], v[76:79], v[68:71], v[64:67]
  v_bitop3_b32 v7, v7, v76, s3 bitop3:0xf6
  s_waitcnt vmcnt(5)
  v_mfma_f32_16x16x32_bf16 v[64:67], v[80:83], v[68:71], v[64:67]
  v_bitop3_b32 v7, v7, v80, s3 bitop3:0xf6
  s_waitcnt vmcnt(4)
  v_mfma_f32_16x16x32_bf16 v[64:67], v[84:87], v[68:71], v[64:67]
  v_bitop3_b32 v7, v7, v84, s3 bitop3:0xf6
  s_waitcnt vmcnt(3)
  v_mfma_f32_16x16x32_bf16 v[64:67], v[88:91], v[68:71], v[64:67]
  v_bitop3_b32 v7, v7, v88, s3 bitop3:0xf6
  s_waitcnt vmcnt(2)
  v_mfma_f32_16x16x32_bf16 v[64:67], v[92:95], v[68:71], v[64:67]
  v_bitop3_b32 v7, v7, v92, s3 bitop3:0xf6
  s_waitcnt vmcnt(1)
  v_mfma_f32_16x16x32_bf16 v[64:67], v[96:99], v[68:71], v[64:67]
  v_bitop3_b32 v7, v7, v96, s3 bitop3:0xf6
  s_waitcnt vmcnt(0)
  v_mfma_f32_16x16x32_bf16 v[64:67], v[100:103], v[68:71], v[64:67]
  v_bitop3_b32 v7, v7, v100, s3 bitop3:0xf6
  v_and_b32 v7, 1, v7
  v_cmp_ne_u32 vcc, 0, v7
  s_add_u32 s46, s46, 1
  s_cbranch_vccz c_publ_47
  buffer_load_dwordx4 v[72:75], v0, s[4:7], s38 offen offset:0 sc1
  buffer_load_dwordx4 v[76:79], v0, s[4:7], s38 offen offset:1024 sc1
  buffer_load_dwordx4 v[80:83], v0, s[4:7], s38 offen offset:2048 sc1
  buffer_load_dwordx4 v[84:87], v0, s[4:7], s38 offen offset:3072 sc1
  buffer_load_dwordx4 v[88:91], v0, s[4:7], s39 offen offset:0 sc1
  buffer_load_dwordx4 v[92:95], v0, s[4:7], s39 offen offset:1024 sc1
  buffer_load_dwordx4 v[96:99], v0, s[4:7], s39 offen offset:2048 sc1
  buffer_load_dwordx4 v[100:103], v0, s[4:7], s39 offen offset:3072 sc1
  s_add_u32 s28, s28, 1
  s_cmp_gt_u32 s28, 1048576
  s_cbranch_scc0 c_p1r_46
  s_branch c_fail_36
c_retry_31:
  v_mov_b64 v[48:49], 0
  v_mov_b64 v[50:51], 0
  s_nop 0
  v_mov_b64 v[52:53], 0
  v_mov_b64 v[54:55], 0
  s_nop 1
  v_mov_b64 v[56:57], 0
  v_mov_b64 v[58:59], 0
c_rl_53:
  buffer_load_dwordx4 v[16:19], v8, s[4:7], s42 offen sc1
  buffer_load_dwordx4 v[20:23], v8, s[4:7], s43 offen sc1
  s_add_u32 s28, s28, 1
  s_add_u32 s47, s47, 1
  s_cmp_gt_u32 s28, 1048576
  s_cbranch_scc1 c_fail_36
  s_waitcnt vmcnt(2)
  v_max3_u32 v7, v16, v17, v18
  v_max3_u32 v7, v19, v20, v7
  v_max3_u32 v7, v21, v22, v7
  v_max_u32 v7, v7, v23
  v_cmp_eq_u32 vcc, -1, v7
  s_cbranch_vccnz c_rl_53
  ds_write_b128 v8, v[16:19] offset:4096
  v_smfmac_f32_16x16x64_bf16 v[48:51], v[16:19], v[24:31], v6
  ds_write_b128 v8, v[20:23] offset:8192
  v_smfmac_f32_16x16x64_bf16 v[52:55], v[16:19], v[32:39], v6
  v_smfmac_f32_16x16x64_bf16 v[56:59], v[16:19], v[40:47], v6
  s_branch c_got_32
c_fb_34:
  v_max3_f32 v7, v48, v49, v50
  v_max_f32 v7, v51, v7
  s_mov_b64 exec, s[18:19]
  v_max3_f32 v7, v16, v17, v7
  s_mov_b64 exec, -1
  s_nop 0
  v_max_f32_dpp v7, v7, v7 quad_perm:[2,3,0,1] row_mask:0xf bank_mask:0xf
  v_mov_b32 v24, v7
  s_nop 0
  s_nop 0
  v_permlane16_swap_b32 v7, v24
  v_max_f32 v7, v7, v24
  v_mov_b32 v24, v7
  s_nop 0
  s_nop 0
  v_permlane32_swap_b32 v7, v24
  v_max_f32 v7, v7, v24
  v_sub_f32 v24, v48, v7
  v_sub_f32 v25, v49, v7
  v_sub_f32 v26, v50, v7
  v_sub_f32 v27, v51, v7
  v_sub_f32 v28, v16, v7
  v_sub_f32 v29, v17, v7
  v_exp_f32 v24, v24
  v_exp_f32 v25, v25
  v_exp_f32 v26, v26
  v_exp_f32 v27, v27
  v_exp_f32 v28, v28
  v_exp_f32 v29, v29
  v_cvt_pk_bf16_f32 v24, v24, v25
  v_cvt_pk_bf16_f32 v25, v26, v27
  v_cvt_pk_bf16_f32 v28, v28, v29
  v_cndmask_b32 v72, v24, 0, s[18:19]
  v_cndmask_b32 v73, v25, 0, s[18:19]
  v_cndmask_b32 v74, 0, v24, s[18:19]
  v_cndmask_b32 v75, 0, v25, s[18:19]
  v_cndmask_b32 v77, 0, v28, s[18:19]
  v_cndmask_b32 v78, 0, v28, s[18:19]
  v_mfma_f32_16x16x32_bf16 v[60:63], v[72:75], v[20:23], 0
  v_mfma_f32_16x16x32_bf16 v[52:55], v[72:75], v[80:83], 0
  v_mfma_f32_16x16x32_bf16 v[56:59], v[72:75], v[84:87], 0
  v_mfma_f32_16x16x16_bf16 v[60:63], v[76:77], v[20:21], v[60:63]
  v_mfma_f32_16x16x16_bf16 v[52:55], v[78:79], v[66:67], v[52:55]
  s_nop 2
  v_mfma_f32_16x16x16_bf16 v[56:59], v[76:77], v[66:67], v[56:59]
  s_nop 7
  v_add_f32 v60, v60, v62
  v_add_f32 v61, v61, v63
  s_branch c_fbr_35
c_fail_36:
  s_endpgm
L_chdone:
  s_cmp_lg_u32 s91, 0
  s_cbranch_scc1 L_end
  s_lshr_b32 s91, s90, 4
  s_add_u32 s91, s91, 7
  v_lshrrev_b32 v0, 4, v0
  s_waitcnt vmcnt(0) lgkmcnt(0)
  s_branch L_o
L_qkv:
  s_mul_i32 s26, s91, 15
  s_add_u32 s26, s26, s90
  s_sub_u32 s26, s26, 61
  s_add_u32 s27, s91, 89
  s_cmp_eq_u32 s90, 31
  s_cselect_b32 s26, s27, s26
  s_add_u32 s27, s90, 60
  s_cmp_eq_u32 s91, 7
  s_cselect_b32 s26, s27, s26
  s_mul_i32 s16, s26, 171
  s_lshr_b32 s16, s16, 9
  s_mul_i32 s27, s16, 3
  s_sub_u32 s60, s26, s27
  s_add_u32 s16, s16, 4
  s_and_b32 s16, s16, 31
  v_and_b32 v19, 63, v0
  v_and_b32 v6, 15, v19
  v_lshrrev_b32 v7, 4, v19
  v_lshlrev_b32 v1, 2, v19
  v_lshlrev_b32 v0, 4, v19
  v_lshlrev_b32 v9, 7, v19
  s_mov_b32 s24, 0x3e0293ee
  s_lshl_b32 s57, s16, 2
  s_add_u32 s57, s57, s17
  v_lshrrev_b32 v24, 1, v7
  v_xor_b32 v24, v24, v6
  v_lshlrev_b32 v24, 4, v24
  v_and_b32 v25, 31, v19
  v_lshl_add_u32 v24, v25, 10, v24
  v_xor_b32 v120, 0, v24
  v_xor_b32 v121, 32, v24
  v_xor_b32 v122, 64, v24
  v_xor_b32 v123, 96, v24
  v_xor_b32 v124, 128, v24
  v_xor_b32 v125, 160, v24
  v_xor_b32 v126, 192, v24
  v_xor_b32 v127, 224, v24
  v_and_b32 v24, 1, v7
  v_lshlrev_b32 v24, 10, v24
  v_lshl_add_u32 v24, v6, 4, v24
  v_lshrrev_b32 v25, 1, v7
  v_lshl_add_u32 v8, v25, 8, v24
  s_and_b32 s26, s17, 1
  s_lshl_b32 s26, s26, 7
  v_xor_b32 v24, s26, v0
  v_xor_b32 v12, 0, v24
  v_xor_b32 v13, 16, v24
  v_xor_b32 v14, 32, v24
  v_xor_b32 v15, 48, v24
  v_xor_b32 v16, 64, v24
  v_xor_b32 v17, 80, v24
  v_xor_b32 v18, 96, v24
  v_xor_b32 v19, 112, v24
  s_lshl_b32 s26, s17, 2
  s_add_u32 s26, s26, 162816
  v_lshrrev_b32 v24, 7, v0
  v_lshl_add_u32 v118, v24, 4, s26
  v_and_b32 v24, 48, v0
  v_add_u32 v119, 162816, v24
  v_lshrrev_b32 v25, 8, v0
  v_and_b32 v20, 0xf0, v0
  v_lshlrev_b32 v21, 6, v25
  v_xor_b32 v20, v20, v21
  v_lshl_add_u32 v20, v25, 13, v20
  v_xor_b32 v21, 32, v20
  s_load_dwordx2 s[64:65], s[0:1], 24
  s_load_dwordx2 s[68:69], s[0:1], 32
  s_load_dwordx2 s[8:9], s[0:1], 16
  s_mov_b32 s10, 4194304
  s_mov_b32 s11, 0x20000
  s_mov_b32 s66, 4194304
  s_mov_b32 s67, 0x20000
  s_mov_b32 s70, 4194304
  s_mov_b32 s71, 0x20000
  v_lshrrev_b32 v25, 2, v6
  v_lshrrev_b32 v26, 1, v7
  v_lshl_add_u32 v27, v26, 3, v25
  v_lshlrev_b32 v27, 8, v27
  v_lshl_add_u32 v26, v25, 1, v26
  v_and_b32 v25, 1, v7
  v_xor_b32 v26, v26, v25
  s_lshl_b32 s26, s17, 1
  v_xor_b32 v26, s26, v26
  v_lshl_add_u32 v27, v26, 5, v27
  v_and_b32 v25, 3, v6
  v_lshl_add_u32 v22, v25, 3, v27
  v_add_u32 v23, 65536, v22
  v_add_u32 v24, 131072, v22
  s_lshl_b32 s28, s17, 13
  s_lshl_b32 s26, s17, 18
  s_lshl_b32 s27, s16, 8
  s_add_u32 s26, s26, s27
  s_waitcnt lgkmcnt(0)
  s_cmp_eq_u32 s60, 1
  s_cbranch_scc1 q_ld_55
  s_cmp_eq_u32 s60, 2
  s_cbranch_scc1 q_ld_56
q_ld_54:
  s_add_u32 s27, s26, 0
  s_add_u32 m0, s28, 0
  s_nop 0
  buffer_load_dwordx4 v20, s[64:67], s27 offen lds
  s_add_u32 m0, s28, 1024
  s_add_u32 s27, s27, 32768
  buffer_load_dwordx4 v20, s[64:67], s27 offen lds
  s_add_u32 m0, s28, 2048
  s_add_u32 s27, s27, 32768
  buffer_load_dwordx4 v21, s[64:67], s27 offen lds
  s_add_u32 m0, s28, 3072
  s_add_u32 s27, s27, 32768
  buffer_load_dwordx4 v21, s[64:67], s27 offen lds
  s_add_u32 m0, s28, 4096
  s_add_u32 s27, s27, 32768
  buffer_load_dwordx4 v20, s[64:67], s27 offen lds
  s_add_u32 m0, s28, 5120
  s_add_u32 s27, s27, 32768
  buffer_load_dwordx4 v20, s[64:67], s27 offen lds
  s_add_u32 m0, s28, 6144
  s_add_u32 s27, s27, 32768
  buffer_load_dwordx4 v21, s[64:67], s27 offen lds
  s_add_u32 m0, s28, 7168
  s_add_u32 s27, s27, 32768
  buffer_load_dwordx4 v21, s[64:67], s27 offen lds
  s_add_u32 s27, s26, 1048576
  s_add_u32 m0, s28, 32768
  s_nop 0
  buffer_load_dwordx4 v20, s[64:67], s27 offen lds
  s_add_u32 m0, s28, 33792
  s_add_u32 s27, s27, 32768
  buffer_load_dwordx4 v20, s[64:67], s27 offen lds
  s_add_u32 m0, s28, 34816
  s_add_u32 s27, s27, 32768
  buffer_load_dwordx4 v21, s[64:67], s27 offen lds
  s_add_u32 m0, s28, 35840
  s_add_u32 s27, s27, 32768
  buffer_load_dwordx4 v21, s[64:67], s27 offen lds
  s_add_u32 m0, s28, 36864
  s_add_u32 s27, s27, 32768
  buffer_load_dwordx4 v20, s[64:67], s27 offen lds
  s_add_u32 m0, s28, 37888
  s_add_u32 s27, s27, 32768
  buffer_load_dwordx4 v20, s[64:67], s27 offen lds
  s_add_u32 m0, s28, 38912
  s_add_u32 s27, s27, 32768
  buffer_load_dwordx4 v21, s[64:67], s27 offen lds
  s_add_u32 m0, s28, 39936
  s_add_u32 s27, s27, 32768
  buffer_load_dwordx4 v21, s[64:67], s27 offen lds
  s_add_u32 s27, s26, 2097152
  s_add_u32 m0, s28, 65536
  s_nop 0
  buffer_load_dwordx4 v20, s[64:67], s27 offen lds
  s_add_u32 m0, s28, 66560
  s_add_u32 s27, s27, 32768
  buffer_load_dwordx4 v20, s[64:67], s27 offen lds
  s_add_u32 m0, s28, 67584
  s_add_u32 s27, s27, 32768
  buffer_load_dwordx4 v21, s[64:67], s27 offen lds
  s_add_u32 m0, s28, 68608
  s_add_u32 s27, s27, 32768
  buffer_load_dwordx4 v21, s[64:67], s27 offen lds
  s_add_u32 m0, s28, 69632
  s_add_u32 s27, s27, 32768
  buffer_load_dwordx4 v20, s[64:67], s27 offen lds
  s_add_u32 m0, s28, 70656
  s_add_u32 s27, s27, 32768
  buffer_load_dwordx4 v20, s[64:67], s27 offen lds
  s_add_u32 m0, s28, 71680
  s_add_u32 s27, s27, 32768
  buffer_load_dwordx4 v21, s[64:67], s27 offen lds
  s_add_u32 m0, s28, 72704
  s_add_u32 s27, s27, 32768
  buffer_load_dwordx4 v21, s[64:67], s27 offen lds
  s_load_dwordx2 s[4:5], s[0:1], 112
  s_load_dwordx2 s[12:13], s[0:1], 104
  s_waitcnt vmcnt(16)
  s_barrier
  s_add_u32 s27, s26, 3145728
  s_add_u32 m0, s28, 98304
  s_nop 0
  buffer_load_dwordx4 v20, s[64:67], s27 offen lds
  s_add_u32 m0, s28, 99328
  s_add_u32 s27, s27, 32768
  buffer_load_dwordx4 v20, s[64:67], s27 offen lds
  s_add_u32 m0, s28, 100352
  s_add_u32 s27, s27, 32768
  buffer_load_dwordx4 v21, s[64:67], s27 offen lds
  s_add_u32 m0, s28, 101376
  s_add_u32 s27, s27, 32768
  buffer_load_dwordx4 v21, s[64:67], s27 offen lds
  s_add_u32 m0, s28, 102400
  s_add_u32 s27, s27, 32768
  buffer_load_dwordx4 v20, s[64:67], s27 offen lds
  s_add_u32 m0, s28, 103424
  s_add_u32 s27, s27, 32768
  buffer_load_dwordx4 v20, s[64:67], s27 offen lds
  s_add_u32 m0, s28, 104448
  s_add_u32 s27, s27, 32768
  buffer_load_dwordx4 v21, s[64:67], s27 offen lds
  s_add_u32 m0, s28, 105472
  s_add_u32 s27, s27, 32768
  buffer_load_dwordx4 v21, s[64:67], s27 offen lds
  ds_read_b64_tr_b16 v[128:129], v22 offset:0
  ds_read_b64_tr_b16 v[130:131], v22 offset:1024
  ds_read_b64_tr_b16 v[132:133], v22 offset:4096
  ds_read_b64_tr_b16 v[134:135], v22 offset:5120
  ds_read_b64_tr_b16 v[136:137], v22 offset:8192
  ds_read_b64_tr_b16 v[138:139], v22 offset:9216
  ds_read_b64_tr_b16 v[140:141], v22 offset:12288
  ds_read_b64_tr_b16 v[142:143], v22 offset:13312
  ds_read_b64_tr_b16 v[144:145], v22 offset:16384
  ds_read_b64_tr_b16 v[146:147], v22 offset:17408
  ds_read_b64_tr_b16 v[148:149], v22 offset:20480
  ds_read_b64_tr_b16 v[150:151], v22 offset:21504
  ds_read_b64_tr_b16 v[152:153], v22 offset:24576
  ds_read_b64_tr_b16 v[154:155], v22 offset:25600
  ds_read_b64_tr_b16 v[156:157], v22 offset:28672
  ds_read_b64_tr_b16 v[158:159], v22 offset:29696
  s_waitcnt lgkmcnt(0)
  s_waitcnt vmcnt(16)
  s_barrier
  s_add_u32 s27, s26, 0
  s_add_u32 m0, s28, 131072
  s_nop 0
  buffer_load_dwordx4 v20, s[68:71], s27 offen lds
  s_add_u32 m0, s28, 132096
  s_add_u32 s27, s27, 32768
  buffer_load_dwordx4 v20, s[68:71], s27 offen lds
  s_add_u32 m0, s28, 133120
  s_add_u32 s27, s27, 32768
  buffer_load_dwordx4 v21, s[68:71], s27 offen lds
  s_add_u32 m0, s28, 134144
  s_add_u32 s27, s27, 32768
  buffer_load_dwordx4 v21, s[68:71], s27 offen lds
  s_add_u32 m0, s28, 135168
  s_add_u32 s27, s27, 32768
  buffer_load_dwordx4 v20, s[68:71], s27 offen lds
  s_add_u32 m0, s28, 136192
  s_add_u32 s27, s27, 32768
  buffer_load_dwordx4 v20, s[68:71], s27 offen lds
  s_add_u32 m0, s28, 137216
  s_add_u32 s27, s27, 32768
  buffer_load_dwordx4 v21, s[68:71], s27 offen lds
  s_add_u32 m0, s28, 138240
  s_add_u32 s27, s27, 32768
  buffer_load_dwordx4 v21, s[68:71], s27 offen lds
  ds_read_b64_tr_b16 v[160:161], v22 offset:32768
  ds_read_b64_tr_b16 v[162:163], v22 offset:33792
  ds_read_b64_tr_b16 v[164:165], v22 offset:36864
  ds_read_b64_tr_b16 v[166:167], v22 offset:37888
  ds_read_b64_tr_b16 v[168:169], v22 offset:40960
  ds_read_b64_tr_b16 v[170:171], v22 offset:41984
  ds_read_b64_tr_b16 v[172:173], v22 offset:45056
  ds_read_b64_tr_b16 v[174:175], v22 offset:46080
  ds_read_b64_tr_b16 v[176:177], v22 offset:49152
  ds_read_b64_tr_b16 v[178:179], v22 offset:50176
  ds_read_b64_tr_b16 v[180:181], v22 offset:53248
  ds_read_b64_tr_b16 v[182:183], v22 offset:54272
  ds_read_b64_tr_b16 v[184:185], v22 offset:57344
  ds_read_b64_tr_b16 v[186:187], v22 offset:58368
  ds_read_b64_tr_b16 v[188:189], v22 offset:61440
  ds_read_b64_tr_b16 v[190:191], v22 offset:62464
  s_waitcnt lgkmcnt(0)
  s_waitcnt vmcnt(16)
  s_barrier
  s_add_u32 s27, s26, 1048576
  s_add_u32 m0, s28, 0
  s_nop 0
  buffer_load_dwordx4 v20, s[68:71], s27 offen lds
  s_add_u32 m0, s28, 1024
  s_add_u32 s27, s27, 32768
  buffer_load_dwordx4 v20, s[68:71], s27 offen lds
  s_add_u32 m0, s28, 2048
  s_add_u32 s27, s27, 32768
  buffer_load_dwordx4 v21, s[68:71], s27 offen lds
  s_add_u32 m0, s28, 3072
  s_add_u32 s27, s27, 32768
  buffer_load_dwordx4 v21, s[68:71], s27 offen lds
  s_add_u32 m0, s28, 4096
  s_add_u32 s27, s27, 32768
  buffer_load_dwordx4 v20, s[68:71], s27 offen lds
  s_add_u32 m0, s28, 5120
  s_add_u32 s27, s27, 32768
  buffer_load_dwordx4 v20, s[68:71], s27 offen lds
  s_add_u32 m0, s28, 6144
  s_add_u32 s27, s27, 32768
  buffer_load_dwordx4 v21, s[68:71], s27 offen lds
  s_add_u32 m0, s28, 7168
  s_add_u32 s27, s27, 32768
  buffer_load_dwordx4 v21, s[68:71], s27 offen lds
  ds_read_b64_tr_b16 v[192:193], v23 offset:0
  ds_read_b64_tr_b16 v[194:195], v23 offset:1024
  ds_read_b64_tr_b16 v[196:197], v23 offset:4096
  ds_read_b64_tr_b16 v[198:199], v23 offset:5120
  ds_read_b64_tr_b16 v[200:201], v23 offset:8192
  ds_read_b64_tr_b16 v[202:203], v23 offset:9216
  ds_read_b64_tr_b16 v[204:205], v23 offset:12288
  ds_read_b64_tr_b16 v[206:207], v23 offset:13312
  ds_read_b64_tr_b16 v[208:209], v23 offset:16384
  ds_read_b64_tr_b16 v[210:211], v23 offset:17408
  ds_read_b64_tr_b16 v[212:213], v23 offset:20480
  ds_read_b64_tr_b16 v[214:215], v23 offset:21504
  ds_read_b64_tr_b16 v[216:217], v23 offset:24576
  ds_read_b64_tr_b16 v[218:219], v23 offset:25600
  ds_read_b64_tr_b16 v[220:221], v23 offset:28672
  ds_read_b64_tr_b16 v[222:223], v23 offset:29696
  s_waitcnt lgkmcnt(0)
  s_waitcnt vmcnt(16)
  s_barrier
  s_add_u32 s27, s26, 2097152
  s_add_u32 m0, s28, 32768
  s_nop 0
  buffer_load_dwordx4 v20, s[68:71], s27 offen lds
  s_add_u32 m0, s28, 33792
  s_add_u32 s27, s27, 32768
  buffer_load_dwordx4 v20, s[68:71], s27 offen lds
  s_add_u32 m0, s28, 34816
  s_add_u32 s27, s27, 32768
  buffer_load_dwordx4 v21, s[68:71], s27 offen lds
  s_add_u32 m0, s28, 35840
  s_add_u32 s27, s27, 32768
  buffer_load_dwordx4 v21, s[68:71], s27 offen lds
  s_add_u32 m0, s28, 36864
  s_add_u32 s27, s27, 32768
  buffer_load_dwordx4 v20, s[68:71], s27 offen lds
  s_add_u32 m0, s28, 37888
  s_add_u32 s27, s27, 32768
  buffer_load_dwordx4 v20, s[68:71], s27 offen lds
  s_add_u32 m0, s28, 38912
  s_add_u32 s27, s27, 32768
  buffer_load_dwordx4 v21, s[68:71], s27 offen lds
  s_add_u32 m0, s28, 39936
  s_add_u32 s27, s27, 32768
  buffer_load_dwordx4 v21, s[68:71], s27 offen lds
  ds_read_b64_tr_b16 v[224:225], v23 offset:32768
  ds_read_b64_tr_b16 v[226:227], v23 offset:33792
  ds_read_b64_tr_b16 v[228:229], v23 offset:36864
  ds_read_b64_tr_b16 v[230:231], v23 offset:37888
  ds_read_b64_tr_b16 v[232:233], v23 offset:40960
  ds_read_b64_tr_b16 v[234:235], v23 offset:41984
  ds_read_b64_tr_b16 v[236:237], v23 offset:45056
  ds_read_b64_tr_b16 v[238:239], v23 offset:46080
  ds_read_b64_tr_b16 v[240:241], v23 offset:49152
  ds_read_b64_tr_b16 v[242:243], v23 offset:50176
  ds_read_b64_tr_b16 v[244:245], v23 offset:53248
  ds_read_b64_tr_b16 v[246:247], v23 offset:54272
  ds_read_b64_tr_b16 v[248:249], v23 offset:57344
  ds_read_b64_tr_b16 v[250:251], v23 offset:58368
  ds_read_b64_tr_b16 v[252:253], v23 offset:61440
  ds_read_b64_tr_b16 v[254:255], v23 offset:62464
  s_waitcnt lgkmcnt(0)
  s_waitcnt vmcnt(16)
  s_barrier
  s_add_u32 s27, s26, 3145728
  s_add_u32 m0, s28, 65536
  s_nop 0
  buffer_load_dwordx4 v20, s[68:71], s27 offen lds
  s_add_u32 m0, s28, 66560
  s_add_u32 s27, s27, 32768
  buffer_load_dwordx4 v20, s[68:71], s27 offen lds
  s_add_u32 m0, s28, 67584
  s_add_u32 s27, s27, 32768
  buffer_load_dwordx4 v21, s[68:71], s27 offen lds
  s_add_u32 m0, s28, 68608
  s_add_u32 s27, s27, 32768
  buffer_load_dwordx4 v21, s[68:71], s27 offen lds
  s_add_u32 m0, s28, 69632
  s_add_u32 s27, s27, 32768
  buffer_load_dwordx4 v20, s[68:71], s27 offen lds
  s_add_u32 m0, s28, 70656
  s_add_u32 s27, s27, 32768
  buffer_load_dwordx4 v20, s[68:71], s27 offen lds
  s_add_u32 m0, s28, 71680
  s_add_u32 s27, s27, 32768
  buffer_load_dwordx4 v21, s[68:71], s27 offen lds
  s_add_u32 m0, s28, 72704
  s_add_u32 s27, s27, 32768
  buffer_load_dwordx4 v21, s[68:71], s27 offen lds
  ds_read_b64_tr_b16 a[0:1], v24 offset:0
  ds_read_b64_tr_b16 a[2:3], v24 offset:1024
  ds_read_b64_tr_b16 a[4:5], v24 offset:4096
  ds_read_b64_tr_b16 a[6:7], v24 offset:5120
  ds_read_b64_tr_b16 a[8:9], v24 offset:8192
  ds_read_b64_tr_b16 a[10:11], v24 offset:9216
  ds_read_b64_tr_b16 a[12:13], v24 offset:12288
  ds_read_b64_tr_b16 a[14:15], v24 offset:13312
  ds_read_b64_tr_b16 a[16:17], v24 offset:16384
  ds_read_b64_tr_b16 a[18:19], v24 offset:17408
  ds_read_b64_tr_b16 a[20:21], v24 offset:20480
  ds_read_b64_tr_b16 a[22:23], v24 offset:21504
  ds_read_b64_tr_b16 a[24:25], v24 offset:24576
  ds_read_b64_tr_b16 a[26:27], v24 offset:25600
  ds_read_b64_tr_b16 a[28:29], v24 offset:28672
  ds_read_b64_tr_b16 a[30:31], v24 offset:29696
  s_waitcnt lgkmcnt(0)
  s_waitcnt vmcnt(16)
  s_barrier
  s_add_u32 s27, s26, 0
  s_add_u32 m0, s28, 98304
  s_nop 0
  buffer_load_dwordx4 v20, s[8:11], s27 offen lds
  s_add_u32 m0, s28, 99328
  s_add_u32 s27, s27, 32768
  buffer_load_dwordx4 v20, s[8:11], s27 offen lds
  s_add_u32 m0, s28, 100352
  s_add_u32 s27, s27, 32768
  buffer_load_dwordx4 v21, s[8:11], s27 offen lds
  s_add_u32 m0, s28, 101376
  s_add_u32 s27, s27, 32768
  buffer_load_dwordx4 v21, s[8:11], s27 offen lds
  s_add_u32 m0, s28, 102400
  s_add_u32 s27, s27, 32768
  buffer_load_dwordx4 v20, s[8:11], s27 offen lds
  s_add_u32 m0, s28, 103424
  s_add_u32 s27, s27, 32768
  buffer_load_dwordx4 v20, s[8:11], s27 offen lds
  s_add_u32 m0, s28, 104448
  s_add_u32 s27, s27, 32768
  buffer_load_dwordx4 v21, s[8:11], s27 offen lds
  s_add_u32 m0, s28, 105472
  s_add_u32 s27, s27, 32768
  buffer_load_dwordx4 v21, s[8:11], s27 offen lds
  ds_read_b64_tr_b16 a[32:33], v22 offset:0
  ds_read_b64_tr_b16 a[34:35], v22 offset:1024
  ds_read_b64_tr_b16 a[36:37], v22 offset:4096
  ds_read_b64_tr_b16 a[38:39], v22 offset:5120
  ds_read_b64_tr_b16 a[40:41], v22 offset:8192
  ds_read_b64_tr_b16 a[42:43], v22 offset:9216
  ds_read_b64_tr_b16 a[44:45], v22 offset:12288
  ds_read_b64_tr_b16 a[46:47], v22 offset:13312
  ds_read_b64_tr_b16 a[48:49], v22 offset:16384
  ds_read_b64_tr_b16 a[50:51], v22 offset:17408
  ds_read_b64_tr_b16 a[52:53], v22 offset:20480
  ds_read_b64_tr_b16 a[54:55], v22 offset:21504
  ds_read_b64_tr_b16 a[56:57], v22 offset:24576
  ds_read_b64_tr_b16 a[58:59], v22 offset:25600
  ds_read_b64_tr_b16 a[60:61], v22 offset:28672
  ds_read_b64_tr_b16 a[62:63], v22 offset:29696
  s_waitcnt lgkmcnt(0)
  s_waitcnt vmcnt(16)
  s_barrier
  s_add_u32 s27, s26, 1048576
  s_add_u32 m0, s28, 131072
  s_nop 0
  buffer_load_dwordx4 v20, s[8:11], s27 offen lds
  s_add_u32 m0, s28, 132096
  s_add_u32 s27, s27, 32768
  buffer_load_dwordx4 v20, s[8:11], s27 offen lds
  s_add_u32 m0, s28, 133120
  s_add_u32 s27, s27, 32768
  buffer_load_dwordx4 v21, s[8:11], s27 offen lds
  s_add_u32 m0, s28, 134144
  s_add_u32 s27, s27, 32768
  buffer_load_dwordx4 v21, s[8:11], s27 offen lds
  s_add_u32 m0, s28, 135168
  s_add_u32 s27, s27, 32768
  buffer_load_dwordx4 v20, s[8:11], s27 offen lds
  s_add_u32 m0, s28, 136192
  s_add_u32 s27, s27, 32768
  buffer_load_dwordx4 v20, s[8:11], s27 offen lds
  s_add_u32 m0, s28, 137216
  s_add_u32 s27, s27, 32768
  buffer_load_dwordx4 v21, s[8:11], s27 offen lds
  s_add_u32 m0, s28, 138240
  s_add_u32 s27, s27, 32768
  buffer_load_dwordx4 v21, s[8:11], s27 offen lds
  ds_read_b64_tr_b16 a[64:65], v22 offset:32768
  ds_read_b64_tr_b16 a[66:67], v22 offset:33792
  ds_read_b64_tr_b16 a[68:69], v22 offset:36864
  ds_read_b64_tr_b16 a[70:71], v22 offset:37888
  ds_read_b64_tr_b16 a[72:73], v22 offset:40960
  ds_read_b64_tr_b16 a[74:75], v22 offset:41984
  ds_read_b64_tr_b16 a[76:77], v22 offset:45056
  ds_read_b64_tr_b16 a[78:79], v22 offset:46080
  ds_read_b64_tr_b16 a[80:81], v22 offset:49152
  ds_read_b64_tr_b16 a[82:83], v22 offset:50176
  ds_read_b64_tr_b16 a[84:85], v22 offset:53248
  ds_read_b64_tr_b16 a[86:87], v22 offset:54272
  ds_read_b64_tr_b16 a[88:89], v22 offset:57344
  ds_read_b64_tr_b16 a[90:91], v22 offset:58368
  ds_read_b64_tr_b16 a[92:93], v22 offset:61440
  ds_read_b64_tr_b16 a[94:95], v22 offset:62464
  s_waitcnt lgkmcnt(0)
  s_waitcnt vmcnt(16)
  s_barrier
  s_add_u32 s27, s26, 2097152
  s_add_u32 m0, s28, 0
  s_nop 0
  buffer_load_dwordx4 v20, s[8:11], s27 offen lds
  s_add_u32 m0, s28, 1024
  s_add_u32 s27, s27, 32768
  buffer_load_dwordx4 v20, s[8:11], s27 offen lds
  s_add_u32 m0, s28, 2048
  s_add_u32 s27, s27, 32768
  buffer_load_dwordx4 v21, s[8:11], s27 offen lds
  s_add_u32 m0, s28, 3072
  s_add_u32 s27, s27, 32768
  buffer_load_dwordx4 v21, s[8:11], s27 offen lds
  s_add_u32 m0, s28, 4096
  s_add_u32 s27, s27, 32768
  buffer_load_dwordx4 v20, s[8:11], s27 offen lds
  s_add_u32 m0, s28, 5120
  s_add_u32 s27, s27, 32768
  buffer_load_dwordx4 v20, s[8:11], s27 offen lds
  s_add_u32 m0, s28, 6144
  s_add_u32 s27, s27, 32768
  buffer_load_dwordx4 v21, s[8:11], s27 offen lds
  s_add_u32 m0, s28, 7168
  s_add_u32 s27, s27, 32768
  buffer_load_dwordx4 v21, s[8:11], s27 offen lds
  ds_read_b64_tr_b16 a[96:97], v23 offset:0
  ds_read_b64_tr_b16 a[98:99], v23 offset:1024
  ds_read_b64_tr_b16 a[100:101], v23 offset:4096
  ds_read_b64_tr_b16 a[102:103], v23 offset:5120
  ds_read_b64_tr_b16 a[104:105], v23 offset:8192
  ds_read_b64_tr_b16 a[106:107], v23 offset:9216
  ds_read_b64_tr_b16 a[108:109], v23 offset:12288
  ds_read_b64_tr_b16 a[110:111], v23 offset:13312
  ds_read_b64_tr_b16 a[112:113], v23 offset:16384
  ds_read_b64_tr_b16 a[114:115], v23 offset:17408
  ds_read_b64_tr_b16 a[116:117], v23 offset:20480
  ds_read_b64_tr_b16 a[118:119], v23 offset:21504
  ds_read_b64_tr_b16 a[120:121], v23 offset:24576
  ds_read_b64_tr_b16 a[122:123], v23 offset:25600
  ds_read_b64_tr_b16 a[124:125], v23 offset:28672
  ds_read_b64_tr_b16 a[126:127], v23 offset:29696
  s_waitcnt lgkmcnt(0)
  s_waitcnt vmcnt(16)
  s_barrier
  s_add_u32 s27, s26, 3145728
  s_add_u32 m0, s28, 32768
  s_nop 0
  buffer_load_dwordx4 v20, s[8:11], s27 offen lds
  s_add_u32 m0, s28, 33792
  s_add_u32 s27, s27, 32768
  buffer_load_dwordx4 v20, s[8:11], s27 offen lds
  s_add_u32 m0, s28, 34816
  s_add_u32 s27, s27, 32768
  buffer_load_dwordx4 v21, s[8:11], s27 offen lds
  s_add_u32 m0, s28, 35840
  s_add_u32 s27, s27, 32768
  buffer_load_dwordx4 v21, s[8:11], s27 offen lds
  s_add_u32 m0, s28, 36864
  s_add_u32 s27, s27, 32768
  buffer_load_dwordx4 v20, s[8:11], s27 offen lds
  s_add_u32 m0, s28, 37888
  s_add_u32 s27, s27, 32768
  buffer_load_dwordx4 v20, s[8:11], s27 offen lds
  s_add_u32 m0, s28, 38912
  s_add_u32 s27, s27, 32768
  buffer_load_dwordx4 v21, s[8:11], s27 offen lds
  s_add_u32 m0, s28, 39936
  s_add_u32 s27, s27, 32768
  buffer_load_dwordx4 v21, s[8:11], s27 offen lds
  ds_read_b64_tr_b16 a[128:129], v23 offset:32768
  ds_read_b64_tr_b16 a[130:131], v23 offset:33792
  ds_read_b64_tr_b16 a[132:133], v23 offset:36864
  ds_read_b64_tr_b16 a[134:135], v23 offset:37888
  ds_read_b64_tr_b16 a[136:137], v23 offset:40960
  ds_read_b64_tr_b16 a[138:139], v23 offset:41984
  ds_read_b64_tr_b16 a[140:141], v23 offset:45056
  ds_read_b64_tr_b16 a[142:143], v23 offset:46080
  ds_read_b64_tr_b16 a[144:145], v23 offset:49152
  ds_read_b64_tr_b16 a[146:147], v23 offset:50176
  ds_read_b64_tr_b16 a[148:149], v23 offset:53248
  ds_read_b64_tr_b16 a[150:151], v23 offset:54272
  ds_read_b64_tr_b16 a[152:153], v23 offset:57344
  ds_read_b64_tr_b16 a[154:155], v23 offset:58368
  ds_read_b64_tr_b16 a[156:157], v23 offset:61440
  ds_read_b64_tr_b16 a[158:159], v23 offset:62464
  s_waitcnt lgkmcnt(0)
  s_waitcnt vmcnt(16)
  s_barrier
  ds_read_b64_tr_b16 a[160:161], v24 offset:0
  ds_read_b64_tr_b16 a[162:163], v24 offset:1024
  ds_read_b64_tr_b16 a[164:165], v24 offset:4096
  ds_read_b64_tr_b16 a[166:167], v24 offset:5120
  ds_read_b64_tr_b16 a[168:169], v24 offset:8192
  ds_read_b64_tr_b16 a[170:171], v24 offset:9216
  ds_read_b64_tr_b16 a[172:173], v24 offset:12288
  ds_read_b64_tr_b16 a[174:175], v24 offset:13312
  ds_read_b64_tr_b16 a[176:177], v24 offset:16384
  ds_read_b64_tr_b16 a[178:179], v24 offset:17408
  ds_read_b64_tr_b16 a[180:181], v24 offset:20480
  ds_read_b64_tr_b16 a[182:183], v24 offset:21504
  ds_read_b64_tr_b16 a[184:185], v24 offset:24576
  ds_read_b64_tr_b16 a[186:187], v24 offset:25600
  ds_read_b64_tr_b16 a[188:189], v24 offset:28672
  ds_read_b64_tr_b16 a[190:191], v24 offset:29696
  s_waitcnt lgkmcnt(0)
  s_waitcnt vmcnt(8)
  s_barrier
  ds_read_b64_tr_b16 a[192:193], v22 offset:0
  ds_read_b64_tr_b16 a[194:195], v22 offset:1024
  ds_read_b64_tr_b16 a[196:197], v22 offset:4096
  ds_read_b64_tr_b16 a[198:199], v22 offset:5120
  ds_read_b64_tr_b16 a[200:201], v22 offset:8192
  ds_read_b64_tr_b16 a[202:203], v22 offset:9216
  ds_read_b64_tr_b16 a[204:205], v22 offset:12288
  ds_read_b64_tr_b16 a[206:207], v22 offset:13312
  ds_read_b64_tr_b16 a[208:209], v22 offset:16384
  ds_read_b64_tr_b16 a[210:211], v22 offset:17408
  ds_read_b64_tr_b16 a[212:213], v22 offset:20480
  ds_read_b64_tr_b16 a[214:215], v22 offset:21504
  ds_read_b64_tr_b16 a[216:217], v22 offset:24576
  ds_read_b64_tr_b16 a[218:219], v22 offset:25600
  ds_read_b64_tr_b16 a[220:221], v22 offset:28672
  ds_read_b64_tr_b16 a[222:223], v22 offset:29696
  s_waitcnt lgkmcnt(0)
  s_waitcnt vmcnt(0)
  s_barrier
  ds_read_b64_tr_b16 a[224:225], v22 offset:32768
  ds_read_b64_tr_b16 a[226:227], v22 offset:33792
  ds_read_b64_tr_b16 a[228:229], v22 offset:36864
  ds_read_b64_tr_b16 a[230:231], v22 offset:37888
  ds_read_b64_tr_b16 a[232:233], v22 offset:40960
  ds_read_b64_tr_b16 a[234:235], v22 offset:41984
  ds_read_b64_tr_b16 a[236:237], v22 offset:45056
  ds_read_b64_tr_b16 a[238:239], v22 offset:46080
  ds_read_b64_tr_b16 a[240:241], v22 offset:49152
  ds_read_b64_tr_b16 a[242:243], v22 offset:50176
  ds_read_b64_tr_b16 a[244:245], v22 offset:53248
  ds_read_b64_tr_b16 a[246:247], v22 offset:54272
  ds_read_b64_tr_b16 a[248:249], v22 offset:57344
  ds_read_b64_tr_b16 a[250:251], v22 offset:58368
  ds_read_b64_tr_b16 a[252:253], v22 offset:61440
  ds_read_b64_tr_b16 a[254:255], v22 offset:62464
  s_waitcnt lgkmcnt(0)
  s_branch q_ld_57
q_ld_55:
  s_add_u32 s27, s26, 0
  s_add_u32 m0, s28, 0
  s_nop 0
  buffer_load_dwordx4 v20, s[68:71], s27 offen lds
  s_add_u32 m0, s28, 1024
  s_add_u32 s27, s27, 32768
  buffer_load_dwordx4 v20, s[68:71], s27 offen lds
  s_add_u32 m0, s28, 2048
  s_add_u32 s27, s27, 32768
  buffer_load_dwordx4 v21, s[68:71], s27 offen lds
  s_add_u32 m0, s28, 3072
  s_add_u32 s27, s27, 32768
  buffer_load_dwordx4 v21, s[68:71], s27 offen lds
  s_add_u32 m0, s28, 4096
  s_add_u32 s27, s27, 32768
  buffer_load_dwordx4 v20, s[68:71], s27 offen lds
  s_add_u32 m0, s28, 5120
  s_add_u32 s27, s27, 32768
  buffer_load_dwordx4 v20, s[68:71], s27 offen lds
  s_add_u32 m0, s28, 6144
  s_add_u32 s27, s27, 32768
  buffer_load_dwordx4 v21, s[68:71], s27 offen lds
  s_add_u32 m0, s28, 7168
  s_add_u32 s27, s27, 32768
  buffer_load_dwordx4 v21, s[68:71], s27 offen lds
  s_add_u32 s27, s26, 1048576
  s_add_u32 m0, s28, 32768
  s_nop 0
  buffer_load_dwordx4 v20, s[68:71], s27 offen lds
  s_add_u32 m0, s28, 33792
  s_add_u32 s27, s27, 32768
  buffer_load_dwordx4 v20, s[68:71], s27 offen lds
  s_add_u32 m0, s28, 34816
  s_add_u32 s27, s27, 32768
  buffer_load_dwordx4 v21, s[68:71], s27 offen lds
  s_add_u32 m0, s28, 35840
  s_add_u32 s27, s27, 32768
  buffer_load_dwordx4 v21, s[68:71], s27 offen lds
  s_add_u32 m0, s28, 36864
  s_add_u32 s27, s27, 32768
  buffer_load_dwordx4 v20, s[68:71], s27 offen lds
  s_add_u32 m0, s28, 37888
  s_add_u32 s27, s27, 32768
  buffer_load_dwordx4 v20, s[68:71], s27 offen lds
  s_add_u32 m0, s28, 38912
  s_add_u32 s27, s27, 32768
  buffer_load_dwordx4 v21, s[68:71], s27 offen lds
  s_add_u32 m0, s28, 39936
  s_add_u32 s27, s27, 32768
  buffer_load_dwordx4 v21, s[68:71], s27 offen lds
  s_add_u32 s27, s26, 2097152
  s_add_u32 m0, s28, 65536
  s_nop 0
  buffer_load_dwordx4 v20, s[68:71], s27 offen lds
  s_add_u32 m0, s28, 66560
  s_add_u32 s27, s27, 32768
  buffer_load_dwordx4 v20, s[68:71], s27 offen lds
  s_add_u32 m0, s28, 67584
  s_add_u32 s27, s27, 32768
  buffer_load_dwordx4 v21, s[68:71], s27 offen lds
  s_add_u32 m0, s28, 68608
  s_add_u32 s27, s27, 32768
  buffer_load_dwordx4 v21, s[68:71], s27 offen lds
  s_add_u32 m0, s28, 69632
  s_add_u32 s27, s27, 32768
  buffer_load_dwordx4 v20, s[68:71], s27 offen lds
  s_add_u32 m0, s28, 70656
  s_add_u32 s27, s27, 32768
  buffer_load_dwordx4 v20, s[68:71], s27 offen lds
  s_add_u32 m0, s28, 71680
  s_add_u32 s27, s27, 32768
  buffer_load_dwordx4 v21, s[68:71], s27 offen lds
  s_add_u32 m0, s28, 72704
  s_add_u32 s27, s27, 32768
  buffer_load_dwordx4 v21, s[68:71], s27 offen lds
  s_load_dwordx2 s[4:5], s[0:1], 112
  s_load_dwordx2 s[12:13], s[0:1], 104
  s_waitcnt vmcnt(16)
  s_barrier
  s_add_u32 s27, s26, 3145728
  s_add_u32 m0, s28, 98304
  s_nop 0
  buffer_load_dwordx4 v20, s[68:71], s27 offen lds
  s_add_u32 m0, s28, 99328
  s_add_u32 s27, s27, 32768
  buffer_load_dwordx4 v20, s[68:71], s27 offen lds
  s_add_u32 m0, s28, 100352
  s_add_u32 s27, s27, 32768
  buffer_load_dwordx4 v21, s[68:71], s27 offen lds
  s_add_u32 m0, s28, 101376
  s_add_u32 s27, s27, 32768
  buffer_load_dwordx4 v21, s[68:71], s27 offen lds
  s_add_u32 m0, s28, 102400
  s_add_u32 s27, s27, 32768
  buffer_load_dwordx4 v20, s[68:71], s27 offen lds
  s_add_u32 m0, s28, 103424
  s_add_u32 s27, s27, 32768
  buffer_load_dwordx4 v20, s[68:71], s27 offen lds
  s_add_u32 m0, s28, 104448
  s_add_u32 s27, s27, 32768
  buffer_load_dwordx4 v21, s[68:71], s27 offen lds
  s_add_u32 m0, s28, 105472
  s_add_u32 s27, s27, 32768
  buffer_load_dwordx4 v21, s[68:71], s27 offen lds
  ds_read_b64_tr_b16 a[0:1], v22 offset:0
  ds_read_b64_tr_b16 a[2:3], v22 offset:1024
  ds_read_b64_tr_b16 a[4:5], v22 offset:4096
  ds_read_b64_tr_b16 a[6:7], v22 offset:5120
  ds_read_b64_tr_b16 a[8:9], v22 offset:8192
  ds_read_b64_tr_b16 a[10:11], v22 offset:9216
  ds_read_b64_tr_b16 a[12:13], v22 offset:12288
  ds_read_b64_tr_b16 a[14:15], v22 offset:13312
  ds_read_b64_tr_b16 a[16:17], v22 offset:16384
  ds_read_b64_tr_b16 a[18:19], v22 offset:17408
  ds_read_b64_tr_b16 a[20:21], v22 offset:20480
  ds_read_b64_tr_b16 a[22:23], v22 offset:21504
  ds_read_b64_tr_b16 a[24:25], v22 offset:24576
  ds_read_b64_tr_b16 a[26:27], v22 offset:25600
  ds_read_b64_tr_b16 a[28:29], v22 offset:28672
  ds_read_b64_tr_b16 a[30:31], v22 offset:29696
  s_waitcnt lgkmcnt(0)
  s_waitcnt vmcnt(16)
  s_barrier
  s_add_u32 s27, s26, 0
  s_add_u32 m0, s28, 131072
  s_nop 0
  buffer_load_dwordx4 v20, s[8:11], s27 offen lds
  s_add_u32 m0, s28, 132096
  s_add_u32 s27, s27, 32768
  buffer_load_dwordx4 v20, s[8:11], s27 offen lds
  s_add_u32 m0, s28, 133120
  s_add_u32 s27, s27, 32768
  buffer_load_dwordx4 v21, s[8:11], s27 offen lds
  s_add_u32 m0, s28, 134144
  s_add_u32 s27, s27, 32768
  buffer_load_dwordx4 v21, s[8:11], s27 offen lds
  s_add_u32 m0, s28, 135168
  s_add_u32 s27, s27, 32768
  buffer_load_dwordx4 v20, s[8:11], s27 offen lds
  s_add_u32 m0, s28, 136192
  s_add_u32 s27, s27, 32768
  buffer_load_dwordx4 v20, s[8:11], s27 offen lds
  s_add_u32 m0, s28, 137216
  s_add_u32 s27, s27, 32768
  buffer_load_dwordx4 v21, s[8:11], s27 offen lds
  s_add_u32 m0, s28, 138240
  s_add_u32 s27, s27, 32768
  buffer_load_dwordx4 v21, s[8:11], s27 offen lds
  ds_read_b64_tr_b16 a[32:33], v22 offset:32768
  ds_read_b64_tr_b16 a[34:35], v22 offset:33792
  ds_read_b64_tr_b16 a[36:37], v22 offset:36864
  ds_read_b64_tr_b16 a[38:39], v22 offset:37888
  ds_read_b64_tr_b16 a[40:41], v22 offset:40960
  ds_read_b64_tr_b16 a[42:43], v22 offset:41984
  ds_read_b64_tr_b16 a[44:45], v22 offset:45056
  ds_read_b64_tr_b16 a[46:47], v22 offset:46080
  ds_read_b64_tr_b16 a[48:49], v22 offset:49152
  ds_read_b64_tr_b16 a[50:51], v22 offset:50176
  ds_read_b64_tr_b16 a[52:53], v22 offset:53248
  ds_read_b64_tr_b16 a[54:55], v22 offset:54272
  ds_read_b64_tr_b16 a[56:57], v22 offset:57344
  ds_read_b64_tr_b16 a[58:59], v22 offset:58368
  ds_read_b64_tr_b16 a[60:61], v22 offset:61440
  ds_read_b64_tr_b16 a[62:63], v22 offset:62464
  s_waitcnt lgkmcnt(0)
  s_waitcnt vmcnt(16)
  s_barrier
  s_add_u32 s27, s26, 1048576
  s_add_u32 m0, s28, 0
  s_nop 0
  buffer_load_dwordx4 v20, s[8:11], s27 offen lds
  s_add_u32 m0, s28, 1024
  s_add_u32 s27, s27, 32768
  buffer_load_dwordx4 v20, s[8:11], s27 offen lds
  s_add_u32 m0, s28, 2048
  s_add_u32 s27, s27, 32768
  buffer_load_dwordx4 v21, s[8:11], s27 offen lds
  s_add_u32 m0, s28, 3072
  s_add_u32 s27, s27, 32768
  buffer_load_dwordx4 v21, s[8:11], s27 offen lds
  s_add_u32 m0, s28, 4096
  s_add_u32 s27, s27, 32768
  buffer_load_dwordx4 v20, s[8:11], s27 offen lds
  s_add_u32 m0, s28, 5120
  s_add_u32 s27, s27, 32768
  buffer_load_dwordx4 v20, s[8:11], s27 offen lds
  s_add_u32 m0, s28, 6144
  s_add_u32 s27, s27, 32768
  buffer_load_dwordx4 v21, s[8:11], s27 offen lds
  s_add_u32 m0, s28, 7168
  s_add_u32 s27, s27, 32768
  buffer_load_dwordx4 v21, s[8:11], s27 offen lds
  ds_read_b64_tr_b16 a[64:65], v23 offset:0
  ds_read_b64_tr_b16 a[66:67], v23 offset:1024
  ds_read_b64_tr_b16 a[68:69], v23 offset:4096
  ds_read_b64_tr_b16 a[70:71], v23 offset:5120
  ds_read_b64_tr_b16 a[72:73], v23 offset:8192
  ds_read_b64_tr_b16 a[74:75], v23 offset:9216
  ds_read_b64_tr_b16 a[76:77], v23 offset:12288
  ds_read_b64_tr_b16 a[78:79], v23 offset:13312
  ds_read_b64_tr_b16 a[80:81], v23 offset:16384
  ds_read_b64_tr_b16 a[82:83], v23 offset:17408
  ds_read_b64_tr_b16 a[84:85], v23 offset:20480
  ds_read_b64_tr_b16 a[86:87], v23 offset:21504
  ds_read_b64_tr_b16 a[88:89], v23 offset:24576
  ds_read_b64_tr_b16 a[90:91], v23 offset:25600
  ds_read_b64_tr_b16 a[92:93], v23 offset:28672
  ds_read_b64_tr_b16 a[94:95], v23 offset:29696
  s_waitcnt lgkmcnt(0)
  s_waitcnt vmcnt(16)
  s_barrier
  s_add_u32 s27, s26, 2097152
  s_add_u32 m0, s28, 32768
  s_nop 0
  buffer_load_dwordx4 v20, s[8:11], s27 offen lds
  s_add_u32 m0, s28, 33792
  s_add_u32 s27, s27, 32768
  buffer_load_dwordx4 v20, s[8:11], s27 offen lds
  s_add_u32 m0, s28, 34816
  s_add_u32 s27, s27, 32768
  buffer_load_dwordx4 v21, s[8:11], s27 offen lds
  s_add_u32 m0, s28, 35840
  s_add_u32 s27, s27, 32768
  buffer_load_dwordx4 v21, s[8:11], s27 offen lds
  s_add_u32 m0, s28, 36864
  s_add_u32 s27, s27, 32768
  buffer_load_dwordx4 v20, s[8:11], s27 offen lds
  s_add_u32 m0, s28, 37888
  s_add_u32 s27, s27, 32768
  buffer_load_dwordx4 v20, s[8:11], s27 offen lds
  s_add_u32 m0, s28, 38912
  s_add_u32 s27, s27, 32768
  buffer_load_dwordx4 v21, s[8:11], s27 offen lds
  s_add_u32 m0, s28, 39936
  s_add_u32 s27, s27, 32768
  buffer_load_dwordx4 v21, s[8:11], s27 offen lds
  ds_read_b64_tr_b16 a[96:97], v23 offset:32768
  ds_read_b64_tr_b16 a[98:99], v23 offset:33792
  ds_read_b64_tr_b16 a[100:101], v23 offset:36864
  ds_read_b64_tr_b16 a[102:103], v23 offset:37888
  ds_read_b64_tr_b16 a[104:105], v23 offset:40960
  ds_read_b64_tr_b16 a[106:107], v23 offset:41984
  ds_read_b64_tr_b16 a[108:109], v23 offset:45056
  ds_read_b64_tr_b16 a[110:111], v23 offset:46080
  ds_read_b64_tr_b16 a[112:113], v23 offset:49152
  ds_read_b64_tr_b16 a[114:115], v23 offset:50176
  ds_read_b64_tr_b16 a[116:117], v23 offset:53248
  ds_read_b64_tr_b16 a[118:119], v23 offset:54272
  ds_read_b64_tr_b16 a[120:121], v23 offset:57344
  ds_read_b64_tr_b16 a[122:123], v23 offset:58368
  ds_read_b64_tr_b16 a[124:125], v23 offset:61440
  ds_read_b64_tr_b16 a[126:127], v23 offset:62464
  s_waitcnt lgkmcnt(0)
  s_waitcnt vmcnt(16)
  s_barrier
  s_add_u32 s27, s26, 3145728
  s_add_u32 m0, s28, 65536
  s_nop 0
  buffer_load_dwordx4 v20, s[8:11], s27 offen lds
  s_add_u32 m0, s28, 66560
  s_add_u32 s27, s27, 32768
  buffer_load_dwordx4 v20, s[8:11], s27 offen lds
  s_add_u32 m0, s28, 67584
  s_add_u32 s27, s27, 32768
  buffer_load_dwordx4 v21, s[8:11], s27 offen lds
  s_add_u32 m0, s28, 68608
  s_add_u32 s27, s27, 32768
  buffer_load_dwordx4 v21, s[8:11], s27 offen lds
  s_add_u32 m0, s28, 69632
  s_add_u32 s27, s27, 32768
  buffer_load_dwordx4 v20, s[8:11], s27 offen lds
  s_add_u32 m0, s28, 70656
  s_add_u32 s27, s27, 32768
  buffer_load_dwordx4 v20, s[8:11], s27 offen lds
  s_add_u32 m0, s28, 71680
  s_add_u32 s27, s27, 32768
  buffer_load_dwordx4 v21, s[8:11], s27 offen lds
  s_add_u32 m0, s28, 72704
  s_add_u32 s27, s27, 32768
  buffer_load_dwordx4 v21, s[8:11], s27 offen lds
  ds_read_b64_tr_b16 a[128:129], v24 offset:0
  ds_read_b64_tr_b16 a[130:131], v24 offset:1024
  ds_read_b64_tr_b16 a[132:133], v24 offset:4096
  ds_read_b64_tr_b16 a[134:135], v24 offset:5120
  ds_read_b64_tr_b16 a[136:137], v24 offset:8192
  ds_read_b64_tr_b16 a[138:139], v24 offset:9216
  ds_read_b64_tr_b16 a[140:141], v24 offset:12288
  ds_read_b64_tr_b16 a[142:143], v24 offset:13312
  ds_read_b64_tr_b16 a[144:145], v24 offset:16384
  ds_read_b64_tr_b16 a[146:147], v24 offset:17408
  ds_read_b64_tr_b16 a[148:149], v24 offset:20480
  ds_read_b64_tr_b16 a[150:151], v24 offset:21504
  ds_read_b64_tr_b16 a[152:153], v24 offset:24576
  ds_read_b64_tr_b16 a[154:155], v24 offset:25600
  ds_read_b64_tr_b16 a[156:157], v24 offset:28672
  ds_read_b64_tr_b16 a[158:159], v24 offset:29696
  s_waitcnt lgkmcnt(0)
  s_waitcnt vmcnt(16)
  s_barrier
  s_add_u32 s27, s26, 0
  s_add_u32 m0, s28, 98304
  s_nop 0
  buffer_load_dwordx4 v20, s[64:67], s27 offen lds
  s_add_u32 m0, s28, 99328
  s_add_u32 s27, s27, 32768
  buffer_load_dwordx4 v20, s[64:67], s27 offen lds
  s_add_u32 m0, s28, 100352
  s_add_u32 s27, s27, 32768
  buffer_load_dwordx4 v21, s[64:67], s27 offen lds
  s_add_u32 m0, s28, 101376
  s_add_u32 s27, s27, 32768
  buffer_load_dwordx4 v21, s[64:67], s27 offen lds
  s_add_u32 m0, s28, 102400
  s_add_u32 s27, s27, 32768
  buffer_load_dwordx4 v20, s[64:67], s27 offen lds
  s_add_u32 m0, s28, 103424
  s_add_u32 s27, s27, 32768
  buffer_load_dwordx4 v20, s[64:67], s27 offen lds
  s_add_u32 m0, s28, 104448
  s_add_u32 s27, s27, 32768
  buffer_load_dwordx4 v21, s[64:67], s27 offen lds
  s_add_u32 m0, s28, 105472
  s_add_u32 s27, s27, 32768
  buffer_load_dwordx4 v21, s[64:67], s27 offen lds
  ds_read_b64_tr_b16 a[160:161], v22 offset:0
  ds_read_b64_tr_b16 a[162:163], v22 offset:1024
  ds_read_b64_tr_b16 a[164:165], v22 offset:4096
  ds_read_b64_tr_b16 a[166:167], v22 offset:5120
  ds_read_b64_tr_b16 a[168:169], v22 offset:8192
  ds_read_b64_tr_b16 a[170:171], v22 offset:9216
  ds_read_b64_tr_b16 a[172:173], v22 offset:12288
  ds_read_b64_tr_b16 a[174:175], v22 offset:13312
  ds_read_b64_tr_b16 a[176:177], v22 offset:16384
  ds_read_b64_tr_b16 a[178:179], v22 offset:17408
  ds_read_b64_tr_b16 a[180:181], v22 offset:20480
  ds_read_b64_tr_b16 a[182:183], v22 offset:21504
  ds_read_b64_tr_b16 a[184:185], v22 offset:24576
  ds_read_b64_tr_b16 a[186:187], v22 offset:25600
  ds_read_b64_tr_b16 a[188:189], v22 offset:28672
  ds_read_b64_tr_b16 a[190:191], v22 offset:29696
  s_waitcnt lgkmcnt(0)
  s_waitcnt vmcnt(16)
  s_barrier
  s_add_u32 s27, s26, 1048576
  s_add_u32 m0, s28, 131072
  s_nop 0
  buffer_load_dwordx4 v20, s[64:67], s27 offen lds
  s_add_u32 m0, s28, 132096
  s_add_u32 s27, s27, 32768
  buffer_load_dwordx4 v20, s[64:67], s27 offen lds
  s_add_u32 m0, s28, 133120
  s_add_u32 s27, s27, 32768
  buffer_load_dwordx4 v21, s[64:67], s27 offen lds
  s_add_u32 m0, s28, 134144
  s_add_u32 s27, s27, 32768
  buffer_load_dwordx4 v21, s[64:67], s27 offen lds
  s_add_u32 m0, s28, 135168
  s_add_u32 s27, s27, 32768
  buffer_load_dwordx4 v20, s[64:67], s27 offen lds
  s_add_u32 m0, s28, 136192
  s_add_u32 s27, s27, 32768
  buffer_load_dwordx4 v20, s[64:67], s27 offen lds
  s_add_u32 m0, s28, 137216
  s_add_u32 s27, s27, 32768
  buffer_load_dwordx4 v21, s[64:67], s27 offen lds
  s_add_u32 m0, s28, 138240
  s_add_u32 s27, s27, 32768
  buffer_load_dwordx4 v21, s[64:67], s27 offen lds
  ds_read_b64_tr_b16 a[192:193], v22 offset:32768
  ds_read_b64_tr_b16 a[194:195], v22 offset:33792
  ds_read_b64_tr_b16 a[196:197], v22 offset:36864
  ds_read_b64_tr_b16 a[198:199], v22 offset:37888
  ds_read_b64_tr_b16 a[200:201], v22 offset:40960
  ds_read_b64_tr_b16 a[202:203], v22 offset:41984
  ds_read_b64_tr_b16 a[204:205], v22 offset:45056
  ds_read_b64_tr_b16 a[206:207], v22 offset:46080
  ds_read_b64_tr_b16 a[208:209], v22 offset:49152
  ds_read_b64_tr_b16 a[210:211], v22 offset:50176
  ds_read_b64_tr_b16 a[212:213], v22 offset:53248
  ds_read_b64_tr_b16 a[214:215], v22 offset:54272
  ds_read_b64_tr_b16 a[216:217], v22 offset:57344
  ds_read_b64_tr_b16 a[218:219], v22 offset:58368
  ds_read_b64_tr_b16 a[220:221], v22 offset:61440
  ds_read_b64_tr_b16 a[222:223], v22 offset:62464
  s_waitcnt lgkmcnt(0)
  s_waitcnt vmcnt(16)
  s_barrier
  s_add_u32 s27, s26, 2097152
  s_add_u32 m0, s28, 0
  s_nop 0
  buffer_load_dwordx4 v20, s[64:67], s27 offen lds
  s_add_u32 m0, s28, 1024
  s_add_u32 s27, s27, 32768
  buffer_load_dwordx4 v20, s[64:67], s27 offen lds
  s_add_u32 m0, s28, 2048
  s_add_u32 s27, s27, 32768
  buffer_load_dwordx4 v21, s[64:67], s27 offen lds
  s_add_u32 m0, s28, 3072
  s_add_u32 s27, s27, 32768
  buffer_load_dwordx4 v21, s[64:67], s27 offen lds
  s_add_u32 m0, s28, 4096
  s_add_u32 s27, s27, 32768
  buffer_load_dwordx4 v20, s[64:67], s27 offen lds
  s_add_u32 m0, s28, 5120
  s_add_u32 s27, s27, 32768
  buffer_load_dwordx4 v20, s[64:67], s27 offen lds
  s_add_u32 m0, s28, 6144
  s_add_u32 s27, s27, 32768
  buffer_load_dwordx4 v21, s[64:67], s27 offen lds
  s_add_u32 m0, s28, 7168
  s_add_u32 s27, s27, 32768
  buffer_load_dwordx4 v21, s[64:67], s27 offen lds
  ds_read_b64_tr_b16 a[224:225], v23 offset:0
  ds_read_b64_tr_b16 a[226:227], v23 offset:1024
  ds_read_b64_tr_b16 a[228:229], v23 offset:4096
  ds_read_b64_tr_b16 a[230:231], v23 offset:5120
  ds_read_b64_tr_b16 a[232:233], v23 offset:8192
  ds_read_b64_tr_b16 a[234:235], v23 offset:9216
  ds_read_b64_tr_b16 a[236:237], v23 offset:12288
  ds_read_b64_tr_b16 a[238:239], v23 offset:13312
  ds_read_b64_tr_b16 a[240:241], v23 offset:16384
  ds_read_b64_tr_b16 a[242:243], v23 offset:17408
  ds_read_b64_tr_b16 a[244:245], v23 offset:20480
  ds_read_b64_tr_b16 a[246:247], v23 offset:21504
  ds_read_b64_tr_b16 a[248:249], v23 offset:24576
  ds_read_b64_tr_b16 a[250:251], v23 offset:25600
  ds_read_b64_tr_b16 a[252:253], v23 offset:28672
  ds_read_b64_tr_b16 a[254:255], v23 offset:29696
  s_waitcnt lgkmcnt(0)
  s_waitcnt vmcnt(16)
  s_barrier
  s_add_u32 s27, s26, 3145728
  s_add_u32 m0, s28, 32768
  s_nop 0
  buffer_load_dwordx4 v20, s[64:67], s27 offen lds
  s_add_u32 m0, s28, 33792
  s_add_u32 s27, s27, 32768
  buffer_load_dwordx4 v20, s[64:67], s27 offen lds
  s_add_u32 m0, s28, 34816
  s_add_u32 s27, s27, 32768
  buffer_load_dwordx4 v21, s[64:67], s27 offen lds
  s_add_u32 m0, s28, 35840
  s_add_u32 s27, s27, 32768
  buffer_load_dwordx4 v21, s[64:67], s27 offen lds
  s_add_u32 m0, s28, 36864
  s_add_u32 s27, s27, 32768
  buffer_load_dwordx4 v20, s[64:67], s27 offen lds
  s_add_u32 m0, s28, 37888
  s_add_u32 s27, s27, 32768
  buffer_load_dwordx4 v20, s[64:67], s27 offen lds
  s_add_u32 m0, s28, 38912
  s_add_u32 s27, s27, 32768
  buffer_load_dwordx4 v21, s[64:67], s27 offen lds
  s_add_u32 m0, s28, 39936
  s_add_u32 s27, s27, 32768
  buffer_load_dwordx4 v21, s[64:67], s27 offen lds
  ds_read_b64_tr_b16 v[128:129], v23 offset:32768
  ds_read_b64_tr_b16 v[130:131], v23 offset:33792
  ds_read_b64_tr_b16 v[132:133], v23 offset:36864
  ds_read_b64_tr_b16 v[134:135], v23 offset:37888
  ds_read_b64_tr_b16 v[136:137], v23 offset:40960
  ds_read_b64_tr_b16 v[138:139], v23 offset:41984
  ds_read_b64_tr_b16 v[140:141], v23 offset:45056
  ds_read_b64_tr_b16 v[142:143], v23 offset:46080
  ds_read_b64_tr_b16 v[144:145], v23 offset:49152
  ds_read_b64_tr_b16 v[146:147], v23 offset:50176
  ds_read_b64_tr_b16 v[148:149], v23 offset:53248
  ds_read_b64_tr_b16 v[150:151], v23 offset:54272
  ds_read_b64_tr_b16 v[152:153], v23 offset:57344
  ds_read_b64_tr_b16 v[154:155], v23 offset:58368
  ds_read_b64_tr_b16 v[156:157], v23 offset:61440
  ds_read_b64_tr_b16 v[158:159], v23 offset:62464
  s_waitcnt lgkmcnt(0)
  s_waitcnt vmcnt(16)
  s_barrier
  ds_read_b64_tr_b16 v[160:161], v24 offset:0
  ds_read_b64_tr_b16 v[162:163], v24 offset:1024
  ds_read_b64_tr_b16 v[164:165], v24 offset:4096
  ds_read_b64_tr_b16 v[166:167], v24 offset:5120
  ds_read_b64_tr_b16 v[168:169], v24 offset:8192
  ds_read_b64_tr_b16 v[170:171], v24 offset:9216
  ds_read_b64_tr_b16 v[172:173], v24 offset:12288
  ds_read_b64_tr_b16 v[174:175], v24 offset:13312
  ds_read_b64_tr_b16 v[176:177], v24 offset:16384
  ds_read_b64_tr_b16 v[178:179], v24 offset:17408
  ds_read_b64_tr_b16 v[180:181], v24 offset:20480
  ds_read_b64_tr_b16 v[182:183], v24 offset:21504
  ds_read_b64_tr_b16 v[184:185], v24 offset:24576
  ds_read_b64_tr_b16 v[186:187], v24 offset:25600
  ds_read_b64_tr_b16 v[188:189], v24 offset:28672
  ds_read_b64_tr_b16 v[190:191], v24 offset:29696
  s_waitcnt lgkmcnt(0)
  s_waitcnt vmcnt(8)
  s_barrier
  ds_read_b64_tr_b16 v[192:193], v22 offset:0
  ds_read_b64_tr_b16 v[194:195], v22 offset:1024
  ds_read_b64_tr_b16 v[196:197], v22 offset:4096
  ds_read_b64_tr_b16 v[198:199], v22 offset:5120
  ds_read_b64_tr_b16 v[200:201], v22 offset:8192
  ds_read_b64_tr_b16 v[202:203], v22 offset:9216
  ds_read_b64_tr_b16 v[204:205], v22 offset:12288
  ds_read_b64_tr_b16 v[206:207], v22 offset:13312
  ds_read_b64_tr_b16 v[208:209], v22 offset:16384
  ds_read_b64_tr_b16 v[210:211], v22 offset:17408
  ds_read_b64_tr_b16 v[212:213], v22 offset:20480
  ds_read_b64_tr_b16 v[214:215], v22 offset:21504
  ds_read_b64_tr_b16 v[216:217], v22 offset:24576
  ds_read_b64_tr_b16 v[218:219], v22 offset:25600
  ds_read_b64_tr_b16 v[220:221], v22 offset:28672
  ds_read_b64_tr_b16 v[222:223], v22 offset:29696
  s_waitcnt lgkmcnt(0)
  s_waitcnt vmcnt(0)
  s_barrier
  ds_read_b64_tr_b16 v[224:225], v22 offset:32768
  ds_read_b64_tr_b16 v[226:227], v22 offset:33792
  ds_read_b64_tr_b16 v[228:229], v22 offset:36864
  ds_read_b64_tr_b16 v[230:231], v22 offset:37888
  ds_read_b64_tr_b16 v[232:233], v22 offset:40960
  ds_read_b64_tr_b16 v[234:235], v22 offset:41984
  ds_read_b64_tr_b16 v[236:237], v22 offset:45056
  ds_read_b64_tr_b16 v[238:239], v22 offset:46080
  ds_read_b64_tr_b16 v[240:241], v22 offset:49152
  ds_read_b64_tr_b16 v[242:243], v22 offset:50176
  ds_read_b64_tr_b16 v[244:245], v22 offset:53248
  ds_read_b64_tr_b16 v[246:247], v22 offset:54272
  ds_read_b64_tr_b16 v[248:249], v22 offset:57344
  ds_read_b64_tr_b16 v[250:251], v22 offset:58368
  ds_read_b64_tr_b16 v[252:253], v22 offset:61440
  ds_read_b64_tr_b16 v[254:255], v22 offset:62464
  s_waitcnt lgkmcnt(0)
  s_branch q_ld_57
q_ld_56:
  s_add_u32 s27, s26, 0
  s_add_u32 m0, s28, 0
  s_nop 0
  buffer_load_dwordx4 v20, s[8:11], s27 offen lds
  s_add_u32 m0, s28, 1024
  s_add_u32 s27, s27, 32768
  buffer_load_dwordx4 v20, s[8:11], s27 offen lds
  s_add_u32 m0, s28, 2048
  s_add_u32 s27, s27, 32768
  buffer_load_dwordx4 v21, s[8:11], s27 offen lds
  s_add_u32 m0, s28, 3072
  s_add_u32 s27, s27, 32768
  buffer_load_dwordx4 v21, s[8:11], s27 offen lds
  s_add_u32 m0, s28, 4096
  s_add_u32 s27, s27, 32768
  buffer_load_dwordx4 v20, s[8:11], s27 offen lds
  s_add_u32 m0, s28, 5120
  s_add_u32 s27, s27, 32768
  buffer_load_dwordx4 v20, s[8:11], s27 offen lds
  s_add_u32 m0, s28, 6144
  s_add_u32 s27, s27, 32768
  buffer_load_dwordx4 v21, s[8:11], s27 offen lds
  s_add_u32 m0, s28, 7168
  s_add_u32 s27, s27, 32768
  buffer_load_dwordx4 v21, s[8:11], s27 offen lds
  s_add_u32 s27, s26, 1048576
  s_add_u32 m0, s28, 32768
  s_nop 0
  buffer_load_dwordx4 v20, s[8:11], s27 offen lds
  s_add_u32 m0, s28, 33792
  s_add_u32 s27, s27, 32768
  buffer_load_dwordx4 v20, s[8:11], s27 offen lds
  s_add_u32 m0, s28, 34816
  s_add_u32 s27, s27, 32768
  buffer_load_dwordx4 v21, s[8:11], s27 offen lds
  s_add_u32 m0, s28, 35840
  s_add_u32 s27, s27, 32768
  buffer_load_dwordx4 v21, s[8:11], s27 offen lds
  s_add_u32 m0, s28, 36864
  s_add_u32 s27, s27, 32768
  buffer_load_dwordx4 v20, s[8:11], s27 offen lds
  s_add_u32 m0, s28, 37888
  s_add_u32 s27, s27, 32768
  buffer_load_dwordx4 v20, s[8:11], s27 offen lds
  s_add_u32 m0, s28, 38912
  s_add_u32 s27, s27, 32768
  buffer_load_dwordx4 v21, s[8:11], s27 offen lds
  s_add_u32 m0, s28, 39936
  s_add_u32 s27, s27, 32768
  buffer_load_dwordx4 v21, s[8:11], s27 offen lds
  s_add_u32 s27, s26, 2097152
  s_add_u32 m0, s28, 65536
  s_nop 0
  buffer_load_dwordx4 v20, s[8:11], s27 offen lds
  s_add_u32 m0, s28, 66560
  s_add_u32 s27, s27, 32768
  buffer_load_dwordx4 v20, s[8:11], s27 offen lds
  s_add_u32 m0, s28, 67584
  s_add_u32 s27, s27, 32768
  buffer_load_dwordx4 v21, s[8:11], s27 offen lds
  s_add_u32 m0, s28, 68608
  s_add_u32 s27, s27, 32768
  buffer_load_dwordx4 v21, s[8:11], s27 offen lds
  s_add_u32 m0, s28, 69632
  s_add_u32 s27, s27, 32768
  buffer_load_dwordx4 v20, s[8:11], s27 offen lds
  s_add_u32 m0, s28, 70656
  s_add_u32 s27, s27, 32768
  buffer_load_dwordx4 v20, s[8:11], s27 offen lds
  s_add_u32 m0, s28, 71680
  s_add_u32 s27, s27, 32768
  buffer_load_dwordx4 v21, s[8:11], s27 offen lds
  s_add_u32 m0, s28, 72704
  s_add_u32 s27, s27, 32768
  buffer_load_dwordx4 v21, s[8:11], s27 offen lds
  s_load_dwordx2 s[4:5], s[0:1], 112
  s_load_dwordx2 s[12:13], s[0:1], 104
  s_waitcnt vmcnt(16)
  s_barrier
  s_add_u32 s27, s26, 3145728
  s_add_u32 m0, s28, 98304
  s_nop 0
  buffer_load_dwordx4 v20, s[8:11], s27 offen lds
  s_add_u32 m0, s28, 99328
  s_add_u32 s27, s27, 32768
  buffer_load_dwordx4 v20, s[8:11], s27 offen lds
  s_add_u32 m0, s28, 100352
  s_add_u32 s27, s27, 32768
  buffer_load_dwordx4 v21, s[8:11], s27 offen lds
  s_add_u32 m0, s28, 101376
  s_add_u32 s27, s27, 32768
  buffer_load_dwordx4 v21, s[8:11], s27 offen lds
  s_add_u32 m0, s28, 102400
  s_add_u32 s27, s27, 32768
  buffer_load_dwordx4 v20, s[8:11], s27 offen lds
  s_add_u32 m0, s28, 103424
  s_add_u32 s27, s27, 32768
  buffer_load_dwordx4 v20, s[8:11], s27 offen lds
  s_add_u32 m0, s28, 104448
  s_add_u32 s27, s27, 32768
  buffer_load_dwordx4 v21, s[8:11], s27 offen lds
  s_add_u32 m0, s28, 105472
  s_add_u32 s27, s27, 32768
  buffer_load_dwordx4 v21, s[8:11], s27 offen lds
  ds_read_b64_tr_b16 a[128:129], v22 offset:0
  ds_read_b64_tr_b16 a[130:131], v22 offset:1024
  ds_read_b64_tr_b16 a[132:133], v22 offset:4096
  ds_read_b64_tr_b16 a[134:135], v22 offset:5120
  ds_read_b64_tr_b16 a[136:137], v22 offset:8192
  ds_read_b64_tr_b16 a[138:139], v22 offset:9216
  ds_read_b64_tr_b16 a[140:141], v22 offset:12288
  ds_read_b64_tr_b16 a[142:143], v22 offset:13312
  ds_read_b64_tr_b16 a[144:145], v22 offset:16384
  ds_read_b64_tr_b16 a[146:147], v22 offset:17408
  ds_read_b64_tr_b16 a[148:149], v22 offset:20480
  ds_read_b64_tr_b16 a[150:151], v22 offset:21504
  ds_read_b64_tr_b16 a[152:153], v22 offset:24576
  ds_read_b64_tr_b16 a[154:155], v22 offset:25600
  ds_read_b64_tr_b16 a[156:157], v22 offset:28672
  ds_read_b64_tr_b16 a[158:159], v22 offset:29696
  s_waitcnt lgkmcnt(0)
  s_waitcnt vmcnt(16)
  s_barrier
  s_add_u32 s27, s26, 0
  s_add_u32 m0, s28, 131072
  s_nop 0
  buffer_load_dwordx4 v20, s[64:67], s27 offen lds
  s_add_u32 m0, s28, 132096
  s_add_u32 s27, s27, 32768
  buffer_load_dwordx4 v20, s[64:67], s27 offen lds
  s_add_u32 m0, s28, 133120
  s_add_u32 s27, s27, 32768
  buffer_load_dwordx4 v21, s[64:67], s27 offen lds
  s_add_u32 m0, s28, 134144
  s_add_u32 s27, s27, 32768
  buffer_load_dwordx4 v21, s[64:67], s27 offen lds
  s_add_u32 m0, s28, 135168
  s_add_u32 s27, s27, 32768
  buffer_load_dwordx4 v20, s[64:67], s27 offen lds
  s_add_u32 m0, s28, 136192
  s_add_u32 s27, s27, 32768
  buffer_load_dwordx4 v20, s[64:67], s27 offen lds
  s_add_u32 m0, s28, 137216
  s_add_u32 s27, s27, 32768
  buffer_load_dwordx4 v21, s[64:67], s27 offen lds
  s_add_u32 m0, s28, 138240
  s_add_u32 s27, s27, 32768
  buffer_load_dwordx4 v21, s[64:67], s27 offen lds
  ds_read_b64_tr_b16 a[160:161], v22 offset:32768
  ds_read_b64_tr_b16 a[162:163], v22 offset:33792
  ds_read_b64_tr_b16 a[164:165], v22 offset:36864
  ds_read_b64_tr_b16 a[166:167], v22 offset:37888
  ds_read_b64_tr_b16 a[168:169], v22 offset:40960
  ds_read_b64_tr_b16 a[170:171], v22 offset:41984
  ds_read_b64_tr_b16 a[172:173], v22 offset:45056
  ds_read_b64_tr_b16 a[174:175], v22 offset:46080
  ds_read_b64_tr_b16 a[176:177], v22 offset:49152
  ds_read_b64_tr_b16 a[178:179], v22 offset:50176
  ds_read_b64_tr_b16 a[180:181], v22 offset:53248
  ds_read_b64_tr_b16 a[182:183], v22 offset:54272
  ds_read_b64_tr_b16 a[184:185], v22 offset:57344
  ds_read_b64_tr_b16 a[186:187], v22 offset:58368
  ds_read_b64_tr_b16 a[188:189], v22 offset:61440
  ds_read_b64_tr_b16 a[190:191], v22 offset:62464
  s_waitcnt lgkmcnt(0)
  s_waitcnt vmcnt(16)
  s_barrier
  s_add_u32 s27, s26, 1048576
  s_add_u32 m0, s28, 0
  s_nop 0
  buffer_load_dwordx4 v20, s[64:67], s27 offen lds
  s_add_u32 m0, s28, 1024
  s_add_u32 s27, s27, 32768
  buffer_load_dwordx4 v20, s[64:67], s27 offen lds
  s_add_u32 m0, s28, 2048
  s_add_u32 s27, s27, 32768
  buffer_load_dwordx4 v21, s[64:67], s27 offen lds
  s_add_u32 m0, s28, 3072
  s_add_u32 s27, s27, 32768
  buffer_load_dwordx4 v21, s[64:67], s27 offen lds
  s_add_u32 m0, s28, 4096
  s_add_u32 s27, s27, 32768
  buffer_load_dwordx4 v20, s[64:67], s27 offen lds
  s_add_u32 m0, s28, 5120
  s_add_u32 s27, s27, 32768
  buffer_load_dwordx4 v20, s[64:67], s27 offen lds
  s_add_u32 m0, s28, 6144
  s_add_u32 s27, s27, 32768
  buffer_load_dwordx4 v21, s[64:67], s27 offen lds
  s_add_u32 m0, s28, 7168
  s_add_u32 s27, s27, 32768
  buffer_load_dwordx4 v21, s[64:67], s27 offen lds
  ds_read_b64_tr_b16 a[192:193], v23 offset:0
  ds_read_b64_tr_b16 a[194:195], v23 offset:1024
  ds_read_b64_tr_b16 a[196:197], v23 offset:4096
  ds_read_b64_tr_b16 a[198:199], v23 offset:5120
  ds_read_b64_tr_b16 a[200:201], v23 offset:8192
  ds_read_b64_tr_b16 a[202:203], v23 offset:9216
  ds_read_b64_tr_b16 a[204:205], v23 offset:12288
  ds_read_b64_tr_b16 a[206:207], v23 offset:13312
  ds_read_b64_tr_b16 a[208:209], v23 offset:16384
  ds_read_b64_tr_b16 a[210:211], v23 offset:17408
  ds_read_b64_tr_b16 a[212:213], v23 offset:20480
  ds_read_b64_tr_b16 a[214:215], v23 offset:21504
  ds_read_b64_tr_b16 a[216:217], v23 offset:24576
  ds_read_b64_tr_b16 a[218:219], v23 offset:25600
  ds_read_b64_tr_b16 a[220:221], v23 offset:28672
  ds_read_b64_tr_b16 a[222:223], v23 offset:29696
  s_waitcnt lgkmcnt(0)
  s_waitcnt vmcnt(16)
  s_barrier
  s_add_u32 s27, s26, 2097152
  s_add_u32 m0, s28, 32768
  s_nop 0
  buffer_load_dwordx4 v20, s[64:67], s27 offen lds
  s_add_u32 m0, s28, 33792
  s_add_u32 s27, s27, 32768
  buffer_load_dwordx4 v20, s[64:67], s27 offen lds
  s_add_u32 m0, s28, 34816
  s_add_u32 s27, s27, 32768
  buffer_load_dwordx4 v21, s[64:67], s27 offen lds
  s_add_u32 m0, s28, 35840
  s_add_u32 s27, s27, 32768
  buffer_load_dwordx4 v21, s[64:67], s27 offen lds
  s_add_u32 m0, s28, 36864
  s_add_u32 s27, s27, 32768
  buffer_load_dwordx4 v20, s[64:67], s27 offen lds
  s_add_u32 m0, s28, 37888
  s_add_u32 s27, s27, 32768
  buffer_load_dwordx4 v20, s[64:67], s27 offen lds
  s_add_u32 m0, s28, 38912
  s_add_u32 s27, s27, 32768
  buffer_load_dwordx4 v21, s[64:67], s27 offen lds
  s_add_u32 m0, s28, 39936
  s_add_u32 s27, s27, 32768
  buffer_load_dwordx4 v21, s[64:67], s27 offen lds
  ds_read_b64_tr_b16 a[224:225], v23 offset:32768
  ds_read_b64_tr_b16 a[226:227], v23 offset:33792
  ds_read_b64_tr_b16 a[228:229], v23 offset:36864
  ds_read_b64_tr_b16 a[230:231], v23 offset:37888
  ds_read_b64_tr_b16 a[232:233], v23 offset:40960
  ds_read_b64_tr_b16 a[234:235], v23 offset:41984
  ds_read_b64_tr_b16 a[236:237], v23 offset:45056
  ds_read_b64_tr_b16 a[238:239], v23 offset:46080
  ds_read_b64_tr_b16 a[240:241], v23 offset:49152
  ds_read_b64_tr_b16 a[242:243], v23 offset:50176
  ds_read_b64_tr_b16 a[244:245], v23 offset:53248
  ds_read_b64_tr_b16 a[246:247], v23 offset:54272
  ds_read_b64_tr_b16 a[248:249], v23 offset:57344
  ds_read_b64_tr_b16 a[250:251], v23 offset:58368
  ds_read_b64_tr_b16 a[252:253], v23 offset:61440
  ds_read_b64_tr_b16 a[254:255], v23 offset:62464
  s_waitcnt lgkmcnt(0)
  s_waitcnt vmcnt(16)
  s_barrier
  s_add_u32 s27, s26, 3145728
  s_add_u32 m0, s28, 65536
  s_nop 0
  buffer_load_dwordx4 v20, s[64:67], s27 offen lds
  s_add_u32 m0, s28, 66560
  s_add_u32 s27, s27, 32768
  buffer_load_dwordx4 v20, s[64:67], s27 offen lds
  s_add_u32 m0, s28, 67584
  s_add_u32 s27, s27, 32768
  buffer_load_dwordx4 v21, s[64:67], s27 offen lds
  s_add_u32 m0, s28, 68608
  s_add_u32 s27, s27, 32768
  buffer_load_dwordx4 v21, s[64:67], s27 offen lds
  s_add_u32 m0, s28, 69632
  s_add_u32 s27, s27, 32768
  buffer_load_dwordx4 v20, s[64:67], s27 offen lds
  s_add_u32 m0, s28, 70656
  s_add_u32 s27, s27, 32768
  buffer_load_dwordx4 v20, s[64:67], s27 offen lds
  s_add_u32 m0, s28, 71680
  s_add_u32 s27, s27, 32768
  buffer_load_dwordx4 v21, s[64:67], s27 offen lds
  s_add_u32 m0, s28, 72704
  s_add_u32 s27, s27, 32768
  buffer_load_dwordx4 v21, s[64:67], s27 offen lds
  ds_read_b64_tr_b16 v[128:129], v24 offset:0
  ds_read_b64_tr_b16 v[130:131], v24 offset:1024
  ds_read_b64_tr_b16 v[132:133], v24 offset:4096
  ds_read_b64_tr_b16 v[134:135], v24 offset:5120
  ds_read_b64_tr_b16 v[136:137], v24 offset:8192
  ds_read_b64_tr_b16 v[138:139], v24 offset:9216
  ds_read_b64_tr_b16 v[140:141], v24 offset:12288
  ds_read_b64_tr_b16 v[142:143], v24 offset:13312
  ds_read_b64_tr_b16 v[144:145], v24 offset:16384
  ds_read_b64_tr_b16 v[146:147], v24 offset:17408
  ds_read_b64_tr_b16 v[148:149], v24 offset:20480
  ds_read_b64_tr_b16 v[150:151], v24 offset:21504
  ds_read_b64_tr_b16 v[152:153], v24 offset:24576
  ds_read_b64_tr_b16 v[154:155], v24 offset:25600
  ds_read_b64_tr_b16 v[156:157], v24 offset:28672
  ds_read_b64_tr_b16 v[158:159], v24 offset:29696
  s_waitcnt lgkmcnt(0)
  s_waitcnt vmcnt(16)
  s_barrier
  s_add_u32 s27, s26, 0
  s_add_u32 m0, s28, 98304
  s_nop 0
  buffer_load_dwordx4 v20, s[68:71], s27 offen lds
  s_add_u32 m0, s28, 99328
  s_add_u32 s27, s27, 32768
  buffer_load_dwordx4 v20, s[68:71], s27 offen lds
  s_add_u32 m0, s28, 100352
  s_add_u32 s27, s27, 32768
  buffer_load_dwordx4 v21, s[68:71], s27 offen lds
  s_add_u32 m0, s28, 101376
  s_add_u32 s27, s27, 32768
  buffer_load_dwordx4 v21, s[68:71], s27 offen lds
  s_add_u32 m0, s28, 102400
  s_add_u32 s27, s27, 32768
  buffer_load_dwordx4 v20, s[68:71], s27 offen lds
  s_add_u32 m0, s28, 103424
  s_add_u32 s27, s27, 32768
  buffer_load_dwordx4 v20, s[68:71], s27 offen lds
  s_add_u32 m0, s28, 104448
  s_add_u32 s27, s27, 32768
  buffer_load_dwordx4 v21, s[68:71], s27 offen lds
  s_add_u32 m0, s28, 105472
  s_add_u32 s27, s27, 32768
  buffer_load_dwordx4 v21, s[68:71], s27 offen lds
  ds_read_b64_tr_b16 v[160:161], v22 offset:0
  ds_read_b64_tr_b16 v[162:163], v22 offset:1024
  ds_read_b64_tr_b16 v[164:165], v22 offset:4096
  ds_read_b64_tr_b16 v[166:167], v22 offset:5120
  ds_read_b64_tr_b16 v[168:169], v22 offset:8192
  ds_read_b64_tr_b16 v[170:171], v22 offset:9216
  ds_read_b64_tr_b16 v[172:173], v22 offset:12288
  ds_read_b64_tr_b16 v[174:175], v22 offset:13312
  ds_read_b64_tr_b16 v[176:177], v22 offset:16384
  ds_read_b64_tr_b16 v[178:179], v22 offset:17408
  ds_read_b64_tr_b16 v[180:181], v22 offset:20480
  ds_read_b64_tr_b16 v[182:183], v22 offset:21504
  ds_read_b64_tr_b16 v[184:185], v22 offset:24576
  ds_read_b64_tr_b16 v[186:187], v22 offset:25600
  ds_read_b64_tr_b16 v[188:189], v22 offset:28672
  ds_read_b64_tr_b16 v[190:191], v22 offset:29696
  s_waitcnt lgkmcnt(0)
  s_waitcnt vmcnt(16)
  s_barrier
  s_add_u32 s27, s26, 1048576
  s_add_u32 m0, s28, 131072
  s_nop 0
  buffer_load_dwordx4 v20, s[68:71], s27 offen lds
  s_add_u32 m0, s28, 132096
  s_add_u32 s27, s27, 32768
  buffer_load_dwordx4 v20, s[68:71], s27 offen lds
  s_add_u32 m0, s28, 133120
  s_add_u32 s27, s27, 32768
  buffer_load_dwordx4 v21, s[68:71], s27 offen lds
  s_add_u32 m0, s28, 134144
  s_add_u32 s27, s27, 32768
  buffer_load_dwordx4 v21, s[68:71], s27 offen lds
  s_add_u32 m0, s28, 135168
  s_add_u32 s27, s27, 32768
  buffer_load_dwordx4 v20, s[68:71], s27 offen lds
  s_add_u32 m0, s28, 136192
  s_add_u32 s27, s27, 32768
  buffer_load_dwordx4 v20, s[68:71], s27 offen lds
  s_add_u32 m0, s28, 137216
  s_add_u32 s27, s27, 32768
  buffer_load_dwordx4 v21, s[68:71], s27 offen lds
  s_add_u32 m0, s28, 138240
  s_add_u32 s27, s27, 32768
  buffer_load_dwordx4 v21, s[68:71], s27 offen lds
  ds_read_b64_tr_b16 v[192:193], v22 offset:32768
  ds_read_b64_tr_b16 v[194:195], v22 offset:33792
  ds_read_b64_tr_b16 v[196:197], v22 offset:36864
  ds_read_b64_tr_b16 v[198:199], v22 offset:37888
  ds_read_b64_tr_b16 v[200:201], v22 offset:40960
  ds_read_b64_tr_b16 v[202:203], v22 offset:41984
  ds_read_b64_tr_b16 v[204:205], v22 offset:45056
  ds_read_b64_tr_b16 v[206:207], v22 offset:46080
  ds_read_b64_tr_b16 v[208:209], v22 offset:49152
  ds_read_b64_tr_b16 v[210:211], v22 offset:50176
  ds_read_b64_tr_b16 v[212:213], v22 offset:53248
  ds_read_b64_tr_b16 v[214:215], v22 offset:54272
  ds_read_b64_tr_b16 v[216:217], v22 offset:57344
  ds_read_b64_tr_b16 v[218:219], v22 offset:58368
  ds_read_b64_tr_b16 v[220:221], v22 offset:61440
  ds_read_b64_tr_b16 v[222:223], v22 offset:62464
  s_waitcnt lgkmcnt(0)
  s_waitcnt vmcnt(16)
  s_barrier
  s_add_u32 s27, s26, 2097152
  s_add_u32 m0, s28, 0
  s_nop 0
  buffer_load_dwordx4 v20, s[68:71], s27 offen lds
  s_add_u32 m0, s28, 1024
  s_add_u32 s27, s27, 32768
  buffer_load_dwordx4 v20, s[68:71], s27 offen lds
  s_add_u32 m0, s28, 2048
  s_add_u32 s27, s27, 32768
  buffer_load_dwordx4 v21, s[68:71], s27 offen lds
  s_add_u32 m0, s28, 3072
  s_add_u32 s27, s27, 32768
  buffer_load_dwordx4 v21, s[68:71], s27 offen lds
  s_add_u32 m0, s28, 4096
  s_add_u32 s27, s27, 32768
  buffer_load_dwordx4 v20, s[68:71], s27 offen lds
  s_add_u32 m0, s28, 5120
  s_add_u32 s27, s27, 32768
  buffer_load_dwordx4 v20, s[68:71], s27 offen lds
  s_add_u32 m0, s28, 6144
  s_add_u32 s27, s27, 32768
  buffer_load_dwordx4 v21, s[68:71], s27 offen lds
  s_add_u32 m0, s28, 7168
  s_add_u32 s27, s27, 32768
  buffer_load_dwordx4 v21, s[68:71], s27 offen lds
  ds_read_b64_tr_b16 v[224:225], v23 offset:0
  ds_read_b64_tr_b16 v[226:227], v23 offset:1024
  ds_read_b64_tr_b16 v[228:229], v23 offset:4096
  ds_read_b64_tr_b16 v[230:231], v23 offset:5120
  ds_read_b64_tr_b16 v[232:233], v23 offset:8192
  ds_read_b64_tr_b16 v[234:235], v23 offset:9216
  ds_read_b64_tr_b16 v[236:237], v23 offset:12288
  ds_read_b64_tr_b16 v[238:239], v23 offset:13312
  ds_read_b64_tr_b16 v[240:241], v23 offset:16384
  ds_read_b64_tr_b16 v[242:243], v23 offset:17408
  ds_read_b64_tr_b16 v[244:245], v23 offset:20480
  ds_read_b64_tr_b16 v[246:247], v23 offset:21504
  ds_read_b64_tr_b16 v[248:249], v23 offset:24576
  ds_read_b64_tr_b16 v[250:251], v23 offset:25600
  ds_read_b64_tr_b16 v[252:253], v23 offset:28672
  ds_read_b64_tr_b16 v[254:255], v23 offset:29696
  s_waitcnt lgkmcnt(0)
  s_waitcnt vmcnt(16)
  s_barrier
  s_add_u32 s27, s26, 3145728
  s_add_u32 m0, s28, 32768
  s_nop 0
  buffer_load_dwordx4 v20, s[68:71], s27 offen lds
  s_add_u32 m0, s28, 33792
  s_add_u32 s27, s27, 32768
  buffer_load_dwordx4 v20, s[68:71], s27 offen lds
  s_add_u32 m0, s28, 34816
  s_add_u32 s27, s27, 32768
  buffer_load_dwordx4 v21, s[68:71], s27 offen lds
  s_add_u32 m0, s28, 35840
  s_add_u32 s27, s27, 32768
  buffer_load_dwordx4 v21, s[68:71], s27 offen lds
  s_add_u32 m0, s28, 36864
  s_add_u32 s27, s27, 32768
  buffer_load_dwordx4 v20, s[68:71], s27 offen lds
  s_add_u32 m0, s28, 37888
  s_add_u32 s27, s27, 32768
  buffer_load_dwordx4 v20, s[68:71], s27 offen lds
  s_add_u32 m0, s28, 38912
  s_add_u32 s27, s27, 32768
  buffer_load_dwordx4 v21, s[68:71], s27 offen lds
  s_add_u32 m0, s28, 39936
  s_add_u32 s27, s27, 32768
  buffer_load_dwordx4 v21, s[68:71], s27 offen lds
  ds_read_b64_tr_b16 a[0:1], v23 offset:32768
  ds_read_b64_tr_b16 a[2:3], v23 offset:33792
  ds_read_b64_tr_b16 a[4:5], v23 offset:36864
  ds_read_b64_tr_b16 a[6:7], v23 offset:37888
  ds_read_b64_tr_b16 a[8:9], v23 offset:40960
  ds_read_b64_tr_b16 a[10:11], v23 offset:41984
  ds_read_b64_tr_b16 a[12:13], v23 offset:45056
  ds_read_b64_tr_b16 a[14:15], v23 offset:46080
  ds_read_b64_tr_b16 a[16:17], v23 offset:49152
  ds_read_b64_tr_b16 a[18:19], v23 offset:50176
  ds_read_b64_tr_b16 a[20:21], v23 offset:53248
  ds_read_b64_tr_b16 a[22:23], v23 offset:54272
  ds_read_b64_tr_b16 a[24:25], v23 offset:57344
  ds_read_b64_tr_b16 a[26:27], v23 offset:58368
  ds_read_b64_tr_b16 a[28:29], v23 offset:61440
  ds_read_b64_tr_b16 a[30:31], v23 offset:62464
  s_waitcnt lgkmcnt(0)
  s_waitcnt vmcnt(16)
  s_barrier
  ds_read_b64_tr_b16 a[32:33], v24 offset:0
  ds_read_b64_tr_b16 a[34:35], v24 offset:1024
  ds_read_b64_tr_b16 a[36:37], v24 offset:4096
  ds_read_b64_tr_b16 a[38:39], v24 offset:5120
  ds_read_b64_tr_b16 a[40:41], v24 offset:8192
  ds_read_b64_tr_b16 a[42:43], v24 offset:9216
  ds_read_b64_tr_b16 a[44:45], v24 offset:12288
  ds_read_b64_tr_b16 a[46:47], v24 offset:13312
  ds_read_b64_tr_b16 a[48:49], v24 offset:16384
  ds_read_b64_tr_b16 a[50:51], v24 offset:17408
  ds_read_b64_tr_b16 a[52:53], v24 offset:20480
  ds_read_b64_tr_b16 a[54:55], v24 offset:21504
  ds_read_b64_tr_b16 a[56:57], v24 offset:24576
  ds_read_b64_tr_b16 a[58:59], v24 offset:25600
  ds_read_b64_tr_b16 a[60:61], v24 offset:28672
  ds_read_b64_tr_b16 a[62:63], v24 offset:29696
  s_waitcnt lgkmcnt(0)
  s_waitcnt vmcnt(8)
  s_barrier
  ds_read_b64_tr_b16 a[64:65], v22 offset:0
  ds_read_b64_tr_b16 a[66:67], v22 offset:1024
  ds_read_b64_tr_b16 a[68:69], v22 offset:4096
  ds_read_b64_tr_b16 a[70:71], v22 offset:5120
  ds_read_b64_tr_b16 a[72:73], v22 offset:8192
  ds_read_b64_tr_b16 a[74:75], v22 offset:9216
  ds_read_b64_tr_b16 a[76:77], v22 offset:12288
  ds_read_b64_tr_b16 a[78:79], v22 offset:13312
  ds_read_b64_tr_b16 a[80:81], v22 offset:16384
  ds_read_b64_tr_b16 a[82:83], v22 offset:17408
  ds_read_b64_tr_b16 a[84:85], v22 offset:20480
  ds_read_b64_tr_b16 a[86:87], v22 offset:21504
  ds_read_b64_tr_b16 a[88:89], v22 offset:24576
  ds_read_b64_tr_b16 a[90:91], v22 offset:25600
  ds_read_b64_tr_b16 a[92:93], v22 offset:28672
  ds_read_b64_tr_b16 a[94:95], v22 offset:29696
  s_waitcnt lgkmcnt(0)
  s_waitcnt vmcnt(0)
  s_barrier
  ds_read_b64_tr_b16 a[96:97], v22 offset:32768
  ds_read_b64_tr_b16 a[98:99], v22 offset:33792
  ds_read_b64_tr_b16 a[100:101], v22 offset:36864
  ds_read_b64_tr_b16 a[102:103], v22 offset:37888
  ds_read_b64_tr_b16 a[104:105], v22 offset:40960
  ds_read_b64_tr_b16 a[106:107], v22 offset:41984
  ds_read_b64_tr_b16 a[108:109], v22 offset:45056
  ds_read_b64_tr_b16 a[110:111], v22 offset:46080
  ds_read_b64_tr_b16 a[112:113], v22 offset:49152
  ds_read_b64_tr_b16 a[114:115], v22 offset:50176
  ds_read_b64_tr_b16 a[116:117], v22 offset:53248
  ds_read_b64_tr_b16 a[118:119], v22 offset:54272
  ds_read_b64_tr_b16 a[120:121], v22 offset:57344
  ds_read_b64_tr_b16 a[122:123], v22 offset:58368
  ds_read_b64_tr_b16 a[124:125], v22 offset:61440
  ds_read_b64_tr_b16 a[126:127], v22 offset:62464
  s_waitcnt lgkmcnt(0)
q_ld_57:
  s_waitcnt lgkmcnt(0)
  s_barrier
  v_mbcnt_lo_u32_b32 v20, -1, 0
  v_and_b32 v20, 0, v20
  v_add_lshl_u32 v20, v20, 1, 2
  s_mov_b32 s26, 0
g_wt_58:
  global_load_dword v21, v20, s[12:13] offset:128 sc1
  s_add_u32 s26, s26, 1
  s_cmp_gt_u32 s26, 1048576
  s_cbranch_scc1 L_end
  s_waitcnt vmcnt(0)
  v_cmp_eq_u32 vcc, 0, v21
  v_readfirstlane_b32 s27, v21
  s_cbranch_vccnz g_wt_58
  v_lshrrev_b32 v7, 7, v0
  v_lshlrev_b32 v7, 12, v7
  v_and_b32 v2, 1023, v9
  s_lshl_b32 s26, s17, 10
  v_add3_u32 v7, v7, v2, s26
  v_mov_b32 v116, 0
  s_mov_b32 s47, s60
  s_add_u32 s76, s60, 3
  s_add_u32 s41, s60, 64
  s_mov_b32 s40, 18
  s_mov_b32 s48, 0
  s_mov_b32 s49, 268435456
  s_mov_b32 s43, 268435456
  s_mov_b32 s50, 32768
  s_mov_b32 s56, 1
  s_mov_b32 s61, 0
  s_mov_b32 s62, 0
  s_lshl_b32 s54, s17, 13
  s_mov_b32 s50, 0
  v_mov_b32 v4, 1
q_slow_59:
  s_nop 1
  s_nop 7
  v_cvt_pk_bf16_f32 v100, v52, v53
  v_cvt_pk_bf16_f32 v101, v54, v55
  v_cvt_pk_bf16_f32 v102, v60, v61
  v_cvt_pk_bf16_f32 v103, v62, v63
  buffer_store_dwordx4 v[100:103], v8, s[4:7], s43 offen offset:0 sc1
  v_cvt_pk_bf16_f32 v104, v56, v57
  v_cvt_pk_bf16_f32 v105, v58, v59
  v_cvt_pk_bf16_f32 v106, v64, v65
  v_cvt_pk_bf16_f32 v107, v66, v67
  buffer_store_dwordx4 v[104:107], v8, s[4:7], s43 offen offset:512 sc1
  s_mov_b32 s43, 268435456
  s_xor_b32 s50, s50, 32768
  s_cmp_lg_u32 s62, 0
  s_cbranch_scc1 q_patch_64
  s_cmp_ge_u32 s47, 128
  s_cbranch_scc1 q_end_60
  s_cmp_lg_u32 s48, 0
  s_cbranch_scc1 q_have_61
  s_mov_b32 s53, 0
q_poll_62:
  s_cmp_lt_u32 s47, 64
  s_cselect_b32 s26, 2, 0
  s_add_u32 s26, s26, s47
  s_lshl_b32 s26, s26, 12
  s_add_u32 s26, s26, 243261440
  s_mov_b64 exec, 0xffffff
  buffer_load_dword v116, v7, s[4:7], s26 offen sc1
  s_mov_b64 exec, -1
  s_add_u32 s53, s53, 1
  s_cmp_gt_u32 s53, 1048576
  s_cbranch_scc1 q_fail_63
  s_waitcnt vmcnt(0)
  s_mov_b64 exec, 1
  buffer_store_dword v4, off, s[4:7], s49 sc1
  s_mov_b64 exec, -1
  s_mov_b32 s49, 268435456
  v_cmp_eq_u32 vcc, 0, v116
  s_nop 0
  s_and_b32 s26, vcc_lo, 0xffffff
  s_cbranch_scc1 q_poll_62
  s_and_b32 s63, s47, 127
  s_lshl_b32 s63, s63, 15
  s_xor_b32 s27, s50, 32768
  s_add_u32 m0, s27, s54
  s_add_u32 s63, s63, s54
  s_add_u32 s63, s63, 6291456
  buffer_load_dwordx4 v12, s[4:7], s63 offen offset:0 sc1 lds
  buffer_load_dwordx4 v13, s[4:7], s63 offen offset:1024 sc1 lds
  buffer_load_dwordx4 v14, s[4:7], s63 offen offset:2048 sc1 lds
  buffer_load_dwordx4 v15, s[4:7], s63 offen offset:3072 sc1 lds
  s_add_u32 m0, m0, 4096
  s_add_u32 s63, s63, 4096
  buffer_load_dwordx4 v16, s[4:7], s63 offen offset:0 sc1 lds
  buffer_load_dwordx4 v17, s[4:7], s63 offen offset:1024 sc1 lds
  buffer_load_dwordx4 v18, s[4:7], s63 offen offset:2048 sc1 lds
  buffer_load_dwordx4 v19, s[4:7], s63 offen offset:3072 sc1 lds
  v_cmp_eq_u32 vcc, 0, v116
  v_max_u32_dpp v117, v116, v116 quad_perm:[1,0,3,2] row_mask:0xf bank_mask:0xf
  s_and_b32 s48, vcc_lo, 0xffffff
  s_cselect_b32 s48, 0, -1
  v_max_u32_dpp v117, v117, v117 quad_perm:[2,3,0,1] row_mask:0xf bank_mask:0xf
  s_nop 1
  v_max_u32_dpp v117, v117, v117 row_half_mirror row_mask:0xf bank_mask:0xf
  v_and_b32 v117, s48, v117
q_have_61:
  ds_write_b32 v118, v117 offset:256
  s_xor_b32 s50, s50, 32768
  s_waitcnt lgkmcnt(0)
  s_barrier
  ds_read_b128 v[108:111], v119 offset:256
  s_cmp_lt_u32 s47, 64
  s_cbranch_scc1 q_nopre_65
  s_waitcnt lgkmcnt(0)
  v_min3_u32 v112, v108, v109, v110
  v_max3_u32 v108, v108, v109, v110
  v_min_u32 v112, v112, v111
  v_max_u32 v108, v108, v111
  v_readfirstlane_b32 s45, v112
  v_readlane_b32 s28, v108, 0
  v_readlane_b32 s29, v108, 1
  v_readlane_b32 s30, v108, 2
  s_cmp_gt_u32 s28, s56
  s_cselect_b32 s26, s40, 0
  s_max_u32 s56, s56, s28
  s_cmp_gt_u32 s26, 10
  s_subb_u32 s40, s40, 0
  s_cmp_gt_u32 s29, s56
  s_cselect_b32 s26, s40, 0
  s_max_u32 s56, s56, s29
  s_cmp_gt_u32 s26, 10
  s_subb_u32 s40, s40, 0
  s_cmp_gt_u32 s30, s56
  s_cselect_b32 s26, s40, 0
  s_max_u32 s56, s56, s30
  s_add_u32 s76, s47, s40
  s_add_u32 s41, s47, 3
  s_sub_u32 s76, s76, 64
  s_cmp_gt_u32 s26, 10
  s_cselect_b32 s76, 64, s76
  s_subb_u32 s40, s40, 0
  s_cmp_lt_u32 s76, 64
  s_cselect_b32 s76, s76, s41
  s_cmp_lg_u32 s26, 0
  s_cbranch_scc1 q_fork_66
q_nopre_65:
  s_waitcnt vmcnt(0)
  s_sub_u32 s26, s47, s60
  s_cmp_lg_u32 s26, 9
  s_cbranch_scc1 q_cold_67
  v_mbcnt_lo_u32_b32 v20, -1, 0
  v_and_b32 v20, 0, v20
  v_add_lshl_u32 v20, v20, 2, 2
  s_mov_b32 s26, 0
g_wt_73:
  global_load_dword v21, v20, s[12:13] offset:128 sc1
  s_add_u32 s26, s26, 1
  s_cmp_gt_u32 s26, 1048576
  s_cbranch_scc1 L_end
  s_waitcnt vmcnt(0)
  v_cmp_eq_u32 vcc, 0, v21
  v_readfirstlane_b32 s27, v21
  s_cbranch_vccnz g_wt_73
  s_load_dwordx2 s[64:65], s[0:1], 72
  s_load_dwordx2 s[68:69], s[0:1], 80
  s_load_dwordx2 s[8:9], s[0:1], 88
  s_mov_b32 s66, 1835008
  s_mov_b32 s70, 1835008
  s_mov_b32 s10, 1835008
  v_lshrrev_b32 v2, 8, v0
  v_and_b32 v3, 0x70, v0
  s_mov_b32 s26, 114688
  v_mul_lo_u32 v6, v2, s26
  v_add_u32 v6, v6, v3
  v_cmp_eq_u32 vcc, 0x70, v3
  v_mov_b32 v3, 0x7ff00000
  s_nop 0
  v_cndmask_b32 v6, v6, v3, vcc
  v_mul_u32_u24 v7, 14336, v2
  v_and_b32 v3, 0xf0, v0
  v_add_u32 v7, v7, v3
  s_mul_i32 s34, s17, 458752
  s_mul_i32 s27, s16, 112
  s_add_u32 s34, s34, s27
  s_add_u32 s34, s34, 0
  s_mul_i32 s35, s16, 57344
  s_lshl_b32 s27, s17, 8
  s_add_u32 s35, s35, s27
  s_mov_b32 s36, 0x00ff00ff
  s_mov_b32 s37, 0x00ff00ff
  s_waitcnt lgkmcnt(0)
  s_mul_i32 s26, s17, 23552
  s_add_u32 m0, s26, 65536
  s_mov_b64 exec, s[36:37]
  buffer_load_dwordx4 v6, s[64:67], s34 offen lds
  s_not_b64 exec, exec
  buffer_load_dwordx4 v6, s[68:71], s34 offen lds
  s_add_u32 s34, s34, 3584
  s_add_u32 m0, m0, 1024
  s_mov_b64 exec, s[36:37]
  buffer_load_dwordx4 v6, s[64:67], s34 offen lds
  s_not_b64 exec, exec
  buffer_load_dwordx4 v6, s[68:71], s34 offen lds
  s_add_u32 s34, s34, 3584
  s_add_u32 m0, m0, 1024
  s_mov_b64 exec, s[36:37]
  buffer_load_dwordx4 v6, s[64:67], s34 offen lds
  s_not_b64 exec, exec
  buffer_load_dwordx4 v6, s[68:71], s34 offen lds
  s_add_u32 s34, s34, 3584
  s_add_u32 m0, m0, 1024
  s_mov_b64 exec, s[36:37]
  buffer_load_dwordx4 v6, s[64:67], s34 offen lds
  s_not_b64 exec, exec
  buffer_load_dwordx4 v6, s[68:71], s34 offen lds
  s_add_u32 s34, s34, 3584
  s_add_u32 m0, m0, 1024
  s_mov_b64 exec, s[36:37]
  buffer_load_dwordx4 v6, s[64:67], s34 offen lds
  s_not_b64 exec, exec
  buffer_load_dwordx4 v6, s[68:71], s34 offen lds
  s_add_u32 s34, s34, 3584
  s_add_u32 m0, m0, 1024
  s_mov_b64 exec, s[36:37]
  buffer_load_dwordx4 v6, s[64:67], s34 offen lds
  s_not_b64 exec, exec
  buffer_load_dwordx4 v6, s[68:71], s34 offen lds
  s_add_u32 s34, s34, 3584
  s_add_u32 m0, m0, 1024
  s_mov_b64 exec, s[36:37]
  buffer_load_dwordx4 v6, s[64:67], s34 offen lds
  s_not_b64 exec, exec
  buffer_load_dwordx4 v6, s[68:71], s34 offen lds
  s_add_u32 s34, s34, 3584
  s_add_u32 m0, m0, 1024
  s_mov_b64 exec, s[36:37]
  buffer_load_dwordx4 v6, s[64:67], s34 offen lds
  s_not_b64 exec, exec
  buffer_load_dwordx4 v6, s[68:71], s34 offen lds
  s_add_u32 s34, s34, 3584
  s_add_u32 m0, m0, 1024
  s_mov_b64 exec, s[36:37]
  buffer_load_dwordx4 v6, s[64:67], s34 offen lds
  s_not_b64 exec, exec
  buffer_load_dwordx4 v6, s[68:71], s34 offen lds
  s_add_u32 s34, s34, 3584
  s_add_u32 m0, m0, 1024
  s_mov_b64 exec, s[36:37]
  buffer_load_dwordx4 v6, s[64:67], s34 offen lds
  s_not_b64 exec, exec
  buffer_load_dwordx4 v6, s[68:71], s34 offen lds
  s_add_u32 s34, s34, 3584
  s_add_u32 m0, m0, 1024
  s_mov_b64 exec, s[36:37]
  buffer_load_dwordx4 v6, s[64:67], s34 offen lds
  s_not_b64 exec, exec
  buffer_load_dwordx4 v6, s[68:71], s34 offen lds
  s_add_u32 s34, s34, 3584
  s_add_u32 m0, m0, 1024
  s_mov_b64 exec, s[36:37]
  buffer_load_dwordx4 v6, s[64:67], s34 offen lds
  s_not_b64 exec, exec
  buffer_load_dwordx4 v6, s[68:71], s34 offen lds
  s_add_u32 s34, s34, 3584
  s_add_u32 m0, m0, 1024
  s_mov_b64 exec, s[36:37]
  buffer_load_dwordx4 v6, s[64:67], s34 offen lds
  s_not_b64 exec, exec
  buffer_load_dwordx4 v6, s[68:71], s34 offen lds
  s_add_u32 s34, s34, 3584
  s_add_u32 m0, m0, 1024
  s_mov_b64 exec, s[36:37]
  buffer_load_dwordx4 v6, s[64:67], s34 offen lds
  s_not_b64 exec, exec
  buffer_load_dwordx4 v6, s[68:71], s34 offen lds
  s_add_u32 s34, s34, 3584
  s_add_u32 m0, m0, 1024
  s_mov_b64 exec, s[36:37]
  buffer_load_dwordx4 v6, s[64:67], s34 offen lds
  s_not_b64 exec, exec
  buffer_load_dwordx4 v6, s[68:71], s34 offen lds
  s_add_u32 s34, s34, 3584
  s_add_u32 m0, m0, 1024
  s_mov_b64 exec, s[36:37]
  buffer_load_dwordx4 v6, s[64:67], s34 offen lds
  s_not_b64 exec, exec
  buffer_load_dwordx4 v6, s[68:71], s34 offen lds
  s_add_u32 s34, s34, 3584
  s_add_u32 m0, m0, 1024
  s_mov_b64 exec, s[36:37]
  buffer_load_dwordx4 v6, s[64:67], s34 offen lds
  s_not_b64 exec, exec
  buffer_load_dwordx4 v6, s[68:71], s34 offen lds
  s_add_u32 s34, s34, 3584
  s_add_u32 m0, m0, 1024
  s_mov_b64 exec, s[36:37]
  buffer_load_dwordx4 v6, s[64:67], s34 offen lds
  s_not_b64 exec, exec
  buffer_load_dwordx4 v6, s[68:71], s34 offen lds
  s_add_u32 s34, s34, 3584
  s_add_u32 m0, m0, 1024
  s_mov_b64 exec, s[36:37]
  buffer_load_dwordx4 v6, s[64:67], s34 offen lds
  s_not_b64 exec, exec
  buffer_load_dwordx4 v6, s[68:71], s34 offen lds
  s_add_u32 s34, s34, 3584
  s_add_u32 m0, m0, 1024
  s_mov_b64 exec, s[36:37]
  buffer_load_dwordx4 v6, s[64:67], s34 offen lds
  s_not_b64 exec, exec
  buffer_load_dwordx4 v6, s[68:71], s34 offen lds
  s_add_u32 s34, s34, 3584
  s_add_u32 m0, m0, 1024
  s_mov_b64 exec, s[36:37]
  buffer_load_dwordx4 v6, s[64:67], s34 offen lds
  s_not_b64 exec, exec
  buffer_load_dwordx4 v6, s[68:71], s34 offen lds
  s_add_u32 s34, s34, 3584
  s_add_u32 m0, m0, 1024
  s_mov_b64 exec, s[36:37]
  buffer_load_dwordx4 v6, s[64:67], s34 offen lds
  s_not_b64 exec, exec
  buffer_load_dwordx4 v6, s[68:71], s34 offen lds
  s_add_u32 s34, s34, 3584
  s_add_u32 m0, m0, 1024
  s_mov_b64 exec, s[36:37]
  buffer_load_dwordx4 v6, s[64:67], s34 offen lds
  s_not_b64 exec, exec
  buffer_load_dwordx4 v6, s[68:71], s34 offen lds
  s_add_u32 s34, s34, 3584
  s_add_u32 m0, m0, 1024
  s_mov_b64 exec, -1
  v_lshrrev_b32 v7, 7, v0
  v_lshlrev_b32 v7, 12, v7
  v_and_b32 v2, 1023, v9
  s_lshl_b32 s26, s17, 10
  v_add3_u32 v7, v7, v2, s26
  v_mov_b32 v116, 0
q_cold_67:
  s_waitcnt lgkmcnt(0)
  s_barrier
  s_cmp_lg_u32 s50, 0
  s_cbranch_scc1 q_c1_70
q_c0_69:
  ds_read_b128 v[68:71], v120 offset:0
  ds_read_b128 v[72:75], v121 offset:0
  ds_read_b128 v[76:79], v122 offset:0
q_w0_71:
  s_waitcnt lgkmcnt(2)
  v_mfma_f32_32x32x16_bf16 v[20:35], v[128:131], v[68:71], 0
  ds_read_b128 v[80:83], v123 offset:0
  s_mov_b32 s46, s47
  s_mov_b32 s47, s76
  s_lshl_b32 s52, s46, 7
  s_add_u32 s52, s52, s57
  s_lshl_b32 s44, s52, 12
  v_mfma_f32_32x32x16_bf16 v[36:51], v[68:71], a[0:3], 0
  s_add_u32 s44, s44, 41943040
  v_cvt_pk_bf16_f32 v100, v52, v53
  v_cvt_pk_bf16_f32 v101, v54, v55
  v_cvt_pk_bf16_f32 v102, v60, v61
  v_cvt_pk_bf16_f32 v103, v62, v63
  s_waitcnt lgkmcnt(2)
  v_mfma_f32_32x32x16_bf16 v[20:35], v[132:135], v[72:75], v[20:35]
  ds_read_b128 v[84:87], v124 offset:0
  buffer_store_dwordx4 v[100:103], v8, s[4:7], s43 offen offset:0 sc1
  v_cvt_pk_bf16_f32 v104, v56, v57
  v_cvt_pk_bf16_f32 v105, v58, v59
  v_mfma_f32_32x32x16_bf16 v[36:51], v[72:75], a[4:7], v[36:51]
  v_cvt_pk_bf16_f32 v106, v64, v65
  v_cvt_pk_bf16_f32 v107, v66, v67
  s_waitcnt lgkmcnt(2)
  v_mfma_f32_32x32x16_bf16 v[20:35], v[136:139], v[76:79], v[20:35]
  ds_read_b128 v[88:91], v125 offset:0
  buffer_store_dwordx4 v[104:107], v8, s[4:7], s43 offen offset:512 sc1
  s_lshl_b32 s43, s52, 11
  s_add_u32 s43, s43, 142606336
  v_mfma_f32_32x32x16_bf16 v[36:51], v[76:79], a[8:11], v[36:51]
  s_lshl_b32 s51, s52, 5
  s_add_u32 s51, s51, 244318208
  s_lshr_b32 s55, s47, 7
  s_or_b32 s55, s55, s62
  s_sub_u32 s27, s47, s60
  s_cmp_eq_u32 s27, 9
  s_cselect_b32 s55, 1, s55
  s_waitcnt lgkmcnt(2)
  v_mfma_f32_32x32x16_bf16 v[20:35], v[140:143], v[80:83], v[20:35]
  ds_read_b128 v[92:95], v126 offset:0
  s_add_u32 s76, s47, 3
  s_cmp_lt_u32 s76, 18
  s_cselect_b32 s76, s76, s41
  v_mfma_f32_32x32x16_bf16 v[36:51], v[80:83], a[12:15], v[36:51]
  s_waitcnt lgkmcnt(2)
  v_mfma_f32_32x32x16_bf16 v[20:35], v[144:147], v[84:87], v[20:35]
  ds_read_b128 v[96:99], v127 offset:0
  v_mfma_f32_32x32x16_bf16 v[36:51], v[84:87], a[16:19], v[36:51]
  s_waitcnt lgkmcnt(2)
  v_mfma_f32_32x32x16_bf16 v[20:35], v[148:151], v[88:91], v[20:35]
  ds_read_b128 v[68:71], v120 offset:256
  v_mfma_f32_32x32x16_bf16 v[36:51], v[88:91], a[20:23], v[36:51]
  s_waitcnt lgkmcnt(2)
  v_mfma_f32_32x32x16_bf16 v[20:35], v[152:155], v[92:95], v[20:35]
  ds_read_b128 v[72:75], v121 offset:256
  s_cmp_lt_u32 s47, 64
  s_cselect_b32 s26, 2, 0
  s_add_u32 s26, s26, s47
  s_lshl_b32 s26, s26, 12
  s_add_u32 s26, s26, 243261440
  v_mfma_f32_32x32x16_bf16 v[36:51], v[92:95], a[24:27], v[36:51]
  s_mov_b64 exec, 0xffffff
  buffer_load_dword v116, v7, s[4:7], s26 offen sc1
  s_mov_b64 exec, -1
  s_waitcnt lgkmcnt(2)
  v_mfma_f32_32x32x16_bf16 v[20:35], v[156:159], v[96:99], v[20:35]
  ds_read_b128 v[76:79], v122 offset:256
  v_mfma_f32_32x32x16_bf16 v[36:51], v[96:99], a[28:31], v[36:51]
  s_waitcnt lgkmcnt(2)
  v_mfma_f32_32x32x16_bf16 v[20:35], v[160:163], v[68:71], v[20:35]
  ds_read_b128 v[80:83], v123 offset:256
  v_mfma_f32_32x32x16_bf16 v[36:51], v[68:71], a[32:35], v[36:51]
  s_waitcnt lgkmcnt(2)
  v_mfma_f32_32x32x16_bf16 v[20:35], v[164:167], v[72:75], v[20:35]
  ds_read_b128 v[84:87], v124 offset:256
  v_mfma_f32_32x32x16_bf16 v[36:51], v[72:75], a[36:39], v[36:51]
  s_waitcnt lgkmcnt(2)
  v_mfma_f32_32x32x16_bf16 v[20:35], v[168:171], v[76:79], v[20:35]
  ds_read_b128 v[88:91], v125 offset:256
  v_mfma_f32_32x32x16_bf16 v[36:51], v[76:79], a[40:43], v[36:51]
  s_waitcnt lgkmcnt(2)
  v_mfma_f32_32x32x16_bf16 v[20:35], v[172:175], v[80:83], v[20:35]
  ds_read_b128 v[92:95], v126 offset:256
  v_mfma_f32_32x32x16_bf16 v[36:51], v[80:83], a[44:47], v[36:51]
  s_waitcnt lgkmcnt(2)
  v_mfma_f32_32x32x16_bf16 v[20:35], v[176:179], v[84:87], v[20:35]
  ds_read_b128 v[96:99], v127 offset:256
  v_mfma_f32_32x32x16_bf16 v[36:51], v[84:87], a[48:51], v[36:51]
  s_waitcnt lgkmcnt(2)
  v_mfma_f32_32x32x16_bf16 v[20:35], v[180:183], v[88:91], v[20:35]
  ds_read_b128 v[68:71], v120 offset:512
  v_mfma_f32_32x32x16_bf16 v[36:51], v[88:91], a[52:55], v[36:51]
  s_waitcnt lgkmcnt(2)
  v_mfma_f32_32x32x16_bf16 v[20:35], v[184:187], v[92:95], v[20:35]
  ds_read_b128 v[72:75], v121 offset:512
  v_mfma_f32_32x32x16_bf16 v[36:51], v[92:95], a[56:59], v[36:51]
  s_waitcnt lgkmcnt(2)
  v_mfma_f32_32x32x16_bf16 v[20:35], v[188:191], v[96:99], v[20:35]
  ds_read_b128 v[76:79], v122 offset:512
  v_mfma_f32_32x32x16_bf16 v[36:51], v[96:99], a[60:63], v[36:51]
  s_waitcnt lgkmcnt(2)
  v_mfma_f32_32x32x16_bf16 v[20:35], v[192:195], v[68:71], v[20:35]
  ds_read_b128 v[80:83], v123 offset:512
  v_mfma_f32_32x32x16_bf16 v[36:51], v[68:71], a[64:67], v[36:51]
  s_waitcnt lgkmcnt(2)
  v_mfma_f32_32x32x16_bf16 v[20:35], v[196:199], v[72:75], v[20:35]
  ds_read_b128 v[84:87], v124 offset:512
  v_mfma_f32_32x32x16_bf16 v[36:51], v[72:75], a[68:71], v[36:51]
  s_waitcnt lgkmcnt(2)
  v_mfma_f32_32x32x16_bf16 v[20:35], v[200:203], v[76:79], v[20:35]
  ds_read_b128 v[88:91], v125 offset:512
  v_mfma_f32_32x32x16_bf16 v[36:51], v[76:79], a[72:75], v[36:51]
  s_waitcnt lgkmcnt(2)
  v_mfma_f32_32x32x16_bf16 v[20:35], v[204:207], v[80:83], v[20:35]
  ds_read_b128 v[92:95], v126 offset:512
  s_waitcnt vmcnt(0)
  s_mov_b64 exec, 1
  buffer_store_dword v4, off, s[4:7], s49 sc1
  s_mov_b64 exec, -1
  v_mfma_f32_32x32x16_bf16 v[36:51], v[80:83], a[76:79], v[36:51]
  v_cmp_eq_u32 vcc, 0, v116
  v_max_u32_dpp v117, v116, v116 quad_perm:[1,0,3,2] row_mask:0xf bank_mask:0xf
  s_and_b32 s48, vcc_lo, 0xffffff
  s_cselect_b32 s48, 0, -1
  v_max_u32_dpp v117, v117, v117 quad_perm:[2,3,0,1] row_mask:0xf bank_mask:0xf
  s_nop 1
  s_waitcnt lgkmcnt(2)
  v_mfma_f32_32x32x16_bf16 v[20:35], v[208:211], v[84:87], v[20:35]
  ds_read_b128 v[96:99], v127 offset:512
  v_max_u32_dpp v117, v117, v117 row_half_mirror row_mask:0xf bank_mask:0xf
  v_and_b32 v117, s48, v117
  s_cmp_lg_u32 s48, 0
  s_cselect_b32 s28, s47, s46
  s_and_b32 s63, s28, 127
  v_mfma_f32_32x32x16_bf16 v[36:51], v[84:87], a[80:83], v[36:51]
  s_lshl_b32 s63, s63, 15
  s_xor_b32 s27, s50, 32768
  s_add_u32 m0, s27, s54
  s_add_u32 s63, s63, s54
  s_add_u32 s63, s63, 6291456
  s_waitcnt lgkmcnt(2)
  v_mfma_f32_32x32x16_bf16 v[20:35], v[212:215], v[88:91], v[20:35]
  ds_read_b128 v[68:71], v120 offset:768
  buffer_load_dwordx4 v12, s[4:7], s63 offen offset:0 sc1 lds
  v_mfma_f32_32x32x16_bf16 v[36:51], v[88:91], a[84:87], v[36:51]
  s_waitcnt lgkmcnt(2)
  v_mfma_f32_32x32x16_bf16 v[20:35], v[216:219], v[92:95], v[20:35]
  ds_read_b128 v[72:75], v121 offset:768
  buffer_load_dwordx4 v13, s[4:7], s63 offen offset:1024 sc1 lds
  v_mfma_f32_32x32x16_bf16 v[36:51], v[92:95], a[88:91], v[36:51]
  s_waitcnt lgkmcnt(2)
  v_mfma_f32_32x32x16_bf16 v[20:35], v[220:223], v[96:99], v[20:35]
  ds_read_b128 v[76:79], v122 offset:768
  buffer_load_dwordx4 v14, s[4:7], s63 offen offset:2048 sc1 lds
  v_mfma_f32_32x32x16_bf16 v[36:51], v[96:99], a[92:95], v[36:51]
  s_waitcnt lgkmcnt(2)
  v_mfma_f32_32x32x16_bf16 v[20:35], v[224:227], v[68:71], v[20:35]
  ds_read_b128 v[80:83], v123 offset:768
  buffer_load_dwordx4 v15, s[4:7], s63 offen offset:3072 sc1 lds
  s_add_u32 m0, m0, 4096
  s_add_u32 s63, s63, 4096
  v_mfma_f32_32x32x16_bf16 v[36:51], v[68:71], a[96:99], v[36:51]
  s_waitcnt lgkmcnt(2)
  v_mfma_f32_32x32x16_bf16 v[20:35], v[228:231], v[72:75], v[20:35]
  ds_read_b128 v[84:87], v124 offset:768
  buffer_load_dwordx4 v16, s[4:7], s63 offen offset:0 sc1 lds
  v_mfma_f32_32x32x16_bf16 v[36:51], v[72:75], a[100:103], v[36:51]
  s_waitcnt lgkmcnt(2)
  v_mfma_f32_32x32x16_bf16 v[20:35], v[232:235], v[76:79], v[20:35]
  ds_read_b128 v[88:91], v125 offset:768
  buffer_load_dwordx4 v17, s[4:7], s63 offen offset:1024 sc1 lds
  v_mfma_f32_32x32x16_bf16 v[36:51], v[76:79], a[104:107], v[36:51]
  s_waitcnt lgkmcnt(2)
  v_mfma_f32_32x32x16_bf16 v[20:35], v[236:239], v[80:83], v[20:35]
  ds_read_b128 v[92:95], v126 offset:768
  buffer_load_dwordx4 v18, s[4:7], s63 offen offset:2048 sc1 lds
  v_mfma_f32_32x32x16_bf16 v[36:51], v[80:83], a[108:111], v[36:51]
  s_waitcnt lgkmcnt(2)
  v_mfma_f32_32x32x16_bf16 v[20:35], v[240:243], v[84:87], v[20:35]
  ds_read_b128 v[96:99], v127 offset:768
  buffer_load_dwordx4 v19, s[4:7], s63 offen offset:3072 sc1 lds
  s_add_u32 s49, s51, 16
  s_add_u32 s26, s62, 1
  v_mfma_f32_32x32x16_bf16 v[36:51], v[84:87], a[112:115], v[36:51]
  v_mov_b32 v4, s26
  ds_write_b32 v118, v117 offset:0
  s_waitcnt lgkmcnt(3)
  v_mfma_f32_32x32x16_bf16 v[20:35], v[244:247], v[88:91], v[20:35]
  ds_read_b128 v[68:71], v120 offset:0
  v_mfma_f32_32x32x16_bf16 v[36:51], v[88:91], a[116:119], v[36:51]
  ds_read_b128 v[72:75], v121 offset:0
  s_waitcnt lgkmcnt(4)
  v_mfma_f32_32x32x16_bf16 v[20:35], v[248:251], v[92:95], v[20:35]
  ds_read_b128 v[76:79], v122 offset:0
  v_mfma_f32_32x32x16_bf16 v[36:51], v[92:95], a[120:123], v[36:51]
  ds_read_b128 v[80:83], v123 offset:0
  s_waitcnt lgkmcnt(5)
  v_mfma_f32_32x32x16_bf16 v[20:35], v[252:255], v[96:99], v[20:35]
  ds_read_b128 v[84:87], v124 offset:0
  v_mfma_f32_32x32x16_bf16 v[36:51], v[96:99], a[124:127], v[36:51]
  ds_read_b128 v[88:91], v125 offset:0
  s_waitcnt lgkmcnt(4)
  v_mfma_f32_32x32x16_bf16 v[52:67], a[128:131], v[68:71], 0
  ds_read_b128 v[92:95], v126 offset:0
  v_mfma_f32_32x32x16_bf16 v[52:67], a[132:135], v[72:75], v[52:67]
  ds_read_b128 v[96:99], v127 offset:0
  v_mul_f32 v20, s24, v20
  v_mul_f32 v21, s24, v21
  v_mul_f32 v22, s24, v22
  v_mul_f32 v23, s24, v23
  v_mul_f32 v24, s24, v24
  s_waitcnt lgkmcnt(4)
  v_mfma_f32_32x32x16_bf16 v[52:67], a[136:139], v[76:79], v[52:67]
  ds_read_b128 v[68:71], v120 offset:256
  v_mul_f32 v25, s24, v25
  v_cvt_pk_bf16_f32 v100, v36, v37
  v_cvt_pk_bf16_f32 v101, v38, v39
  v_cvt_pk_bf16_f32 v102, v44, v45
  v_cvt_pk_bf16_f32 v103, v46, v47
  v_mfma_f32_32x32x16_bf16 v[52:67], a[140:143], v[80:83], v[52:67]
  ds_read_b128 v[72:75], v121 offset:256
  buffer_store_dwordx4 v[100:103], v8, s[4:7], s44 offen offset:2048 sc1
  v_cvt_pk_bf16_f32 v104, v40, v41
  v_cvt_pk_bf16_f32 v105, v42, v43
  s_waitcnt lgkmcnt(4)
  v_mfma_f32_32x32x16_bf16 v[52:67], a[144:147], v[84:87], v[52:67]
  ds_read_b128 v[76:79], v122 offset:256
  v_cvt_pk_bf16_f32 v106, v48, v49
  v_cvt_pk_bf16_f32 v107, v50, v51
  buffer_store_dwordx4 v[104:107], v8, s[4:7], s44 offen offset:2560 sc1
  v_mfma_f32_32x32x16_bf16 v[52:67], a[148:151], v[88:91], v[52:67]
  ds_read_b128 v[80:83], v123 offset:256
  v_mul_f32 v26, s24, v26
  v_mul_f32 v27, s24, v27
  v_mul_f32 v28, s24, v28
  v_mul_f32 v29, s24, v29
  v_mul_f32 v30, s24, v30
  s_waitcnt lgkmcnt(4)
  v_mfma_f32_32x32x16_bf16 v[52:67], a[152:155], v[92:95], v[52:67]
  ds_read_b128 v[84:87], v124 offset:256
  v_mul_f32 v31, s24, v31
  v_mul_f32 v32, s24, v32
  v_mul_f32 v33, s24, v33
  v_mul_f32 v34, s24, v34
  v_mul_f32 v35, s24, v35
  v_mfma_f32_32x32x16_bf16 v[52:67], a[156:159], v[96:99], v[52:67]
  ds_read_b128 v[88:91], v125 offset:256
  v_cvt_pk_bf16_f32 v108, v20, v21
  v_cvt_pk_bf16_f32 v109, v22, v23
  v_cvt_pk_bf16_f32 v110, v28, v29
  v_cvt_pk_bf16_f32 v111, v30, v31
  buffer_store_dwordx4 v[108:111], v8, s[4:7], s44 offen offset:0 sc1
  s_waitcnt lgkmcnt(4)
  v_mfma_f32_32x32x16_bf16 v[52:67], a[160:163], v[68:71], v[52:67]
  ds_read_b128 v[92:95], v126 offset:256
  v_cvt_pk_bf16_f32 v112, v24, v25
  v_cvt_pk_bf16_f32 v113, v26, v27
  v_cvt_pk_bf16_f32 v114, v32, v33
  v_cvt_pk_bf16_f32 v115, v34, v35
  buffer_store_dwordx4 v[112:115], v8, s[4:7], s44 offen offset:512 sc1
  v_mfma_f32_32x32x16_bf16 v[52:67], a[164:167], v[72:75], v[52:67]
  ds_read_b128 v[96:99], v127 offset:256
  s_waitcnt lgkmcnt(4)
  v_mfma_f32_32x32x16_bf16 v[52:67], a[168:171], v[76:79], v[52:67]
  ds_read_b128 v[68:71], v120 offset:512
  v_mfma_f32_32x32x16_bf16 v[52:67], a[172:175], v[80:83], v[52:67]
  ds_read_b128 v[72:75], v121 offset:512
  s_waitcnt lgkmcnt(4)
  v_mfma_f32_32x32x16_bf16 v[52:67], a[176:179], v[84:87], v[52:67]
  ds_read_b128 v[76:79], v122 offset:512
  v_mfma_f32_32x32x16_bf16 v[52:67], a[180:183], v[88:91], v[52:67]
  ds_read_b128 v[80:83], v123 offset:512
  s_waitcnt lgkmcnt(4)
  v_mfma_f32_32x32x16_bf16 v[52:67], a[184:187], v[92:95], v[52:67]
  ds_read_b128 v[84:87], v124 offset:512
  v_mfma_f32_32x32x16_bf16 v[52:67], a[188:191], v[96:99], v[52:67]
  ds_read_b128 v[88:91], v125 offset:512
  s_waitcnt lgkmcnt(4)
  v_mfma_f32_32x32x16_bf16 v[52:67], a[192:195], v[68:71], v[52:67]
  ds_read_b128 v[92:95], v126 offset:512
  v_mfma_f32_32x32x16_bf16 v[52:67], a[196:199], v[72:75], v[52:67]
  ds_read_b128 v[96:99], v127 offset:512
  s_waitcnt lgkmcnt(4)
  v_mfma_f32_32x32x16_bf16 v[52:67], a[200:203], v[76:79], v[52:67]
  ds_read_b128 v[68:71], v120 offset:768
  v_mfma_f32_32x32x16_bf16 v[52:67], a[204:207], v[80:83], v[52:67]
  ds_read_b128 v[72:75], v121 offset:768
  s_waitcnt lgkmcnt(4)
  v_mfma_f32_32x32x16_bf16 v[52:67], a[208:211], v[84:87], v[52:67]
  ds_read_b128 v[76:79], v122 offset:768
  ds_read_b128 v[80:83], v123 offset:768
  v_mfma_f32_32x32x16_bf16 v[52:67], a[212:215], v[88:91], v[52:67]
  ds_read_b128 v[84:87], v124 offset:768
  ds_read_b128 v[88:91], v125 offset:768
  s_waitcnt lgkmcnt(6)
  v_mfma_f32_32x32x16_bf16 v[52:67], a[216:219], v[92:95], v[52:67]
  ds_read_b128 v[92:95], v126 offset:768
  v_mfma_f32_32x32x16_bf16 v[52:67], a[220:223], v[96:99], v[52:67]
  ds_read_b128 v[96:99], v127 offset:768
  s_waitcnt lgkmcnt(6)
  v_mfma_f32_32x32x16_bf16 v[52:67], a[224:227], v[68:71], v[52:67]
  v_mfma_f32_32x32x16_bf16 v[52:67], a[228:231], v[72:75], v[52:67]
  s_waitcnt vmcnt(4) lgkmcnt(0)
  s_barrier
  ds_read_b128 v[100:103], v119 offset:0
  v_mfma_f32_32x32x16_bf16 v[52:67], a[232:235], v[76:79], v[52:67]
  ds_read_b128 v[68:71], v120 offset:32768
  v_mfma_f32_32x32x16_bf16 v[52:67], a[236:239], v[80:83], v[52:67]
  ds_read_b128 v[72:75], v121 offset:32768
  s_xor_b32 s50, s50, 32768
  v_mfma_f32_32x32x16_bf16 v[52:67], a[240:243], v[84:87], v[52:67]
  ds_read_b128 v[76:79], v122 offset:32768
  s_waitcnt vmcnt(0)
  s_mov_b64 exec, 1
  buffer_store_dword v4, off, s[4:7], s51 sc1
  s_mov_b64 exec, -1
  v_mfma_f32_32x32x16_bf16 v[52:67], a[244:247], v[88:91], v[52:67]
  s_waitcnt lgkmcnt(3)
  v_min3_u32 v104, v100, v101, v102
  v_max3_u32 v100, v100, v101, v102
  v_min_u32 v104, v104, v103
  v_max_u32 v100, v100, v103
  v_readfirstlane_b32 s45, v104
  v_mfma_f32_32x32x16_bf16 v[52:67], a[248:251], v[92:95], v[52:67]
  v_readlane_b32 s28, v100, 0
  v_readlane_b32 s29, v100, 1
  v_readlane_b32 s30, v100, 2
  s_cmp_gt_u32 s55, 0
  s_cselect_b32 s45, 0, s45
  v_mfma_f32_32x32x16_bf16 v[52:67], a[252:255], v[96:99], v[52:67]
  s_cmp_eq_u32 s45, 0
  s_cbranch_scc1 q_slow_59
  s_cmp_lt_u32 s47, 64
  s_cbranch_scc1 q_w1_72
  s_cmp_gt_u32 s28, s56
  s_cselect_b32 s26, s40, 0
  s_max_u32 s56, s56, s28
  s_cmp_gt_u32 s26, 10
  s_subb_u32 s40, s40, 0
  s_cmp_gt_u32 s29, s56
  s_cselect_b32 s26, s40, 0
  s_max_u32 s56, s56, s29
  s_cmp_gt_u32 s26, 10
  s_subb_u32 s40, s40, 0
  s_cmp_gt_u32 s30, s56
  s_cselect_b32 s26, s40, 0
  s_max_u32 s56, s56, s30
  s_add_u32 s76, s47, s40
  s_add_u32 s41, s47, 3
  s_sub_u32 s76, s76, 64
  s_cmp_gt_u32 s26, 10
  s_cselect_b32 s76, 64, s76
  s_subb_u32 s40, s40, 0
  s_cmp_lt_u32 s76, 64
  s_cselect_b32 s76, s76, s41
  s_cmp_lg_u32 s26, 0
  s_cbranch_scc0 q_w1_72
  s_branch q_forkw_68
q_c1_70:
  ds_read_b128 v[68:71], v120 offset:32768
  ds_read_b128 v[72:75], v121 offset:32768
  ds_read_b128 v[76:79], v122 offset:32768
q_w1_72:
  s_waitcnt lgkmcnt(2)
  v_mfma_f32_32x32x16_bf16 v[20:35], v[128:131], v[68:71], 0
  ds_read_b128 v[80:83], v123 offset:32768
  s_mov_b32 s46, s47
  s_mov_b32 s47, s76
  s_lshl_b32 s52, s46, 7
  s_add_u32 s52, s52, s57
  s_lshl_b32 s44, s52, 12
  v_mfma_f32_32x32x16_bf16 v[36:51], v[68:71], a[0:3], 0
  s_add_u32 s44, s44, 41943040
  v_cvt_pk_bf16_f32 v100, v52, v53
  v_cvt_pk_bf16_f32 v101, v54, v55
  v_cvt_pk_bf16_f32 v102, v60, v61
  v_cvt_pk_bf16_f32 v103, v62, v63
  s_waitcnt lgkmcnt(2)
  v_mfma_f32_32x32x16_bf16 v[20:35], v[132:135], v[72:75], v[20:35]
  ds_read_b128 v[84:87], v124 offset:32768
  buffer_store_dwordx4 v[100:103], v8, s[4:7], s43 offen offset:0 sc1
  v_cvt_pk_bf16_f32 v104, v56, v57
  v_cvt_pk_bf16_f32 v105, v58, v59
  v_mfma_f32_32x32x16_bf16 v[36:51], v[72:75], a[4:7], v[36:51]
  v_cvt_pk_bf16_f32 v106, v64, v65
  v_cvt_pk_bf16_f32 v107, v66, v67
  s_waitcnt lgkmcnt(2)
  v_mfma_f32_32x32x16_bf16 v[20:35], v[136:139], v[76:79], v[20:35]
  ds_read_b128 v[88:91], v125 offset:32768
  buffer_store_dwordx4 v[104:107], v8, s[4:7], s43 offen offset:512 sc1
  s_lshl_b32 s43, s52, 11
  s_add_u32 s43, s43, 142606336
  v_mfma_f32_32x32x16_bf16 v[36:51], v[76:79], a[8:11], v[36:51]
  s_lshl_b32 s51, s52, 5
  s_add_u32 s51, s51, 244318208
  s_lshr_b32 s55, s47, 7
  s_or_b32 s55, s55, s62
  s_sub_u32 s27, s47, s60
  s_cmp_eq_u32 s27, 9
  s_cselect_b32 s55, 1, s55
  s_waitcnt lgkmcnt(2)
  v_mfma_f32_32x32x16_bf16 v[20:35], v[140:143], v[80:83], v[20:35]
  ds_read_b128 v[92:95], v126 offset:32768
  s_add_u32 s76, s47, 3
  s_cmp_lt_u32 s76, 18
  s_cselect_b32 s76, s76, s41
  v_mfma_f32_32x32x16_bf16 v[36:51], v[80:83], a[12:15], v[36:51]
  s_waitcnt lgkmcnt(2)
  v_mfma_f32_32x32x16_bf16 v[20:35], v[144:147], v[84:87], v[20:35]
  ds_read_b128 v[96:99], v127 offset:32768
  v_mfma_f32_32x32x16_bf16 v[36:51], v[84:87], a[16:19], v[36:51]
  s_waitcnt lgkmcnt(2)
  v_mfma_f32_32x32x16_bf16 v[20:35], v[148:151], v[88:91], v[20:35]
  ds_read_b128 v[68:71], v120 offset:33024
  v_mfma_f32_32x32x16_bf16 v[36:51], v[88:91], a[20:23], v[36:51]
  s_waitcnt lgkmcnt(2)
  v_mfma_f32_32x32x16_bf16 v[20:35], v[152:155], v[92:95], v[20:35]
  ds_read_b128 v[72:75], v121 offset:33024
  s_cmp_lt_u32 s47, 64
  s_cselect_b32 s26, 2, 0
  s_add_u32 s26, s26, s47
  s_lshl_b32 s26, s26, 12
  s_add_u32 s26, s26, 243261440
  v_mfma_f32_32x32x16_bf16 v[36:51], v[92:95], a[24:27], v[36:51]
  s_mov_b64 exec, 0xffffff
  buffer_load_dword v116, v7, s[4:7], s26 offen sc1
  s_mov_b64 exec, -1
  s_waitcnt lgkmcnt(2)
  v_mfma_f32_32x32x16_bf16 v[20:35], v[156:159], v[96:99], v[20:35]
  ds_read_b128 v[76:79], v122 offset:33024
  v_mfma_f32_32x32x16_bf16 v[36:51], v[96:99], a[28:31], v[36:51]
  s_waitcnt lgkmcnt(2)
  v_mfma_f32_32x32x16_bf16 v[20:35], v[160:163], v[68:71], v[20:35]
  ds_read_b128 v[80:83], v123 offset:33024
  v_mfma_f32_32x32x16_bf16 v[36:51], v[68:71], a[32:35], v[36:51]
  s_waitcnt lgkmcnt(2)
  v_mfma_f32_32x32x16_bf16 v[20:35], v[164:167], v[72:75], v[20:35]
  ds_read_b128 v[84:87], v124 offset:33024
  v_mfma_f32_32x32x16_bf16 v[36:51], v[72:75], a[36:39], v[36:51]
  s_waitcnt lgkmcnt(2)
  v_mfma_f32_32x32x16_bf16 v[20:35], v[168:171], v[76:79], v[20:35]
  ds_read_b128 v[88:91], v125 offset:33024
  v_mfma_f32_32x32x16_bf16 v[36:51], v[76:79], a[40:43], v[36:51]
  s_waitcnt lgkmcnt(2)
  v_mfma_f32_32x32x16_bf16 v[20:35], v[172:175], v[80:83], v[20:35]
  ds_read_b128 v[92:95], v126 offset:33024
  v_mfma_f32_32x32x16_bf16 v[36:51], v[80:83], a[44:47], v[36:51]
  s_waitcnt lgkmcnt(2)
  v_mfma_f32_32x32x16_bf16 v[20:35], v[176:179], v[84:87], v[20:35]
  ds_read_b128 v[96:99], v127 offset:33024
  v_mfma_f32_32x32x16_bf16 v[36:51], v[84:87], a[48:51], v[36:51]
  s_waitcnt lgkmcnt(2)
  v_mfma_f32_32x32x16_bf16 v[20:35], v[180:183], v[88:91], v[20:35]
  ds_read_b128 v[68:71], v120 offset:33280
  v_mfma_f32_32x32x16_bf16 v[36:51], v[88:91], a[52:55], v[36:51]
  s_waitcnt lgkmcnt(2)
  v_mfma_f32_32x32x16_bf16 v[20:35], v[184:187], v[92:95], v[20:35]
  ds_read_b128 v[72:75], v121 offset:33280
  v_mfma_f32_32x32x16_bf16 v[36:51], v[92:95], a[56:59], v[36:51]
  s_waitcnt lgkmcnt(2)
  v_mfma_f32_32x32x16_bf16 v[20:35], v[188:191], v[96:99], v[20:35]
  ds_read_b128 v[76:79], v122 offset:33280
  v_mfma_f32_32x32x16_bf16 v[36:51], v[96:99], a[60:63], v[36:51]
  s_waitcnt lgkmcnt(2)
  v_mfma_f32_32x32x16_bf16 v[20:35], v[192:195], v[68:71], v[20:35]
  ds_read_b128 v[80:83], v123 offset:33280
  v_mfma_f32_32x32x16_bf16 v[36:51], v[68:71], a[64:67], v[36:51]
  s_waitcnt lgkmcnt(2)
  v_mfma_f32_32x32x16_bf16 v[20:35], v[196:199], v[72:75], v[20:35]
  ds_read_b128 v[84:87], v124 offset:33280
  v_mfma_f32_32x32x16_bf16 v[36:51], v[72:75], a[68:71], v[36:51]
  s_waitcnt lgkmcnt(2)
  v_mfma_f32_32x32x16_bf16 v[20:35], v[200:203], v[76:79], v[20:35]
  ds_read_b128 v[88:91], v125 offset:33280
  v_mfma_f32_32x32x16_bf16 v[36:51], v[76:79], a[72:75], v[36:51]
  s_waitcnt lgkmcnt(2)
  v_mfma_f32_32x32x16_bf16 v[20:35], v[204:207], v[80:83], v[20:35]
  ds_read_b128 v[92:95], v126 offset:33280
  s_waitcnt vmcnt(0)
  s_mov_b64 exec, 1
  buffer_store_dword v4, off, s[4:7], s49 sc1
  s_mov_b64 exec, -1
  v_mfma_f32_32x32x16_bf16 v[36:51], v[80:83], a[76:79], v[36:51]
  v_cmp_eq_u32 vcc, 0, v116
  v_max_u32_dpp v117, v116, v116 quad_perm:[1,0,3,2] row_mask:0xf bank_mask:0xf
  s_and_b32 s48, vcc_lo, 0xffffff
  s_cselect_b32 s48, 0, -1
  v_max_u32_dpp v117, v117, v117 quad_perm:[2,3,0,1] row_mask:0xf bank_mask:0xf
  s_nop 1
  s_waitcnt lgkmcnt(2)
  v_mfma_f32_32x32x16_bf16 v[20:35], v[208:211], v[84:87], v[20:35]
  ds_read_b128 v[96:99], v127 offset:33280
  v_max_u32_dpp v117, v117, v117 row_half_mirror row_mask:0xf bank_mask:0xf
  v_and_b32 v117, s48, v117
  s_cmp_lg_u32 s48, 0
  s_cselect_b32 s28, s47, s46
  s_and_b32 s63, s28, 127
  v_mfma_f32_32x32x16_bf16 v[36:51], v[84:87], a[80:83], v[36:51]
  s_lshl_b32 s63, s63, 15
  s_xor_b32 s27, s50, 32768
  s_add_u32 m0, s27, s54
  s_add_u32 s63, s63, s54
  s_add_u32 s63, s63, 6291456
  s_waitcnt lgkmcnt(2)
  v_mfma_f32_32x32x16_bf16 v[20:35], v[212:215], v[88:91], v[20:35]
  ds_read_b128 v[68:71], v120 offset:33536
  buffer_load_dwordx4 v12, s[4:7], s63 offen offset:0 sc1 lds
  v_mfma_f32_32x32x16_bf16 v[36:51], v[88:91], a[84:87], v[36:51]
  s_waitcnt lgkmcnt(2)
  v_mfma_f32_32x32x16_bf16 v[20:35], v[216:219], v[92:95], v[20:35]
  ds_read_b128 v[72:75], v121 offset:33536
  buffer_load_dwordx4 v13, s[4:7], s63 offen offset:1024 sc1 lds
  v_mfma_f32_32x32x16_bf16 v[36:51], v[92:95], a[88:91], v[36:51]
  s_waitcnt lgkmcnt(2)
  v_mfma_f32_32x32x16_bf16 v[20:35], v[220:223], v[96:99], v[20:35]
  ds_read_b128 v[76:79], v122 offset:33536
  buffer_load_dwordx4 v14, s[4:7], s63 offen offset:2048 sc1 lds
  v_mfma_f32_32x32x16_bf16 v[36:51], v[96:99], a[92:95], v[36:51]
  s_waitcnt lgkmcnt(2)
  v_mfma_f32_32x32x16_bf16 v[20:35], v[224:227], v[68:71], v[20:35]
  ds_read_b128 v[80:83], v123 offset:33536
  buffer_load_dwordx4 v15, s[4:7], s63 offen offset:3072 sc1 lds
  s_add_u32 m0, m0, 4096
  s_add_u32 s63, s63, 4096
  v_mfma_f32_32x32x16_bf16 v[36:51], v[68:71], a[96:99], v[36:51]
  s_waitcnt lgkmcnt(2)
  v_mfma_f32_32x32x16_bf16 v[20:35], v[228:231], v[72:75], v[20:35]
  ds_read_b128 v[84:87], v124 offset:33536
  buffer_load_dwordx4 v16, s[4:7], s63 offen offset:0 sc1 lds
  v_mfma_f32_32x32x16_bf16 v[36:51], v[72:75], a[100:103], v[36:51]
  s_waitcnt lgkmcnt(2)
  v_mfma_f32_32x32x16_bf16 v[20:35], v[232:235], v[76:79], v[20:35]
  ds_read_b128 v[88:91], v125 offset:33536
  buffer_load_dwordx4 v17, s[4:7], s63 offen offset:1024 sc1 lds
  v_mfma_f32_32x32x16_bf16 v[36:51], v[76:79], a[104:107], v[36:51]
  s_waitcnt lgkmcnt(2)
  v_mfma_f32_32x32x16_bf16 v[20:35], v[236:239], v[80:83], v[20:35]
  ds_read_b128 v[92:95], v126 offset:33536
  buffer_load_dwordx4 v18, s[4:7], s63 offen offset:2048 sc1 lds
  v_mfma_f32_32x32x16_bf16 v[36:51], v[80:83], a[108:111], v[36:51]
  s_waitcnt lgkmcnt(2)
  v_mfma_f32_32x32x16_bf16 v[20:35], v[240:243], v[84:87], v[20:35]
  ds_read_b128 v[96:99], v127 offset:33536
  buffer_load_dwordx4 v19, s[4:7], s63 offen offset:3072 sc1 lds
  s_add_u32 s49, s51, 16
  s_add_u32 s26, s62, 1
  v_mfma_f32_32x32x16_bf16 v[36:51], v[84:87], a[112:115], v[36:51]
  v_mov_b32 v4, s26
  ds_write_b32 v118, v117 offset:128
  s_waitcnt lgkmcnt(3)
  v_mfma_f32_32x32x16_bf16 v[20:35], v[244:247], v[88:91], v[20:35]
  ds_read_b128 v[68:71], v120 offset:32768
  v_mfma_f32_32x32x16_bf16 v[36:51], v[88:91], a[116:119], v[36:51]
  ds_read_b128 v[72:75], v121 offset:32768
  s_waitcnt lgkmcnt(4)
  v_mfma_f32_32x32x16_bf16 v[20:35], v[248:251], v[92:95], v[20:35]
  ds_read_b128 v[76:79], v122 offset:32768
  v_mfma_f32_32x32x16_bf16 v[36:51], v[92:95], a[120:123], v[36:51]
  ds_read_b128 v[80:83], v123 offset:32768
  s_waitcnt lgkmcnt(5)
  v_mfma_f32_32x32x16_bf16 v[20:35], v[252:255], v[96:99], v[20:35]
  ds_read_b128 v[84:87], v124 offset:32768
  v_mfma_f32_32x32x16_bf16 v[36:51], v[96:99], a[124:127], v[36:51]
  ds_read_b128 v[88:91], v125 offset:32768
  s_waitcnt lgkmcnt(4)
  v_mfma_f32_32x32x16_bf16 v[52:67], a[128:131], v[68:71], 0
  ds_read_b128 v[92:95], v126 offset:32768
  v_mfma_f32_32x32x16_bf16 v[52:67], a[132:135], v[72:75], v[52:67]
  ds_read_b128 v[96:99], v127 offset:32768
  v_mul_f32 v20, s24, v20
  v_mul_f32 v21, s24, v21
  v_mul_f32 v22, s24, v22
  v_mul_f32 v23, s24, v23
  v_mul_f32 v24, s24, v24
  s_waitcnt lgkmcnt(4)
  v_mfma_f32_32x32x16_bf16 v[52:67], a[136:139], v[76:79], v[52:67]
  ds_read_b128 v[68:71], v120 offset:33024
  v_mul_f32 v25, s24, v25
  v_cvt_pk_bf16_f32 v100, v36, v37
  v_cvt_pk_bf16_f32 v101, v38, v39
  v_cvt_pk_bf16_f32 v102, v44, v45
  v_cvt_pk_bf16_f32 v103, v46, v47
  v_mfma_f32_32x32x16_bf16 v[52:67], a[140:143], v[80:83], v[52:67]
  ds_read_b128 v[72:75], v121 offset:33024
  buffer_store_dwordx4 v[100:103], v8, s[4:7], s44 offen offset:2048 sc1
  v_cvt_pk_bf16_f32 v104, v40, v41
  v_cvt_pk_bf16_f32 v105, v42, v43
  s_waitcnt lgkmcnt(4)
  v_mfma_f32_32x32x16_bf16 v[52:67], a[144:147], v[84:87], v[52:67]
  ds_read_b128 v[76:79], v122 offset:33024
  v_cvt_pk_bf16_f32 v106, v48, v49
  v_cvt_pk_bf16_f32 v107, v50, v51
  buffer_store_dwordx4 v[104:107], v8, s[4:7], s44 offen offset:2560 sc1
  v_mfma_f32_32x32x16_bf16 v[52:67], a[148:151], v[88:91], v[52:67]
  ds_read_b128 v[80:83], v123 offset:33024
  v_mul_f32 v26, s24, v26
  v_mul_f32 v27, s24, v27
  v_mul_f32 v28, s24, v28
  v_mul_f32 v29, s24, v29
  v_mul_f32 v30, s24, v30
  s_waitcnt lgkmcnt(4)
  v_mfma_f32_32x32x16_bf16 v[52:67], a[152:155], v[92:95], v[52:67]
  ds_read_b128 v[84:87], v124 offset:33024
  v_mul_f32 v31, s24, v31
  v_mul_f32 v32, s24, v32
  v_mul_f32 v33, s24, v33
  v_mul_f32 v34, s24, v34
  v_mul_f32 v35, s24, v35
  v_mfma_f32_32x32x16_bf16 v[52:67], a[156:159], v[96:99], v[52:67]
  ds_read_b128 v[88:91], v125 offset:33024
  v_cvt_pk_bf16_f32 v108, v20, v21
  v_cvt_pk_bf16_f32 v109, v22, v23
  v_cvt_pk_bf16_f32 v110, v28, v29
  v_cvt_pk_bf16_f32 v111, v30, v31
  buffer_store_dwordx4 v[108:111], v8, s[4:7], s44 offen offset:0 sc1
  s_waitcnt lgkmcnt(4)
  v_mfma_f32_32x32x16_bf16 v[52:67], a[160:163], v[68:71], v[52:67]
  ds_read_b128 v[92:95], v126 offset:33024
  v_cvt_pk_bf16_f32 v112, v24, v25
  v_cvt_pk_bf16_f32 v113, v26, v27
  v_cvt_pk_bf16_f32 v114, v32, v33
  v_cvt_pk_bf16_f32 v115, v34, v35
  buffer_store_dwordx4 v[112:115], v8, s[4:7], s44 offen offset:512 sc1
  v_mfma_f32_32x32x16_bf16 v[52:67], a[164:167], v[72:75], v[52:67]
  ds_read_b128 v[96:99], v127 offset:33024
  s_waitcnt lgkmcnt(4)
  v_mfma_f32_32x32x16_bf16 v[52:67], a[168:171], v[76:79], v[52:67]
  ds_read_b128 v[68:71], v120 offset:33280
  v_mfma_f32_32x32x16_bf16 v[52:67], a[172:175], v[80:83], v[52:67]
  ds_read_b128 v[72:75], v121 offset:33280
  s_waitcnt lgkmcnt(4)
  v_mfma_f32_32x32x16_bf16 v[52:67], a[176:179], v[84:87], v[52:67]
  ds_read_b128 v[76:79], v122 offset:33280
  v_mfma_f32_32x32x16_bf16 v[52:67], a[180:183], v[88:91], v[52:67]
  ds_read_b128 v[80:83], v123 offset:33280
  s_waitcnt lgkmcnt(4)
  v_mfma_f32_32x32x16_bf16 v[52:67], a[184:187], v[92:95], v[52:67]
  ds_read_b128 v[84:87], v124 offset:33280
  v_mfma_f32_32x32x16_bf16 v[52:67], a[188:191], v[96:99], v[52:67]
  ds_read_b128 v[88:91], v125 offset:33280
  s_waitcnt lgkmcnt(4)
  v_mfma_f32_32x32x16_bf16 v[52:67], a[192:195], v[68:71], v[52:67]
  ds_read_b128 v[92:95], v126 offset:33280
  v_mfma_f32_32x32x16_bf16 v[52:67], a[196:199], v[72:75], v[52:67]
  ds_read_b128 v[96:99], v127 offset:33280
  s_waitcnt lgkmcnt(4)
  v_mfma_f32_32x32x16_bf16 v[52:67], a[200:203], v[76:79], v[52:67]
  ds_read_b128 v[68:71], v120 offset:33536
  v_mfma_f32_32x32x16_bf16 v[52:67], a[204:207], v[80:83], v[52:67]
  ds_read_b128 v[72:75], v121 offset:33536
  s_waitcnt lgkmcnt(4)
  v_mfma_f32_32x32x16_bf16 v[52:67], a[208:211], v[84:87], v[52:67]
  ds_read_b128 v[76:79], v122 offset:33536
  ds_read_b128 v[80:83], v123 offset:33536
  v_mfma_f32_32x32x16_bf16 v[52:67], a[212:215], v[88:91], v[52:67]
  ds_read_b128 v[84:87], v124 offset:33536
  ds_read_b128 v[88:91], v125 offset:33536
  s_waitcnt lgkmcnt(6)
  v_mfma_f32_32x32x16_bf16 v[52:67], a[216:219], v[92:95], v[52:67]
  ds_read_b128 v[92:95], v126 offset:33536
  v_mfma_f32_32x32x16_bf16 v[52:67], a[220:223], v[96:99], v[52:67]
  ds_read_b128 v[96:99], v127 offset:33536
  s_waitcnt lgkmcnt(6)
  v_mfma_f32_32x32x16_bf16 v[52:67], a[224:227], v[68:71], v[52:67]
  v_mfma_f32_32x32x16_bf16 v[52:67], a[228:231], v[72:75], v[52:67]
  s_waitcnt vmcnt(4) lgkmcnt(0)
  s_barrier
  ds_read_b128 v[100:103], v119 offset:128
  v_mfma_f32_32x32x16_bf16 v[52:67], a[232:235], v[76:79], v[52:67]
  ds_read_b128 v[68:71], v120 offset:0
  v_mfma_f32_32x32x16_bf16 v[52:67], a[236:239], v[80:83], v[52:67]
  ds_read_b128 v[72:75], v121 offset:0
  s_xor_b32 s50, s50, 32768
  v_mfma_f32_32x32x16_bf16 v[52:67], a[240:243], v[84:87], v[52:67]
  ds_read_b128 v[76:79], v122 offset:0
  s_waitcnt vmcnt(0)
  s_mov_b64 exec, 1
  buffer_store_dword v4, off, s[4:7], s51 sc1
  s_mov_b64 exec, -1
  v_mfma_f32_32x32x16_bf16 v[52:67], a[244:247], v[88:91], v[52:67]
  s_waitcnt lgkmcnt(3)
  v_min3_u32 v104, v100, v101, v102
  v_max3_u32 v100, v100, v101, v102
  v_min_u32 v104, v104, v103
  v_max_u32 v100, v100, v103
  v_readfirstlane_b32 s45, v104
  v_mfma_f32_32x32x16_bf16 v[52:67], a[248:251], v[92:95], v[52:67]
  v_readlane_b32 s28, v100, 0
  v_readlane_b32 s29, v100, 1
  v_readlane_b32 s30, v100, 2
  s_cmp_gt_u32 s55, 0
  s_cselect_b32 s45, 0, s45
  v_mfma_f32_32x32x16_bf16 v[52:67], a[252:255], v[96:99], v[52:67]
  s_cmp_eq_u32 s45, 0
  s_cbranch_scc1 q_slow_59
  s_cmp_lt_u32 s47, 64
  s_cbranch_scc1 q_w0_71
  s_cmp_gt_u32 s28, s56
  s_cselect_b32 s26, s40, 0
  s_max_u32 s56, s56, s28
  s_cmp_gt_u32 s26, 10
  s_subb_u32 s40, s40, 0
  s_cmp_gt_u32 s29, s56
  s_cselect_b32 s26, s40, 0
  s_max_u32 s56, s56, s29
  s_cmp_gt_u32 s26, 10
  s_subb_u32 s40, s40, 0
  s_cmp_gt_u32 s30, s56
  s_cselect_b32 s26, s40, 0
  s_max_u32 s56, s56, s30
  s_add_u32 s76, s47, s40
  s_add_u32 s41, s47, 3
  s_sub_u32 s76, s76, 64
  s_cmp_gt_u32 s26, 10
  s_cselect_b32 s76, 64, s76
  s_subb_u32 s40, s40, 0
  s_cmp_lt_u32 s76, 64
  s_cselect_b32 s76, s76, s41
  s_cmp_lg_u32 s26, 0
  s_cbranch_scc0 q_w0_71
  s_branch q_forkw_68
q_forkw_68:
  v_cvt_pk_bf16_f32 v100, v52, v53
  v_cvt_pk_bf16_f32 v101, v54, v55
  v_cvt_pk_bf16_f32 v102, v60, v61
  v_cvt_pk_bf16_f32 v103, v62, v63
  buffer_store_dwordx4 v[100:103], v8, s[4:7], s43 offen offset:0 sc1
  v_cvt_pk_bf16_f32 v104, v56, v57
  v_cvt_pk_bf16_f32 v105, v58, v59
  v_cvt_pk_bf16_f32 v106, v64, v65
  v_cvt_pk_bf16_f32 v107, v66, v67
  buffer_store_dwordx4 v[104:107], v8, s[4:7], s43 offen offset:512 sc1
  s_mov_b32 s43, 268435456
  s_waitcnt lgkmcnt(0)
q_fork_66:
  s_mov_b32 s58, s56
  s_mov_b32 s62, 1
  s_load_dwordx2 s[64:65], s[0:1], 72
  s_load_dwordx2 s[68:69], s[0:1], 80
  s_load_dwordx2 s[8:9], s[0:1], 88
  s_mov_b32 s66, 1835008
  s_mov_b32 s70, 1835008
  s_mov_b32 s10, 1835008
  v_lshrrev_b32 v2, 8, v0
  v_and_b32 v3, 0x70, v0
  s_mov_b32 s26, 114688
  v_mul_lo_u32 v6, v2, s26
  v_add_u32 v6, v6, v3
  v_cmp_eq_u32 vcc, 0x70, v3
  v_mov_b32 v3, 0x7ff00000
  s_nop 0
  v_cndmask_b32 v6, v6, v3, vcc
  v_mul_u32_u24 v7, 14336, v2
  v_and_b32 v3, 0xf0, v0
  v_add_u32 v7, v7, v3
  s_mul_i32 s34, s17, 458752
  s_mul_i32 s27, s16, 112
  s_add_u32 s34, s34, s27
  s_add_u32 s34, s34, 82432
  s_mul_i32 s35, s16, 57344
  s_lshl_b32 s27, s17, 8
  s_add_u32 s35, s35, s27
  s_mov_b32 s36, 0x00ff00ff
  s_mov_b32 s37, 0x00ff00ff
  s_waitcnt lgkmcnt(0)
  s_andn2_b32 s59, 0xfff, s58
  s_lshl_b32 s26, s61, 21
  s_lshl_b32 s27, s59, 10
  s_add_u32 s26, s26, s27
  s_lshl_b32 s27, s17, 8
  s_add_u32 s26, s26, s27
  s_add_u32 s26, s26, 27262976
  v_lshrrev_b32 v3, 8, v0
  v_lshlrev_b32 v3, 6, v3
  buffer_load_dwordx4 v[36:39], v3, s[4:7], s26 offen offset:0 sc1
  buffer_load_dwordx4 v[40:43], v3, s[4:7], s26 offen offset:16 sc1
  buffer_load_dwordx4 v[44:47], v3, s[4:7], s26 offen offset:32 sc1
  buffer_load_dwordx4 v[48:51], v3, s[4:7], s26 offen offset:48 sc1
  s_mov_b64 exec, s[36:37]
  buffer_load_dwordx4 v[64:67], v6, s[64:67], s34 offen
  s_not_b64 exec, exec
  buffer_load_dwordx4 v[64:67], v6, s[68:71], s34 offen
  s_mov_b64 exec, -1
  s_add_u32 s34, s34, 3584
  s_mov_b64 exec, s[36:37]
  buffer_load_dwordx4 v[68:71], v6, s[64:67], s34 offen
  s_not_b64 exec, exec
  buffer_load_dwordx4 v[68:71], v6, s[68:71], s34 offen
  s_mov_b64 exec, -1
  s_add_u32 s34, s34, 3584
  s_mov_b64 exec, s[36:37]
  buffer_load_dwordx4 v[72:75], v6, s[64:67], s34 offen
  s_not_b64 exec, exec
  buffer_load_dwordx4 v[72:75], v6, s[68:71], s34 offen
  s_mov_b64 exec, -1
  s_add_u32 s34, s34, 3584
  s_mov_b64 exec, s[36:37]
  buffer_load_dwordx4 v[76:79], v6, s[64:67], s34 offen
  s_not_b64 exec, exec
  buffer_load_dwordx4 v[76:79], v6, s[68:71], s34 offen
  s_mov_b64 exec, -1
  s_add_u32 s34, s34, 3584
  s_mov_b64 exec, s[36:37]
  buffer_load_dwordx4 v[80:83], v6, s[64:67], s34 offen
  s_not_b64 exec, exec
  buffer_load_dwordx4 v[80:83], v6, s[68:71], s34 offen
  s_mov_b64 exec, -1
  s_add_u32 s34, s34, 3584
  s_mov_b64 exec, s[36:37]
  buffer_load_dwordx4 v[84:87], v6, s[64:67], s34 offen
  s_not_b64 exec, exec
  buffer_load_dwordx4 v[84:87], v6, s[68:71], s34 offen
  s_mov_b64 exec, -1
  s_add_u32 s34, s34, 3584
  s_mov_b64 exec, s[36:37]
  buffer_load_dwordx4 v[88:91], v6, s[64:67], s34 offen
  s_not_b64 exec, exec
  buffer_load_dwordx4 v[88:91], v6, s[68:71], s34 offen
  s_mov_b64 exec, -1
  s_add_u32 s34, s34, 3584
  s_mov_b64 exec, s[36:37]
  buffer_load_dwordx4 v[92:95], v6, s[64:67], s34 offen
  s_not_b64 exec, exec
  buffer_load_dwordx4 v[92:95], v6, s[68:71], s34 offen
  s_mov_b64 exec, -1
  s_add_u32 s34, s34, 3584
  s_mov_b64 exec, s[36:37]
  buffer_load_dwordx4 v[96:99], v6, s[64:67], s34 offen
  s_not_b64 exec, exec
  buffer_load_dwordx4 v[96:99], v6, s[68:71], s34 offen
  s_mov_b64 exec, -1
  s_add_u32 s34, s34, 3584
  buffer_load_dwordx4 v[100:103], v7, s[8:11], s35 offen offset:0
  buffer_load_dwordx4 v[104:107], v7, s[8:11], s35 offen offset:1024
  buffer_load_dwordx4 v[108:111], v7, s[8:11], s35 offen offset:2048
  buffer_load_dwordx4 v[112:115], v7, s[8:11], s35 offen offset:3072
  s_add_u32 s35, s35, 4096
  s_mov_b32 vcc_lo, 0xaaaaaaaa
  s_mov_b32 vcc_hi, 0xaaaaaaaa
  v_mov_b32 v3, 0xffff
  v_mov_b32 v28, 0xffff0000
  v_cndmask_b32 v3, v3, v28, vcc
  s_mov_b32 vcc_lo, 0x30003
  s_mov_b32 vcc_hi, 0x30003
  v_cndmask_b32 v28, 0, v3, vcc
  s_mov_b32 vcc_lo, 0xc000c
  s_mov_b32 vcc_hi, 0xc000c
  v_cndmask_b32 v29, 0, v3, vcc
  s_mov_b32 vcc_lo, 0x300030
  s_mov_b32 vcc_hi, 0x300030
  v_cndmask_b32 v30, 0, v3, vcc
  s_mov_b32 vcc_lo, 0xc000c0
  s_mov_b32 vcc_hi, 0xc000c0
  v_cndmask_b32 v31, 0, v3, vcc
  s_mov_b32 s30, 0x01000100
  s_mov_b32 s31, 0x03020302
  s_mul_i32 s26, s17, 23552
  s_add_u32 s26, s26, 65536
  v_add_u32 v5, s26, v0
  ds_read_b128 v[52:55], v5 offset:0
  ds_read_b128 v[56:59], v5 offset:1024
  ds_read_b128 v[60:63], v5 offset:2048
  s_waitcnt vmcnt(22)
  v_perm_b32 v3, v36, v36, s30
  v_and_b32 v20, v28, v3
  v_and_b32 v21, v29, v3
  v_and_b32 v22, v30, v3
  v_and_b32 v23, v31, v3
  s_waitcnt lgkmcnt(2)
  s_nop 0
  v_mfma_f32_16x16x32_bf16 v[32:35], v[20:23], v[52:55], 0
  ds_read_b128 v[52:55], v5 offset:3072
  v_perm_b32 v3, v36, v36, s31
  v_and_b32 v24, v28, v3
  v_and_b32 v25, v29, v3
  v_and_b32 v26, v30, v3
  v_and_b32 v27, v31, v3
  s_waitcnt lgkmcnt(2)
  s_nop 0
  v_mfma_f32_16x16x32_bf16 v[32:35], v[24:27], v[56:59], v[32:35]
  ds_read_b128 v[56:59], v5 offset:4096
  v_perm_b32 v3, v37, v37, s30
  v_and_b32 v20, v28, v3
  v_and_b32 v21, v29, v3
  v_and_b32 v22, v30, v3
  v_and_b32 v23, v31, v3
  s_waitcnt lgkmcnt(2)
  s_nop 0
  v_mfma_f32_16x16x32_bf16 v[32:35], v[20:23], v[60:63], v[32:35]
  ds_read_b128 v[60:63], v5 offset:5120
  v_perm_b32 v3, v37, v37, s31
  v_and_b32 v24, v28, v3
  v_and_b32 v25, v29, v3
  v_and_b32 v26, v30, v3
  v_and_b32 v27, v31, v3
  s_waitcnt lgkmcnt(2)
  s_nop 0
  v_mfma_f32_16x16x32_bf16 v[32:35], v[24:27], v[52:55], v[32:35]
  ds_read_b128 v[52:55], v5 offset:6144
  v_perm_b32 v3, v38, v38, s30
  v_and_b32 v20, v28, v3
  v_and_b32 v21, v29, v3
  v_and_b32 v22, v30, v3
  v_and_b32 v23, v31, v3
  s_waitcnt lgkmcnt(2)
  s_nop 0
  v_mfma_f32_16x16x32_bf16 v[32:35], v[20:23], v[56:59], v[32:35]
  ds_read_b128 v[56:59], v5 offset:7168
  v_perm_b32 v3, v38, v38, s31
  v_and_b32 v24, v28, v3
  v_and_b32 v25, v29, v3
  v_and_b32 v26, v30, v3
  v_and_b32 v27, v31, v3
  s_waitcnt lgkmcnt(2)
  s_nop 0
  v_mfma_f32_16x16x32_bf16 v[32:35], v[24:27], v[60:63], v[32:35]
  ds_read_b128 v[60:63], v5 offset:8192
  v_perm_b32 v3, v39, v39, s30
  v_and_b32 v20, v28, v3
  v_and_b32 v21, v29, v3
  v_and_b32 v22, v30, v3
  v_and_b32 v23, v31, v3
  s_waitcnt lgkmcnt(2)
  s_nop 0
  v_mfma_f32_16x16x32_bf16 v[32:35], v[20:23], v[52:55], v[32:35]
  ds_read_b128 v[52:55], v5 offset:9216
  v_perm_b32 v3, v39, v39, s31
  v_and_b32 v24, v28, v3
  v_and_b32 v25, v29, v3
  v_and_b32 v26, v30, v3
  v_and_b32 v27, v31, v3
  s_waitcnt lgkmcnt(2)
  s_nop 0
  v_mfma_f32_16x16x32_bf16 v[32:35], v[24:27], v[56:59], v[32:35]
  ds_read_b128 v[56:59], v5 offset:10240
  v_perm_b32 v3, v40, v40, s30
  v_and_b32 v20, v28, v3
  v_and_b32 v21, v29, v3
  v_and_b32 v22, v30, v3
  v_and_b32 v23, v31, v3
  s_waitcnt lgkmcnt(2)
  s_nop 0
  v_mfma_f32_16x16x32_bf16 v[32:35], v[20:23], v[60:63], v[32:35]
  ds_read_b128 v[60:63], v5 offset:11264
  v_perm_b32 v3, v40, v40, s31
  v_and_b32 v24, v28, v3
  v_and_b32 v25, v29, v3
  v_and_b32 v26, v30, v3
  v_and_b32 v27, v31, v3
  s_waitcnt lgkmcnt(2)
  s_nop 0
  v_mfma_f32_16x16x32_bf16 v[32:35], v[24:27], v[52:55], v[32:35]
  ds_read_b128 v[52:55], v5 offset:12288
  v_perm_b32 v3, v41, v41, s30
  v_and_b32 v20, v28, v3
  v_and_b32 v21, v29, v3
  v_and_b32 v22, v30, v3
  v_and_b32 v23, v31, v3
  s_waitcnt lgkmcnt(2)
  s_nop 0
  v_mfma_f32_16x16x32_bf16 v[32:35], v[20:23], v[56:59], v[32:35]
  ds_read_b128 v[56:59], v5 offset:13312
  v_perm_b32 v3, v41, v41, s31
  v_and_b32 v24, v28, v3
  v_and_b32 v25, v29, v3
  v_and_b32 v26, v30, v3
  v_and_b32 v27, v31, v3
  s_waitcnt lgkmcnt(2)
  s_nop 0
  v_mfma_f32_16x16x32_bf16 v[32:35], v[24:27], v[60:63], v[32:35]
  ds_read_b128 v[60:63], v5 offset:14336
  v_perm_b32 v3, v42, v42, s30
  v_and_b32 v20, v28, v3
  v_and_b32 v21, v29, v3
  v_and_b32 v22, v30, v3
  v_and_b32 v23, v31, v3
  s_waitcnt lgkmcnt(2)
  s_nop 0
  v_mfma_f32_16x16x32_bf16 v[32:35], v[20:23], v[52:55], v[32:35]
  ds_read_b128 v[52:55], v5 offset:15360
  v_perm_b32 v3, v42, v42, s31
  v_and_b32 v24, v28, v3
  v_and_b32 v25, v29, v3
  v_and_b32 v26, v30, v3
  v_and_b32 v27, v31, v3
  s_waitcnt lgkmcnt(2)
  s_nop 0
  v_mfma_f32_16x16x32_bf16 v[32:35], v[24:27], v[56:59], v[32:35]
  ds_read_b128 v[56:59], v5 offset:16384
  v_perm_b32 v3, v43, v43, s30
  v_and_b32 v20, v28, v3
  v_and_b32 v21, v29, v3
  v_and_b32 v22, v30, v3
  v_and_b32 v23, v31, v3
  s_waitcnt lgkmcnt(2)
  s_nop 0
  v_mfma_f32_16x16x32_bf16 v[32:35], v[20:23], v[60:63], v[32:35]
  ds_read_b128 v[60:63], v5 offset:17408
  v_perm_b32 v3, v43, v43, s31
  v_and_b32 v24, v28, v3
  v_and_b32 v25, v29, v3
  v_and_b32 v26, v30, v3
  v_and_b32 v27, v31, v3
  s_waitcnt lgkmcnt(2)
  s_nop 0
  v_mfma_f32_16x16x32_bf16 v[32:35], v[24:27], v[52:55], v[32:35]
  ds_read_b128 v[52:55], v5 offset:18432
  v_perm_b32 v3, v44, v44, s30
  v_and_b32 v20, v28, v3
  v_and_b32 v21, v29, v3
  v_and_b32 v22, v30, v3
  v_and_b32 v23, v31, v3
  s_waitcnt lgkmcnt(2)
  s_nop 0
  v_mfma_f32_16x16x32_bf16 v[32:35], v[20:23], v[56:59], v[32:35]
  ds_read_b128 v[56:59], v5 offset:19456
  v_perm_b32 v3, v44, v44, s31
  v_and_b32 v24, v28, v3
  v_and_b32 v25, v29, v3
  v_and_b32 v26, v30, v3
  v_and_b32 v27, v31, v3
  s_waitcnt lgkmcnt(2)
  s_nop 0
  v_mfma_f32_16x16x32_bf16 v[32:35], v[24:27], v[60:63], v[32:35]
  ds_read_b128 v[60:63], v5 offset:20480
  v_perm_b32 v3, v45, v45, s30
  v_and_b32 v20, v28, v3
  v_and_b32 v21, v29, v3
  v_and_b32 v22, v30, v3
  v_and_b32 v23, v31, v3
  s_waitcnt lgkmcnt(2)
  s_nop 0
  v_mfma_f32_16x16x32_bf16 v[32:35], v[20:23], v[52:55], v[32:35]
  ds_read_b128 v[52:55], v5 offset:21504
  v_perm_b32 v3, v45, v45, s31
  v_and_b32 v24, v28, v3
  v_and_b32 v25, v29, v3
  v_and_b32 v26, v30, v3
  v_and_b32 v27, v31, v3
  s_waitcnt lgkmcnt(2)
  s_nop 0
  v_mfma_f32_16x16x32_bf16 v[32:35], v[24:27], v[56:59], v[32:35]
  ds_read_b128 v[56:59], v5 offset:22528
  v_perm_b32 v3, v46, v46, s30
  v_and_b32 v20, v28, v3
  v_and_b32 v21, v29, v3
  v_and_b32 v22, v30, v3
  v_and_b32 v23, v31, v3
  s_waitcnt lgkmcnt(2)
  s_nop 0
  v_mfma_f32_16x16x32_bf16 v[32:35], v[20:23], v[60:63], v[32:35]
  buffer_load_dwordx4 v[60:63], v7, s[8:11], s35 offen offset:0
  v_perm_b32 v3, v46, v46, s31
  v_and_b32 v24, v28, v3
  v_and_b32 v25, v29, v3
  v_and_b32 v26, v30, v3
  v_and_b32 v27, v31, v3
  s_waitcnt lgkmcnt(1)
  s_nop 0
  v_mfma_f32_16x16x32_bf16 v[32:35], v[24:27], v[52:55], v[32:35]
  buffer_load_dwordx4 v[52:55], v7, s[8:11], s35 offen offset:1024
  v_perm_b32 v3, v47, v47, s30
  v_and_b32 v20, v28, v3
  v_and_b32 v21, v29, v3
  v_and_b32 v22, v30, v3
  v_and_b32 v23, v31, v3
  s_waitcnt lgkmcnt(0)
  s_nop 0
  v_mfma_f32_16x16x32_bf16 v[32:35], v[20:23], v[56:59], v[32:35]
  buffer_load_dwordx4 v[56:59], v7, s[8:11], s35 offen offset:2048
  v_perm_b32 v3, v47, v47, s31
  v_and_b32 v24, v28, v3
  v_and_b32 v25, v29, v3
  v_and_b32 v26, v30, v3
  v_and_b32 v27, v31, v3
  s_waitcnt vmcnt(23)
  s_nop 0
  v_mfma_f32_16x16x32_bf16 v[32:35], v[24:27], v[64:67], v[32:35]
  buffer_load_dwordx4 v[64:67], v7, s[8:11], s35 offen offset:3072
  s_add_u32 s35, s35, 4096
  v_perm_b32 v3, v48, v48, s30
  v_and_b32 v20, v28, v3
  v_and_b32 v21, v29, v3
  v_and_b32 v22, v30, v3
  v_and_b32 v23, v31, v3
  s_waitcnt vmcnt(22)
  s_nop 0
  v_mfma_f32_16x16x32_bf16 v[32:35], v[20:23], v[68:71], v[32:35]
  buffer_load_dwordx4 v[68:71], v7, s[8:11], s35 offen offset:0
  v_perm_b32 v3, v48, v48, s31
  v_and_b32 v24, v28, v3
  v_and_b32 v25, v29, v3
  v_and_b32 v26, v30, v3
  v_and_b32 v27, v31, v3
  s_waitcnt vmcnt(21)
  s_nop 0
  v_mfma_f32_16x16x32_bf16 v[32:35], v[24:27], v[72:75], v[32:35]
  buffer_load_dwordx4 v[72:75], v7, s[8:11], s35 offen offset:1024
  v_perm_b32 v3, v49, v49, s30
  v_and_b32 v20, v28, v3
  v_and_b32 v21, v29, v3
  v_and_b32 v22, v30, v3
  v_and_b32 v23, v31, v3
  s_waitcnt vmcnt(20)
  s_nop 0
  v_mfma_f32_16x16x32_bf16 v[32:35], v[20:23], v[76:79], v[32:35]
  buffer_load_dwordx4 v[76:79], v7, s[8:11], s35 offen offset:2048
  v_perm_b32 v3, v49, v49, s31
  v_and_b32 v24, v28, v3
  v_and_b32 v25, v29, v3
  v_and_b32 v26, v30, v3
  v_and_b32 v27, v31, v3
  s_waitcnt vmcnt(19)
  s_nop 0
  v_mfma_f32_16x16x32_bf16 v[32:35], v[24:27], v[80:83], v[32:35]
  buffer_load_dwordx4 v[80:83], v7, s[8:11], s35 offen offset:3072
  s_add_u32 s35, s35, 4096
  v_perm_b32 v3, v50, v50, s30
  v_and_b32 v20, v28, v3
  v_and_b32 v21, v29, v3
  v_and_b32 v22, v30, v3
  v_and_b32 v23, v31, v3
  s_waitcnt vmcnt(18)
  s_nop 0
  v_mfma_f32_16x16x32_bf16 v[32:35], v[20:23], v[84:87], v[32:35]
  buffer_load_dwordx4 v[84:87], v7, s[8:11], s35 offen offset:0
  v_perm_b32 v3, v50, v50, s31
  v_and_b32 v24, v28, v3
  v_and_b32 v25, v29, v3
  v_and_b32 v26, v30, v3
  v_and_b32 v27, v31, v3
  s_waitcnt vmcnt(17)
  s_nop 0
  v_mfma_f32_16x16x32_bf16 v[32:35], v[24:27], v[88:91], v[32:35]
  buffer_load_dwordx4 v[88:91], v7, s[8:11], s35 offen offset:1024
  v_perm_b32 v3, v51, v51, s30
  v_and_b32 v20, v28, v3
  v_and_b32 v21, v29, v3
  v_and_b32 v22, v30, v3
  v_and_b32 v23, v31, v3
  s_waitcnt vmcnt(16)
  s_nop 0
  v_mfma_f32_16x16x32_bf16 v[32:35], v[20:23], v[92:95], v[32:35]
  v_perm_b32 v3, v51, v51, s31
  v_and_b32 v24, v28, v3
  v_and_b32 v25, v29, v3
  v_and_b32 v26, v30, v3
  v_and_b32 v27, v31, v3
  s_waitcnt vmcnt(14)
  s_nop 0
  v_mfma_f32_16x16x32_bf16 v[32:35], v[24:27], v[96:99], v[32:35]
  v_lshrrev_b32 v2, 8, v0
  v_and_b32 v3, 0xf0, v0
  v_lshlrev_b32 v3, 1, v3
  v_lshl_add_u32 v3, v2, 4, v3
  s_lshl_b32 s26, s17, 9
  s_add_u32 s26, s26, 159744
  v_add_u32 v5, s26, v3
  s_mov_b32 exec_hi, 0
  ds_write_b128 v5, v[32:35]
  s_mov_b32 exec_hi, -1
  v_add_u32 v5, 159744, v1
  s_waitcnt lgkmcnt(0)
  s_barrier
  ds_read_b32 v36, v5 offset:0
  ds_read_b32 v37, v5 offset:256
  ds_read_b32 v38, v5 offset:512
  ds_read_b32 v39, v5 offset:768
  ds_read_b32 v40, v5 offset:1024
  ds_read_b32 v41, v5 offset:1280
  ds_read_b32 v42, v5 offset:1536
  ds_read_b32 v43, v5 offset:1792
  s_waitcnt lgkmcnt(0)
  v_add_f32 v36, v36, v38
  v_add_f32 v40, v40, v42
  v_add_f32 v36, v36, v40
  v_cvt_pk_bf16_f32 v36, 0, v36
  v_add_f32 v37, v37, v39
  v_add_f32 v41, v41, v43
  v_add_f32 v37, v37, v41
  v_cvt_pk_bf16_f32 v37, 0, v37
  v_mul_f32 v40, 0xbfb8aa3b, v36
  v_exp_f32 v40, v40
  s_nop 0
  v_add_f32 v40, 1.0, v40
  v_rcp_f32 v40, v40
  s_nop 0
  v_mul_f32 v36, v36, v40
  v_cvt_pk_bf16_f32 v36, 0, v36
  v_mul_f32 v36, v36, v37
  v_cvt_pk_bf16_f32 v36, v36, v36
  s_lshl_b32 s26, s17, 8
  s_add_u32 s26, s26, 161792
  v_add_u32 v5, s26, v1
  ds_write_b32 v5, v36
  v_mul_u32_u24 v5, 56, v2
  v_add_u32 v5, s26, v5
  ds_read_b64 v[36:37], v5 offset:0
  ds_read_b64 v[38:39], v5 offset:8
  ds_read_b64 v[40:41], v5 offset:16
  ds_read_b64 v[42:43], v5 offset:24
  ds_read_b64 v[44:45], v5 offset:32
  ds_read_b64 v[46:47], v5 offset:40
  ds_read_b64 v[48:49], v5 offset:48
  s_waitcnt lgkmcnt(0)
  v_and_b32 v20, v28, v36
  v_and_b32 v21, v29, v36
  v_and_b32 v22, v30, v36
  v_and_b32 v23, v31, v36
  s_waitcnt vmcnt(13)
  s_nop 0
  v_mfma_f32_16x16x32_bf16 v[32:35], v[20:23], v[100:103], 0
  v_and_b32 v24, v28, v37
  v_and_b32 v25, v29, v37
  v_and_b32 v26, v30, v37
  v_and_b32 v27, v31, v37
  s_waitcnt vmcnt(12)
  s_nop 0
  v_mfma_f32_16x16x32_bf16 v[32:35], v[24:27], v[104:107], v[32:35]
  v_and_b32 v20, v28, v38
  v_and_b32 v21, v29, v38
  v_and_b32 v22, v30, v38
  v_and_b32 v23, v31, v38
  s_waitcnt vmcnt(11)
  s_nop 0
  v_mfma_f32_16x16x32_bf16 v[32:35], v[20:23], v[108:111], v[32:35]
  v_and_b32 v24, v28, v39
  v_and_b32 v25, v29, v39
  v_and_b32 v26, v30, v39
  v_and_b32 v27, v31, v39
  s_waitcnt vmcnt(10)
  s_nop 0
  v_mfma_f32_16x16x32_bf16 v[32:35], v[24:27], v[112:115], v[32:35]
  v_and_b32 v20, v28, v40
  v_and_b32 v21, v29, v40
  v_and_b32 v22, v30, v40
  v_and_b32 v23, v31, v40
  s_waitcnt vmcnt(9)
  s_nop 0
  v_mfma_f32_16x16x32_bf16 v[32:35], v[20:23], v[60:63], v[32:35]
  v_and_b32 v24, v28, v41
  v_and_b32 v25, v29, v41
  v_and_b32 v26, v30, v41
  v_and_b32 v27, v31, v41
  s_waitcnt vmcnt(8)
  s_nop 0
  v_mfma_f32_16x16x32_bf16 v[32:35], v[24:27], v[52:55], v[32:35]
  v_and_b32 v20, v28, v42
  v_and_b32 v21, v29, v42
  v_and_b32 v22, v30, v42
  v_and_b32 v23, v31, v42
  s_waitcnt vmcnt(7)
  s_nop 0
  v_mfma_f32_16x16x32_bf16 v[32:35], v[20:23], v[56:59], v[32:35]
  v_and_b32 v24, v28, v43
  v_and_b32 v25, v29, v43
  v_and_b32 v26, v30, v43
  v_and_b32 v27, v31, v43
  s_waitcnt vmcnt(6)
  s_nop 0
  v_mfma_f32_16x16x32_bf16 v[32:35], v[24:27], v[64:67], v[32:35]
  v_and_b32 v20, v28, v44
  v_and_b32 v21, v29, v44
  v_and_b32 v22, v30, v44
  v_and_b32 v23, v31, v44
  s_waitcnt vmcnt(5)
  s_nop 0
  v_mfma_f32_16x16x32_bf16 v[32:35], v[20:23], v[68:71], v[32:35]
  v_and_b32 v24, v28, v45
  v_and_b32 v25, v29, v45
  v_and_b32 v26, v30, v45
  v_and_b32 v27, v31, v45
  s_waitcnt vmcnt(4)
  s_nop 0
  v_mfma_f32_16x16x32_bf16 v[32:35], v[24:27], v[72:75], v[32:35]
  v_and_b32 v20, v28, v46
  v_and_b32 v21, v29, v46
  v_and_b32 v22, v30, v46
  v_and_b32 v23, v31, v46
  s_waitcnt vmcnt(3)
  s_nop 0
  v_mfma_f32_16x16x32_bf16 v[32:35], v[20:23], v[76:79], v[32:35]
  v_and_b32 v24, v28, v47
  v_and_b32 v25, v29, v47
  v_and_b32 v26, v30, v47
  v_and_b32 v27, v31, v47
  s_waitcnt vmcnt(2)
  s_nop 0
  v_mfma_f32_16x16x32_bf16 v[32:35], v[24:27], v[80:83], v[32:35]
  v_and_b32 v20, v28, v48
  v_and_b32 v21, v29, v48
  v_and_b32 v22, v30, v48
  v_and_b32 v23, v31, v48
  s_waitcnt vmcnt(1)
  s_nop 0
  v_mfma_f32_16x16x32_bf16 v[32:35], v[20:23], v[84:87], v[32:35]
  v_and_b32 v24, v28, v49
  v_and_b32 v25, v29, v49
  v_and_b32 v26, v30, v49
  v_and_b32 v27, v31, v49
  s_waitcnt vmcnt(0)
  s_nop 0
  v_mfma_f32_16x16x32_bf16 v[32:35], v[24:27], v[88:91], v[32:35]
  v_lshrrev_b32 v3, 1, v3
  s_lshl_b32 s26, s47, 7
  s_add_u32 s26, s26, s57
  s_lshl_b32 s26, s26, 8
  s_add_u32 s26, s26, 244318208
  s_nop 2
  v_cvt_pk_bf16_f32 v32, v32, v33
  v_cvt_pk_bf16_f32 v33, v34, v35
  v_min_u32 v32, -2, v32
  v_min_u32 v33, -2, v33
  s_mov_b32 exec_hi, 0
  buffer_store_dwordx2 v[32:33], v3, s[4:7], s26 offen sc1
  s_mov_b32 exec_hi, -1
  v_lshrrev_b32 v7, 7, v0
  v_lshlrev_b32 v7, 12, v7
  v_and_b32 v2, 1023, v9
  s_lshl_b32 s26, s17, 10
  v_add3_u32 v7, v7, v2, s26
  v_mov_b32 v116, 0
  s_branch q_cold_67
q_patch_64:
  s_lshl_b32 s26, s61, 21
  s_lshl_b32 s27, s59, 10
  s_add_u32 s26, s26, s27
  s_add_u32 s27, s26, 20971520
  s_add_u32 s28, s26, 27262976
  s_lshl_b32 s26, s46, 7
  s_add_u32 s26, s26, s17
  s_lshl_b32 s26, s26, 8
  s_add_u32 s26, s26, 244318208
  v_lshrrev_b32 v2, 8, v0
  v_and_b32 v3, 0xf0, v0
  v_lshl_add_u32 v5, v2, 10, v3
  buffer_load_dwordx4 v[36:39], v0, s[4:7], s27 offen sc1
  buffer_load_dwordx4 v[40:43], v0, s[4:7], s28 offen sc1
  s_mov_b32 s53, 0
m_w_75:
  s_add_u32 s27, s26, 0
  buffer_load_dwordx4 v[60:63], v5, s[4:7], s27 offen sc1
  s_add_u32 s27, s26, 4096
  buffer_load_dwordx4 v[64:67], v5, s[4:7], s27 offen sc1
  s_add_u32 s27, s26, 8192
  buffer_load_dwordx4 v[68:71], v5, s[4:7], s27 offen sc1
  s_add_u32 s27, s26, 12288
  buffer_load_dwordx4 v[72:75], v5, s[4:7], s27 offen sc1
  s_add_u32 s27, s26, 16384
  buffer_load_dwordx4 v[76:79], v5, s[4:7], s27 offen sc1
  s_add_u32 s27, s26, 20480
  buffer_load_dwordx4 v[80:83], v5, s[4:7], s27 offen sc1
  s_add_u32 s27, s26, 24576
  buffer_load_dwordx4 v[84:87], v5, s[4:7], s27 offen sc1
  s_add_u32 s27, s26, 28672
  buffer_load_dwordx4 v[88:91], v5, s[4:7], s27 offen sc1
  s_add_u32 s53, s53, 1
  s_cmp_gt_u32 s53, 1048576
  s_cbranch_scc1 q_fail_63
  s_mov_b32 vcc_lo, 0xaaaaaaaa
  s_mov_b32 vcc_hi, 0xaaaaaaaa
  v_mov_b32 v28, 0x3f80
  v_mov_b32 v20, 1.0
  v_cndmask_b32 v28, v28, v20, vcc
  s_mov_b32 vcc_lo, 0x30003
  s_mov_b32 vcc_hi, 0x30003
  v_cndmask_b32 v20, 0, v28, vcc
  s_mov_b32 vcc_lo, 0xc000c
  s_mov_b32 vcc_hi, 0xc000c
  v_cndmask_b32 v21, 0, v28, vcc
  s_mov_b32 vcc_lo, 0x300030
  s_mov_b32 vcc_hi, 0x300030
  v_cndmask_b32 v22, 0, v28, vcc
  s_mov_b32 vcc_lo, 0xc000c0
  s_mov_b32 vcc_hi, 0xc000c0
  v_cndmask_b32 v23, 0, v28, vcc
  s_waitcnt vmcnt(7)
  s_nop 0
  v_mfma_f32_16x16x32_bf16 v[28:31], v[20:23], v[60:63], 0
  v_max3_u32 v44, v60, v61, 0
  v_max3_u32 v44, v62, v63, v44
  s_waitcnt vmcnt(6)
  v_mfma_f32_16x16x32_bf16 v[28:31], v[20:23], v[64:67], v[28:31]
  v_max3_u32 v44, v64, v65, v44
  v_max3_u32 v44, v66, v67, v44
  s_waitcnt vmcnt(5)
  v_mfma_f32_16x16x32_bf16 v[28:31], v[20:23], v[68:71], v[28:31]
  v_max3_u32 v44, v68, v69, v44
  v_max3_u32 v44, v70, v71, v44
  s_waitcnt vmcnt(4)
  v_mfma_f32_16x16x32_bf16 v[28:31], v[20:23], v[72:75], v[28:31]
  v_max3_u32 v44, v72, v73, v44
  v_max3_u32 v44, v74, v75, v44
  s_waitcnt vmcnt(3)
  v_mfma_f32_16x16x32_bf16 v[28:31], v[20:23], v[76:79], v[28:31]
  v_max3_u32 v44, v76, v77, v44
  v_max3_u32 v44, v78, v79, v44
  s_waitcnt vmcnt(2)
  v_mfma_f32_16x16x32_bf16 v[28:31], v[20:23], v[80:83], v[28:31]
  v_max3_u32 v44, v80, v81, v44
  v_max3_u32 v44, v82, v83, v44
  s_waitcnt vmcnt(1)
  v_mfma_f32_16x16x32_bf16 v[28:31], v[20:23], v[84:87], v[28:31]
  v_max3_u32 v44, v84, v85, v44
  v_max3_u32 v44, v86, v87, v44
  s_waitcnt vmcnt(0)
  v_mfma_f32_16x16x32_bf16 v[28:31], v[20:23], v[88:91], v[28:31]
  v_max3_u32 v44, v88, v89, v44
  v_max3_u32 v44, v90, v91, v44
  v_cmp_eq_u32 vcc, -1, v44
  s_cbranch_vccnz m_w_75
  v_lshlrev_b32 v3, 1, v3
  v_lshl_add_u32 v3, v2, 4, v3
  s_lshl_b32 s26, s17, 9
  s_add_u32 s26, s26, 159744
  v_add_u32 v3, s26, v3
  s_mov_b32 exec_hi, 0
  ds_write_b128 v3, v[28:31]
  s_mov_b32 exec_hi, -1
  v_lshlrev_b32 v3, 1, v0
  v_add_u32 v3, 159744, v3
  v_lshlrev_b32 v44, 16, v36
  v_and_b32 v45, 0xffff0000, v36
  v_lshlrev_b32 v46, 16, v37
  v_and_b32 v47, 0xffff0000, v37
  v_lshlrev_b32 v48, 16, v38
  v_and_b32 v49, 0xffff0000, v38
  v_lshlrev_b32 v50, 16, v39
  v_and_b32 v51, 0xffff0000, v39
  v_lshlrev_b32 v52, 16, v40
  v_and_b32 v53, 0xffff0000, v40
  v_lshlrev_b32 v54, 16, v41
  v_and_b32 v55, 0xffff0000, v41
  v_lshlrev_b32 v56, 16, v42
  v_and_b32 v57, 0xffff0000, v42
  v_lshlrev_b32 v58, 16, v43
  v_and_b32 v59, 0xffff0000, v43
  s_waitcnt lgkmcnt(0)
  s_barrier
  s_cmp_lg_u32 s17, 0
  s_cbranch_scc1 m_done_74
  ds_read_b128 v[28:31], v3
  ds_read_b128 v[32:35], v3 offset:16
  s_and_b32 s29, s58, 0xffff0000
  s_xor_b32 s27, s29, 0x80000000
  s_xor_b32 s28, s29, 0xffff0000
  s_bitcmp1_b32 s29, 31
  s_cselect_b32 s29, s27, s28
  v_mov_b32 v36, s29
  v_mul_f32 v36, 0xbfb8aa3b, v36
  v_exp_f32 v36, v36
  s_nop 0
  v_add_f32 v36, 1.0, v36
  v_rcp_f32 v36, v36
  s_nop 0
  v_cvt_pk_bf16_f32 v36, 0, v36
  s_waitcnt lgkmcnt(0)
  v_cvt_pk_bf16_f32 v28, 0, v28
  v_cvt_pk_bf16_f32 v29, 0, v29
  v_cvt_pk_bf16_f32 v30, 0, v30
  v_cvt_pk_bf16_f32 v31, 0, v31
  v_cvt_pk_bf16_f32 v32, 0, v32
  v_cvt_pk_bf16_f32 v33, 0, v33
  v_cvt_pk_bf16_f32 v34, 0, v34
  v_cvt_pk_bf16_f32 v35, 0, v35
  v_mul_f32 v28, v28, v36
  v_mul_f32 v29, v29, v36
  v_mul_f32 v30, v30, v36
  v_mul_f32 v31, v31, v36
  v_mul_f32 v32, v32, v36
  v_mul_f32 v33, v33, v36
  v_mul_f32 v34, v34, v36
  v_mul_f32 v35, v35, v36
  v_cvt_pk_bf16_f32 v28, 0, v28
  v_cvt_pk_bf16_f32 v29, 0, v29
  v_cvt_pk_bf16_f32 v30, 0, v30
  v_cvt_pk_bf16_f32 v31, 0, v31
  v_cvt_pk_bf16_f32 v32, 0, v32
  v_cvt_pk_bf16_f32 v33, 0, v33
  v_cvt_pk_bf16_f32 v34, 0, v34
  v_cvt_pk_bf16_f32 v35, 0, v35
  v_add_f32 v28, v28, v52
  v_add_f32 v29, v29, v53
  v_add_f32 v30, v30, v54
  v_add_f32 v31, v31, v55
  v_add_f32 v32, v32, v56
  v_add_f32 v33, v33, v57
  v_add_f32 v34, v34, v58
  v_add_f32 v35, v35, v59
  v_cvt_pk_bf16_f32 v28, 0, v28
  v_cvt_pk_bf16_f32 v29, 0, v29
  v_cvt_pk_bf16_f32 v30, 0, v30
  v_cvt_pk_bf16_f32 v31, 0, v31
  v_cvt_pk_bf16_f32 v32, 0, v32
  v_cvt_pk_bf16_f32 v33, 0, v33
  v_cvt_pk_bf16_f32 v34, 0, v34
  v_cvt_pk_bf16_f32 v35, 0, v35
  v_add_f32 v44, v44, v28
  v_add_f32 v45, v45, v29
  v_add_f32 v46, v46, v30
  v_add_f32 v47, v47, v31
  v_add_f32 v48, v48, v32
  v_add_f32 v49, v49, v33
  v_add_f32 v50, v50, v34
  v_add_f32 v51, v51, v35
  v_cvt_pk_bf16_f32 v40, v44, v45
  v_cvt_pk_bf16_f32 v41, v46, v47
  v_cvt_pk_bf16_f32 v42, v48, v49
  v_cvt_pk_bf16_f32 v43, v50, v51
  v_lshlrev_b32 v44, 16, v40
  v_and_b32 v45, 0xffff0000, v40
  v_lshlrev_b32 v46, 16, v41
  v_and_b32 v47, 0xffff0000, v41
  v_lshlrev_b32 v48, 16, v42
  v_and_b32 v49, 0xffff0000, v42
  v_lshlrev_b32 v50, 16, v43
  v_and_b32 v51, 0xffff0000, v43
  s_lshl_b32 s27, s46, 5
  s_add_u32 s27, s27, s16
  s_lshl_b32 s27, s27, 10
  s_add_u32 s27, s27, 33554432
  buffer_store_dwordx4 v[40:43], v0, s[4:7], s27 offen sc1
  v_add_f32 v60, v44, v45
  v_mul_f32 v61, v44, v44
  v_add_f32 v62, v46, v47
  v_mul_f32 v63, v45, v45
  v_fmac_f32 v61, v46, v46
  v_fmac_f32 v63, v47, v47
  v_add_f32 v60, v60, v48
  v_fmac_f32 v61, v48, v48
  v_add_f32 v62, v62, v49
  v_fmac_f32 v63, v49, v49
  v_add_f32 v60, v60, v50
  v_fmac_f32 v61, v50, v50
  v_add_f32 v62, v62, v51
  v_fmac_f32 v63, v51, v51
  v_add_f32 v60, v60, v62
  v_add_f32 v61, v61, v63
  s_nop 0
  v_add_f32_dpp v60, v60, v60 row_ror:8 row_mask:0xf bank_mask:0xf
  v_add_f32_dpp v61, v61, v61 row_ror:8 row_mask:0xf bank_mask:0xf
  s_nop 0
  v_add_f32_dpp v60, v60, v60 row_ror:4 row_mask:0xf bank_mask:0xf
  v_add_f32_dpp v61, v61, v61 row_ror:4 row_mask:0xf bank_mask:0xf
  s_nop 0
  v_add_f32_dpp v60, v60, v60 row_ror:2 row_mask:0xf bank_mask:0xf
  v_add_f32_dpp v61, v61, v61 row_ror:2 row_mask:0xf bank_mask:0xf
  s_nop 0
  v_add_f32_dpp v60, v60, v60 row_ror:1 row_mask:0xf bank_mask:0xf
  v_add_f32_dpp v61, v61, v61 row_ror:1 row_mask:0xf bank_mask:0xf
  v_mov_b32 v64, v60
  v_mov_b32 v65, v61
  s_nop 0
  v_permlane16_swap_b32 v60, v64
  v_permlane16_swap_b32 v61, v65
  v_add_f32 v60, v60, v64
  v_add_f32 v61, v61, v65
  v_mov_b32 v64, v60
  v_mov_b32 v65, v61
  s_nop 0
  v_permlane32_swap_b32 v60, v64
  v_permlane32_swap_b32 v61, v65
  v_add_f32 v60, v60, v64
  v_add_f32 v61, v61, v65
  v_mul_f32 v60, 0x3b000000, v60
  v_mul_f32 v61, 0x3b000000, v61
  v_fma_f32 v61, -v60, v60, v61
  v_cvt_pk_bf16_f32 v60, 0, v60
  v_max_f32 v61, 0, v61
  v_sub_f32 v64, v44, v60
  v_sub_f32 v65, v45, v60
  v_cvt_pk_bf16_f32 v61, 0, v61
  v_sub_f32 v66, v46, v60
  v_sub_f32 v67, v47, v60
  v_add_f32 v61, 0x3727c5ac, v61
  v_sub_f32 v68, v48, v60
  v_sub_f32 v69, v49, v60
  v_cvt_pk_bf16_f32 v61, 0, v61
  v_sub_f32 v70, v50, v60
  v_sub_f32 v71, v51, v60
  v_sqrt_f32 v61, v61
  v_cvt_pk_bf16_f32 v64, 0, v64
  v_cvt_pk_bf16_f32 v65, 0, v65
  v_cvt_pk_bf16_f32 v61, 0, v61
  v_cvt_pk_bf16_f32 v66, 0, v66
  v_cvt_pk_bf16_f32 v67, 0, v67
  v_rcp_f32 v61, v61
  v_cvt_pk_bf16_f32 v68, 0, v68
  v_cvt_pk_bf16_f32 v69, 0, v69
  v_cvt_pk_bf16_f32 v70, 0, v70
  v_cvt_pk_bf16_f32 v71, 0, v71
  v_mul_f32 v64, v64, v61
  v_mul_f32 v65, v65, v61
  v_mul_f32 v66, v66, v61
  v_mul_f32 v67, v67, v61
  v_mul_f32 v68, v68, v61
  v_mul_f32 v69, v69, v61
  v_mul_f32 v70, v70, v61
  v_mul_f32 v71, v71, v61
  v_cvt_pk_bf16_f32 v72, v64, v65
  v_cvt_pk_bf16_f32 v73, v66, v67
  v_cvt_pk_bf16_f32 v74, v68, v69
  v_cvt_pk_bf16_f32 v75, v70, v71
  s_and_b32 s26, s59, 31
  s_lshl_b32 s27, s26, 10
  s_add_u32 s27, s27, s50
  s_and_b32 s26, s26, 15
  s_lshl_b32 s26, s26, 4
  s_or_b32 s26, s26, s27
  v_xor_b32 v3, s26, v0
  ds_write_b128 v3, v[72:75]
m_done_74:
  s_mov_b32 s62, 0
  s_mov_b32 s76, s47
  s_add_u32 s47, s46, 64
  s_branch q_cold_67
q_end_60:
  s_waitcnt vmcnt(0)
  s_mov_b64 exec, 1
  buffer_store_dword v4, off, s[4:7], s49 sc1
  s_mov_b64 exec, -1
  s_cmp_lg_u32 s60, 0
  s_cbranch_scc1 q_fail_63
  s_load_dwordx2 s[72:73], s[0:1], 96
  s_mov_b32 s74, 2097152
  s_mov_b32 s75, 0x20000
  s_load_dwordx2 s[64:65], s[0:1], 72
  s_load_dwordx2 s[68:69], s[0:1], 80
  s_load_dwordx2 s[8:9], s[0:1], 88
  s_mov_b32 s66, 1835008
  s_mov_b32 s70, 1835008
  s_mov_b32 s10, 1835008
  v_lshrrev_b32 v2, 8, v0
  v_and_b32 v3, 0x70, v0
  s_mov_b32 s26, 114688
  v_mul_lo_u32 v6, v2, s26
  v_add_u32 v6, v6, v3
  v_cmp_eq_u32 vcc, 0x70, v3
  v_mov_b32 v3, 0x7ff00000
  s_nop 0
  v_cndmask_b32 v6, v6, v3, vcc
  v_mul_u32_u24 v7, 14336, v2
  v_and_b32 v3, 0xf0, v0
  v_add_u32 v7, v7, v3
  s_mul_i32 s34, s17, 458752
  s_mul_i32 s27, s16, 112
  s_add_u32 s34, s34, s27
  s_add_u32 s34, s34, 82432
  s_mul_i32 s35, s16, 57344
  s_lshl_b32 s27, s17, 8
  s_add_u32 s35, s35, s27
  s_mov_b32 s36, 0x00ff00ff
  s_mov_b32 s37, 0x00ff00ff
  s_waitcnt lgkmcnt(0)
  s_mov_b64 exec, s[36:37]
  buffer_load_dwordx4 a[0:3], v6, s[64:67], s34 offen
  s_not_b64 exec, exec
  buffer_load_dwordx4 a[0:3], v6, s[68:71], s34 offen
  s_mov_b64 exec, -1
  s_add_u32 s34, s34, 3584
  s_mov_b64 exec, s[36:37]
  buffer_load_dwordx4 a[4:7], v6, s[64:67], s34 offen
  s_not_b64 exec, exec
  buffer_load_dwordx4 a[4:7], v6, s[68:71], s34 offen
  s_mov_b64 exec, -1
  s_add_u32 s34, s34, 3584
  s_mov_b64 exec, s[36:37]
  buffer_load_dwordx4 a[8:11], v6, s[64:67], s34 offen
  s_not_b64 exec, exec
  buffer_load_dwordx4 a[8:11], v6, s[68:71], s34 offen
  s_mov_b64 exec, -1
  s_add_u32 s34, s34, 3584
  s_mov_b64 exec, s[36:37]
  buffer_load_dwordx4 a[12:15], v6, s[64:67], s34 offen
  s_not_b64 exec, exec
  buffer_load_dwordx4 a[12:15], v6, s[68:71], s34 offen
  s_mov_b64 exec, -1
  s_add_u32 s34, s34, 3584
  s_mov_b64 exec, s[36:37]
  buffer_load_dwordx4 a[16:19], v6, s[64:67], s34 offen
  s_not_b64 exec, exec
  buffer_load_dwordx4 a[16:19], v6, s[68:71], s34 offen
  s_mov_b64 exec, -1
  s_add_u32 s34, s34, 3584
  s_mov_b64 exec, s[36:37]
  buffer_load_dwordx4 a[20:23], v6, s[64:67], s34 offen
  s_not_b64 exec, exec
  buffer_load_dwordx4 a[20:23], v6, s[68:71], s34 offen
  s_mov_b64 exec, -1
  s_add_u32 s34, s34, 3584
  s_mov_b64 exec, s[36:37]
  buffer_load_dwordx4 a[24:27], v6, s[64:67], s34 offen
  s_not_b64 exec, exec
  buffer_load_dwordx4 a[24:27], v6, s[68:71], s34 offen
  s_mov_b64 exec, -1
  s_add_u32 s34, s34, 3584
  s_mov_b64 exec, s[36:37]
  buffer_load_dwordx4 a[28:31], v6, s[64:67], s34 offen
  s_not_b64 exec, exec
  buffer_load_dwordx4 a[28:31], v6, s[68:71], s34 offen
  s_mov_b64 exec, -1
  s_add_u32 s34, s34, 3584
  s_mov_b64 exec, s[36:37]
  buffer_load_dwordx4 a[32:35], v6, s[64:67], s34 offen
  s_not_b64 exec, exec
  buffer_load_dwordx4 a[32:35], v6, s[68:71], s34 offen
  s_mov_b64 exec, -1
  s_add_u32 s34, s34, 3584
  buffer_load_dwordx4 a[36:39], v7, s[8:11], s35 offen offset:0
  buffer_load_dwordx4 a[40:43], v7, s[8:11], s35 offen offset:1024
  buffer_load_dwordx4 a[44:47], v7, s[8:11], s35 offen offset:2048
  buffer_load_dwordx4 a[48:51], v7, s[8:11], s35 offen offset:3072
  s_add_u32 s35, s35, 4096
  buffer_load_dwordx4 a[52:55], v7, s[8:11], s35 offen offset:0
  buffer_load_dwordx4 a[56:59], v7, s[8:11], s35 offen offset:1024
  buffer_load_dwordx4 a[60:63], v7, s[8:11], s35 offen offset:2048
  buffer_load_dwordx4 a[64:67], v7, s[8:11], s35 offen offset:3072
  s_add_u32 s35, s35, 4096
  buffer_load_dwordx4 a[68:71], v7, s[8:11], s35 offen offset:0
  buffer_load_dwordx4 a[72:75], v7, s[8:11], s35 offen offset:1024
  buffer_load_dwordx4 a[76:79], v7, s[8:11], s35 offen offset:2048
  buffer_load_dwordx4 a[80:83], v7, s[8:11], s35 offen offset:3072
  s_add_u32 s35, s35, 4096
  buffer_load_dwordx4 a[84:87], v7, s[8:11], s35 offen offset:0
  buffer_load_dwordx4 a[88:91], v7, s[8:11], s35 offen offset:1024
  s_andn2_b32 s28, 0xfe0, s56
  s_lshl_b32 s28, s28, 7
  s_mov_b32 s29, 243793920
  v_mov_b32 v24, 262144
  s_mov_b32 s53, 0
  s_mov_b32 s32, 15
  s_mov_b32 s33, 3
  v_mov_b32 v53, 0
k_w_76:
  s_add_u32 s33, s33, 1
  s_and_b32 s33, s33, 3
  s_bitcmp1_b32 s32, s33
  s_cbranch_scc0 k_w_76
  s_lshl2_add_u32 s26, s33, s17
  s_lshl_b32 s26, s26, 14
  s_add_u32 s27, s26, 8192
  v_add_u32 v22, s26, v9
  v_cmp_le_u32 vcc, s28, v22
  s_nop 1
  v_cndmask_b32 v25, 0, v24, vcc
  v_add_u32 v22, v22, v25
  buffer_load_dword v20, v22, s[4:7], s29 offen sc1
  v_add_u32 v23, s27, v9
  v_cmp_le_u32 vcc, s28, v23
  s_nop 1
  v_cndmask_b32 v25, 0, v24, vcc
  v_add_u32 v23, v23, v25
  buffer_load_dword v21, v23, s[4:7], s29 offen sc1
  s_add_u32 s53, s53, 1
  s_cmp_gt_u32 s53, 1048576
  s_cbranch_scc1 q_fail_63
  s_waitcnt vmcnt(0)
  v_min_u32 v52, v20, v21
  v_max3_u32 v53, v20, v21, v53
  v_cmp_eq_u32 vcc, 0, v52
  s_cbranch_vccnz k_w_76
  s_bitset0_b32 s32, s33
  s_cmp_lg_u32 s32, 0
  s_cbranch_scc1 k_w_76
  v_max_u32_dpp v53, v53, v53 row_ror:8 row_mask:0xf bank_mask:0xf
  s_nop 1
  v_max_u32_dpp v53, v53, v53 row_ror:4 row_mask:0xf bank_mask:0xf
  s_nop 1
  v_max_u32_dpp v53, v53, v53 row_ror:2 row_mask:0xf bank_mask:0xf
  s_nop 1
  v_max_u32_dpp v53, v53, v53 row_ror:1 row_mask:0xf bank_mask:0xf
  v_mov_b32 v52, v53
  s_nop 0
  s_nop 0
  v_permlane16_swap_b32 v53, v52
  v_max_u32 v53, v53, v52
  v_mov_b32 v52, v53
  s_nop 0
  s_nop 0
  v_permlane32_swap_b32 v53, v52
  v_max_u32 v53, v53, v52
  ds_write_b32 v118, v53 offset:256
  s_waitcnt lgkmcnt(0)
  s_barrier
  ds_read_b128 v[20:23], v119 offset:256
  s_waitcnt lgkmcnt(0)
  v_max3_u32 v20, v20, v21, v22
  v_max_u32 v20, v20, v23
  s_nop 0
  v_readfirstlane_b32 s58, v20
  s_andn2_b32 s26, 0xfe0, s56
  s_andn2_b32 s27, 0xfe0, s58
  s_cmp_lt_u32 s27, s26
  s_cselect_b32 s61, 1, 2
  s_andn2_b32 s59, 0xfff, s58
  s_lshl_b32 s26, s61, 21
  s_lshl_b32 s27, s59, 10
  s_add_u32 s26, s26, s27
  s_lshl_b32 s27, s17, 8
  s_add_u32 s26, s26, s27
  s_add_u32 s26, s26, 27262976
  v_lshrrev_b32 v3, 8, v0
  v_lshlrev_b32 v3, 6, v3
  buffer_load_dwordx4 v[36:39], v3, s[4:7], s26 offen offset:0 sc1
  buffer_load_dwordx4 v[40:43], v3, s[4:7], s26 offen offset:16 sc1
  buffer_load_dwordx4 v[44:47], v3, s[4:7], s26 offen offset:32 sc1
  buffer_load_dwordx4 v[48:51], v3, s[4:7], s26 offen offset:48 sc1
  s_mov_b32 vcc_lo, 0xaaaaaaaa
  s_mov_b32 vcc_hi, 0xaaaaaaaa
  v_mov_b32 v3, 0xffff
  v_mov_b32 v28, 0xffff0000
  v_cndmask_b32 v3, v3, v28, vcc
  s_mov_b32 vcc_lo, 0x30003
  s_mov_b32 vcc_hi, 0x30003
  v_cndmask_b32 v28, 0, v3, vcc
  s_mov_b32 vcc_lo, 0xc000c
  s_mov_b32 vcc_hi, 0xc000c
  v_cndmask_b32 v29, 0, v3, vcc
  s_mov_b32 vcc_lo, 0x300030
  s_mov_b32 vcc_hi, 0x300030
  v_cndmask_b32 v30, 0, v3, vcc
  s_mov_b32 vcc_lo, 0xc000c0
  s_mov_b32 vcc_hi, 0xc000c0
  v_cndmask_b32 v31, 0, v3, vcc
  s_mov_b32 s30, 0x01000100
  s_mov_b32 s31, 0x03020302
  s_mul_i32 s26, s17, 23552
  s_add_u32 s26, s26, 65536
  v_add_u32 v5, s26, v0
  ds_read_b128 v[52:55], v5 offset:0
  ds_read_b128 v[56:59], v5 offset:1024
  ds_read_b128 v[60:63], v5 offset:2048
  s_waitcnt vmcnt(0)
  v_perm_b32 v3, v36, v36, s30
  v_and_b32 v20, v28, v3
  v_and_b32 v21, v29, v3
  v_and_b32 v22, v30, v3
  v_and_b32 v23, v31, v3
  s_waitcnt lgkmcnt(2)
  s_nop 0
  v_mfma_f32_16x16x32_bf16 v[32:35], v[20:23], v[52:55], 0
  ds_read_b128 v[52:55], v5 offset:3072
  v_perm_b32 v3, v36, v36, s31
  v_and_b32 v24, v28, v3
  v_and_b32 v25, v29, v3
  v_and_b32 v26, v30, v3
  v_and_b32 v27, v31, v3
  s_waitcnt lgkmcnt(2)
  s_nop 0
  v_mfma_f32_16x16x32_bf16 v[32:35], v[24:27], v[56:59], v[32:35]
  ds_read_b128 v[56:59], v5 offset:4096
  v_perm_b32 v3, v37, v37, s30
  v_and_b32 v20, v28, v3
  v_and_b32 v21, v29, v3
  v_and_b32 v22, v30, v3
  v_and_b32 v23, v31, v3
  s_waitcnt lgkmcnt(2)
  s_nop 0
  v_mfma_f32_16x16x32_bf16 v[32:35], v[20:23], v[60:63], v[32:35]
  ds_read_b128 v[60:63], v5 offset:5120
  v_perm_b32 v3, v37, v37, s31
  v_and_b32 v24, v28, v3
  v_and_b32 v25, v29, v3
  v_and_b32 v26, v30, v3
  v_and_b32 v27, v31, v3
  s_waitcnt lgkmcnt(2)
  s_nop 0
  v_mfma_f32_16x16x32_bf16 v[32:35], v[24:27], v[52:55], v[32:35]
  ds_read_b128 v[52:55], v5 offset:6144
  v_perm_b32 v3, v38, v38, s30
  v_and_b32 v20, v28, v3
  v_and_b32 v21, v29, v3
  v_and_b32 v22, v30, v3
  v_and_b32 v23, v31, v3
  s_waitcnt lgkmcnt(2)
  s_nop 0
  v_mfma_f32_16x16x32_bf16 v[32:35], v[20:23], v[56:59], v[32:35]
  ds_read_b128 v[56:59], v5 offset:7168
  v_perm_b32 v3, v38, v38, s31
  v_and_b32 v24, v28, v3
  v_and_b32 v25, v29, v3
  v_and_b32 v26, v30, v3
  v_and_b32 v27, v31, v3
  s_waitcnt lgkmcnt(2)
  s_nop 0
  v_mfma_f32_16x16x32_bf16 v[32:35], v[24:27], v[60:63], v[32:35]
  ds_read_b128 v[60:63], v5 offset:8192
  v_perm_b32 v3, v39, v39, s30
  v_and_b32 v20, v28, v3
  v_and_b32 v21, v29, v3
  v_and_b32 v22, v30, v3
  v_and_b32 v23, v31, v3
  s_waitcnt lgkmcnt(2)
  s_nop 0
  v_mfma_f32_16x16x32_bf16 v[32:35], v[20:23], v[52:55], v[32:35]
  ds_read_b128 v[52:55], v5 offset:9216
  v_perm_b32 v3, v39, v39, s31
  v_and_b32 v24, v28, v3
  v_and_b32 v25, v29, v3
  v_and_b32 v26, v30, v3
  v_and_b32 v27, v31, v3
  s_waitcnt lgkmcnt(2)
  s_nop 0
  v_mfma_f32_16x16x32_bf16 v[32:35], v[24:27], v[56:59], v[32:35]
  ds_read_b128 v[56:59], v5 offset:10240
  v_perm_b32 v3, v40, v40, s30
  v_and_b32 v20, v28, v3
  v_and_b32 v21, v29, v3
  v_and_b32 v22, v30, v3
  v_and_b32 v23, v31, v3
  s_waitcnt lgkmcnt(2)
  s_nop 0
  v_mfma_f32_16x16x32_bf16 v[32:35], v[20:23], v[60:63], v[32:35]
  ds_read_b128 v[60:63], v5 offset:11264
  v_perm_b32 v3, v40, v40, s31
  v_and_b32 v24, v28, v3
  v_and_b32 v25, v29, v3
  v_and_b32 v26, v30, v3
  v_and_b32 v27, v31, v3
  s_waitcnt lgkmcnt(2)
  s_nop 0
  v_mfma_f32_16x16x32_bf16 v[32:35], v[24:27], v[52:55], v[32:35]
  ds_read_b128 v[52:55], v5 offset:12288
  v_perm_b32 v3, v41, v41, s30
  v_and_b32 v20, v28, v3
  v_and_b32 v21, v29, v3
  v_and_b32 v22, v30, v3
  v_and_b32 v23, v31, v3
  s_waitcnt lgkmcnt(2)
  s_nop 0
  v_mfma_f32_16x16x32_bf16 v[32:35], v[20:23], v[56:59], v[32:35]
  ds_read_b128 v[56:59], v5 offset:13312
  v_perm_b32 v3, v41, v41, s31
  v_and_b32 v24, v28, v3
  v_and_b32 v25, v29, v3
  v_and_b32 v26, v30, v3
  v_and_b32 v27, v31, v3
  s_waitcnt lgkmcnt(2)
  s_nop 0
  v_mfma_f32_16x16x32_bf16 v[32:35], v[24:27], v[60:63], v[32:35]
  ds_read_b128 v[60:63], v5 offset:14336
  v_perm_b32 v3, v42, v42, s30
  v_and_b32 v20, v28, v3
  v_and_b32 v21, v29, v3
  v_and_b32 v22, v30, v3
  v_and_b32 v23, v31, v3
  s_waitcnt lgkmcnt(2)
  s_nop 0
  v_mfma_f32_16x16x32_bf16 v[32:35], v[20:23], v[52:55], v[32:35]
  ds_read_b128 v[52:55], v5 offset:15360
  v_perm_b32 v3, v42, v42, s31
  v_and_b32 v24, v28, v3
  v_and_b32 v25, v29, v3
  v_and_b32 v26, v30, v3
  v_and_b32 v27, v31, v3
  s_waitcnt lgkmcnt(2)
  s_nop 0
  v_mfma_f32_16x16x32_bf16 v[32:35], v[24:27], v[56:59], v[32:35]
  ds_read_b128 v[56:59], v5 offset:16384
  v_perm_b32 v3, v43, v43, s30
  v_and_b32 v20, v28, v3
  v_and_b32 v21, v29, v3
  v_and_b32 v22, v30, v3
  v_and_b32 v23, v31, v3
  s_waitcnt lgkmcnt(2)
  s_nop 0
  v_mfma_f32_16x16x32_bf16 v[32:35], v[20:23], v[60:63], v[32:35]
  ds_read_b128 v[60:63], v5 offset:17408
  v_perm_b32 v3, v43, v43, s31
  v_and_b32 v24, v28, v3
  v_and_b32 v25, v29, v3
  v_and_b32 v26, v30, v3
  v_and_b32 v27, v31, v3
  s_waitcnt lgkmcnt(2)
  s_nop 0
  v_mfma_f32_16x16x32_bf16 v[32:35], v[24:27], v[52:55], v[32:35]
  ds_read_b128 v[52:55], v5 offset:18432
  v_perm_b32 v3, v44, v44, s30
  v_and_b32 v20, v28, v3
  v_and_b32 v21, v29, v3
  v_and_b32 v22, v30, v3
  v_and_b32 v23, v31, v3
  s_waitcnt lgkmcnt(2)
  s_nop 0
  v_mfma_f32_16x16x32_bf16 v[32:35], v[20:23], v[56:59], v[32:35]
  ds_read_b128 v[56:59], v5 offset:19456
  v_perm_b32 v3, v44, v44, s31
  v_and_b32 v24, v28, v3
  v_and_b32 v25, v29, v3
  v_and_b32 v26, v30, v3
  v_and_b32 v27, v31, v3
  s_waitcnt lgkmcnt(2)
  s_nop 0
  v_mfma_f32_16x16x32_bf16 v[32:35], v[24:27], v[60:63], v[32:35]
  ds_read_b128 v[60:63], v5 offset:20480
  v_perm_b32 v3, v45, v45, s30
  v_and_b32 v20, v28, v3
  v_and_b32 v21, v29, v3
  v_and_b32 v22, v30, v3
  v_and_b32 v23, v31, v3
  s_waitcnt lgkmcnt(2)
  s_nop 0
  v_mfma_f32_16x16x32_bf16 v[32:35], v[20:23], v[52:55], v[32:35]
  ds_read_b128 v[52:55], v5 offset:21504
  v_perm_b32 v3, v45, v45, s31
  v_and_b32 v24, v28, v3
  v_and_b32 v25, v29, v3
  v_and_b32 v26, v30, v3
  v_and_b32 v27, v31, v3
  s_waitcnt lgkmcnt(2)
  s_nop 0
  v_mfma_f32_16x16x32_bf16 v[32:35], v[24:27], v[56:59], v[32:35]
  ds_read_b128 v[56:59], v5 offset:22528
  v_perm_b32 v3, v46, v46, s30
  v_and_b32 v20, v28, v3
  v_and_b32 v21, v29, v3
  v_and_b32 v22, v30, v3
  v_and_b32 v23, v31, v3
  s_waitcnt lgkmcnt(2)
  s_nop 0
  v_mfma_f32_16x16x32_bf16 v[32:35], v[20:23], v[60:63], v[32:35]
  v_perm_b32 v3, v46, v46, s31
  v_and_b32 v24, v28, v3
  v_and_b32 v25, v29, v3
  v_and_b32 v26, v30, v3
  v_and_b32 v27, v31, v3
  s_waitcnt lgkmcnt(1)
  s_nop 0
  v_mfma_f32_16x16x32_bf16 v[32:35], v[24:27], v[52:55], v[32:35]
  v_perm_b32 v3, v47, v47, s30
  v_and_b32 v20, v28, v3
  v_and_b32 v21, v29, v3
  v_and_b32 v22, v30, v3
  v_and_b32 v23, v31, v3
  s_waitcnt lgkmcnt(0)
  s_nop 0
  v_mfma_f32_16x16x32_bf16 v[32:35], v[20:23], v[56:59], v[32:35]
  v_perm_b32 v3, v47, v47, s31
  v_and_b32 v24, v28, v3
  v_and_b32 v25, v29, v3
  v_and_b32 v26, v30, v3
  v_and_b32 v27, v31, v3
  s_nop 0
  s_nop 0
  v_mfma_f32_16x16x32_bf16 v[32:35], v[24:27], a[0:3], v[32:35]
  v_perm_b32 v3, v48, v48, s30
  v_and_b32 v20, v28, v3
  v_and_b32 v21, v29, v3
  v_and_b32 v22, v30, v3
  v_and_b32 v23, v31, v3
  s_nop 0
  s_nop 0
  v_mfma_f32_16x16x32_bf16 v[32:35], v[20:23], a[4:7], v[32:35]
  v_perm_b32 v3, v48, v48, s31
  v_and_b32 v24, v28, v3
  v_and_b32 v25, v29, v3
  v_and_b32 v26, v30, v3
  v_and_b32 v27, v31, v3
  s_nop 0
  s_nop 0
  v_mfma_f32_16x16x32_bf16 v[32:35], v[24:27], a[8:11], v[32:35]
  v_perm_b32 v3, v49, v49, s30
  v_and_b32 v20, v28, v3
  v_and_b32 v21, v29, v3
  v_and_b32 v22, v30, v3
  v_and_b32 v23, v31, v3
  s_nop 0
  s_nop 0
  v_mfma_f32_16x16x32_bf16 v[32:35], v[20:23], a[12:15], v[32:35]
  v_perm_b32 v3, v49, v49, s31
  v_and_b32 v24, v28, v3
  v_and_b32 v25, v29, v3
  v_and_b32 v26, v30, v3
  v_and_b32 v27, v31, v3
  s_nop 0
  s_nop 0
  v_mfma_f32_16x16x32_bf16 v[32:35], v[24:27], a[16:19], v[32:35]
  v_perm_b32 v3, v50, v50, s30
  v_and_b32 v20, v28, v3
  v_and_b32 v21, v29, v3
  v_and_b32 v22, v30, v3
  v_and_b32 v23, v31, v3
  s_nop 0
  s_nop 0
  v_mfma_f32_16x16x32_bf16 v[32:35], v[20:23], a[20:23], v[32:35]
  v_perm_b32 v3, v50, v50, s31
  v_and_b32 v24, v28, v3
  v_and_b32 v25, v29, v3
  v_and_b32 v26, v30, v3
  v_and_b32 v27, v31, v3
  s_nop 0
  s_nop 0
  v_mfma_f32_16x16x32_bf16 v[32:35], v[24:27], a[24:27], v[32:35]
  v_perm_b32 v3, v51, v51, s30
  v_and_b32 v20, v28, v3
  v_and_b32 v21, v29, v3
  v_and_b32 v22, v30, v3
  v_and_b32 v23, v31, v3
  s_nop 0
  s_nop 0
  v_mfma_f32_16x16x32_bf16 v[32:35], v[20:23], a[28:31], v[32:35]
  v_perm_b32 v3, v51, v51, s31
  v_and_b32 v24, v28, v3
  v_and_b32 v25, v29, v3
  v_and_b32 v26, v30, v3
  v_and_b32 v27, v31, v3
  s_nop 0
  s_nop 0
  v_mfma_f32_16x16x32_bf16 v[32:35], v[24:27], a[32:35], v[32:35]
  v_lshrrev_b32 v2, 8, v0
  v_and_b32 v3, 0xf0, v0
  v_lshlrev_b32 v3, 1, v3
  v_lshl_add_u32 v3, v2, 4, v3
  s_lshl_b32 s26, s17, 9
  s_add_u32 s26, s26, 159744
  v_add_u32 v5, s26, v3
  s_mov_b32 exec_hi, 0
  ds_write_b128 v5, v[32:35]
  s_mov_b32 exec_hi, -1
  v_add_u32 v5, 159744, v1
  s_waitcnt lgkmcnt(0)
  s_barrier
  ds_read_b32 v36, v5 offset:0
  ds_read_b32 v37, v5 offset:256
  ds_read_b32 v38, v5 offset:512
  ds_read_b32 v39, v5 offset:768
  ds_read_b32 v40, v5 offset:1024
  ds_read_b32 v41, v5 offset:1280
  ds_read_b32 v42, v5 offset:1536
  ds_read_b32 v43, v5 offset:1792
  s_waitcnt lgkmcnt(0)
  v_add_f32 v36, v36, v38
  v_add_f32 v40, v40, v42
  v_add_f32 v36, v36, v40
  v_cvt_pk_bf16_f32 v36, 0, v36
  v_add_f32 v37, v37, v39
  v_add_f32 v41, v41, v43
  v_add_f32 v37, v37, v41
  v_cvt_pk_bf16_f32 v37, 0, v37
  v_mul_f32 v40, 0xbfb8aa3b, v36
  v_exp_f32 v40, v40
  s_nop 0
  v_add_f32 v40, 1.0, v40
  v_rcp_f32 v40, v40
  s_nop 0
  v_mul_f32 v36, v36, v40
  v_cvt_pk_bf16_f32 v36, 0, v36
  v_mul_f32 v36, v36, v37
  v_cvt_pk_bf16_f32 v36, v36, v36
  s_lshl_b32 s26, s17, 8
  s_add_u32 s26, s26, 161792
  v_add_u32 v5, s26, v1
  ds_write_b32 v5, v36
  v_mul_u32_u24 v5, 56, v2
  v_add_u32 v5, s26, v5
  ds_read_b64 v[36:37], v5 offset:0
  ds_read_b64 v[38:39], v5 offset:8
  ds_read_b64 v[40:41], v5 offset:16
  ds_read_b64 v[42:43], v5 offset:24
  ds_read_b64 v[44:45], v5 offset:32
  ds_read_b64 v[46:47], v5 offset:40
  ds_read_b64 v[48:49], v5 offset:48
  s_waitcnt lgkmcnt(0)
  v_and_b32 v20, v28, v36
  v_and_b32 v21, v29, v36
  v_and_b32 v22, v30, v36
  v_and_b32 v23, v31, v36
  s_nop 0
  s_nop 0
  v_mfma_f32_16x16x32_bf16 v[32:35], v[20:23], a[36:39], 0
  v_and_b32 v24, v28, v37
  v_and_b32 v25, v29, v37
  v_and_b32 v26, v30, v37
  v_and_b32 v27, v31, v37
  s_nop 0
  s_nop 0
  v_mfma_f32_16x16x32_bf16 v[32:35], v[24:27], a[40:43], v[32:35]
  v_and_b32 v20, v28, v38
  v_and_b32 v21, v29, v38
  v_and_b32 v22, v30, v38
  v_and_b32 v23, v31, v38
  s_nop 0
  s_nop 0
  v_mfma_f32_16x16x32_bf16 v[32:35], v[20:23], a[44:47], v[32:35]
  v_and_b32 v24, v28, v39
  v_and_b32 v25, v29, v39
  v_and_b32 v26, v30, v39
  v_and_b32 v27, v31, v39
  s_nop 0
  s_nop 0
  v_mfma_f32_16x16x32_bf16 v[32:35], v[24:27], a[48:51], v[32:35]
  v_and_b32 v20, v28, v40
  v_and_b32 v21, v29, v40
  v_and_b32 v22, v30, v40
  v_and_b32 v23, v31, v40
  s_nop 0
  s_nop 0
  v_mfma_f32_16x16x32_bf16 v[32:35], v[20:23], a[52:55], v[32:35]
  v_and_b32 v24, v28, v41
  v_and_b32 v25, v29, v41
  v_and_b32 v26, v30, v41
  v_and_b32 v27, v31, v41
  s_nop 0
  s_nop 0
  v_mfma_f32_16x16x32_bf16 v[32:35], v[24:27], a[56:59], v[32:35]
  v_and_b32 v20, v28, v42
  v_and_b32 v21, v29, v42
  v_and_b32 v22, v30, v42
  v_and_b32 v23, v31, v42
  s_nop 0
  s_nop 0
  v_mfma_f32_16x16x32_bf16 v[32:35], v[20:23], a[60:63], v[32:35]
  v_and_b32 v24, v28, v43
  v_and_b32 v25, v29, v43
  v_and_b32 v26, v30, v43
  v_and_b32 v27, v31, v43
  s_nop 0
  s_nop 0
  v_mfma_f32_16x16x32_bf16 v[32:35], v[24:27], a[64:67], v[32:35]
  v_and_b32 v20, v28, v44
  v_and_b32 v21, v29, v44
  v_and_b32 v22, v30, v44
  v_and_b32 v23, v31, v44
  s_nop 0
  s_nop 0
  v_mfma_f32_16x16x32_bf16 v[32:35], v[20:23], a[68:71], v[32:35]
  v_and_b32 v24, v28, v45
  v_and_b32 v25, v29, v45
  v_and_b32 v26, v30, v45
  v_and_b32 v27, v31, v45
  s_nop 0
  s_nop 0
  v_mfma_f32_16x16x32_bf16 v[32:35], v[24:27], a[72:75], v[32:35]
  v_and_b32 v20, v28, v46
  v_and_b32 v21, v29, v46
  v_and_b32 v22, v30, v46
  v_and_b32 v23, v31, v46
  s_nop 0
  s_nop 0
  v_mfma_f32_16x16x32_bf16 v[32:35], v[20:23], a[76:79], v[32:35]
  v_and_b32 v24, v28, v47
  v_and_b32 v25, v29, v47
  v_and_b32 v26, v30, v47
  v_and_b32 v27, v31, v47
  s_nop 0
  s_nop 0
  v_mfma_f32_16x16x32_bf16 v[32:35], v[24:27], a[80:83], v[32:35]
  v_and_b32 v20, v28, v48
  v_and_b32 v21, v29, v48
  v_and_b32 v22, v30, v48
  v_and_b32 v23, v31, v48
  s_nop 0
  s_nop 0
  v_mfma_f32_16x16x32_bf16 v[32:35], v[20:23], a[84:87], v[32:35]
  v_and_b32 v24, v28, v49
  v_and_b32 v25, v29, v49
  v_and_b32 v26, v30, v49
  v_and_b32 v27, v31, v49
  s_nop 0
  s_nop 0
  v_mfma_f32_16x16x32_bf16 v[32:35], v[24:27], a[88:91], v[32:35]
  v_lshrrev_b32 v3, 1, v3
  s_lshl_b32 s26, s47, 7
  s_add_u32 s26, s26, s57
  s_lshl_b32 s26, s26, 8
  s_add_u32 s26, s26, 244318208
  s_nop 2
  v_cvt_pk_bf16_f32 v32, v32, v33
  v_cvt_pk_bf16_f32 v33, v34, v35
  v_min_u32 v32, -2, v32
  v_min_u32 v33, -2, v33
  s_mov_b32 exec_hi, 0
  buffer_store_dwordx2 v[32:33], v3, s[4:7], s26 offen sc1
  s_mov_b32 exec_hi, -1
  s_cmp_lg_u32 s16, 0
  s_cbranch_scc1 q_fail_63
  s_barrier
  s_lshl_b32 s26, s61, 21
  s_lshl_b32 s27, s59, 10
  s_add_u32 s26, s26, s27
  s_add_u32 s27, s26, 20971520
  s_add_u32 s28, s26, 27262976
  s_lshl_b32 s26, s47, 7
  s_add_u32 s26, s26, s17
  s_lshl_b32 s26, s26, 8
  s_add_u32 s26, s26, 244318208
  v_lshrrev_b32 v2, 8, v0
  v_and_b32 v3, 0xf0, v0
  v_lshl_add_u32 v5, v2, 10, v3
  buffer_load_dwordx4 v[36:39], v0, s[4:7], s27 offen sc1
  buffer_load_dwordx4 v[40:43], v0, s[4:7], s28 offen sc1
  s_mov_b32 s53, 0
m_w_78:
  s_add_u32 s27, s26, 0
  buffer_load_dwordx4 v[60:63], v5, s[4:7], s27 offen sc1
  s_add_u32 s27, s26, 4096
  buffer_load_dwordx4 v[64:67], v5, s[4:7], s27 offen sc1
  s_add_u32 s27, s26, 8192
  buffer_load_dwordx4 v[68:71], v5, s[4:7], s27 offen sc1
  s_add_u32 s27, s26, 12288
  buffer_load_dwordx4 v[72:75], v5, s[4:7], s27 offen sc1
  s_add_u32 s27, s26, 16384
  buffer_load_dwordx4 v[76:79], v5, s[4:7], s27 offen sc1
  s_add_u32 s27, s26, 20480
  buffer_load_dwordx4 v[80:83], v5, s[4:7], s27 offen sc1
  s_add_u32 s27, s26, 24576
  buffer_load_dwordx4 v[84:87], v5, s[4:7], s27 offen sc1
  s_add_u32 s27, s26, 28672
  buffer_load_dwordx4 v[88:91], v5, s[4:7], s27 offen sc1
  s_add_u32 s53, s53, 1
  s_cmp_gt_u32 s53, 1048576
  s_cbranch_scc1 q_fail_63
  s_mov_b32 vcc_lo, 0xaaaaaaaa
  s_mov_b32 vcc_hi, 0xaaaaaaaa
  v_mov_b32 v28, 0x3f80
  v_mov_b32 v20, 1.0
  v_cndmask_b32 v28, v28, v20, vcc
  s_mov_b32 vcc_lo, 0x30003
  s_mov_b32 vcc_hi, 0x30003
  v_cndmask_b32 v20, 0, v28, vcc
  s_mov_b32 vcc_lo, 0xc000c
  s_mov_b32 vcc_hi, 0xc000c
  v_cndmask_b32 v21, 0, v28, vcc
  s_mov_b32 vcc_lo, 0x300030
  s_mov_b32 vcc_hi, 0x300030
  v_cndmask_b32 v22, 0, v28, vcc
  s_mov_b32 vcc_lo, 0xc000c0
  s_mov_b32 vcc_hi, 0xc000c0
  v_cndmask_b32 v23, 0, v28, vcc
  s_waitcnt vmcnt(7)
  s_nop 0
  v_mfma_f32_16x16x32_bf16 v[28:31], v[20:23], v[60:63], 0
  v_max3_u32 v44, v60, v61, 0
  v_max3_u32 v44, v62, v63, v44
  s_waitcnt vmcnt(6)
  v_mfma_f32_16x16x32_bf16 v[28:31], v[20:23], v[64:67], v[28:31]
  v_max3_u32 v44, v64, v65, v44
  v_max3_u32 v44, v66, v67, v44
  s_waitcnt vmcnt(5)
  v_mfma_f32_16x16x32_bf16 v[28:31], v[20:23], v[68:71], v[28:31]
  v_max3_u32 v44, v68, v69, v44
  v_max3_u32 v44, v70, v71, v44
  s_waitcnt vmcnt(4)
  v_mfma_f32_16x16x32_bf16 v[28:31], v[20:23], v[72:75], v[28:31]
  v_max3_u32 v44, v72, v73, v44
  v_max3_u32 v44, v74, v75, v44
  s_waitcnt vmcnt(3)
  v_mfma_f32_16x16x32_bf16 v[28:31], v[20:23], v[76:79], v[28:31]
  v_max3_u32 v44, v76, v77, v44
  v_max3_u32 v44, v78, v79, v44
  s_waitcnt vmcnt(2)
  v_mfma_f32_16x16x32_bf16 v[28:31], v[20:23], v[80:83], v[28:31]
  v_max3_u32 v44, v80, v81, v44
  v_max3_u32 v44, v82, v83, v44
  s_waitcnt vmcnt(1)
  v_mfma_f32_16x16x32_bf16 v[28:31], v[20:23], v[84:87], v[28:31]
  v_max3_u32 v44, v84, v85, v44
  v_max3_u32 v44, v86, v87, v44
  s_waitcnt vmcnt(0)
  v_mfma_f32_16x16x32_bf16 v[28:31], v[20:23], v[88:91], v[28:31]
  v_max3_u32 v44, v88, v89, v44
  v_max3_u32 v44, v90, v91, v44
  v_cmp_eq_u32 vcc, -1, v44
  s_cbranch_vccnz m_w_78
  v_lshlrev_b32 v3, 1, v3
  v_lshl_add_u32 v3, v2, 4, v3
  s_lshl_b32 s26, s17, 9
  s_add_u32 s26, s26, 159744
  v_add_u32 v3, s26, v3
  s_mov_b32 exec_hi, 0
  ds_write_b128 v3, v[28:31]
  s_mov_b32 exec_hi, -1
  v_lshlrev_b32 v3, 1, v0
  v_add_u32 v3, 159744, v3
  v_lshlrev_b32 v44, 16, v36
  v_and_b32 v45, 0xffff0000, v36
  v_lshlrev_b32 v46, 16, v37
  v_and_b32 v47, 0xffff0000, v37
  v_lshlrev_b32 v48, 16, v38
  v_and_b32 v49, 0xffff0000, v38
  v_lshlrev_b32 v50, 16, v39
  v_and_b32 v51, 0xffff0000, v39
  v_lshlrev_b32 v52, 16, v40
  v_and_b32 v53, 0xffff0000, v40
  v_lshlrev_b32 v54, 16, v41
  v_and_b32 v55, 0xffff0000, v41
  v_lshlrev_b32 v56, 16, v42
  v_and_b32 v57, 0xffff0000, v42
  v_lshlrev_b32 v58, 16, v43
  v_and_b32 v59, 0xffff0000, v43
  s_waitcnt lgkmcnt(0)
  s_barrier
  s_cmp_lg_u32 s17, 0
  s_cbranch_scc1 m_done_77
  ds_read_b128 v[28:31], v3
  ds_read_b128 v[32:35], v3 offset:16
  s_and_b32 s29, s58, 0xffff0000
  s_xor_b32 s27, s29, 0x80000000
  s_xor_b32 s28, s29, 0xffff0000
  s_bitcmp1_b32 s29, 31
  s_cselect_b32 s29, s27, s28
  v_mov_b32 v36, s29
  v_mul_f32 v36, 0xbfb8aa3b, v36
  v_exp_f32 v36, v36
  s_nop 0
  v_add_f32 v36, 1.0, v36
  v_rcp_f32 v36, v36
  s_nop 0
  v_cvt_pk_bf16_f32 v36, 0, v36
  s_waitcnt lgkmcnt(0)
  v_cvt_pk_bf16_f32 v28, 0, v28
  v_cvt_pk_bf16_f32 v29, 0, v29
  v_cvt_pk_bf16_f32 v30, 0, v30
  v_cvt_pk_bf16_f32 v31, 0, v31
  v_cvt_pk_bf16_f32 v32, 0, v32
  v_cvt_pk_bf16_f32 v33, 0, v33
  v_cvt_pk_bf16_f32 v34, 0, v34
  v_cvt_pk_bf16_f32 v35, 0, v35
  v_mul_f32 v28, v28, v36
  v_mul_f32 v29, v29, v36
  v_mul_f32 v30, v30, v36
  v_mul_f32 v31, v31, v36
  v_mul_f32 v32, v32, v36
  v_mul_f32 v33, v33, v36
  v_mul_f32 v34, v34, v36
  v_mul_f32 v35, v35, v36
  v_cvt_pk_bf16_f32 v28, 0, v28
  v_cvt_pk_bf16_f32 v29, 0, v29
  v_cvt_pk_bf16_f32 v30, 0, v30
  v_cvt_pk_bf16_f32 v31, 0, v31
  v_cvt_pk_bf16_f32 v32, 0, v32
  v_cvt_pk_bf16_f32 v33, 0, v33
  v_cvt_pk_bf16_f32 v34, 0, v34
  v_cvt_pk_bf16_f32 v35, 0, v35
  v_add_f32 v28, v28, v52
  v_add_f32 v29, v29, v53
  v_add_f32 v30, v30, v54
  v_add_f32 v31, v31, v55
  v_add_f32 v32, v32, v56
  v_add_f32 v33, v33, v57
  v_add_f32 v34, v34, v58
  v_add_f32 v35, v35, v59
  v_cvt_pk_bf16_f32 v28, 0, v28
  v_cvt_pk_bf16_f32 v29, 0, v29
  v_cvt_pk_bf16_f32 v30, 0, v30
  v_cvt_pk_bf16_f32 v31, 0, v31
  v_cvt_pk_bf16_f32 v32, 0, v32
  v_cvt_pk_bf16_f32 v33, 0, v33
  v_cvt_pk_bf16_f32 v34, 0, v34
  v_cvt_pk_bf16_f32 v35, 0, v35
  v_add_f32 v44, v44, v28
  v_add_f32 v45, v45, v29
  v_add_f32 v46, v46, v30
  v_add_f32 v47, v47, v31
  v_add_f32 v48, v48, v32
  v_add_f32 v49, v49, v33
  v_add_f32 v50, v50, v34
  v_add_f32 v51, v51, v35
  v_cvt_pk_bf16_f32 v40, v44, v45
  v_cvt_pk_bf16_f32 v41, v46, v47
  v_cvt_pk_bf16_f32 v42, v48, v49
  v_cvt_pk_bf16_f32 v43, v50, v51
  v_lshlrev_b32 v44, 16, v40
  v_and_b32 v45, 0xffff0000, v40
  v_lshlrev_b32 v46, 16, v41
  v_and_b32 v47, 0xffff0000, v41
  v_lshlrev_b32 v48, 16, v42
  v_and_b32 v49, 0xffff0000, v42
  v_lshlrev_b32 v50, 16, v43
  v_and_b32 v51, 0xffff0000, v43
  s_lshl_b32 s26, s59, 10
  buffer_store_dwordx4 v[40:43], v0, s[72:75], s26 offen sc1
m_done_77:
q_fail_63:
  s_endpgm
L_o:
  s_sub_u32 s60, s91, 3
  s_and_b32 s61, s90, 15
  s_load_dwordx2 s[80:81], s[0:1], 40
  s_load_dwordx2 s[72:73], s[0:1], 0
  s_mov_b32 s82, 4194304
  v_and_b32 v42, 63, v0
  v_and_b32 v40, 15, v42
  v_lshrrev_b32 v41, 4, v42
  v_lshlrev_b32 v1, 3, v42
  v_lshlrev_b32 v2, 2, v42
  v_lshlrev_b32 v0, 4, v42
  s_mov_b32 s24, 0x3e0293ee
  s_mov_b32 s44, 0x05040100
  s_mov_b32 s45, 0x07060302
  s_and_b32 s26, s17, 1
  s_lshl_b32 s26, s26, 4
  v_lshlrev_b32 v43, 2, v41
  v_sub_u32 v43, v40, v43
  v_add_u32 v43, s26, v43
  v_mov_b32 v7, 0xfe000000
  v_cmp_le_i32 vcc, 0, v43
  s_nop 1
  v_cndmask_b32 v24, v7, 0, vcc
  v_cmp_le_i32 vcc, 1, v43
  s_nop 1
  v_cndmask_b32 v25, v7, 0, vcc
  v_cmp_le_i32 vcc, 2, v43
  s_nop 1
  v_cndmask_b32 v26, v7, 0, vcc
  v_cmp_le_i32 vcc, 3, v43
  s_nop 1
  v_cndmask_b32 v27, v7, 0, vcc
  v_cmp_le_i32 vcc, 16, v43
  s_nop 1
  v_cndmask_b32 v28, v7, 0, vcc
  v_cmp_le_i32 vcc, 17, v43
  s_nop 1
  v_cndmask_b32 v29, v7, 0, vcc
  v_cmp_le_i32 vcc, 18, v43
  s_nop 1
  v_cndmask_b32 v30, v7, 0, vcc
  v_cmp_le_i32 vcc, 19, v43
  s_nop 1
  v_cndmask_b32 v31, v7, 0, vcc
  v_lshrrev_b32 v43, 5, v42
  v_lshlrev_b32 v43, 16, v43
  v_and_b32 v4, 1, v41
  v_lshl_add_u32 v43, v4, 14, v43
  v_lshl_add_u32 v43, v40, 4, v43
  s_lshl_b32 s26, s61, 10
  s_lshl_b32 s27, s17, 8
  s_add_u32 s26, s26, s27
  v_add_u32 v4, s26, v43
  v_lshlrev_b32 v43, 10, v41
  v_lshl_add_u32 v5, v40, 4, v43
  s_lshl_b32 s26, s17, 12
  v_add_u32 v6, s26, v0
  v_and_b32 v43, 1, v41
  v_lshlrev_b32 v43, 12, v43
  v_lshl_add_u32 v43, v40, 4, v43
  v_lshrrev_b32 v3, 1, v41
  v_lshl_add_u32 v3, v3, 8, v43
  s_lshr_b32 s26, s17, 1
  s_lshl_b32 s27, s26, 14
  s_add_u32 s27, s27, 16384
  v_add_u32 v32, s27, v0
  s_lshl_b32 s27, s26, 13
  s_and_b32 s28, s17, 1
  s_lshl_b32 s28, s28, 10
  s_add_u32 s28, s28, s27
  s_add_u32 s28, s28, 49152
  v_add_u32 v33, s28, v0
  s_add_u32 s27, s27, 65536
  v_add_u32 v34, s27, v0
  v_add_u32 v35, s27, v1
  v_and_b32 v36, 0xf0, v0
  v_and_b32 v252, 64, v0
  v_mov_b32 v248, 0
  v_lshlrev_b32 v255, 4, v0
  v_and_b32 v43, 1, v42
  v_xor_b32 v254, 1, v43
  s_lshl_b32 s26, s17, 3
  s_add_u32 s26, s26, 81920
  v_mov_b32 v39, s26
  s_mov_b32 vcc_lo, 0xaaaaaaaa
  s_mov_b32 vcc_hi, 0xaaaaaaaa
  v_mov_b32 v43, 0x3f80
  v_cndmask_b32 v43, v43, 1.0, vcc
  s_mov_b32 vcc_lo, 0xf000f
  s_mov_b32 vcc_hi, 0xf000f00
  v_cndmask_b32 v16, 0, v43, vcc
  v_cndmask_b32 v18, 0, v43, vcc
  s_mov_b32 vcc_lo, 0xf000f0
  s_mov_b32 vcc_hi, 0xf000f000
  v_cndmask_b32 v17, 0, v43, vcc
  v_cndmask_b32 v19, 0, v43, vcc
  s_mov_b32 vcc_lo, 0xcccccccc
  s_mov_b32 vcc_hi, 0xcccccccc
  v_mov_b32 v43, 0x4444
  v_mov_b32 v20, 0xeeee
  v_cndmask_b32 v20, v43, v20, vcc
  s_mov_b32 s70, 2097152
  s_mov_b32 s71, 0x20000
  s_mov_b32 s74, 2097152
  s_mov_b32 s75, 0x20000
  s_mov_b32 s10, 1024
  s_mov_b32 s83, 0x20000
  s_lshr_b32 s85, s17, 1
  s_lshl_b32 s26, s61, 1
  s_add_u32 s85, s85, s26
  s_add_u32 s43, s26, s17
  s_lshl_b32 s14, s61, 8
  s_lshl_b32 s15, s61, 7
  s_add_u32 s15, s15, 245104640
  s_add_u32 s14, s14, 244318208
  s_lshl_b32 s26, s61, 2
  s_add_u32 s26, s26, s17
  s_lshl_b32 s18, s26, 13
  s_add_u32 s18, s18, 41943040
  s_lshl_b32 s19, s26, 12
  s_add_u32 s19, s19, 142606336
  s_lshl_b32 s20, s85, 13
  s_add_u32 s20, s20, 192937984
  s_and_b32 s26, s17, 1
  s_mul_i32 s26, s26, 3072
  s_add_u32 s21, s20, s26
  s_lshr_b32 s40, s17, 1
  s_lshl_b32 s40, s40, 13
  s_add_u32 s40, s40, s26
  s_add_u32 s40, s40, 65536
  s_lshl_b32 s22, s17, 12
  s_add_u32 s22, s22, 49152
  s_lshl_b32 s23, s17, 13
  s_add_u32 s23, s23, 16384
  s_lshl_b32 s41, s60, 20
  s_add_u32 s41, s41, 12582912
  v_lshlrev_b32 v246, 3, v0
  s_mov_b32 s11, 0x20000
  s_waitcnt lgkmcnt(0)
  s_lshl_b32 s77, s60, 4
  s_add_u32 s77, s77, s61
  s_lshl_b32 s77, s77, 2
  s_add_u32 s77, s77, s17
  s_lshl_b32 s26, s77, 10
  buffer_load_dwordx4 v[176:179], v0, s[72:75], s26 offen
  s_add_u32 s26, s26, 262144
  buffer_load_dwordx4 v[180:183], v0, s[72:75], s26 offen
  s_add_u32 s26, s26, 262144
  buffer_load_dwordx4 v[184:187], v0, s[72:75], s26 offen
  s_add_u32 s26, s26, 262144
  buffer_load_dwordx4 v[188:191], v0, s[72:75], s26 offen
  s_add_u32 s26, s26, 262144
  buffer_load_dwordx4 v[192:195], v0, s[72:75], s26 offen
  s_add_u32 s26, s26, 262144
  buffer_load_dwordx4 v[196:199], v0, s[72:75], s26 offen
  s_add_u32 s26, s26, 262144
  buffer_load_dwordx4 v[200:203], v0, s[72:75], s26 offen
  s_add_u32 s26, s26, 262144
  buffer_load_dwordx4 v[204:207], v0, s[72:75], s26 offen
  s_add_u32 s26, s26, 262144
  v_lshrrev_b32 v44, 9, v0
  v_lshlrev_b32 v44, 12, v44
  v_and_b32 v45, 0xf0, v0
  v_add_u32 v44, v44, v45
  v_bfe_u32 v45, v0, 8, 1
  v_lshl_add_u32 v44, v45, 3, v44
  s_lshl_b32 s30, s61, 18
  s_lshl_b32 s27, s17, 8
  s_add_u32 s30, s30, s27
  s_add_u32 s27, s30, 0
  buffer_load_dwordx2 v[64:65], v44, s[80:83], s27 offen
  s_add_u32 s27, s30, 1024
  buffer_load_dwordx2 v[66:67], v44, s[80:83], s27 offen
  s_add_u32 s27, s30, 2048
  buffer_load_dwordx2 v[68:69], v44, s[80:83], s27 offen
  s_add_u32 s27, s30, 3072
  buffer_load_dwordx2 v[70:71], v44, s[80:83], s27 offen
  s_add_u32 s27, s30, 16384
  buffer_load_dwordx2 v[72:73], v44, s[80:83], s27 offen
  s_add_u32 s27, s30, 17408
  buffer_load_dwordx2 v[74:75], v44, s[80:83], s27 offen
  s_add_u32 s27, s30, 18432
  buffer_load_dwordx2 v[76:77], v44, s[80:83], s27 offen
  s_add_u32 s27, s30, 19456
  buffer_load_dwordx2 v[78:79], v44, s[80:83], s27 offen
  s_add_u32 s27, s30, 8192
  buffer_load_dwordx2 v[80:81], v44, s[80:83], s27 offen
  s_add_u32 s27, s30, 9216
  buffer_load_dwordx2 v[82:83], v44, s[80:83], s27 offen
  s_add_u32 s27, s30, 10240
  buffer_load_dwordx2 v[84:85], v44, s[80:83], s27 offen
  s_add_u32 s27, s30, 11264
  buffer_load_dwordx2 v[86:87], v44, s[80:83], s27 offen
  s_add_u32 s27, s30, 24576
  buffer_load_dwordx2 v[88:89], v44, s[80:83], s27 offen
  s_add_u32 s27, s30, 25600
  buffer_load_dwordx2 v[90:91], v44, s[80:83], s27 offen
  s_add_u32 s27, s30, 26624
  buffer_load_dwordx2 v[92:93], v44, s[80:83], s27 offen
  s_add_u32 s27, s30, 27648
  buffer_load_dwordx2 v[94:95], v44, s[80:83], s27 offen
  s_add_u32 s27, s30, 32768
  buffer_load_dwordx2 v[96:97], v44, s[80:83], s27 offen
  s_add_u32 s27, s30, 33792
  buffer_load_dwordx2 v[98:99], v44, s[80:83], s27 offen
  s_add_u32 s27, s30, 34816
  buffer_load_dwordx2 v[100:101], v44, s[80:83], s27 offen
  s_add_u32 s27, s30, 35840
  buffer_load_dwordx2 v[102:103], v44, s[80:83], s27 offen
  s_add_u32 s27, s30, 49152
  buffer_load_dwordx2 v[104:105], v44, s[80:83], s27 offen
  s_add_u32 s27, s30, 50176
  buffer_load_dwordx2 v[106:107], v44, s[80:83], s27 offen
  s_add_u32 s27, s30, 51200
  buffer_load_dwordx2 v[108:109], v44, s[80:83], s27 offen
  s_add_u32 s27, s30, 52224
  buffer_load_dwordx2 v[110:111], v44, s[80:83], s27 offen
  s_add_u32 s27, s30, 40960
  buffer_load_dwordx2 v[112:113], v44, s[80:83], s27 offen
  s_add_u32 s27, s30, 41984
  buffer_load_dwordx2 v[114:115], v44, s[80:83], s27 offen
  s_add_u32 s27, s30, 43008
  buffer_load_dwordx2 v[116:117], v44, s[80:83], s27 offen
  s_add_u32 s27, s30, 44032
  buffer_load_dwordx2 v[118:119], v44, s[80:83], s27 offen
  s_add_u32 s27, s30, 57344
  buffer_load_dwordx2 v[120:121], v44, s[80:83], s27 offen
  s_add_u32 s27, s30, 58368
  buffer_load_dwordx2 v[122:123], v44, s[80:83], s27 offen
  s_add_u32 s27, s30, 59392
  buffer_load_dwordx2 v[124:125], v44, s[80:83], s27 offen
  s_add_u32 s27, s30, 60416
  buffer_load_dwordx2 v[126:127], v44, s[80:83], s27 offen
  s_load_dwordx2 s[4:5], s[0:1], 112
  s_load_dwordx2 s[12:13], s[0:1], 104
  s_load_dwordx2 s[68:69], s[0:1], 96
  s_load_dwordx2 s[8:9], s[0:1], 64
  s_waitcnt lgkmcnt(0)
  buffer_load_dwordx4 v[56:59], v0, s[8:11], 0 offen
  s_lshl_b32 s29, s77, 10
  s_add_u32 s29, s29, 6291456
  s_cmp_lt_u32 s60, 4
  s_cbranch_scc1 o_s1_79
  s_waitcnt vmcnt(0)
  s_branch o_s2_80
o_s1_79:
  s_waitcnt vmcnt(40)
  v_lshlrev_b32 v212, 16, v176
  v_and_b32 v213, 0xffff0000, v176
  v_lshlrev_b32 v214, 16, v177
  v_and_b32 v215, 0xffff0000, v177
  v_lshlrev_b32 v216, 16, v178
  v_and_b32 v217, 0xffff0000, v178
  v_lshlrev_b32 v218, 16, v179
  v_and_b32 v219, 0xffff0000, v179
  v_add_f32 v220, v212, v213
  v_add_f32 v221, v214, v215
  v_add_f32 v222, v216, v217
  v_add_f32 v223, v218, v219
  v_add_f32 v220, v220, v221
  v_add_f32 v222, v222, v223
  v_add_f32 v220, v220, v222
  s_nop 1
  v_add_f32_dpp v220, v220, v220 row_ror:8 row_mask:0xf bank_mask:0xf
  s_nop 1
  v_add_f32_dpp v220, v220, v220 row_ror:4 row_mask:0xf bank_mask:0xf
  s_nop 1
  v_add_f32_dpp v220, v220, v220 row_ror:2 row_mask:0xf bank_mask:0xf
  s_nop 1
  v_add_f32_dpp v220, v220, v220 row_ror:1 row_mask:0xf bank_mask:0xf
  v_mov_b32 v222, v220
  s_nop 0
  s_nop 0
  v_permlane16_swap_b32 v220, v222
  v_add_f32 v220, v220, v222
  v_mov_b32 v222, v220
  s_nop 0
  s_nop 0
  v_permlane32_swap_b32 v220, v222
  v_add_f32 v220, v220, v222
  v_mul_f32 v220, 0x3b000000, v220
  v_sub_f32 v224, v212, v220
  v_sub_f32 v225, v213, v220
  v_sub_f32 v226, v214, v220
  v_sub_f32 v227, v215, v220
  v_sub_f32 v228, v216, v220
  v_sub_f32 v229, v217, v220
  v_sub_f32 v230, v218, v220
  v_sub_f32 v231, v219, v220
  v_mul_f32 v221, v224, v224
  v_mul_f32 v222, v225, v225
  v_fmac_f32 v221, v226, v226
  v_fmac_f32 v222, v227, v227
  v_fmac_f32 v221, v228, v228
  v_fmac_f32 v222, v229, v229
  v_fmac_f32 v221, v230, v230
  v_fmac_f32 v222, v231, v231
  v_add_f32 v221, v221, v222
  v_cvt_pk_bf16_f32 v220, 0, v220
  s_nop 0
  v_add_f32_dpp v221, v221, v221 row_ror:8 row_mask:0xf bank_mask:0xf
  v_sub_f32 v224, v212, v220
  v_sub_f32 v225, v213, v220
  v_add_f32_dpp v221, v221, v221 row_ror:4 row_mask:0xf bank_mask:0xf
  v_sub_f32 v226, v214, v220
  v_sub_f32 v227, v215, v220
  v_add_f32_dpp v221, v221, v221 row_ror:2 row_mask:0xf bank_mask:0xf
  v_sub_f32 v228, v216, v220
  v_sub_f32 v229, v217, v220
  v_add_f32_dpp v221, v221, v221 row_ror:1 row_mask:0xf bank_mask:0xf
  v_sub_f32 v230, v218, v220
  v_sub_f32 v231, v219, v220
  v_mov_b32 v222, v221
  v_cvt_pk_bf16_f32 v224, 0, v224
  v_cvt_pk_bf16_f32 v225, 0, v225
  v_permlane16_swap_b32 v221, v222
  v_cvt_pk_bf16_f32 v226, 0, v226
  v_cvt_pk_bf16_f32 v227, 0, v227
  v_add_f32 v221, v221, v222
  v_cvt_pk_bf16_f32 v228, 0, v228
  v_cvt_pk_bf16_f32 v229, 0, v229
  v_mov_b32 v222, v221
  v_cvt_pk_bf16_f32 v230, 0, v230
  v_cvt_pk_bf16_f32 v231, 0, v231
  v_permlane32_swap_b32 v221, v222
  v_add_f32 v221, v221, v222
  v_mul_f32 v221, 0x3b000000, v221
  v_cvt_pk_bf16_f32 v221, 0, v221
  v_add_f32 v221, 0x3727c5ac, v221
  v_cvt_pk_bf16_f32 v221, 0, v221
  v_sqrt_f32 v221, v221
  s_nop 0
  v_cvt_pk_bf16_f32 v221, 0, v221
  v_rcp_f32 v221, v221
  s_nop 0
  v_mul_f32 v224, v224, v221
  v_mul_f32 v225, v225, v221
  v_mul_f32 v226, v226, v221
  v_mul_f32 v227, v227, v221
  v_mul_f32 v228, v228, v221
  v_mul_f32 v229, v229, v221
  v_mul_f32 v230, v230, v221
  v_mul_f32 v231, v231, v221
  v_cvt_pk_bf16_f32 v176, v224, v225
  v_cvt_pk_bf16_f32 v177, v226, v227
  v_cvt_pk_bf16_f32 v178, v228, v229
  v_cvt_pk_bf16_f32 v179, v230, v231
  buffer_store_dwordx4 v[176:179], v0, s[4:7], s29 offen sc1
  s_add_u32 s29, s29, 262144
  s_waitcnt vmcnt(40)
  v_lshlrev_b32 v212, 16, v180
  v_and_b32 v213, 0xffff0000, v180
  v_lshlrev_b32 v214, 16, v181
  v_and_b32 v215, 0xffff0000, v181
  v_lshlrev_b32 v216, 16, v182
  v_and_b32 v217, 0xffff0000, v182
  v_lshlrev_b32 v218, 16, v183
  v_and_b32 v219, 0xffff0000, v183
  v_add_f32 v220, v212, v213
  v_add_f32 v221, v214, v215
  v_add_f32 v222, v216, v217
  v_add_f32 v223, v218, v219
  v_add_f32 v220, v220, v221
  v_add_f32 v222, v222, v223
  v_add_f32 v220, v220, v222
  s_nop 1
  v_add_f32_dpp v220, v220, v220 row_ror:8 row_mask:0xf bank_mask:0xf
  s_nop 1
  v_add_f32_dpp v220, v220, v220 row_ror:4 row_mask:0xf bank_mask:0xf
  s_nop 1
  v_add_f32_dpp v220, v220, v220 row_ror:2 row_mask:0xf bank_mask:0xf
  s_nop 1
  v_add_f32_dpp v220, v220, v220 row_ror:1 row_mask:0xf bank_mask:0xf
  v_mov_b32 v222, v220
  s_nop 0
  s_nop 0
  v_permlane16_swap_b32 v220, v222
  v_add_f32 v220, v220, v222
  v_mov_b32 v222, v220
  s_nop 0
  s_nop 0
  v_permlane32_swap_b32 v220, v222
  v_add_f32 v220, v220, v222
  v_mul_f32 v220, 0x3b000000, v220
  v_sub_f32 v224, v212, v220
  v_sub_f32 v225, v213, v220
  v_sub_f32 v226, v214, v220
  v_sub_f32 v227, v215, v220
  v_sub_f32 v228, v216, v220
  v_sub_f32 v229, v217, v220
  v_sub_f32 v230, v218, v220
  v_sub_f32 v231, v219, v220
  v_mul_f32 v221, v224, v224
  v_mul_f32 v222, v225, v225
  v_fmac_f32 v221, v226, v226
  v_fmac_f32 v222, v227, v227
  v_fmac_f32 v221, v228, v228
  v_fmac_f32 v222, v229, v229
  v_fmac_f32 v221, v230, v230
  v_fmac_f32 v222, v231, v231
  v_add_f32 v221, v221, v222
  v_cvt_pk_bf16_f32 v220, 0, v220
  s_nop 0
  v_add_f32_dpp v221, v221, v221 row_ror:8 row_mask:0xf bank_mask:0xf
  v_sub_f32 v224, v212, v220
  v_sub_f32 v225, v213, v220
  v_add_f32_dpp v221, v221, v221 row_ror:4 row_mask:0xf bank_mask:0xf
  v_sub_f32 v226, v214, v220
  v_sub_f32 v227, v215, v220
  v_add_f32_dpp v221, v221, v221 row_ror:2 row_mask:0xf bank_mask:0xf
  v_sub_f32 v228, v216, v220
  v_sub_f32 v229, v217, v220
  v_add_f32_dpp v221, v221, v221 row_ror:1 row_mask:0xf bank_mask:0xf
  v_sub_f32 v230, v218, v220
  v_sub_f32 v231, v219, v220
  v_mov_b32 v222, v221
  v_cvt_pk_bf16_f32 v224, 0, v224
  v_cvt_pk_bf16_f32 v225, 0, v225
  v_permlane16_swap_b32 v221, v222
  v_cvt_pk_bf16_f32 v226, 0, v226
  v_cvt_pk_bf16_f32 v227, 0, v227
  v_add_f32 v221, v221, v222
  v_cvt_pk_bf16_f32 v228, 0, v228
  v_cvt_pk_bf16_f32 v229, 0, v229
  v_mov_b32 v222, v221
  v_cvt_pk_bf16_f32 v230, 0, v230
  v_cvt_pk_bf16_f32 v231, 0, v231
  v_permlane32_swap_b32 v221, v222
  v_add_f32 v221, v221, v222
  v_mul_f32 v221, 0x3b000000, v221
  v_cvt_pk_bf16_f32 v221, 0, v221
  v_add_f32 v221, 0x3727c5ac, v221
  v_cvt_pk_bf16_f32 v221, 0, v221
  v_sqrt_f32 v221, v221
  s_nop 0
  v_cvt_pk_bf16_f32 v221, 0, v221
  v_rcp_f32 v221, v221
  s_nop 0
  v_mul_f32 v224, v224, v221
  v_mul_f32 v225, v225, v221
  v_mul_f32 v226, v226, v221
  v_mul_f32 v227, v227, v221
  v_mul_f32 v228, v228, v221
  v_mul_f32 v229, v229, v221
  v_mul_f32 v230, v230, v221
  v_mul_f32 v231, v231, v221
  v_cvt_pk_bf16_f32 v180, v224, v225
  v_cvt_pk_bf16_f32 v181, v226, v227
  v_cvt_pk_bf16_f32 v182, v228, v229
  v_cvt_pk_bf16_f32 v183, v230, v231
  buffer_store_dwordx4 v[180:183], v0, s[4:7], s29 offen sc1
  s_add_u32 s29, s29, 262144
  s_waitcnt vmcnt(40)
  v_lshlrev_b32 v212, 16, v184
  v_and_b32 v213, 0xffff0000, v184
  v_lshlrev_b32 v214, 16, v185
  v_and_b32 v215, 0xffff0000, v185
  v_lshlrev_b32 v216, 16, v186
  v_and_b32 v217, 0xffff0000, v186
  v_lshlrev_b32 v218, 16, v187
  v_and_b32 v219, 0xffff0000, v187
  v_add_f32 v220, v212, v213
  v_add_f32 v221, v214, v215
  v_add_f32 v222, v216, v217
  v_add_f32 v223, v218, v219
  v_add_f32 v220, v220, v221
  v_add_f32 v222, v222, v223
  v_add_f32 v220, v220, v222
  s_nop 1
  v_add_f32_dpp v220, v220, v220 row_ror:8 row_mask:0xf bank_mask:0xf
  s_nop 1
  v_add_f32_dpp v220, v220, v220 row_ror:4 row_mask:0xf bank_mask:0xf
  s_nop 1
  v_add_f32_dpp v220, v220, v220 row_ror:2 row_mask:0xf bank_mask:0xf
  s_nop 1
  v_add_f32_dpp v220, v220, v220 row_ror:1 row_mask:0xf bank_mask:0xf
  v_mov_b32 v222, v220
  s_nop 0
  s_nop 0
  v_permlane16_swap_b32 v220, v222
  v_add_f32 v220, v220, v222
  v_mov_b32 v222, v220
  s_nop 0
  s_nop 0
  v_permlane32_swap_b32 v220, v222
  v_add_f32 v220, v220, v222
  v_mul_f32 v220, 0x3b000000, v220
  v_sub_f32 v224, v212, v220
  v_sub_f32 v225, v213, v220
  v_sub_f32 v226, v214, v220
  v_sub_f32 v227, v215, v220
  v_sub_f32 v228, v216, v220
  v_sub_f32 v229, v217, v220
  v_sub_f32 v230, v218, v220
  v_sub_f32 v231, v219, v220
  v_mul_f32 v221, v224, v224
  v_mul_f32 v222, v225, v225
  v_fmac_f32 v221, v226, v226
  v_fmac_f32 v222, v227, v227
  v_fmac_f32 v221, v228, v228
  v_fmac_f32 v222, v229, v229
  v_fmac_f32 v221, v230, v230
  v_fmac_f32 v222, v231, v231
  v_add_f32 v221, v221, v222
  v_cvt_pk_bf16_f32 v220, 0, v220
  s_nop 0
  v_add_f32_dpp v221, v221, v221 row_ror:8 row_mask:0xf bank_mask:0xf
  v_sub_f32 v224, v212, v220
  v_sub_f32 v225, v213, v220
  v_add_f32_dpp v221, v221, v221 row_ror:4 row_mask:0xf bank_mask:0xf
  v_sub_f32 v226, v214, v220
  v_sub_f32 v227, v215, v220
  v_add_f32_dpp v221, v221, v221 row_ror:2 row_mask:0xf bank_mask:0xf
  v_sub_f32 v228, v216, v220
  v_sub_f32 v229, v217, v220
  v_add_f32_dpp v221, v221, v221 row_ror:1 row_mask:0xf bank_mask:0xf
  v_sub_f32 v230, v218, v220
  v_sub_f32 v231, v219, v220
  v_mov_b32 v222, v221
  v_cvt_pk_bf16_f32 v224, 0, v224
  v_cvt_pk_bf16_f32 v225, 0, v225
  v_permlane16_swap_b32 v221, v222
  v_cvt_pk_bf16_f32 v226, 0, v226
  v_cvt_pk_bf16_f32 v227, 0, v227
  v_add_f32 v221, v221, v222
  v_cvt_pk_bf16_f32 v228, 0, v228
  v_cvt_pk_bf16_f32 v229, 0, v229
  v_mov_b32 v222, v221
  v_cvt_pk_bf16_f32 v230, 0, v230
  v_cvt_pk_bf16_f32 v231, 0, v231
  v_permlane32_swap_b32 v221, v222
  v_add_f32 v221, v221, v222
  v_mul_f32 v221, 0x3b000000, v221
  v_cvt_pk_bf16_f32 v221, 0, v221
  v_add_f32 v221, 0x3727c5ac, v221
  v_cvt_pk_bf16_f32 v221, 0, v221
  v_sqrt_f32 v221, v221
  s_nop 0
  v_cvt_pk_bf16_f32 v221, 0, v221
  v_rcp_f32 v221, v221
  s_nop 0
  v_mul_f32 v224, v224, v221
  v_mul_f32 v225, v225, v221
  v_mul_f32 v226, v226, v221
  v_mul_f32 v227, v227, v221
  v_mul_f32 v228, v228, v221
  v_mul_f32 v229, v229, v221
  v_mul_f32 v230, v230, v221
  v_mul_f32 v231, v231, v221
  v_cvt_pk_bf16_f32 v184, v224, v225
  v_cvt_pk_bf16_f32 v185, v226, v227
  v_cvt_pk_bf16_f32 v186, v228, v229
  v_cvt_pk_bf16_f32 v187, v230, v231
  buffer_store_dwordx4 v[184:187], v0, s[4:7], s29 offen sc1
  s_add_u32 s29, s29, 262144
  s_waitcnt vmcnt(40)
  v_lshlrev_b32 v212, 16, v188
  v_and_b32 v213, 0xffff0000, v188
  v_lshlrev_b32 v214, 16, v189
  v_and_b32 v215, 0xffff0000, v189
  v_lshlrev_b32 v216, 16, v190
  v_and_b32 v217, 0xffff0000, v190
  v_lshlrev_b32 v218, 16, v191
  v_and_b32 v219, 0xffff0000, v191
  v_add_f32 v220, v212, v213
  v_add_f32 v221, v214, v215
  v_add_f32 v222, v216, v217
  v_add_f32 v223, v218, v219
  v_add_f32 v220, v220, v221
  v_add_f32 v222, v222, v223
  v_add_f32 v220, v220, v222
  s_nop 1
  v_add_f32_dpp v220, v220, v220 row_ror:8 row_mask:0xf bank_mask:0xf
  s_nop 1
  v_add_f32_dpp v220, v220, v220 row_ror:4 row_mask:0xf bank_mask:0xf
  s_nop 1
  v_add_f32_dpp v220, v220, v220 row_ror:2 row_mask:0xf bank_mask:0xf
  s_nop 1
  v_add_f32_dpp v220, v220, v220 row_ror:1 row_mask:0xf bank_mask:0xf
  v_mov_b32 v222, v220
  s_nop 0
  s_nop 0
  v_permlane16_swap_b32 v220, v222
  v_add_f32 v220, v220, v222
  v_mov_b32 v222, v220
  s_nop 0
  s_nop 0
  v_permlane32_swap_b32 v220, v222
  v_add_f32 v220, v220, v222
  v_mul_f32 v220, 0x3b000000, v220
  v_sub_f32 v224, v212, v220
  v_sub_f32 v225, v213, v220
  v_sub_f32 v226, v214, v220
  v_sub_f32 v227, v215, v220
  v_sub_f32 v228, v216, v220
  v_sub_f32 v229, v217, v220
  v_sub_f32 v230, v218, v220
  v_sub_f32 v231, v219, v220
  v_mul_f32 v221, v224, v224
  v_mul_f32 v222, v225, v225
  v_fmac_f32 v221, v226, v226
  v_fmac_f32 v222, v227, v227
  v_fmac_f32 v221, v228, v228
  v_fmac_f32 v222, v229, v229
  v_fmac_f32 v221, v230, v230
  v_fmac_f32 v222, v231, v231
  v_add_f32 v221, v221, v222
  v_cvt_pk_bf16_f32 v220, 0, v220
  s_nop 0
  v_add_f32_dpp v221, v221, v221 row_ror:8 row_mask:0xf bank_mask:0xf
  v_sub_f32 v224, v212, v220
  v_sub_f32 v225, v213, v220
  v_add_f32_dpp v221, v221, v221 row_ror:4 row_mask:0xf bank_mask:0xf
  v_sub_f32 v226, v214, v220
  v_sub_f32 v227, v215, v220
  v_add_f32_dpp v221, v221, v221 row_ror:2 row_mask:0xf bank_mask:0xf
  v_sub_f32 v228, v216, v220
  v_sub_f32 v229, v217, v220
  v_add_f32_dpp v221, v221, v221 row_ror:1 row_mask:0xf bank_mask:0xf
  v_sub_f32 v230, v218, v220
  v_sub_f32 v231, v219, v220
  v_mov_b32 v222, v221
  v_cvt_pk_bf16_f32 v224, 0, v224
  v_cvt_pk_bf16_f32 v225, 0, v225
  v_permlane16_swap_b32 v221, v222
  v_cvt_pk_bf16_f32 v226, 0, v226
  v_cvt_pk_bf16_f32 v227, 0, v227
  v_add_f32 v221, v221, v222
  v_cvt_pk_bf16_f32 v228, 0, v228
  v_cvt_pk_bf16_f32 v229, 0, v229
  v_mov_b32 v222, v221
  v_cvt_pk_bf16_f32 v230, 0, v230
  v_cvt_pk_bf16_f32 v231, 0, v231
  v_permlane32_swap_b32 v221, v222
  v_add_f32 v221, v221, v222
  v_mul_f32 v221, 0x3b000000, v221
  v_cvt_pk_bf16_f32 v221, 0, v221
  v_add_f32 v221, 0x3727c5ac, v221
  v_cvt_pk_bf16_f32 v221, 0, v221
  v_sqrt_f32 v221, v221
  s_nop 0
  v_cvt_pk_bf16_f32 v221, 0, v221
  v_rcp_f32 v221, v221
  s_nop 0
  v_mul_f32 v224, v224, v221
  v_mul_f32 v225, v225, v221
  v_mul_f32 v226, v226, v221
  v_mul_f32 v227, v227, v221
  v_mul_f32 v228, v228, v221
  v_mul_f32 v229, v229, v221
  v_mul_f32 v230, v230, v221
  v_mul_f32 v231, v231, v221
  v_cvt_pk_bf16_f32 v188, v224, v225
  v_cvt_pk_bf16_f32 v189, v226, v227
  v_cvt_pk_bf16_f32 v190, v228, v229
  v_cvt_pk_bf16_f32 v191, v230, v231
  buffer_store_dwordx4 v[188:191], v0, s[4:7], s29 offen sc1
  s_add_u32 s29, s29, 262144
  s_waitcnt vmcnt(40)
  v_lshlrev_b32 v212, 16, v192
  v_and_b32 v213, 0xffff0000, v192
  v_lshlrev_b32 v214, 16, v193
  v_and_b32 v215, 0xffff0000, v193
  v_lshlrev_b32 v216, 16, v194
  v_and_b32 v217, 0xffff0000, v194
  v_lshlrev_b32 v218, 16, v195
  v_and_b32 v219, 0xffff0000, v195
  v_add_f32 v220, v212, v213
  v_add_f32 v221, v214, v215
  v_add_f32 v222, v216, v217
  v_add_f32 v223, v218, v219
  v_add_f32 v220, v220, v221
  v_add_f32 v222, v222, v223
  v_add_f32 v220, v220, v222
  s_nop 1
  v_add_f32_dpp v220, v220, v220 row_ror:8 row_mask:0xf bank_mask:0xf
  s_nop 1
  v_add_f32_dpp v220, v220, v220 row_ror:4 row_mask:0xf bank_mask:0xf
  s_nop 1
  v_add_f32_dpp v220, v220, v220 row_ror:2 row_mask:0xf bank_mask:0xf
  s_nop 1
  v_add_f32_dpp v220, v220, v220 row_ror:1 row_mask:0xf bank_mask:0xf
  v_mov_b32 v222, v220
  s_nop 0
  s_nop 0
  v_permlane16_swap_b32 v220, v222
  v_add_f32 v220, v220, v222
  v_mov_b32 v222, v220
  s_nop 0
  s_nop 0
  v_permlane32_swap_b32 v220, v222
  v_add_f32 v220, v220, v222
  v_mul_f32 v220, 0x3b000000, v220
  v_sub_f32 v224, v212, v220
  v_sub_f32 v225, v213, v220
  v_sub_f32 v226, v214, v220
  v_sub_f32 v227, v215, v220
  v_sub_f32 v228, v216, v220
  v_sub_f32 v229, v217, v220
  v_sub_f32 v230, v218, v220
  v_sub_f32 v231, v219, v220
  v_mul_f32 v221, v224, v224
  v_mul_f32 v222, v225, v225
  v_fmac_f32 v221, v226, v226
  v_fmac_f32 v222, v227, v227
  v_fmac_f32 v221, v228, v228
  v_fmac_f32 v222, v229, v229
  v_fmac_f32 v221, v230, v230
  v_fmac_f32 v222, v231, v231
  v_add_f32 v221, v221, v222
  v_cvt_pk_bf16_f32 v220, 0, v220
  s_nop 0
  v_add_f32_dpp v221, v221, v221 row_ror:8 row_mask:0xf bank_mask:0xf
  v_sub_f32 v224, v212, v220
  v_sub_f32 v225, v213, v220
  v_add_f32_dpp v221, v221, v221 row_ror:4 row_mask:0xf bank_mask:0xf
  v_sub_f32 v226, v214, v220
  v_sub_f32 v227, v215, v220
  v_add_f32_dpp v221, v221, v221 row_ror:2 row_mask:0xf bank_mask:0xf
  v_sub_f32 v228, v216, v220
  v_sub_f32 v229, v217, v220
  v_add_f32_dpp v221, v221, v221 row_ror:1 row_mask:0xf bank_mask:0xf
  v_sub_f32 v230, v218, v220
  v_sub_f32 v231, v219, v220
  v_mov_b32 v222, v221
  v_cvt_pk_bf16_f32 v224, 0, v224
  v_cvt_pk_bf16_f32 v225, 0, v225
  v_permlane16_swap_b32 v221, v222
  v_cvt_pk_bf16_f32 v226, 0, v226
  v_cvt_pk_bf16_f32 v227, 0, v227
  v_add_f32 v221, v221, v222
  v_cvt_pk_bf16_f32 v228, 0, v228
  v_cvt_pk_bf16_f32 v229, 0, v229
  v_mov_b32 v222, v221
  v_cvt_pk_bf16_f32 v230, 0, v230
  v_cvt_pk_bf16_f32 v231, 0, v231
  v_permlane32_swap_b32 v221, v222
  v_add_f32 v221, v221, v222
  v_mul_f32 v221, 0x3b000000, v221
  v_cvt_pk_bf16_f32 v221, 0, v221
  v_add_f32 v221, 0x3727c5ac, v221
  v_cvt_pk_bf16_f32 v221, 0, v221
  v_sqrt_f32 v221, v221
  s_nop 0
  v_cvt_pk_bf16_f32 v221, 0, v221
  v_rcp_f32 v221, v221
  s_nop 0
  v_mul_f32 v224, v224, v221
  v_mul_f32 v225, v225, v221
  v_mul_f32 v226, v226, v221
  v_mul_f32 v227, v227, v221
  v_mul_f32 v228, v228, v221
  v_mul_f32 v229, v229, v221
  v_mul_f32 v230, v230, v221
  v_mul_f32 v231, v231, v221
  v_cvt_pk_bf16_f32 v192, v224, v225
  v_cvt_pk_bf16_f32 v193, v226, v227
  v_cvt_pk_bf16_f32 v194, v228, v229
  v_cvt_pk_bf16_f32 v195, v230, v231
  buffer_store_dwordx4 v[192:195], v0, s[4:7], s29 offen sc1
  s_add_u32 s29, s29, 262144
  s_waitcnt vmcnt(40)
  v_lshlrev_b32 v212, 16, v196
  v_and_b32 v213, 0xffff0000, v196
  v_lshlrev_b32 v214, 16, v197
  v_and_b32 v215, 0xffff0000, v197
  v_lshlrev_b32 v216, 16, v198
  v_and_b32 v217, 0xffff0000, v198
  v_lshlrev_b32 v218, 16, v199
  v_and_b32 v219, 0xffff0000, v199
  v_add_f32 v220, v212, v213
  v_add_f32 v221, v214, v215
  v_add_f32 v222, v216, v217
  v_add_f32 v223, v218, v219
  v_add_f32 v220, v220, v221
  v_add_f32 v222, v222, v223
  v_add_f32 v220, v220, v222
  s_nop 1
  v_add_f32_dpp v220, v220, v220 row_ror:8 row_mask:0xf bank_mask:0xf
  s_nop 1
  v_add_f32_dpp v220, v220, v220 row_ror:4 row_mask:0xf bank_mask:0xf
  s_nop 1
  v_add_f32_dpp v220, v220, v220 row_ror:2 row_mask:0xf bank_mask:0xf
  s_nop 1
  v_add_f32_dpp v220, v220, v220 row_ror:1 row_mask:0xf bank_mask:0xf
  v_mov_b32 v222, v220
  s_nop 0
  s_nop 0
  v_permlane16_swap_b32 v220, v222
  v_add_f32 v220, v220, v222
  v_mov_b32 v222, v220
  s_nop 0
  s_nop 0
  v_permlane32_swap_b32 v220, v222
  v_add_f32 v220, v220, v222
  v_mul_f32 v220, 0x3b000000, v220
  v_sub_f32 v224, v212, v220
  v_sub_f32 v225, v213, v220
  v_sub_f32 v226, v214, v220
  v_sub_f32 v227, v215, v220
  v_sub_f32 v228, v216, v220
  v_sub_f32 v229, v217, v220
  v_sub_f32 v230, v218, v220
  v_sub_f32 v231, v219, v220
  v_mul_f32 v221, v224, v224
  v_mul_f32 v222, v225, v225
  v_fmac_f32 v221, v226, v226
  v_fmac_f32 v222, v227, v227
  v_fmac_f32 v221, v228, v228
  v_fmac_f32 v222, v229, v229
  v_fmac_f32 v221, v230, v230
  v_fmac_f32 v222, v231, v231
  v_add_f32 v221, v221, v222
  v_cvt_pk_bf16_f32 v220, 0, v220
  s_nop 0
  v_add_f32_dpp v221, v221, v221 row_ror:8 row_mask:0xf bank_mask:0xf
  v_sub_f32 v224, v212, v220
  v_sub_f32 v225, v213, v220
  v_add_f32_dpp v221, v221, v221 row_ror:4 row_mask:0xf bank_mask:0xf
  v_sub_f32 v226, v214, v220
  v_sub_f32 v227, v215, v220
  v_add_f32_dpp v221, v221, v221 row_ror:2 row_mask:0xf bank_mask:0xf
  v_sub_f32 v228, v216, v220
  v_sub_f32 v229, v217, v220
  v_add_f32_dpp v221, v221, v221 row_ror:1 row_mask:0xf bank_mask:0xf
  v_sub_f32 v230, v218, v220
  v_sub_f32 v231, v219, v220
  v_mov_b32 v222, v221
  v_cvt_pk_bf16_f32 v224, 0, v224
  v_cvt_pk_bf16_f32 v225, 0, v225
  v_permlane16_swap_b32 v221, v222
  v_cvt_pk_bf16_f32 v226, 0, v226
  v_cvt_pk_bf16_f32 v227, 0, v227
  v_add_f32 v221, v221, v222
  v_cvt_pk_bf16_f32 v228, 0, v228
  v_cvt_pk_bf16_f32 v229, 0, v229
  v_mov_b32 v222, v221
  v_cvt_pk_bf16_f32 v230, 0, v230
  v_cvt_pk_bf16_f32 v231, 0, v231
  v_permlane32_swap_b32 v221, v222
  v_add_f32 v221, v221, v222
  v_mul_f32 v221, 0x3b000000, v221
  v_cvt_pk_bf16_f32 v221, 0, v221
  v_add_f32 v221, 0x3727c5ac, v221
  v_cvt_pk_bf16_f32 v221, 0, v221
  v_sqrt_f32 v221, v221
  s_nop 0
  v_cvt_pk_bf16_f32 v221, 0, v221
  v_rcp_f32 v221, v221
  s_nop 0
  v_mul_f32 v224, v224, v221
  v_mul_f32 v225, v225, v221
  v_mul_f32 v226, v226, v221
  v_mul_f32 v227, v227, v221
  v_mul_f32 v228, v228, v221
  v_mul_f32 v229, v229, v221
  v_mul_f32 v230, v230, v221
  v_mul_f32 v231, v231, v221
  v_cvt_pk_bf16_f32 v196, v224, v225
  v_cvt_pk_bf16_f32 v197, v226, v227
  v_cvt_pk_bf16_f32 v198, v228, v229
  v_cvt_pk_bf16_f32 v199, v230, v231
  buffer_store_dwordx4 v[196:199], v0, s[4:7], s29 offen sc1
  s_add_u32 s29, s29, 262144
  s_waitcnt vmcnt(40)
  v_lshlrev_b32 v212, 16, v200
  v_and_b32 v213, 0xffff0000, v200
  v_lshlrev_b32 v214, 16, v201
  v_and_b32 v215, 0xffff0000, v201
  v_lshlrev_b32 v216, 16, v202
  v_and_b32 v217, 0xffff0000, v202
  v_lshlrev_b32 v218, 16, v203
  v_and_b32 v219, 0xffff0000, v203
  v_add_f32 v220, v212, v213
  v_add_f32 v221, v214, v215
  v_add_f32 v222, v216, v217
  v_add_f32 v223, v218, v219
  v_add_f32 v220, v220, v221
  v_add_f32 v222, v222, v223
  v_add_f32 v220, v220, v222
  s_nop 1
  v_add_f32_dpp v220, v220, v220 row_ror:8 row_mask:0xf bank_mask:0xf
  s_nop 1
  v_add_f32_dpp v220, v220, v220 row_ror:4 row_mask:0xf bank_mask:0xf
  s_nop 1
  v_add_f32_dpp v220, v220, v220 row_ror:2 row_mask:0xf bank_mask:0xf
  s_nop 1
  v_add_f32_dpp v220, v220, v220 row_ror:1 row_mask:0xf bank_mask:0xf
  v_mov_b32 v222, v220
  s_nop 0
  s_nop 0
  v_permlane16_swap_b32 v220, v222
  v_add_f32 v220, v220, v222
  v_mov_b32 v222, v220
  s_nop 0
  s_nop 0
  v_permlane32_swap_b32 v220, v222
  v_add_f32 v220, v220, v222
  v_mul_f32 v220, 0x3b000000, v220
  v_sub_f32 v224, v212, v220
  v_sub_f32 v225, v213, v220
  v_sub_f32 v226, v214, v220
  v_sub_f32 v227, v215, v220
  v_sub_f32 v228, v216, v220
  v_sub_f32 v229, v217, v220
  v_sub_f32 v230, v218, v220
  v_sub_f32 v231, v219, v220
  v_mul_f32 v221, v224, v224
  v_mul_f32 v222, v225, v225
  v_fmac_f32 v221, v226, v226
  v_fmac_f32 v222, v227, v227
  v_fmac_f32 v221, v228, v228
  v_fmac_f32 v222, v229, v229
  v_fmac_f32 v221, v230, v230
  v_fmac_f32 v222, v231, v231
  v_add_f32 v221, v221, v222
  v_cvt_pk_bf16_f32 v220, 0, v220
  s_nop 0
  v_add_f32_dpp v221, v221, v221 row_ror:8 row_mask:0xf bank_mask:0xf
  v_sub_f32 v224, v212, v220
  v_sub_f32 v225, v213, v220
  v_add_f32_dpp v221, v221, v221 row_ror:4 row_mask:0xf bank_mask:0xf
  v_sub_f32 v226, v214, v220
  v_sub_f32 v227, v215, v220
  v_add_f32_dpp v221, v221, v221 row_ror:2 row_mask:0xf bank_mask:0xf
  v_sub_f32 v228, v216, v220
  v_sub_f32 v229, v217, v220
  v_add_f32_dpp v221, v221, v221 row_ror:1 row_mask:0xf bank_mask:0xf
  v_sub_f32 v230, v218, v220
  v_sub_f32 v231, v219, v220
  v_mov_b32 v222, v221
  v_cvt_pk_bf16_f32 v224, 0, v224
  v_cvt_pk_bf16_f32 v225, 0, v225
  v_permlane16_swap_b32 v221, v222
  v_cvt_pk_bf16_f32 v226, 0, v226
  v_cvt_pk_bf16_f32 v227, 0, v227
  v_add_f32 v221, v221, v222
  v_cvt_pk_bf16_f32 v228, 0, v228
  v_cvt_pk_bf16_f32 v229, 0, v229
  v_mov_b32 v222, v221
  v_cvt_pk_bf16_f32 v230, 0, v230
  v_cvt_pk_bf16_f32 v231, 0, v231
  v_permlane32_swap_b32 v221, v222
  v_add_f32 v221, v221, v222
  v_mul_f32 v221, 0x3b000000, v221
  v_cvt_pk_bf16_f32 v221, 0, v221
  v_add_f32 v221, 0x3727c5ac, v221
  v_cvt_pk_bf16_f32 v221, 0, v221
  v_sqrt_f32 v221, v221
  s_nop 0
  v_cvt_pk_bf16_f32 v221, 0, v221
  v_rcp_f32 v221, v221
  s_nop 0
  v_mul_f32 v224, v224, v221
  v_mul_f32 v225, v225, v221
  v_mul_f32 v226, v226, v221
  v_mul_f32 v227, v227, v221
  v_mul_f32 v228, v228, v221
  v_mul_f32 v229, v229, v221
  v_mul_f32 v230, v230, v221
  v_mul_f32 v231, v231, v221
  v_cvt_pk_bf16_f32 v200, v224, v225
  v_cvt_pk_bf16_f32 v201, v226, v227
  v_cvt_pk_bf16_f32 v202, v228, v229
  v_cvt_pk_bf16_f32 v203, v230, v231
  buffer_store_dwordx4 v[200:203], v0, s[4:7], s29 offen sc1
  s_add_u32 s29, s29, 262144
  s_waitcnt vmcnt(40)
  v_lshlrev_b32 v212, 16, v204
  v_and_b32 v213, 0xffff0000, v204
  v_lshlrev_b32 v214, 16, v205
  v_and_b32 v215, 0xffff0000, v205
  v_lshlrev_b32 v216, 16, v206
  v_and_b32 v217, 0xffff0000, v206
  v_lshlrev_b32 v218, 16, v207
  v_and_b32 v219, 0xffff0000, v207
  v_add_f32 v220, v212, v213
  v_add_f32 v221, v214, v215
  v_add_f32 v222, v216, v217
  v_add_f32 v223, v218, v219
  v_add_f32 v220, v220, v221
  v_add_f32 v222, v222, v223
  v_add_f32 v220, v220, v222
  s_nop 1
  v_add_f32_dpp v220, v220, v220 row_ror:8 row_mask:0xf bank_mask:0xf
  s_nop 1
  v_add_f32_dpp v220, v220, v220 row_ror:4 row_mask:0xf bank_mask:0xf
  s_nop 1
  v_add_f32_dpp v220, v220, v220 row_ror:2 row_mask:0xf bank_mask:0xf
  s_nop 1
  v_add_f32_dpp v220, v220, v220 row_ror:1 row_mask:0xf bank_mask:0xf
  v_mov_b32 v222, v220
  s_nop 0
  s_nop 0
  v_permlane16_swap_b32 v220, v222
  v_add_f32 v220, v220, v222
  v_mov_b32 v222, v220
  s_nop 0
  s_nop 0
  v_permlane32_swap_b32 v220, v222
  v_add_f32 v220, v220, v222
  v_mul_f32 v220, 0x3b000000, v220
  v_sub_f32 v224, v212, v220
  v_sub_f32 v225, v213, v220
  v_sub_f32 v226, v214, v220
  v_sub_f32 v227, v215, v220
  v_sub_f32 v228, v216, v220
  v_sub_f32 v229, v217, v220
  v_sub_f32 v230, v218, v220
  v_sub_f32 v231, v219, v220
  v_mul_f32 v221, v224, v224
  v_mul_f32 v222, v225, v225
  v_fmac_f32 v221, v226, v226
  v_fmac_f32 v222, v227, v227
  v_fmac_f32 v221, v228, v228
  v_fmac_f32 v222, v229, v229
  v_fmac_f32 v221, v230, v230
  v_fmac_f32 v222, v231, v231
  v_add_f32 v221, v221, v222
  v_cvt_pk_bf16_f32 v220, 0, v220
  s_nop 0
  v_add_f32_dpp v221, v221, v221 row_ror:8 row_mask:0xf bank_mask:0xf
  v_sub_f32 v224, v212, v220
  v_sub_f32 v225, v213, v220
  v_add_f32_dpp v221, v221, v221 row_ror:4 row_mask:0xf bank_mask:0xf
  v_sub_f32 v226, v214, v220
  v_sub_f32 v227, v215, v220
  v_add_f32_dpp v221, v221, v221 row_ror:2 row_mask:0xf bank_mask:0xf
  v_sub_f32 v228, v216, v220
  v_sub_f32 v229, v217, v220
  v_add_f32_dpp v221, v221, v221 row_ror:1 row_mask:0xf bank_mask:0xf
  v_sub_f32 v230, v218, v220
  v_sub_f32 v231, v219, v220
  v_mov_b32 v222, v221
  v_cvt_pk_bf16_f32 v224, 0, v224
  v_cvt_pk_bf16_f32 v225, 0, v225
  v_permlane16_swap_b32 v221, v222
  v_cvt_pk_bf16_f32 v226, 0, v226
  v_cvt_pk_bf16_f32 v227, 0, v227
  v_add_f32 v221, v221, v222
  v_cvt_pk_bf16_f32 v228, 0, v228
  v_cvt_pk_bf16_f32 v229, 0, v229
  v_mov_b32 v222, v221
  v_cvt_pk_bf16_f32 v230, 0, v230
  v_cvt_pk_bf16_f32 v231, 0, v231
  v_permlane32_swap_b32 v221, v222
  v_add_f32 v221, v221, v222
  v_mul_f32 v221, 0x3b000000, v221
  v_cvt_pk_bf16_f32 v221, 0, v221
  v_add_f32 v221, 0x3727c5ac, v221
  v_cvt_pk_bf16_f32 v221, 0, v221
  v_sqrt_f32 v221, v221
  s_nop 0
  v_cvt_pk_bf16_f32 v221, 0, v221
  v_rcp_f32 v221, v221
  s_nop 0
  v_mul_f32 v224, v224, v221
  v_mul_f32 v225, v225, v221
  v_mul_f32 v226, v226, v221
  v_mul_f32 v227, v227, v221
  v_mul_f32 v228, v228, v221
  v_mul_f32 v229, v229, v221
  v_mul_f32 v230, v230, v221
  v_mul_f32 v231, v231, v221
  v_cvt_pk_bf16_f32 v204, v224, v225
  v_cvt_pk_bf16_f32 v205, v226, v227
  v_cvt_pk_bf16_f32 v206, v228, v229
  v_cvt_pk_bf16_f32 v207, v230, v231
  buffer_store_dwordx4 v[204:207], v0, s[4:7], s29 offen sc1
  s_add_u32 s29, s29, 262144
o_s2_80:
  s_waitcnt vmcnt(33)
  v_perm_b32 v48, v66, v64, s44
  v_perm_b32 v49, v70, v68, s44
  v_perm_b32 v50, v74, v72, s44
  v_perm_b32 v51, v78, v76, s44
  v_accvgpr_write_b32 a0, v48
  v_accvgpr_write_b32 a1, v49
  v_accvgpr_write_b32 a2, v50
  v_accvgpr_write_b32 a3, v51
  v_perm_b32 v52, v66, v64, s45
  v_perm_b32 v53, v70, v68, s45
  v_perm_b32 v54, v74, v72, s45
  v_perm_b32 v55, v78, v76, s45
  v_accvgpr_write_b32 a4, v52
  v_accvgpr_write_b32 a5, v53
  v_accvgpr_write_b32 a6, v54
  v_accvgpr_write_b32 a7, v55
  v_perm_b32 v48, v67, v65, s44
  v_perm_b32 v49, v71, v69, s44
  v_perm_b32 v50, v75, v73, s44
  v_perm_b32 v51, v79, v77, s44
  v_accvgpr_write_b32 a8, v48
  v_accvgpr_write_b32 a9, v49
  v_accvgpr_write_b32 a10, v50
  v_accvgpr_write_b32 a11, v51
  v_perm_b32 v52, v67, v65, s45
  v_perm_b32 v53, v71, v69, s45
  v_perm_b32 v54, v75, v73, s45
  v_perm_b32 v55, v79, v77, s45
  v_accvgpr_write_b32 a12, v52
  v_accvgpr_write_b32 a13, v53
  v_accvgpr_write_b32 a14, v54
  v_accvgpr_write_b32 a15, v55
  s_waitcnt vmcnt(25)
  v_perm_b32 v48, v82, v80, s44
  v_perm_b32 v49, v86, v84, s44
  v_perm_b32 v50, v90, v88, s44
  v_perm_b32 v51, v94, v92, s44
  v_accvgpr_write_b32 a16, v48
  v_accvgpr_write_b32 a17, v49
  v_accvgpr_write_b32 a18, v50
  v_accvgpr_write_b32 a19, v51
  v_perm_b32 v52, v82, v80, s45
  v_perm_b32 v53, v86, v84, s45
  v_perm_b32 v54, v90, v88, s45
  v_perm_b32 v55, v94, v92, s45
  v_accvgpr_write_b32 a20, v52
  v_accvgpr_write_b32 a21, v53
  v_accvgpr_write_b32 a22, v54
  v_accvgpr_write_b32 a23, v55
  v_perm_b32 v48, v83, v81, s44
  v_perm_b32 v49, v87, v85, s44
  v_perm_b32 v50, v91, v89, s44
  v_perm_b32 v51, v95, v93, s44
  v_accvgpr_write_b32 a24, v48
  v_accvgpr_write_b32 a25, v49
  v_accvgpr_write_b32 a26, v50
  v_accvgpr_write_b32 a27, v51
  v_perm_b32 v52, v83, v81, s45
  v_perm_b32 v53, v87, v85, s45
  v_perm_b32 v54, v91, v89, s45
  v_perm_b32 v55, v95, v93, s45
  v_accvgpr_write_b32 a28, v52
  v_accvgpr_write_b32 a29, v53
  v_accvgpr_write_b32 a30, v54
  v_accvgpr_write_b32 a31, v55
  s_waitcnt vmcnt(17)
  v_perm_b32 v48, v98, v96, s44
  v_perm_b32 v49, v102, v100, s44
  v_perm_b32 v50, v106, v104, s44
  v_perm_b32 v51, v110, v108, s44
  v_accvgpr_write_b32 a32, v48
  v_accvgpr_write_b32 a33, v49
  v_accvgpr_write_b32 a34, v50
  v_accvgpr_write_b32 a35, v51
  v_perm_b32 v52, v98, v96, s45
  v_perm_b32 v53, v102, v100, s45
  v_perm_b32 v54, v106, v104, s45
  v_perm_b32 v55, v110, v108, s45
  v_accvgpr_write_b32 a36, v52
  v_accvgpr_write_b32 a37, v53
  v_accvgpr_write_b32 a38, v54
  v_accvgpr_write_b32 a39, v55
  v_perm_b32 v48, v99, v97, s44
  v_perm_b32 v49, v103, v101, s44
  v_perm_b32 v50, v107, v105, s44
  v_perm_b32 v51, v111, v109, s44
  v_accvgpr_write_b32 a40, v48
  v_accvgpr_write_b32 a41, v49
  v_accvgpr_write_b32 a42, v50
  v_accvgpr_write_b32 a43, v51
  v_perm_b32 v52, v99, v97, s45
  v_perm_b32 v53, v103, v101, s45
  v_perm_b32 v54, v107, v105, s45
  v_perm_b32 v55, v111, v109, s45
  v_accvgpr_write_b32 a44, v52
  v_accvgpr_write_b32 a45, v53
  v_accvgpr_write_b32 a46, v54
  v_accvgpr_write_b32 a47, v55
  s_waitcnt vmcnt(9)
  v_perm_b32 v48, v114, v112, s44
  v_perm_b32 v49, v118, v116, s44
  v_perm_b32 v50, v122, v120, s44
  v_perm_b32 v51, v126, v124, s44
  v_accvgpr_write_b32 a48, v48
  v_accvgpr_write_b32 a49, v49
  v_accvgpr_write_b32 a50, v50
  v_accvgpr_write_b32 a51, v51
  v_perm_b32 v52, v114, v112, s45
  v_perm_b32 v53, v118, v116, s45
  v_perm_b32 v54, v122, v120, s45
  v_perm_b32 v55, v126, v124, s45
  v_accvgpr_write_b32 a52, v52
  v_accvgpr_write_b32 a53, v53
  v_accvgpr_write_b32 a54, v54
  v_accvgpr_write_b32 a55, v55
  v_perm_b32 v48, v115, v113, s44
  v_perm_b32 v49, v119, v117, s44
  v_perm_b32 v50, v123, v121, s44
  v_perm_b32 v51, v127, v125, s44
  v_accvgpr_write_b32 a56, v48
  v_accvgpr_write_b32 a57, v49
  v_accvgpr_write_b32 a58, v50
  v_accvgpr_write_b32 a59, v51
  v_perm_b32 v52, v115, v113, s45
  v_perm_b32 v53, v119, v117, s45
  v_perm_b32 v54, v123, v121, s45
  v_perm_b32 v55, v127, v125, s45
  v_accvgpr_write_b32 a60, v52
  v_accvgpr_write_b32 a61, v53
  v_accvgpr_write_b32 a62, v54
  v_accvgpr_write_b32 a63, v55
  v_mbcnt_lo_u32_b32 v60, -1, 0
  v_and_b32 v60, 0, v60
  v_add_lshl_u32 v60, v60, 1, 2
  s_mov_b32 s26, 0
g_wt_82:
  global_load_dword v61, v60, s[12:13] offset:128 sc1
  s_add_u32 s26, s26, 1
  s_cmp_gt_u32 s26, 1048576
  s_cbranch_scc1 L_end
  s_waitcnt vmcnt(0)
  v_cmp_eq_u32 vcc, 0, v61
  v_readfirstlane_b32 s27, v61
  s_cbranch_vccnz g_wt_82
  s_cmp_ge_u32 s60, 4
  s_cbranch_scc1 o_s3_81
  s_lshl_b32 s27, s77, 7
  s_add_u32 s27, s27, 243269632
  v_lshlrev_b32 v61, 11, v0
  v_mov_b32 v60, 1
  s_mov_b64 exec, 255
  buffer_store_dword v60, v61, s[4:7], s27 offen sc1
  s_mov_b64 exec, -1
o_s3_81:
  s_add_u32 s27, s30, 65536
  s_nop 0
  buffer_load_dwordx2 v[128:129], v44, s[80:83], s27 offen
  s_add_u32 s27, s30, 66560
  buffer_load_dwordx2 v[130:131], v44, s[80:83], s27 offen
  s_add_u32 s27, s30, 67584
  buffer_load_dwordx2 v[132:133], v44, s[80:83], s27 offen
  s_add_u32 s27, s30, 68608
  buffer_load_dwordx2 v[134:135], v44, s[80:83], s27 offen
  s_add_u32 s27, s30, 81920
  buffer_load_dwordx2 v[136:137], v44, s[80:83], s27 offen
  s_add_u32 s27, s30, 82944
  buffer_load_dwordx2 v[138:139], v44, s[80:83], s27 offen
  s_add_u32 s27, s30, 83968
  buffer_load_dwordx2 v[140:141], v44, s[80:83], s27 offen
  s_add_u32 s27, s30, 84992
  buffer_load_dwordx2 v[142:143], v44, s[80:83], s27 offen
  s_add_u32 s27, s30, 73728
  buffer_load_dwordx2 v[144:145], v44, s[80:83], s27 offen
  s_add_u32 s27, s30, 74752
  buffer_load_dwordx2 v[146:147], v44, s[80:83], s27 offen
  s_add_u32 s27, s30, 75776
  buffer_load_dwordx2 v[148:149], v44, s[80:83], s27 offen
  s_add_u32 s27, s30, 76800
  buffer_load_dwordx2 v[150:151], v44, s[80:83], s27 offen
  s_add_u32 s27, s30, 90112
  buffer_load_dwordx2 v[152:153], v44, s[80:83], s27 offen
  s_add_u32 s27, s30, 91136
  buffer_load_dwordx2 v[154:155], v44, s[80:83], s27 offen
  s_add_u32 s27, s30, 92160
  buffer_load_dwordx2 v[156:157], v44, s[80:83], s27 offen
  s_add_u32 s27, s30, 93184
  buffer_load_dwordx2 v[158:159], v44, s[80:83], s27 offen
  s_add_u32 s27, s30, 98304
  buffer_load_dwordx2 v[160:161], v44, s[80:83], s27 offen
  s_add_u32 s27, s30, 99328
  buffer_load_dwordx2 v[162:163], v44, s[80:83], s27 offen
  s_add_u32 s27, s30, 100352
  buffer_load_dwordx2 v[164:165], v44, s[80:83], s27 offen
  s_add_u32 s27, s30, 101376
  buffer_load_dwordx2 v[166:167], v44, s[80:83], s27 offen
  s_add_u32 s27, s30, 114688
  buffer_load_dwordx2 v[168:169], v44, s[80:83], s27 offen
  s_add_u32 s27, s30, 115712
  buffer_load_dwordx2 v[170:171], v44, s[80:83], s27 offen
  s_add_u32 s27, s30, 116736
  buffer_load_dwordx2 v[172:173], v44, s[80:83], s27 offen
  s_add_u32 s27, s30, 117760
  buffer_load_dwordx2 v[174:175], v44, s[80:83], s27 offen
  s_add_u32 s27, s30, 106496
  buffer_load_dwordx2 v[64:65], v44, s[80:83], s27 offen
  s_add_u32 s27, s30, 107520
  buffer_load_dwordx2 v[66:67], v44, s[80:83], s27 offen
  s_add_u32 s27, s30, 108544
  buffer_load_dwordx2 v[68:69], v44, s[80:83], s27 offen
  s_add_u32 s27, s30, 109568
  buffer_load_dwordx2 v[70:71], v44, s[80:83], s27 offen
  s_add_u32 s27, s30, 122880
  buffer_load_dwordx2 v[72:73], v44, s[80:83], s27 offen
  s_add_u32 s27, s30, 123904
  buffer_load_dwordx2 v[74:75], v44, s[80:83], s27 offen
  s_add_u32 s27, s30, 124928
  buffer_load_dwordx2 v[76:77], v44, s[80:83], s27 offen
  s_add_u32 s27, s30, 125952
  buffer_load_dwordx2 v[78:79], v44, s[80:83], s27 offen
  s_add_u32 s27, s30, 131072
  buffer_load_dwordx2 v[80:81], v44, s[80:83], s27 offen
  s_add_u32 s27, s30, 132096
  buffer_load_dwordx2 v[82:83], v44, s[80:83], s27 offen
  s_add_u32 s27, s30, 133120
  buffer_load_dwordx2 v[84:85], v44, s[80:83], s27 offen
  s_add_u32 s27, s30, 134144
  buffer_load_dwordx2 v[86:87], v44, s[80:83], s27 offen
  s_add_u32 s27, s30, 147456
  buffer_load_dwordx2 v[88:89], v44, s[80:83], s27 offen
  s_add_u32 s27, s30, 148480
  buffer_load_dwordx2 v[90:91], v44, s[80:83], s27 offen
  s_add_u32 s27, s30, 149504
  buffer_load_dwordx2 v[92:93], v44, s[80:83], s27 offen
  s_add_u32 s27, s30, 150528
  buffer_load_dwordx2 v[94:95], v44, s[80:83], s27 offen
  s_add_u32 s27, s30, 139264
  buffer_load_dwordx2 v[96:97], v44, s[80:83], s27 offen
  s_add_u32 s27, s30, 140288
  buffer_load_dwordx2 v[98:99], v44, s[80:83], s27 offen
  s_add_u32 s27, s30, 141312
  buffer_load_dwordx2 v[100:101], v44, s[80:83], s27 offen
  s_add_u32 s27, s30, 142336
  buffer_load_dwordx2 v[102:103], v44, s[80:83], s27 offen
  s_add_u32 s27, s30, 155648
  buffer_load_dwordx2 v[104:105], v44, s[80:83], s27 offen
  s_add_u32 s27, s30, 156672
  buffer_load_dwordx2 v[106:107], v44, s[80:83], s27 offen
  s_add_u32 s27, s30, 157696
  buffer_load_dwordx2 v[108:109], v44, s[80:83], s27 offen
  s_add_u32 s27, s30, 158720
  buffer_load_dwordx2 v[110:111], v44, s[80:83], s27 offen
  s_add_u32 s27, s30, 163840
  buffer_load_dwordx2 v[112:113], v44, s[80:83], s27 offen
  s_add_u32 s27, s30, 164864
  buffer_load_dwordx2 v[114:115], v44, s[80:83], s27 offen
  s_add_u32 s27, s30, 165888
  buffer_load_dwordx2 v[116:117], v44, s[80:83], s27 offen
  s_add_u32 s27, s30, 166912
  buffer_load_dwordx2 v[118:119], v44, s[80:83], s27 offen
  s_add_u32 s27, s30, 180224
  buffer_load_dwordx2 v[120:121], v44, s[80:83], s27 offen
  s_add_u32 s27, s30, 181248
  buffer_load_dwordx2 v[122:123], v44, s[80:83], s27 offen
  s_add_u32 s27, s30, 182272
  buffer_load_dwordx2 v[124:125], v44, s[80:83], s27 offen
  s_add_u32 s27, s30, 183296
  buffer_load_dwordx2 v[126:127], v44, s[80:83], s27 offen
  v_lshlrev_b32 v8, 16, v56
  v_and_b32 v9, 0xffff0000, v56
  v_lshlrev_b32 v10, 16, v57
  v_and_b32 v11, 0xffff0000, v57
  v_lshlrev_b32 v12, 16, v58
  v_and_b32 v13, 0xffff0000, v58
  v_lshlrev_b32 v14, 16, v59
  v_and_b32 v15, 0xffff0000, v59
  v_mul_f32 v56, v8, v8
  v_fmac_f32 v56, v9, v9
  v_fmac_f32 v56, v10, v10
  v_fmac_f32 v56, v11, v11
  v_fmac_f32 v56, v12, v12
  v_fmac_f32 v56, v13, v13
  v_fmac_f32 v56, v14, v14
  v_fmac_f32 v56, v15, v15
  s_nop 0
  s_nop 0
  v_add_f32_dpp v56, v56, v56 row_ror:8 row_mask:0xf bank_mask:0xf
  s_nop 1
  v_add_f32_dpp v56, v56, v56 row_ror:4 row_mask:0xf bank_mask:0xf
  s_nop 1
  v_add_f32_dpp v56, v56, v56 row_ror:2 row_mask:0xf bank_mask:0xf
  s_nop 1
  v_add_f32_dpp v56, v56, v56 row_ror:1 row_mask:0xf bank_mask:0xf
  v_mov_b32 v57, v56
  s_nop 0
  s_nop 0
  v_permlane16_swap_b32 v56, v57
  v_add_f32 v56, v56, v57
  v_mov_b32 v57, v56
  s_nop 0
  s_nop 0
  v_permlane32_swap_b32 v56, v57
  v_add_f32 v56, v56, v57
  v_sqrt_f32 v56, v56
  s_mov_b32 s28, 0x40598569
  v_writelane_b32 v247, s28, 0
  s_mov_b32 s28, 0x40598569
  v_writelane_b32 v247, s28, 1
  s_mov_b32 s28, 0x4058ade7
  v_writelane_b32 v247, s28, 2
  s_mov_b32 s28, 0x40577c32
  v_writelane_b32 v247, s28, 3
  s_mov_b32 s28, 0x40563297
  v_writelane_b32 v247, s28, 4
  s_mov_b32 s28, 0x4054cd28
  v_writelane_b32 v247, s28, 5
  s_mov_b32 s28, 0x405346f2
  v_writelane_b32 v247, s28, 6
  s_mov_b32 s28, 0x40519992
  v_writelane_b32 v247, s28, 7
  s_mov_b32 s28, 0x404fbc99
  v_writelane_b32 v247, s28, 8
  s_mov_b32 s28, 0x404da49a
  v_writelane_b32 v247, s28, 9
  s_mov_b32 s28, 0x404b418a
  v_writelane_b32 v247, s28, 10
  s_mov_b32 s28, 0x40487bed
  v_writelane_b32 v247, s28, 11
  s_mov_b32 s28, 0x40452f68
  v_writelane_b32 v247, s28, 12
  s_mov_b32 s28, 0x40411f69
  v_writelane_b32 v247, s28, 13
  s_mov_b32 s28, 0x403bdbac
  v_writelane_b32 v247, s28, 14
  s_mov_b32 s28, 0x40346eae
  v_writelane_b32 v247, s28, 15
  s_mov_b32 s28, 0x4028005c
  v_writelane_b32 v247, s28, 16
  s_mov_b32 s28, 0x4001516e
  v_writelane_b32 v247, s28, 17
  s_mov_b32 s28, 0x4001516e
  v_writelane_b32 v247, s28, 18
  v_mul_f32 v247, v247, v56
  v_or_b32 v247, 0x80000000, v247
  s_lshl_b32 s29, s61, 2
  s_add_u32 s29, s29, s17
  s_lshl_b32 s29, s29, 13
  s_add_u32 s29, s29, s41
  v_mov_b64 v[208:209], 0
  v_mov_b64 v[210:211], 0
  s_waitcnt vmcnt(48)
  v_perm_b32 v48, v130, v128, s44
  v_perm_b32 v49, v134, v132, s44
  v_perm_b32 v50, v138, v136, s44
  v_perm_b32 v51, v142, v140, s44
  v_accvgpr_write_b32 a64, v48
  v_accvgpr_write_b32 a65, v49
  v_accvgpr_write_b32 a66, v50
  v_accvgpr_write_b32 a67, v51
  v_perm_b32 v52, v130, v128, s45
  v_perm_b32 v53, v134, v132, s45
  v_perm_b32 v54, v138, v136, s45
  v_perm_b32 v55, v142, v140, s45
  v_accvgpr_write_b32 a68, v52
  v_accvgpr_write_b32 a69, v53
  v_accvgpr_write_b32 a70, v54
  v_accvgpr_write_b32 a71, v55
  v_perm_b32 v48, v131, v129, s44
  v_perm_b32 v49, v135, v133, s44
  v_perm_b32 v50, v139, v137, s44
  v_perm_b32 v51, v143, v141, s44
  v_accvgpr_write_b32 a72, v48
  v_accvgpr_write_b32 a73, v49
  v_accvgpr_write_b32 a74, v50
  v_accvgpr_write_b32 a75, v51
  v_perm_b32 v52, v131, v129, s45
  v_perm_b32 v53, v135, v133, s45
  v_perm_b32 v54, v139, v137, s45
  v_perm_b32 v55, v143, v141, s45
  v_accvgpr_write_b32 a76, v52
  v_accvgpr_write_b32 a77, v53
  v_accvgpr_write_b32 a78, v54
  v_accvgpr_write_b32 a79, v55
  s_add_u32 s27, s30, 172032
  buffer_load_dwordx2 v[128:129], v44, s[80:83], s27 offen
  s_add_u32 s27, s30, 173056
  buffer_load_dwordx2 v[130:131], v44, s[80:83], s27 offen
  s_add_u32 s27, s30, 174080
  buffer_load_dwordx2 v[132:133], v44, s[80:83], s27 offen
  s_add_u32 s27, s30, 175104
  buffer_load_dwordx2 v[134:135], v44, s[80:83], s27 offen
  s_add_u32 s27, s30, 188416
  buffer_load_dwordx2 v[136:137], v44, s[80:83], s27 offen
  s_add_u32 s27, s30, 189440
  buffer_load_dwordx2 v[138:139], v44, s[80:83], s27 offen
  s_add_u32 s27, s30, 190464
  buffer_load_dwordx2 v[140:141], v44, s[80:83], s27 offen
  s_add_u32 s27, s30, 191488
  buffer_load_dwordx2 v[142:143], v44, s[80:83], s27 offen
  s_waitcnt vmcnt(48)
  v_perm_b32 v48, v146, v144, s44
  v_perm_b32 v49, v150, v148, s44
  v_perm_b32 v50, v154, v152, s44
  v_perm_b32 v51, v158, v156, s44
  v_accvgpr_write_b32 a80, v48
  v_accvgpr_write_b32 a81, v49
  v_accvgpr_write_b32 a82, v50
  v_accvgpr_write_b32 a83, v51
  v_perm_b32 v52, v146, v144, s45
  v_perm_b32 v53, v150, v148, s45
  v_perm_b32 v54, v154, v152, s45
  v_perm_b32 v55, v158, v156, s45
  v_accvgpr_write_b32 a84, v52
  v_accvgpr_write_b32 a85, v53
  v_accvgpr_write_b32 a86, v54
  v_accvgpr_write_b32 a87, v55
  v_perm_b32 v48, v147, v145, s44
  v_perm_b32 v49, v151, v149, s44
  v_perm_b32 v50, v155, v153, s44
  v_perm_b32 v51, v159, v157, s44
  v_accvgpr_write_b32 a88, v48
  v_accvgpr_write_b32 a89, v49
  v_accvgpr_write_b32 a90, v50
  v_accvgpr_write_b32 a91, v51
  v_perm_b32 v52, v147, v145, s45
  v_perm_b32 v53, v151, v149, s45
  v_perm_b32 v54, v155, v153, s45
  v_perm_b32 v55, v159, v157, s45
  v_accvgpr_write_b32 a92, v52
  v_accvgpr_write_b32 a93, v53
  v_accvgpr_write_b32 a94, v54
  v_accvgpr_write_b32 a95, v55
  s_add_u32 s27, s30, 196608
  buffer_load_dwordx2 v[144:145], v44, s[80:83], s27 offen
  s_add_u32 s27, s30, 197632
  buffer_load_dwordx2 v[146:147], v44, s[80:83], s27 offen
  s_add_u32 s27, s30, 198656
  buffer_load_dwordx2 v[148:149], v44, s[80:83], s27 offen
  s_add_u32 s27, s30, 199680
  buffer_load_dwordx2 v[150:151], v44, s[80:83], s27 offen
  s_add_u32 s27, s30, 212992
  buffer_load_dwordx2 v[152:153], v44, s[80:83], s27 offen
  s_add_u32 s27, s30, 214016
  buffer_load_dwordx2 v[154:155], v44, s[80:83], s27 offen
  s_add_u32 s27, s30, 215040
  buffer_load_dwordx2 v[156:157], v44, s[80:83], s27 offen
  s_add_u32 s27, s30, 216064
  buffer_load_dwordx2 v[158:159], v44, s[80:83], s27 offen
  s_waitcnt vmcnt(48)
  v_perm_b32 v48, v162, v160, s44
  v_perm_b32 v49, v166, v164, s44
  v_perm_b32 v50, v170, v168, s44
  v_perm_b32 v51, v174, v172, s44
  v_accvgpr_write_b32 a96, v48
  v_accvgpr_write_b32 a97, v49
  v_accvgpr_write_b32 a98, v50
  v_accvgpr_write_b32 a99, v51
  v_perm_b32 v52, v162, v160, s45
  v_perm_b32 v53, v166, v164, s45
  v_perm_b32 v54, v170, v168, s45
  v_perm_b32 v55, v174, v172, s45
  v_accvgpr_write_b32 a100, v52
  v_accvgpr_write_b32 a101, v53
  v_accvgpr_write_b32 a102, v54
  v_accvgpr_write_b32 a103, v55
  v_perm_b32 v48, v163, v161, s44
  v_perm_b32 v49, v167, v165, s44
  v_perm_b32 v50, v171, v169, s44
  v_perm_b32 v51, v175, v173, s44
  v_accvgpr_write_b32 a104, v48
  v_accvgpr_write_b32 a105, v49
  v_accvgpr_write_b32 a106, v50
  v_accvgpr_write_b32 a107, v51
  v_perm_b32 v52, v163, v161, s45
  v_perm_b32 v53, v167, v165, s45
  v_perm_b32 v54, v171, v169, s45
  v_perm_b32 v55, v175, v173, s45
  v_accvgpr_write_b32 a108, v52
  v_accvgpr_write_b32 a109, v53
  v_accvgpr_write_b32 a110, v54
  v_accvgpr_write_b32 a111, v55
  s_add_u32 s27, s30, 204800
  buffer_load_dwordx2 v[160:161], v44, s[80:83], s27 offen
  s_add_u32 s27, s30, 205824
  buffer_load_dwordx2 v[162:163], v44, s[80:83], s27 offen
  s_add_u32 s27, s30, 206848
  buffer_load_dwordx2 v[164:165], v44, s[80:83], s27 offen
  s_add_u32 s27, s30, 207872
  buffer_load_dwordx2 v[166:167], v44, s[80:83], s27 offen
  s_add_u32 s27, s30, 221184
  buffer_load_dwordx2 v[168:169], v44, s[80:83], s27 offen
  s_add_u32 s27, s30, 222208
  buffer_load_dwordx2 v[170:171], v44, s[80:83], s27 offen
  s_add_u32 s27, s30, 223232
  buffer_load_dwordx2 v[172:173], v44, s[80:83], s27 offen
  s_add_u32 s27, s30, 224256
  buffer_load_dwordx2 v[174:175], v44, s[80:83], s27 offen
  s_waitcnt vmcnt(48)
  v_perm_b32 v48, v66, v64, s44
  v_perm_b32 v49, v70, v68, s44
  v_perm_b32 v50, v74, v72, s44
  v_perm_b32 v51, v78, v76, s44
  v_accvgpr_write_b32 a112, v48
  v_accvgpr_write_b32 a113, v49
  v_accvgpr_write_b32 a114, v50
  v_accvgpr_write_b32 a115, v51
  v_perm_b32 v52, v66, v64, s45
  v_perm_b32 v53, v70, v68, s45
  v_perm_b32 v54, v74, v72, s45
  v_perm_b32 v55, v78, v76, s45
  v_accvgpr_write_b32 a116, v52
  v_accvgpr_write_b32 a117, v53
  v_accvgpr_write_b32 a118, v54
  v_accvgpr_write_b32 a119, v55
  v_perm_b32 v48, v67, v65, s44
  v_perm_b32 v49, v71, v69, s44
  v_perm_b32 v50, v75, v73, s44
  v_perm_b32 v51, v79, v77, s44
  v_accvgpr_write_b32 a120, v48
  v_accvgpr_write_b32 a121, v49
  v_accvgpr_write_b32 a122, v50
  v_accvgpr_write_b32 a123, v51
  v_perm_b32 v52, v67, v65, s45
  v_perm_b32 v53, v71, v69, s45
  v_perm_b32 v54, v75, v73, s45
  v_perm_b32 v55, v79, v77, s45
  v_accvgpr_write_b32 a124, v52
  v_accvgpr_write_b32 a125, v53
  v_accvgpr_write_b32 a126, v54
  v_accvgpr_write_b32 a127, v55
  s_add_u32 s27, s30, 229376
  buffer_load_dwordx2 v[64:65], v44, s[80:83], s27 offen
  s_add_u32 s27, s30, 230400
  buffer_load_dwordx2 v[66:67], v44, s[80:83], s27 offen
  s_add_u32 s27, s30, 231424
  buffer_load_dwordx2 v[68:69], v44, s[80:83], s27 offen
  s_add_u32 s27, s30, 232448
  buffer_load_dwordx2 v[70:71], v44, s[80:83], s27 offen
  s_add_u32 s27, s30, 245760
  buffer_load_dwordx2 v[72:73], v44, s[80:83], s27 offen
  s_add_u32 s27, s30, 246784
  buffer_load_dwordx2 v[74:75], v44, s[80:83], s27 offen
  s_add_u32 s27, s30, 247808
  buffer_load_dwordx2 v[76:77], v44, s[80:83], s27 offen
  s_add_u32 s27, s30, 248832
  buffer_load_dwordx2 v[78:79], v44, s[80:83], s27 offen
  s_waitcnt vmcnt(48)
  v_perm_b32 v48, v82, v80, s44
  v_perm_b32 v49, v86, v84, s44
  v_perm_b32 v50, v90, v88, s44
  v_perm_b32 v51, v94, v92, s44
  v_accvgpr_write_b32 a128, v48
  v_accvgpr_write_b32 a129, v49
  v_accvgpr_write_b32 a130, v50
  v_accvgpr_write_b32 a131, v51
  v_perm_b32 v52, v82, v80, s45
  v_perm_b32 v53, v86, v84, s45
  v_perm_b32 v54, v90, v88, s45
  v_perm_b32 v55, v94, v92, s45
  v_accvgpr_write_b32 a132, v52
  v_accvgpr_write_b32 a133, v53
  v_accvgpr_write_b32 a134, v54
  v_accvgpr_write_b32 a135, v55
  v_perm_b32 v48, v83, v81, s44
  v_perm_b32 v49, v87, v85, s44
  v_perm_b32 v50, v91, v89, s44
  v_perm_b32 v51, v95, v93, s44
  v_accvgpr_write_b32 a136, v48
  v_accvgpr_write_b32 a137, v49
  v_accvgpr_write_b32 a138, v50
  v_accvgpr_write_b32 a139, v51
  v_perm_b32 v52, v83, v81, s45
  v_perm_b32 v53, v87, v85, s45
  v_perm_b32 v54, v91, v89, s45
  v_perm_b32 v55, v95, v93, s45
  v_accvgpr_write_b32 a140, v52
  v_accvgpr_write_b32 a141, v53
  v_accvgpr_write_b32 a142, v54
  v_accvgpr_write_b32 a143, v55
  s_add_u32 s27, s30, 237568
  buffer_load_dwordx2 v[80:81], v44, s[80:83], s27 offen
  s_add_u32 s27, s30, 238592
  buffer_load_dwordx2 v[82:83], v44, s[80:83], s27 offen
  s_add_u32 s27, s30, 239616
  buffer_load_dwordx2 v[84:85], v44, s[80:83], s27 offen
  s_add_u32 s27, s30, 240640
  buffer_load_dwordx2 v[86:87], v44, s[80:83], s27 offen
  s_add_u32 s27, s30, 253952
  buffer_load_dwordx2 v[88:89], v44, s[80:83], s27 offen
  s_add_u32 s27, s30, 254976
  buffer_load_dwordx2 v[90:91], v44, s[80:83], s27 offen
  s_add_u32 s27, s30, 256000
  buffer_load_dwordx2 v[92:93], v44, s[80:83], s27 offen
  s_add_u32 s27, s30, 257024
  buffer_load_dwordx2 v[94:95], v44, s[80:83], s27 offen
  s_waitcnt vmcnt(48)
  v_perm_b32 v48, v98, v96, s44
  v_perm_b32 v49, v102, v100, s44
  v_perm_b32 v50, v106, v104, s44
  v_perm_b32 v51, v110, v108, s44
  v_accvgpr_write_b32 a144, v48
  v_accvgpr_write_b32 a145, v49
  v_accvgpr_write_b32 a146, v50
  v_accvgpr_write_b32 a147, v51
  v_perm_b32 v52, v98, v96, s45
  v_perm_b32 v53, v102, v100, s45
  v_perm_b32 v54, v106, v104, s45
  v_perm_b32 v55, v110, v108, s45
  v_accvgpr_write_b32 a148, v52
  v_accvgpr_write_b32 a149, v53
  v_accvgpr_write_b32 a150, v54
  v_accvgpr_write_b32 a151, v55
  v_perm_b32 v48, v99, v97, s44
  v_perm_b32 v49, v103, v101, s44
  v_perm_b32 v50, v107, v105, s44
  v_perm_b32 v51, v111, v109, s44
  v_accvgpr_write_b32 a152, v48
  v_accvgpr_write_b32 a153, v49
  v_accvgpr_write_b32 a154, v50
  v_accvgpr_write_b32 a155, v51
  v_perm_b32 v52, v99, v97, s45
  v_perm_b32 v53, v103, v101, s45
  v_perm_b32 v54, v107, v105, s45
  v_perm_b32 v55, v111, v109, s45
  v_accvgpr_write_b32 a156, v52
  v_accvgpr_write_b32 a157, v53
  v_accvgpr_write_b32 a158, v54
  v_accvgpr_write_b32 a159, v55
  buffer_store_dwordx4 v[208:211], v0, s[4:7], s29 offen offset:0 sc1
  buffer_store_dwordx4 v[208:211], v0, s[4:7], s29 offen offset:1024 sc1
  buffer_store_dwordx4 v[208:211], v0, s[4:7], s29 offen offset:2048 sc1
  buffer_store_dwordx4 v[208:211], v0, s[4:7], s29 offen offset:3072 sc1
  s_add_u32 s29, s29, 4096
  s_waitcnt vmcnt(44)
  v_perm_b32 v48, v114, v112, s44
  v_perm_b32 v49, v118, v116, s44
  v_perm_b32 v50, v122, v120, s44
  v_perm_b32 v51, v126, v124, s44
  v_accvgpr_write_b32 a160, v48
  v_accvgpr_write_b32 a161, v49
  v_accvgpr_write_b32 a162, v50
  v_accvgpr_write_b32 a163, v51
  v_perm_b32 v52, v114, v112, s45
  v_perm_b32 v53, v118, v116, s45
  v_perm_b32 v54, v122, v120, s45
  v_perm_b32 v55, v126, v124, s45
  v_accvgpr_write_b32 a164, v52
  v_accvgpr_write_b32 a165, v53
  v_accvgpr_write_b32 a166, v54
  v_accvgpr_write_b32 a167, v55
  v_perm_b32 v48, v115, v113, s44
  v_perm_b32 v49, v119, v117, s44
  v_perm_b32 v50, v123, v121, s44
  v_perm_b32 v51, v127, v125, s44
  v_accvgpr_write_b32 a168, v48
  v_accvgpr_write_b32 a169, v49
  v_accvgpr_write_b32 a170, v50
  v_accvgpr_write_b32 a171, v51
  v_perm_b32 v52, v115, v113, s45
  v_perm_b32 v53, v119, v117, s45
  v_perm_b32 v54, v123, v121, s45
  v_perm_b32 v55, v127, v125, s45
  v_accvgpr_write_b32 a172, v52
  v_accvgpr_write_b32 a173, v53
  v_accvgpr_write_b32 a174, v54
  v_accvgpr_write_b32 a175, v55
  buffer_store_dwordx4 v[208:211], v0, s[4:7], s29 offen offset:0 sc1
  buffer_store_dwordx4 v[208:211], v0, s[4:7], s29 offen offset:1024 sc1
  buffer_store_dwordx4 v[208:211], v0, s[4:7], s29 offen offset:2048 sc1
  buffer_store_dwordx4 v[208:211], v0, s[4:7], s29 offen offset:3072 sc1
  s_add_u32 s29, s29, 520192
  s_waitcnt vmcnt(40)
  v_perm_b32 v48, v130, v128, s44
  v_perm_b32 v49, v134, v132, s44
  v_perm_b32 v50, v138, v136, s44
  v_perm_b32 v51, v142, v140, s44
  v_accvgpr_write_b32 a176, v48
  v_accvgpr_write_b32 a177, v49
  v_accvgpr_write_b32 a178, v50
  v_accvgpr_write_b32 a179, v51
  v_perm_b32 v52, v130, v128, s45
  v_perm_b32 v53, v134, v132, s45
  v_perm_b32 v54, v138, v136, s45
  v_perm_b32 v55, v142, v140, s45
  v_accvgpr_write_b32 a180, v52
  v_accvgpr_write_b32 a181, v53
  v_accvgpr_write_b32 a182, v54
  v_accvgpr_write_b32 a183, v55
  v_perm_b32 v48, v131, v129, s44
  v_perm_b32 v49, v135, v133, s44
  v_perm_b32 v50, v139, v137, s44
  v_perm_b32 v51, v143, v141, s44
  v_accvgpr_write_b32 a184, v48
  v_accvgpr_write_b32 a185, v49
  v_accvgpr_write_b32 a186, v50
  v_accvgpr_write_b32 a187, v51
  v_perm_b32 v52, v131, v129, s45
  v_perm_b32 v53, v135, v133, s45
  v_perm_b32 v54, v139, v137, s45
  v_perm_b32 v55, v143, v141, s45
  v_accvgpr_write_b32 a188, v52
  v_accvgpr_write_b32 a189, v53
  v_accvgpr_write_b32 a190, v54
  v_accvgpr_write_b32 a191, v55
  buffer_store_dwordx4 v[208:211], v0, s[4:7], s29 offen offset:0 sc1
  buffer_store_dwordx4 v[208:211], v0, s[4:7], s29 offen offset:1024 sc1
  buffer_store_dwordx4 v[208:211], v0, s[4:7], s29 offen offset:2048 sc1
  buffer_store_dwordx4 v[208:211], v0, s[4:7], s29 offen offset:3072 sc1
  s_add_u32 s29, s29, 4096
  s_waitcnt vmcnt(36)
  v_perm_b32 v48, v146, v144, s44
  v_perm_b32 v49, v150, v148, s44
  v_perm_b32 v50, v154, v152, s44
  v_perm_b32 v51, v158, v156, s44
  v_accvgpr_write_b32 a192, v48
  v_accvgpr_write_b32 a193, v49
  v_accvgpr_write_b32 a194, v50
  v_accvgpr_write_b32 a195, v51
  v_perm_b32 v52, v146, v144, s45
  v_perm_b32 v53, v150, v148, s45
  v_perm_b32 v54, v154, v152, s45
  v_perm_b32 v55, v158, v156, s45
  v_accvgpr_write_b32 a196, v52
  v_accvgpr_write_b32 a197, v53
  v_accvgpr_write_b32 a198, v54
  v_accvgpr_write_b32 a199, v55
  v_perm_b32 v48, v147, v145, s44
  v_perm_b32 v49, v151, v149, s44
  v_perm_b32 v50, v155, v153, s44
  v_perm_b32 v51, v159, v157, s44
  v_accvgpr_write_b32 a200, v48
  v_accvgpr_write_b32 a201, v49
  v_accvgpr_write_b32 a202, v50
  v_accvgpr_write_b32 a203, v51
  v_perm_b32 v52, v147, v145, s45
  v_perm_b32 v53, v151, v149, s45
  v_perm_b32 v54, v155, v153, s45
  v_perm_b32 v55, v159, v157, s45
  v_accvgpr_write_b32 a204, v52
  v_accvgpr_write_b32 a205, v53
  v_accvgpr_write_b32 a206, v54
  v_accvgpr_write_b32 a207, v55
  buffer_store_dwordx4 v[208:211], v0, s[4:7], s29 offen offset:0 sc1
  buffer_store_dwordx4 v[208:211], v0, s[4:7], s29 offen offset:1024 sc1
  buffer_store_dwordx4 v[208:211], v0, s[4:7], s29 offen offset:2048 sc1
  buffer_store_dwordx4 v[208:211], v0, s[4:7], s29 offen offset:3072 sc1
  s_add_u32 s29, s29, 4096
  s_waitcnt vmcnt(32)
  v_perm_b32 v48, v162, v160, s44
  v_perm_b32 v49, v166, v164, s44
  v_perm_b32 v50, v170, v168, s44
  v_perm_b32 v51, v174, v172, s44
  v_accvgpr_write_b32 a208, v48
  v_accvgpr_write_b32 a209, v49
  v_accvgpr_write_b32 a210, v50
  v_accvgpr_write_b32 a211, v51
  v_perm_b32 v52, v162, v160, s45
  v_perm_b32 v53, v166, v164, s45
  v_perm_b32 v54, v170, v168, s45
  v_perm_b32 v55, v174, v172, s45
  v_accvgpr_write_b32 a212, v52
  v_accvgpr_write_b32 a213, v53
  v_accvgpr_write_b32 a214, v54
  v_accvgpr_write_b32 a215, v55
  v_perm_b32 v48, v163, v161, s44
  v_perm_b32 v49, v167, v165, s44
  v_perm_b32 v50, v171, v169, s44
  v_perm_b32 v51, v175, v173, s44
  v_accvgpr_write_b32 a216, v48
  v_accvgpr_write_b32 a217, v49
  v_accvgpr_write_b32 a218, v50
  v_accvgpr_write_b32 a219, v51
  v_perm_b32 v52, v163, v161, s45
  v_perm_b32 v53, v167, v165, s45
  v_perm_b32 v54, v171, v169, s45
  v_perm_b32 v55, v175, v173, s45
  v_accvgpr_write_b32 a220, v52
  v_accvgpr_write_b32 a221, v53
  v_accvgpr_write_b32 a222, v54
  v_accvgpr_write_b32 a223, v55
  s_waitcnt vmcnt(24)
  v_perm_b32 v48, v66, v64, s44
  v_perm_b32 v49, v70, v68, s44
  v_perm_b32 v50, v74, v72, s44
  v_perm_b32 v51, v78, v76, s44
  v_accvgpr_write_b32 a224, v48
  v_accvgpr_write_b32 a225, v49
  v_accvgpr_write_b32 a226, v50
  v_accvgpr_write_b32 a227, v51
  v_perm_b32 v52, v66, v64, s45
  v_perm_b32 v53, v70, v68, s45
  v_perm_b32 v54, v74, v72, s45
  v_perm_b32 v55, v78, v76, s45
  v_accvgpr_write_b32 a228, v52
  v_accvgpr_write_b32 a229, v53
  v_accvgpr_write_b32 a230, v54
  v_accvgpr_write_b32 a231, v55
  v_perm_b32 v48, v67, v65, s44
  v_perm_b32 v49, v71, v69, s44
  v_perm_b32 v50, v75, v73, s44
  v_perm_b32 v51, v79, v77, s44
  v_accvgpr_write_b32 a232, v48
  v_accvgpr_write_b32 a233, v49
  v_accvgpr_write_b32 a234, v50
  v_accvgpr_write_b32 a235, v51
  v_perm_b32 v52, v67, v65, s45
  v_perm_b32 v53, v71, v69, s45
  v_perm_b32 v54, v75, v73, s45
  v_perm_b32 v55, v79, v77, s45
  v_accvgpr_write_b32 a236, v52
  v_accvgpr_write_b32 a237, v53
  v_accvgpr_write_b32 a238, v54
  v_accvgpr_write_b32 a239, v55
  s_waitcnt vmcnt(16)
  v_perm_b32 v48, v82, v80, s44
  v_perm_b32 v49, v86, v84, s44
  v_perm_b32 v50, v90, v88, s44
  v_perm_b32 v51, v94, v92, s44
  v_accvgpr_write_b32 a240, v48
  v_accvgpr_write_b32 a241, v49
  v_accvgpr_write_b32 a242, v50
  v_accvgpr_write_b32 a243, v51
  v_perm_b32 v52, v82, v80, s45
  v_perm_b32 v53, v86, v84, s45
  v_perm_b32 v54, v90, v88, s45
  v_perm_b32 v55, v94, v92, s45
  v_accvgpr_write_b32 a244, v52
  v_accvgpr_write_b32 a245, v53
  v_accvgpr_write_b32 a246, v54
  v_accvgpr_write_b32 a247, v55
  v_perm_b32 v48, v83, v81, s44
  v_perm_b32 v49, v87, v85, s44
  v_perm_b32 v50, v91, v89, s44
  v_perm_b32 v51, v95, v93, s44
  v_accvgpr_write_b32 a248, v48
  v_accvgpr_write_b32 a249, v49
  v_accvgpr_write_b32 a250, v50
  v_accvgpr_write_b32 a251, v51
  v_perm_b32 v52, v83, v81, s45
  v_perm_b32 v53, v87, v85, s45
  v_perm_b32 v54, v91, v89, s45
  v_perm_b32 v55, v95, v93, s45
  v_accvgpr_write_b32 a252, v52
  v_accvgpr_write_b32 a253, v53
  v_accvgpr_write_b32 a254, v54
  v_accvgpr_write_b32 a255, v55
  s_waitcnt vmcnt(0)
  s_barrier
  s_cmp_lg_u32 s17, 0
  s_cbranch_scc1 g_ar_83
  s_lshl_b32 s36, s89, 3
  s_lshl_b64 s[36:37], 1, s36
  v_lshlrev_b32 v52, 3, s91
  v_mov_b32 v48, s36
  v_mov_b32 v49, s37
  s_mov_b64 exec, 1
  global_atomic_add_x2 v[50:51], v52, v[48:49], s[12:13] sc0
  s_mov_b64 exec, -1
g_ar_83:
  s_waitcnt vmcnt(0)
  s_cmp_lg_u32 s17, 0
  s_cbranch_scc1 g_af_84
  v_readfirstlane_b32 s36, v50
  v_readfirstlane_b32 s37, v51
  s_add_u32 s38, s36, s37
  s_mul_i32 s38, s38, 0x01010101
  s_lshr_b32 s38, s38, 24
  s_cmp_lg_u32 s38, 15
  s_cbranch_scc1 g_af_84
  s_lshl_b32 s38, s89, 3
  s_lshr_b64 s[36:37], s[36:37], s38
  s_and_b32 s36, s36, 0xff
  s_cmp_eq_u32 s36, 15
  s_cselect_b32 s36, 1, 2
  v_mov_b32 v48, s36
  v_lshrrev_b32 v52, 1, v52
  s_mov_b64 exec, 1
  global_store_dword v52, v48, s[12:13] offset:128 sc1
  s_mov_b64 exec, -1
g_af_84:
  v_mbcnt_lo_u32_b32 v60, -1, 0
  v_and_b32 v60, 0, v60
  v_add_lshl_u32 v60, v60, s91, 2
  s_mov_b32 s26, 0
g_wt_85:
  global_load_dword v61, v60, s[12:13] offset:128 sc1
  s_add_u32 s26, s26, 1
  s_cmp_gt_u32 s26, 1048576
  s_cbranch_scc1 L_end
  s_waitcnt vmcnt(0)
  v_cmp_eq_u32 vcc, 0, v61
  v_readfirstlane_b32 s27, v61
  s_cbranch_vccnz g_wt_85
  s_cmp_lg_u32 s27, 1
  s_cbranch_scc1 L_o_x
  s_mov_b32 s62, 1
  s_mov_b32 s42, 0
  s_mov_b32 s3, 0
  s_mov_b32 s46, 0
  s_mov_b32 s65, 0
  s_mov_b32 s66, 0
  s_mov_b32 s76, 0
  s_mov_b32 s55, 0
  s_mov_b32 s56, 0
  s_mov_b32 s84, 268435456
  s_mov_b32 s86, s41
  s_mov_b32 s49, s60
  s_mul_i32 s63, s49, 257
  s_or_b32 s63, s63, 1179648
  s_lshr_b32 s57, s60, 2
  s_cbranch_scc1 o_help_97
o_round_86:
  s_max_u32 s46, s46, s3
  s_cmp_lg_u32 s3, 0
  s_mov_b32 s3, 0
  s_cbranch_scc1 d_g_102
  s_mov_b32 s67, 0
d_w_101:
  s_min_u32 s26, s49, 71
  s_lshl_b32 s26, s26, 12
  s_add_u32 s27, s26, 243494912
  s_add_u32 s26, s26, 243486720
  buffer_load_dword v248, v246, s[4:7], s26 offen sc1
  buffer_load_dword v249, v246, s[4:7], s27 offen sc1
  s_add_u32 s67, s67, 1
  s_cmp_gt_u32 s67, 1048576
  s_cbranch_scc1 L_end
  s_waitcnt vmcnt(0)
  s_mov_b64 exec, 1
  buffer_store_dword v38, off, s[4:7], s84 sc1
  s_mov_b64 exec, -1
  s_mov_b32 s84, 268435456
  v_min_u32 v162, v248, v249
  v_max_u32 v163, v248, v249
  v_cmp_eq_u32 vcc, 0, v162
  s_cbranch_vccnz d_w_101
  v_max_u32_dpp v163, v163, v163 row_ror:8 row_mask:0xf bank_mask:0xf
  s_nop 1
  v_max_u32_dpp v163, v163, v163 row_ror:4 row_mask:0xf bank_mask:0xf
  s_nop 1
  v_max_u32_dpp v163, v163, v163 row_ror:2 row_mask:0xf bank_mask:0xf
  s_nop 1
  v_max_u32_dpp v163, v163, v163 row_ror:1 row_mask:0xf bank_mask:0xf
  s_nop 0
  v_readlane_b32 s28, v163, 0
  v_readlane_b32 s29, v163, 16
  v_readlane_b32 s30, v163, 32
  v_readlane_b32 s31, v163, 48
  s_max_u32 s28, s28, s29
  s_max_u32 s30, s30, s31
  s_max_u32 s46, s46, s28
  s_max_u32 s46, s46, s30
d_g_102:
  s_lshr_b32 s27, s49, 2
  s_andn2_b32 s52, 0xfff, s46
  s_lshr_b32 s52, s52, 5
  s_min_u32 s52, s52, 64
  s_add_u32 s26, s52, 3
  v_readlane_b32 s89, v247, s27
  s_sub_u32 s26, s26, s60
  s_lshr_b32 s26, s26, 2
  s_bfm_b32 s54, s26, 0
  s_add_u32 s53, s63, 1028
  s_cmp_lt_u32 s49, 60
  s_cselect_b32 s53, s53, 0
  s_cmp_lt_u32 s49, 64
  s_cselect_b32 s26, 3, 1
  s_sub_i32 s26, s27, s26
  s_max_i32 s26, s26, 0
  s_min_u32 s26, s26, 16
  s_bfm_b32 s58, s26, 0
  s_cmp_eq_u32 s27, 16
  s_cselect_b32 s59, 2, 1
  s_cmp_eq_u32 s27, 18
  s_cselect_b32 s59, 64, s59
  s_cselect_b32 s50, 0, -1
  s_cselect_b32 s89, 0, s89
  s_cbranch_scc1 o_dl_98
o_pick_90:
  s_cmp_eq_u32 s59, 0
  s_cbranch_scc1 o_none_94
  s_sub_u32 s59, s59, 1
  s_andn2_b32 s26, s58, s55
  s_and_b32 s26, s26, s54
  s_cbranch_scc1 o_ga_91
  s_and_b32 s26, s55, s50
  s_or_b32 s26, s26, s56
  s_or_b32 s26, s26, s54
  s_andn2_b32 s26, s58, s26
  s_cbranch_scc0 o_none_94
  s_cmp_ge_u32 s46, s89
  s_cbranch_scc1 o_gb_92
o_ga_91:
  s_ff1_i32_b32 s26, s26
  s_bitset1_b32 s55, s26
  s_mov_b32 s64, 1327168
  s_mov_b32 s27, s64
  s_branch o_gd_93
o_none_94:
  s_cmp_lt_u32 s49, 60
  s_cbranch_scc1 o_nn_95
  s_cmp_eq_u32 s50, 0
  s_cbranch_scc1 o_nn_95
  s_and_b32 s26, s63, 1097728
  s_cmp_eq_u32 s26, 1048576
  s_cbranch_scc1 o_nn_95
  s_cmp_lt_u32 s49, 64
  s_cbranch_scc1 o_adv_96
  s_and_b32 s26, s65, 1097728
  s_cmp_lg_u32 s26, 1048576
  s_cbranch_scc1 o_adv_96
o_nn_95:
  s_mov_b32 s64, s53
  s_mov_b32 s51, 0
  s_branch o_task_87
o_gb_92:
  s_ff1_i32_b32 s26, s26
  s_bitset1_b32 s56, s26
  s_andn2_b32 s27, 31, s46
  s_or_b32 s27, s27, 32
  s_lshl_b32 s27, s27, 22
  s_or_b32 s27, s27, 1474688
  s_mov_b32 s64, 1474624
o_gd_93:
  s_and_b32 s28, s26, s57
  s_lshr_b32 s26, s26, s57
  s_lshl2_add_u32 s26, s26, s60
  s_add_u32 s26, s26, s28
  s_cmp_eq_u32 s26, s52
  s_cselect_b32 s64, s27, s64
  s_mul_i32 s26, s26, 257
  s_or_b32 s64, s64, s26
  s_mov_b32 s51, 1
o_task_87:
  s_cmp_eq_u32 s63, 0
  s_cbranch_scc1 o_nofl_88
  s_cmp_lg_u32 s66, 0
  s_cbranch_scc1 o_have_104
  s_mov_b32 s67, 0
o_w1_103:
  s_and_b32 s32, s63, 0xff
  s_lshl_b32 s32, s32, 12
  s_add_u32 s32, s32, s14
  buffer_load_dword v37, v36, s[4:7], s32 offen sc1
  s_add_u32 s67, s67, 1
  s_cmp_gt_u32 s67, 1048576
  s_cbranch_scc1 L_end
  s_waitcnt vmcnt(0)
  s_mov_b64 exec, 1
  buffer_store_dword v38, off, s[4:7], s84 sc1
  s_mov_b64 exec, -1
  s_mov_b32 s84, 268435456
  v_cmp_eq_u32 vcc, 0, v37
  s_cbranch_vccnz o_w1_103
  s_and_b32 s87, s63, 0xff
  s_lshl_b32 s33, s87, 18
  s_lshl_b32 s32, s87, 19
  s_add_u32 m0, s22, 0
  s_add_u32 s33, s33, s19
  buffer_load_dwordx4 v0, s[4:7], s33 offen offset:0 sc1 lds
  buffer_load_dwordx4 v0, s[4:7], s33 offen offset:1024 sc1 lds
  buffer_load_dwordx4 v0, s[4:7], s33 offen offset:2048 sc1 lds
  buffer_load_dwordx4 v0, s[4:7], s33 offen offset:3072 sc1 lds
  s_add_u32 m0, s23, 0
  s_add_u32 s32, s32, s18
  buffer_load_dwordx4 v0, s[4:7], s32 offen offset:0 sc1 lds
  buffer_load_dwordx4 v0, s[4:7], s32 offen offset:1024 sc1 lds
  buffer_load_dwordx4 v0, s[4:7], s32 offen offset:2048 sc1 lds
  buffer_load_dwordx4 v0, s[4:7], s32 offen offset:3072 sc1 lds
  s_add_u32 m0, m0, 4096
  s_add_u32 s32, s32, 4096
  buffer_load_dwordx4 v0, s[4:7], s32 offen offset:0 sc1 lds
  buffer_load_dwordx4 v0, s[4:7], s32 offen offset:1024 sc1 lds
  buffer_load_dwordx4 v0, s[4:7], s32 offen offset:2048 sc1 lds
  buffer_load_dwordx4 v0, s[4:7], s32 offen offset:3072 sc1 lds
  s_waitcnt vmcnt(0)
  s_barrier
o_have_104:
  ds_read_b128 v[120:123], v33 offset:0
  ds_read_b128 v[40:43], v32 offset:0
  ds_read_b128 v[56:59], v32 offset:1024
  ds_read_b128 v[124:127], v33 offset:2048
  ds_read_b128 v[44:47], v32 offset:4096
  ds_read_b128 v[60:63], v32 offset:5120
  ds_read_b128 v[128:131], v33 offset:4096
  ds_read_b128 v[48:51], v32 offset:8192
  ds_read_b128 v[64:67], v32 offset:9216
  ds_read_b128 v[132:135], v33 offset:6144
  ds_read_b128 v[52:55], v32 offset:12288
  ds_read_b128 v[68:71], v32 offset:13312
  s_cmp_lt_u32 s17, 2
  s_cselect_b32 s65, s65, 0
  s_cmp_lg_u32 s65, 0
  s_cselect_b64 s[44:45], -1, 0
  s_mov_b32 s95, s86
  s_mov_b32 s96, s42
  s_lshl_b32 s97, s43, 14
  s_add_u32 s97, s97, s95
  s_and_b32 s87, s64, 0xff
  s_lshl_b32 s87, s87, 12
  s_add_u32 s87, s87, s14
  s_and_b32 s88, s63, 0xff00
  s_lshl_b32 s88, s88, 3
  s_add_u32 s88, s88, s15
  s_and_b32 s91, s65, 63
  s_lshl_b32 s90, s91, 5
  s_add_u32 s94, s90, s85
  s_add_u32 s90, s90, s43
  s_lshl_b32 s94, s94, 10
  s_lshr_b32 s92, s65, 22
  s_xor_b32 s93, s43, 32
  s_lshl_b32 s91, s90, 10
  s_add_u32 s94, s94, 25165824
  s_cmp_eq_u32 s92, s93
  s_cselect_b32 s92, s94, s91
  s_add_u32 s92, s92, 10485760
  s_and_b32 s93, s65, 49152
  s_cselect_b32 s92, s92, s91
  s_cselect_b64 s[80:81], s[4:5], s[72:73]
  s_cselect_b32 s82, s6, s74
  s_waitcnt lgkmcnt(9)
  v_mfma_f32_16x16x32_bf16 v[104:107], v[40:43], v[120:123], v[24:27]
  v_mfma_f32_16x16x32_bf16 v[108:111], v[56:59], v[120:123], v[28:31]
  s_mov_b64 exec, s[44:45]
  buffer_load_dword v7, v255, s[4:7], s97 offen sc1
  buffer_load_dwordx4 v[184:187], v0, s[80:83], s92 offen sc1
  s_not_b64 exec, exec
  buffer_load_dword v37, v36, s[4:7], s87 offen sc1
  s_mov_b64 exec, -1
  buffer_load_dword v244, v252, s[4:7], s88 offen sc1
  s_waitcnt lgkmcnt(6)
  v_mfma_f32_16x16x32_bf16 v[104:107], v[44:47], v[124:127], v[104:107]
  v_mfma_f32_16x16x32_bf16 v[108:111], v[60:63], v[124:127], v[108:111]
  s_waitcnt lgkmcnt(3)
  v_mfma_f32_16x16x32_bf16 v[104:107], v[48:51], v[128:131], v[104:107]
  v_mfma_f32_16x16x32_bf16 v[108:111], v[64:67], v[128:131], v[108:111]
  s_waitcnt lgkmcnt(0)
  v_mfma_f32_16x16x32_bf16 v[104:107], v[52:55], v[132:135], v[104:107]
  v_mfma_f32_16x16x32_bf16 v[108:111], v[68:71], v[132:135], v[108:111]
  s_cmp_lg_u32 s76, 0
  s_cbranch_scc1 o_klds_107
  v_mov_b32 v196, 0
  v_mov_b32 v199, 0
  v_exp_f32 v56, v104
  v_exp_f32 v57, v105
  v_exp_f32 v58, v106
  v_exp_f32 v59, v107
  v_exp_f32 v60, v108
  v_exp_f32 v61, v109
  v_exp_f32 v62, v110
  v_exp_f32 v63, v111
  v_max3_f32 v116, v104, v105, v106
  v_max3_f32 v116, v107, v108, v116
  v_max3_f32 v116, v109, v110, v116
  v_add_f32 v117, v56, v57
  v_add_f32 v118, v58, v59
  v_add_f32 v117, v117, v60
  v_add_f32 v118, v118, v61
  v_add_f32 v117, v117, v62
  v_add_f32 v118, v118, v63
  s_mov_b32 s67, 0
  s_and_b32 s32, s63, 0xff00
  s_lshl_b32 s32, s32, 10
  s_add_u32 s32, s32, s20
  s_add_u32 s33, s32, 4096
o_w2_105:
  s_waitcnt vmcnt(0)
  v_cmp_eq_u32 vcc, 0, v244
  s_cbranch_vccz o_kgo_115
  s_mov_b64 exec, 1
  buffer_store_dword v38, off, s[4:7], s84 sc1
  s_mov_b64 exec, -1
  s_mov_b32 s84, 268435456
  buffer_load_dword v244, v252, s[4:7], s88 offen sc1
  s_add_u32 s67, s67, 1
  s_cmp_gt_u32 s67, 1048576
  s_cbranch_scc1 L_end
  s_branch o_w2_105
o_kgo_115:
  buffer_load_dwordx4 v[136:139], v0, s[4:7], s32 offen offset:0 sc1
  buffer_load_dwordx4 v[140:143], v0, s[4:7], s32 offen offset:1024 sc1
  buffer_load_dwordx4 v[144:147], v0, s[4:7], s32 offen offset:2048 sc1
  buffer_load_dwordx4 v[148:151], v0, s[4:7], s32 offen offset:3072 sc1
  buffer_load_dwordx2 v[200:201], v1, s[4:7], s33 offen offset:0 sc1
  buffer_load_dwordx2 v[202:203], v1, s[4:7], s33 offen offset:512 sc1
  buffer_load_dwordx2 v[204:205], v1, s[4:7], s33 offen offset:1024 sc1
  buffer_load_dwordx2 v[206:207], v1, s[4:7], s33 offen offset:1536 sc1
  buffer_load_dword v37, v36, s[4:7], s87 offen sc1
  buffer_load_dword v244, v252, s[4:7], s88 offen sc1
  s_barrier
  ds_read_b128 v[152:155], v32 offset:2048
  ds_read_b128 v[156:159], v32 offset:3072
  ds_read_b128 v[160:163], v32 offset:6144
  ds_read_b128 v[164:167], v32 offset:7168
  ds_read_b128 v[168:171], v32 offset:10240
  ds_read_b128 v[172:175], v32 offset:11264
  ds_read_b128 v[176:179], v32 offset:14336
  ds_read_b128 v[180:183], v32 offset:15360
  s_waitcnt vmcnt(9)
  v_mfma_f32_16x16x32_bf16 v[112:115], v[136:139], v[120:123], 0
  s_waitcnt vmcnt(8)
  v_mfma_f32_16x16x32_bf16 v[112:115], v[140:143], v[124:127], v[112:115]
  s_waitcnt vmcnt(7)
  v_mfma_f32_16x16x32_bf16 v[112:115], v[144:147], v[128:131], v[112:115]
  s_waitcnt vmcnt(6)
  v_mfma_f32_16x16x32_bf16 v[112:115], v[148:151], v[132:135], v[112:115]
  s_waitcnt vmcnt(2)
  s_branch o_havek_106
o_klds_107:
  s_waitcnt vmcnt(12)
  s_barrier
  ds_read_b128 v[136:139], v34 offset:0
  ds_read_b128 v[140:143], v34 offset:1024
  ds_read_b128 v[144:147], v34 offset:2048
  ds_read_b128 v[148:151], v34 offset:3072
  ds_read_b64 v[200:201], v35 offset:4096
  ds_read_b64 v[202:203], v35 offset:4608
  ds_read_b64 v[204:205], v35 offset:5120
  ds_read_b64 v[206:207], v35 offset:5632
  v_mov_b32 v196, 0
  v_mov_b32 v199, 0
  v_exp_f32 v56, v104
  v_exp_f32 v57, v105
  v_exp_f32 v58, v106
  v_exp_f32 v59, v107
  v_exp_f32 v60, v108
  v_exp_f32 v61, v109
  v_exp_f32 v62, v110
  v_exp_f32 v63, v111
  v_max3_f32 v116, v104, v105, v106
  v_max3_f32 v116, v107, v108, v116
  v_max3_f32 v116, v109, v110, v116
  s_waitcnt lgkmcnt(4)
  v_mfma_f32_16x16x32_bf16 v[112:115], v[136:139], v[120:123], 0
  ds_read_b128 v[152:155], v32 offset:2048
  ds_read_b128 v[156:159], v32 offset:3072
  v_mfma_f32_16x16x32_bf16 v[112:115], v[140:143], v[124:127], v[112:115]
  ds_read_b128 v[160:163], v32 offset:6144
  ds_read_b128 v[164:167], v32 offset:7168
  v_mfma_f32_16x16x32_bf16 v[112:115], v[144:147], v[128:131], v[112:115]
  ds_read_b128 v[168:171], v32 offset:10240
  ds_read_b128 v[172:175], v32 offset:11264
  v_mfma_f32_16x16x32_bf16 v[112:115], v[148:151], v[132:135], v[112:115]
  ds_read_b128 v[176:179], v32 offset:14336
  ds_read_b128 v[180:183], v32 offset:15360
  v_add_f32 v117, v56, v57
  v_add_f32 v118, v58, v59
  v_add_f32 v117, v117, v60
  v_add_f32 v118, v118, v61
  v_add_f32 v117, v117, v62
  v_add_f32 v118, v118, v63
o_havek_106:
  s_cmp_lg_u32 s65, 0
  s_cbranch_scc1 o_wr1_112
  s_nop 3
  v_mul_f32 v112, s24, v112
  v_mul_f32 v113, s24, v113
  v_exp_f32 v64, v112
  v_exp_f32 v65, v113
  v_max_f32 v116, v111, v116
  v_max3_f32 v116, v112, v113, v116
  v_add_f32 v117, v117, v64
  v_add_f32 v118, v118, v65
  v_add_f32 v117, v117, v118
  s_mov_b32 s28, 0x21800000
  v_mov_b32 v118, v117
  s_nop 1
  v_permlane16_swap_b32 v117, v118
  v_add_f32 v117, v117, v118
  v_mov_b32 v118, v117
  s_nop 0
  s_nop 0
  v_permlane32_swap_b32 v117, v118
  v_add_f32 v117, v117, v118
  v_cmp_lt_f32 vcc, 0x42700000, v116
  v_cmp_gt_f32 s[30:31], s28, v117
  v_rcp_f32 v117, v117
  s_or_b64 vcc, vcc, s[30:31]
  s_cbranch_vccnz o_fb_116
o_fbr_117:
  v_pk_mul_f32 v[56:57], v[56:57], v[116:117] op_sel:[0,1] op_sel_hi:[1,1]
  v_pk_mul_f32 v[58:59], v[58:59], v[116:117] op_sel:[0,1] op_sel_hi:[1,1]
  v_pk_mul_f32 v[60:61], v[60:61], v[116:117] op_sel:[0,1] op_sel_hi:[1,1]
  v_pk_mul_f32 v[62:63], v[62:63], v[116:117] op_sel:[0,1] op_sel_hi:[1,1]
  v_pk_mul_f32 v[64:65], v[64:65], v[116:117] op_sel:[0,1] op_sel_hi:[1,1]
  v_cvt_pk_bf16_f32 v116, v56, v57
  v_cvt_pk_bf16_f32 v117, v58, v59
  v_cvt_pk_bf16_f32 v118, v60, v61
  v_cvt_pk_bf16_f32 v119, v62, v63
  s_waitcnt lgkmcnt(0)
  s_nop 0
  v_mfma_f32_16x16x32_bf16 v[72:75], v[152:155], v[116:119], 0
  s_add_u32 s62, s62, 1
  v_cvt_pk_bf16_f32 v197, v64, v65
  v_cvt_pk_bf16_f32 v198, v64, v65
  v_mfma_f32_16x16x32_bf16 v[76:79], v[156:159], v[116:119], 0
  s_xor_b32 s86, s86, 524288
  v_mfma_f32_16x16x32_bf16 v[80:83], v[160:163], v[116:119], 0
  s_bfe_u32 s42, s62, 0x10001
  v_mfma_f32_16x16x32_bf16 v[84:87], v[164:167], v[116:119], 0
  s_bfe_u32 s26, s64, 65556
  v_mfma_f32_16x16x32_bf16 v[88:91], v[168:171], v[116:119], 0
  s_and_b32 s87, s64, 0xff
  v_mfma_f32_16x16x32_bf16 v[92:95], v[172:175], v[116:119], 0
  s_bfe_u32 s88, s64, 0x80008
  v_mfma_f32_16x16x32_bf16 v[96:99], v[176:179], v[116:119], 0
  s_nop 0
  v_mfma_f32_16x16x32_bf16 v[100:103], v[180:183], v[116:119], 0
  s_nop 0
  v_mfma_f32_16x16x16_bf16 v[72:75], v[200:201], v[198:199], v[72:75]
  s_nop 1
  v_mfma_f32_16x16x16_bf16 v[76:79], v[200:201], v[196:197], v[76:79]
  s_nop 1
  v_mfma_f32_16x16x16_bf16 v[80:83], v[202:203], v[198:199], v[80:83]
  s_nop 1
  v_mfma_f32_16x16x16_bf16 v[84:87], v[202:203], v[196:197], v[84:87]
  s_nop 1
  v_mfma_f32_16x16x16_bf16 v[88:91], v[204:205], v[198:199], v[88:91]
  s_nop 0
  v_cvt_pk_bf16_f32 v40, v72, v73
  v_cvt_pk_bf16_f32 v41, v74, v75
  v_mfma_f32_16x16x16_bf16 v[92:95], v[204:205], v[196:197], v[92:95]
  s_nop 0
  v_cvt_pk_bf16_f32 v42, v76, v77
  v_cvt_pk_bf16_f32 v43, v78, v79
  v_mfma_f32_16x16x16_bf16 v[96:99], v[206:207], v[198:199], v[96:99]
  s_nop 0
  ds_write_b128 v6, v[40:43] offset:0
  v_cvt_pk_bf16_f32 v44, v80, v81
  v_mfma_f32_16x16x16_bf16 v[100:103], v[206:207], v[196:197], v[100:103]
  s_nop 0
  v_cvt_pk_bf16_f32 v45, v82, v83
  v_cvt_pk_bf16_f32 v46, v84, v85
  v_cvt_pk_bf16_f32 v47, v86, v87
  ds_write_b128 v6, v[44:47] offset:1024
  v_cvt_pk_bf16_f32 v48, v88, v89
  v_cvt_pk_bf16_f32 v49, v90, v91
  v_cvt_pk_bf16_f32 v50, v92, v93
  v_cvt_pk_bf16_f32 v51, v94, v95
  ds_write_b128 v6, v[48:51] offset:2048
  v_cvt_pk_bf16_f32 v52, v96, v97
  v_cvt_pk_bf16_f32 v53, v98, v99
  v_cvt_pk_bf16_f32 v54, v100, v101
  v_cvt_pk_bf16_f32 v55, v102, v103
  ds_write_b128 v6, v[52:55] offset:3072
  s_cmp_lt_u32 s17, 2
  s_cbranch_scc1 o_wr0_111
  s_waitcnt lgkmcnt(0)
  s_barrier
  ds_read_b128 v[104:107], v3 offset:0
  ds_read_b128 v[108:111], v3 offset:512
  ds_read_b128 v[112:115], v3 offset:1024
  s_waitcnt lgkmcnt(2)
  v_mfma_f32_32x32x16_bf16 v[40:55], v[104:107], a[0:3], 0
  s_waitcnt vmcnt(0)
  v_cmp_eq_u32 vcc, 0, v37
  s_cmp_eq_u64 vcc, 0
  s_cselect_b32 s66, s26, 0
  s_cmp_eq_u32 s66, 1
  s_cselect_b32 s87, s87, 1024
  s_cselect_b32 s34, 0, 0x28000
  v_mfma_f32_32x32x16_bf16 v[56:71], v[104:107], a[4:7], 0
  ds_read_b128 v[116:119], v3 offset:1536
  s_lshl_b32 s33, s87, 18
  s_lshl_b32 s32, s87, 19
  s_add_u32 m0, s22, s34
  s_add_u32 s33, s33, s19
  s_min_u32 s28, s49, 67
  v_mfma_f32_32x32x16_bf16 v[72:87], v[104:107], a[8:11], 0
  s_lshl1_add_u32 s28, s17, s28
  s_lshl_b32 s28, s28, 12
  s_add_u32 s28, s28, 243486720
  v_mfma_f32_32x32x16_bf16 v[88:103], v[104:107], a[12:15], 0
  buffer_load_dword v249, v246, s[4:7], s28 offen sc1
  s_waitcnt lgkmcnt(2)
  v_mfma_f32_32x32x16_bf16 v[40:55], v[108:111], a[16:19], v[40:55]
  buffer_load_dwordx4 v0, s[4:7], s33 offen offset:0 sc1 lds
  v_mfma_f32_32x32x16_bf16 v[56:71], v[108:111], a[20:23], v[56:71]
  ds_read_b128 v[104:107], v3 offset:2048
  v_mfma_f32_32x32x16_bf16 v[72:87], v[108:111], a[24:27], v[72:87]
  buffer_load_dwordx4 v0, s[4:7], s33 offen offset:1024 sc1 lds
  v_mfma_f32_32x32x16_bf16 v[88:103], v[108:111], a[28:31], v[88:103]
  buffer_load_dwordx4 v0, s[4:7], s33 offen offset:2048 sc1 lds
  s_waitcnt lgkmcnt(2)
  v_mfma_f32_32x32x16_bf16 v[40:55], v[112:115], a[32:35], v[40:55]
  v_mfma_f32_32x32x16_bf16 v[56:71], v[112:115], a[36:39], v[56:71]
  ds_read_b128 v[108:111], v3 offset:2560
  buffer_load_dwordx4 v0, s[4:7], s33 offen offset:3072 sc1 lds
  s_sub_u32 m0, m0, 8192
  s_sub_u32 s33, s33, 8192
  v_mfma_f32_32x32x16_bf16 v[72:87], v[112:115], a[40:43], v[72:87]
  buffer_load_dwordx4 v0, s[4:7], s33 offen offset:0 sc1 lds
  v_mfma_f32_32x32x16_bf16 v[88:103], v[112:115], a[44:47], v[88:103]
  s_waitcnt lgkmcnt(2)
  v_mfma_f32_32x32x16_bf16 v[40:55], v[116:119], a[48:51], v[40:55]
  buffer_load_dwordx4 v0, s[4:7], s33 offen offset:1024 sc1 lds
  v_mfma_f32_32x32x16_bf16 v[56:71], v[116:119], a[52:55], v[56:71]
  ds_read_b128 v[112:115], v3 offset:3072
  buffer_load_dwordx4 v0, s[4:7], s33 offen offset:2048 sc1 lds
  v_mfma_f32_32x32x16_bf16 v[72:87], v[116:119], a[56:59], v[72:87]
  v_mfma_f32_32x32x16_bf16 v[88:103], v[116:119], a[60:63], v[88:103]
  buffer_load_dwordx4 v0, s[4:7], s33 offen offset:3072 sc1 lds
  s_add_u32 m0, s23, s34
  s_add_u32 s32, s32, s18
  s_waitcnt lgkmcnt(2)
  v_mfma_f32_32x32x16_bf16 v[40:55], v[104:107], a[64:67], v[40:55]
  buffer_load_dwordx4 v0, s[4:7], s32 offen offset:0 sc1 lds
  v_mfma_f32_32x32x16_bf16 v[56:71], v[104:107], a[68:71], v[56:71]
  ds_read_b128 v[116:119], v3 offset:3584
  v_mfma_f32_32x32x16_bf16 v[72:87], v[104:107], a[72:75], v[72:87]
  buffer_load_dwordx4 v0, s[4:7], s32 offen offset:1024 sc1 lds
  s_add_i32 m0, m0, 4096
  s_add_i32 s32, s32, 4096
  v_mfma_f32_32x32x16_bf16 v[88:103], v[104:107], a[76:79], v[88:103]
  buffer_load_dwordx4 v0, s[4:7], s32 offen offset:0 sc1 lds
  s_waitcnt lgkmcnt(2)
  v_mfma_f32_32x32x16_bf16 v[40:55], v[108:111], a[80:83], v[40:55]
  v_mfma_f32_32x32x16_bf16 v[56:71], v[108:111], a[84:87], v[56:71]
  ds_read_b128 v[104:107], v3 offset:8192
  buffer_load_dwordx4 v0, s[4:7], s32 offen offset:1024 sc1 lds
  s_add_i32 m0, m0, -16384
  s_add_i32 s32, s32, -16384
  v_mfma_f32_32x32x16_bf16 v[72:87], v[108:111], a[88:91], v[72:87]
  s_and_b32 s29, s64, 0xff00
  s_lshl_b32 s29, s29, 3
  s_add_u32 s29, s29, s15
  buffer_load_dword v245, v252, s[4:7], s29 offen sc1
  v_mfma_f32_32x32x16_bf16 v[88:103], v[108:111], a[92:95], v[88:103]
  s_waitcnt lgkmcnt(2)
  v_mfma_f32_32x32x16_bf16 v[40:55], v[112:115], a[96:99], v[40:55]
  buffer_load_dwordx4 v0, s[4:7], s32 offen offset:0 sc1 lds
  v_mfma_f32_32x32x16_bf16 v[56:71], v[112:115], a[100:103], v[56:71]
  ds_read_b128 v[108:111], v3 offset:8704
  buffer_load_dwordx4 v0, s[4:7], s32 offen offset:1024 sc1 lds
  s_add_i32 m0, m0, -4096
  s_add_i32 s32, s32, -4096
  v_mfma_f32_32x32x16_bf16 v[72:87], v[112:115], a[104:107], v[72:87]
  v_mfma_f32_32x32x16_bf16 v[88:103], v[112:115], a[108:111], v[88:103]
  buffer_load_dwordx4 v0, s[4:7], s32 offen offset:0 sc1 lds
  s_waitcnt lgkmcnt(2)
  v_mfma_f32_32x32x16_bf16 v[40:55], v[116:119], a[112:115], v[40:55]
  buffer_load_dwordx4 v0, s[4:7], s32 offen offset:1024 sc1 lds
  v_mfma_f32_32x32x16_bf16 v[56:71], v[116:119], a[116:119], v[56:71]
  ds_read_b128 v[112:115], v3 offset:9216
  v_mfma_f32_32x32x16_bf16 v[72:87], v[116:119], a[120:123], v[72:87]
  buffer_load_dwordx4 v0, s[4:7], s32 offen offset:2048 sc1 lds
  v_mfma_f32_32x32x16_bf16 v[88:103], v[116:119], a[124:127], v[88:103]
  buffer_load_dwordx4 v0, s[4:7], s32 offen offset:3072 sc1 lds
  s_add_i32 m0, m0, 4096
  s_add_i32 s32, s32, 4096
  s_waitcnt lgkmcnt(2)
  v_mfma_f32_32x32x16_bf16 v[40:55], v[104:107], a[128:131], v[40:55]
  v_mfma_f32_32x32x16_bf16 v[56:71], v[104:107], a[132:135], v[56:71]
  ds_read_b128 v[116:119], v3 offset:9728
  buffer_load_dwordx4 v0, s[4:7], s32 offen offset:2048 sc1 lds
  v_mfma_f32_32x32x16_bf16 v[72:87], v[104:107], a[136:139], v[72:87]
  buffer_load_dwordx4 v0, s[4:7], s32 offen offset:3072 sc1 lds
  s_add_i32 m0, m0, 16384
  s_add_i32 s32, s32, 16384
  v_mfma_f32_32x32x16_bf16 v[88:103], v[104:107], a[140:143], v[88:103]
  s_waitcnt lgkmcnt(2)
  v_mfma_f32_32x32x16_bf16 v[40:55], v[108:111], a[144:147], v[40:55]
  buffer_load_dwordx4 v0, s[4:7], s32 offen offset:2048 sc1 lds
  v_mfma_f32_32x32x16_bf16 v[56:71], v[108:111], a[148:151], v[56:71]
  ds_read_b128 v[104:107], v3 offset:10240
  buffer_load_dwordx4 v0, s[4:7], s32 offen offset:3072 sc1 lds
  s_add_i32 m0, m0, -4096
  s_add_i32 s32, s32, -4096
  v_mfma_f32_32x32x16_bf16 v[72:87], v[108:111], a[152:155], v[72:87]
  v_mfma_f32_32x32x16_bf16 v[88:103], v[108:111], a[156:159], v[88:103]
  buffer_load_dwordx4 v0, s[4:7], s32 offen offset:2048 sc1 lds
  s_waitcnt lgkmcnt(2)
  v_mfma_f32_32x32x16_bf16 v[40:55], v[112:115], a[160:163], v[40:55]
  buffer_load_dwordx4 v0, s[4:7], s32 offen offset:3072 sc1 lds
  v_mfma_f32_32x32x16_bf16 v[56:71], v[112:115], a[164:167], v[56:71]
  ds_read_b128 v[108:111], v3 offset:10752
  v_mfma_f32_32x32x16_bf16 v[72:87], v[112:115], a[168:171], v[72:87]
  v_mfma_f32_32x32x16_bf16 v[88:103], v[112:115], a[172:175], v[88:103]
  s_waitcnt lgkmcnt(2)
  v_mfma_f32_32x32x16_bf16 v[40:55], v[116:119], a[176:179], v[40:55]
  v_mfma_f32_32x32x16_bf16 v[56:71], v[116:119], a[180:183], v[56:71]
  ds_read_b128 v[112:115], v3 offset:11264
  v_mfma_f32_32x32x16_bf16 v[72:87], v[116:119], a[184:187], v[72:87]
  v_mfma_f32_32x32x16_bf16 v[88:103], v[116:119], a[188:191], v[88:103]
  s_waitcnt lgkmcnt(2)
  v_mfma_f32_32x32x16_bf16 v[40:55], v[104:107], a[192:195], v[40:55]
  v_mfma_f32_32x32x16_bf16 v[56:71], v[104:107], a[196:199], v[56:71]
  ds_read_b128 v[116:119], v3 offset:11776
  s_waitcnt vmcnt(12)
  v_cmp_eq_u32 vcc, 0, v245
  s_cmp_eq_u64 vcc, 0
  s_cselect_b32 s76, s26, 0
  s_and_b32 s76, s76, 1
  s_cselect_b32 s88, s88, 1024
  s_waitcnt lgkmcnt(2)
  v_mfma_f32_32x32x16_bf16 v[40:55], v[108:111], a[208:211], v[40:55]
  s_lshl_b32 s32, s88, 18
  s_mov_b32 m0, s40
  s_add_u32 s32, s32, s21
  buffer_load_dwordx4 v0, s[4:7], s32 offen offset:0 sc1 lds
  v_mfma_f32_32x32x16_bf16 v[56:71], v[108:111], a[212:215], v[56:71]
  buffer_load_dwordx4 v0, s[4:7], s32 offen offset:1024 sc1 lds
  s_waitcnt lgkmcnt(1)
  v_mfma_f32_32x32x16_bf16 v[40:55], v[112:115], a[224:227], v[40:55]
  buffer_load_dwordx4 v0, s[4:7], s32 offen offset:2048 sc1 lds
  s_sub_u32 m0, m0, 8192
  s_sub_u32 s32, s32, 8192
  v_mfma_f32_32x32x16_bf16 v[56:71], v[112:115], a[228:231], v[56:71]
  buffer_load_dwordx4 v0, s[4:7], s32 offen offset:0 sc1 lds
  s_waitcnt lgkmcnt(0)
  v_mfma_f32_32x32x16_bf16 v[40:55], v[116:119], a[240:243], v[40:55]
  buffer_load_dwordx4 v0, s[4:7], s32 offen offset:1024 sc1 lds
  v_mfma_f32_32x32x16_bf16 v[56:71], v[116:119], a[244:247], v[56:71]
  buffer_load_dwordx4 v0, s[4:7], s32 offen offset:2048 sc1 lds
  v_cmp_eq_u32 vcc, 0, v249
  v_max_u32_dpp v249, v249, v249 row_ror:8 row_mask:0xf bank_mask:0xf
  s_nop 0
  v_mfma_f32_32x32x16_bf16 v[72:87], v[104:107], a[200:203], v[72:87]
  v_max_u32_dpp v249, v249, v249 row_ror:4 row_mask:0xf bank_mask:0xf
  s_nop 0
  s_nop 0
  v_max_u32_dpp v249, v249, v249 row_ror:2 row_mask:0xf bank_mask:0xf
  s_nop 0
  s_nop 0
  v_max_u32_dpp v249, v249, v249 row_ror:1 row_mask:0xf bank_mask:0xf
  s_nop 0
  v_mfma_f32_32x32x16_bf16 v[88:103], v[104:107], a[204:207], v[88:103]
  v_mov_b32 v248, v249
  s_nop 0
  s_nop 0
  v_permlane16_swap_b32 v249, v248
  v_max_u32 v249, v249, v248
  v_mfma_f32_32x32x16_bf16 v[72:87], v[108:111], a[216:219], v[72:87]
  v_mov_b32 v248, v249
  s_nop 0
  s_nop 0
  v_permlane32_swap_b32 v249, v248
  v_max_u32 v249, v249, v248
  s_cmp_eq_u64 vcc, 0
  s_cselect_b32 s28, 4, 0
  v_mfma_f32_32x32x16_bf16 v[88:103], v[108:111], a[220:223], v[88:103]
  s_lshl_b32 s26, s76, 1
  s_or_b32 s26, s26, s66
  s_or_b32 s26, s26, s28
  v_mov_b32 v248, s26
  ds_write_b64 v39, v[248:249]
  v_mfma_f32_32x32x16_bf16 v[72:87], v[112:115], a[232:235], v[72:87]
  v_cvt_pk_bf16_f32 v212, v40, v56
  v_cvt_pk_bf16_f32 v214, v41, v57
  v_cvt_pk_bf16_f32 v216, v42, v58
  v_cvt_pk_bf16_f32 v218, v43, v59
  v_permlane16_swap_b32 v212, v214
  v_mfma_f32_32x32x16_bf16 v[88:103], v[112:115], a[236:239], v[88:103]
  v_cvt_pk_bf16_f32 v220, v44, v60
  v_cvt_pk_bf16_f32 v222, v45, v61
  v_permlane16_swap_b32 v216, v218
  v_bfi_b32 v212, v254, s42, v212
  v_mfma_f32_32x32x16_bf16 v[72:87], v[116:119], a[248:251], v[72:87]
  v_cvt_pk_bf16_f32 v224, v46, v62
  v_cvt_pk_bf16_f32 v226, v47, v63
  v_permlane16_swap_b32 v220, v222
  v_bfi_b32 v216, v254, s42, v216
  v_cvt_pk_bf16_f32 v228, v48, v64
  v_mfma_f32_32x32x16_bf16 v[88:103], v[116:119], a[252:255], v[88:103]
  v_cvt_pk_bf16_f32 v230, v49, v65
  v_permlane16_swap_b32 v224, v226
  v_bfi_b32 v220, v254, s42, v220
  v_cvt_pk_bf16_f32 v232, v50, v66
  v_cvt_pk_bf16_f32 v234, v51, v67
  v_permlane16_swap_b32 v228, v230
  v_bfi_b32 v224, v254, s42, v224
  v_cvt_pk_bf16_f32 v236, v52, v68
  v_cvt_pk_bf16_f32 v238, v53, v69
  v_permlane16_swap_b32 v232, v234
  v_bfi_b32 v228, v254, s42, v228
  v_cvt_pk_bf16_f32 v240, v54, v70
  v_cvt_pk_bf16_f32 v242, v55, v71
  v_permlane16_swap_b32 v236, v238
  v_bfi_b32 v232, v254, s42, v232
  v_permlane16_swap_b32 v240, v242
  v_bfi_b32 v236, v254, s42, v236
  v_bfi_b32 v240, v254, s42, v240
  v_cvt_pk_bf16_f32 v213, v72, v88
  v_cvt_pk_bf16_f32 v215, v73, v89
  v_cvt_pk_bf16_f32 v217, v74, v90
  v_cvt_pk_bf16_f32 v219, v75, v91
  s_add_u32 s78, s86, 0
  v_permlane16_swap_b32 v213, v215
  buffer_store_dwordx4 v[212:215], v4, s[4:7], s78 offen
  v_cvt_pk_bf16_f32 v221, v76, v92
  v_cvt_pk_bf16_f32 v223, v77, v93
  s_add_u32 s78, s86, 32768
  v_permlane16_swap_b32 v217, v219
  buffer_store_dwordx4 v[216:219], v4, s[4:7], s78 offen
  v_cvt_pk_bf16_f32 v225, v78, v94
  v_cvt_pk_bf16_f32 v227, v79, v95
  s_add_u32 s78, s86, 131072
  v_permlane16_swap_b32 v221, v223
  buffer_store_dwordx4 v[220:223], v4, s[4:7], s78 offen
  v_cvt_pk_bf16_f32 v229, v80, v96
  v_cvt_pk_bf16_f32 v231, v81, v97
  s_add_u32 s78, s86, 163840
  v_permlane16_swap_b32 v225, v227
  buffer_store_dwordx4 v[224:227], v4, s[4:7], s78 offen
  v_cvt_pk_bf16_f32 v233, v82, v98
  v_cvt_pk_bf16_f32 v235, v83, v99
  s_add_u32 s78, s86, 262144
  v_permlane16_swap_b32 v229, v231
  buffer_store_dwordx4 v[228:231], v4, s[4:7], s78 offen
  v_cvt_pk_bf16_f32 v237, v84, v100
  v_cvt_pk_bf16_f32 v239, v85, v101
  s_add_u32 s78, s86, 294912
  v_permlane16_swap_b32 v233, v235
  buffer_store_dwordx4 v[232:235], v4, s[4:7], s78 offen
  v_cvt_pk_bf16_f32 v241, v86, v102
  v_cvt_pk_bf16_f32 v243, v87, v103
  s_add_u32 s78, s86, 393216
  v_permlane16_swap_b32 v237, v239
  buffer_store_dwordx4 v[236:239], v4, s[4:7], s78 offen
  s_add_u32 s78, s86, 425984
  v_permlane16_swap_b32 v241, v243
  buffer_store_dwordx4 v[240:243], v4, s[4:7], s78 offen
  s_waitcnt vmcnt(22)
  s_branch o_we_114
o_wr0_111:
  s_waitcnt lgkmcnt(0)
  s_barrier
  ds_read_b128 v[104:107], v3 offset:0
  ds_read_b128 v[108:111], v3 offset:512
  ds_read_b128 v[112:115], v3 offset:1024
  s_waitcnt lgkmcnt(2)
  v_mfma_f32_32x32x16_bf16 v[40:55], v[104:107], a[0:3], 0
  v_mfma_f32_32x32x16_bf16 v[56:71], v[104:107], a[4:7], 0
  ds_read_b128 v[116:119], v3 offset:1536
  v_mfma_f32_32x32x16_bf16 v[72:87], v[104:107], a[8:11], 0
  v_mfma_f32_32x32x16_bf16 v[88:103], v[104:107], a[12:15], 0
  s_waitcnt lgkmcnt(2)
  v_mfma_f32_32x32x16_bf16 v[40:55], v[108:111], a[16:19], v[40:55]
  v_mfma_f32_32x32x16_bf16 v[56:71], v[108:111], a[20:23], v[56:71]
  ds_read_b128 v[104:107], v3 offset:2048
  v_mfma_f32_32x32x16_bf16 v[72:87], v[108:111], a[24:27], v[72:87]
  v_mfma_f32_32x32x16_bf16 v[88:103], v[108:111], a[28:31], v[88:103]
  s_waitcnt lgkmcnt(2)
  v_mfma_f32_32x32x16_bf16 v[40:55], v[112:115], a[32:35], v[40:55]
  v_mfma_f32_32x32x16_bf16 v[56:71], v[112:115], a[36:39], v[56:71]
  ds_read_b128 v[108:111], v3 offset:2560
  v_mfma_f32_32x32x16_bf16 v[72:87], v[112:115], a[40:43], v[72:87]
  v_mfma_f32_32x32x16_bf16 v[88:103], v[112:115], a[44:47], v[88:103]
  s_waitcnt lgkmcnt(2)
  v_mfma_f32_32x32x16_bf16 v[40:55], v[116:119], a[48:51], v[40:55]
  v_mfma_f32_32x32x16_bf16 v[56:71], v[116:119], a[52:55], v[56:71]
  ds_read_b128 v[112:115], v3 offset:3072
  v_mfma_f32_32x32x16_bf16 v[72:87], v[116:119], a[56:59], v[72:87]
  v_mfma_f32_32x32x16_bf16 v[88:103], v[116:119], a[60:63], v[88:103]
  s_waitcnt lgkmcnt(2)
  v_mfma_f32_32x32x16_bf16 v[40:55], v[104:107], a[64:67], v[40:55]
  v_mfma_f32_32x32x16_bf16 v[56:71], v[104:107], a[68:71], v[56:71]
  ds_read_b128 v[116:119], v3 offset:3584
  v_mfma_f32_32x32x16_bf16 v[72:87], v[104:107], a[72:75], v[72:87]
  v_mfma_f32_32x32x16_bf16 v[88:103], v[104:107], a[76:79], v[88:103]
  s_waitcnt lgkmcnt(2)
  v_mfma_f32_32x32x16_bf16 v[40:55], v[108:111], a[80:83], v[40:55]
  v_mfma_f32_32x32x16_bf16 v[56:71], v[108:111], a[84:87], v[56:71]
  ds_read_b128 v[104:107], v3 offset:8192
  v_mfma_f32_32x32x16_bf16 v[72:87], v[108:111], a[88:91], v[72:87]
  v_mfma_f32_32x32x16_bf16 v[88:103], v[108:111], a[92:95], v[88:103]
  s_waitcnt lgkmcnt(2)
  v_mfma_f32_32x32x16_bf16 v[40:55], v[112:115], a[96:99], v[40:55]
  v_mfma_f32_32x32x16_bf16 v[56:71], v[112:115], a[100:103], v[56:71]
  ds_read_b128 v[108:111], v3 offset:8704
  v_mfma_f32_32x32x16_bf16 v[72:87], v[112:115], a[104:107], v[72:87]
  v_mfma_f32_32x32x16_bf16 v[88:103], v[112:115], a[108:111], v[88:103]
  s_waitcnt lgkmcnt(2)
  v_mfma_f32_32x32x16_bf16 v[40:55], v[116:119], a[112:115], v[40:55]
  v_mfma_f32_32x32x16_bf16 v[56:71], v[116:119], a[116:119], v[56:71]
  ds_read_b128 v[112:115], v3 offset:9216
  v_mfma_f32_32x32x16_bf16 v[72:87], v[116:119], a[120:123], v[72:87]
  v_mfma_f32_32x32x16_bf16 v[88:103], v[116:119], a[124:127], v[88:103]
  s_waitcnt lgkmcnt(2)
  v_mfma_f32_32x32x16_bf16 v[40:55], v[104:107], a[128:131], v[40:55]
  v_mfma_f32_32x32x16_bf16 v[56:71], v[104:107], a[132:135], v[56:71]
  ds_read_b128 v[116:119], v3 offset:9728
  v_mfma_f32_32x32x16_bf16 v[72:87], v[104:107], a[136:139], v[72:87]
  v_mfma_f32_32x32x16_bf16 v[88:103], v[104:107], a[140:143], v[88:103]
  s_waitcnt lgkmcnt(2)
  v_mfma_f32_32x32x16_bf16 v[40:55], v[108:111], a[144:147], v[40:55]
  v_mfma_f32_32x32x16_bf16 v[56:71], v[108:111], a[148:151], v[56:71]
  ds_read_b128 v[104:107], v3 offset:10240
  v_mfma_f32_32x32x16_bf16 v[72:87], v[108:111], a[152:155], v[72:87]
  v_mfma_f32_32x32x16_bf16 v[88:103], v[108:111], a[156:159], v[88:103]
  s_waitcnt lgkmcnt(2)
  v_mfma_f32_32x32x16_bf16 v[40:55], v[112:115], a[160:163], v[40:55]
  v_mfma_f32_32x32x16_bf16 v[56:71], v[112:115], a[164:167], v[56:71]
  ds_read_b128 v[108:111], v3 offset:10752
  v_mfma_f32_32x32x16_bf16 v[72:87], v[112:115], a[168:171], v[72:87]
  v_mfma_f32_32x32x16_bf16 v[88:103], v[112:115], a[172:175], v[88:103]
  s_waitcnt lgkmcnt(2)
  v_mfma_f32_32x32x16_bf16 v[40:55], v[116:119], a[176:179], v[40:55]
  v_mfma_f32_32x32x16_bf16 v[56:71], v[116:119], a[180:183], v[56:71]
  ds_read_b128 v[112:115], v3 offset:11264
  v_mfma_f32_32x32x16_bf16 v[72:87], v[116:119], a[184:187], v[72:87]
  v_mfma_f32_32x32x16_bf16 v[88:103], v[116:119], a[188:191], v[88:103]
  s_waitcnt lgkmcnt(2)
  v_mfma_f32_32x32x16_bf16 v[40:55], v[104:107], a[192:195], v[40:55]
  v_mfma_f32_32x32x16_bf16 v[56:71], v[104:107], a[196:199], v[56:71]
  ds_read_b128 v[116:119], v3 offset:11776
  s_waitcnt lgkmcnt(2)
  v_mfma_f32_32x32x16_bf16 v[40:55], v[108:111], a[208:211], v[40:55]
  v_mfma_f32_32x32x16_bf16 v[56:71], v[108:111], a[212:215], v[56:71]
  s_waitcnt lgkmcnt(1)
  v_mfma_f32_32x32x16_bf16 v[40:55], v[112:115], a[224:227], v[40:55]
  v_mfma_f32_32x32x16_bf16 v[56:71], v[112:115], a[228:231], v[56:71]
  s_waitcnt lgkmcnt(0)
  v_mfma_f32_32x32x16_bf16 v[40:55], v[116:119], a[240:243], v[40:55]
  v_mfma_f32_32x32x16_bf16 v[56:71], v[116:119], a[244:247], v[56:71]
  v_mfma_f32_32x32x16_bf16 v[72:87], v[104:107], a[200:203], v[72:87]
  v_mfma_f32_32x32x16_bf16 v[88:103], v[104:107], a[204:207], v[88:103]
  v_cvt_pk_bf16_f32 v212, v40, v56
  v_cvt_pk_bf16_f32 v214, v41, v57
  v_cvt_pk_bf16_f32 v216, v42, v58
  v_cvt_pk_bf16_f32 v218, v43, v59
  v_permlane16_swap_b32 v212, v214
  v_mfma_f32_32x32x16_bf16 v[72:87], v[108:111], a[216:219], v[72:87]
  v_cvt_pk_bf16_f32 v220, v44, v60
  v_cvt_pk_bf16_f32 v222, v45, v61
  v_permlane16_swap_b32 v216, v218
  v_bfi_b32 v212, v254, s42, v212
  v_cvt_pk_bf16_f32 v224, v46, v62
  v_mfma_f32_32x32x16_bf16 v[88:103], v[108:111], a[220:223], v[88:103]
  v_cvt_pk_bf16_f32 v226, v47, v63
  v_permlane16_swap_b32 v220, v222
  v_bfi_b32 v216, v254, s42, v216
  v_cvt_pk_bf16_f32 v228, v48, v64
  v_mfma_f32_32x32x16_bf16 v[72:87], v[112:115], a[232:235], v[72:87]
  v_cvt_pk_bf16_f32 v230, v49, v65
  v_permlane16_swap_b32 v224, v226
  v_bfi_b32 v220, v254, s42, v220
  v_cvt_pk_bf16_f32 v232, v50, v66
  v_cvt_pk_bf16_f32 v234, v51, v67
  v_mfma_f32_32x32x16_bf16 v[88:103], v[112:115], a[236:239], v[88:103]
  v_permlane16_swap_b32 v228, v230
  v_bfi_b32 v224, v254, s42, v224
  v_cvt_pk_bf16_f32 v236, v52, v68
  v_cvt_pk_bf16_f32 v238, v53, v69
  v_mfma_f32_32x32x16_bf16 v[72:87], v[116:119], a[248:251], v[72:87]
  v_permlane16_swap_b32 v232, v234
  v_bfi_b32 v228, v254, s42, v228
  v_cvt_pk_bf16_f32 v240, v54, v70
  v_cvt_pk_bf16_f32 v242, v55, v71
  v_permlane16_swap_b32 v236, v238
  v_mfma_f32_32x32x16_bf16 v[88:103], v[116:119], a[252:255], v[88:103]
  v_bfi_b32 v232, v254, s42, v232
  v_permlane16_swap_b32 v240, v242
  v_bfi_b32 v236, v254, s42, v236
  v_bfi_b32 v240, v254, s42, v240
  s_nop 7
  v_cvt_pk_bf16_f32 v213, v72, v88
  v_cvt_pk_bf16_f32 v215, v73, v89
  v_cvt_pk_bf16_f32 v217, v74, v90
  v_cvt_pk_bf16_f32 v219, v75, v91
  s_add_u32 s78, s86, 0
  v_permlane16_swap_b32 v213, v215
  buffer_store_dwordx4 v[212:215], v4, s[4:7], s78 offen
  v_cvt_pk_bf16_f32 v221, v76, v92
  v_cvt_pk_bf16_f32 v223, v77, v93
  s_add_u32 s78, s86, 32768
  v_permlane16_swap_b32 v217, v219
  buffer_store_dwordx4 v[216:219], v4, s[4:7], s78 offen
  v_cvt_pk_bf16_f32 v225, v78, v94
  v_cvt_pk_bf16_f32 v227, v79, v95
  s_add_u32 s78, s86, 131072
  v_permlane16_swap_b32 v221, v223
  buffer_store_dwordx4 v[220:223], v4, s[4:7], s78 offen
  v_cvt_pk_bf16_f32 v229, v80, v96
  v_cvt_pk_bf16_f32 v231, v81, v97
  s_add_u32 s78, s86, 163840
  v_permlane16_swap_b32 v225, v227
  buffer_store_dwordx4 v[224:227], v4, s[4:7], s78 offen
  v_cvt_pk_bf16_f32 v233, v82, v98
  v_cvt_pk_bf16_f32 v235, v83, v99
  s_add_u32 s78, s86, 262144
  v_permlane16_swap_b32 v229, v231
  buffer_store_dwordx4 v[228:231], v4, s[4:7], s78 offen
  v_cvt_pk_bf16_f32 v237, v84, v100
  v_cvt_pk_bf16_f32 v239, v85, v101
  s_add_u32 s78, s86, 294912
  v_permlane16_swap_b32 v233, v235
  buffer_store_dwordx4 v[232:235], v4, s[4:7], s78 offen
  v_cvt_pk_bf16_f32 v241, v86, v102
  v_cvt_pk_bf16_f32 v243, v87, v103
  s_add_u32 s78, s86, 393216
  v_permlane16_swap_b32 v237, v239
  buffer_store_dwordx4 v[236:239], v4, s[4:7], s78 offen
  s_add_u32 s78, s86, 425984
  v_permlane16_swap_b32 v241, v243
  buffer_store_dwordx4 v[240:243], v4, s[4:7], s78 offen
  s_branch o_we_114
o_wr1_112:
  s_nop 3
  v_mul_f32 v112, s24, v112
  v_mul_f32 v113, s24, v113
  v_exp_f32 v64, v112
  v_exp_f32 v65, v113
  v_max_f32 v116, v111, v116
  v_max3_f32 v116, v112, v113, v116
  v_add_f32 v117, v117, v64
  v_add_f32 v118, v118, v65
  v_add_f32 v117, v117, v118
  s_mov_b32 s28, 0x21800000
  v_mov_b32 v118, v117
  s_nop 1
  v_permlane16_swap_b32 v117, v118
  v_add_f32 v117, v117, v118
  v_mov_b32 v118, v117
  s_nop 0
  s_nop 0
  v_permlane32_swap_b32 v117, v118
  v_add_f32 v117, v117, v118
  s_mov_b32 s67, 0
  s_mov_b64 vcc, 0
  s_waitcnt vmcnt(3)
o_pl_120:
  v_and_b32 v7, 1, v7
  v_cmp_ne_u32 vcc, s96, v7
  s_cbranch_vccz o_pk_121
  buffer_load_dword v7, v255, s[4:7], s97 offen sc1
  s_add_u32 s67, s67, 1
  s_cmp_gt_u32 s67, 1048576
  s_cbranch_scc1 L_end
  s_waitcnt vmcnt(0)
  s_branch o_pl_120
o_pk_121:
  s_lshl_b32 s94, s43, 14
  s_add_u32 s94, s94, s95
  buffer_load_dwordx4 v[120:123], v5, s[4:7], s94 offen offset:0 sc1
  v_cmp_lt_f32 vcc, 0x42700000, v116
  v_cmp_gt_f32 s[30:31], s28, v117
  v_rcp_f32 v117, v117
  buffer_load_dwordx4 v[124:127], v5, s[4:7], s94 offen offset:512 sc1
  s_or_b64 vcc, vcc, s[30:31]
  s_cbranch_vccnz o_fb_118
o_fbr_119:
  buffer_load_dwordx4 v[128:131], v5, s[4:7], s94 offen offset:256 sc1
  v_pk_mul_f32 v[56:57], v[56:57], v[116:117] op_sel:[0,1] op_sel_hi:[1,1]
  v_pk_mul_f32 v[58:59], v[58:59], v[116:117] op_sel:[0,1] op_sel_hi:[1,1]
  v_pk_mul_f32 v[60:61], v[60:61], v[116:117] op_sel:[0,1] op_sel_hi:[1,1]
  v_pk_mul_f32 v[62:63], v[62:63], v[116:117] op_sel:[0,1] op_sel_hi:[1,1]
  v_pk_mul_f32 v[64:65], v[64:65], v[116:117] op_sel:[0,1] op_sel_hi:[1,1]
  buffer_load_dwordx4 v[132:135], v5, s[4:7], s94 offen offset:768 sc1
  v_cvt_pk_bf16_f32 v116, v56, v57
  v_cvt_pk_bf16_f32 v117, v58, v59
  v_cvt_pk_bf16_f32 v118, v60, v61
  v_cvt_pk_bf16_f32 v119, v62, v63
  s_waitcnt lgkmcnt(0)
  s_nop 0
  v_mfma_f32_16x16x32_bf16 v[72:75], v[152:155], v[116:119], 0
  s_add_u32 s62, s62, 1
  v_cvt_pk_bf16_f32 v197, v64, v65
  v_cvt_pk_bf16_f32 v198, v64, v65
  v_mfma_f32_16x16x32_bf16 v[76:79], v[156:159], v[116:119], 0
  s_add_u32 s94, s94, 4096
  buffer_load_dwordx4 v[136:139], v5, s[4:7], s94 offen offset:0 sc1
  s_xor_b32 s86, s86, 524288
  v_mfma_f32_16x16x32_bf16 v[80:83], v[160:163], v[116:119], 0
  s_bfe_u32 s42, s62, 0x10001
  v_mfma_f32_16x16x32_bf16 v[84:87], v[164:167], v[116:119], 0
  buffer_load_dwordx4 v[140:143], v5, s[4:7], s94 offen offset:512 sc1
  v_mfma_f32_16x16x32_bf16 v[88:91], v[168:171], v[116:119], 0
  v_mfma_f32_16x16x32_bf16 v[92:95], v[172:175], v[116:119], 0
  buffer_load_dwordx4 v[144:147], v5, s[4:7], s94 offen offset:256 sc1
  v_mfma_f32_16x16x32_bf16 v[96:99], v[176:179], v[116:119], 0
  v_mfma_f32_16x16x32_bf16 v[100:103], v[180:183], v[116:119], 0
  buffer_load_dwordx4 v[148:151], v5, s[4:7], s94 offen offset:768 sc1
  v_mfma_f32_16x16x16_bf16 v[72:75], v[200:201], v[198:199], v[72:75]
  s_nop 1
  v_mfma_f32_16x16x16_bf16 v[76:79], v[200:201], v[196:197], v[76:79]
  s_add_u32 s94, s94, 4096
  buffer_load_dwordx4 v[152:155], v5, s[4:7], s94 offen offset:0 sc1
  v_mfma_f32_16x16x16_bf16 v[80:83], v[202:203], v[198:199], v[80:83]
  s_nop 1
  v_mfma_f32_16x16x16_bf16 v[84:87], v[202:203], v[196:197], v[84:87]
  buffer_load_dwordx4 v[156:159], v5, s[4:7], s94 offen offset:512 sc1
  v_mfma_f32_16x16x16_bf16 v[88:91], v[204:205], v[198:199], v[88:91]
  s_nop 0
  v_cvt_pk_bf16_f32 v40, v72, v73
  v_cvt_pk_bf16_f32 v41, v74, v75
  v_mfma_f32_16x16x16_bf16 v[92:95], v[204:205], v[196:197], v[92:95]
  buffer_load_dwordx4 v[160:163], v5, s[4:7], s94 offen offset:256 sc1
  v_cvt_pk_bf16_f32 v42, v76, v77
  v_cvt_pk_bf16_f32 v43, v78, v79
  v_mfma_f32_16x16x16_bf16 v[96:99], v[206:207], v[198:199], v[96:99]
  s_nop 0
  ds_write_b128 v6, v[40:43] offset:0
  v_cvt_pk_bf16_f32 v44, v80, v81
  v_mfma_f32_16x16x16_bf16 v[100:103], v[206:207], v[196:197], v[100:103]
  buffer_load_dwordx4 v[164:167], v5, s[4:7], s94 offen offset:768 sc1
  v_cvt_pk_bf16_f32 v45, v82, v83
  v_cvt_pk_bf16_f32 v46, v84, v85
  v_cvt_pk_bf16_f32 v47, v86, v87
  ds_write_b128 v6, v[44:47] offset:1024
  v_cvt_pk_bf16_f32 v48, v88, v89
  v_cvt_pk_bf16_f32 v49, v90, v91
  v_cvt_pk_bf16_f32 v50, v92, v93
  v_cvt_pk_bf16_f32 v51, v94, v95
  s_add_u32 s94, s94, 4096
  buffer_load_dwordx4 v[168:171], v5, s[4:7], s94 offen offset:0 sc1
  ds_write_b128 v6, v[48:51] offset:2048
  v_cvt_pk_bf16_f32 v52, v96, v97
  v_cvt_pk_bf16_f32 v53, v98, v99
  v_cvt_pk_bf16_f32 v54, v100, v101
  v_cvt_pk_bf16_f32 v55, v102, v103
  ds_write_b128 v6, v[52:55] offset:3072
  buffer_load_dwordx4 v[172:175], v5, s[4:7], s94 offen offset:512 sc1
  s_and_b32 s26, s65, 49152
  s_cbranch_scc1 o_wr2_113
  s_waitcnt lgkmcnt(0)
  s_barrier
  ds_read_b128 v[104:107], v3 offset:0
  ds_read_b128 v[108:111], v3 offset:512
  ds_read_b128 v[112:115], v3 offset:1024
  buffer_load_dwordx4 v[176:179], v5, s[4:7], s94 offen offset:256 sc1
  buffer_load_dwordx4 v[180:183], v5, s[4:7], s94 offen offset:768 sc1
  s_waitcnt lgkmcnt(2)
  v_mfma_f32_32x32x16_bf16 v[40:55], v[104:107], a[0:3], 0
  v_mov_b64 v[188:189], 0
  v_mov_b64 v[190:191], 0
  v_mov_b64 v[192:193], 0
  v_mov_b64 v[194:195], 0
  s_mov_b64 exec, 1
  buffer_store_dword v38, off, s[4:7], s84 sc1
  s_mov_b64 exec, -1
  s_mov_b32 s84, 268435456
  v_mfma_f32_32x32x16_bf16 v[56:71], v[104:107], a[4:7], 0
  ds_read_b128 v[116:119], v3 offset:1536
  v_mfma_f32_32x32x16_bf16 v[72:87], v[104:107], a[8:11], 0
  v_mfma_f32_32x32x16_bf16 v[88:103], v[104:107], a[12:15], 0
  s_waitcnt vmcnt(13)
  v_xor_b32 v7, s96, v120
  v_bitop3_b32 v7, v7, v124, s96 bitop3:0xf6
  v_bitop3_b32 v7, v7, v128, s96 bitop3:0xf6
  v_bitop3_b32 v7, v7, v132, s96 bitop3:0xf6
  s_waitcnt lgkmcnt(2)
  v_mfma_f32_32x32x16_bf16 v[40:55], v[108:111], a[16:19], v[40:55]
  s_waitcnt vmcnt(9)
  v_bitop3_b32 v7, v7, v136, s96 bitop3:0xf6
  v_bitop3_b32 v7, v7, v140, s96 bitop3:0xf6
  v_bitop3_b32 v7, v7, v144, s96 bitop3:0xf6
  v_bitop3_b32 v7, v7, v148, s96 bitop3:0xf6
  s_waitcnt vmcnt(5)
  v_mfma_f32_32x32x16_bf16 v[56:71], v[108:111], a[20:23], v[56:71]
  ds_read_b128 v[104:107], v3 offset:2048
  v_bitop3_b32 v7, v7, v152, s96 bitop3:0xf6
  v_bitop3_b32 v7, v7, v156, s96 bitop3:0xf6
  v_bitop3_b32 v7, v7, v160, s96 bitop3:0xf6
  v_bitop3_b32 v7, v7, v164, s96 bitop3:0xf6
  s_waitcnt vmcnt(1)
  v_mfma_f32_32x32x16_bf16 v[72:87], v[108:111], a[24:27], v[72:87]
  v_bitop3_b32 v7, v7, v168, s96 bitop3:0xf6
  v_bitop3_b32 v7, v7, v172, s96 bitop3:0xf6
  v_bitop3_b32 v7, v7, v176, s96 bitop3:0xf6
  v_bitop3_b32 v7, v7, v180, s96 bitop3:0xf6
  v_and_b32 v7, v254, v7
  v_cmp_ne_u32 vcc, 0, v7
  s_cbranch_vccnz o_rt_122
o_bk_123:
  v_mfma_f32_32x32x16_bf16 v[88:103], v[108:111], a[28:31], v[88:103]
  v_smfmac_f32_16x16x64_bf16 v[188:191], v[16:19], v[120:127], v20
  v_lshlrev_b32 v196, 16, v184
  v_smfmac_f32_16x16x64_bf16 v[192:195], v[16:19], v[128:135], v20
  v_and_b32 v197, 0xffff0000, v184
  v_smfmac_f32_16x16x64_bf16 v[188:191], v[16:19], v[136:143], v20
  v_lshlrev_b32 v198, 16, v185
  s_waitcnt lgkmcnt(2)
  v_mfma_f32_32x32x16_bf16 v[40:55], v[112:115], a[32:35], v[40:55]
  v_smfmac_f32_16x16x64_bf16 v[192:195], v[16:19], v[144:151], v20
  v_and_b32 v199, 0xffff0000, v185
  v_smfmac_f32_16x16x64_bf16 v[188:191], v[16:19], v[152:159], v20
  v_lshlrev_b32 v200, 16, v186
  v_smfmac_f32_16x16x64_bf16 v[192:195], v[16:19], v[160:167], v20
  v_and_b32 v201, 0xffff0000, v186
  v_mfma_f32_32x32x16_bf16 v[56:71], v[112:115], a[36:39], v[56:71]
  ds_read_b128 v[108:111], v3 offset:2560
  v_smfmac_f32_16x16x64_bf16 v[188:191], v[16:19], v[168:175], v20
  v_lshlrev_b32 v202, 16, v187
  v_smfmac_f32_16x16x64_bf16 v[192:195], v[16:19], v[176:183], v20
  v_and_b32 v203, 0xffff0000, v187
  s_bfe_u32 s92, s65, 131086
  v_mfma_f32_32x32x16_bf16 v[72:87], v[112:115], a[40:43], v[72:87]
  s_lshl_b32 s92, s92, 21
  s_add_u32 s92, s92, s91
  s_add_u32 s93, s92, 27262976
  s_add_u32 s92, s92, 20971520
  v_permlane16_swap_b32 v188, v192
  v_mfma_f32_32x32x16_bf16 v[88:103], v[112:115], a[44:47], v[88:103]
  v_permlane16_swap_b32 v189, v193
  v_permlane16_swap_b32 v190, v194
  v_permlane16_swap_b32 v191, v195
  s_waitcnt lgkmcnt(2)
  v_mfma_f32_32x32x16_bf16 v[40:55], v[116:119], a[48:51], v[40:55]
  v_cvt_pk_bf16_f32 v188, 0, v188
  v_cvt_pk_bf16_f32 v189, 0, v189
  v_cvt_pk_bf16_f32 v190, 0, v190
  v_cvt_pk_bf16_f32 v191, 0, v191
  v_cvt_pk_bf16_f32 v192, 0, v192
  v_cvt_pk_bf16_f32 v193, 0, v193
  v_mfma_f32_32x32x16_bf16 v[56:71], v[116:119], a[52:55], v[56:71]
  ds_read_b128 v[112:115], v3 offset:3072
  v_cvt_pk_bf16_f32 v194, 0, v194
  v_cvt_pk_bf16_f32 v195, 0, v195
  v_add_f32 v196, v196, v188
  v_add_f32 v197, v197, v189
  v_add_f32 v198, v198, v190
  v_mfma_f32_32x32x16_bf16 v[72:87], v[116:119], a[56:59], v[72:87]
  v_add_f32 v199, v199, v191
  v_add_f32 v200, v200, v192
  v_add_f32 v201, v201, v193
  v_add_f32 v202, v202, v194
  v_add_f32 v203, v203, v195
  v_cvt_pk_bf16_f32 v120, v196, v197
  v_mfma_f32_32x32x16_bf16 v[88:103], v[116:119], a[60:63], v[88:103]
  v_cvt_pk_bf16_f32 v121, v198, v199
  v_cvt_pk_bf16_f32 v122, v200, v201
  v_cvt_pk_bf16_f32 v123, v202, v203
  v_lshlrev_b32 v196, 16, v120
  v_and_b32 v197, 0xffff0000, v120
  s_waitcnt lgkmcnt(2)
  v_mfma_f32_32x32x16_bf16 v[40:55], v[104:107], a[64:67], v[40:55]
  v_lshlrev_b32 v198, 16, v121
  v_and_b32 v199, 0xffff0000, v121
  v_lshlrev_b32 v200, 16, v122
  v_and_b32 v201, 0xffff0000, v122
  v_lshlrev_b32 v202, 16, v123
  v_and_b32 v203, 0xffff0000, v123
  v_mfma_f32_32x32x16_bf16 v[56:71], v[104:107], a[68:71], v[56:71]
  ds_read_b128 v[116:119], v3 offset:3584
  buffer_store_dwordx4 v[120:123], v0, s[4:7], s92 offen sc1
  v_add_f32 v136, v196, v197
  v_mul_f32 v137, v196, v196
  v_mfma_f32_32x32x16_bf16 v[72:87], v[104:107], a[72:75], v[72:87]
  v_add_f32 v138, v198, v199
  v_mul_f32 v139, v197, v197
  v_fmac_f32 v137, v198, v198
  v_fmac_f32 v139, v199, v199
  v_add_f32 v136, v136, v200
  v_fmac_f32 v137, v200, v200
  v_mfma_f32_32x32x16_bf16 v[88:103], v[104:107], a[76:79], v[88:103]
  v_add_f32 v138, v138, v201
  v_fmac_f32 v139, v201, v201
  v_add_f32 v136, v136, v202
  v_fmac_f32 v137, v202, v202
  v_add_f32 v138, v138, v203
  s_waitcnt lgkmcnt(2)
  v_mfma_f32_32x32x16_bf16 v[40:55], v[108:111], a[80:83], v[40:55]
  v_fmac_f32 v139, v203, v203
  v_add_f32 v136, v136, v138
  v_add_f32 v137, v137, v139
  s_nop 0
  v_add_f32_dpp v136, v136, v136 row_ror:8 row_mask:0xf bank_mask:0xf
  v_add_f32_dpp v137, v137, v137 row_ror:8 row_mask:0xf bank_mask:0xf
  s_nop 0
  v_add_f32_dpp v136, v136, v136 row_ror:4 row_mask:0xf bank_mask:0xf
  v_mfma_f32_32x32x16_bf16 v[56:71], v[108:111], a[84:87], v[56:71]
  ds_read_b128 v[104:107], v3 offset:8192
  v_add_f32_dpp v137, v137, v137 row_ror:4 row_mask:0xf bank_mask:0xf
  v_add_f32_dpp v136, v136, v136 row_ror:2 row_mask:0xf bank_mask:0xf
  s_nop 0
  v_add_f32_dpp v137, v137, v137 row_ror:2 row_mask:0xf bank_mask:0xf
  v_add_f32_dpp v136, v136, v136 row_ror:1 row_mask:0xf bank_mask:0xf
  s_nop 0
  v_add_f32_dpp v137, v137, v137 row_ror:1 row_mask:0xf bank_mask:0xf
  v_mfma_f32_32x32x16_bf16 v[72:87], v[108:111], a[88:91], v[72:87]
  v_mov_b32 v140, v136
  v_mov_b32 v141, v137
  s_nop 0
  v_permlane16_swap_b32 v136, v140
  v_permlane16_swap_b32 v137, v141
  v_mfma_f32_32x32x16_bf16 v[88:103], v[108:111], a[92:95], v[88:103]
  v_add_f32 v136, v136, v140
  v_add_f32 v137, v137, v141
  v_mov_b32 v140, v136
  v_mov_b32 v141, v137
  s_nop 0
  v_permlane32_swap_b32 v136, v140
  s_waitcnt lgkmcnt(2)
  v_mfma_f32_32x32x16_bf16 v[40:55], v[112:115], a[96:99], v[40:55]
  v_permlane32_swap_b32 v137, v141
  v_add_f32 v136, v136, v140
  v_add_f32 v137, v137, v141
  v_mul_f32 v136, 0x3b000000, v136
  v_mul_f32 v137, 0x3b000000, v137
  v_mfma_f32_32x32x16_bf16 v[56:71], v[112:115], a[100:103], v[56:71]
  ds_read_b128 v[108:111], v3 offset:8704
  v_fma_f32 v137, -v136, v136, v137
  v_cvt_pk_bf16_f32 v136, 0, v136
  v_max_f32 v137, 0, v137
  v_sub_f32 v140, v196, v136
  v_sub_f32 v141, v197, v136
  v_mfma_f32_32x32x16_bf16 v[72:87], v[112:115], a[104:107], v[72:87]
  v_cvt_pk_bf16_f32 v137, 0, v137
  v_sub_f32 v142, v198, v136
  v_sub_f32 v143, v199, v136
  v_add_f32 v137, 0x3727c5ac, v137
  v_sub_f32 v144, v200, v136
  v_sub_f32 v145, v201, v136
  v_mfma_f32_32x32x16_bf16 v[88:103], v[112:115], a[108:111], v[88:103]
  v_cvt_pk_bf16_f32 v137, 0, v137
  v_sub_f32 v146, v202, v136
  v_sub_f32 v147, v203, v136
  v_sqrt_f32 v137, v137
  s_waitcnt lgkmcnt(2)
  v_mfma_f32_32x32x16_bf16 v[40:55], v[116:119], a[112:115], v[40:55]
  v_cvt_pk_bf16_f32 v140, 0, v140
  v_cvt_pk_bf16_f32 v141, 0, v141
  v_cvt_pk_bf16_f32 v137, 0, v137
  v_cvt_pk_bf16_f32 v142, 0, v142
  v_cvt_pk_bf16_f32 v143, 0, v143
  v_rcp_f32 v137, v137
  v_mfma_f32_32x32x16_bf16 v[56:71], v[116:119], a[116:119], v[56:71]
  ds_read_b128 v[112:115], v3 offset:9216
  v_cvt_pk_bf16_f32 v144, 0, v144
  v_cvt_pk_bf16_f32 v145, 0, v145
  v_cvt_pk_bf16_f32 v146, 0, v146
  v_cvt_pk_bf16_f32 v147, 0, v147
  v_mul_f32 v140, v140, v137
  v_mfma_f32_32x32x16_bf16 v[72:87], v[116:119], a[120:123], v[72:87]
  v_mul_f32 v141, v141, v137
  v_mul_f32 v142, v142, v137
  v_mul_f32 v143, v143, v137
  v_mul_f32 v144, v144, v137
  v_mul_f32 v145, v145, v137
  v_mul_f32 v146, v146, v137
  v_mfma_f32_32x32x16_bf16 v[88:103], v[116:119], a[124:127], v[88:103]
  v_mul_f32 v147, v147, v137
  v_cvt_pk_bf16_f32 v124, v140, v141
  v_cvt_pk_bf16_f32 v125, v142, v143
  v_cvt_pk_bf16_f32 v126, v144, v145
  v_cvt_pk_bf16_f32 v127, v146, v147
  s_waitcnt lgkmcnt(2)
  v_mfma_f32_32x32x16_bf16 v[40:55], v[104:107], a[128:131], v[40:55]
  v_lshlrev_b32 v204, 16, v124
  v_and_b32 v205, 0xffff0000, v124
  v_lshlrev_b32 v206, 16, v125
  v_and_b32 v207, 0xffff0000, v125
  v_lshlrev_b32 v208, 16, v126
  v_and_b32 v209, 0xffff0000, v126
  v_mfma_f32_32x32x16_bf16 v[56:71], v[104:107], a[132:135], v[56:71]
  ds_read_b128 v[116:119], v3 offset:9728
  v_lshlrev_b32 v210, 16, v127
  v_and_b32 v211, 0xffff0000, v127
  buffer_store_dwordx4 v[124:127], v0, s[4:7], s93 offen sc1
  v_mfma_f32_32x32x16_bf16 v[72:87], v[104:107], a[136:139], v[72:87]
  v_add_f32 v196, v196, v204
  v_add_f32 v197, v197, v205
  v_add_f32 v198, v198, v206
  v_add_f32 v199, v199, v207
  v_add_f32 v200, v200, v208
  v_add_f32 v201, v201, v209
  v_mfma_f32_32x32x16_bf16 v[88:103], v[104:107], a[140:143], v[88:103]
  v_add_f32 v202, v202, v210
  v_add_f32 v203, v203, v211
  v_cvt_pk_bf16_f32 v128, v196, v197
  v_cvt_pk_bf16_f32 v129, v198, v199
  v_cvt_pk_bf16_f32 v130, v200, v201
  s_waitcnt lgkmcnt(2)
  v_mfma_f32_32x32x16_bf16 v[40:55], v[108:111], a[144:147], v[40:55]
  v_cvt_pk_bf16_f32 v131, v202, v203
  v_mul_f32 v188, v204, v8
  v_mul_f32 v189, v205, v9
  v_fmac_f32 v188, v206, v10
  v_fmac_f32 v189, v207, v11
  v_fmac_f32 v188, v208, v12
  v_mfma_f32_32x32x16_bf16 v[56:71], v[108:111], a[148:151], v[56:71]
  ds_read_b128 v[104:107], v3 offset:10240
  v_fmac_f32 v189, v209, v13
  v_fmac_f32 v188, v210, v14
  v_fmac_f32 v189, v211, v15
  v_add_f32 v188, v188, v189
  s_add_u32 s92, s91, 10485760
  v_mfma_f32_32x32x16_bf16 v[72:87], v[108:111], a[152:155], v[72:87]
  s_add_u32 s93, s91, 8388608
  buffer_store_dwordx4 v[128:131], v0, s[4:7], s92 offen sc1
  v_lshlrev_b32 v196, 16, v128
  v_and_b32 v197, 0xffff0000, v128
  v_mfma_f32_32x32x16_bf16 v[88:103], v[108:111], a[156:159], v[88:103]
  v_lshlrev_b32 v198, 16, v129
  v_and_b32 v199, 0xffff0000, v129
  v_lshlrev_b32 v200, 16, v130
  v_and_b32 v201, 0xffff0000, v130
  v_lshlrev_b32 v202, 16, v131
  s_waitcnt lgkmcnt(2)
  v_mfma_f32_32x32x16_bf16 v[40:55], v[112:115], a[160:163], v[40:55]
  v_and_b32 v203, 0xffff0000, v131
  v_add_f32 v136, v196, v197
  v_mul_f32 v137, v196, v196
  v_add_f32 v138, v198, v199
  v_mul_f32 v139, v197, v197
  v_fmac_f32 v137, v198, v198
  v_mfma_f32_32x32x16_bf16 v[56:71], v[112:115], a[164:167], v[56:71]
  ds_read_b128 v[108:111], v3 offset:10752
  v_fmac_f32 v139, v199, v199
  v_add_f32 v136, v136, v200
  v_fmac_f32 v137, v200, v200
  v_add_f32 v138, v138, v201
  v_fmac_f32 v139, v201, v201
  v_mfma_f32_32x32x16_bf16 v[72:87], v[112:115], a[168:171], v[72:87]
  v_add_f32 v136, v136, v202
  v_fmac_f32 v137, v202, v202
  v_add_f32 v138, v138, v203
  v_fmac_f32 v139, v203, v203
  v_add_f32 v136, v136, v138
  v_add_f32 v137, v137, v139
  v_mfma_f32_32x32x16_bf16 v[88:103], v[112:115], a[172:175], v[88:103]
  v_add_f32_dpp v136, v136, v136 row_ror:8 row_mask:0xf bank_mask:0xf
  v_add_f32_dpp v137, v137, v137 row_ror:8 row_mask:0xf bank_mask:0xf
  v_add_f32_dpp v188, v188, v188 row_ror:8 row_mask:0xf bank_mask:0xf
  v_add_f32_dpp v136, v136, v136 row_ror:4 row_mask:0xf bank_mask:0xf
  v_add_f32_dpp v137, v137, v137 row_ror:4 row_mask:0xf bank_mask:0xf
  s_waitcnt lgkmcnt(2)
  v_mfma_f32_32x32x16_bf16 v[40:55], v[116:119], a[176:179], v[40:55]
  v_add_f32_dpp v188, v188, v188 row_ror:4 row_mask:0xf bank_mask:0xf
  v_add_f32_dpp v136, v136, v136 row_ror:2 row_mask:0xf bank_mask:0xf
  v_add_f32_dpp v137, v137, v137 row_ror:2 row_mask:0xf bank_mask:0xf
  v_add_f32_dpp v188, v188, v188 row_ror:2 row_mask:0xf bank_mask:0xf
  v_add_f32_dpp v136, v136, v136 row_ror:1 row_mask:0xf bank_mask:0xf
  v_add_f32_dpp v137, v137, v137 row_ror:1 row_mask:0xf bank_mask:0xf
  v_mfma_f32_32x32x16_bf16 v[56:71], v[116:119], a[180:183], v[56:71]
  ds_read_b128 v[112:115], v3 offset:11264
  v_add_f32_dpp v188, v188, v188 row_ror:1 row_mask:0xf bank_mask:0xf
  v_mov_b32 v140, v136
  v_mov_b32 v141, v137
  v_mov_b32 v142, v188
  v_permlane16_swap_b32 v136, v140
  v_mfma_f32_32x32x16_bf16 v[72:87], v[116:119], a[184:187], v[72:87]
  v_permlane16_swap_b32 v137, v141
  v_permlane16_swap_b32 v188, v142
  v_add_f32 v136, v136, v140
  v_add_f32 v137, v137, v141
  v_mfma_f32_32x32x16_bf16 v[88:103], v[116:119], a[188:191], v[88:103]
  v_add_f32 v188, v188, v142
  v_mov_b32 v140, v136
  v_mov_b32 v141, v137
  v_mov_b32 v142, v188
  v_permlane32_swap_b32 v136, v140
  s_waitcnt lgkmcnt(2)
  v_mfma_f32_32x32x16_bf16 v[40:55], v[104:107], a[192:195], v[40:55]
  v_permlane32_swap_b32 v137, v141
  v_permlane32_swap_b32 v188, v142
  v_add_f32 v136, v136, v140
  v_add_f32 v137, v137, v141
  v_mfma_f32_32x32x16_bf16 v[56:71], v[104:107], a[196:199], v[56:71]
  ds_read_b128 v[116:119], v3 offset:11776
  v_add_f32 v188, v188, v142
  v_mul_f32 v136, 0x3b000000, v136
  v_mul_f32 v137, 0x3b000000, v137
  v_fma_f32 v137, -v136, v136, v137
  v_cvt_pk_bf16_f32 v136, 0, v136
  s_waitcnt lgkmcnt(2)
  v_mfma_f32_32x32x16_bf16 v[40:55], v[108:111], a[208:211], v[40:55]
  v_max_f32 v137, 0, v137
  v_sub_f32 v140, v196, v136
  v_sub_f32 v141, v197, v136
  v_cvt_pk_bf16_f32 v137, 0, v137
  v_sub_f32 v142, v198, v136
  v_sub_f32 v143, v199, v136
  v_mfma_f32_32x32x16_bf16 v[56:71], v[108:111], a[212:215], v[56:71]
  v_add_f32 v137, 0x3727c5ac, v137
  v_sub_f32 v144, v200, v136
  v_sub_f32 v145, v201, v136
  v_cvt_pk_bf16_f32 v137, 0, v137
  v_sub_f32 v146, v202, v136
  v_sub_f32 v147, v203, v136
  s_waitcnt lgkmcnt(1)
  v_mfma_f32_32x32x16_bf16 v[40:55], v[112:115], a[224:227], v[40:55]
  v_sqrt_f32 v137, v137
  v_cvt_pk_bf16_f32 v140, 0, v140
  v_cvt_pk_bf16_f32 v141, 0, v141
  v_cvt_pk_bf16_f32 v137, 0, v137
  v_cvt_pk_bf16_f32 v142, 0, v142
  v_mfma_f32_32x32x16_bf16 v[56:71], v[112:115], a[228:231], v[56:71]
  v_cvt_pk_bf16_f32 v143, 0, v143
  v_rcp_f32 v137, v137
  v_cvt_pk_bf16_f32 v144, 0, v144
  v_cvt_pk_bf16_f32 v145, 0, v145
  v_cvt_pk_bf16_f32 v146, 0, v146
  s_waitcnt lgkmcnt(0)
  v_mfma_f32_32x32x16_bf16 v[40:55], v[116:119], a[240:243], v[40:55]
  v_cvt_pk_bf16_f32 v147, 0, v147
  v_mul_f32 v140, v140, v137
  v_mul_f32 v141, v141, v137
  v_mul_f32 v142, v142, v137
  v_mul_f32 v143, v143, v137
  v_mul_f32 v144, v144, v137
  v_mfma_f32_32x32x16_bf16 v[56:71], v[116:119], a[244:247], v[56:71]
  v_mul_f32 v145, v145, v137
  v_mul_f32 v146, v146, v137
  v_mul_f32 v147, v147, v137
  v_cvt_pk_bf16_f32 v132, v140, v141
  v_cvt_pk_bf16_f32 v133, v142, v143
  v_cvt_pk_bf16_f32 v134, v144, v145
  v_mfma_f32_32x32x16_bf16 v[72:87], v[104:107], a[200:203], v[72:87]
  v_cvt_pk_bf16_f32 v135, v146, v147
  buffer_store_dwordx4 v[132:135], v0, s[4:7], s93 offen sc1
  v_cvt_pk_bf16_f32 v188, 0, v188
  v_ashrrev_i32 v189, 31, v188
  v_mfma_f32_32x32x16_bf16 v[88:103], v[104:107], a[204:207], v[88:103]
  v_or_b32 v189, 0x80000000, v189
  v_xor_b32 v188, v188, v189
  s_sub_u32 s92, 4095, s90
  v_and_b32 v188, 0xffff0000, v188
  v_or_b32 v38, s92, v188
  v_mfma_f32_32x32x16_bf16 v[72:87], v[108:111], a[216:219], v[72:87]
  s_bfe_u32 s92, s65, 196625
  s_lshl_b32 s92, s92, 18
  s_lshl_b32 s93, s90, 7
  s_add_u32 s92, s92, s93
  s_add_u32 s84, s92, 243269632
  v_cvt_pk_bf16_f32 v212, v40, v56
  v_mfma_f32_32x32x16_bf16 v[88:103], v[108:111], a[220:223], v[88:103]
  v_cvt_pk_bf16_f32 v214, v41, v57
  v_cvt_pk_bf16_f32 v216, v42, v58
  v_cvt_pk_bf16_f32 v218, v43, v59
  v_permlane16_swap_b32 v212, v214
  v_mfma_f32_32x32x16_bf16 v[72:87], v[112:115], a[232:235], v[72:87]
  v_cvt_pk_bf16_f32 v220, v44, v60
  v_cvt_pk_bf16_f32 v222, v45, v61
  v_permlane16_swap_b32 v216, v218
  v_bfi_b32 v212, v254, s42, v212
  v_cvt_pk_bf16_f32 v224, v46, v62
  v_mfma_f32_32x32x16_bf16 v[88:103], v[112:115], a[236:239], v[88:103]
  v_cvt_pk_bf16_f32 v226, v47, v63
  v_permlane16_swap_b32 v220, v222
  v_bfi_b32 v216, v254, s42, v216
  v_cvt_pk_bf16_f32 v228, v48, v64
  v_mfma_f32_32x32x16_bf16 v[72:87], v[116:119], a[248:251], v[72:87]
  v_cvt_pk_bf16_f32 v230, v49, v65
  v_permlane16_swap_b32 v224, v226
  v_bfi_b32 v220, v254, s42, v220
  v_cvt_pk_bf16_f32 v232, v50, v66
  v_cvt_pk_bf16_f32 v234, v51, v67
  v_mfma_f32_32x32x16_bf16 v[88:103], v[116:119], a[252:255], v[88:103]
  v_permlane16_swap_b32 v228, v230
  v_bfi_b32 v224, v254, s42, v224
  v_cvt_pk_bf16_f32 v236, v52, v68
  v_cvt_pk_bf16_f32 v238, v53, v69
  v_permlane16_swap_b32 v232, v234
  v_bfi_b32 v228, v254, s42, v228
  v_cvt_pk_bf16_f32 v240, v54, v70
  v_cvt_pk_bf16_f32 v242, v55, v71
  v_permlane16_swap_b32 v236, v238
  v_bfi_b32 v232, v254, s42, v232
  v_permlane16_swap_b32 v240, v242
  v_bfi_b32 v236, v254, s42, v236
  v_bfi_b32 v240, v254, s42, v240
  v_cvt_pk_bf16_f32 v213, v72, v88
  v_cvt_pk_bf16_f32 v215, v73, v89
  v_cvt_pk_bf16_f32 v217, v74, v90
  v_cvt_pk_bf16_f32 v219, v75, v91
  s_add_u32 s78, s86, 0
  v_permlane16_swap_b32 v213, v215
  buffer_store_dwordx4 v[212:215], v4, s[4:7], s78 offen
  v_cvt_pk_bf16_f32 v221, v76, v92
  v_cvt_pk_bf16_f32 v223, v77, v93
  s_add_u32 s78, s86, 32768
  v_permlane16_swap_b32 v217, v219
  buffer_store_dwordx4 v[216:219], v4, s[4:7], s78 offen
  v_cvt_pk_bf16_f32 v225, v78, v94
  v_cvt_pk_bf16_f32 v227, v79, v95
  s_add_u32 s78, s86, 131072
  v_permlane16_swap_b32 v221, v223
  buffer_store_dwordx4 v[220:223], v4, s[4:7], s78 offen
  v_cvt_pk_bf16_f32 v229, v80, v96
  v_cvt_pk_bf16_f32 v231, v81, v97
  s_add_u32 s78, s86, 163840
  v_permlane16_swap_b32 v225, v227
  buffer_store_dwordx4 v[224:227], v4, s[4:7], s78 offen
  v_cvt_pk_bf16_f32 v233, v82, v98
  v_cvt_pk_bf16_f32 v235, v83, v99
  s_add_u32 s78, s86, 262144
  v_permlane16_swap_b32 v229, v231
  buffer_store_dwordx4 v[228:231], v4, s[4:7], s78 offen
  v_cvt_pk_bf16_f32 v237, v84, v100
  v_cvt_pk_bf16_f32 v239, v85, v101
  s_add_u32 s78, s86, 294912
  v_permlane16_swap_b32 v233, v235
  buffer_store_dwordx4 v[232:235], v4, s[4:7], s78 offen
  v_cvt_pk_bf16_f32 v241, v86, v102
  v_cvt_pk_bf16_f32 v243, v87, v103
  s_add_u32 s78, s86, 393216
  v_permlane16_swap_b32 v237, v239
  buffer_store_dwordx4 v[236:239], v4, s[4:7], s78 offen
  s_add_u32 s78, s86, 425984
  v_permlane16_swap_b32 v241, v243
  buffer_store_dwordx4 v[240:243], v4, s[4:7], s78 offen
  s_waitcnt vmcnt(8)
  s_mov_b64 exec, 1
  buffer_store_dword v38, off, s[4:7], s84 sc1
  s_mov_b64 exec, -1
  s_mov_b32 s84, 268435456
  s_branch o_we_114
o_rt_122:
  s_mov_b32 s67, 0
o_rl_126:
  s_lshl_b32 s94, s43, 14
  s_add_u32 s94, s94, s95
  buffer_load_dwordx4 v[120:123], v5, s[4:7], s94 offen offset:0 sc1
  buffer_load_dwordx4 v[124:127], v5, s[4:7], s94 offen offset:512 sc1
  buffer_load_dwordx4 v[128:131], v5, s[4:7], s94 offen offset:256 sc1
  buffer_load_dwordx4 v[132:135], v5, s[4:7], s94 offen offset:768 sc1
  s_add_u32 s94, s94, 4096
  buffer_load_dwordx4 v[136:139], v5, s[4:7], s94 offen offset:0 sc1
  buffer_load_dwordx4 v[140:143], v5, s[4:7], s94 offen offset:512 sc1
  buffer_load_dwordx4 v[144:147], v5, s[4:7], s94 offen offset:256 sc1
  buffer_load_dwordx4 v[148:151], v5, s[4:7], s94 offen offset:768 sc1
  s_add_u32 s94, s94, 4096
  buffer_load_dwordx4 v[152:155], v5, s[4:7], s94 offen offset:0 sc1
  buffer_load_dwordx4 v[156:159], v5, s[4:7], s94 offen offset:512 sc1
  buffer_load_dwordx4 v[160:163], v5, s[4:7], s94 offen offset:256 sc1
  buffer_load_dwordx4 v[164:167], v5, s[4:7], s94 offen offset:768 sc1
  s_add_u32 s94, s94, 4096
  buffer_load_dwordx4 v[168:171], v5, s[4:7], s94 offen offset:0 sc1
  buffer_load_dwordx4 v[172:175], v5, s[4:7], s94 offen offset:512 sc1
  buffer_load_dwordx4 v[176:179], v5, s[4:7], s94 offen offset:256 sc1
  buffer_load_dwordx4 v[180:183], v5, s[4:7], s94 offen offset:768 sc1
  s_add_u32 s67, s67, 1
  s_cmp_gt_u32 s67, 1048576
  s_cbranch_scc1 L_end
  s_waitcnt vmcnt(0)
  v_xor_b32 v7, s96, v120
  v_bitop3_b32 v7, v7, v124, s96 bitop3:0xf6
  v_bitop3_b32 v7, v7, v128, s96 bitop3:0xf6
  v_bitop3_b32 v7, v7, v132, s96 bitop3:0xf6
  v_bitop3_b32 v7, v7, v136, s96 bitop3:0xf6
  v_bitop3_b32 v7, v7, v140, s96 bitop3:0xf6
  v_bitop3_b32 v7, v7, v144, s96 bitop3:0xf6
  v_bitop3_b32 v7, v7, v148, s96 bitop3:0xf6
  v_bitop3_b32 v7, v7, v152, s96 bitop3:0xf6
  v_bitop3_b32 v7, v7, v156, s96 bitop3:0xf6
  v_bitop3_b32 v7, v7, v160, s96 bitop3:0xf6
  v_bitop3_b32 v7, v7, v164, s96 bitop3:0xf6
  v_bitop3_b32 v7, v7, v168, s96 bitop3:0xf6
  v_bitop3_b32 v7, v7, v172, s96 bitop3:0xf6
  v_bitop3_b32 v7, v7, v176, s96 bitop3:0xf6
  v_bitop3_b32 v7, v7, v180, s96 bitop3:0xf6
  v_and_b32 v7, v254, v7
  v_cmp_ne_u32 vcc, 0, v7
  s_cbranch_vccnz o_rl_126
  s_branch o_bk_123
o_rt_124:
  s_mov_b32 s67, 0
o_rl_127:
  s_lshl_b32 s94, s43, 14
  s_add_u32 s94, s94, s95
  buffer_load_dwordx4 v[120:123], v5, s[4:7], s94 offen offset:0 sc1
  buffer_load_dwordx4 v[124:127], v5, s[4:7], s94 offen offset:512 sc1
  buffer_load_dwordx4 v[128:131], v5, s[4:7], s94 offen offset:256 sc1
  buffer_load_dwordx4 v[132:135], v5, s[4:7], s94 offen offset:768 sc1
  s_add_u32 s94, s94, 4096
  buffer_load_dwordx4 v[136:139], v5, s[4:7], s94 offen offset:0 sc1
  buffer_load_dwordx4 v[140:143], v5, s[4:7], s94 offen offset:512 sc1
  buffer_load_dwordx4 v[144:147], v5, s[4:7], s94 offen offset:256 sc1
  buffer_load_dwordx4 v[148:151], v5, s[4:7], s94 offen offset:768 sc1
  s_add_u32 s94, s94, 4096
  buffer_load_dwordx4 v[152:155], v5, s[4:7], s94 offen offset:0 sc1
  buffer_load_dwordx4 v[156:159], v5, s[4:7], s94 offen offset:512 sc1
  buffer_load_dwordx4 v[160:163], v5, s[4:7], s94 offen offset:256 sc1
  buffer_load_dwordx4 v[164:167], v5, s[4:7], s94 offen offset:768 sc1
  s_add_u32 s94, s94, 4096
  buffer_load_dwordx4 v[168:171], v5, s[4:7], s94 offen offset:0 sc1
  buffer_load_dwordx4 v[172:175], v5, s[4:7], s94 offen offset:512 sc1
  buffer_load_dwordx4 v[176:179], v5, s[4:7], s94 offen offset:256 sc1
  buffer_load_dwordx4 v[180:183], v5, s[4:7], s94 offen offset:768 sc1
  s_add_u32 s67, s67, 1
  s_cmp_gt_u32 s67, 1048576
  s_cbranch_scc1 L_end
  s_waitcnt vmcnt(0)
  v_xor_b32 v7, s96, v120
  v_bitop3_b32 v7, v7, v124, s96 bitop3:0xf6
  v_bitop3_b32 v7, v7, v128, s96 bitop3:0xf6
  v_bitop3_b32 v7, v7, v132, s96 bitop3:0xf6
  v_bitop3_b32 v7, v7, v136, s96 bitop3:0xf6
  v_bitop3_b32 v7, v7, v140, s96 bitop3:0xf6
  v_bitop3_b32 v7, v7, v144, s96 bitop3:0xf6
  v_bitop3_b32 v7, v7, v148, s96 bitop3:0xf6
  v_bitop3_b32 v7, v7, v152, s96 bitop3:0xf6
  v_bitop3_b32 v7, v7, v156, s96 bitop3:0xf6
  v_bitop3_b32 v7, v7, v160, s96 bitop3:0xf6
  v_bitop3_b32 v7, v7, v164, s96 bitop3:0xf6
  v_bitop3_b32 v7, v7, v168, s96 bitop3:0xf6
  v_bitop3_b32 v7, v7, v172, s96 bitop3:0xf6
  v_bitop3_b32 v7, v7, v176, s96 bitop3:0xf6
  v_bitop3_b32 v7, v7, v180, s96 bitop3:0xf6
  v_and_b32 v7, v254, v7
  v_cmp_ne_u32 vcc, 0, v7
  s_cbranch_vccnz o_rl_127
  s_branch o_bk_125
o_fb_116:
  v_mov_b32 v118, v116
  s_nop 1
  v_permlane16_swap_b32 v116, v118
  v_max_f32 v116, v116, v118
  v_mov_b32 v118, v116
  s_nop 0
  s_nop 0
  v_permlane32_swap_b32 v116, v118
  v_max_f32 v116, v116, v118
  v_sub_f32 v56, v104, v116
  v_sub_f32 v57, v105, v116
  v_sub_f32 v58, v106, v116
  v_sub_f32 v59, v107, v116
  v_sub_f32 v60, v108, v116
  v_sub_f32 v61, v109, v116
  v_sub_f32 v62, v110, v116
  v_sub_f32 v63, v111, v116
  v_sub_f32 v64, v112, v116
  v_sub_f32 v65, v113, v116
  v_exp_f32 v56, v56
  v_exp_f32 v57, v57
  v_exp_f32 v58, v58
  v_exp_f32 v59, v59
  v_exp_f32 v60, v60
  v_exp_f32 v61, v61
  v_exp_f32 v62, v62
  v_exp_f32 v63, v63
  v_exp_f32 v64, v64
  v_exp_f32 v65, v65
  v_add_f32 v117, v56, v57
  v_add_f32 v117, v117, v58
  v_add_f32 v117, v117, v59
  v_add_f32 v117, v117, v60
  v_add_f32 v117, v117, v61
  v_add_f32 v117, v117, v62
  v_add_f32 v117, v117, v63
  v_add_f32 v117, v117, v64
  v_add_f32 v117, v117, v65
  v_mov_b32 v118, v117
  s_nop 0
  s_nop 0
  v_permlane16_swap_b32 v117, v118
  v_add_f32 v117, v117, v118
  v_mov_b32 v118, v117
  s_nop 0
  s_nop 0
  v_permlane32_swap_b32 v117, v118
  v_add_f32 v117, v117, v118
  v_rcp_f32 v117, v117
  s_branch o_fbr_117
o_fb_118:
  v_mov_b32 v118, v116
  s_nop 1
  v_permlane16_swap_b32 v116, v118
  v_max_f32 v116, v116, v118
  v_mov_b32 v118, v116
  s_nop 0
  s_nop 0
  v_permlane32_swap_b32 v116, v118
  v_max_f32 v116, v116, v118
  v_sub_f32 v56, v104, v116
  v_sub_f32 v57, v105, v116
  v_sub_f32 v58, v106, v116
  v_sub_f32 v59, v107, v116
  v_sub_f32 v60, v108, v116
  v_sub_f32 v61, v109, v116
  v_sub_f32 v62, v110, v116
  v_sub_f32 v63, v111, v116
  v_sub_f32 v64, v112, v116
  v_sub_f32 v65, v113, v116
  v_exp_f32 v56, v56
  v_exp_f32 v57, v57
  v_exp_f32 v58, v58
  v_exp_f32 v59, v59
  v_exp_f32 v60, v60
  v_exp_f32 v61, v61
  v_exp_f32 v62, v62
  v_exp_f32 v63, v63
  v_exp_f32 v64, v64
  v_exp_f32 v65, v65
  v_add_f32 v117, v56, v57
  v_add_f32 v117, v117, v58
  v_add_f32 v117, v117, v59
  v_add_f32 v117, v117, v60
  v_add_f32 v117, v117, v61
  v_add_f32 v117, v117, v62
  v_add_f32 v117, v117, v63
  v_add_f32 v117, v117, v64
  v_add_f32 v117, v117, v65
  v_mov_b32 v118, v117
  s_nop 0
  s_nop 0
  v_permlane16_swap_b32 v117, v118
  v_add_f32 v117, v117, v118
  v_mov_b32 v118, v117
  s_nop 0
  s_nop 0
  v_permlane32_swap_b32 v117, v118
  v_add_f32 v117, v117, v118
  v_rcp_f32 v117, v117
  s_branch o_fbr_119
o_wr2_113:
  s_waitcnt lgkmcnt(0)
  s_barrier
  ds_read_b128 v[104:107], v3 offset:0
  ds_read_b128 v[108:111], v3 offset:512
  ds_read_b128 v[112:115], v3 offset:1024
  buffer_load_dwordx4 v[176:179], v5, s[4:7], s94 offen offset:256 sc1
  buffer_load_dwordx4 v[180:183], v5, s[4:7], s94 offen offset:768 sc1
  s_waitcnt lgkmcnt(2)
  v_mfma_f32_32x32x16_bf16 v[40:55], v[104:107], a[0:3], 0
  v_mov_b64 v[188:189], 0
  v_mov_b64 v[190:191], 0
  v_mov_b64 v[192:193], 0
  v_mov_b64 v[194:195], 0
  s_mov_b64 exec, 1
  buffer_store_dword v38, off, s[4:7], s84 sc1
  s_mov_b64 exec, -1
  s_mov_b32 s84, 268435456
  v_mfma_f32_32x32x16_bf16 v[56:71], v[104:107], a[4:7], 0
  ds_read_b128 v[116:119], v3 offset:1536
  v_mfma_f32_32x32x16_bf16 v[72:87], v[104:107], a[8:11], 0
  v_mfma_f32_32x32x16_bf16 v[88:103], v[104:107], a[12:15], 0
  s_waitcnt vmcnt(13)
  v_xor_b32 v7, s96, v120
  v_bitop3_b32 v7, v7, v124, s96 bitop3:0xf6
  v_bitop3_b32 v7, v7, v128, s96 bitop3:0xf6
  v_bitop3_b32 v7, v7, v132, s96 bitop3:0xf6
  s_waitcnt lgkmcnt(2)
  v_mfma_f32_32x32x16_bf16 v[40:55], v[108:111], a[16:19], v[40:55]
  s_waitcnt vmcnt(9)
  v_bitop3_b32 v7, v7, v136, s96 bitop3:0xf6
  v_bitop3_b32 v7, v7, v140, s96 bitop3:0xf6
  v_bitop3_b32 v7, v7, v144, s96 bitop3:0xf6
  v_bitop3_b32 v7, v7, v148, s96 bitop3:0xf6
  s_waitcnt vmcnt(5)
  v_mfma_f32_32x32x16_bf16 v[56:71], v[108:111], a[20:23], v[56:71]
  ds_read_b128 v[104:107], v3 offset:2048
  v_bitop3_b32 v7, v7, v152, s96 bitop3:0xf6
  v_bitop3_b32 v7, v7, v156, s96 bitop3:0xf6
  v_bitop3_b32 v7, v7, v160, s96 bitop3:0xf6
  v_bitop3_b32 v7, v7, v164, s96 bitop3:0xf6
  s_waitcnt vmcnt(1)
  v_mfma_f32_32x32x16_bf16 v[72:87], v[108:111], a[24:27], v[72:87]
  v_bitop3_b32 v7, v7, v168, s96 bitop3:0xf6
  v_bitop3_b32 v7, v7, v172, s96 bitop3:0xf6
  v_bitop3_b32 v7, v7, v176, s96 bitop3:0xf6
  v_bitop3_b32 v7, v7, v180, s96 bitop3:0xf6
  v_and_b32 v7, v254, v7
  v_cmp_ne_u32 vcc, 0, v7
  s_cbranch_vccnz o_rt_124
o_bk_125:
  v_mfma_f32_32x32x16_bf16 v[88:103], v[108:111], a[28:31], v[88:103]
  v_smfmac_f32_16x16x64_bf16 v[188:191], v[16:19], v[120:127], v20
  v_lshlrev_b32 v196, 16, v184
  v_smfmac_f32_16x16x64_bf16 v[192:195], v[16:19], v[128:135], v20
  v_and_b32 v197, 0xffff0000, v184
  v_smfmac_f32_16x16x64_bf16 v[188:191], v[16:19], v[136:143], v20
  v_lshlrev_b32 v198, 16, v185
  s_waitcnt lgkmcnt(2)
  v_mfma_f32_32x32x16_bf16 v[40:55], v[112:115], a[32:35], v[40:55]
  v_smfmac_f32_16x16x64_bf16 v[192:195], v[16:19], v[144:151], v20
  v_and_b32 v199, 0xffff0000, v185
  v_smfmac_f32_16x16x64_bf16 v[188:191], v[16:19], v[152:159], v20
  v_lshlrev_b32 v200, 16, v186
  v_smfmac_f32_16x16x64_bf16 v[192:195], v[16:19], v[160:167], v20
  v_and_b32 v201, 0xffff0000, v186
  v_mfma_f32_32x32x16_bf16 v[56:71], v[112:115], a[36:39], v[56:71]
  ds_read_b128 v[108:111], v3 offset:2560
  v_smfmac_f32_16x16x64_bf16 v[188:191], v[16:19], v[168:175], v20
  v_lshlrev_b32 v202, 16, v187
  v_smfmac_f32_16x16x64_bf16 v[192:195], v[16:19], v[176:183], v20
  v_and_b32 v203, 0xffff0000, v187
  s_bfe_u32 s92, s65, 131086
  v_mfma_f32_32x32x16_bf16 v[72:87], v[112:115], a[40:43], v[72:87]
  s_lshl_b32 s92, s92, 21
  s_add_u32 s92, s92, s91
  s_add_u32 s93, s92, 27262976
  s_add_u32 s92, s92, 20971520
  v_permlane16_swap_b32 v188, v192
  v_mfma_f32_32x32x16_bf16 v[88:103], v[112:115], a[44:47], v[88:103]
  v_permlane16_swap_b32 v189, v193
  v_permlane16_swap_b32 v190, v194
  v_permlane16_swap_b32 v191, v195
  s_waitcnt lgkmcnt(2)
  v_mfma_f32_32x32x16_bf16 v[40:55], v[116:119], a[48:51], v[40:55]
  v_cvt_pk_bf16_f32 v188, 0, v188
  v_cvt_pk_bf16_f32 v189, 0, v189
  v_cvt_pk_bf16_f32 v190, 0, v190
  v_cvt_pk_bf16_f32 v191, 0, v191
  v_cvt_pk_bf16_f32 v192, 0, v192
  v_cvt_pk_bf16_f32 v193, 0, v193
  v_mfma_f32_32x32x16_bf16 v[56:71], v[116:119], a[52:55], v[56:71]
  ds_read_b128 v[112:115], v3 offset:3072
  v_cvt_pk_bf16_f32 v194, 0, v194
  v_cvt_pk_bf16_f32 v195, 0, v195
  v_add_f32 v196, v196, v188
  v_add_f32 v197, v197, v189
  v_add_f32 v198, v198, v190
  v_mfma_f32_32x32x16_bf16 v[72:87], v[116:119], a[56:59], v[72:87]
  v_add_f32 v199, v199, v191
  v_add_f32 v200, v200, v192
  v_add_f32 v201, v201, v193
  v_add_f32 v202, v202, v194
  v_add_f32 v203, v203, v195
  v_cvt_pk_bf16_f32 v120, v196, v197
  v_mfma_f32_32x32x16_bf16 v[88:103], v[116:119], a[60:63], v[88:103]
  v_cvt_pk_bf16_f32 v121, v198, v199
  v_cvt_pk_bf16_f32 v122, v200, v201
  v_cvt_pk_bf16_f32 v123, v202, v203
  v_lshlrev_b32 v196, 16, v120
  v_and_b32 v197, 0xffff0000, v120
  s_waitcnt lgkmcnt(2)
  v_mfma_f32_32x32x16_bf16 v[40:55], v[104:107], a[64:67], v[40:55]
  v_lshlrev_b32 v198, 16, v121
  v_and_b32 v199, 0xffff0000, v121
  v_lshlrev_b32 v200, 16, v122
  v_and_b32 v201, 0xffff0000, v122
  v_lshlrev_b32 v202, 16, v123
  v_and_b32 v203, 0xffff0000, v123
  v_mfma_f32_32x32x16_bf16 v[56:71], v[104:107], a[68:71], v[56:71]
  ds_read_b128 v[116:119], v3 offset:3584
  buffer_store_dwordx4 v[120:123], v0, s[4:7], s92 offen sc1
  v_add_f32 v136, v196, v197
  v_mul_f32 v137, v196, v196
  v_mfma_f32_32x32x16_bf16 v[72:87], v[104:107], a[72:75], v[72:87]
  v_add_f32 v138, v198, v199
  v_mul_f32 v139, v197, v197
  v_fmac_f32 v137, v198, v198
  v_fmac_f32 v139, v199, v199
  v_add_f32 v136, v136, v200
  v_fmac_f32 v137, v200, v200
  v_mfma_f32_32x32x16_bf16 v[88:103], v[104:107], a[76:79], v[88:103]
  v_add_f32 v138, v138, v201
  v_fmac_f32 v139, v201, v201
  v_add_f32 v136, v136, v202
  v_fmac_f32 v137, v202, v202
  v_add_f32 v138, v138, v203
  s_waitcnt lgkmcnt(2)
  v_mfma_f32_32x32x16_bf16 v[40:55], v[108:111], a[80:83], v[40:55]
  v_fmac_f32 v139, v203, v203
  v_add_f32 v136, v136, v138
  v_add_f32 v137, v137, v139
  s_nop 0
  v_add_f32_dpp v136, v136, v136 row_ror:8 row_mask:0xf bank_mask:0xf
  v_add_f32_dpp v137, v137, v137 row_ror:8 row_mask:0xf bank_mask:0xf
  s_nop 0
  v_add_f32_dpp v136, v136, v136 row_ror:4 row_mask:0xf bank_mask:0xf
  v_mfma_f32_32x32x16_bf16 v[56:71], v[108:111], a[84:87], v[56:71]
  ds_read_b128 v[104:107], v3 offset:8192
  v_add_f32_dpp v137, v137, v137 row_ror:4 row_mask:0xf bank_mask:0xf
  v_add_f32_dpp v136, v136, v136 row_ror:2 row_mask:0xf bank_mask:0xf
  s_nop 0
  v_add_f32_dpp v137, v137, v137 row_ror:2 row_mask:0xf bank_mask:0xf
  v_add_f32_dpp v136, v136, v136 row_ror:1 row_mask:0xf bank_mask:0xf
  s_nop 0
  v_add_f32_dpp v137, v137, v137 row_ror:1 row_mask:0xf bank_mask:0xf
  v_mfma_f32_32x32x16_bf16 v[72:87], v[108:111], a[88:91], v[72:87]
  v_mov_b32 v140, v136
  v_mov_b32 v141, v137
  s_nop 0
  v_permlane16_swap_b32 v136, v140
  v_permlane16_swap_b32 v137, v141
  v_mfma_f32_32x32x16_bf16 v[88:103], v[108:111], a[92:95], v[88:103]
  v_add_f32 v136, v136, v140
  v_add_f32 v137, v137, v141
  v_mov_b32 v140, v136
  v_mov_b32 v141, v137
  s_nop 0
  v_permlane32_swap_b32 v136, v140
  s_waitcnt lgkmcnt(2)
  v_mfma_f32_32x32x16_bf16 v[40:55], v[112:115], a[96:99], v[40:55]
  v_permlane32_swap_b32 v137, v141
  v_add_f32 v136, v136, v140
  v_add_f32 v137, v137, v141
  v_mul_f32 v136, 0x3b000000, v136
  v_mul_f32 v137, 0x3b000000, v137
  v_mfma_f32_32x32x16_bf16 v[56:71], v[112:115], a[100:103], v[56:71]
  ds_read_b128 v[108:111], v3 offset:8704
  v_fma_f32 v137, -v136, v136, v137
  v_cvt_pk_bf16_f32 v136, 0, v136
  v_max_f32 v137, 0, v137
  v_sub_f32 v140, v196, v136
  v_sub_f32 v141, v197, v136
  v_mfma_f32_32x32x16_bf16 v[72:87], v[112:115], a[104:107], v[72:87]
  v_cvt_pk_bf16_f32 v137, 0, v137
  v_sub_f32 v142, v198, v136
  v_sub_f32 v143, v199, v136
  v_add_f32 v137, 0x3727c5ac, v137
  v_sub_f32 v144, v200, v136
  v_sub_f32 v145, v201, v136
  v_mfma_f32_32x32x16_bf16 v[88:103], v[112:115], a[108:111], v[88:103]
  v_cvt_pk_bf16_f32 v137, 0, v137
  v_sub_f32 v146, v202, v136
  v_sub_f32 v147, v203, v136
  v_sqrt_f32 v137, v137
  s_waitcnt lgkmcnt(2)
  v_mfma_f32_32x32x16_bf16 v[40:55], v[116:119], a[112:115], v[40:55]
  v_cvt_pk_bf16_f32 v140, 0, v140
  v_cvt_pk_bf16_f32 v141, 0, v141
  v_cvt_pk_bf16_f32 v137, 0, v137
  v_cvt_pk_bf16_f32 v142, 0, v142
  v_cvt_pk_bf16_f32 v143, 0, v143
  v_rcp_f32 v137, v137
  v_mfma_f32_32x32x16_bf16 v[56:71], v[116:119], a[116:119], v[56:71]
  ds_read_b128 v[112:115], v3 offset:9216
  v_cvt_pk_bf16_f32 v144, 0, v144
  v_cvt_pk_bf16_f32 v145, 0, v145
  v_cvt_pk_bf16_f32 v146, 0, v146
  v_cvt_pk_bf16_f32 v147, 0, v147
  v_mul_f32 v140, v140, v137
  v_mfma_f32_32x32x16_bf16 v[72:87], v[116:119], a[120:123], v[72:87]
  v_mul_f32 v141, v141, v137
  v_mul_f32 v142, v142, v137
  v_mul_f32 v143, v143, v137
  v_mul_f32 v144, v144, v137
  v_mul_f32 v145, v145, v137
  v_mul_f32 v146, v146, v137
  v_mfma_f32_32x32x16_bf16 v[88:103], v[116:119], a[124:127], v[88:103]
  v_mul_f32 v147, v147, v137
  v_cvt_pk_bf16_f32 v124, v140, v141
  v_cvt_pk_bf16_f32 v125, v142, v143
  v_cvt_pk_bf16_f32 v126, v144, v145
  v_cvt_pk_bf16_f32 v127, v146, v147
  s_waitcnt lgkmcnt(2)
  v_mfma_f32_32x32x16_bf16 v[40:55], v[104:107], a[128:131], v[40:55]
  v_lshlrev_b32 v204, 16, v124
  v_and_b32 v205, 0xffff0000, v124
  v_lshlrev_b32 v206, 16, v125
  v_and_b32 v207, 0xffff0000, v125
  v_lshlrev_b32 v208, 16, v126
  v_and_b32 v209, 0xffff0000, v126
  v_mfma_f32_32x32x16_bf16 v[56:71], v[104:107], a[132:135], v[56:71]
  ds_read_b128 v[116:119], v3 offset:9728
  v_lshlrev_b32 v210, 16, v127
  v_and_b32 v211, 0xffff0000, v127
  buffer_store_dwordx4 v[124:127], v0, s[4:7], s93 offen sc1
  v_mfma_f32_32x32x16_bf16 v[72:87], v[104:107], a[136:139], v[72:87]
  v_add_f32 v196, v196, v204
  v_add_f32 v197, v197, v205
  v_add_f32 v198, v198, v206
  v_add_f32 v199, v199, v207
  v_add_f32 v200, v200, v208
  v_add_f32 v201, v201, v209
  v_mfma_f32_32x32x16_bf16 v[88:103], v[104:107], a[140:143], v[88:103]
  v_add_f32 v202, v202, v210
  v_add_f32 v203, v203, v211
  v_cvt_pk_bf16_f32 v128, v196, v197
  v_cvt_pk_bf16_f32 v129, v198, v199
  v_cvt_pk_bf16_f32 v130, v200, v201
  s_waitcnt lgkmcnt(2)
  v_mfma_f32_32x32x16_bf16 v[40:55], v[108:111], a[144:147], v[40:55]
  v_cvt_pk_bf16_f32 v131, v202, v203
  v_mul_f32 v188, v204, v8
  v_mul_f32 v189, v205, v9
  v_fmac_f32 v188, v206, v10
  v_fmac_f32 v189, v207, v11
  v_fmac_f32 v188, v208, v12
  v_mfma_f32_32x32x16_bf16 v[56:71], v[108:111], a[148:151], v[56:71]
  ds_read_b128 v[104:107], v3 offset:10240
  v_fmac_f32 v189, v209, v13
  v_fmac_f32 v188, v210, v14
  v_fmac_f32 v189, v211, v15
  v_add_f32 v188, v188, v189
  buffer_store_dwordx4 v[128:131], v0, s[68:71], s91 offen sc1
  v_mfma_f32_32x32x16_bf16 v[72:87], v[108:111], a[152:155], v[72:87]
  v_add_f32_dpp v188, v188, v188 row_ror:8 row_mask:0xf bank_mask:0xf
  s_nop 1
  v_add_f32_dpp v188, v188, v188 row_ror:4 row_mask:0xf bank_mask:0xf
  s_nop 1
  v_add_f32_dpp v188, v188, v188 row_ror:2 row_mask:0xf bank_mask:0xf
  s_nop 1
  v_add_f32_dpp v188, v188, v188 row_ror:1 row_mask:0xf bank_mask:0xf
  v_mov_b32 v189, v188
  s_nop 0
  s_nop 0
  v_permlane16_swap_b32 v188, v189
  v_mfma_f32_32x32x16_bf16 v[88:103], v[108:111], a[156:159], v[88:103]
  v_add_f32 v188, v188, v189
  v_mov_b32 v189, v188
  s_nop 0
  s_nop 0
  v_permlane32_swap_b32 v188, v189
  v_add_f32 v188, v188, v189
  s_waitcnt lgkmcnt(2)
  v_mfma_f32_32x32x16_bf16 v[40:55], v[112:115], a[160:163], v[40:55]
  v_cvt_pk_bf16_f32 v188, 0, v188
  v_ashrrev_i32 v189, 31, v188
  v_or_b32 v189, 0x80000000, v189
  v_xor_b32 v188, v188, v189
  s_sub_u32 s92, 4095, s90
  v_and_b32 v188, 0xffff0000, v188
  v_mfma_f32_32x32x16_bf16 v[56:71], v[112:115], a[164:167], v[56:71]
  ds_read_b128 v[108:111], v3 offset:10752
  v_or_b32 v38, s92, v188
  s_bfe_u32 s92, s65, 196625
  s_lshl_b32 s92, s92, 18
  s_lshl_b32 s93, s90, 7
  s_add_u32 s92, s92, s93
  v_mfma_f32_32x32x16_bf16 v[72:87], v[112:115], a[168:171], v[72:87]
  s_add_u32 s84, s92, 243269632
  v_mfma_f32_32x32x16_bf16 v[88:103], v[112:115], a[172:175], v[88:103]
  s_waitcnt lgkmcnt(2)
  v_mfma_f32_32x32x16_bf16 v[40:55], v[116:119], a[176:179], v[40:55]
  v_mfma_f32_32x32x16_bf16 v[56:71], v[116:119], a[180:183], v[56:71]
  ds_read_b128 v[112:115], v3 offset:11264
  v_mfma_f32_32x32x16_bf16 v[72:87], v[116:119], a[184:187], v[72:87]
  v_mfma_f32_32x32x16_bf16 v[88:103], v[116:119], a[188:191], v[88:103]
  s_waitcnt lgkmcnt(2)
  v_mfma_f32_32x32x16_bf16 v[40:55], v[104:107], a[192:195], v[40:55]
  v_mfma_f32_32x32x16_bf16 v[56:71], v[104:107], a[196:199], v[56:71]
  ds_read_b128 v[116:119], v3 offset:11776
  s_waitcnt lgkmcnt(2)
  v_mfma_f32_32x32x16_bf16 v[40:55], v[108:111], a[208:211], v[40:55]
  v_mfma_f32_32x32x16_bf16 v[56:71], v[108:111], a[212:215], v[56:71]
  s_waitcnt lgkmcnt(1)
  v_mfma_f32_32x32x16_bf16 v[40:55], v[112:115], a[224:227], v[40:55]
  v_mfma_f32_32x32x16_bf16 v[56:71], v[112:115], a[228:231], v[56:71]
  s_waitcnt lgkmcnt(0)
  v_mfma_f32_32x32x16_bf16 v[40:55], v[116:119], a[240:243], v[40:55]
  v_mfma_f32_32x32x16_bf16 v[56:71], v[116:119], a[244:247], v[56:71]
  v_mfma_f32_32x32x16_bf16 v[72:87], v[104:107], a[200:203], v[72:87]
  v_mfma_f32_32x32x16_bf16 v[88:103], v[104:107], a[204:207], v[88:103]
  v_cvt_pk_bf16_f32 v212, v40, v56
  v_cvt_pk_bf16_f32 v214, v41, v57
  v_cvt_pk_bf16_f32 v216, v42, v58
  v_cvt_pk_bf16_f32 v218, v43, v59
  v_permlane16_swap_b32 v212, v214
  v_mfma_f32_32x32x16_bf16 v[72:87], v[108:111], a[216:219], v[72:87]
  v_cvt_pk_bf16_f32 v220, v44, v60
  v_cvt_pk_bf16_f32 v222, v45, v61
  v_permlane16_swap_b32 v216, v218
  v_bfi_b32 v212, v254, s42, v212
  v_cvt_pk_bf16_f32 v224, v46, v62
  v_mfma_f32_32x32x16_bf16 v[88:103], v[108:111], a[220:223], v[88:103]
  v_cvt_pk_bf16_f32 v226, v47, v63
  v_permlane16_swap_b32 v220, v222
  v_bfi_b32 v216, v254, s42, v216
  v_cvt_pk_bf16_f32 v228, v48, v64
  v_mfma_f32_32x32x16_bf16 v[72:87], v[112:115], a[232:235], v[72:87]
  v_cvt_pk_bf16_f32 v230, v49, v65
  v_permlane16_swap_b32 v224, v226
  v_bfi_b32 v220, v254, s42, v220
  v_cvt_pk_bf16_f32 v232, v50, v66
  v_cvt_pk_bf16_f32 v234, v51, v67
  v_mfma_f32_32x32x16_bf16 v[88:103], v[112:115], a[236:239], v[88:103]
  v_permlane16_swap_b32 v228, v230
  v_bfi_b32 v224, v254, s42, v224
  v_cvt_pk_bf16_f32 v236, v52, v68
  v_cvt_pk_bf16_f32 v238, v53, v69
  v_mfma_f32_32x32x16_bf16 v[72:87], v[116:119], a[248:251], v[72:87]
  v_permlane16_swap_b32 v232, v234
  v_bfi_b32 v228, v254, s42, v228
  v_cvt_pk_bf16_f32 v240, v54, v70
  v_cvt_pk_bf16_f32 v242, v55, v71
  v_permlane16_swap_b32 v236, v238
  v_mfma_f32_32x32x16_bf16 v[88:103], v[116:119], a[252:255], v[88:103]
  v_bfi_b32 v232, v254, s42, v232
  v_permlane16_swap_b32 v240, v242
  v_bfi_b32 v236, v254, s42, v236
  v_bfi_b32 v240, v254, s42, v240
  s_nop 7
  v_cvt_pk_bf16_f32 v213, v72, v88
  v_cvt_pk_bf16_f32 v215, v73, v89
  v_cvt_pk_bf16_f32 v217, v74, v90
  v_cvt_pk_bf16_f32 v219, v75, v91
  s_add_u32 s78, s86, 0
  v_permlane16_swap_b32 v213, v215
  buffer_store_dwordx4 v[212:215], v4, s[4:7], s78 offen
  v_cvt_pk_bf16_f32 v221, v76, v92
  v_cvt_pk_bf16_f32 v223, v77, v93
  s_add_u32 s78, s86, 32768
  v_permlane16_swap_b32 v217, v219
  buffer_store_dwordx4 v[216:219], v4, s[4:7], s78 offen
  v_cvt_pk_bf16_f32 v225, v78, v94
  v_cvt_pk_bf16_f32 v227, v79, v95
  s_add_u32 s78, s86, 131072
  v_permlane16_swap_b32 v221, v223
  buffer_store_dwordx4 v[220:223], v4, s[4:7], s78 offen
  v_cvt_pk_bf16_f32 v229, v80, v96
  v_cvt_pk_bf16_f32 v231, v81, v97
  s_add_u32 s78, s86, 163840
  v_permlane16_swap_b32 v225, v227
  buffer_store_dwordx4 v[224:227], v4, s[4:7], s78 offen
  v_cvt_pk_bf16_f32 v233, v82, v98
  v_cvt_pk_bf16_f32 v235, v83, v99
  s_add_u32 s78, s86, 262144
  v_permlane16_swap_b32 v229, v231
  buffer_store_dwordx4 v[228:231], v4, s[4:7], s78 offen
  v_cvt_pk_bf16_f32 v237, v84, v100
  v_cvt_pk_bf16_f32 v239, v85, v101
  s_add_u32 s78, s86, 294912
  v_permlane16_swap_b32 v233, v235
  buffer_store_dwordx4 v[232:235], v4, s[4:7], s78 offen
  v_cvt_pk_bf16_f32 v241, v86, v102
  v_cvt_pk_bf16_f32 v243, v87, v103
  s_add_u32 s78, s86, 393216
  v_permlane16_swap_b32 v237, v239
  buffer_store_dwordx4 v[236:239], v4, s[4:7], s78 offen
  s_add_u32 s78, s86, 425984
  v_permlane16_swap_b32 v241, v243
  buffer_store_dwordx4 v[240:243], v4, s[4:7], s78 offen
o_we_114:
  v_and_b32 v37, -32, v39
  s_waitcnt lgkmcnt(0)
  s_barrier
  ds_read_b128 v[104:107], v37 offset:16
  s_mov_b32 s65, s63
  s_waitcnt lgkmcnt(0)
  v_and_b32 v104, v104, v106
  v_max_u32 v105, v105, v107
  v_readfirstlane_b32 s26, v104
  v_readfirstlane_b32 s3, v105
  s_and_b32 s66, s26, 1
  s_and_b32 s76, s26, 2
  s_bitcmp1_b32 s26, 2
  s_cselect_b32 s3, s3, 0
  s_cmp_lg_u32 s76, 0
  s_cbranch_scc1 o_nofl_88
  s_and_b32 s26, s63, 49152
  s_cbranch_scc0 o_fl_89
  s_and_b32 s26, s64, s50
  s_cbranch_scc1 o_nofl_88
o_fl_89:
  s_cmp_ge_u32 s17, 2
  s_cbranch_scc1 o_fd_128
  s_cmp_eq_u32 s65, 0
  s_cbranch_scc1 o_fd_128
  s_mov_b32 s96, s42
  s_waitcnt vmcnt(0)
  s_mov_b64 exec, 1
  buffer_store_dword v38, off, s[4:7], s84 sc1
  s_mov_b64 exec, -1
  s_mov_b32 s84, 268435456
  s_lshl_b32 s97, s43, 14
  s_add_u32 s97, s97, s86
  buffer_load_dword v7, v255, s[4:7], s97 offen sc1
  s_and_b32 s91, s65, 63
  s_lshl_b32 s90, s91, 5
  s_add_u32 s94, s90, s85
  s_add_u32 s90, s90, s43
  s_lshl_b32 s94, s94, 10
  s_lshr_b32 s92, s65, 22
  s_xor_b32 s93, s43, 32
  s_lshl_b32 s91, s90, 10
  s_add_u32 s94, s94, 25165824
  s_cmp_eq_u32 s92, s93
  s_cselect_b32 s92, s94, s91
  s_add_u32 s92, s92, 10485760
  s_and_b32 s93, s65, 49152
  s_cselect_b32 s92, s92, s91
  s_cselect_b64 s[80:81], s[4:5], s[72:73]
  s_cselect_b32 s82, s6, s74
  buffer_load_dwordx4 v[184:187], v0, s[80:83], s92 offen sc1
  s_mov_b32 s67, 0
  s_mov_b64 vcc, 0
  s_waitcnt vmcnt(1)
o_pl_130:
  v_and_b32 v7, 1, v7
  v_cmp_ne_u32 vcc, s96, v7
  s_cbranch_vccz o_pk_131
  buffer_load_dword v7, v255, s[4:7], s97 offen sc1
  s_add_u32 s67, s67, 1
  s_cmp_gt_u32 s67, 1048576
  s_cbranch_scc1 L_end
  s_waitcnt vmcnt(0)
  s_branch o_pl_130
o_pk_131:
  s_and_b32 s26, s65, 49152
  s_cbranch_scc1 o_f2_129
  s_lshl_b32 s94, s43, 14
  s_add_u32 s94, s94, s86
  buffer_load_dwordx4 v[120:123], v5, s[4:7], s94 offen offset:0 sc1
  buffer_load_dwordx4 v[124:127], v5, s[4:7], s94 offen offset:512 sc1
  buffer_load_dwordx4 v[128:131], v5, s[4:7], s94 offen offset:256 sc1
  buffer_load_dwordx4 v[132:135], v5, s[4:7], s94 offen offset:768 sc1
  s_add_u32 s94, s94, 4096
  buffer_load_dwordx4 v[136:139], v5, s[4:7], s94 offen offset:0 sc1
  buffer_load_dwordx4 v[140:143], v5, s[4:7], s94 offen offset:512 sc1
  buffer_load_dwordx4 v[144:147], v5, s[4:7], s94 offen offset:256 sc1
  buffer_load_dwordx4 v[148:151], v5, s[4:7], s94 offen offset:768 sc1
  s_add_u32 s94, s94, 4096
  buffer_load_dwordx4 v[152:155], v5, s[4:7], s94 offen offset:0 sc1
  buffer_load_dwordx4 v[156:159], v5, s[4:7], s94 offen offset:512 sc1
  buffer_load_dwordx4 v[160:163], v5, s[4:7], s94 offen offset:256 sc1
  buffer_load_dwordx4 v[164:167], v5, s[4:7], s94 offen offset:768 sc1
  s_add_u32 s94, s94, 4096
  buffer_load_dwordx4 v[168:171], v5, s[4:7], s94 offen offset:0 sc1
  buffer_load_dwordx4 v[172:175], v5, s[4:7], s94 offen offset:512 sc1
  buffer_load_dwordx4 v[176:179], v5, s[4:7], s94 offen offset:256 sc1
  buffer_load_dwordx4 v[180:183], v5, s[4:7], s94 offen offset:768 sc1
  v_mov_b64 v[188:189], 0
  v_mov_b64 v[190:191], 0
  v_mov_b64 v[192:193], 0
  v_mov_b64 v[194:195], 0
  s_waitcnt vmcnt(12)
  v_xor_b32 v7, s96, v120
  v_bitop3_b32 v7, v7, v124, s96 bitop3:0xf6
  v_bitop3_b32 v7, v7, v128, s96 bitop3:0xf6
  v_bitop3_b32 v7, v7, v132, s96 bitop3:0xf6
  s_waitcnt vmcnt(8)
  v_bitop3_b32 v7, v7, v136, s96 bitop3:0xf6
  v_bitop3_b32 v7, v7, v140, s96 bitop3:0xf6
  v_bitop3_b32 v7, v7, v144, s96 bitop3:0xf6
  v_bitop3_b32 v7, v7, v148, s96 bitop3:0xf6
  s_waitcnt vmcnt(4)
  v_bitop3_b32 v7, v7, v152, s96 bitop3:0xf6
  v_bitop3_b32 v7, v7, v156, s96 bitop3:0xf6
  v_bitop3_b32 v7, v7, v160, s96 bitop3:0xf6
  v_bitop3_b32 v7, v7, v164, s96 bitop3:0xf6
  s_waitcnt vmcnt(0)
  v_bitop3_b32 v7, v7, v168, s96 bitop3:0xf6
  v_bitop3_b32 v7, v7, v172, s96 bitop3:0xf6
  v_bitop3_b32 v7, v7, v176, s96 bitop3:0xf6
  v_bitop3_b32 v7, v7, v180, s96 bitop3:0xf6
  v_and_b32 v7, v254, v7
  v_cmp_ne_u32 vcc, 0, v7
  s_cbranch_vccnz o_rt_132
o_bk_133:
  v_smfmac_f32_16x16x64_bf16 v[188:191], v[16:19], v[120:127], v20
  v_lshlrev_b32 v196, 16, v184
  v_smfmac_f32_16x16x64_bf16 v[192:195], v[16:19], v[128:135], v20
  v_and_b32 v197, 0xffff0000, v184
  v_smfmac_f32_16x16x64_bf16 v[188:191], v[16:19], v[136:143], v20
  v_lshlrev_b32 v198, 16, v185
  v_smfmac_f32_16x16x64_bf16 v[192:195], v[16:19], v[144:151], v20
  v_and_b32 v199, 0xffff0000, v185
  v_smfmac_f32_16x16x64_bf16 v[188:191], v[16:19], v[152:159], v20
  v_lshlrev_b32 v200, 16, v186
  v_smfmac_f32_16x16x64_bf16 v[192:195], v[16:19], v[160:167], v20
  v_and_b32 v201, 0xffff0000, v186
  v_smfmac_f32_16x16x64_bf16 v[188:191], v[16:19], v[168:175], v20
  v_lshlrev_b32 v202, 16, v187
  v_smfmac_f32_16x16x64_bf16 v[192:195], v[16:19], v[176:183], v20
  v_and_b32 v203, 0xffff0000, v187
  s_bfe_u32 s92, s65, 131086
  s_lshl_b32 s92, s92, 21
  s_add_u32 s92, s92, s91
  s_add_u32 s93, s92, 27262976
  s_add_u32 s92, s92, 20971520
  s_nop 1
  v_permlane16_swap_b32 v188, v192
  v_permlane16_swap_b32 v189, v193
  v_permlane16_swap_b32 v190, v194
  v_permlane16_swap_b32 v191, v195
  v_cvt_pk_bf16_f32 v188, 0, v188
  v_cvt_pk_bf16_f32 v189, 0, v189
  v_cvt_pk_bf16_f32 v190, 0, v190
  v_cvt_pk_bf16_f32 v191, 0, v191
  v_cvt_pk_bf16_f32 v192, 0, v192
  v_cvt_pk_bf16_f32 v193, 0, v193
  v_cvt_pk_bf16_f32 v194, 0, v194
  v_cvt_pk_bf16_f32 v195, 0, v195
  v_add_f32 v196, v196, v188
  v_add_f32 v197, v197, v189
  v_add_f32 v198, v198, v190
  v_add_f32 v199, v199, v191
  v_add_f32 v200, v200, v192
  v_add_f32 v201, v201, v193
  v_add_f32 v202, v202, v194
  v_add_f32 v203, v203, v195
  v_cvt_pk_bf16_f32 v120, v196, v197
  v_cvt_pk_bf16_f32 v121, v198, v199
  v_cvt_pk_bf16_f32 v122, v200, v201
  v_cvt_pk_bf16_f32 v123, v202, v203
  v_lshlrev_b32 v196, 16, v120
  v_and_b32 v197, 0xffff0000, v120
  v_lshlrev_b32 v198, 16, v121
  v_and_b32 v199, 0xffff0000, v121
  v_lshlrev_b32 v200, 16, v122
  v_and_b32 v201, 0xffff0000, v122
  v_lshlrev_b32 v202, 16, v123
  v_and_b32 v203, 0xffff0000, v123
  buffer_store_dwordx4 v[120:123], v0, s[4:7], s92 offen sc1
  v_add_f32 v136, v196, v197
  v_mul_f32 v137, v196, v196
  v_add_f32 v138, v198, v199
  v_mul_f32 v139, v197, v197
  v_fmac_f32 v137, v198, v198
  v_fmac_f32 v139, v199, v199
  v_add_f32 v136, v136, v200
  v_fmac_f32 v137, v200, v200
  v_add_f32 v138, v138, v201
  v_fmac_f32 v139, v201, v201
  v_add_f32 v136, v136, v202
  v_fmac_f32 v137, v202, v202
  v_add_f32 v138, v138, v203
  v_fmac_f32 v139, v203, v203
  v_add_f32 v136, v136, v138
  v_add_f32 v137, v137, v139
  s_nop 0
  v_add_f32_dpp v136, v136, v136 row_ror:8 row_mask:0xf bank_mask:0xf
  v_add_f32_dpp v137, v137, v137 row_ror:8 row_mask:0xf bank_mask:0xf
  s_nop 0
  v_add_f32_dpp v136, v136, v136 row_ror:4 row_mask:0xf bank_mask:0xf
  v_add_f32_dpp v137, v137, v137 row_ror:4 row_mask:0xf bank_mask:0xf
  s_nop 0
  v_add_f32_dpp v136, v136, v136 row_ror:2 row_mask:0xf bank_mask:0xf
  v_add_f32_dpp v137, v137, v137 row_ror:2 row_mask:0xf bank_mask:0xf
  s_nop 0
  v_add_f32_dpp v136, v136, v136 row_ror:1 row_mask:0xf bank_mask:0xf
  v_add_f32_dpp v137, v137, v137 row_ror:1 row_mask:0xf bank_mask:0xf
  v_mov_b32 v140, v136
  v_mov_b32 v141, v137
  s_nop 0
  v_permlane16_swap_b32 v136, v140
  v_permlane16_swap_b32 v137, v141
  v_add_f32 v136, v136, v140
  v_add_f32 v137, v137, v141
  v_mov_b32 v140, v136
  v_mov_b32 v141, v137
  s_nop 0
  v_permlane32_swap_b32 v136, v140
  v_permlane32_swap_b32 v137, v141
  v_add_f32 v136, v136, v140
  v_add_f32 v137, v137, v141
  v_mul_f32 v136, 0x3b000000, v136
  v_mul_f32 v137, 0x3b000000, v137
  v_fma_f32 v137, -v136, v136, v137
  v_cvt_pk_bf16_f32 v136, 0, v136
  v_max_f32 v137, 0, v137
  v_sub_f32 v140, v196, v136
  v_sub_f32 v141, v197, v136
  v_cvt_pk_bf16_f32 v137, 0, v137
  v_sub_f32 v142, v198, v136
  v_sub_f32 v143, v199, v136
  v_add_f32 v137, 0x3727c5ac, v137
  v_sub_f32 v144, v200, v136
  v_sub_f32 v145, v201, v136
  v_cvt_pk_bf16_f32 v137, 0, v137
  v_sub_f32 v146, v202, v136
  v_sub_f32 v147, v203, v136
  v_sqrt_f32 v137, v137
  v_cvt_pk_bf16_f32 v140, 0, v140
  v_cvt_pk_bf16_f32 v141, 0, v141
  v_cvt_pk_bf16_f32 v137, 0, v137
  v_cvt_pk_bf16_f32 v142, 0, v142
  v_cvt_pk_bf16_f32 v143, 0, v143
  v_rcp_f32 v137, v137
  v_cvt_pk_bf16_f32 v144, 0, v144
  v_cvt_pk_bf16_f32 v145, 0, v145
  v_cvt_pk_bf16_f32 v146, 0, v146
  v_cvt_pk_bf16_f32 v147, 0, v147
  v_mul_f32 v140, v140, v137
  v_mul_f32 v141, v141, v137
  v_mul_f32 v142, v142, v137
  v_mul_f32 v143, v143, v137
  v_mul_f32 v144, v144, v137
  v_mul_f32 v145, v145, v137
  v_mul_f32 v146, v146, v137
  v_mul_f32 v147, v147, v137
  v_cvt_pk_bf16_f32 v124, v140, v141
  v_cvt_pk_bf16_f32 v125, v142, v143
  v_cvt_pk_bf16_f32 v126, v144, v145
  v_cvt_pk_bf16_f32 v127, v146, v147
  v_lshlrev_b32 v204, 16, v124
  v_and_b32 v205, 0xffff0000, v124
  v_lshlrev_b32 v206, 16, v125
  v_and_b32 v207, 0xffff0000, v125
  v_lshlrev_b32 v208, 16, v126
  v_and_b32 v209, 0xffff0000, v126
  v_lshlrev_b32 v210, 16, v127
  v_and_b32 v211, 0xffff0000, v127
  buffer_store_dwordx4 v[124:127], v0, s[4:7], s93 offen sc1
  v_add_f32 v196, v196, v204
  v_add_f32 v197, v197, v205
  v_add_f32 v198, v198, v206
  v_add_f32 v199, v199, v207
  v_add_f32 v200, v200, v208
  v_add_f32 v201, v201, v209
  v_add_f32 v202, v202, v210
  v_add_f32 v203, v203, v211
  v_cvt_pk_bf16_f32 v128, v196, v197
  v_cvt_pk_bf16_f32 v129, v198, v199
  v_cvt_pk_bf16_f32 v130, v200, v201
  v_cvt_pk_bf16_f32 v131, v202, v203
  v_mul_f32 v188, v204, v8
  v_mul_f32 v189, v205, v9
  v_fmac_f32 v188, v206, v10
  v_fmac_f32 v189, v207, v11
  v_fmac_f32 v188, v208, v12
  v_fmac_f32 v189, v209, v13
  v_fmac_f32 v188, v210, v14
  v_fmac_f32 v189, v211, v15
  v_add_f32 v188, v188, v189
  s_add_u32 s92, s91, 10485760
  s_add_u32 s93, s91, 8388608
  buffer_store_dwordx4 v[128:131], v0, s[4:7], s92 offen sc1
  v_lshlrev_b32 v196, 16, v128
  v_and_b32 v197, 0xffff0000, v128
  v_lshlrev_b32 v198, 16, v129
  v_and_b32 v199, 0xffff0000, v129
  v_lshlrev_b32 v200, 16, v130
  v_and_b32 v201, 0xffff0000, v130
  v_lshlrev_b32 v202, 16, v131
  v_and_b32 v203, 0xffff0000, v131
  v_add_f32 v136, v196, v197
  v_mul_f32 v137, v196, v196
  v_add_f32 v138, v198, v199
  v_mul_f32 v139, v197, v197
  v_fmac_f32 v137, v198, v198
  v_fmac_f32 v139, v199, v199
  v_add_f32 v136, v136, v200
  v_fmac_f32 v137, v200, v200
  v_add_f32 v138, v138, v201
  v_fmac_f32 v139, v201, v201
  v_add_f32 v136, v136, v202
  v_fmac_f32 v137, v202, v202
  v_add_f32 v138, v138, v203
  v_fmac_f32 v139, v203, v203
  v_add_f32 v136, v136, v138
  v_add_f32 v137, v137, v139
  s_nop 0
  v_add_f32_dpp v136, v136, v136 row_ror:8 row_mask:0xf bank_mask:0xf
  v_add_f32_dpp v137, v137, v137 row_ror:8 row_mask:0xf bank_mask:0xf
  v_add_f32_dpp v188, v188, v188 row_ror:8 row_mask:0xf bank_mask:0xf
  v_add_f32_dpp v136, v136, v136 row_ror:4 row_mask:0xf bank_mask:0xf
  v_add_f32_dpp v137, v137, v137 row_ror:4 row_mask:0xf bank_mask:0xf
  v_add_f32_dpp v188, v188, v188 row_ror:4 row_mask:0xf bank_mask:0xf
  v_add_f32_dpp v136, v136, v136 row_ror:2 row_mask:0xf bank_mask:0xf
  v_add_f32_dpp v137, v137, v137 row_ror:2 row_mask:0xf bank_mask:0xf
  v_add_f32_dpp v188, v188, v188 row_ror:2 row_mask:0xf bank_mask:0xf
  v_add_f32_dpp v136, v136, v136 row_ror:1 row_mask:0xf bank_mask:0xf
  v_add_f32_dpp v137, v137, v137 row_ror:1 row_mask:0xf bank_mask:0xf
  v_add_f32_dpp v188, v188, v188 row_ror:1 row_mask:0xf bank_mask:0xf
  v_mov_b32 v140, v136
  v_mov_b32 v141, v137
  v_mov_b32 v142, v188
  v_permlane16_swap_b32 v136, v140
  v_permlane16_swap_b32 v137, v141
  v_permlane16_swap_b32 v188, v142
  v_add_f32 v136, v136, v140
  v_add_f32 v137, v137, v141
  v_add_f32 v188, v188, v142
  v_mov_b32 v140, v136
  v_mov_b32 v141, v137
  v_mov_b32 v142, v188
  v_permlane32_swap_b32 v136, v140
  v_permlane32_swap_b32 v137, v141
  v_permlane32_swap_b32 v188, v142
  v_add_f32 v136, v136, v140
  v_add_f32 v137, v137, v141
  v_add_f32 v188, v188, v142
  v_mul_f32 v136, 0x3b000000, v136
  v_mul_f32 v137, 0x3b000000, v137
  v_fma_f32 v137, -v136, v136, v137
  v_cvt_pk_bf16_f32 v136, 0, v136
  v_max_f32 v137, 0, v137
  v_sub_f32 v140, v196, v136
  v_sub_f32 v141, v197, v136
  v_cvt_pk_bf16_f32 v137, 0, v137
  v_sub_f32 v142, v198, v136
  v_sub_f32 v143, v199, v136
  v_add_f32 v137, 0x3727c5ac, v137
  v_sub_f32 v144, v200, v136
  v_sub_f32 v145, v201, v136
  v_cvt_pk_bf16_f32 v137, 0, v137
  v_sub_f32 v146, v202, v136
  v_sub_f32 v147, v203, v136
  v_sqrt_f32 v137, v137
  v_cvt_pk_bf16_f32 v140, 0, v140
  v_cvt_pk_bf16_f32 v141, 0, v141
  v_cvt_pk_bf16_f32 v137, 0, v137
  v_cvt_pk_bf16_f32 v142, 0, v142
  v_cvt_pk_bf16_f32 v143, 0, v143
  v_rcp_f32 v137, v137
  v_cvt_pk_bf16_f32 v144, 0, v144
  v_cvt_pk_bf16_f32 v145, 0, v145
  v_cvt_pk_bf16_f32 v146, 0, v146
  v_cvt_pk_bf16_f32 v147, 0, v147
  v_mul_f32 v140, v140, v137
  v_mul_f32 v141, v141, v137
  v_mul_f32 v142, v142, v137
  v_mul_f32 v143, v143, v137
  v_mul_f32 v144, v144, v137
  v_mul_f32 v145, v145, v137
  v_mul_f32 v146, v146, v137
  v_mul_f32 v147, v147, v137
  v_cvt_pk_bf16_f32 v132, v140, v141
  v_cvt_pk_bf16_f32 v133, v142, v143
  v_cvt_pk_bf16_f32 v134, v144, v145
  v_cvt_pk_bf16_f32 v135, v146, v147
  buffer_store_dwordx4 v[132:135], v0, s[4:7], s93 offen sc1
  v_cvt_pk_bf16_f32 v188, 0, v188
  v_ashrrev_i32 v189, 31, v188
  v_or_b32 v189, 0x80000000, v189
  v_xor_b32 v188, v188, v189
  s_sub_u32 s92, 4095, s90
  v_and_b32 v188, 0xffff0000, v188
  v_or_b32 v38, s92, v188
  s_bfe_u32 s92, s65, 196625
  s_lshl_b32 s92, s92, 18
  s_lshl_b32 s93, s90, 7
  s_add_u32 s92, s92, s93
  s_add_u32 s84, s92, 243269632
  s_waitcnt vmcnt(0)
  s_mov_b64 exec, 1
  buffer_store_dword v38, off, s[4:7], s84 sc1
  s_mov_b64 exec, -1
  s_mov_b32 s84, 268435456
  s_branch o_fd_128
o_rt_132:
  s_mov_b32 s67, 0
o_rl_134:
  s_lshl_b32 s94, s43, 14
  s_add_u32 s94, s94, s86
  buffer_load_dwordx4 v[120:123], v5, s[4:7], s94 offen offset:0 sc1
  buffer_load_dwordx4 v[124:127], v5, s[4:7], s94 offen offset:512 sc1
  buffer_load_dwordx4 v[128:131], v5, s[4:7], s94 offen offset:256 sc1
  buffer_load_dwordx4 v[132:135], v5, s[4:7], s94 offen offset:768 sc1
  s_add_u32 s94, s94, 4096
  buffer_load_dwordx4 v[136:139], v5, s[4:7], s94 offen offset:0 sc1
  buffer_load_dwordx4 v[140:143], v5, s[4:7], s94 offen offset:512 sc1
  buffer_load_dwordx4 v[144:147], v5, s[4:7], s94 offen offset:256 sc1
  buffer_load_dwordx4 v[148:151], v5, s[4:7], s94 offen offset:768 sc1
  s_add_u32 s94, s94, 4096
  buffer_load_dwordx4 v[152:155], v5, s[4:7], s94 offen offset:0 sc1
  buffer_load_dwordx4 v[156:159], v5, s[4:7], s94 offen offset:512 sc1
  buffer_load_dwordx4 v[160:163], v5, s[4:7], s94 offen offset:256 sc1
  buffer_load_dwordx4 v[164:167], v5, s[4:7], s94 offen offset:768 sc1
  s_add_u32 s94, s94, 4096
  buffer_load_dwordx4 v[168:171], v5, s[4:7], s94 offen offset:0 sc1
  buffer_load_dwordx4 v[172:175], v5, s[4:7], s94 offen offset:512 sc1
  buffer_load_dwordx4 v[176:179], v5, s[4:7], s94 offen offset:256 sc1
  buffer_load_dwordx4 v[180:183], v5, s[4:7], s94 offen offset:768 sc1
  s_add_u32 s67, s67, 1
  s_cmp_gt_u32 s67, 1048576
  s_cbranch_scc1 L_end
  s_waitcnt vmcnt(0)
  v_xor_b32 v7, s96, v120
  v_bitop3_b32 v7, v7, v124, s96 bitop3:0xf6
  v_bitop3_b32 v7, v7, v128, s96 bitop3:0xf6
  v_bitop3_b32 v7, v7, v132, s96 bitop3:0xf6
  v_bitop3_b32 v7, v7, v136, s96 bitop3:0xf6
  v_bitop3_b32 v7, v7, v140, s96 bitop3:0xf6
  v_bitop3_b32 v7, v7, v144, s96 bitop3:0xf6
  v_bitop3_b32 v7, v7, v148, s96 bitop3:0xf6
  v_bitop3_b32 v7, v7, v152, s96 bitop3:0xf6
  v_bitop3_b32 v7, v7, v156, s96 bitop3:0xf6
  v_bitop3_b32 v7, v7, v160, s96 bitop3:0xf6
  v_bitop3_b32 v7, v7, v164, s96 bitop3:0xf6
  v_bitop3_b32 v7, v7, v168, s96 bitop3:0xf6
  v_bitop3_b32 v7, v7, v172, s96 bitop3:0xf6
  v_bitop3_b32 v7, v7, v176, s96 bitop3:0xf6
  v_bitop3_b32 v7, v7, v180, s96 bitop3:0xf6
  v_and_b32 v7, v254, v7
  v_cmp_ne_u32 vcc, 0, v7
  s_cbranch_vccnz o_rl_134
  s_branch o_bk_133
o_f2_129:
  s_lshl_b32 s94, s43, 14
  s_add_u32 s94, s94, s86
  buffer_load_dwordx4 v[120:123], v5, s[4:7], s94 offen offset:0 sc1
  buffer_load_dwordx4 v[124:127], v5, s[4:7], s94 offen offset:512 sc1
  buffer_load_dwordx4 v[128:131], v5, s[4:7], s94 offen offset:256 sc1
  buffer_load_dwordx4 v[132:135], v5, s[4:7], s94 offen offset:768 sc1
  s_add_u32 s94, s94, 4096
  buffer_load_dwordx4 v[136:139], v5, s[4:7], s94 offen offset:0 sc1
  buffer_load_dwordx4 v[140:143], v5, s[4:7], s94 offen offset:512 sc1
  buffer_load_dwordx4 v[144:147], v5, s[4:7], s94 offen offset:256 sc1
  buffer_load_dwordx4 v[148:151], v5, s[4:7], s94 offen offset:768 sc1
  s_add_u32 s94, s94, 4096
  buffer_load_dwordx4 v[152:155], v5, s[4:7], s94 offen offset:0 sc1
  buffer_load_dwordx4 v[156:159], v5, s[4:7], s94 offen offset:512 sc1
  buffer_load_dwordx4 v[160:163], v5, s[4:7], s94 offen offset:256 sc1
  buffer_load_dwordx4 v[164:167], v5, s[4:7], s94 offen offset:768 sc1
  s_add_u32 s94, s94, 4096
  buffer_load_dwordx4 v[168:171], v5, s[4:7], s94 offen offset:0 sc1
  buffer_load_dwordx4 v[172:175], v5, s[4:7], s94 offen offset:512 sc1
  buffer_load_dwordx4 v[176:179], v5, s[4:7], s94 offen offset:256 sc1
  buffer_load_dwordx4 v[180:183], v5, s[4:7], s94 offen offset:768 sc1
  v_mov_b64 v[188:189], 0
  v_mov_b64 v[190:191], 0
  v_mov_b64 v[192:193], 0
  v_mov_b64 v[194:195], 0
  s_waitcnt vmcnt(12)
  v_xor_b32 v7, s96, v120
  v_bitop3_b32 v7, v7, v124, s96 bitop3:0xf6
  v_bitop3_b32 v7, v7, v128, s96 bitop3:0xf6
  v_bitop3_b32 v7, v7, v132, s96 bitop3:0xf6
  s_waitcnt vmcnt(8)
  v_bitop3_b32 v7, v7, v136, s96 bitop3:0xf6
  v_bitop3_b32 v7, v7, v140, s96 bitop3:0xf6
  v_bitop3_b32 v7, v7, v144, s96 bitop3:0xf6
  v_bitop3_b32 v7, v7, v148, s96 bitop3:0xf6
  s_waitcnt vmcnt(4)
  v_bitop3_b32 v7, v7, v152, s96 bitop3:0xf6
  v_bitop3_b32 v7, v7, v156, s96 bitop3:0xf6
  v_bitop3_b32 v7, v7, v160, s96 bitop3:0xf6
  v_bitop3_b32 v7, v7, v164, s96 bitop3:0xf6
  s_waitcnt vmcnt(0)
  v_bitop3_b32 v7, v7, v168, s96 bitop3:0xf6
  v_bitop3_b32 v7, v7, v172, s96 bitop3:0xf6
  v_bitop3_b32 v7, v7, v176, s96 bitop3:0xf6
  v_bitop3_b32 v7, v7, v180, s96 bitop3:0xf6
  v_and_b32 v7, v254, v7
  v_cmp_ne_u32 vcc, 0, v7
  s_cbranch_vccnz o_rt_135
o_bk_136:
  v_smfmac_f32_16x16x64_bf16 v[188:191], v[16:19], v[120:127], v20
  v_lshlrev_b32 v196, 16, v184
  v_smfmac_f32_16x16x64_bf16 v[192:195], v[16:19], v[128:135], v20
  v_and_b32 v197, 0xffff0000, v184
  v_smfmac_f32_16x16x64_bf16 v[188:191], v[16:19], v[136:143], v20
  v_lshlrev_b32 v198, 16, v185
  v_smfmac_f32_16x16x64_bf16 v[192:195], v[16:19], v[144:151], v20
  v_and_b32 v199, 0xffff0000, v185
  v_smfmac_f32_16x16x64_bf16 v[188:191], v[16:19], v[152:159], v20
  v_lshlrev_b32 v200, 16, v186
  v_smfmac_f32_16x16x64_bf16 v[192:195], v[16:19], v[160:167], v20
  v_and_b32 v201, 0xffff0000, v186
  v_smfmac_f32_16x16x64_bf16 v[188:191], v[16:19], v[168:175], v20
  v_lshlrev_b32 v202, 16, v187
  v_smfmac_f32_16x16x64_bf16 v[192:195], v[16:19], v[176:183], v20
  v_and_b32 v203, 0xffff0000, v187
  s_bfe_u32 s92, s65, 131086
  s_lshl_b32 s92, s92, 21
  s_add_u32 s92, s92, s91
  s_add_u32 s93, s92, 27262976
  s_add_u32 s92, s92, 20971520
  s_nop 1
  v_permlane16_swap_b32 v188, v192
  v_permlane16_swap_b32 v189, v193
  v_permlane16_swap_b32 v190, v194
  v_permlane16_swap_b32 v191, v195
  v_cvt_pk_bf16_f32 v188, 0, v188
  v_cvt_pk_bf16_f32 v189, 0, v189
  v_cvt_pk_bf16_f32 v190, 0, v190
  v_cvt_pk_bf16_f32 v191, 0, v191
  v_cvt_pk_bf16_f32 v192, 0, v192
  v_cvt_pk_bf16_f32 v193, 0, v193
  v_cvt_pk_bf16_f32 v194, 0, v194
  v_cvt_pk_bf16_f32 v195, 0, v195
  v_add_f32 v196, v196, v188
  v_add_f32 v197, v197, v189
  v_add_f32 v198, v198, v190
  v_add_f32 v199, v199, v191
  v_add_f32 v200, v200, v192
  v_add_f32 v201, v201, v193
  v_add_f32 v202, v202, v194
  v_add_f32 v203, v203, v195
  v_cvt_pk_bf16_f32 v120, v196, v197
  v_cvt_pk_bf16_f32 v121, v198, v199
  v_cvt_pk_bf16_f32 v122, v200, v201
  v_cvt_pk_bf16_f32 v123, v202, v203
  v_lshlrev_b32 v196, 16, v120
  v_and_b32 v197, 0xffff0000, v120
  v_lshlrev_b32 v198, 16, v121
  v_and_b32 v199, 0xffff0000, v121
  v_lshlrev_b32 v200, 16, v122
  v_and_b32 v201, 0xffff0000, v122
  v_lshlrev_b32 v202, 16, v123
  v_and_b32 v203, 0xffff0000, v123
  buffer_store_dwordx4 v[120:123], v0, s[4:7], s92 offen sc1
  v_add_f32 v136, v196, v197
  v_mul_f32 v137, v196, v196
  v_add_f32 v138, v198, v199
  v_mul_f32 v139, v197, v197
  v_fmac_f32 v137, v198, v198
  v_fmac_f32 v139, v199, v199
  v_add_f32 v136, v136, v200
  v_fmac_f32 v137, v200, v200
  v_add_f32 v138, v138, v201
  v_fmac_f32 v139, v201, v201
  v_add_f32 v136, v136, v202
  v_fmac_f32 v137, v202, v202
  v_add_f32 v138, v138, v203
  v_fmac_f32 v139, v203, v203
  v_add_f32 v136, v136, v138
  v_add_f32 v137, v137, v139
  s_nop 0
  v_add_f32_dpp v136, v136, v136 row_ror:8 row_mask:0xf bank_mask:0xf
  v_add_f32_dpp v137, v137, v137 row_ror:8 row_mask:0xf bank_mask:0xf
  s_nop 0
  v_add_f32_dpp v136, v136, v136 row_ror:4 row_mask:0xf bank_mask:0xf
  v_add_f32_dpp v137, v137, v137 row_ror:4 row_mask:0xf bank_mask:0xf
  s_nop 0
  v_add_f32_dpp v136, v136, v136 row_ror:2 row_mask:0xf bank_mask:0xf
  v_add_f32_dpp v137, v137, v137 row_ror:2 row_mask:0xf bank_mask:0xf
  s_nop 0
  v_add_f32_dpp v136, v136, v136 row_ror:1 row_mask:0xf bank_mask:0xf
  v_add_f32_dpp v137, v137, v137 row_ror:1 row_mask:0xf bank_mask:0xf
  v_mov_b32 v140, v136
  v_mov_b32 v141, v137
  s_nop 0
  v_permlane16_swap_b32 v136, v140
  v_permlane16_swap_b32 v137, v141
  v_add_f32 v136, v136, v140
  v_add_f32 v137, v137, v141
  v_mov_b32 v140, v136
  v_mov_b32 v141, v137
  s_nop 0
  v_permlane32_swap_b32 v136, v140
  v_permlane32_swap_b32 v137, v141
  v_add_f32 v136, v136, v140
  v_add_f32 v137, v137, v141
  v_mul_f32 v136, 0x3b000000, v136
  v_mul_f32 v137, 0x3b000000, v137
  v_fma_f32 v137, -v136, v136, v137
  v_cvt_pk_bf16_f32 v136, 0, v136
  v_max_f32 v137, 0, v137
  v_sub_f32 v140, v196, v136
  v_sub_f32 v141, v197, v136
  v_cvt_pk_bf16_f32 v137, 0, v137
  v_sub_f32 v142, v198, v136
  v_sub_f32 v143, v199, v136
  v_add_f32 v137, 0x3727c5ac, v137
  v_sub_f32 v144, v200, v136
  v_sub_f32 v145, v201, v136
  v_cvt_pk_bf16_f32 v137, 0, v137
  v_sub_f32 v146, v202, v136
  v_sub_f32 v147, v203, v136
  v_sqrt_f32 v137, v137
  v_cvt_pk_bf16_f32 v140, 0, v140
  v_cvt_pk_bf16_f32 v141, 0, v141
  v_cvt_pk_bf16_f32 v137, 0, v137
  v_cvt_pk_bf16_f32 v142, 0, v142
  v_cvt_pk_bf16_f32 v143, 0, v143
  v_rcp_f32 v137, v137
  v_cvt_pk_bf16_f32 v144, 0, v144
  v_cvt_pk_bf16_f32 v145, 0, v145
  v_cvt_pk_bf16_f32 v146, 0, v146
  v_cvt_pk_bf16_f32 v147, 0, v147
  v_mul_f32 v140, v140, v137
  v_mul_f32 v141, v141, v137
  v_mul_f32 v142, v142, v137
  v_mul_f32 v143, v143, v137
  v_mul_f32 v144, v144, v137
  v_mul_f32 v145, v145, v137
  v_mul_f32 v146, v146, v137
  v_mul_f32 v147, v147, v137
  v_cvt_pk_bf16_f32 v124, v140, v141
  v_cvt_pk_bf16_f32 v125, v142, v143
  v_cvt_pk_bf16_f32 v126, v144, v145
  v_cvt_pk_bf16_f32 v127, v146, v147
  v_lshlrev_b32 v204, 16, v124
  v_and_b32 v205, 0xffff0000, v124
  v_lshlrev_b32 v206, 16, v125
  v_and_b32 v207, 0xffff0000, v125
  v_lshlrev_b32 v208, 16, v126
  v_and_b32 v209, 0xffff0000, v126
  v_lshlrev_b32 v210, 16, v127
  v_and_b32 v211, 0xffff0000, v127
  buffer_store_dwordx4 v[124:127], v0, s[4:7], s93 offen sc1
  v_add_f32 v196, v196, v204
  v_add_f32 v197, v197, v205
  v_add_f32 v198, v198, v206
  v_add_f32 v199, v199, v207
  v_add_f32 v200, v200, v208
  v_add_f32 v201, v201, v209
  v_add_f32 v202, v202, v210
  v_add_f32 v203, v203, v211
  v_cvt_pk_bf16_f32 v128, v196, v197
  v_cvt_pk_bf16_f32 v129, v198, v199
  v_cvt_pk_bf16_f32 v130, v200, v201
  v_cvt_pk_bf16_f32 v131, v202, v203
  v_mul_f32 v188, v204, v8
  v_mul_f32 v189, v205, v9
  v_fmac_f32 v188, v206, v10
  v_fmac_f32 v189, v207, v11
  v_fmac_f32 v188, v208, v12
  v_fmac_f32 v189, v209, v13
  v_fmac_f32 v188, v210, v14
  v_fmac_f32 v189, v211, v15
  v_add_f32 v188, v188, v189
  buffer_store_dwordx4 v[128:131], v0, s[68:71], s91 offen sc1
  s_nop 0
  v_add_f32_dpp v188, v188, v188 row_ror:8 row_mask:0xf bank_mask:0xf
  s_nop 1
  v_add_f32_dpp v188, v188, v188 row_ror:4 row_mask:0xf bank_mask:0xf
  s_nop 1
  v_add_f32_dpp v188, v188, v188 row_ror:2 row_mask:0xf bank_mask:0xf
  s_nop 1
  v_add_f32_dpp v188, v188, v188 row_ror:1 row_mask:0xf bank_mask:0xf
  v_mov_b32 v189, v188
  s_nop 0
  s_nop 0
  v_permlane16_swap_b32 v188, v189
  v_add_f32 v188, v188, v189
  v_mov_b32 v189, v188
  s_nop 0
  s_nop 0
  v_permlane32_swap_b32 v188, v189
  v_add_f32 v188, v188, v189
  v_cvt_pk_bf16_f32 v188, 0, v188
  v_ashrrev_i32 v189, 31, v188
  v_or_b32 v189, 0x80000000, v189
  v_xor_b32 v188, v188, v189
  s_sub_u32 s92, 4095, s90
  v_and_b32 v188, 0xffff0000, v188
  v_or_b32 v38, s92, v188
  s_bfe_u32 s92, s65, 196625
  s_lshl_b32 s92, s92, 18
  s_lshl_b32 s93, s90, 7
  s_add_u32 s92, s92, s93
  s_add_u32 s84, s92, 243269632
  s_waitcnt vmcnt(0)
  s_mov_b64 exec, 1
  buffer_store_dword v38, off, s[4:7], s84 sc1
  s_mov_b64 exec, -1
  s_mov_b32 s84, 268435456
  s_branch o_fd_128
o_rt_135:
  s_mov_b32 s67, 0
o_rl_137:
  s_lshl_b32 s94, s43, 14
  s_add_u32 s94, s94, s86
  buffer_load_dwordx4 v[120:123], v5, s[4:7], s94 offen offset:0 sc1
  buffer_load_dwordx4 v[124:127], v5, s[4:7], s94 offen offset:512 sc1
  buffer_load_dwordx4 v[128:131], v5, s[4:7], s94 offen offset:256 sc1
  buffer_load_dwordx4 v[132:135], v5, s[4:7], s94 offen offset:768 sc1
  s_add_u32 s94, s94, 4096
  buffer_load_dwordx4 v[136:139], v5, s[4:7], s94 offen offset:0 sc1
  buffer_load_dwordx4 v[140:143], v5, s[4:7], s94 offen offset:512 sc1
  buffer_load_dwordx4 v[144:147], v5, s[4:7], s94 offen offset:256 sc1
  buffer_load_dwordx4 v[148:151], v5, s[4:7], s94 offen offset:768 sc1
  s_add_u32 s94, s94, 4096
  buffer_load_dwordx4 v[152:155], v5, s[4:7], s94 offen offset:0 sc1
  buffer_load_dwordx4 v[156:159], v5, s[4:7], s94 offen offset:512 sc1
  buffer_load_dwordx4 v[160:163], v5, s[4:7], s94 offen offset:256 sc1
  buffer_load_dwordx4 v[164:167], v5, s[4:7], s94 offen offset:768 sc1
  s_add_u32 s94, s94, 4096
  buffer_load_dwordx4 v[168:171], v5, s[4:7], s94 offen offset:0 sc1
  buffer_load_dwordx4 v[172:175], v5, s[4:7], s94 offen offset:512 sc1
  buffer_load_dwordx4 v[176:179], v5, s[4:7], s94 offen offset:256 sc1
  buffer_load_dwordx4 v[180:183], v5, s[4:7], s94 offen offset:768 sc1
  s_add_u32 s67, s67, 1
  s_cmp_gt_u32 s67, 1048576
  s_cbranch_scc1 L_end
  s_waitcnt vmcnt(0)
  v_xor_b32 v7, s96, v120
  v_bitop3_b32 v7, v7, v124, s96 bitop3:0xf6
  v_bitop3_b32 v7, v7, v128, s96 bitop3:0xf6
  v_bitop3_b32 v7, v7, v132, s96 bitop3:0xf6
  v_bitop3_b32 v7, v7, v136, s96 bitop3:0xf6
  v_bitop3_b32 v7, v7, v140, s96 bitop3:0xf6
  v_bitop3_b32 v7, v7, v144, s96 bitop3:0xf6
  v_bitop3_b32 v7, v7, v148, s96 bitop3:0xf6
  v_bitop3_b32 v7, v7, v152, s96 bitop3:0xf6
  v_bitop3_b32 v7, v7, v156, s96 bitop3:0xf6
  v_bitop3_b32 v7, v7, v160, s96 bitop3:0xf6
  v_bitop3_b32 v7, v7, v164, s96 bitop3:0xf6
  v_bitop3_b32 v7, v7, v168, s96 bitop3:0xf6
  v_bitop3_b32 v7, v7, v172, s96 bitop3:0xf6
  v_bitop3_b32 v7, v7, v176, s96 bitop3:0xf6
  v_bitop3_b32 v7, v7, v180, s96 bitop3:0xf6
  v_and_b32 v7, v254, v7
  v_cmp_ne_u32 vcc, 0, v7
  s_cbranch_vccnz o_rl_137
  s_branch o_bk_136
o_fd_128:
  s_mov_b32 s65, 0
o_nofl_88:
  s_mov_b32 s63, s64
  s_cmp_lg_u32 s51, 0
  s_cbranch_scc1 o_pick_90
  s_cmp_eq_u32 s50, 0
  s_cbranch_scc1 L_end
o_adv_96:
  s_add_u32 s49, s49, 4
  s_branch o_round_86
o_dl_98:
  s_and_b32 s26, s55, s54
  s_andn2_b32 s27, s56, s54
  s_or_b32 s26, s26, s27
  s_andn2_b32 s26, s58, s26
  s_bcnt1_i32_b32 s27, s26
  s_add_u32 s27, s27, 0
  s_mul_i32 s27, s27, 86
  s_lshr_b32 s27, s27, 8
o_dl1_99:
  s_cbranch_scc0 o_dl2_100
  s_ff1_i32_b32 s28, s26
  s_bitset0_b32 s26, s28
  s_bitset0_b32 s58, s28
  s_sub_u32 s27, s27, 1
  s_cmp_lg_u32 s27, 0
  s_branch o_dl1_99
o_dl2_100:
  s_xor_b32 s26, s58, 0x8000ffff
  s_lshl_b32 s27, s60, 7
  s_add_u32 s27, s27, 243269696
  s_cmp_lg_u32 s43, 0
  s_cbranch_scc1 o_pick_90
  v_mov_b32 v162, s26
  v_mov_b32 v163, s46
  s_mov_b64 exec, 1
  buffer_store_dwordx2 v[162:163], off, s[4:7], s27 sc1
  s_mov_b64 exec, -1
  s_branch o_pick_90
o_help_97:
  s_lshl_b32 s60, s60, 1
  s_and_b32 s60, s60, 2
  s_lshl_b32 s27, s60, 7
  s_add_u32 s27, s27, 243269696
  s_mov_b32 s67, 0
o_help_97_w:
  buffer_load_dwordx2 v[162:163], off, s[4:7], s27 sc1
  buffer_load_dword v164, off, s[4:7], s27 offset:128 sc1
  s_add_u32 s67, s67, 1
  s_cmp_gt_u32 s67, 1048576
  s_cbranch_scc1 L_end
  s_waitcnt vmcnt(0)
  v_readfirstlane_b32 s28, v162
  v_readfirstlane_b32 s30, v164
  v_readfirstlane_b32 s46, v163
  s_and_b32 s26, s28, s30
  s_bitcmp1_b32 s26, 31
  s_cbranch_scc0 o_help_97_w
  s_bitreplicate_b64_b32 s[28:29], s28
  s_bitreplicate_b64_b32 s[30:31], s30
  s_and_b32 s28, s28, 0x55555555
  s_and_b32 s30, s30, 0xaaaaaaaa
  s_or_b32 s58, s28, s30
  s_andn2_b32 s52, 0xfff, s46
  s_lshr_b32 s52, s52, 5
  s_sub_u32 s26, s52, s60
  s_add_u32 s27, s26, 3
  s_add_u32 s26, s26, 2
  s_lshr_b32 s27, s27, 2
  s_lshr_b32 s26, s26, 2
  s_add_u32 s26, s26, s27
  s_bfm_b64 s[28:29], s26, 0
  s_mov_b32 s54, s28
  s_mov_b32 s53, 0
  s_mov_b32 s63, 0
  s_mov_b32 s49, 72
  s_mov_b32 s59, 64
  s_mov_b32 s50, 0
  s_mov_b32 s89, 0
  s_branch o_pick_90
L_o_x:
  s_mov_b32 s62, 1
  s_mov_b32 s42, 0
  s_mov_b32 s3, 0
  s_mov_b32 s46, 0
  s_mov_b32 s65, 0
  s_mov_b32 s66, 0
  s_mov_b32 s76, 0
  s_mov_b32 s55, 0
  s_mov_b32 s56, 0
  s_mov_b32 s84, 268435456
  s_mov_b32 s86, s41
  s_mov_b32 s49, s60
  s_mul_i32 s63, s49, 257
  s_or_b32 s63, s63, 1179648
  s_lshr_b32 s57, s60, 2
  s_cbranch_scc1 o_help_149
o_round_138:
  s_max_u32 s46, s46, s3
  s_cmp_lg_u32 s3, 0
  s_mov_b32 s3, 0
  s_cbranch_scc1 d_g_154
  s_mov_b32 s67, 0
d_w_153:
  s_min_u32 s26, s49, 71
  s_lshl_b32 s26, s26, 12
  s_add_u32 s27, s26, 243494912
  s_add_u32 s26, s26, 243486720
  buffer_load_dword v248, v246, s[4:7], s26 offen sc1
  buffer_load_dword v249, v246, s[4:7], s27 offen sc1
  s_add_u32 s67, s67, 1
  s_cmp_gt_u32 s67, 1048576
  s_cbranch_scc1 L_end
  s_waitcnt vmcnt(0)
  s_mov_b64 exec, 1
  buffer_store_dword v38, off, s[4:7], s84 sc1
  s_mov_b64 exec, -1
  s_mov_b32 s84, 268435456
  v_min_u32 v162, v248, v249
  v_max_u32 v163, v248, v249
  v_cmp_eq_u32 vcc, 0, v162
  s_cbranch_vccnz d_w_153
  v_max_u32_dpp v163, v163, v163 row_ror:8 row_mask:0xf bank_mask:0xf
  s_nop 1
  v_max_u32_dpp v163, v163, v163 row_ror:4 row_mask:0xf bank_mask:0xf
  s_nop 1
  v_max_u32_dpp v163, v163, v163 row_ror:2 row_mask:0xf bank_mask:0xf
  s_nop 1
  v_max_u32_dpp v163, v163, v163 row_ror:1 row_mask:0xf bank_mask:0xf
  s_nop 0
  v_readlane_b32 s28, v163, 0
  v_readlane_b32 s29, v163, 16
  v_readlane_b32 s30, v163, 32
  v_readlane_b32 s31, v163, 48
  s_max_u32 s28, s28, s29
  s_max_u32 s30, s30, s31
  s_max_u32 s46, s46, s28
  s_max_u32 s46, s46, s30
d_g_154:
  s_lshr_b32 s27, s49, 2
  s_andn2_b32 s52, 0xfff, s46
  s_lshr_b32 s52, s52, 5
  s_min_u32 s52, s52, 64
  s_add_u32 s26, s52, 3
  v_readlane_b32 s89, v247, s27
  s_sub_u32 s26, s26, s60
  s_lshr_b32 s26, s26, 2
  s_bfm_b32 s54, s26, 0
  s_add_u32 s53, s63, 1028
  s_cmp_lt_u32 s49, 60
  s_cselect_b32 s53, s53, 0
  s_cmp_lt_u32 s49, 64
  s_cselect_b32 s26, 3, 1
  s_sub_i32 s26, s27, s26
  s_max_i32 s26, s26, 0
  s_min_u32 s26, s26, 16
  s_bfm_b32 s58, s26, 0
  s_cmp_eq_u32 s27, 16
  s_cselect_b32 s59, 2, 1
  s_cmp_eq_u32 s27, 18
  s_cselect_b32 s59, 64, s59
  s_cselect_b32 s50, 0, -1
  s_cselect_b32 s89, 0, s89
  s_cbranch_scc1 o_dl_150
o_pick_142:
  s_cmp_eq_u32 s59, 0
  s_cbranch_scc1 o_none_146
  s_sub_u32 s59, s59, 1
  s_andn2_b32 s26, s58, s55
  s_and_b32 s26, s26, s54
  s_cbranch_scc1 o_ga_143
  s_and_b32 s26, s55, s50
  s_or_b32 s26, s26, s56
  s_or_b32 s26, s26, s54
  s_andn2_b32 s26, s58, s26
  s_cbranch_scc0 o_none_146
  s_cmp_ge_u32 s46, s89
  s_cbranch_scc1 o_gb_144
o_ga_143:
  s_ff1_i32_b32 s26, s26
  s_bitset1_b32 s55, s26
  s_mov_b32 s64, 1327168
  s_mov_b32 s27, s64
  s_branch o_gd_145
o_none_146:
  s_cmp_lt_u32 s49, 60
  s_cbranch_scc1 o_nn_147
  s_cmp_eq_u32 s50, 0
  s_cbranch_scc1 o_nn_147
  s_and_b32 s26, s63, 1097728
  s_cmp_eq_u32 s26, 1048576
  s_cbranch_scc1 o_nn_147
  s_cmp_lt_u32 s49, 64
  s_cbranch_scc1 o_adv_148
  s_and_b32 s26, s65, 1097728
  s_cmp_lg_u32 s26, 1048576
  s_cbranch_scc1 o_adv_148
o_nn_147:
  s_mov_b32 s64, s53
  s_mov_b32 s51, 0
  s_branch o_task_139
o_gb_144:
  s_ff1_i32_b32 s26, s26
  s_bitset1_b32 s56, s26
  s_andn2_b32 s27, 31, s46
  s_or_b32 s27, s27, 32
  s_lshl_b32 s27, s27, 22
  s_or_b32 s27, s27, 1474688
  s_mov_b32 s64, 1474624
o_gd_145:
  s_and_b32 s28, s26, s57
  s_lshr_b32 s26, s26, s57
  s_lshl2_add_u32 s26, s26, s60
  s_add_u32 s26, s26, s28
  s_cmp_eq_u32 s26, s52
  s_cselect_b32 s64, s27, s64
  s_mul_i32 s26, s26, 257
  s_or_b32 s64, s64, s26
  s_mov_b32 s51, 1
o_task_139:
  s_cmp_eq_u32 s63, 0
  s_cbranch_scc1 o_nofl_140
  s_cmp_lg_u32 s66, 0
  s_cbranch_scc1 o_have_156
  s_mov_b32 s67, 0
o_w1_155:
  s_and_b32 s32, s63, 0xff
  s_lshl_b32 s32, s32, 12
  s_add_u32 s32, s32, s14
  buffer_load_dword v37, v36, s[4:7], s32 offen sc1
  s_add_u32 s67, s67, 1
  s_cmp_gt_u32 s67, 1048576
  s_cbranch_scc1 L_end
  s_waitcnt vmcnt(0)
  s_mov_b64 exec, 1
  buffer_store_dword v38, off, s[4:7], s84 sc1
  s_mov_b64 exec, -1
  s_mov_b32 s84, 268435456
  v_cmp_eq_u32 vcc, 0, v37
  s_cbranch_vccnz o_w1_155
  s_and_b32 s87, s63, 0xff
  s_lshl_b32 s33, s87, 18
  s_lshl_b32 s32, s87, 19
  s_add_u32 m0, s22, 0
  s_add_u32 s33, s33, s19
  buffer_load_dwordx4 v0, s[4:7], s33 offen offset:0 sc1 lds
  buffer_load_dwordx4 v0, s[4:7], s33 offen offset:1024 sc1 lds
  buffer_load_dwordx4 v0, s[4:7], s33 offen offset:2048 sc1 lds
  buffer_load_dwordx4 v0, s[4:7], s33 offen offset:3072 sc1 lds
  s_add_u32 m0, s23, 0
  s_add_u32 s32, s32, s18
  buffer_load_dwordx4 v0, s[4:7], s32 offen offset:0 sc1 lds
  buffer_load_dwordx4 v0, s[4:7], s32 offen offset:1024 sc1 lds
  buffer_load_dwordx4 v0, s[4:7], s32 offen offset:2048 sc1 lds
  buffer_load_dwordx4 v0, s[4:7], s32 offen offset:3072 sc1 lds
  s_add_u32 m0, m0, 4096
  s_add_u32 s32, s32, 4096
  buffer_load_dwordx4 v0, s[4:7], s32 offen offset:0 sc1 lds
  buffer_load_dwordx4 v0, s[4:7], s32 offen offset:1024 sc1 lds
  buffer_load_dwordx4 v0, s[4:7], s32 offen offset:2048 sc1 lds
  buffer_load_dwordx4 v0, s[4:7], s32 offen offset:3072 sc1 lds
  s_waitcnt vmcnt(0)
  s_barrier
o_have_156:
  ds_read_b128 v[120:123], v33 offset:0
  ds_read_b128 v[40:43], v32 offset:0
  ds_read_b128 v[56:59], v32 offset:1024
  ds_read_b128 v[124:127], v33 offset:2048
  ds_read_b128 v[44:47], v32 offset:4096
  ds_read_b128 v[60:63], v32 offset:5120
  ds_read_b128 v[128:131], v33 offset:4096
  ds_read_b128 v[48:51], v32 offset:8192
  ds_read_b128 v[64:67], v32 offset:9216
  ds_read_b128 v[132:135], v33 offset:6144
  ds_read_b128 v[52:55], v32 offset:12288
  ds_read_b128 v[68:71], v32 offset:13312
  s_cmp_lt_u32 s17, 2
  s_cselect_b32 s65, s65, 0
  s_cmp_lg_u32 s65, 0
  s_cselect_b64 s[44:45], -1, 0
  s_mov_b32 s95, s86
  s_mov_b32 s96, s42
  s_lshl_b32 s97, s43, 14
  s_add_u32 s97, s97, s95
  s_and_b32 s87, s64, 0xff
  s_lshl_b32 s87, s87, 12
  s_add_u32 s87, s87, s14
  s_and_b32 s88, s63, 0xff00
  s_lshl_b32 s88, s88, 3
  s_add_u32 s88, s88, s15
  s_and_b32 s91, s65, 63
  s_lshl_b32 s90, s91, 5
  s_add_u32 s94, s90, s85
  s_add_u32 s90, s90, s43
  s_lshl_b32 s94, s94, 10
  s_lshr_b32 s92, s65, 22
  s_xor_b32 s93, s43, 32
  s_lshl_b32 s91, s90, 10
  s_add_u32 s94, s94, 25165824
  s_cmp_eq_u32 s92, s93
  s_cselect_b32 s92, s94, s91
  s_add_u32 s92, s92, 10485760
  s_and_b32 s93, s65, 49152
  s_cselect_b32 s92, s92, s91
  s_cselect_b64 s[80:81], s[4:5], s[72:73]
  s_cselect_b32 s82, s6, s74
  s_waitcnt lgkmcnt(9)
  v_mfma_f32_16x16x32_bf16 v[104:107], v[40:43], v[120:123], v[24:27]
  v_mfma_f32_16x16x32_bf16 v[108:111], v[56:59], v[120:123], v[28:31]
  s_mov_b64 exec, s[44:45]
  buffer_load_dword v7, v255, s[4:7], s97 offen sc1
  buffer_load_dwordx4 v[184:187], v0, s[80:83], s92 offen sc1
  s_not_b64 exec, exec
  buffer_load_dword v37, v36, s[4:7], s87 offen sc1
  s_mov_b64 exec, -1
  buffer_load_dword v244, v252, s[4:7], s88 offen sc1
  s_waitcnt lgkmcnt(6)
  v_mfma_f32_16x16x32_bf16 v[104:107], v[44:47], v[124:127], v[104:107]
  v_mfma_f32_16x16x32_bf16 v[108:111], v[60:63], v[124:127], v[108:111]
  s_waitcnt lgkmcnt(3)
  v_mfma_f32_16x16x32_bf16 v[104:107], v[48:51], v[128:131], v[104:107]
  v_mfma_f32_16x16x32_bf16 v[108:111], v[64:67], v[128:131], v[108:111]
  s_waitcnt lgkmcnt(0)
  v_mfma_f32_16x16x32_bf16 v[104:107], v[52:55], v[132:135], v[104:107]
  v_mfma_f32_16x16x32_bf16 v[108:111], v[68:71], v[132:135], v[108:111]
  s_cmp_lg_u32 s76, 0
  s_cbranch_scc1 o_klds_159
  v_mov_b32 v196, 0
  v_mov_b32 v199, 0
  v_exp_f32 v56, v104
  v_exp_f32 v57, v105
  v_exp_f32 v58, v106
  v_exp_f32 v59, v107
  v_exp_f32 v60, v108
  v_exp_f32 v61, v109
  v_exp_f32 v62, v110
  v_exp_f32 v63, v111
  v_max3_f32 v116, v104, v105, v106
  v_max3_f32 v116, v107, v108, v116
  v_max3_f32 v116, v109, v110, v116
  v_add_f32 v117, v56, v57
  v_add_f32 v118, v58, v59
  v_add_f32 v117, v117, v60
  v_add_f32 v118, v118, v61
  v_add_f32 v117, v117, v62
  v_add_f32 v118, v118, v63
  s_mov_b32 s67, 0
  s_and_b32 s32, s63, 0xff00
  s_lshl_b32 s32, s32, 10
  s_add_u32 s32, s32, s20
  s_add_u32 s33, s32, 4096
o_w2_157:
  s_waitcnt vmcnt(0)
  v_cmp_eq_u32 vcc, 0, v244
  s_cbranch_vccz o_kgo_167
  s_mov_b64 exec, 1
  buffer_store_dword v38, off, s[4:7], s84 sc1
  s_mov_b64 exec, -1
  s_mov_b32 s84, 268435456
  buffer_load_dword v244, v252, s[4:7], s88 offen sc1
  s_add_u32 s67, s67, 1
  s_cmp_gt_u32 s67, 1048576
  s_cbranch_scc1 L_end
  s_branch o_w2_157
o_kgo_167:
  buffer_load_dwordx4 v[136:139], v0, s[4:7], s32 offen offset:0 sc1
  buffer_load_dwordx4 v[140:143], v0, s[4:7], s32 offen offset:1024 sc1
  buffer_load_dwordx4 v[144:147], v0, s[4:7], s32 offen offset:2048 sc1
  buffer_load_dwordx4 v[148:151], v0, s[4:7], s32 offen offset:3072 sc1
  buffer_load_dwordx2 v[200:201], v1, s[4:7], s33 offen offset:0 sc1
  buffer_load_dwordx2 v[202:203], v1, s[4:7], s33 offen offset:512 sc1
  buffer_load_dwordx2 v[204:205], v1, s[4:7], s33 offen offset:1024 sc1
  buffer_load_dwordx2 v[206:207], v1, s[4:7], s33 offen offset:1536 sc1
  buffer_load_dword v37, v36, s[4:7], s87 offen sc1
  buffer_load_dword v244, v252, s[4:7], s88 offen sc1
  s_barrier
  ds_read_b128 v[152:155], v32 offset:2048
  ds_read_b128 v[156:159], v32 offset:3072
  ds_read_b128 v[160:163], v32 offset:6144
  ds_read_b128 v[164:167], v32 offset:7168
  ds_read_b128 v[168:171], v32 offset:10240
  ds_read_b128 v[172:175], v32 offset:11264
  ds_read_b128 v[176:179], v32 offset:14336
  ds_read_b128 v[180:183], v32 offset:15360
  s_waitcnt vmcnt(9)
  v_mfma_f32_16x16x32_bf16 v[112:115], v[136:139], v[120:123], 0
  s_waitcnt vmcnt(8)
  v_mfma_f32_16x16x32_bf16 v[112:115], v[140:143], v[124:127], v[112:115]
  s_waitcnt vmcnt(7)
  v_mfma_f32_16x16x32_bf16 v[112:115], v[144:147], v[128:131], v[112:115]
  s_waitcnt vmcnt(6)
  v_mfma_f32_16x16x32_bf16 v[112:115], v[148:151], v[132:135], v[112:115]
  s_waitcnt vmcnt(2)
  s_branch o_havek_158
o_klds_159:
  s_waitcnt vmcnt(12)
  s_barrier
  ds_read_b128 v[136:139], v34 offset:0
  ds_read_b128 v[140:143], v34 offset:1024
  ds_read_b128 v[144:147], v34 offset:2048
  ds_read_b128 v[148:151], v34 offset:3072
  ds_read_b64 v[200:201], v35 offset:4096
  ds_read_b64 v[202:203], v35 offset:4608
  ds_read_b64 v[204:205], v35 offset:5120
  ds_read_b64 v[206:207], v35 offset:5632
  v_mov_b32 v196, 0
  v_mov_b32 v199, 0
  v_exp_f32 v56, v104
  v_exp_f32 v57, v105
  v_exp_f32 v58, v106
  v_exp_f32 v59, v107
  v_exp_f32 v60, v108
  v_exp_f32 v61, v109
  v_exp_f32 v62, v110
  v_exp_f32 v63, v111
  v_max3_f32 v116, v104, v105, v106
  v_max3_f32 v116, v107, v108, v116
  v_max3_f32 v116, v109, v110, v116
  s_waitcnt lgkmcnt(4)
  v_mfma_f32_16x16x32_bf16 v[112:115], v[136:139], v[120:123], 0
  ds_read_b128 v[152:155], v32 offset:2048
  ds_read_b128 v[156:159], v32 offset:3072
  v_mfma_f32_16x16x32_bf16 v[112:115], v[140:143], v[124:127], v[112:115]
  ds_read_b128 v[160:163], v32 offset:6144
  ds_read_b128 v[164:167], v32 offset:7168
  v_mfma_f32_16x16x32_bf16 v[112:115], v[144:147], v[128:131], v[112:115]
  ds_read_b128 v[168:171], v32 offset:10240
  ds_read_b128 v[172:175], v32 offset:11264
  v_mfma_f32_16x16x32_bf16 v[112:115], v[148:151], v[132:135], v[112:115]
  ds_read_b128 v[176:179], v32 offset:14336
  ds_read_b128 v[180:183], v32 offset:15360
  v_add_f32 v117, v56, v57
  v_add_f32 v118, v58, v59
  v_add_f32 v117, v117, v60
  v_add_f32 v118, v118, v61
  v_add_f32 v117, v117, v62
  v_add_f32 v118, v118, v63
o_havek_158:
  s_cmp_lg_u32 s65, 0
  s_cbranch_scc1 o_wr1_164
  s_nop 3
  v_mul_f32 v112, s24, v112
  v_mul_f32 v113, s24, v113
  v_exp_f32 v64, v112
  v_exp_f32 v65, v113
  v_max_f32 v116, v111, v116
  v_max3_f32 v116, v112, v113, v116
  v_add_f32 v117, v117, v64
  v_add_f32 v118, v118, v65
  v_add_f32 v117, v117, v118
  s_mov_b32 s28, 0x21800000
  v_mov_b32 v118, v117
  s_nop 1
  v_permlane16_swap_b32 v117, v118
  v_add_f32 v117, v117, v118
  v_mov_b32 v118, v117
  s_nop 0
  s_nop 0
  v_permlane32_swap_b32 v117, v118
  v_add_f32 v117, v117, v118
  v_cmp_lt_f32 vcc, 0x42700000, v116
  v_cmp_gt_f32 s[30:31], s28, v117
  v_rcp_f32 v117, v117
  s_or_b64 vcc, vcc, s[30:31]
  s_cbranch_vccnz o_fb_168
o_fbr_169:
  v_pk_mul_f32 v[56:57], v[56:57], v[116:117] op_sel:[0,1] op_sel_hi:[1,1]
  v_pk_mul_f32 v[58:59], v[58:59], v[116:117] op_sel:[0,1] op_sel_hi:[1,1]
  v_pk_mul_f32 v[60:61], v[60:61], v[116:117] op_sel:[0,1] op_sel_hi:[1,1]
  v_pk_mul_f32 v[62:63], v[62:63], v[116:117] op_sel:[0,1] op_sel_hi:[1,1]
  v_pk_mul_f32 v[64:65], v[64:65], v[116:117] op_sel:[0,1] op_sel_hi:[1,1]
  v_cvt_pk_bf16_f32 v116, v56, v57
  v_cvt_pk_bf16_f32 v117, v58, v59
  v_cvt_pk_bf16_f32 v118, v60, v61
  v_cvt_pk_bf16_f32 v119, v62, v63
  s_waitcnt lgkmcnt(0)
  s_nop 0
  v_mfma_f32_16x16x32_bf16 v[72:75], v[152:155], v[116:119], 0
  s_add_u32 s62, s62, 1
  v_cvt_pk_bf16_f32 v197, v64, v65
  v_cvt_pk_bf16_f32 v198, v64, v65
  v_mfma_f32_16x16x32_bf16 v[76:79], v[156:159], v[116:119], 0
  s_xor_b32 s86, s86, 524288
  v_mfma_f32_16x16x32_bf16 v[80:83], v[160:163], v[116:119], 0
  s_bfe_u32 s42, s62, 0x10001
  v_mfma_f32_16x16x32_bf16 v[84:87], v[164:167], v[116:119], 0
  s_bfe_u32 s26, s64, 65556
  v_mfma_f32_16x16x32_bf16 v[88:91], v[168:171], v[116:119], 0
  s_and_b32 s87, s64, 0xff
  v_mfma_f32_16x16x32_bf16 v[92:95], v[172:175], v[116:119], 0
  s_bfe_u32 s88, s64, 0x80008
  v_mfma_f32_16x16x32_bf16 v[96:99], v[176:179], v[116:119], 0
  s_nop 0
  v_mfma_f32_16x16x32_bf16 v[100:103], v[180:183], v[116:119], 0
  s_nop 0
  v_mfma_f32_16x16x16_bf16 v[72:75], v[200:201], v[198:199], v[72:75]
  s_nop 1
  v_mfma_f32_16x16x16_bf16 v[76:79], v[200:201], v[196:197], v[76:79]
  s_nop 1
  v_mfma_f32_16x16x16_bf16 v[80:83], v[202:203], v[198:199], v[80:83]
  s_nop 1
  v_mfma_f32_16x16x16_bf16 v[84:87], v[202:203], v[196:197], v[84:87]
  s_nop 1
  v_mfma_f32_16x16x16_bf16 v[88:91], v[204:205], v[198:199], v[88:91]
  s_nop 0
  v_cvt_pk_bf16_f32 v40, v72, v73
  v_cvt_pk_bf16_f32 v41, v74, v75
  v_mfma_f32_16x16x16_bf16 v[92:95], v[204:205], v[196:197], v[92:95]
  s_nop 0
  v_cvt_pk_bf16_f32 v42, v76, v77
  v_cvt_pk_bf16_f32 v43, v78, v79
  v_mfma_f32_16x16x16_bf16 v[96:99], v[206:207], v[198:199], v[96:99]
  s_nop 0
  ds_write_b128 v6, v[40:43] offset:0
  v_cvt_pk_bf16_f32 v44, v80, v81
  v_mfma_f32_16x16x16_bf16 v[100:103], v[206:207], v[196:197], v[100:103]
  s_nop 0
  v_cvt_pk_bf16_f32 v45, v82, v83
  v_cvt_pk_bf16_f32 v46, v84, v85
  v_cvt_pk_bf16_f32 v47, v86, v87
  ds_write_b128 v6, v[44:47] offset:1024
  v_cvt_pk_bf16_f32 v48, v88, v89
  v_cvt_pk_bf16_f32 v49, v90, v91
  v_cvt_pk_bf16_f32 v50, v92, v93
  v_cvt_pk_bf16_f32 v51, v94, v95
  ds_write_b128 v6, v[48:51] offset:2048
  v_cvt_pk_bf16_f32 v52, v96, v97
  v_cvt_pk_bf16_f32 v53, v98, v99
  v_cvt_pk_bf16_f32 v54, v100, v101
  v_cvt_pk_bf16_f32 v55, v102, v103
  ds_write_b128 v6, v[52:55] offset:3072
  s_cmp_lt_u32 s17, 2
  s_cbranch_scc1 o_wr0_163
  s_waitcnt lgkmcnt(0)
  s_barrier
  ds_read_b128 v[104:107], v3 offset:0
  ds_read_b128 v[108:111], v3 offset:512
  ds_read_b128 v[112:115], v3 offset:1024
  s_waitcnt lgkmcnt(2)
  v_mfma_f32_32x32x16_bf16 v[40:55], v[104:107], a[0:3], 0
  s_waitcnt vmcnt(0)
  v_cmp_eq_u32 vcc, 0, v37
  s_cmp_eq_u64 vcc, 0
  s_cselect_b32 s66, s26, 0
  s_cmp_eq_u32 s66, 1
  s_cselect_b32 s87, s87, 1024
  s_cselect_b32 s34, 0, 0x28000
  v_mfma_f32_32x32x16_bf16 v[56:71], v[104:107], a[4:7], 0
  ds_read_b128 v[116:119], v3 offset:1536
  s_lshl_b32 s33, s87, 18
  s_lshl_b32 s32, s87, 19
  s_add_u32 m0, s22, s34
  s_add_u32 s33, s33, s19
  s_min_u32 s28, s49, 67
  v_mfma_f32_32x32x16_bf16 v[72:87], v[104:107], a[8:11], 0
  s_lshl1_add_u32 s28, s17, s28
  s_lshl_b32 s28, s28, 12
  s_add_u32 s28, s28, 243486720
  v_mfma_f32_32x32x16_bf16 v[88:103], v[104:107], a[12:15], 0
  buffer_load_dword v249, v246, s[4:7], s28 offen sc1
  s_waitcnt lgkmcnt(2)
  v_mfma_f32_32x32x16_bf16 v[40:55], v[108:111], a[16:19], v[40:55]
  buffer_load_dwordx4 v0, s[4:7], s33 offen offset:0 sc1 lds
  v_mfma_f32_32x32x16_bf16 v[56:71], v[108:111], a[20:23], v[56:71]
  ds_read_b128 v[104:107], v3 offset:2048
  v_mfma_f32_32x32x16_bf16 v[72:87], v[108:111], a[24:27], v[72:87]
  buffer_load_dwordx4 v0, s[4:7], s33 offen offset:1024 sc1 lds
  v_mfma_f32_32x32x16_bf16 v[88:103], v[108:111], a[28:31], v[88:103]
  buffer_load_dwordx4 v0, s[4:7], s33 offen offset:2048 sc1 lds
  s_waitcnt lgkmcnt(2)
  v_mfma_f32_32x32x16_bf16 v[40:55], v[112:115], a[32:35], v[40:55]
  v_mfma_f32_32x32x16_bf16 v[56:71], v[112:115], a[36:39], v[56:71]
  ds_read_b128 v[108:111], v3 offset:2560
  buffer_load_dwordx4 v0, s[4:7], s33 offen offset:3072 sc1 lds
  s_sub_u32 m0, m0, 8192
  s_sub_u32 s33, s33, 8192
  v_mfma_f32_32x32x16_bf16 v[72:87], v[112:115], a[40:43], v[72:87]
  buffer_load_dwordx4 v0, s[4:7], s33 offen offset:0 sc1 lds
  v_mfma_f32_32x32x16_bf16 v[88:103], v[112:115], a[44:47], v[88:103]
  s_waitcnt lgkmcnt(2)
  v_mfma_f32_32x32x16_bf16 v[40:55], v[116:119], a[48:51], v[40:55]
  buffer_load_dwordx4 v0, s[4:7], s33 offen offset:1024 sc1 lds
  v_mfma_f32_32x32x16_bf16 v[56:71], v[116:119], a[52:55], v[56:71]
  ds_read_b128 v[112:115], v3 offset:3072
  buffer_load_dwordx4 v0, s[4:7], s33 offen offset:2048 sc1 lds
  v_mfma_f32_32x32x16_bf16 v[72:87], v[116:119], a[56:59], v[72:87]
  v_mfma_f32_32x32x16_bf16 v[88:103], v[116:119], a[60:63], v[88:103]
  buffer_load_dwordx4 v0, s[4:7], s33 offen offset:3072 sc1 lds
  s_add_u32 m0, s23, s34
  s_add_u32 s32, s32, s18
  s_waitcnt lgkmcnt(2)
  v_mfma_f32_32x32x16_bf16 v[40:55], v[104:107], a[64:67], v[40:55]
  buffer_load_dwordx4 v0, s[4:7], s32 offen offset:0 sc1 lds
  v_mfma_f32_32x32x16_bf16 v[56:71], v[104:107], a[68:71], v[56:71]
  ds_read_b128 v[116:119], v3 offset:3584
  v_mfma_f32_32x32x16_bf16 v[72:87], v[104:107], a[72:75], v[72:87]
  buffer_load_dwordx4 v0, s[4:7], s32 offen offset:1024 sc1 lds
  s_add_i32 m0, m0, 4096
  s_add_i32 s32, s32, 4096
  v_mfma_f32_32x32x16_bf16 v[88:103], v[104:107], a[76:79], v[88:103]
  buffer_load_dwordx4 v0, s[4:7], s32 offen offset:0 sc1 lds
  s_waitcnt lgkmcnt(2)
  v_mfma_f32_32x32x16_bf16 v[40:55], v[108:111], a[80:83], v[40:55]
  v_mfma_f32_32x32x16_bf16 v[56:71], v[108:111], a[84:87], v[56:71]
  ds_read_b128 v[104:107], v3 offset:8192
  buffer_load_dwordx4 v0, s[4:7], s32 offen offset:1024 sc1 lds
  s_add_i32 m0, m0, -16384
  s_add_i32 s32, s32, -16384
  v_mfma_f32_32x32x16_bf16 v[72:87], v[108:111], a[88:91], v[72:87]
  s_and_b32 s29, s64, 0xff00
  s_lshl_b32 s29, s29, 3
  s_add_u32 s29, s29, s15
  buffer_load_dword v245, v252, s[4:7], s29 offen sc1
  v_mfma_f32_32x32x16_bf16 v[88:103], v[108:111], a[92:95], v[88:103]
  s_waitcnt lgkmcnt(2)
  v_mfma_f32_32x32x16_bf16 v[40:55], v[112:115], a[96:99], v[40:55]
  buffer_load_dwordx4 v0, s[4:7], s32 offen offset:0 sc1 lds
  v_mfma_f32_32x32x16_bf16 v[56:71], v[112:115], a[100:103], v[56:71]
  ds_read_b128 v[108:111], v3 offset:8704
  buffer_load_dwordx4 v0, s[4:7], s32 offen offset:1024 sc1 lds
  s_add_i32 m0, m0, -4096
  s_add_i32 s32, s32, -4096
  v_mfma_f32_32x32x16_bf16 v[72:87], v[112:115], a[104:107], v[72:87]
  v_mfma_f32_32x32x16_bf16 v[88:103], v[112:115], a[108:111], v[88:103]
  buffer_load_dwordx4 v0, s[4:7], s32 offen offset:0 sc1 lds
  s_waitcnt lgkmcnt(2)
  v_mfma_f32_32x32x16_bf16 v[40:55], v[116:119], a[112:115], v[40:55]
  buffer_load_dwordx4 v0, s[4:7], s32 offen offset:1024 sc1 lds
  v_mfma_f32_32x32x16_bf16 v[56:71], v[116:119], a[116:119], v[56:71]
  ds_read_b128 v[112:115], v3 offset:9216
  v_mfma_f32_32x32x16_bf16 v[72:87], v[116:119], a[120:123], v[72:87]
  buffer_load_dwordx4 v0, s[4:7], s32 offen offset:2048 sc1 lds
  v_mfma_f32_32x32x16_bf16 v[88:103], v[116:119], a[124:127], v[88:103]
  buffer_load_dwordx4 v0, s[4:7], s32 offen offset:3072 sc1 lds
  s_add_i32 m0, m0, 4096
  s_add_i32 s32, s32, 4096
  s_waitcnt lgkmcnt(2)
  v_mfma_f32_32x32x16_bf16 v[40:55], v[104:107], a[128:131], v[40:55]
  v_mfma_f32_32x32x16_bf16 v[56:71], v[104:107], a[132:135], v[56:71]
  ds_read_b128 v[116:119], v3 offset:9728
  buffer_load_dwordx4 v0, s[4:7], s32 offen offset:2048 sc1 lds
  v_mfma_f32_32x32x16_bf16 v[72:87], v[104:107], a[136:139], v[72:87]
  buffer_load_dwordx4 v0, s[4:7], s32 offen offset:3072 sc1 lds
  s_add_i32 m0, m0, 16384
  s_add_i32 s32, s32, 16384
  v_mfma_f32_32x32x16_bf16 v[88:103], v[104:107], a[140:143], v[88:103]
  s_waitcnt lgkmcnt(2)
  v_mfma_f32_32x32x16_bf16 v[40:55], v[108:111], a[144:147], v[40:55]
  buffer_load_dwordx4 v0, s[4:7], s32 offen offset:2048 sc1 lds
  v_mfma_f32_32x32x16_bf16 v[56:71], v[108:111], a[148:151], v[56:71]
  ds_read_b128 v[104:107], v3 offset:10240
  buffer_load_dwordx4 v0, s[4:7], s32 offen offset:3072 sc1 lds
  s_add_i32 m0, m0, -4096
  s_add_i32 s32, s32, -4096
  v_mfma_f32_32x32x16_bf16 v[72:87], v[108:111], a[152:155], v[72:87]
  v_mfma_f32_32x32x16_bf16 v[88:103], v[108:111], a[156:159], v[88:103]
  buffer_load_dwordx4 v0, s[4:7], s32 offen offset:2048 sc1 lds
  s_waitcnt lgkmcnt(2)
  v_mfma_f32_32x32x16_bf16 v[40:55], v[112:115], a[160:163], v[40:55]
  buffer_load_dwordx4 v0, s[4:7], s32 offen offset:3072 sc1 lds
  v_mfma_f32_32x32x16_bf16 v[56:71], v[112:115], a[164:167], v[56:71]
  ds_read_b128 v[108:111], v3 offset:10752
  v_mfma_f32_32x32x16_bf16 v[72:87], v[112:115], a[168:171], v[72:87]
  v_mfma_f32_32x32x16_bf16 v[88:103], v[112:115], a[172:175], v[88:103]
  s_waitcnt lgkmcnt(2)
  v_mfma_f32_32x32x16_bf16 v[40:55], v[116:119], a[176:179], v[40:55]
  v_mfma_f32_32x32x16_bf16 v[56:71], v[116:119], a[180:183], v[56:71]
  ds_read_b128 v[112:115], v3 offset:11264
  v_mfma_f32_32x32x16_bf16 v[72:87], v[116:119], a[184:187], v[72:87]
  v_mfma_f32_32x32x16_bf16 v[88:103], v[116:119], a[188:191], v[88:103]
  s_waitcnt lgkmcnt(2)
  v_mfma_f32_32x32x16_bf16 v[40:55], v[104:107], a[192:195], v[40:55]
  v_mfma_f32_32x32x16_bf16 v[56:71], v[104:107], a[196:199], v[56:71]
  ds_read_b128 v[116:119], v3 offset:11776
  s_waitcnt vmcnt(12)
  v_cmp_eq_u32 vcc, 0, v245
  s_cmp_eq_u64 vcc, 0
  s_cselect_b32 s76, s26, 0
  s_and_b32 s76, s76, 1
  s_cselect_b32 s88, s88, 1024
  s_waitcnt lgkmcnt(2)
  v_mfma_f32_32x32x16_bf16 v[40:55], v[108:111], a[208:211], v[40:55]
  s_lshl_b32 s32, s88, 18
  s_mov_b32 m0, s40
  s_add_u32 s32, s32, s21
  buffer_load_dwordx4 v0, s[4:7], s32 offen offset:0 sc1 lds
  v_mfma_f32_32x32x16_bf16 v[56:71], v[108:111], a[212:215], v[56:71]
  buffer_load_dwordx4 v0, s[4:7], s32 offen offset:1024 sc1 lds
  s_waitcnt lgkmcnt(1)
  v_mfma_f32_32x32x16_bf16 v[40:55], v[112:115], a[224:227], v[40:55]
  buffer_load_dwordx4 v0, s[4:7], s32 offen offset:2048 sc1 lds
  s_sub_u32 m0, m0, 8192
  s_sub_u32 s32, s32, 8192
  v_mfma_f32_32x32x16_bf16 v[56:71], v[112:115], a[228:231], v[56:71]
  buffer_load_dwordx4 v0, s[4:7], s32 offen offset:0 sc1 lds
  s_waitcnt lgkmcnt(0)
  v_mfma_f32_32x32x16_bf16 v[40:55], v[116:119], a[240:243], v[40:55]
  buffer_load_dwordx4 v0, s[4:7], s32 offen offset:1024 sc1 lds
  v_mfma_f32_32x32x16_bf16 v[56:71], v[116:119], a[244:247], v[56:71]
  buffer_load_dwordx4 v0, s[4:7], s32 offen offset:2048 sc1 lds
  v_cmp_eq_u32 vcc, 0, v249
  v_max_u32_dpp v249, v249, v249 row_ror:8 row_mask:0xf bank_mask:0xf
  s_nop 0
  v_mfma_f32_32x32x16_bf16 v[72:87], v[104:107], a[200:203], v[72:87]
  v_max_u32_dpp v249, v249, v249 row_ror:4 row_mask:0xf bank_mask:0xf
  s_nop 0
  s_nop 0
  v_max_u32_dpp v249, v249, v249 row_ror:2 row_mask:0xf bank_mask:0xf
  s_nop 0
  s_nop 0
  v_max_u32_dpp v249, v249, v249 row_ror:1 row_mask:0xf bank_mask:0xf
  s_nop 0
  v_mfma_f32_32x32x16_bf16 v[88:103], v[104:107], a[204:207], v[88:103]
  v_mov_b32 v248, v249
  s_nop 0
  s_nop 0
  v_permlane16_swap_b32 v249, v248
  v_max_u32 v249, v249, v248
  v_mfma_f32_32x32x16_bf16 v[72:87], v[108:111], a[216:219], v[72:87]
  v_mov_b32 v248, v249
  s_nop 0
  s_nop 0
  v_permlane32_swap_b32 v249, v248
  v_max_u32 v249, v249, v248
  s_cmp_eq_u64 vcc, 0
  s_cselect_b32 s28, 4, 0
  v_mfma_f32_32x32x16_bf16 v[88:103], v[108:111], a[220:223], v[88:103]
  s_lshl_b32 s26, s76, 1
  s_or_b32 s26, s26, s66
  s_or_b32 s26, s26, s28
  v_mov_b32 v248, s26
  ds_write_b64 v39, v[248:249]
  v_mfma_f32_32x32x16_bf16 v[72:87], v[112:115], a[232:235], v[72:87]
  v_cvt_pk_bf16_f32 v212, v40, v56
  v_cvt_pk_bf16_f32 v214, v41, v57
  v_cvt_pk_bf16_f32 v216, v42, v58
  v_cvt_pk_bf16_f32 v218, v43, v59
  v_permlane16_swap_b32 v212, v214
  v_mfma_f32_32x32x16_bf16 v[88:103], v[112:115], a[236:239], v[88:103]
  v_cvt_pk_bf16_f32 v220, v44, v60
  v_cvt_pk_bf16_f32 v222, v45, v61
  v_permlane16_swap_b32 v216, v218
  v_bfi_b32 v212, v254, s42, v212
  v_mfma_f32_32x32x16_bf16 v[72:87], v[116:119], a[248:251], v[72:87]
  v_cvt_pk_bf16_f32 v224, v46, v62
  v_cvt_pk_bf16_f32 v226, v47, v63
  v_permlane16_swap_b32 v220, v222
  v_bfi_b32 v216, v254, s42, v216
  v_cvt_pk_bf16_f32 v228, v48, v64
  v_mfma_f32_32x32x16_bf16 v[88:103], v[116:119], a[252:255], v[88:103]
  v_cvt_pk_bf16_f32 v230, v49, v65
  v_permlane16_swap_b32 v224, v226
  v_bfi_b32 v220, v254, s42, v220
  v_cvt_pk_bf16_f32 v232, v50, v66
  v_cvt_pk_bf16_f32 v234, v51, v67
  v_permlane16_swap_b32 v228, v230
  v_bfi_b32 v224, v254, s42, v224
  v_cvt_pk_bf16_f32 v236, v52, v68
  v_cvt_pk_bf16_f32 v238, v53, v69
  v_permlane16_swap_b32 v232, v234
  v_bfi_b32 v228, v254, s42, v228
  v_cvt_pk_bf16_f32 v240, v54, v70
  v_cvt_pk_bf16_f32 v242, v55, v71
  v_permlane16_swap_b32 v236, v238
  v_bfi_b32 v232, v254, s42, v232
  v_permlane16_swap_b32 v240, v242
  v_bfi_b32 v236, v254, s42, v236
  v_bfi_b32 v240, v254, s42, v240
  v_cvt_pk_bf16_f32 v213, v72, v88
  v_cvt_pk_bf16_f32 v215, v73, v89
  v_cvt_pk_bf16_f32 v217, v74, v90
  v_cvt_pk_bf16_f32 v219, v75, v91
  s_add_u32 s78, s86, 0
  v_permlane16_swap_b32 v213, v215
  buffer_store_dwordx4 v[212:215], v4, s[4:7], s78 offen sc1
  v_cvt_pk_bf16_f32 v221, v76, v92
  v_cvt_pk_bf16_f32 v223, v77, v93
  s_add_u32 s78, s86, 32768
  v_permlane16_swap_b32 v217, v219
  buffer_store_dwordx4 v[216:219], v4, s[4:7], s78 offen sc1
  v_cvt_pk_bf16_f32 v225, v78, v94
  v_cvt_pk_bf16_f32 v227, v79, v95
  s_add_u32 s78, s86, 131072
  v_permlane16_swap_b32 v221, v223
  buffer_store_dwordx4 v[220:223], v4, s[4:7], s78 offen sc1
  v_cvt_pk_bf16_f32 v229, v80, v96
  v_cvt_pk_bf16_f32 v231, v81, v97
  s_add_u32 s78, s86, 163840
  v_permlane16_swap_b32 v225, v227
  buffer_store_dwordx4 v[224:227], v4, s[4:7], s78 offen sc1
  v_cvt_pk_bf16_f32 v233, v82, v98
  v_cvt_pk_bf16_f32 v235, v83, v99
  s_add_u32 s78, s86, 262144
  v_permlane16_swap_b32 v229, v231
  buffer_store_dwordx4 v[228:231], v4, s[4:7], s78 offen sc1
  v_cvt_pk_bf16_f32 v237, v84, v100
  v_cvt_pk_bf16_f32 v239, v85, v101
  s_add_u32 s78, s86, 294912
  v_permlane16_swap_b32 v233, v235
  buffer_store_dwordx4 v[232:235], v4, s[4:7], s78 offen sc1
  v_cvt_pk_bf16_f32 v241, v86, v102
  v_cvt_pk_bf16_f32 v243, v87, v103
  s_add_u32 s78, s86, 393216
  v_permlane16_swap_b32 v237, v239
  buffer_store_dwordx4 v[236:239], v4, s[4:7], s78 offen sc1
  s_add_u32 s78, s86, 425984
  v_permlane16_swap_b32 v241, v243
  buffer_store_dwordx4 v[240:243], v4, s[4:7], s78 offen sc1
  s_waitcnt vmcnt(22)
  s_branch o_we_166
o_wr0_163:
  s_waitcnt lgkmcnt(0)
  s_barrier
  ds_read_b128 v[104:107], v3 offset:0
  ds_read_b128 v[108:111], v3 offset:512
  ds_read_b128 v[112:115], v3 offset:1024
  s_waitcnt lgkmcnt(2)
  v_mfma_f32_32x32x16_bf16 v[40:55], v[104:107], a[0:3], 0
  v_mfma_f32_32x32x16_bf16 v[56:71], v[104:107], a[4:7], 0
  ds_read_b128 v[116:119], v3 offset:1536
  v_mfma_f32_32x32x16_bf16 v[72:87], v[104:107], a[8:11], 0
  v_mfma_f32_32x32x16_bf16 v[88:103], v[104:107], a[12:15], 0
  s_waitcnt lgkmcnt(2)
  v_mfma_f32_32x32x16_bf16 v[40:55], v[108:111], a[16:19], v[40:55]
  v_mfma_f32_32x32x16_bf16 v[56:71], v[108:111], a[20:23], v[56:71]
  ds_read_b128 v[104:107], v3 offset:2048
  v_mfma_f32_32x32x16_bf16 v[72:87], v[108:111], a[24:27], v[72:87]
  v_mfma_f32_32x32x16_bf16 v[88:103], v[108:111], a[28:31], v[88:103]
  s_waitcnt lgkmcnt(2)
  v_mfma_f32_32x32x16_bf16 v[40:55], v[112:115], a[32:35], v[40:55]
  v_mfma_f32_32x32x16_bf16 v[56:71], v[112:115], a[36:39], v[56:71]
  ds_read_b128 v[108:111], v3 offset:2560
  v_mfma_f32_32x32x16_bf16 v[72:87], v[112:115], a[40:43], v[72:87]
  v_mfma_f32_32x32x16_bf16 v[88:103], v[112:115], a[44:47], v[88:103]
  s_waitcnt lgkmcnt(2)
  v_mfma_f32_32x32x16_bf16 v[40:55], v[116:119], a[48:51], v[40:55]
  v_mfma_f32_32x32x16_bf16 v[56:71], v[116:119], a[52:55], v[56:71]
  ds_read_b128 v[112:115], v3 offset:3072
  v_mfma_f32_32x32x16_bf16 v[72:87], v[116:119], a[56:59], v[72:87]
  v_mfma_f32_32x32x16_bf16 v[88:103], v[116:119], a[60:63], v[88:103]
  s_waitcnt lgkmcnt(2)
  v_mfma_f32_32x32x16_bf16 v[40:55], v[104:107], a[64:67], v[40:55]
  v_mfma_f32_32x32x16_bf16 v[56:71], v[104:107], a[68:71], v[56:71]
  ds_read_b128 v[116:119], v3 offset:3584
  v_mfma_f32_32x32x16_bf16 v[72:87], v[104:107], a[72:75], v[72:87]
  v_mfma_f32_32x32x16_bf16 v[88:103], v[104:107], a[76:79], v[88:103]
  s_waitcnt lgkmcnt(2)
  v_mfma_f32_32x32x16_bf16 v[40:55], v[108:111], a[80:83], v[40:55]
  v_mfma_f32_32x32x16_bf16 v[56:71], v[108:111], a[84:87], v[56:71]
  ds_read_b128 v[104:107], v3 offset:8192
  v_mfma_f32_32x32x16_bf16 v[72:87], v[108:111], a[88:91], v[72:87]
  v_mfma_f32_32x32x16_bf16 v[88:103], v[108:111], a[92:95], v[88:103]
  s_waitcnt lgkmcnt(2)
  v_mfma_f32_32x32x16_bf16 v[40:55], v[112:115], a[96:99], v[40:55]
  v_mfma_f32_32x32x16_bf16 v[56:71], v[112:115], a[100:103], v[56:71]
  ds_read_b128 v[108:111], v3 offset:8704
  v_mfma_f32_32x32x16_bf16 v[72:87], v[112:115], a[104:107], v[72:87]
  v_mfma_f32_32x32x16_bf16 v[88:103], v[112:115], a[108:111], v[88:103]
  s_waitcnt lgkmcnt(2)
  v_mfma_f32_32x32x16_bf16 v[40:55], v[116:119], a[112:115], v[40:55]
  v_mfma_f32_32x32x16_bf16 v[56:71], v[116:119], a[116:119], v[56:71]
  ds_read_b128 v[112:115], v3 offset:9216
  v_mfma_f32_32x32x16_bf16 v[72:87], v[116:119], a[120:123], v[72:87]
  v_mfma_f32_32x32x16_bf16 v[88:103], v[116:119], a[124:127], v[88:103]
  s_waitcnt lgkmcnt(2)
  v_mfma_f32_32x32x16_bf16 v[40:55], v[104:107], a[128:131], v[40:55]
  v_mfma_f32_32x32x16_bf16 v[56:71], v[104:107], a[132:135], v[56:71]
  ds_read_b128 v[116:119], v3 offset:9728
  v_mfma_f32_32x32x16_bf16 v[72:87], v[104:107], a[136:139], v[72:87]
  v_mfma_f32_32x32x16_bf16 v[88:103], v[104:107], a[140:143], v[88:103]
  s_waitcnt lgkmcnt(2)
  v_mfma_f32_32x32x16_bf16 v[40:55], v[108:111], a[144:147], v[40:55]
  v_mfma_f32_32x32x16_bf16 v[56:71], v[108:111], a[148:151], v[56:71]
  ds_read_b128 v[104:107], v3 offset:10240
  v_mfma_f32_32x32x16_bf16 v[72:87], v[108:111], a[152:155], v[72:87]
  v_mfma_f32_32x32x16_bf16 v[88:103], v[108:111], a[156:159], v[88:103]
  s_waitcnt lgkmcnt(2)
  v_mfma_f32_32x32x16_bf16 v[40:55], v[112:115], a[160:163], v[40:55]
  v_mfma_f32_32x32x16_bf16 v[56:71], v[112:115], a[164:167], v[56:71]
  ds_read_b128 v[108:111], v3 offset:10752
  v_mfma_f32_32x32x16_bf16 v[72:87], v[112:115], a[168:171], v[72:87]
  v_mfma_f32_32x32x16_bf16 v[88:103], v[112:115], a[172:175], v[88:103]
  s_waitcnt lgkmcnt(2)
  v_mfma_f32_32x32x16_bf16 v[40:55], v[116:119], a[176:179], v[40:55]
  v_mfma_f32_32x32x16_bf16 v[56:71], v[116:119], a[180:183], v[56:71]
  ds_read_b128 v[112:115], v3 offset:11264
  v_mfma_f32_32x32x16_bf16 v[72:87], v[116:119], a[184:187], v[72:87]
  v_mfma_f32_32x32x16_bf16 v[88:103], v[116:119], a[188:191], v[88:103]
  s_waitcnt lgkmcnt(2)
  v_mfma_f32_32x32x16_bf16 v[40:55], v[104:107], a[192:195], v[40:55]
  v_mfma_f32_32x32x16_bf16 v[56:71], v[104:107], a[196:199], v[56:71]
  ds_read_b128 v[116:119], v3 offset:11776
  s_waitcnt lgkmcnt(2)
  v_mfma_f32_32x32x16_bf16 v[40:55], v[108:111], a[208:211], v[40:55]
  v_mfma_f32_32x32x16_bf16 v[56:71], v[108:111], a[212:215], v[56:71]
  s_waitcnt lgkmcnt(1)
  v_mfma_f32_32x32x16_bf16 v[40:55], v[112:115], a[224:227], v[40:55]
  v_mfma_f32_32x32x16_bf16 v[56:71], v[112:115], a[228:231], v[56:71]
  s_waitcnt lgkmcnt(0)
  v_mfma_f32_32x32x16_bf16 v[40:55], v[116:119], a[240:243], v[40:55]
  v_mfma_f32_32x32x16_bf16 v[56:71], v[116:119], a[244:247], v[56:71]
  v_mfma_f32_32x32x16_bf16 v[72:87], v[104:107], a[200:203], v[72:87]
  v_mfma_f32_32x32x16_bf16 v[88:103], v[104:107], a[204:207], v[88:103]
  v_cvt_pk_bf16_f32 v212, v40, v56
  v_cvt_pk_bf16_f32 v214, v41, v57
  v_cvt_pk_bf16_f32 v216, v42, v58
  v_cvt_pk_bf16_f32 v218, v43, v59
  v_permlane16_swap_b32 v212, v214
  v_mfma_f32_32x32x16_bf16 v[72:87], v[108:111], a[216:219], v[72:87]
  v_cvt_pk_bf16_f32 v220, v44, v60
  v_cvt_pk_bf16_f32 v222, v45, v61
  v_permlane16_swap_b32 v216, v218
  v_bfi_b32 v212, v254, s42, v212
  v_cvt_pk_bf16_f32 v224, v46, v62
  v_mfma_f32_32x32x16_bf16 v[88:103], v[108:111], a[220:223], v[88:103]
  v_cvt_pk_bf16_f32 v226, v47, v63
  v_permlane16_swap_b32 v220, v222
  v_bfi_b32 v216, v254, s42, v216
  v_cvt_pk_bf16_f32 v228, v48, v64
  v_mfma_f32_32x32x16_bf16 v[72:87], v[112:115], a[232:235], v[72:87]
  v_cvt_pk_bf16_f32 v230, v49, v65
  v_permlane16_swap_b32 v224, v226
  v_bfi_b32 v220, v254, s42, v220
  v_cvt_pk_bf16_f32 v232, v50, v66
  v_cvt_pk_bf16_f32 v234, v51, v67
  v_mfma_f32_32x32x16_bf16 v[88:103], v[112:115], a[236:239], v[88:103]
  v_permlane16_swap_b32 v228, v230
  v_bfi_b32 v224, v254, s42, v224
  v_cvt_pk_bf16_f32 v236, v52, v68
  v_cvt_pk_bf16_f32 v238, v53, v69
  v_mfma_f32_32x32x16_bf16 v[72:87], v[116:119], a[248:251], v[72:87]
  v_permlane16_swap_b32 v232, v234
  v_bfi_b32 v228, v254, s42, v228
  v_cvt_pk_bf16_f32 v240, v54, v70
  v_cvt_pk_bf16_f32 v242, v55, v71
  v_permlane16_swap_b32 v236, v238
  v_mfma_f32_32x32x16_bf16 v[88:103], v[116:119], a[252:255], v[88:103]
  v_bfi_b32 v232, v254, s42, v232
  v_permlane16_swap_b32 v240, v242
  v_bfi_b32 v236, v254, s42, v236
  v_bfi_b32 v240, v254, s42, v240
  s_nop 7
  v_cvt_pk_bf16_f32 v213, v72, v88
  v_cvt_pk_bf16_f32 v215, v73, v89
  v_cvt_pk_bf16_f32 v217, v74, v90
  v_cvt_pk_bf16_f32 v219, v75, v91
  s_add_u32 s78, s86, 0
  v_permlane16_swap_b32 v213, v215
  buffer_store_dwordx4 v[212:215], v4, s[4:7], s78 offen sc1
  v_cvt_pk_bf16_f32 v221, v76, v92
  v_cvt_pk_bf16_f32 v223, v77, v93
  s_add_u32 s78, s86, 32768
  v_permlane16_swap_b32 v217, v219
  buffer_store_dwordx4 v[216:219], v4, s[4:7], s78 offen sc1
  v_cvt_pk_bf16_f32 v225, v78, v94
  v_cvt_pk_bf16_f32 v227, v79, v95
  s_add_u32 s78, s86, 131072
  v_permlane16_swap_b32 v221, v223
  buffer_store_dwordx4 v[220:223], v4, s[4:7], s78 offen sc1
  v_cvt_pk_bf16_f32 v229, v80, v96
  v_cvt_pk_bf16_f32 v231, v81, v97
  s_add_u32 s78, s86, 163840
  v_permlane16_swap_b32 v225, v227
  buffer_store_dwordx4 v[224:227], v4, s[4:7], s78 offen sc1
  v_cvt_pk_bf16_f32 v233, v82, v98
  v_cvt_pk_bf16_f32 v235, v83, v99
  s_add_u32 s78, s86, 262144
  v_permlane16_swap_b32 v229, v231
  buffer_store_dwordx4 v[228:231], v4, s[4:7], s78 offen sc1
  v_cvt_pk_bf16_f32 v237, v84, v100
  v_cvt_pk_bf16_f32 v239, v85, v101
  s_add_u32 s78, s86, 294912
  v_permlane16_swap_b32 v233, v235
  buffer_store_dwordx4 v[232:235], v4, s[4:7], s78 offen sc1
  v_cvt_pk_bf16_f32 v241, v86, v102
  v_cvt_pk_bf16_f32 v243, v87, v103
  s_add_u32 s78, s86, 393216
  v_permlane16_swap_b32 v237, v239
  buffer_store_dwordx4 v[236:239], v4, s[4:7], s78 offen sc1
  s_add_u32 s78, s86, 425984
  v_permlane16_swap_b32 v241, v243
  buffer_store_dwordx4 v[240:243], v4, s[4:7], s78 offen sc1
  s_branch o_we_166
o_wr1_164:
  s_nop 3
  v_mul_f32 v112, s24, v112
  v_mul_f32 v113, s24, v113
  v_exp_f32 v64, v112
  v_exp_f32 v65, v113
  v_max_f32 v116, v111, v116
  v_max3_f32 v116, v112, v113, v116
  v_add_f32 v117, v117, v64
  v_add_f32 v118, v118, v65
  v_add_f32 v117, v117, v118
  s_mov_b32 s28, 0x21800000
  v_mov_b32 v118, v117
  s_nop 1
  v_permlane16_swap_b32 v117, v118
  v_add_f32 v117, v117, v118
  v_mov_b32 v118, v117
  s_nop 0
  s_nop 0
  v_permlane32_swap_b32 v117, v118
  v_add_f32 v117, v117, v118
  s_mov_b32 s67, 0
  s_mov_b64 vcc, 0
  s_waitcnt vmcnt(3)
o_pl_172:
  v_and_b32 v7, 1, v7
  v_cmp_ne_u32 vcc, s96, v7
  s_cbranch_vccz o_pk_173
  buffer_load_dword v7, v255, s[4:7], s97 offen sc1
  s_add_u32 s67, s67, 1
  s_cmp_gt_u32 s67, 1048576
  s_cbranch_scc1 L_end
  s_waitcnt vmcnt(0)
  s_branch o_pl_172
o_pk_173:
  s_lshl_b32 s94, s43, 14
  s_add_u32 s94, s94, s95
  buffer_load_dwordx4 v[120:123], v5, s[4:7], s94 offen offset:0 sc1
  v_cmp_lt_f32 vcc, 0x42700000, v116
  v_cmp_gt_f32 s[30:31], s28, v117
  v_rcp_f32 v117, v117
  buffer_load_dwordx4 v[124:127], v5, s[4:7], s94 offen offset:512 sc1
  s_or_b64 vcc, vcc, s[30:31]
  s_cbranch_vccnz o_fb_170
o_fbr_171:
  buffer_load_dwordx4 v[128:131], v5, s[4:7], s94 offen offset:256 sc1
  v_pk_mul_f32 v[56:57], v[56:57], v[116:117] op_sel:[0,1] op_sel_hi:[1,1]
  v_pk_mul_f32 v[58:59], v[58:59], v[116:117] op_sel:[0,1] op_sel_hi:[1,1]
  v_pk_mul_f32 v[60:61], v[60:61], v[116:117] op_sel:[0,1] op_sel_hi:[1,1]
  v_pk_mul_f32 v[62:63], v[62:63], v[116:117] op_sel:[0,1] op_sel_hi:[1,1]
  v_pk_mul_f32 v[64:65], v[64:65], v[116:117] op_sel:[0,1] op_sel_hi:[1,1]
  buffer_load_dwordx4 v[132:135], v5, s[4:7], s94 offen offset:768 sc1
  v_cvt_pk_bf16_f32 v116, v56, v57
  v_cvt_pk_bf16_f32 v117, v58, v59
  v_cvt_pk_bf16_f32 v118, v60, v61
  v_cvt_pk_bf16_f32 v119, v62, v63
  s_waitcnt lgkmcnt(0)
  s_nop 0
  v_mfma_f32_16x16x32_bf16 v[72:75], v[152:155], v[116:119], 0
  s_add_u32 s62, s62, 1
  v_cvt_pk_bf16_f32 v197, v64, v65
  v_cvt_pk_bf16_f32 v198, v64, v65
  v_mfma_f32_16x16x32_bf16 v[76:79], v[156:159], v[116:119], 0
  s_add_u32 s94, s94, 4096
  buffer_load_dwordx4 v[136:139], v5, s[4:7], s94 offen offset:0 sc1
  s_xor_b32 s86, s86, 524288
  v_mfma_f32_16x16x32_bf16 v[80:83], v[160:163], v[116:119], 0
  s_bfe_u32 s42, s62, 0x10001
  v_mfma_f32_16x16x32_bf16 v[84:87], v[164:167], v[116:119], 0
  buffer_load_dwordx4 v[140:143], v5, s[4:7], s94 offen offset:512 sc1
  v_mfma_f32_16x16x32_bf16 v[88:91], v[168:171], v[116:119], 0
  v_mfma_f32_16x16x32_bf16 v[92:95], v[172:175], v[116:119], 0
  buffer_load_dwordx4 v[144:147], v5, s[4:7], s94 offen offset:256 sc1
  v_mfma_f32_16x16x32_bf16 v[96:99], v[176:179], v[116:119], 0
  v_mfma_f32_16x16x32_bf16 v[100:103], v[180:183], v[116:119], 0
  buffer_load_dwordx4 v[148:151], v5, s[4:7], s94 offen offset:768 sc1
  v_mfma_f32_16x16x16_bf16 v[72:75], v[200:201], v[198:199], v[72:75]
  s_nop 1
  v_mfma_f32_16x16x16_bf16 v[76:79], v[200:201], v[196:197], v[76:79]
  s_add_u32 s94, s94, 4096
  buffer_load_dwordx4 v[152:155], v5, s[4:7], s94 offen offset:0 sc1
  v_mfma_f32_16x16x16_bf16 v[80:83], v[202:203], v[198:199], v[80:83]
  s_nop 1
  v_mfma_f32_16x16x16_bf16 v[84:87], v[202:203], v[196:197], v[84:87]
  buffer_load_dwordx4 v[156:159], v5, s[4:7], s94 offen offset:512 sc1
  v_mfma_f32_16x16x16_bf16 v[88:91], v[204:205], v[198:199], v[88:91]
  s_nop 0
  v_cvt_pk_bf16_f32 v40, v72, v73
  v_cvt_pk_bf16_f32 v41, v74, v75
  v_mfma_f32_16x16x16_bf16 v[92:95], v[204:205], v[196:197], v[92:95]
  buffer_load_dwordx4 v[160:163], v5, s[4:7], s94 offen offset:256 sc1
  v_cvt_pk_bf16_f32 v42, v76, v77
  v_cvt_pk_bf16_f32 v43, v78, v79
  v_mfma_f32_16x16x16_bf16 v[96:99], v[206:207], v[198:199], v[96:99]
  s_nop 0
  ds_write_b128 v6, v[40:43] offset:0
  v_cvt_pk_bf16_f32 v44, v80, v81
  v_mfma_f32_16x16x16_bf16 v[100:103], v[206:207], v[196:197], v[100:103]
  buffer_load_dwordx4 v[164:167], v5, s[4:7], s94 offen offset:768 sc1
  v_cvt_pk_bf16_f32 v45, v82, v83
  v_cvt_pk_bf16_f32 v46, v84, v85
  v_cvt_pk_bf16_f32 v47, v86, v87
  ds_write_b128 v6, v[44:47] offset:1024
  v_cvt_pk_bf16_f32 v48, v88, v89
  v_cvt_pk_bf16_f32 v49, v90, v91
  v_cvt_pk_bf16_f32 v50, v92, v93
  v_cvt_pk_bf16_f32 v51, v94, v95
  s_add_u32 s94, s94, 4096
  buffer_load_dwordx4 v[168:171], v5, s[4:7], s94 offen offset:0 sc1
  ds_write_b128 v6, v[48:51] offset:2048
  v_cvt_pk_bf16_f32 v52, v96, v97
  v_cvt_pk_bf16_f32 v53, v98, v99
  v_cvt_pk_bf16_f32 v54, v100, v101
  v_cvt_pk_bf16_f32 v55, v102, v103
  ds_write_b128 v6, v[52:55] offset:3072
  buffer_load_dwordx4 v[172:175], v5, s[4:7], s94 offen offset:512 sc1
  s_and_b32 s26, s65, 49152
  s_cbranch_scc1 o_wr2_165
  s_waitcnt lgkmcnt(0)
  s_barrier
  ds_read_b128 v[104:107], v3 offset:0
  ds_read_b128 v[108:111], v3 offset:512
  ds_read_b128 v[112:115], v3 offset:1024
  buffer_load_dwordx4 v[176:179], v5, s[4:7], s94 offen offset:256 sc1
  buffer_load_dwordx4 v[180:183], v5, s[4:7], s94 offen offset:768 sc1
  s_waitcnt lgkmcnt(2)
  v_mfma_f32_32x32x16_bf16 v[40:55], v[104:107], a[0:3], 0
  v_mov_b64 v[188:189], 0
  v_mov_b64 v[190:191], 0
  v_mov_b64 v[192:193], 0
  v_mov_b64 v[194:195], 0
  s_mov_b64 exec, 1
  buffer_store_dword v38, off, s[4:7], s84 sc1
  s_mov_b64 exec, -1
  s_mov_b32 s84, 268435456
  v_mfma_f32_32x32x16_bf16 v[56:71], v[104:107], a[4:7], 0
  ds_read_b128 v[116:119], v3 offset:1536
  v_mfma_f32_32x32x16_bf16 v[72:87], v[104:107], a[8:11], 0
  v_mfma_f32_32x32x16_bf16 v[88:103], v[104:107], a[12:15], 0
  s_waitcnt vmcnt(13)
  v_xor_b32 v7, s96, v120
  v_bitop3_b32 v7, v7, v124, s96 bitop3:0xf6
  v_bitop3_b32 v7, v7, v128, s96 bitop3:0xf6
  v_bitop3_b32 v7, v7, v132, s96 bitop3:0xf6
  s_waitcnt lgkmcnt(2)
  v_mfma_f32_32x32x16_bf16 v[40:55], v[108:111], a[16:19], v[40:55]
  s_waitcnt vmcnt(9)
  v_bitop3_b32 v7, v7, v136, s96 bitop3:0xf6
  v_bitop3_b32 v7, v7, v140, s96 bitop3:0xf6
  v_bitop3_b32 v7, v7, v144, s96 bitop3:0xf6
  v_bitop3_b32 v7, v7, v148, s96 bitop3:0xf6
  s_waitcnt vmcnt(5)
  v_mfma_f32_32x32x16_bf16 v[56:71], v[108:111], a[20:23], v[56:71]
  ds_read_b128 v[104:107], v3 offset:2048
  v_bitop3_b32 v7, v7, v152, s96 bitop3:0xf6
  v_bitop3_b32 v7, v7, v156, s96 bitop3:0xf6
  v_bitop3_b32 v7, v7, v160, s96 bitop3:0xf6
  v_bitop3_b32 v7, v7, v164, s96 bitop3:0xf6
  s_waitcnt vmcnt(1)
  v_mfma_f32_32x32x16_bf16 v[72:87], v[108:111], a[24:27], v[72:87]
  v_bitop3_b32 v7, v7, v168, s96 bitop3:0xf6
  v_bitop3_b32 v7, v7, v172, s96 bitop3:0xf6
  v_bitop3_b32 v7, v7, v176, s96 bitop3:0xf6
  v_bitop3_b32 v7, v7, v180, s96 bitop3:0xf6
  v_and_b32 v7, v254, v7
  v_cmp_ne_u32 vcc, 0, v7
  s_cbranch_vccnz o_rt_174
o_bk_175:
  v_mfma_f32_32x32x16_bf16 v[88:103], v[108:111], a[28:31], v[88:103]
  v_smfmac_f32_16x16x64_bf16 v[188:191], v[16:19], v[120:127], v20
  v_lshlrev_b32 v196, 16, v184
  v_smfmac_f32_16x16x64_bf16 v[192:195], v[16:19], v[128:135], v20
  v_and_b32 v197, 0xffff0000, v184
  v_smfmac_f32_16x16x64_bf16 v[188:191], v[16:19], v[136:143], v20
  v_lshlrev_b32 v198, 16, v185
  s_waitcnt lgkmcnt(2)
  v_mfma_f32_32x32x16_bf16 v[40:55], v[112:115], a[32:35], v[40:55]
  v_smfmac_f32_16x16x64_bf16 v[192:195], v[16:19], v[144:151], v20
  v_and_b32 v199, 0xffff0000, v185
  v_smfmac_f32_16x16x64_bf16 v[188:191], v[16:19], v[152:159], v20
  v_lshlrev_b32 v200, 16, v186
  v_smfmac_f32_16x16x64_bf16 v[192:195], v[16:19], v[160:167], v20
  v_and_b32 v201, 0xffff0000, v186
  v_mfma_f32_32x32x16_bf16 v[56:71], v[112:115], a[36:39], v[56:71]
  ds_read_b128 v[108:111], v3 offset:2560
  v_smfmac_f32_16x16x64_bf16 v[188:191], v[16:19], v[168:175], v20
  v_lshlrev_b32 v202, 16, v187
  v_smfmac_f32_16x16x64_bf16 v[192:195], v[16:19], v[176:183], v20
  v_and_b32 v203, 0xffff0000, v187
  s_bfe_u32 s92, s65, 131086
  v_mfma_f32_32x32x16_bf16 v[72:87], v[112:115], a[40:43], v[72:87]
  s_lshl_b32 s92, s92, 21
  s_add_u32 s92, s92, s91
  s_add_u32 s93, s92, 27262976
  s_add_u32 s92, s92, 20971520
  v_permlane16_swap_b32 v188, v192
  v_mfma_f32_32x32x16_bf16 v[88:103], v[112:115], a[44:47], v[88:103]
  v_permlane16_swap_b32 v189, v193
  v_permlane16_swap_b32 v190, v194
  v_permlane16_swap_b32 v191, v195
  s_waitcnt lgkmcnt(2)
  v_mfma_f32_32x32x16_bf16 v[40:55], v[116:119], a[48:51], v[40:55]
  v_cvt_pk_bf16_f32 v188, 0, v188
  v_cvt_pk_bf16_f32 v189, 0, v189
  v_cvt_pk_bf16_f32 v190, 0, v190
  v_cvt_pk_bf16_f32 v191, 0, v191
  v_cvt_pk_bf16_f32 v192, 0, v192
  v_cvt_pk_bf16_f32 v193, 0, v193
  v_mfma_f32_32x32x16_bf16 v[56:71], v[116:119], a[52:55], v[56:71]
  ds_read_b128 v[112:115], v3 offset:3072
  v_cvt_pk_bf16_f32 v194, 0, v194
  v_cvt_pk_bf16_f32 v195, 0, v195
  v_add_f32 v196, v196, v188
  v_add_f32 v197, v197, v189
  v_add_f32 v198, v198, v190
  v_mfma_f32_32x32x16_bf16 v[72:87], v[116:119], a[56:59], v[72:87]
  v_add_f32 v199, v199, v191
  v_add_f32 v200, v200, v192
  v_add_f32 v201, v201, v193
  v_add_f32 v202, v202, v194
  v_add_f32 v203, v203, v195
  v_cvt_pk_bf16_f32 v120, v196, v197
  v_mfma_f32_32x32x16_bf16 v[88:103], v[116:119], a[60:63], v[88:103]
  v_cvt_pk_bf16_f32 v121, v198, v199
  v_cvt_pk_bf16_f32 v122, v200, v201
  v_cvt_pk_bf16_f32 v123, v202, v203
  v_lshlrev_b32 v196, 16, v120
  v_and_b32 v197, 0xffff0000, v120
  s_waitcnt lgkmcnt(2)
  v_mfma_f32_32x32x16_bf16 v[40:55], v[104:107], a[64:67], v[40:55]
  v_lshlrev_b32 v198, 16, v121
  v_and_b32 v199, 0xffff0000, v121
  v_lshlrev_b32 v200, 16, v122
  v_and_b32 v201, 0xffff0000, v122
  v_lshlrev_b32 v202, 16, v123
  v_and_b32 v203, 0xffff0000, v123
  v_mfma_f32_32x32x16_bf16 v[56:71], v[104:107], a[68:71], v[56:71]
  ds_read_b128 v[116:119], v3 offset:3584
  buffer_store_dwordx4 v[120:123], v0, s[4:7], s92 offen sc1
  v_add_f32 v136, v196, v197
  v_mul_f32 v137, v196, v196
  v_mfma_f32_32x32x16_bf16 v[72:87], v[104:107], a[72:75], v[72:87]
  v_add_f32 v138, v198, v199
  v_mul_f32 v139, v197, v197
  v_fmac_f32 v137, v198, v198
  v_fmac_f32 v139, v199, v199
  v_add_f32 v136, v136, v200
  v_fmac_f32 v137, v200, v200
  v_mfma_f32_32x32x16_bf16 v[88:103], v[104:107], a[76:79], v[88:103]
  v_add_f32 v138, v138, v201
  v_fmac_f32 v139, v201, v201
  v_add_f32 v136, v136, v202
  v_fmac_f32 v137, v202, v202
  v_add_f32 v138, v138, v203
  s_waitcnt lgkmcnt(2)
  v_mfma_f32_32x32x16_bf16 v[40:55], v[108:111], a[80:83], v[40:55]
  v_fmac_f32 v139, v203, v203
  v_add_f32 v136, v136, v138
  v_add_f32 v137, v137, v139
  s_nop 0
  v_add_f32_dpp v136, v136, v136 row_ror:8 row_mask:0xf bank_mask:0xf
  v_add_f32_dpp v137, v137, v137 row_ror:8 row_mask:0xf bank_mask:0xf
  s_nop 0
  v_add_f32_dpp v136, v136, v136 row_ror:4 row_mask:0xf bank_mask:0xf
  v_mfma_f32_32x32x16_bf16 v[56:71], v[108:111], a[84:87], v[56:71]
  ds_read_b128 v[104:107], v3 offset:8192
  v_add_f32_dpp v137, v137, v137 row_ror:4 row_mask:0xf bank_mask:0xf
  v_add_f32_dpp v136, v136, v136 row_ror:2 row_mask:0xf bank_mask:0xf
  s_nop 0
  v_add_f32_dpp v137, v137, v137 row_ror:2 row_mask:0xf bank_mask:0xf
  v_add_f32_dpp v136, v136, v136 row_ror:1 row_mask:0xf bank_mask:0xf
  s_nop 0
  v_add_f32_dpp v137, v137, v137 row_ror:1 row_mask:0xf bank_mask:0xf
  v_mfma_f32_32x32x16_bf16 v[72:87], v[108:111], a[88:91], v[72:87]
  v_mov_b32 v140, v136
  v_mov_b32 v141, v137
  s_nop 0
  v_permlane16_swap_b32 v136, v140
  v_permlane16_swap_b32 v137, v141
  v_mfma_f32_32x32x16_bf16 v[88:103], v[108:111], a[92:95], v[88:103]
  v_add_f32 v136, v136, v140
  v_add_f32 v137, v137, v141
  v_mov_b32 v140, v136
  v_mov_b32 v141, v137
  s_nop 0
  v_permlane32_swap_b32 v136, v140
  s_waitcnt lgkmcnt(2)
  v_mfma_f32_32x32x16_bf16 v[40:55], v[112:115], a[96:99], v[40:55]
  v_permlane32_swap_b32 v137, v141
  v_add_f32 v136, v136, v140
  v_add_f32 v137, v137, v141
  v_mul_f32 v136, 0x3b000000, v136
  v_mul_f32 v137, 0x3b000000, v137
  v_mfma_f32_32x32x16_bf16 v[56:71], v[112:115], a[100:103], v[56:71]
  ds_read_b128 v[108:111], v3 offset:8704
  v_fma_f32 v137, -v136, v136, v137
  v_cvt_pk_bf16_f32 v136, 0, v136
  v_max_f32 v137, 0, v137
  v_sub_f32 v140, v196, v136
  v_sub_f32 v141, v197, v136
  v_mfma_f32_32x32x16_bf16 v[72:87], v[112:115], a[104:107], v[72:87]
  v_cvt_pk_bf16_f32 v137, 0, v137
  v_sub_f32 v142, v198, v136
  v_sub_f32 v143, v199, v136
  v_add_f32 v137, 0x3727c5ac, v137
  v_sub_f32 v144, v200, v136
  v_sub_f32 v145, v201, v136
  v_mfma_f32_32x32x16_bf16 v[88:103], v[112:115], a[108:111], v[88:103]
  v_cvt_pk_bf16_f32 v137, 0, v137
  v_sub_f32 v146, v202, v136
  v_sub_f32 v147, v203, v136
  v_sqrt_f32 v137, v137
  s_waitcnt lgkmcnt(2)
  v_mfma_f32_32x32x16_bf16 v[40:55], v[116:119], a[112:115], v[40:55]
  v_cvt_pk_bf16_f32 v140, 0, v140
  v_cvt_pk_bf16_f32 v141, 0, v141
  v_cvt_pk_bf16_f32 v137, 0, v137
  v_cvt_pk_bf16_f32 v142, 0, v142
  v_cvt_pk_bf16_f32 v143, 0, v143
  v_rcp_f32 v137, v137
  v_mfma_f32_32x32x16_bf16 v[56:71], v[116:119], a[116:119], v[56:71]
  ds_read_b128 v[112:115], v3 offset:9216
  v_cvt_pk_bf16_f32 v144, 0, v144
  v_cvt_pk_bf16_f32 v145, 0, v145
  v_cvt_pk_bf16_f32 v146, 0, v146
  v_cvt_pk_bf16_f32 v147, 0, v147
  v_mul_f32 v140, v140, v137
  v_mfma_f32_32x32x16_bf16 v[72:87], v[116:119], a[120:123], v[72:87]
  v_mul_f32 v141, v141, v137
  v_mul_f32 v142, v142, v137
  v_mul_f32 v143, v143, v137
  v_mul_f32 v144, v144, v137
  v_mul_f32 v145, v145, v137
  v_mul_f32 v146, v146, v137
  v_mfma_f32_32x32x16_bf16 v[88:103], v[116:119], a[124:127], v[88:103]
  v_mul_f32 v147, v147, v137
  v_cvt_pk_bf16_f32 v124, v140, v141
  v_cvt_pk_bf16_f32 v125, v142, v143
  v_cvt_pk_bf16_f32 v126, v144, v145
  v_cvt_pk_bf16_f32 v127, v146, v147
  s_waitcnt lgkmcnt(2)
  v_mfma_f32_32x32x16_bf16 v[40:55], v[104:107], a[128:131], v[40:55]
  v_lshlrev_b32 v204, 16, v124
  v_and_b32 v205, 0xffff0000, v124
  v_lshlrev_b32 v206, 16, v125
  v_and_b32 v207, 0xffff0000, v125
  v_lshlrev_b32 v208, 16, v126
  v_and_b32 v209, 0xffff0000, v126
  v_mfma_f32_32x32x16_bf16 v[56:71], v[104:107], a[132:135], v[56:71]
  ds_read_b128 v[116:119], v3 offset:9728
  v_lshlrev_b32 v210, 16, v127
  v_and_b32 v211, 0xffff0000, v127
  buffer_store_dwordx4 v[124:127], v0, s[4:7], s93 offen sc1
  v_mfma_f32_32x32x16_bf16 v[72:87], v[104:107], a[136:139], v[72:87]
  v_add_f32 v196, v196, v204
  v_add_f32 v197, v197, v205
  v_add_f32 v198, v198, v206
  v_add_f32 v199, v199, v207
  v_add_f32 v200, v200, v208
  v_add_f32 v201, v201, v209
  v_mfma_f32_32x32x16_bf16 v[88:103], v[104:107], a[140:143], v[88:103]
  v_add_f32 v202, v202, v210
  v_add_f32 v203, v203, v211
  v_cvt_pk_bf16_f32 v128, v196, v197
  v_cvt_pk_bf16_f32 v129, v198, v199
  v_cvt_pk_bf16_f32 v130, v200, v201
  s_waitcnt lgkmcnt(2)
  v_mfma_f32_32x32x16_bf16 v[40:55], v[108:111], a[144:147], v[40:55]
  v_cvt_pk_bf16_f32 v131, v202, v203
  v_mul_f32 v188, v204, v8
  v_mul_f32 v189, v205, v9
  v_fmac_f32 v188, v206, v10
  v_fmac_f32 v189, v207, v11
  v_fmac_f32 v188, v208, v12
  v_mfma_f32_32x32x16_bf16 v[56:71], v[108:111], a[148:151], v[56:71]
  ds_read_b128 v[104:107], v3 offset:10240
  v_fmac_f32 v189, v209, v13
  v_fmac_f32 v188, v210, v14
  v_fmac_f32 v189, v211, v15
  v_add_f32 v188, v188, v189
  s_add_u32 s92, s91, 10485760
  v_mfma_f32_32x32x16_bf16 v[72:87], v[108:111], a[152:155], v[72:87]
  s_add_u32 s93, s91, 8388608
  buffer_store_dwordx4 v[128:131], v0, s[4:7], s92 offen sc1
  v_lshlrev_b32 v196, 16, v128
  v_and_b32 v197, 0xffff0000, v128
  v_mfma_f32_32x32x16_bf16 v[88:103], v[108:111], a[156:159], v[88:103]
  v_lshlrev_b32 v198, 16, v129
  v_and_b32 v199, 0xffff0000, v129
  v_lshlrev_b32 v200, 16, v130
  v_and_b32 v201, 0xffff0000, v130
  v_lshlrev_b32 v202, 16, v131
  s_waitcnt lgkmcnt(2)
  v_mfma_f32_32x32x16_bf16 v[40:55], v[112:115], a[160:163], v[40:55]
  v_and_b32 v203, 0xffff0000, v131
  v_add_f32 v136, v196, v197
  v_mul_f32 v137, v196, v196
  v_add_f32 v138, v198, v199
  v_mul_f32 v139, v197, v197
  v_fmac_f32 v137, v198, v198
  v_mfma_f32_32x32x16_bf16 v[56:71], v[112:115], a[164:167], v[56:71]
  ds_read_b128 v[108:111], v3 offset:10752
  v_fmac_f32 v139, v199, v199
  v_add_f32 v136, v136, v200
  v_fmac_f32 v137, v200, v200
  v_add_f32 v138, v138, v201
  v_fmac_f32 v139, v201, v201
  v_mfma_f32_32x32x16_bf16 v[72:87], v[112:115], a[168:171], v[72:87]
  v_add_f32 v136, v136, v202
  v_fmac_f32 v137, v202, v202
  v_add_f32 v138, v138, v203
  v_fmac_f32 v139, v203, v203
  v_add_f32 v136, v136, v138
  v_add_f32 v137, v137, v139
  v_mfma_f32_32x32x16_bf16 v[88:103], v[112:115], a[172:175], v[88:103]
  v_add_f32_dpp v136, v136, v136 row_ror:8 row_mask:0xf bank_mask:0xf
  v_add_f32_dpp v137, v137, v137 row_ror:8 row_mask:0xf bank_mask:0xf
  v_add_f32_dpp v188, v188, v188 row_ror:8 row_mask:0xf bank_mask:0xf
  v_add_f32_dpp v136, v136, v136 row_ror:4 row_mask:0xf bank_mask:0xf
  v_add_f32_dpp v137, v137, v137 row_ror:4 row_mask:0xf bank_mask:0xf
  s_waitcnt lgkmcnt(2)
  v_mfma_f32_32x32x16_bf16 v[40:55], v[116:119], a[176:179], v[40:55]
  v_add_f32_dpp v188, v188, v188 row_ror:4 row_mask:0xf bank_mask:0xf
  v_add_f32_dpp v136, v136, v136 row_ror:2 row_mask:0xf bank_mask:0xf
  v_add_f32_dpp v137, v137, v137 row_ror:2 row_mask:0xf bank_mask:0xf
  v_add_f32_dpp v188, v188, v188 row_ror:2 row_mask:0xf bank_mask:0xf
  v_add_f32_dpp v136, v136, v136 row_ror:1 row_mask:0xf bank_mask:0xf
  v_add_f32_dpp v137, v137, v137 row_ror:1 row_mask:0xf bank_mask:0xf
  v_mfma_f32_32x32x16_bf16 v[56:71], v[116:119], a[180:183], v[56:71]
  ds_read_b128 v[112:115], v3 offset:11264
  v_add_f32_dpp v188, v188, v188 row_ror:1 row_mask:0xf bank_mask:0xf
  v_mov_b32 v140, v136
  v_mov_b32 v141, v137
  v_mov_b32 v142, v188
  v_permlane16_swap_b32 v136, v140
  v_mfma_f32_32x32x16_bf16 v[72:87], v[116:119], a[184:187], v[72:87]
  v_permlane16_swap_b32 v137, v141
  v_permlane16_swap_b32 v188, v142
  v_add_f32 v136, v136, v140
  v_add_f32 v137, v137, v141
  v_mfma_f32_32x32x16_bf16 v[88:103], v[116:119], a[188:191], v[88:103]
  v_add_f32 v188, v188, v142
  v_mov_b32 v140, v136
  v_mov_b32 v141, v137
  v_mov_b32 v142, v188
  v_permlane32_swap_b32 v136, v140
  s_waitcnt lgkmcnt(2)
  v_mfma_f32_32x32x16_bf16 v[40:55], v[104:107], a[192:195], v[40:55]
  v_permlane32_swap_b32 v137, v141
  v_permlane32_swap_b32 v188, v142
  v_add_f32 v136, v136, v140
  v_add_f32 v137, v137, v141
  v_mfma_f32_32x32x16_bf16 v[56:71], v[104:107], a[196:199], v[56:71]
  ds_read_b128 v[116:119], v3 offset:11776
  v_add_f32 v188, v188, v142
  v_mul_f32 v136, 0x3b000000, v136
  v_mul_f32 v137, 0x3b000000, v137
  v_fma_f32 v137, -v136, v136, v137
  v_cvt_pk_bf16_f32 v136, 0, v136
  s_waitcnt lgkmcnt(2)
  v_mfma_f32_32x32x16_bf16 v[40:55], v[108:111], a[208:211], v[40:55]
  v_max_f32 v137, 0, v137
  v_sub_f32 v140, v196, v136
  v_sub_f32 v141, v197, v136
  v_cvt_pk_bf16_f32 v137, 0, v137
  v_sub_f32 v142, v198, v136
  v_sub_f32 v143, v199, v136
  v_mfma_f32_32x32x16_bf16 v[56:71], v[108:111], a[212:215], v[56:71]
  v_add_f32 v137, 0x3727c5ac, v137
  v_sub_f32 v144, v200, v136
  v_sub_f32 v145, v201, v136
  v_cvt_pk_bf16_f32 v137, 0, v137
  v_sub_f32 v146, v202, v136
  v_sub_f32 v147, v203, v136
  s_waitcnt lgkmcnt(1)
  v_mfma_f32_32x32x16_bf16 v[40:55], v[112:115], a[224:227], v[40:55]
  v_sqrt_f32 v137, v137
  v_cvt_pk_bf16_f32 v140, 0, v140
  v_cvt_pk_bf16_f32 v141, 0, v141
  v_cvt_pk_bf16_f32 v137, 0, v137
  v_cvt_pk_bf16_f32 v142, 0, v142
  v_mfma_f32_32x32x16_bf16 v[56:71], v[112:115], a[228:231], v[56:71]
  v_cvt_pk_bf16_f32 v143, 0, v143
  v_rcp_f32 v137, v137
  v_cvt_pk_bf16_f32 v144, 0, v144
  v_cvt_pk_bf16_f32 v145, 0, v145
  v_cvt_pk_bf16_f32 v146, 0, v146
  s_waitcnt lgkmcnt(0)
  v_mfma_f32_32x32x16_bf16 v[40:55], v[116:119], a[240:243], v[40:55]
  v_cvt_pk_bf16_f32 v147, 0, v147
  v_mul_f32 v140, v140, v137
  v_mul_f32 v141, v141, v137
  v_mul_f32 v142, v142, v137
  v_mul_f32 v143, v143, v137
  v_mul_f32 v144, v144, v137
  v_mfma_f32_32x32x16_bf16 v[56:71], v[116:119], a[244:247], v[56:71]
  v_mul_f32 v145, v145, v137
  v_mul_f32 v146, v146, v137
  v_mul_f32 v147, v147, v137
  v_cvt_pk_bf16_f32 v132, v140, v141
  v_cvt_pk_bf16_f32 v133, v142, v143
  v_cvt_pk_bf16_f32 v134, v144, v145
  v_mfma_f32_32x32x16_bf16 v[72:87], v[104:107], a[200:203], v[72:87]
  v_cvt_pk_bf16_f32 v135, v146, v147
  buffer_store_dwordx4 v[132:135], v0, s[4:7], s93 offen sc1
  v_cvt_pk_bf16_f32 v188, 0, v188
  v_ashrrev_i32 v189, 31, v188
  v_mfma_f32_32x32x16_bf16 v[88:103], v[104:107], a[204:207], v[88:103]
  v_or_b32 v189, 0x80000000, v189
  v_xor_b32 v188, v188, v189
  s_sub_u32 s92, 4095, s90
  v_and_b32 v188, 0xffff0000, v188
  v_or_b32 v38, s92, v188
  v_mfma_f32_32x32x16_bf16 v[72:87], v[108:111], a[216:219], v[72:87]
  s_bfe_u32 s92, s65, 196625
  s_lshl_b32 s92, s92, 18
  s_lshl_b32 s93, s90, 7
  s_add_u32 s92, s92, s93
  s_add_u32 s84, s92, 243269632
  v_cvt_pk_bf16_f32 v212, v40, v56
  v_mfma_f32_32x32x16_bf16 v[88:103], v[108:111], a[220:223], v[88:103]
  v_cvt_pk_bf16_f32 v214, v41, v57
  v_cvt_pk_bf16_f32 v216, v42, v58
  v_cvt_pk_bf16_f32 v218, v43, v59
  v_permlane16_swap_b32 v212, v214
  v_mfma_f32_32x32x16_bf16 v[72:87], v[112:115], a[232:235], v[72:87]
  v_cvt_pk_bf16_f32 v220, v44, v60
  v_cvt_pk_bf16_f32 v222, v45, v61
  v_permlane16_swap_b32 v216, v218
  v_bfi_b32 v212, v254, s42, v212
  v_cvt_pk_bf16_f32 v224, v46, v62
  v_mfma_f32_32x32x16_bf16 v[88:103], v[112:115], a[236:239], v[88:103]
  v_cvt_pk_bf16_f32 v226, v47, v63
  v_permlane16_swap_b32 v220, v222
  v_bfi_b32 v216, v254, s42, v216
  v_cvt_pk_bf16_f32 v228, v48, v64
  v_mfma_f32_32x32x16_bf16 v[72:87], v[116:119], a[248:251], v[72:87]
  v_cvt_pk_bf16_f32 v230, v49, v65
  v_permlane16_swap_b32 v224, v226
  v_bfi_b32 v220, v254, s42, v220
  v_cvt_pk_bf16_f32 v232, v50, v66
  v_cvt_pk_bf16_f32 v234, v51, v67
  v_mfma_f32_32x32x16_bf16 v[88:103], v[116:119], a[252:255], v[88:103]
  v_permlane16_swap_b32 v228, v230
  v_bfi_b32 v224, v254, s42, v224
  v_cvt_pk_bf16_f32 v236, v52, v68
  v_cvt_pk_bf16_f32 v238, v53, v69
  v_permlane16_swap_b32 v232, v234
  v_bfi_b32 v228, v254, s42, v228
  v_cvt_pk_bf16_f32 v240, v54, v70
  v_cvt_pk_bf16_f32 v242, v55, v71
  v_permlane16_swap_b32 v236, v238
  v_bfi_b32 v232, v254, s42, v232
  v_permlane16_swap_b32 v240, v242
  v_bfi_b32 v236, v254, s42, v236
  v_bfi_b32 v240, v254, s42, v240
  v_cvt_pk_bf16_f32 v213, v72, v88
  v_cvt_pk_bf16_f32 v215, v73, v89
  v_cvt_pk_bf16_f32 v217, v74, v90
  v_cvt_pk_bf16_f32 v219, v75, v91
  s_add_u32 s78, s86, 0
  v_permlane16_swap_b32 v213, v215
  buffer_store_dwordx4 v[212:215], v4, s[4:7], s78 offen sc1
  v_cvt_pk_bf16_f32 v221, v76, v92
  v_cvt_pk_bf16_f32 v223, v77, v93
  s_add_u32 s78, s86, 32768
  v_permlane16_swap_b32 v217, v219
  buffer_store_dwordx4 v[216:219], v4, s[4:7], s78 offen sc1
  v_cvt_pk_bf16_f32 v225, v78, v94
  v_cvt_pk_bf16_f32 v227, v79, v95
  s_add_u32 s78, s86, 131072
  v_permlane16_swap_b32 v221, v223
  buffer_store_dwordx4 v[220:223], v4, s[4:7], s78 offen sc1
  v_cvt_pk_bf16_f32 v229, v80, v96
  v_cvt_pk_bf16_f32 v231, v81, v97
  s_add_u32 s78, s86, 163840
  v_permlane16_swap_b32 v225, v227
  buffer_store_dwordx4 v[224:227], v4, s[4:7], s78 offen sc1
  v_cvt_pk_bf16_f32 v233, v82, v98
  v_cvt_pk_bf16_f32 v235, v83, v99
  s_add_u32 s78, s86, 262144
  v_permlane16_swap_b32 v229, v231
  buffer_store_dwordx4 v[228:231], v4, s[4:7], s78 offen sc1
  v_cvt_pk_bf16_f32 v237, v84, v100
  v_cvt_pk_bf16_f32 v239, v85, v101
  s_add_u32 s78, s86, 294912
  v_permlane16_swap_b32 v233, v235
  buffer_store_dwordx4 v[232:235], v4, s[4:7], s78 offen sc1
  v_cvt_pk_bf16_f32 v241, v86, v102
  v_cvt_pk_bf16_f32 v243, v87, v103
  s_add_u32 s78, s86, 393216
  v_permlane16_swap_b32 v237, v239
  buffer_store_dwordx4 v[236:239], v4, s[4:7], s78 offen sc1
  s_add_u32 s78, s86, 425984
  v_permlane16_swap_b32 v241, v243
  buffer_store_dwordx4 v[240:243], v4, s[4:7], s78 offen sc1
  s_waitcnt vmcnt(8)
  s_mov_b64 exec, 1
  buffer_store_dword v38, off, s[4:7], s84 sc1
  s_mov_b64 exec, -1
  s_mov_b32 s84, 268435456
  s_branch o_we_166
o_rt_174:
  s_mov_b32 s67, 0
o_rl_178:
  s_lshl_b32 s94, s43, 14
  s_add_u32 s94, s94, s95
  buffer_load_dwordx4 v[120:123], v5, s[4:7], s94 offen offset:0 sc1
  buffer_load_dwordx4 v[124:127], v5, s[4:7], s94 offen offset:512 sc1
  buffer_load_dwordx4 v[128:131], v5, s[4:7], s94 offen offset:256 sc1
  buffer_load_dwordx4 v[132:135], v5, s[4:7], s94 offen offset:768 sc1
  s_add_u32 s94, s94, 4096
  buffer_load_dwordx4 v[136:139], v5, s[4:7], s94 offen offset:0 sc1
  buffer_load_dwordx4 v[140:143], v5, s[4:7], s94 offen offset:512 sc1
  buffer_load_dwordx4 v[144:147], v5, s[4:7], s94 offen offset:256 sc1
  buffer_load_dwordx4 v[148:151], v5, s[4:7], s94 offen offset:768 sc1
  s_add_u32 s94, s94, 4096
  buffer_load_dwordx4 v[152:155], v5, s[4:7], s94 offen offset:0 sc1
  buffer_load_dwordx4 v[156:159], v5, s[4:7], s94 offen offset:512 sc1
  buffer_load_dwordx4 v[160:163], v5, s[4:7], s94 offen offset:256 sc1
  buffer_load_dwordx4 v[164:167], v5, s[4:7], s94 offen offset:768 sc1
  s_add_u32 s94, s94, 4096
  buffer_load_dwordx4 v[168:171], v5, s[4:7], s94 offen offset:0 sc1
  buffer_load_dwordx4 v[172:175], v5, s[4:7], s94 offen offset:512 sc1
  buffer_load_dwordx4 v[176:179], v5, s[4:7], s94 offen offset:256 sc1
  buffer_load_dwordx4 v[180:183], v5, s[4:7], s94 offen offset:768 sc1
  s_add_u32 s67, s67, 1
  s_cmp_gt_u32 s67, 1048576
  s_cbranch_scc1 L_end
  s_waitcnt vmcnt(0)
  v_xor_b32 v7, s96, v120
  v_bitop3_b32 v7, v7, v124, s96 bitop3:0xf6
  v_bitop3_b32 v7, v7, v128, s96 bitop3:0xf6
  v_bitop3_b32 v7, v7, v132, s96 bitop3:0xf6
  v_bitop3_b32 v7, v7, v136, s96 bitop3:0xf6
  v_bitop3_b32 v7, v7, v140, s96 bitop3:0xf6
  v_bitop3_b32 v7, v7, v144, s96 bitop3:0xf6
  v_bitop3_b32 v7, v7, v148, s96 bitop3:0xf6
  v_bitop3_b32 v7, v7, v152, s96 bitop3:0xf6
  v_bitop3_b32 v7, v7, v156, s96 bitop3:0xf6
  v_bitop3_b32 v7, v7, v160, s96 bitop3:0xf6
  v_bitop3_b32 v7, v7, v164, s96 bitop3:0xf6
  v_bitop3_b32 v7, v7, v168, s96 bitop3:0xf6
  v_bitop3_b32 v7, v7, v172, s96 bitop3:0xf6
  v_bitop3_b32 v7, v7, v176, s96 bitop3:0xf6
  v_bitop3_b32 v7, v7, v180, s96 bitop3:0xf6
  v_and_b32 v7, v254, v7
  v_cmp_ne_u32 vcc, 0, v7
  s_cbranch_vccnz o_rl_178
  s_branch o_bk_175
o_rt_176:
  s_mov_b32 s67, 0
o_rl_179:
  s_lshl_b32 s94, s43, 14
  s_add_u32 s94, s94, s95
  buffer_load_dwordx4 v[120:123], v5, s[4:7], s94 offen offset:0 sc1
  buffer_load_dwordx4 v[124:127], v5, s[4:7], s94 offen offset:512 sc1
  buffer_load_dwordx4 v[128:131], v5, s[4:7], s94 offen offset:256 sc1
  buffer_load_dwordx4 v[132:135], v5, s[4:7], s94 offen offset:768 sc1
  s_add_u32 s94, s94, 4096
  buffer_load_dwordx4 v[136:139], v5, s[4:7], s94 offen offset:0 sc1
  buffer_load_dwordx4 v[140:143], v5, s[4:7], s94 offen offset:512 sc1
  buffer_load_dwordx4 v[144:147], v5, s[4:7], s94 offen offset:256 sc1
  buffer_load_dwordx4 v[148:151], v5, s[4:7], s94 offen offset:768 sc1
  s_add_u32 s94, s94, 4096
  buffer_load_dwordx4 v[152:155], v5, s[4:7], s94 offen offset:0 sc1
  buffer_load_dwordx4 v[156:159], v5, s[4:7], s94 offen offset:512 sc1
  buffer_load_dwordx4 v[160:163], v5, s[4:7], s94 offen offset:256 sc1
  buffer_load_dwordx4 v[164:167], v5, s[4:7], s94 offen offset:768 sc1
  s_add_u32 s94, s94, 4096
  buffer_load_dwordx4 v[168:171], v5, s[4:7], s94 offen offset:0 sc1
  buffer_load_dwordx4 v[172:175], v5, s[4:7], s94 offen offset:512 sc1
  buffer_load_dwordx4 v[176:179], v5, s[4:7], s94 offen offset:256 sc1
  buffer_load_dwordx4 v[180:183], v5, s[4:7], s94 offen offset:768 sc1
  s_add_u32 s67, s67, 1
  s_cmp_gt_u32 s67, 1048576
  s_cbranch_scc1 L_end
  s_waitcnt vmcnt(0)
  v_xor_b32 v7, s96, v120
  v_bitop3_b32 v7, v7, v124, s96 bitop3:0xf6
  v_bitop3_b32 v7, v7, v128, s96 bitop3:0xf6
  v_bitop3_b32 v7, v7, v132, s96 bitop3:0xf6
  v_bitop3_b32 v7, v7, v136, s96 bitop3:0xf6
  v_bitop3_b32 v7, v7, v140, s96 bitop3:0xf6
  v_bitop3_b32 v7, v7, v144, s96 bitop3:0xf6
  v_bitop3_b32 v7, v7, v148, s96 bitop3:0xf6
  v_bitop3_b32 v7, v7, v152, s96 bitop3:0xf6
  v_bitop3_b32 v7, v7, v156, s96 bitop3:0xf6
  v_bitop3_b32 v7, v7, v160, s96 bitop3:0xf6
  v_bitop3_b32 v7, v7, v164, s96 bitop3:0xf6
  v_bitop3_b32 v7, v7, v168, s96 bitop3:0xf6
  v_bitop3_b32 v7, v7, v172, s96 bitop3:0xf6
  v_bitop3_b32 v7, v7, v176, s96 bitop3:0xf6
  v_bitop3_b32 v7, v7, v180, s96 bitop3:0xf6
  v_and_b32 v7, v254, v7
  v_cmp_ne_u32 vcc, 0, v7
  s_cbranch_vccnz o_rl_179
  s_branch o_bk_177
o_fb_168:
  v_mov_b32 v118, v116
  s_nop 1
  v_permlane16_swap_b32 v116, v118
  v_max_f32 v116, v116, v118
  v_mov_b32 v118, v116
  s_nop 0
  s_nop 0
  v_permlane32_swap_b32 v116, v118
  v_max_f32 v116, v116, v118
  v_sub_f32 v56, v104, v116
  v_sub_f32 v57, v105, v116
  v_sub_f32 v58, v106, v116
  v_sub_f32 v59, v107, v116
  v_sub_f32 v60, v108, v116
  v_sub_f32 v61, v109, v116
  v_sub_f32 v62, v110, v116
  v_sub_f32 v63, v111, v116
  v_sub_f32 v64, v112, v116
  v_sub_f32 v65, v113, v116
  v_exp_f32 v56, v56
  v_exp_f32 v57, v57
  v_exp_f32 v58, v58
  v_exp_f32 v59, v59
  v_exp_f32 v60, v60
  v_exp_f32 v61, v61
  v_exp_f32 v62, v62
  v_exp_f32 v63, v63
  v_exp_f32 v64, v64
  v_exp_f32 v65, v65
  v_add_f32 v117, v56, v57
  v_add_f32 v117, v117, v58
  v_add_f32 v117, v117, v59
  v_add_f32 v117, v117, v60
  v_add_f32 v117, v117, v61
  v_add_f32 v117, v117, v62
  v_add_f32 v117, v117, v63
  v_add_f32 v117, v117, v64
  v_add_f32 v117, v117, v65
  v_mov_b32 v118, v117
  s_nop 0
  s_nop 0
  v_permlane16_swap_b32 v117, v118
  v_add_f32 v117, v117, v118
  v_mov_b32 v118, v117
  s_nop 0
  s_nop 0
  v_permlane32_swap_b32 v117, v118
  v_add_f32 v117, v117, v118
  v_rcp_f32 v117, v117
  s_branch o_fbr_169
o_fb_170:
  v_mov_b32 v118, v116
  s_nop 1
  v_permlane16_swap_b32 v116, v118
  v_max_f32 v116, v116, v118
  v_mov_b32 v118, v116
  s_nop 0
  s_nop 0
  v_permlane32_swap_b32 v116, v118
  v_max_f32 v116, v116, v118
  v_sub_f32 v56, v104, v116
  v_sub_f32 v57, v105, v116
  v_sub_f32 v58, v106, v116
  v_sub_f32 v59, v107, v116
  v_sub_f32 v60, v108, v116
  v_sub_f32 v61, v109, v116
  v_sub_f32 v62, v110, v116
  v_sub_f32 v63, v111, v116
  v_sub_f32 v64, v112, v116
  v_sub_f32 v65, v113, v116
  v_exp_f32 v56, v56
  v_exp_f32 v57, v57
  v_exp_f32 v58, v58
  v_exp_f32 v59, v59
  v_exp_f32 v60, v60
  v_exp_f32 v61, v61
  v_exp_f32 v62, v62
  v_exp_f32 v63, v63
  v_exp_f32 v64, v64
  v_exp_f32 v65, v65
  v_add_f32 v117, v56, v57
  v_add_f32 v117, v117, v58
  v_add_f32 v117, v117, v59
  v_add_f32 v117, v117, v60
  v_add_f32 v117, v117, v61
  v_add_f32 v117, v117, v62
  v_add_f32 v117, v117, v63
  v_add_f32 v117, v117, v64
  v_add_f32 v117, v117, v65
  v_mov_b32 v118, v117
  s_nop 0
  s_nop 0
  v_permlane16_swap_b32 v117, v118
  v_add_f32 v117, v117, v118
  v_mov_b32 v118, v117
  s_nop 0
  s_nop 0
  v_permlane32_swap_b32 v117, v118
  v_add_f32 v117, v117, v118
  v_rcp_f32 v117, v117
  s_branch o_fbr_171
o_wr2_165:
  s_waitcnt lgkmcnt(0)
  s_barrier
  ds_read_b128 v[104:107], v3 offset:0
  ds_read_b128 v[108:111], v3 offset:512
  ds_read_b128 v[112:115], v3 offset:1024
  buffer_load_dwordx4 v[176:179], v5, s[4:7], s94 offen offset:256 sc1
  buffer_load_dwordx4 v[180:183], v5, s[4:7], s94 offen offset:768 sc1
  s_waitcnt lgkmcnt(2)
  v_mfma_f32_32x32x16_bf16 v[40:55], v[104:107], a[0:3], 0
  v_mov_b64 v[188:189], 0
  v_mov_b64 v[190:191], 0
  v_mov_b64 v[192:193], 0
  v_mov_b64 v[194:195], 0
  s_mov_b64 exec, 1
  buffer_store_dword v38, off, s[4:7], s84 sc1
  s_mov_b64 exec, -1
  s_mov_b32 s84, 268435456
  v_mfma_f32_32x32x16_bf16 v[56:71], v[104:107], a[4:7], 0
  ds_read_b128 v[116:119], v3 offset:1536
  v_mfma_f32_32x32x16_bf16 v[72:87], v[104:107], a[8:11], 0
  v_mfma_f32_32x32x16_bf16 v[88:103], v[104:107], a[12:15], 0
  s_waitcnt vmcnt(13)
  v_xor_b32 v7, s96, v120
  v_bitop3_b32 v7, v7, v124, s96 bitop3:0xf6
  v_bitop3_b32 v7, v7, v128, s96 bitop3:0xf6
  v_bitop3_b32 v7, v7, v132, s96 bitop3:0xf6
  s_waitcnt lgkmcnt(2)
  v_mfma_f32_32x32x16_bf16 v[40:55], v[108:111], a[16:19], v[40:55]
  s_waitcnt vmcnt(9)
  v_bitop3_b32 v7, v7, v136, s96 bitop3:0xf6
  v_bitop3_b32 v7, v7, v140, s96 bitop3:0xf6
  v_bitop3_b32 v7, v7, v144, s96 bitop3:0xf6
  v_bitop3_b32 v7, v7, v148, s96 bitop3:0xf6
  s_waitcnt vmcnt(5)
  v_mfma_f32_32x32x16_bf16 v[56:71], v[108:111], a[20:23], v[56:71]
  ds_read_b128 v[104:107], v3 offset:2048
  v_bitop3_b32 v7, v7, v152, s96 bitop3:0xf6
  v_bitop3_b32 v7, v7, v156, s96 bitop3:0xf6
  v_bitop3_b32 v7, v7, v160, s96 bitop3:0xf6
  v_bitop3_b32 v7, v7, v164, s96 bitop3:0xf6
  s_waitcnt vmcnt(1)
  v_mfma_f32_32x32x16_bf16 v[72:87], v[108:111], a[24:27], v[72:87]
  v_bitop3_b32 v7, v7, v168, s96 bitop3:0xf6
  v_bitop3_b32 v7, v7, v172, s96 bitop3:0xf6
  v_bitop3_b32 v7, v7, v176, s96 bitop3:0xf6
  v_bitop3_b32 v7, v7, v180, s96 bitop3:0xf6
  v_and_b32 v7, v254, v7
  v_cmp_ne_u32 vcc, 0, v7
  s_cbranch_vccnz o_rt_176
o_bk_177:
  v_mfma_f32_32x32x16_bf16 v[88:103], v[108:111], a[28:31], v[88:103]
  v_smfmac_f32_16x16x64_bf16 v[188:191], v[16:19], v[120:127], v20
  v_lshlrev_b32 v196, 16, v184
  v_smfmac_f32_16x16x64_bf16 v[192:195], v[16:19], v[128:135], v20
  v_and_b32 v197, 0xffff0000, v184
  v_smfmac_f32_16x16x64_bf16 v[188:191], v[16:19], v[136:143], v20
  v_lshlrev_b32 v198, 16, v185
  s_waitcnt lgkmcnt(2)
  v_mfma_f32_32x32x16_bf16 v[40:55], v[112:115], a[32:35], v[40:55]
  v_smfmac_f32_16x16x64_bf16 v[192:195], v[16:19], v[144:151], v20
  v_and_b32 v199, 0xffff0000, v185
  v_smfmac_f32_16x16x64_bf16 v[188:191], v[16:19], v[152:159], v20
  v_lshlrev_b32 v200, 16, v186
  v_smfmac_f32_16x16x64_bf16 v[192:195], v[16:19], v[160:167], v20
  v_and_b32 v201, 0xffff0000, v186
  v_mfma_f32_32x32x16_bf16 v[56:71], v[112:115], a[36:39], v[56:71]
  ds_read_b128 v[108:111], v3 offset:2560
  v_smfmac_f32_16x16x64_bf16 v[188:191], v[16:19], v[168:175], v20
  v_lshlrev_b32 v202, 16, v187
  v_smfmac_f32_16x16x64_bf16 v[192:195], v[16:19], v[176:183], v20
  v_and_b32 v203, 0xffff0000, v187
  s_bfe_u32 s92, s65, 131086
  v_mfma_f32_32x32x16_bf16 v[72:87], v[112:115], a[40:43], v[72:87]
  s_lshl_b32 s92, s92, 21
  s_add_u32 s92, s92, s91
  s_add_u32 s93, s92, 27262976
  s_add_u32 s92, s92, 20971520
  v_permlane16_swap_b32 v188, v192
  v_mfma_f32_32x32x16_bf16 v[88:103], v[112:115], a[44:47], v[88:103]
  v_permlane16_swap_b32 v189, v193
  v_permlane16_swap_b32 v190, v194
  v_permlane16_swap_b32 v191, v195
  s_waitcnt lgkmcnt(2)
  v_mfma_f32_32x32x16_bf16 v[40:55], v[116:119], a[48:51], v[40:55]
  v_cvt_pk_bf16_f32 v188, 0, v188
  v_cvt_pk_bf16_f32 v189, 0, v189
  v_cvt_pk_bf16_f32 v190, 0, v190
  v_cvt_pk_bf16_f32 v191, 0, v191
  v_cvt_pk_bf16_f32 v192, 0, v192
  v_cvt_pk_bf16_f32 v193, 0, v193
  v_mfma_f32_32x32x16_bf16 v[56:71], v[116:119], a[52:55], v[56:71]
  ds_read_b128 v[112:115], v3 offset:3072
  v_cvt_pk_bf16_f32 v194, 0, v194
  v_cvt_pk_bf16_f32 v195, 0, v195
  v_add_f32 v196, v196, v188
  v_add_f32 v197, v197, v189
  v_add_f32 v198, v198, v190
  v_mfma_f32_32x32x16_bf16 v[72:87], v[116:119], a[56:59], v[72:87]
  v_add_f32 v199, v199, v191
  v_add_f32 v200, v200, v192
  v_add_f32 v201, v201, v193
  v_add_f32 v202, v202, v194
  v_add_f32 v203, v203, v195
  v_cvt_pk_bf16_f32 v120, v196, v197
  v_mfma_f32_32x32x16_bf16 v[88:103], v[116:119], a[60:63], v[88:103]
  v_cvt_pk_bf16_f32 v121, v198, v199
  v_cvt_pk_bf16_f32 v122, v200, v201
  v_cvt_pk_bf16_f32 v123, v202, v203
  v_lshlrev_b32 v196, 16, v120
  v_and_b32 v197, 0xffff0000, v120
  s_waitcnt lgkmcnt(2)
  v_mfma_f32_32x32x16_bf16 v[40:55], v[104:107], a[64:67], v[40:55]
  v_lshlrev_b32 v198, 16, v121
  v_and_b32 v199, 0xffff0000, v121
  v_lshlrev_b32 v200, 16, v122
  v_and_b32 v201, 0xffff0000, v122
  v_lshlrev_b32 v202, 16, v123
  v_and_b32 v203, 0xffff0000, v123
  v_mfma_f32_32x32x16_bf16 v[56:71], v[104:107], a[68:71], v[56:71]
  ds_read_b128 v[116:119], v3 offset:3584
  buffer_store_dwordx4 v[120:123], v0, s[4:7], s92 offen sc1
  v_add_f32 v136, v196, v197
  v_mul_f32 v137, v196, v196
  v_mfma_f32_32x32x16_bf16 v[72:87], v[104:107], a[72:75], v[72:87]
  v_add_f32 v138, v198, v199
  v_mul_f32 v139, v197, v197
  v_fmac_f32 v137, v198, v198
  v_fmac_f32 v139, v199, v199
  v_add_f32 v136, v136, v200
  v_fmac_f32 v137, v200, v200
  v_mfma_f32_32x32x16_bf16 v[88:103], v[104:107], a[76:79], v[88:103]
  v_add_f32 v138, v138, v201
  v_fmac_f32 v139, v201, v201
  v_add_f32 v136, v136, v202
  v_fmac_f32 v137, v202, v202
  v_add_f32 v138, v138, v203
  s_waitcnt lgkmcnt(2)
  v_mfma_f32_32x32x16_bf16 v[40:55], v[108:111], a[80:83], v[40:55]
  v_fmac_f32 v139, v203, v203
  v_add_f32 v136, v136, v138
  v_add_f32 v137, v137, v139
  s_nop 0
  v_add_f32_dpp v136, v136, v136 row_ror:8 row_mask:0xf bank_mask:0xf
  v_add_f32_dpp v137, v137, v137 row_ror:8 row_mask:0xf bank_mask:0xf
  s_nop 0
  v_add_f32_dpp v136, v136, v136 row_ror:4 row_mask:0xf bank_mask:0xf
  v_mfma_f32_32x32x16_bf16 v[56:71], v[108:111], a[84:87], v[56:71]
  ds_read_b128 v[104:107], v3 offset:8192
  v_add_f32_dpp v137, v137, v137 row_ror:4 row_mask:0xf bank_mask:0xf
  v_add_f32_dpp v136, v136, v136 row_ror:2 row_mask:0xf bank_mask:0xf
  s_nop 0
  v_add_f32_dpp v137, v137, v137 row_ror:2 row_mask:0xf bank_mask:0xf
  v_add_f32_dpp v136, v136, v136 row_ror:1 row_mask:0xf bank_mask:0xf
  s_nop 0
  v_add_f32_dpp v137, v137, v137 row_ror:1 row_mask:0xf bank_mask:0xf
  v_mfma_f32_32x32x16_bf16 v[72:87], v[108:111], a[88:91], v[72:87]
  v_mov_b32 v140, v136
  v_mov_b32 v141, v137
  s_nop 0
  v_permlane16_swap_b32 v136, v140
  v_permlane16_swap_b32 v137, v141
  v_mfma_f32_32x32x16_bf16 v[88:103], v[108:111], a[92:95], v[88:103]
  v_add_f32 v136, v136, v140
  v_add_f32 v137, v137, v141
  v_mov_b32 v140, v136
  v_mov_b32 v141, v137
  s_nop 0
  v_permlane32_swap_b32 v136, v140
  s_waitcnt lgkmcnt(2)
  v_mfma_f32_32x32x16_bf16 v[40:55], v[112:115], a[96:99], v[40:55]
  v_permlane32_swap_b32 v137, v141
  v_add_f32 v136, v136, v140
  v_add_f32 v137, v137, v141
  v_mul_f32 v136, 0x3b000000, v136
  v_mul_f32 v137, 0x3b000000, v137
  v_mfma_f32_32x32x16_bf16 v[56:71], v[112:115], a[100:103], v[56:71]
  ds_read_b128 v[108:111], v3 offset:8704
  v_fma_f32 v137, -v136, v136, v137
  v_cvt_pk_bf16_f32 v136, 0, v136
  v_max_f32 v137, 0, v137
  v_sub_f32 v140, v196, v136
  v_sub_f32 v141, v197, v136
  v_mfma_f32_32x32x16_bf16 v[72:87], v[112:115], a[104:107], v[72:87]
  v_cvt_pk_bf16_f32 v137, 0, v137
  v_sub_f32 v142, v198, v136
  v_sub_f32 v143, v199, v136
  v_add_f32 v137, 0x3727c5ac, v137
  v_sub_f32 v144, v200, v136
  v_sub_f32 v145, v201, v136
  v_mfma_f32_32x32x16_bf16 v[88:103], v[112:115], a[108:111], v[88:103]
  v_cvt_pk_bf16_f32 v137, 0, v137
  v_sub_f32 v146, v202, v136
  v_sub_f32 v147, v203, v136
  v_sqrt_f32 v137, v137
  s_waitcnt lgkmcnt(2)
  v_mfma_f32_32x32x16_bf16 v[40:55], v[116:119], a[112:115], v[40:55]
  v_cvt_pk_bf16_f32 v140, 0, v140
  v_cvt_pk_bf16_f32 v141, 0, v141
  v_cvt_pk_bf16_f32 v137, 0, v137
  v_cvt_pk_bf16_f32 v142, 0, v142
  v_cvt_pk_bf16_f32 v143, 0, v143
  v_rcp_f32 v137, v137
  v_mfma_f32_32x32x16_bf16 v[56:71], v[116:119], a[116:119], v[56:71]
  ds_read_b128 v[112:115], v3 offset:9216
  v_cvt_pk_bf16_f32 v144, 0, v144
  v_cvt_pk_bf16_f32 v145, 0, v145
  v_cvt_pk_bf16_f32 v146, 0, v146
  v_cvt_pk_bf16_f32 v147, 0, v147
  v_mul_f32 v140, v140, v137
  v_mfma_f32_32x32x16_bf16 v[72:87], v[116:119], a[120:123], v[72:87]
  v_mul_f32 v141, v141, v137
  v_mul_f32 v142, v142, v137
  v_mul_f32 v143, v143, v137
  v_mul_f32 v144, v144, v137
  v_mul_f32 v145, v145, v137
  v_mul_f32 v146, v146, v137
  v_mfma_f32_32x32x16_bf16 v[88:103], v[116:119], a[124:127], v[88:103]
  v_mul_f32 v147, v147, v137
  v_cvt_pk_bf16_f32 v124, v140, v141
  v_cvt_pk_bf16_f32 v125, v142, v143
  v_cvt_pk_bf16_f32 v126, v144, v145
  v_cvt_pk_bf16_f32 v127, v146, v147
  s_waitcnt lgkmcnt(2)
  v_mfma_f32_32x32x16_bf16 v[40:55], v[104:107], a[128:131], v[40:55]
  v_lshlrev_b32 v204, 16, v124
  v_and_b32 v205, 0xffff0000, v124
  v_lshlrev_b32 v206, 16, v125
  v_and_b32 v207, 0xffff0000, v125
  v_lshlrev_b32 v208, 16, v126
  v_and_b32 v209, 0xffff0000, v126
  v_mfma_f32_32x32x16_bf16 v[56:71], v[104:107], a[132:135], v[56:71]
  ds_read_b128 v[116:119], v3 offset:9728
  v_lshlrev_b32 v210, 16, v127
  v_and_b32 v211, 0xffff0000, v127
  buffer_store_dwordx4 v[124:127], v0, s[4:7], s93 offen sc1
  v_mfma_f32_32x32x16_bf16 v[72:87], v[104:107], a[136:139], v[72:87]
  v_add_f32 v196, v196, v204
  v_add_f32 v197, v197, v205
  v_add_f32 v198, v198, v206
  v_add_f32 v199, v199, v207
  v_add_f32 v200, v200, v208
  v_add_f32 v201, v201, v209
  v_mfma_f32_32x32x16_bf16 v[88:103], v[104:107], a[140:143], v[88:103]
  v_add_f32 v202, v202, v210
  v_add_f32 v203, v203, v211
  v_cvt_pk_bf16_f32 v128, v196, v197
  v_cvt_pk_bf16_f32 v129, v198, v199
  v_cvt_pk_bf16_f32 v130, v200, v201
  s_waitcnt lgkmcnt(2)
  v_mfma_f32_32x32x16_bf16 v[40:55], v[108:111], a[144:147], v[40:55]
  v_cvt_pk_bf16_f32 v131, v202, v203
  v_mul_f32 v188, v204, v8
  v_mul_f32 v189, v205, v9
  v_fmac_f32 v188, v206, v10
  v_fmac_f32 v189, v207, v11
  v_fmac_f32 v188, v208, v12
  v_mfma_f32_32x32x16_bf16 v[56:71], v[108:111], a[148:151], v[56:71]
  ds_read_b128 v[104:107], v3 offset:10240
  v_fmac_f32 v189, v209, v13
  v_fmac_f32 v188, v210, v14
  v_fmac_f32 v189, v211, v15
  v_add_f32 v188, v188, v189
  buffer_store_dwordx4 v[128:131], v0, s[68:71], s91 offen sc1
  v_mfma_f32_32x32x16_bf16 v[72:87], v[108:111], a[152:155], v[72:87]
  v_add_f32_dpp v188, v188, v188 row_ror:8 row_mask:0xf bank_mask:0xf
  s_nop 1
  v_add_f32_dpp v188, v188, v188 row_ror:4 row_mask:0xf bank_mask:0xf
  s_nop 1
  v_add_f32_dpp v188, v188, v188 row_ror:2 row_mask:0xf bank_mask:0xf
  s_nop 1
  v_add_f32_dpp v188, v188, v188 row_ror:1 row_mask:0xf bank_mask:0xf
  v_mov_b32 v189, v188
  s_nop 0
  s_nop 0
  v_permlane16_swap_b32 v188, v189
  v_mfma_f32_32x32x16_bf16 v[88:103], v[108:111], a[156:159], v[88:103]
  v_add_f32 v188, v188, v189
  v_mov_b32 v189, v188
  s_nop 0
  s_nop 0
  v_permlane32_swap_b32 v188, v189
  v_add_f32 v188, v188, v189
  s_waitcnt lgkmcnt(2)
  v_mfma_f32_32x32x16_bf16 v[40:55], v[112:115], a[160:163], v[40:55]
  v_cvt_pk_bf16_f32 v188, 0, v188
  v_ashrrev_i32 v189, 31, v188
  v_or_b32 v189, 0x80000000, v189
  v_xor_b32 v188, v188, v189
  s_sub_u32 s92, 4095, s90
  v_and_b32 v188, 0xffff0000, v188
  v_mfma_f32_32x32x16_bf16 v[56:71], v[112:115], a[164:167], v[56:71]
  ds_read_b128 v[108:111], v3 offset:10752
  v_or_b32 v38, s92, v188
  s_bfe_u32 s92, s65, 196625
  s_lshl_b32 s92, s92, 18
  s_lshl_b32 s93, s90, 7
  s_add_u32 s92, s92, s93
  v_mfma_f32_32x32x16_bf16 v[72:87], v[112:115], a[168:171], v[72:87]
  s_add_u32 s84, s92, 243269632
  v_mfma_f32_32x32x16_bf16 v[88:103], v[112:115], a[172:175], v[88:103]
  s_waitcnt lgkmcnt(2)
  v_mfma_f32_32x32x16_bf16 v[40:55], v[116:119], a[176:179], v[40:55]
  v_mfma_f32_32x32x16_bf16 v[56:71], v[116:119], a[180:183], v[56:71]
  ds_read_b128 v[112:115], v3 offset:11264
  v_mfma_f32_32x32x16_bf16 v[72:87], v[116:119], a[184:187], v[72:87]
  v_mfma_f32_32x32x16_bf16 v[88:103], v[116:119], a[188:191], v[88:103]
  s_waitcnt lgkmcnt(2)
  v_mfma_f32_32x32x16_bf16 v[40:55], v[104:107], a[192:195], v[40:55]
  v_mfma_f32_32x32x16_bf16 v[56:71], v[104:107], a[196:199], v[56:71]
  ds_read_b128 v[116:119], v3 offset:11776
  s_waitcnt lgkmcnt(2)
  v_mfma_f32_32x32x16_bf16 v[40:55], v[108:111], a[208:211], v[40:55]
  v_mfma_f32_32x32x16_bf16 v[56:71], v[108:111], a[212:215], v[56:71]
  s_waitcnt lgkmcnt(1)
  v_mfma_f32_32x32x16_bf16 v[40:55], v[112:115], a[224:227], v[40:55]
  v_mfma_f32_32x32x16_bf16 v[56:71], v[112:115], a[228:231], v[56:71]
  s_waitcnt lgkmcnt(0)
  v_mfma_f32_32x32x16_bf16 v[40:55], v[116:119], a[240:243], v[40:55]
  v_mfma_f32_32x32x16_bf16 v[56:71], v[116:119], a[244:247], v[56:71]
  v_mfma_f32_32x32x16_bf16 v[72:87], v[104:107], a[200:203], v[72:87]
  v_mfma_f32_32x32x16_bf16 v[88:103], v[104:107], a[204:207], v[88:103]
  v_cvt_pk_bf16_f32 v212, v40, v56
  v_cvt_pk_bf16_f32 v214, v41, v57
  v_cvt_pk_bf16_f32 v216, v42, v58
  v_cvt_pk_bf16_f32 v218, v43, v59
  v_permlane16_swap_b32 v212, v214
  v_mfma_f32_32x32x16_bf16 v[72:87], v[108:111], a[216:219], v[72:87]
  v_cvt_pk_bf16_f32 v220, v44, v60
  v_cvt_pk_bf16_f32 v222, v45, v61
  v_permlane16_swap_b32 v216, v218
  v_bfi_b32 v212, v254, s42, v212
  v_cvt_pk_bf16_f32 v224, v46, v62
  v_mfma_f32_32x32x16_bf16 v[88:103], v[108:111], a[220:223], v[88:103]
  v_cvt_pk_bf16_f32 v226, v47, v63
  v_permlane16_swap_b32 v220, v222
  v_bfi_b32 v216, v254, s42, v216
  v_cvt_pk_bf16_f32 v228, v48, v64
  v_mfma_f32_32x32x16_bf16 v[72:87], v[112:115], a[232:235], v[72:87]
  v_cvt_pk_bf16_f32 v230, v49, v65
  v_permlane16_swap_b32 v224, v226
  v_bfi_b32 v220, v254, s42, v220
  v_cvt_pk_bf16_f32 v232, v50, v66
  v_cvt_pk_bf16_f32 v234, v51, v67
  v_mfma_f32_32x32x16_bf16 v[88:103], v[112:115], a[236:239], v[88:103]
  v_permlane16_swap_b32 v228, v230
  v_bfi_b32 v224, v254, s42, v224
  v_cvt_pk_bf16_f32 v236, v52, v68
  v_cvt_pk_bf16_f32 v238, v53, v69
  v_mfma_f32_32x32x16_bf16 v[72:87], v[116:119], a[248:251], v[72:87]
  v_permlane16_swap_b32 v232, v234
  v_bfi_b32 v228, v254, s42, v228
  v_cvt_pk_bf16_f32 v240, v54, v70
  v_cvt_pk_bf16_f32 v242, v55, v71
  v_permlane16_swap_b32 v236, v238
  v_mfma_f32_32x32x16_bf16 v[88:103], v[116:119], a[252:255], v[88:103]
  v_bfi_b32 v232, v254, s42, v232
  v_permlane16_swap_b32 v240, v242
  v_bfi_b32 v236, v254, s42, v236
  v_bfi_b32 v240, v254, s42, v240
  s_nop 7
  v_cvt_pk_bf16_f32 v213, v72, v88
  v_cvt_pk_bf16_f32 v215, v73, v89
  v_cvt_pk_bf16_f32 v217, v74, v90
  v_cvt_pk_bf16_f32 v219, v75, v91
  s_add_u32 s78, s86, 0
  v_permlane16_swap_b32 v213, v215
  buffer_store_dwordx4 v[212:215], v4, s[4:7], s78 offen sc1
  v_cvt_pk_bf16_f32 v221, v76, v92
  v_cvt_pk_bf16_f32 v223, v77, v93
  s_add_u32 s78, s86, 32768
  v_permlane16_swap_b32 v217, v219
  buffer_store_dwordx4 v[216:219], v4, s[4:7], s78 offen sc1
  v_cvt_pk_bf16_f32 v225, v78, v94
  v_cvt_pk_bf16_f32 v227, v79, v95
  s_add_u32 s78, s86, 131072
  v_permlane16_swap_b32 v221, v223
  buffer_store_dwordx4 v[220:223], v4, s[4:7], s78 offen sc1
  v_cvt_pk_bf16_f32 v229, v80, v96
  v_cvt_pk_bf16_f32 v231, v81, v97
  s_add_u32 s78, s86, 163840
  v_permlane16_swap_b32 v225, v227
  buffer_store_dwordx4 v[224:227], v4, s[4:7], s78 offen sc1
  v_cvt_pk_bf16_f32 v233, v82, v98
  v_cvt_pk_bf16_f32 v235, v83, v99
  s_add_u32 s78, s86, 262144
  v_permlane16_swap_b32 v229, v231
  buffer_store_dwordx4 v[228:231], v4, s[4:7], s78 offen sc1
  v_cvt_pk_bf16_f32 v237, v84, v100
  v_cvt_pk_bf16_f32 v239, v85, v101
  s_add_u32 s78, s86, 294912
  v_permlane16_swap_b32 v233, v235
  buffer_store_dwordx4 v[232:235], v4, s[4:7], s78 offen sc1
  v_cvt_pk_bf16_f32 v241, v86, v102
  v_cvt_pk_bf16_f32 v243, v87, v103
  s_add_u32 s78, s86, 393216
  v_permlane16_swap_b32 v237, v239
  buffer_store_dwordx4 v[236:239], v4, s[4:7], s78 offen sc1
  s_add_u32 s78, s86, 425984
  v_permlane16_swap_b32 v241, v243
  buffer_store_dwordx4 v[240:243], v4, s[4:7], s78 offen sc1
o_we_166:
  v_and_b32 v37, -32, v39
  s_waitcnt lgkmcnt(0)
  s_barrier
  ds_read_b128 v[104:107], v37 offset:16
  s_mov_b32 s65, s63
  s_waitcnt lgkmcnt(0)
  v_and_b32 v104, v104, v106
  v_max_u32 v105, v105, v107
  v_readfirstlane_b32 s26, v104
  v_readfirstlane_b32 s3, v105
  s_and_b32 s66, s26, 1
  s_and_b32 s76, s26, 2
  s_bitcmp1_b32 s26, 2
  s_cselect_b32 s3, s3, 0
  s_cmp_lg_u32 s76, 0
  s_cbranch_scc1 o_nofl_140
  s_and_b32 s26, s63, 49152
  s_cbranch_scc0 o_fl_141
  s_and_b32 s26, s64, s50
  s_cbranch_scc1 o_nofl_140
o_fl_141:
  s_cmp_ge_u32 s17, 2
  s_cbranch_scc1 o_fd_180
  s_cmp_eq_u32 s65, 0
  s_cbranch_scc1 o_fd_180
  s_mov_b32 s96, s42
  s_waitcnt vmcnt(0)
  s_mov_b64 exec, 1
  buffer_store_dword v38, off, s[4:7], s84 sc1
  s_mov_b64 exec, -1
  s_mov_b32 s84, 268435456
  s_lshl_b32 s97, s43, 14
  s_add_u32 s97, s97, s86
  buffer_load_dword v7, v255, s[4:7], s97 offen sc1
  s_and_b32 s91, s65, 63
  s_lshl_b32 s90, s91, 5
  s_add_u32 s94, s90, s85
  s_add_u32 s90, s90, s43
  s_lshl_b32 s94, s94, 10
  s_lshr_b32 s92, s65, 22
  s_xor_b32 s93, s43, 32
  s_lshl_b32 s91, s90, 10
  s_add_u32 s94, s94, 25165824
  s_cmp_eq_u32 s92, s93
  s_cselect_b32 s92, s94, s91
  s_add_u32 s92, s92, 10485760
  s_and_b32 s93, s65, 49152
  s_cselect_b32 s92, s92, s91
  s_cselect_b64 s[80:81], s[4:5], s[72:73]
  s_cselect_b32 s82, s6, s74
  buffer_load_dwordx4 v[184:187], v0, s[80:83], s92 offen sc1
  s_mov_b32 s67, 0
  s_mov_b64 vcc, 0
  s_waitcnt vmcnt(1)
o_pl_182:
  v_and_b32 v7, 1, v7
  v_cmp_ne_u32 vcc, s96, v7
  s_cbranch_vccz o_pk_183
  buffer_load_dword v7, v255, s[4:7], s97 offen sc1
  s_add_u32 s67, s67, 1
  s_cmp_gt_u32 s67, 1048576
  s_cbranch_scc1 L_end
  s_waitcnt vmcnt(0)
  s_branch o_pl_182
o_pk_183:
  s_and_b32 s26, s65, 49152
  s_cbranch_scc1 o_f2_181
  s_lshl_b32 s94, s43, 14
  s_add_u32 s94, s94, s86
  buffer_load_dwordx4 v[120:123], v5, s[4:7], s94 offen offset:0 sc1
  buffer_load_dwordx4 v[124:127], v5, s[4:7], s94 offen offset:512 sc1
  buffer_load_dwordx4 v[128:131], v5, s[4:7], s94 offen offset:256 sc1
  buffer_load_dwordx4 v[132:135], v5, s[4:7], s94 offen offset:768 sc1
  s_add_u32 s94, s94, 4096
  buffer_load_dwordx4 v[136:139], v5, s[4:7], s94 offen offset:0 sc1
  buffer_load_dwordx4 v[140:143], v5, s[4:7], s94 offen offset:512 sc1
  buffer_load_dwordx4 v[144:147], v5, s[4:7], s94 offen offset:256 sc1
  buffer_load_dwordx4 v[148:151], v5, s[4:7], s94 offen offset:768 sc1
  s_add_u32 s94, s94, 4096
  buffer_load_dwordx4 v[152:155], v5, s[4:7], s94 offen offset:0 sc1
  buffer_load_dwordx4 v[156:159], v5, s[4:7], s94 offen offset:512 sc1
  buffer_load_dwordx4 v[160:163], v5, s[4:7], s94 offen offset:256 sc1
  buffer_load_dwordx4 v[164:167], v5, s[4:7], s94 offen offset:768 sc1
  s_add_u32 s94, s94, 4096
  buffer_load_dwordx4 v[168:171], v5, s[4:7], s94 offen offset:0 sc1
  buffer_load_dwordx4 v[172:175], v5, s[4:7], s94 offen offset:512 sc1
  buffer_load_dwordx4 v[176:179], v5, s[4:7], s94 offen offset:256 sc1
  buffer_load_dwordx4 v[180:183], v5, s[4:7], s94 offen offset:768 sc1
  v_mov_b64 v[188:189], 0
  v_mov_b64 v[190:191], 0
  v_mov_b64 v[192:193], 0
  v_mov_b64 v[194:195], 0
  s_waitcnt vmcnt(12)
  v_xor_b32 v7, s96, v120
  v_bitop3_b32 v7, v7, v124, s96 bitop3:0xf6
  v_bitop3_b32 v7, v7, v128, s96 bitop3:0xf6
  v_bitop3_b32 v7, v7, v132, s96 bitop3:0xf6
  s_waitcnt vmcnt(8)
  v_bitop3_b32 v7, v7, v136, s96 bitop3:0xf6
  v_bitop3_b32 v7, v7, v140, s96 bitop3:0xf6
  v_bitop3_b32 v7, v7, v144, s96 bitop3:0xf6
  v_bitop3_b32 v7, v7, v148, s96 bitop3:0xf6
  s_waitcnt vmcnt(4)
  v_bitop3_b32 v7, v7, v152, s96 bitop3:0xf6
  v_bitop3_b32 v7, v7, v156, s96 bitop3:0xf6
  v_bitop3_b32 v7, v7, v160, s96 bitop3:0xf6
  v_bitop3_b32 v7, v7, v164, s96 bitop3:0xf6
  s_waitcnt vmcnt(0)
  v_bitop3_b32 v7, v7, v168, s96 bitop3:0xf6
  v_bitop3_b32 v7, v7, v172, s96 bitop3:0xf6
  v_bitop3_b32 v7, v7, v176, s96 bitop3:0xf6
  v_bitop3_b32 v7, v7, v180, s96 bitop3:0xf6
  v_and_b32 v7, v254, v7
  v_cmp_ne_u32 vcc, 0, v7
  s_cbranch_vccnz o_rt_184
o_bk_185:
  v_smfmac_f32_16x16x64_bf16 v[188:191], v[16:19], v[120:127], v20
  v_lshlrev_b32 v196, 16, v184
  v_smfmac_f32_16x16x64_bf16 v[192:195], v[16:19], v[128:135], v20
  v_and_b32 v197, 0xffff0000, v184
  v_smfmac_f32_16x16x64_bf16 v[188:191], v[16:19], v[136:143], v20
  v_lshlrev_b32 v198, 16, v185
  v_smfmac_f32_16x16x64_bf16 v[192:195], v[16:19], v[144:151], v20
  v_and_b32 v199, 0xffff0000, v185
  v_smfmac_f32_16x16x64_bf16 v[188:191], v[16:19], v[152:159], v20
  v_lshlrev_b32 v200, 16, v186
  v_smfmac_f32_16x16x64_bf16 v[192:195], v[16:19], v[160:167], v20
  v_and_b32 v201, 0xffff0000, v186
  v_smfmac_f32_16x16x64_bf16 v[188:191], v[16:19], v[168:175], v20
  v_lshlrev_b32 v202, 16, v187
  v_smfmac_f32_16x16x64_bf16 v[192:195], v[16:19], v[176:183], v20
  v_and_b32 v203, 0xffff0000, v187
  s_bfe_u32 s92, s65, 131086
  s_lshl_b32 s92, s92, 21
  s_add_u32 s92, s92, s91
  s_add_u32 s93, s92, 27262976
  s_add_u32 s92, s92, 20971520
  s_nop 1
  v_permlane16_swap_b32 v188, v192
  v_permlane16_swap_b32 v189, v193
  v_permlane16_swap_b32 v190, v194
  v_permlane16_swap_b32 v191, v195
  v_cvt_pk_bf16_f32 v188, 0, v188
  v_cvt_pk_bf16_f32 v189, 0, v189
  v_cvt_pk_bf16_f32 v190, 0, v190
  v_cvt_pk_bf16_f32 v191, 0, v191
  v_cvt_pk_bf16_f32 v192, 0, v192
  v_cvt_pk_bf16_f32 v193, 0, v193
  v_cvt_pk_bf16_f32 v194, 0, v194
  v_cvt_pk_bf16_f32 v195, 0, v195
  v_add_f32 v196, v196, v188
  v_add_f32 v197, v197, v189
  v_add_f32 v198, v198, v190
  v_add_f32 v199, v199, v191
  v_add_f32 v200, v200, v192
  v_add_f32 v201, v201, v193
  v_add_f32 v202, v202, v194
  v_add_f32 v203, v203, v195
  v_cvt_pk_bf16_f32 v120, v196, v197
  v_cvt_pk_bf16_f32 v121, v198, v199
  v_cvt_pk_bf16_f32 v122, v200, v201
  v_cvt_pk_bf16_f32 v123, v202, v203
  v_lshlrev_b32 v196, 16, v120
  v_and_b32 v197, 0xffff0000, v120
  v_lshlrev_b32 v198, 16, v121
  v_and_b32 v199, 0xffff0000, v121
  v_lshlrev_b32 v200, 16, v122
  v_and_b32 v201, 0xffff0000, v122
  v_lshlrev_b32 v202, 16, v123
  v_and_b32 v203, 0xffff0000, v123
  buffer_store_dwordx4 v[120:123], v0, s[4:7], s92 offen sc1
  v_add_f32 v136, v196, v197
  v_mul_f32 v137, v196, v196
  v_add_f32 v138, v198, v199
  v_mul_f32 v139, v197, v197
  v_fmac_f32 v137, v198, v198
  v_fmac_f32 v139, v199, v199
  v_add_f32 v136, v136, v200
  v_fmac_f32 v137, v200, v200
  v_add_f32 v138, v138, v201
  v_fmac_f32 v139, v201, v201
  v_add_f32 v136, v136, v202
  v_fmac_f32 v137, v202, v202
  v_add_f32 v138, v138, v203
  v_fmac_f32 v139, v203, v203
  v_add_f32 v136, v136, v138
  v_add_f32 v137, v137, v139
  s_nop 0
  v_add_f32_dpp v136, v136, v136 row_ror:8 row_mask:0xf bank_mask:0xf
  v_add_f32_dpp v137, v137, v137 row_ror:8 row_mask:0xf bank_mask:0xf
  s_nop 0
  v_add_f32_dpp v136, v136, v136 row_ror:4 row_mask:0xf bank_mask:0xf
  v_add_f32_dpp v137, v137, v137 row_ror:4 row_mask:0xf bank_mask:0xf
  s_nop 0
  v_add_f32_dpp v136, v136, v136 row_ror:2 row_mask:0xf bank_mask:0xf
  v_add_f32_dpp v137, v137, v137 row_ror:2 row_mask:0xf bank_mask:0xf
  s_nop 0
  v_add_f32_dpp v136, v136, v136 row_ror:1 row_mask:0xf bank_mask:0xf
  v_add_f32_dpp v137, v137, v137 row_ror:1 row_mask:0xf bank_mask:0xf
  v_mov_b32 v140, v136
  v_mov_b32 v141, v137
  s_nop 0
  v_permlane16_swap_b32 v136, v140
  v_permlane16_swap_b32 v137, v141
  v_add_f32 v136, v136, v140
  v_add_f32 v137, v137, v141
  v_mov_b32 v140, v136
  v_mov_b32 v141, v137
  s_nop 0
  v_permlane32_swap_b32 v136, v140
  v_permlane32_swap_b32 v137, v141
  v_add_f32 v136, v136, v140
  v_add_f32 v137, v137, v141
  v_mul_f32 v136, 0x3b000000, v136
  v_mul_f32 v137, 0x3b000000, v137
  v_fma_f32 v137, -v136, v136, v137
  v_cvt_pk_bf16_f32 v136, 0, v136
  v_max_f32 v137, 0, v137
  v_sub_f32 v140, v196, v136
  v_sub_f32 v141, v197, v136
  v_cvt_pk_bf16_f32 v137, 0, v137
  v_sub_f32 v142, v198, v136
  v_sub_f32 v143, v199, v136
  v_add_f32 v137, 0x3727c5ac, v137
  v_sub_f32 v144, v200, v136
  v_sub_f32 v145, v201, v136
  v_cvt_pk_bf16_f32 v137, 0, v137
  v_sub_f32 v146, v202, v136
  v_sub_f32 v147, v203, v136
  v_sqrt_f32 v137, v137
  v_cvt_pk_bf16_f32 v140, 0, v140
  v_cvt_pk_bf16_f32 v141, 0, v141
  v_cvt_pk_bf16_f32 v137, 0, v137
  v_cvt_pk_bf16_f32 v142, 0, v142
  v_cvt_pk_bf16_f32 v143, 0, v143
  v_rcp_f32 v137, v137
  v_cvt_pk_bf16_f32 v144, 0, v144
  v_cvt_pk_bf16_f32 v145, 0, v145
  v_cvt_pk_bf16_f32 v146, 0, v146
  v_cvt_pk_bf16_f32 v147, 0, v147
  v_mul_f32 v140, v140, v137
  v_mul_f32 v141, v141, v137
  v_mul_f32 v142, v142, v137
  v_mul_f32 v143, v143, v137
  v_mul_f32 v144, v144, v137
  v_mul_f32 v145, v145, v137
  v_mul_f32 v146, v146, v137
  v_mul_f32 v147, v147, v137
  v_cvt_pk_bf16_f32 v124, v140, v141
  v_cvt_pk_bf16_f32 v125, v142, v143
  v_cvt_pk_bf16_f32 v126, v144, v145
  v_cvt_pk_bf16_f32 v127, v146, v147
  v_lshlrev_b32 v204, 16, v124
  v_and_b32 v205, 0xffff0000, v124
  v_lshlrev_b32 v206, 16, v125
  v_and_b32 v207, 0xffff0000, v125
  v_lshlrev_b32 v208, 16, v126
  v_and_b32 v209, 0xffff0000, v126
  v_lshlrev_b32 v210, 16, v127
  v_and_b32 v211, 0xffff0000, v127
  buffer_store_dwordx4 v[124:127], v0, s[4:7], s93 offen sc1
  v_add_f32 v196, v196, v204
  v_add_f32 v197, v197, v205
  v_add_f32 v198, v198, v206
  v_add_f32 v199, v199, v207
  v_add_f32 v200, v200, v208
  v_add_f32 v201, v201, v209
  v_add_f32 v202, v202, v210
  v_add_f32 v203, v203, v211
  v_cvt_pk_bf16_f32 v128, v196, v197
  v_cvt_pk_bf16_f32 v129, v198, v199
  v_cvt_pk_bf16_f32 v130, v200, v201
  v_cvt_pk_bf16_f32 v131, v202, v203
  v_mul_f32 v188, v204, v8
  v_mul_f32 v189, v205, v9
  v_fmac_f32 v188, v206, v10
  v_fmac_f32 v189, v207, v11
  v_fmac_f32 v188, v208, v12
  v_fmac_f32 v189, v209, v13
  v_fmac_f32 v188, v210, v14
  v_fmac_f32 v189, v211, v15
  v_add_f32 v188, v188, v189
  s_add_u32 s92, s91, 10485760
  s_add_u32 s93, s91, 8388608
  buffer_store_dwordx4 v[128:131], v0, s[4:7], s92 offen sc1
  v_lshlrev_b32 v196, 16, v128
  v_and_b32 v197, 0xffff0000, v128
  v_lshlrev_b32 v198, 16, v129
  v_and_b32 v199, 0xffff0000, v129
  v_lshlrev_b32 v200, 16, v130
  v_and_b32 v201, 0xffff0000, v130
  v_lshlrev_b32 v202, 16, v131
  v_and_b32 v203, 0xffff0000, v131
  v_add_f32 v136, v196, v197
  v_mul_f32 v137, v196, v196
  v_add_f32 v138, v198, v199
  v_mul_f32 v139, v197, v197
  v_fmac_f32 v137, v198, v198
  v_fmac_f32 v139, v199, v199
  v_add_f32 v136, v136, v200
  v_fmac_f32 v137, v200, v200
  v_add_f32 v138, v138, v201
  v_fmac_f32 v139, v201, v201
  v_add_f32 v136, v136, v202
  v_fmac_f32 v137, v202, v202
  v_add_f32 v138, v138, v203
  v_fmac_f32 v139, v203, v203
  v_add_f32 v136, v136, v138
  v_add_f32 v137, v137, v139
  s_nop 0
  v_add_f32_dpp v136, v136, v136 row_ror:8 row_mask:0xf bank_mask:0xf
  v_add_f32_dpp v137, v137, v137 row_ror:8 row_mask:0xf bank_mask:0xf
  v_add_f32_dpp v188, v188, v188 row_ror:8 row_mask:0xf bank_mask:0xf
  v_add_f32_dpp v136, v136, v136 row_ror:4 row_mask:0xf bank_mask:0xf
  v_add_f32_dpp v137, v137, v137 row_ror:4 row_mask:0xf bank_mask:0xf
  v_add_f32_dpp v188, v188, v188 row_ror:4 row_mask:0xf bank_mask:0xf
  v_add_f32_dpp v136, v136, v136 row_ror:2 row_mask:0xf bank_mask:0xf
  v_add_f32_dpp v137, v137, v137 row_ror:2 row_mask:0xf bank_mask:0xf
  v_add_f32_dpp v188, v188, v188 row_ror:2 row_mask:0xf bank_mask:0xf
  v_add_f32_dpp v136, v136, v136 row_ror:1 row_mask:0xf bank_mask:0xf
  v_add_f32_dpp v137, v137, v137 row_ror:1 row_mask:0xf bank_mask:0xf
  v_add_f32_dpp v188, v188, v188 row_ror:1 row_mask:0xf bank_mask:0xf
  v_mov_b32 v140, v136
  v_mov_b32 v141, v137
  v_mov_b32 v142, v188
  v_permlane16_swap_b32 v136, v140
  v_permlane16_swap_b32 v137, v141
  v_permlane16_swap_b32 v188, v142
  v_add_f32 v136, v136, v140
  v_add_f32 v137, v137, v141
  v_add_f32 v188, v188, v142
  v_mov_b32 v140, v136
  v_mov_b32 v141, v137
  v_mov_b32 v142, v188
  v_permlane32_swap_b32 v136, v140
  v_permlane32_swap_b32 v137, v141
  v_permlane32_swap_b32 v188, v142
  v_add_f32 v136, v136, v140
  v_add_f32 v137, v137, v141
  v_add_f32 v188, v188, v142
  v_mul_f32 v136, 0x3b000000, v136
  v_mul_f32 v137, 0x3b000000, v137
  v_fma_f32 v137, -v136, v136, v137
  v_cvt_pk_bf16_f32 v136, 0, v136
  v_max_f32 v137, 0, v137
  v_sub_f32 v140, v196, v136
  v_sub_f32 v141, v197, v136
  v_cvt_pk_bf16_f32 v137, 0, v137
  v_sub_f32 v142, v198, v136
  v_sub_f32 v143, v199, v136
  v_add_f32 v137, 0x3727c5ac, v137
  v_sub_f32 v144, v200, v136
  v_sub_f32 v145, v201, v136
  v_cvt_pk_bf16_f32 v137, 0, v137
  v_sub_f32 v146, v202, v136
  v_sub_f32 v147, v203, v136
  v_sqrt_f32 v137, v137
  v_cvt_pk_bf16_f32 v140, 0, v140
  v_cvt_pk_bf16_f32 v141, 0, v141
  v_cvt_pk_bf16_f32 v137, 0, v137
  v_cvt_pk_bf16_f32 v142, 0, v142
  v_cvt_pk_bf16_f32 v143, 0, v143
  v_rcp_f32 v137, v137
  v_cvt_pk_bf16_f32 v144, 0, v144
  v_cvt_pk_bf16_f32 v145, 0, v145
  v_cvt_pk_bf16_f32 v146, 0, v146
  v_cvt_pk_bf16_f32 v147, 0, v147
  v_mul_f32 v140, v140, v137
  v_mul_f32 v141, v141, v137
  v_mul_f32 v142, v142, v137
  v_mul_f32 v143, v143, v137
  v_mul_f32 v144, v144, v137
  v_mul_f32 v145, v145, v137
  v_mul_f32 v146, v146, v137
  v_mul_f32 v147, v147, v137
  v_cvt_pk_bf16_f32 v132, v140, v141
  v_cvt_pk_bf16_f32 v133, v142, v143
  v_cvt_pk_bf16_f32 v134, v144, v145
  v_cvt_pk_bf16_f32 v135, v146, v147
  buffer_store_dwordx4 v[132:135], v0, s[4:7], s93 offen sc1
  v_cvt_pk_bf16_f32 v188, 0, v188
  v_ashrrev_i32 v189, 31, v188
  v_or_b32 v189, 0x80000000, v189
  v_xor_b32 v188, v188, v189
  s_sub_u32 s92, 4095, s90
  v_and_b32 v188, 0xffff0000, v188
  v_or_b32 v38, s92, v188
  s_bfe_u32 s92, s65, 196625
  s_lshl_b32 s92, s92, 18
  s_lshl_b32 s93, s90, 7
  s_add_u32 s92, s92, s93
  s_add_u32 s84, s92, 243269632
  s_waitcnt vmcnt(0)
  s_mov_b64 exec, 1
  buffer_store_dword v38, off, s[4:7], s84 sc1
  s_mov_b64 exec, -1
  s_mov_b32 s84, 268435456
  s_branch o_fd_180
o_rt_184:
  s_mov_b32 s67, 0
o_rl_186:
  s_lshl_b32 s94, s43, 14
  s_add_u32 s94, s94, s86
  buffer_load_dwordx4 v[120:123], v5, s[4:7], s94 offen offset:0 sc1
  buffer_load_dwordx4 v[124:127], v5, s[4:7], s94 offen offset:512 sc1
  buffer_load_dwordx4 v[128:131], v5, s[4:7], s94 offen offset:256 sc1
  buffer_load_dwordx4 v[132:135], v5, s[4:7], s94 offen offset:768 sc1
  s_add_u32 s94, s94, 4096
  buffer_load_dwordx4 v[136:139], v5, s[4:7], s94 offen offset:0 sc1
  buffer_load_dwordx4 v[140:143], v5, s[4:7], s94 offen offset:512 sc1
  buffer_load_dwordx4 v[144:147], v5, s[4:7], s94 offen offset:256 sc1
  buffer_load_dwordx4 v[148:151], v5, s[4:7], s94 offen offset:768 sc1
  s_add_u32 s94, s94, 4096
  buffer_load_dwordx4 v[152:155], v5, s[4:7], s94 offen offset:0 sc1
  buffer_load_dwordx4 v[156:159], v5, s[4:7], s94 offen offset:512 sc1
  buffer_load_dwordx4 v[160:163], v5, s[4:7], s94 offen offset:256 sc1
  buffer_load_dwordx4 v[164:167], v5, s[4:7], s94 offen offset:768 sc1
  s_add_u32 s94, s94, 4096
  buffer_load_dwordx4 v[168:171], v5, s[4:7], s94 offen offset:0 sc1
  buffer_load_dwordx4 v[172:175], v5, s[4:7], s94 offen offset:512 sc1
  buffer_load_dwordx4 v[176:179], v5, s[4:7], s94 offen offset:256 sc1
  buffer_load_dwordx4 v[180:183], v5, s[4:7], s94 offen offset:768 sc1
  s_add_u32 s67, s67, 1
  s_cmp_gt_u32 s67, 1048576
  s_cbranch_scc1 L_end
  s_waitcnt vmcnt(0)
  v_xor_b32 v7, s96, v120
  v_bitop3_b32 v7, v7, v124, s96 bitop3:0xf6
  v_bitop3_b32 v7, v7, v128, s96 bitop3:0xf6
  v_bitop3_b32 v7, v7, v132, s96 bitop3:0xf6
  v_bitop3_b32 v7, v7, v136, s96 bitop3:0xf6
  v_bitop3_b32 v7, v7, v140, s96 bitop3:0xf6
  v_bitop3_b32 v7, v7, v144, s96 bitop3:0xf6
  v_bitop3_b32 v7, v7, v148, s96 bitop3:0xf6
  v_bitop3_b32 v7, v7, v152, s96 bitop3:0xf6
  v_bitop3_b32 v7, v7, v156, s96 bitop3:0xf6
  v_bitop3_b32 v7, v7, v160, s96 bitop3:0xf6
  v_bitop3_b32 v7, v7, v164, s96 bitop3:0xf6
  v_bitop3_b32 v7, v7, v168, s96 bitop3:0xf6
  v_bitop3_b32 v7, v7, v172, s96 bitop3:0xf6
  v_bitop3_b32 v7, v7, v176, s96 bitop3:0xf6
  v_bitop3_b32 v7, v7, v180, s96 bitop3:0xf6
  v_and_b32 v7, v254, v7
  v_cmp_ne_u32 vcc, 0, v7
  s_cbranch_vccnz o_rl_186
  s_branch o_bk_185
o_f2_181:
  s_lshl_b32 s94, s43, 14
  s_add_u32 s94, s94, s86
  buffer_load_dwordx4 v[120:123], v5, s[4:7], s94 offen offset:0 sc1
  buffer_load_dwordx4 v[124:127], v5, s[4:7], s94 offen offset:512 sc1
  buffer_load_dwordx4 v[128:131], v5, s[4:7], s94 offen offset:256 sc1
  buffer_load_dwordx4 v[132:135], v5, s[4:7], s94 offen offset:768 sc1
  s_add_u32 s94, s94, 4096
  buffer_load_dwordx4 v[136:139], v5, s[4:7], s94 offen offset:0 sc1
  buffer_load_dwordx4 v[140:143], v5, s[4:7], s94 offen offset:512 sc1
  buffer_load_dwordx4 v[144:147], v5, s[4:7], s94 offen offset:256 sc1
  buffer_load_dwordx4 v[148:151], v5, s[4:7], s94 offen offset:768 sc1
  s_add_u32 s94, s94, 4096
  buffer_load_dwordx4 v[152:155], v5, s[4:7], s94 offen offset:0 sc1
  buffer_load_dwordx4 v[156:159], v5, s[4:7], s94 offen offset:512 sc1
  buffer_load_dwordx4 v[160:163], v5, s[4:7], s94 offen offset:256 sc1
  buffer_load_dwordx4 v[164:167], v5, s[4:7], s94 offen offset:768 sc1
  s_add_u32 s94, s94, 4096
  buffer_load_dwordx4 v[168:171], v5, s[4:7], s94 offen offset:0 sc1
  buffer_load_dwordx4 v[172:175], v5, s[4:7], s94 offen offset:512 sc1
  buffer_load_dwordx4 v[176:179], v5, s[4:7], s94 offen offset:256 sc1
  buffer_load_dwordx4 v[180:183], v5, s[4:7], s94 offen offset:768 sc1
  v_mov_b64 v[188:189], 0
  v_mov_b64 v[190:191], 0
  v_mov_b64 v[192:193], 0
  v_mov_b64 v[194:195], 0
  s_waitcnt vmcnt(12)
  v_xor_b32 v7, s96, v120
  v_bitop3_b32 v7, v7, v124, s96 bitop3:0xf6
  v_bitop3_b32 v7, v7, v128, s96 bitop3:0xf6
  v_bitop3_b32 v7, v7, v132, s96 bitop3:0xf6
  s_waitcnt vmcnt(8)
  v_bitop3_b32 v7, v7, v136, s96 bitop3:0xf6
  v_bitop3_b32 v7, v7, v140, s96 bitop3:0xf6
  v_bitop3_b32 v7, v7, v144, s96 bitop3:0xf6
  v_bitop3_b32 v7, v7, v148, s96 bitop3:0xf6
  s_waitcnt vmcnt(4)
  v_bitop3_b32 v7, v7, v152, s96 bitop3:0xf6
  v_bitop3_b32 v7, v7, v156, s96 bitop3:0xf6
  v_bitop3_b32 v7, v7, v160, s96 bitop3:0xf6
  v_bitop3_b32 v7, v7, v164, s96 bitop3:0xf6
  s_waitcnt vmcnt(0)
  v_bitop3_b32 v7, v7, v168, s96 bitop3:0xf6
  v_bitop3_b32 v7, v7, v172, s96 bitop3:0xf6
  v_bitop3_b32 v7, v7, v176, s96 bitop3:0xf6
  v_bitop3_b32 v7, v7, v180, s96 bitop3:0xf6
  v_and_b32 v7, v254, v7
  v_cmp_ne_u32 vcc, 0, v7
  s_cbranch_vccnz o_rt_187
o_bk_188:
  v_smfmac_f32_16x16x64_bf16 v[188:191], v[16:19], v[120:127], v20
  v_lshlrev_b32 v196, 16, v184
  v_smfmac_f32_16x16x64_bf16 v[192:195], v[16:19], v[128:135], v20
  v_and_b32 v197, 0xffff0000, v184
  v_smfmac_f32_16x16x64_bf16 v[188:191], v[16:19], v[136:143], v20
  v_lshlrev_b32 v198, 16, v185
  v_smfmac_f32_16x16x64_bf16 v[192:195], v[16:19], v[144:151], v20
  v_and_b32 v199, 0xffff0000, v185
  v_smfmac_f32_16x16x64_bf16 v[188:191], v[16:19], v[152:159], v20
  v_lshlrev_b32 v200, 16, v186
  v_smfmac_f32_16x16x64_bf16 v[192:195], v[16:19], v[160:167], v20
  v_and_b32 v201, 0xffff0000, v186
  v_smfmac_f32_16x16x64_bf16 v[188:191], v[16:19], v[168:175], v20
  v_lshlrev_b32 v202, 16, v187
  v_smfmac_f32_16x16x64_bf16 v[192:195], v[16:19], v[176:183], v20
  v_and_b32 v203, 0xffff0000, v187
  s_bfe_u32 s92, s65, 131086
  s_lshl_b32 s92, s92, 21
  s_add_u32 s92, s92, s91
  s_add_u32 s93, s92, 27262976
  s_add_u32 s92, s92, 20971520
  s_nop 1
  v_permlane16_swap_b32 v188, v192
  v_permlane16_swap_b32 v189, v193
  v_permlane16_swap_b32 v190, v194
  v_permlane16_swap_b32 v191, v195
  v_cvt_pk_bf16_f32 v188, 0, v188
  v_cvt_pk_bf16_f32 v189, 0, v189
  v_cvt_pk_bf16_f32 v190, 0, v190
  v_cvt_pk_bf16_f32 v191, 0, v191
  v_cvt_pk_bf16_f32 v192, 0, v192
  v_cvt_pk_bf16_f32 v193, 0, v193
  v_cvt_pk_bf16_f32 v194, 0, v194
  v_cvt_pk_bf16_f32 v195, 0, v195
  v_add_f32 v196, v196, v188
  v_add_f32 v197, v197, v189
  v_add_f32 v198, v198, v190
  v_add_f32 v199, v199, v191
  v_add_f32 v200, v200, v192
  v_add_f32 v201, v201, v193
  v_add_f32 v202, v202, v194
  v_add_f32 v203, v203, v195
  v_cvt_pk_bf16_f32 v120, v196, v197
  v_cvt_pk_bf16_f32 v121, v198, v199
  v_cvt_pk_bf16_f32 v122, v200, v201
  v_cvt_pk_bf16_f32 v123, v202, v203
  v_lshlrev_b32 v196, 16, v120
  v_and_b32 v197, 0xffff0000, v120
  v_lshlrev_b32 v198, 16, v121
  v_and_b32 v199, 0xffff0000, v121
  v_lshlrev_b32 v200, 16, v122
  v_and_b32 v201, 0xffff0000, v122
  v_lshlrev_b32 v202, 16, v123
  v_and_b32 v203, 0xffff0000, v123
  buffer_store_dwordx4 v[120:123], v0, s[4:7], s92 offen sc1
  v_add_f32 v136, v196, v197
  v_mul_f32 v137, v196, v196
  v_add_f32 v138, v198, v199
  v_mul_f32 v139, v197, v197
  v_fmac_f32 v137, v198, v198
  v_fmac_f32 v139, v199, v199
  v_add_f32 v136, v136, v200
  v_fmac_f32 v137, v200, v200
  v_add_f32 v138, v138, v201
  v_fmac_f32 v139, v201, v201
  v_add_f32 v136, v136, v202
  v_fmac_f32 v137, v202, v202
  v_add_f32 v138, v138, v203
  v_fmac_f32 v139, v203, v203
  v_add_f32 v136, v136, v138
  v_add_f32 v137, v137, v139
  s_nop 0
  v_add_f32_dpp v136, v136, v136 row_ror:8 row_mask:0xf bank_mask:0xf
  v_add_f32_dpp v137, v137, v137 row_ror:8 row_mask:0xf bank_mask:0xf
  s_nop 0
  v_add_f32_dpp v136, v136, v136 row_ror:4 row_mask:0xf bank_mask:0xf
  v_add_f32_dpp v137, v137, v137 row_ror:4 row_mask:0xf bank_mask:0xf
  s_nop 0
  v_add_f32_dpp v136, v136, v136 row_ror:2 row_mask:0xf bank_mask:0xf
  v_add_f32_dpp v137, v137, v137 row_ror:2 row_mask:0xf bank_mask:0xf
  s_nop 0
  v_add_f32_dpp v136, v136, v136 row_ror:1 row_mask:0xf bank_mask:0xf
  v_add_f32_dpp v137, v137, v137 row_ror:1 row_mask:0xf bank_mask:0xf
  v_mov_b32 v140, v136
  v_mov_b32 v141, v137
  s_nop 0
  v_permlane16_swap_b32 v136, v140
  v_permlane16_swap_b32 v137, v141
  v_add_f32 v136, v136, v140
  v_add_f32 v137, v137, v141
  v_mov_b32 v140, v136
  v_mov_b32 v141, v137
  s_nop 0
  v_permlane32_swap_b32 v136, v140
  v_permlane32_swap_b32 v137, v141
  v_add_f32 v136, v136, v140
  v_add_f32 v137, v137, v141
  v_mul_f32 v136, 0x3b000000, v136
  v_mul_f32 v137, 0x3b000000, v137
  v_fma_f32 v137, -v136, v136, v137
  v_cvt_pk_bf16_f32 v136, 0, v136
  v_max_f32 v137, 0, v137
  v_sub_f32 v140, v196, v136
  v_sub_f32 v141, v197, v136
  v_cvt_pk_bf16_f32 v137, 0, v137
  v_sub_f32 v142, v198, v136
  v_sub_f32 v143, v199, v136
  v_add_f32 v137, 0x3727c5ac, v137
  v_sub_f32 v144, v200, v136
  v_sub_f32 v145, v201, v136
  v_cvt_pk_bf16_f32 v137, 0, v137
  v_sub_f32 v146, v202, v136
  v_sub_f32 v147, v203, v136
  v_sqrt_f32 v137, v137
  v_cvt_pk_bf16_f32 v140, 0, v140
  v_cvt_pk_bf16_f32 v141, 0, v141
  v_cvt_pk_bf16_f32 v137, 0, v137
  v_cvt_pk_bf16_f32 v142, 0, v142
  v_cvt_pk_bf16_f32 v143, 0, v143
  v_rcp_f32 v137, v137
  v_cvt_pk_bf16_f32 v144, 0, v144
  v_cvt_pk_bf16_f32 v145, 0, v145
  v_cvt_pk_bf16_f32 v146, 0, v146
  v_cvt_pk_bf16_f32 v147, 0, v147
  v_mul_f32 v140, v140, v137
  v_mul_f32 v141, v141, v137
  v_mul_f32 v142, v142, v137
  v_mul_f32 v143, v143, v137
  v_mul_f32 v144, v144, v137
  v_mul_f32 v145, v145, v137
  v_mul_f32 v146, v146, v137
  v_mul_f32 v147, v147, v137
  v_cvt_pk_bf16_f32 v124, v140, v141
  v_cvt_pk_bf16_f32 v125, v142, v143
  v_cvt_pk_bf16_f32 v126, v144, v145
  v_cvt_pk_bf16_f32 v127, v146, v147
  v_lshlrev_b32 v204, 16, v124
  v_and_b32 v205, 0xffff0000, v124
  v_lshlrev_b32 v206, 16, v125
  v_and_b32 v207, 0xffff0000, v125
  v_lshlrev_b32 v208, 16, v126
  v_and_b32 v209, 0xffff0000, v126
  v_lshlrev_b32 v210, 16, v127
  v_and_b32 v211, 0xffff0000, v127
  buffer_store_dwordx4 v[124:127], v0, s[4:7], s93 offen sc1
  v_add_f32 v196, v196, v204
  v_add_f32 v197, v197, v205
  v_add_f32 v198, v198, v206
  v_add_f32 v199, v199, v207
  v_add_f32 v200, v200, v208
  v_add_f32 v201, v201, v209
  v_add_f32 v202, v202, v210
  v_add_f32 v203, v203, v211
  v_cvt_pk_bf16_f32 v128, v196, v197
  v_cvt_pk_bf16_f32 v129, v198, v199
  v_cvt_pk_bf16_f32 v130, v200, v201
  v_cvt_pk_bf16_f32 v131, v202, v203
  v_mul_f32 v188, v204, v8
  v_mul_f32 v189, v205, v9
  v_fmac_f32 v188, v206, v10
  v_fmac_f32 v189, v207, v11
  v_fmac_f32 v188, v208, v12
  v_fmac_f32 v189, v209, v13
  v_fmac_f32 v188, v210, v14
  v_fmac_f32 v189, v211, v15
  v_add_f32 v188, v188, v189
  buffer_store_dwordx4 v[128:131], v0, s[68:71], s91 offen sc1
  s_nop 0
  v_add_f32_dpp v188, v188, v188 row_ror:8 row_mask:0xf bank_mask:0xf
  s_nop 1
  v_add_f32_dpp v188, v188, v188 row_ror:4 row_mask:0xf bank_mask:0xf
  s_nop 1
  v_add_f32_dpp v188, v188, v188 row_ror:2 row_mask:0xf bank_mask:0xf
  s_nop 1
  v_add_f32_dpp v188, v188, v188 row_ror:1 row_mask:0xf bank_mask:0xf
  v_mov_b32 v189, v188
  s_nop 0
  s_nop 0
  v_permlane16_swap_b32 v188, v189
  v_add_f32 v188, v188, v189
  v_mov_b32 v189, v188
  s_nop 0
  s_nop 0
  v_permlane32_swap_b32 v188, v189
  v_add_f32 v188, v188, v189
  v_cvt_pk_bf16_f32 v188, 0, v188
  v_ashrrev_i32 v189, 31, v188
  v_or_b32 v189, 0x80000000, v189
  v_xor_b32 v188, v188, v189
  s_sub_u32 s92, 4095, s90
  v_and_b32 v188, 0xffff0000, v188
  v_or_b32 v38, s92, v188
  s_bfe_u32 s92, s65, 196625
  s_lshl_b32 s92, s92, 18
  s_lshl_b32 s93, s90, 7
  s_add_u32 s92, s92, s93
  s_add_u32 s84, s92, 243269632
  s_waitcnt vmcnt(0)
  s_mov_b64 exec, 1
  buffer_store_dword v38, off, s[4:7], s84 sc1
  s_mov_b64 exec, -1
  s_mov_b32 s84, 268435456
  s_branch o_fd_180
o_rt_187:
  s_mov_b32 s67, 0
o_rl_189:
  s_lshl_b32 s94, s43, 14
  s_add_u32 s94, s94, s86
  buffer_load_dwordx4 v[120:123], v5, s[4:7], s94 offen offset:0 sc1
  buffer_load_dwordx4 v[124:127], v5, s[4:7], s94 offen offset:512 sc1
  buffer_load_dwordx4 v[128:131], v5, s[4:7], s94 offen offset:256 sc1
  buffer_load_dwordx4 v[132:135], v5, s[4:7], s94 offen offset:768 sc1
  s_add_u32 s94, s94, 4096
  buffer_load_dwordx4 v[136:139], v5, s[4:7], s94 offen offset:0 sc1
  buffer_load_dwordx4 v[140:143], v5, s[4:7], s94 offen offset:512 sc1
  buffer_load_dwordx4 v[144:147], v5, s[4:7], s94 offen offset:256 sc1
  buffer_load_dwordx4 v[148:151], v5, s[4:7], s94 offen offset:768 sc1
  s_add_u32 s94, s94, 4096
  buffer_load_dwordx4 v[152:155], v5, s[4:7], s94 offen offset:0 sc1
  buffer_load_dwordx4 v[156:159], v5, s[4:7], s94 offen offset:512 sc1
  buffer_load_dwordx4 v[160:163], v5, s[4:7], s94 offen offset:256 sc1
  buffer_load_dwordx4 v[164:167], v5, s[4:7], s94 offen offset:768 sc1
  s_add_u32 s94, s94, 4096
  buffer_load_dwordx4 v[168:171], v5, s[4:7], s94 offen offset:0 sc1
  buffer_load_dwordx4 v[172:175], v5, s[4:7], s94 offen offset:512 sc1
  buffer_load_dwordx4 v[176:179], v5, s[4:7], s94 offen offset:256 sc1
  buffer_load_dwordx4 v[180:183], v5, s[4:7], s94 offen offset:768 sc1
  s_add_u32 s67, s67, 1
  s_cmp_gt_u32 s67, 1048576
  s_cbranch_scc1 L_end
  s_waitcnt vmcnt(0)
  v_xor_b32 v7, s96, v120
  v_bitop3_b32 v7, v7, v124, s96 bitop3:0xf6
  v_bitop3_b32 v7, v7, v128, s96 bitop3:0xf6
  v_bitop3_b32 v7, v7, v132, s96 bitop3:0xf6
  v_bitop3_b32 v7, v7, v136, s96 bitop3:0xf6
  v_bitop3_b32 v7, v7, v140, s96 bitop3:0xf6
  v_bitop3_b32 v7, v7, v144, s96 bitop3:0xf6
  v_bitop3_b32 v7, v7, v148, s96 bitop3:0xf6
  v_bitop3_b32 v7, v7, v152, s96 bitop3:0xf6
  v_bitop3_b32 v7, v7, v156, s96 bitop3:0xf6
  v_bitop3_b32 v7, v7, v160, s96 bitop3:0xf6
  v_bitop3_b32 v7, v7, v164, s96 bitop3:0xf6
  v_bitop3_b32 v7, v7, v168, s96 bitop3:0xf6
  v_bitop3_b32 v7, v7, v172, s96 bitop3:0xf6
  v_bitop3_b32 v7, v7, v176, s96 bitop3:0xf6
  v_bitop3_b32 v7, v7, v180, s96 bitop3:0xf6
  v_and_b32 v7, v254, v7
  v_cmp_ne_u32 vcc, 0, v7
  s_cbranch_vccnz o_rl_189
  s_branch o_bk_188
o_fd_180:
  s_mov_b32 s65, 0
o_nofl_140:
  s_mov_b32 s63, s64
  s_cmp_lg_u32 s51, 0
  s_cbranch_scc1 o_pick_142
  s_cmp_eq_u32 s50, 0
  s_cbranch_scc1 L_end
o_adv_148:
  s_add_u32 s49, s49, 4
  s_branch o_round_138
o_dl_150:
  s_and_b32 s26, s55, s54
  s_andn2_b32 s27, s56, s54
  s_or_b32 s26, s26, s27
  s_andn2_b32 s26, s58, s26
  s_bcnt1_i32_b32 s27, s26
  s_add_u32 s27, s27, 0
  s_mul_i32 s27, s27, 86
  s_lshr_b32 s27, s27, 8
o_dl1_151:
  s_cbranch_scc0 o_dl2_152
  s_ff1_i32_b32 s28, s26
  s_bitset0_b32 s26, s28
  s_bitset0_b32 s58, s28
  s_sub_u32 s27, s27, 1
  s_cmp_lg_u32 s27, 0
  s_branch o_dl1_151
o_dl2_152:
  s_xor_b32 s26, s58, 0x8000ffff
  s_lshl_b32 s27, s60, 7
  s_add_u32 s27, s27, 243269696
  s_cmp_lg_u32 s43, 0
  s_cbranch_scc1 o_pick_142
  v_mov_b32 v162, s26
  v_mov_b32 v163, s46
  s_mov_b64 exec, 1
  buffer_store_dwordx2 v[162:163], off, s[4:7], s27 sc1
  s_mov_b64 exec, -1
  s_branch o_pick_142
o_help_149:
  s_lshl_b32 s60, s60, 1
  s_and_b32 s60, s60, 2
  s_lshl_b32 s27, s60, 7
  s_add_u32 s27, s27, 243269696
  s_mov_b32 s67, 0
o_help_149_w:
  buffer_load_dwordx2 v[162:163], off, s[4:7], s27 sc1
  buffer_load_dword v164, off, s[4:7], s27 offset:128 sc1
  s_add_u32 s67, s67, 1
  s_cmp_gt_u32 s67, 1048576
  s_cbranch_scc1 L_end
  s_waitcnt vmcnt(0)
  v_readfirstlane_b32 s28, v162
  v_readfirstlane_b32 s30, v164
  v_readfirstlane_b32 s46, v163
  s_and_b32 s26, s28, s30
  s_bitcmp1_b32 s26, 31
  s_cbranch_scc0 o_help_149_w
  s_bitreplicate_b64_b32 s[28:29], s28
  s_bitreplicate_b64_b32 s[30:31], s30
  s_and_b32 s28, s28, 0x55555555
  s_and_b32 s30, s30, 0xaaaaaaaa
  s_or_b32 s58, s28, s30
  s_andn2_b32 s52, 0xfff, s46
  s_lshr_b32 s52, s52, 5
  s_sub_u32 s26, s52, s60
  s_add_u32 s27, s26, 3
  s_add_u32 s26, s26, 2
  s_lshr_b32 s27, s27, 2
  s_lshr_b32 s26, s26, 2
  s_add_u32 s26, s26, s27
  s_bfm_b64 s[28:29], s26, 0
  s_mov_b32 s54, s28
  s_mov_b32 s53, 0
  s_mov_b32 s63, 0
  s_mov_b32 s49, 72
  s_mov_b32 s59, 64
  s_mov_b32 s50, 0
  s_mov_b32 s89, 0
  s_branch o_pick_142

.section .rodata,"a"
.p2align 6
.amdhsa_kernel interleave_layers__memory_aug_recurrent_mem_tr__moe_arch_mod__prompt_kernel
  .amdhsa_next_free_vgpr 512
  .amdhsa_next_free_sgpr 102
  .amdhsa_accum_offset 256
  .amdhsa_group_segment_fixed_size 0
  .amdhsa_kernarg_size 120
  .amdhsa_user_sgpr_count 2
  .amdhsa_user_sgpr_kernarg_segment_ptr 1
  .amdhsa_system_sgpr_workgroup_id_x 1
  .amdhsa_float_denorm_mode_32 3
.end_amdhsa_kernel
```

```asm
; @launch grid=(256,1,1) block=(256,1,1) lds=163840
.amdgcn_target "amdgcn-amd-amdhsa--gfx950"
.text
.globl interleave_layers__memory_aug_recurrent_mem_tr__moe_arch_mod__prompt_kernel
.p2align 8
.type interleave_layers__memory_aug_recurrent_mem_tr__moe_arch_mod__prompt_kernel,@function
interleave_layers__memory_aug_recurrent_mem_tr__moe_arch_mod__prompt_kernel:
  s_cmp_ge_u32 s2, 256
  s_cbranch_scc1 L_end
  s_mov_b32 s6, 268435456
  s_mov_b32 s7, 0x20000
  s_mov_b32 s11, 0x20000
  s_getreg_b32 s89, hwreg(HW_REG_XCC_ID)
  s_and_b32 s89, s89, 7
  v_lshrrev_b32 v1, 6, v0
  s_and_b32 s91, s2, 7
  s_lshr_b32 s90, s2, 3
  v_readfirstlane_b32 s17, v1
  s_lshl_b32 s100, s91, 5
  s_add_u32 s100, s100, s90
  s_lshl_b32 s100, s100, 2
  s_add_u32 s100, s100, s17
  s_lshl_b32 s100, s100, 12
  s_add_u32 s100, s100, 37748736
  s_cmp_lt_u32 s91, 3
  s_cbranch_scc1 L_chain
  s_cmp_eq_u32 s91, 7
  s_cbranch_scc1 L_qkv
  s_bitcmp1_b32 s90, 4
  s_cbranch_scc1 L_qkv
  s_branch L_o
L_end:
  s_endpgm
L_chain:
  s_load_dwordx2 s[4:5], s[0:1], 112
  s_load_dwordx2 s[12:13], s[0:1], 104
  s_mov_b32 s16, s90
  s_mov_b32 s60, s91
  s_min_u32 s61, s91, 1
  v_lshrrev_b32 v18, 6, v0
  v_and_b32 v19, 63, v0
  v_readfirstlane_b32 s17, v18
  v_and_b32 v7, 15, v19
  v_lshrrev_b32 v17, 4, v19
  v_lshlrev_b32 v0, 4, v19
  s_load_dwordx2 s[56:57], s[0:1], 8
  s_mov_b32 s44, 0x05040100
  s_mov_b32 s45, 0x07060302
  s_mov_b32 s18, 0xcccccccc
  s_mov_b32 s19, 0xcccccccc
  s_mov_b32 s24, 0x3e0293ee
  s_lshl_b32 s26, s17, 10
  v_add_u32 v8, s26, v0
  v_xor_b32 v9, 1024, v8
  v_xor_b32 v10, 2048, v8
  v_xor_b32 v11, 3072, v8
  s_mov_b32 s14, 0x3f803f80
  s_mov_b32 s15, 0x3f803f80
  s_mul_i32 s27, s17, 24576
  s_add_u32 s27, s27, 65536
  v_add_u32 v1, s27, v0
  v_lshrrev_b32 v20, 2, v7
  v_xor_b32 v21, v17, v20
  v_lshlrev_b32 v22, 5, v7
  v_add_u32 v22, s26, v22
  v_lshl_add_u32 v2, v21, 3, v22
  v_and_b32 v21, 3, v7
  v_xor_b32 v21, v21, v17
  v_lshl_add_u32 v22, v17, 2, v20
  v_lshlrev_b32 v22, 5, v22
  v_lshl_add_u32 v3, v21, 3, v22
  v_add_u32 v12, s26, v3
  v_xor_b32 v13, 1024, v12
  v_xor_b32 v14, 2048, v12
  v_xor_b32 v15, 3072, v12
  v_lshlrev_b32 v21, 13, v20
  v_and_b32 v22, 3, v7
  v_lshl_add_u32 v22, v17, 2, v22
  v_lshl_add_u32 v21, v22, 4, v21
  s_lshl_b32 s27, s17, 16
  s_lshl_b32 s28, s16, 8
  s_add_u32 s27, s27, s28
  v_add_u32 v4, s27, v21
  v_and_b32 v21, 1, v7
  v_lshl_add_u32 v21, v17, 2, v21
  v_bfe_u32 v22, v7, 2, 1
  v_lshl_add_u32 v21, v22, 1, v21
  v_lshlrev_b32 v21, 4, v21
  v_bfe_u32 v22, v7, 1, 1
  v_lshl_add_u32 v21, v22, 3, v21
  v_add_u32 v5, s28, v21
  v_cmp_lt_u32 vcc, 7, v7
  v_mov_b32 v22, 0x7ff00000
  s_nop 0
  v_cndmask_b32 v5, v5, v22, vcc
  v_mov_b32 v21, 0x4444
  v_mov_b32 v22, 0xeeee
  v_cndmask_b32 v6, v21, v22, s[18:19]
  s_lshl_b32 s40, s60, 20
  s_add_u32 s40, s40, 0
  s_add_u32 s41, s40, 32768
  s_lshl_b32 s62, s60, 16
  s_add_u32 s62, s62, 4194304
  v_mov_b32 v24, -1
  v_mov_b32 v25, -1
  v_mov_b32 v26, -1
  v_mov_b32 v27, -1
  s_waitcnt lgkmcnt(0)
  buffer_store_dwordx4 v[24:27], v4, s[4:7], s40 offen sc1
  buffer_store_dwordx4 v[24:27], v4, s[4:7], s41 offen sc1
  s_add_u32 s27, s62, 0
  buffer_store_dwordx2 v[24:25], v5, s[4:7], s27 offen sc1
  s_add_u32 s27, s62, 8192
  buffer_store_dwordx2 v[24:25], v5, s[4:7], s27 offen sc1
  s_add_u32 s27, s62, 16384
  buffer_store_dwordx2 v[24:25], v5, s[4:7], s27 offen sc1
  s_add_u32 s27, s62, 24576
  buffer_store_dwordx2 v[24:25], v5, s[4:7], s27 offen sc1
  s_lshl_b32 s26, s16, 12
  s_cmp_eq_u32 s91, 0
  s_cbranch_scc1 L_ch0
  s_cmp_eq_u32 s91, 2
  s_cbranch_scc1 L_ch2
  v_mov_b64 v[28:29], 0
  v_mov_b64 v[30:31], 0
  s_add_u32 s27, s26, 243269632
  buffer_store_dwordx4 v[28:31], v8, s[4:7], s27 offen sc1
  s_add_u32 s27, s26, 243400704
  buffer_store_dwordx4 v[28:31], v8, s[4:7], s27 offen sc1
  s_add_u32 s27, s26, 243531776
  buffer_store_dwordx4 v[28:31], v8, s[4:7], s27 offen sc1
  s_add_u32 s27, s26, 243662848
  buffer_store_dwordx4 v[28:31], v8, s[4:7], s27 offen sc1
  s_add_u32 s27, s26, 243793920
  buffer_store_dwordx4 v[28:31], v8, s[4:7], s27 offen sc1
  s_add_u32 s27, s26, 243924992
  buffer_store_dwordx4 v[28:31], v8, s[4:7], s27 offen sc1
  s_add_u32 s27, s26, 244056064
  buffer_store_dwordx4 v[28:31], v8, s[4:7], s27 offen sc1
  s_add_u32 s27, s26, 244187136
  buffer_store_dwordx4 v[28:31], v8, s[4:7], s27 offen sc1
  s_add_u32 s27, s26, 244318208
  buffer_store_dwordx4 v[28:31], v8, s[4:7], s27 offen sc1
  s_add_u32 s27, s26, 244449280
  buffer_store_dwordx4 v[28:31], v8, s[4:7], s27 offen sc1
  s_add_u32 s27, s26, 244580352
  buffer_store_dwordx4 v[28:31], v8, s[4:7], s27 offen sc1
  s_add_u32 s27, s26, 244711424
  buffer_store_dwordx4 v[28:31], v8, s[4:7], s27 offen sc1
  s_add_u32 s27, s26, 244842496
  buffer_store_dwordx4 v[28:31], v8, s[4:7], s27 offen sc1
  s_add_u32 s27, s26, 244973568
  buffer_store_dwordx4 v[28:31], v8, s[4:7], s27 offen sc1
  s_add_u32 s27, s26, 245104640
  buffer_store_dwordx4 v[28:31], v8, s[4:7], s27 offen sc1
  s_add_u32 s27, s26, 245235712
  buffer_store_dwordx4 v[28:31], v8, s[4:7], s27 offen sc1
  s_add_u32 s27, s26, 245366784
  buffer_store_dwordx4 v[28:31], v8, s[4:7], s27 offen sc1
  s_branch L_ch0
L_ch2:
  s_add_u32 s27, s26, 245891072
  buffer_store_dwordx4 v[24:27], v8, s[4:7], s27 offen sc1
  s_add_u32 s27, s26, 246022144
  buffer_store_dwordx4 v[24:27], v8, s[4:7], s27 offen sc1
  s_add_u32 s27, s26, 246153216
  buffer_store_dwordx4 v[24:27], v8, s[4:7], s27 offen sc1
  s_add_u32 s27, s26, 246284288
  buffer_store_dwordx4 v[24:27], v8, s[4:7], s27 offen sc1
  s_add_u32 s27, s26, 246415360
  buffer_store_dwordx4 v[24:27], v8, s[4:7], s27 offen sc1
  s_add_u32 s27, s26, 246546432
  buffer_store_dwordx4 v[24:27], v8, s[4:7], s27 offen sc1
  s_add_u32 s27, s26, 246677504
  buffer_store_dwordx4 v[24:27], v8, s[4:7], s27 offen sc1
  s_add_u32 s27, s26, 246808576
  buffer_store_dwordx4 v[24:27], v8, s[4:7], s27 offen sc1
  s_add_u32 s27, s26, 246939648
  buffer_store_dwordx4 v[24:27], v8, s[4:7], s27 offen sc1
  s_add_u32 s27, s26, 247070720
  buffer_store_dwordx4 v[24:27], v8, s[4:7], s27 offen sc1
  s_add_u32 s27, s26, 247201792
  buffer_store_dwordx4 v[24:27], v8, s[4:7], s27 offen sc1
  s_add_u32 s27, s26, 247332864
  buffer_store_dwordx4 v[24:27], v8, s[4:7], s27 offen sc1
  s_add_u32 s27, s26, 247463936
  buffer_store_dwordx4 v[24:27], v8, s[4:7], s27 offen sc1
  s_add_u32 s27, s26, 247595008
  buffer_store_dwordx4 v[24:27], v8, s[4:7], s27 offen sc1
  s_add_u32 s27, s26, 247726080
  buffer_store_dwordx4 v[24:27], v8, s[4:7], s27 offen sc1
  s_add_u32 s27, s26, 247857152
  buffer_store_dwordx4 v[24:27], v8, s[4:7], s27 offen sc1
  s_add_u32 s27, s26, 247988224
  buffer_store_dwordx4 v[24:27], v8, s[4:7], s27 offen sc1
  s_add_u32 s27, s26, 248119296
  buffer_store_dwordx4 v[24:27], v8, s[4:7], s27 offen sc1
  s_add_u32 s27, s26, 248250368
  buffer_store_dwordx4 v[24:27], v8, s[4:7], s27 offen sc1
  s_add_u32 s27, s26, 248381440
  buffer_store_dwordx4 v[24:27], v8, s[4:7], s27 offen sc1
  s_add_u32 s27, s26, 248512512
  buffer_store_dwordx4 v[24:27], v8, s[4:7], s27 offen sc1
  s_add_u32 s27, s26, 248643584
  buffer_store_dwordx4 v[24:27], v8, s[4:7], s27 offen sc1
L_ch0:
  s_waitcnt vmcnt(0)
  s_barrier
  s_cmp_lg_u32 s17, 0
  s_cbranch_scc1 g_ar_1
  s_lshl_b32 s36, s89, 3
  s_lshl_b64 s[36:37], 1, s36
  v_lshlrev_b32 v124, 3, s91
  v_mov_b32 v120, s36
  v_mov_b32 v121, s37
  s_mov_b64 exec, 1
  global_atomic_add_x2 v[122:123], v124, v[120:121], s[12:13] sc0
  s_mov_b64 exec, -1
g_ar_1:
  s_cmp_lg_u32 s91, 1
  s_cbranch_scc1 L_ch1
  s_waitcnt vmcnt(0)
  s_cmp_lg_u32 s17, 0
  s_cbranch_scc1 g_af_2
  v_readfirstlane_b32 s36, v122
  v_readfirstlane_b32 s37, v123
  s_add_u32 s38, s36, s37
  s_mul_i32 s38, s38, 0x01010101
  s_lshr_b32 s38, s38, 24
  s_cmp_lg_u32 s38, 31
  s_cbranch_scc1 g_af_2
  s_lshl_b32 s38, s89, 3
  s_lshr_b64 s[36:37], s[36:37], s38
  s_and_b32 s36, s36, 0xff
  s_cmp_eq_u32 s36, 31
  s_cselect_b32 s36, 1, 2
  v_mov_b32 v120, s36
  v_lshrrev_b32 v124, 1, v124
  s_mov_b64 exec, 1
  global_store_dword v124, v120, s[12:13] offset:128 sc1
  s_mov_b64 exec, -1
g_af_2:
  v_mov_b64 v[122:123], 0
L_ch1:
  s_mov_b32 s58, 8192
  s_mov_b32 s59, 0x20000
  v_and_b32 v21, 1, v7
  v_lshl_add_u32 v21, v17, 1, v21
  v_lshlrev_b32 v21, 10, v21
  v_bfe_u32 v22, v7, 1, 2
  v_lshl_add_u32 v21, v22, 1, v21
  s_lshr_b32 s27, s16, 3
  s_lshl_b32 s27, s27, 8
  s_and_b32 s28, s16, 3
  s_lshl_b32 s28, s28, 6
  s_add_u32 s27, s27, s28
  s_and_b32 s28, s16, 4
  s_lshl_b32 s28, s28, 1
  s_add_u32 s27, s27, s28
  s_waitcnt lgkmcnt(0)
  buffer_load_ushort v28, v21, s[56:59], s27 offen offset:0
  buffer_load_ushort v29, v21, s[56:59], s27 offen offset:16
  buffer_load_ushort v30, v21, s[56:59], s27 offen offset:32
  buffer_load_ushort v31, v21, s[56:59], s27 offen offset:48
  s_cmp_eq_u32 s91, 0
  s_cbranch_scc1 L_ha
  s_waitcnt vmcnt(0)
  s_cmp_lg_u32 s17, 0
  s_cbranch_scc1 g_af_3
  v_readfirstlane_b32 s36, v122
  v_readfirstlane_b32 s37, v123
  s_add_u32 s38, s36, s37
  s_mul_i32 s38, s38, 0x01010101
  s_lshr_b32 s38, s38, 24
  s_cmp_lg_u32 s38, 31
  s_cbranch_scc1 g_af_3
  s_lshl_b32 s38, s89, 3
  s_lshr_b64 s[36:37], s[36:37], s38
  s_and_b32 s36, s36, 0xff
  s_cmp_eq_u32 s36, 31
  s_cselect_b32 s36, 1, 2
  v_mov_b32 v120, s36
  v_lshrrev_b32 v124, 1, v124
  s_mov_b64 exec, 1
  global_store_dword v124, v120, s[12:13] offset:128 sc1
  s_mov_b64 exec, -1
g_af_3:
  v_mov_b64 v[122:123], 0
  v_mbcnt_lo_u32_b32 v116, -1, 0
  v_and_b32 v116, 0, v116
  v_add_lshl_u32 v116, v116, 1, 2
  s_mov_b32 s26, 0
g_wt_4:
  global_load_dword v117, v116, s[12:13] offset:128 sc1
  s_add_u32 s26, s26, 1
  s_cmp_gt_u32 s26, 1048576
  s_cbranch_scc1 L_end
  s_waitcnt vmcnt(0)
  v_cmp_eq_u32 vcc, 0, v117
  v_readfirstlane_b32 s27, v117
  s_cbranch_vccnz g_wt_4
  s_and_b32 s28, s16, 28
  s_or_b32 s28, s28, 1
  s_lshl_b32 s27, s28, 6
  s_add_u32 s27, s27, 245104640
  s_mov_b32 s26, 0
g_h_5:
  buffer_load_dwordx2 v[116:117], off, s[4:7], s27 sc1
  s_add_u32 s26, s26, 1
  s_cmp_gt_u32 s26, 1048576
  s_cbranch_scc1 L_end
  s_waitcnt vmcnt(0)
  v_or_b32 v116, v116, v117
  v_cmp_eq_u32 vcc, 0, v116
  s_cbranch_vccnz g_h_5
L_ha:
  s_load_dwordx2 s[8:9], s[0:1], 40
  s_load_dwordx2 s[52:53], s[0:1], 16
  s_load_dwordx2 s[32:33], s[0:1], 24
  s_load_dwordx2 s[48:49], s[0:1], 32
  s_mov_b32 s10, 4194304
  s_mov_b32 s11, 0x20000
  s_mov_b32 s54, 4194304
  s_mov_b32 s55, 0x20000
  s_mov_b32 s34, 4194304
  s_mov_b32 s35, 0x20000
  s_mov_b32 s50, 4194304
  s_mov_b32 s51, 0x20000
  v_and_b32 v20, 1, v17
  v_lshlrev_b32 v20, 5, v20
  v_lshrrev_b32 v21, 1, v17
  v_lshl_add_u32 v20, v21, 2, v20
  v_lshlrev_b32 v20, 10, v20
  v_lshl_add_u32 v20, v7, 4, v20
  s_lshl_b32 s26, s16, 17
  s_lshl_b32 s27, s17, 8
  s_add_u32 s26, s26, s27
  s_waitcnt lgkmcnt(0)
  s_add_u32 s27, s26, 0
  buffer_load_dwordx4 v[128:131], v20, s[8:11], s27 offen
  s_add_u32 s27, s26, 1024
  buffer_load_dwordx4 v[132:135], v20, s[8:11], s27 offen
  s_add_u32 s27, s26, 16384
  buffer_load_dwordx4 v[136:139], v20, s[8:11], s27 offen
  s_add_u32 s27, s26, 17408
  buffer_load_dwordx4 v[140:143], v20, s[8:11], s27 offen
  s_add_u32 s27, s26, 2048
  buffer_load_dwordx4 v[144:147], v20, s[8:11], s27 offen
  s_add_u32 s27, s26, 3072
  buffer_load_dwordx4 v[148:151], v20, s[8:11], s27 offen
  s_add_u32 s27, s26, 18432
  buffer_load_dwordx4 v[152:155], v20, s[8:11], s27 offen
  s_add_u32 s27, s26, 19456
  buffer_load_dwordx4 v[156:159], v20, s[8:11], s27 offen
  s_add_u32 s27, s26, 8192
  buffer_load_dwordx4 v[160:163], v20, s[8:11], s27 offen
  s_add_u32 s27, s26, 9216
  buffer_load_dwordx4 v[164:167], v20, s[8:11], s27 offen
  s_add_u32 s27, s26, 24576
  buffer_load_dwordx4 v[168:171], v20, s[8:11], s27 offen
  s_add_u32 s27, s26, 25600
  buffer_load_dwordx4 v[172:175], v20, s[8:11], s27 offen
  s_add_u32 s27, s26, 10240
  buffer_load_dwordx4 v[176:179], v20, s[8:11], s27 offen
  s_add_u32 s27, s26, 11264
  buffer_load_dwordx4 v[180:183], v20, s[8:11], s27 offen
  s_add_u32 s27, s26, 26624
  buffer_load_dwordx4 v[184:187], v20, s[8:11], s27 offen
  s_add_u32 s27, s26, 27648
  buffer_load_dwordx4 v[188:191], v20, s[8:11], s27 offen
  s_add_u32 s27, s26, 65536
  buffer_load_dwordx4 v[192:195], v20, s[8:11], s27 offen
  s_add_u32 s27, s26, 66560
  buffer_load_dwordx4 v[196:199], v20, s[8:11], s27 offen
  s_add_u32 s27, s26, 81920
  buffer_load_dwordx4 v[200:203], v20, s[8:11], s27 offen
  s_add_u32 s27, s26, 82944
  buffer_load_dwordx4 v[204:207], v20, s[8:11], s27 offen
  s_add_u32 s27, s26, 67584
  buffer_load_dwordx4 v[208:211], v20, s[8:11], s27 offen
  s_add_u32 s27, s26, 68608
  buffer_load_dwordx4 v[212:215], v20, s[8:11], s27 offen
  s_add_u32 s27, s26, 83968
  buffer_load_dwordx4 v[216:219], v20, s[8:11], s27 offen
  s_add_u32 s27, s26, 84992
  buffer_load_dwordx4 v[220:223], v20, s[8:11], s27 offen
  s_add_u32 s27, s26, 73728
  buffer_load_dwordx4 v[224:227], v20, s[8:11], s27 offen
  s_add_u32 s27, s26, 74752
  buffer_load_dwordx4 v[228:231], v20, s[8:11], s27 offen
  s_add_u32 s27, s26, 90112
  buffer_load_dwordx4 v[232:235], v20, s[8:11], s27 offen
  s_add_u32 s27, s26, 91136
  buffer_load_dwordx4 v[236:239], v20, s[8:11], s27 offen
  s_add_u32 s27, s26, 75776
  buffer_load_dwordx4 v[240:243], v20, s[8:11], s27 offen
  s_add_u32 s27, s26, 76800
  buffer_load_dwordx4 v[244:247], v20, s[8:11], s27 offen
  s_add_u32 s27, s26, 92160
  buffer_load_dwordx4 v[248:251], v20, s[8:11], s27 offen
  s_add_u32 s27, s26, 93184
  buffer_load_dwordx4 v[252:255], v20, s[8:11], s27 offen
  s_waitcnt vmcnt(36)
  s_cmp_lg_u32 s17, 0
  s_cbranch_scc1 g_af_6
  v_readfirstlane_b32 s36, v122
  v_readfirstlane_b32 s37, v123
  s_add_u32 s38, s36, s37
  s_mul_i32 s38, s38, 0x01010101
  s_lshr_b32 s38, s38, 24
  s_cmp_lg_u32 s38, 31
  s_cbranch_scc1 g_af_6
  s_lshl_b32 s38, s89, 3
  s_lshr_b64 s[36:37], s[36:37], s38
  s_and_b32 s36, s36, 0xff
  s_cmp_eq_u32 s36, 31
  s_cselect_b32 s36, 1, 2
  v_mov_b32 v120, s36
  v_lshrrev_b32 v124, 1, v124
  s_mov_b64 exec, 1
  global_store_dword v124, v120, s[12:13] offset:128 sc1
  s_mov_b64 exec, -1
g_af_6:
  v_lshrrev_b32 v20, 8, v0
  v_and_b32 v22, 0xf0, v0
  v_lshlrev_b32 v23, 6, v20
  v_xor_b32 v22, v22, v23
  v_lshl_add_u32 v22, v20, 13, v22
  v_xor_b32 v23, 32, v22
  s_lshr_b32 s26, s17, 1
  s_lshl_b32 s26, s26, 20
  s_and_b32 s27, s17, 1
  s_lshl_b32 s27, s27, 18
  s_add_u32 s26, s26, s27
  s_lshl_b32 s27, s16, 8
  s_add_u32 s26, s26, s27
  s_lshl_b32 s28, s17, 13
  s_add_u32 s27, s26, 0
  s_add_u32 m0, s28, 65536
  s_nop 0
  buffer_load_dwordx4 v22, s[32:35], s27 offen lds
  s_add_u32 m0, s28, 66560
  s_add_u32 s27, s27, 32768
  buffer_load_dwordx4 v22, s[32:35], s27 offen lds
  s_add_u32 m0, s28, 67584
  s_add_u32 s27, s27, 32768
  buffer_load_dwordx4 v23, s[32:35], s27 offen lds
  s_add_u32 m0, s28, 68608
  s_add_u32 s27, s27, 32768
  buffer_load_dwordx4 v23, s[32:35], s27 offen lds
  s_add_u32 m0, s28, 69632
  s_add_u32 s27, s27, 32768
  buffer_load_dwordx4 v22, s[32:35], s27 offen lds
  s_add_u32 m0, s28, 70656
  s_add_u32 s27, s27, 32768
  buffer_load_dwordx4 v22, s[32:35], s27 offen lds
  s_add_u32 m0, s28, 71680
  s_add_u32 s27, s27, 32768
  buffer_load_dwordx4 v23, s[32:35], s27 offen lds
  s_add_u32 m0, s28, 72704
  s_add_u32 s27, s27, 32768
  buffer_load_dwordx4 v23, s[32:35], s27 offen lds
  s_add_u32 s27, s26, 524288
  s_add_u32 m0, s28, 98304
  s_nop 0
  buffer_load_dwordx4 v22, s[32:35], s27 offen lds
  s_add_u32 m0, s28, 99328
  s_add_u32 s27, s27, 32768
  buffer_load_dwordx4 v22, s[32:35], s27 offen lds
  s_add_u32 m0, s28, 100352
  s_add_u32 s27, s27, 32768
  buffer_load_dwordx4 v23, s[32:35], s27 offen lds
  s_add_u32 m0, s28, 101376
  s_add_u32 s27, s27, 32768
  buffer_load_dwordx4 v23, s[32:35], s27 offen lds
  s_add_u32 m0, s28, 102400
  s_add_u32 s27, s27, 32768
  buffer_load_dwordx4 v22, s[32:35], s27 offen lds
  s_add_u32 m0, s28, 103424
  s_add_u32 s27, s27, 32768
  buffer_load_dwordx4 v22, s[32:35], s27 offen lds
  s_add_u32 m0, s28, 104448
  s_add_u32 s27, s27, 32768
  buffer_load_dwordx4 v23, s[32:35], s27 offen lds
  s_add_u32 m0, s28, 105472
  s_add_u32 s27, s27, 32768
  buffer_load_dwordx4 v23, s[32:35], s27 offen lds
  s_waitcnt vmcnt(48)
  v_lshl_or_b32 v28, v29, 16, v28
  v_lshl_or_b32 v29, v31, 16, v30
  v_min_u32 v28, -2, v28
  v_min_u32 v29, -2, v29
  buffer_store_dwordx2 v[28:29], v5, s[4:7], s62 offen sc1
  s_add_u32 s27, s26, 2097152
  s_add_u32 m0, s28, 131072
  s_nop 0
  buffer_load_dwordx4 v22, s[32:35], s27 offen lds
  s_add_u32 m0, s28, 132096
  s_add_u32 s27, s27, 32768
  buffer_load_dwordx4 v22, s[32:35], s27 offen lds
  s_add_u32 m0, s28, 133120
  s_add_u32 s27, s27, 32768
  buffer_load_dwordx4 v23, s[32:35], s27 offen lds
  s_add_u32 m0, s28, 134144
  s_add_u32 s27, s27, 32768
  buffer_load_dwordx4 v23, s[32:35], s27 offen lds
  s_add_u32 m0, s28, 135168
  s_add_u32 s27, s27, 32768
  buffer_load_dwordx4 v22, s[32:35], s27 offen lds
  s_add_u32 m0, s28, 136192
  s_add_u32 s27, s27, 32768
  buffer_load_dwordx4 v22, s[32:35], s27 offen lds
  s_add_u32 m0, s28, 137216
  s_add_u32 s27, s27, 32768
  buffer_load_dwordx4 v23, s[32:35], s27 offen lds
  s_add_u32 m0, s28, 138240
  s_add_u32 s27, s27, 32768
  buffer_load_dwordx4 v23, s[32:35], s27 offen lds
  v_bfe_u32 v20, v7, 2, 1
  v_lshrrev_b32 v21, 3, v7
  v_and_b32 v104, 1, v17
  v_lshl_add_u32 v21, v21, 1, v104
  v_lshl_add_u32 v104, v20, 3, v21
  v_lshrrev_b32 v105, 1, v17
  v_lshl_add_u32 v104, v105, 5, v104
  v_lshl_add_u32 v20, v21, 1, v20
  s_lshl_b32 s29, s17, 1
  v_xor_b32 v20, s29, v20
  v_lshlrev_b32 v20, 5, v20
  v_lshl_add_u32 v20, v104, 8, v20
  v_and_b32 v21, 3, v7
  v_lshl_add_u32 v20, v21, 3, v20
  s_lshr_b32 s29, s17, 1
  s_lshl_b32 s29, s29, 14
  s_and_b32 s30, s17, 1
  s_lshl_b32 s30, s30, 10
  s_add_u32 s29, s29, s30
  s_add_u32 s29, s29, 65536
  v_add_u32 v20, s29, v20
  v_xor_b32 v104, 0, v20
  v_xor_b32 v105, 32, v20
  v_xor_b32 v106, 1024, v20
  v_xor_b32 v107, 1056, v20
  v_xor_b32 v108, 16384, v20
  v_xor_b32 v109, 16416, v20
  v_xor_b32 v110, 17408, v20
  v_xor_b32 v111, 17440, v20
  s_waitcnt vmcnt(49)
  v_perm_b32 v120, v132, v128, s44
  v_perm_b32 v121, v140, v136, s44
  v_perm_b32 v122, v148, v144, s44
  v_perm_b32 v123, v156, v152, s44
  v_accvgpr_write_b32 a248, v120
  v_accvgpr_write_b32 a249, v121
  v_accvgpr_write_b32 a250, v122
  v_accvgpr_write_b32 a251, v123
  v_perm_b32 v124, v132, v128, s45
  v_perm_b32 v125, v140, v136, s45
  v_perm_b32 v126, v148, v144, s45
  v_perm_b32 v127, v156, v152, s45
  v_accvgpr_write_b32 a232, v124
  v_accvgpr_write_b32 a233, v125
  v_accvgpr_write_b32 a234, v126
  v_accvgpr_write_b32 a235, v127
  v_perm_b32 v120, v133, v129, s44
  v_perm_b32 v121, v141, v137, s44
  v_perm_b32 v122, v149, v145, s44
  v_perm_b32 v123, v157, v153, s44
  v_accvgpr_write_b32 a216, v120
  v_accvgpr_write_b32 a217, v121
  v_accvgpr_write_b32 a218, v122
  v_accvgpr_write_b32 a219, v123
  v_perm_b32 v124, v133, v129, s45
  v_perm_b32 v125, v141, v137, s45
  v_perm_b32 v126, v149, v145, s45
  v_perm_b32 v127, v157, v153, s45
  v_accvgpr_write_b32 a200, v124
  v_accvgpr_write_b32 a201, v125
  v_accvgpr_write_b32 a202, v126
  v_accvgpr_write_b32 a203, v127
  v_perm_b32 v120, v134, v130, s44
  v_perm_b32 v121, v142, v138, s44
  v_perm_b32 v122, v150, v146, s44
  v_perm_b32 v123, v158, v154, s44
  v_accvgpr_write_b32 a184, v120
  v_accvgpr_write_b32 a185, v121
  v_accvgpr_write_b32 a186, v122
  v_accvgpr_write_b32 a187, v123
  v_perm_b32 v24, v134, v130, s45
  v_perm_b32 v25, v142, v138, s45
  v_perm_b32 v26, v150, v146, s45
  v_perm_b32 v27, v158, v154, s45
  v_perm_b32 v40, v135, v131, s44
  v_perm_b32 v41, v143, v139, s44
  v_perm_b32 v42, v151, v147, s44
  v_perm_b32 v43, v159, v155, s44
  v_perm_b32 v56, v135, v131, s45
  v_perm_b32 v57, v143, v139, s45
  v_perm_b32 v58, v151, v147, s45
  v_perm_b32 v59, v159, v155, s45
  s_waitcnt vmcnt(41)
  v_perm_b32 v120, v164, v160, s44
  v_perm_b32 v121, v172, v168, s44
  v_perm_b32 v122, v180, v176, s44
  v_perm_b32 v123, v188, v184, s44
  v_accvgpr_write_b32 a252, v120
  v_accvgpr_write_b32 a253, v121
  v_accvgpr_write_b32 a254, v122
  v_accvgpr_write_b32 a255, v123
  v_perm_b32 v124, v164, v160, s45
  v_perm_b32 v125, v172, v168, s45
  v_perm_b32 v126, v180, v176, s45
  v_perm_b32 v127, v188, v184, s45
  v_accvgpr_write_b32 a236, v124
  v_accvgpr_write_b32 a237, v125
  v_accvgpr_write_b32 a238, v126
  v_accvgpr_write_b32 a239, v127
  v_perm_b32 v120, v165, v161, s44
  v_perm_b32 v121, v173, v169, s44
  v_perm_b32 v122, v181, v177, s44
  v_perm_b32 v123, v189, v185, s44
  v_accvgpr_write_b32 a220, v120
  v_accvgpr_write_b32 a221, v121
  v_accvgpr_write_b32 a222, v122
  v_accvgpr_write_b32 a223, v123
  v_perm_b32 v124, v165, v161, s45
  v_perm_b32 v125, v173, v169, s45
  v_perm_b32 v126, v181, v177, s45
  v_perm_b32 v127, v189, v185, s45
  v_accvgpr_write_b32 a204, v124
  v_accvgpr_write_b32 a205, v125
  v_accvgpr_write_b32 a206, v126
  v_accvgpr_write_b32 a207, v127
  v_perm_b32 v120, v166, v162, s44
  v_perm_b32 v121, v174, v170, s44
  v_perm_b32 v122, v182, v178, s44
  v_perm_b32 v123, v190, v186, s44
  v_accvgpr_write_b32 a188, v120
  v_accvgpr_write_b32 a189, v121
  v_accvgpr_write_b32 a190, v122
  v_accvgpr_write_b32 a191, v123
  v_perm_b32 v28, v166, v162, s45
  v_perm_b32 v29, v174, v170, s45
  v_perm_b32 v30, v182, v178, s45
  v_perm_b32 v31, v190, v186, s45
  v_perm_b32 v44, v167, v163, s44
  v_perm_b32 v45, v175, v171, s44
  v_perm_b32 v46, v183, v179, s44
  v_perm_b32 v47, v191, v187, s44
  v_perm_b32 v60, v167, v163, s45
  v_perm_b32 v61, v175, v171, s45
  v_perm_b32 v62, v183, v179, s45
  v_perm_b32 v63, v191, v187, s45
  s_waitcnt vmcnt(33)
  v_perm_b32 v120, v196, v192, s44
  v_perm_b32 v121, v204, v200, s44
  v_perm_b32 v122, v212, v208, s44
  v_perm_b32 v123, v220, v216, s44
  v_accvgpr_write_b32 a240, v120
  v_accvgpr_write_b32 a241, v121
  v_accvgpr_write_b32 a242, v122
  v_accvgpr_write_b32 a243, v123
  v_perm_b32 v124, v196, v192, s45
  v_perm_b32 v125, v204, v200, s45
  v_perm_b32 v126, v212, v208, s45
  v_perm_b32 v127, v220, v216, s45
  v_accvgpr_write_b32 a224, v124
  v_accvgpr_write_b32 a225, v125
  v_accvgpr_write_b32 a226, v126
  v_accvgpr_write_b32 a227, v127
  v_perm_b32 v120, v197, v193, s44
  v_perm_b32 v121, v205, v201, s44
  v_perm_b32 v122, v213, v209, s44
  v_perm_b32 v123, v221, v217, s44
  v_accvgpr_write_b32 a208, v120
  v_accvgpr_write_b32 a209, v121
  v_accvgpr_write_b32 a210, v122
  v_accvgpr_write_b32 a211, v123
  v_perm_b32 v124, v197, v193, s45
  v_perm_b32 v125, v205, v201, s45
  v_perm_b32 v126, v213, v209, s45
  v_perm_b32 v127, v221, v217, s45
  v_accvgpr_write_b32 a192, v124
  v_accvgpr_write_b32 a193, v125
  v_accvgpr_write_b32 a194, v126
  v_accvgpr_write_b32 a195, v127
  v_perm_b32 v120, v198, v194, s44
  v_perm_b32 v121, v206, v202, s44
  v_perm_b32 v122, v214, v210, s44
  v_perm_b32 v123, v222, v218, s44
  v_accvgpr_write_b32 a176, v120
  v_accvgpr_write_b32 a177, v121
  v_accvgpr_write_b32 a178, v122
  v_accvgpr_write_b32 a179, v123
  v_perm_b32 v32, v198, v194, s45
  v_perm_b32 v33, v206, v202, s45
  v_perm_b32 v34, v214, v210, s45
  v_perm_b32 v35, v222, v218, s45
  v_perm_b32 v48, v199, v195, s44
  v_perm_b32 v49, v207, v203, s44
  v_perm_b32 v50, v215, v211, s44
  v_perm_b32 v51, v223, v219, s44
  v_perm_b32 v64, v199, v195, s45
  v_perm_b32 v65, v207, v203, s45
  v_perm_b32 v66, v215, v211, s45
  v_perm_b32 v67, v223, v219, s45
  s_waitcnt vmcnt(25)
  v_perm_b32 v120, v228, v224, s44
  v_perm_b32 v121, v236, v232, s44
  v_perm_b32 v122, v244, v240, s44
  v_perm_b32 v123, v252, v248, s44
  v_accvgpr_write_b32 a244, v120
  v_accvgpr_write_b32 a245, v121
  v_accvgpr_write_b32 a246, v122
  v_accvgpr_write_b32 a247, v123
  v_perm_b32 v124, v228, v224, s45
  v_perm_b32 v125, v236, v232, s45
  v_perm_b32 v126, v244, v240, s45
  v_perm_b32 v127, v252, v248, s45
  v_accvgpr_write_b32 a228, v124
  v_accvgpr_write_b32 a229, v125
  v_accvgpr_write_b32 a230, v126
  v_accvgpr_write_b32 a231, v127
  v_perm_b32 v120, v229, v225, s44
  v_perm_b32 v121, v237, v233, s44
  v_perm_b32 v122, v245, v241, s44
  v_perm_b32 v123, v253, v249, s44
  v_accvgpr_write_b32 a212, v120
  v_accvgpr_write_b32 a213, v121
  v_accvgpr_write_b32 a214, v122
  v_accvgpr_write_b32 a215, v123
  v_perm_b32 v124, v229, v225, s45
  v_perm_b32 v125, v237, v233, s45
  v_perm_b32 v126, v245, v241, s45
  v_perm_b32 v127, v253, v249, s45
  v_accvgpr_write_b32 a196, v124
  v_accvgpr_write_b32 a197, v125
  v_accvgpr_write_b32 a198, v126
  v_accvgpr_write_b32 a199, v127
  v_perm_b32 v120, v230, v226, s44
  v_perm_b32 v121, v238, v234, s44
  v_perm_b32 v122, v246, v242, s44
  v_perm_b32 v123, v254, v250, s44
  v_accvgpr_write_b32 a180, v120
  v_accvgpr_write_b32 a181, v121
  v_accvgpr_write_b32 a182, v122
  v_accvgpr_write_b32 a183, v123
  v_perm_b32 v36, v230, v226, s45
  v_perm_b32 v37, v238, v234, s45
  v_perm_b32 v38, v246, v242, s45
  v_perm_b32 v39, v254, v250, s45
  v_perm_b32 v52, v231, v227, s44
  v_perm_b32 v53, v239, v235, s44
  v_perm_b32 v54, v247, v243, s44
  v_perm_b32 v55, v255, v251, s44
  v_perm_b32 v68, v231, v227, s45
  v_perm_b32 v69, v239, v235, s45
  v_perm_b32 v70, v247, v243, s45
  v_perm_b32 v71, v255, v251, s45
  v_mov_b64 v[128:129], v[24:25]
  v_mov_b64 v[130:131], v[26:27]
  v_mov_b64 v[132:133], v[28:29]
  v_mov_b64 v[134:135], v[30:31]
  v_mov_b64 v[136:137], v[32:33]
  v_mov_b64 v[138:139], v[34:35]
  v_mov_b64 v[140:141], v[36:37]
  v_mov_b64 v[142:143], v[38:39]
  v_mov_b64 v[144:145], v[40:41]
  v_mov_b64 v[146:147], v[42:43]
  v_mov_b64 v[148:149], v[44:45]
  v_mov_b64 v[150:151], v[46:47]
  v_mov_b64 v[152:153], v[48:49]
  v_mov_b64 v[154:155], v[50:51]
  v_mov_b64 v[156:157], v[52:53]
  v_mov_b64 v[158:159], v[54:55]
  v_mov_b64 v[184:185], v[56:57]
  v_mov_b64 v[186:187], v[58:59]
  v_mov_b64 v[188:189], v[60:61]
  v_mov_b64 v[190:191], v[62:63]
  v_mov_b64 v[192:193], v[64:65]
  v_mov_b64 v[194:195], v[66:67]
  v_mov_b64 v[196:197], v[68:69]
  v_mov_b64 v[198:199], v[70:71]
  s_waitcnt vmcnt(17)
  s_barrier
  s_add_u32 s27, s26, 2621440
  s_add_u32 m0, s28, 0
  s_nop 0
  buffer_load_dwordx4 v22, s[32:35], s27 offen lds
  s_add_u32 m0, s28, 1024
  s_add_u32 s27, s27, 32768
  buffer_load_dwordx4 v22, s[32:35], s27 offen lds
  s_add_u32 m0, s28, 2048
  s_add_u32 s27, s27, 32768
  buffer_load_dwordx4 v23, s[32:35], s27 offen lds
  s_add_u32 m0, s28, 3072
  s_add_u32 s27, s27, 32768
  buffer_load_dwordx4 v23, s[32:35], s27 offen lds
  s_add_u32 m0, s28, 4096
  s_add_u32 s27, s27, 32768
  buffer_load_dwordx4 v22, s[32:35], s27 offen lds
  s_add_u32 m0, s28, 5120
  s_add_u32 s27, s27, 32768
  buffer_load_dwordx4 v22, s[32:35], s27 offen lds
  s_add_u32 m0, s28, 6144
  s_add_u32 s27, s27, 32768
  buffer_load_dwordx4 v23, s[32:35], s27 offen lds
  s_add_u32 m0, s28, 7168
  s_add_u32 s27, s27, 32768
  buffer_load_dwordx4 v23, s[32:35], s27 offen lds
  ds_read_b64_tr_b16 v[40:41], v104 offset:0
  ds_read_b64_tr_b16 v[42:43], v104 offset:4096
  ds_read_b64_tr_b16 v[48:49], v105 offset:0
  ds_read_b64_tr_b16 v[50:51], v105 offset:4096
  ds_read_b64_tr_b16 a[72:73], v106 offset:0
  ds_read_b64_tr_b16 a[74:75], v106 offset:4096
  ds_read_b64_tr_b16 a[24:25], v107 offset:0
  ds_read_b64_tr_b16 a[26:27], v107 offset:4096
  ds_read_b64_tr_b16 a[64:65], v108 offset:0
  ds_read_b64_tr_b16 a[66:67], v108 offset:4096
  ds_read_b64_tr_b16 a[16:17], v109 offset:0
  ds_read_b64_tr_b16 a[18:19], v109 offset:4096
  ds_read_b64_tr_b16 a[56:57], v110 offset:0
  ds_read_b64_tr_b16 a[58:59], v110 offset:4096
  ds_read_b64_tr_b16 a[8:9], v111 offset:0
  ds_read_b64_tr_b16 a[10:11], v111 offset:4096
  s_waitcnt lgkmcnt(0)
  s_waitcnt vmcnt(17)
  s_barrier
  s_add_u32 s27, s26, 0
  s_add_u32 m0, s28, 32768
  s_nop 0
  buffer_load_dwordx4 v22, s[52:55], s27 offen lds
  s_add_u32 m0, s28, 33792
  s_add_u32 s27, s27, 32768
  buffer_load_dwordx4 v22, s[52:55], s27 offen lds
  s_add_u32 m0, s28, 34816
  s_add_u32 s27, s27, 32768
  buffer_load_dwordx4 v23, s[52:55], s27 offen lds
  s_add_u32 m0, s28, 35840
  s_add_u32 s27, s27, 32768
  buffer_load_dwordx4 v23, s[52:55], s27 offen lds
  s_add_u32 m0, s28, 36864
  s_add_u32 s27, s27, 32768
  buffer_load_dwordx4 v22, s[52:55], s27 offen lds
  s_add_u32 m0, s28, 37888
  s_add_u32 s27, s27, 32768
  buffer_load_dwordx4 v22, s[52:55], s27 offen lds
  s_add_u32 m0, s28, 38912
  s_add_u32 s27, s27, 32768
  buffer_load_dwordx4 v23, s[52:55], s27 offen lds
  s_add_u32 m0, s28, 39936
  s_add_u32 s27, s27, 32768
  buffer_load_dwordx4 v23, s[52:55], s27 offen lds
  ds_read_b64_tr_b16 v[44:45], v104 offset:32768
  ds_read_b64_tr_b16 v[46:47], v104 offset:36864
  ds_read_b64_tr_b16 v[52:53], v105 offset:32768
  ds_read_b64_tr_b16 v[54:55], v105 offset:36864
  ds_read_b64_tr_b16 a[76:77], v106 offset:32768
  ds_read_b64_tr_b16 a[78:79], v106 offset:36864
  ds_read_b64_tr_b16 a[28:29], v107 offset:32768
  ds_read_b64_tr_b16 a[30:31], v107 offset:36864
  ds_read_b64_tr_b16 a[68:69], v108 offset:32768
  ds_read_b64_tr_b16 a[70:71], v108 offset:36864
  ds_read_b64_tr_b16 a[20:21], v109 offset:32768
  ds_read_b64_tr_b16 a[22:23], v109 offset:36864
  ds_read_b64_tr_b16 a[60:61], v110 offset:32768
  ds_read_b64_tr_b16 a[62:63], v110 offset:36864
  ds_read_b64_tr_b16 a[12:13], v111 offset:32768
  ds_read_b64_tr_b16 a[14:15], v111 offset:36864
  s_waitcnt lgkmcnt(0)
  v_add_u32 v104, 65536, v104
  v_add_u32 v105, 65536, v105
  v_add_u32 v106, 65536, v106
  v_add_u32 v107, 65536, v107
  v_add_u32 v108, 65536, v108
  v_add_u32 v109, 65536, v109
  v_add_u32 v110, 65536, v110
  v_add_u32 v111, 65536, v111
  s_waitcnt vmcnt(16)
  s_barrier
  s_add_u32 s27, s26, 524288
  s_add_u32 m0, s28, 65536
  s_nop 0
  buffer_load_dwordx4 v22, s[52:55], s27 offen lds
  s_add_u32 m0, s28, 66560
  s_add_u32 s27, s27, 32768
  buffer_load_dwordx4 v22, s[52:55], s27 offen lds
  s_add_u32 m0, s28, 67584
  s_add_u32 s27, s27, 32768
  buffer_load_dwordx4 v23, s[52:55], s27 offen lds
  s_add_u32 m0, s28, 68608
  s_add_u32 s27, s27, 32768
  buffer_load_dwordx4 v23, s[52:55], s27 offen lds
  s_add_u32 m0, s28, 69632
  s_add_u32 s27, s27, 32768
  buffer_load_dwordx4 v22, s[52:55], s27 offen lds
  s_add_u32 m0, s28, 70656
  s_add_u32 s27, s27, 32768
  buffer_load_dwordx4 v22, s[52:55], s27 offen lds
  s_add_u32 m0, s28, 71680
  s_add_u32 s27, s27, 32768
  buffer_load_dwordx4 v23, s[52:55], s27 offen lds
  s_add_u32 m0, s28, 72704
  s_add_u32 s27, s27, 32768
  buffer_load_dwordx4 v23, s[52:55], s27 offen lds
  ds_read_b64_tr_b16 v[72:73], v104 offset:0
  ds_read_b64_tr_b16 v[74:75], v104 offset:4096
  ds_read_b64_tr_b16 v[80:81], v105 offset:0
  ds_read_b64_tr_b16 v[82:83], v105 offset:4096
  ds_read_b64_tr_b16 a[48:49], v106 offset:0
  ds_read_b64_tr_b16 a[50:51], v106 offset:4096
  ds_read_b64_tr_b16 a[0:1], v107 offset:0
  ds_read_b64_tr_b16 a[2:3], v107 offset:4096
  ds_read_b64_tr_b16 a[40:41], v108 offset:0
  ds_read_b64_tr_b16 a[42:43], v108 offset:4096
  ds_read_b64_tr_b16 v[248:249], v109 offset:0
  ds_read_b64_tr_b16 v[250:251], v109 offset:4096
  ds_read_b64_tr_b16 a[32:33], v110 offset:0
  ds_read_b64_tr_b16 a[34:35], v110 offset:4096
  ds_read_b64_tr_b16 v[240:241], v111 offset:0
  ds_read_b64_tr_b16 v[242:243], v111 offset:4096
  s_waitcnt lgkmcnt(0)
  v_add_u32 v104, -131072, v104
  v_add_u32 v105, -131072, v105
  v_add_u32 v106, -131072, v106
  v_add_u32 v107, -131072, v107
  v_add_u32 v108, -131072, v108
  v_add_u32 v109, -131072, v109
  v_add_u32 v110, -131072, v110
  v_add_u32 v111, -131072, v111
  s_waitcnt vmcnt(16)
  s_barrier
  s_add_u32 s27, s26, 2097152
  s_add_u32 m0, s28, 98304
  s_nop 0
  buffer_load_dwordx4 v22, s[52:55], s27 offen lds
  s_add_u32 m0, s28, 99328
  s_add_u32 s27, s27, 32768
  buffer_load_dwordx4 v22, s[52:55], s27 offen lds
  s_add_u32 m0, s28, 100352
  s_add_u32 s27, s27, 32768
  buffer_load_dwordx4 v23, s[52:55], s27 offen lds
  s_add_u32 m0, s28, 101376
  s_add_u32 s27, s27, 32768
  buffer_load_dwordx4 v23, s[52:55], s27 offen lds
  s_add_u32 m0, s28, 102400
  s_add_u32 s27, s27, 32768
  buffer_load_dwordx4 v22, s[52:55], s27 offen lds
  s_add_u32 m0, s28, 103424
  s_add_u32 s27, s27, 32768
  buffer_load_dwordx4 v22, s[52:55], s27 offen lds
  s_add_u32 m0, s28, 104448
  s_add_u32 s27, s27, 32768
  buffer_load_dwordx4 v23, s[52:55], s27 offen lds
  s_add_u32 m0, s28, 105472
  s_add_u32 s27, s27, 32768
  buffer_load_dwordx4 v23, s[52:55], s27 offen lds
  ds_read_b64_tr_b16 v[76:77], v104 offset:0
  ds_read_b64_tr_b16 v[78:79], v104 offset:4096
  ds_read_b64_tr_b16 v[84:85], v105 offset:0
  ds_read_b64_tr_b16 v[86:87], v105 offset:4096
  ds_read_b64_tr_b16 a[52:53], v106 offset:0
  ds_read_b64_tr_b16 a[54:55], v106 offset:4096
  ds_read_b64_tr_b16 a[4:5], v107 offset:0
  ds_read_b64_tr_b16 a[6:7], v107 offset:4096
  ds_read_b64_tr_b16 a[44:45], v108 offset:0
  ds_read_b64_tr_b16 a[46:47], v108 offset:4096
  ds_read_b64_tr_b16 v[252:253], v109 offset:0
  ds_read_b64_tr_b16 v[254:255], v109 offset:4096
  ds_read_b64_tr_b16 a[36:37], v110 offset:0
  ds_read_b64_tr_b16 a[38:39], v110 offset:4096
  ds_read_b64_tr_b16 v[244:245], v111 offset:0
  ds_read_b64_tr_b16 v[246:247], v111 offset:4096
  s_waitcnt lgkmcnt(0)
  s_waitcnt vmcnt(16)
  s_barrier
  s_add_u32 s27, s26, 2621440
  s_add_u32 m0, s28, 131072
  s_nop 0
  buffer_load_dwordx4 v22, s[52:55], s27 offen lds
  s_add_u32 m0, s28, 132096
  s_add_u32 s27, s27, 32768
  buffer_load_dwordx4 v22, s[52:55], s27 offen lds
  s_add_u32 m0, s28, 133120
  s_add_u32 s27, s27, 32768
  buffer_load_dwordx4 v23, s[52:55], s27 offen lds
  s_add_u32 m0, s28, 134144
  s_add_u32 s27, s27, 32768
  buffer_load_dwordx4 v23, s[52:55], s27 offen lds
  s_add_u32 m0, s28, 135168
  s_add_u32 s27, s27, 32768
  buffer_load_dwordx4 v22, s[52:55], s27 offen lds
  s_add_u32 m0, s28, 136192
  s_add_u32 s27, s27, 32768
  buffer_load_dwordx4 v22, s[52:55], s27 offen lds
  s_add_u32 m0, s28, 137216
  s_add_u32 s27, s27, 32768
  buffer_load_dwordx4 v23, s[52:55], s27 offen lds
  s_add_u32 m0, s28, 138240
  s_add_u32 s27, s27, 32768
  buffer_load_dwordx4 v23, s[52:55], s27 offen lds
  v_mbcnt_lo_u32_b32 v116, -1, 0
  v_and_b32 v116, 1, v116
  v_lshlrev_b32 v118, 2, v116
  global_load_dword v117, v118, s[12:13] offset:128 sc1
  ds_read_b64_tr_b16 v[24:25], v104 offset:32768
  ds_read_b64_tr_b16 v[26:27], v104 offset:36864
  ds_read_b64_tr_b16 v[32:33], v105 offset:32768
  ds_read_b64_tr_b16 v[34:35], v105 offset:36864
  ds_read_b64_tr_b16 a[168:169], v106 offset:32768
  ds_read_b64_tr_b16 a[170:171], v106 offset:36864
  ds_read_b64_tr_b16 a[120:121], v107 offset:32768
  ds_read_b64_tr_b16 a[122:123], v107 offset:36864
  ds_read_b64_tr_b16 a[160:161], v108 offset:32768
  ds_read_b64_tr_b16 a[162:163], v108 offset:36864
  ds_read_b64_tr_b16 a[112:113], v109 offset:32768
  ds_read_b64_tr_b16 a[114:115], v109 offset:36864
  ds_read_b64_tr_b16 a[152:153], v110 offset:32768
  ds_read_b64_tr_b16 a[154:155], v110 offset:36864
  ds_read_b64_tr_b16 a[104:105], v111 offset:32768
  ds_read_b64_tr_b16 a[106:107], v111 offset:36864
  s_waitcnt lgkmcnt(0)
  v_add_u32 v104, 65536, v104
  v_add_u32 v105, 65536, v105
  v_add_u32 v106, 65536, v106
  v_add_u32 v107, 65536, v107
  v_add_u32 v108, 65536, v108
  v_add_u32 v109, 65536, v109
  v_add_u32 v110, 65536, v110
  v_add_u32 v111, 65536, v111
  s_waitcnt vmcnt(16)
  s_barrier
  s_add_u32 s27, s26, 0
  s_add_u32 m0, s28, 0
  s_nop 0
  buffer_load_dwordx4 v22, s[48:51], s27 offen lds
  s_add_u32 m0, s28, 1024
  s_add_u32 s27, s27, 32768
  buffer_load_dwordx4 v22, s[48:51], s27 offen lds
  s_add_u32 m0, s28, 2048
  s_add_u32 s27, s27, 32768
  buffer_load_dwordx4 v23, s[48:51], s27 offen lds
  s_add_u32 m0, s28, 3072
  s_add_u32 s27, s27, 32768
  buffer_load_dwordx4 v23, s[48:51], s27 offen lds
  s_add_u32 m0, s28, 4096
  s_add_u32 s27, s27, 32768
  buffer_load_dwordx4 v22, s[48:51], s27 offen lds
  s_add_u32 m0, s28, 5120
  s_add_u32 s27, s27, 32768
  buffer_load_dwordx4 v22, s[48:51], s27 offen lds
  s_add_u32 m0, s28, 6144
  s_add_u32 s27, s27, 32768
  buffer_load_dwordx4 v23, s[48:51], s27 offen lds
  s_add_u32 m0, s28, 7168
  s_add_u32 s27, s27, 32768
  buffer_load_dwordx4 v23, s[48:51], s27 offen lds
  ds_read_b64_tr_b16 v[28:29], v104 offset:0
  ds_read_b64_tr_b16 v[30:31], v104 offset:4096
  ds_read_b64_tr_b16 v[36:37], v105 offset:0
  ds_read_b64_tr_b16 v[38:39], v105 offset:4096
  ds_read_b64_tr_b16 a[172:173], v106 offset:0
  ds_read_b64_tr_b16 a[174:175], v106 offset:4096
  ds_read_b64_tr_b16 a[124:125], v107 offset:0
  ds_read_b64_tr_b16 a[126:127], v107 offset:4096
  ds_read_b64_tr_b16 a[164:165], v108 offset:0
  ds_read_b64_tr_b16 a[166:167], v108 offset:4096
  ds_read_b64_tr_b16 a[116:117], v109 offset:0
  ds_read_b64_tr_b16 a[118:119], v109 offset:4096
  ds_read_b64_tr_b16 a[156:157], v110 offset:0
  ds_read_b64_tr_b16 a[158:159], v110 offset:4096
  ds_read_b64_tr_b16 a[108:109], v111 offset:0
  ds_read_b64_tr_b16 a[110:111], v111 offset:4096
  s_waitcnt lgkmcnt(0)
  s_waitcnt vmcnt(16)
  s_barrier
  s_add_u32 s27, s26, 524288
  s_add_u32 m0, s28, 32768
  s_nop 0
  buffer_load_dwordx4 v22, s[48:51], s27 offen lds
  s_add_u32 m0, s28, 33792
  s_add_u32 s27, s27, 32768
  buffer_load_dwordx4 v22, s[48:51], s27 offen lds
  s_add_u32 m0, s28, 34816
  s_add_u32 s27, s27, 32768
  buffer_load_dwordx4 v23, s[48:51], s27 offen lds
  s_add_u32 m0, s28, 35840
  s_add_u32 s27, s27, 32768
  buffer_load_dwordx4 v23, s[48:51], s27 offen lds
  s_add_u32 m0, s28, 36864
  s_add_u32 s27, s27, 32768
  buffer_load_dwordx4 v22, s[48:51], s27 offen lds
  s_add_u32 m0, s28, 37888
  s_add_u32 s27, s27, 32768
  buffer_load_dwordx4 v22, s[48:51], s27 offen lds
  s_add_u32 m0, s28, 38912
  s_add_u32 s27, s27, 32768
  buffer_load_dwordx4 v23, s[48:51], s27 offen lds
  s_add_u32 m0, s28, 39936
  s_add_u32 s27, s27, 32768
  buffer_load_dwordx4 v23, s[48:51], s27 offen lds
  ds_read_b64_tr_b16 v[56:57], v104 offset:32768
  ds_read_b64_tr_b16 v[58:59], v104 offset:36864
  ds_read_b64_tr_b16 v[64:65], v105 offset:32768
  ds_read_b64_tr_b16 v[66:67], v105 offset:36864
  ds_read_b64_tr_b16 a[144:145], v106 offset:32768
  ds_read_b64_tr_b16 a[146:147], v106 offset:36864
  ds_read_b64_tr_b16 a[96:97], v107 offset:32768
  ds_read_b64_tr_b16 a[98:99], v107 offset:36864
  ds_read_b64_tr_b16 a[136:137], v108 offset:32768
  ds_read_b64_tr_b16 a[138:139], v108 offset:36864
  ds_read_b64_tr_b16 a[88:89], v109 offset:32768
  ds_read_b64_tr_b16 a[90:91], v109 offset:36864
  ds_read_b64_tr_b16 a[128:129], v110 offset:32768
  ds_read_b64_tr_b16 a[130:131], v110 offset:36864
  ds_read_b64_tr_b16 a[80:81], v111 offset:32768
  ds_read_b64_tr_b16 a[82:83], v111 offset:36864
  s_waitcnt lgkmcnt(0)
  v_add_u32 v104, 65536, v104
  v_add_u32 v105, 65536, v105
  v_add_u32 v106, 65536, v106
  v_add_u32 v107, 65536, v107
  v_add_u32 v108, 65536, v108
  v_add_u32 v109, 65536, v109
  v_add_u32 v110, 65536, v110
  v_add_u32 v111, 65536, v111
  s_waitcnt vmcnt(16)
  s_barrier
  s_add_u32 s27, s26, 2097152
  s_add_u32 m0, s28, 65536
  s_nop 0
  buffer_load_dwordx4 v22, s[48:51], s27 offen lds
  s_add_u32 m0, s28, 66560
  s_add_u32 s27, s27, 32768
  buffer_load_dwordx4 v22, s[48:51], s27 offen lds
  s_add_u32 m0, s28, 67584
  s_add_u32 s27, s27, 32768
  buffer_load_dwordx4 v23, s[48:51], s27 offen lds
  s_add_u32 m0, s28, 68608
  s_add_u32 s27, s27, 32768
  buffer_load_dwordx4 v23, s[48:51], s27 offen lds
  s_add_u32 m0, s28, 69632
  s_add_u32 s27, s27, 32768
  buffer_load_dwordx4 v22, s[48:51], s27 offen lds
  s_add_u32 m0, s28, 70656
  s_add_u32 s27, s27, 32768
  buffer_load_dwordx4 v22, s[48:51], s27 offen lds
  s_add_u32 m0, s28, 71680
  s_add_u32 s27, s27, 32768
  buffer_load_dwordx4 v23, s[48:51], s27 offen lds
  s_add_u32 m0, s28, 72704
  s_add_u32 s27, s27, 32768
  buffer_load_dwordx4 v23, s[48:51], s27 offen lds
  ds_read_b64_tr_b16 v[60:61], v104 offset:0
  ds_read_b64_tr_b16 v[62:63], v104 offset:4096
  ds_read_b64_tr_b16 v[68:69], v105 offset:0
  ds_read_b64_tr_b16 v[70:71], v105 offset:4096
  ds_read_b64_tr_b16 a[148:149], v106 offset:0
  ds_read_b64_tr_b16 a[150:151], v106 offset:4096
  ds_read_b64_tr_b16 a[100:101], v107 offset:0
  ds_read_b64_tr_b16 a[102:103], v107 offset:4096
  ds_read_b64_tr_b16 a[140:141], v108 offset:0
  ds_read_b64_tr_b16 a[142:143], v108 offset:4096
  ds_read_b64_tr_b16 a[92:93], v109 offset:0
  ds_read_b64_tr_b16 a[94:95], v109 offset:4096
  ds_read_b64_tr_b16 a[132:133], v110 offset:0
  ds_read_b64_tr_b16 a[134:135], v110 offset:4096
  ds_read_b64_tr_b16 a[84:85], v111 offset:0
  ds_read_b64_tr_b16 a[86:87], v111 offset:4096
  s_waitcnt lgkmcnt(0)
  v_add_u32 v104, -131072, v104
  v_add_u32 v105, -131072, v105
  v_add_u32 v106, -131072, v106
  v_add_u32 v107, -131072, v107
  v_add_u32 v108, -131072, v108
  v_add_u32 v109, -131072, v109
  v_add_u32 v110, -131072, v110
  v_add_u32 v111, -131072, v111
  s_waitcnt vmcnt(16)
  s_barrier
  s_add_u32 s27, s26, 2621440
  s_add_u32 m0, s28, 98304
  s_nop 0
  buffer_load_dwordx4 v22, s[48:51], s27 offen lds
  s_add_u32 m0, s28, 99328
  s_add_u32 s27, s27, 32768
  buffer_load_dwordx4 v22, s[48:51], s27 offen lds
  s_add_u32 m0, s28, 100352
  s_add_u32 s27, s27, 32768
  buffer_load_dwordx4 v23, s[48:51], s27 offen lds
  s_add_u32 m0, s28, 101376
  s_add_u32 s27, s27, 32768
  buffer_load_dwordx4 v23, s[48:51], s27 offen lds
  s_add_u32 m0, s28, 102400
  s_add_u32 s27, s27, 32768
  buffer_load_dwordx4 v22, s[48:51], s27 offen lds
  s_add_u32 m0, s28, 103424
  s_add_u32 s27, s27, 32768
  buffer_load_dwordx4 v22, s[48:51], s27 offen lds
  s_add_u32 m0, s28, 104448
  s_add_u32 s27, s27, 32768
  buffer_load_dwordx4 v23, s[48:51], s27 offen lds
  s_add_u32 m0, s28, 105472
  s_add_u32 s27, s27, 32768
  buffer_load_dwordx4 v23, s[48:51], s27 offen lds
  ds_read_b64_tr_b16 v[88:89], v104 offset:0
  ds_read_b64_tr_b16 v[90:91], v104 offset:4096
  ds_read_b64_tr_b16 v[96:97], v105 offset:0
  ds_read_b64_tr_b16 v[98:99], v105 offset:4096
  ds_read_b64_tr_b16 v[232:233], v106 offset:0
  ds_read_b64_tr_b16 v[234:235], v106 offset:4096
  ds_read_b64_tr_b16 v[176:177], v107 offset:0
  ds_read_b64_tr_b16 v[178:179], v107 offset:4096
  ds_read_b64_tr_b16 v[224:225], v108 offset:0
  ds_read_b64_tr_b16 v[226:227], v108 offset:4096
  ds_read_b64_tr_b16 v[168:169], v109 offset:0
  ds_read_b64_tr_b16 v[170:171], v109 offset:4096
  ds_read_b64_tr_b16 v[216:217], v110 offset:0
  ds_read_b64_tr_b16 v[218:219], v110 offset:4096
  ds_read_b64_tr_b16 v[160:161], v111 offset:0
  ds_read_b64_tr_b16 v[162:163], v111 offset:4096
  s_waitcnt lgkmcnt(0)
  s_waitcnt vmcnt(16)
  s_barrier
  s_or_b32 s36, s91, s17
  s_cbranch_scc1 L_sig
  s_lshl_b32 s36, s16, 6
  s_add_u32 s36, s36, 245104644
  v_mov_b32 v120, 1
  s_mov_b64 exec, 1
  buffer_store_dword v120, off, s[4:7], s36 sc1
  s_mov_b64 exec, -1
L_sig:
  ds_read_b64_tr_b16 v[92:93], v104 offset:32768
  ds_read_b64_tr_b16 v[94:95], v104 offset:36864
  ds_read_b64_tr_b16 v[100:101], v105 offset:32768
  ds_read_b64_tr_b16 v[102:103], v105 offset:36864
  ds_read_b64_tr_b16 v[236:237], v106 offset:32768
  ds_read_b64_tr_b16 v[238:239], v106 offset:36864
  ds_read_b64_tr_b16 v[180:181], v107 offset:32768
  ds_read_b64_tr_b16 v[182:183], v107 offset:36864
  ds_read_b64_tr_b16 v[228:229], v108 offset:32768
  ds_read_b64_tr_b16 v[230:231], v108 offset:36864
  ds_read_b64_tr_b16 v[172:173], v109 offset:32768
  ds_read_b64_tr_b16 v[174:175], v109 offset:36864
  ds_read_b64_tr_b16 v[220:221], v110 offset:32768
  ds_read_b64_tr_b16 v[222:223], v110 offset:36864
  ds_read_b64_tr_b16 v[164:165], v111 offset:32768
  ds_read_b64_tr_b16 v[166:167], v111 offset:36864
  s_waitcnt lgkmcnt(0)
  s_barrier
  v_add_u32 v104, 65536, v104
  v_add_u32 v105, 65536, v105
  v_add_u32 v106, 65536, v106
  v_add_u32 v107, 65536, v107
  v_add_u32 v108, 65536, v108
  v_add_u32 v109, 65536, v109
  v_add_u32 v110, 65536, v110
  v_add_u32 v111, 65536, v111
  ds_write_b128 v8, v[128:131] offset:16384
  ds_write_b128 v8, v[132:135] offset:20480
  ds_write_b128 v8, v[136:139] offset:24576
  ds_write_b128 v8, v[140:143] offset:28672
  ds_write_b128 v8, v[144:147] offset:32768
  ds_write_b128 v8, v[148:151] offset:36864
  ds_write_b128 v8, v[152:155] offset:40960
  ds_write_b128 v8, v[156:159] offset:45056
  ds_write_b128 v8, v[184:187] offset:49152
  ds_write_b128 v8, v[188:191] offset:53248
  ds_write_b128 v8, v[192:195] offset:57344
  ds_write_b128 v8, v[196:199] offset:61440
  s_waitcnt lgkmcnt(0)
  s_waitcnt vmcnt(8)
  s_barrier
  v_cmp_eq_u32 vcc, 0, v117
  v_lshlrev_b32 v116, 12, v116
  s_or_b32 s66, vcc_lo, s91
  s_cselect_b32 s66, 0, 1
  s_lshl2_add_u32 s36, s16, s17
  s_lshl_b32 s36, s36, 5
  s_add_u32 s36, s36, 244318208
  buffer_load_dword v118, v116, s[4:7], s36 offen sc1
  ds_read_b64_tr_b16 v[208:209], v104 offset:0
  ds_read_b64_tr_b16 v[210:211], v104 offset:4096
  ds_read_b64_tr_b16 v[152:153], v105 offset:0
  ds_read_b64_tr_b16 v[154:155], v105 offset:4096
  ds_read_b64_tr_b16 v[200:201], v106 offset:0
  ds_read_b64_tr_b16 v[202:203], v106 offset:4096
  ds_read_b64_tr_b16 v[144:145], v107 offset:0
  ds_read_b64_tr_b16 v[146:147], v107 offset:4096
  ds_read_b64_tr_b16 v[192:193], v108 offset:0
  ds_read_b64_tr_b16 v[194:195], v108 offset:4096
  ds_read_b64_tr_b16 v[136:137], v109 offset:0
  ds_read_b64_tr_b16 v[138:139], v109 offset:4096
  ds_read_b64_tr_b16 v[184:185], v110 offset:0
  ds_read_b64_tr_b16 v[186:187], v110 offset:4096
  ds_read_b64_tr_b16 v[128:129], v111 offset:0
  ds_read_b64_tr_b16 v[130:131], v111 offset:4096
  s_waitcnt lgkmcnt(0)
  s_waitcnt vmcnt(0)
  s_barrier
  ds_read_b64_tr_b16 v[212:213], v104 offset:32768
  ds_read_b64_tr_b16 v[214:215], v104 offset:36864
  ds_read_b64_tr_b16 v[156:157], v105 offset:32768
  ds_read_b64_tr_b16 v[158:159], v105 offset:36864
  ds_read_b64_tr_b16 v[204:205], v106 offset:32768
  ds_read_b64_tr_b16 v[206:207], v106 offset:36864
  ds_read_b64_tr_b16 v[148:149], v107 offset:32768
  ds_read_b64_tr_b16 v[150:151], v107 offset:36864
  ds_read_b64_tr_b16 v[196:197], v108 offset:32768
  ds_read_b64_tr_b16 v[198:199], v108 offset:36864
  ds_read_b64_tr_b16 v[140:141], v109 offset:32768
  ds_read_b64_tr_b16 v[142:143], v109 offset:36864
  ds_read_b64_tr_b16 v[188:189], v110 offset:32768
  ds_read_b64_tr_b16 v[190:191], v110 offset:36864
  ds_read_b64_tr_b16 v[132:133], v111 offset:32768
  ds_read_b64_tr_b16 v[134:135], v111 offset:36864
  s_waitcnt lgkmcnt(0)
  s_barrier
  s_waitcnt vmcnt(0)
  s_lshl_b32 s26, s16, 13
  s_add_u32 s26, s26, s40
  s_add_u32 s27, s26, 4096
  s_lshl_b32 s28, s17, 13
  s_add_u32 s28, s28, s62
  buffer_load_dwordx4 v[104:107], v8, s[4:7], s26 offen sc1
  buffer_load_dwordx4 v[104:107], v8, s[4:7], s27 offen sc1
  buffer_load_dwordx2 v[104:105], v5, s[4:7], s28 offen sc1
  ds_write_b128 v1, v[24:27] offset:0
  ds_write_b128 v1, v[28:31] offset:1024
  ds_write_b128 v1, v[32:35] offset:2048
  ds_write_b128 v1, v[36:39] offset:3072
  ds_write_b128 v1, v[40:43] offset:4096
  ds_write_b128 v1, v[44:47] offset:5120
  ds_write_b128 v1, v[48:51] offset:6144
  ds_write_b128 v1, v[52:55] offset:7168
  ds_write_b128 v1, v[56:59] offset:8192
  ds_write_b128 v1, v[60:63] offset:9216
  ds_write_b128 v1, v[64:67] offset:10240
  ds_write_b128 v1, v[68:71] offset:11264
  ds_write_b128 v1, v[72:75] offset:12288
  ds_write_b128 v1, v[76:79] offset:13312
  ds_write_b128 v1, v[80:83] offset:14336
  ds_write_b128 v1, v[84:87] offset:15360
  ds_write_b128 v1, v[88:91] offset:16384
  ds_write_b128 v1, v[92:95] offset:17408
  ds_write_b128 v1, v[96:99] offset:18432
  ds_write_b128 v1, v[100:103] offset:19456
  s_mul_i32 s27, s17, 24576
  s_add_u32 m0, s27, 86016
  s_waitcnt lgkmcnt(0)
  v_readlane_b32 s67, v118, 1
  v_readlane_b32 s26, v118, 0
  v_mov_b32 v21, v117
  s_and_b32 s66, s66, s26
  s_cbranch_scc1 L_pk
  v_mbcnt_lo_u32_b32 v20, -1, 0
  v_and_b32 v20, 1, v20
  v_add_lshl_u32 v20, v20, s61, 2
  s_mov_b32 s26, 0
g_wt_7:
  global_load_dword v21, v20, s[12:13] offset:128 sc1
  s_add_u32 s26, s26, 1
  s_cmp_gt_u32 s26, 1048576
  s_cbranch_scc1 L_end
  s_waitcnt vmcnt(0)
  v_cmp_eq_u32 vcc, 0, v21
  v_readfirstlane_b32 s27, v21
  s_cbranch_vccnz g_wt_7
L_pk:
  s_lshr_b32 s26, s91, 1
  s_nop 3
  v_readlane_b32 s27, v21, s26
  s_cmp_lg_u32 s27, 1
  s_cbranch_scc1 L_chain_x
  s_mov_b32 s22, 0
  s_mov_b32 s21, 0
  s_mov_b32 s42, s62
  s_add_u32 s43, s62, 4096
  s_mov_b32 s46, 0
  s_mov_b32 s47, 0
  s_lshl_b32 s26, s16, 2
  s_add_u32 s26, s26, s17
  s_lshl_b32 s27, s60, 13
  s_add_u32 s27, s27, s26
  s_lshr_b32 s25, s27, 2
  s_lshl_b32 s25, s25, 13
  s_add_u32 s25, s25, 192937984
  s_lshr_b32 s64, s27, 2
  s_lshl_b32 s64, s64, 6
  s_add_u32 s64, s64, 513538048
  s_cmp_eq_u32 s17, 3
  s_cselect_b32 s2, 268435456, 0
  s_lshl_b32 s27, s61, 13
  s_add_u32 s27, s27, s26
  s_lshl_b32 s23, s27, 12
  s_add_u32 s23, s23, 41943040
  s_lshl_b32 s63, s27, 5
  s_add_u32 s63, s63, 244318208
  s_mov_b32 s97, 268435456
  s_cmp_eq_u32 s60, 2
  s_cselect_b32 s20, 262144, s97
  s_cselect_b32 s93, 1, 3
  s_lshl_b32 s26, s17, 2
  s_add_u32 s26, s26, s60
  s_cmp_eq_u32 s26, 1
  s_cselect_b32 s97, 245891072, s97
  s_mov_b32 s95, 0
  s_mov_b32 s96, s23
  s_add_u32 s23, s23, 524288
  s_add_u32 s63, s63, 4096
  s_cmp_eq_u32 s66, 0
  s_cbranch_scc1 c_pk_16
  s_sub_u32 s96, s23, 524288
  s_mov_b32 s65, s67
  s_mov_b32 s94, 0
  buffer_load_dwordx4 v0, s[4:7], s96 offen offset:0  lds
  buffer_load_dwordx4 v0, s[4:7], s96 offen offset:1024  lds
  buffer_load_dwordx4 v0, s[4:7], s96 offen offset:2048  lds
  buffer_load_dwordx4 v0, s[4:7], s96 offen offset:3072  lds
  s_branch c_pk2_17
c_pk_16:
  s_mov_b32 s29, 0
  s_sub_u32 s92, s63, 4096
  s_sub_u32 s96, s23, 524288
  s_mov_b32 s95, 0
c_gw_18:
  buffer_load_dword v7, off, s[4:7], s92 sc1
  s_add_u32 s29, s29, 1
  s_cmp_gt_u32 s29, 1048576
  s_cbranch_scc1 c_fail_14
  s_waitcnt vmcnt(0) lgkmcnt(0)
  v_readfirstlane_b32 s65, v7
  s_cmp_eq_u32 s65, 0
  s_cbranch_scc1 c_gw_18
  s_and_b32 s65, s65, s93
  s_cbranch_scc1 c_kvx_20
  s_mov_b32 s95, 1
  s_add_u32 s96, s96, 33554432
  s_add_u32 s92, s92, 262144
c_kvw_19:
  buffer_load_dword v7, off, s[4:7], s92 sc1
  s_add_u32 s29, s29, 1
  s_cmp_gt_u32 s29, 1048576
  s_cbranch_scc1 c_fail_14
  s_waitcnt vmcnt(0) lgkmcnt(0)
  v_readfirstlane_b32 s65, v7
  s_cmp_eq_u32 s65, 0
  s_cbranch_scc1 c_kvw_19
c_kvx_20:
  buffer_load_dword v7, off, s[4:7], s63 sc1
  buffer_load_dwordx4 v0, s[4:7], s96 offen offset:0  lds
  buffer_load_dwordx4 v0, s[4:7], s96 offen offset:1024  lds
  buffer_load_dwordx4 v0, s[4:7], s96 offen offset:2048  lds
  buffer_load_dwordx4 v0, s[4:7], s96 offen offset:3072  lds
  s_waitcnt vmcnt(4)
  v_readfirstlane_b32 s65, v7
  s_mov_b32 s94, 0
c_pk2_17:
  s_waitcnt vmcnt(4)
  ds_read_b128 v[72:75], v1 offset:6144
  ds_read_b128 v[76:79], v1 offset:7168
  ds_read_b128 v[80:83], v1 offset:8192
  ds_read_b128 v[84:87], v1 offset:9216
  ds_read_b128 v[88:91], v1 offset:10240
  ds_read_b128 v[92:95], v1 offset:11264
  ds_read_b128 v[96:99], v1 offset:12288
  ds_read_b128 v[100:103], v1 offset:13312
  ds_read_b128 v[104:107], v1 offset:14336
  ds_read_b128 v[108:111], v1 offset:15360
  ds_read_b128 v[112:115], v1 offset:16384
  ds_read_b128 v[116:119], v1 offset:17408
  ds_read_b128 v[120:123], v1 offset:18432
  ds_read_b128 v[124:127], v1 offset:19456
  v_mov_b64 v[48:49], 0
  v_mov_b64 v[50:51], 0
  v_mov_b64 v[52:53], 0
  v_mov_b64 v[54:55], 0
  v_mov_b64 v[56:57], 0
  v_mov_b64 v[58:59], 0
  v_mov_b64 v[60:61], 0
  v_mov_b64 v[62:63], 0
  v_mov_b64 v[64:65], 0
  v_mov_b64 v[66:67], 0
  v_mov_b64 v[68:69], 0
  v_mov_b64 v[70:71], 0
  s_lshl_b32 s38, s16, 13
  s_add_u32 s38, s38, s40
  s_add_u32 s39, s38, 4096
  ds_read_b128 v[24:27], v1 offset:0
  ds_read_b128 v[28:31], v1 offset:1024
  ds_read_b128 v[32:35], v1 offset:2048
  ds_read_b128 v[36:39], v1 offset:3072
  ds_read_b128 v[40:43], v1 offset:4096
  ds_read_b128 v[44:47], v1 offset:5120
  s_waitcnt lgkmcnt(0)
c_loop_8:
  buffer_load_dwordx4 v[16:19], v8, s[4:7], s42 offen sc1
  buffer_load_dwordx4 v[20:23], v8, s[4:7], s43 offen sc1
  s_mov_b32 s28, 0
  v_mov_b64 v[48:49], 0
  v_mov_b64 v[50:51], 0
  v_mov_b64 v[52:53], 0
  v_mov_b64 v[54:55], 0
  v_mov_b64 v[56:57], 0
  v_mov_b64 v[58:59], 0
  v_mov_b64 v[60:61], 0
  v_mov_b64 v[62:63], 0
  v_mov_b64 v[64:65], 0
  v_mov_b64 v[66:67], 0
  v_mov_b64 v[68:69], 0
  v_mov_b64 v[70:71], 0
  buffer_load_dwordx4 v[16:19], v8, s[4:7], s42 offen sc1
  buffer_load_dwordx4 v[20:23], v8, s[4:7], s43 offen sc1
  s_waitcnt lgkmcnt(0)
  s_and_b32 s29, s65, s93
  s_cbranch_scc0 c_xb_23
c_xr_24:
  s_waitcnt vmcnt(3)
  v_max3_u32 v7, v16, v17, v18
  v_max_u32 v7, v7, v19
  ds_write_b128 v8, v[16:19] offset:4096
  v_smfmac_f32_16x16x64_bf16 v[48:51], v[16:19], v[24:31], v6
  s_waitcnt vmcnt(2)
  v_max3_u32 v7, v20, v21, v7
  v_max3_u32 v7, v22, v23, v7
  ds_write_b128 v8, v[20:23] offset:8192
  v_smfmac_f32_16x16x64_bf16 v[52:55], v[16:19], v[32:39], v6
  v_cmp_eq_u32 vcc, -1, v7
  v_smfmac_f32_16x16x64_bf16 v[56:59], v[16:19], v[40:47], v6
  s_cbranch_vccnz c_retry_9
c_got_10:
  v_smfmac_f32_16x16x64_bf16 v[60:63], v[16:19], v[72:79], v6
  ds_read_b128 v[72:75], v1 offset:20480
  s_and_b32 s65, s65, s93
  s_cselect_b32 s96, s23, 268435456
  v_smfmac_f32_16x16x64_bf16 v[48:51], v[20:23], v[80:87], v6
  ds_read_b128 v[76:79], v1 offset:21504
  v_mov_b32 v7, 1
  v_smfmac_f32_16x16x64_bf16 v[52:55], v[20:23], v[88:95], v6
  ds_read_b128 v[80:83], v1 offset:22528
  v_smfmac_f32_16x16x64_bf16 v[56:59], v[20:23], v[96:103], v6
  ds_read_b128 v[84:87], v1 offset:23552
  s_waitcnt lgkmcnt(4)
  s_barrier
  ds_read_b128 v[24:27], v9 offset:4096
  ds_read_b128 v[28:31], v10 offset:4096
  v_smfmac_f32_16x16x64_bf16 v[60:63], v[20:23], v[104:111], v6
  ds_read_b128 v[32:35], v11 offset:4096
  v_smfmac_f32_16x16x64_bf16 v[64:67], v[16:19], v[112:119], v6
  ds_read_b128 v[36:39], v9 offset:8192
  v_smfmac_f32_16x16x64_bf16 v[68:71], v[16:19], v[120:127], v6
  ds_read_b128 v[40:43], v10 offset:8192
  v_smfmac_f32_16x16x64_bf16 v[64:67], v[20:23], v[208:215], v6
  ds_read_b128 v[44:47], v11 offset:8192
  s_waitcnt lgkmcnt(5)
  v_smfmac_f32_16x16x64_bf16 v[48:51], v[24:27], a[168:175], v6
  s_mov_b64 exec, 1
  buffer_store_dword v7, off, s[4:7], s64 sc1
  s_mov_b64 exec, -1
  s_waitcnt lgkmcnt(4)
  v_smfmac_f32_16x16x64_bf16 v[48:51], v[28:31], a[160:167], v6
  buffer_load_dwordx4 v0, s[4:7], s96 offen offset:0  lds
  s_waitcnt lgkmcnt(3)
  v_smfmac_f32_16x16x64_bf16 v[48:51], v[32:35], a[152:159], v6
  ds_read_b128 v[104:107], v8 offset:16384
  s_waitcnt lgkmcnt(3)
  v_smfmac_f32_16x16x64_bf16 v[48:51], v[36:39], a[144:151], v6
  buffer_load_dwordx4 v0, s[4:7], s96 offen offset:1024  lds
  s_waitcnt lgkmcnt(2)
  v_smfmac_f32_16x16x64_bf16 v[48:51], v[40:43], a[136:143], v6
  ds_read_b128 v[108:111], v8 offset:20480
  s_waitcnt lgkmcnt(2)
  v_smfmac_f32_16x16x64_bf16 v[48:51], v[44:47], a[128:135], v6
  buffer_load_dwordx4 v0, s[4:7], s96 offen offset:2048  lds
  v_smfmac_f32_16x16x64_bf16 v[52:55], v[24:27], a[120:127], v6
  buffer_load_dwordx4 v0, s[4:7], s96 offen offset:3072  lds
  v_smfmac_f32_16x16x64_bf16 v[52:55], v[28:31], a[112:119], v6
  ds_read_b64 v[100:101], v5 offset:4096
  v_add_f32 v48, v48, v50
  v_smfmac_f32_16x16x64_bf16 v[52:55], v[32:35], a[104:111], v6
  ds_read_b128 v[112:115], v8 offset:24576
  v_add_f32 v49, v49, v51
  v_smfmac_f32_16x16x64_bf16 v[52:55], v[36:39], a[96:103], v6
  ds_read_b128 v[116:119], v8 offset:28672
  v_cvt_pk_bf16_f32 v50, v48, v49
  v_smfmac_f32_16x16x64_bf16 v[52:55], v[40:43], a[88:95], v6
  ds_write2_b32 v2, v50, v50 offset0:0 offset1:1
  v_smfmac_f32_16x16x64_bf16 v[52:55], v[44:47], a[80:87], v6
  ds_read_b64_tr_b16 v[88:89], v12 offset:0
  v_smfmac_f32_16x16x64_bf16 v[56:59], v[24:27], a[72:79], v6
  v_smfmac_f32_16x16x64_bf16 v[56:59], v[28:31], a[64:71], v6
  ds_read_b128 v[120:123], v8 offset:32768
  v_add_f32 v52, v52, v54
  v_smfmac_f32_16x16x64_bf16 v[56:59], v[32:35], a[56:63], v6
  ds_read_b128 v[124:127], v8 offset:36864
  v_add_f32 v53, v53, v55
  v_cvt_pk_bf16_f32 v54, v52, v53
  v_smfmac_f32_16x16x64_bf16 v[56:59], v[36:39], a[48:55], v6
  ds_write2_b32 v2, v54, v54 offset0:128 offset1:129
  ds_read_b64_tr_b16 v[90:91], v12 offset:512
  v_smfmac_f32_16x16x64_bf16 v[56:59], v[40:43], a[40:47], v6
  v_smfmac_f32_16x16x64_bf16 v[56:59], v[44:47], a[32:39], v6
  v_smfmac_f32_16x16x64_bf16 v[60:63], v[24:27], a[24:31], v6
  v_smfmac_f32_16x16x64_bf16 v[60:63], v[28:31], a[16:23], v6
  s_waitcnt lgkmcnt(0)
  v_add_f32 v56, v56, v58
  v_mfma_f32_16x16x32_bf16 v[92:95], v[72:75], v[88:91], 0
  buffer_store_dwordx2 v[100:101], v5, s[4:7], s97 offen sc1
  v_add_f32 v57, v57, v59
  v_cvt_pk_bf16_f32 v58, v56, v57
  v_mfma_f32_16x16x32_bf16 v[96:99], v[76:79], v[88:91], 0
  ds_write_b32 v2, v58
  v_smfmac_f32_16x16x64_bf16 v[60:63], v[32:35], a[8:15], v6
  v_mov_b32 v76, 0
  v_smfmac_f32_16x16x64_bf16 v[60:63], v[36:39], a[0:7], v6
  v_cndmask_b32 v48, v92, v96, s[18:19]
  v_smfmac_f32_16x16x64_bf16 v[60:63], v[40:43], v[248:255], v6
  v_cndmask_b32 v49, v93, v97, s[18:19]
  v_smfmac_f32_16x16x64_bf16 v[60:63], v[44:47], v[240:247], v6
  v_cndmask_b32 v50, v94, v98, s[18:19]
  v_smfmac_f32_16x16x64_bf16 v[68:71], v[20:23], v[152:159], v6
  v_cndmask_b32 v51, v95, v99, s[18:19]
  v_smfmac_f32_16x16x64_bf16 v[64:67], v[24:27], v[232:239], v6
  ds_write_b128 v8, v[48:51] offset:12288
  v_add_f32 v60, v60, v62
  v_add_f32 v61, v61, v63
  v_cvt_pk_bf16_f32 v62, v60, v61
  v_smfmac_f32_16x16x64_bf16 v[64:67], v[28:31], v[224:231], v6
  ds_write_b32 v2, v62 offset:512
  s_waitcnt vmcnt(6)
  v_mov_b32 v79, 0
  v_smfmac_f32_16x16x64_bf16 v[64:67], v[32:35], v[216:223], v6
  v_mov_b64 v[20:21], s[14:15]
  v_smfmac_f32_16x16x64_bf16 v[64:67], v[36:39], v[200:207], v6
  v_mov_b64 v[22:23], s[14:15]
  v_smfmac_f32_16x16x64_bf16 v[64:67], v[40:43], v[192:199], v6
  s_waitcnt lgkmcnt(0)
  s_barrier
  ds_read_b128 v[52:55], v9 offset:12288
  ds_read_b128 v[56:59], v10 offset:12288
  v_smfmac_f32_16x16x64_bf16 v[64:67], v[44:47], v[184:191], v6
  ds_read_b128 v[60:63], v11 offset:12288
  v_smfmac_f32_16x16x64_bf16 v[68:71], v[24:27], v[176:183], v6
  ds_read_b64_tr_b16 v[88:89], v12 offset:0
  ds_read_b64_tr_b16 v[90:91], v12 offset:512
  v_smfmac_f32_16x16x64_bf16 v[68:71], v[28:31], v[168:175], v6
  ds_read_b64_tr_b16 v[92:93], v13 offset:0
  ds_read_b64_tr_b16 v[94:95], v13 offset:512
  v_add_f32 v64, v64, v66
  v_smfmac_f32_16x16x64_bf16 v[68:71], v[32:35], v[160:167], v6
  ds_read_b64_tr_b16 v[96:97], v14 offset:0
  ds_read_b64_tr_b16 v[98:99], v14 offset:512
  v_add_f32 v65, v65, v67
  v_smfmac_f32_16x16x64_bf16 v[68:71], v[36:39], v[144:151], v6
  ds_read_b64_tr_b16 v[100:101], v15 offset:0
  ds_read_b64_tr_b16 v[102:103], v15 offset:512
  s_waitcnt lgkmcnt(8)
  v_cvt_pk_bf16_f32 v66, v64, v65
  v_smfmac_f32_16x16x64_bf16 v[68:71], v[40:43], v[136:143], v6
  v_add_f32 v48, v48, v52
  v_smfmac_f32_16x16x64_bf16 v[68:71], v[44:47], v[128:135], v6
  s_waitcnt lgkmcnt(4)
  v_add_f32 v49, v49, v53
  v_mfma_f32_16x16x32_bf16 v[16:19], v[88:91], v[88:91], 0
  buffer_store_dwordx4 v[88:91], v8, s[4:7], s25 offen sc1
  v_add_f32 v50, v50, v54
  v_add_f32 v51, v51, v55
  v_mfma_f32_16x16x32_bf16 v[16:19], v[92:95], v[92:95], v[16:19]
  s_waitcnt lgkmcnt(0)
  v_add_f32 v56, v56, v60
  v_add_f32 v57, v57, v61
  v_mfma_f32_16x16x32_bf16 v[16:19], v[96:99], v[96:99], v[16:19]
  v_add_f32 v58, v58, v62
  v_add_f32 v59, v59, v63
  v_mfma_f32_16x16x32_bf16 v[16:19], v[100:103], v[100:103], v[16:19]
  v_add_f32 v48, v48, v56
  v_add_f32 v49, v49, v57
  v_add_f32 v50, v50, v58
  v_add_f32 v51, v51, v59
  v_exp_f32 v24, v48
  v_exp_f32 v25, v49
  v_exp_f32 v26, v50
  v_exp_f32 v27, v51
  v_cvt_pk_bf16_f32 v24, v24, v25
  v_mul_f32 v16, s24, v16
  v_cvt_pk_bf16_f32 v25, v26, v27
  v_cndmask_b32 v72, v24, 0, s[18:19]
  v_cndmask_b32 v73, v25, 0, s[18:19]
  v_cndmask_b32 v74, 0, v24, s[18:19]
  v_cndmask_b32 v75, 0, v25, s[18:19]
  v_mul_f32 v17, s24, v17
  v_exp_f32 v28, v16
  v_mfma_f32_16x16x32_bf16 v[60:63], v[72:75], v[20:23], 0
  v_exp_f32 v29, v17
  v_add_f32 v68, v68, v70
  v_mfma_f32_16x16x32_bf16 v[52:55], v[72:75], v[80:83], 0
  s_add_u32 s30, s25, 4096
  v_cvt_pk_bf16_f32 v28, v28, v29
  v_add_f32 v69, v69, v71
  v_mfma_f32_16x16x32_bf16 v[56:59], v[72:75], v[84:87], 0
  v_cndmask_b32 v77, 0, v28, s[18:19]
  v_cndmask_b32 v78, 0, v28, s[18:19]
  v_cvt_pk_bf16_f32 v67, v68, v69
  v_lshrrev_b32 v92, 1, v8
  v_mfma_f32_16x16x16_bf16 v[60:63], v[76:77], v[20:21], v[60:63]
  buffer_store_dwordx2 v[66:67], v92, s[4:7], s30 offen sc1
  v_max3_f32 v7, |v48|, |v49|, |v50|
  v_max_f32 v26, |v16|, |v17|
  v_mfma_f32_16x16x16_bf16 v[52:55], v[78:79], v[66:67], v[52:55]
  v_cndmask_b32 v26, 0, v26, s[18:19]
  v_max3_f32 v7, |v51|, v26, v7
  v_mfma_f32_16x16x16_bf16 v[56:59], v[76:77], v[66:67], v[56:59]
  v_cmp_lt_f32 vcc, 0x42700000, v7
  v_mov_b64 v[44:45], 0
  v_add_f32 v60, v60, v62
  v_add_f32 v61, v61, v63
  s_cbranch_vccnz c_fb_12
c_fbr_13:
  v_rcp_f32 v60, v60
  v_rcp_f32 v61, v61
  v_pk_add_f32 v[52:53], v[52:53], v[54:55]
  v_pk_add_f32 v[56:57], v[56:57], v[58:59]
  v_pk_mul_f32 v[52:53], v[52:53], v[60:61]
  v_pk_mul_f32 v[56:57], v[56:57], v[60:61]
  v_cvt_pk_bf16_f32 v54, v52, v53
  v_cvt_pk_bf16_f32 v55, v56, v57
  ds_write_b64 v2, v[54:55] offset:4096
  v_mov_b64 v[46:47], 0
  v_mov_b64 v[40:41], 0
  v_mov_b64 v[42:43], 0
  v_mov_b64 v[36:37], 0
  v_mov_b64 v[38:39], 0
  v_mov_b64 v[32:33], 0
  v_mov_b64 v[34:35], 0
  v_mov_b64 v[28:29], 0
  v_mov_b64 v[30:31], 0
  v_mov_b64 v[24:25], 0
  v_mov_b64 v[26:27], 0
  v_mov_b64 v[80:81], 0
  s_waitcnt lgkmcnt(0)
  s_barrier
  ds_read_b64_tr_b16 v[72:73], v3 offset:4096
  ds_read_b64_tr_b16 v[74:75], v3 offset:5120
  ds_read_b64_tr_b16 v[76:77], v3 offset:6144
  ds_read_b64_tr_b16 v[78:79], v3 offset:7168
  s_and_b32 s3, s21, 1
  s_add_u32 s21, s21, 1
  s_add_u32 s22, s22, 1
  s_and_b32 s42, s21, 3
  s_lshl_b32 s42, s42, 13
  s_cmp_eq_u32 s22, 64
  s_cbranch_scc1 c_last_15
  s_waitcnt lgkmcnt(2)
  v_smfmac_f32_16x16x64_bf16 v[44:47], v[72:75], a[248:255], v6
  s_waitcnt lgkmcnt(0)
  ds_read_b128 v[16:19], v8 offset:40960
  v_mov_b64 v[82:83], 0
  v_smfmac_f32_16x16x64_bf16 v[44:47], v[76:79], a[240:247], v6
  ds_read_b128 v[20:23], v8 offset:45056
  v_mov_b64 v[84:85], 0
  v_smfmac_f32_16x16x64_bf16 v[40:43], v[72:75], a[232:239], v6
  ds_read_b128 v[88:91], v8 offset:49152
  v_mov_b64 v[86:87], 0
  v_smfmac_f32_16x16x64_bf16 v[40:43], v[76:79], a[224:231], v6
  ds_read_b128 v[92:95], v8 offset:53248
  v_add_f32 v44, v44, v46
  v_add_f32 v45, v45, v47
  v_smfmac_f32_16x16x64_bf16 v[36:39], v[72:75], a[216:223], v6
  ds_read_b128 v[96:99], v8 offset:57344
  v_cvt_pk_bf16_f32 v48, v44, v45
  v_and_or_b32 v48, v48, -2, s3
  v_smfmac_f32_16x16x64_bf16 v[36:39], v[76:79], a[208:215], v6
  ds_read_b128 v[100:103], v8 offset:61440
  v_add_f32 v40, v40, v42
  v_add_f32 v41, v41, v43
  v_smfmac_f32_16x16x64_bf16 v[32:35], v[72:75], a[200:207], v6
  v_cvt_pk_bf16_f32 v49, v40, v41
  v_smfmac_f32_16x16x64_bf16 v[32:35], v[76:79], a[192:199], v6
  v_add_f32 v36, v36, v38
  v_add_f32 v37, v37, v39
  v_smfmac_f32_16x16x64_bf16 v[28:31], v[72:75], a[184:191], v6
  v_cvt_pk_bf16_f32 v50, v36, v37
  v_smfmac_f32_16x16x64_bf16 v[28:31], v[76:79], a[176:183], v6
  v_add_f32 v32, v32, v34
  v_add_f32 v33, v33, v35
  v_smfmac_f32_16x16x64_bf16 v[24:27], v[72:75], v[104:111], v6
  v_cvt_pk_bf16_f32 v51, v32, v33
  v_smfmac_f32_16x16x64_bf16 v[24:27], v[76:79], v[112:119], v6
  buffer_store_dwordx4 v[48:51], v4, s[4:7], s40 offen
  v_add_f32 v28, v28, v30
  v_add_f32 v29, v29, v31
  v_smfmac_f32_16x16x64_bf16 v[80:83], v[72:75], v[120:127], v6
  s_waitcnt lgkmcnt(0)
  v_cvt_pk_bf16_f32 v52, v28, v29
  v_and_or_b32 v52, v52, -2, s3
  v_smfmac_f32_16x16x64_bf16 v[80:83], v[76:79], v[16:23], v6
  v_add_f32 v24, v24, v26
  v_add_f32 v25, v25, v27
  v_smfmac_f32_16x16x64_bf16 v[84:87], v[72:75], v[88:95], v6
  v_cvt_pk_bf16_f32 v53, v24, v25
  v_smfmac_f32_16x16x64_bf16 v[84:87], v[76:79], v[96:103], v6
  v_add_f32 v80, v80, v82
  v_add_f32 v81, v81, v83
  v_cvt_pk_bf16_f32 v54, v80, v81
  s_nop 0
  s_nop 3
  v_pk_add_f32 v[84:85], v[84:85], v[86:87]
  v_cvt_pk_bf16_f32 v55, v84, v85
  buffer_store_dwordx4 v[52:55], v4, s[4:7], s41 offen
  s_add_u32 s42, s42, s62
  s_add_u32 s43, s42, 4096
  s_add_u32 s23, s23, 524288
  s_add_u32 s25, s25, 262144
  s_add_u32 s63, s63, 4096
  s_add_u32 s64, s64, 2048
  s_andn2_b32 s64, s64, s2
  s_add_u32 s97, s97, 8192
  s_add_u32 s92, s63, s20
  s_cmp_lg_u32 s17, 0
  s_cbranch_scc1 c_oth_27
  s_mov_b32 s28, 0
  s_add_u32 s46, s46, 1
  v_mov_b64 v[64:65], -1
  s_xor_b32 s34, s42, 16384
  buffer_store_dwordx2 v[64:65], v5, s[4:7], s34 offen
  s_mov_b32 vcc_lo, 0xaaaaaaaa
  s_mov_b32 vcc_hi, 0xaaaaaaaa
  v_mov_b32 v7, 0x3f80
  v_cndmask_b32 v7, v7, 1.0, vcc
  s_mov_b32 vcc_lo, 0x30003
  s_mov_b32 vcc_hi, 0x30003
  v_cndmask_b32 v68, 0, v7, vcc
  s_mov_b32 vcc_lo, 0xc000c
  s_mov_b32 vcc_hi, 0xc000c
  v_cndmask_b32 v69, 0, v7, vcc
  s_mov_b32 vcc_lo, 0x300030
  s_mov_b32 vcc_hi, 0x300030
  v_cndmask_b32 v70, 0, v7, vcc
  s_mov_b32 vcc_lo, 0xc000c0
  s_mov_b32 vcc_hi, 0xc000c0
  v_cndmask_b32 v71, 0, v7, vcc
  ds_read_b128 v[104:107], v1 offset:14336
  ds_read_b128 v[108:111], v1 offset:15360
  s_waitcnt lgkmcnt(0)
  ds_read_b128 v[112:115], v1 offset:16384
  ds_read_b128 v[116:119], v1 offset:17408
  ds_read_b128 v[120:123], v1 offset:18432
  ds_read_b128 v[124:127], v1 offset:19456
  s_waitcnt lgkmcnt(0)
  buffer_load_dwordx4 v[16:19], v0, s[4:7], s38 offen offset:0 sc1
  buffer_load_dwordx4 v[20:23], v0, s[4:7], s38 offen offset:1024 sc1
  buffer_load_dwordx4 v[24:27], v0, s[4:7], s38 offen offset:2048 sc1
  buffer_load_dwordx4 v[28:31], v0, s[4:7], s38 offen offset:3072 sc1
  buffer_load_dwordx4 v[32:35], v0, s[4:7], s39 offen offset:0 sc1
  buffer_load_dwordx4 v[36:39], v0, s[4:7], s39 offen offset:1024 sc1
  buffer_load_dwordx4 v[40:43], v0, s[4:7], s39 offen offset:2048 sc1
  buffer_load_dwordx4 v[44:47], v0, s[4:7], s39 offen offset:3072 sc1
  buffer_load_dwordx4 v[72:75], v0, s[4:7], s38 offen offset:0 sc1
  buffer_load_dwordx4 v[76:79], v0, s[4:7], s38 offen offset:1024 sc1
  buffer_load_dwordx4 v[80:83], v0, s[4:7], s38 offen offset:2048 sc1
  buffer_load_dwordx4 v[84:87], v0, s[4:7], s38 offen offset:3072 sc1
  buffer_load_dwordx4 v[88:91], v0, s[4:7], s39 offen offset:0 sc1
  buffer_load_dwordx4 v[92:95], v0, s[4:7], s39 offen offset:1024 sc1
  buffer_load_dwordx4 v[96:99], v0, s[4:7], s39 offen offset:2048 sc1
  buffer_load_dwordx4 v[100:103], v0, s[4:7], s39 offen offset:3072 sc1
  s_buffer_load_dword s65, s[4:7], s63
  s_waitcnt vmcnt(15)
  v_mfma_f32_16x16x32_bf16 v[64:67], v[16:19], v[68:71], 0
  v_xor_b32 v7, s3, v16
  s_waitcnt vmcnt(14)
  v_mfma_f32_16x16x32_bf16 v[64:67], v[20:23], v[68:71], v[64:67]
  v_bitop3_b32 v7, v7, v20, s3 bitop3:0xf6
  s_waitcnt vmcnt(13)
  v_mfma_f32_16x16x32_bf16 v[64:67], v[24:27], v[68:71], v[64:67]
  v_bitop3_b32 v7, v7, v24, s3 bitop3:0xf6
  s_waitcnt vmcnt(12)
  v_mfma_f32_16x16x32_bf16 v[64:67], v[28:31], v[68:71], v[64:67]
  v_bitop3_b32 v7, v7, v28, s3 bitop3:0xf6
  s_waitcnt vmcnt(11)
  v_mfma_f32_16x16x32_bf16 v[64:67], v[32:35], v[68:71], v[64:67]
  v_bitop3_b32 v7, v7, v32, s3 bitop3:0xf6
  s_waitcnt vmcnt(10)
  v_mfma_f32_16x16x32_bf16 v[64:67], v[36:39], v[68:71], v[64:67]
  v_bitop3_b32 v7, v7, v36, s3 bitop3:0xf6
  s_waitcnt vmcnt(9)
  v_mfma_f32_16x16x32_bf16 v[64:67], v[40:43], v[68:71], v[64:67]
  v_bitop3_b32 v7, v7, v40, s3 bitop3:0xf6
  s_waitcnt vmcnt(8)
  v_mfma_f32_16x16x32_bf16 v[64:67], v[44:47], v[68:71], v[64:67]
  v_bitop3_b32 v7, v7, v44, s3 bitop3:0xf6
  v_and_b32 v7, 1, v7
  v_cmp_ne_u32 vcc, 0, v7
  v_mov_b32 v7, 0
  v_mov_b32 v7, 0
  s_cbranch_vccnz c_p1r_28
c_publ_29:
  s_nop 1
  s_nop 0
  v_cvt_pk_bf16_f32 v64, v64, v65
  v_cvt_pk_bf16_f32 v65, v66, v67
  v_min_u32 v64, -2, v64
  v_min_u32 v65, -2, v65
  buffer_store_dwordx2 v[64:65], v5, s[4:7], s42 offen
  s_waitcnt vmcnt(1)
  ds_read_b128 v[24:27], v1 offset:0
  ds_read_b128 v[28:31], v1 offset:1024
  ds_read_b128 v[32:35], v1 offset:2048
  ds_read_b128 v[36:39], v1 offset:3072
  ds_read_b128 v[40:43], v1 offset:4096
  ds_read_b128 v[44:47], v1 offset:5120
  ds_read_b128 v[72:75], v1 offset:6144
  ds_read_b128 v[76:79], v1 offset:7168
  ds_read_b128 v[80:83], v1 offset:8192
  ds_read_b128 v[84:87], v1 offset:9216
  ds_read_b128 v[88:91], v1 offset:10240
  ds_read_b128 v[92:95], v1 offset:11264
  ds_read_b128 v[96:99], v1 offset:12288
  ds_read_b128 v[100:103], v1 offset:13312
c_hop2_11:
  s_barrier
  s_cmp_le_u32 s96, s23
  s_cbranch_scc1 c_loop_8
  s_cmp_lg_u32 s96, 268435456
  s_cbranch_scc1 c_fk0_30
  buffer_store_dwordx2 v[64:65], v5, s[4:7], s97 offen sc1
  s_mov_b32 s29, 0
  s_sub_u32 s92, s63, 4096
  s_sub_u32 s96, s23, 524288
  s_mov_b32 s95, 0
c_gw_31:
  buffer_load_dword v7, off, s[4:7], s92 sc1
  s_add_u32 s29, s29, 1
  s_cmp_gt_u32 s29, 1048576
  s_cbranch_scc1 c_fail_14
  s_waitcnt vmcnt(0) lgkmcnt(0)
  v_readfirstlane_b32 s65, v7
  s_cmp_eq_u32 s65, 0
  s_cbranch_scc1 c_gw_31
  s_and_b32 s65, s65, s93
  s_cbranch_scc1 c_kvx_33
  s_mov_b32 s95, 1
  s_add_u32 s96, s96, 33554432
  s_add_u32 s92, s92, 262144
c_kvw_32:
  buffer_load_dword v7, off, s[4:7], s92 sc1
  s_add_u32 s29, s29, 1
  s_cmp_gt_u32 s29, 1048576
  s_cbranch_scc1 c_fail_14
  s_waitcnt vmcnt(0) lgkmcnt(0)
  v_readfirstlane_b32 s65, v7
  s_cmp_eq_u32 s65, 0
  s_cbranch_scc1 c_kvw_32
c_kvx_33:
  buffer_load_dword v7, off, s[4:7], s63 sc1
  buffer_load_dwordx4 v0, s[4:7], s96 offen offset:0  lds
  buffer_load_dwordx4 v0, s[4:7], s96 offen offset:1024  lds
  buffer_load_dwordx4 v0, s[4:7], s96 offen offset:2048  lds
  buffer_load_dwordx4 v0, s[4:7], s96 offen offset:3072  lds
  s_waitcnt vmcnt(4)
  v_readfirstlane_b32 s65, v7
  s_mov_b32 s94, 0
  s_cmp_eq_u32 s95, 0
  s_cbranch_scc1 c_loop_8
c_fk0_30:
  s_mov_b32 s29, 0
c_fk_34:
  buffer_load_dwordx4 v[16:19], v8, s[4:7], s42 offen sc1
  buffer_load_dwordx4 v[20:23], v8, s[4:7], s43 offen sc1
  s_add_u32 s29, s29, 1
  s_cmp_gt_u32 s29, 1048576
  s_cbranch_scc1 c_fail_14
  s_waitcnt vmcnt(0)
  v_max3_u32 v7, v16, v17, v18
  v_max3_u32 v7, v19, v20, v7
  v_max3_u32 v7, v21, v22, v7
  v_max_u32 v7, v7, v23
  v_cmp_eq_u32 vcc, -1, v7
  s_cbranch_vccnz c_fk_34
c_fk1_35:
  s_lshl_b32 s42, s22, 13
  s_add_u32 s42, s42, 245891072
  s_add_u32 s43, s42, 4096
  s_mov_b32 s95, 0
  s_branch c_loop_8
c_xb_23:
  s_cmp_lg_u32 s93, 1
  s_cbranch_scc1 c_xr_24
  s_cmp_ge_u32 s22, 63
  s_cbranch_scc1 c_xr_24
c_xp_36:
  s_cmp_lg_u32 s65, 0
  s_cbranch_scc1 c_xs_37
  buffer_load_dword v7, off, s[4:7], s63 sc1
  s_add_u32 s29, s29, 1
  s_cmp_gt_u32 s29, 1048576
  s_cbranch_scc1 c_fail_14
  s_waitcnt vmcnt(0)
  v_readfirstlane_b32 s65, v7
  s_branch c_xp_36
c_xs_37:
  s_cmp_eq_u32 s65, 1
  s_cbranch_scc1 c_xr_24
  s_mov_b32 s29, 0
c_xw_38:
  buffer_load_dwordx4 v[16:19], v8, s[4:7], s42 offen sc1
  buffer_load_dwordx4 v[20:23], v8, s[4:7], s43 offen sc1
  s_add_u32 s29, s29, 1
  s_cmp_gt_u32 s29, 1048576
  s_cbranch_scc1 c_fail_14
  s_waitcnt vmcnt(0)
  v_max3_u32 v7, v16, v17, v18
  v_max3_u32 v7, v19, v20, v7
  v_max3_u32 v7, v21, v22, v7
  v_max_u32 v7, v7, v23
  v_cmp_eq_u32 vcc, -1, v7
  s_cbranch_vccnz c_xw_38
  v_mov_b32 v7, 1
  s_barrier
  s_mov_b64 exec, 1
  buffer_store_dword v7, off, s[4:7], s64 sc1
  s_mov_b64 exec, -1
  s_add_u32 s22, s22, 1
  s_add_u32 s23, s23, 524288
  s_add_u32 s25, s25, 262144
  s_add_u32 s63, s63, 4096
  s_add_u32 s64, s64, 2048
  s_andn2_b32 s64, s64, s2
  s_mov_b32 s29, 0
  s_sub_u32 s92, s63, 4096
  s_sub_u32 s96, s23, 524288
  s_mov_b32 s95, 0
  s_mov_b32 s95, 1
  s_add_u32 s96, s96, 33554432
  s_add_u32 s92, s92, 262144
c_kvw_40:
  buffer_load_dword v7, off, s[4:7], s92 sc1
  s_add_u32 s29, s29, 1
  s_cmp_gt_u32 s29, 1048576
  s_cbranch_scc1 c_fail_14
  s_waitcnt vmcnt(0) lgkmcnt(0)
  v_readfirstlane_b32 s65, v7
  s_cmp_eq_u32 s65, 0
  s_cbranch_scc1 c_kvw_40
c_kvx_41:
  buffer_load_dword v7, off, s[4:7], s63 sc1
  buffer_load_dwordx4 v0, s[4:7], s96 offen offset:0  lds
  buffer_load_dwordx4 v0, s[4:7], s96 offen offset:1024  lds
  buffer_load_dwordx4 v0, s[4:7], s96 offen offset:2048  lds
  buffer_load_dwordx4 v0, s[4:7], s96 offen offset:3072  lds
  s_waitcnt vmcnt(4)
  v_readfirstlane_b32 s65, v7
  s_mov_b32 s94, 0
  s_branch c_fk1_35
c_last_15:
  s_add_u32 s64, s64, 2048
  v_mov_b32 v7, 1
  s_waitcnt vmcnt(0)
  s_barrier
  s_mov_b64 exec, 1
  buffer_store_dword v7, off, s[4:7], s64 sc1
  s_mov_b64 exec, -1
  s_branch L_chdone
c_oth_27:
  s_buffer_load_dword s65, s[4:7], s63
  ds_read_b128 v[24:27], v1 offset:0
  ds_read_b128 v[28:31], v1 offset:1024
  ds_read_b128 v[32:35], v1 offset:2048
  ds_read_b128 v[36:39], v1 offset:3072
  ds_read_b128 v[40:43], v1 offset:4096
  ds_read_b128 v[44:47], v1 offset:5120
  ds_read_b128 v[72:75], v1 offset:6144
  ds_read_b128 v[76:79], v1 offset:7168
  ds_read_b128 v[80:83], v1 offset:8192
  ds_read_b128 v[84:87], v1 offset:9216
  ds_read_b128 v[88:91], v1 offset:10240
  ds_read_b128 v[92:95], v1 offset:11264
  ds_read_b128 v[96:99], v1 offset:12288
  ds_read_b128 v[100:103], v1 offset:13312
  ds_read_b128 v[104:107], v1 offset:14336
  ds_read_b128 v[108:111], v1 offset:15360
  ds_read_b128 v[112:115], v1 offset:16384
  ds_read_b128 v[116:119], v1 offset:17408
  ds_read_b128 v[120:123], v1 offset:18432
  ds_read_b128 v[124:127], v1 offset:19456
  s_branch c_hop2_11
c_p1r_28:
  s_waitcnt vmcnt(7)
  s_nop 0
  v_mfma_f32_16x16x32_bf16 v[64:67], v[72:75], v[68:71], 0
  v_xor_b32 v7, s3, v72
  s_waitcnt vmcnt(6)
  v_mfma_f32_16x16x32_bf16 v[64:67], v[76:79], v[68:71], v[64:67]
  v_bitop3_b32 v7, v7, v76, s3 bitop3:0xf6
  s_waitcnt vmcnt(5)
  v_mfma_f32_16x16x32_bf16 v[64:67], v[80:83], v[68:71], v[64:67]
  v_bitop3_b32 v7, v7, v80, s3 bitop3:0xf6
  s_waitcnt vmcnt(4)
  v_mfma_f32_16x16x32_bf16 v[64:67], v[84:87], v[68:71], v[64:67]
  v_bitop3_b32 v7, v7, v84, s3 bitop3:0xf6
  s_waitcnt vmcnt(3)
  v_mfma_f32_16x16x32_bf16 v[64:67], v[88:91], v[68:71], v[64:67]
  v_bitop3_b32 v7, v7, v88, s3 bitop3:0xf6
  s_waitcnt vmcnt(2)
  v_mfma_f32_16x16x32_bf16 v[64:67], v[92:95], v[68:71], v[64:67]
  v_bitop3_b32 v7, v7, v92, s3 bitop3:0xf6
  s_waitcnt vmcnt(1)
  v_mfma_f32_16x16x32_bf16 v[64:67], v[96:99], v[68:71], v[64:67]
  v_bitop3_b32 v7, v7, v96, s3 bitop3:0xf6
  s_waitcnt vmcnt(0)
  v_mfma_f32_16x16x32_bf16 v[64:67], v[100:103], v[68:71], v[64:67]
  v_bitop3_b32 v7, v7, v100, s3 bitop3:0xf6
  v_and_b32 v7, 1, v7
  v_cmp_ne_u32 vcc, 0, v7
  s_add_u32 s46, s46, 1
  s_cbranch_vccz c_publ_29
  buffer_load_dwordx4 v[72:75], v0, s[4:7], s38 offen offset:0 sc1
  buffer_load_dwordx4 v[76:79], v0, s[4:7], s38 offen offset:1024 sc1
  buffer_load_dwordx4 v[80:83], v0, s[4:7], s38 offen offset:2048 sc1
  buffer_load_dwordx4 v[84:87], v0, s[4:7], s38 offen offset:3072 sc1
  buffer_load_dwordx4 v[88:91], v0, s[4:7], s39 offen offset:0 sc1
  buffer_load_dwordx4 v[92:95], v0, s[4:7], s39 offen offset:1024 sc1
  buffer_load_dwordx4 v[96:99], v0, s[4:7], s39 offen offset:2048 sc1
  buffer_load_dwordx4 v[100:103], v0, s[4:7], s39 offen offset:3072 sc1
  s_add_u32 s28, s28, 1
  s_cmp_gt_u32 s28, 1048576
  s_cbranch_scc0 c_p1r_28
  s_branch c_fail_14
c_retry_9:
  v_mov_b64 v[48:49], 0
  v_mov_b64 v[50:51], 0
  s_nop 0
  v_mov_b64 v[52:53], 0
  v_mov_b64 v[54:55], 0
  s_nop 1
  v_mov_b64 v[56:57], 0
  v_mov_b64 v[58:59], 0
c_rl_42:
  buffer_load_dwordx4 v[16:19], v8, s[4:7], s42 offen sc1
  buffer_load_dwordx4 v[20:23], v8, s[4:7], s43 offen sc1
  s_add_u32 s28, s28, 1
  s_add_u32 s47, s47, 1
  s_cmp_gt_u32 s28, 1048576
  s_cbranch_scc1 c_fail_14
  s_waitcnt vmcnt(2)
  v_max3_u32 v7, v16, v17, v18
  v_max3_u32 v7, v19, v20, v7
  v_max3_u32 v7, v21, v22, v7
  v_max_u32 v7, v7, v23
  v_cmp_eq_u32 vcc, -1, v7
  s_cbranch_vccnz c_rl_42
  ds_write_b128 v8, v[16:19] offset:4096
  v_smfmac_f32_16x16x64_bf16 v[48:51], v[16:19], v[24:31], v6
  ds_write_b128 v8, v[20:23] offset:8192
  v_smfmac_f32_16x16x64_bf16 v[52:55], v[16:19], v[32:39], v6
  v_smfmac_f32_16x16x64_bf16 v[56:59], v[16:19], v[40:47], v6
  s_branch c_got_10
c_fb_12:
  v_max3_f32 v7, v48, v49, v50
  v_max_f32 v7, v51, v7
  s_mov_b64 exec, s[18:19]
  v_max3_f32 v7, v16, v17, v7
  s_mov_b64 exec, -1
  s_nop 0
  v_max_f32_dpp v7, v7, v7 quad_perm:[2,3,0,1] row_mask:0xf bank_mask:0xf
  v_mov_b32 v24, v7
  s_nop 0
  s_nop 0
  v_permlane16_swap_b32 v7, v24
  v_max_f32 v7, v7, v24
  v_mov_b32 v24, v7
  s_nop 0
  s_nop 0
  v_permlane32_swap_b32 v7, v24
  v_max_f32 v7, v7, v24
  v_sub_f32 v24, v48, v7
  v_sub_f32 v25, v49, v7
  v_sub_f32 v26, v50, v7
  v_sub_f32 v27, v51, v7
  v_sub_f32 v28, v16, v7
  v_sub_f32 v29, v17, v7
  v_exp_f32 v24, v24
  v_exp_f32 v25, v25
  v_exp_f32 v26, v26
  v_exp_f32 v27, v27
  v_exp_f32 v28, v28
  v_exp_f32 v29, v29
  v_cvt_pk_bf16_f32 v24, v24, v25
  v_cvt_pk_bf16_f32 v25, v26, v27
  v_cvt_pk_bf16_f32 v28, v28, v29
  v_cndmask_b32 v72, v24, 0, s[18:19]
  v_cndmask_b32 v73, v25, 0, s[18:19]
  v_cndmask_b32 v74, 0, v24, s[18:19]
  v_cndmask_b32 v75, 0, v25, s[18:19]
  v_cndmask_b32 v77, 0, v28, s[18:19]
  v_cndmask_b32 v78, 0, v28, s[18:19]
  v_mfma_f32_16x16x32_bf16 v[60:63], v[72:75], v[20:23], 0
  v_mfma_f32_16x16x32_bf16 v[52:55], v[72:75], v[80:83], 0
  v_mfma_f32_16x16x32_bf16 v[56:59], v[72:75], v[84:87], 0
  v_mfma_f32_16x16x16_bf16 v[60:63], v[76:77], v[20:21], v[60:63]
  v_mfma_f32_16x16x16_bf16 v[52:55], v[78:79], v[66:67], v[52:55]
  s_nop 2
  v_mfma_f32_16x16x16_bf16 v[56:59], v[76:77], v[66:67], v[56:59]
  s_nop 7
  v_add_f32 v60, v60, v62
  v_add_f32 v61, v61, v63
  s_branch c_fbr_13
c_fail_14:
  s_endpgm
L_chain_x:
  s_mov_b32 s22, 0
  s_mov_b32 s21, 0
  s_mov_b32 s42, s62
  s_add_u32 s43, s62, 4096
  s_mov_b32 s46, 0
  s_mov_b32 s47, 0
  s_lshl_b32 s26, s16, 2
  s_add_u32 s26, s26, s17
  s_lshl_b32 s27, s60, 13
  s_add_u32 s27, s27, s26
  s_lshr_b32 s25, s27, 2
  s_lshl_b32 s25, s25, 13
  s_add_u32 s25, s25, 192937984
  s_lshr_b32 s64, s27, 2
  s_lshl_b32 s64, s64, 6
  s_add_u32 s64, s64, 513538048
  s_cmp_eq_u32 s17, 3
  s_cselect_b32 s2, 268435456, 0
  s_lshl_b32 s27, s61, 13
  s_add_u32 s27, s27, s26
  s_lshl_b32 s23, s27, 12
  s_add_u32 s23, s23, 41943040
  s_lshl_b32 s63, s27, 5
  s_add_u32 s63, s63, 244318208
  s_mov_b32 s97, 268435456
  s_cmp_eq_u32 s60, 2
  s_cselect_b32 s20, 262144, s97
  s_cselect_b32 s93, 1, 3
  s_lshl_b32 s26, s17, 2
  s_add_u32 s26, s26, s60
  s_cmp_eq_u32 s26, 1
  s_cselect_b32 s97, 245891072, s97
  s_mov_b32 s95, 0
  s_mov_b32 s96, s23
  s_add_u32 s23, s23, 524288
  s_add_u32 s63, s63, 4096
  s_cmp_eq_u32 s66, 0
  s_cbranch_scc1 c_pk_51
  s_sub_u32 s96, s23, 524288
  s_mov_b32 s65, s67
  s_mov_b32 s94, 0
  buffer_load_dwordx4 v0, s[4:7], s96 offen offset:0  lds
  buffer_load_dwordx4 v0, s[4:7], s96 offen offset:1024  lds
  buffer_load_dwordx4 v0, s[4:7], s96 offen offset:2048  lds
  buffer_load_dwordx4 v0, s[4:7], s96 offen offset:3072  lds
  s_branch c_pk2_52
c_pk_51:
  s_mov_b32 s29, 0
  s_sub_u32 s92, s63, 4096
  s_sub_u32 s96, s23, 524288
  s_mov_b32 s95, 0
c_gw_53:
  buffer_load_dword v7, off, s[4:7], s92 sc1
  s_add_u32 s29, s29, 1
  s_cmp_gt_u32 s29, 1048576
  s_cbranch_scc1 c_fail_49
  s_waitcnt vmcnt(0) lgkmcnt(0)
  v_readfirstlane_b32 s65, v7
  s_cmp_eq_u32 s65, 0
  s_cbranch_scc1 c_gw_53
  s_and_b32 s65, s65, s93
  s_cbranch_scc1 c_kvx_55
  s_mov_b32 s95, 1
  s_add_u32 s96, s96, 33554432
  s_add_u32 s92, s92, 262144
c_kvw_54:
  buffer_load_dword v7, off, s[4:7], s92 sc1
  s_add_u32 s29, s29, 1
  s_cmp_gt_u32 s29, 1048576
  s_cbranch_scc1 c_fail_49
  s_waitcnt vmcnt(0) lgkmcnt(0)
  v_readfirstlane_b32 s65, v7
  s_cmp_eq_u32 s65, 0
  s_cbranch_scc1 c_kvw_54
c_kvx_55:
  buffer_load_dword v7, off, s[4:7], s63 sc1
  buffer_load_dwordx4 v0, s[4:7], s96 offen offset:0  lds
  buffer_load_dwordx4 v0, s[4:7], s96 offen offset:1024  lds
  buffer_load_dwordx4 v0, s[4:7], s96 offen offset:2048  lds
  buffer_load_dwordx4 v0, s[4:7], s96 offen offset:3072  lds
  s_waitcnt vmcnt(4)
  v_readfirstlane_b32 s65, v7
  s_mov_b32 s94, 0
c_pk2_52:
  s_waitcnt vmcnt(4)
  ds_read_b128 v[72:75], v1 offset:6144
  ds_read_b128 v[76:79], v1 offset:7168
  ds_read_b128 v[80:83], v1 offset:8192
  ds_read_b128 v[84:87], v1 offset:9216
  ds_read_b128 v[88:91], v1 offset:10240
  ds_read_b128 v[92:95], v1 offset:11264
  ds_read_b128 v[96:99], v1 offset:12288
  ds_read_b128 v[100:103], v1 offset:13312
  ds_read_b128 v[104:107], v1 offset:14336
  ds_read_b128 v[108:111], v1 offset:15360
  ds_read_b128 v[112:115], v1 offset:16384
  ds_read_b128 v[116:119], v1 offset:17408
  ds_read_b128 v[120:123], v1 offset:18432
  ds_read_b128 v[124:127], v1 offset:19456
  v_mov_b64 v[48:49], 0
  v_mov_b64 v[50:51], 0
  v_mov_b64 v[52:53], 0
  v_mov_b64 v[54:55], 0
  v_mov_b64 v[56:57], 0
  v_mov_b64 v[58:59], 0
  v_mov_b64 v[60:61], 0
  v_mov_b64 v[62:63], 0
  v_mov_b64 v[64:65], 0
  v_mov_b64 v[66:67], 0
  v_mov_b64 v[68:69], 0
  v_mov_b64 v[70:71], 0
  s_lshl_b32 s38, s16, 13
  s_add_u32 s38, s38, s40
  s_add_u32 s39, s38, 4096
  ds_read_b128 v[24:27], v1 offset:0
  ds_read_b128 v[28:31], v1 offset:1024
  ds_read_b128 v[32:35], v1 offset:2048
  ds_read_b128 v[36:39], v1 offset:3072
  ds_read_b128 v[40:43], v1 offset:4096
  ds_read_b128 v[44:47], v1 offset:5120
  s_waitcnt lgkmcnt(0)
c_loop_43:
  buffer_load_dwordx4 v[16:19], v8, s[4:7], s42 offen sc1
  buffer_load_dwordx4 v[20:23], v8, s[4:7], s43 offen sc1
  s_mov_b32 s28, 0
  v_mov_b64 v[48:49], 0
  v_mov_b64 v[50:51], 0
  v_mov_b64 v[52:53], 0
  v_mov_b64 v[54:55], 0
  v_mov_b64 v[56:57], 0
  v_mov_b64 v[58:59], 0
  v_mov_b64 v[60:61], 0
  v_mov_b64 v[62:63], 0
  v_mov_b64 v[64:65], 0
  v_mov_b64 v[66:67], 0
  v_mov_b64 v[68:69], 0
  v_mov_b64 v[70:71], 0
  buffer_load_dwordx4 v[16:19], v8, s[4:7], s42 offen sc1
  buffer_load_dwordx4 v[20:23], v8, s[4:7], s43 offen sc1
  s_waitcnt lgkmcnt(0)
  s_and_b32 s29, s65, s93
  s_cbranch_scc0 c_xb_58
c_xr_59:
  s_waitcnt vmcnt(3)
  v_max3_u32 v7, v16, v17, v18
  v_max_u32 v7, v7, v19
  ds_write_b128 v8, v[16:19] offset:4096
  v_smfmac_f32_16x16x64_bf16 v[48:51], v[16:19], v[24:31], v6
  s_waitcnt vmcnt(2)
  v_max3_u32 v7, v20, v21, v7
  v_max3_u32 v7, v22, v23, v7
  ds_write_b128 v8, v[20:23] offset:8192
  v_smfmac_f32_16x16x64_bf16 v[52:55], v[16:19], v[32:39], v6
  v_cmp_eq_u32 vcc, -1, v7
  v_smfmac_f32_16x16x64_bf16 v[56:59], v[16:19], v[40:47], v6
  s_cbranch_vccnz c_retry_44
c_got_45:
  v_smfmac_f32_16x16x64_bf16 v[60:63], v[16:19], v[72:79], v6
  ds_read_b128 v[72:75], v1 offset:20480
  s_and_b32 s65, s65, s93
  s_cselect_b32 s96, s23, 268435456
  v_smfmac_f32_16x16x64_bf16 v[48:51], v[20:23], v[80:87], v6
  ds_read_b128 v[76:79], v1 offset:21504
  v_mov_b32 v7, 1
  v_smfmac_f32_16x16x64_bf16 v[52:55], v[20:23], v[88:95], v6
  ds_read_b128 v[80:83], v1 offset:22528
  v_smfmac_f32_16x16x64_bf16 v[56:59], v[20:23], v[96:103], v6
  ds_read_b128 v[84:87], v1 offset:23552
  s_waitcnt lgkmcnt(4)
  s_barrier
  ds_read_b128 v[24:27], v9 offset:4096
  ds_read_b128 v[28:31], v10 offset:4096
  v_smfmac_f32_16x16x64_bf16 v[60:63], v[20:23], v[104:111], v6
  ds_read_b128 v[32:35], v11 offset:4096
  v_smfmac_f32_16x16x64_bf16 v[64:67], v[16:19], v[112:119], v6
  ds_read_b128 v[36:39], v9 offset:8192
  v_smfmac_f32_16x16x64_bf16 v[68:71], v[16:19], v[120:127], v6
  ds_read_b128 v[40:43], v10 offset:8192
  v_smfmac_f32_16x16x64_bf16 v[64:67], v[20:23], v[208:215], v6
  ds_read_b128 v[44:47], v11 offset:8192
  s_waitcnt lgkmcnt(5)
  v_smfmac_f32_16x16x64_bf16 v[48:51], v[24:27], a[168:175], v6
  s_mov_b64 exec, 1
  buffer_store_dword v7, off, s[4:7], s64 sc1
  s_mov_b64 exec, -1
  s_waitcnt lgkmcnt(4)
  v_smfmac_f32_16x16x64_bf16 v[48:51], v[28:31], a[160:167], v6
  buffer_load_dwordx4 v0, s[4:7], s96 offen offset:0  lds
  s_waitcnt lgkmcnt(3)
  v_smfmac_f32_16x16x64_bf16 v[48:51], v[32:35], a[152:159], v6
  ds_read_b128 v[104:107], v8 offset:16384
  s_waitcnt lgkmcnt(3)
  v_smfmac_f32_16x16x64_bf16 v[48:51], v[36:39], a[144:151], v6
  buffer_load_dwordx4 v0, s[4:7], s96 offen offset:1024  lds
  s_waitcnt lgkmcnt(2)
  v_smfmac_f32_16x16x64_bf16 v[48:51], v[40:43], a[136:143], v6
  ds_read_b128 v[108:111], v8 offset:20480
  s_waitcnt lgkmcnt(2)
  v_smfmac_f32_16x16x64_bf16 v[48:51], v[44:47], a[128:135], v6
  buffer_load_dwordx4 v0, s[4:7], s96 offen offset:2048  lds
  v_smfmac_f32_16x16x64_bf16 v[52:55], v[24:27], a[120:127], v6
  buffer_load_dwordx4 v0, s[4:7], s96 offen offset:3072  lds
  v_smfmac_f32_16x16x64_bf16 v[52:55], v[28:31], a[112:119], v6
  ds_read_b64 v[100:101], v5 offset:4096
  v_add_f32 v48, v48, v50
  v_smfmac_f32_16x16x64_bf16 v[52:55], v[32:35], a[104:111], v6
  ds_read_b128 v[112:115], v8 offset:24576
  v_add_f32 v49, v49, v51
  v_smfmac_f32_16x16x64_bf16 v[52:55], v[36:39], a[96:103], v6
  ds_read_b128 v[116:119], v8 offset:28672
  v_cvt_pk_bf16_f32 v50, v48, v49
  v_smfmac_f32_16x16x64_bf16 v[52:55], v[40:43], a[88:95], v6
  ds_write2_b32 v2, v50, v50 offset0:0 offset1:1
  v_smfmac_f32_16x16x64_bf16 v[52:55], v[44:47], a[80:87], v6
  ds_read_b64_tr_b16 v[88:89], v12 offset:0
  v_smfmac_f32_16x16x64_bf16 v[56:59], v[24:27], a[72:79], v6
  v_smfmac_f32_16x16x64_bf16 v[56:59], v[28:31], a[64:71], v6
  ds_read_b128 v[120:123], v8 offset:32768
  v_add_f32 v52, v52, v54
  v_smfmac_f32_16x16x64_bf16 v[56:59], v[32:35], a[56:63], v6
  ds_read_b128 v[124:127], v8 offset:36864
  v_add_f32 v53, v53, v55
  v_cvt_pk_bf16_f32 v54, v52, v53
  v_smfmac_f32_16x16x64_bf16 v[56:59], v[36:39], a[48:55], v6
  ds_write2_b32 v2, v54, v54 offset0:128 offset1:129
  ds_read_b64_tr_b16 v[90:91], v12 offset:512
  v_smfmac_f32_16x16x64_bf16 v[56:59], v[40:43], a[40:47], v6
  v_smfmac_f32_16x16x64_bf16 v[56:59], v[44:47], a[32:39], v6
  v_smfmac_f32_16x16x64_bf16 v[60:63], v[24:27], a[24:31], v6
  v_smfmac_f32_16x16x64_bf16 v[60:63], v[28:31], a[16:23], v6
  s_waitcnt lgkmcnt(0)
  v_add_f32 v56, v56, v58
  v_mfma_f32_16x16x32_bf16 v[92:95], v[72:75], v[88:91], 0
  buffer_store_dwordx2 v[100:101], v5, s[4:7], s97 offen sc1
  v_add_f32 v57, v57, v59
  v_cvt_pk_bf16_f32 v58, v56, v57
  v_mfma_f32_16x16x32_bf16 v[96:99], v[76:79], v[88:91], 0
  ds_write_b32 v2, v58
  v_smfmac_f32_16x16x64_bf16 v[60:63], v[32:35], a[8:15], v6
  v_mov_b32 v76, 0
  v_smfmac_f32_16x16x64_bf16 v[60:63], v[36:39], a[0:7], v6
  v_cndmask_b32 v48, v92, v96, s[18:19]
  v_smfmac_f32_16x16x64_bf16 v[60:63], v[40:43], v[248:255], v6
  v_cndmask_b32 v49, v93, v97, s[18:19]
  v_smfmac_f32_16x16x64_bf16 v[60:63], v[44:47], v[240:247], v6
  v_cndmask_b32 v50, v94, v98, s[18:19]
  v_smfmac_f32_16x16x64_bf16 v[68:71], v[20:23], v[152:159], v6
  v_cndmask_b32 v51, v95, v99, s[18:19]
  v_smfmac_f32_16x16x64_bf16 v[64:67], v[24:27], v[232:239], v6
  ds_write_b128 v8, v[48:51] offset:12288
  v_add_f32 v60, v60, v62
  v_add_f32 v61, v61, v63
  v_cvt_pk_bf16_f32 v62, v60, v61
  v_smfmac_f32_16x16x64_bf16 v[64:67], v[28:31], v[224:231], v6
  ds_write_b32 v2, v62 offset:512
  s_waitcnt vmcnt(6)
  v_mov_b32 v79, 0
  v_smfmac_f32_16x16x64_bf16 v[64:67], v[32:35], v[216:223], v6
  v_mov_b64 v[20:21], s[14:15]
  v_smfmac_f32_16x16x64_bf16 v[64:67], v[36:39], v[200:207], v6
  v_mov_b64 v[22:23], s[14:15]
  v_smfmac_f32_16x16x64_bf16 v[64:67], v[40:43], v[192:199], v6
  s_waitcnt lgkmcnt(0)
  s_barrier
  ds_read_b128 v[52:55], v9 offset:12288
  ds_read_b128 v[56:59], v10 offset:12288
  v_smfmac_f32_16x16x64_bf16 v[64:67], v[44:47], v[184:191], v6
  ds_read_b128 v[60:63], v11 offset:12288
  v_smfmac_f32_16x16x64_bf16 v[68:71], v[24:27], v[176:183], v6
  ds_read_b64_tr_b16 v[88:89], v12 offset:0
  ds_read_b64_tr_b16 v[90:91], v12 offset:512
  v_smfmac_f32_16x16x64_bf16 v[68:71], v[28:31], v[168:175], v6
  ds_read_b64_tr_b16 v[92:93], v13 offset:0
  ds_read_b64_tr_b16 v[94:95], v13 offset:512
  v_add_f32 v64, v64, v66
  v_smfmac_f32_16x16x64_bf16 v[68:71], v[32:35], v[160:167], v6
  ds_read_b64_tr_b16 v[96:97], v14 offset:0
  ds_read_b64_tr_b16 v[98:99], v14 offset:512
  v_add_f32 v65, v65, v67
  v_smfmac_f32_16x16x64_bf16 v[68:71], v[36:39], v[144:151], v6
  ds_read_b64_tr_b16 v[100:101], v15 offset:0
  ds_read_b64_tr_b16 v[102:103], v15 offset:512
  s_waitcnt lgkmcnt(8)
  v_cvt_pk_bf16_f32 v66, v64, v65
  v_smfmac_f32_16x16x64_bf16 v[68:71], v[40:43], v[136:143], v6
  v_add_f32 v48, v48, v52
  v_smfmac_f32_16x16x64_bf16 v[68:71], v[44:47], v[128:135], v6
  s_waitcnt lgkmcnt(4)
  v_add_f32 v49, v49, v53
  v_mfma_f32_16x16x32_bf16 v[16:19], v[88:91], v[88:91], 0
  buffer_store_dwordx4 v[88:91], v8, s[4:7], s25 offen sc1
  v_add_f32 v50, v50, v54
  v_add_f32 v51, v51, v55
  v_mfma_f32_16x16x32_bf16 v[16:19], v[92:95], v[92:95], v[16:19]
  s_waitcnt lgkmcnt(0)
  v_add_f32 v56, v56, v60
  v_add_f32 v57, v57, v61
  v_mfma_f32_16x16x32_bf16 v[16:19], v[96:99], v[96:99], v[16:19]
  v_add_f32 v58, v58, v62
  v_add_f32 v59, v59, v63
  v_mfma_f32_16x16x32_bf16 v[16:19], v[100:103], v[100:103], v[16:19]
  v_add_f32 v48, v48, v56
  v_add_f32 v49, v49, v57
  v_add_f32 v50, v50, v58
  v_add_f32 v51, v51, v59
  v_exp_f32 v24, v48
  v_exp_f32 v25, v49
  v_exp_f32 v26, v50
  v_exp_f32 v27, v51
  v_cvt_pk_bf16_f32 v24, v24, v25
  v_mul_f32 v16, s24, v16
  v_cvt_pk_bf16_f32 v25, v26, v27
  v_cndmask_b32 v72, v24, 0, s[18:19]
  v_cndmask_b32 v73, v25, 0, s[18:19]
  v_cndmask_b32 v74, 0, v24, s[18:19]
  v_cndmask_b32 v75, 0, v25, s[18:19]
  v_mul_f32 v17, s24, v17
  v_exp_f32 v28, v16
  v_mfma_f32_16x16x32_bf16 v[60:63], v[72:75], v[20:23], 0
  v_exp_f32 v29, v17
  v_add_f32 v68, v68, v70
  v_mfma_f32_16x16x32_bf16 v[52:55], v[72:75], v[80:83], 0
  s_add_u32 s30, s25, 4096
  v_cvt_pk_bf16_f32 v28, v28, v29
  v_add_f32 v69, v69, v71
  v_mfma_f32_16x16x32_bf16 v[56:59], v[72:75], v[84:87], 0
  v_cndmask_b32 v77, 0, v28, s[18:19]
  v_cndmask_b32 v78, 0, v28, s[18:19]
  v_cvt_pk_bf16_f32 v67, v68, v69
  v_lshrrev_b32 v92, 1, v8
  v_mfma_f32_16x16x16_bf16 v[60:63], v[76:77], v[20:21], v[60:63]
  buffer_store_dwordx2 v[66:67], v92, s[4:7], s30 offen sc1
  v_max3_f32 v7, |v48|, |v49|, |v50|
  v_max_f32 v26, |v16|, |v17|
  v_mfma_f32_16x16x16_bf16 v[52:55], v[78:79], v[66:67], v[52:55]
  v_cndmask_b32 v26, 0, v26, s[18:19]
  v_max3_f32 v7, |v51|, v26, v7
  v_mfma_f32_16x16x16_bf16 v[56:59], v[76:77], v[66:67], v[56:59]
  v_cmp_lt_f32 vcc, 0x42700000, v7
  v_mov_b64 v[44:45], 0
  v_add_f32 v60, v60, v62
  v_add_f32 v61, v61, v63
  s_cbranch_vccnz c_fb_47
c_fbr_48:
  v_rcp_f32 v60, v60
  v_rcp_f32 v61, v61
  v_pk_add_f32 v[52:53], v[52:53], v[54:55]
  v_pk_add_f32 v[56:57], v[56:57], v[58:59]
  v_pk_mul_f32 v[52:53], v[52:53], v[60:61]
  v_pk_mul_f32 v[56:57], v[56:57], v[60:61]
  v_cvt_pk_bf16_f32 v54, v52, v53
  v_cvt_pk_bf16_f32 v55, v56, v57
  ds_write_b64 v2, v[54:55] offset:4096
  v_mov_b64 v[46:47], 0
  v_mov_b64 v[40:41], 0
  v_mov_b64 v[42:43], 0
  v_mov_b64 v[36:37], 0
  v_mov_b64 v[38:39], 0
  v_mov_b64 v[32:33], 0
  v_mov_b64 v[34:35], 0
  v_mov_b64 v[28:29], 0
  v_mov_b64 v[30:31], 0
  v_mov_b64 v[24:25], 0
  v_mov_b64 v[26:27], 0
  v_mov_b64 v[80:81], 0
  s_waitcnt lgkmcnt(0)
  s_barrier
  ds_read_b64_tr_b16 v[72:73], v3 offset:4096
  ds_read_b64_tr_b16 v[74:75], v3 offset:5120
  ds_read_b64_tr_b16 v[76:77], v3 offset:6144
  ds_read_b64_tr_b16 v[78:79], v3 offset:7168
  s_and_b32 s3, s21, 1
  s_add_u32 s21, s21, 1
  s_add_u32 s22, s22, 1
  s_and_b32 s42, s21, 3
  s_lshl_b32 s42, s42, 13
  s_cmp_eq_u32 s22, 64
  s_cbranch_scc1 c_last_50
  s_waitcnt lgkmcnt(2)
  v_smfmac_f32_16x16x64_bf16 v[44:47], v[72:75], a[248:255], v6
  s_waitcnt lgkmcnt(0)
  ds_read_b128 v[16:19], v8 offset:40960
  v_mov_b64 v[82:83], 0
  v_smfmac_f32_16x16x64_bf16 v[44:47], v[76:79], a[240:247], v6
  ds_read_b128 v[20:23], v8 offset:45056
  v_mov_b64 v[84:85], 0
  v_smfmac_f32_16x16x64_bf16 v[40:43], v[72:75], a[232:239], v6
  ds_read_b128 v[88:91], v8 offset:49152
  v_mov_b64 v[86:87], 0
  v_smfmac_f32_16x16x64_bf16 v[40:43], v[76:79], a[224:231], v6
  ds_read_b128 v[92:95], v8 offset:53248
  v_add_f32 v44, v44, v46
  v_add_f32 v45, v45, v47
  v_smfmac_f32_16x16x64_bf16 v[36:39], v[72:75], a[216:223], v6
  ds_read_b128 v[96:99], v8 offset:57344
  v_cvt_pk_bf16_f32 v48, v44, v45
  v_and_or_b32 v48, v48, -2, s3
  v_smfmac_f32_16x16x64_bf16 v[36:39], v[76:79], a[208:215], v6
  ds_read_b128 v[100:103], v8 offset:61440
  v_add_f32 v40, v40, v42
  v_add_f32 v41, v41, v43
  v_smfmac_f32_16x16x64_bf16 v[32:35], v[72:75], a[200:207], v6
  v_cvt_pk_bf16_f32 v49, v40, v41
  v_smfmac_f32_16x16x64_bf16 v[32:35], v[76:79], a[192:199], v6
  v_add_f32 v36, v36, v38
  v_add_f32 v37, v37, v39
  v_smfmac_f32_16x16x64_bf16 v[28:31], v[72:75], a[184:191], v6
  v_cvt_pk_bf16_f32 v50, v36, v37
  v_smfmac_f32_16x16x64_bf16 v[28:31], v[76:79], a[176:183], v6
  v_add_f32 v32, v32, v34
  v_add_f32 v33, v33, v35
  v_smfmac_f32_16x16x64_bf16 v[24:27], v[72:75], v[104:111], v6
  v_cvt_pk_bf16_f32 v51, v32, v33
  v_smfmac_f32_16x16x64_bf16 v[24:27], v[76:79], v[112:119], v6
  buffer_store_dwordx4 v[48:51], v4, s[4:7], s40 offen sc1
  v_add_f32 v28, v28, v30
  v_add_f32 v29, v29, v31
  v_smfmac_f32_16x16x64_bf16 v[80:83], v[72:75], v[120:127], v6
  s_waitcnt lgkmcnt(0)
  v_cvt_pk_bf16_f32 v52, v28, v29
  v_and_or_b32 v52, v52, -2, s3
  v_smfmac_f32_16x16x64_bf16 v[80:83], v[76:79], v[16:23], v6
  v_add_f32 v24, v24, v26
  v_add_f32 v25, v25, v27
  v_smfmac_f32_16x16x64_bf16 v[84:87], v[72:75], v[88:95], v6
  v_cvt_pk_bf16_f32 v53, v24, v25
  v_smfmac_f32_16x16x64_bf16 v[84:87], v[76:79], v[96:103], v6
  v_add_f32 v80, v80, v82
  v_add_f32 v81, v81, v83
  v_cvt_pk_bf16_f32 v54, v80, v81
  s_nop 0
  s_nop 3
  v_pk_add_f32 v[84:85], v[84:85], v[86:87]
  v_cvt_pk_bf16_f32 v55, v84, v85
  buffer_store_dwordx4 v[52:55], v4, s[4:7], s41 offen sc1
  s_add_u32 s42, s42, s62
  s_add_u32 s43, s42, 4096
  s_add_u32 s23, s23, 524288
  s_add_u32 s25, s25, 262144
  s_add_u32 s63, s63, 4096
  s_add_u32 s64, s64, 2048
  s_andn2_b32 s64, s64, s2
  s_add_u32 s97, s97, 8192
  s_add_u32 s92, s63, s20
  s_cmp_lg_u32 s17, 0
  s_cbranch_scc1 c_oth_62
  s_mov_b32 s28, 0
  s_add_u32 s46, s46, 1
  v_mov_b64 v[64:65], -1
  s_xor_b32 s34, s42, 16384
  buffer_store_dwordx2 v[64:65], v5, s[4:7], s34 offen sc1
  s_mov_b32 vcc_lo, 0xaaaaaaaa
  s_mov_b32 vcc_hi, 0xaaaaaaaa
  v_mov_b32 v7, 0x3f80
  v_cndmask_b32 v7, v7, 1.0, vcc
  s_mov_b32 vcc_lo, 0x30003
  s_mov_b32 vcc_hi, 0x30003
  v_cndmask_b32 v68, 0, v7, vcc
  s_mov_b32 vcc_lo, 0xc000c
  s_mov_b32 vcc_hi, 0xc000c
  v_cndmask_b32 v69, 0, v7, vcc
  s_mov_b32 vcc_lo, 0x300030
  s_mov_b32 vcc_hi, 0x300030
  v_cndmask_b32 v70, 0, v7, vcc
  s_mov_b32 vcc_lo, 0xc000c0
  s_mov_b32 vcc_hi, 0xc000c0
  v_cndmask_b32 v71, 0, v7, vcc
  ds_read_b128 v[104:107], v1 offset:14336
  ds_read_b128 v[108:111], v1 offset:15360
  s_waitcnt lgkmcnt(0)
  ds_read_b128 v[112:115], v1 offset:16384
  ds_read_b128 v[116:119], v1 offset:17408
  ds_read_b128 v[120:123], v1 offset:18432
  ds_read_b128 v[124:127], v1 offset:19456
  s_waitcnt lgkmcnt(0)
  buffer_load_dwordx4 v[16:19], v0, s[4:7], s38 offen offset:0 sc1
  buffer_load_dwordx4 v[20:23], v0, s[4:7], s38 offen offset:1024 sc1
  buffer_load_dwordx4 v[24:27], v0, s[4:7], s38 offen offset:2048 sc1
  buffer_load_dwordx4 v[28:31], v0, s[4:7], s38 offen offset:3072 sc1
  buffer_load_dwordx4 v[32:35], v0, s[4:7], s39 offen offset:0 sc1
  buffer_load_dwordx4 v[36:39], v0, s[4:7], s39 offen offset:1024 sc1
  buffer_load_dwordx4 v[40:43], v0, s[4:7], s39 offen offset:2048 sc1
  buffer_load_dwordx4 v[44:47], v0, s[4:7], s39 offen offset:3072 sc1
  buffer_load_dwordx4 v[72:75], v0, s[4:7], s38 offen offset:0 sc1
  buffer_load_dwordx4 v[76:79], v0, s[4:7], s38 offen offset:1024 sc1
  buffer_load_dwordx4 v[80:83], v0, s[4:7], s38 offen offset:2048 sc1
  buffer_load_dwordx4 v[84:87], v0, s[4:7], s38 offen offset:3072 sc1
  buffer_load_dwordx4 v[88:91], v0, s[4:7], s39 offen offset:0 sc1
  buffer_load_dwordx4 v[92:95], v0, s[4:7], s39 offen offset:1024 sc1
  buffer_load_dwordx4 v[96:99], v0, s[4:7], s39 offen offset:2048 sc1
  buffer_load_dwordx4 v[100:103], v0, s[4:7], s39 offen offset:3072 sc1
  s_buffer_load_dword s65, s[4:7], s63
  s_waitcnt vmcnt(15)
  v_mfma_f32_16x16x32_bf16 v[64:67], v[16:19], v[68:71], 0
  v_xor_b32 v7, s3, v16
  s_waitcnt vmcnt(14)
  v_mfma_f32_16x16x32_bf16 v[64:67], v[20:23], v[68:71], v[64:67]
  v_bitop3_b32 v7, v7, v20, s3 bitop3:0xf6
  s_waitcnt vmcnt(13)
  v_mfma_f32_16x16x32_bf16 v[64:67], v[24:27], v[68:71], v[64:67]
  v_bitop3_b32 v7, v7, v24, s3 bitop3:0xf6
  s_waitcnt vmcnt(12)
  v_mfma_f32_16x16x32_bf16 v[64:67], v[28:31], v[68:71], v[64:67]
  v_bitop3_b32 v7, v7, v28, s3 bitop3:0xf6
  s_waitcnt vmcnt(11)
  v_mfma_f32_16x16x32_bf16 v[64:67], v[32:35], v[68:71], v[64:67]
  v_bitop3_b32 v7, v7, v32, s3 bitop3:0xf6
  s_waitcnt vmcnt(10)
  v_mfma_f32_16x16x32_bf16 v[64:67], v[36:39], v[68:71], v[64:67]
  v_bitop3_b32 v7, v7, v36, s3 bitop3:0xf6
  s_waitcnt vmcnt(9)
  v_mfma_f32_16x16x32_bf16 v[64:67], v[40:43], v[68:71], v[64:67]
  v_bitop3_b32 v7, v7, v40, s3 bitop3:0xf6
  s_waitcnt vmcnt(8)
  v_mfma_f32_16x16x32_bf16 v[64:67], v[44:47], v[68:71], v[64:67]
  v_bitop3_b32 v7, v7, v44, s3 bitop3:0xf6
  v_and_b32 v7, 1, v7
  v_cmp_ne_u32 vcc, 0, v7
  v_mov_b32 v7, 0
  v_mov_b32 v7, 0
  s_cbranch_vccnz c_p1r_63
c_publ_64:
  s_nop 1
  s_nop 0
  v_cvt_pk_bf16_f32 v64, v64, v65
  v_cvt_pk_bf16_f32 v65, v66, v67
  v_min_u32 v64, -2, v64
  v_min_u32 v65, -2, v65
  buffer_store_dwordx2 v[64:65], v5, s[4:7], s42 offen sc1
  s_waitcnt vmcnt(1)
  ds_read_b128 v[24:27], v1 offset:0
  ds_read_b128 v[28:31], v1 offset:1024
  ds_read_b128 v[32:35], v1 offset:2048
  ds_read_b128 v[36:39], v1 offset:3072
  ds_read_b128 v[40:43], v1 offset:4096
  ds_read_b128 v[44:47], v1 offset:5120
  ds_read_b128 v[72:75], v1 offset:6144
  ds_read_b128 v[76:79], v1 offset:7168
  ds_read_b128 v[80:83], v1 offset:8192
  ds_read_b128 v[84:87], v1 offset:9216
  ds_read_b128 v[88:91], v1 offset:10240
  ds_read_b128 v[92:95], v1 offset:11264
  ds_read_b128 v[96:99], v1 offset:12288
  ds_read_b128 v[100:103], v1 offset:13312
c_hop2_46:
  s_barrier
  s_cmp_le_u32 s96, s23
  s_cbranch_scc1 c_loop_43
  s_cmp_lg_u32 s96, 268435456
  s_cbranch_scc1 c_fk0_65
  buffer_store_dwordx2 v[64:65], v5, s[4:7], s97 offen sc1
  s_mov_b32 s29, 0
  s_sub_u32 s92, s63, 4096
  s_sub_u32 s96, s23, 524288
  s_mov_b32 s95, 0
c_gw_66:
  buffer_load_dword v7, off, s[4:7], s92 sc1
  s_add_u32 s29, s29, 1
  s_cmp_gt_u32 s29, 1048576
  s_cbranch_scc1 c_fail_49
  s_waitcnt vmcnt(0) lgkmcnt(0)
  v_readfirstlane_b32 s65, v7
  s_cmp_eq_u32 s65, 0
  s_cbranch_scc1 c_gw_66
  s_and_b32 s65, s65, s93
  s_cbranch_scc1 c_kvx_68
  s_mov_b32 s95, 1
  s_add_u32 s96, s96, 33554432
  s_add_u32 s92, s92, 262144
c_kvw_67:
  buffer_load_dword v7, off, s[4:7], s92 sc1
  s_add_u32 s29, s29, 1
  s_cmp_gt_u32 s29, 1048576
  s_cbranch_scc1 c_fail_49
  s_waitcnt vmcnt(0) lgkmcnt(0)
  v_readfirstlane_b32 s65, v7
  s_cmp_eq_u32 s65, 0
  s_cbranch_scc1 c_kvw_67
c_kvx_68:
  buffer_load_dword v7, off, s[4:7], s63 sc1
  buffer_load_dwordx4 v0, s[4:7], s96 offen offset:0  lds
  buffer_load_dwordx4 v0, s[4:7], s96 offen offset:1024  lds
  buffer_load_dwordx4 v0, s[4:7], s96 offen offset:2048  lds
  buffer_load_dwordx4 v0, s[4:7], s96 offen offset:3072  lds
  s_waitcnt vmcnt(4)
  v_readfirstlane_b32 s65, v7
  s_mov_b32 s94, 0
  s_cmp_eq_u32 s95, 0
  s_cbranch_scc1 c_loop_43
c_fk0_65:
  s_mov_b32 s29, 0
c_fk_69:
  buffer_load_dwordx4 v[16:19], v8, s[4:7], s42 offen sc1
  buffer_load_dwordx4 v[20:23], v8, s[4:7], s43 offen sc1
  s_add_u32 s29, s29, 1
  s_cmp_gt_u32 s29, 1048576
  s_cbranch_scc1 c_fail_49
  s_waitcnt vmcnt(0)
  v_max3_u32 v7, v16, v17, v18
  v_max3_u32 v7, v19, v20, v7
  v_max3_u32 v7, v21, v22, v7
  v_max_u32 v7, v7, v23
  v_cmp_eq_u32 vcc, -1, v7
  s_cbranch_vccnz c_fk_69
c_fk1_70:
  s_lshl_b32 s42, s22, 13
  s_add_u32 s42, s42, 245891072
  s_add_u32 s43, s42, 4096
  s_mov_b32 s95, 0
  s_branch c_loop_43
c_xb_58:
  s_cmp_lg_u32 s93, 1
  s_cbranch_scc1 c_xr_59
  s_cmp_ge_u32 s22, 63
  s_cbranch_scc1 c_xr_59
c_xp_71:
  s_cmp_lg_u32 s65, 0
  s_cbranch_scc1 c_xs_72
  buffer_load_dword v7, off, s[4:7], s63 sc1
  s_add_u32 s29, s29, 1
  s_cmp_gt_u32 s29, 1048576
  s_cbranch_scc1 c_fail_49
  s_waitcnt vmcnt(0)
  v_readfirstlane_b32 s65, v7
  s_branch c_xp_71
c_xs_72:
  s_cmp_eq_u32 s65, 1
  s_cbranch_scc1 c_xr_59
  s_mov_b32 s29, 0
c_xw_73:
  buffer_load_dwordx4 v[16:19], v8, s[4:7], s42 offen sc1
  buffer_load_dwordx4 v[20:23], v8, s[4:7], s43 offen sc1
  s_add_u32 s29, s29, 1
  s_cmp_gt_u32 s29, 1048576
  s_cbranch_scc1 c_fail_49
  s_waitcnt vmcnt(0)
  v_max3_u32 v7, v16, v17, v18
  v_max3_u32 v7, v19, v20, v7
  v_max3_u32 v7, v21, v22, v7
  v_max_u32 v7, v7, v23
  v_cmp_eq_u32 vcc, -1, v7
  s_cbranch_vccnz c_xw_73
  v_mov_b32 v7, 1
  s_barrier
  s_mov_b64 exec, 1
  buffer_store_dword v7, off, s[4:7], s64 sc1
  s_mov_b64 exec, -1
  s_add_u32 s22, s22, 1
  s_add_u32 s23, s23, 524288
  s_add_u32 s25, s25, 262144
  s_add_u32 s63, s63, 4096
  s_add_u32 s64, s64, 2048
  s_andn2_b32 s64, s64, s2
  s_mov_b32 s29, 0
  s_sub_u32 s92, s63, 4096
  s_sub_u32 s96, s23, 524288
  s_mov_b32 s95, 0
  s_mov_b32 s95, 1
  s_add_u32 s96, s96, 33554432
  s_add_u32 s92, s92, 262144
c_kvw_75:
  buffer_load_dword v7, off, s[4:7], s92 sc1
  s_add_u32 s29, s29, 1
  s_cmp_gt_u32 s29, 1048576
  s_cbranch_scc1 c_fail_49
  s_waitcnt vmcnt(0) lgkmcnt(0)
  v_readfirstlane_b32 s65, v7
  s_cmp_eq_u32 s65, 0
  s_cbranch_scc1 c_kvw_75
c_kvx_76:
  buffer_load_dword v7, off, s[4:7], s63 sc1
  buffer_load_dwordx4 v0, s[4:7], s96 offen offset:0  lds
  buffer_load_dwordx4 v0, s[4:7], s96 offen offset:1024  lds
  buffer_load_dwordx4 v0, s[4:7], s96 offen offset:2048  lds
  buffer_load_dwordx4 v0, s[4:7], s96 offen offset:3072  lds
  s_waitcnt vmcnt(4)
  v_readfirstlane_b32 s65, v7
  s_mov_b32 s94, 0
  s_branch c_fk1_70
c_last_50:
  s_add_u32 s64, s64, 2048
  v_mov_b32 v7, 1
  s_waitcnt vmcnt(0)
  s_barrier
  s_mov_b64 exec, 1
  buffer_store_dword v7, off, s[4:7], s64 sc1
  s_mov_b64 exec, -1
  s_branch L_chdone
c_oth_62:
  s_buffer_load_dword s65, s[4:7], s63
  ds_read_b128 v[24:27], v1 offset:0
  ds_read_b128 v[28:31], v1 offset:1024
  ds_read_b128 v[32:35], v1 offset:2048
  ds_read_b128 v[36:39], v1 offset:3072
  ds_read_b128 v[40:43], v1 offset:4096
  ds_read_b128 v[44:47], v1 offset:5120
  ds_read_b128 v[72:75], v1 offset:6144
  ds_read_b128 v[76:79], v1 offset:7168
  ds_read_b128 v[80:83], v1 offset:8192
  ds_read_b128 v[84:87], v1 offset:9216
  ds_read_b128 v[88:91], v1 offset:10240
  ds_read_b128 v[92:95], v1 offset:11264
  ds_read_b128 v[96:99], v1 offset:12288
  ds_read_b128 v[100:103], v1 offset:13312
  ds_read_b128 v[104:107], v1 offset:14336
  ds_read_b128 v[108:111], v1 offset:15360
  ds_read_b128 v[112:115], v1 offset:16384
  ds_read_b128 v[116:119], v1 offset:17408
  ds_read_b128 v[120:123], v1 offset:18432
  ds_read_b128 v[124:127], v1 offset:19456
  s_branch c_hop2_46
c_p1r_63:
  s_waitcnt vmcnt(7)
  s_nop 0
  v_mfma_f32_16x16x32_bf16 v[64:67], v[72:75], v[68:71], 0
  v_xor_b32 v7, s3, v72
  s_waitcnt vmcnt(6)
  v_mfma_f32_16x16x32_bf16 v[64:67], v[76:79], v[68:71], v[64:67]
  v_bitop3_b32 v7, v7, v76, s3 bitop3:0xf6
  s_waitcnt vmcnt(5)
  v_mfma_f32_16x16x32_bf16 v[64:67], v[80:83], v[68:71], v[64:67]
  v_bitop3_b32 v7, v7, v80, s3 bitop3:0xf6
  s_waitcnt vmcnt(4)
  v_mfma_f32_16x16x32_bf16 v[64:67], v[84:87], v[68:71], v[64:67]
  v_bitop3_b32 v7, v7, v84, s3 bitop3:0xf6
  s_waitcnt vmcnt(3)
  v_mfma_f32_16x16x32_bf16 v[64:67], v[88:91], v[68:71], v[64:67]
  v_bitop3_b32 v7, v7, v88, s3 bitop3:0xf6
  s_waitcnt vmcnt(2)
  v_mfma_f32_16x16x32_bf16 v[64:67], v[92:95], v[68:71], v[64:67]
  v_bitop3_b32 v7, v7, v92, s3 bitop3:0xf6
  s_waitcnt vmcnt(1)
  v_mfma_f32_16x16x32_bf16 v[64:67], v[96:99], v[68:71], v[64:67]
  v_bitop3_b32 v7, v7, v96, s3 bitop3:0xf6
  s_waitcnt vmcnt(0)
  v_mfma_f32_16x16x32_bf16 v[64:67], v[100:103], v[68:71], v[64:67]
  v_bitop3_b32 v7, v7, v100, s3 bitop3:0xf6
  v_and_b32 v7, 1, v7
  v_cmp_ne_u32 vcc, 0, v7
  s_add_u32 s46, s46, 1
  s_cbranch_vccz c_publ_64
  buffer_load_dwordx4 v[72:75], v0, s[4:7], s38 offen offset:0 sc1
  buffer_load_dwordx4 v[76:79], v0, s[4:7], s38 offen offset:1024 sc1
  buffer_load_dwordx4 v[80:83], v0, s[4:7], s38 offen offset:2048 sc1
  buffer_load_dwordx4 v[84:87], v0, s[4:7], s38 offen offset:3072 sc1
  buffer_load_dwordx4 v[88:91], v0, s[4:7], s39 offen offset:0 sc1
  buffer_load_dwordx4 v[92:95], v0, s[4:7], s39 offen offset:1024 sc1
  buffer_load_dwordx4 v[96:99], v0, s[4:7], s39 offen offset:2048 sc1
  buffer_load_dwordx4 v[100:103], v0, s[4:7], s39 offen offset:3072 sc1
  s_add_u32 s28, s28, 1
  s_cmp_gt_u32 s28, 1048576
  s_cbranch_scc0 c_p1r_63
  s_branch c_fail_49
c_retry_44:
  v_mov_b64 v[48:49], 0
  v_mov_b64 v[50:51], 0
  s_nop 0
  v_mov_b64 v[52:53], 0
  v_mov_b64 v[54:55], 0
  s_nop 1
  v_mov_b64 v[56:57], 0
  v_mov_b64 v[58:59], 0
c_rl_77:
  buffer_load_dwordx4 v[16:19], v8, s[4:7], s42 offen sc1
  buffer_load_dwordx4 v[20:23], v8, s[4:7], s43 offen sc1
  s_add_u32 s28, s28, 1
  s_add_u32 s47, s47, 1
  s_cmp_gt_u32 s28, 1048576
  s_cbranch_scc1 c_fail_49
  s_waitcnt vmcnt(2)
  v_max3_u32 v7, v16, v17, v18
  v_max3_u32 v7, v19, v20, v7
  v_max3_u32 v7, v21, v22, v7
  v_max_u32 v7, v7, v23
  v_cmp_eq_u32 vcc, -1, v7
  s_cbranch_vccnz c_rl_77
  ds_write_b128 v8, v[16:19] offset:4096
  v_smfmac_f32_16x16x64_bf16 v[48:51], v[16:19], v[24:31], v6
  ds_write_b128 v8, v[20:23] offset:8192
  v_smfmac_f32_16x16x64_bf16 v[52:55], v[16:19], v[32:39], v6
  v_smfmac_f32_16x16x64_bf16 v[56:59], v[16:19], v[40:47], v6
  s_branch c_got_45
c_fb_47:
  v_max3_f32 v7, v48, v49, v50
  v_max_f32 v7, v51, v7
  s_mov_b64 exec, s[18:19]
  v_max3_f32 v7, v16, v17, v7
  s_mov_b64 exec, -1
  s_nop 0
  v_max_f32_dpp v7, v7, v7 quad_perm:[2,3,0,1] row_mask:0xf bank_mask:0xf
  v_mov_b32 v24, v7
  s_nop 0
  s_nop 0
  v_permlane16_swap_b32 v7, v24
  v_max_f32 v7, v7, v24
  v_mov_b32 v24, v7
  s_nop 0
  s_nop 0
  v_permlane32_swap_b32 v7, v24
  v_max_f32 v7, v7, v24
  v_sub_f32 v24, v48, v7
  v_sub_f32 v25, v49, v7
  v_sub_f32 v26, v50, v7
  v_sub_f32 v27, v51, v7
  v_sub_f32 v28, v16, v7
  v_sub_f32 v29, v17, v7
  v_exp_f32 v24, v24
  v_exp_f32 v25, v25
  v_exp_f32 v26, v26
  v_exp_f32 v27, v27
  v_exp_f32 v28, v28
  v_exp_f32 v29, v29
  v_cvt_pk_bf16_f32 v24, v24, v25
  v_cvt_pk_bf16_f32 v25, v26, v27
  v_cvt_pk_bf16_f32 v28, v28, v29
  v_cndmask_b32 v72, v24, 0, s[18:19]
  v_cndmask_b32 v73, v25, 0, s[18:19]
  v_cndmask_b32 v74, 0, v24, s[18:19]
  v_cndmask_b32 v75, 0, v25, s[18:19]
  v_cndmask_b32 v77, 0, v28, s[18:19]
  v_cndmask_b32 v78, 0, v28, s[18:19]
  v_mfma_f32_16x16x32_bf16 v[60:63], v[72:75], v[20:23], 0
  v_mfma_f32_16x16x32_bf16 v[52:55], v[72:75], v[80:83], 0
  v_mfma_f32_16x16x32_bf16 v[56:59], v[72:75], v[84:87], 0
  v_mfma_f32_16x16x16_bf16 v[60:63], v[76:77], v[20:21], v[60:63]
  v_mfma_f32_16x16x16_bf16 v[52:55], v[78:79], v[66:67], v[52:55]
  s_nop 2
  v_mfma_f32_16x16x16_bf16 v[56:59], v[76:77], v[66:67], v[56:59]
  s_nop 7
  v_add_f32 v60, v60, v62
  v_add_f32 v61, v61, v63
  s_branch c_fbr_48
c_fail_49:
  s_endpgm
L_chdone:
  s_cmp_lg_u32 s91, 0
  s_cbranch_scc1 L_end
  s_lshr_b32 s91, s90, 4
  s_add_u32 s91, s91, 7
  v_lshrrev_b32 v0, 4, v0
  s_waitcnt vmcnt(0) lgkmcnt(0)
  s_branch L_o
L_qkv:
  s_mul_i32 s26, s91, 15
  s_add_u32 s26, s26, s90
  s_sub_u32 s26, s26, 61
  s_add_u32 s27, s91, 89
  s_cmp_eq_u32 s90, 31
  s_cselect_b32 s26, s27, s26
  s_add_u32 s27, s90, 60
  s_cmp_eq_u32 s91, 7
  s_cselect_b32 s26, s27, s26
  s_mul_i32 s16, s26, 171
  s_lshr_b32 s16, s16, 9
  s_mul_i32 s27, s16, 3
  s_sub_u32 s60, s26, s27
  s_add_u32 s16, s16, 4
  s_and_b32 s16, s16, 31
  v_and_b32 v19, 63, v0
  v_and_b32 v6, 15, v19
  v_lshrrev_b32 v7, 4, v19
  v_lshlrev_b32 v1, 2, v19
  v_lshlrev_b32 v0, 4, v19
  v_lshlrev_b32 v9, 7, v19
  s_mov_b32 s24, 0x3e0293ee
  s_lshl_b32 s57, s16, 2
  s_add_u32 s57, s57, s17
  v_and_b32 v24, 1, v7
  v_lshlrev_b32 v24, 10, v24
  v_lshl_add_u32 v24, v6, 4, v24
  v_lshrrev_b32 v25, 1, v7
  v_lshl_add_u32 v8, v25, 8, v24
  v_lshrrev_b32 v24, 9, v0
  v_lshlrev_b32 v24, 4, v24
  v_and_b32 v25, 0xf0, v0
  v_xor_b32 v24, v24, v25
  v_and_b32 v25, 0x1f0, v0
  v_lshl_add_u32 v24, v25, 6, v24
  v_xor_b32 v120, 0, v24
  v_xor_b32 v121, 32, v24
  v_xor_b32 v122, 64, v24
  v_xor_b32 v123, 96, v24
  v_xor_b32 v124, 128, v24
  v_xor_b32 v125, 160, v24
  v_xor_b32 v126, 192, v24
  v_xor_b32 v127, 224, v24
  s_and_b32 s26, s17, 1
  s_lshl_b32 s26, s26, 7
  v_xor_b32 v24, s26, v0
  v_xor_b32 v12, 0, v24
  v_xor_b32 v13, 16, v24
  v_xor_b32 v14, 32, v24
  v_xor_b32 v15, 48, v24
  v_xor_b32 v16, 64, v24
  v_xor_b32 v17, 80, v24
  v_xor_b32 v18, 96, v24
  v_xor_b32 v19, 112, v24
  s_lshl_b32 s26, s17, 2
  s_add_u32 s26, s26, 162816
  v_lshrrev_b32 v24, 7, v0
  v_lshl_add_u32 v118, v24, 4, s26
  v_and_b32 v24, 48, v0
  v_add_u32 v119, 162816, v24
  v_lshrrev_b32 v25, 8, v0
  v_and_b32 v20, 0xf0, v0
  v_lshlrev_b32 v21, 6, v25
  v_xor_b32 v20, v20, v21
  v_lshl_add_u32 v20, v25, 13, v20
  v_xor_b32 v21, 32, v20
  s_load_dwordx2 s[64:65], s[0:1], 24
  s_load_dwordx2 s[68:69], s[0:1], 32
  s_load_dwordx2 s[8:9], s[0:1], 16
  s_mov_b32 s10, 4194304
  s_mov_b32 s11, 0x20000
  s_mov_b32 s66, 4194304
  s_mov_b32 s67, 0x20000
  s_mov_b32 s70, 4194304
  s_mov_b32 s71, 0x20000
  v_lshrrev_b32 v25, 2, v6
  v_lshrrev_b32 v26, 1, v7
  v_lshl_add_u32 v27, v26, 3, v25
  v_lshlrev_b32 v27, 8, v27
  v_lshl_add_u32 v26, v25, 1, v26
  v_and_b32 v25, 1, v7
  v_xor_b32 v26, v26, v25
  s_lshl_b32 s26, s17, 1
  v_xor_b32 v26, s26, v26
  v_lshl_add_u32 v27, v26, 5, v27
  v_and_b32 v25, 3, v6
  v_lshl_add_u32 v22, v25, 3, v27
  v_add_u32 v23, 65536, v22
  v_add_u32 v24, 131072, v22
  s_lshl_b32 s28, s17, 13
  s_lshl_b32 s26, s17, 18
  s_lshl_b32 s27, s16, 8
  s_add_u32 s26, s26, s27
  s_waitcnt lgkmcnt(0)
  s_cmp_eq_u32 s60, 1
  s_cbranch_scc1 q_ld_79
  s_cmp_eq_u32 s60, 2
  s_cbranch_scc1 q_ld_80
q_ld_78:
  s_add_u32 s27, s26, 0
  s_add_u32 m0, s28, 0
  s_nop 0
  buffer_load_dwordx4 v20, s[64:67], s27 offen lds
  s_add_u32 m0, s28, 1024
  s_add_u32 s27, s27, 32768
  buffer_load_dwordx4 v20, s[64:67], s27 offen lds
  s_add_u32 m0, s28, 2048
  s_add_u32 s27, s27, 32768
  buffer_load_dwordx4 v21, s[64:67], s27 offen lds
  s_add_u32 m0, s28, 3072
  s_add_u32 s27, s27, 32768
  buffer_load_dwordx4 v21, s[64:67], s27 offen lds
  s_add_u32 m0, s28, 4096
  s_add_u32 s27, s27, 32768
  buffer_load_dwordx4 v20, s[64:67], s27 offen lds
  s_add_u32 m0, s28, 5120
  s_add_u32 s27, s27, 32768
  buffer_load_dwordx4 v20, s[64:67], s27 offen lds
  s_add_u32 m0, s28, 6144
  s_add_u32 s27, s27, 32768
  buffer_load_dwordx4 v21, s[64:67], s27 offen lds
  s_add_u32 m0, s28, 7168
  s_add_u32 s27, s27, 32768
  buffer_load_dwordx4 v21, s[64:67], s27 offen lds
  s_add_u32 s27, s26, 1048576
  s_add_u32 m0, s28, 32768
  s_nop 0
  buffer_load_dwordx4 v20, s[64:67], s27 offen lds
  s_add_u32 m0, s28, 33792
  s_add_u32 s27, s27, 32768
  buffer_load_dwordx4 v20, s[64:67], s27 offen lds
  s_add_u32 m0, s28, 34816
  s_add_u32 s27, s27, 32768
  buffer_load_dwordx4 v21, s[64:67], s27 offen lds
  s_add_u32 m0, s28, 35840
  s_add_u32 s27, s27, 32768
  buffer_load_dwordx4 v21, s[64:67], s27 offen lds
  s_add_u32 m0, s28, 36864
  s_add_u32 s27, s27, 32768
  buffer_load_dwordx4 v20, s[64:67], s27 offen lds
  s_add_u32 m0, s28, 37888
  s_add_u32 s27, s27, 32768
  buffer_load_dwordx4 v20, s[64:67], s27 offen lds
  s_add_u32 m0, s28, 38912
  s_add_u32 s27, s27, 32768
  buffer_load_dwordx4 v21, s[64:67], s27 offen lds
  s_add_u32 m0, s28, 39936
  s_add_u32 s27, s27, 32768
  buffer_load_dwordx4 v21, s[64:67], s27 offen lds
  s_add_u32 s27, s26, 2097152
  s_add_u32 m0, s28, 65536
  s_nop 0
  buffer_load_dwordx4 v20, s[64:67], s27 offen lds
  s_add_u32 m0, s28, 66560
  s_add_u32 s27, s27, 32768
  buffer_load_dwordx4 v20, s[64:67], s27 offen lds
  s_add_u32 m0, s28, 67584
  s_add_u32 s27, s27, 32768
  buffer_load_dwordx4 v21, s[64:67], s27 offen lds
  s_add_u32 m0, s28, 68608
  s_add_u32 s27, s27, 32768
  buffer_load_dwordx4 v21, s[64:67], s27 offen lds
  s_add_u32 m0, s28, 69632
  s_add_u32 s27, s27, 32768
  buffer_load_dwordx4 v20, s[64:67], s27 offen lds
  s_add_u32 m0, s28, 70656
  s_add_u32 s27, s27, 32768
  buffer_load_dwordx4 v20, s[64:67], s27 offen lds
  s_add_u32 m0, s28, 71680
  s_add_u32 s27, s27, 32768
  buffer_load_dwordx4 v21, s[64:67], s27 offen lds
  s_add_u32 m0, s28, 72704
  s_add_u32 s27, s27, 32768
  buffer_load_dwordx4 v21, s[64:67], s27 offen lds
  s_load_dwordx2 s[4:5], s[0:1], 112
  s_load_dwordx2 s[12:13], s[0:1], 104
  s_waitcnt vmcnt(16)
  s_barrier
  s_add_u32 s27, s26, 3145728
  s_add_u32 m0, s28, 98304
  s_nop 0
  buffer_load_dwordx4 v20, s[64:67], s27 offen lds
  s_add_u32 m0, s28, 99328
  s_add_u32 s27, s27, 32768
  buffer_load_dwordx4 v20, s[64:67], s27 offen lds
  s_add_u32 m0, s28, 100352
  s_add_u32 s27, s27, 32768
  buffer_load_dwordx4 v21, s[64:67], s27 offen lds
  s_add_u32 m0, s28, 101376
  s_add_u32 s27, s27, 32768
  buffer_load_dwordx4 v21, s[64:67], s27 offen lds
  s_add_u32 m0, s28, 102400
  s_add_u32 s27, s27, 32768
  buffer_load_dwordx4 v20, s[64:67], s27 offen lds
  s_add_u32 m0, s28, 103424
  s_add_u32 s27, s27, 32768
  buffer_load_dwordx4 v20, s[64:67], s27 offen lds
  s_add_u32 m0, s28, 104448
  s_add_u32 s27, s27, 32768
  buffer_load_dwordx4 v21, s[64:67], s27 offen lds
  s_add_u32 m0, s28, 105472
  s_add_u32 s27, s27, 32768
  buffer_load_dwordx4 v21, s[64:67], s27 offen lds
  ds_read_b64_tr_b16 v[128:129], v22 offset:0
  ds_read_b64_tr_b16 v[130:131], v22 offset:1024
  ds_read_b64_tr_b16 v[132:133], v22 offset:4096
  ds_read_b64_tr_b16 v[134:135], v22 offset:5120
  ds_read_b64_tr_b16 v[136:137], v22 offset:8192
  ds_read_b64_tr_b16 v[138:139], v22 offset:9216
  ds_read_b64_tr_b16 v[140:141], v22 offset:12288
  ds_read_b64_tr_b16 v[142:143], v22 offset:13312
  ds_read_b64_tr_b16 v[144:145], v22 offset:16384
  ds_read_b64_tr_b16 v[146:147], v22 offset:17408
  ds_read_b64_tr_b16 v[148:149], v22 offset:20480
  ds_read_b64_tr_b16 v[150:151], v22 offset:21504
  ds_read_b64_tr_b16 v[152:153], v22 offset:24576
  ds_read_b64_tr_b16 v[154:155], v22 offset:25600
  ds_read_b64_tr_b16 v[156:157], v22 offset:28672
  ds_read_b64_tr_b16 v[158:159], v22 offset:29696
  s_waitcnt lgkmcnt(0)
  s_waitcnt vmcnt(16)
  s_barrier
  s_add_u32 s27, s26, 0
  s_add_u32 m0, s28, 131072
  s_nop 0
  buffer_load_dwordx4 v20, s[68:71], s27 offen lds
  s_add_u32 m0, s28, 132096
  s_add_u32 s27, s27, 32768
  buffer_load_dwordx4 v20, s[68:71], s27 offen lds
  s_add_u32 m0, s28, 133120
  s_add_u32 s27, s27, 32768
  buffer_load_dwordx4 v21, s[68:71], s27 offen lds
  s_add_u32 m0, s28, 134144
  s_add_u32 s27, s27, 32768
  buffer_load_dwordx4 v21, s[68:71], s27 offen lds
  s_add_u32 m0, s28, 135168
  s_add_u32 s27, s27, 32768
  buffer_load_dwordx4 v20, s[68:71], s27 offen lds
  s_add_u32 m0, s28, 136192
  s_add_u32 s27, s27, 32768
  buffer_load_dwordx4 v20, s[68:71], s27 offen lds
  s_add_u32 m0, s28, 137216
  s_add_u32 s27, s27, 32768
  buffer_load_dwordx4 v21, s[68:71], s27 offen lds
  s_add_u32 m0, s28, 138240
  s_add_u32 s27, s27, 32768
  buffer_load_dwordx4 v21, s[68:71], s27 offen lds
  ds_read_b64_tr_b16 v[160:161], v22 offset:32768
  ds_read_b64_tr_b16 v[162:163], v22 offset:33792
  ds_read_b64_tr_b16 v[164:165], v22 offset:36864
  ds_read_b64_tr_b16 v[166:167], v22 offset:37888
  ds_read_b64_tr_b16 v[168:169], v22 offset:40960
  ds_read_b64_tr_b16 v[170:171], v22 offset:41984
  ds_read_b64_tr_b16 v[172:173], v22 offset:45056
  ds_read_b64_tr_b16 v[174:175], v22 offset:46080
  ds_read_b64_tr_b16 v[176:177], v22 offset:49152
  ds_read_b64_tr_b16 v[178:179], v22 offset:50176
  ds_read_b64_tr_b16 v[180:181], v22 offset:53248
  ds_read_b64_tr_b16 v[182:183], v22 offset:54272
  ds_read_b64_tr_b16 v[184:185], v22 offset:57344
  ds_read_b64_tr_b16 v[186:187], v22 offset:58368
  ds_read_b64_tr_b16 v[188:189], v22 offset:61440
  ds_read_b64_tr_b16 v[190:191], v22 offset:62464
  s_waitcnt lgkmcnt(0)
  s_waitcnt vmcnt(16)
  s_barrier
  s_add_u32 s27, s26, 1048576
  s_add_u32 m0, s28, 0
  s_nop 0
  buffer_load_dwordx4 v20, s[68:71], s27 offen lds
  s_add_u32 m0, s28, 1024
  s_add_u32 s27, s27, 32768
  buffer_load_dwordx4 v20, s[68:71], s27 offen lds
  s_add_u32 m0, s28, 2048
  s_add_u32 s27, s27, 32768
  buffer_load_dwordx4 v21, s[68:71], s27 offen lds
  s_add_u32 m0, s28, 3072
  s_add_u32 s27, s27, 32768
  buffer_load_dwordx4 v21, s[68:71], s27 offen lds
  s_add_u32 m0, s28, 4096
  s_add_u32 s27, s27, 32768
  buffer_load_dwordx4 v20, s[68:71], s27 offen lds
  s_add_u32 m0, s28, 5120
  s_add_u32 s27, s27, 32768
  buffer_load_dwordx4 v20, s[68:71], s27 offen lds
  s_add_u32 m0, s28, 6144
  s_add_u32 s27, s27, 32768
  buffer_load_dwordx4 v21, s[68:71], s27 offen lds
  s_add_u32 m0, s28, 7168
  s_add_u32 s27, s27, 32768
  buffer_load_dwordx4 v21, s[68:71], s27 offen lds
  ds_read_b64_tr_b16 v[192:193], v23 offset:0
  ds_read_b64_tr_b16 v[194:195], v23 offset:1024
  ds_read_b64_tr_b16 v[196:197], v23 offset:4096
  ds_read_b64_tr_b16 v[198:199], v23 offset:5120
  ds_read_b64_tr_b16 v[200:201], v23 offset:8192
  ds_read_b64_tr_b16 v[202:203], v23 offset:9216
  ds_read_b64_tr_b16 v[204:205], v23 offset:12288
  ds_read_b64_tr_b16 v[206:207], v23 offset:13312
  ds_read_b64_tr_b16 v[208:209], v23 offset:16384
  ds_read_b64_tr_b16 v[210:211], v23 offset:17408
  ds_read_b64_tr_b16 v[212:213], v23 offset:20480
  ds_read_b64_tr_b16 v[214:215], v23 offset:21504
  ds_read_b64_tr_b16 v[216:217], v23 offset:24576
  ds_read_b64_tr_b16 v[218:219], v23 offset:25600
  ds_read_b64_tr_b16 v[220:221], v23 offset:28672
  ds_read_b64_tr_b16 v[222:223], v23 offset:29696
  s_waitcnt lgkmcnt(0)
  s_waitcnt vmcnt(16)
  s_barrier
  s_add_u32 s27, s26, 2097152
  s_add_u32 m0, s28, 32768
  s_nop 0
  buffer_load_dwordx4 v20, s[68:71], s27 offen lds
  s_add_u32 m0, s28, 33792
  s_add_u32 s27, s27, 32768
  buffer_load_dwordx4 v20, s[68:71], s27 offen lds
  s_add_u32 m0, s28, 34816
  s_add_u32 s27, s27, 32768
  buffer_load_dwordx4 v21, s[68:71], s27 offen lds
  s_add_u32 m0, s28, 35840
  s_add_u32 s27, s27, 32768
  buffer_load_dwordx4 v21, s[68:71], s27 offen lds
  s_add_u32 m0, s28, 36864
  s_add_u32 s27, s27, 32768
  buffer_load_dwordx4 v20, s[68:71], s27 offen lds
  s_add_u32 m0, s28, 37888
  s_add_u32 s27, s27, 32768
  buffer_load_dwordx4 v20, s[68:71], s27 offen lds
  s_add_u32 m0, s28, 38912
  s_add_u32 s27, s27, 32768
  buffer_load_dwordx4 v21, s[68:71], s27 offen lds
  s_add_u32 m0, s28, 39936
  s_add_u32 s27, s27, 32768
  buffer_load_dwordx4 v21, s[68:71], s27 offen lds
  ds_read_b64_tr_b16 v[224:225], v23 offset:32768
  ds_read_b64_tr_b16 v[226:227], v23 offset:33792
  ds_read_b64_tr_b16 v[228:229], v23 offset:36864
  ds_read_b64_tr_b16 v[230:231], v23 offset:37888
  ds_read_b64_tr_b16 v[232:233], v23 offset:40960
  ds_read_b64_tr_b16 v[234:235], v23 offset:41984
  ds_read_b64_tr_b16 v[236:237], v23 offset:45056
  ds_read_b64_tr_b16 v[238:239], v23 offset:46080
  ds_read_b64_tr_b16 v[240:241], v23 offset:49152
  ds_read_b64_tr_b16 v[242:243], v23 offset:50176
  ds_read_b64_tr_b16 v[244:245], v23 offset:53248
  ds_read_b64_tr_b16 v[246:247], v23 offset:54272
  ds_read_b64_tr_b16 v[248:249], v23 offset:57344
  ds_read_b64_tr_b16 v[250:251], v23 offset:58368
  ds_read_b64_tr_b16 v[252:253], v23 offset:61440
  ds_read_b64_tr_b16 v[254:255], v23 offset:62464
  s_waitcnt lgkmcnt(0)
  s_waitcnt vmcnt(16)
  s_barrier
  s_add_u32 s27, s26, 3145728
  s_add_u32 m0, s28, 65536
  s_nop 0
  buffer_load_dwordx4 v20, s[68:71], s27 offen lds
  s_add_u32 m0, s28, 66560
  s_add_u32 s27, s27, 32768
  buffer_load_dwordx4 v20, s[68:71], s27 offen lds
  s_add_u32 m0, s28, 67584
  s_add_u32 s27, s27, 32768
  buffer_load_dwordx4 v21, s[68:71], s27 offen lds
  s_add_u32 m0, s28, 68608
  s_add_u32 s27, s27, 32768
  buffer_load_dwordx4 v21, s[68:71], s27 offen lds
  s_add_u32 m0, s28, 69632
  s_add_u32 s27, s27, 32768
  buffer_load_dwordx4 v20, s[68:71], s27 offen lds
  s_add_u32 m0, s28, 70656
  s_add_u32 s27, s27, 32768
  buffer_load_dwordx4 v20, s[68:71], s27 offen lds
  s_add_u32 m0, s28, 71680
  s_add_u32 s27, s27, 32768
  buffer_load_dwordx4 v21, s[68:71], s27 offen lds
  s_add_u32 m0, s28, 72704
  s_add_u32 s27, s27, 32768
  buffer_load_dwordx4 v21, s[68:71], s27 offen lds
  ds_read_b64_tr_b16 a[0:1], v24 offset:0
  ds_read_b64_tr_b16 a[2:3], v24 offset:1024
  ds_read_b64_tr_b16 a[4:5], v24 offset:4096
  ds_read_b64_tr_b16 a[6:7], v24 offset:5120
  ds_read_b64_tr_b16 a[8:9], v24 offset:8192
  ds_read_b64_tr_b16 a[10:11], v24 offset:9216
  ds_read_b64_tr_b16 a[12:13], v24 offset:12288
  ds_read_b64_tr_b16 a[14:15], v24 offset:13312
  ds_read_b64_tr_b16 a[16:17], v24 offset:16384
  ds_read_b64_tr_b16 a[18:19], v24 offset:17408
  ds_read_b64_tr_b16 a[20:21], v24 offset:20480
  ds_read_b64_tr_b16 a[22:23], v24 offset:21504
  ds_read_b64_tr_b16 a[24:25], v24 offset:24576
  ds_read_b64_tr_b16 a[26:27], v24 offset:25600
  ds_read_b64_tr_b16 a[28:29], v24 offset:28672
  ds_read_b64_tr_b16 a[30:31], v24 offset:29696
  s_waitcnt lgkmcnt(0)
  s_waitcnt vmcnt(16)
  s_barrier
  s_add_u32 s27, s26, 0
  s_add_u32 m0, s28, 98304
  s_nop 0
  buffer_load_dwordx4 v20, s[8:11], s27 offen lds
  s_add_u32 m0, s28, 99328
  s_add_u32 s27, s27, 32768
  buffer_load_dwordx4 v20, s[8:11], s27 offen lds
  s_add_u32 m0, s28, 100352
  s_add_u32 s27, s27, 32768
  buffer_load_dwordx4 v21, s[8:11], s27 offen lds
  s_add_u32 m0, s28, 101376
  s_add_u32 s27, s27, 32768
  buffer_load_dwordx4 v21, s[8:11], s27 offen lds
  s_add_u32 m0, s28, 102400
  s_add_u32 s27, s27, 32768
  buffer_load_dwordx4 v20, s[8:11], s27 offen lds
  s_add_u32 m0, s28, 103424
  s_add_u32 s27, s27, 32768
  buffer_load_dwordx4 v20, s[8:11], s27 offen lds
  s_add_u32 m0, s28, 104448
  s_add_u32 s27, s27, 32768
  buffer_load_dwordx4 v21, s[8:11], s27 offen lds
  s_add_u32 m0, s28, 105472
  s_add_u32 s27, s27, 32768
  buffer_load_dwordx4 v21, s[8:11], s27 offen lds
  ds_read_b64_tr_b16 a[32:33], v22 offset:0
  ds_read_b64_tr_b16 a[34:35], v22 offset:1024
  ds_read_b64_tr_b16 a[36:37], v22 offset:4096
  ds_read_b64_tr_b16 a[38:39], v22 offset:5120
  ds_read_b64_tr_b16 a[40:41], v22 offset:8192
  ds_read_b64_tr_b16 a[42:43], v22 offset:9216
  ds_read_b64_tr_b16 a[44:45], v22 offset:12288
  ds_read_b64_tr_b16 a[46:47], v22 offset:13312
  ds_read_b64_tr_b16 a[48:49], v22 offset:16384
  ds_read_b64_tr_b16 a[50:51], v22 offset:17408
  ds_read_b64_tr_b16 a[52:53], v22 offset:20480
  ds_read_b64_tr_b16 a[54:55], v22 offset:21504
  ds_read_b64_tr_b16 a[56:57], v22 offset:24576
  ds_read_b64_tr_b16 a[58:59], v22 offset:25600
  ds_read_b64_tr_b16 a[60:61], v22 offset:28672
  ds_read_b64_tr_b16 a[62:63], v22 offset:29696
  s_waitcnt lgkmcnt(0)
  s_waitcnt vmcnt(16)
  s_barrier
  s_add_u32 s27, s26, 1048576
  s_add_u32 m0, s28, 131072
  s_nop 0
  buffer_load_dwordx4 v20, s[8:11], s27 offen lds
  s_add_u32 m0, s28, 132096
  s_add_u32 s27, s27, 32768
  buffer_load_dwordx4 v20, s[8:11], s27 offen lds
  s_add_u32 m0, s28, 133120
  s_add_u32 s27, s27, 32768
  buffer_load_dwordx4 v21, s[8:11], s27 offen lds
  s_add_u32 m0, s28, 134144
  s_add_u32 s27, s27, 32768
  buffer_load_dwordx4 v21, s[8:11], s27 offen lds
  s_add_u32 m0, s28, 135168
  s_add_u32 s27, s27, 32768
  buffer_load_dwordx4 v20, s[8:11], s27 offen lds
  s_add_u32 m0, s28, 136192
  s_add_u32 s27, s27, 32768
  buffer_load_dwordx4 v20, s[8:11], s27 offen lds
  s_add_u32 m0, s28, 137216
  s_add_u32 s27, s27, 32768
  buffer_load_dwordx4 v21, s[8:11], s27 offen lds
  s_add_u32 m0, s28, 138240
  s_add_u32 s27, s27, 32768
  buffer_load_dwordx4 v21, s[8:11], s27 offen lds
  ds_read_b64_tr_b16 a[64:65], v22 offset:32768
  ds_read_b64_tr_b16 a[66:67], v22 offset:33792
  ds_read_b64_tr_b16 a[68:69], v22 offset:36864
  ds_read_b64_tr_b16 a[70:71], v22 offset:37888
  ds_read_b64_tr_b16 a[72:73], v22 offset:40960
  ds_read_b64_tr_b16 a[74:75], v22 offset:41984
  ds_read_b64_tr_b16 a[76:77], v22 offset:45056
  ds_read_b64_tr_b16 a[78:79], v22 offset:46080
  ds_read_b64_tr_b16 a[80:81], v22 offset:49152
  ds_read_b64_tr_b16 a[82:83], v22 offset:50176
  ds_read_b64_tr_b16 a[84:85], v22 offset:53248
  ds_read_b64_tr_b16 a[86:87], v22 offset:54272
  ds_read_b64_tr_b16 a[88:89], v22 offset:57344
  ds_read_b64_tr_b16 a[90:91], v22 offset:58368
  ds_read_b64_tr_b16 a[92:93], v22 offset:61440
  ds_read_b64_tr_b16 a[94:95], v22 offset:62464
  s_waitcnt lgkmcnt(0)
  s_waitcnt vmcnt(16)
  s_barrier
  s_add_u32 s27, s26, 2097152
  s_add_u32 m0, s28, 0
  s_nop 0
  buffer_load_dwordx4 v20, s[8:11], s27 offen lds
  s_add_u32 m0, s28, 1024
  s_add_u32 s27, s27, 32768
  buffer_load_dwordx4 v20, s[8:11], s27 offen lds
  s_add_u32 m0, s28, 2048
  s_add_u32 s27, s27, 32768
  buffer_load_dwordx4 v21, s[8:11], s27 offen lds
  s_add_u32 m0, s28, 3072
  s_add_u32 s27, s27, 32768
  buffer_load_dwordx4 v21, s[8:11], s27 offen lds
  s_add_u32 m0, s28, 4096
  s_add_u32 s27, s27, 32768
  buffer_load_dwordx4 v20, s[8:11], s27 offen lds
  s_add_u32 m0, s28, 5120
  s_add_u32 s27, s27, 32768
  buffer_load_dwordx4 v20, s[8:11], s27 offen lds
  s_add_u32 m0, s28, 6144
  s_add_u32 s27, s27, 32768
  buffer_load_dwordx4 v21, s[8:11], s27 offen lds
  s_add_u32 m0, s28, 7168
  s_add_u32 s27, s27, 32768
  buffer_load_dwordx4 v21, s[8:11], s27 offen lds
  ds_read_b64_tr_b16 a[96:97], v23 offset:0
  ds_read_b64_tr_b16 a[98:99], v23 offset:1024
  ds_read_b64_tr_b16 a[100:101], v23 offset:4096
  ds_read_b64_tr_b16 a[102:103], v23 offset:5120
  ds_read_b64_tr_b16 a[104:105], v23 offset:8192
  ds_read_b64_tr_b16 a[106:107], v23 offset:9216
  ds_read_b64_tr_b16 a[108:109], v23 offset:12288
  ds_read_b64_tr_b16 a[110:111], v23 offset:13312
  ds_read_b64_tr_b16 a[112:113], v23 offset:16384
  ds_read_b64_tr_b16 a[114:115], v23 offset:17408
  ds_read_b64_tr_b16 a[116:117], v23 offset:20480
  ds_read_b64_tr_b16 a[118:119], v23 offset:21504
  ds_read_b64_tr_b16 a[120:121], v23 offset:24576
  ds_read_b64_tr_b16 a[122:123], v23 offset:25600
  ds_read_b64_tr_b16 a[124:125], v23 offset:28672
  ds_read_b64_tr_b16 a[126:127], v23 offset:29696
  s_waitcnt lgkmcnt(0)
  s_waitcnt vmcnt(16)
  s_barrier
  s_add_u32 s27, s26, 3145728
  s_add_u32 m0, s28, 32768
  s_nop 0
  buffer_load_dwordx4 v20, s[8:11], s27 offen lds
  s_add_u32 m0, s28, 33792
  s_add_u32 s27, s27, 32768
  buffer_load_dwordx4 v20, s[8:11], s27 offen lds
  s_add_u32 m0, s28, 34816
  s_add_u32 s27, s27, 32768
  buffer_load_dwordx4 v21, s[8:11], s27 offen lds
  s_add_u32 m0, s28, 35840
  s_add_u32 s27, s27, 32768
  buffer_load_dwordx4 v21, s[8:11], s27 offen lds
  s_add_u32 m0, s28, 36864
  s_add_u32 s27, s27, 32768
  buffer_load_dwordx4 v20, s[8:11], s27 offen lds
  s_add_u32 m0, s28, 37888
  s_add_u32 s27, s27, 32768
  buffer_load_dwordx4 v20, s[8:11], s27 offen lds
  s_add_u32 m0, s28, 38912
  s_add_u32 s27, s27, 32768
  buffer_load_dwordx4 v21, s[8:11], s27 offen lds
  s_add_u32 m0, s28, 39936
  s_add_u32 s27, s27, 32768
  buffer_load_dwordx4 v21, s[8:11], s27 offen lds
  ds_read_b64_tr_b16 a[128:129], v23 offset:32768
  ds_read_b64_tr_b16 a[130:131], v23 offset:33792
  ds_read_b64_tr_b16 a[132:133], v23 offset:36864
  ds_read_b64_tr_b16 a[134:135], v23 offset:37888
  ds_read_b64_tr_b16 a[136:137], v23 offset:40960
  ds_read_b64_tr_b16 a[138:139], v23 offset:41984
  ds_read_b64_tr_b16 a[140:141], v23 offset:45056
  ds_read_b64_tr_b16 a[142:143], v23 offset:46080
  ds_read_b64_tr_b16 a[144:145], v23 offset:49152
  ds_read_b64_tr_b16 a[146:147], v23 offset:50176
  ds_read_b64_tr_b16 a[148:149], v23 offset:53248
  ds_read_b64_tr_b16 a[150:151], v23 offset:54272
  ds_read_b64_tr_b16 a[152:153], v23 offset:57344
  ds_read_b64_tr_b16 a[154:155], v23 offset:58368
  ds_read_b64_tr_b16 a[156:157], v23 offset:61440
  ds_read_b64_tr_b16 a[158:159], v23 offset:62464
  s_waitcnt lgkmcnt(0)
  s_waitcnt vmcnt(16)
  s_barrier
  ds_read_b64_tr_b16 a[160:161], v24 offset:0
  ds_read_b64_tr_b16 a[162:163], v24 offset:1024
  ds_read_b64_tr_b16 a[164:165], v24 offset:4096
  ds_read_b64_tr_b16 a[166:167], v24 offset:5120
  ds_read_b64_tr_b16 a[168:169], v24 offset:8192
  ds_read_b64_tr_b16 a[170:171], v24 offset:9216
  ds_read_b64_tr_b16 a[172:173], v24 offset:12288
  ds_read_b64_tr_b16 a[174:175], v24 offset:13312
  ds_read_b64_tr_b16 a[176:177], v24 offset:16384
  ds_read_b64_tr_b16 a[178:179], v24 offset:17408
  ds_read_b64_tr_b16 a[180:181], v24 offset:20480
  ds_read_b64_tr_b16 a[182:183], v24 offset:21504
  ds_read_b64_tr_b16 a[184:185], v24 offset:24576
  ds_read_b64_tr_b16 a[186:187], v24 offset:25600
  ds_read_b64_tr_b16 a[188:189], v24 offset:28672
  ds_read_b64_tr_b16 a[190:191], v24 offset:29696
  s_waitcnt lgkmcnt(0)
  s_waitcnt vmcnt(8)
  s_barrier
  ds_read_b64_tr_b16 a[192:193], v22 offset:0
  ds_read_b64_tr_b16 a[194:195], v22 offset:1024
  ds_read_b64_tr_b16 a[196:197], v22 offset:4096
  ds_read_b64_tr_b16 a[198:199], v22 offset:5120
  ds_read_b64_tr_b16 a[200:201], v22 offset:8192
  ds_read_b64_tr_b16 a[202:203], v22 offset:9216
  ds_read_b64_tr_b16 a[204:205], v22 offset:12288
  ds_read_b64_tr_b16 a[206:207], v22 offset:13312
  ds_read_b64_tr_b16 a[208:209], v22 offset:16384
  ds_read_b64_tr_b16 a[210:211], v22 offset:17408
  ds_read_b64_tr_b16 a[212:213], v22 offset:20480
  ds_read_b64_tr_b16 a[214:215], v22 offset:21504
  ds_read_b64_tr_b16 a[216:217], v22 offset:24576
  ds_read_b64_tr_b16 a[218:219], v22 offset:25600
  ds_read_b64_tr_b16 a[220:221], v22 offset:28672
  ds_read_b64_tr_b16 a[222:223], v22 offset:29696
  s_waitcnt lgkmcnt(0)
  s_waitcnt vmcnt(0)
  s_barrier
  ds_read_b64_tr_b16 a[224:225], v22 offset:32768
  ds_read_b64_tr_b16 a[226:227], v22 offset:33792
  ds_read_b64_tr_b16 a[228:229], v22 offset:36864
  ds_read_b64_tr_b16 a[230:231], v22 offset:37888
  ds_read_b64_tr_b16 a[232:233], v22 offset:40960
  ds_read_b64_tr_b16 a[234:235], v22 offset:41984
  ds_read_b64_tr_b16 a[236:237], v22 offset:45056
  ds_read_b64_tr_b16 a[238:239], v22 offset:46080
  ds_read_b64_tr_b16 a[240:241], v22 offset:49152
  ds_read_b64_tr_b16 a[242:243], v22 offset:50176
  ds_read_b64_tr_b16 a[244:245], v22 offset:53248
  ds_read_b64_tr_b16 a[246:247], v22 offset:54272
  ds_read_b64_tr_b16 a[248:249], v22 offset:57344
  ds_read_b64_tr_b16 a[250:251], v22 offset:58368
  ds_read_b64_tr_b16 a[252:253], v22 offset:61440
  ds_read_b64_tr_b16 a[254:255], v22 offset:62464
  s_waitcnt lgkmcnt(0)
  s_branch q_ld_81
q_ld_79:
  s_add_u32 s27, s26, 0
  s_add_u32 m0, s28, 0
  s_nop 0
  buffer_load_dwordx4 v20, s[68:71], s27 offen lds
  s_add_u32 m0, s28, 1024
  s_add_u32 s27, s27, 32768
  buffer_load_dwordx4 v20, s[68:71], s27 offen lds
  s_add_u32 m0, s28, 2048
  s_add_u32 s27, s27, 32768
  buffer_load_dwordx4 v21, s[68:71], s27 offen lds
  s_add_u32 m0, s28, 3072
  s_add_u32 s27, s27, 32768
  buffer_load_dwordx4 v21, s[68:71], s27 offen lds
  s_add_u32 m0, s28, 4096
  s_add_u32 s27, s27, 32768
  buffer_load_dwordx4 v20, s[68:71], s27 offen lds
  s_add_u32 m0, s28, 5120
  s_add_u32 s27, s27, 32768
  buffer_load_dwordx4 v20, s[68:71], s27 offen lds
  s_add_u32 m0, s28, 6144
  s_add_u32 s27, s27, 32768
  buffer_load_dwordx4 v21, s[68:71], s27 offen lds
  s_add_u32 m0, s28, 7168
  s_add_u32 s27, s27, 32768
  buffer_load_dwordx4 v21, s[68:71], s27 offen lds
  s_add_u32 s27, s26, 1048576
  s_add_u32 m0, s28, 32768
  s_nop 0
  buffer_load_dwordx4 v20, s[68:71], s27 offen lds
  s_add_u32 m0, s28, 33792
  s_add_u32 s27, s27, 32768
  buffer_load_dwordx4 v20, s[68:71], s27 offen lds
  s_add_u32 m0, s28, 34816
  s_add_u32 s27, s27, 32768
  buffer_load_dwordx4 v21, s[68:71], s27 offen lds
  s_add_u32 m0, s28, 35840
  s_add_u32 s27, s27, 32768
  buffer_load_dwordx4 v21, s[68:71], s27 offen lds
  s_add_u32 m0, s28, 36864
  s_add_u32 s27, s27, 32768
  buffer_load_dwordx4 v20, s[68:71], s27 offen lds
  s_add_u32 m0, s28, 37888
  s_add_u32 s27, s27, 32768
  buffer_load_dwordx4 v20, s[68:71], s27 offen lds
  s_add_u32 m0, s28, 38912
  s_add_u32 s27, s27, 32768
  buffer_load_dwordx4 v21, s[68:71], s27 offen lds
  s_add_u32 m0, s28, 39936
  s_add_u32 s27, s27, 32768
  buffer_load_dwordx4 v21, s[68:71], s27 offen lds
  s_add_u32 s27, s26, 2097152
  s_add_u32 m0, s28, 65536
  s_nop 0
  buffer_load_dwordx4 v20, s[68:71], s27 offen lds
  s_add_u32 m0, s28, 66560
  s_add_u32 s27, s27, 32768
  buffer_load_dwordx4 v20, s[68:71], s27 offen lds
  s_add_u32 m0, s28, 67584
  s_add_u32 s27, s27, 32768
  buffer_load_dwordx4 v21, s[68:71], s27 offen lds
  s_add_u32 m0, s28, 68608
  s_add_u32 s27, s27, 32768
  buffer_load_dwordx4 v21, s[68:71], s27 offen lds
  s_add_u32 m0, s28, 69632
  s_add_u32 s27, s27, 32768
  buffer_load_dwordx4 v20, s[68:71], s27 offen lds
  s_add_u32 m0, s28, 70656
  s_add_u32 s27, s27, 32768
  buffer_load_dwordx4 v20, s[68:71], s27 offen lds
  s_add_u32 m0, s28, 71680
  s_add_u32 s27, s27, 32768
  buffer_load_dwordx4 v21, s[68:71], s27 offen lds
  s_add_u32 m0, s28, 72704
  s_add_u32 s27, s27, 32768
  buffer_load_dwordx4 v21, s[68:71], s27 offen lds
  s_load_dwordx2 s[4:5], s[0:1], 112
  s_load_dwordx2 s[12:13], s[0:1], 104
  s_waitcnt vmcnt(16)
  s_barrier
  s_add_u32 s27, s26, 3145728
  s_add_u32 m0, s28, 98304
  s_nop 0
  buffer_load_dwordx4 v20, s[68:71], s27 offen lds
  s_add_u32 m0, s28, 99328
  s_add_u32 s27, s27, 32768
  buffer_load_dwordx4 v20, s[68:71], s27 offen lds
  s_add_u32 m0, s28, 100352
  s_add_u32 s27, s27, 32768
  buffer_load_dwordx4 v21, s[68:71], s27 offen lds
  s_add_u32 m0, s28, 101376
  s_add_u32 s27, s27, 32768
  buffer_load_dwordx4 v21, s[68:71], s27 offen lds
  s_add_u32 m0, s28, 102400
  s_add_u32 s27, s27, 32768
  buffer_load_dwordx4 v20, s[68:71], s27 offen lds
  s_add_u32 m0, s28, 103424
  s_add_u32 s27, s27, 32768
  buffer_load_dwordx4 v20, s[68:71], s27 offen lds
  s_add_u32 m0, s28, 104448
  s_add_u32 s27, s27, 32768
  buffer_load_dwordx4 v21, s[68:71], s27 offen lds
  s_add_u32 m0, s28, 105472
  s_add_u32 s27, s27, 32768
  buffer_load_dwordx4 v21, s[68:71], s27 offen lds
  ds_read_b64_tr_b16 a[0:1], v22 offset:0
  ds_read_b64_tr_b16 a[2:3], v22 offset:1024
  ds_read_b64_tr_b16 a[4:5], v22 offset:4096
  ds_read_b64_tr_b16 a[6:7], v22 offset:5120
  ds_read_b64_tr_b16 a[8:9], v22 offset:8192
  ds_read_b64_tr_b16 a[10:11], v22 offset:9216
  ds_read_b64_tr_b16 a[12:13], v22 offset:12288
  ds_read_b64_tr_b16 a[14:15], v22 offset:13312
  ds_read_b64_tr_b16 a[16:17], v22 offset:16384
  ds_read_b64_tr_b16 a[18:19], v22 offset:17408
  ds_read_b64_tr_b16 a[20:21], v22 offset:20480
  ds_read_b64_tr_b16 a[22:23], v22 offset:21504
  ds_read_b64_tr_b16 a[24:25], v22 offset:24576
  ds_read_b64_tr_b16 a[26:27], v22 offset:25600
  ds_read_b64_tr_b16 a[28:29], v22 offset:28672
  ds_read_b64_tr_b16 a[30:31], v22 offset:29696
  s_waitcnt lgkmcnt(0)
  s_waitcnt vmcnt(16)
  s_barrier
  s_add_u32 s27, s26, 0
  s_add_u32 m0, s28, 131072
  s_nop 0
  buffer_load_dwordx4 v20, s[8:11], s27 offen lds
  s_add_u32 m0, s28, 132096
  s_add_u32 s27, s27, 32768
  buffer_load_dwordx4 v20, s[8:11], s27 offen lds
  s_add_u32 m0, s28, 133120
  s_add_u32 s27, s27, 32768
  buffer_load_dwordx4 v21, s[8:11], s27 offen lds
  s_add_u32 m0, s28, 134144
  s_add_u32 s27, s27, 32768
  buffer_load_dwordx4 v21, s[8:11], s27 offen lds
  s_add_u32 m0, s28, 135168
  s_add_u32 s27, s27, 32768
  buffer_load_dwordx4 v20, s[8:11], s27 offen lds
  s_add_u32 m0, s28, 136192
  s_add_u32 s27, s27, 32768
  buffer_load_dwordx4 v20, s[8:11], s27 offen lds
  s_add_u32 m0, s28, 137216
  s_add_u32 s27, s27, 32768
  buffer_load_dwordx4 v21, s[8:11], s27 offen lds
  s_add_u32 m0, s28, 138240
  s_add_u32 s27, s27, 32768
  buffer_load_dwordx4 v21, s[8:11], s27 offen lds
  ds_read_b64_tr_b16 a[32:33], v22 offset:32768
  ds_read_b64_tr_b16 a[34:35], v22 offset:33792
  ds_read_b64_tr_b16 a[36:37], v22 offset:36864
  ds_read_b64_tr_b16 a[38:39], v22 offset:37888
  ds_read_b64_tr_b16 a[40:41], v22 offset:40960
  ds_read_b64_tr_b16 a[42:43], v22 offset:41984
  ds_read_b64_tr_b16 a[44:45], v22 offset:45056
  ds_read_b64_tr_b16 a[46:47], v22 offset:46080
  ds_read_b64_tr_b16 a[48:49], v22 offset:49152
  ds_read_b64_tr_b16 a[50:51], v22 offset:50176
  ds_read_b64_tr_b16 a[52:53], v22 offset:53248
  ds_read_b64_tr_b16 a[54:55], v22 offset:54272
  ds_read_b64_tr_b16 a[56:57], v22 offset:57344
  ds_read_b64_tr_b16 a[58:59], v22 offset:58368
  ds_read_b64_tr_b16 a[60:61], v22 offset:61440
  ds_read_b64_tr_b16 a[62:63], v22 offset:62464
  s_waitcnt lgkmcnt(0)
  s_waitcnt vmcnt(16)
  s_barrier
  s_add_u32 s27, s26, 1048576
  s_add_u32 m0, s28, 0
  s_nop 0
  buffer_load_dwordx4 v20, s[8:11], s27 offen lds
  s_add_u32 m0, s28, 1024
  s_add_u32 s27, s27, 32768
  buffer_load_dwordx4 v20, s[8:11], s27 offen lds
  s_add_u32 m0, s28, 2048
  s_add_u32 s27, s27, 32768
  buffer_load_dwordx4 v21, s[8:11], s27 offen lds
  s_add_u32 m0, s28, 3072
  s_add_u32 s27, s27, 32768
  buffer_load_dwordx4 v21, s[8:11], s27 offen lds
  s_add_u32 m0, s28, 4096
  s_add_u32 s27, s27, 32768
  buffer_load_dwordx4 v20, s[8:11], s27 offen lds
  s_add_u32 m0, s28, 5120
  s_add_u32 s27, s27, 32768
  buffer_load_dwordx4 v20, s[8:11], s27 offen lds
  s_add_u32 m0, s28, 6144
  s_add_u32 s27, s27, 32768
  buffer_load_dwordx4 v21, s[8:11], s27 offen lds
  s_add_u32 m0, s28, 7168
  s_add_u32 s27, s27, 32768
  buffer_load_dwordx4 v21, s[8:11], s27 offen lds
  ds_read_b64_tr_b16 a[64:65], v23 offset:0
  ds_read_b64_tr_b16 a[66:67], v23 offset:1024
  ds_read_b64_tr_b16 a[68:69], v23 offset:4096
  ds_read_b64_tr_b16 a[70:71], v23 offset:5120
  ds_read_b64_tr_b16 a[72:73], v23 offset:8192
  ds_read_b64_tr_b16 a[74:75], v23 offset:9216
  ds_read_b64_tr_b16 a[76:77], v23 offset:12288
  ds_read_b64_tr_b16 a[78:79], v23 offset:13312
  ds_read_b64_tr_b16 a[80:81], v23 offset:16384
  ds_read_b64_tr_b16 a[82:83], v23 offset:17408
  ds_read_b64_tr_b16 a[84:85], v23 offset:20480
  ds_read_b64_tr_b16 a[86:87], v23 offset:21504
  ds_read_b64_tr_b16 a[88:89], v23 offset:24576
  ds_read_b64_tr_b16 a[90:91], v23 offset:25600
  ds_read_b64_tr_b16 a[92:93], v23 offset:28672
  ds_read_b64_tr_b16 a[94:95], v23 offset:29696
  s_waitcnt lgkmcnt(0)
  s_waitcnt vmcnt(16)
  s_barrier
  s_add_u32 s27, s26, 2097152
  s_add_u32 m0, s28, 32768
  s_nop 0
  buffer_load_dwordx4 v20, s[8:11], s27 offen lds
  s_add_u32 m0, s28, 33792
  s_add_u32 s27, s27, 32768
  buffer_load_dwordx4 v20, s[8:11], s27 offen lds
  s_add_u32 m0, s28, 34816
  s_add_u32 s27, s27, 32768
  buffer_load_dwordx4 v21, s[8:11], s27 offen lds
  s_add_u32 m0, s28, 35840
  s_add_u32 s27, s27, 32768
  buffer_load_dwordx4 v21, s[8:11], s27 offen lds
  s_add_u32 m0, s28, 36864
  s_add_u32 s27, s27, 32768
  buffer_load_dwordx4 v20, s[8:11], s27 offen lds
  s_add_u32 m0, s28, 37888
  s_add_u32 s27, s27, 32768
  buffer_load_dwordx4 v20, s[8:11], s27 offen lds
  s_add_u32 m0, s28, 38912
  s_add_u32 s27, s27, 32768
  buffer_load_dwordx4 v21, s[8:11], s27 offen lds
  s_add_u32 m0, s28, 39936
  s_add_u32 s27, s27, 32768
  buffer_load_dwordx4 v21, s[8:11], s27 offen lds
  ds_read_b64_tr_b16 a[96:97], v23 offset:32768
  ds_read_b64_tr_b16 a[98:99], v23 offset:33792
  ds_read_b64_tr_b16 a[100:101], v23 offset:36864
  ds_read_b64_tr_b16 a[102:103], v23 offset:37888
  ds_read_b64_tr_b16 a[104:105], v23 offset:40960
  ds_read_b64_tr_b16 a[106:107], v23 offset:41984
  ds_read_b64_tr_b16 a[108:109], v23 offset:45056
  ds_read_b64_tr_b16 a[110:111], v23 offset:46080
  ds_read_b64_tr_b16 a[112:113], v23 offset:49152
  ds_read_b64_tr_b16 a[114:115], v23 offset:50176
  ds_read_b64_tr_b16 a[116:117], v23 offset:53248
  ds_read_b64_tr_b16 a[118:119], v23 offset:54272
  ds_read_b64_tr_b16 a[120:121], v23 offset:57344
  ds_read_b64_tr_b16 a[122:123], v23 offset:58368
  ds_read_b64_tr_b16 a[124:125], v23 offset:61440
  ds_read_b64_tr_b16 a[126:127], v23 offset:62464
  s_waitcnt lgkmcnt(0)
  s_waitcnt vmcnt(16)
  s_barrier
  s_add_u32 s27, s26, 3145728
  s_add_u32 m0, s28, 65536
  s_nop 0
  buffer_load_dwordx4 v20, s[8:11], s27 offen lds
  s_add_u32 m0, s28, 66560
  s_add_u32 s27, s27, 32768
  buffer_load_dwordx4 v20, s[8:11], s27 offen lds
  s_add_u32 m0, s28, 67584
  s_add_u32 s27, s27, 32768
  buffer_load_dwordx4 v21, s[8:11], s27 offen lds
  s_add_u32 m0, s28, 68608
  s_add_u32 s27, s27, 32768
  buffer_load_dwordx4 v21, s[8:11], s27 offen lds
  s_add_u32 m0, s28, 69632
  s_add_u32 s27, s27, 32768
  buffer_load_dwordx4 v20, s[8:11], s27 offen lds
  s_add_u32 m0, s28, 70656
  s_add_u32 s27, s27, 32768
  buffer_load_dwordx4 v20, s[8:11], s27 offen lds
  s_add_u32 m0, s28, 71680
  s_add_u32 s27, s27, 32768
  buffer_load_dwordx4 v21, s[8:11], s27 offen lds
  s_add_u32 m0, s28, 72704
  s_add_u32 s27, s27, 32768
  buffer_load_dwordx4 v21, s[8:11], s27 offen lds
  ds_read_b64_tr_b16 a[128:129], v24 offset:0
  ds_read_b64_tr_b16 a[130:131], v24 offset:1024
  ds_read_b64_tr_b16 a[132:133], v24 offset:4096
  ds_read_b64_tr_b16 a[134:135], v24 offset:5120
  ds_read_b64_tr_b16 a[136:137], v24 offset:8192
  ds_read_b64_tr_b16 a[138:139], v24 offset:9216
  ds_read_b64_tr_b16 a[140:141], v24 offset:12288
  ds_read_b64_tr_b16 a[142:143], v24 offset:13312
  ds_read_b64_tr_b16 a[144:145], v24 offset:16384
  ds_read_b64_tr_b16 a[146:147], v24 offset:17408
  ds_read_b64_tr_b16 a[148:149], v24 offset:20480
  ds_read_b64_tr_b16 a[150:151], v24 offset:21504
  ds_read_b64_tr_b16 a[152:153], v24 offset:24576
  ds_read_b64_tr_b16 a[154:155], v24 offset:25600
  ds_read_b64_tr_b16 a[156:157], v24 offset:28672
  ds_read_b64_tr_b16 a[158:159], v24 offset:29696
  s_waitcnt lgkmcnt(0)
  s_waitcnt vmcnt(16)
  s_barrier
  s_add_u32 s27, s26, 0
  s_add_u32 m0, s28, 98304
  s_nop 0
  buffer_load_dwordx4 v20, s[64:67], s27 offen lds
  s_add_u32 m0, s28, 99328
  s_add_u32 s27, s27, 32768
  buffer_load_dwordx4 v20, s[64:67], s27 offen lds
  s_add_u32 m0, s28, 100352
  s_add_u32 s27, s27, 32768
  buffer_load_dwordx4 v21, s[64:67], s27 offen lds
  s_add_u32 m0, s28, 101376
  s_add_u32 s27, s27, 32768
  buffer_load_dwordx4 v21, s[64:67], s27 offen lds
  s_add_u32 m0, s28, 102400
  s_add_u32 s27, s27, 32768
  buffer_load_dwordx4 v20, s[64:67], s27 offen lds
  s_add_u32 m0, s28, 103424
  s_add_u32 s27, s27, 32768
  buffer_load_dwordx4 v20, s[64:67], s27 offen lds
  s_add_u32 m0, s28, 104448
  s_add_u32 s27, s27, 32768
  buffer_load_dwordx4 v21, s[64:67], s27 offen lds
  s_add_u32 m0, s28, 105472
  s_add_u32 s27, s27, 32768
  buffer_load_dwordx4 v21, s[64:67], s27 offen lds
  ds_read_b64_tr_b16 a[160:161], v22 offset:0
  ds_read_b64_tr_b16 a[162:163], v22 offset:1024
  ds_read_b64_tr_b16 a[164:165], v22 offset:4096
  ds_read_b64_tr_b16 a[166:167], v22 offset:5120
  ds_read_b64_tr_b16 a[168:169], v22 offset:8192
  ds_read_b64_tr_b16 a[170:171], v22 offset:9216
  ds_read_b64_tr_b16 a[172:173], v22 offset:12288
  ds_read_b64_tr_b16 a[174:175], v22 offset:13312
  ds_read_b64_tr_b16 a[176:177], v22 offset:16384
  ds_read_b64_tr_b16 a[178:179], v22 offset:17408
  ds_read_b64_tr_b16 a[180:181], v22 offset:20480
  ds_read_b64_tr_b16 a[182:183], v22 offset:21504
  ds_read_b64_tr_b16 a[184:185], v22 offset:24576
  ds_read_b64_tr_b16 a[186:187], v22 offset:25600
  ds_read_b64_tr_b16 a[188:189], v22 offset:28672
  ds_read_b64_tr_b16 a[190:191], v22 offset:29696
  s_waitcnt lgkmcnt(0)
  s_waitcnt vmcnt(16)
  s_barrier
  s_add_u32 s27, s26, 1048576
  s_add_u32 m0, s28, 131072
  s_nop 0
  buffer_load_dwordx4 v20, s[64:67], s27 offen lds
  s_add_u32 m0, s28, 132096
  s_add_u32 s27, s27, 32768
  buffer_load_dwordx4 v20, s[64:67], s27 offen lds
  s_add_u32 m0, s28, 133120
  s_add_u32 s27, s27, 32768
  buffer_load_dwordx4 v21, s[64:67], s27 offen lds
  s_add_u32 m0, s28, 134144
  s_add_u32 s27, s27, 32768
  buffer_load_dwordx4 v21, s[64:67], s27 offen lds
  s_add_u32 m0, s28, 135168
  s_add_u32 s27, s27, 32768
  buffer_load_dwordx4 v20, s[64:67], s27 offen lds
  s_add_u32 m0, s28, 136192
  s_add_u32 s27, s27, 32768
  buffer_load_dwordx4 v20, s[64:67], s27 offen lds
  s_add_u32 m0, s28, 137216
  s_add_u32 s27, s27, 32768
  buffer_load_dwordx4 v21, s[64:67], s27 offen lds
  s_add_u32 m0, s28, 138240
  s_add_u32 s27, s27, 32768
  buffer_load_dwordx4 v21, s[64:67], s27 offen lds
  ds_read_b64_tr_b16 a[192:193], v22 offset:32768
  ds_read_b64_tr_b16 a[194:195], v22 offset:33792
  ds_read_b64_tr_b16 a[196:197], v22 offset:36864
  ds_read_b64_tr_b16 a[198:199], v22 offset:37888
  ds_read_b64_tr_b16 a[200:201], v22 offset:40960
  ds_read_b64_tr_b16 a[202:203], v22 offset:41984
  ds_read_b64_tr_b16 a[204:205], v22 offset:45056
  ds_read_b64_tr_b16 a[206:207], v22 offset:46080
  ds_read_b64_tr_b16 a[208:209], v22 offset:49152
  ds_read_b64_tr_b16 a[210:211], v22 offset:50176
  ds_read_b64_tr_b16 a[212:213], v22 offset:53248
  ds_read_b64_tr_b16 a[214:215], v22 offset:54272
  ds_read_b64_tr_b16 a[216:217], v22 offset:57344
  ds_read_b64_tr_b16 a[218:219], v22 offset:58368
  ds_read_b64_tr_b16 a[220:221], v22 offset:61440
  ds_read_b64_tr_b16 a[222:223], v22 offset:62464
  s_waitcnt lgkmcnt(0)
  s_waitcnt vmcnt(16)
  s_barrier
  s_add_u32 s27, s26, 2097152
  s_add_u32 m0, s28, 0
  s_nop 0
  buffer_load_dwordx4 v20, s[64:67], s27 offen lds
  s_add_u32 m0, s28, 1024
  s_add_u32 s27, s27, 32768
  buffer_load_dwordx4 v20, s[64:67], s27 offen lds
  s_add_u32 m0, s28, 2048
  s_add_u32 s27, s27, 32768
  buffer_load_dwordx4 v21, s[64:67], s27 offen lds
  s_add_u32 m0, s28, 3072
  s_add_u32 s27, s27, 32768
  buffer_load_dwordx4 v21, s[64:67], s27 offen lds
  s_add_u32 m0, s28, 4096
  s_add_u32 s27, s27, 32768
  buffer_load_dwordx4 v20, s[64:67], s27 offen lds
  s_add_u32 m0, s28, 5120
  s_add_u32 s27, s27, 32768
  buffer_load_dwordx4 v20, s[64:67], s27 offen lds
  s_add_u32 m0, s28, 6144
  s_add_u32 s27, s27, 32768
  buffer_load_dwordx4 v21, s[64:67], s27 offen lds
  s_add_u32 m0, s28, 7168
  s_add_u32 s27, s27, 32768
  buffer_load_dwordx4 v21, s[64:67], s27 offen lds
  ds_read_b64_tr_b16 a[224:225], v23 offset:0
  ds_read_b64_tr_b16 a[226:227], v23 offset:1024
  ds_read_b64_tr_b16 a[228:229], v23 offset:4096
  ds_read_b64_tr_b16 a[230:231], v23 offset:5120
  ds_read_b64_tr_b16 a[232:233], v23 offset:8192
  ds_read_b64_tr_b16 a[234:235], v23 offset:9216
  ds_read_b64_tr_b16 a[236:237], v23 offset:12288
  ds_read_b64_tr_b16 a[238:239], v23 offset:13312
  ds_read_b64_tr_b16 a[240:241], v23 offset:16384
  ds_read_b64_tr_b16 a[242:243], v23 offset:17408
  ds_read_b64_tr_b16 a[244:245], v23 offset:20480
  ds_read_b64_tr_b16 a[246:247], v23 offset:21504
  ds_read_b64_tr_b16 a[248:249], v23 offset:24576
  ds_read_b64_tr_b16 a[250:251], v23 offset:25600
  ds_read_b64_tr_b16 a[252:253], v23 offset:28672
  ds_read_b64_tr_b16 a[254:255], v23 offset:29696
  s_waitcnt lgkmcnt(0)
  s_waitcnt vmcnt(16)
  s_barrier
  s_add_u32 s27, s26, 3145728
  s_add_u32 m0, s28, 32768
  s_nop 0
  buffer_load_dwordx4 v20, s[64:67], s27 offen lds
  s_add_u32 m0, s28, 33792
  s_add_u32 s27, s27, 32768
  buffer_load_dwordx4 v20, s[64:67], s27 offen lds
  s_add_u32 m0, s28, 34816
  s_add_u32 s27, s27, 32768
  buffer_load_dwordx4 v21, s[64:67], s27 offen lds
  s_add_u32 m0, s28, 35840
  s_add_u32 s27, s27, 32768
  buffer_load_dwordx4 v21, s[64:67], s27 offen lds
  s_add_u32 m0, s28, 36864
  s_add_u32 s27, s27, 32768
  buffer_load_dwordx4 v20, s[64:67], s27 offen lds
  s_add_u32 m0, s28, 37888
  s_add_u32 s27, s27, 32768
  buffer_load_dwordx4 v20, s[64:67], s27 offen lds
  s_add_u32 m0, s28, 38912
  s_add_u32 s27, s27, 32768
  buffer_load_dwordx4 v21, s[64:67], s27 offen lds
  s_add_u32 m0, s28, 39936
  s_add_u32 s27, s27, 32768
  buffer_load_dwordx4 v21, s[64:67], s27 offen lds
  ds_read_b64_tr_b16 v[128:129], v23 offset:32768
  ds_read_b64_tr_b16 v[130:131], v23 offset:33792
  ds_read_b64_tr_b16 v[132:133], v23 offset:36864
  ds_read_b64_tr_b16 v[134:135], v23 offset:37888
  ds_read_b64_tr_b16 v[136:137], v23 offset:40960
  ds_read_b64_tr_b16 v[138:139], v23 offset:41984
  ds_read_b64_tr_b16 v[140:141], v23 offset:45056
  ds_read_b64_tr_b16 v[142:143], v23 offset:46080
  ds_read_b64_tr_b16 v[144:145], v23 offset:49152
  ds_read_b64_tr_b16 v[146:147], v23 offset:50176
  ds_read_b64_tr_b16 v[148:149], v23 offset:53248
  ds_read_b64_tr_b16 v[150:151], v23 offset:54272
  ds_read_b64_tr_b16 v[152:153], v23 offset:57344
  ds_read_b64_tr_b16 v[154:155], v23 offset:58368
  ds_read_b64_tr_b16 v[156:157], v23 offset:61440
  ds_read_b64_tr_b16 v[158:159], v23 offset:62464
  s_waitcnt lgkmcnt(0)
  s_waitcnt vmcnt(16)
  s_barrier
  ds_read_b64_tr_b16 v[160:161], v24 offset:0
  ds_read_b64_tr_b16 v[162:163], v24 offset:1024
  ds_read_b64_tr_b16 v[164:165], v24 offset:4096
  ds_read_b64_tr_b16 v[166:167], v24 offset:5120
  ds_read_b64_tr_b16 v[168:169], v24 offset:8192
  ds_read_b64_tr_b16 v[170:171], v24 offset:9216
  ds_read_b64_tr_b16 v[172:173], v24 offset:12288
  ds_read_b64_tr_b16 v[174:175], v24 offset:13312
  ds_read_b64_tr_b16 v[176:177], v24 offset:16384
  ds_read_b64_tr_b16 v[178:179], v24 offset:17408
  ds_read_b64_tr_b16 v[180:181], v24 offset:20480
  ds_read_b64_tr_b16 v[182:183], v24 offset:21504
  ds_read_b64_tr_b16 v[184:185], v24 offset:24576
  ds_read_b64_tr_b16 v[186:187], v24 offset:25600
  ds_read_b64_tr_b16 v[188:189], v24 offset:28672
  ds_read_b64_tr_b16 v[190:191], v24 offset:29696
  s_waitcnt lgkmcnt(0)
  s_waitcnt vmcnt(8)
  s_barrier
  ds_read_b64_tr_b16 v[192:193], v22 offset:0
  ds_read_b64_tr_b16 v[194:195], v22 offset:1024
  ds_read_b64_tr_b16 v[196:197], v22 offset:4096
  ds_read_b64_tr_b16 v[198:199], v22 offset:5120
  ds_read_b64_tr_b16 v[200:201], v22 offset:8192
  ds_read_b64_tr_b16 v[202:203], v22 offset:9216
  ds_read_b64_tr_b16 v[204:205], v22 offset:12288
  ds_read_b64_tr_b16 v[206:207], v22 offset:13312
  ds_read_b64_tr_b16 v[208:209], v22 offset:16384
  ds_read_b64_tr_b16 v[210:211], v22 offset:17408
  ds_read_b64_tr_b16 v[212:213], v22 offset:20480
  ds_read_b64_tr_b16 v[214:215], v22 offset:21504
  ds_read_b64_tr_b16 v[216:217], v22 offset:24576
  ds_read_b64_tr_b16 v[218:219], v22 offset:25600
  ds_read_b64_tr_b16 v[220:221], v22 offset:28672
  ds_read_b64_tr_b16 v[222:223], v22 offset:29696
  s_waitcnt lgkmcnt(0)
  s_waitcnt vmcnt(0)
  s_barrier
  ds_read_b64_tr_b16 v[224:225], v22 offset:32768
  ds_read_b64_tr_b16 v[226:227], v22 offset:33792
  ds_read_b64_tr_b16 v[228:229], v22 offset:36864
  ds_read_b64_tr_b16 v[230:231], v22 offset:37888
  ds_read_b64_tr_b16 v[232:233], v22 offset:40960
  ds_read_b64_tr_b16 v[234:235], v22 offset:41984
  ds_read_b64_tr_b16 v[236:237], v22 offset:45056
  ds_read_b64_tr_b16 v[238:239], v22 offset:46080
  ds_read_b64_tr_b16 v[240:241], v22 offset:49152
  ds_read_b64_tr_b16 v[242:243], v22 offset:50176
  ds_read_b64_tr_b16 v[244:245], v22 offset:53248
  ds_read_b64_tr_b16 v[246:247], v22 offset:54272
  ds_read_b64_tr_b16 v[248:249], v22 offset:57344
  ds_read_b64_tr_b16 v[250:251], v22 offset:58368
  ds_read_b64_tr_b16 v[252:253], v22 offset:61440
  ds_read_b64_tr_b16 v[254:255], v22 offset:62464
  s_waitcnt lgkmcnt(0)
  s_branch q_ld_81
q_ld_80:
  s_add_u32 s27, s26, 0
  s_add_u32 m0, s28, 0
  s_nop 0
  buffer_load_dwordx4 v20, s[8:11], s27 offen lds
  s_add_u32 m0, s28, 1024
  s_add_u32 s27, s27, 32768
  buffer_load_dwordx4 v20, s[8:11], s27 offen lds
  s_add_u32 m0, s28, 2048
  s_add_u32 s27, s27, 32768
  buffer_load_dwordx4 v21, s[8:11], s27 offen lds
  s_add_u32 m0, s28, 3072
  s_add_u32 s27, s27, 32768
  buffer_load_dwordx4 v21, s[8:11], s27 offen lds
  s_add_u32 m0, s28, 4096
  s_add_u32 s27, s27, 32768
  buffer_load_dwordx4 v20, s[8:11], s27 offen lds
  s_add_u32 m0, s28, 5120
  s_add_u32 s27, s27, 32768
  buffer_load_dwordx4 v20, s[8:11], s27 offen lds
  s_add_u32 m0, s28, 6144
  s_add_u32 s27, s27, 32768
  buffer_load_dwordx4 v21, s[8:11], s27 offen lds
  s_add_u32 m0, s28, 7168
  s_add_u32 s27, s27, 32768
  buffer_load_dwordx4 v21, s[8:11], s27 offen lds
  s_add_u32 s27, s26, 1048576
  s_add_u32 m0, s28, 32768
  s_nop 0
  buffer_load_dwordx4 v20, s[8:11], s27 offen lds
  s_add_u32 m0, s28, 33792
  s_add_u32 s27, s27, 32768
  buffer_load_dwordx4 v20, s[8:11], s27 offen lds
  s_add_u32 m0, s28, 34816
  s_add_u32 s27, s27, 32768
  buffer_load_dwordx4 v21, s[8:11], s27 offen lds
  s_add_u32 m0, s28, 35840
  s_add_u32 s27, s27, 32768
  buffer_load_dwordx4 v21, s[8:11], s27 offen lds
  s_add_u32 m0, s28, 36864
  s_add_u32 s27, s27, 32768
  buffer_load_dwordx4 v20, s[8:11], s27 offen lds
  s_add_u32 m0, s28, 37888
  s_add_u32 s27, s27, 32768
  buffer_load_dwordx4 v20, s[8:11], s27 offen lds
  s_add_u32 m0, s28, 38912
  s_add_u32 s27, s27, 32768
  buffer_load_dwordx4 v21, s[8:11], s27 offen lds
  s_add_u32 m0, s28, 39936
  s_add_u32 s27, s27, 32768
  buffer_load_dwordx4 v21, s[8:11], s27 offen lds
  s_add_u32 s27, s26, 2097152
  s_add_u32 m0, s28, 65536
  s_nop 0
  buffer_load_dwordx4 v20, s[8:11], s27 offen lds
  s_add_u32 m0, s28, 66560
  s_add_u32 s27, s27, 32768
  buffer_load_dwordx4 v20, s[8:11], s27 offen lds
  s_add_u32 m0, s28, 67584
  s_add_u32 s27, s27, 32768
  buffer_load_dwordx4 v21, s[8:11], s27 offen lds
  s_add_u32 m0, s28, 68608
  s_add_u32 s27, s27, 32768
  buffer_load_dwordx4 v21, s[8:11], s27 offen lds
  s_add_u32 m0, s28, 69632
  s_add_u32 s27, s27, 32768
  buffer_load_dwordx4 v20, s[8:11], s27 offen lds
  s_add_u32 m0, s28, 70656
  s_add_u32 s27, s27, 32768
  buffer_load_dwordx4 v20, s[8:11], s27 offen lds
  s_add_u32 m0, s28, 71680
  s_add_u32 s27, s27, 32768
  buffer_load_dwordx4 v21, s[8:11], s27 offen lds
  s_add_u32 m0, s28, 72704
  s_add_u32 s27, s27, 32768
  buffer_load_dwordx4 v21, s[8:11], s27 offen lds
  s_load_dwordx2 s[4:5], s[0:1], 112
  s_load_dwordx2 s[12:13], s[0:1], 104
  s_waitcnt vmcnt(16)
  s_barrier
  s_add_u32 s27, s26, 3145728
  s_add_u32 m0, s28, 98304
  s_nop 0
  buffer_load_dwordx4 v20, s[8:11], s27 offen lds
  s_add_u32 m0, s28, 99328
  s_add_u32 s27, s27, 32768
  buffer_load_dwordx4 v20, s[8:11], s27 offen lds
  s_add_u32 m0, s28, 100352
  s_add_u32 s27, s27, 32768
  buffer_load_dwordx4 v21, s[8:11], s27 offen lds
  s_add_u32 m0, s28, 101376
  s_add_u32 s27, s27, 32768
  buffer_load_dwordx4 v21, s[8:11], s27 offen lds
  s_add_u32 m0, s28, 102400
  s_add_u32 s27, s27, 32768
  buffer_load_dwordx4 v20, s[8:11], s27 offen lds
  s_add_u32 m0, s28, 103424
  s_add_u32 s27, s27, 32768
  buffer_load_dwordx4 v20, s[8:11], s27 offen lds
  s_add_u32 m0, s28, 104448
  s_add_u32 s27, s27, 32768
  buffer_load_dwordx4 v21, s[8:11], s27 offen lds
  s_add_u32 m0, s28, 105472
  s_add_u32 s27, s27, 32768
  buffer_load_dwordx4 v21, s[8:11], s27 offen lds
  ds_read_b64_tr_b16 a[128:129], v22 offset:0
  ds_read_b64_tr_b16 a[130:131], v22 offset:1024
  ds_read_b64_tr_b16 a[132:133], v22 offset:4096
  ds_read_b64_tr_b16 a[134:135], v22 offset:5120
  ds_read_b64_tr_b16 a[136:137], v22 offset:8192
  ds_read_b64_tr_b16 a[138:139], v22 offset:9216
  ds_read_b64_tr_b16 a[140:141], v22 offset:12288
  ds_read_b64_tr_b16 a[142:143], v22 offset:13312
  ds_read_b64_tr_b16 a[144:145], v22 offset:16384
  ds_read_b64_tr_b16 a[146:147], v22 offset:17408
  ds_read_b64_tr_b16 a[148:149], v22 offset:20480
  ds_read_b64_tr_b16 a[150:151], v22 offset:21504
  ds_read_b64_tr_b16 a[152:153], v22 offset:24576
  ds_read_b64_tr_b16 a[154:155], v22 offset:25600
  ds_read_b64_tr_b16 a[156:157], v22 offset:28672
  ds_read_b64_tr_b16 a[158:159], v22 offset:29696
  s_waitcnt lgkmcnt(0)
  s_waitcnt vmcnt(16)
  s_barrier
  s_add_u32 s27, s26, 0
  s_add_u32 m0, s28, 131072
  s_nop 0
  buffer_load_dwordx4 v20, s[64:67], s27 offen lds
  s_add_u32 m0, s28, 132096
  s_add_u32 s27, s27, 32768
  buffer_load_dwordx4 v20, s[64:67], s27 offen lds
  s_add_u32 m0, s28, 133120
  s_add_u32 s27, s27, 32768
  buffer_load_dwordx4 v21, s[64:67], s27 offen lds
  s_add_u32 m0, s28, 134144
  s_add_u32 s27, s27, 32768
  buffer_load_dwordx4 v21, s[64:67], s27 offen lds
  s_add_u32 m0, s28, 135168
  s_add_u32 s27, s27, 32768
  buffer_load_dwordx4 v20, s[64:67], s27 offen lds
  s_add_u32 m0, s28, 136192
  s_add_u32 s27, s27, 32768
  buffer_load_dwordx4 v20, s[64:67], s27 offen lds
  s_add_u32 m0, s28, 137216
  s_add_u32 s27, s27, 32768
  buffer_load_dwordx4 v21, s[64:67], s27 offen lds
  s_add_u32 m0, s28, 138240
  s_add_u32 s27, s27, 32768
  buffer_load_dwordx4 v21, s[64:67], s27 offen lds
  ds_read_b64_tr_b16 a[160:161], v22 offset:32768
  ds_read_b64_tr_b16 a[162:163], v22 offset:33792
  ds_read_b64_tr_b16 a[164:165], v22 offset:36864
  ds_read_b64_tr_b16 a[166:167], v22 offset:37888
  ds_read_b64_tr_b16 a[168:169], v22 offset:40960
  ds_read_b64_tr_b16 a[170:171], v22 offset:41984
  ds_read_b64_tr_b16 a[172:173], v22 offset:45056
  ds_read_b64_tr_b16 a[174:175], v22 offset:46080
  ds_read_b64_tr_b16 a[176:177], v22 offset:49152
  ds_read_b64_tr_b16 a[178:179], v22 offset:50176
  ds_read_b64_tr_b16 a[180:181], v22 offset:53248
  ds_read_b64_tr_b16 a[182:183], v22 offset:54272
  ds_read_b64_tr_b16 a[184:185], v22 offset:57344
  ds_read_b64_tr_b16 a[186:187], v22 offset:58368
  ds_read_b64_tr_b16 a[188:189], v22 offset:61440
  ds_read_b64_tr_b16 a[190:191], v22 offset:62464
  s_waitcnt lgkmcnt(0)
  s_waitcnt vmcnt(16)
  s_barrier
  s_add_u32 s27, s26, 1048576
  s_add_u32 m0, s28, 0
  s_nop 0
  buffer_load_dwordx4 v20, s[64:67], s27 offen lds
  s_add_u32 m0, s28, 1024
  s_add_u32 s27, s27, 32768
  buffer_load_dwordx4 v20, s[64:67], s27 offen lds
  s_add_u32 m0, s28, 2048
  s_add_u32 s27, s27, 32768
  buffer_load_dwordx4 v21, s[64:67], s27 offen lds
  s_add_u32 m0, s28, 3072
  s_add_u32 s27, s27, 32768
  buffer_load_dwordx4 v21, s[64:67], s27 offen lds
  s_add_u32 m0, s28, 4096
  s_add_u32 s27, s27, 32768
  buffer_load_dwordx4 v20, s[64:67], s27 offen lds
  s_add_u32 m0, s28, 5120
  s_add_u32 s27, s27, 32768
  buffer_load_dwordx4 v20, s[64:67], s27 offen lds
  s_add_u32 m0, s28, 6144
  s_add_u32 s27, s27, 32768
  buffer_load_dwordx4 v21, s[64:67], s27 offen lds
  s_add_u32 m0, s28, 7168
  s_add_u32 s27, s27, 32768
  buffer_load_dwordx4 v21, s[64:67], s27 offen lds
  ds_read_b64_tr_b16 a[192:193], v23 offset:0
  ds_read_b64_tr_b16 a[194:195], v23 offset:1024
  ds_read_b64_tr_b16 a[196:197], v23 offset:4096
  ds_read_b64_tr_b16 a[198:199], v23 offset:5120
  ds_read_b64_tr_b16 a[200:201], v23 offset:8192
  ds_read_b64_tr_b16 a[202:203], v23 offset:9216
  ds_read_b64_tr_b16 a[204:205], v23 offset:12288
  ds_read_b64_tr_b16 a[206:207], v23 offset:13312
  ds_read_b64_tr_b16 a[208:209], v23 offset:16384
  ds_read_b64_tr_b16 a[210:211], v23 offset:17408
  ds_read_b64_tr_b16 a[212:213], v23 offset:20480
  ds_read_b64_tr_b16 a[214:215], v23 offset:21504
  ds_read_b64_tr_b16 a[216:217], v23 offset:24576
  ds_read_b64_tr_b16 a[218:219], v23 offset:25600
  ds_read_b64_tr_b16 a[220:221], v23 offset:28672
  ds_read_b64_tr_b16 a[222:223], v23 offset:29696
  s_waitcnt lgkmcnt(0)
  s_waitcnt vmcnt(16)
  s_barrier
  s_add_u32 s27, s26, 2097152
  s_add_u32 m0, s28, 32768
  s_nop 0
  buffer_load_dwordx4 v20, s[64:67], s27 offen lds
  s_add_u32 m0, s28, 33792
  s_add_u32 s27, s27, 32768
  buffer_load_dwordx4 v20, s[64:67], s27 offen lds
  s_add_u32 m0, s28, 34816
  s_add_u32 s27, s27, 32768
  buffer_load_dwordx4 v21, s[64:67], s27 offen lds
  s_add_u32 m0, s28, 35840
  s_add_u32 s27, s27, 32768
  buffer_load_dwordx4 v21, s[64:67], s27 offen lds
  s_add_u32 m0, s28, 36864
  s_add_u32 s27, s27, 32768
  buffer_load_dwordx4 v20, s[64:67], s27 offen lds
  s_add_u32 m0, s28, 37888
  s_add_u32 s27, s27, 32768
  buffer_load_dwordx4 v20, s[64:67], s27 offen lds
  s_add_u32 m0, s28, 38912
  s_add_u32 s27, s27, 32768
  buffer_load_dwordx4 v21, s[64:67], s27 offen lds
  s_add_u32 m0, s28, 39936
  s_add_u32 s27, s27, 32768
  buffer_load_dwordx4 v21, s[64:67], s27 offen lds
  ds_read_b64_tr_b16 a[224:225], v23 offset:32768
  ds_read_b64_tr_b16 a[226:227], v23 offset:33792
  ds_read_b64_tr_b16 a[228:229], v23 offset:36864
  ds_read_b64_tr_b16 a[230:231], v23 offset:37888
  ds_read_b64_tr_b16 a[232:233], v23 offset:40960
  ds_read_b64_tr_b16 a[234:235], v23 offset:41984
  ds_read_b64_tr_b16 a[236:237], v23 offset:45056
  ds_read_b64_tr_b16 a[238:239], v23 offset:46080
  ds_read_b64_tr_b16 a[240:241], v23 offset:49152
  ds_read_b64_tr_b16 a[242:243], v23 offset:50176
  ds_read_b64_tr_b16 a[244:245], v23 offset:53248
  ds_read_b64_tr_b16 a[246:247], v23 offset:54272
  ds_read_b64_tr_b16 a[248:249], v23 offset:57344
  ds_read_b64_tr_b16 a[250:251], v23 offset:58368
  ds_read_b64_tr_b16 a[252:253], v23 offset:61440
  ds_read_b64_tr_b16 a[254:255], v23 offset:62464
  s_waitcnt lgkmcnt(0)
  s_waitcnt vmcnt(16)
  s_barrier
  s_add_u32 s27, s26, 3145728
  s_add_u32 m0, s28, 65536
  s_nop 0
  buffer_load_dwordx4 v20, s[64:67], s27 offen lds
  s_add_u32 m0, s28, 66560
  s_add_u32 s27, s27, 32768
  buffer_load_dwordx4 v20, s[64:67], s27 offen lds
  s_add_u32 m0, s28, 67584
  s_add_u32 s27, s27, 32768
  buffer_load_dwordx4 v21, s[64:67], s27 offen lds
  s_add_u32 m0, s28, 68608
  s_add_u32 s27, s27, 32768
  buffer_load_dwordx4 v21, s[64:67], s27 offen lds
  s_add_u32 m0, s28, 69632
  s_add_u32 s27, s27, 32768
  buffer_load_dwordx4 v20, s[64:67], s27 offen lds
  s_add_u32 m0, s28, 70656
  s_add_u32 s27, s27, 32768
  buffer_load_dwordx4 v20, s[64:67], s27 offen lds
  s_add_u32 m0, s28, 71680
  s_add_u32 s27, s27, 32768
  buffer_load_dwordx4 v21, s[64:67], s27 offen lds
  s_add_u32 m0, s28, 72704
  s_add_u32 s27, s27, 32768
  buffer_load_dwordx4 v21, s[64:67], s27 offen lds
  ds_read_b64_tr_b16 v[128:129], v24 offset:0
  ds_read_b64_tr_b16 v[130:131], v24 offset:1024
  ds_read_b64_tr_b16 v[132:133], v24 offset:4096
  ds_read_b64_tr_b16 v[134:135], v24 offset:5120
  ds_read_b64_tr_b16 v[136:137], v24 offset:8192
  ds_read_b64_tr_b16 v[138:139], v24 offset:9216
  ds_read_b64_tr_b16 v[140:141], v24 offset:12288
  ds_read_b64_tr_b16 v[142:143], v24 offset:13312
  ds_read_b64_tr_b16 v[144:145], v24 offset:16384
  ds_read_b64_tr_b16 v[146:147], v24 offset:17408
  ds_read_b64_tr_b16 v[148:149], v24 offset:20480
  ds_read_b64_tr_b16 v[150:151], v24 offset:21504
  ds_read_b64_tr_b16 v[152:153], v24 offset:24576
  ds_read_b64_tr_b16 v[154:155], v24 offset:25600
  ds_read_b64_tr_b16 v[156:157], v24 offset:28672
  ds_read_b64_tr_b16 v[158:159], v24 offset:29696
  s_waitcnt lgkmcnt(0)
  s_waitcnt vmcnt(16)
  s_barrier
  s_add_u32 s27, s26, 0
  s_add_u32 m0, s28, 98304
  s_nop 0
  buffer_load_dwordx4 v20, s[68:71], s27 offen lds
  s_add_u32 m0, s28, 99328
  s_add_u32 s27, s27, 32768
  buffer_load_dwordx4 v20, s[68:71], s27 offen lds
  s_add_u32 m0, s28, 100352
  s_add_u32 s27, s27, 32768
  buffer_load_dwordx4 v21, s[68:71], s27 offen lds
  s_add_u32 m0, s28, 101376
  s_add_u32 s27, s27, 32768
  buffer_load_dwordx4 v21, s[68:71], s27 offen lds
  s_add_u32 m0, s28, 102400
  s_add_u32 s27, s27, 32768
  buffer_load_dwordx4 v20, s[68:71], s27 offen lds
  s_add_u32 m0, s28, 103424
  s_add_u32 s27, s27, 32768
  buffer_load_dwordx4 v20, s[68:71], s27 offen lds
  s_add_u32 m0, s28, 104448
  s_add_u32 s27, s27, 32768
  buffer_load_dwordx4 v21, s[68:71], s27 offen lds
  s_add_u32 m0, s28, 105472
  s_add_u32 s27, s27, 32768
  buffer_load_dwordx4 v21, s[68:71], s27 offen lds
  ds_read_b64_tr_b16 v[160:161], v22 offset:0
  ds_read_b64_tr_b16 v[162:163], v22 offset:1024
  ds_read_b64_tr_b16 v[164:165], v22 offset:4096
  ds_read_b64_tr_b16 v[166:167], v22 offset:5120
  ds_read_b64_tr_b16 v[168:169], v22 offset:8192
  ds_read_b64_tr_b16 v[170:171], v22 offset:9216
  ds_read_b64_tr_b16 v[172:173], v22 offset:12288
  ds_read_b64_tr_b16 v[174:175], v22 offset:13312
  ds_read_b64_tr_b16 v[176:177], v22 offset:16384
  ds_read_b64_tr_b16 v[178:179], v22 offset:17408
  ds_read_b64_tr_b16 v[180:181], v22 offset:20480
  ds_read_b64_tr_b16 v[182:183], v22 offset:21504
  ds_read_b64_tr_b16 v[184:185], v22 offset:24576
  ds_read_b64_tr_b16 v[186:187], v22 offset:25600
  ds_read_b64_tr_b16 v[188:189], v22 offset:28672
  ds_read_b64_tr_b16 v[190:191], v22 offset:29696
  s_waitcnt lgkmcnt(0)
  s_waitcnt vmcnt(16)
  s_barrier
  s_add_u32 s27, s26, 1048576
  s_add_u32 m0, s28, 131072
  s_nop 0
  buffer_load_dwordx4 v20, s[68:71], s27 offen lds
  s_add_u32 m0, s28, 132096
  s_add_u32 s27, s27, 32768
  buffer_load_dwordx4 v20, s[68:71], s27 offen lds
  s_add_u32 m0, s28, 133120
  s_add_u32 s27, s27, 32768
  buffer_load_dwordx4 v21, s[68:71], s27 offen lds
  s_add_u32 m0, s28, 134144
  s_add_u32 s27, s27, 32768
  buffer_load_dwordx4 v21, s[68:71], s27 offen lds
  s_add_u32 m0, s28, 135168
  s_add_u32 s27, s27, 32768
  buffer_load_dwordx4 v20, s[68:71], s27 offen lds
  s_add_u32 m0, s28, 136192
  s_add_u32 s27, s27, 32768
  buffer_load_dwordx4 v20, s[68:71], s27 offen lds
  s_add_u32 m0, s28, 137216
  s_add_u32 s27, s27, 32768
  buffer_load_dwordx4 v21, s[68:71], s27 offen lds
  s_add_u32 m0, s28, 138240
  s_add_u32 s27, s27, 32768
  buffer_load_dwordx4 v21, s[68:71], s27 offen lds
  ds_read_b64_tr_b16 v[192:193], v22 offset:32768
  ds_read_b64_tr_b16 v[194:195], v22 offset:33792
  ds_read_b64_tr_b16 v[196:197], v22 offset:36864
  ds_read_b64_tr_b16 v[198:199], v22 offset:37888
  ds_read_b64_tr_b16 v[200:201], v22 offset:40960
  ds_read_b64_tr_b16 v[202:203], v22 offset:41984
  ds_read_b64_tr_b16 v[204:205], v22 offset:45056
  ds_read_b64_tr_b16 v[206:207], v22 offset:46080
  ds_read_b64_tr_b16 v[208:209], v22 offset:49152
  ds_read_b64_tr_b16 v[210:211], v22 offset:50176
  ds_read_b64_tr_b16 v[212:213], v22 offset:53248
  ds_read_b64_tr_b16 v[214:215], v22 offset:54272
  ds_read_b64_tr_b16 v[216:217], v22 offset:57344
  ds_read_b64_tr_b16 v[218:219], v22 offset:58368
  ds_read_b64_tr_b16 v[220:221], v22 offset:61440
  ds_read_b64_tr_b16 v[222:223], v22 offset:62464
  s_waitcnt lgkmcnt(0)
  s_waitcnt vmcnt(16)
  s_barrier
  s_add_u32 s27, s26, 2097152
  s_add_u32 m0, s28, 0
  s_nop 0
  buffer_load_dwordx4 v20, s[68:71], s27 offen lds
  s_add_u32 m0, s28, 1024
  s_add_u32 s27, s27, 32768
  buffer_load_dwordx4 v20, s[68:71], s27 offen lds
  s_add_u32 m0, s28, 2048
  s_add_u32 s27, s27, 32768
  buffer_load_dwordx4 v21, s[68:71], s27 offen lds
  s_add_u32 m0, s28, 3072
  s_add_u32 s27, s27, 32768
  buffer_load_dwordx4 v21, s[68:71], s27 offen lds
  s_add_u32 m0, s28, 4096
  s_add_u32 s27, s27, 32768
  buffer_load_dwordx4 v20, s[68:71], s27 offen lds
  s_add_u32 m0, s28, 5120
  s_add_u32 s27, s27, 32768
  buffer_load_dwordx4 v20, s[68:71], s27 offen lds
  s_add_u32 m0, s28, 6144
  s_add_u32 s27, s27, 32768
  buffer_load_dwordx4 v21, s[68:71], s27 offen lds
  s_add_u32 m0, s28, 7168
  s_add_u32 s27, s27, 32768
  buffer_load_dwordx4 v21, s[68:71], s27 offen lds
  ds_read_b64_tr_b16 v[224:225], v23 offset:0
  ds_read_b64_tr_b16 v[226:227], v23 offset:1024
  ds_read_b64_tr_b16 v[228:229], v23 offset:4096
  ds_read_b64_tr_b16 v[230:231], v23 offset:5120
  ds_read_b64_tr_b16 v[232:233], v23 offset:8192
  ds_read_b64_tr_b16 v[234:235], v23 offset:9216
  ds_read_b64_tr_b16 v[236:237], v23 offset:12288
  ds_read_b64_tr_b16 v[238:239], v23 offset:13312
  ds_read_b64_tr_b16 v[240:241], v23 offset:16384
  ds_read_b64_tr_b16 v[242:243], v23 offset:17408
  ds_read_b64_tr_b16 v[244:245], v23 offset:20480
  ds_read_b64_tr_b16 v[246:247], v23 offset:21504
  ds_read_b64_tr_b16 v[248:249], v23 offset:24576
  ds_read_b64_tr_b16 v[250:251], v23 offset:25600
  ds_read_b64_tr_b16 v[252:253], v23 offset:28672
  ds_read_b64_tr_b16 v[254:255], v23 offset:29696
  s_waitcnt lgkmcnt(0)
  s_waitcnt vmcnt(16)
  s_barrier
  s_add_u32 s27, s26, 3145728
  s_add_u32 m0, s28, 32768
  s_nop 0
  buffer_load_dwordx4 v20, s[68:71], s27 offen lds
  s_add_u32 m0, s28, 33792
  s_add_u32 s27, s27, 32768
  buffer_load_dwordx4 v20, s[68:71], s27 offen lds
  s_add_u32 m0, s28, 34816
  s_add_u32 s27, s27, 32768
  buffer_load_dwordx4 v21, s[68:71], s27 offen lds
  s_add_u32 m0, s28, 35840
  s_add_u32 s27, s27, 32768
  buffer_load_dwordx4 v21, s[68:71], s27 offen lds
  s_add_u32 m0, s28, 36864
  s_add_u32 s27, s27, 32768
  buffer_load_dwordx4 v20, s[68:71], s27 offen lds
  s_add_u32 m0, s28, 37888
  s_add_u32 s27, s27, 32768
  buffer_load_dwordx4 v20, s[68:71], s27 offen lds
  s_add_u32 m0, s28, 38912
  s_add_u32 s27, s27, 32768
  buffer_load_dwordx4 v21, s[68:71], s27 offen lds
  s_add_u32 m0, s28, 39936
  s_add_u32 s27, s27, 32768
  buffer_load_dwordx4 v21, s[68:71], s27 offen lds
  ds_read_b64_tr_b16 a[0:1], v23 offset:32768
  ds_read_b64_tr_b16 a[2:3], v23 offset:33792
  ds_read_b64_tr_b16 a[4:5], v23 offset:36864
  ds_read_b64_tr_b16 a[6:7], v23 offset:37888
  ds_read_b64_tr_b16 a[8:9], v23 offset:40960
  ds_read_b64_tr_b16 a[10:11], v23 offset:41984
  ds_read_b64_tr_b16 a[12:13], v23 offset:45056
  ds_read_b64_tr_b16 a[14:15], v23 offset:46080
  ds_read_b64_tr_b16 a[16:17], v23 offset:49152
  ds_read_b64_tr_b16 a[18:19], v23 offset:50176
  ds_read_b64_tr_b16 a[20:21], v23 offset:53248
  ds_read_b64_tr_b16 a[22:23], v23 offset:54272
  ds_read_b64_tr_b16 a[24:25], v23 offset:57344
  ds_read_b64_tr_b16 a[26:27], v23 offset:58368
  ds_read_b64_tr_b16 a[28:29], v23 offset:61440
  ds_read_b64_tr_b16 a[30:31], v23 offset:62464
  s_waitcnt lgkmcnt(0)
  s_waitcnt vmcnt(16)
  s_barrier
  ds_read_b64_tr_b16 a[32:33], v24 offset:0
  ds_read_b64_tr_b16 a[34:35], v24 offset:1024
  ds_read_b64_tr_b16 a[36:37], v24 offset:4096
  ds_read_b64_tr_b16 a[38:39], v24 offset:5120
  ds_read_b64_tr_b16 a[40:41], v24 offset:8192
  ds_read_b64_tr_b16 a[42:43], v24 offset:9216
  ds_read_b64_tr_b16 a[44:45], v24 offset:12288
  ds_read_b64_tr_b16 a[46:47], v24 offset:13312
  ds_read_b64_tr_b16 a[48:49], v24 offset:16384
  ds_read_b64_tr_b16 a[50:51], v24 offset:17408
  ds_read_b64_tr_b16 a[52:53], v24 offset:20480
  ds_read_b64_tr_b16 a[54:55], v24 offset:21504
  ds_read_b64_tr_b16 a[56:57], v24 offset:24576
  ds_read_b64_tr_b16 a[58:59], v24 offset:25600
  ds_read_b64_tr_b16 a[60:61], v24 offset:28672
  ds_read_b64_tr_b16 a[62:63], v24 offset:29696
  s_waitcnt lgkmcnt(0)
  s_waitcnt vmcnt(8)
  s_barrier
  ds_read_b64_tr_b16 a[64:65], v22 offset:0
  ds_read_b64_tr_b16 a[66:67], v22 offset:1024
  ds_read_b64_tr_b16 a[68:69], v22 offset:4096
  ds_read_b64_tr_b16 a[70:71], v22 offset:5120
  ds_read_b64_tr_b16 a[72:73], v22 offset:8192
  ds_read_b64_tr_b16 a[74:75], v22 offset:9216
  ds_read_b64_tr_b16 a[76:77], v22 offset:12288
  ds_read_b64_tr_b16 a[78:79], v22 offset:13312
  ds_read_b64_tr_b16 a[80:81], v22 offset:16384
  ds_read_b64_tr_b16 a[82:83], v22 offset:17408
  ds_read_b64_tr_b16 a[84:85], v22 offset:20480
  ds_read_b64_tr_b16 a[86:87], v22 offset:21504
  ds_read_b64_tr_b16 a[88:89], v22 offset:24576
  ds_read_b64_tr_b16 a[90:91], v22 offset:25600
  ds_read_b64_tr_b16 a[92:93], v22 offset:28672
  ds_read_b64_tr_b16 a[94:95], v22 offset:29696
  s_waitcnt lgkmcnt(0)
  s_waitcnt vmcnt(0)
  s_barrier
  ds_read_b64_tr_b16 a[96:97], v22 offset:32768
  ds_read_b64_tr_b16 a[98:99], v22 offset:33792
  ds_read_b64_tr_b16 a[100:101], v22 offset:36864
  ds_read_b64_tr_b16 a[102:103], v22 offset:37888
  ds_read_b64_tr_b16 a[104:105], v22 offset:40960
  ds_read_b64_tr_b16 a[106:107], v22 offset:41984
  ds_read_b64_tr_b16 a[108:109], v22 offset:45056
  ds_read_b64_tr_b16 a[110:111], v22 offset:46080
  ds_read_b64_tr_b16 a[112:113], v22 offset:49152
  ds_read_b64_tr_b16 a[114:115], v22 offset:50176
  ds_read_b64_tr_b16 a[116:117], v22 offset:53248
  ds_read_b64_tr_b16 a[118:119], v22 offset:54272
  ds_read_b64_tr_b16 a[120:121], v22 offset:57344
  ds_read_b64_tr_b16 a[122:123], v22 offset:58368
  ds_read_b64_tr_b16 a[124:125], v22 offset:61440
  ds_read_b64_tr_b16 a[126:127], v22 offset:62464
  s_waitcnt lgkmcnt(0)
q_ld_81:
  s_waitcnt lgkmcnt(0)
  s_barrier
  v_mbcnt_lo_u32_b32 v20, -1, 0
  v_and_b32 v20, 0, v20
  v_add_lshl_u32 v20, v20, 1, 2
  s_mov_b32 s26, 0
g_wt_82:
  global_load_dword v21, v20, s[12:13] offset:128 sc1
  s_add_u32 s26, s26, 1
  s_cmp_gt_u32 s26, 1048576
  s_cbranch_scc1 L_end
  s_waitcnt vmcnt(0)
  v_cmp_eq_u32 vcc, 0, v21
  v_readfirstlane_b32 s27, v21
  s_cbranch_vccnz g_wt_82
  v_lshrrev_b32 v7, 7, v0
  v_lshlrev_b32 v7, 12, v7
  v_and_b32 v2, 1023, v9
  s_lshl_b32 s26, s17, 10
  v_add3_u32 v7, v7, v2, s26
  v_mov_b32 v116, 0
  s_mov_b32 s47, s60
  s_add_u32 s76, s60, 3
  s_add_u32 s41, s60, 64
  s_mov_b32 s40, 18
  s_mov_b32 s48, 0
  s_mov_b32 s49, 268435456
  s_mov_b32 s43, 268435456
  s_mov_b32 s50, 32768
  s_mov_b32 s56, 1
  s_mov_b32 s61, 0
  s_mov_b32 s62, 0
  s_lshl_b32 s54, s17, 13
  s_mov_b32 s50, 0
  v_mov_b32 v4, 1
q_slow_83:
  s_nop 1
  s_nop 7
  v_cvt_pk_bf16_f32 v100, v52, v53
  v_cvt_pk_bf16_f32 v101, v54, v55
  v_cvt_pk_bf16_f32 v102, v60, v61
  v_cvt_pk_bf16_f32 v103, v62, v63
  buffer_store_dwordx4 v[100:103], v8, s[4:7], s43 offen offset:0 sc1
  v_cvt_pk_bf16_f32 v104, v56, v57
  v_cvt_pk_bf16_f32 v105, v58, v59
  v_cvt_pk_bf16_f32 v106, v64, v65
  v_cvt_pk_bf16_f32 v107, v66, v67
  buffer_store_dwordx4 v[104:107], v8, s[4:7], s43 offen offset:512 sc1
  s_mov_b32 s43, 268435456
  s_xor_b32 s50, s50, 32768
  s_cmp_lg_u32 s62, 0
  s_cbranch_scc1 q_patch_88
q_nxt_93:
  s_cmp_ge_u32 s47, 128
  s_cbranch_scc1 q_end_84
  s_cmp_lg_u32 s48, 0
  s_cbranch_scc1 q_have_85
  s_mov_b32 s53, 0
q_poll_86:
  s_cmp_lt_u32 s47, 64
  s_cselect_b32 s26, 2, 0
  s_add_u32 s26, s26, s47
  s_lshl_b32 s26, s26, 12
  s_add_u32 s26, s26, 243261440
  s_mov_b64 exec, 0xffffff
  buffer_load_dword v116, v7, s[4:7], s26 offen sc1
  s_mov_b64 exec, -1
  s_add_u32 s53, s53, 1
  s_cmp_gt_u32 s53, 1048576
  s_cbranch_scc1 q_fail_87
  s_waitcnt vmcnt(0)
  s_mov_b64 exec, 1
  buffer_store_dword v4, off, s[4:7], s49 sc1
  s_mov_b64 exec, -1
  s_mov_b32 s49, 268435456
  v_cmp_eq_u32 vcc, 0, v116
  s_nop 0
  s_and_b32 s26, vcc_lo, 0xffffff
  s_cbranch_scc1 q_poll_86
  s_and_b32 s63, s47, 127
  s_lshl_b32 s63, s63, 15
  s_xor_b32 s27, s50, 32768
  s_add_u32 m0, s27, s54
  s_add_u32 s63, s63, s54
  s_add_u32 s63, s63, 6291456
  buffer_load_dwordx4 v12, s[4:7], s63 offen offset:0 sc1 lds
  buffer_load_dwordx4 v13, s[4:7], s63 offen offset:1024 sc1 lds
  buffer_load_dwordx4 v14, s[4:7], s63 offen offset:2048 sc1 lds
  buffer_load_dwordx4 v15, s[4:7], s63 offen offset:3072 sc1 lds
  s_add_u32 m0, m0, 4096
  s_add_u32 s63, s63, 4096
  buffer_load_dwordx4 v16, s[4:7], s63 offen offset:0 sc1 lds
  buffer_load_dwordx4 v17, s[4:7], s63 offen offset:1024 sc1 lds
  buffer_load_dwordx4 v18, s[4:7], s63 offen offset:2048 sc1 lds
  buffer_load_dwordx4 v19, s[4:7], s63 offen offset:3072 sc1 lds
  v_cmp_eq_u32 vcc, 0, v116
  v_max_u32_dpp v117, v116, v116 quad_perm:[1,0,3,2] row_mask:0xf bank_mask:0xf
  s_and_b32 s48, vcc_lo, 0xffffff
  s_cselect_b32 s48, 0, -1
  v_max_u32_dpp v117, v117, v117 quad_perm:[2,3,0,1] row_mask:0xf bank_mask:0xf
  s_nop 1
  v_max_u32_dpp v117, v117, v117 row_half_mirror row_mask:0xf bank_mask:0xf
  v_and_b32 v117, s48, v117
q_have_85:
  ds_write_b32 v118, v117 offset:256
  s_xor_b32 s50, s50, 32768
  s_waitcnt lgkmcnt(0)
  s_barrier
  ds_read_b128 v[108:111], v119 offset:256
  s_cmp_lt_u32 s47, 64
  s_cbranch_scc1 q_nopre_89
  s_waitcnt lgkmcnt(0)
  v_min3_u32 v112, v108, v109, v110
  v_max3_u32 v108, v108, v109, v110
  v_min_u32 v112, v112, v111
  v_max_u32 v108, v108, v111
  v_readfirstlane_b32 s45, v112
  v_readlane_b32 s28, v108, 0
  v_readlane_b32 s29, v108, 1
  v_readlane_b32 s30, v108, 2
  s_cmp_gt_u32 s28, s56
  s_cselect_b32 s26, s40, 0
  s_max_u32 s56, s56, s28
  s_cmp_gt_u32 s26, 10
  s_subb_u32 s40, s40, 0
  s_cmp_gt_u32 s29, s56
  s_cselect_b32 s26, s40, 0
  s_max_u32 s56, s56, s29
  s_cmp_gt_u32 s26, 10
  s_subb_u32 s40, s40, 0
  s_cmp_gt_u32 s30, s56
  s_cselect_b32 s26, s40, 0
  s_max_u32 s56, s56, s30
  s_add_u32 s76, s47, s40
  s_add_u32 s41, s47, 3
  s_sub_u32 s76, s76, 64
  s_cmp_gt_u32 s26, 10
  s_cselect_b32 s76, 64, s76
  s_subb_u32 s40, s40, 0
  s_cmp_lt_u32 s76, 64
  s_cselect_b32 s76, s76, s41
  s_cmp_lg_u32 s26, 0
  s_cbranch_scc1 q_fork_90
q_nopre_89:
  s_waitcnt vmcnt(0)
  s_sub_u32 s26, s47, s60
  s_cmp_lg_u32 s26, 15
  s_cbranch_scc1 q_cold_91
  v_mbcnt_lo_u32_b32 v20, -1, 0
  v_and_b32 v20, 0, v20
  v_add_lshl_u32 v20, v20, 2, 2
  s_mov_b32 s26, 0
g_wt_98:
  global_load_dword v21, v20, s[12:13] offset:128 sc1
  s_add_u32 s26, s26, 1
  s_cmp_gt_u32 s26, 1048576
  s_cbranch_scc1 L_end
  s_waitcnt vmcnt(0)
  v_cmp_eq_u32 vcc, 0, v21
  v_readfirstlane_b32 s27, v21
  s_cbranch_vccnz g_wt_98
  s_load_dwordx2 s[64:65], s[0:1], 72
  s_load_dwordx2 s[68:69], s[0:1], 80
  s_load_dwordx2 s[8:9], s[0:1], 88
  s_mov_b32 s66, 1835008
  s_mov_b32 s70, 1835008
  s_mov_b32 s10, 1835008
  v_lshrrev_b32 v2, 7, v0
  v_and_b32 v3, 0x70, v0
  v_mul_u32_u24 v6, 57344, v2
  v_add_u32 v6, v6, v3
  v_cmp_eq_u32 vcc, 0x70, v3
  v_mov_b32 v3, 0x7ff00000
  s_nop 0
  v_cndmask_b32 v6, v6, v3, vcc
  v_lshrrev_b32 v2, 8, v0
  v_mul_u32_u24 v7, 14336, v2
  v_and_b32 v3, 0xf0, v0
  v_add_u32 v7, v7, v3
  s_mul_i32 s34, s17, 458752
  s_mul_i32 s27, s16, 112
  s_add_u32 s34, s34, s27
  s_mul_i32 s35, s16, 57344
  s_lshl_b32 s27, s17, 8
  s_add_u32 s35, s35, s27
  s_waitcnt lgkmcnt(0)
  s_mul_i32 s26, s17, 23552
  s_add_u32 m0, s26, 65536
  s_add_u32 s36, s34, 0
  buffer_load_dwordx4 v6, s[64:67], s36 offen lds
  s_add_u32 m0, m0, 1024
  s_add_u32 s36, s34, 0
  buffer_load_dwordx4 v6, s[68:71], s36 offen lds
  s_add_u32 m0, m0, 1024
  s_add_u32 s36, s34, 3584
  buffer_load_dwordx4 v6, s[64:67], s36 offen lds
  s_add_u32 m0, m0, 1024
  s_add_u32 s36, s34, 3584
  buffer_load_dwordx4 v6, s[68:71], s36 offen lds
  s_add_u32 m0, m0, 1024
  s_add_u32 s36, s34, 7168
  buffer_load_dwordx4 v6, s[64:67], s36 offen lds
  s_add_u32 m0, m0, 1024
  s_add_u32 s36, s34, 7168
  buffer_load_dwordx4 v6, s[68:71], s36 offen lds
  s_add_u32 m0, m0, 1024
  s_add_u32 s36, s34, 10752
  buffer_load_dwordx4 v6, s[64:67], s36 offen lds
  s_add_u32 m0, m0, 1024
  s_add_u32 s36, s34, 10752
  buffer_load_dwordx4 v6, s[68:71], s36 offen lds
  s_add_u32 m0, m0, 1024
  s_add_u32 s36, s34, 14336
  buffer_load_dwordx4 v6, s[64:67], s36 offen lds
  s_add_u32 m0, m0, 1024
  s_add_u32 s36, s34, 14336
  buffer_load_dwordx4 v6, s[68:71], s36 offen lds
  s_add_u32 m0, m0, 1024
  s_add_u32 s36, s34, 17920
  buffer_load_dwordx4 v6, s[64:67], s36 offen lds
  s_add_u32 m0, m0, 1024
  s_add_u32 s36, s34, 17920
  buffer_load_dwordx4 v6, s[68:71], s36 offen lds
  s_add_u32 m0, m0, 1024
  s_add_u32 s36, s34, 21504
  buffer_load_dwordx4 v6, s[64:67], s36 offen lds
  s_add_u32 m0, m0, 1024
  s_add_u32 s36, s34, 21504
  buffer_load_dwordx4 v6, s[68:71], s36 offen lds
  s_add_u32 m0, m0, 1024
  s_add_u32 s36, s34, 25088
  buffer_load_dwordx4 v6, s[64:67], s36 offen lds
  s_add_u32 m0, m0, 1024
  s_add_u32 s36, s34, 25088
  buffer_load_dwordx4 v6, s[68:71], s36 offen lds
  s_add_u32 m0, m0, 1024
  s_add_u32 s36, s34, 28672
  buffer_load_dwordx4 v6, s[64:67], s36 offen lds
  s_add_u32 m0, m0, 1024
  s_add_u32 s36, s34, 28672
  buffer_load_dwordx4 v6, s[68:71], s36 offen lds
  s_add_u32 m0, m0, 1024
  s_add_u32 s36, s34, 32256
  buffer_load_dwordx4 v6, s[64:67], s36 offen lds
  s_add_u32 m0, m0, 1024
  s_add_u32 s36, s34, 32256
  buffer_load_dwordx4 v6, s[68:71], s36 offen lds
  s_add_u32 m0, m0, 1024
  s_add_u32 s36, s34, 35840
  buffer_load_dwordx4 v6, s[64:67], s36 offen lds
  s_add_u32 m0, m0, 1024
  s_add_u32 s36, s34, 35840
  buffer_load_dwordx4 v6, s[68:71], s36 offen lds
  s_add_u32 m0, m0, 1024
  s_add_u32 s36, s34, 39424
  buffer_load_dwordx4 v6, s[64:67], s36 offen lds
  s_add_u32 m0, m0, 1024
  v_lshrrev_b32 v7, 7, v0
  v_lshlrev_b32 v7, 12, v7
  v_and_b32 v2, 1023, v9
  s_lshl_b32 s26, s17, 10
  v_add3_u32 v7, v7, v2, s26
  v_mov_b32 v116, 0
q_cold_91:
  s_waitcnt lgkmcnt(0)
  s_barrier
  s_cmp_lg_u32 s50, 0
  s_cbranch_scc1 q_c1_95
q_c0_94:
  ds_read_b128 v[68:71], v120 offset:0
  ds_read_b128 v[72:75], v121 offset:0
  ds_read_b128 v[76:79], v122 offset:0
q_w0_96:
  s_waitcnt lgkmcnt(2)
  v_mfma_f32_32x32x16_bf16 v[20:35], v[128:131], v[68:71], 0
  ds_read_b128 v[80:83], v123 offset:0
  s_mov_b32 s46, s47
  s_mov_b32 s47, s76
  s_lshl_b32 s52, s46, 7
  s_add_u32 s52, s52, s57
  s_lshl_b32 s44, s52, 12
  v_mfma_f32_32x32x16_bf16 v[36:51], v[68:71], a[0:3], 0
  s_add_u32 s44, s44, 41943040
  v_cvt_pk_bf16_f32 v100, v52, v53
  v_cvt_pk_bf16_f32 v101, v54, v55
  v_cvt_pk_bf16_f32 v102, v60, v61
  v_cvt_pk_bf16_f32 v103, v62, v63
  s_waitcnt lgkmcnt(2)
  v_mfma_f32_32x32x16_bf16 v[20:35], v[132:135], v[72:75], v[20:35]
  ds_read_b128 v[84:87], v124 offset:0
  buffer_store_dwordx4 v[100:103], v8, s[4:7], s43 offen offset:0 sc1
  v_cvt_pk_bf16_f32 v104, v56, v57
  v_cvt_pk_bf16_f32 v105, v58, v59
  v_mfma_f32_32x32x16_bf16 v[36:51], v[72:75], a[4:7], v[36:51]
  v_cvt_pk_bf16_f32 v106, v64, v65
  v_cvt_pk_bf16_f32 v107, v66, v67
  s_waitcnt lgkmcnt(2)
  v_mfma_f32_32x32x16_bf16 v[20:35], v[136:139], v[76:79], v[20:35]
  ds_read_b128 v[88:91], v125 offset:0
  buffer_store_dwordx4 v[104:107], v8, s[4:7], s43 offen offset:512 sc1
  s_lshl_b32 s43, s52, 11
  s_add_u32 s43, s43, 142606336
  v_mfma_f32_32x32x16_bf16 v[36:51], v[76:79], a[8:11], v[36:51]
  s_lshl_b32 s51, s52, 5
  s_add_u32 s51, s51, 244318208
  s_lshr_b32 s55, s47, 7
  s_or_b32 s55, s55, s62
  s_sub_u32 s27, s47, s60
  s_cmp_eq_u32 s27, 15
  s_cselect_b32 s55, 1, s55
  s_waitcnt lgkmcnt(2)
  v_mfma_f32_32x32x16_bf16 v[20:35], v[140:143], v[80:83], v[20:35]
  ds_read_b128 v[92:95], v126 offset:0
  s_add_u32 s76, s47, 3
  s_cmp_lt_u32 s76, 18
  s_cselect_b32 s76, s76, s41
  v_mfma_f32_32x32x16_bf16 v[36:51], v[80:83], a[12:15], v[36:51]
  s_waitcnt lgkmcnt(2)
  v_mfma_f32_32x32x16_bf16 v[20:35], v[144:147], v[84:87], v[20:35]
  ds_read_b128 v[96:99], v127 offset:0
  v_mfma_f32_32x32x16_bf16 v[36:51], v[84:87], a[16:19], v[36:51]
  s_waitcnt lgkmcnt(2)
  v_mfma_f32_32x32x16_bf16 v[20:35], v[148:151], v[88:91], v[20:35]
  ds_read_b128 v[68:71], v120 offset:256
  v_mfma_f32_32x32x16_bf16 v[36:51], v[88:91], a[20:23], v[36:51]
  s_waitcnt lgkmcnt(2)
  v_mfma_f32_32x32x16_bf16 v[20:35], v[152:155], v[92:95], v[20:35]
  ds_read_b128 v[72:75], v121 offset:256
  s_cmp_lt_u32 s47, 64
  s_cselect_b32 s26, 2, 0
  s_add_u32 s26, s26, s47
  s_lshl_b32 s26, s26, 12
  s_add_u32 s26, s26, 243261440
  v_mfma_f32_32x32x16_bf16 v[36:51], v[92:95], a[24:27], v[36:51]
  s_mov_b64 exec, 0xffffff
  buffer_load_dword v116, v7, s[4:7], s26 offen sc1
  s_mov_b64 exec, -1
  s_waitcnt lgkmcnt(2)
  v_mfma_f32_32x32x16_bf16 v[20:35], v[156:159], v[96:99], v[20:35]
  ds_read_b128 v[76:79], v122 offset:256
  v_mfma_f32_32x32x16_bf16 v[36:51], v[96:99], a[28:31], v[36:51]
  s_waitcnt lgkmcnt(2)
  v_mfma_f32_32x32x16_bf16 v[20:35], v[160:163], v[68:71], v[20:35]
  ds_read_b128 v[80:83], v123 offset:256
  v_mfma_f32_32x32x16_bf16 v[36:51], v[68:71], a[32:35], v[36:51]
  s_waitcnt lgkmcnt(2)
  v_mfma_f32_32x32x16_bf16 v[20:35], v[164:167], v[72:75], v[20:35]
  ds_read_b128 v[84:87], v124 offset:256
  v_mfma_f32_32x32x16_bf16 v[36:51], v[72:75], a[36:39], v[36:51]
  s_waitcnt lgkmcnt(2)
  v_mfma_f32_32x32x16_bf16 v[20:35], v[168:171], v[76:79], v[20:35]
  ds_read_b128 v[88:91], v125 offset:256
  v_mfma_f32_32x32x16_bf16 v[36:51], v[76:79], a[40:43], v[36:51]
  s_waitcnt lgkmcnt(2)
  v_mfma_f32_32x32x16_bf16 v[20:35], v[172:175], v[80:83], v[20:35]
  ds_read_b128 v[92:95], v126 offset:256
  v_mfma_f32_32x32x16_bf16 v[36:51], v[80:83], a[44:47], v[36:51]
  s_waitcnt lgkmcnt(2)
  v_mfma_f32_32x32x16_bf16 v[20:35], v[176:179], v[84:87], v[20:35]
  ds_read_b128 v[96:99], v127 offset:256
  v_mfma_f32_32x32x16_bf16 v[36:51], v[84:87], a[48:51], v[36:51]
  s_waitcnt lgkmcnt(2)
  v_mfma_f32_32x32x16_bf16 v[20:35], v[180:183], v[88:91], v[20:35]
  ds_read_b128 v[68:71], v120 offset:512
  v_mfma_f32_32x32x16_bf16 v[36:51], v[88:91], a[52:55], v[36:51]
  s_waitcnt lgkmcnt(2)
  v_mfma_f32_32x32x16_bf16 v[20:35], v[184:187], v[92:95], v[20:35]
  ds_read_b128 v[72:75], v121 offset:512
  v_mfma_f32_32x32x16_bf16 v[36:51], v[92:95], a[56:59], v[36:51]
  s_waitcnt lgkmcnt(2)
  v_mfma_f32_32x32x16_bf16 v[20:35], v[188:191], v[96:99], v[20:35]
  ds_read_b128 v[76:79], v122 offset:512
  v_mfma_f32_32x32x16_bf16 v[36:51], v[96:99], a[60:63], v[36:51]
  s_waitcnt lgkmcnt(2)
  v_mfma_f32_32x32x16_bf16 v[20:35], v[192:195], v[68:71], v[20:35]
  ds_read_b128 v[80:83], v123 offset:512
  v_mfma_f32_32x32x16_bf16 v[36:51], v[68:71], a[64:67], v[36:51]
  s_waitcnt lgkmcnt(2)
  v_mfma_f32_32x32x16_bf16 v[20:35], v[196:199], v[72:75], v[20:35]
  ds_read_b128 v[84:87], v124 offset:512
  v_mfma_f32_32x32x16_bf16 v[36:51], v[72:75], a[68:71], v[36:51]
  s_waitcnt lgkmcnt(2)
  v_mfma_f32_32x32x16_bf16 v[20:35], v[200:203], v[76:79], v[20:35]
  ds_read_b128 v[88:91], v125 offset:512
  v_mfma_f32_32x32x16_bf16 v[36:51], v[76:79], a[72:75], v[36:51]
  s_waitcnt lgkmcnt(2)
  v_mfma_f32_32x32x16_bf16 v[20:35], v[204:207], v[80:83], v[20:35]
  ds_read_b128 v[92:95], v126 offset:512
  s_waitcnt vmcnt(0)
  s_mov_b64 exec, 1
  buffer_store_dword v4, off, s[4:7], s49 sc1
  s_mov_b64 exec, -1
  v_mfma_f32_32x32x16_bf16 v[36:51], v[80:83], a[76:79], v[36:51]
  v_cmp_eq_u32 vcc, 0, v116
  v_max_u32_dpp v117, v116, v116 quad_perm:[1,0,3,2] row_mask:0xf bank_mask:0xf
  s_and_b32 s48, vcc_lo, 0xffffff
  s_cselect_b32 s48, 0, -1
  v_max_u32_dpp v117, v117, v117 quad_perm:[2,3,0,1] row_mask:0xf bank_mask:0xf
  s_nop 1
  s_waitcnt lgkmcnt(2)
  v_mfma_f32_32x32x16_bf16 v[20:35], v[208:211], v[84:87], v[20:35]
  ds_read_b128 v[96:99], v127 offset:512
  v_max_u32_dpp v117, v117, v117 row_half_mirror row_mask:0xf bank_mask:0xf
  v_and_b32 v117, s48, v117
  s_cmp_lg_u32 s48, 0
  s_cselect_b32 s28, s47, s46
  s_and_b32 s63, s28, 127
  v_mfma_f32_32x32x16_bf16 v[36:51], v[84:87], a[80:83], v[36:51]
  s_lshl_b32 s63, s63, 15
  s_xor_b32 s27, s50, 32768
  s_add_u32 m0, s27, s54
  s_add_u32 s63, s63, s54
  s_add_u32 s63, s63, 6291456
  s_waitcnt lgkmcnt(2)
  v_mfma_f32_32x32x16_bf16 v[20:35], v[212:215], v[88:91], v[20:35]
  ds_read_b128 v[68:71], v120 offset:768
  buffer_load_dwordx4 v12, s[4:7], s63 offen offset:0 sc1 lds
  v_mfma_f32_32x32x16_bf16 v[36:51], v[88:91], a[84:87], v[36:51]
  s_waitcnt lgkmcnt(2)
  v_mfma_f32_32x32x16_bf16 v[20:35], v[216:219], v[92:95], v[20:35]
  ds_read_b128 v[72:75], v121 offset:768
  buffer_load_dwordx4 v13, s[4:7], s63 offen offset:1024 sc1 lds
  v_mfma_f32_32x32x16_bf16 v[36:51], v[92:95], a[88:91], v[36:51]
  s_waitcnt lgkmcnt(2)
  v_mfma_f32_32x32x16_bf16 v[20:35], v[220:223], v[96:99], v[20:35]
  ds_read_b128 v[76:79], v122 offset:768
  buffer_load_dwordx4 v14, s[4:7], s63 offen offset:2048 sc1 lds
  v_mfma_f32_32x32x16_bf16 v[36:51], v[96:99], a[92:95], v[36:51]
  s_waitcnt lgkmcnt(2)
  v_mfma_f32_32x32x16_bf16 v[20:35], v[224:227], v[68:71], v[20:35]
  ds_read_b128 v[80:83], v123 offset:768
  buffer_load_dwordx4 v15, s[4:7], s63 offen offset:3072 sc1 lds
  s_add_u32 m0, m0, 4096
  s_add_u32 s63, s63, 4096
  v_mfma_f32_32x32x16_bf16 v[36:51], v[68:71], a[96:99], v[36:51]
  s_waitcnt lgkmcnt(2)
  v_mfma_f32_32x32x16_bf16 v[20:35], v[228:231], v[72:75], v[20:35]
  ds_read_b128 v[84:87], v124 offset:768
  buffer_load_dwordx4 v16, s[4:7], s63 offen offset:0 sc1 lds
  v_mfma_f32_32x32x16_bf16 v[36:51], v[72:75], a[100:103], v[36:51]
  s_waitcnt lgkmcnt(2)
  v_mfma_f32_32x32x16_bf16 v[20:35], v[232:235], v[76:79], v[20:35]
  ds_read_b128 v[88:91], v125 offset:768
  buffer_load_dwordx4 v17, s[4:7], s63 offen offset:1024 sc1 lds
  v_mfma_f32_32x32x16_bf16 v[36:51], v[76:79], a[104:107], v[36:51]
  s_waitcnt lgkmcnt(2)
  v_mfma_f32_32x32x16_bf16 v[20:35], v[236:239], v[80:83], v[20:35]
  ds_read_b128 v[92:95], v126 offset:768
  buffer_load_dwordx4 v18, s[4:7], s63 offen offset:2048 sc1 lds
  v_mfma_f32_32x32x16_bf16 v[36:51], v[80:83], a[108:111], v[36:51]
  s_waitcnt lgkmcnt(2)
  v_mfma_f32_32x32x16_bf16 v[20:35], v[240:243], v[84:87], v[20:35]
  ds_read_b128 v[96:99], v127 offset:768
  buffer_load_dwordx4 v19, s[4:7], s63 offen offset:3072 sc1 lds
  s_add_u32 s49, s51, 16
  s_add_u32 s26, s62, 1
  v_mfma_f32_32x32x16_bf16 v[36:51], v[84:87], a[112:115], v[36:51]
  v_mov_b32 v4, s26
  ds_write_b32 v118, v117 offset:0
  s_waitcnt lgkmcnt(3)
  v_mfma_f32_32x32x16_bf16 v[20:35], v[244:247], v[88:91], v[20:35]
  ds_read_b128 v[68:71], v120 offset:0
  v_mfma_f32_32x32x16_bf16 v[36:51], v[88:91], a[116:119], v[36:51]
  ds_read_b128 v[72:75], v121 offset:0
  s_waitcnt lgkmcnt(4)
  v_mfma_f32_32x32x16_bf16 v[20:35], v[248:251], v[92:95], v[20:35]
  ds_read_b128 v[76:79], v122 offset:0
  v_mfma_f32_32x32x16_bf16 v[36:51], v[92:95], a[120:123], v[36:51]
  ds_read_b128 v[80:83], v123 offset:0
  s_waitcnt lgkmcnt(5)
  v_mfma_f32_32x32x16_bf16 v[20:35], v[252:255], v[96:99], v[20:35]
  ds_read_b128 v[84:87], v124 offset:0
  v_mfma_f32_32x32x16_bf16 v[36:51], v[96:99], a[124:127], v[36:51]
  ds_read_b128 v[88:91], v125 offset:0
  s_waitcnt lgkmcnt(4)
  v_mfma_f32_32x32x16_bf16 v[52:67], a[128:131], v[68:71], 0
  ds_read_b128 v[92:95], v126 offset:0
  v_mfma_f32_32x32x16_bf16 v[52:67], a[132:135], v[72:75], v[52:67]
  ds_read_b128 v[96:99], v127 offset:0
  v_mul_f32 v20, s24, v20
  v_mul_f32 v21, s24, v21
  v_mul_f32 v22, s24, v22
  v_mul_f32 v23, s24, v23
  v_mul_f32 v24, s24, v24
  s_waitcnt lgkmcnt(4)
  v_mfma_f32_32x32x16_bf16 v[52:67], a[136:139], v[76:79], v[52:67]
  ds_read_b128 v[68:71], v120 offset:256
  v_mul_f32 v25, s24, v25
  v_cvt_pk_bf16_f32 v100, v36, v37
  v_cvt_pk_bf16_f32 v101, v38, v39
  v_cvt_pk_bf16_f32 v102, v44, v45
  v_cvt_pk_bf16_f32 v103, v46, v47
  v_mfma_f32_32x32x16_bf16 v[52:67], a[140:143], v[80:83], v[52:67]
  ds_read_b128 v[72:75], v121 offset:256
  buffer_store_dwordx4 v[100:103], v8, s[4:7], s44 offen offset:2048 sc1
  v_cvt_pk_bf16_f32 v104, v40, v41
  v_cvt_pk_bf16_f32 v105, v42, v43
  s_waitcnt lgkmcnt(4)
  v_mfma_f32_32x32x16_bf16 v[52:67], a[144:147], v[84:87], v[52:67]
  ds_read_b128 v[76:79], v122 offset:256
  v_cvt_pk_bf16_f32 v106, v48, v49
  v_cvt_pk_bf16_f32 v107, v50, v51
  buffer_store_dwordx4 v[104:107], v8, s[4:7], s44 offen offset:2560 sc1
  v_mfma_f32_32x32x16_bf16 v[52:67], a[148:151], v[88:91], v[52:67]
  ds_read_b128 v[80:83], v123 offset:256
  v_mul_f32 v26, s24, v26
  v_mul_f32 v27, s24, v27
  v_mul_f32 v28, s24, v28
  v_mul_f32 v29, s24, v29
  v_mul_f32 v30, s24, v30
  s_waitcnt lgkmcnt(4)
  v_mfma_f32_32x32x16_bf16 v[52:67], a[152:155], v[92:95], v[52:67]
  ds_read_b128 v[84:87], v124 offset:256
  v_mul_f32 v31, s24, v31
  v_mul_f32 v32, s24, v32
  v_mul_f32 v33, s24, v33
  v_mul_f32 v34, s24, v34
  v_mul_f32 v35, s24, v35
  v_mfma_f32_32x32x16_bf16 v[52:67], a[156:159], v[96:99], v[52:67]
  ds_read_b128 v[88:91], v125 offset:256
  v_cvt_pk_bf16_f32 v108, v20, v21
  v_cvt_pk_bf16_f32 v109, v22, v23
  v_cvt_pk_bf16_f32 v110, v28, v29
  v_cvt_pk_bf16_f32 v111, v30, v31
  buffer_store_dwordx4 v[108:111], v8, s[4:7], s44 offen offset:0 sc1
  s_waitcnt lgkmcnt(4)
  v_mfma_f32_32x32x16_bf16 v[52:67], a[160:163], v[68:71], v[52:67]
  ds_read_b128 v[92:95], v126 offset:256
  v_cvt_pk_bf16_f32 v112, v24, v25
  v_cvt_pk_bf16_f32 v113, v26, v27
  v_cvt_pk_bf16_f32 v114, v32, v33
  v_cvt_pk_bf16_f32 v115, v34, v35
  buffer_store_dwordx4 v[112:115], v8, s[4:7], s44 offen offset:512 sc1
  v_mfma_f32_32x32x16_bf16 v[52:67], a[164:167], v[72:75], v[52:67]
  ds_read_b128 v[96:99], v127 offset:256
  s_waitcnt lgkmcnt(4)
  v_mfma_f32_32x32x16_bf16 v[52:67], a[168:171], v[76:79], v[52:67]
  ds_read_b128 v[68:71], v120 offset:512
  v_mfma_f32_32x32x16_bf16 v[52:67], a[172:175], v[80:83], v[52:67]
  ds_read_b128 v[72:75], v121 offset:512
  s_waitcnt lgkmcnt(4)
  v_mfma_f32_32x32x16_bf16 v[52:67], a[176:179], v[84:87], v[52:67]
  ds_read_b128 v[76:79], v122 offset:512
  v_mfma_f32_32x32x16_bf16 v[52:67], a[180:183], v[88:91], v[52:67]
  ds_read_b128 v[80:83], v123 offset:512
  s_waitcnt lgkmcnt(4)
  v_mfma_f32_32x32x16_bf16 v[52:67], a[184:187], v[92:95], v[52:67]
  ds_read_b128 v[84:87], v124 offset:512
  v_mfma_f32_32x32x16_bf16 v[52:67], a[188:191], v[96:99], v[52:67]
  ds_read_b128 v[88:91], v125 offset:512
  s_waitcnt lgkmcnt(4)
  v_mfma_f32_32x32x16_bf16 v[52:67], a[192:195], v[68:71], v[52:67]
  ds_read_b128 v[92:95], v126 offset:512
  v_mfma_f32_32x32x16_bf16 v[52:67], a[196:199], v[72:75], v[52:67]
  ds_read_b128 v[96:99], v127 offset:512
  s_waitcnt lgkmcnt(4)
  v_mfma_f32_32x32x16_bf16 v[52:67], a[200:203], v[76:79], v[52:67]
  ds_read_b128 v[68:71], v120 offset:768
  v_mfma_f32_32x32x16_bf16 v[52:67], a[204:207], v[80:83], v[52:67]
  ds_read_b128 v[72:75], v121 offset:768
  s_waitcnt lgkmcnt(4)
  v_mfma_f32_32x32x16_bf16 v[52:67], a[208:211], v[84:87], v[52:67]
  ds_read_b128 v[76:79], v122 offset:768
  ds_read_b128 v[80:83], v123 offset:768
  v_mfma_f32_32x32x16_bf16 v[52:67], a[212:215], v[88:91], v[52:67]
  ds_read_b128 v[84:87], v124 offset:768
  ds_read_b128 v[88:91], v125 offset:768
  s_waitcnt lgkmcnt(6)
  v_mfma_f32_32x32x16_bf16 v[52:67], a[216:219], v[92:95], v[52:67]
  ds_read_b128 v[92:95], v126 offset:768
  v_mfma_f32_32x32x16_bf16 v[52:67], a[220:223], v[96:99], v[52:67]
  ds_read_b128 v[96:99], v127 offset:768
  s_waitcnt lgkmcnt(6)
  v_mfma_f32_32x32x16_bf16 v[52:67], a[224:227], v[68:71], v[52:67]
  v_mfma_f32_32x32x16_bf16 v[52:67], a[228:231], v[72:75], v[52:67]
  s_waitcnt vmcnt(4) lgkmcnt(0)
  s_barrier
  ds_read_b128 v[100:103], v119 offset:0
  v_mfma_f32_32x32x16_bf16 v[52:67], a[232:235], v[76:79], v[52:67]
  ds_read_b128 v[68:71], v120 offset:32768
  v_mfma_f32_32x32x16_bf16 v[52:67], a[236:239], v[80:83], v[52:67]
  ds_read_b128 v[72:75], v121 offset:32768
  s_xor_b32 s50, s50, 32768
  v_mfma_f32_32x32x16_bf16 v[52:67], a[240:243], v[84:87], v[52:67]
  ds_read_b128 v[76:79], v122 offset:32768
  s_waitcnt vmcnt(0)
  s_mov_b64 exec, 1
  buffer_store_dword v4, off, s[4:7], s51 sc1
  s_mov_b64 exec, -1
  v_mfma_f32_32x32x16_bf16 v[52:67], a[244:247], v[88:91], v[52:67]
  s_waitcnt lgkmcnt(3)
  v_min3_u32 v104, v100, v101, v102
  v_max3_u32 v100, v100, v101, v102
  v_min_u32 v104, v104, v103
  v_max_u32 v100, v100, v103
  v_readfirstlane_b32 s45, v104
  v_mfma_f32_32x32x16_bf16 v[52:67], a[248:251], v[92:95], v[52:67]
  v_readlane_b32 s28, v100, 0
  v_readlane_b32 s29, v100, 1
  v_readlane_b32 s30, v100, 2
  s_cmp_gt_u32 s55, 0
  s_cselect_b32 s45, 0, s45
  v_mfma_f32_32x32x16_bf16 v[52:67], a[252:255], v[96:99], v[52:67]
  s_cmp_eq_u32 s45, 0
  s_cbranch_scc1 q_slow_83
  s_cmp_lt_u32 s47, 64
  s_cbranch_scc1 q_w1_97
  s_cmp_gt_u32 s28, s56
  s_cselect_b32 s26, s40, 0
  s_max_u32 s56, s56, s28
  s_cmp_gt_u32 s26, 10
  s_subb_u32 s40, s40, 0
  s_cmp_gt_u32 s29, s56
  s_cselect_b32 s26, s40, 0
  s_max_u32 s56, s56, s29
  s_cmp_gt_u32 s26, 10
  s_subb_u32 s40, s40, 0
  s_cmp_gt_u32 s30, s56
  s_cselect_b32 s26, s40, 0
  s_max_u32 s56, s56, s30
  s_add_u32 s76, s47, s40
  s_add_u32 s41, s47, 3
  s_sub_u32 s76, s76, 64
  s_cmp_gt_u32 s26, 10
  s_cselect_b32 s76, 64, s76
  s_subb_u32 s40, s40, 0
  s_cmp_lt_u32 s76, 64
  s_cselect_b32 s76, s76, s41
  s_cmp_lg_u32 s26, 0
  s_cbranch_scc0 q_w1_97
  s_branch q_forkw_92
q_c1_95:
  ds_read_b128 v[68:71], v120 offset:32768
  ds_read_b128 v[72:75], v121 offset:32768
  ds_read_b128 v[76:79], v122 offset:32768
q_w1_97:
  s_waitcnt lgkmcnt(2)
  v_mfma_f32_32x32x16_bf16 v[20:35], v[128:131], v[68:71], 0
  ds_read_b128 v[80:83], v123 offset:32768
  s_mov_b32 s46, s47
  s_mov_b32 s47, s76
  s_lshl_b32 s52, s46, 7
  s_add_u32 s52, s52, s57
  s_lshl_b32 s44, s52, 12
  v_mfma_f32_32x32x16_bf16 v[36:51], v[68:71], a[0:3], 0
  s_add_u32 s44, s44, 41943040
  v_cvt_pk_bf16_f32 v100, v52, v53
  v_cvt_pk_bf16_f32 v101, v54, v55
  v_cvt_pk_bf16_f32 v102, v60, v61
  v_cvt_pk_bf16_f32 v103, v62, v63
  s_waitcnt lgkmcnt(2)
  v_mfma_f32_32x32x16_bf16 v[20:35], v[132:135], v[72:75], v[20:35]
  ds_read_b128 v[84:87], v124 offset:32768
  buffer_store_dwordx4 v[100:103], v8, s[4:7], s43 offen offset:0 sc1
  v_cvt_pk_bf16_f32 v104, v56, v57
  v_cvt_pk_bf16_f32 v105, v58, v59
  v_mfma_f32_32x32x16_bf16 v[36:51], v[72:75], a[4:7], v[36:51]
  v_cvt_pk_bf16_f32 v106, v64, v65
  v_cvt_pk_bf16_f32 v107, v66, v67
  s_waitcnt lgkmcnt(2)
  v_mfma_f32_32x32x16_bf16 v[20:35], v[136:139], v[76:79], v[20:35]
  ds_read_b128 v[88:91], v125 offset:32768
  buffer_store_dwordx4 v[104:107], v8, s[4:7], s43 offen offset:512 sc1
  s_lshl_b32 s43, s52, 11
  s_add_u32 s43, s43, 142606336
  v_mfma_f32_32x32x16_bf16 v[36:51], v[76:79], a[8:11], v[36:51]
  s_lshl_b32 s51, s52, 5
  s_add_u32 s51, s51, 244318208
  s_lshr_b32 s55, s47, 7
  s_or_b32 s55, s55, s62
  s_sub_u32 s27, s47, s60
  s_cmp_eq_u32 s27, 15
  s_cselect_b32 s55, 1, s55
  s_waitcnt lgkmcnt(2)
  v_mfma_f32_32x32x16_bf16 v[20:35], v[140:143], v[80:83], v[20:35]
  ds_read_b128 v[92:95], v126 offset:32768
  s_add_u32 s76, s47, 3
  s_cmp_lt_u32 s76, 18
  s_cselect_b32 s76, s76, s41
  v_mfma_f32_32x32x16_bf16 v[36:51], v[80:83], a[12:15], v[36:51]
  s_waitcnt lgkmcnt(2)
  v_mfma_f32_32x32x16_bf16 v[20:35], v[144:147], v[84:87], v[20:35]
  ds_read_b128 v[96:99], v127 offset:32768
  v_mfma_f32_32x32x16_bf16 v[36:51], v[84:87], a[16:19], v[36:51]
  s_waitcnt lgkmcnt(2)
  v_mfma_f32_32x32x16_bf16 v[20:35], v[148:151], v[88:91], v[20:35]
  ds_read_b128 v[68:71], v120 offset:33024
  v_mfma_f32_32x32x16_bf16 v[36:51], v[88:91], a[20:23], v[36:51]
  s_waitcnt lgkmcnt(2)
  v_mfma_f32_32x32x16_bf16 v[20:35], v[152:155], v[92:95], v[20:35]
  ds_read_b128 v[72:75], v121 offset:33024
  s_cmp_lt_u32 s47, 64
  s_cselect_b32 s26, 2, 0
  s_add_u32 s26, s26, s47
  s_lshl_b32 s26, s26, 12
  s_add_u32 s26, s26, 243261440
  v_mfma_f32_32x32x16_bf16 v[36:51], v[92:95], a[24:27], v[36:51]
  s_mov_b64 exec, 0xffffff
  buffer_load_dword v116, v7, s[4:7], s26 offen sc1
  s_mov_b64 exec, -1
  s_waitcnt lgkmcnt(2)
  v_mfma_f32_32x32x16_bf16 v[20:35], v[156:159], v[96:99], v[20:35]
  ds_read_b128 v[76:79], v122 offset:33024
  v_mfma_f32_32x32x16_bf16 v[36:51], v[96:99], a[28:31], v[36:51]
  s_waitcnt lgkmcnt(2)
  v_mfma_f32_32x32x16_bf16 v[20:35], v[160:163], v[68:71], v[20:35]
  ds_read_b128 v[80:83], v123 offset:33024
  v_mfma_f32_32x32x16_bf16 v[36:51], v[68:71], a[32:35], v[36:51]
  s_waitcnt lgkmcnt(2)
  v_mfma_f32_32x32x16_bf16 v[20:35], v[164:167], v[72:75], v[20:35]
  ds_read_b128 v[84:87], v124 offset:33024
  v_mfma_f32_32x32x16_bf16 v[36:51], v[72:75], a[36:39], v[36:51]
  s_waitcnt lgkmcnt(2)
  v_mfma_f32_32x32x16_bf16 v[20:35], v[168:171], v[76:79], v[20:35]
  ds_read_b128 v[88:91], v125 offset:33024
  v_mfma_f32_32x32x16_bf16 v[36:51], v[76:79], a[40:43], v[36:51]
  s_waitcnt lgkmcnt(2)
  v_mfma_f32_32x32x16_bf16 v[20:35], v[172:175], v[80:83], v[20:35]
  ds_read_b128 v[92:95], v126 offset:33024
  v_mfma_f32_32x32x16_bf16 v[36:51], v[80:83], a[44:47], v[36:51]
  s_waitcnt lgkmcnt(2)
  v_mfma_f32_32x32x16_bf16 v[20:35], v[176:179], v[84:87], v[20:35]
  ds_read_b128 v[96:99], v127 offset:33024
  v_mfma_f32_32x32x16_bf16 v[36:51], v[84:87], a[48:51], v[36:51]
  s_waitcnt lgkmcnt(2)
  v_mfma_f32_32x32x16_bf16 v[20:35], v[180:183], v[88:91], v[20:35]
  ds_read_b128 v[68:71], v120 offset:33280
  v_mfma_f32_32x32x16_bf16 v[36:51], v[88:91], a[52:55], v[36:51]
  s_waitcnt lgkmcnt(2)
  v_mfma_f32_32x32x16_bf16 v[20:35], v[184:187], v[92:95], v[20:35]
  ds_read_b128 v[72:75], v121 offset:33280
  v_mfma_f32_32x32x16_bf16 v[36:51], v[92:95], a[56:59], v[36:51]
  s_waitcnt lgkmcnt(2)
  v_mfma_f32_32x32x16_bf16 v[20:35], v[188:191], v[96:99], v[20:35]
  ds_read_b128 v[76:79], v122 offset:33280
  v_mfma_f32_32x32x16_bf16 v[36:51], v[96:99], a[60:63], v[36:51]
  s_waitcnt lgkmcnt(2)
  v_mfma_f32_32x32x16_bf16 v[20:35], v[192:195], v[68:71], v[20:35]
  ds_read_b128 v[80:83], v123 offset:33280
  v_mfma_f32_32x32x16_bf16 v[36:51], v[68:71], a[64:67], v[36:51]
  s_waitcnt lgkmcnt(2)
  v_mfma_f32_32x32x16_bf16 v[20:35], v[196:199], v[72:75], v[20:35]
  ds_read_b128 v[84:87], v124 offset:33280
  v_mfma_f32_32x32x16_bf16 v[36:51], v[72:75], a[68:71], v[36:51]
  s_waitcnt lgkmcnt(2)
  v_mfma_f32_32x32x16_bf16 v[20:35], v[200:203], v[76:79], v[20:35]
  ds_read_b128 v[88:91], v125 offset:33280
  v_mfma_f32_32x32x16_bf16 v[36:51], v[76:79], a[72:75], v[36:51]
  s_waitcnt lgkmcnt(2)
  v_mfma_f32_32x32x16_bf16 v[20:35], v[204:207], v[80:83], v[20:35]
  ds_read_b128 v[92:95], v126 offset:33280
  s_waitcnt vmcnt(0)
  s_mov_b64 exec, 1
  buffer_store_dword v4, off, s[4:7], s49 sc1
  s_mov_b64 exec, -1
  v_mfma_f32_32x32x16_bf16 v[36:51], v[80:83], a[76:79], v[36:51]
  v_cmp_eq_u32 vcc, 0, v116
  v_max_u32_dpp v117, v116, v116 quad_perm:[1,0,3,2] row_mask:0xf bank_mask:0xf
  s_and_b32 s48, vcc_lo, 0xffffff
  s_cselect_b32 s48, 0, -1
  v_max_u32_dpp v117, v117, v117 quad_perm:[2,3,0,1] row_mask:0xf bank_mask:0xf
  s_nop 1
  s_waitcnt lgkmcnt(2)
  v_mfma_f32_32x32x16_bf16 v[20:35], v[208:211], v[84:87], v[20:35]
  ds_read_b128 v[96:99], v127 offset:33280
  v_max_u32_dpp v117, v117, v117 row_half_mirror row_mask:0xf bank_mask:0xf
  v_and_b32 v117, s48, v117
  s_cmp_lg_u32 s48, 0
  s_cselect_b32 s28, s47, s46
  s_and_b32 s63, s28, 127
  v_mfma_f32_32x32x16_bf16 v[36:51], v[84:87], a[80:83], v[36:51]
  s_lshl_b32 s63, s63, 15
  s_xor_b32 s27, s50, 32768
  s_add_u32 m0, s27, s54
  s_add_u32 s63, s63, s54
  s_add_u32 s63, s63, 6291456
  s_waitcnt lgkmcnt(2)
  v_mfma_f32_32x32x16_bf16 v[20:35], v[212:215], v[88:91], v[20:35]
  ds_read_b128 v[68:71], v120 offset:33536
  buffer_load_dwordx4 v12, s[4:7], s63 offen offset:0 sc1 lds
  v_mfma_f32_32x32x16_bf16 v[36:51], v[88:91], a[84:87], v[36:51]
  s_waitcnt lgkmcnt(2)
  v_mfma_f32_32x32x16_bf16 v[20:35], v[216:219], v[92:95], v[20:35]
  ds_read_b128 v[72:75], v121 offset:33536
  buffer_load_dwordx4 v13, s[4:7], s63 offen offset:1024 sc1 lds
  v_mfma_f32_32x32x16_bf16 v[36:51], v[92:95], a[88:91], v[36:51]
  s_waitcnt lgkmcnt(2)
  v_mfma_f32_32x32x16_bf16 v[20:35], v[220:223], v[96:99], v[20:35]
  ds_read_b128 v[76:79], v122 offset:33536
  buffer_load_dwordx4 v14, s[4:7], s63 offen offset:2048 sc1 lds
  v_mfma_f32_32x32x16_bf16 v[36:51], v[96:99], a[92:95], v[36:51]
  s_waitcnt lgkmcnt(2)
  v_mfma_f32_32x32x16_bf16 v[20:35], v[224:227], v[68:71], v[20:35]
  ds_read_b128 v[80:83], v123 offset:33536
  buffer_load_dwordx4 v15, s[4:7], s63 offen offset:3072 sc1 lds
  s_add_u32 m0, m0, 4096
  s_add_u32 s63, s63, 4096
  v_mfma_f32_32x32x16_bf16 v[36:51], v[68:71], a[96:99], v[36:51]
  s_waitcnt lgkmcnt(2)
  v_mfma_f32_32x32x16_bf16 v[20:35], v[228:231], v[72:75], v[20:35]
  ds_read_b128 v[84:87], v124 offset:33536
  buffer_load_dwordx4 v16, s[4:7], s63 offen offset:0 sc1 lds
  v_mfma_f32_32x32x16_bf16 v[36:51], v[72:75], a[100:103], v[36:51]
  s_waitcnt lgkmcnt(2)
  v_mfma_f32_32x32x16_bf16 v[20:35], v[232:235], v[76:79], v[20:35]
  ds_read_b128 v[88:91], v125 offset:33536
  buffer_load_dwordx4 v17, s[4:7], s63 offen offset:1024 sc1 lds
  v_mfma_f32_32x32x16_bf16 v[36:51], v[76:79], a[104:107], v[36:51]
  s_waitcnt lgkmcnt(2)
  v_mfma_f32_32x32x16_bf16 v[20:35], v[236:239], v[80:83], v[20:35]
  ds_read_b128 v[92:95], v126 offset:33536
  buffer_load_dwordx4 v18, s[4:7], s63 offen offset:2048 sc1 lds
  v_mfma_f32_32x32x16_bf16 v[36:51], v[80:83], a[108:111], v[36:51]
  s_waitcnt lgkmcnt(2)
  v_mfma_f32_32x32x16_bf16 v[20:35], v[240:243], v[84:87], v[20:35]
  ds_read_b128 v[96:99], v127 offset:33536
  buffer_load_dwordx4 v19, s[4:7], s63 offen offset:3072 sc1 lds
  s_add_u32 s49, s51, 16
  s_add_u32 s26, s62, 1
  v_mfma_f32_32x32x16_bf16 v[36:51], v[84:87], a[112:115], v[36:51]
  v_mov_b32 v4, s26
  ds_write_b32 v118, v117 offset:128
  s_waitcnt lgkmcnt(3)
  v_mfma_f32_32x32x16_bf16 v[20:35], v[244:247], v[88:91], v[20:35]
  ds_read_b128 v[68:71], v120 offset:32768
  v_mfma_f32_32x32x16_bf16 v[36:51], v[88:91], a[116:119], v[36:51]
  ds_read_b128 v[72:75], v121 offset:32768
  s_waitcnt lgkmcnt(4)
  v_mfma_f32_32x32x16_bf16 v[20:35], v[248:251], v[92:95], v[20:35]
  ds_read_b128 v[76:79], v122 offset:32768
  v_mfma_f32_32x32x16_bf16 v[36:51], v[92:95], a[120:123], v[36:51]
  ds_read_b128 v[80:83], v123 offset:32768
  s_waitcnt lgkmcnt(5)
  v_mfma_f32_32x32x16_bf16 v[20:35], v[252:255], v[96:99], v[20:35]
  ds_read_b128 v[84:87], v124 offset:32768
  v_mfma_f32_32x32x16_bf16 v[36:51], v[96:99], a[124:127], v[36:51]
  ds_read_b128 v[88:91], v125 offset:32768
  s_waitcnt lgkmcnt(4)
  v_mfma_f32_32x32x16_bf16 v[52:67], a[128:131], v[68:71], 0
  ds_read_b128 v[92:95], v126 offset:32768
  v_mfma_f32_32x32x16_bf16 v[52:67], a[132:135], v[72:75], v[52:67]
  ds_read_b128 v[96:99], v127 offset:32768
  v_mul_f32 v20, s24, v20
  v_mul_f32 v21, s24, v21
  v_mul_f32 v22, s24, v22
  v_mul_f32 v23, s24, v23
  v_mul_f32 v24, s24, v24
  s_waitcnt lgkmcnt(4)
  v_mfma_f32_32x32x16_bf16 v[52:67], a[136:139], v[76:79], v[52:67]
  ds_read_b128 v[68:71], v120 offset:33024
  v_mul_f32 v25, s24, v25
  v_cvt_pk_bf16_f32 v100, v36, v37
  v_cvt_pk_bf16_f32 v101, v38, v39
  v_cvt_pk_bf16_f32 v102, v44, v45
  v_cvt_pk_bf16_f32 v103, v46, v47
  v_mfma_f32_32x32x16_bf16 v[52:67], a[140:143], v[80:83], v[52:67]
  ds_read_b128 v[72:75], v121 offset:33024
  buffer_store_dwordx4 v[100:103], v8, s[4:7], s44 offen offset:2048 sc1
  v_cvt_pk_bf16_f32 v104, v40, v41
  v_cvt_pk_bf16_f32 v105, v42, v43
  s_waitcnt lgkmcnt(4)
  v_mfma_f32_32x32x16_bf16 v[52:67], a[144:147], v[84:87], v[52:67]
  ds_read_b128 v[76:79], v122 offset:33024
  v_cvt_pk_bf16_f32 v106, v48, v49
  v_cvt_pk_bf16_f32 v107, v50, v51
  buffer_store_dwordx4 v[104:107], v8, s[4:7], s44 offen offset:2560 sc1
  v_mfma_f32_32x32x16_bf16 v[52:67], a[148:151], v[88:91], v[52:67]
  ds_read_b128 v[80:83], v123 offset:33024
  v_mul_f32 v26, s24, v26
  v_mul_f32 v27, s24, v27
  v_mul_f32 v28, s24, v28
  v_mul_f32 v29, s24, v29
  v_mul_f32 v30, s24, v30
  s_waitcnt lgkmcnt(4)
  v_mfma_f32_32x32x16_bf16 v[52:67], a[152:155], v[92:95], v[52:67]
  ds_read_b128 v[84:87], v124 offset:33024
  v_mul_f32 v31, s24, v31
  v_mul_f32 v32, s24, v32
  v_mul_f32 v33, s24, v33
  v_mul_f32 v34, s24, v34
  v_mul_f32 v35, s24, v35
  v_mfma_f32_32x32x16_bf16 v[52:67], a[156:159], v[96:99], v[52:67]
  ds_read_b128 v[88:91], v125 offset:33024
  v_cvt_pk_bf16_f32 v108, v20, v21
  v_cvt_pk_bf16_f32 v109, v22, v23
  v_cvt_pk_bf16_f32 v110, v28, v29
  v_cvt_pk_bf16_f32 v111, v30, v31
  buffer_store_dwordx4 v[108:111], v8, s[4:7], s44 offen offset:0 sc1
  s_waitcnt lgkmcnt(4)
  v_mfma_f32_32x32x16_bf16 v[52:67], a[160:163], v[68:71], v[52:67]
  ds_read_b128 v[92:95], v126 offset:33024
  v_cvt_pk_bf16_f32 v112, v24, v25
  v_cvt_pk_bf16_f32 v113, v26, v27
  v_cvt_pk_bf16_f32 v114, v32, v33
  v_cvt_pk_bf16_f32 v115, v34, v35
  buffer_store_dwordx4 v[112:115], v8, s[4:7], s44 offen offset:512 sc1
  v_mfma_f32_32x32x16_bf16 v[52:67], a[164:167], v[72:75], v[52:67]
  ds_read_b128 v[96:99], v127 offset:33024
  s_waitcnt lgkmcnt(4)
  v_mfma_f32_32x32x16_bf16 v[52:67], a[168:171], v[76:79], v[52:67]
  ds_read_b128 v[68:71], v120 offset:33280
  v_mfma_f32_32x32x16_bf16 v[52:67], a[172:175], v[80:83], v[52:67]
  ds_read_b128 v[72:75], v121 offset:33280
  s_waitcnt lgkmcnt(4)
  v_mfma_f32_32x32x16_bf16 v[52:67], a[176:179], v[84:87], v[52:67]
  ds_read_b128 v[76:79], v122 offset:33280
  v_mfma_f32_32x32x16_bf16 v[52:67], a[180:183], v[88:91], v[52:67]
  ds_read_b128 v[80:83], v123 offset:33280
  s_waitcnt lgkmcnt(4)
  v_mfma_f32_32x32x16_bf16 v[52:67], a[184:187], v[92:95], v[52:67]
  ds_read_b128 v[84:87], v124 offset:33280
  v_mfma_f32_32x32x16_bf16 v[52:67], a[188:191], v[96:99], v[52:67]
  ds_read_b128 v[88:91], v125 offset:33280
  s_waitcnt lgkmcnt(4)
  v_mfma_f32_32x32x16_bf16 v[52:67], a[192:195], v[68:71], v[52:67]
  ds_read_b128 v[92:95], v126 offset:33280
  v_mfma_f32_32x32x16_bf16 v[52:67], a[196:199], v[72:75], v[52:67]
  ds_read_b128 v[96:99], v127 offset:33280
  s_waitcnt lgkmcnt(4)
  v_mfma_f32_32x32x16_bf16 v[52:67], a[200:203], v[76:79], v[52:67]
  ds_read_b128 v[68:71], v120 offset:33536
  v_mfma_f32_32x32x16_bf16 v[52:67], a[204:207], v[80:83], v[52:67]
  ds_read_b128 v[72:75], v121 offset:33536
  s_waitcnt lgkmcnt(4)
  v_mfma_f32_32x32x16_bf16 v[52:67], a[208:211], v[84:87], v[52:67]
  ds_read_b128 v[76:79], v122 offset:33536
  ds_read_b128 v[80:83], v123 offset:33536
  v_mfma_f32_32x32x16_bf16 v[52:67], a[212:215], v[88:91], v[52:67]
  ds_read_b128 v[84:87], v124 offset:33536
  ds_read_b128 v[88:91], v125 offset:33536
  s_waitcnt lgkmcnt(6)
  v_mfma_f32_32x32x16_bf16 v[52:67], a[216:219], v[92:95], v[52:67]
  ds_read_b128 v[92:95], v126 offset:33536
  v_mfma_f32_32x32x16_bf16 v[52:67], a[220:223], v[96:99], v[52:67]
  ds_read_b128 v[96:99], v127 offset:33536
  s_waitcnt lgkmcnt(6)
  v_mfma_f32_32x32x16_bf16 v[52:67], a[224:227], v[68:71], v[52:67]
  v_mfma_f32_32x32x16_bf16 v[52:67], a[228:231], v[72:75], v[52:67]
  s_waitcnt vmcnt(4) lgkmcnt(0)
  s_barrier
  ds_read_b128 v[100:103], v119 offset:128
  v_mfma_f32_32x32x16_bf16 v[52:67], a[232:235], v[76:79], v[52:67]
  ds_read_b128 v[68:71], v120 offset:0
  v_mfma_f32_32x32x16_bf16 v[52:67], a[236:239], v[80:83], v[52:67]
  ds_read_b128 v[72:75], v121 offset:0
  s_xor_b32 s50, s50, 32768
  v_mfma_f32_32x32x16_bf16 v[52:67], a[240:243], v[84:87], v[52:67]
  ds_read_b128 v[76:79], v122 offset:0
  s_waitcnt vmcnt(0)
  s_mov_b64 exec, 1
  buffer_store_dword v4, off, s[4:7], s51 sc1
  s_mov_b64 exec, -1
  v_mfma_f32_32x32x16_bf16 v[52:67], a[244:247], v[88:91], v[52:67]
  s_waitcnt lgkmcnt(3)
  v_min3_u32 v104, v100, v101, v102
  v_max3_u32 v100, v100, v101, v102
  v_min_u32 v104, v104, v103
  v_max_u32 v100, v100, v103
  v_readfirstlane_b32 s45, v104
  v_mfma_f32_32x32x16_bf16 v[52:67], a[248:251], v[92:95], v[52:67]
  v_readlane_b32 s28, v100, 0
  v_readlane_b32 s29, v100, 1
  v_readlane_b32 s30, v100, 2
  s_cmp_gt_u32 s55, 0
  s_cselect_b32 s45, 0, s45
  v_mfma_f32_32x32x16_bf16 v[52:67], a[252:255], v[96:99], v[52:67]
  s_cmp_eq_u32 s45, 0
  s_cbranch_scc1 q_slow_83
  s_cmp_lt_u32 s47, 64
  s_cbranch_scc1 q_w0_96
  s_cmp_gt_u32 s28, s56
  s_cselect_b32 s26, s40, 0
  s_max_u32 s56, s56, s28
  s_cmp_gt_u32 s26, 10
  s_subb_u32 s40, s40, 0
  s_cmp_gt_u32 s29, s56
  s_cselect_b32 s26, s40, 0
  s_max_u32 s56, s56, s29
  s_cmp_gt_u32 s26, 10
  s_subb_u32 s40, s40, 0
  s_cmp_gt_u32 s30, s56
  s_cselect_b32 s26, s40, 0
  s_max_u32 s56, s56, s30
  s_add_u32 s76, s47, s40
  s_add_u32 s41, s47, 3
  s_sub_u32 s76, s76, 64
  s_cmp_gt_u32 s26, 10
  s_cselect_b32 s76, 64, s76
  s_subb_u32 s40, s40, 0
  s_cmp_lt_u32 s76, 64
  s_cselect_b32 s76, s76, s41
  s_cmp_lg_u32 s26, 0
  s_cbranch_scc0 q_w0_96
  s_branch q_forkw_92
q_forkw_92:
  v_cvt_pk_bf16_f32 v100, v52, v53
  v_cvt_pk_bf16_f32 v101, v54, v55
  v_cvt_pk_bf16_f32 v102, v60, v61
  v_cvt_pk_bf16_f32 v103, v62, v63
  buffer_store_dwordx4 v[100:103], v8, s[4:7], s43 offen offset:0 sc1
  v_cvt_pk_bf16_f32 v104, v56, v57
  v_cvt_pk_bf16_f32 v105, v58, v59
  v_cvt_pk_bf16_f32 v106, v64, v65
  v_cvt_pk_bf16_f32 v107, v66, v67
  buffer_store_dwordx4 v[104:107], v8, s[4:7], s43 offen offset:512 sc1
  s_mov_b32 s43, 268435456
  s_waitcnt lgkmcnt(0)
q_fork_90:
  s_mov_b32 s58, s56
  s_mov_b32 s62, 1
  s_andn2_b32 s59, 0xfff, s58
  s_lshl_b32 s26, s61, 21
  s_lshl_b32 s27, s59, 10
  s_add_u32 s26, s26, s27
  s_lshl_b32 s27, s17, 8
  s_add_u32 s26, s26, s27
  s_add_u32 s26, s26, 27262976
  v_lshrrev_b32 v5, 7, v0
  v_lshlrev_b32 v5, 5, v5
  buffer_load_dwordx4 v[36:39], v5, s[4:7], s26 offen offset:0 sc1
  buffer_load_dwordx4 v[40:43], v5, s[4:7], s26 offen offset:16 sc1
  s_load_dwordx2 s[64:65], s[0:1], 72
  s_load_dwordx2 s[68:69], s[0:1], 80
  s_load_dwordx2 s[8:9], s[0:1], 88
  s_mov_b32 s66, 1835008
  s_mov_b32 s70, 1835008
  s_mov_b32 s10, 1835008
  v_lshrrev_b32 v2, 7, v0
  v_and_b32 v3, 0x70, v0
  v_mul_u32_u24 v6, 57344, v2
  v_add_u32 v6, v6, v3
  v_cmp_eq_u32 vcc, 0x70, v3
  v_mov_b32 v3, 0x7ff00000
  s_nop 0
  v_cndmask_b32 v6, v6, v3, vcc
  v_lshrrev_b32 v2, 8, v0
  v_mul_u32_u24 v7, 14336, v2
  v_and_b32 v3, 0xf0, v0
  v_add_u32 v7, v7, v3
  s_mul_i32 s34, s17, 458752
  s_mul_i32 s27, s16, 112
  s_add_u32 s34, s34, s27
  s_mul_i32 s35, s16, 57344
  s_lshl_b32 s27, s17, 8
  s_add_u32 s35, s35, s27
  s_waitcnt lgkmcnt(0)
  s_xor_b32 s37, s50, 32768
  s_add_u32 s37, s37, s54
  s_mov_b32 m0, s37
  s_add_u32 s36, s34, 39424
  buffer_load_dwordx4 v6, s[68:71], s36 offen lds
  s_add_u32 m0, m0, 1024
  s_add_u32 s36, s34, 43008
  buffer_load_dwordx4 v6, s[64:67], s36 offen lds
  s_add_u32 m0, m0, 1024
  s_add_u32 s36, s34, 43008
  buffer_load_dwordx4 v6, s[68:71], s36 offen lds
  s_add_u32 m0, m0, 1024
  s_add_u32 s36, s34, 46592
  buffer_load_dwordx4 v6, s[64:67], s36 offen lds
  s_add_u32 m0, m0, 1024
  s_add_u32 s36, s34, 46592
  buffer_load_dwordx4 v6, s[68:71], s36 offen lds
  s_add_u32 m0, m0, 1024
  s_add_u32 s36, s34, 50176
  buffer_load_dwordx4 v6, s[64:67], s36 offen lds
  s_add_u32 m0, m0, 1024
  s_add_u32 s36, s34, 50176
  buffer_load_dwordx4 v6, s[68:71], s36 offen lds
  s_add_u32 m0, m0, 1024
  s_add_u32 s36, s34, 53760
  buffer_load_dwordx4 v6, s[64:67], s36 offen lds
  s_add_u32 m0, m0, 1024
  s_add_u32 s36, s34, 53760
  buffer_load_dwordx4 v[56:59], v6, s[68:71], s36 offen
  buffer_load_dwordx4 v[60:63], v7, s[8:11], s35 offen offset:0
  buffer_load_dwordx4 v[64:67], v7, s[8:11], s35 offen offset:1024
  buffer_load_dwordx4 v[68:71], v7, s[8:11], s35 offen offset:2048
  buffer_load_dwordx4 v[72:75], v7, s[8:11], s35 offen offset:3072
  s_add_u32 s35, s35, 4096
  buffer_load_dwordx4 v[76:79], v7, s[8:11], s35 offen offset:0
  buffer_load_dwordx4 v[80:83], v7, s[8:11], s35 offen offset:1024
  buffer_load_dwordx4 v[84:87], v7, s[8:11], s35 offen offset:2048
  buffer_load_dwordx4 v[88:91], v7, s[8:11], s35 offen offset:3072
  s_add_u32 s35, s35, 4096
  buffer_load_dwordx4 v[92:95], v7, s[8:11], s35 offen offset:0
  buffer_load_dwordx4 v[96:99], v7, s[8:11], s35 offen offset:1024
  buffer_load_dwordx4 v[100:103], v7, s[8:11], s35 offen offset:2048
  buffer_load_dwordx4 v[104:107], v7, s[8:11], s35 offen offset:3072
  s_add_u32 s35, s35, 4096
  buffer_load_dwordx4 v[108:111], v7, s[8:11], s35 offen offset:0
  buffer_load_dwordx4 v[112:115], v7, s[8:11], s35 offen offset:1024
  s_mov_b32 vcc_lo, 0xaaaaaaaa
  s_mov_b32 vcc_hi, 0xaaaaaaaa
  v_mov_b32 v3, 0xffff
  v_mov_b32 v24, 0xffff0000
  v_cndmask_b32 v3, v3, v24, vcc
  s_mov_b32 vcc_lo, 0x3030303
  s_mov_b32 vcc_hi, 0x3030303
  v_cndmask_b32 v24, 0, v3, vcc
  s_mov_b32 vcc_lo, 0xc0c0c0c
  s_mov_b32 vcc_hi, 0xc0c0c0c
  v_cndmask_b32 v25, 0, v3, vcc
  s_mov_b32 vcc_lo, 0x30303030
  s_mov_b32 vcc_hi, 0x30303030
  v_cndmask_b32 v26, 0, v3, vcc
  s_mov_b32 vcc_lo, 0xc0c0c0c0
  s_mov_b32 vcc_hi, 0xc0c0c0c0
  v_cndmask_b32 v27, 0, v3, vcc
  s_mov_b32 s30, 0x01000100
  s_mov_b32 s31, 0x03020302
  s_mul_i32 s26, s17, 23552
  s_add_u32 s26, s26, 65536
  v_add_u32 v5, s26, v0
  v_add_u32 v2, s37, v0
  ds_read_b128 v[44:47], v5 offset:0
  ds_read_b128 v[48:51], v5 offset:1024
  ds_read_b128 v[52:55], v5 offset:2048
  ds_read_b128 v[12:15], v5 offset:3072
  ds_read_b128 v[16:19], v5 offset:4096
  ds_read_b128 v[120:123], v5 offset:5120
  ds_read_b128 v[124:127], v5 offset:6144
  s_waitcnt vmcnt(23)
  v_perm_b32 v3, v36, v36, s30
  v_and_b32 v20, v24, v3
  v_and_b32 v21, v25, v3
  v_and_b32 v22, v26, v3
  v_and_b32 v23, v27, v3
  s_waitcnt lgkmcnt(5)
  s_nop 0
  v_mfma_f32_16x16x32_bf16 v[28:31], v[20:23], v[44:47], 0
  ds_read_b128 v[44:47], v5 offset:7168
  v_mfma_f32_16x16x32_bf16 v[32:35], v[20:23], v[48:51], 0
  ds_read_b128 v[48:51], v5 offset:8192
  v_perm_b32 v3, v36, v36, s31
  v_and_b32 v20, v24, v3
  v_and_b32 v21, v25, v3
  v_and_b32 v22, v26, v3
  v_and_b32 v23, v27, v3
  s_waitcnt lgkmcnt(5)
  s_nop 0
  v_mfma_f32_16x16x32_bf16 v[28:31], v[20:23], v[52:55], v[28:31]
  ds_read_b128 v[52:55], v5 offset:9216
  v_mfma_f32_16x16x32_bf16 v[32:35], v[20:23], v[12:15], v[32:35]
  ds_read_b128 v[12:15], v5 offset:10240
  v_perm_b32 v3, v37, v37, s30
  v_and_b32 v20, v24, v3
  v_and_b32 v21, v25, v3
  v_and_b32 v22, v26, v3
  v_and_b32 v23, v27, v3
  s_waitcnt lgkmcnt(5)
  s_nop 0
  v_mfma_f32_16x16x32_bf16 v[28:31], v[20:23], v[16:19], v[28:31]
  ds_read_b128 v[16:19], v5 offset:11264
  v_mfma_f32_16x16x32_bf16 v[32:35], v[20:23], v[120:123], v[32:35]
  ds_read_b128 v[120:123], v5 offset:12288
  v_perm_b32 v3, v37, v37, s31
  v_and_b32 v20, v24, v3
  v_and_b32 v21, v25, v3
  v_and_b32 v22, v26, v3
  v_and_b32 v23, v27, v3
  s_waitcnt lgkmcnt(5)
  s_nop 0
  v_mfma_f32_16x16x32_bf16 v[28:31], v[20:23], v[124:127], v[28:31]
  ds_read_b128 v[124:127], v5 offset:13312
  v_mfma_f32_16x16x32_bf16 v[32:35], v[20:23], v[44:47], v[32:35]
  ds_read_b128 v[44:47], v5 offset:14336
  v_perm_b32 v3, v38, v38, s30
  v_and_b32 v20, v24, v3
  v_and_b32 v21, v25, v3
  v_and_b32 v22, v26, v3
  v_and_b32 v23, v27, v3
  s_waitcnt lgkmcnt(5)
  s_nop 0
  v_mfma_f32_16x16x32_bf16 v[28:31], v[20:23], v[48:51], v[28:31]
  ds_read_b128 v[48:51], v5 offset:15360
  v_mfma_f32_16x16x32_bf16 v[32:35], v[20:23], v[52:55], v[32:35]
  ds_read_b128 v[52:55], v5 offset:16384
  v_perm_b32 v3, v38, v38, s31
  v_and_b32 v20, v24, v3
  v_and_b32 v21, v25, v3
  v_and_b32 v22, v26, v3
  v_and_b32 v23, v27, v3
  s_waitcnt lgkmcnt(5)
  s_nop 0
  v_mfma_f32_16x16x32_bf16 v[28:31], v[20:23], v[12:15], v[28:31]
  ds_read_b128 v[12:15], v5 offset:17408
  v_mfma_f32_16x16x32_bf16 v[32:35], v[20:23], v[16:19], v[32:35]
  ds_read_b128 v[16:19], v5 offset:18432
  v_perm_b32 v3, v39, v39, s30
  v_and_b32 v20, v24, v3
  v_and_b32 v21, v25, v3
  v_and_b32 v22, v26, v3
  v_and_b32 v23, v27, v3
  s_waitcnt lgkmcnt(5)
  s_nop 0
  v_mfma_f32_16x16x32_bf16 v[28:31], v[20:23], v[120:123], v[28:31]
  ds_read_b128 v[120:123], v5 offset:19456
  v_mfma_f32_16x16x32_bf16 v[32:35], v[20:23], v[124:127], v[32:35]
  ds_read_b128 v[124:127], v5 offset:20480
  v_perm_b32 v3, v39, v39, s31
  v_and_b32 v20, v24, v3
  v_and_b32 v21, v25, v3
  v_and_b32 v22, v26, v3
  v_and_b32 v23, v27, v3
  s_waitcnt lgkmcnt(5)
  s_nop 0
  v_mfma_f32_16x16x32_bf16 v[28:31], v[20:23], v[44:47], v[28:31]
  ds_read_b128 v[44:47], v5 offset:21504
  v_mfma_f32_16x16x32_bf16 v[32:35], v[20:23], v[48:51], v[32:35]
  ds_read_b128 v[48:51], v5 offset:22528
  v_perm_b32 v3, v40, v40, s30
  v_and_b32 v20, v24, v3
  v_and_b32 v21, v25, v3
  v_and_b32 v22, v26, v3
  v_and_b32 v23, v27, v3
  s_waitcnt lgkmcnt(5)
  s_nop 0
  v_mfma_f32_16x16x32_bf16 v[28:31], v[20:23], v[52:55], v[28:31]
  s_waitcnt vmcnt(22)
  ds_read_b128 v[52:55], v2 offset:0
  v_mfma_f32_16x16x32_bf16 v[32:35], v[20:23], v[12:15], v[32:35]
  s_waitcnt vmcnt(21)
  ds_read_b128 v[12:15], v2 offset:1024
  v_perm_b32 v3, v40, v40, s31
  v_and_b32 v20, v24, v3
  v_and_b32 v21, v25, v3
  v_and_b32 v22, v26, v3
  v_and_b32 v23, v27, v3
  s_waitcnt lgkmcnt(5)
  s_nop 0
  v_mfma_f32_16x16x32_bf16 v[28:31], v[20:23], v[16:19], v[28:31]
  s_waitcnt vmcnt(20)
  ds_read_b128 v[16:19], v2 offset:2048
  v_mfma_f32_16x16x32_bf16 v[32:35], v[20:23], v[120:123], v[32:35]
  s_waitcnt vmcnt(19)
  ds_read_b128 v[120:123], v2 offset:3072
  v_perm_b32 v3, v41, v41, s30
  v_and_b32 v20, v24, v3
  v_and_b32 v21, v25, v3
  v_and_b32 v22, v26, v3
  v_and_b32 v23, v27, v3
  s_waitcnt lgkmcnt(5)
  s_nop 0
  v_mfma_f32_16x16x32_bf16 v[28:31], v[20:23], v[124:127], v[28:31]
  s_waitcnt vmcnt(18)
  ds_read_b128 v[124:127], v2 offset:4096
  v_mfma_f32_16x16x32_bf16 v[32:35], v[20:23], v[44:47], v[32:35]
  s_waitcnt vmcnt(17)
  ds_read_b128 v[44:47], v2 offset:5120
  v_perm_b32 v3, v41, v41, s31
  v_and_b32 v20, v24, v3
  v_and_b32 v21, v25, v3
  v_and_b32 v22, v26, v3
  v_and_b32 v23, v27, v3
  s_waitcnt lgkmcnt(5)
  s_nop 0
  v_mfma_f32_16x16x32_bf16 v[28:31], v[20:23], v[48:51], v[28:31]
  s_waitcnt vmcnt(16)
  ds_read_b128 v[48:51], v2 offset:6144
  v_mfma_f32_16x16x32_bf16 v[32:35], v[20:23], v[52:55], v[32:35]
  s_waitcnt vmcnt(15)
  ds_read_b128 v[52:55], v2 offset:7168
  v_perm_b32 v3, v42, v42, s30
  v_and_b32 v20, v24, v3
  v_and_b32 v21, v25, v3
  v_and_b32 v22, v26, v3
  v_and_b32 v23, v27, v3
  s_waitcnt lgkmcnt(5)
  s_nop 0
  v_mfma_f32_16x16x32_bf16 v[28:31], v[20:23], v[12:15], v[28:31]
  v_mfma_f32_16x16x32_bf16 v[32:35], v[20:23], v[16:19], v[32:35]
  v_perm_b32 v3, v42, v42, s31
  v_and_b32 v20, v24, v3
  v_and_b32 v21, v25, v3
  v_and_b32 v22, v26, v3
  v_and_b32 v23, v27, v3
  s_waitcnt lgkmcnt(3)
  s_nop 0
  v_mfma_f32_16x16x32_bf16 v[28:31], v[20:23], v[120:123], v[28:31]
  v_mfma_f32_16x16x32_bf16 v[32:35], v[20:23], v[124:127], v[32:35]
  v_perm_b32 v3, v43, v43, s30
  v_and_b32 v20, v24, v3
  v_and_b32 v21, v25, v3
  v_and_b32 v22, v26, v3
  v_and_b32 v23, v27, v3
  s_waitcnt lgkmcnt(1)
  s_nop 0
  v_mfma_f32_16x16x32_bf16 v[28:31], v[20:23], v[44:47], v[28:31]
  v_mfma_f32_16x16x32_bf16 v[32:35], v[20:23], v[48:51], v[32:35]
  v_perm_b32 v3, v43, v43, s31
  v_and_b32 v20, v24, v3
  v_and_b32 v21, v25, v3
  v_and_b32 v22, v26, v3
  v_and_b32 v23, v27, v3
  s_waitcnt lgkmcnt(0)
  s_waitcnt vmcnt(14)
  v_mfma_f32_16x16x32_bf16 v[28:31], v[20:23], v[52:55], v[28:31]
  v_mfma_f32_16x16x32_bf16 v[32:35], v[20:23], v[56:59], v[32:35]
  v_lshrrev_b32 v2, 8, v0
  v_and_b32 v3, 0xf0, v0
  v_lshlrev_b32 v3, 1, v3
  v_and_b32 v5, 1, v2
  v_lshl_add_u32 v5, v5, 4, v3
  v_add_u32 v5, s37, v5
  s_mov_b32 exec_lo, 0x00ff00ff
  s_mov_b32 exec_hi, 0xff00ff00
  ds_write_b128 v5, v[28:31]
  ds_write_b128 v5, v[32:35] offset:512
  s_mov_b64 exec, -1
  s_xor_b32 s26, s50, 32768
  v_add_u32 v5, s26, v1
  v_lshl_add_u32 v3, v2, 4, v3
  s_waitcnt lgkmcnt(0)
  s_barrier
  ds_read2st64_b32 v[36:37], v5 offset0:0 offset1:1
  ds_read2st64_b32 v[44:45], v5 offset0:2 offset1:3
  ds_read2st64_b32 v[38:39], v5 offset0:32 offset1:33
  ds_read2st64_b32 v[46:47], v5 offset0:34 offset1:35
  ds_read2st64_b32 v[40:41], v5 offset0:64 offset1:65
  ds_read2st64_b32 v[48:49], v5 offset0:66 offset1:67
  ds_read2st64_b32 v[42:43], v5 offset0:96 offset1:97
  ds_read2st64_b32 v[50:51], v5 offset0:98 offset1:99
  s_waitcnt lgkmcnt(0)
  v_add_f32 v36, v36, v40
  v_add_f32 v37, v37, v41
  v_add_f32 v38, v38, v42
  v_add_f32 v39, v39, v43
  v_add_f32 v44, v44, v48
  v_add_f32 v45, v45, v49
  v_add_f32 v46, v46, v50
  v_add_f32 v47, v47, v51
  v_add_f32 v36, v36, v38
  v_add_f32 v37, v37, v39
  v_add_f32 v44, v44, v46
  v_add_f32 v45, v45, v47
  v_add_f32 v36, v36, v37
  v_add_f32 v44, v44, v45
  v_cvt_pk_bf16_f32 v36, 0, v36
  v_cvt_pk_bf16_f32 v44, 0, v44
  v_mul_f32 v40, 0xbfb8aa3b, v36
  v_exp_f32 v40, v40
  s_nop 0
  v_add_f32 v40, 1.0, v40
  v_rcp_f32 v40, v40
  s_nop 0
  v_mul_f32 v36, v36, v40
  v_cvt_pk_bf16_f32 v36, 0, v36
  v_mul_f32 v36, v36, v44
  v_cvt_pk_bf16_f32 v36, v36, v36
  s_lshl_b32 s26, s17, 8
  s_add_u32 s26, s26, 161792
  v_add_u32 v5, s26, v1
  ds_write_b32 v5, v36
  v_mul_u32_u24 v5, 56, v2
  v_add_u32 v5, s26, v5
  ds_read_b64 v[36:37], v5 offset:0
  ds_read_b64 v[38:39], v5 offset:8
  ds_read_b64 v[40:41], v5 offset:16
  ds_read_b64 v[42:43], v5 offset:24
  ds_read_b64 v[44:45], v5 offset:32
  ds_read_b64 v[46:47], v5 offset:40
  ds_read_b64 v[48:49], v5 offset:48
  s_waitcnt lgkmcnt(0)
  v_and_b32 v20, v24, v36
  v_and_b32 v21, v25, v36
  v_and_b32 v22, v26, v36
  v_and_b32 v23, v27, v36
  s_waitcnt vmcnt(13)
  s_nop 0
  v_mfma_f32_16x16x32_bf16 v[28:31], v[20:23], v[60:63], 0
  v_and_b32 v32, v24, v37
  v_and_b32 v33, v25, v37
  v_and_b32 v34, v26, v37
  v_and_b32 v35, v27, v37
  s_waitcnt vmcnt(12)
  s_nop 0
  v_mfma_f32_16x16x32_bf16 v[28:31], v[32:35], v[64:67], v[28:31]
  v_and_b32 v20, v24, v38
  v_and_b32 v21, v25, v38
  v_and_b32 v22, v26, v38
  v_and_b32 v23, v27, v38
  s_waitcnt vmcnt(11)
  s_nop 0
  v_mfma_f32_16x16x32_bf16 v[28:31], v[20:23], v[68:71], v[28:31]
  v_and_b32 v32, v24, v39
  v_and_b32 v33, v25, v39
  v_and_b32 v34, v26, v39
  v_and_b32 v35, v27, v39
  s_waitcnt vmcnt(10)
  s_nop 0
  v_mfma_f32_16x16x32_bf16 v[28:31], v[32:35], v[72:75], v[28:31]
  v_and_b32 v20, v24, v40
  v_and_b32 v21, v25, v40
  v_and_b32 v22, v26, v40
  v_and_b32 v23, v27, v40
  s_waitcnt vmcnt(9)
  s_nop 0
  v_mfma_f32_16x16x32_bf16 v[28:31], v[20:23], v[76:79], v[28:31]
  v_and_b32 v32, v24, v41
  v_and_b32 v33, v25, v41
  v_and_b32 v34, v26, v41
  v_and_b32 v35, v27, v41
  s_waitcnt vmcnt(8)
  s_nop 0
  v_mfma_f32_16x16x32_bf16 v[28:31], v[32:35], v[80:83], v[28:31]
  v_and_b32 v20, v24, v42
  v_and_b32 v21, v25, v42
  v_and_b32 v22, v26, v42
  v_and_b32 v23, v27, v42
  s_waitcnt vmcnt(7)
  s_nop 0
  v_mfma_f32_16x16x32_bf16 v[28:31], v[20:23], v[84:87], v[28:31]
  v_and_b32 v32, v24, v43
  v_and_b32 v33, v25, v43
  v_and_b32 v34, v26, v43
  v_and_b32 v35, v27, v43
  s_waitcnt vmcnt(6)
  s_nop 0
  v_mfma_f32_16x16x32_bf16 v[28:31], v[32:35], v[88:91], v[28:31]
  v_and_b32 v20, v24, v44
  v_and_b32 v21, v25, v44
  v_and_b32 v22, v26, v44
  v_and_b32 v23, v27, v44
  s_waitcnt vmcnt(5)
  s_nop 0
  v_mfma_f32_16x16x32_bf16 v[28:31], v[20:23], v[92:95], v[28:31]
  v_and_b32 v32, v24, v45
  v_and_b32 v33, v25, v45
  v_and_b32 v34, v26, v45
  v_and_b32 v35, v27, v45
  s_waitcnt vmcnt(4)
  s_nop 0
  v_mfma_f32_16x16x32_bf16 v[28:31], v[32:35], v[96:99], v[28:31]
  v_and_b32 v20, v24, v46
  v_and_b32 v21, v25, v46
  v_and_b32 v22, v26, v46
  v_and_b32 v23, v27, v46
  s_waitcnt vmcnt(3)
  s_nop 0
  v_mfma_f32_16x16x32_bf16 v[28:31], v[20:23], v[100:103], v[28:31]
  v_and_b32 v32, v24, v47
  v_and_b32 v33, v25, v47
  v_and_b32 v34, v26, v47
  v_and_b32 v35, v27, v47
  s_waitcnt vmcnt(2)
  s_nop 0
  v_mfma_f32_16x16x32_bf16 v[28:31], v[32:35], v[104:107], v[28:31]
  v_and_b32 v20, v24, v48
  v_and_b32 v21, v25, v48
  v_and_b32 v22, v26, v48
  v_and_b32 v23, v27, v48
  s_waitcnt vmcnt(1)
  s_nop 0
  v_mfma_f32_16x16x32_bf16 v[28:31], v[20:23], v[108:111], v[28:31]
  v_and_b32 v32, v24, v49
  v_and_b32 v33, v25, v49
  v_and_b32 v34, v26, v49
  v_and_b32 v35, v27, v49
  s_waitcnt vmcnt(0)
  s_nop 0
  v_mfma_f32_16x16x32_bf16 v[28:31], v[32:35], v[112:115], v[28:31]
  v_lshrrev_b32 v3, 1, v3
  s_lshl_b32 s26, s47, 7
  s_add_u32 s26, s26, s57
  s_lshl_b32 s26, s26, 8
  s_add_u32 s26, s26, 244318208
  s_nop 2
  v_cvt_pk_bf16_f32 v28, v28, v29
  v_cvt_pk_bf16_f32 v29, v30, v31
  v_min_u32 v28, -2, v28
  v_min_u32 v29, -2, v29
  s_mov_b32 exec_hi, 0
  buffer_store_dwordx2 v[28:29], v3, s[4:7], s26 offen sc1
  s_mov_b32 exec_hi, -1
  v_lshrrev_b32 v7, 7, v0
  v_lshlrev_b32 v7, 12, v7
  v_and_b32 v2, 1023, v9
  s_lshl_b32 s26, s17, 10
  v_add3_u32 v7, v7, v2, s26
  v_mov_b32 v116, 0
  v_lshrrev_b32 v24, 9, v0
  v_lshlrev_b32 v24, 4, v24
  v_and_b32 v25, 0xf0, v0
  v_xor_b32 v24, v24, v25
  v_and_b32 v25, 0x1f0, v0
  v_lshl_add_u32 v24, v25, 6, v24
  v_xor_b32 v120, 0, v24
  v_xor_b32 v121, 32, v24
  v_xor_b32 v122, 64, v24
  v_xor_b32 v123, 96, v24
  v_xor_b32 v124, 128, v24
  v_xor_b32 v125, 160, v24
  v_xor_b32 v126, 192, v24
  v_xor_b32 v127, 224, v24
  s_and_b32 s26, s17, 1
  s_lshl_b32 s26, s26, 7
  v_xor_b32 v24, s26, v0
  v_xor_b32 v12, 0, v24
  v_xor_b32 v13, 16, v24
  v_xor_b32 v14, 32, v24
  v_xor_b32 v15, 48, v24
  v_xor_b32 v16, 64, v24
  v_xor_b32 v17, 80, v24
  v_xor_b32 v18, 96, v24
  v_xor_b32 v19, 112, v24
  s_branch q_cold_91
q_patch_88:
  s_add_u32 s44, s44, 33554432
  s_lshl_b32 s77, s52, 11
  s_add_u32 s77, s77, 159383552
  s_add_u32 s51, s51, 262144
  buffer_store_dwordx4 v[100:103], v8, s[4:7], s77 offen offset:0 sc1
  buffer_store_dwordx4 v[104:107], v8, s[4:7], s77 offen offset:512 sc1
  buffer_store_dwordx4 v[108:111], v8, s[4:7], s44 offen offset:0 sc1
  buffer_store_dwordx4 v[112:115], v8, s[4:7], s44 offen offset:512 sc1
  v_cvt_pk_bf16_f32 v20, v36, v37
  v_cvt_pk_bf16_f32 v21, v38, v39
  v_cvt_pk_bf16_f32 v22, v44, v45
  v_cvt_pk_bf16_f32 v23, v46, v47
  buffer_store_dwordx4 v[20:23], v8, s[4:7], s44 offen offset:2048 sc1
  v_cvt_pk_bf16_f32 v24, v40, v41
  v_cvt_pk_bf16_f32 v25, v42, v43
  v_cvt_pk_bf16_f32 v26, v48, v49
  v_cvt_pk_bf16_f32 v27, v50, v51
  buffer_store_dwordx4 v[24:27], v8, s[4:7], s44 offen offset:2560 sc1
  s_cmp_lt_u32 s47, 64
  s_cselect_b32 s26, 2, 0
  s_add_u32 s26, s26, s47
  s_lshl_b32 s26, s26, 12
  s_add_u32 s26, s26, 243261440
  s_mov_b64 exec, 0xffffff
  buffer_load_dword v116, v7, s[4:7], s26 offen sc1
  s_mov_b64 exec, -1
  s_lshl_b32 s26, s61, 21
  s_lshl_b32 s27, s59, 10
  s_add_u32 s26, s26, s27
  s_add_u32 s27, s26, 20971520
  s_add_u32 s28, s26, 27262976
  s_lshl_b32 s26, s46, 7
  s_add_u32 s26, s26, s17
  s_lshl_b32 s26, s26, 8
  s_add_u32 s26, s26, 244318208
  v_lshrrev_b32 v2, 8, v0
  v_and_b32 v3, 0xf0, v0
  v_lshl_add_u32 v5, v2, 10, v3
  buffer_load_dwordx4 v[36:39], v0, s[4:7], s27 offen sc1
  buffer_load_dwordx4 v[40:43], v0, s[4:7], s28 offen sc1
  s_mov_b32 s53, 0
m_w_100:
  s_add_u32 s27, s26, 0
  buffer_load_dwordx4 v[60:63], v5, s[4:7], s27 offen sc1
  s_add_u32 s27, s26, 4096
  buffer_load_dwordx4 v[64:67], v5, s[4:7], s27 offen sc1
  s_add_u32 s27, s26, 8192
  buffer_load_dwordx4 v[68:71], v5, s[4:7], s27 offen sc1
  s_add_u32 s27, s26, 12288
  buffer_load_dwordx4 v[72:75], v5, s[4:7], s27 offen sc1
  s_add_u32 s27, s26, 16384
  buffer_load_dwordx4 v[76:79], v5, s[4:7], s27 offen sc1
  s_add_u32 s27, s26, 20480
  buffer_load_dwordx4 v[80:83], v5, s[4:7], s27 offen sc1
  s_add_u32 s27, s26, 24576
  buffer_load_dwordx4 v[84:87], v5, s[4:7], s27 offen sc1
  s_add_u32 s27, s26, 28672
  buffer_load_dwordx4 v[88:91], v5, s[4:7], s27 offen sc1
  s_add_u32 s53, s53, 1
  s_cmp_gt_u32 s53, 1048576
  s_cbranch_scc1 q_fail_87
  s_mov_b32 vcc_lo, 0xaaaaaaaa
  s_mov_b32 vcc_hi, 0xaaaaaaaa
  v_mov_b32 v28, 0x3f80
  v_mov_b32 v20, 1.0
  v_cndmask_b32 v28, v28, v20, vcc
  s_mov_b32 vcc_lo, 0x30003
  s_mov_b32 vcc_hi, 0x30003
  v_cndmask_b32 v20, 0, v28, vcc
  s_mov_b32 vcc_lo, 0xc000c
  s_mov_b32 vcc_hi, 0xc000c
  v_cndmask_b32 v21, 0, v28, vcc
  s_mov_b32 vcc_lo, 0x300030
  s_mov_b32 vcc_hi, 0x300030
  v_cndmask_b32 v22, 0, v28, vcc
  s_mov_b32 vcc_lo, 0xc000c0
  s_mov_b32 vcc_hi, 0xc000c0
  v_cndmask_b32 v23, 0, v28, vcc
  s_waitcnt vmcnt(7)
  s_nop 0
  v_mfma_f32_16x16x32_bf16 v[28:31], v[20:23], v[60:63], 0
  v_max3_u32 v44, v60, v61, 0
  v_max3_u32 v44, v62, v63, v44
  s_waitcnt vmcnt(6)
  v_mfma_f32_16x16x32_bf16 v[28:31], v[20:23], v[64:67], v[28:31]
  v_max3_u32 v44, v64, v65, v44
  v_max3_u32 v44, v66, v67, v44
  s_waitcnt vmcnt(5)
  v_mfma_f32_16x16x32_bf16 v[28:31], v[20:23], v[68:71], v[28:31]
  v_max3_u32 v44, v68, v69, v44
  v_max3_u32 v44, v70, v71, v44
  s_waitcnt vmcnt(4)
  v_mfma_f32_16x16x32_bf16 v[28:31], v[20:23], v[72:75], v[28:31]
  v_max3_u32 v44, v72, v73, v44
  v_max3_u32 v44, v74, v75, v44
  s_waitcnt vmcnt(3)
  v_mfma_f32_16x16x32_bf16 v[28:31], v[20:23], v[76:79], v[28:31]
  v_max3_u32 v44, v76, v77, v44
  v_max3_u32 v44, v78, v79, v44
  s_waitcnt vmcnt(2)
  v_mfma_f32_16x16x32_bf16 v[28:31], v[20:23], v[80:83], v[28:31]
  v_max3_u32 v44, v80, v81, v44
  v_max3_u32 v44, v82, v83, v44
  s_waitcnt vmcnt(1)
  v_mfma_f32_16x16x32_bf16 v[28:31], v[20:23], v[84:87], v[28:31]
  v_max3_u32 v44, v84, v85, v44
  v_max3_u32 v44, v86, v87, v44
  s_waitcnt vmcnt(0)
  v_mfma_f32_16x16x32_bf16 v[28:31], v[20:23], v[88:91], v[28:31]
  v_max3_u32 v44, v88, v89, v44
  v_max3_u32 v44, v90, v91, v44
  v_cmp_eq_u32 vcc, -1, v44
  s_cbranch_vccnz m_w_100
  v_lshlrev_b32 v3, 1, v3
  v_lshl_add_u32 v3, v2, 4, v3
  s_lshl_b32 s26, s17, 9
  s_add_u32 s26, s26, 159744
  v_add_u32 v3, s26, v3
  s_mov_b32 exec_hi, 0
  ds_write_b128 v3, v[28:31]
  s_mov_b32 exec_hi, -1
  v_lshlrev_b32 v3, 1, v0
  v_add_u32 v3, 159744, v3
  v_lshlrev_b32 v44, 16, v36
  v_and_b32 v45, 0xffff0000, v36
  v_lshlrev_b32 v46, 16, v37
  v_and_b32 v47, 0xffff0000, v37
  v_lshlrev_b32 v48, 16, v38
  v_and_b32 v49, 0xffff0000, v38
  v_lshlrev_b32 v50, 16, v39
  v_and_b32 v51, 0xffff0000, v39
  v_lshlrev_b32 v52, 16, v40
  v_and_b32 v53, 0xffff0000, v40
  v_lshlrev_b32 v54, 16, v41
  v_and_b32 v55, 0xffff0000, v41
  v_lshlrev_b32 v56, 16, v42
  v_and_b32 v57, 0xffff0000, v42
  v_lshlrev_b32 v58, 16, v43
  v_and_b32 v59, 0xffff0000, v43
  s_waitcnt lgkmcnt(0)
  s_barrier
  s_cmp_lg_u32 s17, 0
  s_cbranch_scc1 m_done_99
  ds_read_b128 v[28:31], v3
  ds_read_b128 v[32:35], v3 offset:16
  s_and_b32 s29, s58, 0xffff0000
  s_xor_b32 s27, s29, 0x80000000
  s_xor_b32 s28, s29, 0xffff0000
  s_bitcmp1_b32 s29, 31
  s_cselect_b32 s29, s27, s28
  v_mov_b32 v36, s29
  v_mul_f32 v36, 0xbfb8aa3b, v36
  v_exp_f32 v36, v36
  s_nop 0
  v_add_f32 v36, 1.0, v36
  v_rcp_f32 v36, v36
  s_nop 0
  v_cvt_pk_bf16_f32 v36, 0, v36
  s_waitcnt lgkmcnt(0)
  v_cvt_pk_bf16_f32 v28, 0, v28
  v_cvt_pk_bf16_f32 v29, 0, v29
  v_cvt_pk_bf16_f32 v30, 0, v30
  v_cvt_pk_bf16_f32 v31, 0, v31
  v_cvt_pk_bf16_f32 v32, 0, v32
  v_cvt_pk_bf16_f32 v33, 0, v33
  v_cvt_pk_bf16_f32 v34, 0, v34
  v_cvt_pk_bf16_f32 v35, 0, v35
  v_mul_f32 v28, v28, v36
  v_mul_f32 v29, v29, v36
  v_mul_f32 v30, v30, v36
  v_mul_f32 v31, v31, v36
  v_mul_f32 v32, v32, v36
  v_mul_f32 v33, v33, v36
  v_mul_f32 v34, v34, v36
  v_mul_f32 v35, v35, v36
  v_cvt_pk_bf16_f32 v28, 0, v28
  v_cvt_pk_bf16_f32 v29, 0, v29
  v_cvt_pk_bf16_f32 v30, 0, v30
  v_cvt_pk_bf16_f32 v31, 0, v31
  v_cvt_pk_bf16_f32 v32, 0, v32
  v_cvt_pk_bf16_f32 v33, 0, v33
  v_cvt_pk_bf16_f32 v34, 0, v34
  v_cvt_pk_bf16_f32 v35, 0, v35
  v_add_f32 v28, v28, v52
  v_add_f32 v29, v29, v53
  v_add_f32 v30, v30, v54
  v_add_f32 v31, v31, v55
  v_add_f32 v32, v32, v56
  v_add_f32 v33, v33, v57
  v_add_f32 v34, v34, v58
  v_add_f32 v35, v35, v59
  v_cvt_pk_bf16_f32 v28, 0, v28
  v_cvt_pk_bf16_f32 v29, 0, v29
  v_cvt_pk_bf16_f32 v30, 0, v30
  v_cvt_pk_bf16_f32 v31, 0, v31
  v_cvt_pk_bf16_f32 v32, 0, v32
  v_cvt_pk_bf16_f32 v33, 0, v33
  v_cvt_pk_bf16_f32 v34, 0, v34
  v_cvt_pk_bf16_f32 v35, 0, v35
  v_add_f32 v44, v44, v28
  v_add_f32 v45, v45, v29
  v_add_f32 v46, v46, v30
  v_add_f32 v47, v47, v31
  v_add_f32 v48, v48, v32
  v_add_f32 v49, v49, v33
  v_add_f32 v50, v50, v34
  v_add_f32 v51, v51, v35
  v_cvt_pk_bf16_f32 v40, v44, v45
  v_cvt_pk_bf16_f32 v41, v46, v47
  v_cvt_pk_bf16_f32 v42, v48, v49
  v_cvt_pk_bf16_f32 v43, v50, v51
  v_lshlrev_b32 v44, 16, v40
  v_and_b32 v45, 0xffff0000, v40
  v_lshlrev_b32 v46, 16, v41
  v_and_b32 v47, 0xffff0000, v41
  v_lshlrev_b32 v48, 16, v42
  v_and_b32 v49, 0xffff0000, v42
  v_lshlrev_b32 v50, 16, v43
  v_and_b32 v51, 0xffff0000, v43
  s_lshl_b32 s27, s46, 5
  s_add_u32 s27, s27, s16
  s_lshl_b32 s27, s27, 10
  s_add_u32 s27, s27, 33554432
  buffer_store_dwordx4 v[40:43], v0, s[4:7], s27 offen sc1
  v_add_f32 v60, v44, v45
  v_mul_f32 v61, v44, v44
  v_add_f32 v62, v46, v47
  v_mul_f32 v63, v45, v45
  v_fmac_f32 v61, v46, v46
  v_fmac_f32 v63, v47, v47
  v_add_f32 v60, v60, v48
  v_fmac_f32 v61, v48, v48
  v_add_f32 v62, v62, v49
  v_fmac_f32 v63, v49, v49
  v_add_f32 v60, v60, v50
  v_fmac_f32 v61, v50, v50
  v_add_f32 v62, v62, v51
  v_fmac_f32 v63, v51, v51
  v_add_f32 v60, v60, v62
  v_add_f32 v61, v61, v63
  s_nop 0
  v_add_f32_dpp v60, v60, v60 row_ror:8 row_mask:0xf bank_mask:0xf
  v_add_f32_dpp v61, v61, v61 row_ror:8 row_mask:0xf bank_mask:0xf
  s_nop 0
  v_add_f32_dpp v60, v60, v60 row_ror:4 row_mask:0xf bank_mask:0xf
  v_add_f32_dpp v61, v61, v61 row_ror:4 row_mask:0xf bank_mask:0xf
  s_nop 0
  v_add_f32_dpp v60, v60, v60 row_ror:2 row_mask:0xf bank_mask:0xf
  v_add_f32_dpp v61, v61, v61 row_ror:2 row_mask:0xf bank_mask:0xf
  s_nop 0
  v_add_f32_dpp v60, v60, v60 row_ror:1 row_mask:0xf bank_mask:0xf
  v_add_f32_dpp v61, v61, v61 row_ror:1 row_mask:0xf bank_mask:0xf
  v_mov_b32 v64, v60
  v_mov_b32 v65, v61
  s_nop 0
  v_permlane16_swap_b32 v60, v64
  v_permlane16_swap_b32 v61, v65
  v_add_f32 v60, v60, v64
  v_add_f32 v61, v61, v65
  v_mov_b32 v64, v60
  v_mov_b32 v65, v61
  s_nop 0
  v_permlane32_swap_b32 v60, v64
  v_permlane32_swap_b32 v61, v65
  v_add_f32 v60, v60, v64
  v_add_f32 v61, v61, v65
  v_mul_f32 v60, 0x3b000000, v60
  v_mul_f32 v61, 0x3b000000, v61
  v_fma_f32 v61, -v60, v60, v61
  v_cvt_pk_bf16_f32 v60, 0, v60
  v_max_f32 v61, 0, v61
  v_sub_f32 v64, v44, v60
  v_sub_f32 v65, v45, v60
  v_cvt_pk_bf16_f32 v61, 0, v61
  v_sub_f32 v66, v46, v60
  v_sub_f32 v67, v47, v60
  v_add_f32 v61, 0x3727c5ac, v61
  v_sub_f32 v68, v48, v60
  v_sub_f32 v69, v49, v60
  v_cvt_pk_bf16_f32 v61, 0, v61
  v_sub_f32 v70, v50, v60
  v_sub_f32 v71, v51, v60
  v_sqrt_f32 v61, v61
  v_cvt_pk_bf16_f32 v64, 0, v64
  v_cvt_pk_bf16_f32 v65, 0, v65
  v_cvt_pk_bf16_f32 v61, 0, v61
  v_cvt_pk_bf16_f32 v66, 0, v66
  v_cvt_pk_bf16_f32 v67, 0, v67
  v_rcp_f32 v61, v61
  v_cvt_pk_bf16_f32 v68, 0, v68
  v_cvt_pk_bf16_f32 v69, 0, v69
  v_cvt_pk_bf16_f32 v70, 0, v70
  v_cvt_pk_bf16_f32 v71, 0, v71
  v_mul_f32 v64, v64, v61
  v_mul_f32 v65, v65, v61
  v_mul_f32 v66, v66, v61
  v_mul_f32 v67, v67, v61
  v_mul_f32 v68, v68, v61
  v_mul_f32 v69, v69, v61
  v_mul_f32 v70, v70, v61
  v_mul_f32 v71, v71, v61
  v_cvt_pk_bf16_f32 v72, v64, v65
  v_cvt_pk_bf16_f32 v73, v66, v67
  v_cvt_pk_bf16_f32 v74, v68, v69
  v_cvt_pk_bf16_f32 v75, v70, v71
  v_lshl_add_u32 v3, v0, 2, s50
  v_mov_b64 v[60:61], 0
  v_mov_b64 v[64:65], 0
  v_mov_b64 v[68:69], 0
  v_mov_b32 v62, v72
  v_mov_b32 v63, v74
  v_mov_b32 v66, v73
  v_mov_b32 v67, v75
  ds_write_b128 v3, v[62:65] offset:4096
  ds_write_b128 v3, v[60:63] offset:4112
  ds_write_b128 v3, v[66:69] offset:4128
  ds_write_b128 v3, v[64:67] offset:4144
m_done_99:
  s_cmp_lg_u32 s48, 0
  s_cbranch_scc1 q_nb_101
  v_cmp_eq_u32 vcc, 0, v116
  v_max_u32_dpp v117, v116, v116 quad_perm:[1,0,3,2] row_mask:0xf bank_mask:0xf
  s_and_b32 s48, vcc_lo, 0xffffff
  s_cselect_b32 s48, 0, -1
  v_max_u32_dpp v117, v117, v117 quad_perm:[2,3,0,1] row_mask:0xf bank_mask:0xf
  s_nop 1
  v_max_u32_dpp v117, v117, v117 row_half_mirror row_mask:0xf bank_mask:0xf
  v_and_b32 v117, s48, v117
  s_cmp_eq_u32 s48, 0
  s_cbranch_scc1 q_nb_101
  s_and_b32 s63, s47, 127
  s_lshl_b32 s63, s63, 15
  s_xor_b32 s27, s50, 32768
  s_add_u32 m0, s27, s54
  s_add_u32 s63, s63, s54
  s_add_u32 s63, s63, 6291456
  buffer_load_dwordx4 v12, s[4:7], s63 offen offset:0 sc1 lds
  buffer_load_dwordx4 v13, s[4:7], s63 offen offset:1024 sc1 lds
  buffer_load_dwordx4 v14, s[4:7], s63 offen offset:2048 sc1 lds
  buffer_load_dwordx4 v15, s[4:7], s63 offen offset:3072 sc1 lds
  s_add_u32 m0, m0, 4096
  s_add_u32 s63, s63, 4096
  buffer_load_dwordx4 v16, s[4:7], s63 offen offset:0 sc1 lds
  buffer_load_dwordx4 v17, s[4:7], s63 offen offset:1024 sc1 lds
  buffer_load_dwordx4 v18, s[4:7], s63 offen offset:2048 sc1 lds
  buffer_load_dwordx4 v19, s[4:7], s63 offen offset:3072 sc1 lds
q_nb_101:
  v_lshrrev_b32 v2, 8, v0
  v_and_b32 v3, 48, v0
  v_lshl_add_u32 v3, v2, 6, v3
  v_add_u32 v3, s50, v3
  s_mov_b32 vcc_lo, 0xcccccccc
  s_mov_b32 vcc_hi, 0xcccccccc
  v_mov_b32 v32, 0x4444
  v_mov_b32 v33, 0xeeee
  v_cndmask_b32 v32, v32, v33, vcc
  s_waitcnt lgkmcnt(0)
  s_barrier
  ds_read_b128 v[36:39], v3 offset:4096
  ds_read_b128 v[40:43], v3 offset:4352
  ds_read_b128 v[44:47], v3 offset:4608
  ds_read_b128 v[48:51], v3 offset:4864
  ds_read_b128 v[52:55], v3 offset:5120
  ds_read_b128 v[56:59], v3 offset:5376
  ds_read_b128 v[60:63], v3 offset:5632
  ds_read_b128 v[64:67], v3 offset:5888
  v_mov_b64 v[20:21], 0
  v_mov_b64 v[22:23], 0
  v_mov_b64 v[24:25], 0
  v_mov_b64 v[26:27], 0
  v_mov_b64 v[28:29], 0
  v_mov_b64 v[30:31], 0
  s_waitcnt lgkmcnt(7)
  v_smfmac_f32_16x16x64_bf16 v[20:23], v[36:39], v[128:135], v32
  ds_read_b128 v[68:71], v3 offset:6144
  v_smfmac_f32_16x16x64_bf16 v[24:27], v[36:39], a[0:7], v32
  s_and_b32 s26, s59, 16
  v_smfmac_f32_16x16x64_bf16 v[28:31], v[36:39], a[128:135], v32
  s_lshl_b32 s27, s26, 6
  s_waitcnt lgkmcnt(7)
  v_smfmac_f32_16x16x64_bf16 v[20:23], v[40:43], v[136:143], v32
  ds_read_b128 v[72:75], v3 offset:6400
  v_smfmac_f32_16x16x64_bf16 v[24:27], v[40:43], a[8:15], v32
  s_and_b32 s28, s59, 15
  v_smfmac_f32_16x16x64_bf16 v[28:31], v[40:43], a[136:143], v32
  s_lshl4_add_u32 s27, s28, s27
  s_waitcnt lgkmcnt(7)
  v_smfmac_f32_16x16x64_bf16 v[20:23], v[44:47], v[144:151], v32
  ds_read_b128 v[76:79], v3 offset:6656
  v_smfmac_f32_16x16x64_bf16 v[24:27], v[44:47], a[16:23], v32
  s_add_u32 s77, s77, s27
  v_smfmac_f32_16x16x64_bf16 v[28:31], v[44:47], a[144:151], v32
  s_add_u32 s27, s27, s44
  s_waitcnt lgkmcnt(7)
  v_smfmac_f32_16x16x64_bf16 v[20:23], v[48:51], v[152:159], v32
  ds_read_b128 v[80:83], v3 offset:6912
  v_smfmac_f32_16x16x64_bf16 v[24:27], v[48:51], a[24:31], v32
  s_lshr_b32 s26, s26, 1
  v_smfmac_f32_16x16x64_bf16 v[28:31], v[48:51], a[152:159], v32
  s_and_b32 s28, s59, 3
  s_waitcnt lgkmcnt(7)
  v_smfmac_f32_16x16x64_bf16 v[20:23], v[52:55], v[160:167], v32
  ds_read_b128 v[84:87], v3 offset:7168
  v_smfmac_f32_16x16x64_bf16 v[24:27], v[52:55], a[32:39], v32
  s_lshl1_add_u32 s26, s28, s26
  v_smfmac_f32_16x16x64_bf16 v[28:31], v[52:55], a[160:167], v32
  s_and_b32 s28, s59, 12
  s_waitcnt lgkmcnt(7)
  v_smfmac_f32_16x16x64_bf16 v[20:23], v[56:59], v[168:175], v32
  ds_read_b128 v[88:91], v3 offset:7424
  v_smfmac_f32_16x16x64_bf16 v[24:27], v[56:59], a[40:47], v32
  s_lshl_b32 s28, s28, 6
  v_smfmac_f32_16x16x64_bf16 v[28:31], v[56:59], a[168:175], v32
  s_add_u32 s26, s26, s28
  s_waitcnt lgkmcnt(7)
  v_smfmac_f32_16x16x64_bf16 v[20:23], v[60:63], v[176:183], v32
  ds_read_b128 v[92:95], v3 offset:7680
  v_smfmac_f32_16x16x64_bf16 v[24:27], v[60:63], a[48:55], v32
  s_add_u32 s26, s26, s44
  v_smfmac_f32_16x16x64_bf16 v[28:31], v[60:63], a[176:183], v32
  v_and_b32 v2, 0xc0, v0
  s_waitcnt lgkmcnt(7)
  v_smfmac_f32_16x16x64_bf16 v[20:23], v[64:67], v[184:191], v32
  ds_read_b128 v[96:99], v3 offset:7936
  v_smfmac_f32_16x16x64_bf16 v[24:27], v[64:67], a[56:63], v32
  v_and_b32 v5, 12, v1
  v_smfmac_f32_16x16x64_bf16 v[28:31], v[64:67], a[184:191], v32
  v_lshrrev_b32 v5, 1, v5
  s_waitcnt lgkmcnt(7)
  v_smfmac_f32_16x16x64_bf16 v[20:23], v[68:71], v[192:199], v32
  v_lshl_add_u32 v2, v2, 2, v5
  v_smfmac_f32_16x16x64_bf16 v[24:27], v[68:71], a[64:71], v32
  v_smfmac_f32_16x16x64_bf16 v[28:31], v[68:71], a[192:199], v32
  s_waitcnt lgkmcnt(6)
  v_smfmac_f32_16x16x64_bf16 v[20:23], v[72:75], v[200:207], v32
  v_smfmac_f32_16x16x64_bf16 v[24:27], v[72:75], a[72:79], v32
  v_smfmac_f32_16x16x64_bf16 v[28:31], v[72:75], a[200:207], v32
  s_waitcnt lgkmcnt(5)
  v_smfmac_f32_16x16x64_bf16 v[20:23], v[76:79], v[208:215], v32
  v_smfmac_f32_16x16x64_bf16 v[24:27], v[76:79], a[80:87], v32
  v_smfmac_f32_16x16x64_bf16 v[28:31], v[76:79], a[208:215], v32
  s_waitcnt lgkmcnt(4)
  v_smfmac_f32_16x16x64_bf16 v[20:23], v[80:83], v[216:223], v32
  v_smfmac_f32_16x16x64_bf16 v[24:27], v[80:83], a[88:95], v32
  v_smfmac_f32_16x16x64_bf16 v[28:31], v[80:83], a[216:223], v32
  s_waitcnt lgkmcnt(3)
  v_smfmac_f32_16x16x64_bf16 v[20:23], v[84:87], v[224:231], v32
  v_smfmac_f32_16x16x64_bf16 v[24:27], v[84:87], a[96:103], v32
  v_smfmac_f32_16x16x64_bf16 v[28:31], v[84:87], a[224:231], v32
  s_waitcnt lgkmcnt(2)
  v_smfmac_f32_16x16x64_bf16 v[20:23], v[88:91], v[232:239], v32
  v_smfmac_f32_16x16x64_bf16 v[24:27], v[88:91], a[104:111], v32
  v_smfmac_f32_16x16x64_bf16 v[28:31], v[88:91], a[232:239], v32
  s_waitcnt lgkmcnt(1)
  v_smfmac_f32_16x16x64_bf16 v[20:23], v[92:95], v[240:247], v32
  v_smfmac_f32_16x16x64_bf16 v[24:27], v[92:95], a[112:119], v32
  v_smfmac_f32_16x16x64_bf16 v[28:31], v[92:95], a[240:247], v32
  s_waitcnt lgkmcnt(0)
  v_smfmac_f32_16x16x64_bf16 v[20:23], v[96:99], v[248:255], v32
  v_smfmac_f32_16x16x64_bf16 v[24:27], v[96:99], a[120:127], v32
  v_smfmac_f32_16x16x64_bf16 v[28:31], v[96:99], a[248:255], v32
  v_add_f32 v20, v20, v22
  v_add_f32 v21, v21, v23
  s_nop 1
  v_add_f32 v24, v24, v26
  v_add_f32 v25, v25, v27
  s_nop 1
  v_add_f32 v28, v28, v30
  v_add_f32 v29, v29, v31
  v_mul_f32 v20, s24, v20
  v_mul_f32 v21, s24, v21
  v_cvt_pk_bf16_f32 v20, v20, v21
  v_cvt_pk_bf16_f32 v24, v24, v25
  v_cvt_pk_bf16_f32 v28, v28, v29
  s_mov_b64 exec, 0xffff
  buffer_store_short v20, v2, s[4:7], s27 offen sc1
  buffer_store_short_d16_hi v20, v2, s[4:7], s27 offen offset:8 sc1
  buffer_store_short v24, v0, s[4:7], s26 offen offset:2048 sc1
  buffer_store_short_d16_hi v24, v0, s[4:7], s26 offen offset:3072 sc1
  buffer_store_short v28, v2, s[4:7], s77 offen sc1
  buffer_store_short_d16_hi v28, v2, s[4:7], s77 offen offset:8 sc1
  s_mov_b64 exec, 3
  s_mov_b32 s62, 0
  s_waitcnt vmcnt(0)
  buffer_store_dword v4, v0, s[4:7], s51 offen sc1
  s_mov_b64 exec, -1
  s_branch q_nxt_93
q_end_84:
  s_waitcnt vmcnt(0)
  s_mov_b64 exec, 1
  buffer_store_dword v4, off, s[4:7], s49 sc1
  s_mov_b64 exec, -1
  s_cmp_lg_u32 s60, 0
  s_cbranch_scc1 q_fail_87
  s_load_dwordx2 s[72:73], s[0:1], 96
  s_mov_b32 s74, 2097152
  s_mov_b32 s75, 0x20000
  s_mov_b32 s58, 0
  s_cmp_eq_u32 s17, 3
  s_cselect_b32 s48, 7, 15
k_fin_102:
  s_load_dwordx2 s[64:65], s[0:1], 72
  s_load_dwordx2 s[68:69], s[0:1], 80
  s_load_dwordx2 s[8:9], s[0:1], 88
  s_mov_b32 s66, 1835008
  s_mov_b32 s70, 1835008
  s_mov_b32 s10, 1835008
  v_lshrrev_b32 v2, 7, v0
  v_and_b32 v3, 0x70, v0
  v_mul_u32_u24 v6, 57344, v2
  v_add_u32 v6, v6, v3
  v_cmp_eq_u32 vcc, 0x70, v3
  v_mov_b32 v3, 0x7ff00000
  s_nop 0
  v_cndmask_b32 v6, v6, v3, vcc
  v_lshrrev_b32 v2, 8, v0
  v_mul_u32_u24 v7, 14336, v2
  v_and_b32 v3, 0xf0, v0
  v_add_u32 v7, v7, v3
  s_mul_i32 s34, s17, 458752
  s_mul_i32 s27, s16, 112
  s_add_u32 s34, s34, s27
  s_mul_i32 s35, s16, 57344
  s_lshl_b32 s27, s17, 8
  s_add_u32 s35, s35, s27
  s_waitcnt lgkmcnt(0)
  s_xor_b32 s37, s50, 32768
  s_add_u32 s37, s37, s54
  s_mov_b32 m0, s37
  s_add_u32 s36, s34, 39424
  buffer_load_dwordx4 v6, s[68:71], s36 offen lds
  s_add_u32 m0, m0, 1024
  s_add_u32 s36, s34, 43008
  buffer_load_dwordx4 v6, s[64:67], s36 offen lds
  s_add_u32 m0, m0, 1024
  s_add_u32 s36, s34, 43008
  buffer_load_dwordx4 v6, s[68:71], s36 offen lds
  s_add_u32 m0, m0, 1024
  s_add_u32 s36, s34, 46592
  buffer_load_dwordx4 v6, s[64:67], s36 offen lds
  s_add_u32 m0, m0, 1024
  s_add_u32 s36, s34, 46592
  buffer_load_dwordx4 v6, s[68:71], s36 offen lds
  s_add_u32 m0, m0, 1024
  s_add_u32 s36, s34, 50176
  buffer_load_dwordx4 v6, s[64:67], s36 offen lds
  s_add_u32 m0, m0, 1024
  s_add_u32 s36, s34, 50176
  buffer_load_dwordx4 v6, s[68:71], s36 offen lds
  s_add_u32 m0, m0, 1024
  s_add_u32 s36, s34, 53760
  buffer_load_dwordx4 v6, s[64:67], s36 offen lds
  s_add_u32 m0, m0, 1024
  s_add_u32 s36, s34, 53760
  buffer_load_dwordx4 v[56:59], v6, s[68:71], s36 offen
  buffer_load_dwordx4 v[60:63], v7, s[8:11], s35 offen offset:0
  buffer_load_dwordx4 v[64:67], v7, s[8:11], s35 offen offset:1024
  buffer_load_dwordx4 v[68:71], v7, s[8:11], s35 offen offset:2048
  buffer_load_dwordx4 v[72:75], v7, s[8:11], s35 offen offset:3072
  s_add_u32 s35, s35, 4096
  buffer_load_dwordx4 v[76:79], v7, s[8:11], s35 offen offset:0
  buffer_load_dwordx4 v[80:83], v7, s[8:11], s35 offen offset:1024
  buffer_load_dwordx4 v[84:87], v7, s[8:11], s35 offen offset:2048
  buffer_load_dwordx4 v[88:91], v7, s[8:11], s35 offen offset:3072
  s_add_u32 s35, s35, 4096
  buffer_load_dwordx4 v[92:95], v7, s[8:11], s35 offen offset:0
  buffer_load_dwordx4 v[96:99], v7, s[8:11], s35 offen offset:1024
  buffer_load_dwordx4 v[100:103], v7, s[8:11], s35 offen offset:2048
  buffer_load_dwordx4 v[104:107], v7, s[8:11], s35 offen offset:3072
  s_add_u32 s35, s35, 4096
  buffer_load_dwordx4 v[108:111], v7, s[8:11], s35 offen offset:0
  buffer_load_dwordx4 v[112:115], v7, s[8:11], s35 offen offset:1024
  s_andn2_b32 s28, 0xfe0, s56
  s_lshl_b32 s28, s28, 7
  s_mov_b32 s29, 243793920
  v_mov_b32 v24, 262144
  s_mov_b32 s53, 0
  s_mov_b32 s33, 3
  v_mov_b32 v53, s58
  s_and_b32 s32, s48, 15
  s_cbranch_scc0 k_x_105
k_w_104:
  s_add_u32 s33, s33, 1
  s_and_b32 s33, s33, 3
  s_bitcmp1_b32 s32, s33
  s_cbranch_scc0 k_w_104
  s_lshl2_add_u32 s26, s33, s17
  s_lshl_b32 s26, s26, 14
  s_add_u32 s27, s26, 8192
  v_add_u32 v22, s26, v9
  v_cmp_le_u32 vcc, s28, v22
  s_nop 1
  v_cndmask_b32 v25, 0, v24, vcc
  v_add_u32 v22, v22, v25
  buffer_load_dword v20, v22, s[4:7], s29 offen sc1
  v_add_u32 v23, s27, v9
  v_cmp_le_u32 vcc, s28, v23
  s_nop 1
  v_cndmask_b32 v25, 0, v24, vcc
  v_add_u32 v23, v23, v25
  buffer_load_dword v21, v23, s[4:7], s29 offen sc1
  s_add_u32 s53, s53, 1
  s_cmp_gt_u32 s53, 1048576
  s_cbranch_scc1 q_fail_87
  s_waitcnt vmcnt(0)
  v_min_u32 v52, v20, v21
  v_max3_u32 v53, v20, v21, v53
  v_cmp_eq_u32 vcc, 0, v52
  s_cbranch_vccnz k_w_104
  s_bitset0_b32 s32, s33
  s_cmp_lg_u32 s32, 0
  s_cbranch_scc1 k_w_104
  v_max_u32_dpp v53, v53, v53 row_ror:8 row_mask:0xf bank_mask:0xf
  s_nop 1
  v_max_u32_dpp v53, v53, v53 row_ror:4 row_mask:0xf bank_mask:0xf
  s_nop 1
  v_max_u32_dpp v53, v53, v53 row_ror:2 row_mask:0xf bank_mask:0xf
  s_nop 1
  v_max_u32_dpp v53, v53, v53 row_ror:1 row_mask:0xf bank_mask:0xf
  v_mov_b32 v52, v53
  s_nop 0
  s_nop 0
  v_permlane16_swap_b32 v53, v52
  v_max_u32 v53, v53, v52
  v_mov_b32 v52, v53
  s_nop 0
  s_nop 0
  v_permlane32_swap_b32 v53, v52
  v_max_u32 v53, v53, v52
k_x_105:
  ds_write_b32 v118, v53 offset:256
  s_waitcnt vmcnt(0) lgkmcnt(0)
  s_barrier
  ds_read_b128 v[20:23], v119 offset:256
  s_waitcnt lgkmcnt(0)
  v_max3_u32 v20, v20, v21, v22
  v_max_u32 v20, v20, v23
  s_nop 0
  v_readfirstlane_b32 s26, v20
  s_cmp_eq_u32 s26, s58
  s_cbranch_scc1 q_fail_87
  s_cmp_eq_u32 s58, 0
  s_mov_b32 s58, s26
  s_cbranch_scc1 k_r_106
  s_cmp_lg_u32 s57, 0
  s_cbranch_scc1 k_r_106
  s_lshl_b32 s26, s59, 10
  buffer_store_dwordx4 a[0:3], v0, s[72:75], s26 offen sc1
k_r_106:
  s_andn2_b32 s26, 0xfe0, s56
  s_andn2_b32 s27, 0xfe0, s58
  s_cmp_lt_u32 s27, s26
  s_cselect_b32 s61, 1, 2
  s_andn2_b32 s59, 0xfff, s58
  s_lshl_b32 s26, s61, 21
  s_lshl_b32 s27, s59, 10
  s_add_u32 s26, s26, s27
  s_lshl_b32 s27, s17, 8
  s_add_u32 s26, s26, s27
  s_add_u32 s26, s26, 27262976
  v_lshrrev_b32 v5, 7, v0
  v_lshlrev_b32 v5, 5, v5
  buffer_load_dwordx4 v[36:39], v5, s[4:7], s26 offen offset:0 sc1
  buffer_load_dwordx4 v[40:43], v5, s[4:7], s26 offen offset:16 sc1
  s_mov_b32 vcc_lo, 0xaaaaaaaa
  s_mov_b32 vcc_hi, 0xaaaaaaaa
  v_mov_b32 v3, 0xffff
  v_mov_b32 v24, 0xffff0000
  v_cndmask_b32 v3, v3, v24, vcc
  s_mov_b32 vcc_lo, 0x3030303
  s_mov_b32 vcc_hi, 0x3030303
  v_cndmask_b32 v24, 0, v3, vcc
  s_mov_b32 vcc_lo, 0xc0c0c0c
  s_mov_b32 vcc_hi, 0xc0c0c0c
  v_cndmask_b32 v25, 0, v3, vcc
  s_mov_b32 vcc_lo, 0x30303030
  s_mov_b32 vcc_hi, 0x30303030
  v_cndmask_b32 v26, 0, v3, vcc
  s_mov_b32 vcc_lo, 0xc0c0c0c0
  s_mov_b32 vcc_hi, 0xc0c0c0c0
  v_cndmask_b32 v27, 0, v3, vcc
  s_mov_b32 s30, 0x01000100
  s_mov_b32 s31, 0x03020302
  s_mul_i32 s26, s17, 23552
  s_add_u32 s26, s26, 65536
  v_add_u32 v5, s26, v0
  v_add_u32 v2, s37, v0
  ds_read_b128 v[44:47], v5 offset:0
  ds_read_b128 v[48:51], v5 offset:1024
  ds_read_b128 v[52:55], v5 offset:2048
  ds_read_b128 v[12:15], v5 offset:3072
  ds_read_b128 v[16:19], v5 offset:4096
  ds_read_b128 v[120:123], v5 offset:5120
  ds_read_b128 v[124:127], v5 offset:6144
  s_waitcnt vmcnt(0)
  v_perm_b32 v3, v36, v36, s30
  v_and_b32 v20, v24, v3
  v_and_b32 v21, v25, v3
  v_and_b32 v22, v26, v3
  v_and_b32 v23, v27, v3
  s_waitcnt lgkmcnt(5)
  s_nop 0
  v_mfma_f32_16x16x32_bf16 v[28:31], v[20:23], v[44:47], 0
  ds_read_b128 v[44:47], v5 offset:7168
  v_mfma_f32_16x16x32_bf16 v[32:35], v[20:23], v[48:51], 0
  ds_read_b128 v[48:51], v5 offset:8192
  v_perm_b32 v3, v36, v36, s31
  v_and_b32 v20, v24, v3
  v_and_b32 v21, v25, v3
  v_and_b32 v22, v26, v3
  v_and_b32 v23, v27, v3
  s_waitcnt lgkmcnt(5)
  s_nop 0
  v_mfma_f32_16x16x32_bf16 v[28:31], v[20:23], v[52:55], v[28:31]
  ds_read_b128 v[52:55], v5 offset:9216
  v_mfma_f32_16x16x32_bf16 v[32:35], v[20:23], v[12:15], v[32:35]
  ds_read_b128 v[12:15], v5 offset:10240
  v_perm_b32 v3, v37, v37, s30
  v_and_b32 v20, v24, v3
  v_and_b32 v21, v25, v3
  v_and_b32 v22, v26, v3
  v_and_b32 v23, v27, v3
  s_waitcnt lgkmcnt(5)
  s_nop 0
  v_mfma_f32_16x16x32_bf16 v[28:31], v[20:23], v[16:19], v[28:31]
  ds_read_b128 v[16:19], v5 offset:11264
  v_mfma_f32_16x16x32_bf16 v[32:35], v[20:23], v[120:123], v[32:35]
  ds_read_b128 v[120:123], v5 offset:12288
  v_perm_b32 v3, v37, v37, s31
  v_and_b32 v20, v24, v3
  v_and_b32 v21, v25, v3
  v_and_b32 v22, v26, v3
  v_and_b32 v23, v27, v3
  s_waitcnt lgkmcnt(5)
  s_nop 0
  v_mfma_f32_16x16x32_bf16 v[28:31], v[20:23], v[124:127], v[28:31]
  ds_read_b128 v[124:127], v5 offset:13312
  v_mfma_f32_16x16x32_bf16 v[32:35], v[20:23], v[44:47], v[32:35]
  ds_read_b128 v[44:47], v5 offset:14336
  v_perm_b32 v3, v38, v38, s30
  v_and_b32 v20, v24, v3
  v_and_b32 v21, v25, v3
  v_and_b32 v22, v26, v3
  v_and_b32 v23, v27, v3
  s_waitcnt lgkmcnt(5)
  s_nop 0
  v_mfma_f32_16x16x32_bf16 v[28:31], v[20:23], v[48:51], v[28:31]
  ds_read_b128 v[48:51], v5 offset:15360
  v_mfma_f32_16x16x32_bf16 v[32:35], v[20:23], v[52:55], v[32:35]
  ds_read_b128 v[52:55], v5 offset:16384
  v_perm_b32 v3, v38, v38, s31
  v_and_b32 v20, v24, v3
  v_and_b32 v21, v25, v3
  v_and_b32 v22, v26, v3
  v_and_b32 v23, v27, v3
  s_waitcnt lgkmcnt(5)
  s_nop 0
  v_mfma_f32_16x16x32_bf16 v[28:31], v[20:23], v[12:15], v[28:31]
  ds_read_b128 v[12:15], v5 offset:17408
  v_mfma_f32_16x16x32_bf16 v[32:35], v[20:23], v[16:19], v[32:35]
  ds_read_b128 v[16:19], v5 offset:18432
  v_perm_b32 v3, v39, v39, s30
  v_and_b32 v20, v24, v3
  v_and_b32 v21, v25, v3
  v_and_b32 v22, v26, v3
  v_and_b32 v23, v27, v3
  s_waitcnt lgkmcnt(5)
  s_nop 0
  v_mfma_f32_16x16x32_bf16 v[28:31], v[20:23], v[120:123], v[28:31]
  ds_read_b128 v[120:123], v5 offset:19456
  v_mfma_f32_16x16x32_bf16 v[32:35], v[20:23], v[124:127], v[32:35]
  ds_read_b128 v[124:127], v5 offset:20480
  v_perm_b32 v3, v39, v39, s31
  v_and_b32 v20, v24, v3
  v_and_b32 v21, v25, v3
  v_and_b32 v22, v26, v3
  v_and_b32 v23, v27, v3
  s_waitcnt lgkmcnt(5)
  s_nop 0
  v_mfma_f32_16x16x32_bf16 v[28:31], v[20:23], v[44:47], v[28:31]
  ds_read_b128 v[44:47], v5 offset:21504
  v_mfma_f32_16x16x32_bf16 v[32:35], v[20:23], v[48:51], v[32:35]
  ds_read_b128 v[48:51], v5 offset:22528
  v_perm_b32 v3, v40, v40, s30
  v_and_b32 v20, v24, v3
  v_and_b32 v21, v25, v3
  v_and_b32 v22, v26, v3
  v_and_b32 v23, v27, v3
  s_waitcnt lgkmcnt(5)
  s_nop 0
  v_mfma_f32_16x16x32_bf16 v[28:31], v[20:23], v[52:55], v[28:31]
  ds_read_b128 v[52:55], v2 offset:0
  v_mfma_f32_16x16x32_bf16 v[32:35], v[20:23], v[12:15], v[32:35]
  ds_read_b128 v[12:15], v2 offset:1024
  v_perm_b32 v3, v40, v40, s31
  v_and_b32 v20, v24, v3
  v_and_b32 v21, v25, v3
  v_and_b32 v22, v26, v3
  v_and_b32 v23, v27, v3
  s_waitcnt lgkmcnt(5)
  s_nop 0
  v_mfma_f32_16x16x32_bf16 v[28:31], v[20:23], v[16:19], v[28:31]
  ds_read_b128 v[16:19], v2 offset:2048
  v_mfma_f32_16x16x32_bf16 v[32:35], v[20:23], v[120:123], v[32:35]
  ds_read_b128 v[120:123], v2 offset:3072
  v_perm_b32 v3, v41, v41, s30
  v_and_b32 v20, v24, v3
  v_and_b32 v21, v25, v3
  v_and_b32 v22, v26, v3
  v_and_b32 v23, v27, v3
  s_waitcnt lgkmcnt(5)
  s_nop 0
  v_mfma_f32_16x16x32_bf16 v[28:31], v[20:23], v[124:127], v[28:31]
  ds_read_b128 v[124:127], v2 offset:4096
  v_mfma_f32_16x16x32_bf16 v[32:35], v[20:23], v[44:47], v[32:35]
  ds_read_b128 v[44:47], v2 offset:5120
  v_perm_b32 v3, v41, v41, s31
  v_and_b32 v20, v24, v3
  v_and_b32 v21, v25, v3
  v_and_b32 v22, v26, v3
  v_and_b32 v23, v27, v3
  s_waitcnt lgkmcnt(5)
  s_nop 0
  v_mfma_f32_16x16x32_bf16 v[28:31], v[20:23], v[48:51], v[28:31]
  ds_read_b128 v[48:51], v2 offset:6144
  v_mfma_f32_16x16x32_bf16 v[32:35], v[20:23], v[52:55], v[32:35]
  ds_read_b128 v[52:55], v2 offset:7168
  v_perm_b32 v3, v42, v42, s30
  v_and_b32 v20, v24, v3
  v_and_b32 v21, v25, v3
  v_and_b32 v22, v26, v3
  v_and_b32 v23, v27, v3
  s_waitcnt lgkmcnt(5)
  s_nop 0
  v_mfma_f32_16x16x32_bf16 v[28:31], v[20:23], v[12:15], v[28:31]
  v_mfma_f32_16x16x32_bf16 v[32:35], v[20:23], v[16:19], v[32:35]
  v_perm_b32 v3, v42, v42, s31
  v_and_b32 v20, v24, v3
  v_and_b32 v21, v25, v3
  v_and_b32 v22, v26, v3
  v_and_b32 v23, v27, v3
  s_waitcnt lgkmcnt(3)
  s_nop 0
  v_mfma_f32_16x16x32_bf16 v[28:31], v[20:23], v[120:123], v[28:31]
  v_mfma_f32_16x16x32_bf16 v[32:35], v[20:23], v[124:127], v[32:35]
  v_perm_b32 v3, v43, v43, s30
  v_and_b32 v20, v24, v3
  v_and_b32 v21, v25, v3
  v_and_b32 v22, v26, v3
  v_and_b32 v23, v27, v3
  s_waitcnt lgkmcnt(1)
  s_nop 0
  v_mfma_f32_16x16x32_bf16 v[28:31], v[20:23], v[44:47], v[28:31]
  v_mfma_f32_16x16x32_bf16 v[32:35], v[20:23], v[48:51], v[32:35]
  v_perm_b32 v3, v43, v43, s31
  v_and_b32 v20, v24, v3
  v_and_b32 v21, v25, v3
  v_and_b32 v22, v26, v3
  v_and_b32 v23, v27, v3
  s_waitcnt lgkmcnt(0)
  s_nop 0
  v_mfma_f32_16x16x32_bf16 v[28:31], v[20:23], v[52:55], v[28:31]
  v_mfma_f32_16x16x32_bf16 v[32:35], v[20:23], v[56:59], v[32:35]
  v_lshrrev_b32 v2, 8, v0
  v_and_b32 v3, 0xf0, v0
  v_lshlrev_b32 v3, 1, v3
  v_and_b32 v5, 1, v2
  v_lshl_add_u32 v5, v5, 4, v3
  v_add_u32 v5, s37, v5
  s_mov_b32 exec_lo, 0x00ff00ff
  s_mov_b32 exec_hi, 0xff00ff00
  ds_write_b128 v5, v[28:31]
  ds_write_b128 v5, v[32:35] offset:512
  s_mov_b64 exec, -1
  s_xor_b32 s26, s50, 32768
  v_add_u32 v5, s26, v1
  v_lshl_add_u32 v3, v2, 4, v3
  s_waitcnt lgkmcnt(0)
  s_barrier
  ds_read2st64_b32 v[36:37], v5 offset0:0 offset1:1
  ds_read2st64_b32 v[44:45], v5 offset0:2 offset1:3
  ds_read2st64_b32 v[38:39], v5 offset0:32 offset1:33
  ds_read2st64_b32 v[46:47], v5 offset0:34 offset1:35
  ds_read2st64_b32 v[40:41], v5 offset0:64 offset1:65
  ds_read2st64_b32 v[48:49], v5 offset0:66 offset1:67
  ds_read2st64_b32 v[42:43], v5 offset0:96 offset1:97
  ds_read2st64_b32 v[50:51], v5 offset0:98 offset1:99
  s_waitcnt lgkmcnt(0)
  v_add_f32 v36, v36, v40
  v_add_f32 v37, v37, v41
  v_add_f32 v38, v38, v42
  v_add_f32 v39, v39, v43
  v_add_f32 v44, v44, v48
  v_add_f32 v45, v45, v49
  v_add_f32 v46, v46, v50
  v_add_f32 v47, v47, v51
  v_add_f32 v36, v36, v38
  v_add_f32 v37, v37, v39
  v_add_f32 v44, v44, v46
  v_add_f32 v45, v45, v47
  v_add_f32 v36, v36, v37
  v_add_f32 v44, v44, v45
  v_cvt_pk_bf16_f32 v36, 0, v36
  v_cvt_pk_bf16_f32 v44, 0, v44
  v_mul_f32 v40, 0xbfb8aa3b, v36
  v_exp_f32 v40, v40
  s_nop 0
  v_add_f32 v40, 1.0, v40
  v_rcp_f32 v40, v40
  s_nop 0
  v_mul_f32 v36, v36, v40
  v_cvt_pk_bf16_f32 v36, 0, v36
  v_mul_f32 v36, v36, v44
  v_cvt_pk_bf16_f32 v36, v36, v36
  s_lshl_b32 s26, s17, 8
  s_add_u32 s26, s26, 161792
  v_add_u32 v5, s26, v1
  ds_write_b32 v5, v36
  v_mul_u32_u24 v5, 56, v2
  v_add_u32 v5, s26, v5
  ds_read_b64 v[36:37], v5 offset:0
  ds_read_b64 v[38:39], v5 offset:8
  ds_read_b64 v[40:41], v5 offset:16
  ds_read_b64 v[42:43], v5 offset:24
  ds_read_b64 v[44:45], v5 offset:32
  ds_read_b64 v[46:47], v5 offset:40
  ds_read_b64 v[48:49], v5 offset:48
  s_waitcnt lgkmcnt(0)
  v_and_b32 v20, v24, v36
  v_and_b32 v21, v25, v36
  v_and_b32 v22, v26, v36
  v_and_b32 v23, v27, v36
  s_nop 0
  s_nop 0
  v_mfma_f32_16x16x32_bf16 v[28:31], v[20:23], v[60:63], 0
  v_and_b32 v32, v24, v37
  v_and_b32 v33, v25, v37
  v_and_b32 v34, v26, v37
  v_and_b32 v35, v27, v37
  s_nop 0
  s_nop 0
  v_mfma_f32_16x16x32_bf16 v[28:31], v[32:35], v[64:67], v[28:31]
  v_and_b32 v20, v24, v38
  v_and_b32 v21, v25, v38
  v_and_b32 v22, v26, v38
  v_and_b32 v23, v27, v38
  s_nop 0
  s_nop 0
  v_mfma_f32_16x16x32_bf16 v[28:31], v[20:23], v[68:71], v[28:31]
  v_and_b32 v32, v24, v39
  v_and_b32 v33, v25, v39
  v_and_b32 v34, v26, v39
  v_and_b32 v35, v27, v39
  s_nop 0
  s_nop 0
  v_mfma_f32_16x16x32_bf16 v[28:31], v[32:35], v[72:75], v[28:31]
  v_and_b32 v20, v24, v40
  v_and_b32 v21, v25, v40
  v_and_b32 v22, v26, v40
  v_and_b32 v23, v27, v40
  s_nop 0
  s_nop 0
  v_mfma_f32_16x16x32_bf16 v[28:31], v[20:23], v[76:79], v[28:31]
  v_and_b32 v32, v24, v41
  v_and_b32 v33, v25, v41
  v_and_b32 v34, v26, v41
  v_and_b32 v35, v27, v41
  s_nop 0
  s_nop 0
  v_mfma_f32_16x16x32_bf16 v[28:31], v[32:35], v[80:83], v[28:31]
  v_and_b32 v20, v24, v42
  v_and_b32 v21, v25, v42
  v_and_b32 v22, v26, v42
  v_and_b32 v23, v27, v42
  s_nop 0
  s_nop 0
  v_mfma_f32_16x16x32_bf16 v[28:31], v[20:23], v[84:87], v[28:31]
  v_and_b32 v32, v24, v43
  v_and_b32 v33, v25, v43
  v_and_b32 v34, v26, v43
  v_and_b32 v35, v27, v43
  s_nop 0
  s_nop 0
  v_mfma_f32_16x16x32_bf16 v[28:31], v[32:35], v[88:91], v[28:31]
  v_and_b32 v20, v24, v44
  v_and_b32 v21, v25, v44
  v_and_b32 v22, v26, v44
  v_and_b32 v23, v27, v44
  s_nop 0
  s_nop 0
  v_mfma_f32_16x16x32_bf16 v[28:31], v[20:23], v[92:95], v[28:31]
  v_and_b32 v32, v24, v45
  v_and_b32 v33, v25, v45
  v_and_b32 v34, v26, v45
  v_and_b32 v35, v27, v45
  s_nop 0
  s_nop 0
  v_mfma_f32_16x16x32_bf16 v[28:31], v[32:35], v[96:99], v[28:31]
  v_and_b32 v20, v24, v46
  v_and_b32 v21, v25, v46
  v_and_b32 v22, v26, v46
  v_and_b32 v23, v27, v46
  s_nop 0
  s_nop 0
  v_mfma_f32_16x16x32_bf16 v[28:31], v[20:23], v[100:103], v[28:31]
  v_and_b32 v32, v24, v47
  v_and_b32 v33, v25, v47
  v_and_b32 v34, v26, v47
  v_and_b32 v35, v27, v47
  s_nop 0
  s_nop 0
  v_mfma_f32_16x16x32_bf16 v[28:31], v[32:35], v[104:107], v[28:31]
  v_and_b32 v20, v24, v48
  v_and_b32 v21, v25, v48
  v_and_b32 v22, v26, v48
  v_and_b32 v23, v27, v48
  s_nop 0
  s_nop 0
  v_mfma_f32_16x16x32_bf16 v[28:31], v[20:23], v[108:111], v[28:31]
  v_and_b32 v32, v24, v49
  v_and_b32 v33, v25, v49
  v_and_b32 v34, v26, v49
  v_and_b32 v35, v27, v49
  s_nop 0
  s_nop 0
  v_mfma_f32_16x16x32_bf16 v[28:31], v[32:35], v[112:115], v[28:31]
  v_lshrrev_b32 v3, 1, v3
  s_lshl_b32 s26, s47, 7
  s_add_u32 s26, s26, s57
  s_lshl_b32 s26, s26, 8
  s_add_u32 s26, s26, 244318208
  s_nop 2
  v_cvt_pk_bf16_f32 v28, v28, v29
  v_cvt_pk_bf16_f32 v29, v30, v31
  v_min_u32 v28, -2, v28
  v_min_u32 v29, -2, v29
  s_mov_b32 exec_hi, 0
  buffer_store_dwordx2 v[28:29], v3, s[4:7], s26 offen sc1
  s_mov_b32 exec_hi, -1
  s_cmp_lg_u32 s16, 0
  s_cbranch_scc1 k_nx_103
  s_barrier
  s_lshl_b32 s26, s61, 21
  s_lshl_b32 s27, s59, 10
  s_add_u32 s26, s26, s27
  s_add_u32 s27, s26, 20971520
  s_add_u32 s28, s26, 27262976
  s_lshl_b32 s26, s47, 7
  s_add_u32 s26, s26, s17
  s_lshl_b32 s26, s26, 8
  s_add_u32 s26, s26, 244318208
  v_lshrrev_b32 v2, 8, v0
  v_and_b32 v3, 0xf0, v0
  v_lshl_add_u32 v5, v2, 10, v3
  buffer_load_dwordx4 v[36:39], v0, s[4:7], s27 offen sc1
  buffer_load_dwordx4 v[40:43], v0, s[4:7], s28 offen sc1
  s_mov_b32 s53, 0
m_w_108:
  s_add_u32 s27, s26, 0
  buffer_load_dwordx4 v[60:63], v5, s[4:7], s27 offen sc1
  s_add_u32 s27, s26, 4096
  buffer_load_dwordx4 v[64:67], v5, s[4:7], s27 offen sc1
  s_add_u32 s27, s26, 8192
  buffer_load_dwordx4 v[68:71], v5, s[4:7], s27 offen sc1
  s_add_u32 s27, s26, 12288
  buffer_load_dwordx4 v[72:75], v5, s[4:7], s27 offen sc1
  s_add_u32 s27, s26, 16384
  buffer_load_dwordx4 v[76:79], v5, s[4:7], s27 offen sc1
  s_add_u32 s27, s26, 20480
  buffer_load_dwordx4 v[80:83], v5, s[4:7], s27 offen sc1
  s_add_u32 s27, s26, 24576
  buffer_load_dwordx4 v[84:87], v5, s[4:7], s27 offen sc1
  s_add_u32 s27, s26, 28672
  buffer_load_dwordx4 v[88:91], v5, s[4:7], s27 offen sc1
  s_add_u32 s53, s53, 1
  s_cmp_gt_u32 s53, 1048576
  s_cbranch_scc1 q_fail_87
  s_mov_b32 vcc_lo, 0xaaaaaaaa
  s_mov_b32 vcc_hi, 0xaaaaaaaa
  v_mov_b32 v28, 0x3f80
  v_mov_b32 v20, 1.0
  v_cndmask_b32 v28, v28, v20, vcc
  s_mov_b32 vcc_lo, 0x30003
  s_mov_b32 vcc_hi, 0x30003
  v_cndmask_b32 v20, 0, v28, vcc
  s_mov_b32 vcc_lo, 0xc000c
  s_mov_b32 vcc_hi, 0xc000c
  v_cndmask_b32 v21, 0, v28, vcc
  s_mov_b32 vcc_lo, 0x300030
  s_mov_b32 vcc_hi, 0x300030
  v_cndmask_b32 v22, 0, v28, vcc
  s_mov_b32 vcc_lo, 0xc000c0
  s_mov_b32 vcc_hi, 0xc000c0
  v_cndmask_b32 v23, 0, v28, vcc
  s_waitcnt vmcnt(7)
  s_nop 0
  v_mfma_f32_16x16x32_bf16 v[28:31], v[20:23], v[60:63], 0
  v_max3_u32 v44, v60, v61, 0
  v_max3_u32 v44, v62, v63, v44
  s_waitcnt vmcnt(6)
  v_mfma_f32_16x16x32_bf16 v[28:31], v[20:23], v[64:67], v[28:31]
  v_max3_u32 v44, v64, v65, v44
  v_max3_u32 v44, v66, v67, v44
  s_waitcnt vmcnt(5)
  v_mfma_f32_16x16x32_bf16 v[28:31], v[20:23], v[68:71], v[28:31]
  v_max3_u32 v44, v68, v69, v44
  v_max3_u32 v44, v70, v71, v44
  s_waitcnt vmcnt(4)
  v_mfma_f32_16x16x32_bf16 v[28:31], v[20:23], v[72:75], v[28:31]
  v_max3_u32 v44, v72, v73, v44
  v_max3_u32 v44, v74, v75, v44
  s_waitcnt vmcnt(3)
  v_mfma_f32_16x16x32_bf16 v[28:31], v[20:23], v[76:79], v[28:31]
  v_max3_u32 v44, v76, v77, v44
  v_max3_u32 v44, v78, v79, v44
  s_waitcnt vmcnt(2)
  v_mfma_f32_16x16x32_bf16 v[28:31], v[20:23], v[80:83], v[28:31]
  v_max3_u32 v44, v80, v81, v44
  v_max3_u32 v44, v82, v83, v44
  s_waitcnt vmcnt(1)
  v_mfma_f32_16x16x32_bf16 v[28:31], v[20:23], v[84:87], v[28:31]
  v_max3_u32 v44, v84, v85, v44
  v_max3_u32 v44, v86, v87, v44
  s_waitcnt vmcnt(0)
  v_mfma_f32_16x16x32_bf16 v[28:31], v[20:23], v[88:91], v[28:31]
  v_max3_u32 v44, v88, v89, v44
  v_max3_u32 v44, v90, v91, v44
  v_cmp_eq_u32 vcc, -1, v44
  s_cbranch_vccnz m_w_108
  v_lshlrev_b32 v3, 1, v3
  v_lshl_add_u32 v3, v2, 4, v3
  s_lshl_b32 s26, s17, 9
  s_add_u32 s26, s26, 159744
  v_add_u32 v3, s26, v3
  s_mov_b32 exec_hi, 0
  ds_write_b128 v3, v[28:31]
  s_mov_b32 exec_hi, -1
  v_lshlrev_b32 v3, 1, v0
  v_add_u32 v3, 159744, v3
  v_lshlrev_b32 v44, 16, v36
  v_and_b32 v45, 0xffff0000, v36
  v_lshlrev_b32 v46, 16, v37
  v_and_b32 v47, 0xffff0000, v37
  v_lshlrev_b32 v48, 16, v38
  v_and_b32 v49, 0xffff0000, v38
  v_lshlrev_b32 v50, 16, v39
  v_and_b32 v51, 0xffff0000, v39
  v_lshlrev_b32 v52, 16, v40
  v_and_b32 v53, 0xffff0000, v40
  v_lshlrev_b32 v54, 16, v41
  v_and_b32 v55, 0xffff0000, v41
  v_lshlrev_b32 v56, 16, v42
  v_and_b32 v57, 0xffff0000, v42
  v_lshlrev_b32 v58, 16, v43
  v_and_b32 v59, 0xffff0000, v43
  s_waitcnt lgkmcnt(0)
  s_barrier
  s_cmp_lg_u32 s17, 0
  s_cbranch_scc1 m_done_107
  ds_read_b128 v[28:31], v3
  ds_read_b128 v[32:35], v3 offset:16
  s_and_b32 s29, s58, 0xffff0000
  s_xor_b32 s27, s29, 0x80000000
  s_xor_b32 s28, s29, 0xffff0000
  s_bitcmp1_b32 s29, 31
  s_cselect_b32 s29, s27, s28
  v_mov_b32 v36, s29
  v_mul_f32 v36, 0xbfb8aa3b, v36
  v_exp_f32 v36, v36
  s_nop 0
  v_add_f32 v36, 1.0, v36
  v_rcp_f32 v36, v36
  s_nop 0
  v_cvt_pk_bf16_f32 v36, 0, v36
  v_add_f32 v60, v44, v52
  v_add_f32 v61, v45, v53
  v_add_f32 v62, v46, v54
  v_add_f32 v63, v47, v55
  v_add_f32 v64, v48, v56
  v_add_f32 v65, v49, v57
  v_add_f32 v66, v50, v58
  v_add_f32 v67, v51, v59
  v_cvt_pk_bf16_f32 v68, v60, v61
  v_cvt_pk_bf16_f32 v69, v62, v63
  v_cvt_pk_bf16_f32 v70, v64, v65
  v_cvt_pk_bf16_f32 v71, v66, v67
  v_accvgpr_write_b32 a0, v68
  v_accvgpr_write_b32 a1, v69
  v_accvgpr_write_b32 a2, v70
  v_accvgpr_write_b32 a3, v71
  s_waitcnt lgkmcnt(0)
  v_cvt_pk_bf16_f32 v28, 0, v28
  v_cvt_pk_bf16_f32 v29, 0, v29
  v_cvt_pk_bf16_f32 v30, 0, v30
  v_cvt_pk_bf16_f32 v31, 0, v31
  v_cvt_pk_bf16_f32 v32, 0, v32
  v_cvt_pk_bf16_f32 v33, 0, v33
  v_cvt_pk_bf16_f32 v34, 0, v34
  v_cvt_pk_bf16_f32 v35, 0, v35
  v_mul_f32 v28, v28, v36
  v_mul_f32 v29, v29, v36
  v_mul_f32 v30, v30, v36
  v_mul_f32 v31, v31, v36
  v_mul_f32 v32, v32, v36
  v_mul_f32 v33, v33, v36
  v_mul_f32 v34, v34, v36
  v_mul_f32 v35, v35, v36
  v_cvt_pk_bf16_f32 v28, 0, v28
  v_cvt_pk_bf16_f32 v29, 0, v29
  v_cvt_pk_bf16_f32 v30, 0, v30
  v_cvt_pk_bf16_f32 v31, 0, v31
  v_cvt_pk_bf16_f32 v32, 0, v32
  v_cvt_pk_bf16_f32 v33, 0, v33
  v_cvt_pk_bf16_f32 v34, 0, v34
  v_cvt_pk_bf16_f32 v35, 0, v35
  v_add_f32 v28, v28, v52
  v_add_f32 v29, v29, v53
  v_add_f32 v30, v30, v54
  v_add_f32 v31, v31, v55
  v_add_f32 v32, v32, v56
  v_add_f32 v33, v33, v57
  v_add_f32 v34, v34, v58
  v_add_f32 v35, v35, v59
  v_cvt_pk_bf16_f32 v28, 0, v28
  v_cvt_pk_bf16_f32 v29, 0, v29
  v_cvt_pk_bf16_f32 v30, 0, v30
  v_cvt_pk_bf16_f32 v31, 0, v31
  v_cvt_pk_bf16_f32 v32, 0, v32
  v_cvt_pk_bf16_f32 v33, 0, v33
  v_cvt_pk_bf16_f32 v34, 0, v34
  v_cvt_pk_bf16_f32 v35, 0, v35
  v_add_f32 v44, v44, v28
  v_add_f32 v45, v45, v29
  v_add_f32 v46, v46, v30
  v_add_f32 v47, v47, v31
  v_add_f32 v48, v48, v32
  v_add_f32 v49, v49, v33
  v_add_f32 v50, v50, v34
  v_add_f32 v51, v51, v35
  v_cvt_pk_bf16_f32 v40, v44, v45
  v_cvt_pk_bf16_f32 v41, v46, v47
  v_cvt_pk_bf16_f32 v42, v48, v49
  v_cvt_pk_bf16_f32 v43, v50, v51
  v_lshlrev_b32 v44, 16, v40
  v_and_b32 v45, 0xffff0000, v40
  v_lshlrev_b32 v46, 16, v41
  v_and_b32 v47, 0xffff0000, v41
  v_lshlrev_b32 v48, 16, v42
  v_and_b32 v49, 0xffff0000, v42
  v_lshlrev_b32 v50, 16, v43
  v_and_b32 v51, 0xffff0000, v43
  s_lshl_b32 s26, s59, 10
  buffer_store_dwordx4 v[40:43], v0, s[72:75], s26 offen sc1
m_done_107:
k_nx_103:
  s_add_u32 s47, s47, 3
  s_xor_b32 s48, s48, 31
  s_waitcnt vmcnt(0)
  s_barrier
  s_bitcmp1_b32 s48, 4
  s_cbranch_scc1 k_fin_102
q_fail_87:
  s_endpgm
L_o:
  s_sub_u32 s60, s91, 3
  s_and_b32 s61, s90, 15
  s_load_dwordx2 s[80:81], s[0:1], 40
  s_load_dwordx2 s[72:73], s[0:1], 0
  s_mov_b32 s82, 4194304
  v_and_b32 v42, 63, v0
  v_and_b32 v40, 15, v42
  v_lshrrev_b32 v41, 4, v42
  v_lshlrev_b32 v1, 3, v42
  v_lshlrev_b32 v2, 2, v42
  v_lshlrev_b32 v0, 4, v42
  s_mov_b32 s24, 0x3e0293ee
  s_mov_b32 s44, 0x05040100
  s_mov_b32 s45, 0x07060302
  s_and_b32 s26, s17, 1
  s_lshl_b32 s26, s26, 4
  v_lshlrev_b32 v43, 2, v41
  v_sub_u32 v43, v40, v43
  v_add_u32 v43, s26, v43
  v_mov_b32 v7, 0xfe000000
  v_cmp_le_i32 vcc, 0, v43
  s_nop 1
  v_cndmask_b32 v24, v7, 0, vcc
  v_cmp_le_i32 vcc, 1, v43
  s_nop 1
  v_cndmask_b32 v25, v7, 0, vcc
  v_cmp_le_i32 vcc, 2, v43
  s_nop 1
  v_cndmask_b32 v26, v7, 0, vcc
  v_cmp_le_i32 vcc, 3, v43
  s_nop 1
  v_cndmask_b32 v27, v7, 0, vcc
  v_cmp_le_i32 vcc, 16, v43
  s_nop 1
  v_cndmask_b32 v28, v7, 0, vcc
  v_cmp_le_i32 vcc, 17, v43
  s_nop 1
  v_cndmask_b32 v29, v7, 0, vcc
  v_cmp_le_i32 vcc, 18, v43
  s_nop 1
  v_cndmask_b32 v30, v7, 0, vcc
  v_cmp_le_i32 vcc, 19, v43
  s_nop 1
  v_cndmask_b32 v31, v7, 0, vcc
  v_lshrrev_b32 v43, 5, v42
  v_lshlrev_b32 v43, 16, v43
  v_and_b32 v4, 1, v41
  v_lshl_add_u32 v43, v4, 14, v43
  v_lshl_add_u32 v43, v40, 4, v43
  s_lshl_b32 s26, s61, 10
  s_lshl_b32 s27, s17, 8
  s_add_u32 s26, s26, s27
  v_add_u32 v4, s26, v43
  v_lshlrev_b32 v43, 10, v41
  v_lshl_add_u32 v5, v40, 4, v43
  s_lshl_b32 s26, s17, 12
  v_add_u32 v6, s26, v0
  v_and_b32 v43, 1, v41
  v_lshlrev_b32 v43, 12, v43
  v_lshl_add_u32 v43, v40, 4, v43
  v_lshrrev_b32 v3, 1, v41
  v_lshl_add_u32 v3, v3, 8, v43
  s_lshr_b32 s26, s17, 1
  s_lshl_b32 s27, s26, 14
  s_add_u32 s27, s27, 16384
  v_add_u32 v32, s27, v0
  s_lshl_b32 s27, s26, 13
  s_and_b32 s28, s17, 1
  s_lshl_b32 s28, s28, 10
  s_add_u32 s28, s28, s27
  s_add_u32 s28, s28, 49152
  v_add_u32 v33, s28, v0
  s_add_u32 s27, s27, 65536
  v_add_u32 v34, s27, v0
  v_add_u32 v35, s27, v1
  v_and_b32 v36, 0xf0, v0
  v_and_b32 v252, 64, v0
  v_mov_b32 v248, 0
  v_lshlrev_b32 v255, 4, v0
  v_and_b32 v43, 1, v42
  v_xor_b32 v254, 1, v43
  s_lshl_b32 s26, s17, 3
  s_add_u32 s26, s26, 81920
  v_mov_b32 v39, s26
  s_mov_b32 vcc_lo, 0xaaaaaaaa
  s_mov_b32 vcc_hi, 0xaaaaaaaa
  v_mov_b32 v43, 0x3f80
  v_cndmask_b32 v43, v43, 1.0, vcc
  s_mov_b32 vcc_lo, 0xf000f
  s_mov_b32 vcc_hi, 0xf000f00
  v_cndmask_b32 v16, 0, v43, vcc
  v_cndmask_b32 v18, 0, v43, vcc
  s_mov_b32 vcc_lo, 0xf000f0
  s_mov_b32 vcc_hi, 0xf000f000
  v_cndmask_b32 v17, 0, v43, vcc
  v_cndmask_b32 v19, 0, v43, vcc
  s_mov_b32 vcc_lo, 0xcccccccc
  s_mov_b32 vcc_hi, 0xcccccccc
  v_mov_b32 v43, 0x4444
  v_mov_b32 v20, 0xeeee
  v_cndmask_b32 v20, v43, v20, vcc
  s_mov_b32 s70, 2097152
  s_mov_b32 s71, 0x20000
  s_mov_b32 s74, 2097152
  s_mov_b32 s75, 0x20000
  s_mov_b32 s10, 1024
  s_mov_b32 s83, 0x20000
  s_lshr_b32 s85, s17, 1
  s_lshl_b32 s26, s61, 1
  s_add_u32 s85, s85, s26
  s_add_u32 s43, s26, s17
  s_lshl_b32 s14, s61, 8
  s_lshl_b32 s15, s61, 7
  s_add_u32 s15, s15, 245104640
  s_add_u32 s14, s14, 244318208
  s_lshl_b32 s26, s61, 2
  s_add_u32 s26, s26, s17
  s_lshl_b32 s18, s26, 13
  s_add_u32 s18, s18, 41943040
  s_lshl_b32 s19, s26, 12
  s_add_u32 s19, s19, 142606336
  s_lshl_b32 s20, s85, 13
  s_add_u32 s20, s20, 192937984
  s_and_b32 s26, s17, 1
  s_mul_i32 s26, s26, 3072
  s_add_u32 s21, s20, s26
  s_lshr_b32 s40, s17, 1
  s_lshl_b32 s40, s40, 13
  s_add_u32 s40, s40, s26
  s_add_u32 s40, s40, 65536
  s_lshl_b32 s22, s17, 12
  s_add_u32 s22, s22, 49152
  s_lshl_b32 s23, s17, 13
  s_add_u32 s23, s23, 16384
  s_lshl_b32 s41, s60, 20
  s_add_u32 s41, s41, 12582912
  v_lshlrev_b32 v246, 3, v0
  s_mov_b32 s11, 0x20000
  s_waitcnt lgkmcnt(0)
  s_lshl_b32 s77, s60, 4
  s_add_u32 s77, s77, s61
  s_lshl_b32 s77, s77, 2
  s_add_u32 s77, s77, s17
  s_lshl_b32 s26, s77, 10
  buffer_load_dwordx4 v[176:179], v0, s[72:75], s26 offen
  s_add_u32 s26, s26, 262144
  buffer_load_dwordx4 v[180:183], v0, s[72:75], s26 offen
  s_add_u32 s26, s26, 262144
  buffer_load_dwordx4 v[184:187], v0, s[72:75], s26 offen
  s_add_u32 s26, s26, 262144
  buffer_load_dwordx4 v[188:191], v0, s[72:75], s26 offen
  s_add_u32 s26, s26, 262144
  buffer_load_dwordx4 v[192:195], v0, s[72:75], s26 offen
  s_add_u32 s26, s26, 262144
  buffer_load_dwordx4 v[196:199], v0, s[72:75], s26 offen
  s_add_u32 s26, s26, 262144
  buffer_load_dwordx4 v[200:203], v0, s[72:75], s26 offen
  s_add_u32 s26, s26, 262144
  buffer_load_dwordx4 v[204:207], v0, s[72:75], s26 offen
  s_add_u32 s26, s26, 262144
  v_lshrrev_b32 v44, 9, v0
  v_lshlrev_b32 v44, 12, v44
  v_and_b32 v45, 0xf0, v0
  v_add_u32 v44, v44, v45
  v_bfe_u32 v45, v0, 8, 1
  v_lshl_add_u32 v44, v45, 3, v44
  s_lshl_b32 s30, s61, 18
  s_lshl_b32 s27, s17, 8
  s_add_u32 s30, s30, s27
  s_add_u32 s27, s30, 0
  buffer_load_dwordx2 v[64:65], v44, s[80:83], s27 offen
  s_add_u32 s27, s30, 1024
  buffer_load_dwordx2 v[66:67], v44, s[80:83], s27 offen
  s_add_u32 s27, s30, 2048
  buffer_load_dwordx2 v[68:69], v44, s[80:83], s27 offen
  s_add_u32 s27, s30, 3072
  buffer_load_dwordx2 v[70:71], v44, s[80:83], s27 offen
  s_add_u32 s27, s30, 16384
  buffer_load_dwordx2 v[72:73], v44, s[80:83], s27 offen
  s_add_u32 s27, s30, 17408
  buffer_load_dwordx2 v[74:75], v44, s[80:83], s27 offen
  s_add_u32 s27, s30, 18432
  buffer_load_dwordx2 v[76:77], v44, s[80:83], s27 offen
  s_add_u32 s27, s30, 19456
  buffer_load_dwordx2 v[78:79], v44, s[80:83], s27 offen
  s_add_u32 s27, s30, 8192
  buffer_load_dwordx2 v[80:81], v44, s[80:83], s27 offen
  s_add_u32 s27, s30, 9216
  buffer_load_dwordx2 v[82:83], v44, s[80:83], s27 offen
  s_add_u32 s27, s30, 10240
  buffer_load_dwordx2 v[84:85], v44, s[80:83], s27 offen
  s_add_u32 s27, s30, 11264
  buffer_load_dwordx2 v[86:87], v44, s[80:83], s27 offen
  s_add_u32 s27, s30, 24576
  buffer_load_dwordx2 v[88:89], v44, s[80:83], s27 offen
  s_add_u32 s27, s30, 25600
  buffer_load_dwordx2 v[90:91], v44, s[80:83], s27 offen
  s_add_u32 s27, s30, 26624
  buffer_load_dwordx2 v[92:93], v44, s[80:83], s27 offen
  s_add_u32 s27, s30, 27648
  buffer_load_dwordx2 v[94:95], v44, s[80:83], s27 offen
  s_add_u32 s27, s30, 32768
  buffer_load_dwordx2 v[96:97], v44, s[80:83], s27 offen
  s_add_u32 s27, s30, 33792
  buffer_load_dwordx2 v[98:99], v44, s[80:83], s27 offen
  s_add_u32 s27, s30, 34816
  buffer_load_dwordx2 v[100:101], v44, s[80:83], s27 offen
  s_add_u32 s27, s30, 35840
  buffer_load_dwordx2 v[102:103], v44, s[80:83], s27 offen
  s_add_u32 s27, s30, 49152
  buffer_load_dwordx2 v[104:105], v44, s[80:83], s27 offen
  s_add_u32 s27, s30, 50176
  buffer_load_dwordx2 v[106:107], v44, s[80:83], s27 offen
  s_add_u32 s27, s30, 51200
  buffer_load_dwordx2 v[108:109], v44, s[80:83], s27 offen
  s_add_u32 s27, s30, 52224
  buffer_load_dwordx2 v[110:111], v44, s[80:83], s27 offen
  s_add_u32 s27, s30, 40960
  buffer_load_dwordx2 v[112:113], v44, s[80:83], s27 offen
  s_add_u32 s27, s30, 41984
  buffer_load_dwordx2 v[114:115], v44, s[80:83], s27 offen
  s_add_u32 s27, s30, 43008
  buffer_load_dwordx2 v[116:117], v44, s[80:83], s27 offen
  s_add_u32 s27, s30, 44032
  buffer_load_dwordx2 v[118:119], v44, s[80:83], s27 offen
  s_add_u32 s27, s30, 57344
  buffer_load_dwordx2 v[120:121], v44, s[80:83], s27 offen
  s_add_u32 s27, s30, 58368
  buffer_load_dwordx2 v[122:123], v44, s[80:83], s27 offen
  s_add_u32 s27, s30, 59392
  buffer_load_dwordx2 v[124:125], v44, s[80:83], s27 offen
  s_add_u32 s27, s30, 60416
  buffer_load_dwordx2 v[126:127], v44, s[80:83], s27 offen
  s_load_dwordx2 s[4:5], s[0:1], 112
  s_load_dwordx2 s[12:13], s[0:1], 104
  s_load_dwordx2 s[68:69], s[0:1], 96
  s_load_dwordx2 s[8:9], s[0:1], 64
  s_waitcnt lgkmcnt(0)
  buffer_load_dwordx4 v[56:59], v0, s[8:11], 0 offen
  s_lshl_b32 s29, s77, 10
  s_add_u32 s29, s29, 6291456
  s_cmp_lt_u32 s60, 4
  s_cbranch_scc1 o_s1_109
  s_waitcnt vmcnt(0)
  s_branch o_s2_110
o_s1_109:
  s_waitcnt vmcnt(40)
  v_lshlrev_b32 v212, 16, v176
  v_and_b32 v213, 0xffff0000, v176
  v_lshlrev_b32 v214, 16, v177
  v_and_b32 v215, 0xffff0000, v177
  v_lshlrev_b32 v216, 16, v178
  v_and_b32 v217, 0xffff0000, v178
  v_lshlrev_b32 v218, 16, v179
  v_and_b32 v219, 0xffff0000, v179
  v_add_f32 v220, v212, v213
  v_add_f32 v221, v214, v215
  v_add_f32 v222, v216, v217
  v_add_f32 v223, v218, v219
  v_add_f32 v220, v220, v221
  v_add_f32 v222, v222, v223
  v_add_f32 v220, v220, v222
  s_nop 1
  v_add_f32_dpp v220, v220, v220 row_ror:8 row_mask:0xf bank_mask:0xf
  s_nop 1
  v_add_f32_dpp v220, v220, v220 row_ror:4 row_mask:0xf bank_mask:0xf
  s_nop 1
  v_add_f32_dpp v220, v220, v220 row_ror:2 row_mask:0xf bank_mask:0xf
  s_nop 1
  v_add_f32_dpp v220, v220, v220 row_ror:1 row_mask:0xf bank_mask:0xf
  v_mov_b32 v222, v220
  s_nop 0
  s_nop 0
  v_permlane16_swap_b32 v220, v222
  v_add_f32 v220, v220, v222
  v_mov_b32 v222, v220
  s_nop 0
  s_nop 0
  v_permlane32_swap_b32 v220, v222
  v_add_f32 v220, v220, v222
  v_mul_f32 v220, 0x3b000000, v220
  v_sub_f32 v224, v212, v220
  v_sub_f32 v225, v213, v220
  v_sub_f32 v226, v214, v220
  v_sub_f32 v227, v215, v220
  v_sub_f32 v228, v216, v220
  v_sub_f32 v229, v217, v220
  v_sub_f32 v230, v218, v220
  v_sub_f32 v231, v219, v220
  v_mul_f32 v221, v224, v224
  v_mul_f32 v222, v225, v225
  v_fmac_f32 v221, v226, v226
  v_fmac_f32 v222, v227, v227
  v_fmac_f32 v221, v228, v228
  v_fmac_f32 v222, v229, v229
  v_fmac_f32 v221, v230, v230
  v_fmac_f32 v222, v231, v231
  v_add_f32 v221, v221, v222
  v_cvt_pk_bf16_f32 v220, 0, v220
  s_nop 0
  v_add_f32_dpp v221, v221, v221 row_ror:8 row_mask:0xf bank_mask:0xf
  v_sub_f32 v224, v212, v220
  v_sub_f32 v225, v213, v220
  v_add_f32_dpp v221, v221, v221 row_ror:4 row_mask:0xf bank_mask:0xf
  v_sub_f32 v226, v214, v220
  v_sub_f32 v227, v215, v220
  v_add_f32_dpp v221, v221, v221 row_ror:2 row_mask:0xf bank_mask:0xf
  v_sub_f32 v228, v216, v220
  v_sub_f32 v229, v217, v220
  v_add_f32_dpp v221, v221, v221 row_ror:1 row_mask:0xf bank_mask:0xf
  v_sub_f32 v230, v218, v220
  v_sub_f32 v231, v219, v220
  v_mov_b32 v222, v221
  v_cvt_pk_bf16_f32 v224, 0, v224
  v_cvt_pk_bf16_f32 v225, 0, v225
  v_permlane16_swap_b32 v221, v222
  v_cvt_pk_bf16_f32 v226, 0, v226
  v_cvt_pk_bf16_f32 v227, 0, v227
  v_add_f32 v221, v221, v222
  v_cvt_pk_bf16_f32 v228, 0, v228
  v_cvt_pk_bf16_f32 v229, 0, v229
  v_mov_b32 v222, v221
  v_cvt_pk_bf16_f32 v230, 0, v230
  v_cvt_pk_bf16_f32 v231, 0, v231
  v_permlane32_swap_b32 v221, v222
  v_add_f32 v221, v221, v222
  v_mul_f32 v221, 0x3b000000, v221
  v_cvt_pk_bf16_f32 v221, 0, v221
  v_add_f32 v221, 0x3727c5ac, v221
  v_cvt_pk_bf16_f32 v221, 0, v221
  v_sqrt_f32 v221, v221
  s_nop 0
  v_cvt_pk_bf16_f32 v221, 0, v221
  v_rcp_f32 v221, v221
  s_nop 0
  v_mul_f32 v224, v224, v221
  v_mul_f32 v225, v225, v221
  v_mul_f32 v226, v226, v221
  v_mul_f32 v227, v227, v221
  v_mul_f32 v228, v228, v221
  v_mul_f32 v229, v229, v221
  v_mul_f32 v230, v230, v221
  v_mul_f32 v231, v231, v221
  v_cvt_pk_bf16_f32 v176, v224, v225
  v_cvt_pk_bf16_f32 v177, v226, v227
  v_cvt_pk_bf16_f32 v178, v228, v229
  v_cvt_pk_bf16_f32 v179, v230, v231
  buffer_store_dwordx4 v[176:179], v0, s[4:7], s29 offen sc1
  s_add_u32 s29, s29, 262144
  s_waitcnt vmcnt(40)
  v_lshlrev_b32 v212, 16, v180
  v_and_b32 v213, 0xffff0000, v180
  v_lshlrev_b32 v214, 16, v181
  v_and_b32 v215, 0xffff0000, v181
  v_lshlrev_b32 v216, 16, v182
  v_and_b32 v217, 0xffff0000, v182
  v_lshlrev_b32 v218, 16, v183
  v_and_b32 v219, 0xffff0000, v183
  v_add_f32 v220, v212, v213
  v_add_f32 v221, v214, v215
  v_add_f32 v222, v216, v217
  v_add_f32 v223, v218, v219
  v_add_f32 v220, v220, v221
  v_add_f32 v222, v222, v223
  v_add_f32 v220, v220, v222
  s_nop 1
  v_add_f32_dpp v220, v220, v220 row_ror:8 row_mask:0xf bank_mask:0xf
  s_nop 1
  v_add_f32_dpp v220, v220, v220 row_ror:4 row_mask:0xf bank_mask:0xf
  s_nop 1
  v_add_f32_dpp v220, v220, v220 row_ror:2 row_mask:0xf bank_mask:0xf
  s_nop 1
  v_add_f32_dpp v220, v220, v220 row_ror:1 row_mask:0xf bank_mask:0xf
  v_mov_b32 v222, v220
  s_nop 0
  s_nop 0
  v_permlane16_swap_b32 v220, v222
  v_add_f32 v220, v220, v222
  v_mov_b32 v222, v220
  s_nop 0
  s_nop 0
  v_permlane32_swap_b32 v220, v222
  v_add_f32 v220, v220, v222
  v_mul_f32 v220, 0x3b000000, v220
  v_sub_f32 v224, v212, v220
  v_sub_f32 v225, v213, v220
  v_sub_f32 v226, v214, v220
  v_sub_f32 v227, v215, v220
  v_sub_f32 v228, v216, v220
  v_sub_f32 v229, v217, v220
  v_sub_f32 v230, v218, v220
  v_sub_f32 v231, v219, v220
  v_mul_f32 v221, v224, v224
  v_mul_f32 v222, v225, v225
  v_fmac_f32 v221, v226, v226
  v_fmac_f32 v222, v227, v227
  v_fmac_f32 v221, v228, v228
  v_fmac_f32 v222, v229, v229
  v_fmac_f32 v221, v230, v230
  v_fmac_f32 v222, v231, v231
  v_add_f32 v221, v221, v222
  v_cvt_pk_bf16_f32 v220, 0, v220
  s_nop 0
  v_add_f32_dpp v221, v221, v221 row_ror:8 row_mask:0xf bank_mask:0xf
  v_sub_f32 v224, v212, v220
  v_sub_f32 v225, v213, v220
  v_add_f32_dpp v221, v221, v221 row_ror:4 row_mask:0xf bank_mask:0xf
  v_sub_f32 v226, v214, v220
  v_sub_f32 v227, v215, v220
  v_add_f32_dpp v221, v221, v221 row_ror:2 row_mask:0xf bank_mask:0xf
  v_sub_f32 v228, v216, v220
  v_sub_f32 v229, v217, v220
  v_add_f32_dpp v221, v221, v221 row_ror:1 row_mask:0xf bank_mask:0xf
  v_sub_f32 v230, v218, v220
  v_sub_f32 v231, v219, v220
  v_mov_b32 v222, v221
  v_cvt_pk_bf16_f32 v224, 0, v224
  v_cvt_pk_bf16_f32 v225, 0, v225
  v_permlane16_swap_b32 v221, v222
  v_cvt_pk_bf16_f32 v226, 0, v226
  v_cvt_pk_bf16_f32 v227, 0, v227
  v_add_f32 v221, v221, v222
  v_cvt_pk_bf16_f32 v228, 0, v228
  v_cvt_pk_bf16_f32 v229, 0, v229
  v_mov_b32 v222, v221
  v_cvt_pk_bf16_f32 v230, 0, v230
  v_cvt_pk_bf16_f32 v231, 0, v231
  v_permlane32_swap_b32 v221, v222
  v_add_f32 v221, v221, v222
  v_mul_f32 v221, 0x3b000000, v221
  v_cvt_pk_bf16_f32 v221, 0, v221
  v_add_f32 v221, 0x3727c5ac, v221
  v_cvt_pk_bf16_f32 v221, 0, v221
  v_sqrt_f32 v221, v221
  s_nop 0
  v_cvt_pk_bf16_f32 v221, 0, v221
  v_rcp_f32 v221, v221
  s_nop 0
  v_mul_f32 v224, v224, v221
  v_mul_f32 v225, v225, v221
  v_mul_f32 v226, v226, v221
  v_mul_f32 v227, v227, v221
  v_mul_f32 v228, v228, v221
  v_mul_f32 v229, v229, v221
  v_mul_f32 v230, v230, v221
  v_mul_f32 v231, v231, v221
  v_cvt_pk_bf16_f32 v180, v224, v225
  v_cvt_pk_bf16_f32 v181, v226, v227
  v_cvt_pk_bf16_f32 v182, v228, v229
  v_cvt_pk_bf16_f32 v183, v230, v231
  buffer_store_dwordx4 v[180:183], v0, s[4:7], s29 offen sc1
  s_add_u32 s29, s29, 262144
  s_waitcnt vmcnt(40)
  v_lshlrev_b32 v212, 16, v184
  v_and_b32 v213, 0xffff0000, v184
  v_lshlrev_b32 v214, 16, v185
  v_and_b32 v215, 0xffff0000, v185
  v_lshlrev_b32 v216, 16, v186
  v_and_b32 v217, 0xffff0000, v186
  v_lshlrev_b32 v218, 16, v187
  v_and_b32 v219, 0xffff0000, v187
  v_add_f32 v220, v212, v213
  v_add_f32 v221, v214, v215
  v_add_f32 v222, v216, v217
  v_add_f32 v223, v218, v219
  v_add_f32 v220, v220, v221
  v_add_f32 v222, v222, v223
  v_add_f32 v220, v220, v222
  s_nop 1
  v_add_f32_dpp v220, v220, v220 row_ror:8 row_mask:0xf bank_mask:0xf
  s_nop 1
  v_add_f32_dpp v220, v220, v220 row_ror:4 row_mask:0xf bank_mask:0xf
  s_nop 1
  v_add_f32_dpp v220, v220, v220 row_ror:2 row_mask:0xf bank_mask:0xf
  s_nop 1
  v_add_f32_dpp v220, v220, v220 row_ror:1 row_mask:0xf bank_mask:0xf
  v_mov_b32 v222, v220
  s_nop 0
  s_nop 0
  v_permlane16_swap_b32 v220, v222
  v_add_f32 v220, v220, v222
  v_mov_b32 v222, v220
  s_nop 0
  s_nop 0
  v_permlane32_swap_b32 v220, v222
  v_add_f32 v220, v220, v222
  v_mul_f32 v220, 0x3b000000, v220
  v_sub_f32 v224, v212, v220
  v_sub_f32 v225, v213, v220
  v_sub_f32 v226, v214, v220
  v_sub_f32 v227, v215, v220
  v_sub_f32 v228, v216, v220
  v_sub_f32 v229, v217, v220
  v_sub_f32 v230, v218, v220
  v_sub_f32 v231, v219, v220
  v_mul_f32 v221, v224, v224
  v_mul_f32 v222, v225, v225
  v_fmac_f32 v221, v226, v226
  v_fmac_f32 v222, v227, v227
  v_fmac_f32 v221, v228, v228
  v_fmac_f32 v222, v229, v229
  v_fmac_f32 v221, v230, v230
  v_fmac_f32 v222, v231, v231
  v_add_f32 v221, v221, v222
  v_cvt_pk_bf16_f32 v220, 0, v220
  s_nop 0
  v_add_f32_dpp v221, v221, v221 row_ror:8 row_mask:0xf bank_mask:0xf
  v_sub_f32 v224, v212, v220
  v_sub_f32 v225, v213, v220
  v_add_f32_dpp v221, v221, v221 row_ror:4 row_mask:0xf bank_mask:0xf
  v_sub_f32 v226, v214, v220
  v_sub_f32 v227, v215, v220
  v_add_f32_dpp v221, v221, v221 row_ror:2 row_mask:0xf bank_mask:0xf
  v_sub_f32 v228, v216, v220
  v_sub_f32 v229, v217, v220
  v_add_f32_dpp v221, v221, v221 row_ror:1 row_mask:0xf bank_mask:0xf
  v_sub_f32 v230, v218, v220
  v_sub_f32 v231, v219, v220
  v_mov_b32 v222, v221
  v_cvt_pk_bf16_f32 v224, 0, v224
  v_cvt_pk_bf16_f32 v225, 0, v225
  v_permlane16_swap_b32 v221, v222
  v_cvt_pk_bf16_f32 v226, 0, v226
  v_cvt_pk_bf16_f32 v227, 0, v227
  v_add_f32 v221, v221, v222
  v_cvt_pk_bf16_f32 v228, 0, v228
  v_cvt_pk_bf16_f32 v229, 0, v229
  v_mov_b32 v222, v221
  v_cvt_pk_bf16_f32 v230, 0, v230
  v_cvt_pk_bf16_f32 v231, 0, v231
  v_permlane32_swap_b32 v221, v222
  v_add_f32 v221, v221, v222
  v_mul_f32 v221, 0x3b000000, v221
  v_cvt_pk_bf16_f32 v221, 0, v221
  v_add_f32 v221, 0x3727c5ac, v221
  v_cvt_pk_bf16_f32 v221, 0, v221
  v_sqrt_f32 v221, v221
  s_nop 0
  v_cvt_pk_bf16_f32 v221, 0, v221
  v_rcp_f32 v221, v221
  s_nop 0
  v_mul_f32 v224, v224, v221
  v_mul_f32 v225, v225, v221
  v_mul_f32 v226, v226, v221
  v_mul_f32 v227, v227, v221
  v_mul_f32 v228, v228, v221
  v_mul_f32 v229, v229, v221
  v_mul_f32 v230, v230, v221
  v_mul_f32 v231, v231, v221
  v_cvt_pk_bf16_f32 v184, v224, v225
  v_cvt_pk_bf16_f32 v185, v226, v227
  v_cvt_pk_bf16_f32 v186, v228, v229
  v_cvt_pk_bf16_f32 v187, v230, v231
  buffer_store_dwordx4 v[184:187], v0, s[4:7], s29 offen sc1
  s_add_u32 s29, s29, 262144
  s_waitcnt vmcnt(40)
  v_lshlrev_b32 v212, 16, v188
  v_and_b32 v213, 0xffff0000, v188
  v_lshlrev_b32 v214, 16, v189
  v_and_b32 v215, 0xffff0000, v189
  v_lshlrev_b32 v216, 16, v190
  v_and_b32 v217, 0xffff0000, v190
  v_lshlrev_b32 v218, 16, v191
  v_and_b32 v219, 0xffff0000, v191
  v_add_f32 v220, v212, v213
  v_add_f32 v221, v214, v215
  v_add_f32 v222, v216, v217
  v_add_f32 v223, v218, v219
  v_add_f32 v220, v220, v221
  v_add_f32 v222, v222, v223
  v_add_f32 v220, v220, v222
  s_nop 1
  v_add_f32_dpp v220, v220, v220 row_ror:8 row_mask:0xf bank_mask:0xf
  s_nop 1
  v_add_f32_dpp v220, v220, v220 row_ror:4 row_mask:0xf bank_mask:0xf
  s_nop 1
  v_add_f32_dpp v220, v220, v220 row_ror:2 row_mask:0xf bank_mask:0xf
  s_nop 1
  v_add_f32_dpp v220, v220, v220 row_ror:1 row_mask:0xf bank_mask:0xf
  v_mov_b32 v222, v220
  s_nop 0
  s_nop 0
  v_permlane16_swap_b32 v220, v222
  v_add_f32 v220, v220, v222
  v_mov_b32 v222, v220
  s_nop 0
  s_nop 0
  v_permlane32_swap_b32 v220, v222
  v_add_f32 v220, v220, v222
  v_mul_f32 v220, 0x3b000000, v220
  v_sub_f32 v224, v212, v220
  v_sub_f32 v225, v213, v220
  v_sub_f32 v226, v214, v220
  v_sub_f32 v227, v215, v220
  v_sub_f32 v228, v216, v220
  v_sub_f32 v229, v217, v220
  v_sub_f32 v230, v218, v220
  v_sub_f32 v231, v219, v220
  v_mul_f32 v221, v224, v224
  v_mul_f32 v222, v225, v225
  v_fmac_f32 v221, v226, v226
  v_fmac_f32 v222, v227, v227
  v_fmac_f32 v221, v228, v228
  v_fmac_f32 v222, v229, v229
  v_fmac_f32 v221, v230, v230
  v_fmac_f32 v222, v231, v231
  v_add_f32 v221, v221, v222
  v_cvt_pk_bf16_f32 v220, 0, v220
  s_nop 0
  v_add_f32_dpp v221, v221, v221 row_ror:8 row_mask:0xf bank_mask:0xf
  v_sub_f32 v224, v212, v220
  v_sub_f32 v225, v213, v220
  v_add_f32_dpp v221, v221, v221 row_ror:4 row_mask:0xf bank_mask:0xf
  v_sub_f32 v226, v214, v220
  v_sub_f32 v227, v215, v220
  v_add_f32_dpp v221, v221, v221 row_ror:2 row_mask:0xf bank_mask:0xf
  v_sub_f32 v228, v216, v220
  v_sub_f32 v229, v217, v220
  v_add_f32_dpp v221, v221, v221 row_ror:1 row_mask:0xf bank_mask:0xf
  v_sub_f32 v230, v218, v220
  v_sub_f32 v231, v219, v220
  v_mov_b32 v222, v221
  v_cvt_pk_bf16_f32 v224, 0, v224
  v_cvt_pk_bf16_f32 v225, 0, v225
  v_permlane16_swap_b32 v221, v222
  v_cvt_pk_bf16_f32 v226, 0, v226
  v_cvt_pk_bf16_f32 v227, 0, v227
  v_add_f32 v221, v221, v222
  v_cvt_pk_bf16_f32 v228, 0, v228
  v_cvt_pk_bf16_f32 v229, 0, v229
  v_mov_b32 v222, v221
  v_cvt_pk_bf16_f32 v230, 0, v230
  v_cvt_pk_bf16_f32 v231, 0, v231
  v_permlane32_swap_b32 v221, v222
  v_add_f32 v221, v221, v222
  v_mul_f32 v221, 0x3b000000, v221
  v_cvt_pk_bf16_f32 v221, 0, v221
  v_add_f32 v221, 0x3727c5ac, v221
  v_cvt_pk_bf16_f32 v221, 0, v221
  v_sqrt_f32 v221, v221
  s_nop 0
  v_cvt_pk_bf16_f32 v221, 0, v221
  v_rcp_f32 v221, v221
  s_nop 0
  v_mul_f32 v224, v224, v221
  v_mul_f32 v225, v225, v221
  v_mul_f32 v226, v226, v221
  v_mul_f32 v227, v227, v221
  v_mul_f32 v228, v228, v221
  v_mul_f32 v229, v229, v221
  v_mul_f32 v230, v230, v221
  v_mul_f32 v231, v231, v221
  v_cvt_pk_bf16_f32 v188, v224, v225
  v_cvt_pk_bf16_f32 v189, v226, v227
  v_cvt_pk_bf16_f32 v190, v228, v229
  v_cvt_pk_bf16_f32 v191, v230, v231
  buffer_store_dwordx4 v[188:191], v0, s[4:7], s29 offen sc1
  s_add_u32 s29, s29, 262144
  s_waitcnt vmcnt(40)
  v_lshlrev_b32 v212, 16, v192
  v_and_b32 v213, 0xffff0000, v192
  v_lshlrev_b32 v214, 16, v193
  v_and_b32 v215, 0xffff0000, v193
  v_lshlrev_b32 v216, 16, v194
  v_and_b32 v217, 0xffff0000, v194
  v_lshlrev_b32 v218, 16, v195
  v_and_b32 v219, 0xffff0000, v195
  v_add_f32 v220, v212, v213
  v_add_f32 v221, v214, v215
  v_add_f32 v222, v216, v217
  v_add_f32 v223, v218, v219
  v_add_f32 v220, v220, v221
  v_add_f32 v222, v222, v223
  v_add_f32 v220, v220, v222
  s_nop 1
  v_add_f32_dpp v220, v220, v220 row_ror:8 row_mask:0xf bank_mask:0xf
  s_nop 1
  v_add_f32_dpp v220, v220, v220 row_ror:4 row_mask:0xf bank_mask:0xf
  s_nop 1
  v_add_f32_dpp v220, v220, v220 row_ror:2 row_mask:0xf bank_mask:0xf
  s_nop 1
  v_add_f32_dpp v220, v220, v220 row_ror:1 row_mask:0xf bank_mask:0xf
  v_mov_b32 v222, v220
  s_nop 0
  s_nop 0
  v_permlane16_swap_b32 v220, v222
  v_add_f32 v220, v220, v222
  v_mov_b32 v222, v220
  s_nop 0
  s_nop 0
  v_permlane32_swap_b32 v220, v222
  v_add_f32 v220, v220, v222
  v_mul_f32 v220, 0x3b000000, v220
  v_sub_f32 v224, v212, v220
  v_sub_f32 v225, v213, v220
  v_sub_f32 v226, v214, v220
  v_sub_f32 v227, v215, v220
  v_sub_f32 v228, v216, v220
  v_sub_f32 v229, v217, v220
  v_sub_f32 v230, v218, v220
  v_sub_f32 v231, v219, v220
  v_mul_f32 v221, v224, v224
  v_mul_f32 v222, v225, v225
  v_fmac_f32 v221, v226, v226
  v_fmac_f32 v222, v227, v227
  v_fmac_f32 v221, v228, v228
  v_fmac_f32 v222, v229, v229
  v_fmac_f32 v221, v230, v230
  v_fmac_f32 v222, v231, v231
  v_add_f32 v221, v221, v222
  v_cvt_pk_bf16_f32 v220, 0, v220
  s_nop 0
  v_add_f32_dpp v221, v221, v221 row_ror:8 row_mask:0xf bank_mask:0xf
  v_sub_f32 v224, v212, v220
  v_sub_f32 v225, v213, v220
  v_add_f32_dpp v221, v221, v221 row_ror:4 row_mask:0xf bank_mask:0xf
  v_sub_f32 v226, v214, v220
  v_sub_f32 v227, v215, v220
  v_add_f32_dpp v221, v221, v221 row_ror:2 row_mask:0xf bank_mask:0xf
  v_sub_f32 v228, v216, v220
  v_sub_f32 v229, v217, v220
  v_add_f32_dpp v221, v221, v221 row_ror:1 row_mask:0xf bank_mask:0xf
  v_sub_f32 v230, v218, v220
  v_sub_f32 v231, v219, v220
  v_mov_b32 v222, v221
  v_cvt_pk_bf16_f32 v224, 0, v224
  v_cvt_pk_bf16_f32 v225, 0, v225
  v_permlane16_swap_b32 v221, v222
  v_cvt_pk_bf16_f32 v226, 0, v226
  v_cvt_pk_bf16_f32 v227, 0, v227
  v_add_f32 v221, v221, v222
  v_cvt_pk_bf16_f32 v228, 0, v228
  v_cvt_pk_bf16_f32 v229, 0, v229
  v_mov_b32 v222, v221
  v_cvt_pk_bf16_f32 v230, 0, v230
  v_cvt_pk_bf16_f32 v231, 0, v231
  v_permlane32_swap_b32 v221, v222
  v_add_f32 v221, v221, v222
  v_mul_f32 v221, 0x3b000000, v221
  v_cvt_pk_bf16_f32 v221, 0, v221
  v_add_f32 v221, 0x3727c5ac, v221
  v_cvt_pk_bf16_f32 v221, 0, v221
  v_sqrt_f32 v221, v221
  s_nop 0
  v_cvt_pk_bf16_f32 v221, 0, v221
  v_rcp_f32 v221, v221
  s_nop 0
  v_mul_f32 v224, v224, v221
  v_mul_f32 v225, v225, v221
  v_mul_f32 v226, v226, v221
  v_mul_f32 v227, v227, v221
  v_mul_f32 v228, v228, v221
  v_mul_f32 v229, v229, v221
  v_mul_f32 v230, v230, v221
  v_mul_f32 v231, v231, v221
  v_cvt_pk_bf16_f32 v192, v224, v225
  v_cvt_pk_bf16_f32 v193, v226, v227
  v_cvt_pk_bf16_f32 v194, v228, v229
  v_cvt_pk_bf16_f32 v195, v230, v231
  buffer_store_dwordx4 v[192:195], v0, s[4:7], s29 offen sc1
  s_add_u32 s29, s29, 262144
  s_waitcnt vmcnt(40)
  v_lshlrev_b32 v212, 16, v196
  v_and_b32 v213, 0xffff0000, v196
  v_lshlrev_b32 v214, 16, v197
  v_and_b32 v215, 0xffff0000, v197
  v_lshlrev_b32 v216, 16, v198
  v_and_b32 v217, 0xffff0000, v198
  v_lshlrev_b32 v218, 16, v199
  v_and_b32 v219, 0xffff0000, v199
  v_add_f32 v220, v212, v213
  v_add_f32 v221, v214, v215
  v_add_f32 v222, v216, v217
  v_add_f32 v223, v218, v219
  v_add_f32 v220, v220, v221
  v_add_f32 v222, v222, v223
  v_add_f32 v220, v220, v222
  s_nop 1
  v_add_f32_dpp v220, v220, v220 row_ror:8 row_mask:0xf bank_mask:0xf
  s_nop 1
  v_add_f32_dpp v220, v220, v220 row_ror:4 row_mask:0xf bank_mask:0xf
  s_nop 1
  v_add_f32_dpp v220, v220, v220 row_ror:2 row_mask:0xf bank_mask:0xf
  s_nop 1
  v_add_f32_dpp v220, v220, v220 row_ror:1 row_mask:0xf bank_mask:0xf
  v_mov_b32 v222, v220
  s_nop 0
  s_nop 0
  v_permlane16_swap_b32 v220, v222
  v_add_f32 v220, v220, v222
  v_mov_b32 v222, v220
  s_nop 0
  s_nop 0
  v_permlane32_swap_b32 v220, v222
  v_add_f32 v220, v220, v222
  v_mul_f32 v220, 0x3b000000, v220
  v_sub_f32 v224, v212, v220
  v_sub_f32 v225, v213, v220
  v_sub_f32 v226, v214, v220
  v_sub_f32 v227, v215, v220
  v_sub_f32 v228, v216, v220
  v_sub_f32 v229, v217, v220
  v_sub_f32 v230, v218, v220
  v_sub_f32 v231, v219, v220
  v_mul_f32 v221, v224, v224
  v_mul_f32 v222, v225, v225
  v_fmac_f32 v221, v226, v226
  v_fmac_f32 v222, v227, v227
  v_fmac_f32 v221, v228, v228
  v_fmac_f32 v222, v229, v229
  v_fmac_f32 v221, v230, v230
  v_fmac_f32 v222, v231, v231
  v_add_f32 v221, v221, v222
  v_cvt_pk_bf16_f32 v220, 0, v220
  s_nop 0
  v_add_f32_dpp v221, v221, v221 row_ror:8 row_mask:0xf bank_mask:0xf
  v_sub_f32 v224, v212, v220
  v_sub_f32 v225, v213, v220
  v_add_f32_dpp v221, v221, v221 row_ror:4 row_mask:0xf bank_mask:0xf
  v_sub_f32 v226, v214, v220
  v_sub_f32 v227, v215, v220
  v_add_f32_dpp v221, v221, v221 row_ror:2 row_mask:0xf bank_mask:0xf
  v_sub_f32 v228, v216, v220
  v_sub_f32 v229, v217, v220
  v_add_f32_dpp v221, v221, v221 row_ror:1 row_mask:0xf bank_mask:0xf
  v_sub_f32 v230, v218, v220
  v_sub_f32 v231, v219, v220
  v_mov_b32 v222, v221
  v_cvt_pk_bf16_f32 v224, 0, v224
  v_cvt_pk_bf16_f32 v225, 0, v225
  v_permlane16_swap_b32 v221, v222
  v_cvt_pk_bf16_f32 v226, 0, v226
  v_cvt_pk_bf16_f32 v227, 0, v227
  v_add_f32 v221, v221, v222
  v_cvt_pk_bf16_f32 v228, 0, v228
  v_cvt_pk_bf16_f32 v229, 0, v229
  v_mov_b32 v222, v221
  v_cvt_pk_bf16_f32 v230, 0, v230
  v_cvt_pk_bf16_f32 v231, 0, v231
  v_permlane32_swap_b32 v221, v222
  v_add_f32 v221, v221, v222
  v_mul_f32 v221, 0x3b000000, v221
  v_cvt_pk_bf16_f32 v221, 0, v221
  v_add_f32 v221, 0x3727c5ac, v221
  v_cvt_pk_bf16_f32 v221, 0, v221
  v_sqrt_f32 v221, v221
  s_nop 0
  v_cvt_pk_bf16_f32 v221, 0, v221
  v_rcp_f32 v221, v221
  s_nop 0
  v_mul_f32 v224, v224, v221
  v_mul_f32 v225, v225, v221
  v_mul_f32 v226, v226, v221
  v_mul_f32 v227, v227, v221
  v_mul_f32 v228, v228, v221
  v_mul_f32 v229, v229, v221
  v_mul_f32 v230, v230, v221
  v_mul_f32 v231, v231, v221
  v_cvt_pk_bf16_f32 v196, v224, v225
  v_cvt_pk_bf16_f32 v197, v226, v227
  v_cvt_pk_bf16_f32 v198, v228, v229
  v_cvt_pk_bf16_f32 v199, v230, v231
  buffer_store_dwordx4 v[196:199], v0, s[4:7], s29 offen sc1
  s_add_u32 s29, s29, 262144
  s_waitcnt vmcnt(40)
  v_lshlrev_b32 v212, 16, v200
  v_and_b32 v213, 0xffff0000, v200
  v_lshlrev_b32 v214, 16, v201
  v_and_b32 v215, 0xffff0000, v201
  v_lshlrev_b32 v216, 16, v202
  v_and_b32 v217, 0xffff0000, v202
  v_lshlrev_b32 v218, 16, v203
  v_and_b32 v219, 0xffff0000, v203
  v_add_f32 v220, v212, v213
  v_add_f32 v221, v214, v215
  v_add_f32 v222, v216, v217
  v_add_f32 v223, v218, v219
  v_add_f32 v220, v220, v221
  v_add_f32 v222, v222, v223
  v_add_f32 v220, v220, v222
  s_nop 1
  v_add_f32_dpp v220, v220, v220 row_ror:8 row_mask:0xf bank_mask:0xf
  s_nop 1
  v_add_f32_dpp v220, v220, v220 row_ror:4 row_mask:0xf bank_mask:0xf
  s_nop 1
  v_add_f32_dpp v220, v220, v220 row_ror:2 row_mask:0xf bank_mask:0xf
  s_nop 1
  v_add_f32_dpp v220, v220, v220 row_ror:1 row_mask:0xf bank_mask:0xf
  v_mov_b32 v222, v220
  s_nop 0
  s_nop 0
  v_permlane16_swap_b32 v220, v222
  v_add_f32 v220, v220, v222
  v_mov_b32 v222, v220
  s_nop 0
  s_nop 0
  v_permlane32_swap_b32 v220, v222
  v_add_f32 v220, v220, v222
  v_mul_f32 v220, 0x3b000000, v220
  v_sub_f32 v224, v212, v220
  v_sub_f32 v225, v213, v220
  v_sub_f32 v226, v214, v220
  v_sub_f32 v227, v215, v220
  v_sub_f32 v228, v216, v220
  v_sub_f32 v229, v217, v220
  v_sub_f32 v230, v218, v220
  v_sub_f32 v231, v219, v220
  v_mul_f32 v221, v224, v224
  v_mul_f32 v222, v225, v225
  v_fmac_f32 v221, v226, v226
  v_fmac_f32 v222, v227, v227
  v_fmac_f32 v221, v228, v228
  v_fmac_f32 v222, v229, v229
  v_fmac_f32 v221, v230, v230
  v_fmac_f32 v222, v231, v231
  v_add_f32 v221, v221, v222
  v_cvt_pk_bf16_f32 v220, 0, v220
  s_nop 0
  v_add_f32_dpp v221, v221, v221 row_ror:8 row_mask:0xf bank_mask:0xf
  v_sub_f32 v224, v212, v220
  v_sub_f32 v225, v213, v220
  v_add_f32_dpp v221, v221, v221 row_ror:4 row_mask:0xf bank_mask:0xf
  v_sub_f32 v226, v214, v220
  v_sub_f32 v227, v215, v220
  v_add_f32_dpp v221, v221, v221 row_ror:2 row_mask:0xf bank_mask:0xf
  v_sub_f32 v228, v216, v220
  v_sub_f32 v229, v217, v220
  v_add_f32_dpp v221, v221, v221 row_ror:1 row_mask:0xf bank_mask:0xf
  v_sub_f32 v230, v218, v220
  v_sub_f32 v231, v219, v220
  v_mov_b32 v222, v221
  v_cvt_pk_bf16_f32 v224, 0, v224
  v_cvt_pk_bf16_f32 v225, 0, v225
  v_permlane16_swap_b32 v221, v222
  v_cvt_pk_bf16_f32 v226, 0, v226
  v_cvt_pk_bf16_f32 v227, 0, v227
  v_add_f32 v221, v221, v222
  v_cvt_pk_bf16_f32 v228, 0, v228
  v_cvt_pk_bf16_f32 v229, 0, v229
  v_mov_b32 v222, v221
  v_cvt_pk_bf16_f32 v230, 0, v230
  v_cvt_pk_bf16_f32 v231, 0, v231
  v_permlane32_swap_b32 v221, v222
  v_add_f32 v221, v221, v222
  v_mul_f32 v221, 0x3b000000, v221
  v_cvt_pk_bf16_f32 v221, 0, v221
  v_add_f32 v221, 0x3727c5ac, v221
  v_cvt_pk_bf16_f32 v221, 0, v221
  v_sqrt_f32 v221, v221
  s_nop 0
  v_cvt_pk_bf16_f32 v221, 0, v221
  v_rcp_f32 v221, v221
  s_nop 0
  v_mul_f32 v224, v224, v221
  v_mul_f32 v225, v225, v221
  v_mul_f32 v226, v226, v221
  v_mul_f32 v227, v227, v221
  v_mul_f32 v228, v228, v221
  v_mul_f32 v229, v229, v221
  v_mul_f32 v230, v230, v221
  v_mul_f32 v231, v231, v221
  v_cvt_pk_bf16_f32 v200, v224, v225
  v_cvt_pk_bf16_f32 v201, v226, v227
  v_cvt_pk_bf16_f32 v202, v228, v229
  v_cvt_pk_bf16_f32 v203, v230, v231
  buffer_store_dwordx4 v[200:203], v0, s[4:7], s29 offen sc1
  s_add_u32 s29, s29, 262144
  s_waitcnt vmcnt(40)
  v_lshlrev_b32 v212, 16, v204
  v_and_b32 v213, 0xffff0000, v204
  v_lshlrev_b32 v214, 16, v205
  v_and_b32 v215, 0xffff0000, v205
  v_lshlrev_b32 v216, 16, v206
  v_and_b32 v217, 0xffff0000, v206
  v_lshlrev_b32 v218, 16, v207
  v_and_b32 v219, 0xffff0000, v207
  v_add_f32 v220, v212, v213
  v_add_f32 v221, v214, v215
  v_add_f32 v222, v216, v217
  v_add_f32 v223, v218, v219
  v_add_f32 v220, v220, v221
  v_add_f32 v222, v222, v223
  v_add_f32 v220, v220, v222
  s_nop 1
  v_add_f32_dpp v220, v220, v220 row_ror:8 row_mask:0xf bank_mask:0xf
  s_nop 1
  v_add_f32_dpp v220, v220, v220 row_ror:4 row_mask:0xf bank_mask:0xf
  s_nop 1
  v_add_f32_dpp v220, v220, v220 row_ror:2 row_mask:0xf bank_mask:0xf
  s_nop 1
  v_add_f32_dpp v220, v220, v220 row_ror:1 row_mask:0xf bank_mask:0xf
  v_mov_b32 v222, v220
  s_nop 0
  s_nop 0
  v_permlane16_swap_b32 v220, v222
  v_add_f32 v220, v220, v222
  v_mov_b32 v222, v220
  s_nop 0
  s_nop 0
  v_permlane32_swap_b32 v220, v222
  v_add_f32 v220, v220, v222
  v_mul_f32 v220, 0x3b000000, v220
  v_sub_f32 v224, v212, v220
  v_sub_f32 v225, v213, v220
  v_sub_f32 v226, v214, v220
  v_sub_f32 v227, v215, v220
  v_sub_f32 v228, v216, v220
  v_sub_f32 v229, v217, v220
  v_sub_f32 v230, v218, v220
  v_sub_f32 v231, v219, v220
  v_mul_f32 v221, v224, v224
  v_mul_f32 v222, v225, v225
  v_fmac_f32 v221, v226, v226
  v_fmac_f32 v222, v227, v227
  v_fmac_f32 v221, v228, v228
  v_fmac_f32 v222, v229, v229
  v_fmac_f32 v221, v230, v230
  v_fmac_f32 v222, v231, v231
  v_add_f32 v221, v221, v222
  v_cvt_pk_bf16_f32 v220, 0, v220
  s_nop 0
  v_add_f32_dpp v221, v221, v221 row_ror:8 row_mask:0xf bank_mask:0xf
  v_sub_f32 v224, v212, v220
  v_sub_f32 v225, v213, v220
  v_add_f32_dpp v221, v221, v221 row_ror:4 row_mask:0xf bank_mask:0xf
  v_sub_f32 v226, v214, v220
  v_sub_f32 v227, v215, v220
  v_add_f32_dpp v221, v221, v221 row_ror:2 row_mask:0xf bank_mask:0xf
  v_sub_f32 v228, v216, v220
  v_sub_f32 v229, v217, v220
  v_add_f32_dpp v221, v221, v221 row_ror:1 row_mask:0xf bank_mask:0xf
  v_sub_f32 v230, v218, v220
  v_sub_f32 v231, v219, v220
  v_mov_b32 v222, v221
  v_cvt_pk_bf16_f32 v224, 0, v224
  v_cvt_pk_bf16_f32 v225, 0, v225
  v_permlane16_swap_b32 v221, v222
  v_cvt_pk_bf16_f32 v226, 0, v226
  v_cvt_pk_bf16_f32 v227, 0, v227
  v_add_f32 v221, v221, v222
  v_cvt_pk_bf16_f32 v228, 0, v228
  v_cvt_pk_bf16_f32 v229, 0, v229
  v_mov_b32 v222, v221
  v_cvt_pk_bf16_f32 v230, 0, v230
  v_cvt_pk_bf16_f32 v231, 0, v231
  v_permlane32_swap_b32 v221, v222
  v_add_f32 v221, v221, v222
  v_mul_f32 v221, 0x3b000000, v221
  v_cvt_pk_bf16_f32 v221, 0, v221
  v_add_f32 v221, 0x3727c5ac, v221
  v_cvt_pk_bf16_f32 v221, 0, v221
  v_sqrt_f32 v221, v221
  s_nop 0
  v_cvt_pk_bf16_f32 v221, 0, v221
  v_rcp_f32 v221, v221
  s_nop 0
  v_mul_f32 v224, v224, v221
  v_mul_f32 v225, v225, v221
  v_mul_f32 v226, v226, v221
  v_mul_f32 v227, v227, v221
  v_mul_f32 v228, v228, v221
  v_mul_f32 v229, v229, v221
  v_mul_f32 v230, v230, v221
  v_mul_f32 v231, v231, v221
  v_cvt_pk_bf16_f32 v204, v224, v225
  v_cvt_pk_bf16_f32 v205, v226, v227
  v_cvt_pk_bf16_f32 v206, v228, v229
  v_cvt_pk_bf16_f32 v207, v230, v231
  buffer_store_dwordx4 v[204:207], v0, s[4:7], s29 offen sc1
  s_add_u32 s29, s29, 262144
o_s2_110:
  s_waitcnt vmcnt(33)
  v_perm_b32 v48, v66, v64, s44
  v_perm_b32 v49, v70, v68, s44
  v_perm_b32 v50, v74, v72, s44
  v_perm_b32 v51, v78, v76, s44
  v_accvgpr_write_b32 a0, v48
  v_accvgpr_write_b32 a1, v49
  v_accvgpr_write_b32 a2, v50
  v_accvgpr_write_b32 a3, v51
  v_perm_b32 v52, v66, v64, s45
  v_perm_b32 v53, v70, v68, s45
  v_perm_b32 v54, v74, v72, s45
  v_perm_b32 v55, v78, v76, s45
  v_accvgpr_write_b32 a4, v52
  v_accvgpr_write_b32 a5, v53
  v_accvgpr_write_b32 a6, v54
  v_accvgpr_write_b32 a7, v55
  v_perm_b32 v48, v67, v65, s44
  v_perm_b32 v49, v71, v69, s44
  v_perm_b32 v50, v75, v73, s44
  v_perm_b32 v51, v79, v77, s44
  v_accvgpr_write_b32 a8, v48
  v_accvgpr_write_b32 a9, v49
  v_accvgpr_write_b32 a10, v50
  v_accvgpr_write_b32 a11, v51
  v_perm_b32 v52, v67, v65, s45
  v_perm_b32 v53, v71, v69, s45
  v_perm_b32 v54, v75, v73, s45
  v_perm_b32 v55, v79, v77, s45
  v_accvgpr_write_b32 a12, v52
  v_accvgpr_write_b32 a13, v53
  v_accvgpr_write_b32 a14, v54
  v_accvgpr_write_b32 a15, v55
  s_waitcnt vmcnt(25)
  v_perm_b32 v48, v82, v80, s44
  v_perm_b32 v49, v86, v84, s44
  v_perm_b32 v50, v90, v88, s44
  v_perm_b32 v51, v94, v92, s44
  v_accvgpr_write_b32 a16, v48
  v_accvgpr_write_b32 a17, v49
  v_accvgpr_write_b32 a18, v50
  v_accvgpr_write_b32 a19, v51
  v_perm_b32 v52, v82, v80, s45
  v_perm_b32 v53, v86, v84, s45
  v_perm_b32 v54, v90, v88, s45
  v_perm_b32 v55, v94, v92, s45
  v_accvgpr_write_b32 a20, v52
  v_accvgpr_write_b32 a21, v53
  v_accvgpr_write_b32 a22, v54
  v_accvgpr_write_b32 a23, v55
  v_perm_b32 v48, v83, v81, s44
  v_perm_b32 v49, v87, v85, s44
  v_perm_b32 v50, v91, v89, s44
  v_perm_b32 v51, v95, v93, s44
  v_accvgpr_write_b32 a24, v48
  v_accvgpr_write_b32 a25, v49
  v_accvgpr_write_b32 a26, v50
  v_accvgpr_write_b32 a27, v51
  v_perm_b32 v52, v83, v81, s45
  v_perm_b32 v53, v87, v85, s45
  v_perm_b32 v54, v91, v89, s45
  v_perm_b32 v55, v95, v93, s45
  v_accvgpr_write_b32 a28, v52
  v_accvgpr_write_b32 a29, v53
  v_accvgpr_write_b32 a30, v54
  v_accvgpr_write_b32 a31, v55
  s_waitcnt vmcnt(17)
  v_perm_b32 v48, v98, v96, s44
  v_perm_b32 v49, v102, v100, s44
  v_perm_b32 v50, v106, v104, s44
  v_perm_b32 v51, v110, v108, s44
  v_accvgpr_write_b32 a32, v48
  v_accvgpr_write_b32 a33, v49
  v_accvgpr_write_b32 a34, v50
  v_accvgpr_write_b32 a35, v51
  v_perm_b32 v52, v98, v96, s45
  v_perm_b32 v53, v102, v100, s45
  v_perm_b32 v54, v106, v104, s45
  v_perm_b32 v55, v110, v108, s45
  v_accvgpr_write_b32 a36, v52
  v_accvgpr_write_b32 a37, v53
  v_accvgpr_write_b32 a38, v54
  v_accvgpr_write_b32 a39, v55
  v_perm_b32 v48, v99, v97, s44
  v_perm_b32 v49, v103, v101, s44
  v_perm_b32 v50, v107, v105, s44
  v_perm_b32 v51, v111, v109, s44
  v_accvgpr_write_b32 a40, v48
  v_accvgpr_write_b32 a41, v49
  v_accvgpr_write_b32 a42, v50
  v_accvgpr_write_b32 a43, v51
  v_perm_b32 v52, v99, v97, s45
  v_perm_b32 v53, v103, v101, s45
  v_perm_b32 v54, v107, v105, s45
  v_perm_b32 v55, v111, v109, s45
  v_accvgpr_write_b32 a44, v52
  v_accvgpr_write_b32 a45, v53
  v_accvgpr_write_b32 a46, v54
  v_accvgpr_write_b32 a47, v55
  s_waitcnt vmcnt(9)
  v_perm_b32 v48, v114, v112, s44
  v_perm_b32 v49, v118, v116, s44
  v_perm_b32 v50, v122, v120, s44
  v_perm_b32 v51, v126, v124, s44
  v_accvgpr_write_b32 a48, v48
  v_accvgpr_write_b32 a49, v49
  v_accvgpr_write_b32 a50, v50
  v_accvgpr_write_b32 a51, v51
  v_perm_b32 v52, v114, v112, s45
  v_perm_b32 v53, v118, v116, s45
  v_perm_b32 v54, v122, v120, s45
  v_perm_b32 v55, v126, v124, s45
  v_accvgpr_write_b32 a52, v52
  v_accvgpr_write_b32 a53, v53
  v_accvgpr_write_b32 a54, v54
  v_accvgpr_write_b32 a55, v55
  v_perm_b32 v48, v115, v113, s44
  v_perm_b32 v49, v119, v117, s44
  v_perm_b32 v50, v123, v121, s44
  v_perm_b32 v51, v127, v125, s44
  v_accvgpr_write_b32 a56, v48
  v_accvgpr_write_b32 a57, v49
  v_accvgpr_write_b32 a58, v50
  v_accvgpr_write_b32 a59, v51
  v_perm_b32 v52, v115, v113, s45
  v_perm_b32 v53, v119, v117, s45
  v_perm_b32 v54, v123, v121, s45
  v_perm_b32 v55, v127, v125, s45
  v_accvgpr_write_b32 a60, v52
  v_accvgpr_write_b32 a61, v53
  v_accvgpr_write_b32 a62, v54
  v_accvgpr_write_b32 a63, v55
  v_mbcnt_lo_u32_b32 v60, -1, 0
  v_and_b32 v60, 0, v60
  v_add_lshl_u32 v60, v60, 1, 2
  s_mov_b32 s26, 0
g_wt_112:
  global_load_dword v61, v60, s[12:13] offset:128 sc1
  s_add_u32 s26, s26, 1
  s_cmp_gt_u32 s26, 1048576
  s_cbranch_scc1 L_end
  s_waitcnt vmcnt(0)
  v_cmp_eq_u32 vcc, 0, v61
  v_readfirstlane_b32 s27, v61
  s_cbranch_vccnz g_wt_112
  s_cmp_ge_u32 s60, 4
  s_cbranch_scc1 o_s3_111
  s_lshl_b32 s27, s77, 7
  s_add_u32 s27, s27, 243269632
  v_lshlrev_b32 v61, 11, v0
  v_mov_b32 v60, 1
  s_mov_b64 exec, 255
  buffer_store_dword v60, v61, s[4:7], s27 offen sc1
  s_mov_b64 exec, -1
o_s3_111:
  s_add_u32 s27, s30, 65536
  s_nop 0
  buffer_load_dwordx2 v[128:129], v44, s[80:83], s27 offen
  s_add_u32 s27, s30, 66560
  buffer_load_dwordx2 v[130:131], v44, s[80:83], s27 offen
  s_add_u32 s27, s30, 67584
  buffer_load_dwordx2 v[132:133], v44, s[80:83], s27 offen
  s_add_u32 s27, s30, 68608
  buffer_load_dwordx2 v[134:135], v44, s[80:83], s27 offen
  s_add_u32 s27, s30, 81920
  buffer_load_dwordx2 v[136:137], v44, s[80:83], s27 offen
  s_add_u32 s27, s30, 82944
  buffer_load_dwordx2 v[138:139], v44, s[80:83], s27 offen
  s_add_u32 s27, s30, 83968
  buffer_load_dwordx2 v[140:141], v44, s[80:83], s27 offen
  s_add_u32 s27, s30, 84992
  buffer_load_dwordx2 v[142:143], v44, s[80:83], s27 offen
  s_add_u32 s27, s30, 73728
  buffer_load_dwordx2 v[144:145], v44, s[80:83], s27 offen
  s_add_u32 s27, s30, 74752
  buffer_load_dwordx2 v[146:147], v44, s[80:83], s27 offen
  s_add_u32 s27, s30, 75776
  buffer_load_dwordx2 v[148:149], v44, s[80:83], s27 offen
  s_add_u32 s27, s30, 76800
  buffer_load_dwordx2 v[150:151], v44, s[80:83], s27 offen
  s_add_u32 s27, s30, 90112
  buffer_load_dwordx2 v[152:153], v44, s[80:83], s27 offen
  s_add_u32 s27, s30, 91136
  buffer_load_dwordx2 v[154:155], v44, s[80:83], s27 offen
  s_add_u32 s27, s30, 92160
  buffer_load_dwordx2 v[156:157], v44, s[80:83], s27 offen
  s_add_u32 s27, s30, 93184
  buffer_load_dwordx2 v[158:159], v44, s[80:83], s27 offen
  s_add_u32 s27, s30, 98304
  buffer_load_dwordx2 v[160:161], v44, s[80:83], s27 offen
  s_add_u32 s27, s30, 99328
  buffer_load_dwordx2 v[162:163], v44, s[80:83], s27 offen
  s_add_u32 s27, s30, 100352
  buffer_load_dwordx2 v[164:165], v44, s[80:83], s27 offen
  s_add_u32 s27, s30, 101376
  buffer_load_dwordx2 v[166:167], v44, s[80:83], s27 offen
  s_add_u32 s27, s30, 114688
  buffer_load_dwordx2 v[168:169], v44, s[80:83], s27 offen
  s_add_u32 s27, s30, 115712
  buffer_load_dwordx2 v[170:171], v44, s[80:83], s27 offen
  s_add_u32 s27, s30, 116736
  buffer_load_dwordx2 v[172:173], v44, s[80:83], s27 offen
  s_add_u32 s27, s30, 117760
  buffer_load_dwordx2 v[174:175], v44, s[80:83], s27 offen
  s_add_u32 s27, s30, 106496
  buffer_load_dwordx2 v[64:65], v44, s[80:83], s27 offen
  s_add_u32 s27, s30, 107520
  buffer_load_dwordx2 v[66:67], v44, s[80:83], s27 offen
  s_add_u32 s27, s30, 108544
  buffer_load_dwordx2 v[68:69], v44, s[80:83], s27 offen
  s_add_u32 s27, s30, 109568
  buffer_load_dwordx2 v[70:71], v44, s[80:83], s27 offen
  s_add_u32 s27, s30, 122880
  buffer_load_dwordx2 v[72:73], v44, s[80:83], s27 offen
  s_add_u32 s27, s30, 123904
  buffer_load_dwordx2 v[74:75], v44, s[80:83], s27 offen
  s_add_u32 s27, s30, 124928
  buffer_load_dwordx2 v[76:77], v44, s[80:83], s27 offen
  s_add_u32 s27, s30, 125952
  buffer_load_dwordx2 v[78:79], v44, s[80:83], s27 offen
  s_add_u32 s27, s30, 131072
  buffer_load_dwordx2 v[80:81], v44, s[80:83], s27 offen
  s_add_u32 s27, s30, 132096
  buffer_load_dwordx2 v[82:83], v44, s[80:83], s27 offen
  s_add_u32 s27, s30, 133120
  buffer_load_dwordx2 v[84:85], v44, s[80:83], s27 offen
  s_add_u32 s27, s30, 134144
  buffer_load_dwordx2 v[86:87], v44, s[80:83], s27 offen
  s_add_u32 s27, s30, 147456
  buffer_load_dwordx2 v[88:89], v44, s[80:83], s27 offen
  s_add_u32 s27, s30, 148480
  buffer_load_dwordx2 v[90:91], v44, s[80:83], s27 offen
  s_add_u32 s27, s30, 149504
  buffer_load_dwordx2 v[92:93], v44, s[80:83], s27 offen
  s_add_u32 s27, s30, 150528
  buffer_load_dwordx2 v[94:95], v44, s[80:83], s27 offen
  s_add_u32 s27, s30, 139264
  buffer_load_dwordx2 v[96:97], v44, s[80:83], s27 offen
  s_add_u32 s27, s30, 140288
  buffer_load_dwordx2 v[98:99], v44, s[80:83], s27 offen
  s_add_u32 s27, s30, 141312
  buffer_load_dwordx2 v[100:101], v44, s[80:83], s27 offen
  s_add_u32 s27, s30, 142336
  buffer_load_dwordx2 v[102:103], v44, s[80:83], s27 offen
  s_add_u32 s27, s30, 155648
  buffer_load_dwordx2 v[104:105], v44, s[80:83], s27 offen
  s_add_u32 s27, s30, 156672
  buffer_load_dwordx2 v[106:107], v44, s[80:83], s27 offen
  s_add_u32 s27, s30, 157696
  buffer_load_dwordx2 v[108:109], v44, s[80:83], s27 offen
  s_add_u32 s27, s30, 158720
  buffer_load_dwordx2 v[110:111], v44, s[80:83], s27 offen
  s_add_u32 s27, s30, 163840
  buffer_load_dwordx2 v[112:113], v44, s[80:83], s27 offen
  s_add_u32 s27, s30, 164864
  buffer_load_dwordx2 v[114:115], v44, s[80:83], s27 offen
  s_add_u32 s27, s30, 165888
  buffer_load_dwordx2 v[116:117], v44, s[80:83], s27 offen
  s_add_u32 s27, s30, 166912
  buffer_load_dwordx2 v[118:119], v44, s[80:83], s27 offen
  s_add_u32 s27, s30, 180224
  buffer_load_dwordx2 v[120:121], v44, s[80:83], s27 offen
  s_add_u32 s27, s30, 181248
  buffer_load_dwordx2 v[122:123], v44, s[80:83], s27 offen
  s_add_u32 s27, s30, 182272
  buffer_load_dwordx2 v[124:125], v44, s[80:83], s27 offen
  s_add_u32 s27, s30, 183296
  buffer_load_dwordx2 v[126:127], v44, s[80:83], s27 offen
  v_lshlrev_b32 v8, 16, v56
  v_and_b32 v9, 0xffff0000, v56
  v_lshlrev_b32 v10, 16, v57
  v_and_b32 v11, 0xffff0000, v57
  v_lshlrev_b32 v12, 16, v58
  v_and_b32 v13, 0xffff0000, v58
  v_lshlrev_b32 v14, 16, v59
  v_and_b32 v15, 0xffff0000, v59
  v_mul_f32 v56, v8, v8
  v_fmac_f32 v56, v9, v9
  v_fmac_f32 v56, v10, v10
  v_fmac_f32 v56, v11, v11
  v_fmac_f32 v56, v12, v12
  v_fmac_f32 v56, v13, v13
  v_fmac_f32 v56, v14, v14
  v_fmac_f32 v56, v15, v15
  s_nop 0
  s_nop 0
  v_add_f32_dpp v56, v56, v56 row_ror:8 row_mask:0xf bank_mask:0xf
  s_nop 1
  v_add_f32_dpp v56, v56, v56 row_ror:4 row_mask:0xf bank_mask:0xf
  s_nop 1
  v_add_f32_dpp v56, v56, v56 row_ror:2 row_mask:0xf bank_mask:0xf
  s_nop 1
  v_add_f32_dpp v56, v56, v56 row_ror:1 row_mask:0xf bank_mask:0xf
  v_mov_b32 v57, v56
  s_nop 0
  s_nop 0
  v_permlane16_swap_b32 v56, v57
  v_add_f32 v56, v56, v57
  v_mov_b32 v57, v56
  s_nop 0
  s_nop 0
  v_permlane32_swap_b32 v56, v57
  v_add_f32 v56, v56, v57
  v_sqrt_f32 v56, v56
  s_mov_b32 s28, 0x40598569
  v_writelane_b32 v247, s28, 0
  s_mov_b32 s28, 0x40598569
  v_writelane_b32 v247, s28, 1
  s_mov_b32 s28, 0x4058ade7
  v_writelane_b32 v247, s28, 2
  s_mov_b32 s28, 0x40577c32
  v_writelane_b32 v247, s28, 3
  s_mov_b32 s28, 0x40563297
  v_writelane_b32 v247, s28, 4
  s_mov_b32 s28, 0x4054cd28
  v_writelane_b32 v247, s28, 5
  s_mov_b32 s28, 0x405346f2
  v_writelane_b32 v247, s28, 6
  s_mov_b32 s28, 0x40519992
  v_writelane_b32 v247, s28, 7
  s_mov_b32 s28, 0x404fbc99
  v_writelane_b32 v247, s28, 8
  s_mov_b32 s28, 0x404da49a
  v_writelane_b32 v247, s28, 9
  s_mov_b32 s28, 0x404b418a
  v_writelane_b32 v247, s28, 10
  s_mov_b32 s28, 0x40487bed
  v_writelane_b32 v247, s28, 11
  s_mov_b32 s28, 0x40452f68
  v_writelane_b32 v247, s28, 12
  s_mov_b32 s28, 0x40411f69
  v_writelane_b32 v247, s28, 13
  s_mov_b32 s28, 0x403bdbac
  v_writelane_b32 v247, s28, 14
  s_mov_b32 s28, 0x40346eae
  v_writelane_b32 v247, s28, 15
  s_mov_b32 s28, 0x4028005c
  v_writelane_b32 v247, s28, 16
  s_mov_b32 s28, 0x4001516e
  v_writelane_b32 v247, s28, 17
  s_mov_b32 s28, 0x4001516e
  v_writelane_b32 v247, s28, 18
  v_mul_f32 v247, v247, v56
  v_or_b32 v247, 0x80000000, v247
  s_lshl_b32 s29, s61, 2
  s_add_u32 s29, s29, s17
  s_lshl_b32 s29, s29, 13
  s_add_u32 s29, s29, s41
  v_mov_b64 v[208:209], 0
  v_mov_b64 v[210:211], 0
  s_waitcnt vmcnt(48)
  v_perm_b32 v48, v130, v128, s44
  v_perm_b32 v49, v134, v132, s44
  v_perm_b32 v50, v138, v136, s44
  v_perm_b32 v51, v142, v140, s44
  v_accvgpr_write_b32 a64, v48
  v_accvgpr_write_b32 a65, v49
  v_accvgpr_write_b32 a66, v50
  v_accvgpr_write_b32 a67, v51
  v_perm_b32 v52, v130, v128, s45
  v_perm_b32 v53, v134, v132, s45
  v_perm_b32 v54, v138, v136, s45
  v_perm_b32 v55, v142, v140, s45
  v_accvgpr_write_b32 a68, v52
  v_accvgpr_write_b32 a69, v53
  v_accvgpr_write_b32 a70, v54
  v_accvgpr_write_b32 a71, v55
  v_perm_b32 v48, v131, v129, s44
  v_perm_b32 v49, v135, v133, s44
  v_perm_b32 v50, v139, v137, s44
  v_perm_b32 v51, v143, v141, s44
  v_accvgpr_write_b32 a72, v48
  v_accvgpr_write_b32 a73, v49
  v_accvgpr_write_b32 a74, v50
  v_accvgpr_write_b32 a75, v51
  v_perm_b32 v52, v131, v129, s45
  v_perm_b32 v53, v135, v133, s45
  v_perm_b32 v54, v139, v137, s45
  v_perm_b32 v55, v143, v141, s45
  v_accvgpr_write_b32 a76, v52
  v_accvgpr_write_b32 a77, v53
  v_accvgpr_write_b32 a78, v54
  v_accvgpr_write_b32 a79, v55
  s_add_u32 s27, s30, 172032
  buffer_load_dwordx2 v[128:129], v44, s[80:83], s27 offen
  s_add_u32 s27, s30, 173056
  buffer_load_dwordx2 v[130:131], v44, s[80:83], s27 offen
  s_add_u32 s27, s30, 174080
  buffer_load_dwordx2 v[132:133], v44, s[80:83], s27 offen
  s_add_u32 s27, s30, 175104
  buffer_load_dwordx2 v[134:135], v44, s[80:83], s27 offen
  s_add_u32 s27, s30, 188416
  buffer_load_dwordx2 v[136:137], v44, s[80:83], s27 offen
  s_add_u32 s27, s30, 189440
  buffer_load_dwordx2 v[138:139], v44, s[80:83], s27 offen
  s_add_u32 s27, s30, 190464
  buffer_load_dwordx2 v[140:141], v44, s[80:83], s27 offen
  s_add_u32 s27, s30, 191488
  buffer_load_dwordx2 v[142:143], v44, s[80:83], s27 offen
  s_waitcnt vmcnt(48)
  v_perm_b32 v48, v146, v144, s44
  v_perm_b32 v49, v150, v148, s44
  v_perm_b32 v50, v154, v152, s44
  v_perm_b32 v51, v158, v156, s44
  v_accvgpr_write_b32 a80, v48
  v_accvgpr_write_b32 a81, v49
  v_accvgpr_write_b32 a82, v50
  v_accvgpr_write_b32 a83, v51
  v_perm_b32 v52, v146, v144, s45
  v_perm_b32 v53, v150, v148, s45
  v_perm_b32 v54, v154, v152, s45
  v_perm_b32 v55, v158, v156, s45
  v_accvgpr_write_b32 a84, v52
  v_accvgpr_write_b32 a85, v53
  v_accvgpr_write_b32 a86, v54
  v_accvgpr_write_b32 a87, v55
  v_perm_b32 v48, v147, v145, s44
  v_perm_b32 v49, v151, v149, s44
  v_perm_b32 v50, v155, v153, s44
  v_perm_b32 v51, v159, v157, s44
  v_accvgpr_write_b32 a88, v48
  v_accvgpr_write_b32 a89, v49
  v_accvgpr_write_b32 a90, v50
  v_accvgpr_write_b32 a91, v51
  v_perm_b32 v52, v147, v145, s45
  v_perm_b32 v53, v151, v149, s45
  v_perm_b32 v54, v155, v153, s45
  v_perm_b32 v55, v159, v157, s45
  v_accvgpr_write_b32 a92, v52
  v_accvgpr_write_b32 a93, v53
  v_accvgpr_write_b32 a94, v54
  v_accvgpr_write_b32 a95, v55
  s_add_u32 s27, s30, 196608
  buffer_load_dwordx2 v[144:145], v44, s[80:83], s27 offen
  s_add_u32 s27, s30, 197632
  buffer_load_dwordx2 v[146:147], v44, s[80:83], s27 offen
  s_add_u32 s27, s30, 198656
  buffer_load_dwordx2 v[148:149], v44, s[80:83], s27 offen
  s_add_u32 s27, s30, 199680
  buffer_load_dwordx2 v[150:151], v44, s[80:83], s27 offen
  s_add_u32 s27, s30, 212992
  buffer_load_dwordx2 v[152:153], v44, s[80:83], s27 offen
  s_add_u32 s27, s30, 214016
  buffer_load_dwordx2 v[154:155], v44, s[80:83], s27 offen
  s_add_u32 s27, s30, 215040
  buffer_load_dwordx2 v[156:157], v44, s[80:83], s27 offen
  s_add_u32 s27, s30, 216064
  buffer_load_dwordx2 v[158:159], v44, s[80:83], s27 offen
  s_waitcnt vmcnt(48)
  v_perm_b32 v48, v162, v160, s44
  v_perm_b32 v49, v166, v164, s44
  v_perm_b32 v50, v170, v168, s44
  v_perm_b32 v51, v174, v172, s44
  v_accvgpr_write_b32 a96, v48
  v_accvgpr_write_b32 a97, v49
  v_accvgpr_write_b32 a98, v50
  v_accvgpr_write_b32 a99, v51
  v_perm_b32 v52, v162, v160, s45
  v_perm_b32 v53, v166, v164, s45
  v_perm_b32 v54, v170, v168, s45
  v_perm_b32 v55, v174, v172, s45
  v_accvgpr_write_b32 a100, v52
  v_accvgpr_write_b32 a101, v53
  v_accvgpr_write_b32 a102, v54
  v_accvgpr_write_b32 a103, v55
  v_perm_b32 v48, v163, v161, s44
  v_perm_b32 v49, v167, v165, s44
  v_perm_b32 v50, v171, v169, s44
  v_perm_b32 v51, v175, v173, s44
  v_accvgpr_write_b32 a104, v48
  v_accvgpr_write_b32 a105, v49
  v_accvgpr_write_b32 a106, v50
  v_accvgpr_write_b32 a107, v51
  v_perm_b32 v52, v163, v161, s45
  v_perm_b32 v53, v167, v165, s45
  v_perm_b32 v54, v171, v169, s45
  v_perm_b32 v55, v175, v173, s45
  v_accvgpr_write_b32 a108, v52
  v_accvgpr_write_b32 a109, v53
  v_accvgpr_write_b32 a110, v54
  v_accvgpr_write_b32 a111, v55
  s_add_u32 s27, s30, 204800
  buffer_load_dwordx2 v[160:161], v44, s[80:83], s27 offen
  s_add_u32 s27, s30, 205824
  buffer_load_dwordx2 v[162:163], v44, s[80:83], s27 offen
  s_add_u32 s27, s30, 206848
  buffer_load_dwordx2 v[164:165], v44, s[80:83], s27 offen
  s_add_u32 s27, s30, 207872
  buffer_load_dwordx2 v[166:167], v44, s[80:83], s27 offen
  s_add_u32 s27, s30, 221184
  buffer_load_dwordx2 v[168:169], v44, s[80:83], s27 offen
  s_add_u32 s27, s30, 222208
  buffer_load_dwordx2 v[170:171], v44, s[80:83], s27 offen
  s_add_u32 s27, s30, 223232
  buffer_load_dwordx2 v[172:173], v44, s[80:83], s27 offen
  s_add_u32 s27, s30, 224256
  buffer_load_dwordx2 v[174:175], v44, s[80:83], s27 offen
  s_waitcnt vmcnt(48)
  v_perm_b32 v48, v66, v64, s44
  v_perm_b32 v49, v70, v68, s44
  v_perm_b32 v50, v74, v72, s44
  v_perm_b32 v51, v78, v76, s44
  v_accvgpr_write_b32 a112, v48
  v_accvgpr_write_b32 a113, v49
  v_accvgpr_write_b32 a114, v50
  v_accvgpr_write_b32 a115, v51
  v_perm_b32 v52, v66, v64, s45
  v_perm_b32 v53, v70, v68, s45
  v_perm_b32 v54, v74, v72, s45
  v_perm_b32 v55, v78, v76, s45
  v_accvgpr_write_b32 a116, v52
  v_accvgpr_write_b32 a117, v53
  v_accvgpr_write_b32 a118, v54
  v_accvgpr_write_b32 a119, v55
  v_perm_b32 v48, v67, v65, s44
  v_perm_b32 v49, v71, v69, s44
  v_perm_b32 v50, v75, v73, s44
  v_perm_b32 v51, v79, v77, s44
  v_accvgpr_write_b32 a120, v48
  v_accvgpr_write_b32 a121, v49
  v_accvgpr_write_b32 a122, v50
  v_accvgpr_write_b32 a123, v51
  v_perm_b32 v52, v67, v65, s45
  v_perm_b32 v53, v71, v69, s45
  v_perm_b32 v54, v75, v73, s45
  v_perm_b32 v55, v79, v77, s45
  v_accvgpr_write_b32 a124, v52
  v_accvgpr_write_b32 a125, v53
  v_accvgpr_write_b32 a126, v54
  v_accvgpr_write_b32 a127, v55
  s_add_u32 s27, s30, 229376
  buffer_load_dwordx2 v[64:65], v44, s[80:83], s27 offen
  s_add_u32 s27, s30, 230400
  buffer_load_dwordx2 v[66:67], v44, s[80:83], s27 offen
  s_add_u32 s27, s30, 231424
  buffer_load_dwordx2 v[68:69], v44, s[80:83], s27 offen
  s_add_u32 s27, s30, 232448
  buffer_load_dwordx2 v[70:71], v44, s[80:83], s27 offen
  s_add_u32 s27, s30, 245760
  buffer_load_dwordx2 v[72:73], v44, s[80:83], s27 offen
  s_add_u32 s27, s30, 246784
  buffer_load_dwordx2 v[74:75], v44, s[80:83], s27 offen
  s_add_u32 s27, s30, 247808
  buffer_load_dwordx2 v[76:77], v44, s[80:83], s27 offen
  s_add_u32 s27, s30, 248832
  buffer_load_dwordx2 v[78:79], v44, s[80:83], s27 offen
  s_waitcnt vmcnt(48)
  v_perm_b32 v48, v82, v80, s44
  v_perm_b32 v49, v86, v84, s44
  v_perm_b32 v50, v90, v88, s44
  v_perm_b32 v51, v94, v92, s44
  v_accvgpr_write_b32 a128, v48
  v_accvgpr_write_b32 a129, v49
  v_accvgpr_write_b32 a130, v50
  v_accvgpr_write_b32 a131, v51
  v_perm_b32 v52, v82, v80, s45
  v_perm_b32 v53, v86, v84, s45
  v_perm_b32 v54, v90, v88, s45
  v_perm_b32 v55, v94, v92, s45
  v_accvgpr_write_b32 a132, v52
  v_accvgpr_write_b32 a133, v53
  v_accvgpr_write_b32 a134, v54
  v_accvgpr_write_b32 a135, v55
  v_perm_b32 v48, v83, v81, s44
  v_perm_b32 v49, v87, v85, s44
  v_perm_b32 v50, v91, v89, s44
  v_perm_b32 v51, v95, v93, s44
  v_accvgpr_write_b32 a136, v48
  v_accvgpr_write_b32 a137, v49
  v_accvgpr_write_b32 a138, v50
  v_accvgpr_write_b32 a139, v51
  v_perm_b32 v52, v83, v81, s45
  v_perm_b32 v53, v87, v85, s45
  v_perm_b32 v54, v91, v89, s45
  v_perm_b32 v55, v95, v93, s45
  v_accvgpr_write_b32 a140, v52
  v_accvgpr_write_b32 a141, v53
  v_accvgpr_write_b32 a142, v54
  v_accvgpr_write_b32 a143, v55
  s_add_u32 s27, s30, 237568
  buffer_load_dwordx2 v[80:81], v44, s[80:83], s27 offen
  s_add_u32 s27, s30, 238592
  buffer_load_dwordx2 v[82:83], v44, s[80:83], s27 offen
  s_add_u32 s27, s30, 239616
  buffer_load_dwordx2 v[84:85], v44, s[80:83], s27 offen
  s_add_u32 s27, s30, 240640
  buffer_load_dwordx2 v[86:87], v44, s[80:83], s27 offen
  s_add_u32 s27, s30, 253952
  buffer_load_dwordx2 v[88:89], v44, s[80:83], s27 offen
  s_add_u32 s27, s30, 254976
  buffer_load_dwordx2 v[90:91], v44, s[80:83], s27 offen
  s_add_u32 s27, s30, 256000
  buffer_load_dwordx2 v[92:93], v44, s[80:83], s27 offen
  s_add_u32 s27, s30, 257024
  buffer_load_dwordx2 v[94:95], v44, s[80:83], s27 offen
  s_waitcnt vmcnt(48)
  v_perm_b32 v48, v98, v96, s44
  v_perm_b32 v49, v102, v100, s44
  v_perm_b32 v50, v106, v104, s44
  v_perm_b32 v51, v110, v108, s44
  v_accvgpr_write_b32 a144, v48
  v_accvgpr_write_b32 a145, v49
  v_accvgpr_write_b32 a146, v50
  v_accvgpr_write_b32 a147, v51
  v_perm_b32 v52, v98, v96, s45
  v_perm_b32 v53, v102, v100, s45
  v_perm_b32 v54, v106, v104, s45
  v_perm_b32 v55, v110, v108, s45
  v_accvgpr_write_b32 a148, v52
  v_accvgpr_write_b32 a149, v53
  v_accvgpr_write_b32 a150, v54
  v_accvgpr_write_b32 a151, v55
  v_perm_b32 v48, v99, v97, s44
  v_perm_b32 v49, v103, v101, s44
  v_perm_b32 v50, v107, v105, s44
  v_perm_b32 v51, v111, v109, s44
  v_accvgpr_write_b32 a152, v48
  v_accvgpr_write_b32 a153, v49
  v_accvgpr_write_b32 a154, v50
  v_accvgpr_write_b32 a155, v51
  v_perm_b32 v52, v99, v97, s45
  v_perm_b32 v53, v103, v101, s45
  v_perm_b32 v54, v107, v105, s45
  v_perm_b32 v55, v111, v109, s45
  v_accvgpr_write_b32 a156, v52
  v_accvgpr_write_b32 a157, v53
  v_accvgpr_write_b32 a158, v54
  v_accvgpr_write_b32 a159, v55
  buffer_store_dwordx4 v[208:211], v0, s[4:7], s29 offen offset:0 sc1
  buffer_store_dwordx4 v[208:211], v0, s[4:7], s29 offen offset:1024 sc1
  buffer_store_dwordx4 v[208:211], v0, s[4:7], s29 offen offset:2048 sc1
  buffer_store_dwordx4 v[208:211], v0, s[4:7], s29 offen offset:3072 sc1
  s_add_u32 s29, s29, 4096
  s_waitcnt vmcnt(44)
  v_perm_b32 v48, v114, v112, s44
  v_perm_b32 v49, v118, v116, s44
  v_perm_b32 v50, v122, v120, s44
  v_perm_b32 v51, v126, v124, s44
  v_accvgpr_write_b32 a160, v48
  v_accvgpr_write_b32 a161, v49
  v_accvgpr_write_b32 a162, v50
  v_accvgpr_write_b32 a163, v51
  v_perm_b32 v52, v114, v112, s45
  v_perm_b32 v53, v118, v116, s45
  v_perm_b32 v54, v122, v120, s45
  v_perm_b32 v55, v126, v124, s45
  v_accvgpr_write_b32 a164, v52
  v_accvgpr_write_b32 a165, v53
  v_accvgpr_write_b32 a166, v54
  v_accvgpr_write_b32 a167, v55
  v_perm_b32 v48, v115, v113, s44
  v_perm_b32 v49, v119, v117, s44
  v_perm_b32 v50, v123, v121, s44
  v_perm_b32 v51, v127, v125, s44
  v_accvgpr_write_b32 a168, v48
  v_accvgpr_write_b32 a169, v49
  v_accvgpr_write_b32 a170, v50
  v_accvgpr_write_b32 a171, v51
  v_perm_b32 v52, v115, v113, s45
  v_perm_b32 v53, v119, v117, s45
  v_perm_b32 v54, v123, v121, s45
  v_perm_b32 v55, v127, v125, s45
  v_accvgpr_write_b32 a172, v52
  v_accvgpr_write_b32 a173, v53
  v_accvgpr_write_b32 a174, v54
  v_accvgpr_write_b32 a175, v55
  buffer_store_dwordx4 v[208:211], v0, s[4:7], s29 offen offset:0 sc1
  buffer_store_dwordx4 v[208:211], v0, s[4:7], s29 offen offset:1024 sc1
  buffer_store_dwordx4 v[208:211], v0, s[4:7], s29 offen offset:2048 sc1
  buffer_store_dwordx4 v[208:211], v0, s[4:7], s29 offen offset:3072 sc1
  s_add_u32 s29, s29, 520192
  s_waitcnt vmcnt(40)
  v_perm_b32 v48, v130, v128, s44
  v_perm_b32 v49, v134, v132, s44
  v_perm_b32 v50, v138, v136, s44
  v_perm_b32 v51, v142, v140, s44
  v_accvgpr_write_b32 a176, v48
  v_accvgpr_write_b32 a177, v49
  v_accvgpr_write_b32 a178, v50
  v_accvgpr_write_b32 a179, v51
  v_perm_b32 v52, v130, v128, s45
  v_perm_b32 v53, v134, v132, s45
  v_perm_b32 v54, v138, v136, s45
  v_perm_b32 v55, v142, v140, s45
  v_accvgpr_write_b32 a180, v52
  v_accvgpr_write_b32 a181, v53
  v_accvgpr_write_b32 a182, v54
  v_accvgpr_write_b32 a183, v55
  v_perm_b32 v48, v131, v129, s44
  v_perm_b32 v49, v135, v133, s44
  v_perm_b32 v50, v139, v137, s44
  v_perm_b32 v51, v143, v141, s44
  v_accvgpr_write_b32 a184, v48
  v_accvgpr_write_b32 a185, v49
  v_accvgpr_write_b32 a186, v50
  v_accvgpr_write_b32 a187, v51
  v_perm_b32 v52, v131, v129, s45
  v_perm_b32 v53, v135, v133, s45
  v_perm_b32 v54, v139, v137, s45
  v_perm_b32 v55, v143, v141, s45
  v_accvgpr_write_b32 a188, v52
  v_accvgpr_write_b32 a189, v53
  v_accvgpr_write_b32 a190, v54
  v_accvgpr_write_b32 a191, v55
  buffer_store_dwordx4 v[208:211], v0, s[4:7], s29 offen offset:0 sc1
  buffer_store_dwordx4 v[208:211], v0, s[4:7], s29 offen offset:1024 sc1
  buffer_store_dwordx4 v[208:211], v0, s[4:7], s29 offen offset:2048 sc1
  buffer_store_dwordx4 v[208:211], v0, s[4:7], s29 offen offset:3072 sc1
  s_add_u32 s29, s29, 4096
  s_waitcnt vmcnt(36)
  v_perm_b32 v48, v146, v144, s44
  v_perm_b32 v49, v150, v148, s44
  v_perm_b32 v50, v154, v152, s44
  v_perm_b32 v51, v158, v156, s44
  v_accvgpr_write_b32 a192, v48
  v_accvgpr_write_b32 a193, v49
  v_accvgpr_write_b32 a194, v50
  v_accvgpr_write_b32 a195, v51
  v_perm_b32 v52, v146, v144, s45
  v_perm_b32 v53, v150, v148, s45
  v_perm_b32 v54, v154, v152, s45
  v_perm_b32 v55, v158, v156, s45
  v_accvgpr_write_b32 a196, v52
  v_accvgpr_write_b32 a197, v53
  v_accvgpr_write_b32 a198, v54
  v_accvgpr_write_b32 a199, v55
  v_perm_b32 v48, v147, v145, s44
  v_perm_b32 v49, v151, v149, s44
  v_perm_b32 v50, v155, v153, s44
  v_perm_b32 v51, v159, v157, s44
  v_accvgpr_write_b32 a200, v48
  v_accvgpr_write_b32 a201, v49
  v_accvgpr_write_b32 a202, v50
  v_accvgpr_write_b32 a203, v51
  v_perm_b32 v52, v147, v145, s45
  v_perm_b32 v53, v151, v149, s45
  v_perm_b32 v54, v155, v153, s45
  v_perm_b32 v55, v159, v157, s45
  v_accvgpr_write_b32 a204, v52
  v_accvgpr_write_b32 a205, v53
  v_accvgpr_write_b32 a206, v54
  v_accvgpr_write_b32 a207, v55
  buffer_store_dwordx4 v[208:211], v0, s[4:7], s29 offen offset:0 sc1
  buffer_store_dwordx4 v[208:211], v0, s[4:7], s29 offen offset:1024 sc1
  buffer_store_dwordx4 v[208:211], v0, s[4:7], s29 offen offset:2048 sc1
  buffer_store_dwordx4 v[208:211], v0, s[4:7], s29 offen offset:3072 sc1
  s_add_u32 s29, s29, 4096
  s_waitcnt vmcnt(32)
  v_perm_b32 v48, v162, v160, s44
  v_perm_b32 v49, v166, v164, s44
  v_perm_b32 v50, v170, v168, s44
  v_perm_b32 v51, v174, v172, s44
  v_accvgpr_write_b32 a208, v48
  v_accvgpr_write_b32 a209, v49
  v_accvgpr_write_b32 a210, v50
  v_accvgpr_write_b32 a211, v51
  v_perm_b32 v52, v162, v160, s45
  v_perm_b32 v53, v166, v164, s45
  v_perm_b32 v54, v170, v168, s45
  v_perm_b32 v55, v174, v172, s45
  v_accvgpr_write_b32 a212, v52
  v_accvgpr_write_b32 a213, v53
  v_accvgpr_write_b32 a214, v54
  v_accvgpr_write_b32 a215, v55
  v_perm_b32 v48, v163, v161, s44
  v_perm_b32 v49, v167, v165, s44
  v_perm_b32 v50, v171, v169, s44
  v_perm_b32 v51, v175, v173, s44
  v_accvgpr_write_b32 a216, v48
  v_accvgpr_write_b32 a217, v49
  v_accvgpr_write_b32 a218, v50
  v_accvgpr_write_b32 a219, v51
  v_perm_b32 v52, v163, v161, s45
  v_perm_b32 v53, v167, v165, s45
  v_perm_b32 v54, v171, v169, s45
  v_perm_b32 v55, v175, v173, s45
  v_accvgpr_write_b32 a220, v52
  v_accvgpr_write_b32 a221, v53
  v_accvgpr_write_b32 a222, v54
  v_accvgpr_write_b32 a223, v55
  s_waitcnt vmcnt(24)
  v_perm_b32 v48, v66, v64, s44
  v_perm_b32 v49, v70, v68, s44
  v_perm_b32 v50, v74, v72, s44
  v_perm_b32 v51, v78, v76, s44
  v_accvgpr_write_b32 a224, v48
  v_accvgpr_write_b32 a225, v49
  v_accvgpr_write_b32 a226, v50
  v_accvgpr_write_b32 a227, v51
  v_perm_b32 v52, v66, v64, s45
  v_perm_b32 v53, v70, v68, s45
  v_perm_b32 v54, v74, v72, s45
  v_perm_b32 v55, v78, v76, s45
  v_accvgpr_write_b32 a228, v52
  v_accvgpr_write_b32 a229, v53
  v_accvgpr_write_b32 a230, v54
  v_accvgpr_write_b32 a231, v55
  v_perm_b32 v48, v67, v65, s44
  v_perm_b32 v49, v71, v69, s44
  v_perm_b32 v50, v75, v73, s44
  v_perm_b32 v51, v79, v77, s44
  v_accvgpr_write_b32 a232, v48
  v_accvgpr_write_b32 a233, v49
  v_accvgpr_write_b32 a234, v50
  v_accvgpr_write_b32 a235, v51
  v_perm_b32 v52, v67, v65, s45
  v_perm_b32 v53, v71, v69, s45
  v_perm_b32 v54, v75, v73, s45
  v_perm_b32 v55, v79, v77, s45
  v_accvgpr_write_b32 a236, v52
  v_accvgpr_write_b32 a237, v53
  v_accvgpr_write_b32 a238, v54
  v_accvgpr_write_b32 a239, v55
  s_waitcnt vmcnt(16)
  v_perm_b32 v48, v82, v80, s44
  v_perm_b32 v49, v86, v84, s44
  v_perm_b32 v50, v90, v88, s44
  v_perm_b32 v51, v94, v92, s44
  v_accvgpr_write_b32 a240, v48
  v_accvgpr_write_b32 a241, v49
  v_accvgpr_write_b32 a242, v50
  v_accvgpr_write_b32 a243, v51
  v_perm_b32 v52, v82, v80, s45
  v_perm_b32 v53, v86, v84, s45
  v_perm_b32 v54, v90, v88, s45
  v_perm_b32 v55, v94, v92, s45
  v_accvgpr_write_b32 a244, v52
  v_accvgpr_write_b32 a245, v53
  v_accvgpr_write_b32 a246, v54
  v_accvgpr_write_b32 a247, v55
  v_perm_b32 v48, v83, v81, s44
  v_perm_b32 v49, v87, v85, s44
  v_perm_b32 v50, v91, v89, s44
  v_perm_b32 v51, v95, v93, s44
  v_accvgpr_write_b32 a248, v48
  v_accvgpr_write_b32 a249, v49
  v_accvgpr_write_b32 a250, v50
  v_accvgpr_write_b32 a251, v51
  v_perm_b32 v52, v83, v81, s45
  v_perm_b32 v53, v87, v85, s45
  v_perm_b32 v54, v91, v89, s45
  v_perm_b32 v55, v95, v93, s45
  v_accvgpr_write_b32 a252, v52
  v_accvgpr_write_b32 a253, v53
  v_accvgpr_write_b32 a254, v54
  v_accvgpr_write_b32 a255, v55
  s_waitcnt vmcnt(0)
  s_barrier
  s_cmp_lg_u32 s17, 0
  s_cbranch_scc1 g_ar_113
  s_lshl_b32 s36, s89, 3
  s_lshl_b64 s[36:37], 1, s36
  v_lshlrev_b32 v52, 3, s91
  v_mov_b32 v48, s36
  v_mov_b32 v49, s37
  s_mov_b64 exec, 1
  global_atomic_add_x2 v[50:51], v52, v[48:49], s[12:13] sc0
  s_mov_b64 exec, -1
g_ar_113:
  s_waitcnt vmcnt(0)
  s_cmp_lg_u32 s17, 0
  s_cbranch_scc1 g_af_114
  v_readfirstlane_b32 s36, v50
  v_readfirstlane_b32 s37, v51
  s_add_u32 s38, s36, s37
  s_mul_i32 s38, s38, 0x01010101
  s_lshr_b32 s38, s38, 24
  s_cmp_lg_u32 s38, 15
  s_cbranch_scc1 g_af_114
  s_lshl_b32 s38, s89, 3
  s_lshr_b64 s[36:37], s[36:37], s38
  s_and_b32 s36, s36, 0xff
  s_cmp_eq_u32 s36, 15
  s_cselect_b32 s36, 1, 2
  v_mov_b32 v48, s36
  v_lshrrev_b32 v52, 1, v52
  s_mov_b64 exec, 1
  global_store_dword v52, v48, s[12:13] offset:128 sc1
  s_mov_b64 exec, -1
g_af_114:
  s_lshr_b32 s26, s60, 1
  s_cmp_lg_u32 s26, 1
  s_cbranch_scc1 L_ow
  s_and_b32 s28, s85, 28
  s_or_b32 s28, s28, 1
  s_lshl_b32 s27, s28, 6
  s_add_u32 s27, s27, 245104640
  s_mov_b32 s26, 0
g_h_115:
  buffer_load_dwordx2 v[60:61], off, s[4:7], s27 sc1
  s_add_u32 s26, s26, 1
  s_cmp_gt_u32 s26, 1048576
  s_cbranch_scc1 L_end
  s_waitcnt vmcnt(0)
  v_or_b32 v60, v60, v61
  v_cmp_eq_u32 vcc, 0, v60
  s_cbranch_vccnz g_h_115
  s_mov_b32 s10, 1835008
  s_load_dwordx2 s[8:9], s[0:1], 72
  s_mul_i32 s26, s77, 14336
  s_sub_u32 s26, s26, 1835008
  s_waitcnt lgkmcnt(0)
  buffer_load_dwordx4 v[64:67], v0, s[8:11], s26 offen offset:0
  buffer_load_dwordx4 v[64:67], v0, s[8:11], s26 offen offset:1024
  buffer_load_dwordx4 v[64:67], v0, s[8:11], s26 offen offset:2048
  buffer_load_dwordx4 v[64:67], v0, s[8:11], s26 offen offset:3072
  s_add_u32 s26, s26, 4096
  buffer_load_dwordx4 v[64:67], v0, s[8:11], s26 offen offset:0
  buffer_load_dwordx4 v[64:67], v0, s[8:11], s26 offen offset:1024
  buffer_load_dwordx4 v[64:67], v0, s[8:11], s26 offen offset:2048
  buffer_load_dwordx4 v[64:67], v0, s[8:11], s26 offen offset:3072
  s_add_u32 s26, s26, 4096
  buffer_load_dwordx4 v[64:67], v0, s[8:11], s26 offen offset:0
  buffer_load_dwordx4 v[64:67], v0, s[8:11], s26 offen offset:1024
  buffer_load_dwordx4 v[64:67], v0, s[8:11], s26 offen offset:2048
  buffer_load_dwordx4 v[64:67], v0, s[8:11], s26 offen offset:3072
  s_add_u32 s26, s26, 4096
  buffer_load_dwordx4 v[64:67], v0, s[8:11], s26 offen offset:0
  buffer_load_dwordx4 v[64:67], v0, s[8:11], s26 offen offset:1024
  s_load_dwordx2 s[8:9], s[0:1], 80
  s_mul_i32 s26, s77, 14336
  s_sub_u32 s26, s26, 1835008
  s_waitcnt lgkmcnt(0)
  buffer_load_dwordx4 v[64:67], v0, s[8:11], s26 offen offset:0
  buffer_load_dwordx4 v[64:67], v0, s[8:11], s26 offen offset:1024
  buffer_load_dwordx4 v[64:67], v0, s[8:11], s26 offen offset:2048
  buffer_load_dwordx4 v[64:67], v0, s[8:11], s26 offen offset:3072
  s_add_u32 s26, s26, 4096
  buffer_load_dwordx4 v[64:67], v0, s[8:11], s26 offen offset:0
  buffer_load_dwordx4 v[64:67], v0, s[8:11], s26 offen offset:1024
  buffer_load_dwordx4 v[64:67], v0, s[8:11], s26 offen offset:2048
  buffer_load_dwordx4 v[64:67], v0, s[8:11], s26 offen offset:3072
  s_add_u32 s26, s26, 4096
  buffer_load_dwordx4 v[64:67], v0, s[8:11], s26 offen offset:0
  buffer_load_dwordx4 v[64:67], v0, s[8:11], s26 offen offset:1024
  buffer_load_dwordx4 v[64:67], v0, s[8:11], s26 offen offset:2048
  buffer_load_dwordx4 v[64:67], v0, s[8:11], s26 offen offset:3072
  s_add_u32 s26, s26, 4096
  buffer_load_dwordx4 v[64:67], v0, s[8:11], s26 offen offset:0
  buffer_load_dwordx4 v[64:67], v0, s[8:11], s26 offen offset:1024
  s_load_dwordx2 s[8:9], s[0:1], 88
  s_mul_i32 s26, s77, 14336
  s_sub_u32 s26, s26, 1835008
  s_waitcnt lgkmcnt(0)
  buffer_load_dwordx4 v[64:67], v0, s[8:11], s26 offen offset:0
  buffer_load_dwordx4 v[64:67], v0, s[8:11], s26 offen offset:1024
  buffer_load_dwordx4 v[64:67], v0, s[8:11], s26 offen offset:2048
  buffer_load_dwordx4 v[64:67], v0, s[8:11], s26 offen offset:3072
  s_add_u32 s26, s26, 4096
  buffer_load_dwordx4 v[64:67], v0, s[8:11], s26 offen offset:0
  buffer_load_dwordx4 v[64:67], v0, s[8:11], s26 offen offset:1024
  buffer_load_dwordx4 v[64:67], v0, s[8:11], s26 offen offset:2048
  buffer_load_dwordx4 v[64:67], v0, s[8:11], s26 offen offset:3072
  s_add_u32 s26, s26, 4096
  buffer_load_dwordx4 v[64:67], v0, s[8:11], s26 offen offset:0
  buffer_load_dwordx4 v[64:67], v0, s[8:11], s26 offen offset:1024
  buffer_load_dwordx4 v[64:67], v0, s[8:11], s26 offen offset:2048
  buffer_load_dwordx4 v[64:67], v0, s[8:11], s26 offen offset:3072
  s_add_u32 s26, s26, 4096
  buffer_load_dwordx4 v[64:67], v0, s[8:11], s26 offen offset:0
  buffer_load_dwordx4 v[64:67], v0, s[8:11], s26 offen offset:1024
L_ow:
  v_mbcnt_lo_u32_b32 v60, -1, 0
  v_and_b32 v60, 0, v60
  v_add_lshl_u32 v60, v60, s91, 2
  s_mov_b32 s26, 0
g_wt_116:
  global_load_dword v61, v60, s[12:13] offset:128 sc1
  s_add_u32 s26, s26, 1
  s_cmp_gt_u32 s26, 1048576
  s_cbranch_scc1 L_end
  s_waitcnt vmcnt(0)
  v_cmp_eq_u32 vcc, 0, v61
  v_readfirstlane_b32 s27, v61
  s_cbranch_vccnz g_wt_116
  s_cmp_lg_u32 s27, 1
  s_cbranch_scc1 L_o_x
  s_mov_b32 s62, 1
  s_mov_b32 s42, 0
  s_mov_b32 s3, 0
  s_mov_b32 s46, 0
  s_mov_b32 s65, 0
  s_mov_b32 s66, 0
  s_mov_b32 s76, 0
  s_mov_b32 s55, 0
  s_mov_b32 s56, 0
  s_mov_b32 s84, 268435456
  s_mov_b32 s86, s41
  s_mov_b32 s49, s60
  s_mul_i32 s63, s49, 257
  s_or_b32 s63, s63, 1179648
  s_lshr_b32 s57, s60, 2
  s_cbranch_scc1 o_help_128
o_round_117:
  s_max_u32 s46, s46, s3
  s_cmp_lg_u32 s3, 0
  s_mov_b32 s3, 0
  s_cbranch_scc1 d_g_133
  s_mov_b32 s67, 0
d_w_132:
  s_min_u32 s26, s49, 71
  s_lshl_b32 s26, s26, 12
  s_add_u32 s27, s26, 243494912
  s_add_u32 s26, s26, 243486720
  buffer_load_dword v248, v246, s[4:7], s26 offen sc1
  buffer_load_dword v249, v246, s[4:7], s27 offen sc1
  s_add_u32 s67, s67, 1
  s_cmp_gt_u32 s67, 1048576
  s_cbranch_scc1 L_end
  s_waitcnt vmcnt(0)
  s_mov_b64 exec, 1
  buffer_store_dword v38, off, s[4:7], s84 sc1
  s_mov_b64 exec, -1
  s_mov_b32 s84, 268435456
  v_min_u32 v162, v248, v249
  v_max_u32 v163, v248, v249
  v_cmp_eq_u32 vcc, 0, v162
  s_cbranch_vccnz d_w_132
  v_max_u32_dpp v163, v163, v163 row_ror:8 row_mask:0xf bank_mask:0xf
  s_nop 1
  v_max_u32_dpp v163, v163, v163 row_ror:4 row_mask:0xf bank_mask:0xf
  s_nop 1
  v_max_u32_dpp v163, v163, v163 row_ror:2 row_mask:0xf bank_mask:0xf
  s_nop 1
  v_max_u32_dpp v163, v163, v163 row_ror:1 row_mask:0xf bank_mask:0xf
  s_nop 0
  v_readlane_b32 s28, v163, 0
  v_readlane_b32 s29, v163, 16
  v_readlane_b32 s30, v163, 32
  v_readlane_b32 s31, v163, 48
  s_max_u32 s28, s28, s29
  s_max_u32 s30, s30, s31
  s_max_u32 s46, s46, s28
  s_max_u32 s46, s46, s30
d_g_133:
  s_lshr_b32 s27, s49, 2
  s_andn2_b32 s52, 0xfff, s46
  s_lshr_b32 s52, s52, 5
  s_min_u32 s52, s52, 64
  s_add_u32 s26, s52, 3
  v_readlane_b32 s89, v247, s27
  s_sub_u32 s26, s26, s60
  s_lshr_b32 s26, s26, 2
  s_bfm_b32 s54, s26, 0
  s_add_u32 s53, s63, 1028
  s_cmp_lt_u32 s49, 60
  s_cselect_b32 s53, s53, 0
  s_cmp_lt_u32 s49, 64
  s_cselect_b32 s26, 3, 1
  s_sub_i32 s26, s27, s26
  s_max_i32 s26, s26, 0
  s_min_u32 s26, s26, 16
  s_bfm_b32 s58, s26, 0
  s_cmp_eq_u32 s27, 16
  s_cselect_b32 s59, 2, 1
  s_cmp_eq_u32 s27, 18
  s_cselect_b32 s59, 64, s59
  s_cselect_b32 s50, 0, -1
  s_cselect_b32 s89, 0, s89
  s_cbranch_scc1 o_dl_129
o_pick_121:
  s_cmp_eq_u32 s59, 0
  s_cbranch_scc1 o_none_125
  s_sub_u32 s59, s59, 1
  s_andn2_b32 s26, s58, s55
  s_and_b32 s26, s26, s54
  s_cbranch_scc1 o_ga_122
  s_and_b32 s26, s55, s50
  s_or_b32 s26, s26, s56
  s_or_b32 s26, s26, s54
  s_andn2_b32 s26, s58, s26
  s_cbranch_scc0 o_none_125
  s_cmp_ge_u32 s46, s89
  s_cbranch_scc1 o_gb_123
o_ga_122:
  s_ff1_i32_b32 s26, s26
  s_bitset1_b32 s55, s26
  s_mov_b32 s64, 1327168
  s_mov_b32 s27, s64
  s_branch o_gd_124
o_none_125:
  s_cmp_lt_u32 s49, 60
  s_cbranch_scc1 o_nn_126
  s_cmp_eq_u32 s50, 0
  s_cbranch_scc1 o_nn_126
  s_and_b32 s26, s63, 1097728
  s_cmp_eq_u32 s26, 1048576
  s_cbranch_scc1 o_nn_126
  s_cmp_lt_u32 s49, 64
  s_cbranch_scc1 o_adv_127
  s_and_b32 s26, s65, 1097728
  s_cmp_lg_u32 s26, 1048576
  s_cbranch_scc1 o_adv_127
o_nn_126:
  s_mov_b32 s64, s53
  s_mov_b32 s51, 0
  s_branch o_task_118
o_gb_123:
  s_ff1_i32_b32 s26, s26
  s_bitset1_b32 s56, s26
  s_andn2_b32 s27, 31, s46
  s_or_b32 s27, s27, 32
  s_lshl_b32 s27, s27, 22
  s_or_b32 s27, s27, 1474688
  s_mov_b32 s64, 1474624
o_gd_124:
  s_and_b32 s28, s26, s57
  s_lshr_b32 s26, s26, s57
  s_lshl2_add_u32 s26, s26, s60
  s_add_u32 s26, s26, s28
  s_cmp_eq_u32 s26, s52
  s_cselect_b32 s64, s27, s64
  s_mul_i32 s26, s26, 257
  s_or_b32 s64, s64, s26
  s_mov_b32 s51, 1
o_task_118:
  s_cmp_eq_u32 s63, 0
  s_cbranch_scc1 o_nofl_119
  s_cmp_lg_u32 s66, 0
  s_cbranch_scc1 o_have_135
  s_mov_b32 s67, 0
o_w1_134:
  s_and_b32 s32, s63, 0xff
  s_lshl_b32 s32, s32, 12
  s_add_u32 s32, s32, s14
  buffer_load_dword v37, v36, s[4:7], s32 offen sc1
  s_add_u32 s67, s67, 1
  s_cmp_gt_u32 s67, 1048576
  s_cbranch_scc1 L_end
  s_waitcnt vmcnt(0)
  s_mov_b64 exec, 1
  buffer_store_dword v38, off, s[4:7], s84 sc1
  s_mov_b64 exec, -1
  s_mov_b32 s84, 268435456
  v_cmp_eq_u32 vcc, 0, v37
  s_cbranch_vccnz o_w1_134
  s_and_b32 s87, s63, 0xff
  s_lshl_b32 s33, s87, 18
  s_lshl_b32 s32, s87, 19
  s_add_u32 m0, s22, 0
  s_add_u32 s33, s33, s19
  buffer_load_dwordx4 v0, s[4:7], s33 offen offset:0 sc1 lds
  buffer_load_dwordx4 v0, s[4:7], s33 offen offset:1024 sc1 lds
  buffer_load_dwordx4 v0, s[4:7], s33 offen offset:2048 sc1 lds
  buffer_load_dwordx4 v0, s[4:7], s33 offen offset:3072 sc1 lds
  s_add_u32 m0, s23, 0
  s_add_u32 s32, s32, s18
  buffer_load_dwordx4 v0, s[4:7], s32 offen offset:0 sc1 lds
  buffer_load_dwordx4 v0, s[4:7], s32 offen offset:1024 sc1 lds
  buffer_load_dwordx4 v0, s[4:7], s32 offen offset:2048 sc1 lds
  buffer_load_dwordx4 v0, s[4:7], s32 offen offset:3072 sc1 lds
  s_add_u32 m0, m0, 4096
  s_add_u32 s32, s32, 4096
  buffer_load_dwordx4 v0, s[4:7], s32 offen offset:0 sc1 lds
  buffer_load_dwordx4 v0, s[4:7], s32 offen offset:1024 sc1 lds
  buffer_load_dwordx4 v0, s[4:7], s32 offen offset:2048 sc1 lds
  buffer_load_dwordx4 v0, s[4:7], s32 offen offset:3072 sc1 lds
  s_waitcnt vmcnt(0)
  s_barrier
o_have_135:
  ds_read_b128 v[120:123], v33 offset:0
  ds_read_b128 v[40:43], v32 offset:0
  ds_read_b128 v[56:59], v32 offset:1024
  ds_read_b128 v[124:127], v33 offset:2048
  ds_read_b128 v[44:47], v32 offset:4096
  ds_read_b128 v[60:63], v32 offset:5120
  ds_read_b128 v[128:131], v33 offset:4096
  ds_read_b128 v[48:51], v32 offset:8192
  ds_read_b128 v[64:67], v32 offset:9216
  ds_read_b128 v[132:135], v33 offset:6144
  ds_read_b128 v[52:55], v32 offset:12288
  ds_read_b128 v[68:71], v32 offset:13312
  s_cmp_lt_u32 s17, 2
  s_cselect_b32 s65, s65, 0
  s_cmp_lg_u32 s65, 0
  s_cselect_b64 s[44:45], -1, 0
  s_mov_b32 s95, s86
  s_mov_b32 s96, s42
  s_lshl_b32 s97, s43, 14
  s_add_u32 s97, s97, s95
  s_and_b32 s87, s64, 0xff
  s_lshl_b32 s87, s87, 12
  s_add_u32 s87, s87, s14
  s_and_b32 s88, s63, 0xff00
  s_lshl_b32 s88, s88, 3
  s_add_u32 s88, s88, s15
  s_and_b32 s91, s65, 63
  s_lshl_b32 s90, s91, 5
  s_add_u32 s94, s90, s85
  s_add_u32 s90, s90, s43
  s_lshl_b32 s94, s94, 10
  s_lshr_b32 s92, s65, 22
  s_xor_b32 s93, s43, 32
  s_lshl_b32 s91, s90, 10
  s_add_u32 s94, s94, 25165824
  s_cmp_eq_u32 s92, s93
  s_cselect_b32 s92, s94, s91
  s_add_u32 s92, s92, 10485760
  s_and_b32 s93, s65, 49152
  s_cselect_b32 s92, s92, s91
  s_cselect_b64 s[80:81], s[4:5], s[72:73]
  s_cselect_b32 s82, s6, s74
  s_waitcnt lgkmcnt(9)
  v_mfma_f32_16x16x32_bf16 v[104:107], v[40:43], v[120:123], v[24:27]
  v_mfma_f32_16x16x32_bf16 v[108:111], v[56:59], v[120:123], v[28:31]
  s_mov_b64 exec, s[44:45]
  buffer_load_dword v7, v255, s[4:7], s97 offen sc1
  buffer_load_dwordx4 v[184:187], v0, s[80:83], s92 offen sc1
  s_not_b64 exec, exec
  buffer_load_dword v37, v36, s[4:7], s87 offen sc1
  s_mov_b64 exec, -1
  buffer_load_dword v244, v252, s[4:7], s88 offen sc1
  s_waitcnt lgkmcnt(6)
  v_mfma_f32_16x16x32_bf16 v[104:107], v[44:47], v[124:127], v[104:107]
  v_mfma_f32_16x16x32_bf16 v[108:111], v[60:63], v[124:127], v[108:111]
  s_waitcnt lgkmcnt(3)
  v_mfma_f32_16x16x32_bf16 v[104:107], v[48:51], v[128:131], v[104:107]
  v_mfma_f32_16x16x32_bf16 v[108:111], v[64:67], v[128:131], v[108:111]
  s_waitcnt lgkmcnt(0)
  v_mfma_f32_16x16x32_bf16 v[104:107], v[52:55], v[132:135], v[104:107]
  v_mfma_f32_16x16x32_bf16 v[108:111], v[68:71], v[132:135], v[108:111]
  s_cmp_lg_u32 s76, 0
  s_cbranch_scc1 o_klds_138
  v_mov_b32 v196, 0
  v_mov_b32 v199, 0
  v_exp_f32 v56, v104
  v_exp_f32 v57, v105
  v_exp_f32 v58, v106
  v_exp_f32 v59, v107
  v_exp_f32 v60, v108
  v_exp_f32 v61, v109
  v_exp_f32 v62, v110
  v_exp_f32 v63, v111
  v_max3_f32 v116, v104, v105, v106
  v_max3_f32 v116, v107, v108, v116
  v_max3_f32 v116, v109, v110, v116
  v_add_f32 v117, v56, v57
  v_add_f32 v118, v58, v59
  v_add_f32 v117, v117, v60
  v_add_f32 v118, v118, v61
  v_add_f32 v117, v117, v62
  v_add_f32 v118, v118, v63
  s_mov_b32 s67, 0
  s_and_b32 s32, s63, 0xff00
  s_lshl_b32 s32, s32, 10
  s_add_u32 s32, s32, s20
  s_add_u32 s33, s32, 4096
o_w2_136:
  s_waitcnt vmcnt(0)
  v_cmp_eq_u32 vcc, 0, v244
  s_cbranch_vccz o_kgo_146
  s_mov_b64 exec, 1
  buffer_store_dword v38, off, s[4:7], s84 sc1
  s_mov_b64 exec, -1
  s_mov_b32 s84, 268435456
  buffer_load_dword v244, v252, s[4:7], s88 offen sc1
  s_add_u32 s67, s67, 1
  s_cmp_gt_u32 s67, 1048576
  s_cbranch_scc1 L_end
  s_branch o_w2_136
o_kgo_146:
  buffer_load_dwordx4 v[136:139], v0, s[4:7], s32 offen offset:0 sc1
  buffer_load_dwordx4 v[140:143], v0, s[4:7], s32 offen offset:1024 sc1
  buffer_load_dwordx4 v[144:147], v0, s[4:7], s32 offen offset:2048 sc1
  buffer_load_dwordx4 v[148:151], v0, s[4:7], s32 offen offset:3072 sc1
  buffer_load_dwordx2 v[200:201], v1, s[4:7], s33 offen offset:0 sc1
  buffer_load_dwordx2 v[202:203], v1, s[4:7], s33 offen offset:512 sc1
  buffer_load_dwordx2 v[204:205], v1, s[4:7], s33 offen offset:1024 sc1
  buffer_load_dwordx2 v[206:207], v1, s[4:7], s33 offen offset:1536 sc1
  buffer_load_dword v37, v36, s[4:7], s87 offen sc1
  buffer_load_dword v244, v252, s[4:7], s88 offen sc1
  s_barrier
  ds_read_b128 v[152:155], v32 offset:2048
  ds_read_b128 v[156:159], v32 offset:3072
  ds_read_b128 v[160:163], v32 offset:6144
  ds_read_b128 v[164:167], v32 offset:7168
  ds_read_b128 v[168:171], v32 offset:10240
  ds_read_b128 v[172:175], v32 offset:11264
  ds_read_b128 v[176:179], v32 offset:14336
  ds_read_b128 v[180:183], v32 offset:15360
  s_waitcnt vmcnt(9)
  v_mfma_f32_16x16x32_bf16 v[112:115], v[136:139], v[120:123], 0
  s_waitcnt vmcnt(8)
  v_mfma_f32_16x16x32_bf16 v[112:115], v[140:143], v[124:127], v[112:115]
  s_waitcnt vmcnt(7)
  v_mfma_f32_16x16x32_bf16 v[112:115], v[144:147], v[128:131], v[112:115]
  s_waitcnt vmcnt(6)
  v_mfma_f32_16x16x32_bf16 v[112:115], v[148:151], v[132:135], v[112:115]
  s_waitcnt vmcnt(2)
  s_branch o_havek_137
o_klds_138:
  s_waitcnt vmcnt(12)
  s_barrier
  ds_read_b128 v[136:139], v34 offset:0
  ds_read_b128 v[140:143], v34 offset:1024
  ds_read_b128 v[144:147], v34 offset:2048
  ds_read_b128 v[148:151], v34 offset:3072
  ds_read_b64 v[200:201], v35 offset:4096
  ds_read_b64 v[202:203], v35 offset:4608
  ds_read_b64 v[204:205], v35 offset:5120
  ds_read_b64 v[206:207], v35 offset:5632
  v_mov_b32 v196, 0
  v_mov_b32 v199, 0
  v_exp_f32 v56, v104
  v_exp_f32 v57, v105
  v_exp_f32 v58, v106
  v_exp_f32 v59, v107
  v_exp_f32 v60, v108
  v_exp_f32 v61, v109
  v_exp_f32 v62, v110
  v_exp_f32 v63, v111
  v_max3_f32 v116, v104, v105, v106
  v_max3_f32 v116, v107, v108, v116
  v_max3_f32 v116, v109, v110, v116
  s_waitcnt lgkmcnt(4)
  v_mfma_f32_16x16x32_bf16 v[112:115], v[136:139], v[120:123], 0
  ds_read_b128 v[152:155], v32 offset:2048
  ds_read_b128 v[156:159], v32 offset:3072
  v_mfma_f32_16x16x32_bf16 v[112:115], v[140:143], v[124:127], v[112:115]
  ds_read_b128 v[160:163], v32 offset:6144
  ds_read_b128 v[164:167], v32 offset:7168
  v_mfma_f32_16x16x32_bf16 v[112:115], v[144:147], v[128:131], v[112:115]
  ds_read_b128 v[168:171], v32 offset:10240
  ds_read_b128 v[172:175], v32 offset:11264
  v_mfma_f32_16x16x32_bf16 v[112:115], v[148:151], v[132:135], v[112:115]
  ds_read_b128 v[176:179], v32 offset:14336
  ds_read_b128 v[180:183], v32 offset:15360
  v_add_f32 v117, v56, v57
  v_add_f32 v118, v58, v59
  v_add_f32 v117, v117, v60
  v_add_f32 v118, v118, v61
  v_add_f32 v117, v117, v62
  v_add_f32 v118, v118, v63
o_havek_137:
  s_cmp_lg_u32 s65, 0
  s_cbranch_scc1 o_wr1_143
  s_nop 3
  v_mul_f32 v112, s24, v112
  v_mul_f32 v113, s24, v113
  v_exp_f32 v64, v112
  v_exp_f32 v65, v113
  v_max_f32 v116, v111, v116
  v_max3_f32 v116, v112, v113, v116
  v_add_f32 v117, v117, v64
  v_add_f32 v118, v118, v65
  v_add_f32 v117, v117, v118
  s_mov_b32 s28, 0x21800000
  v_mov_b32 v118, v117
  s_nop 1
  v_permlane16_swap_b32 v117, v118
  v_add_f32 v117, v117, v118
  v_mov_b32 v118, v117
  s_nop 0
  s_nop 0
  v_permlane32_swap_b32 v117, v118
  v_add_f32 v117, v117, v118
  v_cmp_lt_f32 vcc, 0x42700000, v116
  v_cmp_gt_f32 s[30:31], s28, v117
  v_rcp_f32 v117, v117
  s_or_b64 vcc, vcc, s[30:31]
  s_cbranch_vccnz o_fb_147
o_fbr_148:
  v_pk_mul_f32 v[56:57], v[56:57], v[116:117] op_sel:[0,1] op_sel_hi:[1,1]
  v_pk_mul_f32 v[58:59], v[58:59], v[116:117] op_sel:[0,1] op_sel_hi:[1,1]
  v_pk_mul_f32 v[60:61], v[60:61], v[116:117] op_sel:[0,1] op_sel_hi:[1,1]
  v_pk_mul_f32 v[62:63], v[62:63], v[116:117] op_sel:[0,1] op_sel_hi:[1,1]
  v_pk_mul_f32 v[64:65], v[64:65], v[116:117] op_sel:[0,1] op_sel_hi:[1,1]
  v_cvt_pk_bf16_f32 v116, v56, v57
  v_cvt_pk_bf16_f32 v117, v58, v59
  v_cvt_pk_bf16_f32 v118, v60, v61
  v_cvt_pk_bf16_f32 v119, v62, v63
  s_waitcnt lgkmcnt(0)
  s_nop 0
  v_mfma_f32_16x16x32_bf16 v[72:75], v[152:155], v[116:119], 0
  s_add_u32 s62, s62, 1
  v_cvt_pk_bf16_f32 v197, v64, v65
  v_cvt_pk_bf16_f32 v198, v64, v65
  v_mfma_f32_16x16x32_bf16 v[76:79], v[156:159], v[116:119], 0
  s_xor_b32 s86, s86, 524288
  v_mfma_f32_16x16x32_bf16 v[80:83], v[160:163], v[116:119], 0
  s_bfe_u32 s42, s62, 0x10001
  v_mfma_f32_16x16x32_bf16 v[84:87], v[164:167], v[116:119], 0
  s_bfe_u32 s26, s64, 65556
  v_mfma_f32_16x16x32_bf16 v[88:91], v[168:171], v[116:119], 0
  s_and_b32 s87, s64, 0xff
  v_mfma_f32_16x16x32_bf16 v[92:95], v[172:175], v[116:119], 0
  s_bfe_u32 s88, s64, 0x80008
  v_mfma_f32_16x16x32_bf16 v[96:99], v[176:179], v[116:119], 0
  s_nop 0
  v_mfma_f32_16x16x32_bf16 v[100:103], v[180:183], v[116:119], 0
  s_nop 0
  v_mfma_f32_16x16x16_bf16 v[72:75], v[200:201], v[198:199], v[72:75]
  s_nop 1
  v_mfma_f32_16x16x16_bf16 v[76:79], v[200:201], v[196:197], v[76:79]
  s_nop 1
  v_mfma_f32_16x16x16_bf16 v[80:83], v[202:203], v[198:199], v[80:83]
  s_nop 1
  v_mfma_f32_16x16x16_bf16 v[84:87], v[202:203], v[196:197], v[84:87]
  s_nop 1
  v_mfma_f32_16x16x16_bf16 v[88:91], v[204:205], v[198:199], v[88:91]
  s_nop 0
  v_cvt_pk_bf16_f32 v40, v72, v73
  v_cvt_pk_bf16_f32 v41, v74, v75
  v_mfma_f32_16x16x16_bf16 v[92:95], v[204:205], v[196:197], v[92:95]
  s_nop 0
  v_cvt_pk_bf16_f32 v42, v76, v77
  v_cvt_pk_bf16_f32 v43, v78, v79
  v_mfma_f32_16x16x16_bf16 v[96:99], v[206:207], v[198:199], v[96:99]
  s_nop 0
  ds_write_b128 v6, v[40:43] offset:0
  v_cvt_pk_bf16_f32 v44, v80, v81
  v_mfma_f32_16x16x16_bf16 v[100:103], v[206:207], v[196:197], v[100:103]
  s_nop 0
  v_cvt_pk_bf16_f32 v45, v82, v83
  v_cvt_pk_bf16_f32 v46, v84, v85
  v_cvt_pk_bf16_f32 v47, v86, v87
  ds_write_b128 v6, v[44:47] offset:1024
  v_cvt_pk_bf16_f32 v48, v88, v89
  v_cvt_pk_bf16_f32 v49, v90, v91
  v_cvt_pk_bf16_f32 v50, v92, v93
  v_cvt_pk_bf16_f32 v51, v94, v95
  ds_write_b128 v6, v[48:51] offset:2048
  v_cvt_pk_bf16_f32 v52, v96, v97
  v_cvt_pk_bf16_f32 v53, v98, v99
  v_cvt_pk_bf16_f32 v54, v100, v101
  v_cvt_pk_bf16_f32 v55, v102, v103
  ds_write_b128 v6, v[52:55] offset:3072
  s_cmp_lt_u32 s17, 2
  s_cbranch_scc1 o_wr0_142
  s_waitcnt lgkmcnt(0)
  s_barrier
  ds_read_b128 v[104:107], v3 offset:0
  ds_read_b128 v[108:111], v3 offset:512
  ds_read_b128 v[112:115], v3 offset:1024
  s_waitcnt lgkmcnt(2)
  v_mfma_f32_32x32x16_bf16 v[40:55], v[104:107], a[0:3], 0
  s_waitcnt vmcnt(0)
  v_cmp_eq_u32 vcc, 0, v37
  s_cmp_eq_u64 vcc, 0
  s_cselect_b32 s66, s26, 0
  s_cmp_eq_u32 s66, 1
  s_cselect_b32 s87, s87, 1024
  s_cselect_b32 s34, 0, 0x28000
  v_mfma_f32_32x32x16_bf16 v[56:71], v[104:107], a[4:7], 0
  ds_read_b128 v[116:119], v3 offset:1536
  s_lshl_b32 s33, s87, 18
  s_lshl_b32 s32, s87, 19
  s_add_u32 m0, s22, s34
  s_add_u32 s33, s33, s19
  s_min_u32 s28, s49, 67
  v_mfma_f32_32x32x16_bf16 v[72:87], v[104:107], a[8:11], 0
  s_lshl1_add_u32 s28, s17, s28
  s_lshl_b32 s28, s28, 12
  s_add_u32 s28, s28, 243486720
  v_mfma_f32_32x32x16_bf16 v[88:103], v[104:107], a[12:15], 0
  buffer_load_dword v249, v246, s[4:7], s28 offen sc1
  s_waitcnt lgkmcnt(2)
  v_mfma_f32_32x32x16_bf16 v[40:55], v[108:111], a[16:19], v[40:55]
  buffer_load_dwordx4 v0, s[4:7], s33 offen offset:0 sc1 lds
  v_mfma_f32_32x32x16_bf16 v[56:71], v[108:111], a[20:23], v[56:71]
  ds_read_b128 v[104:107], v3 offset:2048
  v_mfma_f32_32x32x16_bf16 v[72:87], v[108:111], a[24:27], v[72:87]
  buffer_load_dwordx4 v0, s[4:7], s33 offen offset:1024 sc1 lds
  v_mfma_f32_32x32x16_bf16 v[88:103], v[108:111], a[28:31], v[88:103]
  buffer_load_dwordx4 v0, s[4:7], s33 offen offset:2048 sc1 lds
  s_waitcnt lgkmcnt(2)
  v_mfma_f32_32x32x16_bf16 v[40:55], v[112:115], a[32:35], v[40:55]
  v_mfma_f32_32x32x16_bf16 v[56:71], v[112:115], a[36:39], v[56:71]
  ds_read_b128 v[108:111], v3 offset:2560
  buffer_load_dwordx4 v0, s[4:7], s33 offen offset:3072 sc1 lds
  s_sub_u32 m0, m0, 8192
  s_sub_u32 s33, s33, 8192
  v_mfma_f32_32x32x16_bf16 v[72:87], v[112:115], a[40:43], v[72:87]
  buffer_load_dwordx4 v0, s[4:7], s33 offen offset:0 sc1 lds
  v_mfma_f32_32x32x16_bf16 v[88:103], v[112:115], a[44:47], v[88:103]
  s_waitcnt lgkmcnt(2)
  v_mfma_f32_32x32x16_bf16 v[40:55], v[116:119], a[48:51], v[40:55]
  buffer_load_dwordx4 v0, s[4:7], s33 offen offset:1024 sc1 lds
  v_mfma_f32_32x32x16_bf16 v[56:71], v[116:119], a[52:55], v[56:71]
  ds_read_b128 v[112:115], v3 offset:3072
  buffer_load_dwordx4 v0, s[4:7], s33 offen offset:2048 sc1 lds
  v_mfma_f32_32x32x16_bf16 v[72:87], v[116:119], a[56:59], v[72:87]
  v_mfma_f32_32x32x16_bf16 v[88:103], v[116:119], a[60:63], v[88:103]
  buffer_load_dwordx4 v0, s[4:7], s33 offen offset:3072 sc1 lds
  s_add_u32 m0, s23, s34
  s_add_u32 s32, s32, s18
  s_waitcnt lgkmcnt(2)
  v_mfma_f32_32x32x16_bf16 v[40:55], v[104:107], a[64:67], v[40:55]
  buffer_load_dwordx4 v0, s[4:7], s32 offen offset:0 sc1 lds
  v_mfma_f32_32x32x16_bf16 v[56:71], v[104:107], a[68:71], v[56:71]
  ds_read_b128 v[116:119], v3 offset:3584
  v_mfma_f32_32x32x16_bf16 v[72:87], v[104:107], a[72:75], v[72:87]
  buffer_load_dwordx4 v0, s[4:7], s32 offen offset:1024 sc1 lds
  s_add_i32 m0, m0, 4096
  s_add_i32 s32, s32, 4096
  v_mfma_f32_32x32x16_bf16 v[88:103], v[104:107], a[76:79], v[88:103]
  buffer_load_dwordx4 v0, s[4:7], s32 offen offset:0 sc1 lds
  s_waitcnt lgkmcnt(2)
  v_mfma_f32_32x32x16_bf16 v[40:55], v[108:111], a[80:83], v[40:55]
  v_mfma_f32_32x32x16_bf16 v[56:71], v[108:111], a[84:87], v[56:71]
  ds_read_b128 v[104:107], v3 offset:8192
  buffer_load_dwordx4 v0, s[4:7], s32 offen offset:1024 sc1 lds
  s_add_i32 m0, m0, -16384
  s_add_i32 s32, s32, -16384
  v_mfma_f32_32x32x16_bf16 v[72:87], v[108:111], a[88:91], v[72:87]
  s_and_b32 s29, s64, 0xff00
  s_lshl_b32 s29, s29, 3
  s_add_u32 s29, s29, s15
  buffer_load_dword v245, v252, s[4:7], s29 offen sc1
  v_mfma_f32_32x32x16_bf16 v[88:103], v[108:111], a[92:95], v[88:103]
  s_waitcnt lgkmcnt(2)
  v_mfma_f32_32x32x16_bf16 v[40:55], v[112:115], a[96:99], v[40:55]
  buffer_load_dwordx4 v0, s[4:7], s32 offen offset:0 sc1 lds
  v_mfma_f32_32x32x16_bf16 v[56:71], v[112:115], a[100:103], v[56:71]
  ds_read_b128 v[108:111], v3 offset:8704
  buffer_load_dwordx4 v0, s[4:7], s32 offen offset:1024 sc1 lds
  s_add_i32 m0, m0, -4096
  s_add_i32 s32, s32, -4096
  v_mfma_f32_32x32x16_bf16 v[72:87], v[112:115], a[104:107], v[72:87]
  v_mfma_f32_32x32x16_bf16 v[88:103], v[112:115], a[108:111], v[88:103]
  buffer_load_dwordx4 v0, s[4:7], s32 offen offset:0 sc1 lds
  s_waitcnt lgkmcnt(2)
  v_mfma_f32_32x32x16_bf16 v[40:55], v[116:119], a[112:115], v[40:55]
  buffer_load_dwordx4 v0, s[4:7], s32 offen offset:1024 sc1 lds
  v_mfma_f32_32x32x16_bf16 v[56:71], v[116:119], a[116:119], v[56:71]
  ds_read_b128 v[112:115], v3 offset:9216
  v_mfma_f32_32x32x16_bf16 v[72:87], v[116:119], a[120:123], v[72:87]
  buffer_load_dwordx4 v0, s[4:7], s32 offen offset:2048 sc1 lds
  v_mfma_f32_32x32x16_bf16 v[88:103], v[116:119], a[124:127], v[88:103]
  buffer_load_dwordx4 v0, s[4:7], s32 offen offset:3072 sc1 lds
  s_add_i32 m0, m0, 4096
  s_add_i32 s32, s32, 4096
  s_waitcnt lgkmcnt(2)
  v_mfma_f32_32x32x16_bf16 v[40:55], v[104:107], a[128:131], v[40:55]
  v_mfma_f32_32x32x16_bf16 v[56:71], v[104:107], a[132:135], v[56:71]
  ds_read_b128 v[116:119], v3 offset:9728
  buffer_load_dwordx4 v0, s[4:7], s32 offen offset:2048 sc1 lds
  v_mfma_f32_32x32x16_bf16 v[72:87], v[104:107], a[136:139], v[72:87]
  buffer_load_dwordx4 v0, s[4:7], s32 offen offset:3072 sc1 lds
  s_add_i32 m0, m0, 16384
  s_add_i32 s32, s32, 16384
  v_mfma_f32_32x32x16_bf16 v[88:103], v[104:107], a[140:143], v[88:103]
  s_waitcnt lgkmcnt(2)
  v_mfma_f32_32x32x16_bf16 v[40:55], v[108:111], a[144:147], v[40:55]
  buffer_load_dwordx4 v0, s[4:7], s32 offen offset:2048 sc1 lds
  v_mfma_f32_32x32x16_bf16 v[56:71], v[108:111], a[148:151], v[56:71]
  ds_read_b128 v[104:107], v3 offset:10240
  buffer_load_dwordx4 v0, s[4:7], s32 offen offset:3072 sc1 lds
  s_add_i32 m0, m0, -4096
  s_add_i32 s32, s32, -4096
  v_mfma_f32_32x32x16_bf16 v[72:87], v[108:111], a[152:155], v[72:87]
  v_mfma_f32_32x32x16_bf16 v[88:103], v[108:111], a[156:159], v[88:103]
  buffer_load_dwordx4 v0, s[4:7], s32 offen offset:2048 sc1 lds
  s_waitcnt lgkmcnt(2)
  v_mfma_f32_32x32x16_bf16 v[40:55], v[112:115], a[160:163], v[40:55]
  buffer_load_dwordx4 v0, s[4:7], s32 offen offset:3072 sc1 lds
  v_mfma_f32_32x32x16_bf16 v[56:71], v[112:115], a[164:167], v[56:71]
  ds_read_b128 v[108:111], v3 offset:10752
  v_mfma_f32_32x32x16_bf16 v[72:87], v[112:115], a[168:171], v[72:87]
  v_mfma_f32_32x32x16_bf16 v[88:103], v[112:115], a[172:175], v[88:103]
  s_waitcnt lgkmcnt(2)
  v_mfma_f32_32x32x16_bf16 v[40:55], v[116:119], a[176:179], v[40:55]
  v_mfma_f32_32x32x16_bf16 v[56:71], v[116:119], a[180:183], v[56:71]
  ds_read_b128 v[112:115], v3 offset:11264
  v_mfma_f32_32x32x16_bf16 v[72:87], v[116:119], a[184:187], v[72:87]
  v_mfma_f32_32x32x16_bf16 v[88:103], v[116:119], a[188:191], v[88:103]
  s_waitcnt lgkmcnt(2)
  v_mfma_f32_32x32x16_bf16 v[40:55], v[104:107], a[192:195], v[40:55]
  v_mfma_f32_32x32x16_bf16 v[56:71], v[104:107], a[196:199], v[56:71]
  ds_read_b128 v[116:119], v3 offset:11776
  s_waitcnt vmcnt(12)
  v_cmp_eq_u32 vcc, 0, v245
  s_cmp_eq_u64 vcc, 0
  s_cselect_b32 s76, s26, 0
  s_and_b32 s76, s76, 1
  s_cselect_b32 s88, s88, 1024
  s_waitcnt lgkmcnt(2)
  v_mfma_f32_32x32x16_bf16 v[40:55], v[108:111], a[208:211], v[40:55]
  s_lshl_b32 s32, s88, 18
  s_mov_b32 m0, s40
  s_add_u32 s32, s32, s21
  buffer_load_dwordx4 v0, s[4:7], s32 offen offset:0 sc1 lds
  v_mfma_f32_32x32x16_bf16 v[56:71], v[108:111], a[212:215], v[56:71]
  buffer_load_dwordx4 v0, s[4:7], s32 offen offset:1024 sc1 lds
  s_waitcnt lgkmcnt(1)
  v_mfma_f32_32x32x16_bf16 v[40:55], v[112:115], a[224:227], v[40:55]
  buffer_load_dwordx4 v0, s[4:7], s32 offen offset:2048 sc1 lds
  s_sub_u32 m0, m0, 8192
  s_sub_u32 s32, s32, 8192
  v_mfma_f32_32x32x16_bf16 v[56:71], v[112:115], a[228:231], v[56:71]
  buffer_load_dwordx4 v0, s[4:7], s32 offen offset:0 sc1 lds
  s_waitcnt lgkmcnt(0)
  v_mfma_f32_32x32x16_bf16 v[40:55], v[116:119], a[240:243], v[40:55]
  buffer_load_dwordx4 v0, s[4:7], s32 offen offset:1024 sc1 lds
  v_mfma_f32_32x32x16_bf16 v[56:71], v[116:119], a[244:247], v[56:71]
  buffer_load_dwordx4 v0, s[4:7], s32 offen offset:2048 sc1 lds
  v_cmp_eq_u32 vcc, 0, v249
  v_max_u32_dpp v249, v249, v249 row_ror:8 row_mask:0xf bank_mask:0xf
  s_nop 0
  v_mfma_f32_32x32x16_bf16 v[72:87], v[104:107], a[200:203], v[72:87]
  v_max_u32_dpp v249, v249, v249 row_ror:4 row_mask:0xf bank_mask:0xf
  s_nop 0
  s_nop 0
  v_max_u32_dpp v249, v249, v249 row_ror:2 row_mask:0xf bank_mask:0xf
  s_nop 0
  s_nop 0
  v_max_u32_dpp v249, v249, v249 row_ror:1 row_mask:0xf bank_mask:0xf
  s_nop 0
  v_mfma_f32_32x32x16_bf16 v[88:103], v[104:107], a[204:207], v[88:103]
  v_mov_b32 v248, v249
  s_nop 0
  s_nop 0
  v_permlane16_swap_b32 v249, v248
  v_max_u32 v249, v249, v248
  v_mfma_f32_32x32x16_bf16 v[72:87], v[108:111], a[216:219], v[72:87]
  v_mov_b32 v248, v249
  s_nop 0
  s_nop 0
  v_permlane32_swap_b32 v249, v248
  v_max_u32 v249, v249, v248
  s_cmp_eq_u64 vcc, 0
  s_cselect_b32 s28, 4, 0
  v_mfma_f32_32x32x16_bf16 v[88:103], v[108:111], a[220:223], v[88:103]
  s_lshl_b32 s26, s76, 1
  s_or_b32 s26, s26, s66
  s_or_b32 s26, s26, s28
  v_mov_b32 v248, s26
  ds_write_b64 v39, v[248:249]
  v_mfma_f32_32x32x16_bf16 v[72:87], v[112:115], a[232:235], v[72:87]
  v_cvt_pk_bf16_f32 v212, v40, v56
  v_cvt_pk_bf16_f32 v214, v41, v57
  v_cvt_pk_bf16_f32 v216, v42, v58
  v_cvt_pk_bf16_f32 v218, v43, v59
  v_permlane16_swap_b32 v212, v214
  v_mfma_f32_32x32x16_bf16 v[88:103], v[112:115], a[236:239], v[88:103]
  v_cvt_pk_bf16_f32 v220, v44, v60
  v_cvt_pk_bf16_f32 v222, v45, v61
  v_permlane16_swap_b32 v216, v218
  v_bfi_b32 v212, v254, s42, v212
  v_mfma_f32_32x32x16_bf16 v[72:87], v[116:119], a[248:251], v[72:87]
  v_cvt_pk_bf16_f32 v224, v46, v62
  v_cvt_pk_bf16_f32 v226, v47, v63
  v_permlane16_swap_b32 v220, v222
  v_bfi_b32 v216, v254, s42, v216
  v_cvt_pk_bf16_f32 v228, v48, v64
  v_mfma_f32_32x32x16_bf16 v[88:103], v[116:119], a[252:255], v[88:103]
  v_cvt_pk_bf16_f32 v230, v49, v65
  v_permlane16_swap_b32 v224, v226
  v_bfi_b32 v220, v254, s42, v220
  v_cvt_pk_bf16_f32 v232, v50, v66
  v_cvt_pk_bf16_f32 v234, v51, v67
  v_permlane16_swap_b32 v228, v230
  v_bfi_b32 v224, v254, s42, v224
  v_cvt_pk_bf16_f32 v236, v52, v68
  v_cvt_pk_bf16_f32 v238, v53, v69
  v_permlane16_swap_b32 v232, v234
  v_bfi_b32 v228, v254, s42, v228
  v_cvt_pk_bf16_f32 v240, v54, v70
  v_cvt_pk_bf16_f32 v242, v55, v71
  v_permlane16_swap_b32 v236, v238
  v_bfi_b32 v232, v254, s42, v232
  v_permlane16_swap_b32 v240, v242
  v_bfi_b32 v236, v254, s42, v236
  v_bfi_b32 v240, v254, s42, v240
  v_cvt_pk_bf16_f32 v213, v72, v88
  v_cvt_pk_bf16_f32 v215, v73, v89
  v_cvt_pk_bf16_f32 v217, v74, v90
  v_cvt_pk_bf16_f32 v219, v75, v91
  s_add_u32 s78, s86, 0
  v_permlane16_swap_b32 v213, v215
  buffer_store_dwordx4 v[212:215], v4, s[4:7], s78 offen
  v_cvt_pk_bf16_f32 v221, v76, v92
  v_cvt_pk_bf16_f32 v223, v77, v93
  s_add_u32 s78, s86, 32768
  v_permlane16_swap_b32 v217, v219
  buffer_store_dwordx4 v[216:219], v4, s[4:7], s78 offen
  v_cvt_pk_bf16_f32 v225, v78, v94
  v_cvt_pk_bf16_f32 v227, v79, v95
  s_add_u32 s78, s86, 131072
  v_permlane16_swap_b32 v221, v223
  buffer_store_dwordx4 v[220:223], v4, s[4:7], s78 offen
  v_cvt_pk_bf16_f32 v229, v80, v96
  v_cvt_pk_bf16_f32 v231, v81, v97
  s_add_u32 s78, s86, 163840
  v_permlane16_swap_b32 v225, v227
  buffer_store_dwordx4 v[224:227], v4, s[4:7], s78 offen
  v_cvt_pk_bf16_f32 v233, v82, v98
  v_cvt_pk_bf16_f32 v235, v83, v99
  s_add_u32 s78, s86, 262144
  v_permlane16_swap_b32 v229, v231
  buffer_store_dwordx4 v[228:231], v4, s[4:7], s78 offen
  v_cvt_pk_bf16_f32 v237, v84, v100
  v_cvt_pk_bf16_f32 v239, v85, v101
  s_add_u32 s78, s86, 294912
  v_permlane16_swap_b32 v233, v235
  buffer_store_dwordx4 v[232:235], v4, s[4:7], s78 offen
  v_cvt_pk_bf16_f32 v241, v86, v102
  v_cvt_pk_bf16_f32 v243, v87, v103
  s_add_u32 s78, s86, 393216
  v_permlane16_swap_b32 v237, v239
  buffer_store_dwordx4 v[236:239], v4, s[4:7], s78 offen
  s_add_u32 s78, s86, 425984
  v_permlane16_swap_b32 v241, v243
  buffer_store_dwordx4 v[240:243], v4, s[4:7], s78 offen
  s_waitcnt vmcnt(22)
  s_branch o_we_145
o_wr0_142:
  s_waitcnt lgkmcnt(0)
  s_barrier
  ds_read_b128 v[104:107], v3 offset:0
  ds_read_b128 v[108:111], v3 offset:512
  ds_read_b128 v[112:115], v3 offset:1024
  s_waitcnt lgkmcnt(2)
  v_mfma_f32_32x32x16_bf16 v[40:55], v[104:107], a[0:3], 0
  v_mfma_f32_32x32x16_bf16 v[56:71], v[104:107], a[4:7], 0
  ds_read_b128 v[116:119], v3 offset:1536
  v_mfma_f32_32x32x16_bf16 v[72:87], v[104:107], a[8:11], 0
  v_mfma_f32_32x32x16_bf16 v[88:103], v[104:107], a[12:15], 0
  s_waitcnt lgkmcnt(2)
  v_mfma_f32_32x32x16_bf16 v[40:55], v[108:111], a[16:19], v[40:55]
  v_mfma_f32_32x32x16_bf16 v[56:71], v[108:111], a[20:23], v[56:71]
  ds_read_b128 v[104:107], v3 offset:2048
  v_mfma_f32_32x32x16_bf16 v[72:87], v[108:111], a[24:27], v[72:87]
  v_mfma_f32_32x32x16_bf16 v[88:103], v[108:111], a[28:31], v[88:103]
  s_waitcnt lgkmcnt(2)
  v_mfma_f32_32x32x16_bf16 v[40:55], v[112:115], a[32:35], v[40:55]
  v_mfma_f32_32x32x16_bf16 v[56:71], v[112:115], a[36:39], v[56:71]
  ds_read_b128 v[108:111], v3 offset:2560
  v_mfma_f32_32x32x16_bf16 v[72:87], v[112:115], a[40:43], v[72:87]
  v_mfma_f32_32x32x16_bf16 v[88:103], v[112:115], a[44:47], v[88:103]
  s_waitcnt lgkmcnt(2)
  v_mfma_f32_32x32x16_bf16 v[40:55], v[116:119], a[48:51], v[40:55]
  v_mfma_f32_32x32x16_bf16 v[56:71], v[116:119], a[52:55], v[56:71]
  ds_read_b128 v[112:115], v3 offset:3072
  v_mfma_f32_32x32x16_bf16 v[72:87], v[116:119], a[56:59], v[72:87]
  v_mfma_f32_32x32x16_bf16 v[88:103], v[116:119], a[60:63], v[88:103]
  s_waitcnt lgkmcnt(2)
  v_mfma_f32_32x32x16_bf16 v[40:55], v[104:107], a[64:67], v[40:55]
  v_mfma_f32_32x32x16_bf16 v[56:71], v[104:107], a[68:71], v[56:71]
  ds_read_b128 v[116:119], v3 offset:3584
  v_mfma_f32_32x32x16_bf16 v[72:87], v[104:107], a[72:75], v[72:87]
  v_mfma_f32_32x32x16_bf16 v[88:103], v[104:107], a[76:79], v[88:103]
  s_waitcnt lgkmcnt(2)
  v_mfma_f32_32x32x16_bf16 v[40:55], v[108:111], a[80:83], v[40:55]
  v_mfma_f32_32x32x16_bf16 v[56:71], v[108:111], a[84:87], v[56:71]
  ds_read_b128 v[104:107], v3 offset:8192
  v_mfma_f32_32x32x16_bf16 v[72:87], v[108:111], a[88:91], v[72:87]
  v_mfma_f32_32x32x16_bf16 v[88:103], v[108:111], a[92:95], v[88:103]
  s_waitcnt lgkmcnt(2)
  v_mfma_f32_32x32x16_bf16 v[40:55], v[112:115], a[96:99], v[40:55]
  v_mfma_f32_32x32x16_bf16 v[56:71], v[112:115], a[100:103], v[56:71]
  ds_read_b128 v[108:111], v3 offset:8704
  v_mfma_f32_32x32x16_bf16 v[72:87], v[112:115], a[104:107], v[72:87]
  v_mfma_f32_32x32x16_bf16 v[88:103], v[112:115], a[108:111], v[88:103]
  s_waitcnt lgkmcnt(2)
  v_mfma_f32_32x32x16_bf16 v[40:55], v[116:119], a[112:115], v[40:55]
  v_mfma_f32_32x32x16_bf16 v[56:71], v[116:119], a[116:119], v[56:71]
  ds_read_b128 v[112:115], v3 offset:9216
  v_mfma_f32_32x32x16_bf16 v[72:87], v[116:119], a[120:123], v[72:87]
  v_mfma_f32_32x32x16_bf16 v[88:103], v[116:119], a[124:127], v[88:103]
  s_waitcnt lgkmcnt(2)
  v_mfma_f32_32x32x16_bf16 v[40:55], v[104:107], a[128:131], v[40:55]
  v_mfma_f32_32x32x16_bf16 v[56:71], v[104:107], a[132:135], v[56:71]
  ds_read_b128 v[116:119], v3 offset:9728
  v_mfma_f32_32x32x16_bf16 v[72:87], v[104:107], a[136:139], v[72:87]
  v_mfma_f32_32x32x16_bf16 v[88:103], v[104:107], a[140:143], v[88:103]
  s_waitcnt lgkmcnt(2)
  v_mfma_f32_32x32x16_bf16 v[40:55], v[108:111], a[144:147], v[40:55]
  v_mfma_f32_32x32x16_bf16 v[56:71], v[108:111], a[148:151], v[56:71]
  ds_read_b128 v[104:107], v3 offset:10240
  v_mfma_f32_32x32x16_bf16 v[72:87], v[108:111], a[152:155], v[72:87]
  v_mfma_f32_32x32x16_bf16 v[88:103], v[108:111], a[156:159], v[88:103]
  s_waitcnt lgkmcnt(2)
  v_mfma_f32_32x32x16_bf16 v[40:55], v[112:115], a[160:163], v[40:55]
  v_mfma_f32_32x32x16_bf16 v[56:71], v[112:115], a[164:167], v[56:71]
  ds_read_b128 v[108:111], v3 offset:10752
  v_mfma_f32_32x32x16_bf16 v[72:87], v[112:115], a[168:171], v[72:87]
  v_mfma_f32_32x32x16_bf16 v[88:103], v[112:115], a[172:175], v[88:103]
  s_waitcnt lgkmcnt(2)
  v_mfma_f32_32x32x16_bf16 v[40:55], v[116:119], a[176:179], v[40:55]
  v_mfma_f32_32x32x16_bf16 v[56:71], v[116:119], a[180:183], v[56:71]
  ds_read_b128 v[112:115], v3 offset:11264
  v_mfma_f32_32x32x16_bf16 v[72:87], v[116:119], a[184:187], v[72:87]
  v_mfma_f32_32x32x16_bf16 v[88:103], v[116:119], a[188:191], v[88:103]
  s_waitcnt lgkmcnt(2)
  v_mfma_f32_32x32x16_bf16 v[40:55], v[104:107], a[192:195], v[40:55]
  v_mfma_f32_32x32x16_bf16 v[56:71], v[104:107], a[196:199], v[56:71]
  ds_read_b128 v[116:119], v3 offset:11776
  s_waitcnt lgkmcnt(2)
  v_mfma_f32_32x32x16_bf16 v[40:55], v[108:111], a[208:211], v[40:55]
  v_mfma_f32_32x32x16_bf16 v[56:71], v[108:111], a[212:215], v[56:71]
  s_waitcnt lgkmcnt(1)
  v_mfma_f32_32x32x16_bf16 v[40:55], v[112:115], a[224:227], v[40:55]
  v_mfma_f32_32x32x16_bf16 v[56:71], v[112:115], a[228:231], v[56:71]
  s_waitcnt lgkmcnt(0)
  v_mfma_f32_32x32x16_bf16 v[40:55], v[116:119], a[240:243], v[40:55]
  v_mfma_f32_32x32x16_bf16 v[56:71], v[116:119], a[244:247], v[56:71]
  v_mfma_f32_32x32x16_bf16 v[72:87], v[104:107], a[200:203], v[72:87]
  v_mfma_f32_32x32x16_bf16 v[88:103], v[104:107], a[204:207], v[88:103]
  v_cvt_pk_bf16_f32 v212, v40, v56
  v_cvt_pk_bf16_f32 v214, v41, v57
  v_cvt_pk_bf16_f32 v216, v42, v58
  v_cvt_pk_bf16_f32 v218, v43, v59
  v_permlane16_swap_b32 v212, v214
  v_mfma_f32_32x32x16_bf16 v[72:87], v[108:111], a[216:219], v[72:87]
  v_cvt_pk_bf16_f32 v220, v44, v60
  v_cvt_pk_bf16_f32 v222, v45, v61
  v_permlane16_swap_b32 v216, v218
  v_bfi_b32 v212, v254, s42, v212
  v_cvt_pk_bf16_f32 v224, v46, v62
  v_mfma_f32_32x32x16_bf16 v[88:103], v[108:111], a[220:223], v[88:103]
  v_cvt_pk_bf16_f32 v226, v47, v63
  v_permlane16_swap_b32 v220, v222
  v_bfi_b32 v216, v254, s42, v216
  v_cvt_pk_bf16_f32 v228, v48, v64
  v_mfma_f32_32x32x16_bf16 v[72:87], v[112:115], a[232:235], v[72:87]
  v_cvt_pk_bf16_f32 v230, v49, v65
  v_permlane16_swap_b32 v224, v226
  v_bfi_b32 v220, v254, s42, v220
  v_cvt_pk_bf16_f32 v232, v50, v66
  v_cvt_pk_bf16_f32 v234, v51, v67
  v_mfma_f32_32x32x16_bf16 v[88:103], v[112:115], a[236:239], v[88:103]
  v_permlane16_swap_b32 v228, v230
  v_bfi_b32 v224, v254, s42, v224
  v_cvt_pk_bf16_f32 v236, v52, v68
  v_cvt_pk_bf16_f32 v238, v53, v69
  v_mfma_f32_32x32x16_bf16 v[72:87], v[116:119], a[248:251], v[72:87]
  v_permlane16_swap_b32 v232, v234
  v_bfi_b32 v228, v254, s42, v228
  v_cvt_pk_bf16_f32 v240, v54, v70
  v_cvt_pk_bf16_f32 v242, v55, v71
  v_permlane16_swap_b32 v236, v238
  v_mfma_f32_32x32x16_bf16 v[88:103], v[116:119], a[252:255], v[88:103]
  v_bfi_b32 v232, v254, s42, v232
  v_permlane16_swap_b32 v240, v242
  v_bfi_b32 v236, v254, s42, v236
  v_bfi_b32 v240, v254, s42, v240
  s_nop 7
  v_cvt_pk_bf16_f32 v213, v72, v88
  v_cvt_pk_bf16_f32 v215, v73, v89
  v_cvt_pk_bf16_f32 v217, v74, v90
  v_cvt_pk_bf16_f32 v219, v75, v91
  s_add_u32 s78, s86, 0
  v_permlane16_swap_b32 v213, v215
  buffer_store_dwordx4 v[212:215], v4, s[4:7], s78 offen
  v_cvt_pk_bf16_f32 v221, v76, v92
  v_cvt_pk_bf16_f32 v223, v77, v93
  s_add_u32 s78, s86, 32768
  v_permlane16_swap_b32 v217, v219
  buffer_store_dwordx4 v[216:219], v4, s[4:7], s78 offen
  v_cvt_pk_bf16_f32 v225, v78, v94
  v_cvt_pk_bf16_f32 v227, v79, v95
  s_add_u32 s78, s86, 131072
  v_permlane16_swap_b32 v221, v223
  buffer_store_dwordx4 v[220:223], v4, s[4:7], s78 offen
  v_cvt_pk_bf16_f32 v229, v80, v96
  v_cvt_pk_bf16_f32 v231, v81, v97
  s_add_u32 s78, s86, 163840
  v_permlane16_swap_b32 v225, v227
  buffer_store_dwordx4 v[224:227], v4, s[4:7], s78 offen
  v_cvt_pk_bf16_f32 v233, v82, v98
  v_cvt_pk_bf16_f32 v235, v83, v99
  s_add_u32 s78, s86, 262144
  v_permlane16_swap_b32 v229, v231
  buffer_store_dwordx4 v[228:231], v4, s[4:7], s78 offen
  v_cvt_pk_bf16_f32 v237, v84, v100
  v_cvt_pk_bf16_f32 v239, v85, v101
  s_add_u32 s78, s86, 294912
  v_permlane16_swap_b32 v233, v235
  buffer_store_dwordx4 v[232:235], v4, s[4:7], s78 offen
  v_cvt_pk_bf16_f32 v241, v86, v102
  v_cvt_pk_bf16_f32 v243, v87, v103
  s_add_u32 s78, s86, 393216
  v_permlane16_swap_b32 v237, v239
  buffer_store_dwordx4 v[236:239], v4, s[4:7], s78 offen
  s_add_u32 s78, s86, 425984
  v_permlane16_swap_b32 v241, v243
  buffer_store_dwordx4 v[240:243], v4, s[4:7], s78 offen
  s_branch o_we_145
o_wr1_143:
  s_nop 3
  v_mul_f32 v112, s24, v112
  v_mul_f32 v113, s24, v113
  v_exp_f32 v64, v112
  v_exp_f32 v65, v113
  v_max_f32 v116, v111, v116
  v_max3_f32 v116, v112, v113, v116
  v_add_f32 v117, v117, v64
  v_add_f32 v118, v118, v65
  v_add_f32 v117, v117, v118
  s_mov_b32 s28, 0x21800000
  v_mov_b32 v118, v117
  s_nop 1
  v_permlane16_swap_b32 v117, v118
  v_add_f32 v117, v117, v118
  v_mov_b32 v118, v117
  s_nop 0
  s_nop 0
  v_permlane32_swap_b32 v117, v118
  v_add_f32 v117, v117, v118
  s_mov_b32 s67, 0
  s_mov_b64 vcc, 0
  s_waitcnt vmcnt(3)
o_pl_151:
  v_and_b32 v7, 1, v7
  v_cmp_ne_u32 vcc, s96, v7
  s_cbranch_vccz o_pk_152
  buffer_load_dword v7, v255, s[4:7], s97 offen sc1
  s_add_u32 s67, s67, 1
  s_cmp_gt_u32 s67, 1048576
  s_cbranch_scc1 L_end
  s_waitcnt vmcnt(0)
  s_branch o_pl_151
o_pk_152:
  s_lshl_b32 s94, s43, 14
  s_add_u32 s94, s94, s95
  buffer_load_dwordx4 v[120:123], v5, s[4:7], s94 offen offset:0 sc1
  v_cmp_lt_f32 vcc, 0x42700000, v116
  v_cmp_gt_f32 s[30:31], s28, v117
  v_rcp_f32 v117, v117
  buffer_load_dwordx4 v[124:127], v5, s[4:7], s94 offen offset:512 sc1
  s_or_b64 vcc, vcc, s[30:31]
  s_cbranch_vccnz o_fb_149
o_fbr_150:
  buffer_load_dwordx4 v[128:131], v5, s[4:7], s94 offen offset:256 sc1
  v_pk_mul_f32 v[56:57], v[56:57], v[116:117] op_sel:[0,1] op_sel_hi:[1,1]
  v_pk_mul_f32 v[58:59], v[58:59], v[116:117] op_sel:[0,1] op_sel_hi:[1,1]
  v_pk_mul_f32 v[60:61], v[60:61], v[116:117] op_sel:[0,1] op_sel_hi:[1,1]
  v_pk_mul_f32 v[62:63], v[62:63], v[116:117] op_sel:[0,1] op_sel_hi:[1,1]
  v_pk_mul_f32 v[64:65], v[64:65], v[116:117] op_sel:[0,1] op_sel_hi:[1,1]
  buffer_load_dwordx4 v[132:135], v5, s[4:7], s94 offen offset:768 sc1
  v_cvt_pk_bf16_f32 v116, v56, v57
  v_cvt_pk_bf16_f32 v117, v58, v59
  v_cvt_pk_bf16_f32 v118, v60, v61
  v_cvt_pk_bf16_f32 v119, v62, v63
  s_waitcnt lgkmcnt(0)
  s_nop 0
  v_mfma_f32_16x16x32_bf16 v[72:75], v[152:155], v[116:119], 0
  s_add_u32 s62, s62, 1
  v_cvt_pk_bf16_f32 v197, v64, v65
  v_cvt_pk_bf16_f32 v198, v64, v65
  v_mfma_f32_16x16x32_bf16 v[76:79], v[156:159], v[116:119], 0
  s_add_u32 s94, s94, 4096
  buffer_load_dwordx4 v[136:139], v5, s[4:7], s94 offen offset:0 sc1
  s_xor_b32 s86, s86, 524288
  v_mfma_f32_16x16x32_bf16 v[80:83], v[160:163], v[116:119], 0
  s_bfe_u32 s42, s62, 0x10001
  v_mfma_f32_16x16x32_bf16 v[84:87], v[164:167], v[116:119], 0
  buffer_load_dwordx4 v[140:143], v5, s[4:7], s94 offen offset:512 sc1
  v_mfma_f32_16x16x32_bf16 v[88:91], v[168:171], v[116:119], 0
  v_mfma_f32_16x16x32_bf16 v[92:95], v[172:175], v[116:119], 0
  buffer_load_dwordx4 v[144:147], v5, s[4:7], s94 offen offset:256 sc1
  v_mfma_f32_16x16x32_bf16 v[96:99], v[176:179], v[116:119], 0
  v_mfma_f32_16x16x32_bf16 v[100:103], v[180:183], v[116:119], 0
  buffer_load_dwordx4 v[148:151], v5, s[4:7], s94 offen offset:768 sc1
  v_mfma_f32_16x16x16_bf16 v[72:75], v[200:201], v[198:199], v[72:75]
  s_nop 1
  v_mfma_f32_16x16x16_bf16 v[76:79], v[200:201], v[196:197], v[76:79]
  s_add_u32 s94, s94, 4096
  buffer_load_dwordx4 v[152:155], v5, s[4:7], s94 offen offset:0 sc1
  v_mfma_f32_16x16x16_bf16 v[80:83], v[202:203], v[198:199], v[80:83]
  s_nop 1
  v_mfma_f32_16x16x16_bf16 v[84:87], v[202:203], v[196:197], v[84:87]
  buffer_load_dwordx4 v[156:159], v5, s[4:7], s94 offen offset:512 sc1
  v_mfma_f32_16x16x16_bf16 v[88:91], v[204:205], v[198:199], v[88:91]
  s_nop 0
  v_cvt_pk_bf16_f32 v40, v72, v73
  v_cvt_pk_bf16_f32 v41, v74, v75
  v_mfma_f32_16x16x16_bf16 v[92:95], v[204:205], v[196:197], v[92:95]
  buffer_load_dwordx4 v[160:163], v5, s[4:7], s94 offen offset:256 sc1
  v_cvt_pk_bf16_f32 v42, v76, v77
  v_cvt_pk_bf16_f32 v43, v78, v79
  v_mfma_f32_16x16x16_bf16 v[96:99], v[206:207], v[198:199], v[96:99]
  s_nop 0
  ds_write_b128 v6, v[40:43] offset:0
  v_cvt_pk_bf16_f32 v44, v80, v81
  v_mfma_f32_16x16x16_bf16 v[100:103], v[206:207], v[196:197], v[100:103]
  buffer_load_dwordx4 v[164:167], v5, s[4:7], s94 offen offset:768 sc1
  v_cvt_pk_bf16_f32 v45, v82, v83
  v_cvt_pk_bf16_f32 v46, v84, v85
  v_cvt_pk_bf16_f32 v47, v86, v87
  ds_write_b128 v6, v[44:47] offset:1024
  v_cvt_pk_bf16_f32 v48, v88, v89
  v_cvt_pk_bf16_f32 v49, v90, v91
  v_cvt_pk_bf16_f32 v50, v92, v93
  v_cvt_pk_bf16_f32 v51, v94, v95
  s_add_u32 s94, s94, 4096
  buffer_load_dwordx4 v[168:171], v5, s[4:7], s94 offen offset:0 sc1
  ds_write_b128 v6, v[48:51] offset:2048
  v_cvt_pk_bf16_f32 v52, v96, v97
  v_cvt_pk_bf16_f32 v53, v98, v99
  v_cvt_pk_bf16_f32 v54, v100, v101
  v_cvt_pk_bf16_f32 v55, v102, v103
  ds_write_b128 v6, v[52:55] offset:3072
  buffer_load_dwordx4 v[172:175], v5, s[4:7], s94 offen offset:512 sc1
  s_and_b32 s26, s65, 49152
  s_cbranch_scc1 o_wr2_144
  s_waitcnt lgkmcnt(0)
  s_barrier
  ds_read_b128 v[104:107], v3 offset:0
  ds_read_b128 v[108:111], v3 offset:512
  ds_read_b128 v[112:115], v3 offset:1024
  buffer_load_dwordx4 v[176:179], v5, s[4:7], s94 offen offset:256 sc1
  buffer_load_dwordx4 v[180:183], v5, s[4:7], s94 offen offset:768 sc1
  s_waitcnt lgkmcnt(2)
  v_mfma_f32_32x32x16_bf16 v[40:55], v[104:107], a[0:3], 0
  v_mov_b64 v[188:189], 0
  v_mov_b64 v[190:191], 0
  v_mov_b64 v[192:193], 0
  v_mov_b64 v[194:195], 0
  s_mov_b64 exec, 1
  buffer_store_dword v38, off, s[4:7], s84 sc1
  s_mov_b64 exec, -1
  s_mov_b32 s84, 268435456
  v_mfma_f32_32x32x16_bf16 v[56:71], v[104:107], a[4:7], 0
  ds_read_b128 v[116:119], v3 offset:1536
  v_mfma_f32_32x32x16_bf16 v[72:87], v[104:107], a[8:11], 0
  v_mfma_f32_32x32x16_bf16 v[88:103], v[104:107], a[12:15], 0
  s_waitcnt vmcnt(13)
  v_xor_b32 v7, s96, v120
  v_bitop3_b32 v7, v7, v124, s96 bitop3:0xf6
  v_bitop3_b32 v7, v7, v128, s96 bitop3:0xf6
  v_bitop3_b32 v7, v7, v132, s96 bitop3:0xf6
  s_waitcnt lgkmcnt(2)
  v_mfma_f32_32x32x16_bf16 v[40:55], v[108:111], a[16:19], v[40:55]
  s_waitcnt vmcnt(9)
  v_bitop3_b32 v7, v7, v136, s96 bitop3:0xf6
  v_bitop3_b32 v7, v7, v140, s96 bitop3:0xf6
  v_bitop3_b32 v7, v7, v144, s96 bitop3:0xf6
  v_bitop3_b32 v7, v7, v148, s96 bitop3:0xf6
  s_waitcnt vmcnt(5)
  v_mfma_f32_32x32x16_bf16 v[56:71], v[108:111], a[20:23], v[56:71]
  ds_read_b128 v[104:107], v3 offset:2048
  v_bitop3_b32 v7, v7, v152, s96 bitop3:0xf6
  v_bitop3_b32 v7, v7, v156, s96 bitop3:0xf6
  v_bitop3_b32 v7, v7, v160, s96 bitop3:0xf6
  v_bitop3_b32 v7, v7, v164, s96 bitop3:0xf6
  s_waitcnt vmcnt(1)
  v_mfma_f32_32x32x16_bf16 v[72:87], v[108:111], a[24:27], v[72:87]
  v_bitop3_b32 v7, v7, v168, s96 bitop3:0xf6
  v_bitop3_b32 v7, v7, v172, s96 bitop3:0xf6
  v_bitop3_b32 v7, v7, v176, s96 bitop3:0xf6
  v_bitop3_b32 v7, v7, v180, s96 bitop3:0xf6
  v_and_b32 v7, v254, v7
  v_cmp_ne_u32 vcc, 0, v7
  s_cbranch_vccnz o_rt_153
o_bk_154:
  v_mfma_f32_32x32x16_bf16 v[88:103], v[108:111], a[28:31], v[88:103]
  v_smfmac_f32_16x16x64_bf16 v[188:191], v[16:19], v[120:127], v20
  v_lshlrev_b32 v196, 16, v184
  v_smfmac_f32_16x16x64_bf16 v[192:195], v[16:19], v[128:135], v20
  v_and_b32 v197, 0xffff0000, v184
  v_smfmac_f32_16x16x64_bf16 v[188:191], v[16:19], v[136:143], v20
  v_lshlrev_b32 v198, 16, v185
  s_waitcnt lgkmcnt(2)
  v_mfma_f32_32x32x16_bf16 v[40:55], v[112:115], a[32:35], v[40:55]
  v_smfmac_f32_16x16x64_bf16 v[192:195], v[16:19], v[144:151], v20
  v_and_b32 v199, 0xffff0000, v185
  v_smfmac_f32_16x16x64_bf16 v[188:191], v[16:19], v[152:159], v20
  v_lshlrev_b32 v200, 16, v186
  v_smfmac_f32_16x16x64_bf16 v[192:195], v[16:19], v[160:167], v20
  v_and_b32 v201, 0xffff0000, v186
  v_mfma_f32_32x32x16_bf16 v[56:71], v[112:115], a[36:39], v[56:71]
  ds_read_b128 v[108:111], v3 offset:2560
  v_smfmac_f32_16x16x64_bf16 v[188:191], v[16:19], v[168:175], v20
  v_lshlrev_b32 v202, 16, v187
  v_smfmac_f32_16x16x64_bf16 v[192:195], v[16:19], v[176:183], v20
  v_and_b32 v203, 0xffff0000, v187
  s_bfe_u32 s92, s65, 131086
  v_mfma_f32_32x32x16_bf16 v[72:87], v[112:115], a[40:43], v[72:87]
  s_lshl_b32 s92, s92, 21
  s_add_u32 s92, s92, s91
  s_add_u32 s93, s92, 27262976
  s_add_u32 s92, s92, 20971520
  v_permlane16_swap_b32 v188, v192
  v_mfma_f32_32x32x16_bf16 v[88:103], v[112:115], a[44:47], v[88:103]
  v_permlane16_swap_b32 v189, v193
  v_permlane16_swap_b32 v190, v194
  v_permlane16_swap_b32 v191, v195
  s_waitcnt lgkmcnt(2)
  v_mfma_f32_32x32x16_bf16 v[40:55], v[116:119], a[48:51], v[40:55]
  v_cvt_pk_bf16_f32 v188, 0, v188
  v_cvt_pk_bf16_f32 v189, 0, v189
  v_cvt_pk_bf16_f32 v190, 0, v190
  v_cvt_pk_bf16_f32 v191, 0, v191
  v_cvt_pk_bf16_f32 v192, 0, v192
  v_cvt_pk_bf16_f32 v193, 0, v193
  v_mfma_f32_32x32x16_bf16 v[56:71], v[116:119], a[52:55], v[56:71]
  ds_read_b128 v[112:115], v3 offset:3072
  v_cvt_pk_bf16_f32 v194, 0, v194
  v_cvt_pk_bf16_f32 v195, 0, v195
  v_add_f32 v196, v196, v188
  v_add_f32 v197, v197, v189
  v_add_f32 v198, v198, v190
  v_mfma_f32_32x32x16_bf16 v[72:87], v[116:119], a[56:59], v[72:87]
  v_add_f32 v199, v199, v191
  v_add_f32 v200, v200, v192
  v_add_f32 v201, v201, v193
  v_add_f32 v202, v202, v194
  v_add_f32 v203, v203, v195
  v_cvt_pk_bf16_f32 v120, v196, v197
  v_mfma_f32_32x32x16_bf16 v[88:103], v[116:119], a[60:63], v[88:103]
  v_cvt_pk_bf16_f32 v121, v198, v199
  v_cvt_pk_bf16_f32 v122, v200, v201
  v_cvt_pk_bf16_f32 v123, v202, v203
  v_lshlrev_b32 v196, 16, v120
  v_and_b32 v197, 0xffff0000, v120
  s_waitcnt lgkmcnt(2)
  v_mfma_f32_32x32x16_bf16 v[40:55], v[104:107], a[64:67], v[40:55]
  v_lshlrev_b32 v198, 16, v121
  v_and_b32 v199, 0xffff0000, v121
  v_lshlrev_b32 v200, 16, v122
  v_and_b32 v201, 0xffff0000, v122
  v_lshlrev_b32 v202, 16, v123
  v_and_b32 v203, 0xffff0000, v123
  v_mfma_f32_32x32x16_bf16 v[56:71], v[104:107], a[68:71], v[56:71]
  ds_read_b128 v[116:119], v3 offset:3584
  buffer_store_dwordx4 v[120:123], v0, s[4:7], s92 offen sc1
  v_add_f32 v136, v196, v197
  v_mul_f32 v137, v196, v196
  v_mfma_f32_32x32x16_bf16 v[72:87], v[104:107], a[72:75], v[72:87]
  v_add_f32 v138, v198, v199
  v_mul_f32 v139, v197, v197
  v_fmac_f32 v137, v198, v198
  v_fmac_f32 v139, v199, v199
  v_add_f32 v136, v136, v200
  v_fmac_f32 v137, v200, v200
  v_mfma_f32_32x32x16_bf16 v[88:103], v[104:107], a[76:79], v[88:103]
  v_add_f32 v138, v138, v201
  v_fmac_f32 v139, v201, v201
  v_add_f32 v136, v136, v202
  v_fmac_f32 v137, v202, v202
  v_add_f32 v138, v138, v203
  s_waitcnt lgkmcnt(2)
  v_mfma_f32_32x32x16_bf16 v[40:55], v[108:111], a[80:83], v[40:55]
  v_fmac_f32 v139, v203, v203
  v_add_f32 v136, v136, v138
  v_add_f32 v137, v137, v139
  s_nop 0
  v_add_f32_dpp v136, v136, v136 row_ror:8 row_mask:0xf bank_mask:0xf
  v_add_f32_dpp v137, v137, v137 row_ror:8 row_mask:0xf bank_mask:0xf
  s_nop 0
  v_add_f32_dpp v136, v136, v136 row_ror:4 row_mask:0xf bank_mask:0xf
  v_mfma_f32_32x32x16_bf16 v[56:71], v[108:111], a[84:87], v[56:71]
  ds_read_b128 v[104:107], v3 offset:8192
  v_add_f32_dpp v137, v137, v137 row_ror:4 row_mask:0xf bank_mask:0xf
  v_add_f32_dpp v136, v136, v136 row_ror:2 row_mask:0xf bank_mask:0xf
  s_nop 0
  v_add_f32_dpp v137, v137, v137 row_ror:2 row_mask:0xf bank_mask:0xf
  v_add_f32_dpp v136, v136, v136 row_ror:1 row_mask:0xf bank_mask:0xf
  s_nop 0
  v_add_f32_dpp v137, v137, v137 row_ror:1 row_mask:0xf bank_mask:0xf
  v_mfma_f32_32x32x16_bf16 v[72:87], v[108:111], a[88:91], v[72:87]
  v_mov_b32 v140, v136
  v_mov_b32 v141, v137
  s_nop 0
  v_permlane16_swap_b32 v136, v140
  v_permlane16_swap_b32 v137, v141
  v_mfma_f32_32x32x16_bf16 v[88:103], v[108:111], a[92:95], v[88:103]
  v_add_f32 v136, v136, v140
  v_add_f32 v137, v137, v141
  v_mov_b32 v140, v136
  v_mov_b32 v141, v137
  s_nop 0
  v_permlane32_swap_b32 v136, v140
  s_waitcnt lgkmcnt(2)
  v_mfma_f32_32x32x16_bf16 v[40:55], v[112:115], a[96:99], v[40:55]
  v_permlane32_swap_b32 v137, v141
  v_add_f32 v136, v136, v140
  v_add_f32 v137, v137, v141
  v_mul_f32 v136, 0x3b000000, v136
  v_mul_f32 v137, 0x3b000000, v137
  v_mfma_f32_32x32x16_bf16 v[56:71], v[112:115], a[100:103], v[56:71]
  ds_read_b128 v[108:111], v3 offset:8704
  v_fma_f32 v137, -v136, v136, v137
  v_cvt_pk_bf16_f32 v136, 0, v136
  v_max_f32 v137, 0, v137
  v_sub_f32 v140, v196, v136
  v_sub_f32 v141, v197, v136
  v_mfma_f32_32x32x16_bf16 v[72:87], v[112:115], a[104:107], v[72:87]
  v_cvt_pk_bf16_f32 v137, 0, v137
  v_sub_f32 v142, v198, v136
  v_sub_f32 v143, v199, v136
  v_add_f32 v137, 0x3727c5ac, v137
  v_sub_f32 v144, v200, v136
  v_sub_f32 v145, v201, v136
  v_mfma_f32_32x32x16_bf16 v[88:103], v[112:115], a[108:111], v[88:103]
  v_cvt_pk_bf16_f32 v137, 0, v137
  v_sub_f32 v146, v202, v136
  v_sub_f32 v147, v203, v136
  v_sqrt_f32 v137, v137
  s_waitcnt lgkmcnt(2)
  v_mfma_f32_32x32x16_bf16 v[40:55], v[116:119], a[112:115], v[40:55]
  v_cvt_pk_bf16_f32 v140, 0, v140
  v_cvt_pk_bf16_f32 v141, 0, v141
  v_cvt_pk_bf16_f32 v137, 0, v137
  v_cvt_pk_bf16_f32 v142, 0, v142
  v_cvt_pk_bf16_f32 v143, 0, v143
  v_rcp_f32 v137, v137
  v_mfma_f32_32x32x16_bf16 v[56:71], v[116:119], a[116:119], v[56:71]
  ds_read_b128 v[112:115], v3 offset:9216
  v_cvt_pk_bf16_f32 v144, 0, v144
  v_cvt_pk_bf16_f32 v145, 0, v145
  v_cvt_pk_bf16_f32 v146, 0, v146
  v_cvt_pk_bf16_f32 v147, 0, v147
  v_mul_f32 v140, v140, v137
  v_mfma_f32_32x32x16_bf16 v[72:87], v[116:119], a[120:123], v[72:87]
  v_mul_f32 v141, v141, v137
  v_mul_f32 v142, v142, v137
  v_mul_f32 v143, v143, v137
  v_mul_f32 v144, v144, v137
  v_mul_f32 v145, v145, v137
  v_mul_f32 v146, v146, v137
  v_mfma_f32_32x32x16_bf16 v[88:103], v[116:119], a[124:127], v[88:103]
  v_mul_f32 v147, v147, v137
  v_cvt_pk_bf16_f32 v124, v140, v141
  v_cvt_pk_bf16_f32 v125, v142, v143
  v_cvt_pk_bf16_f32 v126, v144, v145
  v_cvt_pk_bf16_f32 v127, v146, v147
  s_waitcnt lgkmcnt(2)
  v_mfma_f32_32x32x16_bf16 v[40:55], v[104:107], a[128:131], v[40:55]
  v_lshlrev_b32 v204, 16, v124
  v_and_b32 v205, 0xffff0000, v124
  v_lshlrev_b32 v206, 16, v125
  v_and_b32 v207, 0xffff0000, v125
  v_lshlrev_b32 v208, 16, v126
  v_and_b32 v209, 0xffff0000, v126
  v_mfma_f32_32x32x16_bf16 v[56:71], v[104:107], a[132:135], v[56:71]
  ds_read_b128 v[116:119], v3 offset:9728
  v_lshlrev_b32 v210, 16, v127
  v_and_b32 v211, 0xffff0000, v127
  buffer_store_dwordx4 v[124:127], v0, s[4:7], s93 offen sc1
  v_mfma_f32_32x32x16_bf16 v[72:87], v[104:107], a[136:139], v[72:87]
  v_add_f32 v196, v196, v204
  v_add_f32 v197, v197, v205
  v_add_f32 v198, v198, v206
  v_add_f32 v199, v199, v207
  v_add_f32 v200, v200, v208
  v_add_f32 v201, v201, v209
  v_mfma_f32_32x32x16_bf16 v[88:103], v[104:107], a[140:143], v[88:103]
  v_add_f32 v202, v202, v210
  v_add_f32 v203, v203, v211
  v_cvt_pk_bf16_f32 v128, v196, v197
  v_cvt_pk_bf16_f32 v129, v198, v199
  v_cvt_pk_bf16_f32 v130, v200, v201
  s_waitcnt lgkmcnt(2)
  v_mfma_f32_32x32x16_bf16 v[40:55], v[108:111], a[144:147], v[40:55]
  v_cvt_pk_bf16_f32 v131, v202, v203
  v_mul_f32 v188, v204, v8
  v_mul_f32 v189, v205, v9
  v_fmac_f32 v188, v206, v10
  v_fmac_f32 v189, v207, v11
  v_fmac_f32 v188, v208, v12
  v_mfma_f32_32x32x16_bf16 v[56:71], v[108:111], a[148:151], v[56:71]
  ds_read_b128 v[104:107], v3 offset:10240
  v_fmac_f32 v189, v209, v13
  v_fmac_f32 v188, v210, v14
  v_fmac_f32 v189, v211, v15
  v_add_f32 v188, v188, v189
  s_add_u32 s92, s91, 10485760
  v_mfma_f32_32x32x16_bf16 v[72:87], v[108:111], a[152:155], v[72:87]
  s_add_u32 s93, s91, 8388608
  buffer_store_dwordx4 v[128:131], v0, s[4:7], s92 offen sc1
  v_lshlrev_b32 v196, 16, v128
  v_and_b32 v197, 0xffff0000, v128
  v_mfma_f32_32x32x16_bf16 v[88:103], v[108:111], a[156:159], v[88:103]
  v_lshlrev_b32 v198, 16, v129
  v_and_b32 v199, 0xffff0000, v129
  v_lshlrev_b32 v200, 16, v130
  v_and_b32 v201, 0xffff0000, v130
  v_lshlrev_b32 v202, 16, v131
  s_waitcnt lgkmcnt(2)
  v_mfma_f32_32x32x16_bf16 v[40:55], v[112:115], a[160:163], v[40:55]
  v_and_b32 v203, 0xffff0000, v131
  v_add_f32 v136, v196, v197
  v_mul_f32 v137, v196, v196
  v_add_f32 v138, v198, v199
  v_mul_f32 v139, v197, v197
  v_fmac_f32 v137, v198, v198
  v_mfma_f32_32x32x16_bf16 v[56:71], v[112:115], a[164:167], v[56:71]
  ds_read_b128 v[108:111], v3 offset:10752
  v_fmac_f32 v139, v199, v199
  v_add_f32 v136, v136, v200
  v_fmac_f32 v137, v200, v200
  v_add_f32 v138, v138, v201
  v_fmac_f32 v139, v201, v201
  v_mfma_f32_32x32x16_bf16 v[72:87], v[112:115], a[168:171], v[72:87]
  v_add_f32 v136, v136, v202
  v_fmac_f32 v137, v202, v202
  v_add_f32 v138, v138, v203
  v_fmac_f32 v139, v203, v203
  v_add_f32 v136, v136, v138
  v_add_f32 v137, v137, v139
  v_mfma_f32_32x32x16_bf16 v[88:103], v[112:115], a[172:175], v[88:103]
  v_add_f32_dpp v136, v136, v136 row_ror:8 row_mask:0xf bank_mask:0xf
  v_add_f32_dpp v137, v137, v137 row_ror:8 row_mask:0xf bank_mask:0xf
  v_add_f32_dpp v188, v188, v188 row_ror:8 row_mask:0xf bank_mask:0xf
  v_add_f32_dpp v136, v136, v136 row_ror:4 row_mask:0xf bank_mask:0xf
  v_add_f32_dpp v137, v137, v137 row_ror:4 row_mask:0xf bank_mask:0xf
  s_waitcnt lgkmcnt(2)
  v_mfma_f32_32x32x16_bf16 v[40:55], v[116:119], a[176:179], v[40:55]
  v_add_f32_dpp v188, v188, v188 row_ror:4 row_mask:0xf bank_mask:0xf
  v_add_f32_dpp v136, v136, v136 row_ror:2 row_mask:0xf bank_mask:0xf
  v_add_f32_dpp v137, v137, v137 row_ror:2 row_mask:0xf bank_mask:0xf
  v_add_f32_dpp v188, v188, v188 row_ror:2 row_mask:0xf bank_mask:0xf
  v_add_f32_dpp v136, v136, v136 row_ror:1 row_mask:0xf bank_mask:0xf
  v_add_f32_dpp v137, v137, v137 row_ror:1 row_mask:0xf bank_mask:0xf
  v_mfma_f32_32x32x16_bf16 v[56:71], v[116:119], a[180:183], v[56:71]
  ds_read_b128 v[112:115], v3 offset:11264
  v_add_f32_dpp v188, v188, v188 row_ror:1 row_mask:0xf bank_mask:0xf
  v_mov_b32 v140, v136
  v_mov_b32 v141, v137
  v_mov_b32 v142, v188
  v_permlane16_swap_b32 v136, v140
  v_mfma_f32_32x32x16_bf16 v[72:87], v[116:119], a[184:187], v[72:87]
  v_permlane16_swap_b32 v137, v141
  v_permlane16_swap_b32 v188, v142
  v_add_f32 v136, v136, v140
  v_add_f32 v137, v137, v141
  v_mfma_f32_32x32x16_bf16 v[88:103], v[116:119], a[188:191], v[88:103]
  v_add_f32 v188, v188, v142
  v_mov_b32 v140, v136
  v_mov_b32 v141, v137
  v_mov_b32 v142, v188
  v_permlane32_swap_b32 v136, v140
  s_waitcnt lgkmcnt(2)
  v_mfma_f32_32x32x16_bf16 v[40:55], v[104:107], a[192:195], v[40:55]
  v_permlane32_swap_b32 v137, v141
  v_permlane32_swap_b32 v188, v142
  v_add_f32 v136, v136, v140
  v_add_f32 v137, v137, v141
  v_mfma_f32_32x32x16_bf16 v[56:71], v[104:107], a[196:199], v[56:71]
  ds_read_b128 v[116:119], v3 offset:11776
  v_add_f32 v188, v188, v142
  v_mul_f32 v136, 0x3b000000, v136
  v_mul_f32 v137, 0x3b000000, v137
  v_fma_f32 v137, -v136, v136, v137
  v_cvt_pk_bf16_f32 v136, 0, v136
  s_waitcnt lgkmcnt(2)
  v_mfma_f32_32x32x16_bf16 v[40:55], v[108:111], a[208:211], v[40:55]
  v_max_f32 v137, 0, v137
  v_sub_f32 v140, v196, v136
  v_sub_f32 v141, v197, v136
  v_cvt_pk_bf16_f32 v137, 0, v137
  v_sub_f32 v142, v198, v136
  v_sub_f32 v143, v199, v136
  v_mfma_f32_32x32x16_bf16 v[56:71], v[108:111], a[212:215], v[56:71]
  v_add_f32 v137, 0x3727c5ac, v137
  v_sub_f32 v144, v200, v136
  v_sub_f32 v145, v201, v136
  v_cvt_pk_bf16_f32 v137, 0, v137
  v_sub_f32 v146, v202, v136
  v_sub_f32 v147, v203, v136
  s_waitcnt lgkmcnt(1)
  v_mfma_f32_32x32x16_bf16 v[40:55], v[112:115], a[224:227], v[40:55]
  v_sqrt_f32 v137, v137
  v_cvt_pk_bf16_f32 v140, 0, v140
  v_cvt_pk_bf16_f32 v141, 0, v141
  v_cvt_pk_bf16_f32 v137, 0, v137
  v_cvt_pk_bf16_f32 v142, 0, v142
  v_mfma_f32_32x32x16_bf16 v[56:71], v[112:115], a[228:231], v[56:71]
  v_cvt_pk_bf16_f32 v143, 0, v143
  v_rcp_f32 v137, v137
  v_cvt_pk_bf16_f32 v144, 0, v144
  v_cvt_pk_bf16_f32 v145, 0, v145
  v_cvt_pk_bf16_f32 v146, 0, v146
  s_waitcnt lgkmcnt(0)
  v_mfma_f32_32x32x16_bf16 v[40:55], v[116:119], a[240:243], v[40:55]
  v_cvt_pk_bf16_f32 v147, 0, v147
  v_mul_f32 v140, v140, v137
  v_mul_f32 v141, v141, v137
  v_mul_f32 v142, v142, v137
  v_mul_f32 v143, v143, v137
  v_mul_f32 v144, v144, v137
  v_mfma_f32_32x32x16_bf16 v[56:71], v[116:119], a[244:247], v[56:71]
  v_mul_f32 v145, v145, v137
  v_mul_f32 v146, v146, v137
  v_mul_f32 v147, v147, v137
  v_cvt_pk_bf16_f32 v132, v140, v141
  v_cvt_pk_bf16_f32 v133, v142, v143
  v_cvt_pk_bf16_f32 v134, v144, v145
  v_mfma_f32_32x32x16_bf16 v[72:87], v[104:107], a[200:203], v[72:87]
  v_cvt_pk_bf16_f32 v135, v146, v147
  buffer_store_dwordx4 v[132:135], v0, s[4:7], s93 offen sc1
  v_cvt_pk_bf16_f32 v188, 0, v188
  v_ashrrev_i32 v189, 31, v188
  v_mfma_f32_32x32x16_bf16 v[88:103], v[104:107], a[204:207], v[88:103]
  v_or_b32 v189, 0x80000000, v189
  v_xor_b32 v188, v188, v189
  s_sub_u32 s92, 4095, s90
  v_and_b32 v188, 0xffff0000, v188
  v_or_b32 v38, s92, v188
  v_mfma_f32_32x32x16_bf16 v[72:87], v[108:111], a[216:219], v[72:87]
  s_bfe_u32 s92, s65, 196625
  s_lshl_b32 s92, s92, 18
  s_lshl_b32 s93, s90, 7
  s_add_u32 s92, s92, s93
  s_add_u32 s84, s92, 243269632
  v_cvt_pk_bf16_f32 v212, v40, v56
  v_mfma_f32_32x32x16_bf16 v[88:103], v[108:111], a[220:223], v[88:103]
  v_cvt_pk_bf16_f32 v214, v41, v57
  v_cvt_pk_bf16_f32 v216, v42, v58
  v_cvt_pk_bf16_f32 v218, v43, v59
  v_permlane16_swap_b32 v212, v214
  v_mfma_f32_32x32x16_bf16 v[72:87], v[112:115], a[232:235], v[72:87]
  v_cvt_pk_bf16_f32 v220, v44, v60
  v_cvt_pk_bf16_f32 v222, v45, v61
  v_permlane16_swap_b32 v216, v218
  v_bfi_b32 v212, v254, s42, v212
  v_cvt_pk_bf16_f32 v224, v46, v62
  v_mfma_f32_32x32x16_bf16 v[88:103], v[112:115], a[236:239], v[88:103]
  v_cvt_pk_bf16_f32 v226, v47, v63
  v_permlane16_swap_b32 v220, v222
  v_bfi_b32 v216, v254, s42, v216
  v_cvt_pk_bf16_f32 v228, v48, v64
  v_mfma_f32_32x32x16_bf16 v[72:87], v[116:119], a[248:251], v[72:87]
  v_cvt_pk_bf16_f32 v230, v49, v65
  v_permlane16_swap_b32 v224, v226
  v_bfi_b32 v220, v254, s42, v220
  v_cvt_pk_bf16_f32 v232, v50, v66
  v_cvt_pk_bf16_f32 v234, v51, v67
  v_mfma_f32_32x32x16_bf16 v[88:103], v[116:119], a[252:255], v[88:103]
  v_permlane16_swap_b32 v228, v230
  v_bfi_b32 v224, v254, s42, v224
  v_cvt_pk_bf16_f32 v236, v52, v68
  v_cvt_pk_bf16_f32 v238, v53, v69
  v_permlane16_swap_b32 v232, v234
  v_bfi_b32 v228, v254, s42, v228
  v_cvt_pk_bf16_f32 v240, v54, v70
  v_cvt_pk_bf16_f32 v242, v55, v71
  v_permlane16_swap_b32 v236, v238
  v_bfi_b32 v232, v254, s42, v232
  v_permlane16_swap_b32 v240, v242
  v_bfi_b32 v236, v254, s42, v236
  v_bfi_b32 v240, v254, s42, v240
  v_cvt_pk_bf16_f32 v213, v72, v88
  v_cvt_pk_bf16_f32 v215, v73, v89
  v_cvt_pk_bf16_f32 v217, v74, v90
  v_cvt_pk_bf16_f32 v219, v75, v91
  s_add_u32 s78, s86, 0
  v_permlane16_swap_b32 v213, v215
  buffer_store_dwordx4 v[212:215], v4, s[4:7], s78 offen
  v_cvt_pk_bf16_f32 v221, v76, v92
  v_cvt_pk_bf16_f32 v223, v77, v93
  s_add_u32 s78, s86, 32768
  v_permlane16_swap_b32 v217, v219
  buffer_store_dwordx4 v[216:219], v4, s[4:7], s78 offen
  v_cvt_pk_bf16_f32 v225, v78, v94
  v_cvt_pk_bf16_f32 v227, v79, v95
  s_add_u32 s78, s86, 131072
  v_permlane16_swap_b32 v221, v223
  buffer_store_dwordx4 v[220:223], v4, s[4:7], s78 offen
  v_cvt_pk_bf16_f32 v229, v80, v96
  v_cvt_pk_bf16_f32 v231, v81, v97
  s_add_u32 s78, s86, 163840
  v_permlane16_swap_b32 v225, v227
  buffer_store_dwordx4 v[224:227], v4, s[4:7], s78 offen
  v_cvt_pk_bf16_f32 v233, v82, v98
  v_cvt_pk_bf16_f32 v235, v83, v99
  s_add_u32 s78, s86, 262144
  v_permlane16_swap_b32 v229, v231
  buffer_store_dwordx4 v[228:231], v4, s[4:7], s78 offen
  v_cvt_pk_bf16_f32 v237, v84, v100
  v_cvt_pk_bf16_f32 v239, v85, v101
  s_add_u32 s78, s86, 294912
  v_permlane16_swap_b32 v233, v235
  buffer_store_dwordx4 v[232:235], v4, s[4:7], s78 offen
  v_cvt_pk_bf16_f32 v241, v86, v102
  v_cvt_pk_bf16_f32 v243, v87, v103
  s_add_u32 s78, s86, 393216
  v_permlane16_swap_b32 v237, v239
  buffer_store_dwordx4 v[236:239], v4, s[4:7], s78 offen
  s_add_u32 s78, s86, 425984
  v_permlane16_swap_b32 v241, v243
  buffer_store_dwordx4 v[240:243], v4, s[4:7], s78 offen
  s_waitcnt vmcnt(8)
  s_mov_b64 exec, 1
  buffer_store_dword v38, off, s[4:7], s84 sc1
  s_mov_b64 exec, -1
  s_mov_b32 s84, 268435456
  s_branch o_we_145
o_rt_153:
  s_mov_b32 s67, 0
o_rl_157:
  s_lshl_b32 s94, s43, 14
  s_add_u32 s94, s94, s95
  buffer_load_dwordx4 v[120:123], v5, s[4:7], s94 offen offset:0 sc1
  buffer_load_dwordx4 v[124:127], v5, s[4:7], s94 offen offset:512 sc1
  buffer_load_dwordx4 v[128:131], v5, s[4:7], s94 offen offset:256 sc1
  buffer_load_dwordx4 v[132:135], v5, s[4:7], s94 offen offset:768 sc1
  s_add_u32 s94, s94, 4096
  buffer_load_dwordx4 v[136:139], v5, s[4:7], s94 offen offset:0 sc1
  buffer_load_dwordx4 v[140:143], v5, s[4:7], s94 offen offset:512 sc1
  buffer_load_dwordx4 v[144:147], v5, s[4:7], s94 offen offset:256 sc1
  buffer_load_dwordx4 v[148:151], v5, s[4:7], s94 offen offset:768 sc1
  s_add_u32 s94, s94, 4096
  buffer_load_dwordx4 v[152:155], v5, s[4:7], s94 offen offset:0 sc1
  buffer_load_dwordx4 v[156:159], v5, s[4:7], s94 offen offset:512 sc1
  buffer_load_dwordx4 v[160:163], v5, s[4:7], s94 offen offset:256 sc1
  buffer_load_dwordx4 v[164:167], v5, s[4:7], s94 offen offset:768 sc1
  s_add_u32 s94, s94, 4096
  buffer_load_dwordx4 v[168:171], v5, s[4:7], s94 offen offset:0 sc1
  buffer_load_dwordx4 v[172:175], v5, s[4:7], s94 offen offset:512 sc1
  buffer_load_dwordx4 v[176:179], v5, s[4:7], s94 offen offset:256 sc1
  buffer_load_dwordx4 v[180:183], v5, s[4:7], s94 offen offset:768 sc1
  s_add_u32 s67, s67, 1
  s_cmp_gt_u32 s67, 1048576
  s_cbranch_scc1 L_end
  s_waitcnt vmcnt(0)
  v_xor_b32 v7, s96, v120
  v_bitop3_b32 v7, v7, v124, s96 bitop3:0xf6
  v_bitop3_b32 v7, v7, v128, s96 bitop3:0xf6
  v_bitop3_b32 v7, v7, v132, s96 bitop3:0xf6
  v_bitop3_b32 v7, v7, v136, s96 bitop3:0xf6
  v_bitop3_b32 v7, v7, v140, s96 bitop3:0xf6
  v_bitop3_b32 v7, v7, v144, s96 bitop3:0xf6
  v_bitop3_b32 v7, v7, v148, s96 bitop3:0xf6
  v_bitop3_b32 v7, v7, v152, s96 bitop3:0xf6
  v_bitop3_b32 v7, v7, v156, s96 bitop3:0xf6
  v_bitop3_b32 v7, v7, v160, s96 bitop3:0xf6
  v_bitop3_b32 v7, v7, v164, s96 bitop3:0xf6
  v_bitop3_b32 v7, v7, v168, s96 bitop3:0xf6
  v_bitop3_b32 v7, v7, v172, s96 bitop3:0xf6
  v_bitop3_b32 v7, v7, v176, s96 bitop3:0xf6
  v_bitop3_b32 v7, v7, v180, s96 bitop3:0xf6
  v_and_b32 v7, v254, v7
  v_cmp_ne_u32 vcc, 0, v7
  s_cbranch_vccnz o_rl_157
  s_branch o_bk_154
o_rt_155:
  s_mov_b32 s67, 0
o_rl_158:
  s_lshl_b32 s94, s43, 14
  s_add_u32 s94, s94, s95
  buffer_load_dwordx4 v[120:123], v5, s[4:7], s94 offen offset:0 sc1
  buffer_load_dwordx4 v[124:127], v5, s[4:7], s94 offen offset:512 sc1
  buffer_load_dwordx4 v[128:131], v5, s[4:7], s94 offen offset:256 sc1
  buffer_load_dwordx4 v[132:135], v5, s[4:7], s94 offen offset:768 sc1
  s_add_u32 s94, s94, 4096
  buffer_load_dwordx4 v[136:139], v5, s[4:7], s94 offen offset:0 sc1
  buffer_load_dwordx4 v[140:143], v5, s[4:7], s94 offen offset:512 sc1
  buffer_load_dwordx4 v[144:147], v5, s[4:7], s94 offen offset:256 sc1
  buffer_load_dwordx4 v[148:151], v5, s[4:7], s94 offen offset:768 sc1
  s_add_u32 s94, s94, 4096
  buffer_load_dwordx4 v[152:155], v5, s[4:7], s94 offen offset:0 sc1
  buffer_load_dwordx4 v[156:159], v5, s[4:7], s94 offen offset:512 sc1
  buffer_load_dwordx4 v[160:163], v5, s[4:7], s94 offen offset:256 sc1
  buffer_load_dwordx4 v[164:167], v5, s[4:7], s94 offen offset:768 sc1
  s_add_u32 s94, s94, 4096
  buffer_load_dwordx4 v[168:171], v5, s[4:7], s94 offen offset:0 sc1
  buffer_load_dwordx4 v[172:175], v5, s[4:7], s94 offen offset:512 sc1
  buffer_load_dwordx4 v[176:179], v5, s[4:7], s94 offen offset:256 sc1
  buffer_load_dwordx4 v[180:183], v5, s[4:7], s94 offen offset:768 sc1
  s_add_u32 s67, s67, 1
  s_cmp_gt_u32 s67, 1048576
  s_cbranch_scc1 L_end
  s_waitcnt vmcnt(0)
  v_xor_b32 v7, s96, v120
  v_bitop3_b32 v7, v7, v124, s96 bitop3:0xf6
  v_bitop3_b32 v7, v7, v128, s96 bitop3:0xf6
  v_bitop3_b32 v7, v7, v132, s96 bitop3:0xf6
  v_bitop3_b32 v7, v7, v136, s96 bitop3:0xf6
  v_bitop3_b32 v7, v7, v140, s96 bitop3:0xf6
  v_bitop3_b32 v7, v7, v144, s96 bitop3:0xf6
  v_bitop3_b32 v7, v7, v148, s96 bitop3:0xf6
  v_bitop3_b32 v7, v7, v152, s96 bitop3:0xf6
  v_bitop3_b32 v7, v7, v156, s96 bitop3:0xf6
  v_bitop3_b32 v7, v7, v160, s96 bitop3:0xf6
  v_bitop3_b32 v7, v7, v164, s96 bitop3:0xf6
  v_bitop3_b32 v7, v7, v168, s96 bitop3:0xf6
  v_bitop3_b32 v7, v7, v172, s96 bitop3:0xf6
  v_bitop3_b32 v7, v7, v176, s96 bitop3:0xf6
  v_bitop3_b32 v7, v7, v180, s96 bitop3:0xf6
  v_and_b32 v7, v254, v7
  v_cmp_ne_u32 vcc, 0, v7
  s_cbranch_vccnz o_rl_158
  s_branch o_bk_156
o_fb_147:
  v_mov_b32 v118, v116
  s_nop 1
  v_permlane16_swap_b32 v116, v118
  v_max_f32 v116, v116, v118
  v_mov_b32 v118, v116
  s_nop 0
  s_nop 0
  v_permlane32_swap_b32 v116, v118
  v_max_f32 v116, v116, v118
  v_sub_f32 v56, v104, v116
  v_sub_f32 v57, v105, v116
  v_sub_f32 v58, v106, v116
  v_sub_f32 v59, v107, v116
  v_sub_f32 v60, v108, v116
  v_sub_f32 v61, v109, v116
  v_sub_f32 v62, v110, v116
  v_sub_f32 v63, v111, v116
  v_sub_f32 v64, v112, v116
  v_sub_f32 v65, v113, v116
  v_exp_f32 v56, v56
  v_exp_f32 v57, v57
  v_exp_f32 v58, v58
  v_exp_f32 v59, v59
  v_exp_f32 v60, v60
  v_exp_f32 v61, v61
  v_exp_f32 v62, v62
  v_exp_f32 v63, v63
  v_exp_f32 v64, v64
  v_exp_f32 v65, v65
  v_add_f32 v117, v56, v57
  v_add_f32 v117, v117, v58
  v_add_f32 v117, v117, v59
  v_add_f32 v117, v117, v60
  v_add_f32 v117, v117, v61
  v_add_f32 v117, v117, v62
  v_add_f32 v117, v117, v63
  v_add_f32 v117, v117, v64
  v_add_f32 v117, v117, v65
  v_mov_b32 v118, v117
  s_nop 0
  s_nop 0
  v_permlane16_swap_b32 v117, v118
  v_add_f32 v117, v117, v118
  v_mov_b32 v118, v117
  s_nop 0
  s_nop 0
  v_permlane32_swap_b32 v117, v118
  v_add_f32 v117, v117, v118
  v_rcp_f32 v117, v117
  s_branch o_fbr_148
o_fb_149:
  v_mov_b32 v118, v116
  s_nop 1
  v_permlane16_swap_b32 v116, v118
  v_max_f32 v116, v116, v118
  v_mov_b32 v118, v116
  s_nop 0
  s_nop 0
  v_permlane32_swap_b32 v116, v118
  v_max_f32 v116, v116, v118
  v_sub_f32 v56, v104, v116
  v_sub_f32 v57, v105, v116
  v_sub_f32 v58, v106, v116
  v_sub_f32 v59, v107, v116
  v_sub_f32 v60, v108, v116
  v_sub_f32 v61, v109, v116
  v_sub_f32 v62, v110, v116
  v_sub_f32 v63, v111, v116
  v_sub_f32 v64, v112, v116
  v_sub_f32 v65, v113, v116
  v_exp_f32 v56, v56
  v_exp_f32 v57, v57
  v_exp_f32 v58, v58
  v_exp_f32 v59, v59
  v_exp_f32 v60, v60
  v_exp_f32 v61, v61
  v_exp_f32 v62, v62
  v_exp_f32 v63, v63
  v_exp_f32 v64, v64
  v_exp_f32 v65, v65
  v_add_f32 v117, v56, v57
  v_add_f32 v117, v117, v58
  v_add_f32 v117, v117, v59
  v_add_f32 v117, v117, v60
  v_add_f32 v117, v117, v61
  v_add_f32 v117, v117, v62
  v_add_f32 v117, v117, v63
  v_add_f32 v117, v117, v64
  v_add_f32 v117, v117, v65
  v_mov_b32 v118, v117
  s_nop 0
  s_nop 0
  v_permlane16_swap_b32 v117, v118
  v_add_f32 v117, v117, v118
  v_mov_b32 v118, v117
  s_nop 0
  s_nop 0
  v_permlane32_swap_b32 v117, v118
  v_add_f32 v117, v117, v118
  v_rcp_f32 v117, v117
  s_branch o_fbr_150
o_wr2_144:
  s_waitcnt lgkmcnt(0)
  s_barrier
  ds_read_b128 v[104:107], v3 offset:0
  ds_read_b128 v[108:111], v3 offset:512
  ds_read_b128 v[112:115], v3 offset:1024
  buffer_load_dwordx4 v[176:179], v5, s[4:7], s94 offen offset:256 sc1
  buffer_load_dwordx4 v[180:183], v5, s[4:7], s94 offen offset:768 sc1
  s_waitcnt lgkmcnt(2)
  v_mfma_f32_32x32x16_bf16 v[40:55], v[104:107], a[0:3], 0
  v_mov_b64 v[188:189], 0
  v_mov_b64 v[190:191], 0
  v_mov_b64 v[192:193], 0
  v_mov_b64 v[194:195], 0
  s_mov_b64 exec, 1
  buffer_store_dword v38, off, s[4:7], s84 sc1
  s_mov_b64 exec, -1
  s_mov_b32 s84, 268435456
  v_mfma_f32_32x32x16_bf16 v[56:71], v[104:107], a[4:7], 0
  ds_read_b128 v[116:119], v3 offset:1536
  v_mfma_f32_32x32x16_bf16 v[72:87], v[104:107], a[8:11], 0
  v_mfma_f32_32x32x16_bf16 v[88:103], v[104:107], a[12:15], 0
  s_waitcnt vmcnt(13)
  v_xor_b32 v7, s96, v120
  v_bitop3_b32 v7, v7, v124, s96 bitop3:0xf6
  v_bitop3_b32 v7, v7, v128, s96 bitop3:0xf6
  v_bitop3_b32 v7, v7, v132, s96 bitop3:0xf6
  s_waitcnt lgkmcnt(2)
  v_mfma_f32_32x32x16_bf16 v[40:55], v[108:111], a[16:19], v[40:55]
  s_waitcnt vmcnt(9)
  v_bitop3_b32 v7, v7, v136, s96 bitop3:0xf6
  v_bitop3_b32 v7, v7, v140, s96 bitop3:0xf6
  v_bitop3_b32 v7, v7, v144, s96 bitop3:0xf6
  v_bitop3_b32 v7, v7, v148, s96 bitop3:0xf6
  s_waitcnt vmcnt(5)
  v_mfma_f32_32x32x16_bf16 v[56:71], v[108:111], a[20:23], v[56:71]
  ds_read_b128 v[104:107], v3 offset:2048
  v_bitop3_b32 v7, v7, v152, s96 bitop3:0xf6
  v_bitop3_b32 v7, v7, v156, s96 bitop3:0xf6
  v_bitop3_b32 v7, v7, v160, s96 bitop3:0xf6
  v_bitop3_b32 v7, v7, v164, s96 bitop3:0xf6
  s_waitcnt vmcnt(1)
  v_mfma_f32_32x32x16_bf16 v[72:87], v[108:111], a[24:27], v[72:87]
  v_bitop3_b32 v7, v7, v168, s96 bitop3:0xf6
  v_bitop3_b32 v7, v7, v172, s96 bitop3:0xf6
  v_bitop3_b32 v7, v7, v176, s96 bitop3:0xf6
  v_bitop3_b32 v7, v7, v180, s96 bitop3:0xf6
  v_and_b32 v7, v254, v7
  v_cmp_ne_u32 vcc, 0, v7
  s_cbranch_vccnz o_rt_155
o_bk_156:
  v_mfma_f32_32x32x16_bf16 v[88:103], v[108:111], a[28:31], v[88:103]
  v_smfmac_f32_16x16x64_bf16 v[188:191], v[16:19], v[120:127], v20
  v_lshlrev_b32 v196, 16, v184
  v_smfmac_f32_16x16x64_bf16 v[192:195], v[16:19], v[128:135], v20
  v_and_b32 v197, 0xffff0000, v184
  v_smfmac_f32_16x16x64_bf16 v[188:191], v[16:19], v[136:143], v20
  v_lshlrev_b32 v198, 16, v185
  s_waitcnt lgkmcnt(2)
  v_mfma_f32_32x32x16_bf16 v[40:55], v[112:115], a[32:35], v[40:55]
  v_smfmac_f32_16x16x64_bf16 v[192:195], v[16:19], v[144:151], v20
  v_and_b32 v199, 0xffff0000, v185
  v_smfmac_f32_16x16x64_bf16 v[188:191], v[16:19], v[152:159], v20
  v_lshlrev_b32 v200, 16, v186
  v_smfmac_f32_16x16x64_bf16 v[192:195], v[16:19], v[160:167], v20
  v_and_b32 v201, 0xffff0000, v186
  v_mfma_f32_32x32x16_bf16 v[56:71], v[112:115], a[36:39], v[56:71]
  ds_read_b128 v[108:111], v3 offset:2560
  v_smfmac_f32_16x16x64_bf16 v[188:191], v[16:19], v[168:175], v20
  v_lshlrev_b32 v202, 16, v187
  v_smfmac_f32_16x16x64_bf16 v[192:195], v[16:19], v[176:183], v20
  v_and_b32 v203, 0xffff0000, v187
  s_bfe_u32 s92, s65, 131086
  v_mfma_f32_32x32x16_bf16 v[72:87], v[112:115], a[40:43], v[72:87]
  s_lshl_b32 s92, s92, 21
  s_add_u32 s92, s92, s91
  s_add_u32 s93, s92, 27262976
  s_add_u32 s92, s92, 20971520
  v_permlane16_swap_b32 v188, v192
  v_mfma_f32_32x32x16_bf16 v[88:103], v[112:115], a[44:47], v[88:103]
  v_permlane16_swap_b32 v189, v193
  v_permlane16_swap_b32 v190, v194
  v_permlane16_swap_b32 v191, v195
  s_waitcnt lgkmcnt(2)
  v_mfma_f32_32x32x16_bf16 v[40:55], v[116:119], a[48:51], v[40:55]
  v_cvt_pk_bf16_f32 v188, 0, v188
  v_cvt_pk_bf16_f32 v189, 0, v189
  v_cvt_pk_bf16_f32 v190, 0, v190
  v_cvt_pk_bf16_f32 v191, 0, v191
  v_cvt_pk_bf16_f32 v192, 0, v192
  v_cvt_pk_bf16_f32 v193, 0, v193
  v_mfma_f32_32x32x16_bf16 v[56:71], v[116:119], a[52:55], v[56:71]
  ds_read_b128 v[112:115], v3 offset:3072
  v_cvt_pk_bf16_f32 v194, 0, v194
  v_cvt_pk_bf16_f32 v195, 0, v195
  v_add_f32 v196, v196, v188
  v_add_f32 v197, v197, v189
  v_add_f32 v198, v198, v190
  v_mfma_f32_32x32x16_bf16 v[72:87], v[116:119], a[56:59], v[72:87]
  v_add_f32 v199, v199, v191
  v_add_f32 v200, v200, v192
  v_add_f32 v201, v201, v193
  v_add_f32 v202, v202, v194
  v_add_f32 v203, v203, v195
  v_cvt_pk_bf16_f32 v120, v196, v197
  v_mfma_f32_32x32x16_bf16 v[88:103], v[116:119], a[60:63], v[88:103]
  v_cvt_pk_bf16_f32 v121, v198, v199
  v_cvt_pk_bf16_f32 v122, v200, v201
  v_cvt_pk_bf16_f32 v123, v202, v203
  v_lshlrev_b32 v196, 16, v120
  v_and_b32 v197, 0xffff0000, v120
  s_waitcnt lgkmcnt(2)
  v_mfma_f32_32x32x16_bf16 v[40:55], v[104:107], a[64:67], v[40:55]
  v_lshlrev_b32 v198, 16, v121
  v_and_b32 v199, 0xffff0000, v121
  v_lshlrev_b32 v200, 16, v122
  v_and_b32 v201, 0xffff0000, v122
  v_lshlrev_b32 v202, 16, v123
  v_and_b32 v203, 0xffff0000, v123
  v_mfma_f32_32x32x16_bf16 v[56:71], v[104:107], a[68:71], v[56:71]
  ds_read_b128 v[116:119], v3 offset:3584
  buffer_store_dwordx4 v[120:123], v0, s[4:7], s92 offen sc1
  v_add_f32 v136, v196, v197
  v_mul_f32 v137, v196, v196
  v_mfma_f32_32x32x16_bf16 v[72:87], v[104:107], a[72:75], v[72:87]
  v_add_f32 v138, v198, v199
  v_mul_f32 v139, v197, v197
  v_fmac_f32 v137, v198, v198
  v_fmac_f32 v139, v199, v199
  v_add_f32 v136, v136, v200
  v_fmac_f32 v137, v200, v200
  v_mfma_f32_32x32x16_bf16 v[88:103], v[104:107], a[76:79], v[88:103]
  v_add_f32 v138, v138, v201
  v_fmac_f32 v139, v201, v201
  v_add_f32 v136, v136, v202
  v_fmac_f32 v137, v202, v202
  v_add_f32 v138, v138, v203
  s_waitcnt lgkmcnt(2)
  v_mfma_f32_32x32x16_bf16 v[40:55], v[108:111], a[80:83], v[40:55]
  v_fmac_f32 v139, v203, v203
  v_add_f32 v136, v136, v138
  v_add_f32 v137, v137, v139
  s_nop 0
  v_add_f32_dpp v136, v136, v136 row_ror:8 row_mask:0xf bank_mask:0xf
  v_add_f32_dpp v137, v137, v137 row_ror:8 row_mask:0xf bank_mask:0xf
  s_nop 0
  v_add_f32_dpp v136, v136, v136 row_ror:4 row_mask:0xf bank_mask:0xf
  v_mfma_f32_32x32x16_bf16 v[56:71], v[108:111], a[84:87], v[56:71]
  ds_read_b128 v[104:107], v3 offset:8192
  v_add_f32_dpp v137, v137, v137 row_ror:4 row_mask:0xf bank_mask:0xf
  v_add_f32_dpp v136, v136, v136 row_ror:2 row_mask:0xf bank_mask:0xf
  s_nop 0
  v_add_f32_dpp v137, v137, v137 row_ror:2 row_mask:0xf bank_mask:0xf
  v_add_f32_dpp v136, v136, v136 row_ror:1 row_mask:0xf bank_mask:0xf
  s_nop 0
  v_add_f32_dpp v137, v137, v137 row_ror:1 row_mask:0xf bank_mask:0xf
  v_mfma_f32_32x32x16_bf16 v[72:87], v[108:111], a[88:91], v[72:87]
  v_mov_b32 v140, v136
  v_mov_b32 v141, v137
  s_nop 0
  v_permlane16_swap_b32 v136, v140
  v_permlane16_swap_b32 v137, v141
  v_mfma_f32_32x32x16_bf16 v[88:103], v[108:111], a[92:95], v[88:103]
  v_add_f32 v136, v136, v140
  v_add_f32 v137, v137, v141
  v_mov_b32 v140, v136
  v_mov_b32 v141, v137
  s_nop 0
  v_permlane32_swap_b32 v136, v140
  s_waitcnt lgkmcnt(2)
  v_mfma_f32_32x32x16_bf16 v[40:55], v[112:115], a[96:99], v[40:55]
  v_permlane32_swap_b32 v137, v141
  v_add_f32 v136, v136, v140
  v_add_f32 v137, v137, v141
  v_mul_f32 v136, 0x3b000000, v136
  v_mul_f32 v137, 0x3b000000, v137
  v_mfma_f32_32x32x16_bf16 v[56:71], v[112:115], a[100:103], v[56:71]
  ds_read_b128 v[108:111], v3 offset:8704
  v_fma_f32 v137, -v136, v136, v137
  v_cvt_pk_bf16_f32 v136, 0, v136
  v_max_f32 v137, 0, v137
  v_sub_f32 v140, v196, v136
  v_sub_f32 v141, v197, v136
  v_mfma_f32_32x32x16_bf16 v[72:87], v[112:115], a[104:107], v[72:87]
  v_cvt_pk_bf16_f32 v137, 0, v137
  v_sub_f32 v142, v198, v136
  v_sub_f32 v143, v199, v136
  v_add_f32 v137, 0x3727c5ac, v137
  v_sub_f32 v144, v200, v136
  v_sub_f32 v145, v201, v136
  v_mfma_f32_32x32x16_bf16 v[88:103], v[112:115], a[108:111], v[88:103]
  v_cvt_pk_bf16_f32 v137, 0, v137
  v_sub_f32 v146, v202, v136
  v_sub_f32 v147, v203, v136
  v_sqrt_f32 v137, v137
  s_waitcnt lgkmcnt(2)
  v_mfma_f32_32x32x16_bf16 v[40:55], v[116:119], a[112:115], v[40:55]
  v_cvt_pk_bf16_f32 v140, 0, v140
  v_cvt_pk_bf16_f32 v141, 0, v141
  v_cvt_pk_bf16_f32 v137, 0, v137
  v_cvt_pk_bf16_f32 v142, 0, v142
  v_cvt_pk_bf16_f32 v143, 0, v143
  v_rcp_f32 v137, v137
  v_mfma_f32_32x32x16_bf16 v[56:71], v[116:119], a[116:119], v[56:71]
  ds_read_b128 v[112:115], v3 offset:9216
  v_cvt_pk_bf16_f32 v144, 0, v144
  v_cvt_pk_bf16_f32 v145, 0, v145
  v_cvt_pk_bf16_f32 v146, 0, v146
  v_cvt_pk_bf16_f32 v147, 0, v147
  v_mul_f32 v140, v140, v137
  v_mfma_f32_32x32x16_bf16 v[72:87], v[116:119], a[120:123], v[72:87]
  v_mul_f32 v141, v141, v137
  v_mul_f32 v142, v142, v137
  v_mul_f32 v143, v143, v137
  v_mul_f32 v144, v144, v137
  v_mul_f32 v145, v145, v137
  v_mul_f32 v146, v146, v137
  v_mfma_f32_32x32x16_bf16 v[88:103], v[116:119], a[124:127], v[88:103]
  v_mul_f32 v147, v147, v137
  v_cvt_pk_bf16_f32 v124, v140, v141
  v_cvt_pk_bf16_f32 v125, v142, v143
  v_cvt_pk_bf16_f32 v126, v144, v145
  v_cvt_pk_bf16_f32 v127, v146, v147
  s_waitcnt lgkmcnt(2)
  v_mfma_f32_32x32x16_bf16 v[40:55], v[104:107], a[128:131], v[40:55]
  v_lshlrev_b32 v204, 16, v124
  v_and_b32 v205, 0xffff0000, v124
  v_lshlrev_b32 v206, 16, v125
  v_and_b32 v207, 0xffff0000, v125
  v_lshlrev_b32 v208, 16, v126
  v_and_b32 v209, 0xffff0000, v126
  v_mfma_f32_32x32x16_bf16 v[56:71], v[104:107], a[132:135], v[56:71]
  ds_read_b128 v[116:119], v3 offset:9728
  v_lshlrev_b32 v210, 16, v127
  v_and_b32 v211, 0xffff0000, v127
  buffer_store_dwordx4 v[124:127], v0, s[4:7], s93 offen sc1
  v_mfma_f32_32x32x16_bf16 v[72:87], v[104:107], a[136:139], v[72:87]
  v_add_f32 v196, v196, v204
  v_add_f32 v197, v197, v205
  v_add_f32 v198, v198, v206
  v_add_f32 v199, v199, v207
  v_add_f32 v200, v200, v208
  v_add_f32 v201, v201, v209
  v_mfma_f32_32x32x16_bf16 v[88:103], v[104:107], a[140:143], v[88:103]
  v_add_f32 v202, v202, v210
  v_add_f32 v203, v203, v211
  v_cvt_pk_bf16_f32 v128, v196, v197
  v_cvt_pk_bf16_f32 v129, v198, v199
  v_cvt_pk_bf16_f32 v130, v200, v201
  s_waitcnt lgkmcnt(2)
  v_mfma_f32_32x32x16_bf16 v[40:55], v[108:111], a[144:147], v[40:55]
  v_cvt_pk_bf16_f32 v131, v202, v203
  v_mul_f32 v188, v204, v8
  v_mul_f32 v189, v205, v9
  v_fmac_f32 v188, v206, v10
  v_fmac_f32 v189, v207, v11
  v_fmac_f32 v188, v208, v12
  v_mfma_f32_32x32x16_bf16 v[56:71], v[108:111], a[148:151], v[56:71]
  ds_read_b128 v[104:107], v3 offset:10240
  v_fmac_f32 v189, v209, v13
  v_fmac_f32 v188, v210, v14
  v_fmac_f32 v189, v211, v15
  v_add_f32 v188, v188, v189
  buffer_store_dwordx4 v[128:131], v0, s[68:71], s91 offen sc1
  v_mfma_f32_32x32x16_bf16 v[72:87], v[108:111], a[152:155], v[72:87]
  v_add_f32_dpp v188, v188, v188 row_ror:8 row_mask:0xf bank_mask:0xf
  s_nop 1
  v_add_f32_dpp v188, v188, v188 row_ror:4 row_mask:0xf bank_mask:0xf
  s_nop 1
  v_add_f32_dpp v188, v188, v188 row_ror:2 row_mask:0xf bank_mask:0xf
  s_nop 1
  v_add_f32_dpp v188, v188, v188 row_ror:1 row_mask:0xf bank_mask:0xf
  v_mov_b32 v189, v188
  s_nop 0
  s_nop 0
  v_permlane16_swap_b32 v188, v189
  v_mfma_f32_32x32x16_bf16 v[88:103], v[108:111], a[156:159], v[88:103]
  v_add_f32 v188, v188, v189
  v_mov_b32 v189, v188
  s_nop 0
  s_nop 0
  v_permlane32_swap_b32 v188, v189
  v_add_f32 v188, v188, v189
  s_waitcnt lgkmcnt(2)
  v_mfma_f32_32x32x16_bf16 v[40:55], v[112:115], a[160:163], v[40:55]
  v_cvt_pk_bf16_f32 v188, 0, v188
  v_ashrrev_i32 v189, 31, v188
  v_or_b32 v189, 0x80000000, v189
  v_xor_b32 v188, v188, v189
  s_sub_u32 s92, 4095, s90
  v_and_b32 v188, 0xffff0000, v188
  v_mfma_f32_32x32x16_bf16 v[56:71], v[112:115], a[164:167], v[56:71]
  ds_read_b128 v[108:111], v3 offset:10752
  v_or_b32 v38, s92, v188
  s_bfe_u32 s92, s65, 196625
  s_lshl_b32 s92, s92, 18
  s_lshl_b32 s93, s90, 7
  s_add_u32 s92, s92, s93
  v_mfma_f32_32x32x16_bf16 v[72:87], v[112:115], a[168:171], v[72:87]
  s_add_u32 s84, s92, 243269632
  v_mfma_f32_32x32x16_bf16 v[88:103], v[112:115], a[172:175], v[88:103]
  s_waitcnt lgkmcnt(2)
  v_mfma_f32_32x32x16_bf16 v[40:55], v[116:119], a[176:179], v[40:55]
  v_mfma_f32_32x32x16_bf16 v[56:71], v[116:119], a[180:183], v[56:71]
  ds_read_b128 v[112:115], v3 offset:11264
  v_mfma_f32_32x32x16_bf16 v[72:87], v[116:119], a[184:187], v[72:87]
  v_mfma_f32_32x32x16_bf16 v[88:103], v[116:119], a[188:191], v[88:103]
  s_waitcnt lgkmcnt(2)
  v_mfma_f32_32x32x16_bf16 v[40:55], v[104:107], a[192:195], v[40:55]
  v_mfma_f32_32x32x16_bf16 v[56:71], v[104:107], a[196:199], v[56:71]
  ds_read_b128 v[116:119], v3 offset:11776
  s_waitcnt lgkmcnt(2)
  v_mfma_f32_32x32x16_bf16 v[40:55], v[108:111], a[208:211], v[40:55]
  v_mfma_f32_32x32x16_bf16 v[56:71], v[108:111], a[212:215], v[56:71]
  s_waitcnt lgkmcnt(1)
  v_mfma_f32_32x32x16_bf16 v[40:55], v[112:115], a[224:227], v[40:55]
  v_mfma_f32_32x32x16_bf16 v[56:71], v[112:115], a[228:231], v[56:71]
  s_waitcnt lgkmcnt(0)
  v_mfma_f32_32x32x16_bf16 v[40:55], v[116:119], a[240:243], v[40:55]
  v_mfma_f32_32x32x16_bf16 v[56:71], v[116:119], a[244:247], v[56:71]
  v_mfma_f32_32x32x16_bf16 v[72:87], v[104:107], a[200:203], v[72:87]
  v_mfma_f32_32x32x16_bf16 v[88:103], v[104:107], a[204:207], v[88:103]
  v_cvt_pk_bf16_f32 v212, v40, v56
  v_cvt_pk_bf16_f32 v214, v41, v57
  v_cvt_pk_bf16_f32 v216, v42, v58
  v_cvt_pk_bf16_f32 v218, v43, v59
  v_permlane16_swap_b32 v212, v214
  v_mfma_f32_32x32x16_bf16 v[72:87], v[108:111], a[216:219], v[72:87]
  v_cvt_pk_bf16_f32 v220, v44, v60
  v_cvt_pk_bf16_f32 v222, v45, v61
  v_permlane16_swap_b32 v216, v218
  v_bfi_b32 v212, v254, s42, v212
  v_cvt_pk_bf16_f32 v224, v46, v62
  v_mfma_f32_32x32x16_bf16 v[88:103], v[108:111], a[220:223], v[88:103]
  v_cvt_pk_bf16_f32 v226, v47, v63
  v_permlane16_swap_b32 v220, v222
  v_bfi_b32 v216, v254, s42, v216
  v_cvt_pk_bf16_f32 v228, v48, v64
  v_mfma_f32_32x32x16_bf16 v[72:87], v[112:115], a[232:235], v[72:87]
  v_cvt_pk_bf16_f32 v230, v49, v65
  v_permlane16_swap_b32 v224, v226
  v_bfi_b32 v220, v254, s42, v220
  v_cvt_pk_bf16_f32 v232, v50, v66
  v_cvt_pk_bf16_f32 v234, v51, v67
  v_mfma_f32_32x32x16_bf16 v[88:103], v[112:115], a[236:239], v[88:103]
  v_permlane16_swap_b32 v228, v230
  v_bfi_b32 v224, v254, s42, v224
  v_cvt_pk_bf16_f32 v236, v52, v68
  v_cvt_pk_bf16_f32 v238, v53, v69
  v_mfma_f32_32x32x16_bf16 v[72:87], v[116:119], a[248:251], v[72:87]
  v_permlane16_swap_b32 v232, v234
  v_bfi_b32 v228, v254, s42, v228
  v_cvt_pk_bf16_f32 v240, v54, v70
  v_cvt_pk_bf16_f32 v242, v55, v71
  v_permlane16_swap_b32 v236, v238
  v_mfma_f32_32x32x16_bf16 v[88:103], v[116:119], a[252:255], v[88:103]
  v_bfi_b32 v232, v254, s42, v232
  v_permlane16_swap_b32 v240, v242
  v_bfi_b32 v236, v254, s42, v236
  v_bfi_b32 v240, v254, s42, v240
  s_nop 7
  v_cvt_pk_bf16_f32 v213, v72, v88
  v_cvt_pk_bf16_f32 v215, v73, v89
  v_cvt_pk_bf16_f32 v217, v74, v90
  v_cvt_pk_bf16_f32 v219, v75, v91
  s_add_u32 s78, s86, 0
  v_permlane16_swap_b32 v213, v215
  buffer_store_dwordx4 v[212:215], v4, s[4:7], s78 offen
  v_cvt_pk_bf16_f32 v221, v76, v92
  v_cvt_pk_bf16_f32 v223, v77, v93
  s_add_u32 s78, s86, 32768
  v_permlane16_swap_b32 v217, v219
  buffer_store_dwordx4 v[216:219], v4, s[4:7], s78 offen
  v_cvt_pk_bf16_f32 v225, v78, v94
  v_cvt_pk_bf16_f32 v227, v79, v95
  s_add_u32 s78, s86, 131072
  v_permlane16_swap_b32 v221, v223
  buffer_store_dwordx4 v[220:223], v4, s[4:7], s78 offen
  v_cvt_pk_bf16_f32 v229, v80, v96
  v_cvt_pk_bf16_f32 v231, v81, v97
  s_add_u32 s78, s86, 163840
  v_permlane16_swap_b32 v225, v227
  buffer_store_dwordx4 v[224:227], v4, s[4:7], s78 offen
  v_cvt_pk_bf16_f32 v233, v82, v98
  v_cvt_pk_bf16_f32 v235, v83, v99
  s_add_u32 s78, s86, 262144
  v_permlane16_swap_b32 v229, v231
  buffer_store_dwordx4 v[228:231], v4, s[4:7], s78 offen
  v_cvt_pk_bf16_f32 v237, v84, v100
  v_cvt_pk_bf16_f32 v239, v85, v101
  s_add_u32 s78, s86, 294912
  v_permlane16_swap_b32 v233, v235
  buffer_store_dwordx4 v[232:235], v4, s[4:7], s78 offen
  v_cvt_pk_bf16_f32 v241, v86, v102
  v_cvt_pk_bf16_f32 v243, v87, v103
  s_add_u32 s78, s86, 393216
  v_permlane16_swap_b32 v237, v239
  buffer_store_dwordx4 v[236:239], v4, s[4:7], s78 offen
  s_add_u32 s78, s86, 425984
  v_permlane16_swap_b32 v241, v243
  buffer_store_dwordx4 v[240:243], v4, s[4:7], s78 offen
o_we_145:
  v_and_b32 v37, -32, v39
  s_waitcnt lgkmcnt(0)
  s_barrier
  ds_read_b128 v[104:107], v37 offset:16
  s_mov_b32 s65, s63
  s_waitcnt lgkmcnt(0)
  v_and_b32 v104, v104, v106
  v_max_u32 v105, v105, v107
  v_readfirstlane_b32 s26, v104
  v_readfirstlane_b32 s3, v105
  s_and_b32 s66, s26, 1
  s_and_b32 s76, s26, 2
  s_bitcmp1_b32 s26, 2
  s_cselect_b32 s3, s3, 0
  s_cmp_lg_u32 s76, 0
  s_cbranch_scc1 o_nofl_119
  s_and_b32 s26, s63, 49152
  s_cbranch_scc0 o_fl_120
  s_and_b32 s26, s64, s50
  s_cbranch_scc1 o_nofl_119
o_fl_120:
  s_cmp_ge_u32 s17, 2
  s_cbranch_scc1 o_fd_159
  s_cmp_eq_u32 s65, 0
  s_cbranch_scc1 o_fd_159
  s_mov_b32 s96, s42
  s_waitcnt vmcnt(0)
  s_mov_b64 exec, 1
  buffer_store_dword v38, off, s[4:7], s84 sc1
  s_mov_b64 exec, -1
  s_mov_b32 s84, 268435456
  s_lshl_b32 s97, s43, 14
  s_add_u32 s97, s97, s86
  buffer_load_dword v7, v255, s[4:7], s97 offen sc1
  s_and_b32 s91, s65, 63
  s_lshl_b32 s90, s91, 5
  s_add_u32 s94, s90, s85
  s_add_u32 s90, s90, s43
  s_lshl_b32 s94, s94, 10
  s_lshr_b32 s92, s65, 22
  s_xor_b32 s93, s43, 32
  s_lshl_b32 s91, s90, 10
  s_add_u32 s94, s94, 25165824
  s_cmp_eq_u32 s92, s93
  s_cselect_b32 s92, s94, s91
  s_add_u32 s92, s92, 10485760
  s_and_b32 s93, s65, 49152
  s_cselect_b32 s92, s92, s91
  s_cselect_b64 s[80:81], s[4:5], s[72:73]
  s_cselect_b32 s82, s6, s74
  buffer_load_dwordx4 v[184:187], v0, s[80:83], s92 offen sc1
  s_mov_b32 s67, 0
  s_mov_b64 vcc, 0
  s_waitcnt vmcnt(1)
o_pl_161:
  v_and_b32 v7, 1, v7
  v_cmp_ne_u32 vcc, s96, v7
  s_cbranch_vccz o_pk_162
  buffer_load_dword v7, v255, s[4:7], s97 offen sc1
  s_add_u32 s67, s67, 1
  s_cmp_gt_u32 s67, 1048576
  s_cbranch_scc1 L_end
  s_waitcnt vmcnt(0)
  s_branch o_pl_161
o_pk_162:
  s_and_b32 s26, s65, 49152
  s_cbranch_scc1 o_f2_160
  s_lshl_b32 s94, s43, 14
  s_add_u32 s94, s94, s86
  buffer_load_dwordx4 v[120:123], v5, s[4:7], s94 offen offset:0 sc1
  buffer_load_dwordx4 v[124:127], v5, s[4:7], s94 offen offset:512 sc1
  buffer_load_dwordx4 v[128:131], v5, s[4:7], s94 offen offset:256 sc1
  buffer_load_dwordx4 v[132:135], v5, s[4:7], s94 offen offset:768 sc1
  s_add_u32 s94, s94, 4096
  buffer_load_dwordx4 v[136:139], v5, s[4:7], s94 offen offset:0 sc1
  buffer_load_dwordx4 v[140:143], v5, s[4:7], s94 offen offset:512 sc1
  buffer_load_dwordx4 v[144:147], v5, s[4:7], s94 offen offset:256 sc1
  buffer_load_dwordx4 v[148:151], v5, s[4:7], s94 offen offset:768 sc1
  s_add_u32 s94, s94, 4096
  buffer_load_dwordx4 v[152:155], v5, s[4:7], s94 offen offset:0 sc1
  buffer_load_dwordx4 v[156:159], v5, s[4:7], s94 offen offset:512 sc1
  buffer_load_dwordx4 v[160:163], v5, s[4:7], s94 offen offset:256 sc1
  buffer_load_dwordx4 v[164:167], v5, s[4:7], s94 offen offset:768 sc1
  s_add_u32 s94, s94, 4096
  buffer_load_dwordx4 v[168:171], v5, s[4:7], s94 offen offset:0 sc1
  buffer_load_dwordx4 v[172:175], v5, s[4:7], s94 offen offset:512 sc1
  buffer_load_dwordx4 v[176:179], v5, s[4:7], s94 offen offset:256 sc1
  buffer_load_dwordx4 v[180:183], v5, s[4:7], s94 offen offset:768 sc1
  v_mov_b64 v[188:189], 0
  v_mov_b64 v[190:191], 0
  v_mov_b64 v[192:193], 0
  v_mov_b64 v[194:195], 0
  s_waitcnt vmcnt(12)
  v_xor_b32 v7, s96, v120
  v_bitop3_b32 v7, v7, v124, s96 bitop3:0xf6
  v_bitop3_b32 v7, v7, v128, s96 bitop3:0xf6
  v_bitop3_b32 v7, v7, v132, s96 bitop3:0xf6
  s_waitcnt vmcnt(8)
  v_bitop3_b32 v7, v7, v136, s96 bitop3:0xf6
  v_bitop3_b32 v7, v7, v140, s96 bitop3:0xf6
  v_bitop3_b32 v7, v7, v144, s96 bitop3:0xf6
  v_bitop3_b32 v7, v7, v148, s96 bitop3:0xf6
  s_waitcnt vmcnt(4)
  v_bitop3_b32 v7, v7, v152, s96 bitop3:0xf6
  v_bitop3_b32 v7, v7, v156, s96 bitop3:0xf6
  v_bitop3_b32 v7, v7, v160, s96 bitop3:0xf6
  v_bitop3_b32 v7, v7, v164, s96 bitop3:0xf6
  s_waitcnt vmcnt(0)
  v_bitop3_b32 v7, v7, v168, s96 bitop3:0xf6
  v_bitop3_b32 v7, v7, v172, s96 bitop3:0xf6
  v_bitop3_b32 v7, v7, v176, s96 bitop3:0xf6
  v_bitop3_b32 v7, v7, v180, s96 bitop3:0xf6
  v_and_b32 v7, v254, v7
  v_cmp_ne_u32 vcc, 0, v7
  s_cbranch_vccnz o_rt_163
o_bk_164:
  v_smfmac_f32_16x16x64_bf16 v[188:191], v[16:19], v[120:127], v20
  v_lshlrev_b32 v196, 16, v184
  v_smfmac_f32_16x16x64_bf16 v[192:195], v[16:19], v[128:135], v20
  v_and_b32 v197, 0xffff0000, v184
  v_smfmac_f32_16x16x64_bf16 v[188:191], v[16:19], v[136:143], v20
  v_lshlrev_b32 v198, 16, v185
  v_smfmac_f32_16x16x64_bf16 v[192:195], v[16:19], v[144:151], v20
  v_and_b32 v199, 0xffff0000, v185
  v_smfmac_f32_16x16x64_bf16 v[188:191], v[16:19], v[152:159], v20
  v_lshlrev_b32 v200, 16, v186
  v_smfmac_f32_16x16x64_bf16 v[192:195], v[16:19], v[160:167], v20
  v_and_b32 v201, 0xffff0000, v186
  v_smfmac_f32_16x16x64_bf16 v[188:191], v[16:19], v[168:175], v20
  v_lshlrev_b32 v202, 16, v187
  v_smfmac_f32_16x16x64_bf16 v[192:195], v[16:19], v[176:183], v20
  v_and_b32 v203, 0xffff0000, v187
  s_bfe_u32 s92, s65, 131086
  s_lshl_b32 s92, s92, 21
  s_add_u32 s92, s92, s91
  s_add_u32 s93, s92, 27262976
  s_add_u32 s92, s92, 20971520
  s_nop 1
  v_permlane16_swap_b32 v188, v192
  v_permlane16_swap_b32 v189, v193
  v_permlane16_swap_b32 v190, v194
  v_permlane16_swap_b32 v191, v195
  v_cvt_pk_bf16_f32 v188, 0, v188
  v_cvt_pk_bf16_f32 v189, 0, v189
  v_cvt_pk_bf16_f32 v190, 0, v190
  v_cvt_pk_bf16_f32 v191, 0, v191
  v_cvt_pk_bf16_f32 v192, 0, v192
  v_cvt_pk_bf16_f32 v193, 0, v193
  v_cvt_pk_bf16_f32 v194, 0, v194
  v_cvt_pk_bf16_f32 v195, 0, v195
  v_add_f32 v196, v196, v188
  v_add_f32 v197, v197, v189
  v_add_f32 v198, v198, v190
  v_add_f32 v199, v199, v191
  v_add_f32 v200, v200, v192
  v_add_f32 v201, v201, v193
  v_add_f32 v202, v202, v194
  v_add_f32 v203, v203, v195
  v_cvt_pk_bf16_f32 v120, v196, v197
  v_cvt_pk_bf16_f32 v121, v198, v199
  v_cvt_pk_bf16_f32 v122, v200, v201
  v_cvt_pk_bf16_f32 v123, v202, v203
  v_lshlrev_b32 v196, 16, v120
  v_and_b32 v197, 0xffff0000, v120
  v_lshlrev_b32 v198, 16, v121
  v_and_b32 v199, 0xffff0000, v121
  v_lshlrev_b32 v200, 16, v122
  v_and_b32 v201, 0xffff0000, v122
  v_lshlrev_b32 v202, 16, v123
  v_and_b32 v203, 0xffff0000, v123
  buffer_store_dwordx4 v[120:123], v0, s[4:7], s92 offen sc1
  v_add_f32 v136, v196, v197
  v_mul_f32 v137, v196, v196
  v_add_f32 v138, v198, v199
  v_mul_f32 v139, v197, v197
  v_fmac_f32 v137, v198, v198
  v_fmac_f32 v139, v199, v199
  v_add_f32 v136, v136, v200
  v_fmac_f32 v137, v200, v200
  v_add_f32 v138, v138, v201
  v_fmac_f32 v139, v201, v201
  v_add_f32 v136, v136, v202
  v_fmac_f32 v137, v202, v202
  v_add_f32 v138, v138, v203
  v_fmac_f32 v139, v203, v203
  v_add_f32 v136, v136, v138
  v_add_f32 v137, v137, v139
  s_nop 0
  v_add_f32_dpp v136, v136, v136 row_ror:8 row_mask:0xf bank_mask:0xf
  v_add_f32_dpp v137, v137, v137 row_ror:8 row_mask:0xf bank_mask:0xf
  s_nop 0
  v_add_f32_dpp v136, v136, v136 row_ror:4 row_mask:0xf bank_mask:0xf
  v_add_f32_dpp v137, v137, v137 row_ror:4 row_mask:0xf bank_mask:0xf
  s_nop 0
  v_add_f32_dpp v136, v136, v136 row_ror:2 row_mask:0xf bank_mask:0xf
  v_add_f32_dpp v137, v137, v137 row_ror:2 row_mask:0xf bank_mask:0xf
  s_nop 0
  v_add_f32_dpp v136, v136, v136 row_ror:1 row_mask:0xf bank_mask:0xf
  v_add_f32_dpp v137, v137, v137 row_ror:1 row_mask:0xf bank_mask:0xf
  v_mov_b32 v140, v136
  v_mov_b32 v141, v137
  s_nop 0
  v_permlane16_swap_b32 v136, v140
  v_permlane16_swap_b32 v137, v141
  v_add_f32 v136, v136, v140
  v_add_f32 v137, v137, v141
  v_mov_b32 v140, v136
  v_mov_b32 v141, v137
  s_nop 0
  v_permlane32_swap_b32 v136, v140
  v_permlane32_swap_b32 v137, v141
  v_add_f32 v136, v136, v140
  v_add_f32 v137, v137, v141
  v_mul_f32 v136, 0x3b000000, v136
  v_mul_f32 v137, 0x3b000000, v137
  v_fma_f32 v137, -v136, v136, v137
  v_cvt_pk_bf16_f32 v136, 0, v136
  v_max_f32 v137, 0, v137
  v_sub_f32 v140, v196, v136
  v_sub_f32 v141, v197, v136
  v_cvt_pk_bf16_f32 v137, 0, v137
  v_sub_f32 v142, v198, v136
  v_sub_f32 v143, v199, v136
  v_add_f32 v137, 0x3727c5ac, v137
  v_sub_f32 v144, v200, v136
  v_sub_f32 v145, v201, v136
  v_cvt_pk_bf16_f32 v137, 0, v137
  v_sub_f32 v146, v202, v136
  v_sub_f32 v147, v203, v136
  v_sqrt_f32 v137, v137
  v_cvt_pk_bf16_f32 v140, 0, v140
  v_cvt_pk_bf16_f32 v141, 0, v141
  v_cvt_pk_bf16_f32 v137, 0, v137
  v_cvt_pk_bf16_f32 v142, 0, v142
  v_cvt_pk_bf16_f32 v143, 0, v143
  v_rcp_f32 v137, v137
  v_cvt_pk_bf16_f32 v144, 0, v144
  v_cvt_pk_bf16_f32 v145, 0, v145
  v_cvt_pk_bf16_f32 v146, 0, v146
  v_cvt_pk_bf16_f32 v147, 0, v147
  v_mul_f32 v140, v140, v137
  v_mul_f32 v141, v141, v137
  v_mul_f32 v142, v142, v137
  v_mul_f32 v143, v143, v137
  v_mul_f32 v144, v144, v137
  v_mul_f32 v145, v145, v137
  v_mul_f32 v146, v146, v137
  v_mul_f32 v147, v147, v137
  v_cvt_pk_bf16_f32 v124, v140, v141
  v_cvt_pk_bf16_f32 v125, v142, v143
  v_cvt_pk_bf16_f32 v126, v144, v145
  v_cvt_pk_bf16_f32 v127, v146, v147
  v_lshlrev_b32 v204, 16, v124
  v_and_b32 v205, 0xffff0000, v124
  v_lshlrev_b32 v206, 16, v125
  v_and_b32 v207, 0xffff0000, v125
  v_lshlrev_b32 v208, 16, v126
  v_and_b32 v209, 0xffff0000, v126
  v_lshlrev_b32 v210, 16, v127
  v_and_b32 v211, 0xffff0000, v127
  buffer_store_dwordx4 v[124:127], v0, s[4:7], s93 offen sc1
  v_add_f32 v196, v196, v204
  v_add_f32 v197, v197, v205
  v_add_f32 v198, v198, v206
  v_add_f32 v199, v199, v207
  v_add_f32 v200, v200, v208
  v_add_f32 v201, v201, v209
  v_add_f32 v202, v202, v210
  v_add_f32 v203, v203, v211
  v_cvt_pk_bf16_f32 v128, v196, v197
  v_cvt_pk_bf16_f32 v129, v198, v199
  v_cvt_pk_bf16_f32 v130, v200, v201
  v_cvt_pk_bf16_f32 v131, v202, v203
  v_mul_f32 v188, v204, v8
  v_mul_f32 v189, v205, v9
  v_fmac_f32 v188, v206, v10
  v_fmac_f32 v189, v207, v11
  v_fmac_f32 v188, v208, v12
  v_fmac_f32 v189, v209, v13
  v_fmac_f32 v188, v210, v14
  v_fmac_f32 v189, v211, v15
  v_add_f32 v188, v188, v189
  s_add_u32 s92, s91, 10485760
  s_add_u32 s93, s91, 8388608
  buffer_store_dwordx4 v[128:131], v0, s[4:7], s92 offen sc1
  v_lshlrev_b32 v196, 16, v128
  v_and_b32 v197, 0xffff0000, v128
  v_lshlrev_b32 v198, 16, v129
  v_and_b32 v199, 0xffff0000, v129
  v_lshlrev_b32 v200, 16, v130
  v_and_b32 v201, 0xffff0000, v130
  v_lshlrev_b32 v202, 16, v131
  v_and_b32 v203, 0xffff0000, v131
  v_add_f32 v136, v196, v197
  v_mul_f32 v137, v196, v196
  v_add_f32 v138, v198, v199
  v_mul_f32 v139, v197, v197
  v_fmac_f32 v137, v198, v198
  v_fmac_f32 v139, v199, v199
  v_add_f32 v136, v136, v200
  v_fmac_f32 v137, v200, v200
  v_add_f32 v138, v138, v201
  v_fmac_f32 v139, v201, v201
  v_add_f32 v136, v136, v202
  v_fmac_f32 v137, v202, v202
  v_add_f32 v138, v138, v203
  v_fmac_f32 v139, v203, v203
  v_add_f32 v136, v136, v138
  v_add_f32 v137, v137, v139
  s_nop 0
  v_add_f32_dpp v136, v136, v136 row_ror:8 row_mask:0xf bank_mask:0xf
  v_add_f32_dpp v137, v137, v137 row_ror:8 row_mask:0xf bank_mask:0xf
  v_add_f32_dpp v188, v188, v188 row_ror:8 row_mask:0xf bank_mask:0xf
  v_add_f32_dpp v136, v136, v136 row_ror:4 row_mask:0xf bank_mask:0xf
  v_add_f32_dpp v137, v137, v137 row_ror:4 row_mask:0xf bank_mask:0xf
  v_add_f32_dpp v188, v188, v188 row_ror:4 row_mask:0xf bank_mask:0xf
  v_add_f32_dpp v136, v136, v136 row_ror:2 row_mask:0xf bank_mask:0xf
  v_add_f32_dpp v137, v137, v137 row_ror:2 row_mask:0xf bank_mask:0xf
  v_add_f32_dpp v188, v188, v188 row_ror:2 row_mask:0xf bank_mask:0xf
  v_add_f32_dpp v136, v136, v136 row_ror:1 row_mask:0xf bank_mask:0xf
  v_add_f32_dpp v137, v137, v137 row_ror:1 row_mask:0xf bank_mask:0xf
  v_add_f32_dpp v188, v188, v188 row_ror:1 row_mask:0xf bank_mask:0xf
  v_mov_b32 v140, v136
  v_mov_b32 v141, v137
  v_mov_b32 v142, v188
  v_permlane16_swap_b32 v136, v140
  v_permlane16_swap_b32 v137, v141
  v_permlane16_swap_b32 v188, v142
  v_add_f32 v136, v136, v140
  v_add_f32 v137, v137, v141
  v_add_f32 v188, v188, v142
  v_mov_b32 v140, v136
  v_mov_b32 v141, v137
  v_mov_b32 v142, v188
  v_permlane32_swap_b32 v136, v140
  v_permlane32_swap_b32 v137, v141
  v_permlane32_swap_b32 v188, v142
  v_add_f32 v136, v136, v140
  v_add_f32 v137, v137, v141
  v_add_f32 v188, v188, v142
  v_mul_f32 v136, 0x3b000000, v136
  v_mul_f32 v137, 0x3b000000, v137
  v_fma_f32 v137, -v136, v136, v137
  v_cvt_pk_bf16_f32 v136, 0, v136
  v_max_f32 v137, 0, v137
  v_sub_f32 v140, v196, v136
  v_sub_f32 v141, v197, v136
  v_cvt_pk_bf16_f32 v137, 0, v137
  v_sub_f32 v142, v198, v136
  v_sub_f32 v143, v199, v136
  v_add_f32 v137, 0x3727c5ac, v137
  v_sub_f32 v144, v200, v136
  v_sub_f32 v145, v201, v136
  v_cvt_pk_bf16_f32 v137, 0, v137
  v_sub_f32 v146, v202, v136
  v_sub_f32 v147, v203, v136
  v_sqrt_f32 v137, v137
  v_cvt_pk_bf16_f32 v140, 0, v140
  v_cvt_pk_bf16_f32 v141, 0, v141
  v_cvt_pk_bf16_f32 v137, 0, v137
  v_cvt_pk_bf16_f32 v142, 0, v142
  v_cvt_pk_bf16_f32 v143, 0, v143
  v_rcp_f32 v137, v137
  v_cvt_pk_bf16_f32 v144, 0, v144
  v_cvt_pk_bf16_f32 v145, 0, v145
  v_cvt_pk_bf16_f32 v146, 0, v146
  v_cvt_pk_bf16_f32 v147, 0, v147
  v_mul_f32 v140, v140, v137
  v_mul_f32 v141, v141, v137
  v_mul_f32 v142, v142, v137
  v_mul_f32 v143, v143, v137
  v_mul_f32 v144, v144, v137
  v_mul_f32 v145, v145, v137
  v_mul_f32 v146, v146, v137
  v_mul_f32 v147, v147, v137
  v_cvt_pk_bf16_f32 v132, v140, v141
  v_cvt_pk_bf16_f32 v133, v142, v143
  v_cvt_pk_bf16_f32 v134, v144, v145
  v_cvt_pk_bf16_f32 v135, v146, v147
  buffer_store_dwordx4 v[132:135], v0, s[4:7], s93 offen sc1
  v_cvt_pk_bf16_f32 v188, 0, v188
  v_ashrrev_i32 v189, 31, v188
  v_or_b32 v189, 0x80000000, v189
  v_xor_b32 v188, v188, v189
  s_sub_u32 s92, 4095, s90
  v_and_b32 v188, 0xffff0000, v188
  v_or_b32 v38, s92, v188
  s_bfe_u32 s92, s65, 196625
  s_lshl_b32 s92, s92, 18
  s_lshl_b32 s93, s90, 7
  s_add_u32 s92, s92, s93
  s_add_u32 s84, s92, 243269632
  s_waitcnt vmcnt(0)
  s_mov_b64 exec, 1
  buffer_store_dword v38, off, s[4:7], s84 sc1
  s_mov_b64 exec, -1
  s_mov_b32 s84, 268435456
  s_branch o_fd_159
o_rt_163:
  s_mov_b32 s67, 0
o_rl_165:
  s_lshl_b32 s94, s43, 14
  s_add_u32 s94, s94, s86
  buffer_load_dwordx4 v[120:123], v5, s[4:7], s94 offen offset:0 sc1
  buffer_load_dwordx4 v[124:127], v5, s[4:7], s94 offen offset:512 sc1
  buffer_load_dwordx4 v[128:131], v5, s[4:7], s94 offen offset:256 sc1
  buffer_load_dwordx4 v[132:135], v5, s[4:7], s94 offen offset:768 sc1
  s_add_u32 s94, s94, 4096
  buffer_load_dwordx4 v[136:139], v5, s[4:7], s94 offen offset:0 sc1
  buffer_load_dwordx4 v[140:143], v5, s[4:7], s94 offen offset:512 sc1
  buffer_load_dwordx4 v[144:147], v5, s[4:7], s94 offen offset:256 sc1
  buffer_load_dwordx4 v[148:151], v5, s[4:7], s94 offen offset:768 sc1
  s_add_u32 s94, s94, 4096
  buffer_load_dwordx4 v[152:155], v5, s[4:7], s94 offen offset:0 sc1
  buffer_load_dwordx4 v[156:159], v5, s[4:7], s94 offen offset:512 sc1
  buffer_load_dwordx4 v[160:163], v5, s[4:7], s94 offen offset:256 sc1
  buffer_load_dwordx4 v[164:167], v5, s[4:7], s94 offen offset:768 sc1
  s_add_u32 s94, s94, 4096
  buffer_load_dwordx4 v[168:171], v5, s[4:7], s94 offen offset:0 sc1
  buffer_load_dwordx4 v[172:175], v5, s[4:7], s94 offen offset:512 sc1
  buffer_load_dwordx4 v[176:179], v5, s[4:7], s94 offen offset:256 sc1
  buffer_load_dwordx4 v[180:183], v5, s[4:7], s94 offen offset:768 sc1
  s_add_u32 s67, s67, 1
  s_cmp_gt_u32 s67, 1048576
  s_cbranch_scc1 L_end
  s_waitcnt vmcnt(0)
  v_xor_b32 v7, s96, v120
  v_bitop3_b32 v7, v7, v124, s96 bitop3:0xf6
  v_bitop3_b32 v7, v7, v128, s96 bitop3:0xf6
  v_bitop3_b32 v7, v7, v132, s96 bitop3:0xf6
  v_bitop3_b32 v7, v7, v136, s96 bitop3:0xf6
  v_bitop3_b32 v7, v7, v140, s96 bitop3:0xf6
  v_bitop3_b32 v7, v7, v144, s96 bitop3:0xf6
  v_bitop3_b32 v7, v7, v148, s96 bitop3:0xf6
  v_bitop3_b32 v7, v7, v152, s96 bitop3:0xf6
  v_bitop3_b32 v7, v7, v156, s96 bitop3:0xf6
  v_bitop3_b32 v7, v7, v160, s96 bitop3:0xf6
  v_bitop3_b32 v7, v7, v164, s96 bitop3:0xf6
  v_bitop3_b32 v7, v7, v168, s96 bitop3:0xf6
  v_bitop3_b32 v7, v7, v172, s96 bitop3:0xf6
  v_bitop3_b32 v7, v7, v176, s96 bitop3:0xf6
  v_bitop3_b32 v7, v7, v180, s96 bitop3:0xf6
  v_and_b32 v7, v254, v7
  v_cmp_ne_u32 vcc, 0, v7
  s_cbranch_vccnz o_rl_165
  s_branch o_bk_164
o_f2_160:
  s_lshl_b32 s94, s43, 14
  s_add_u32 s94, s94, s86
  buffer_load_dwordx4 v[120:123], v5, s[4:7], s94 offen offset:0 sc1
  buffer_load_dwordx4 v[124:127], v5, s[4:7], s94 offen offset:512 sc1
  buffer_load_dwordx4 v[128:131], v5, s[4:7], s94 offen offset:256 sc1
  buffer_load_dwordx4 v[132:135], v5, s[4:7], s94 offen offset:768 sc1
  s_add_u32 s94, s94, 4096
  buffer_load_dwordx4 v[136:139], v5, s[4:7], s94 offen offset:0 sc1
  buffer_load_dwordx4 v[140:143], v5, s[4:7], s94 offen offset:512 sc1
  buffer_load_dwordx4 v[144:147], v5, s[4:7], s94 offen offset:256 sc1
  buffer_load_dwordx4 v[148:151], v5, s[4:7], s94 offen offset:768 sc1
  s_add_u32 s94, s94, 4096
  buffer_load_dwordx4 v[152:155], v5, s[4:7], s94 offen offset:0 sc1
  buffer_load_dwordx4 v[156:159], v5, s[4:7], s94 offen offset:512 sc1
  buffer_load_dwordx4 v[160:163], v5, s[4:7], s94 offen offset:256 sc1
  buffer_load_dwordx4 v[164:167], v5, s[4:7], s94 offen offset:768 sc1
  s_add_u32 s94, s94, 4096
  buffer_load_dwordx4 v[168:171], v5, s[4:7], s94 offen offset:0 sc1
  buffer_load_dwordx4 v[172:175], v5, s[4:7], s94 offen offset:512 sc1
  buffer_load_dwordx4 v[176:179], v5, s[4:7], s94 offen offset:256 sc1
  buffer_load_dwordx4 v[180:183], v5, s[4:7], s94 offen offset:768 sc1
  v_mov_b64 v[188:189], 0
  v_mov_b64 v[190:191], 0
  v_mov_b64 v[192:193], 0
  v_mov_b64 v[194:195], 0
  s_waitcnt vmcnt(12)
  v_xor_b32 v7, s96, v120
  v_bitop3_b32 v7, v7, v124, s96 bitop3:0xf6
  v_bitop3_b32 v7, v7, v128, s96 bitop3:0xf6
  v_bitop3_b32 v7, v7, v132, s96 bitop3:0xf6
  s_waitcnt vmcnt(8)
  v_bitop3_b32 v7, v7, v136, s96 bitop3:0xf6
  v_bitop3_b32 v7, v7, v140, s96 bitop3:0xf6
  v_bitop3_b32 v7, v7, v144, s96 bitop3:0xf6
  v_bitop3_b32 v7, v7, v148, s96 bitop3:0xf6
  s_waitcnt vmcnt(4)
  v_bitop3_b32 v7, v7, v152, s96 bitop3:0xf6
  v_bitop3_b32 v7, v7, v156, s96 bitop3:0xf6
  v_bitop3_b32 v7, v7, v160, s96 bitop3:0xf6
  v_bitop3_b32 v7, v7, v164, s96 bitop3:0xf6
  s_waitcnt vmcnt(0)
  v_bitop3_b32 v7, v7, v168, s96 bitop3:0xf6
  v_bitop3_b32 v7, v7, v172, s96 bitop3:0xf6
  v_bitop3_b32 v7, v7, v176, s96 bitop3:0xf6
  v_bitop3_b32 v7, v7, v180, s96 bitop3:0xf6
  v_and_b32 v7, v254, v7
  v_cmp_ne_u32 vcc, 0, v7
  s_cbranch_vccnz o_rt_166
o_bk_167:
  v_smfmac_f32_16x16x64_bf16 v[188:191], v[16:19], v[120:127], v20
  v_lshlrev_b32 v196, 16, v184
  v_smfmac_f32_16x16x64_bf16 v[192:195], v[16:19], v[128:135], v20
  v_and_b32 v197, 0xffff0000, v184
  v_smfmac_f32_16x16x64_bf16 v[188:191], v[16:19], v[136:143], v20
  v_lshlrev_b32 v198, 16, v185
  v_smfmac_f32_16x16x64_bf16 v[192:195], v[16:19], v[144:151], v20
  v_and_b32 v199, 0xffff0000, v185
  v_smfmac_f32_16x16x64_bf16 v[188:191], v[16:19], v[152:159], v20
  v_lshlrev_b32 v200, 16, v186
  v_smfmac_f32_16x16x64_bf16 v[192:195], v[16:19], v[160:167], v20
  v_and_b32 v201, 0xffff0000, v186
  v_smfmac_f32_16x16x64_bf16 v[188:191], v[16:19], v[168:175], v20
  v_lshlrev_b32 v202, 16, v187
  v_smfmac_f32_16x16x64_bf16 v[192:195], v[16:19], v[176:183], v20
  v_and_b32 v203, 0xffff0000, v187
  s_bfe_u32 s92, s65, 131086
  s_lshl_b32 s92, s92, 21
  s_add_u32 s92, s92, s91
  s_add_u32 s93, s92, 27262976
  s_add_u32 s92, s92, 20971520
  s_nop 1
  v_permlane16_swap_b32 v188, v192
  v_permlane16_swap_b32 v189, v193
  v_permlane16_swap_b32 v190, v194
  v_permlane16_swap_b32 v191, v195
  v_cvt_pk_bf16_f32 v188, 0, v188
  v_cvt_pk_bf16_f32 v189, 0, v189
  v_cvt_pk_bf16_f32 v190, 0, v190
  v_cvt_pk_bf16_f32 v191, 0, v191
  v_cvt_pk_bf16_f32 v192, 0, v192
  v_cvt_pk_bf16_f32 v193, 0, v193
  v_cvt_pk_bf16_f32 v194, 0, v194
  v_cvt_pk_bf16_f32 v195, 0, v195
  v_add_f32 v196, v196, v188
  v_add_f32 v197, v197, v189
  v_add_f32 v198, v198, v190
  v_add_f32 v199, v199, v191
  v_add_f32 v200, v200, v192
  v_add_f32 v201, v201, v193
  v_add_f32 v202, v202, v194
  v_add_f32 v203, v203, v195
  v_cvt_pk_bf16_f32 v120, v196, v197
  v_cvt_pk_bf16_f32 v121, v198, v199
  v_cvt_pk_bf16_f32 v122, v200, v201
  v_cvt_pk_bf16_f32 v123, v202, v203
  v_lshlrev_b32 v196, 16, v120
  v_and_b32 v197, 0xffff0000, v120
  v_lshlrev_b32 v198, 16, v121
  v_and_b32 v199, 0xffff0000, v121
  v_lshlrev_b32 v200, 16, v122
  v_and_b32 v201, 0xffff0000, v122
  v_lshlrev_b32 v202, 16, v123
  v_and_b32 v203, 0xffff0000, v123
  buffer_store_dwordx4 v[120:123], v0, s[4:7], s92 offen sc1
  v_add_f32 v136, v196, v197
  v_mul_f32 v137, v196, v196
  v_add_f32 v138, v198, v199
  v_mul_f32 v139, v197, v197
  v_fmac_f32 v137, v198, v198
  v_fmac_f32 v139, v199, v199
  v_add_f32 v136, v136, v200
  v_fmac_f32 v137, v200, v200
  v_add_f32 v138, v138, v201
  v_fmac_f32 v139, v201, v201
  v_add_f32 v136, v136, v202
  v_fmac_f32 v137, v202, v202
  v_add_f32 v138, v138, v203
  v_fmac_f32 v139, v203, v203
  v_add_f32 v136, v136, v138
  v_add_f32 v137, v137, v139
  s_nop 0
  v_add_f32_dpp v136, v136, v136 row_ror:8 row_mask:0xf bank_mask:0xf
  v_add_f32_dpp v137, v137, v137 row_ror:8 row_mask:0xf bank_mask:0xf
  s_nop 0
  v_add_f32_dpp v136, v136, v136 row_ror:4 row_mask:0xf bank_mask:0xf
  v_add_f32_dpp v137, v137, v137 row_ror:4 row_mask:0xf bank_mask:0xf
  s_nop 0
  v_add_f32_dpp v136, v136, v136 row_ror:2 row_mask:0xf bank_mask:0xf
  v_add_f32_dpp v137, v137, v137 row_ror:2 row_mask:0xf bank_mask:0xf
  s_nop 0
  v_add_f32_dpp v136, v136, v136 row_ror:1 row_mask:0xf bank_mask:0xf
  v_add_f32_dpp v137, v137, v137 row_ror:1 row_mask:0xf bank_mask:0xf
  v_mov_b32 v140, v136
  v_mov_b32 v141, v137
  s_nop 0
  v_permlane16_swap_b32 v136, v140
  v_permlane16_swap_b32 v137, v141
  v_add_f32 v136, v136, v140
  v_add_f32 v137, v137, v141
  v_mov_b32 v140, v136
  v_mov_b32 v141, v137
  s_nop 0
  v_permlane32_swap_b32 v136, v140
  v_permlane32_swap_b32 v137, v141
  v_add_f32 v136, v136, v140
  v_add_f32 v137, v137, v141
  v_mul_f32 v136, 0x3b000000, v136
  v_mul_f32 v137, 0x3b000000, v137
  v_fma_f32 v137, -v136, v136, v137
  v_cvt_pk_bf16_f32 v136, 0, v136
  v_max_f32 v137, 0, v137
  v_sub_f32 v140, v196, v136
  v_sub_f32 v141, v197, v136
  v_cvt_pk_bf16_f32 v137, 0, v137
  v_sub_f32 v142, v198, v136
  v_sub_f32 v143, v199, v136
  v_add_f32 v137, 0x3727c5ac, v137
  v_sub_f32 v144, v200, v136
  v_sub_f32 v145, v201, v136
  v_cvt_pk_bf16_f32 v137, 0, v137
  v_sub_f32 v146, v202, v136
  v_sub_f32 v147, v203, v136
  v_sqrt_f32 v137, v137
  v_cvt_pk_bf16_f32 v140, 0, v140
  v_cvt_pk_bf16_f32 v141, 0, v141
  v_cvt_pk_bf16_f32 v137, 0, v137
  v_cvt_pk_bf16_f32 v142, 0, v142
  v_cvt_pk_bf16_f32 v143, 0, v143
  v_rcp_f32 v137, v137
  v_cvt_pk_bf16_f32 v144, 0, v144
  v_cvt_pk_bf16_f32 v145, 0, v145
  v_cvt_pk_bf16_f32 v146, 0, v146
  v_cvt_pk_bf16_f32 v147, 0, v147
  v_mul_f32 v140, v140, v137
  v_mul_f32 v141, v141, v137
  v_mul_f32 v142, v142, v137
  v_mul_f32 v143, v143, v137
  v_mul_f32 v144, v144, v137
  v_mul_f32 v145, v145, v137
  v_mul_f32 v146, v146, v137
  v_mul_f32 v147, v147, v137
  v_cvt_pk_bf16_f32 v124, v140, v141
  v_cvt_pk_bf16_f32 v125, v142, v143
  v_cvt_pk_bf16_f32 v126, v144, v145
  v_cvt_pk_bf16_f32 v127, v146, v147
  v_lshlrev_b32 v204, 16, v124
  v_and_b32 v205, 0xffff0000, v124
  v_lshlrev_b32 v206, 16, v125
  v_and_b32 v207, 0xffff0000, v125
  v_lshlrev_b32 v208, 16, v126
  v_and_b32 v209, 0xffff0000, v126
  v_lshlrev_b32 v210, 16, v127
  v_and_b32 v211, 0xffff0000, v127
  buffer_store_dwordx4 v[124:127], v0, s[4:7], s93 offen sc1
  v_add_f32 v196, v196, v204
  v_add_f32 v197, v197, v205
  v_add_f32 v198, v198, v206
  v_add_f32 v199, v199, v207
  v_add_f32 v200, v200, v208
  v_add_f32 v201, v201, v209
  v_add_f32 v202, v202, v210
  v_add_f32 v203, v203, v211
  v_cvt_pk_bf16_f32 v128, v196, v197
  v_cvt_pk_bf16_f32 v129, v198, v199
  v_cvt_pk_bf16_f32 v130, v200, v201
  v_cvt_pk_bf16_f32 v131, v202, v203
  v_mul_f32 v188, v204, v8
  v_mul_f32 v189, v205, v9
  v_fmac_f32 v188, v206, v10
  v_fmac_f32 v189, v207, v11
  v_fmac_f32 v188, v208, v12
  v_fmac_f32 v189, v209, v13
  v_fmac_f32 v188, v210, v14
  v_fmac_f32 v189, v211, v15
  v_add_f32 v188, v188, v189
  buffer_store_dwordx4 v[128:131], v0, s[68:71], s91 offen sc1
  s_nop 0
  v_add_f32_dpp v188, v188, v188 row_ror:8 row_mask:0xf bank_mask:0xf
  s_nop 1
  v_add_f32_dpp v188, v188, v188 row_ror:4 row_mask:0xf bank_mask:0xf
  s_nop 1
  v_add_f32_dpp v188, v188, v188 row_ror:2 row_mask:0xf bank_mask:0xf
  s_nop 1
  v_add_f32_dpp v188, v188, v188 row_ror:1 row_mask:0xf bank_mask:0xf
  v_mov_b32 v189, v188
  s_nop 0
  s_nop 0
  v_permlane16_swap_b32 v188, v189
  v_add_f32 v188, v188, v189
  v_mov_b32 v189, v188
  s_nop 0
  s_nop 0
  v_permlane32_swap_b32 v188, v189
  v_add_f32 v188, v188, v189
  v_cvt_pk_bf16_f32 v188, 0, v188
  v_ashrrev_i32 v189, 31, v188
  v_or_b32 v189, 0x80000000, v189
  v_xor_b32 v188, v188, v189
  s_sub_u32 s92, 4095, s90
  v_and_b32 v188, 0xffff0000, v188
  v_or_b32 v38, s92, v188
  s_bfe_u32 s92, s65, 196625
  s_lshl_b32 s92, s92, 18
  s_lshl_b32 s93, s90, 7
  s_add_u32 s92, s92, s93
  s_add_u32 s84, s92, 243269632
  s_waitcnt vmcnt(0)
  s_mov_b64 exec, 1
  buffer_store_dword v38, off, s[4:7], s84 sc1
  s_mov_b64 exec, -1
  s_mov_b32 s84, 268435456
  s_branch o_fd_159
o_rt_166:
  s_mov_b32 s67, 0
o_rl_168:
  s_lshl_b32 s94, s43, 14
  s_add_u32 s94, s94, s86
  buffer_load_dwordx4 v[120:123], v5, s[4:7], s94 offen offset:0 sc1
  buffer_load_dwordx4 v[124:127], v5, s[4:7], s94 offen offset:512 sc1
  buffer_load_dwordx4 v[128:131], v5, s[4:7], s94 offen offset:256 sc1
  buffer_load_dwordx4 v[132:135], v5, s[4:7], s94 offen offset:768 sc1
  s_add_u32 s94, s94, 4096
  buffer_load_dwordx4 v[136:139], v5, s[4:7], s94 offen offset:0 sc1
  buffer_load_dwordx4 v[140:143], v5, s[4:7], s94 offen offset:512 sc1
  buffer_load_dwordx4 v[144:147], v5, s[4:7], s94 offen offset:256 sc1
  buffer_load_dwordx4 v[148:151], v5, s[4:7], s94 offen offset:768 sc1
  s_add_u32 s94, s94, 4096
  buffer_load_dwordx4 v[152:155], v5, s[4:7], s94 offen offset:0 sc1
  buffer_load_dwordx4 v[156:159], v5, s[4:7], s94 offen offset:512 sc1
  buffer_load_dwordx4 v[160:163], v5, s[4:7], s94 offen offset:256 sc1
  buffer_load_dwordx4 v[164:167], v5, s[4:7], s94 offen offset:768 sc1
  s_add_u32 s94, s94, 4096
  buffer_load_dwordx4 v[168:171], v5, s[4:7], s94 offen offset:0 sc1
  buffer_load_dwordx4 v[172:175], v5, s[4:7], s94 offen offset:512 sc1
  buffer_load_dwordx4 v[176:179], v5, s[4:7], s94 offen offset:256 sc1
  buffer_load_dwordx4 v[180:183], v5, s[4:7], s94 offen offset:768 sc1
  s_add_u32 s67, s67, 1
  s_cmp_gt_u32 s67, 1048576
  s_cbranch_scc1 L_end
  s_waitcnt vmcnt(0)
  v_xor_b32 v7, s96, v120
  v_bitop3_b32 v7, v7, v124, s96 bitop3:0xf6
  v_bitop3_b32 v7, v7, v128, s96 bitop3:0xf6
  v_bitop3_b32 v7, v7, v132, s96 bitop3:0xf6
  v_bitop3_b32 v7, v7, v136, s96 bitop3:0xf6
  v_bitop3_b32 v7, v7, v140, s96 bitop3:0xf6
  v_bitop3_b32 v7, v7, v144, s96 bitop3:0xf6
  v_bitop3_b32 v7, v7, v148, s96 bitop3:0xf6
  v_bitop3_b32 v7, v7, v152, s96 bitop3:0xf6
  v_bitop3_b32 v7, v7, v156, s96 bitop3:0xf6
  v_bitop3_b32 v7, v7, v160, s96 bitop3:0xf6
  v_bitop3_b32 v7, v7, v164, s96 bitop3:0xf6
  v_bitop3_b32 v7, v7, v168, s96 bitop3:0xf6
  v_bitop3_b32 v7, v7, v172, s96 bitop3:0xf6
  v_bitop3_b32 v7, v7, v176, s96 bitop3:0xf6
  v_bitop3_b32 v7, v7, v180, s96 bitop3:0xf6
  v_and_b32 v7, v254, v7
  v_cmp_ne_u32 vcc, 0, v7
  s_cbranch_vccnz o_rl_168
  s_branch o_bk_167
o_fd_159:
  s_mov_b32 s65, 0
o_nofl_119:
  s_mov_b32 s63, s64
  s_cmp_lg_u32 s51, 0
  s_cbranch_scc1 o_pick_121
  s_cmp_eq_u32 s50, 0
  s_cbranch_scc1 L_end
o_adv_127:
  s_add_u32 s49, s49, 4
  s_branch o_round_117
o_dl_129:
  s_and_b32 s26, s55, s54
  s_andn2_b32 s27, s56, s54
  s_or_b32 s26, s26, s27
  s_andn2_b32 s26, s58, s26
  s_bcnt1_i32_b32 s27, s26
  s_add_u32 s27, s27, 0
  s_mul_i32 s27, s27, 86
  s_lshr_b32 s27, s27, 8
o_dl1_130:
  s_cbranch_scc0 o_dl2_131
  s_ff1_i32_b32 s28, s26
  s_bitset0_b32 s26, s28
  s_bitset0_b32 s58, s28
  s_sub_u32 s27, s27, 1
  s_cmp_lg_u32 s27, 0
  s_branch o_dl1_130
o_dl2_131:
  s_xor_b32 s26, s58, 0x8000ffff
  s_lshl_b32 s27, s60, 7
  s_add_u32 s27, s27, 243269696
  s_cmp_lg_u32 s43, 0
  s_cbranch_scc1 o_pick_121
  v_mov_b32 v162, s26
  v_mov_b32 v163, s46
  s_mov_b64 exec, 1
  buffer_store_dwordx2 v[162:163], off, s[4:7], s27 sc1
  s_mov_b64 exec, -1
  s_branch o_pick_121
o_help_128:
  s_lshl_b32 s60, s60, 1
  s_and_b32 s60, s60, 2
  s_lshl_b32 s27, s60, 7
  s_add_u32 s27, s27, 243269696
  s_mov_b32 s67, 0
o_help_128_w:
  buffer_load_dwordx2 v[162:163], off, s[4:7], s27 sc1
  buffer_load_dword v164, off, s[4:7], s27 offset:128 sc1
  s_add_u32 s67, s67, 1
  s_cmp_gt_u32 s67, 1048576
  s_cbranch_scc1 L_end
  s_waitcnt vmcnt(0)
  v_readfirstlane_b32 s28, v162
  v_readfirstlane_b32 s30, v164
  v_readfirstlane_b32 s46, v163
  s_and_b32 s26, s28, s30
  s_bitcmp1_b32 s26, 31
  s_cbranch_scc0 o_help_128_w
  s_bitreplicate_b64_b32 s[28:29], s28
  s_bitreplicate_b64_b32 s[30:31], s30
  s_and_b32 s28, s28, 0x55555555
  s_and_b32 s30, s30, 0xaaaaaaaa
  s_or_b32 s58, s28, s30
  s_andn2_b32 s52, 0xfff, s46
  s_lshr_b32 s52, s52, 5
  s_sub_u32 s26, s52, s60
  s_add_u32 s27, s26, 3
  s_add_u32 s26, s26, 2
  s_lshr_b32 s27, s27, 2
  s_lshr_b32 s26, s26, 2
  s_add_u32 s26, s26, s27
  s_bfm_b64 s[28:29], s26, 0
  s_mov_b32 s54, s28
  s_mov_b32 s53, 0
  s_mov_b32 s63, 0
  s_mov_b32 s49, 72
  s_mov_b32 s59, 64
  s_mov_b32 s50, 0
  s_mov_b32 s89, 0
  s_branch o_pick_121
L_o_x:
  s_mov_b32 s62, 1
  s_mov_b32 s42, 0
  s_mov_b32 s3, 0
  s_mov_b32 s46, 0
  s_mov_b32 s65, 0
  s_mov_b32 s66, 0
  s_mov_b32 s76, 0
  s_mov_b32 s55, 0
  s_mov_b32 s56, 0
  s_mov_b32 s84, 268435456
  s_mov_b32 s86, s41
  s_mov_b32 s49, s60
  s_mul_i32 s63, s49, 257
  s_or_b32 s63, s63, 1179648
  s_lshr_b32 s57, s60, 2
  s_cbranch_scc1 o_help_180
o_round_169:
  s_max_u32 s46, s46, s3
  s_cmp_lg_u32 s3, 0
  s_mov_b32 s3, 0
  s_cbranch_scc1 d_g_185
  s_mov_b32 s67, 0
d_w_184:
  s_min_u32 s26, s49, 71
  s_lshl_b32 s26, s26, 12
  s_add_u32 s27, s26, 243494912
  s_add_u32 s26, s26, 243486720
  buffer_load_dword v248, v246, s[4:7], s26 offen sc1
  buffer_load_dword v249, v246, s[4:7], s27 offen sc1
  s_add_u32 s67, s67, 1
  s_cmp_gt_u32 s67, 1048576
  s_cbranch_scc1 L_end
  s_waitcnt vmcnt(0)
  s_mov_b64 exec, 1
  buffer_store_dword v38, off, s[4:7], s84 sc1
  s_mov_b64 exec, -1
  s_mov_b32 s84, 268435456
  v_min_u32 v162, v248, v249
  v_max_u32 v163, v248, v249
  v_cmp_eq_u32 vcc, 0, v162
  s_cbranch_vccnz d_w_184
  v_max_u32_dpp v163, v163, v163 row_ror:8 row_mask:0xf bank_mask:0xf
  s_nop 1
  v_max_u32_dpp v163, v163, v163 row_ror:4 row_mask:0xf bank_mask:0xf
  s_nop 1
  v_max_u32_dpp v163, v163, v163 row_ror:2 row_mask:0xf bank_mask:0xf
  s_nop 1
  v_max_u32_dpp v163, v163, v163 row_ror:1 row_mask:0xf bank_mask:0xf
  s_nop 0
  v_readlane_b32 s28, v163, 0
  v_readlane_b32 s29, v163, 16
  v_readlane_b32 s30, v163, 32
  v_readlane_b32 s31, v163, 48
  s_max_u32 s28, s28, s29
  s_max_u32 s30, s30, s31
  s_max_u32 s46, s46, s28
  s_max_u32 s46, s46, s30
d_g_185:
  s_lshr_b32 s27, s49, 2
  s_andn2_b32 s52, 0xfff, s46
  s_lshr_b32 s52, s52, 5
  s_min_u32 s52, s52, 64
  s_add_u32 s26, s52, 3
  v_readlane_b32 s89, v247, s27
  s_sub_u32 s26, s26, s60
  s_lshr_b32 s26, s26, 2
  s_bfm_b32 s54, s26, 0
  s_add_u32 s53, s63, 1028
  s_cmp_lt_u32 s49, 60
  s_cselect_b32 s53, s53, 0
  s_cmp_lt_u32 s49, 64
  s_cselect_b32 s26, 3, 1
  s_sub_i32 s26, s27, s26
  s_max_i32 s26, s26, 0
  s_min_u32 s26, s26, 16
  s_bfm_b32 s58, s26, 0
  s_cmp_eq_u32 s27, 16
  s_cselect_b32 s59, 2, 1
  s_cmp_eq_u32 s27, 18
  s_cselect_b32 s59, 64, s59
  s_cselect_b32 s50, 0, -1
  s_cselect_b32 s89, 0, s89
  s_cbranch_scc1 o_dl_181
o_pick_173:
  s_cmp_eq_u32 s59, 0
  s_cbranch_scc1 o_none_177
  s_sub_u32 s59, s59, 1
  s_andn2_b32 s26, s58, s55
  s_and_b32 s26, s26, s54
  s_cbranch_scc1 o_ga_174
  s_and_b32 s26, s55, s50
  s_or_b32 s26, s26, s56
  s_or_b32 s26, s26, s54
  s_andn2_b32 s26, s58, s26
  s_cbranch_scc0 o_none_177
  s_cmp_ge_u32 s46, s89
  s_cbranch_scc1 o_gb_175
o_ga_174:
  s_ff1_i32_b32 s26, s26
  s_bitset1_b32 s55, s26
  s_mov_b32 s64, 1327168
  s_mov_b32 s27, s64
  s_branch o_gd_176
o_none_177:
  s_cmp_lt_u32 s49, 60
  s_cbranch_scc1 o_nn_178
  s_cmp_eq_u32 s50, 0
  s_cbranch_scc1 o_nn_178
  s_and_b32 s26, s63, 1097728
  s_cmp_eq_u32 s26, 1048576
  s_cbranch_scc1 o_nn_178
  s_cmp_lt_u32 s49, 64
  s_cbranch_scc1 o_adv_179
  s_and_b32 s26, s65, 1097728
  s_cmp_lg_u32 s26, 1048576
  s_cbranch_scc1 o_adv_179
o_nn_178:
  s_mov_b32 s64, s53
  s_mov_b32 s51, 0
  s_branch o_task_170
o_gb_175:
  s_ff1_i32_b32 s26, s26
  s_bitset1_b32 s56, s26
  s_andn2_b32 s27, 31, s46
  s_or_b32 s27, s27, 32
  s_lshl_b32 s27, s27, 22
  s_or_b32 s27, s27, 1474688
  s_mov_b32 s64, 1474624
o_gd_176:
  s_and_b32 s28, s26, s57
  s_lshr_b32 s26, s26, s57
  s_lshl2_add_u32 s26, s26, s60
  s_add_u32 s26, s26, s28
  s_cmp_eq_u32 s26, s52
  s_cselect_b32 s64, s27, s64
  s_mul_i32 s26, s26, 257
  s_or_b32 s64, s64, s26
  s_mov_b32 s51, 1
o_task_170:
  s_cmp_eq_u32 s63, 0
  s_cbranch_scc1 o_nofl_171
  s_cmp_lg_u32 s66, 0
  s_cbranch_scc1 o_have_187
  s_mov_b32 s67, 0
o_w1_186:
  s_and_b32 s32, s63, 0xff
  s_lshl_b32 s32, s32, 12
  s_add_u32 s32, s32, s14
  buffer_load_dword v37, v36, s[4:7], s32 offen sc1
  s_add_u32 s67, s67, 1
  s_cmp_gt_u32 s67, 1048576
  s_cbranch_scc1 L_end
  s_waitcnt vmcnt(0)
  s_mov_b64 exec, 1
  buffer_store_dword v38, off, s[4:7], s84 sc1
  s_mov_b64 exec, -1
  s_mov_b32 s84, 268435456
  v_cmp_eq_u32 vcc, 0, v37
  s_cbranch_vccnz o_w1_186
  s_and_b32 s87, s63, 0xff
  s_lshl_b32 s33, s87, 18
  s_lshl_b32 s32, s87, 19
  s_add_u32 m0, s22, 0
  s_add_u32 s33, s33, s19
  buffer_load_dwordx4 v0, s[4:7], s33 offen offset:0 sc1 lds
  buffer_load_dwordx4 v0, s[4:7], s33 offen offset:1024 sc1 lds
  buffer_load_dwordx4 v0, s[4:7], s33 offen offset:2048 sc1 lds
  buffer_load_dwordx4 v0, s[4:7], s33 offen offset:3072 sc1 lds
  s_add_u32 m0, s23, 0
  s_add_u32 s32, s32, s18
  buffer_load_dwordx4 v0, s[4:7], s32 offen offset:0 sc1 lds
  buffer_load_dwordx4 v0, s[4:7], s32 offen offset:1024 sc1 lds
  buffer_load_dwordx4 v0, s[4:7], s32 offen offset:2048 sc1 lds
  buffer_load_dwordx4 v0, s[4:7], s32 offen offset:3072 sc1 lds
  s_add_u32 m0, m0, 4096
  s_add_u32 s32, s32, 4096
  buffer_load_dwordx4 v0, s[4:7], s32 offen offset:0 sc1 lds
  buffer_load_dwordx4 v0, s[4:7], s32 offen offset:1024 sc1 lds
  buffer_load_dwordx4 v0, s[4:7], s32 offen offset:2048 sc1 lds
  buffer_load_dwordx4 v0, s[4:7], s32 offen offset:3072 sc1 lds
  s_waitcnt vmcnt(0)
  s_barrier
o_have_187:
  ds_read_b128 v[120:123], v33 offset:0
  ds_read_b128 v[40:43], v32 offset:0
  ds_read_b128 v[56:59], v32 offset:1024
  ds_read_b128 v[124:127], v33 offset:2048
  ds_read_b128 v[44:47], v32 offset:4096
  ds_read_b128 v[60:63], v32 offset:5120
  ds_read_b128 v[128:131], v33 offset:4096
  ds_read_b128 v[48:51], v32 offset:8192
  ds_read_b128 v[64:67], v32 offset:9216
  ds_read_b128 v[132:135], v33 offset:6144
  ds_read_b128 v[52:55], v32 offset:12288
  ds_read_b128 v[68:71], v32 offset:13312
  s_cmp_lt_u32 s17, 2
  s_cselect_b32 s65, s65, 0
  s_cmp_lg_u32 s65, 0
  s_cselect_b64 s[44:45], -1, 0
  s_mov_b32 s95, s86
  s_mov_b32 s96, s42
  s_lshl_b32 s97, s43, 14
  s_add_u32 s97, s97, s95
  s_and_b32 s87, s64, 0xff
  s_lshl_b32 s87, s87, 12
  s_add_u32 s87, s87, s14
  s_and_b32 s88, s63, 0xff00
  s_lshl_b32 s88, s88, 3
  s_add_u32 s88, s88, s15
  s_and_b32 s91, s65, 63
  s_lshl_b32 s90, s91, 5
  s_add_u32 s94, s90, s85
  s_add_u32 s90, s90, s43
  s_lshl_b32 s94, s94, 10
  s_lshr_b32 s92, s65, 22
  s_xor_b32 s93, s43, 32
  s_lshl_b32 s91, s90, 10
  s_add_u32 s94, s94, 25165824
  s_cmp_eq_u32 s92, s93
  s_cselect_b32 s92, s94, s91
  s_add_u32 s92, s92, 10485760
  s_and_b32 s93, s65, 49152
  s_cselect_b32 s92, s92, s91
  s_cselect_b64 s[80:81], s[4:5], s[72:73]
  s_cselect_b32 s82, s6, s74
  s_waitcnt lgkmcnt(9)
  v_mfma_f32_16x16x32_bf16 v[104:107], v[40:43], v[120:123], v[24:27]
  v_mfma_f32_16x16x32_bf16 v[108:111], v[56:59], v[120:123], v[28:31]
  s_mov_b64 exec, s[44:45]
  buffer_load_dword v7, v255, s[4:7], s97 offen sc1
  buffer_load_dwordx4 v[184:187], v0, s[80:83], s92 offen sc1
  s_not_b64 exec, exec
  buffer_load_dword v37, v36, s[4:7], s87 offen sc1
  s_mov_b64 exec, -1
  buffer_load_dword v244, v252, s[4:7], s88 offen sc1
  s_waitcnt lgkmcnt(6)
  v_mfma_f32_16x16x32_bf16 v[104:107], v[44:47], v[124:127], v[104:107]
  v_mfma_f32_16x16x32_bf16 v[108:111], v[60:63], v[124:127], v[108:111]
  s_waitcnt lgkmcnt(3)
  v_mfma_f32_16x16x32_bf16 v[104:107], v[48:51], v[128:131], v[104:107]
  v_mfma_f32_16x16x32_bf16 v[108:111], v[64:67], v[128:131], v[108:111]
  s_waitcnt lgkmcnt(0)
  v_mfma_f32_16x16x32_bf16 v[104:107], v[52:55], v[132:135], v[104:107]
  v_mfma_f32_16x16x32_bf16 v[108:111], v[68:71], v[132:135], v[108:111]
  s_cmp_lg_u32 s76, 0
  s_cbranch_scc1 o_klds_190
  v_mov_b32 v196, 0
  v_mov_b32 v199, 0
  v_exp_f32 v56, v104
  v_exp_f32 v57, v105
  v_exp_f32 v58, v106
  v_exp_f32 v59, v107
  v_exp_f32 v60, v108
  v_exp_f32 v61, v109
  v_exp_f32 v62, v110
  v_exp_f32 v63, v111
  v_max3_f32 v116, v104, v105, v106
  v_max3_f32 v116, v107, v108, v116
  v_max3_f32 v116, v109, v110, v116
  v_add_f32 v117, v56, v57
  v_add_f32 v118, v58, v59
  v_add_f32 v117, v117, v60
  v_add_f32 v118, v118, v61
  v_add_f32 v117, v117, v62
  v_add_f32 v118, v118, v63
  s_mov_b32 s67, 0
  s_and_b32 s32, s63, 0xff00
  s_lshl_b32 s32, s32, 10
  s_add_u32 s32, s32, s20
  s_add_u32 s33, s32, 4096
o_w2_188:
  s_waitcnt vmcnt(0)
  v_cmp_eq_u32 vcc, 0, v244
  s_cbranch_vccz o_kgo_198
  s_mov_b64 exec, 1
  buffer_store_dword v38, off, s[4:7], s84 sc1
  s_mov_b64 exec, -1
  s_mov_b32 s84, 268435456
  buffer_load_dword v244, v252, s[4:7], s88 offen sc1
  s_add_u32 s67, s67, 1
  s_cmp_gt_u32 s67, 1048576
  s_cbranch_scc1 L_end
  s_branch o_w2_188
o_kgo_198:
  buffer_load_dwordx4 v[136:139], v0, s[4:7], s32 offen offset:0 sc1
  buffer_load_dwordx4 v[140:143], v0, s[4:7], s32 offen offset:1024 sc1
  buffer_load_dwordx4 v[144:147], v0, s[4:7], s32 offen offset:2048 sc1
  buffer_load_dwordx4 v[148:151], v0, s[4:7], s32 offen offset:3072 sc1
  buffer_load_dwordx2 v[200:201], v1, s[4:7], s33 offen offset:0 sc1
  buffer_load_dwordx2 v[202:203], v1, s[4:7], s33 offen offset:512 sc1
  buffer_load_dwordx2 v[204:205], v1, s[4:7], s33 offen offset:1024 sc1
  buffer_load_dwordx2 v[206:207], v1, s[4:7], s33 offen offset:1536 sc1
  buffer_load_dword v37, v36, s[4:7], s87 offen sc1
  buffer_load_dword v244, v252, s[4:7], s88 offen sc1
  s_barrier
  ds_read_b128 v[152:155], v32 offset:2048
  ds_read_b128 v[156:159], v32 offset:3072
  ds_read_b128 v[160:163], v32 offset:6144
  ds_read_b128 v[164:167], v32 offset:7168
  ds_read_b128 v[168:171], v32 offset:10240
  ds_read_b128 v[172:175], v32 offset:11264
  ds_read_b128 v[176:179], v32 offset:14336
  ds_read_b128 v[180:183], v32 offset:15360
  s_waitcnt vmcnt(9)
  v_mfma_f32_16x16x32_bf16 v[112:115], v[136:139], v[120:123], 0
  s_waitcnt vmcnt(8)
  v_mfma_f32_16x16x32_bf16 v[112:115], v[140:143], v[124:127], v[112:115]
  s_waitcnt vmcnt(7)
  v_mfma_f32_16x16x32_bf16 v[112:115], v[144:147], v[128:131], v[112:115]
  s_waitcnt vmcnt(6)
  v_mfma_f32_16x16x32_bf16 v[112:115], v[148:151], v[132:135], v[112:115]
  s_waitcnt vmcnt(2)
  s_branch o_havek_189
o_klds_190:
  s_waitcnt vmcnt(12)
  s_barrier
  ds_read_b128 v[136:139], v34 offset:0
  ds_read_b128 v[140:143], v34 offset:1024
  ds_read_b128 v[144:147], v34 offset:2048
  ds_read_b128 v[148:151], v34 offset:3072
  ds_read_b64 v[200:201], v35 offset:4096
  ds_read_b64 v[202:203], v35 offset:4608
  ds_read_b64 v[204:205], v35 offset:5120
  ds_read_b64 v[206:207], v35 offset:5632
  v_mov_b32 v196, 0
  v_mov_b32 v199, 0
  v_exp_f32 v56, v104
  v_exp_f32 v57, v105
  v_exp_f32 v58, v106
  v_exp_f32 v59, v107
  v_exp_f32 v60, v108
  v_exp_f32 v61, v109
  v_exp_f32 v62, v110
  v_exp_f32 v63, v111
  v_max3_f32 v116, v104, v105, v106
  v_max3_f32 v116, v107, v108, v116
  v_max3_f32 v116, v109, v110, v116
  s_waitcnt lgkmcnt(4)
  v_mfma_f32_16x16x32_bf16 v[112:115], v[136:139], v[120:123], 0
  ds_read_b128 v[152:155], v32 offset:2048
  ds_read_b128 v[156:159], v32 offset:3072
  v_mfma_f32_16x16x32_bf16 v[112:115], v[140:143], v[124:127], v[112:115]
  ds_read_b128 v[160:163], v32 offset:6144
  ds_read_b128 v[164:167], v32 offset:7168
  v_mfma_f32_16x16x32_bf16 v[112:115], v[144:147], v[128:131], v[112:115]
  ds_read_b128 v[168:171], v32 offset:10240
  ds_read_b128 v[172:175], v32 offset:11264
  v_mfma_f32_16x16x32_bf16 v[112:115], v[148:151], v[132:135], v[112:115]
  ds_read_b128 v[176:179], v32 offset:14336
  ds_read_b128 v[180:183], v32 offset:15360
  v_add_f32 v117, v56, v57
  v_add_f32 v118, v58, v59
  v_add_f32 v117, v117, v60
  v_add_f32 v118, v118, v61
  v_add_f32 v117, v117, v62
  v_add_f32 v118, v118, v63
o_havek_189:
  s_cmp_lg_u32 s65, 0
  s_cbranch_scc1 o_wr1_195
  s_nop 3
  v_mul_f32 v112, s24, v112
  v_mul_f32 v113, s24, v113
  v_exp_f32 v64, v112
  v_exp_f32 v65, v113
  v_max_f32 v116, v111, v116
  v_max3_f32 v116, v112, v113, v116
  v_add_f32 v117, v117, v64
  v_add_f32 v118, v118, v65
  v_add_f32 v117, v117, v118
  s_mov_b32 s28, 0x21800000
  v_mov_b32 v118, v117
  s_nop 1
  v_permlane16_swap_b32 v117, v118
  v_add_f32 v117, v117, v118
  v_mov_b32 v118, v117
  s_nop 0
  s_nop 0
  v_permlane32_swap_b32 v117, v118
  v_add_f32 v117, v117, v118
  v_cmp_lt_f32 vcc, 0x42700000, v116
  v_cmp_gt_f32 s[30:31], s28, v117
  v_rcp_f32 v117, v117
  s_or_b64 vcc, vcc, s[30:31]
  s_cbranch_vccnz o_fb_199
o_fbr_200:
  v_pk_mul_f32 v[56:57], v[56:57], v[116:117] op_sel:[0,1] op_sel_hi:[1,1]
  v_pk_mul_f32 v[58:59], v[58:59], v[116:117] op_sel:[0,1] op_sel_hi:[1,1]
  v_pk_mul_f32 v[60:61], v[60:61], v[116:117] op_sel:[0,1] op_sel_hi:[1,1]
  v_pk_mul_f32 v[62:63], v[62:63], v[116:117] op_sel:[0,1] op_sel_hi:[1,1]
  v_pk_mul_f32 v[64:65], v[64:65], v[116:117] op_sel:[0,1] op_sel_hi:[1,1]
  v_cvt_pk_bf16_f32 v116, v56, v57
  v_cvt_pk_bf16_f32 v117, v58, v59
  v_cvt_pk_bf16_f32 v118, v60, v61
  v_cvt_pk_bf16_f32 v119, v62, v63
  s_waitcnt lgkmcnt(0)
  s_nop 0
  v_mfma_f32_16x16x32_bf16 v[72:75], v[152:155], v[116:119], 0
  s_add_u32 s62, s62, 1
  v_cvt_pk_bf16_f32 v197, v64, v65
  v_cvt_pk_bf16_f32 v198, v64, v65
  v_mfma_f32_16x16x32_bf16 v[76:79], v[156:159], v[116:119], 0
  s_xor_b32 s86, s86, 524288
  v_mfma_f32_16x16x32_bf16 v[80:83], v[160:163], v[116:119], 0
  s_bfe_u32 s42, s62, 0x10001
  v_mfma_f32_16x16x32_bf16 v[84:87], v[164:167], v[116:119], 0
  s_bfe_u32 s26, s64, 65556
  v_mfma_f32_16x16x32_bf16 v[88:91], v[168:171], v[116:119], 0
  s_and_b32 s87, s64, 0xff
  v_mfma_f32_16x16x32_bf16 v[92:95], v[172:175], v[116:119], 0
  s_bfe_u32 s88, s64, 0x80008
  v_mfma_f32_16x16x32_bf16 v[96:99], v[176:179], v[116:119], 0
  s_nop 0
  v_mfma_f32_16x16x32_bf16 v[100:103], v[180:183], v[116:119], 0
  s_nop 0
  v_mfma_f32_16x16x16_bf16 v[72:75], v[200:201], v[198:199], v[72:75]
  s_nop 1
  v_mfma_f32_16x16x16_bf16 v[76:79], v[200:201], v[196:197], v[76:79]
  s_nop 1
  v_mfma_f32_16x16x16_bf16 v[80:83], v[202:203], v[198:199], v[80:83]
  s_nop 1
  v_mfma_f32_16x16x16_bf16 v[84:87], v[202:203], v[196:197], v[84:87]
  s_nop 1
  v_mfma_f32_16x16x16_bf16 v[88:91], v[204:205], v[198:199], v[88:91]
  s_nop 0
  v_cvt_pk_bf16_f32 v40, v72, v73
  v_cvt_pk_bf16_f32 v41, v74, v75
  v_mfma_f32_16x16x16_bf16 v[92:95], v[204:205], v[196:197], v[92:95]
  s_nop 0
  v_cvt_pk_bf16_f32 v42, v76, v77
  v_cvt_pk_bf16_f32 v43, v78, v79
  v_mfma_f32_16x16x16_bf16 v[96:99], v[206:207], v[198:199], v[96:99]
  s_nop 0
  ds_write_b128 v6, v[40:43] offset:0
  v_cvt_pk_bf16_f32 v44, v80, v81
  v_mfma_f32_16x16x16_bf16 v[100:103], v[206:207], v[196:197], v[100:103]
  s_nop 0
  v_cvt_pk_bf16_f32 v45, v82, v83
  v_cvt_pk_bf16_f32 v46, v84, v85
  v_cvt_pk_bf16_f32 v47, v86, v87
  ds_write_b128 v6, v[44:47] offset:1024
  v_cvt_pk_bf16_f32 v48, v88, v89
  v_cvt_pk_bf16_f32 v49, v90, v91
  v_cvt_pk_bf16_f32 v50, v92, v93
  v_cvt_pk_bf16_f32 v51, v94, v95
  ds_write_b128 v6, v[48:51] offset:2048
  v_cvt_pk_bf16_f32 v52, v96, v97
  v_cvt_pk_bf16_f32 v53, v98, v99
  v_cvt_pk_bf16_f32 v54, v100, v101
  v_cvt_pk_bf16_f32 v55, v102, v103
  ds_write_b128 v6, v[52:55] offset:3072
  s_cmp_lt_u32 s17, 2
  s_cbranch_scc1 o_wr0_194
  s_waitcnt lgkmcnt(0)
  s_barrier
  ds_read_b128 v[104:107], v3 offset:0
  ds_read_b128 v[108:111], v3 offset:512
  ds_read_b128 v[112:115], v3 offset:1024
  s_waitcnt lgkmcnt(2)
  v_mfma_f32_32x32x16_bf16 v[40:55], v[104:107], a[0:3], 0
  s_waitcnt vmcnt(0)
  v_cmp_eq_u32 vcc, 0, v37
  s_cmp_eq_u64 vcc, 0
  s_cselect_b32 s66, s26, 0
  s_cmp_eq_u32 s66, 1
  s_cselect_b32 s87, s87, 1024
  s_cselect_b32 s34, 0, 0x28000
  v_mfma_f32_32x32x16_bf16 v[56:71], v[104:107], a[4:7], 0
  ds_read_b128 v[116:119], v3 offset:1536
  s_lshl_b32 s33, s87, 18
  s_lshl_b32 s32, s87, 19
  s_add_u32 m0, s22, s34
  s_add_u32 s33, s33, s19
  s_min_u32 s28, s49, 67
  v_mfma_f32_32x32x16_bf16 v[72:87], v[104:107], a[8:11], 0
  s_lshl1_add_u32 s28, s17, s28
  s_lshl_b32 s28, s28, 12
  s_add_u32 s28, s28, 243486720
  v_mfma_f32_32x32x16_bf16 v[88:103], v[104:107], a[12:15], 0
  buffer_load_dword v249, v246, s[4:7], s28 offen sc1
  s_waitcnt lgkmcnt(2)
  v_mfma_f32_32x32x16_bf16 v[40:55], v[108:111], a[16:19], v[40:55]
  buffer_load_dwordx4 v0, s[4:7], s33 offen offset:0 sc1 lds
  v_mfma_f32_32x32x16_bf16 v[56:71], v[108:111], a[20:23], v[56:71]
  ds_read_b128 v[104:107], v3 offset:2048
  v_mfma_f32_32x32x16_bf16 v[72:87], v[108:111], a[24:27], v[72:87]
  buffer_load_dwordx4 v0, s[4:7], s33 offen offset:1024 sc1 lds
  v_mfma_f32_32x32x16_bf16 v[88:103], v[108:111], a[28:31], v[88:103]
  buffer_load_dwordx4 v0, s[4:7], s33 offen offset:2048 sc1 lds
  s_waitcnt lgkmcnt(2)
  v_mfma_f32_32x32x16_bf16 v[40:55], v[112:115], a[32:35], v[40:55]
  v_mfma_f32_32x32x16_bf16 v[56:71], v[112:115], a[36:39], v[56:71]
  ds_read_b128 v[108:111], v3 offset:2560
  buffer_load_dwordx4 v0, s[4:7], s33 offen offset:3072 sc1 lds
  s_sub_u32 m0, m0, 8192
  s_sub_u32 s33, s33, 8192
  v_mfma_f32_32x32x16_bf16 v[72:87], v[112:115], a[40:43], v[72:87]
  buffer_load_dwordx4 v0, s[4:7], s33 offen offset:0 sc1 lds
  v_mfma_f32_32x32x16_bf16 v[88:103], v[112:115], a[44:47], v[88:103]
  s_waitcnt lgkmcnt(2)
  v_mfma_f32_32x32x16_bf16 v[40:55], v[116:119], a[48:51], v[40:55]
  buffer_load_dwordx4 v0, s[4:7], s33 offen offset:1024 sc1 lds
  v_mfma_f32_32x32x16_bf16 v[56:71], v[116:119], a[52:55], v[56:71]
  ds_read_b128 v[112:115], v3 offset:3072
  buffer_load_dwordx4 v0, s[4:7], s33 offen offset:2048 sc1 lds
  v_mfma_f32_32x32x16_bf16 v[72:87], v[116:119], a[56:59], v[72:87]
  v_mfma_f32_32x32x16_bf16 v[88:103], v[116:119], a[60:63], v[88:103]
  buffer_load_dwordx4 v0, s[4:7], s33 offen offset:3072 sc1 lds
  s_add_u32 m0, s23, s34
  s_add_u32 s32, s32, s18
  s_waitcnt lgkmcnt(2)
  v_mfma_f32_32x32x16_bf16 v[40:55], v[104:107], a[64:67], v[40:55]
  buffer_load_dwordx4 v0, s[4:7], s32 offen offset:0 sc1 lds
  v_mfma_f32_32x32x16_bf16 v[56:71], v[104:107], a[68:71], v[56:71]
  ds_read_b128 v[116:119], v3 offset:3584
  v_mfma_f32_32x32x16_bf16 v[72:87], v[104:107], a[72:75], v[72:87]
  buffer_load_dwordx4 v0, s[4:7], s32 offen offset:1024 sc1 lds
  s_add_i32 m0, m0, 4096
  s_add_i32 s32, s32, 4096
  v_mfma_f32_32x32x16_bf16 v[88:103], v[104:107], a[76:79], v[88:103]
  buffer_load_dwordx4 v0, s[4:7], s32 offen offset:0 sc1 lds
  s_waitcnt lgkmcnt(2)
  v_mfma_f32_32x32x16_bf16 v[40:55], v[108:111], a[80:83], v[40:55]
  v_mfma_f32_32x32x16_bf16 v[56:71], v[108:111], a[84:87], v[56:71]
  ds_read_b128 v[104:107], v3 offset:8192
  buffer_load_dwordx4 v0, s[4:7], s32 offen offset:1024 sc1 lds
  s_add_i32 m0, m0, -16384
  s_add_i32 s32, s32, -16384
  v_mfma_f32_32x32x16_bf16 v[72:87], v[108:111], a[88:91], v[72:87]
  s_and_b32 s29, s64, 0xff00
  s_lshl_b32 s29, s29, 3
  s_add_u32 s29, s29, s15
  buffer_load_dword v245, v252, s[4:7], s29 offen sc1
  v_mfma_f32_32x32x16_bf16 v[88:103], v[108:111], a[92:95], v[88:103]
  s_waitcnt lgkmcnt(2)
  v_mfma_f32_32x32x16_bf16 v[40:55], v[112:115], a[96:99], v[40:55]
  buffer_load_dwordx4 v0, s[4:7], s32 offen offset:0 sc1 lds
  v_mfma_f32_32x32x16_bf16 v[56:71], v[112:115], a[100:103], v[56:71]
  ds_read_b128 v[108:111], v3 offset:8704
  buffer_load_dwordx4 v0, s[4:7], s32 offen offset:1024 sc1 lds
  s_add_i32 m0, m0, -4096
  s_add_i32 s32, s32, -4096
  v_mfma_f32_32x32x16_bf16 v[72:87], v[112:115], a[104:107], v[72:87]
  v_mfma_f32_32x32x16_bf16 v[88:103], v[112:115], a[108:111], v[88:103]
  buffer_load_dwordx4 v0, s[4:7], s32 offen offset:0 sc1 lds
  s_waitcnt lgkmcnt(2)
  v_mfma_f32_32x32x16_bf16 v[40:55], v[116:119], a[112:115], v[40:55]
  buffer_load_dwordx4 v0, s[4:7], s32 offen offset:1024 sc1 lds
  v_mfma_f32_32x32x16_bf16 v[56:71], v[116:119], a[116:119], v[56:71]
  ds_read_b128 v[112:115], v3 offset:9216
  v_mfma_f32_32x32x16_bf16 v[72:87], v[116:119], a[120:123], v[72:87]
  buffer_load_dwordx4 v0, s[4:7], s32 offen offset:2048 sc1 lds
  v_mfma_f32_32x32x16_bf16 v[88:103], v[116:119], a[124:127], v[88:103]
  buffer_load_dwordx4 v0, s[4:7], s32 offen offset:3072 sc1 lds
  s_add_i32 m0, m0, 4096
  s_add_i32 s32, s32, 4096
  s_waitcnt lgkmcnt(2)
  v_mfma_f32_32x32x16_bf16 v[40:55], v[104:107], a[128:131], v[40:55]
  v_mfma_f32_32x32x16_bf16 v[56:71], v[104:107], a[132:135], v[56:71]
  ds_read_b128 v[116:119], v3 offset:9728
  buffer_load_dwordx4 v0, s[4:7], s32 offen offset:2048 sc1 lds
  v_mfma_f32_32x32x16_bf16 v[72:87], v[104:107], a[136:139], v[72:87]
  buffer_load_dwordx4 v0, s[4:7], s32 offen offset:3072 sc1 lds
  s_add_i32 m0, m0, 16384
  s_add_i32 s32, s32, 16384
  v_mfma_f32_32x32x16_bf16 v[88:103], v[104:107], a[140:143], v[88:103]
  s_waitcnt lgkmcnt(2)
  v_mfma_f32_32x32x16_bf16 v[40:55], v[108:111], a[144:147], v[40:55]
  buffer_load_dwordx4 v0, s[4:7], s32 offen offset:2048 sc1 lds
  v_mfma_f32_32x32x16_bf16 v[56:71], v[108:111], a[148:151], v[56:71]
  ds_read_b128 v[104:107], v3 offset:10240
  buffer_load_dwordx4 v0, s[4:7], s32 offen offset:3072 sc1 lds
  s_add_i32 m0, m0, -4096
  s_add_i32 s32, s32, -4096
  v_mfma_f32_32x32x16_bf16 v[72:87], v[108:111], a[152:155], v[72:87]
  v_mfma_f32_32x32x16_bf16 v[88:103], v[108:111], a[156:159], v[88:103]
  buffer_load_dwordx4 v0, s[4:7], s32 offen offset:2048 sc1 lds
  s_waitcnt lgkmcnt(2)
  v_mfma_f32_32x32x16_bf16 v[40:55], v[112:115], a[160:163], v[40:55]
  buffer_load_dwordx4 v0, s[4:7], s32 offen offset:3072 sc1 lds
  v_mfma_f32_32x32x16_bf16 v[56:71], v[112:115], a[164:167], v[56:71]
  ds_read_b128 v[108:111], v3 offset:10752
  v_mfma_f32_32x32x16_bf16 v[72:87], v[112:115], a[168:171], v[72:87]
  v_mfma_f32_32x32x16_bf16 v[88:103], v[112:115], a[172:175], v[88:103]
  s_waitcnt lgkmcnt(2)
  v_mfma_f32_32x32x16_bf16 v[40:55], v[116:119], a[176:179], v[40:55]
  v_mfma_f32_32x32x16_bf16 v[56:71], v[116:119], a[180:183], v[56:71]
  ds_read_b128 v[112:115], v3 offset:11264
  v_mfma_f32_32x32x16_bf16 v[72:87], v[116:119], a[184:187], v[72:87]
  v_mfma_f32_32x32x16_bf16 v[88:103], v[116:119], a[188:191], v[88:103]
  s_waitcnt lgkmcnt(2)
  v_mfma_f32_32x32x16_bf16 v[40:55], v[104:107], a[192:195], v[40:55]
  v_mfma_f32_32x32x16_bf16 v[56:71], v[104:107], a[196:199], v[56:71]
  ds_read_b128 v[116:119], v3 offset:11776
  s_waitcnt vmcnt(12)
  v_cmp_eq_u32 vcc, 0, v245
  s_cmp_eq_u64 vcc, 0
  s_cselect_b32 s76, s26, 0
  s_and_b32 s76, s76, 1
  s_cselect_b32 s88, s88, 1024
  s_waitcnt lgkmcnt(2)
  v_mfma_f32_32x32x16_bf16 v[40:55], v[108:111], a[208:211], v[40:55]
  s_lshl_b32 s32, s88, 18
  s_mov_b32 m0, s40
  s_add_u32 s32, s32, s21
  buffer_load_dwordx4 v0, s[4:7], s32 offen offset:0 sc1 lds
  v_mfma_f32_32x32x16_bf16 v[56:71], v[108:111], a[212:215], v[56:71]
  buffer_load_dwordx4 v0, s[4:7], s32 offen offset:1024 sc1 lds
  s_waitcnt lgkmcnt(1)
  v_mfma_f32_32x32x16_bf16 v[40:55], v[112:115], a[224:227], v[40:55]
  buffer_load_dwordx4 v0, s[4:7], s32 offen offset:2048 sc1 lds
  s_sub_u32 m0, m0, 8192
  s_sub_u32 s32, s32, 8192
  v_mfma_f32_32x32x16_bf16 v[56:71], v[112:115], a[228:231], v[56:71]
  buffer_load_dwordx4 v0, s[4:7], s32 offen offset:0 sc1 lds
  s_waitcnt lgkmcnt(0)
  v_mfma_f32_32x32x16_bf16 v[40:55], v[116:119], a[240:243], v[40:55]
  buffer_load_dwordx4 v0, s[4:7], s32 offen offset:1024 sc1 lds
  v_mfma_f32_32x32x16_bf16 v[56:71], v[116:119], a[244:247], v[56:71]
  buffer_load_dwordx4 v0, s[4:7], s32 offen offset:2048 sc1 lds
  v_cmp_eq_u32 vcc, 0, v249
  v_max_u32_dpp v249, v249, v249 row_ror:8 row_mask:0xf bank_mask:0xf
  s_nop 0
  v_mfma_f32_32x32x16_bf16 v[72:87], v[104:107], a[200:203], v[72:87]
  v_max_u32_dpp v249, v249, v249 row_ror:4 row_mask:0xf bank_mask:0xf
  s_nop 0
  s_nop 0
  v_max_u32_dpp v249, v249, v249 row_ror:2 row_mask:0xf bank_mask:0xf
  s_nop 0
  s_nop 0
  v_max_u32_dpp v249, v249, v249 row_ror:1 row_mask:0xf bank_mask:0xf
  s_nop 0
  v_mfma_f32_32x32x16_bf16 v[88:103], v[104:107], a[204:207], v[88:103]
  v_mov_b32 v248, v249
  s_nop 0
  s_nop 0
  v_permlane16_swap_b32 v249, v248
  v_max_u32 v249, v249, v248
  v_mfma_f32_32x32x16_bf16 v[72:87], v[108:111], a[216:219], v[72:87]
  v_mov_b32 v248, v249
  s_nop 0
  s_nop 0
  v_permlane32_swap_b32 v249, v248
  v_max_u32 v249, v249, v248
  s_cmp_eq_u64 vcc, 0
  s_cselect_b32 s28, 4, 0
  v_mfma_f32_32x32x16_bf16 v[88:103], v[108:111], a[220:223], v[88:103]
  s_lshl_b32 s26, s76, 1
  s_or_b32 s26, s26, s66
  s_or_b32 s26, s26, s28
  v_mov_b32 v248, s26
  ds_write_b64 v39, v[248:249]
  v_mfma_f32_32x32x16_bf16 v[72:87], v[112:115], a[232:235], v[72:87]
  v_cvt_pk_bf16_f32 v212, v40, v56
  v_cvt_pk_bf16_f32 v214, v41, v57
  v_cvt_pk_bf16_f32 v216, v42, v58
  v_cvt_pk_bf16_f32 v218, v43, v59
  v_permlane16_swap_b32 v212, v214
  v_mfma_f32_32x32x16_bf16 v[88:103], v[112:115], a[236:239], v[88:103]
  v_cvt_pk_bf16_f32 v220, v44, v60
  v_cvt_pk_bf16_f32 v222, v45, v61
  v_permlane16_swap_b32 v216, v218
  v_bfi_b32 v212, v254, s42, v212
  v_mfma_f32_32x32x16_bf16 v[72:87], v[116:119], a[248:251], v[72:87]
  v_cvt_pk_bf16_f32 v224, v46, v62
  v_cvt_pk_bf16_f32 v226, v47, v63
  v_permlane16_swap_b32 v220, v222
  v_bfi_b32 v216, v254, s42, v216
  v_cvt_pk_bf16_f32 v228, v48, v64
  v_mfma_f32_32x32x16_bf16 v[88:103], v[116:119], a[252:255], v[88:103]
  v_cvt_pk_bf16_f32 v230, v49, v65
  v_permlane16_swap_b32 v224, v226
  v_bfi_b32 v220, v254, s42, v220
  v_cvt_pk_bf16_f32 v232, v50, v66
  v_cvt_pk_bf16_f32 v234, v51, v67
  v_permlane16_swap_b32 v228, v230
  v_bfi_b32 v224, v254, s42, v224
  v_cvt_pk_bf16_f32 v236, v52, v68
  v_cvt_pk_bf16_f32 v238, v53, v69
  v_permlane16_swap_b32 v232, v234
  v_bfi_b32 v228, v254, s42, v228
  v_cvt_pk_bf16_f32 v240, v54, v70
  v_cvt_pk_bf16_f32 v242, v55, v71
  v_permlane16_swap_b32 v236, v238
  v_bfi_b32 v232, v254, s42, v232
  v_permlane16_swap_b32 v240, v242
  v_bfi_b32 v236, v254, s42, v236
  v_bfi_b32 v240, v254, s42, v240
  v_cvt_pk_bf16_f32 v213, v72, v88
  v_cvt_pk_bf16_f32 v215, v73, v89
  v_cvt_pk_bf16_f32 v217, v74, v90
  v_cvt_pk_bf16_f32 v219, v75, v91
  s_add_u32 s78, s86, 0
  v_permlane16_swap_b32 v213, v215
  buffer_store_dwordx4 v[212:215], v4, s[4:7], s78 offen sc1
  v_cvt_pk_bf16_f32 v221, v76, v92
  v_cvt_pk_bf16_f32 v223, v77, v93
  s_add_u32 s78, s86, 32768
  v_permlane16_swap_b32 v217, v219
  buffer_store_dwordx4 v[216:219], v4, s[4:7], s78 offen sc1
  v_cvt_pk_bf16_f32 v225, v78, v94
  v_cvt_pk_bf16_f32 v227, v79, v95
  s_add_u32 s78, s86, 131072
  v_permlane16_swap_b32 v221, v223
  buffer_store_dwordx4 v[220:223], v4, s[4:7], s78 offen sc1
  v_cvt_pk_bf16_f32 v229, v80, v96
  v_cvt_pk_bf16_f32 v231, v81, v97
  s_add_u32 s78, s86, 163840
  v_permlane16_swap_b32 v225, v227
  buffer_store_dwordx4 v[224:227], v4, s[4:7], s78 offen sc1
  v_cvt_pk_bf16_f32 v233, v82, v98
  v_cvt_pk_bf16_f32 v235, v83, v99
  s_add_u32 s78, s86, 262144
  v_permlane16_swap_b32 v229, v231
  buffer_store_dwordx4 v[228:231], v4, s[4:7], s78 offen sc1
  v_cvt_pk_bf16_f32 v237, v84, v100
  v_cvt_pk_bf16_f32 v239, v85, v101
  s_add_u32 s78, s86, 294912
  v_permlane16_swap_b32 v233, v235
  buffer_store_dwordx4 v[232:235], v4, s[4:7], s78 offen sc1
  v_cvt_pk_bf16_f32 v241, v86, v102
  v_cvt_pk_bf16_f32 v243, v87, v103
  s_add_u32 s78, s86, 393216
  v_permlane16_swap_b32 v237, v239
  buffer_store_dwordx4 v[236:239], v4, s[4:7], s78 offen sc1
  s_add_u32 s78, s86, 425984
  v_permlane16_swap_b32 v241, v243
  buffer_store_dwordx4 v[240:243], v4, s[4:7], s78 offen sc1
  s_waitcnt vmcnt(22)
  s_branch o_we_197
o_wr0_194:
  s_waitcnt lgkmcnt(0)
  s_barrier
  ds_read_b128 v[104:107], v3 offset:0
  ds_read_b128 v[108:111], v3 offset:512
  ds_read_b128 v[112:115], v3 offset:1024
  s_waitcnt lgkmcnt(2)
  v_mfma_f32_32x32x16_bf16 v[40:55], v[104:107], a[0:3], 0
  v_mfma_f32_32x32x16_bf16 v[56:71], v[104:107], a[4:7], 0
  ds_read_b128 v[116:119], v3 offset:1536
  v_mfma_f32_32x32x16_bf16 v[72:87], v[104:107], a[8:11], 0
  v_mfma_f32_32x32x16_bf16 v[88:103], v[104:107], a[12:15], 0
  s_waitcnt lgkmcnt(2)
  v_mfma_f32_32x32x16_bf16 v[40:55], v[108:111], a[16:19], v[40:55]
  v_mfma_f32_32x32x16_bf16 v[56:71], v[108:111], a[20:23], v[56:71]
  ds_read_b128 v[104:107], v3 offset:2048
  v_mfma_f32_32x32x16_bf16 v[72:87], v[108:111], a[24:27], v[72:87]
  v_mfma_f32_32x32x16_bf16 v[88:103], v[108:111], a[28:31], v[88:103]
  s_waitcnt lgkmcnt(2)
  v_mfma_f32_32x32x16_bf16 v[40:55], v[112:115], a[32:35], v[40:55]
  v_mfma_f32_32x32x16_bf16 v[56:71], v[112:115], a[36:39], v[56:71]
  ds_read_b128 v[108:111], v3 offset:2560
  v_mfma_f32_32x32x16_bf16 v[72:87], v[112:115], a[40:43], v[72:87]
  v_mfma_f32_32x32x16_bf16 v[88:103], v[112:115], a[44:47], v[88:103]
  s_waitcnt lgkmcnt(2)
  v_mfma_f32_32x32x16_bf16 v[40:55], v[116:119], a[48:51], v[40:55]
  v_mfma_f32_32x32x16_bf16 v[56:71], v[116:119], a[52:55], v[56:71]
  ds_read_b128 v[112:115], v3 offset:3072
  v_mfma_f32_32x32x16_bf16 v[72:87], v[116:119], a[56:59], v[72:87]
  v_mfma_f32_32x32x16_bf16 v[88:103], v[116:119], a[60:63], v[88:103]
  s_waitcnt lgkmcnt(2)
  v_mfma_f32_32x32x16_bf16 v[40:55], v[104:107], a[64:67], v[40:55]
  v_mfma_f32_32x32x16_bf16 v[56:71], v[104:107], a[68:71], v[56:71]
  ds_read_b128 v[116:119], v3 offset:3584
  v_mfma_f32_32x32x16_bf16 v[72:87], v[104:107], a[72:75], v[72:87]
  v_mfma_f32_32x32x16_bf16 v[88:103], v[104:107], a[76:79], v[88:103]
  s_waitcnt lgkmcnt(2)
  v_mfma_f32_32x32x16_bf16 v[40:55], v[108:111], a[80:83], v[40:55]
  v_mfma_f32_32x32x16_bf16 v[56:71], v[108:111], a[84:87], v[56:71]
  ds_read_b128 v[104:107], v3 offset:8192
  v_mfma_f32_32x32x16_bf16 v[72:87], v[108:111], a[88:91], v[72:87]
  v_mfma_f32_32x32x16_bf16 v[88:103], v[108:111], a[92:95], v[88:103]
  s_waitcnt lgkmcnt(2)
  v_mfma_f32_32x32x16_bf16 v[40:55], v[112:115], a[96:99], v[40:55]
  v_mfma_f32_32x32x16_bf16 v[56:71], v[112:115], a[100:103], v[56:71]
  ds_read_b128 v[108:111], v3 offset:8704
  v_mfma_f32_32x32x16_bf16 v[72:87], v[112:115], a[104:107], v[72:87]
  v_mfma_f32_32x32x16_bf16 v[88:103], v[112:115], a[108:111], v[88:103]
  s_waitcnt lgkmcnt(2)
  v_mfma_f32_32x32x16_bf16 v[40:55], v[116:119], a[112:115], v[40:55]
  v_mfma_f32_32x32x16_bf16 v[56:71], v[116:119], a[116:119], v[56:71]
  ds_read_b128 v[112:115], v3 offset:9216
  v_mfma_f32_32x32x16_bf16 v[72:87], v[116:119], a[120:123], v[72:87]
  v_mfma_f32_32x32x16_bf16 v[88:103], v[116:119], a[124:127], v[88:103]
  s_waitcnt lgkmcnt(2)
  v_mfma_f32_32x32x16_bf16 v[40:55], v[104:107], a[128:131], v[40:55]
  v_mfma_f32_32x32x16_bf16 v[56:71], v[104:107], a[132:135], v[56:71]
  ds_read_b128 v[116:119], v3 offset:9728
  v_mfma_f32_32x32x16_bf16 v[72:87], v[104:107], a[136:139], v[72:87]
  v_mfma_f32_32x32x16_bf16 v[88:103], v[104:107], a[140:143], v[88:103]
  s_waitcnt lgkmcnt(2)
  v_mfma_f32_32x32x16_bf16 v[40:55], v[108:111], a[144:147], v[40:55]
  v_mfma_f32_32x32x16_bf16 v[56:71], v[108:111], a[148:151], v[56:71]
  ds_read_b128 v[104:107], v3 offset:10240
  v_mfma_f32_32x32x16_bf16 v[72:87], v[108:111], a[152:155], v[72:87]
  v_mfma_f32_32x32x16_bf16 v[88:103], v[108:111], a[156:159], v[88:103]
  s_waitcnt lgkmcnt(2)
  v_mfma_f32_32x32x16_bf16 v[40:55], v[112:115], a[160:163], v[40:55]
  v_mfma_f32_32x32x16_bf16 v[56:71], v[112:115], a[164:167], v[56:71]
  ds_read_b128 v[108:111], v3 offset:10752
  v_mfma_f32_32x32x16_bf16 v[72:87], v[112:115], a[168:171], v[72:87]
  v_mfma_f32_32x32x16_bf16 v[88:103], v[112:115], a[172:175], v[88:103]
  s_waitcnt lgkmcnt(2)
  v_mfma_f32_32x32x16_bf16 v[40:55], v[116:119], a[176:179], v[40:55]
  v_mfma_f32_32x32x16_bf16 v[56:71], v[116:119], a[180:183], v[56:71]
  ds_read_b128 v[112:115], v3 offset:11264
  v_mfma_f32_32x32x16_bf16 v[72:87], v[116:119], a[184:187], v[72:87]
  v_mfma_f32_32x32x16_bf16 v[88:103], v[116:119], a[188:191], v[88:103]
  s_waitcnt lgkmcnt(2)
  v_mfma_f32_32x32x16_bf16 v[40:55], v[104:107], a[192:195], v[40:55]
  v_mfma_f32_32x32x16_bf16 v[56:71], v[104:107], a[196:199], v[56:71]
  ds_read_b128 v[116:119], v3 offset:11776
  s_waitcnt lgkmcnt(2)
  v_mfma_f32_32x32x16_bf16 v[40:55], v[108:111], a[208:211], v[40:55]
  v_mfma_f32_32x32x16_bf16 v[56:71], v[108:111], a[212:215], v[56:71]
  s_waitcnt lgkmcnt(1)
  v_mfma_f32_32x32x16_bf16 v[40:55], v[112:115], a[224:227], v[40:55]
  v_mfma_f32_32x32x16_bf16 v[56:71], v[112:115], a[228:231], v[56:71]
  s_waitcnt lgkmcnt(0)
  v_mfma_f32_32x32x16_bf16 v[40:55], v[116:119], a[240:243], v[40:55]
  v_mfma_f32_32x32x16_bf16 v[56:71], v[116:119], a[244:247], v[56:71]
  v_mfma_f32_32x32x16_bf16 v[72:87], v[104:107], a[200:203], v[72:87]
  v_mfma_f32_32x32x16_bf16 v[88:103], v[104:107], a[204:207], v[88:103]
  v_cvt_pk_bf16_f32 v212, v40, v56
  v_cvt_pk_bf16_f32 v214, v41, v57
  v_cvt_pk_bf16_f32 v216, v42, v58
  v_cvt_pk_bf16_f32 v218, v43, v59
  v_permlane16_swap_b32 v212, v214
  v_mfma_f32_32x32x16_bf16 v[72:87], v[108:111], a[216:219], v[72:87]
  v_cvt_pk_bf16_f32 v220, v44, v60
  v_cvt_pk_bf16_f32 v222, v45, v61
  v_permlane16_swap_b32 v216, v218
  v_bfi_b32 v212, v254, s42, v212
  v_cvt_pk_bf16_f32 v224, v46, v62
  v_mfma_f32_32x32x16_bf16 v[88:103], v[108:111], a[220:223], v[88:103]
  v_cvt_pk_bf16_f32 v226, v47, v63
  v_permlane16_swap_b32 v220, v222
  v_bfi_b32 v216, v254, s42, v216
  v_cvt_pk_bf16_f32 v228, v48, v64
  v_mfma_f32_32x32x16_bf16 v[72:87], v[112:115], a[232:235], v[72:87]
  v_cvt_pk_bf16_f32 v230, v49, v65
  v_permlane16_swap_b32 v224, v226
  v_bfi_b32 v220, v254, s42, v220
  v_cvt_pk_bf16_f32 v232, v50, v66
  v_cvt_pk_bf16_f32 v234, v51, v67
  v_mfma_f32_32x32x16_bf16 v[88:103], v[112:115], a[236:239], v[88:103]
  v_permlane16_swap_b32 v228, v230
  v_bfi_b32 v224, v254, s42, v224
  v_cvt_pk_bf16_f32 v236, v52, v68
  v_cvt_pk_bf16_f32 v238, v53, v69
  v_mfma_f32_32x32x16_bf16 v[72:87], v[116:119], a[248:251], v[72:87]
  v_permlane16_swap_b32 v232, v234
  v_bfi_b32 v228, v254, s42, v228
  v_cvt_pk_bf16_f32 v240, v54, v70
  v_cvt_pk_bf16_f32 v242, v55, v71
  v_permlane16_swap_b32 v236, v238
  v_mfma_f32_32x32x16_bf16 v[88:103], v[116:119], a[252:255], v[88:103]
  v_bfi_b32 v232, v254, s42, v232
  v_permlane16_swap_b32 v240, v242
  v_bfi_b32 v236, v254, s42, v236
  v_bfi_b32 v240, v254, s42, v240
  s_nop 7
  v_cvt_pk_bf16_f32 v213, v72, v88
  v_cvt_pk_bf16_f32 v215, v73, v89
  v_cvt_pk_bf16_f32 v217, v74, v90
  v_cvt_pk_bf16_f32 v219, v75, v91
  s_add_u32 s78, s86, 0
  v_permlane16_swap_b32 v213, v215
  buffer_store_dwordx4 v[212:215], v4, s[4:7], s78 offen sc1
  v_cvt_pk_bf16_f32 v221, v76, v92
  v_cvt_pk_bf16_f32 v223, v77, v93
  s_add_u32 s78, s86, 32768
  v_permlane16_swap_b32 v217, v219
  buffer_store_dwordx4 v[216:219], v4, s[4:7], s78 offen sc1
  v_cvt_pk_bf16_f32 v225, v78, v94
  v_cvt_pk_bf16_f32 v227, v79, v95
  s_add_u32 s78, s86, 131072
  v_permlane16_swap_b32 v221, v223
  buffer_store_dwordx4 v[220:223], v4, s[4:7], s78 offen sc1
  v_cvt_pk_bf16_f32 v229, v80, v96
  v_cvt_pk_bf16_f32 v231, v81, v97
  s_add_u32 s78, s86, 163840
  v_permlane16_swap_b32 v225, v227
  buffer_store_dwordx4 v[224:227], v4, s[4:7], s78 offen sc1
  v_cvt_pk_bf16_f32 v233, v82, v98
  v_cvt_pk_bf16_f32 v235, v83, v99
  s_add_u32 s78, s86, 262144
  v_permlane16_swap_b32 v229, v231
  buffer_store_dwordx4 v[228:231], v4, s[4:7], s78 offen sc1
  v_cvt_pk_bf16_f32 v237, v84, v100
  v_cvt_pk_bf16_f32 v239, v85, v101
  s_add_u32 s78, s86, 294912
  v_permlane16_swap_b32 v233, v235
  buffer_store_dwordx4 v[232:235], v4, s[4:7], s78 offen sc1
  v_cvt_pk_bf16_f32 v241, v86, v102
  v_cvt_pk_bf16_f32 v243, v87, v103
  s_add_u32 s78, s86, 393216
  v_permlane16_swap_b32 v237, v239
  buffer_store_dwordx4 v[236:239], v4, s[4:7], s78 offen sc1
  s_add_u32 s78, s86, 425984
  v_permlane16_swap_b32 v241, v243
  buffer_store_dwordx4 v[240:243], v4, s[4:7], s78 offen sc1
  s_branch o_we_197
o_wr1_195:
  s_nop 3
  v_mul_f32 v112, s24, v112
  v_mul_f32 v113, s24, v113
  v_exp_f32 v64, v112
  v_exp_f32 v65, v113
  v_max_f32 v116, v111, v116
  v_max3_f32 v116, v112, v113, v116
  v_add_f32 v117, v117, v64
  v_add_f32 v118, v118, v65
  v_add_f32 v117, v117, v118
  s_mov_b32 s28, 0x21800000
  v_mov_b32 v118, v117
  s_nop 1
  v_permlane16_swap_b32 v117, v118
  v_add_f32 v117, v117, v118
  v_mov_b32 v118, v117
  s_nop 0
  s_nop 0
  v_permlane32_swap_b32 v117, v118
  v_add_f32 v117, v117, v118
  s_mov_b32 s67, 0
  s_mov_b64 vcc, 0
  s_waitcnt vmcnt(3)
o_pl_203:
  v_and_b32 v7, 1, v7
  v_cmp_ne_u32 vcc, s96, v7
  s_cbranch_vccz o_pk_204
  buffer_load_dword v7, v255, s[4:7], s97 offen sc1
  s_add_u32 s67, s67, 1
  s_cmp_gt_u32 s67, 1048576
  s_cbranch_scc1 L_end
  s_waitcnt vmcnt(0)
  s_branch o_pl_203
o_pk_204:
  s_lshl_b32 s94, s43, 14
  s_add_u32 s94, s94, s95
  buffer_load_dwordx4 v[120:123], v5, s[4:7], s94 offen offset:0 sc1
  v_cmp_lt_f32 vcc, 0x42700000, v116
  v_cmp_gt_f32 s[30:31], s28, v117
  v_rcp_f32 v117, v117
  buffer_load_dwordx4 v[124:127], v5, s[4:7], s94 offen offset:512 sc1
  s_or_b64 vcc, vcc, s[30:31]
  s_cbranch_vccnz o_fb_201
o_fbr_202:
  buffer_load_dwordx4 v[128:131], v5, s[4:7], s94 offen offset:256 sc1
  v_pk_mul_f32 v[56:57], v[56:57], v[116:117] op_sel:[0,1] op_sel_hi:[1,1]
  v_pk_mul_f32 v[58:59], v[58:59], v[116:117] op_sel:[0,1] op_sel_hi:[1,1]
  v_pk_mul_f32 v[60:61], v[60:61], v[116:117] op_sel:[0,1] op_sel_hi:[1,1]
  v_pk_mul_f32 v[62:63], v[62:63], v[116:117] op_sel:[0,1] op_sel_hi:[1,1]
  v_pk_mul_f32 v[64:65], v[64:65], v[116:117] op_sel:[0,1] op_sel_hi:[1,1]
  buffer_load_dwordx4 v[132:135], v5, s[4:7], s94 offen offset:768 sc1
  v_cvt_pk_bf16_f32 v116, v56, v57
  v_cvt_pk_bf16_f32 v117, v58, v59
  v_cvt_pk_bf16_f32 v118, v60, v61
  v_cvt_pk_bf16_f32 v119, v62, v63
  s_waitcnt lgkmcnt(0)
  s_nop 0
  v_mfma_f32_16x16x32_bf16 v[72:75], v[152:155], v[116:119], 0
  s_add_u32 s62, s62, 1
  v_cvt_pk_bf16_f32 v197, v64, v65
  v_cvt_pk_bf16_f32 v198, v64, v65
  v_mfma_f32_16x16x32_bf16 v[76:79], v[156:159], v[116:119], 0
  s_add_u32 s94, s94, 4096
  buffer_load_dwordx4 v[136:139], v5, s[4:7], s94 offen offset:0 sc1
  s_xor_b32 s86, s86, 524288
  v_mfma_f32_16x16x32_bf16 v[80:83], v[160:163], v[116:119], 0
  s_bfe_u32 s42, s62, 0x10001
  v_mfma_f32_16x16x32_bf16 v[84:87], v[164:167], v[116:119], 0
  buffer_load_dwordx4 v[140:143], v5, s[4:7], s94 offen offset:512 sc1
  v_mfma_f32_16x16x32_bf16 v[88:91], v[168:171], v[116:119], 0
  v_mfma_f32_16x16x32_bf16 v[92:95], v[172:175], v[116:119], 0
  buffer_load_dwordx4 v[144:147], v5, s[4:7], s94 offen offset:256 sc1
  v_mfma_f32_16x16x32_bf16 v[96:99], v[176:179], v[116:119], 0
  v_mfma_f32_16x16x32_bf16 v[100:103], v[180:183], v[116:119], 0
  buffer_load_dwordx4 v[148:151], v5, s[4:7], s94 offen offset:768 sc1
  v_mfma_f32_16x16x16_bf16 v[72:75], v[200:201], v[198:199], v[72:75]
  s_nop 1
  v_mfma_f32_16x16x16_bf16 v[76:79], v[200:201], v[196:197], v[76:79]
  s_add_u32 s94, s94, 4096
  buffer_load_dwordx4 v[152:155], v5, s[4:7], s94 offen offset:0 sc1
  v_mfma_f32_16x16x16_bf16 v[80:83], v[202:203], v[198:199], v[80:83]
  s_nop 1
  v_mfma_f32_16x16x16_bf16 v[84:87], v[202:203], v[196:197], v[84:87]
  buffer_load_dwordx4 v[156:159], v5, s[4:7], s94 offen offset:512 sc1
  v_mfma_f32_16x16x16_bf16 v[88:91], v[204:205], v[198:199], v[88:91]
  s_nop 0
  v_cvt_pk_bf16_f32 v40, v72, v73
  v_cvt_pk_bf16_f32 v41, v74, v75
  v_mfma_f32_16x16x16_bf16 v[92:95], v[204:205], v[196:197], v[92:95]
  buffer_load_dwordx4 v[160:163], v5, s[4:7], s94 offen offset:256 sc1
  v_cvt_pk_bf16_f32 v42, v76, v77
  v_cvt_pk_bf16_f32 v43, v78, v79
  v_mfma_f32_16x16x16_bf16 v[96:99], v[206:207], v[198:199], v[96:99]
  s_nop 0
  ds_write_b128 v6, v[40:43] offset:0
  v_cvt_pk_bf16_f32 v44, v80, v81
  v_mfma_f32_16x16x16_bf16 v[100:103], v[206:207], v[196:197], v[100:103]
  buffer_load_dwordx4 v[164:167], v5, s[4:7], s94 offen offset:768 sc1
  v_cvt_pk_bf16_f32 v45, v82, v83
  v_cvt_pk_bf16_f32 v46, v84, v85
  v_cvt_pk_bf16_f32 v47, v86, v87
  ds_write_b128 v6, v[44:47] offset:1024
  v_cvt_pk_bf16_f32 v48, v88, v89
  v_cvt_pk_bf16_f32 v49, v90, v91
  v_cvt_pk_bf16_f32 v50, v92, v93
  v_cvt_pk_bf16_f32 v51, v94, v95
  s_add_u32 s94, s94, 4096
  buffer_load_dwordx4 v[168:171], v5, s[4:7], s94 offen offset:0 sc1
  ds_write_b128 v6, v[48:51] offset:2048
  v_cvt_pk_bf16_f32 v52, v96, v97
  v_cvt_pk_bf16_f32 v53, v98, v99
  v_cvt_pk_bf16_f32 v54, v100, v101
  v_cvt_pk_bf16_f32 v55, v102, v103
  ds_write_b128 v6, v[52:55] offset:3072
  buffer_load_dwordx4 v[172:175], v5, s[4:7], s94 offen offset:512 sc1
  s_and_b32 s26, s65, 49152
  s_cbranch_scc1 o_wr2_196
  s_waitcnt lgkmcnt(0)
  s_barrier
  ds_read_b128 v[104:107], v3 offset:0
  ds_read_b128 v[108:111], v3 offset:512
  ds_read_b128 v[112:115], v3 offset:1024
  buffer_load_dwordx4 v[176:179], v5, s[4:7], s94 offen offset:256 sc1
  buffer_load_dwordx4 v[180:183], v5, s[4:7], s94 offen offset:768 sc1
  s_waitcnt lgkmcnt(2)
  v_mfma_f32_32x32x16_bf16 v[40:55], v[104:107], a[0:3], 0
  v_mov_b64 v[188:189], 0
  v_mov_b64 v[190:191], 0
  v_mov_b64 v[192:193], 0
  v_mov_b64 v[194:195], 0
  s_mov_b64 exec, 1
  buffer_store_dword v38, off, s[4:7], s84 sc1
  s_mov_b64 exec, -1
  s_mov_b32 s84, 268435456
  v_mfma_f32_32x32x16_bf16 v[56:71], v[104:107], a[4:7], 0
  ds_read_b128 v[116:119], v3 offset:1536
  v_mfma_f32_32x32x16_bf16 v[72:87], v[104:107], a[8:11], 0
  v_mfma_f32_32x32x16_bf16 v[88:103], v[104:107], a[12:15], 0
  s_waitcnt vmcnt(13)
  v_xor_b32 v7, s96, v120
  v_bitop3_b32 v7, v7, v124, s96 bitop3:0xf6
  v_bitop3_b32 v7, v7, v128, s96 bitop3:0xf6
  v_bitop3_b32 v7, v7, v132, s96 bitop3:0xf6
  s_waitcnt lgkmcnt(2)
  v_mfma_f32_32x32x16_bf16 v[40:55], v[108:111], a[16:19], v[40:55]
  s_waitcnt vmcnt(9)
  v_bitop3_b32 v7, v7, v136, s96 bitop3:0xf6
  v_bitop3_b32 v7, v7, v140, s96 bitop3:0xf6
  v_bitop3_b32 v7, v7, v144, s96 bitop3:0xf6
  v_bitop3_b32 v7, v7, v148, s96 bitop3:0xf6
  s_waitcnt vmcnt(5)
  v_mfma_f32_32x32x16_bf16 v[56:71], v[108:111], a[20:23], v[56:71]
  ds_read_b128 v[104:107], v3 offset:2048
  v_bitop3_b32 v7, v7, v152, s96 bitop3:0xf6
  v_bitop3_b32 v7, v7, v156, s96 bitop3:0xf6
  v_bitop3_b32 v7, v7, v160, s96 bitop3:0xf6
  v_bitop3_b32 v7, v7, v164, s96 bitop3:0xf6
  s_waitcnt vmcnt(1)
  v_mfma_f32_32x32x16_bf16 v[72:87], v[108:111], a[24:27], v[72:87]
  v_bitop3_b32 v7, v7, v168, s96 bitop3:0xf6
  v_bitop3_b32 v7, v7, v172, s96 bitop3:0xf6
  v_bitop3_b32 v7, v7, v176, s96 bitop3:0xf6
  v_bitop3_b32 v7, v7, v180, s96 bitop3:0xf6
  v_and_b32 v7, v254, v7
  v_cmp_ne_u32 vcc, 0, v7
  s_cbranch_vccnz o_rt_205
o_bk_206:
  v_mfma_f32_32x32x16_bf16 v[88:103], v[108:111], a[28:31], v[88:103]
  v_smfmac_f32_16x16x64_bf16 v[188:191], v[16:19], v[120:127], v20
  v_lshlrev_b32 v196, 16, v184
  v_smfmac_f32_16x16x64_bf16 v[192:195], v[16:19], v[128:135], v20
  v_and_b32 v197, 0xffff0000, v184
  v_smfmac_f32_16x16x64_bf16 v[188:191], v[16:19], v[136:143], v20
  v_lshlrev_b32 v198, 16, v185
  s_waitcnt lgkmcnt(2)
  v_mfma_f32_32x32x16_bf16 v[40:55], v[112:115], a[32:35], v[40:55]
  v_smfmac_f32_16x16x64_bf16 v[192:195], v[16:19], v[144:151], v20
  v_and_b32 v199, 0xffff0000, v185
  v_smfmac_f32_16x16x64_bf16 v[188:191], v[16:19], v[152:159], v20
  v_lshlrev_b32 v200, 16, v186
  v_smfmac_f32_16x16x64_bf16 v[192:195], v[16:19], v[160:167], v20
  v_and_b32 v201, 0xffff0000, v186
  v_mfma_f32_32x32x16_bf16 v[56:71], v[112:115], a[36:39], v[56:71]
  ds_read_b128 v[108:111], v3 offset:2560
  v_smfmac_f32_16x16x64_bf16 v[188:191], v[16:19], v[168:175], v20
  v_lshlrev_b32 v202, 16, v187
  v_smfmac_f32_16x16x64_bf16 v[192:195], v[16:19], v[176:183], v20
  v_and_b32 v203, 0xffff0000, v187
  s_bfe_u32 s92, s65, 131086
  v_mfma_f32_32x32x16_bf16 v[72:87], v[112:115], a[40:43], v[72:87]
  s_lshl_b32 s92, s92, 21
  s_add_u32 s92, s92, s91
  s_add_u32 s93, s92, 27262976
  s_add_u32 s92, s92, 20971520
  v_permlane16_swap_b32 v188, v192
  v_mfma_f32_32x32x16_bf16 v[88:103], v[112:115], a[44:47], v[88:103]
  v_permlane16_swap_b32 v189, v193
  v_permlane16_swap_b32 v190, v194
  v_permlane16_swap_b32 v191, v195
  s_waitcnt lgkmcnt(2)
  v_mfma_f32_32x32x16_bf16 v[40:55], v[116:119], a[48:51], v[40:55]
  v_cvt_pk_bf16_f32 v188, 0, v188
  v_cvt_pk_bf16_f32 v189, 0, v189
  v_cvt_pk_bf16_f32 v190, 0, v190
  v_cvt_pk_bf16_f32 v191, 0, v191
  v_cvt_pk_bf16_f32 v192, 0, v192
  v_cvt_pk_bf16_f32 v193, 0, v193
  v_mfma_f32_32x32x16_bf16 v[56:71], v[116:119], a[52:55], v[56:71]
  ds_read_b128 v[112:115], v3 offset:3072
  v_cvt_pk_bf16_f32 v194, 0, v194
  v_cvt_pk_bf16_f32 v195, 0, v195
  v_add_f32 v196, v196, v188
  v_add_f32 v197, v197, v189
  v_add_f32 v198, v198, v190
  v_mfma_f32_32x32x16_bf16 v[72:87], v[116:119], a[56:59], v[72:87]
  v_add_f32 v199, v199, v191
  v_add_f32 v200, v200, v192
  v_add_f32 v201, v201, v193
  v_add_f32 v202, v202, v194
  v_add_f32 v203, v203, v195
  v_cvt_pk_bf16_f32 v120, v196, v197
  v_mfma_f32_32x32x16_bf16 v[88:103], v[116:119], a[60:63], v[88:103]
  v_cvt_pk_bf16_f32 v121, v198, v199
  v_cvt_pk_bf16_f32 v122, v200, v201
  v_cvt_pk_bf16_f32 v123, v202, v203
  v_lshlrev_b32 v196, 16, v120
  v_and_b32 v197, 0xffff0000, v120
  s_waitcnt lgkmcnt(2)
  v_mfma_f32_32x32x16_bf16 v[40:55], v[104:107], a[64:67], v[40:55]
  v_lshlrev_b32 v198, 16, v121
  v_and_b32 v199, 0xffff0000, v121
  v_lshlrev_b32 v200, 16, v122
  v_and_b32 v201, 0xffff0000, v122
  v_lshlrev_b32 v202, 16, v123
  v_and_b32 v203, 0xffff0000, v123
  v_mfma_f32_32x32x16_bf16 v[56:71], v[104:107], a[68:71], v[56:71]
  ds_read_b128 v[116:119], v3 offset:3584
  buffer_store_dwordx4 v[120:123], v0, s[4:7], s92 offen sc1
  v_add_f32 v136, v196, v197
  v_mul_f32 v137, v196, v196
  v_mfma_f32_32x32x16_bf16 v[72:87], v[104:107], a[72:75], v[72:87]
  v_add_f32 v138, v198, v199
  v_mul_f32 v139, v197, v197
  v_fmac_f32 v137, v198, v198
  v_fmac_f32 v139, v199, v199
  v_add_f32 v136, v136, v200
  v_fmac_f32 v137, v200, v200
  v_mfma_f32_32x32x16_bf16 v[88:103], v[104:107], a[76:79], v[88:103]
  v_add_f32 v138, v138, v201
  v_fmac_f32 v139, v201, v201
  v_add_f32 v136, v136, v202
  v_fmac_f32 v137, v202, v202
  v_add_f32 v138, v138, v203
  s_waitcnt lgkmcnt(2)
  v_mfma_f32_32x32x16_bf16 v[40:55], v[108:111], a[80:83], v[40:55]
  v_fmac_f32 v139, v203, v203
  v_add_f32 v136, v136, v138
  v_add_f32 v137, v137, v139
  s_nop 0
  v_add_f32_dpp v136, v136, v136 row_ror:8 row_mask:0xf bank_mask:0xf
  v_add_f32_dpp v137, v137, v137 row_ror:8 row_mask:0xf bank_mask:0xf
  s_nop 0
  v_add_f32_dpp v136, v136, v136 row_ror:4 row_mask:0xf bank_mask:0xf
  v_mfma_f32_32x32x16_bf16 v[56:71], v[108:111], a[84:87], v[56:71]
  ds_read_b128 v[104:107], v3 offset:8192
  v_add_f32_dpp v137, v137, v137 row_ror:4 row_mask:0xf bank_mask:0xf
  v_add_f32_dpp v136, v136, v136 row_ror:2 row_mask:0xf bank_mask:0xf
  s_nop 0
  v_add_f32_dpp v137, v137, v137 row_ror:2 row_mask:0xf bank_mask:0xf
  v_add_f32_dpp v136, v136, v136 row_ror:1 row_mask:0xf bank_mask:0xf
  s_nop 0
  v_add_f32_dpp v137, v137, v137 row_ror:1 row_mask:0xf bank_mask:0xf
  v_mfma_f32_32x32x16_bf16 v[72:87], v[108:111], a[88:91], v[72:87]
  v_mov_b32 v140, v136
  v_mov_b32 v141, v137
  s_nop 0
  v_permlane16_swap_b32 v136, v140
  v_permlane16_swap_b32 v137, v141
  v_mfma_f32_32x32x16_bf16 v[88:103], v[108:111], a[92:95], v[88:103]
  v_add_f32 v136, v136, v140
  v_add_f32 v137, v137, v141
  v_mov_b32 v140, v136
  v_mov_b32 v141, v137
  s_nop 0
  v_permlane32_swap_b32 v136, v140
  s_waitcnt lgkmcnt(2)
  v_mfma_f32_32x32x16_bf16 v[40:55], v[112:115], a[96:99], v[40:55]
  v_permlane32_swap_b32 v137, v141
  v_add_f32 v136, v136, v140
  v_add_f32 v137, v137, v141
  v_mul_f32 v136, 0x3b000000, v136
  v_mul_f32 v137, 0x3b000000, v137
  v_mfma_f32_32x32x16_bf16 v[56:71], v[112:115], a[100:103], v[56:71]
  ds_read_b128 v[108:111], v3 offset:8704
  v_fma_f32 v137, -v136, v136, v137
  v_cvt_pk_bf16_f32 v136, 0, v136
  v_max_f32 v137, 0, v137
  v_sub_f32 v140, v196, v136
  v_sub_f32 v141, v197, v136
  v_mfma_f32_32x32x16_bf16 v[72:87], v[112:115], a[104:107], v[72:87]
  v_cvt_pk_bf16_f32 v137, 0, v137
  v_sub_f32 v142, v198, v136
  v_sub_f32 v143, v199, v136
  v_add_f32 v137, 0x3727c5ac, v137
  v_sub_f32 v144, v200, v136
  v_sub_f32 v145, v201, v136
  v_mfma_f32_32x32x16_bf16 v[88:103], v[112:115], a[108:111], v[88:103]
  v_cvt_pk_bf16_f32 v137, 0, v137
  v_sub_f32 v146, v202, v136
  v_sub_f32 v147, v203, v136
  v_sqrt_f32 v137, v137
  s_waitcnt lgkmcnt(2)
  v_mfma_f32_32x32x16_bf16 v[40:55], v[116:119], a[112:115], v[40:55]
  v_cvt_pk_bf16_f32 v140, 0, v140
  v_cvt_pk_bf16_f32 v141, 0, v141
  v_cvt_pk_bf16_f32 v137, 0, v137
  v_cvt_pk_bf16_f32 v142, 0, v142
  v_cvt_pk_bf16_f32 v143, 0, v143
  v_rcp_f32 v137, v137
  v_mfma_f32_32x32x16_bf16 v[56:71], v[116:119], a[116:119], v[56:71]
  ds_read_b128 v[112:115], v3 offset:9216
  v_cvt_pk_bf16_f32 v144, 0, v144
  v_cvt_pk_bf16_f32 v145, 0, v145
  v_cvt_pk_bf16_f32 v146, 0, v146
  v_cvt_pk_bf16_f32 v147, 0, v147
  v_mul_f32 v140, v140, v137
  v_mfma_f32_32x32x16_bf16 v[72:87], v[116:119], a[120:123], v[72:87]
  v_mul_f32 v141, v141, v137
  v_mul_f32 v142, v142, v137
  v_mul_f32 v143, v143, v137
  v_mul_f32 v144, v144, v137
  v_mul_f32 v145, v145, v137
  v_mul_f32 v146, v146, v137
  v_mfma_f32_32x32x16_bf16 v[88:103], v[116:119], a[124:127], v[88:103]
  v_mul_f32 v147, v147, v137
  v_cvt_pk_bf16_f32 v124, v140, v141
  v_cvt_pk_bf16_f32 v125, v142, v143
  v_cvt_pk_bf16_f32 v126, v144, v145
  v_cvt_pk_bf16_f32 v127, v146, v147
  s_waitcnt lgkmcnt(2)
  v_mfma_f32_32x32x16_bf16 v[40:55], v[104:107], a[128:131], v[40:55]
  v_lshlrev_b32 v204, 16, v124
  v_and_b32 v205, 0xffff0000, v124
  v_lshlrev_b32 v206, 16, v125
  v_and_b32 v207, 0xffff0000, v125
  v_lshlrev_b32 v208, 16, v126
  v_and_b32 v209, 0xffff0000, v126
  v_mfma_f32_32x32x16_bf16 v[56:71], v[104:107], a[132:135], v[56:71]
  ds_read_b128 v[116:119], v3 offset:9728
  v_lshlrev_b32 v210, 16, v127
  v_and_b32 v211, 0xffff0000, v127
  buffer_store_dwordx4 v[124:127], v0, s[4:7], s93 offen sc1
  v_mfma_f32_32x32x16_bf16 v[72:87], v[104:107], a[136:139], v[72:87]
  v_add_f32 v196, v196, v204
  v_add_f32 v197, v197, v205
  v_add_f32 v198, v198, v206
  v_add_f32 v199, v199, v207
  v_add_f32 v200, v200, v208
  v_add_f32 v201, v201, v209
  v_mfma_f32_32x32x16_bf16 v[88:103], v[104:107], a[140:143], v[88:103]
  v_add_f32 v202, v202, v210
  v_add_f32 v203, v203, v211
  v_cvt_pk_bf16_f32 v128, v196, v197
  v_cvt_pk_bf16_f32 v129, v198, v199
  v_cvt_pk_bf16_f32 v130, v200, v201
  s_waitcnt lgkmcnt(2)
  v_mfma_f32_32x32x16_bf16 v[40:55], v[108:111], a[144:147], v[40:55]
  v_cvt_pk_bf16_f32 v131, v202, v203
  v_mul_f32 v188, v204, v8
  v_mul_f32 v189, v205, v9
  v_fmac_f32 v188, v206, v10
  v_fmac_f32 v189, v207, v11
  v_fmac_f32 v188, v208, v12
  v_mfma_f32_32x32x16_bf16 v[56:71], v[108:111], a[148:151], v[56:71]
  ds_read_b128 v[104:107], v3 offset:10240
  v_fmac_f32 v189, v209, v13
  v_fmac_f32 v188, v210, v14
  v_fmac_f32 v189, v211, v15
  v_add_f32 v188, v188, v189
  s_add_u32 s92, s91, 10485760
  v_mfma_f32_32x32x16_bf16 v[72:87], v[108:111], a[152:155], v[72:87]
  s_add_u32 s93, s91, 8388608
  buffer_store_dwordx4 v[128:131], v0, s[4:7], s92 offen sc1
  v_lshlrev_b32 v196, 16, v128
  v_and_b32 v197, 0xffff0000, v128
  v_mfma_f32_32x32x16_bf16 v[88:103], v[108:111], a[156:159], v[88:103]
  v_lshlrev_b32 v198, 16, v129
  v_and_b32 v199, 0xffff0000, v129
  v_lshlrev_b32 v200, 16, v130
  v_and_b32 v201, 0xffff0000, v130
  v_lshlrev_b32 v202, 16, v131
  s_waitcnt lgkmcnt(2)
  v_mfma_f32_32x32x16_bf16 v[40:55], v[112:115], a[160:163], v[40:55]
  v_and_b32 v203, 0xffff0000, v131
  v_add_f32 v136, v196, v197
  v_mul_f32 v137, v196, v196
  v_add_f32 v138, v198, v199
  v_mul_f32 v139, v197, v197
  v_fmac_f32 v137, v198, v198
  v_mfma_f32_32x32x16_bf16 v[56:71], v[112:115], a[164:167], v[56:71]
  ds_read_b128 v[108:111], v3 offset:10752
  v_fmac_f32 v139, v199, v199
  v_add_f32 v136, v136, v200
  v_fmac_f32 v137, v200, v200
  v_add_f32 v138, v138, v201
  v_fmac_f32 v139, v201, v201
  v_mfma_f32_32x32x16_bf16 v[72:87], v[112:115], a[168:171], v[72:87]
  v_add_f32 v136, v136, v202
  v_fmac_f32 v137, v202, v202
  v_add_f32 v138, v138, v203
  v_fmac_f32 v139, v203, v203
  v_add_f32 v136, v136, v138
  v_add_f32 v137, v137, v139
  v_mfma_f32_32x32x16_bf16 v[88:103], v[112:115], a[172:175], v[88:103]
  v_add_f32_dpp v136, v136, v136 row_ror:8 row_mask:0xf bank_mask:0xf
  v_add_f32_dpp v137, v137, v137 row_ror:8 row_mask:0xf bank_mask:0xf
  v_add_f32_dpp v188, v188, v188 row_ror:8 row_mask:0xf bank_mask:0xf
  v_add_f32_dpp v136, v136, v136 row_ror:4 row_mask:0xf bank_mask:0xf
  v_add_f32_dpp v137, v137, v137 row_ror:4 row_mask:0xf bank_mask:0xf
  s_waitcnt lgkmcnt(2)
  v_mfma_f32_32x32x16_bf16 v[40:55], v[116:119], a[176:179], v[40:55]
  v_add_f32_dpp v188, v188, v188 row_ror:4 row_mask:0xf bank_mask:0xf
  v_add_f32_dpp v136, v136, v136 row_ror:2 row_mask:0xf bank_mask:0xf
  v_add_f32_dpp v137, v137, v137 row_ror:2 row_mask:0xf bank_mask:0xf
  v_add_f32_dpp v188, v188, v188 row_ror:2 row_mask:0xf bank_mask:0xf
  v_add_f32_dpp v136, v136, v136 row_ror:1 row_mask:0xf bank_mask:0xf
  v_add_f32_dpp v137, v137, v137 row_ror:1 row_mask:0xf bank_mask:0xf
  v_mfma_f32_32x32x16_bf16 v[56:71], v[116:119], a[180:183], v[56:71]
  ds_read_b128 v[112:115], v3 offset:11264
  v_add_f32_dpp v188, v188, v188 row_ror:1 row_mask:0xf bank_mask:0xf
  v_mov_b32 v140, v136
  v_mov_b32 v141, v137
  v_mov_b32 v142, v188
  v_permlane16_swap_b32 v136, v140
  v_mfma_f32_32x32x16_bf16 v[72:87], v[116:119], a[184:187], v[72:87]
  v_permlane16_swap_b32 v137, v141
  v_permlane16_swap_b32 v188, v142
  v_add_f32 v136, v136, v140
  v_add_f32 v137, v137, v141
  v_mfma_f32_32x32x16_bf16 v[88:103], v[116:119], a[188:191], v[88:103]
  v_add_f32 v188, v188, v142
  v_mov_b32 v140, v136
  v_mov_b32 v141, v137
  v_mov_b32 v142, v188
  v_permlane32_swap_b32 v136, v140
  s_waitcnt lgkmcnt(2)
  v_mfma_f32_32x32x16_bf16 v[40:55], v[104:107], a[192:195], v[40:55]
  v_permlane32_swap_b32 v137, v141
  v_permlane32_swap_b32 v188, v142
  v_add_f32 v136, v136, v140
  v_add_f32 v137, v137, v141
  v_mfma_f32_32x32x16_bf16 v[56:71], v[104:107], a[196:199], v[56:71]
  ds_read_b128 v[116:119], v3 offset:11776
  v_add_f32 v188, v188, v142
  v_mul_f32 v136, 0x3b000000, v136
  v_mul_f32 v137, 0x3b000000, v137
  v_fma_f32 v137, -v136, v136, v137
  v_cvt_pk_bf16_f32 v136, 0, v136
  s_waitcnt lgkmcnt(2)
  v_mfma_f32_32x32x16_bf16 v[40:55], v[108:111], a[208:211], v[40:55]
  v_max_f32 v137, 0, v137
  v_sub_f32 v140, v196, v136
  v_sub_f32 v141, v197, v136
  v_cvt_pk_bf16_f32 v137, 0, v137
  v_sub_f32 v142, v198, v136
  v_sub_f32 v143, v199, v136
  v_mfma_f32_32x32x16_bf16 v[56:71], v[108:111], a[212:215], v[56:71]
  v_add_f32 v137, 0x3727c5ac, v137
  v_sub_f32 v144, v200, v136
  v_sub_f32 v145, v201, v136
  v_cvt_pk_bf16_f32 v137, 0, v137
  v_sub_f32 v146, v202, v136
  v_sub_f32 v147, v203, v136
  s_waitcnt lgkmcnt(1)
  v_mfma_f32_32x32x16_bf16 v[40:55], v[112:115], a[224:227], v[40:55]
  v_sqrt_f32 v137, v137
  v_cvt_pk_bf16_f32 v140, 0, v140
  v_cvt_pk_bf16_f32 v141, 0, v141
  v_cvt_pk_bf16_f32 v137, 0, v137
  v_cvt_pk_bf16_f32 v142, 0, v142
  v_mfma_f32_32x32x16_bf16 v[56:71], v[112:115], a[228:231], v[56:71]
  v_cvt_pk_bf16_f32 v143, 0, v143
  v_rcp_f32 v137, v137
  v_cvt_pk_bf16_f32 v144, 0, v144
  v_cvt_pk_bf16_f32 v145, 0, v145
  v_cvt_pk_bf16_f32 v146, 0, v146
  s_waitcnt lgkmcnt(0)
  v_mfma_f32_32x32x16_bf16 v[40:55], v[116:119], a[240:243], v[40:55]
  v_cvt_pk_bf16_f32 v147, 0, v147
  v_mul_f32 v140, v140, v137
  v_mul_f32 v141, v141, v137
  v_mul_f32 v142, v142, v137
  v_mul_f32 v143, v143, v137
  v_mul_f32 v144, v144, v137
  v_mfma_f32_32x32x16_bf16 v[56:71], v[116:119], a[244:247], v[56:71]
  v_mul_f32 v145, v145, v137
  v_mul_f32 v146, v146, v137
  v_mul_f32 v147, v147, v137
  v_cvt_pk_bf16_f32 v132, v140, v141
  v_cvt_pk_bf16_f32 v133, v142, v143
  v_cvt_pk_bf16_f32 v134, v144, v145
  v_mfma_f32_32x32x16_bf16 v[72:87], v[104:107], a[200:203], v[72:87]
  v_cvt_pk_bf16_f32 v135, v146, v147
  buffer_store_dwordx4 v[132:135], v0, s[4:7], s93 offen sc1
  v_cvt_pk_bf16_f32 v188, 0, v188
  v_ashrrev_i32 v189, 31, v188
  v_mfma_f32_32x32x16_bf16 v[88:103], v[104:107], a[204:207], v[88:103]
  v_or_b32 v189, 0x80000000, v189
  v_xor_b32 v188, v188, v189
  s_sub_u32 s92, 4095, s90
  v_and_b32 v188, 0xffff0000, v188
  v_or_b32 v38, s92, v188
  v_mfma_f32_32x32x16_bf16 v[72:87], v[108:111], a[216:219], v[72:87]
  s_bfe_u32 s92, s65, 196625
  s_lshl_b32 s92, s92, 18
  s_lshl_b32 s93, s90, 7
  s_add_u32 s92, s92, s93
  s_add_u32 s84, s92, 243269632
  v_cvt_pk_bf16_f32 v212, v40, v56
  v_mfma_f32_32x32x16_bf16 v[88:103], v[108:111], a[220:223], v[88:103]
  v_cvt_pk_bf16_f32 v214, v41, v57
  v_cvt_pk_bf16_f32 v216, v42, v58
  v_cvt_pk_bf16_f32 v218, v43, v59
  v_permlane16_swap_b32 v212, v214
  v_mfma_f32_32x32x16_bf16 v[72:87], v[112:115], a[232:235], v[72:87]
  v_cvt_pk_bf16_f32 v220, v44, v60
  v_cvt_pk_bf16_f32 v222, v45, v61
  v_permlane16_swap_b32 v216, v218
  v_bfi_b32 v212, v254, s42, v212
  v_cvt_pk_bf16_f32 v224, v46, v62
  v_mfma_f32_32x32x16_bf16 v[88:103], v[112:115], a[236:239], v[88:103]
  v_cvt_pk_bf16_f32 v226, v47, v63
  v_permlane16_swap_b32 v220, v222
  v_bfi_b32 v216, v254, s42, v216
  v_cvt_pk_bf16_f32 v228, v48, v64
  v_mfma_f32_32x32x16_bf16 v[72:87], v[116:119], a[248:251], v[72:87]
  v_cvt_pk_bf16_f32 v230, v49, v65
  v_permlane16_swap_b32 v224, v226
  v_bfi_b32 v220, v254, s42, v220
  v_cvt_pk_bf16_f32 v232, v50, v66
  v_cvt_pk_bf16_f32 v234, v51, v67
  v_mfma_f32_32x32x16_bf16 v[88:103], v[116:119], a[252:255], v[88:103]
  v_permlane16_swap_b32 v228, v230
  v_bfi_b32 v224, v254, s42, v224
  v_cvt_pk_bf16_f32 v236, v52, v68
  v_cvt_pk_bf16_f32 v238, v53, v69
  v_permlane16_swap_b32 v232, v234
  v_bfi_b32 v228, v254, s42, v228
  v_cvt_pk_bf16_f32 v240, v54, v70
  v_cvt_pk_bf16_f32 v242, v55, v71
  v_permlane16_swap_b32 v236, v238
  v_bfi_b32 v232, v254, s42, v232
  v_permlane16_swap_b32 v240, v242
  v_bfi_b32 v236, v254, s42, v236
  v_bfi_b32 v240, v254, s42, v240
  v_cvt_pk_bf16_f32 v213, v72, v88
  v_cvt_pk_bf16_f32 v215, v73, v89
  v_cvt_pk_bf16_f32 v217, v74, v90
  v_cvt_pk_bf16_f32 v219, v75, v91
  s_add_u32 s78, s86, 0
  v_permlane16_swap_b32 v213, v215
  buffer_store_dwordx4 v[212:215], v4, s[4:7], s78 offen sc1
  v_cvt_pk_bf16_f32 v221, v76, v92
  v_cvt_pk_bf16_f32 v223, v77, v93
  s_add_u32 s78, s86, 32768
  v_permlane16_swap_b32 v217, v219
  buffer_store_dwordx4 v[216:219], v4, s[4:7], s78 offen sc1
  v_cvt_pk_bf16_f32 v225, v78, v94
  v_cvt_pk_bf16_f32 v227, v79, v95
  s_add_u32 s78, s86, 131072
  v_permlane16_swap_b32 v221, v223
  buffer_store_dwordx4 v[220:223], v4, s[4:7], s78 offen sc1
  v_cvt_pk_bf16_f32 v229, v80, v96
  v_cvt_pk_bf16_f32 v231, v81, v97
  s_add_u32 s78, s86, 163840
  v_permlane16_swap_b32 v225, v227
  buffer_store_dwordx4 v[224:227], v4, s[4:7], s78 offen sc1
  v_cvt_pk_bf16_f32 v233, v82, v98
  v_cvt_pk_bf16_f32 v235, v83, v99
  s_add_u32 s78, s86, 262144
  v_permlane16_swap_b32 v229, v231
  buffer_store_dwordx4 v[228:231], v4, s[4:7], s78 offen sc1
  v_cvt_pk_bf16_f32 v237, v84, v100
  v_cvt_pk_bf16_f32 v239, v85, v101
  s_add_u32 s78, s86, 294912
  v_permlane16_swap_b32 v233, v235
  buffer_store_dwordx4 v[232:235], v4, s[4:7], s78 offen sc1
  v_cvt_pk_bf16_f32 v241, v86, v102
  v_cvt_pk_bf16_f32 v243, v87, v103
  s_add_u32 s78, s86, 393216
  v_permlane16_swap_b32 v237, v239
  buffer_store_dwordx4 v[236:239], v4, s[4:7], s78 offen sc1
  s_add_u32 s78, s86, 425984
  v_permlane16_swap_b32 v241, v243
  buffer_store_dwordx4 v[240:243], v4, s[4:7], s78 offen sc1
  s_waitcnt vmcnt(8)
  s_mov_b64 exec, 1
  buffer_store_dword v38, off, s[4:7], s84 sc1
  s_mov_b64 exec, -1
  s_mov_b32 s84, 268435456
  s_branch o_we_197
o_rt_205:
  s_mov_b32 s67, 0
o_rl_209:
  s_lshl_b32 s94, s43, 14
  s_add_u32 s94, s94, s95
  buffer_load_dwordx4 v[120:123], v5, s[4:7], s94 offen offset:0 sc1
  buffer_load_dwordx4 v[124:127], v5, s[4:7], s94 offen offset:512 sc1
  buffer_load_dwordx4 v[128:131], v5, s[4:7], s94 offen offset:256 sc1
  buffer_load_dwordx4 v[132:135], v5, s[4:7], s94 offen offset:768 sc1
  s_add_u32 s94, s94, 4096
  buffer_load_dwordx4 v[136:139], v5, s[4:7], s94 offen offset:0 sc1
  buffer_load_dwordx4 v[140:143], v5, s[4:7], s94 offen offset:512 sc1
  buffer_load_dwordx4 v[144:147], v5, s[4:7], s94 offen offset:256 sc1
  buffer_load_dwordx4 v[148:151], v5, s[4:7], s94 offen offset:768 sc1
  s_add_u32 s94, s94, 4096
  buffer_load_dwordx4 v[152:155], v5, s[4:7], s94 offen offset:0 sc1
  buffer_load_dwordx4 v[156:159], v5, s[4:7], s94 offen offset:512 sc1
  buffer_load_dwordx4 v[160:163], v5, s[4:7], s94 offen offset:256 sc1
  buffer_load_dwordx4 v[164:167], v5, s[4:7], s94 offen offset:768 sc1
  s_add_u32 s94, s94, 4096
  buffer_load_dwordx4 v[168:171], v5, s[4:7], s94 offen offset:0 sc1
  buffer_load_dwordx4 v[172:175], v5, s[4:7], s94 offen offset:512 sc1
  buffer_load_dwordx4 v[176:179], v5, s[4:7], s94 offen offset:256 sc1
  buffer_load_dwordx4 v[180:183], v5, s[4:7], s94 offen offset:768 sc1
  s_add_u32 s67, s67, 1
  s_cmp_gt_u32 s67, 1048576
  s_cbranch_scc1 L_end
  s_waitcnt vmcnt(0)
  v_xor_b32 v7, s96, v120
  v_bitop3_b32 v7, v7, v124, s96 bitop3:0xf6
  v_bitop3_b32 v7, v7, v128, s96 bitop3:0xf6
  v_bitop3_b32 v7, v7, v132, s96 bitop3:0xf6
  v_bitop3_b32 v7, v7, v136, s96 bitop3:0xf6
  v_bitop3_b32 v7, v7, v140, s96 bitop3:0xf6
  v_bitop3_b32 v7, v7, v144, s96 bitop3:0xf6
  v_bitop3_b32 v7, v7, v148, s96 bitop3:0xf6
  v_bitop3_b32 v7, v7, v152, s96 bitop3:0xf6
  v_bitop3_b32 v7, v7, v156, s96 bitop3:0xf6
  v_bitop3_b32 v7, v7, v160, s96 bitop3:0xf6
  v_bitop3_b32 v7, v7, v164, s96 bitop3:0xf6
  v_bitop3_b32 v7, v7, v168, s96 bitop3:0xf6
  v_bitop3_b32 v7, v7, v172, s96 bitop3:0xf6
  v_bitop3_b32 v7, v7, v176, s96 bitop3:0xf6
  v_bitop3_b32 v7, v7, v180, s96 bitop3:0xf6
  v_and_b32 v7, v254, v7
  v_cmp_ne_u32 vcc, 0, v7
  s_cbranch_vccnz o_rl_209
  s_branch o_bk_206
o_rt_207:
  s_mov_b32 s67, 0
o_rl_210:
  s_lshl_b32 s94, s43, 14
  s_add_u32 s94, s94, s95
  buffer_load_dwordx4 v[120:123], v5, s[4:7], s94 offen offset:0 sc1
  buffer_load_dwordx4 v[124:127], v5, s[4:7], s94 offen offset:512 sc1
  buffer_load_dwordx4 v[128:131], v5, s[4:7], s94 offen offset:256 sc1
  buffer_load_dwordx4 v[132:135], v5, s[4:7], s94 offen offset:768 sc1
  s_add_u32 s94, s94, 4096
  buffer_load_dwordx4 v[136:139], v5, s[4:7], s94 offen offset:0 sc1
  buffer_load_dwordx4 v[140:143], v5, s[4:7], s94 offen offset:512 sc1
  buffer_load_dwordx4 v[144:147], v5, s[4:7], s94 offen offset:256 sc1
  buffer_load_dwordx4 v[148:151], v5, s[4:7], s94 offen offset:768 sc1
  s_add_u32 s94, s94, 4096
  buffer_load_dwordx4 v[152:155], v5, s[4:7], s94 offen offset:0 sc1
  buffer_load_dwordx4 v[156:159], v5, s[4:7], s94 offen offset:512 sc1
  buffer_load_dwordx4 v[160:163], v5, s[4:7], s94 offen offset:256 sc1
  buffer_load_dwordx4 v[164:167], v5, s[4:7], s94 offen offset:768 sc1
  s_add_u32 s94, s94, 4096
  buffer_load_dwordx4 v[168:171], v5, s[4:7], s94 offen offset:0 sc1
  buffer_load_dwordx4 v[172:175], v5, s[4:7], s94 offen offset:512 sc1
  buffer_load_dwordx4 v[176:179], v5, s[4:7], s94 offen offset:256 sc1
  buffer_load_dwordx4 v[180:183], v5, s[4:7], s94 offen offset:768 sc1
  s_add_u32 s67, s67, 1
  s_cmp_gt_u32 s67, 1048576
  s_cbranch_scc1 L_end
  s_waitcnt vmcnt(0)
  v_xor_b32 v7, s96, v120
  v_bitop3_b32 v7, v7, v124, s96 bitop3:0xf6
  v_bitop3_b32 v7, v7, v128, s96 bitop3:0xf6
  v_bitop3_b32 v7, v7, v132, s96 bitop3:0xf6
  v_bitop3_b32 v7, v7, v136, s96 bitop3:0xf6
  v_bitop3_b32 v7, v7, v140, s96 bitop3:0xf6
  v_bitop3_b32 v7, v7, v144, s96 bitop3:0xf6
  v_bitop3_b32 v7, v7, v148, s96 bitop3:0xf6
  v_bitop3_b32 v7, v7, v152, s96 bitop3:0xf6
  v_bitop3_b32 v7, v7, v156, s96 bitop3:0xf6
  v_bitop3_b32 v7, v7, v160, s96 bitop3:0xf6
  v_bitop3_b32 v7, v7, v164, s96 bitop3:0xf6
  v_bitop3_b32 v7, v7, v168, s96 bitop3:0xf6
  v_bitop3_b32 v7, v7, v172, s96 bitop3:0xf6
  v_bitop3_b32 v7, v7, v176, s96 bitop3:0xf6
  v_bitop3_b32 v7, v7, v180, s96 bitop3:0xf6
  v_and_b32 v7, v254, v7
  v_cmp_ne_u32 vcc, 0, v7
  s_cbranch_vccnz o_rl_210
  s_branch o_bk_208
o_fb_199:
  v_mov_b32 v118, v116
  s_nop 1
  v_permlane16_swap_b32 v116, v118
  v_max_f32 v116, v116, v118
  v_mov_b32 v118, v116
  s_nop 0
  s_nop 0
  v_permlane32_swap_b32 v116, v118
  v_max_f32 v116, v116, v118
  v_sub_f32 v56, v104, v116
  v_sub_f32 v57, v105, v116
  v_sub_f32 v58, v106, v116
  v_sub_f32 v59, v107, v116
  v_sub_f32 v60, v108, v116
  v_sub_f32 v61, v109, v116
  v_sub_f32 v62, v110, v116
  v_sub_f32 v63, v111, v116
  v_sub_f32 v64, v112, v116
  v_sub_f32 v65, v113, v116
  v_exp_f32 v56, v56
  v_exp_f32 v57, v57
  v_exp_f32 v58, v58
  v_exp_f32 v59, v59
  v_exp_f32 v60, v60
  v_exp_f32 v61, v61
  v_exp_f32 v62, v62
  v_exp_f32 v63, v63
  v_exp_f32 v64, v64
  v_exp_f32 v65, v65
  v_add_f32 v117, v56, v57
  v_add_f32 v117, v117, v58
  v_add_f32 v117, v117, v59
  v_add_f32 v117, v117, v60
  v_add_f32 v117, v117, v61
  v_add_f32 v117, v117, v62
  v_add_f32 v117, v117, v63
  v_add_f32 v117, v117, v64
  v_add_f32 v117, v117, v65
  v_mov_b32 v118, v117
  s_nop 0
  s_nop 0
  v_permlane16_swap_b32 v117, v118
  v_add_f32 v117, v117, v118
  v_mov_b32 v118, v117
  s_nop 0
  s_nop 0
  v_permlane32_swap_b32 v117, v118
  v_add_f32 v117, v117, v118
  v_rcp_f32 v117, v117
  s_branch o_fbr_200
o_fb_201:
  v_mov_b32 v118, v116
  s_nop 1
  v_permlane16_swap_b32 v116, v118
  v_max_f32 v116, v116, v118
  v_mov_b32 v118, v116
  s_nop 0
  s_nop 0
  v_permlane32_swap_b32 v116, v118
  v_max_f32 v116, v116, v118
  v_sub_f32 v56, v104, v116
  v_sub_f32 v57, v105, v116
  v_sub_f32 v58, v106, v116
  v_sub_f32 v59, v107, v116
  v_sub_f32 v60, v108, v116
  v_sub_f32 v61, v109, v116
  v_sub_f32 v62, v110, v116
  v_sub_f32 v63, v111, v116
  v_sub_f32 v64, v112, v116
  v_sub_f32 v65, v113, v116
  v_exp_f32 v56, v56
  v_exp_f32 v57, v57
  v_exp_f32 v58, v58
  v_exp_f32 v59, v59
  v_exp_f32 v60, v60
  v_exp_f32 v61, v61
  v_exp_f32 v62, v62
  v_exp_f32 v63, v63
  v_exp_f32 v64, v64
  v_exp_f32 v65, v65
  v_add_f32 v117, v56, v57
  v_add_f32 v117, v117, v58
  v_add_f32 v117, v117, v59
  v_add_f32 v117, v117, v60
  v_add_f32 v117, v117, v61
  v_add_f32 v117, v117, v62
  v_add_f32 v117, v117, v63
  v_add_f32 v117, v117, v64
  v_add_f32 v117, v117, v65
  v_mov_b32 v118, v117
  s_nop 0
  s_nop 0
  v_permlane16_swap_b32 v117, v118
  v_add_f32 v117, v117, v118
  v_mov_b32 v118, v117
  s_nop 0
  s_nop 0
  v_permlane32_swap_b32 v117, v118
  v_add_f32 v117, v117, v118
  v_rcp_f32 v117, v117
  s_branch o_fbr_202
o_wr2_196:
  s_waitcnt lgkmcnt(0)
  s_barrier
  ds_read_b128 v[104:107], v3 offset:0
  ds_read_b128 v[108:111], v3 offset:512
  ds_read_b128 v[112:115], v3 offset:1024
  buffer_load_dwordx4 v[176:179], v5, s[4:7], s94 offen offset:256 sc1
  buffer_load_dwordx4 v[180:183], v5, s[4:7], s94 offen offset:768 sc1
  s_waitcnt lgkmcnt(2)
  v_mfma_f32_32x32x16_bf16 v[40:55], v[104:107], a[0:3], 0
  v_mov_b64 v[188:189], 0
  v_mov_b64 v[190:191], 0
  v_mov_b64 v[192:193], 0
  v_mov_b64 v[194:195], 0
  s_mov_b64 exec, 1
  buffer_store_dword v38, off, s[4:7], s84 sc1
  s_mov_b64 exec, -1
  s_mov_b32 s84, 268435456
  v_mfma_f32_32x32x16_bf16 v[56:71], v[104:107], a[4:7], 0
  ds_read_b128 v[116:119], v3 offset:1536
  v_mfma_f32_32x32x16_bf16 v[72:87], v[104:107], a[8:11], 0
  v_mfma_f32_32x32x16_bf16 v[88:103], v[104:107], a[12:15], 0
  s_waitcnt vmcnt(13)
  v_xor_b32 v7, s96, v120
  v_bitop3_b32 v7, v7, v124, s96 bitop3:0xf6
  v_bitop3_b32 v7, v7, v128, s96 bitop3:0xf6
  v_bitop3_b32 v7, v7, v132, s96 bitop3:0xf6
  s_waitcnt lgkmcnt(2)
  v_mfma_f32_32x32x16_bf16 v[40:55], v[108:111], a[16:19], v[40:55]
  s_waitcnt vmcnt(9)
  v_bitop3_b32 v7, v7, v136, s96 bitop3:0xf6
  v_bitop3_b32 v7, v7, v140, s96 bitop3:0xf6
  v_bitop3_b32 v7, v7, v144, s96 bitop3:0xf6
  v_bitop3_b32 v7, v7, v148, s96 bitop3:0xf6
  s_waitcnt vmcnt(5)
  v_mfma_f32_32x32x16_bf16 v[56:71], v[108:111], a[20:23], v[56:71]
  ds_read_b128 v[104:107], v3 offset:2048
  v_bitop3_b32 v7, v7, v152, s96 bitop3:0xf6
  v_bitop3_b32 v7, v7, v156, s96 bitop3:0xf6
  v_bitop3_b32 v7, v7, v160, s96 bitop3:0xf6
  v_bitop3_b32 v7, v7, v164, s96 bitop3:0xf6
  s_waitcnt vmcnt(1)
  v_mfma_f32_32x32x16_bf16 v[72:87], v[108:111], a[24:27], v[72:87]
  v_bitop3_b32 v7, v7, v168, s96 bitop3:0xf6
  v_bitop3_b32 v7, v7, v172, s96 bitop3:0xf6
  v_bitop3_b32 v7, v7, v176, s96 bitop3:0xf6
  v_bitop3_b32 v7, v7, v180, s96 bitop3:0xf6
  v_and_b32 v7, v254, v7
  v_cmp_ne_u32 vcc, 0, v7
  s_cbranch_vccnz o_rt_207
o_bk_208:
  v_mfma_f32_32x32x16_bf16 v[88:103], v[108:111], a[28:31], v[88:103]
  v_smfmac_f32_16x16x64_bf16 v[188:191], v[16:19], v[120:127], v20
  v_lshlrev_b32 v196, 16, v184
  v_smfmac_f32_16x16x64_bf16 v[192:195], v[16:19], v[128:135], v20
  v_and_b32 v197, 0xffff0000, v184
  v_smfmac_f32_16x16x64_bf16 v[188:191], v[16:19], v[136:143], v20
  v_lshlrev_b32 v198, 16, v185
  s_waitcnt lgkmcnt(2)
  v_mfma_f32_32x32x16_bf16 v[40:55], v[112:115], a[32:35], v[40:55]
  v_smfmac_f32_16x16x64_bf16 v[192:195], v[16:19], v[144:151], v20
  v_and_b32 v199, 0xffff0000, v185
  v_smfmac_f32_16x16x64_bf16 v[188:191], v[16:19], v[152:159], v20
  v_lshlrev_b32 v200, 16, v186
  v_smfmac_f32_16x16x64_bf16 v[192:195], v[16:19], v[160:167], v20
  v_and_b32 v201, 0xffff0000, v186
  v_mfma_f32_32x32x16_bf16 v[56:71], v[112:115], a[36:39], v[56:71]
  ds_read_b128 v[108:111], v3 offset:2560
  v_smfmac_f32_16x16x64_bf16 v[188:191], v[16:19], v[168:175], v20
  v_lshlrev_b32 v202, 16, v187
  v_smfmac_f32_16x16x64_bf16 v[192:195], v[16:19], v[176:183], v20
  v_and_b32 v203, 0xffff0000, v187
  s_bfe_u32 s92, s65, 131086
  v_mfma_f32_32x32x16_bf16 v[72:87], v[112:115], a[40:43], v[72:87]
  s_lshl_b32 s92, s92, 21
  s_add_u32 s92, s92, s91
  s_add_u32 s93, s92, 27262976
  s_add_u32 s92, s92, 20971520
  v_permlane16_swap_b32 v188, v192
  v_mfma_f32_32x32x16_bf16 v[88:103], v[112:115], a[44:47], v[88:103]
  v_permlane16_swap_b32 v189, v193
  v_permlane16_swap_b32 v190, v194
  v_permlane16_swap_b32 v191, v195
  s_waitcnt lgkmcnt(2)
  v_mfma_f32_32x32x16_bf16 v[40:55], v[116:119], a[48:51], v[40:55]
  v_cvt_pk_bf16_f32 v188, 0, v188
  v_cvt_pk_bf16_f32 v189, 0, v189
  v_cvt_pk_bf16_f32 v190, 0, v190
  v_cvt_pk_bf16_f32 v191, 0, v191
  v_cvt_pk_bf16_f32 v192, 0, v192
  v_cvt_pk_bf16_f32 v193, 0, v193
  v_mfma_f32_32x32x16_bf16 v[56:71], v[116:119], a[52:55], v[56:71]
  ds_read_b128 v[112:115], v3 offset:3072
  v_cvt_pk_bf16_f32 v194, 0, v194
  v_cvt_pk_bf16_f32 v195, 0, v195
  v_add_f32 v196, v196, v188
  v_add_f32 v197, v197, v189
  v_add_f32 v198, v198, v190
  v_mfma_f32_32x32x16_bf16 v[72:87], v[116:119], a[56:59], v[72:87]
  v_add_f32 v199, v199, v191
  v_add_f32 v200, v200, v192
  v_add_f32 v201, v201, v193
  v_add_f32 v202, v202, v194
  v_add_f32 v203, v203, v195
  v_cvt_pk_bf16_f32 v120, v196, v197
  v_mfma_f32_32x32x16_bf16 v[88:103], v[116:119], a[60:63], v[88:103]
  v_cvt_pk_bf16_f32 v121, v198, v199
  v_cvt_pk_bf16_f32 v122, v200, v201
  v_cvt_pk_bf16_f32 v123, v202, v203
  v_lshlrev_b32 v196, 16, v120
  v_and_b32 v197, 0xffff0000, v120
  s_waitcnt lgkmcnt(2)
  v_mfma_f32_32x32x16_bf16 v[40:55], v[104:107], a[64:67], v[40:55]
  v_lshlrev_b32 v198, 16, v121
  v_and_b32 v199, 0xffff0000, v121
  v_lshlrev_b32 v200, 16, v122
  v_and_b32 v201, 0xffff0000, v122
  v_lshlrev_b32 v202, 16, v123
  v_and_b32 v203, 0xffff0000, v123
  v_mfma_f32_32x32x16_bf16 v[56:71], v[104:107], a[68:71], v[56:71]
  ds_read_b128 v[116:119], v3 offset:3584
  buffer_store_dwordx4 v[120:123], v0, s[4:7], s92 offen sc1
  v_add_f32 v136, v196, v197
  v_mul_f32 v137, v196, v196
  v_mfma_f32_32x32x16_bf16 v[72:87], v[104:107], a[72:75], v[72:87]
  v_add_f32 v138, v198, v199
  v_mul_f32 v139, v197, v197
  v_fmac_f32 v137, v198, v198
  v_fmac_f32 v139, v199, v199
  v_add_f32 v136, v136, v200
  v_fmac_f32 v137, v200, v200
  v_mfma_f32_32x32x16_bf16 v[88:103], v[104:107], a[76:79], v[88:103]
  v_add_f32 v138, v138, v201
  v_fmac_f32 v139, v201, v201
  v_add_f32 v136, v136, v202
  v_fmac_f32 v137, v202, v202
  v_add_f32 v138, v138, v203
  s_waitcnt lgkmcnt(2)
  v_mfma_f32_32x32x16_bf16 v[40:55], v[108:111], a[80:83], v[40:55]
  v_fmac_f32 v139, v203, v203
  v_add_f32 v136, v136, v138
  v_add_f32 v137, v137, v139
  s_nop 0
  v_add_f32_dpp v136, v136, v136 row_ror:8 row_mask:0xf bank_mask:0xf
  v_add_f32_dpp v137, v137, v137 row_ror:8 row_mask:0xf bank_mask:0xf
  s_nop 0
  v_add_f32_dpp v136, v136, v136 row_ror:4 row_mask:0xf bank_mask:0xf
  v_mfma_f32_32x32x16_bf16 v[56:71], v[108:111], a[84:87], v[56:71]
  ds_read_b128 v[104:107], v3 offset:8192
  v_add_f32_dpp v137, v137, v137 row_ror:4 row_mask:0xf bank_mask:0xf
  v_add_f32_dpp v136, v136, v136 row_ror:2 row_mask:0xf bank_mask:0xf
  s_nop 0
  v_add_f32_dpp v137, v137, v137 row_ror:2 row_mask:0xf bank_mask:0xf
  v_add_f32_dpp v136, v136, v136 row_ror:1 row_mask:0xf bank_mask:0xf
  s_nop 0
  v_add_f32_dpp v137, v137, v137 row_ror:1 row_mask:0xf bank_mask:0xf
  v_mfma_f32_32x32x16_bf16 v[72:87], v[108:111], a[88:91], v[72:87]
  v_mov_b32 v140, v136
  v_mov_b32 v141, v137
  s_nop 0
  v_permlane16_swap_b32 v136, v140
  v_permlane16_swap_b32 v137, v141
  v_mfma_f32_32x32x16_bf16 v[88:103], v[108:111], a[92:95], v[88:103]
  v_add_f32 v136, v136, v140
  v_add_f32 v137, v137, v141
  v_mov_b32 v140, v136
  v_mov_b32 v141, v137
  s_nop 0
  v_permlane32_swap_b32 v136, v140
  s_waitcnt lgkmcnt(2)
  v_mfma_f32_32x32x16_bf16 v[40:55], v[112:115], a[96:99], v[40:55]
  v_permlane32_swap_b32 v137, v141
  v_add_f32 v136, v136, v140
  v_add_f32 v137, v137, v141
  v_mul_f32 v136, 0x3b000000, v136
  v_mul_f32 v137, 0x3b000000, v137
  v_mfma_f32_32x32x16_bf16 v[56:71], v[112:115], a[100:103], v[56:71]
  ds_read_b128 v[108:111], v3 offset:8704
  v_fma_f32 v137, -v136, v136, v137
  v_cvt_pk_bf16_f32 v136, 0, v136
  v_max_f32 v137, 0, v137
  v_sub_f32 v140, v196, v136
  v_sub_f32 v141, v197, v136
  v_mfma_f32_32x32x16_bf16 v[72:87], v[112:115], a[104:107], v[72:87]
  v_cvt_pk_bf16_f32 v137, 0, v137
  v_sub_f32 v142, v198, v136
  v_sub_f32 v143, v199, v136
  v_add_f32 v137, 0x3727c5ac, v137
  v_sub_f32 v144, v200, v136
  v_sub_f32 v145, v201, v136
  v_mfma_f32_32x32x16_bf16 v[88:103], v[112:115], a[108:111], v[88:103]
  v_cvt_pk_bf16_f32 v137, 0, v137
  v_sub_f32 v146, v202, v136
  v_sub_f32 v147, v203, v136
  v_sqrt_f32 v137, v137
  s_waitcnt lgkmcnt(2)
  v_mfma_f32_32x32x16_bf16 v[40:55], v[116:119], a[112:115], v[40:55]
  v_cvt_pk_bf16_f32 v140, 0, v140
  v_cvt_pk_bf16_f32 v141, 0, v141
  v_cvt_pk_bf16_f32 v137, 0, v137
  v_cvt_pk_bf16_f32 v142, 0, v142
  v_cvt_pk_bf16_f32 v143, 0, v143
  v_rcp_f32 v137, v137
  v_mfma_f32_32x32x16_bf16 v[56:71], v[116:119], a[116:119], v[56:71]
  ds_read_b128 v[112:115], v3 offset:9216
  v_cvt_pk_bf16_f32 v144, 0, v144
  v_cvt_pk_bf16_f32 v145, 0, v145
  v_cvt_pk_bf16_f32 v146, 0, v146
  v_cvt_pk_bf16_f32 v147, 0, v147
  v_mul_f32 v140, v140, v137
  v_mfma_f32_32x32x16_bf16 v[72:87], v[116:119], a[120:123], v[72:87]
  v_mul_f32 v141, v141, v137
  v_mul_f32 v142, v142, v137
  v_mul_f32 v143, v143, v137
  v_mul_f32 v144, v144, v137
  v_mul_f32 v145, v145, v137
  v_mul_f32 v146, v146, v137
  v_mfma_f32_32x32x16_bf16 v[88:103], v[116:119], a[124:127], v[88:103]
  v_mul_f32 v147, v147, v137
  v_cvt_pk_bf16_f32 v124, v140, v141
  v_cvt_pk_bf16_f32 v125, v142, v143
  v_cvt_pk_bf16_f32 v126, v144, v145
  v_cvt_pk_bf16_f32 v127, v146, v147
  s_waitcnt lgkmcnt(2)
  v_mfma_f32_32x32x16_bf16 v[40:55], v[104:107], a[128:131], v[40:55]
  v_lshlrev_b32 v204, 16, v124
  v_and_b32 v205, 0xffff0000, v124
  v_lshlrev_b32 v206, 16, v125
  v_and_b32 v207, 0xffff0000, v125
  v_lshlrev_b32 v208, 16, v126
  v_and_b32 v209, 0xffff0000, v126
  v_mfma_f32_32x32x16_bf16 v[56:71], v[104:107], a[132:135], v[56:71]
  ds_read_b128 v[116:119], v3 offset:9728
  v_lshlrev_b32 v210, 16, v127
  v_and_b32 v211, 0xffff0000, v127
  buffer_store_dwordx4 v[124:127], v0, s[4:7], s93 offen sc1
  v_mfma_f32_32x32x16_bf16 v[72:87], v[104:107], a[136:139], v[72:87]
  v_add_f32 v196, v196, v204
  v_add_f32 v197, v197, v205
  v_add_f32 v198, v198, v206
  v_add_f32 v199, v199, v207
  v_add_f32 v200, v200, v208
  v_add_f32 v201, v201, v209
  v_mfma_f32_32x32x16_bf16 v[88:103], v[104:107], a[140:143], v[88:103]
  v_add_f32 v202, v202, v210
  v_add_f32 v203, v203, v211
  v_cvt_pk_bf16_f32 v128, v196, v197
  v_cvt_pk_bf16_f32 v129, v198, v199
  v_cvt_pk_bf16_f32 v130, v200, v201
  s_waitcnt lgkmcnt(2)
  v_mfma_f32_32x32x16_bf16 v[40:55], v[108:111], a[144:147], v[40:55]
  v_cvt_pk_bf16_f32 v131, v202, v203
  v_mul_f32 v188, v204, v8
  v_mul_f32 v189, v205, v9
  v_fmac_f32 v188, v206, v10
  v_fmac_f32 v189, v207, v11
  v_fmac_f32 v188, v208, v12
  v_mfma_f32_32x32x16_bf16 v[56:71], v[108:111], a[148:151], v[56:71]
  ds_read_b128 v[104:107], v3 offset:10240
  v_fmac_f32 v189, v209, v13
  v_fmac_f32 v188, v210, v14
  v_fmac_f32 v189, v211, v15
  v_add_f32 v188, v188, v189
  buffer_store_dwordx4 v[128:131], v0, s[68:71], s91 offen sc1
  v_mfma_f32_32x32x16_bf16 v[72:87], v[108:111], a[152:155], v[72:87]
  v_add_f32_dpp v188, v188, v188 row_ror:8 row_mask:0xf bank_mask:0xf
  s_nop 1
  v_add_f32_dpp v188, v188, v188 row_ror:4 row_mask:0xf bank_mask:0xf
  s_nop 1
  v_add_f32_dpp v188, v188, v188 row_ror:2 row_mask:0xf bank_mask:0xf
  s_nop 1
  v_add_f32_dpp v188, v188, v188 row_ror:1 row_mask:0xf bank_mask:0xf
  v_mov_b32 v189, v188
  s_nop 0
  s_nop 0
  v_permlane16_swap_b32 v188, v189
  v_mfma_f32_32x32x16_bf16 v[88:103], v[108:111], a[156:159], v[88:103]
  v_add_f32 v188, v188, v189
  v_mov_b32 v189, v188
  s_nop 0
  s_nop 0
  v_permlane32_swap_b32 v188, v189
  v_add_f32 v188, v188, v189
  s_waitcnt lgkmcnt(2)
  v_mfma_f32_32x32x16_bf16 v[40:55], v[112:115], a[160:163], v[40:55]
  v_cvt_pk_bf16_f32 v188, 0, v188
  v_ashrrev_i32 v189, 31, v188
  v_or_b32 v189, 0x80000000, v189
  v_xor_b32 v188, v188, v189
  s_sub_u32 s92, 4095, s90
  v_and_b32 v188, 0xffff0000, v188
  v_mfma_f32_32x32x16_bf16 v[56:71], v[112:115], a[164:167], v[56:71]
  ds_read_b128 v[108:111], v3 offset:10752
  v_or_b32 v38, s92, v188
  s_bfe_u32 s92, s65, 196625
  s_lshl_b32 s92, s92, 18
  s_lshl_b32 s93, s90, 7
  s_add_u32 s92, s92, s93
  v_mfma_f32_32x32x16_bf16 v[72:87], v[112:115], a[168:171], v[72:87]
  s_add_u32 s84, s92, 243269632
  v_mfma_f32_32x32x16_bf16 v[88:103], v[112:115], a[172:175], v[88:103]
  s_waitcnt lgkmcnt(2)
  v_mfma_f32_32x32x16_bf16 v[40:55], v[116:119], a[176:179], v[40:55]
  v_mfma_f32_32x32x16_bf16 v[56:71], v[116:119], a[180:183], v[56:71]
  ds_read_b128 v[112:115], v3 offset:11264
  v_mfma_f32_32x32x16_bf16 v[72:87], v[116:119], a[184:187], v[72:87]
  v_mfma_f32_32x32x16_bf16 v[88:103], v[116:119], a[188:191], v[88:103]
  s_waitcnt lgkmcnt(2)
  v_mfma_f32_32x32x16_bf16 v[40:55], v[104:107], a[192:195], v[40:55]
  v_mfma_f32_32x32x16_bf16 v[56:71], v[104:107], a[196:199], v[56:71]
  ds_read_b128 v[116:119], v3 offset:11776
  s_waitcnt lgkmcnt(2)
  v_mfma_f32_32x32x16_bf16 v[40:55], v[108:111], a[208:211], v[40:55]
  v_mfma_f32_32x32x16_bf16 v[56:71], v[108:111], a[212:215], v[56:71]
  s_waitcnt lgkmcnt(1)
  v_mfma_f32_32x32x16_bf16 v[40:55], v[112:115], a[224:227], v[40:55]
  v_mfma_f32_32x32x16_bf16 v[56:71], v[112:115], a[228:231], v[56:71]
  s_waitcnt lgkmcnt(0)
  v_mfma_f32_32x32x16_bf16 v[40:55], v[116:119], a[240:243], v[40:55]
  v_mfma_f32_32x32x16_bf16 v[56:71], v[116:119], a[244:247], v[56:71]
  v_mfma_f32_32x32x16_bf16 v[72:87], v[104:107], a[200:203], v[72:87]
  v_mfma_f32_32x32x16_bf16 v[88:103], v[104:107], a[204:207], v[88:103]
  v_cvt_pk_bf16_f32 v212, v40, v56
  v_cvt_pk_bf16_f32 v214, v41, v57
  v_cvt_pk_bf16_f32 v216, v42, v58
  v_cvt_pk_bf16_f32 v218, v43, v59
  v_permlane16_swap_b32 v212, v214
  v_mfma_f32_32x32x16_bf16 v[72:87], v[108:111], a[216:219], v[72:87]
  v_cvt_pk_bf16_f32 v220, v44, v60
  v_cvt_pk_bf16_f32 v222, v45, v61
  v_permlane16_swap_b32 v216, v218
  v_bfi_b32 v212, v254, s42, v212
  v_cvt_pk_bf16_f32 v224, v46, v62
  v_mfma_f32_32x32x16_bf16 v[88:103], v[108:111], a[220:223], v[88:103]
  v_cvt_pk_bf16_f32 v226, v47, v63
  v_permlane16_swap_b32 v220, v222
  v_bfi_b32 v216, v254, s42, v216
  v_cvt_pk_bf16_f32 v228, v48, v64
  v_mfma_f32_32x32x16_bf16 v[72:87], v[112:115], a[232:235], v[72:87]
  v_cvt_pk_bf16_f32 v230, v49, v65
  v_permlane16_swap_b32 v224, v226
  v_bfi_b32 v220, v254, s42, v220
  v_cvt_pk_bf16_f32 v232, v50, v66
  v_cvt_pk_bf16_f32 v234, v51, v67
  v_mfma_f32_32x32x16_bf16 v[88:103], v[112:115], a[236:239], v[88:103]
  v_permlane16_swap_b32 v228, v230
  v_bfi_b32 v224, v254, s42, v224
  v_cvt_pk_bf16_f32 v236, v52, v68
  v_cvt_pk_bf16_f32 v238, v53, v69
  v_mfma_f32_32x32x16_bf16 v[72:87], v[116:119], a[248:251], v[72:87]
  v_permlane16_swap_b32 v232, v234
  v_bfi_b32 v228, v254, s42, v228
  v_cvt_pk_bf16_f32 v240, v54, v70
  v_cvt_pk_bf16_f32 v242, v55, v71
  v_permlane16_swap_b32 v236, v238
  v_mfma_f32_32x32x16_bf16 v[88:103], v[116:119], a[252:255], v[88:103]
  v_bfi_b32 v232, v254, s42, v232
  v_permlane16_swap_b32 v240, v242
  v_bfi_b32 v236, v254, s42, v236
  v_bfi_b32 v240, v254, s42, v240
  s_nop 7
  v_cvt_pk_bf16_f32 v213, v72, v88
  v_cvt_pk_bf16_f32 v215, v73, v89
  v_cvt_pk_bf16_f32 v217, v74, v90
  v_cvt_pk_bf16_f32 v219, v75, v91
  s_add_u32 s78, s86, 0
  v_permlane16_swap_b32 v213, v215
  buffer_store_dwordx4 v[212:215], v4, s[4:7], s78 offen sc1
  v_cvt_pk_bf16_f32 v221, v76, v92
  v_cvt_pk_bf16_f32 v223, v77, v93
  s_add_u32 s78, s86, 32768
  v_permlane16_swap_b32 v217, v219
  buffer_store_dwordx4 v[216:219], v4, s[4:7], s78 offen sc1
  v_cvt_pk_bf16_f32 v225, v78, v94
  v_cvt_pk_bf16_f32 v227, v79, v95
  s_add_u32 s78, s86, 131072
  v_permlane16_swap_b32 v221, v223
  buffer_store_dwordx4 v[220:223], v4, s[4:7], s78 offen sc1
  v_cvt_pk_bf16_f32 v229, v80, v96
  v_cvt_pk_bf16_f32 v231, v81, v97
  s_add_u32 s78, s86, 163840
  v_permlane16_swap_b32 v225, v227
  buffer_store_dwordx4 v[224:227], v4, s[4:7], s78 offen sc1
  v_cvt_pk_bf16_f32 v233, v82, v98
  v_cvt_pk_bf16_f32 v235, v83, v99
  s_add_u32 s78, s86, 262144
  v_permlane16_swap_b32 v229, v231
  buffer_store_dwordx4 v[228:231], v4, s[4:7], s78 offen sc1
  v_cvt_pk_bf16_f32 v237, v84, v100
  v_cvt_pk_bf16_f32 v239, v85, v101
  s_add_u32 s78, s86, 294912
  v_permlane16_swap_b32 v233, v235
  buffer_store_dwordx4 v[232:235], v4, s[4:7], s78 offen sc1
  v_cvt_pk_bf16_f32 v241, v86, v102
  v_cvt_pk_bf16_f32 v243, v87, v103
  s_add_u32 s78, s86, 393216
  v_permlane16_swap_b32 v237, v239
  buffer_store_dwordx4 v[236:239], v4, s[4:7], s78 offen sc1
  s_add_u32 s78, s86, 425984
  v_permlane16_swap_b32 v241, v243
  buffer_store_dwordx4 v[240:243], v4, s[4:7], s78 offen sc1
o_we_197:
  v_and_b32 v37, -32, v39
  s_waitcnt lgkmcnt(0)
  s_barrier
  ds_read_b128 v[104:107], v37 offset:16
  s_mov_b32 s65, s63
  s_waitcnt lgkmcnt(0)
  v_and_b32 v104, v104, v106
  v_max_u32 v105, v105, v107
  v_readfirstlane_b32 s26, v104
  v_readfirstlane_b32 s3, v105
  s_and_b32 s66, s26, 1
  s_and_b32 s76, s26, 2
  s_bitcmp1_b32 s26, 2
  s_cselect_b32 s3, s3, 0
  s_cmp_lg_u32 s76, 0
  s_cbranch_scc1 o_nofl_171
  s_and_b32 s26, s63, 49152
  s_cbranch_scc0 o_fl_172
  s_and_b32 s26, s64, s50
  s_cbranch_scc1 o_nofl_171
o_fl_172:
  s_cmp_ge_u32 s17, 2
  s_cbranch_scc1 o_fd_211
  s_cmp_eq_u32 s65, 0
  s_cbranch_scc1 o_fd_211
  s_mov_b32 s96, s42
  s_waitcnt vmcnt(0)
  s_mov_b64 exec, 1
  buffer_store_dword v38, off, s[4:7], s84 sc1
  s_mov_b64 exec, -1
  s_mov_b32 s84, 268435456
  s_lshl_b32 s97, s43, 14
  s_add_u32 s97, s97, s86
  buffer_load_dword v7, v255, s[4:7], s97 offen sc1
  s_and_b32 s91, s65, 63
  s_lshl_b32 s90, s91, 5
  s_add_u32 s94, s90, s85
  s_add_u32 s90, s90, s43
  s_lshl_b32 s94, s94, 10
  s_lshr_b32 s92, s65, 22
  s_xor_b32 s93, s43, 32
  s_lshl_b32 s91, s90, 10
  s_add_u32 s94, s94, 25165824
  s_cmp_eq_u32 s92, s93
  s_cselect_b32 s92, s94, s91
  s_add_u32 s92, s92, 10485760
  s_and_b32 s93, s65, 49152
  s_cselect_b32 s92, s92, s91
  s_cselect_b64 s[80:81], s[4:5], s[72:73]
  s_cselect_b32 s82, s6, s74
  buffer_load_dwordx4 v[184:187], v0, s[80:83], s92 offen sc1
  s_mov_b32 s67, 0
  s_mov_b64 vcc, 0
  s_waitcnt vmcnt(1)
o_pl_213:
  v_and_b32 v7, 1, v7
  v_cmp_ne_u32 vcc, s96, v7
  s_cbranch_vccz o_pk_214
  buffer_load_dword v7, v255, s[4:7], s97 offen sc1
  s_add_u32 s67, s67, 1
  s_cmp_gt_u32 s67, 1048576
  s_cbranch_scc1 L_end
  s_waitcnt vmcnt(0)
  s_branch o_pl_213
o_pk_214:
  s_and_b32 s26, s65, 49152
  s_cbranch_scc1 o_f2_212
  s_lshl_b32 s94, s43, 14
  s_add_u32 s94, s94, s86
  buffer_load_dwordx4 v[120:123], v5, s[4:7], s94 offen offset:0 sc1
  buffer_load_dwordx4 v[124:127], v5, s[4:7], s94 offen offset:512 sc1
  buffer_load_dwordx4 v[128:131], v5, s[4:7], s94 offen offset:256 sc1
  buffer_load_dwordx4 v[132:135], v5, s[4:7], s94 offen offset:768 sc1
  s_add_u32 s94, s94, 4096
  buffer_load_dwordx4 v[136:139], v5, s[4:7], s94 offen offset:0 sc1
  buffer_load_dwordx4 v[140:143], v5, s[4:7], s94 offen offset:512 sc1
  buffer_load_dwordx4 v[144:147], v5, s[4:7], s94 offen offset:256 sc1
  buffer_load_dwordx4 v[148:151], v5, s[4:7], s94 offen offset:768 sc1
  s_add_u32 s94, s94, 4096
  buffer_load_dwordx4 v[152:155], v5, s[4:7], s94 offen offset:0 sc1
  buffer_load_dwordx4 v[156:159], v5, s[4:7], s94 offen offset:512 sc1
  buffer_load_dwordx4 v[160:163], v5, s[4:7], s94 offen offset:256 sc1
  buffer_load_dwordx4 v[164:167], v5, s[4:7], s94 offen offset:768 sc1
  s_add_u32 s94, s94, 4096
  buffer_load_dwordx4 v[168:171], v5, s[4:7], s94 offen offset:0 sc1
  buffer_load_dwordx4 v[172:175], v5, s[4:7], s94 offen offset:512 sc1
  buffer_load_dwordx4 v[176:179], v5, s[4:7], s94 offen offset:256 sc1
  buffer_load_dwordx4 v[180:183], v5, s[4:7], s94 offen offset:768 sc1
  v_mov_b64 v[188:189], 0
  v_mov_b64 v[190:191], 0
  v_mov_b64 v[192:193], 0
  v_mov_b64 v[194:195], 0
  s_waitcnt vmcnt(12)
  v_xor_b32 v7, s96, v120
  v_bitop3_b32 v7, v7, v124, s96 bitop3:0xf6
  v_bitop3_b32 v7, v7, v128, s96 bitop3:0xf6
  v_bitop3_b32 v7, v7, v132, s96 bitop3:0xf6
  s_waitcnt vmcnt(8)
  v_bitop3_b32 v7, v7, v136, s96 bitop3:0xf6
  v_bitop3_b32 v7, v7, v140, s96 bitop3:0xf6
  v_bitop3_b32 v7, v7, v144, s96 bitop3:0xf6
  v_bitop3_b32 v7, v7, v148, s96 bitop3:0xf6
  s_waitcnt vmcnt(4)
  v_bitop3_b32 v7, v7, v152, s96 bitop3:0xf6
  v_bitop3_b32 v7, v7, v156, s96 bitop3:0xf6
  v_bitop3_b32 v7, v7, v160, s96 bitop3:0xf6
  v_bitop3_b32 v7, v7, v164, s96 bitop3:0xf6
  s_waitcnt vmcnt(0)
  v_bitop3_b32 v7, v7, v168, s96 bitop3:0xf6
  v_bitop3_b32 v7, v7, v172, s96 bitop3:0xf6
  v_bitop3_b32 v7, v7, v176, s96 bitop3:0xf6
  v_bitop3_b32 v7, v7, v180, s96 bitop3:0xf6
  v_and_b32 v7, v254, v7
  v_cmp_ne_u32 vcc, 0, v7
  s_cbranch_vccnz o_rt_215
o_bk_216:
  v_smfmac_f32_16x16x64_bf16 v[188:191], v[16:19], v[120:127], v20
  v_lshlrev_b32 v196, 16, v184
  v_smfmac_f32_16x16x64_bf16 v[192:195], v[16:19], v[128:135], v20
  v_and_b32 v197, 0xffff0000, v184
  v_smfmac_f32_16x16x64_bf16 v[188:191], v[16:19], v[136:143], v20
  v_lshlrev_b32 v198, 16, v185
  v_smfmac_f32_16x16x64_bf16 v[192:195], v[16:19], v[144:151], v20
  v_and_b32 v199, 0xffff0000, v185
  v_smfmac_f32_16x16x64_bf16 v[188:191], v[16:19], v[152:159], v20
  v_lshlrev_b32 v200, 16, v186
  v_smfmac_f32_16x16x64_bf16 v[192:195], v[16:19], v[160:167], v20
  v_and_b32 v201, 0xffff0000, v186
  v_smfmac_f32_16x16x64_bf16 v[188:191], v[16:19], v[168:175], v20
  v_lshlrev_b32 v202, 16, v187
  v_smfmac_f32_16x16x64_bf16 v[192:195], v[16:19], v[176:183], v20
  v_and_b32 v203, 0xffff0000, v187
  s_bfe_u32 s92, s65, 131086
  s_lshl_b32 s92, s92, 21
  s_add_u32 s92, s92, s91
  s_add_u32 s93, s92, 27262976
  s_add_u32 s92, s92, 20971520
  s_nop 1
  v_permlane16_swap_b32 v188, v192
  v_permlane16_swap_b32 v189, v193
  v_permlane16_swap_b32 v190, v194
  v_permlane16_swap_b32 v191, v195
  v_cvt_pk_bf16_f32 v188, 0, v188
  v_cvt_pk_bf16_f32 v189, 0, v189
  v_cvt_pk_bf16_f32 v190, 0, v190
  v_cvt_pk_bf16_f32 v191, 0, v191
  v_cvt_pk_bf16_f32 v192, 0, v192
  v_cvt_pk_bf16_f32 v193, 0, v193
  v_cvt_pk_bf16_f32 v194, 0, v194
  v_cvt_pk_bf16_f32 v195, 0, v195
  v_add_f32 v196, v196, v188
  v_add_f32 v197, v197, v189
  v_add_f32 v198, v198, v190
  v_add_f32 v199, v199, v191
  v_add_f32 v200, v200, v192
  v_add_f32 v201, v201, v193
  v_add_f32 v202, v202, v194
  v_add_f32 v203, v203, v195
  v_cvt_pk_bf16_f32 v120, v196, v197
  v_cvt_pk_bf16_f32 v121, v198, v199
  v_cvt_pk_bf16_f32 v122, v200, v201
  v_cvt_pk_bf16_f32 v123, v202, v203
  v_lshlrev_b32 v196, 16, v120
  v_and_b32 v197, 0xffff0000, v120
  v_lshlrev_b32 v198, 16, v121
  v_and_b32 v199, 0xffff0000, v121
  v_lshlrev_b32 v200, 16, v122
  v_and_b32 v201, 0xffff0000, v122
  v_lshlrev_b32 v202, 16, v123
  v_and_b32 v203, 0xffff0000, v123
  buffer_store_dwordx4 v[120:123], v0, s[4:7], s92 offen sc1
  v_add_f32 v136, v196, v197
  v_mul_f32 v137, v196, v196
  v_add_f32 v138, v198, v199
  v_mul_f32 v139, v197, v197
  v_fmac_f32 v137, v198, v198
  v_fmac_f32 v139, v199, v199
  v_add_f32 v136, v136, v200
  v_fmac_f32 v137, v200, v200
  v_add_f32 v138, v138, v201
  v_fmac_f32 v139, v201, v201
  v_add_f32 v136, v136, v202
  v_fmac_f32 v137, v202, v202
  v_add_f32 v138, v138, v203
  v_fmac_f32 v139, v203, v203
  v_add_f32 v136, v136, v138
  v_add_f32 v137, v137, v139
  s_nop 0
  v_add_f32_dpp v136, v136, v136 row_ror:8 row_mask:0xf bank_mask:0xf
  v_add_f32_dpp v137, v137, v137 row_ror:8 row_mask:0xf bank_mask:0xf
  s_nop 0
  v_add_f32_dpp v136, v136, v136 row_ror:4 row_mask:0xf bank_mask:0xf
  v_add_f32_dpp v137, v137, v137 row_ror:4 row_mask:0xf bank_mask:0xf
  s_nop 0
  v_add_f32_dpp v136, v136, v136 row_ror:2 row_mask:0xf bank_mask:0xf
  v_add_f32_dpp v137, v137, v137 row_ror:2 row_mask:0xf bank_mask:0xf
  s_nop 0
  v_add_f32_dpp v136, v136, v136 row_ror:1 row_mask:0xf bank_mask:0xf
  v_add_f32_dpp v137, v137, v137 row_ror:1 row_mask:0xf bank_mask:0xf
  v_mov_b32 v140, v136
  v_mov_b32 v141, v137
  s_nop 0
  v_permlane16_swap_b32 v136, v140
  v_permlane16_swap_b32 v137, v141
  v_add_f32 v136, v136, v140
  v_add_f32 v137, v137, v141
  v_mov_b32 v140, v136
  v_mov_b32 v141, v137
  s_nop 0
  v_permlane32_swap_b32 v136, v140
  v_permlane32_swap_b32 v137, v141
  v_add_f32 v136, v136, v140
  v_add_f32 v137, v137, v141
  v_mul_f32 v136, 0x3b000000, v136
  v_mul_f32 v137, 0x3b000000, v137
  v_fma_f32 v137, -v136, v136, v137
  v_cvt_pk_bf16_f32 v136, 0, v136
  v_max_f32 v137, 0, v137
  v_sub_f32 v140, v196, v136
  v_sub_f32 v141, v197, v136
  v_cvt_pk_bf16_f32 v137, 0, v137
  v_sub_f32 v142, v198, v136
  v_sub_f32 v143, v199, v136
  v_add_f32 v137, 0x3727c5ac, v137
  v_sub_f32 v144, v200, v136
  v_sub_f32 v145, v201, v136
  v_cvt_pk_bf16_f32 v137, 0, v137
  v_sub_f32 v146, v202, v136
  v_sub_f32 v147, v203, v136
  v_sqrt_f32 v137, v137
  v_cvt_pk_bf16_f32 v140, 0, v140
  v_cvt_pk_bf16_f32 v141, 0, v141
  v_cvt_pk_bf16_f32 v137, 0, v137
  v_cvt_pk_bf16_f32 v142, 0, v142
  v_cvt_pk_bf16_f32 v143, 0, v143
  v_rcp_f32 v137, v137
  v_cvt_pk_bf16_f32 v144, 0, v144
  v_cvt_pk_bf16_f32 v145, 0, v145
  v_cvt_pk_bf16_f32 v146, 0, v146
  v_cvt_pk_bf16_f32 v147, 0, v147
  v_mul_f32 v140, v140, v137
  v_mul_f32 v141, v141, v137
  v_mul_f32 v142, v142, v137
  v_mul_f32 v143, v143, v137
  v_mul_f32 v144, v144, v137
  v_mul_f32 v145, v145, v137
  v_mul_f32 v146, v146, v137
  v_mul_f32 v147, v147, v137
  v_cvt_pk_bf16_f32 v124, v140, v141
  v_cvt_pk_bf16_f32 v125, v142, v143
  v_cvt_pk_bf16_f32 v126, v144, v145
  v_cvt_pk_bf16_f32 v127, v146, v147
  v_lshlrev_b32 v204, 16, v124
  v_and_b32 v205, 0xffff0000, v124
  v_lshlrev_b32 v206, 16, v125
  v_and_b32 v207, 0xffff0000, v125
  v_lshlrev_b32 v208, 16, v126
  v_and_b32 v209, 0xffff0000, v126
  v_lshlrev_b32 v210, 16, v127
  v_and_b32 v211, 0xffff0000, v127
  buffer_store_dwordx4 v[124:127], v0, s[4:7], s93 offen sc1
  v_add_f32 v196, v196, v204
  v_add_f32 v197, v197, v205
  v_add_f32 v198, v198, v206
  v_add_f32 v199, v199, v207
  v_add_f32 v200, v200, v208
  v_add_f32 v201, v201, v209
  v_add_f32 v202, v202, v210
  v_add_f32 v203, v203, v211
  v_cvt_pk_bf16_f32 v128, v196, v197
  v_cvt_pk_bf16_f32 v129, v198, v199
  v_cvt_pk_bf16_f32 v130, v200, v201
  v_cvt_pk_bf16_f32 v131, v202, v203
  v_mul_f32 v188, v204, v8
  v_mul_f32 v189, v205, v9
  v_fmac_f32 v188, v206, v10
  v_fmac_f32 v189, v207, v11
  v_fmac_f32 v188, v208, v12
  v_fmac_f32 v189, v209, v13
  v_fmac_f32 v188, v210, v14
  v_fmac_f32 v189, v211, v15
  v_add_f32 v188, v188, v189
  s_add_u32 s92, s91, 10485760
  s_add_u32 s93, s91, 8388608
  buffer_store_dwordx4 v[128:131], v0, s[4:7], s92 offen sc1
  v_lshlrev_b32 v196, 16, v128
  v_and_b32 v197, 0xffff0000, v128
  v_lshlrev_b32 v198, 16, v129
  v_and_b32 v199, 0xffff0000, v129
  v_lshlrev_b32 v200, 16, v130
  v_and_b32 v201, 0xffff0000, v130
  v_lshlrev_b32 v202, 16, v131
  v_and_b32 v203, 0xffff0000, v131
  v_add_f32 v136, v196, v197
  v_mul_f32 v137, v196, v196
  v_add_f32 v138, v198, v199
  v_mul_f32 v139, v197, v197
  v_fmac_f32 v137, v198, v198
  v_fmac_f32 v139, v199, v199
  v_add_f32 v136, v136, v200
  v_fmac_f32 v137, v200, v200
  v_add_f32 v138, v138, v201
  v_fmac_f32 v139, v201, v201
  v_add_f32 v136, v136, v202
  v_fmac_f32 v137, v202, v202
  v_add_f32 v138, v138, v203
  v_fmac_f32 v139, v203, v203
  v_add_f32 v136, v136, v138
  v_add_f32 v137, v137, v139
  s_nop 0
  v_add_f32_dpp v136, v136, v136 row_ror:8 row_mask:0xf bank_mask:0xf
  v_add_f32_dpp v137, v137, v137 row_ror:8 row_mask:0xf bank_mask:0xf
  v_add_f32_dpp v188, v188, v188 row_ror:8 row_mask:0xf bank_mask:0xf
  v_add_f32_dpp v136, v136, v136 row_ror:4 row_mask:0xf bank_mask:0xf
  v_add_f32_dpp v137, v137, v137 row_ror:4 row_mask:0xf bank_mask:0xf
  v_add_f32_dpp v188, v188, v188 row_ror:4 row_mask:0xf bank_mask:0xf
  v_add_f32_dpp v136, v136, v136 row_ror:2 row_mask:0xf bank_mask:0xf
  v_add_f32_dpp v137, v137, v137 row_ror:2 row_mask:0xf bank_mask:0xf
  v_add_f32_dpp v188, v188, v188 row_ror:2 row_mask:0xf bank_mask:0xf
  v_add_f32_dpp v136, v136, v136 row_ror:1 row_mask:0xf bank_mask:0xf
  v_add_f32_dpp v137, v137, v137 row_ror:1 row_mask:0xf bank_mask:0xf
  v_add_f32_dpp v188, v188, v188 row_ror:1 row_mask:0xf bank_mask:0xf
  v_mov_b32 v140, v136
  v_mov_b32 v141, v137
  v_mov_b32 v142, v188
  v_permlane16_swap_b32 v136, v140
  v_permlane16_swap_b32 v137, v141
  v_permlane16_swap_b32 v188, v142
  v_add_f32 v136, v136, v140
  v_add_f32 v137, v137, v141
  v_add_f32 v188, v188, v142
  v_mov_b32 v140, v136
  v_mov_b32 v141, v137
  v_mov_b32 v142, v188
  v_permlane32_swap_b32 v136, v140
  v_permlane32_swap_b32 v137, v141
  v_permlane32_swap_b32 v188, v142
  v_add_f32 v136, v136, v140
  v_add_f32 v137, v137, v141
  v_add_f32 v188, v188, v142
  v_mul_f32 v136, 0x3b000000, v136
  v_mul_f32 v137, 0x3b000000, v137
  v_fma_f32 v137, -v136, v136, v137
  v_cvt_pk_bf16_f32 v136, 0, v136
  v_max_f32 v137, 0, v137
  v_sub_f32 v140, v196, v136
  v_sub_f32 v141, v197, v136
  v_cvt_pk_bf16_f32 v137, 0, v137
  v_sub_f32 v142, v198, v136
  v_sub_f32 v143, v199, v136
  v_add_f32 v137, 0x3727c5ac, v137
  v_sub_f32 v144, v200, v136
  v_sub_f32 v145, v201, v136
  v_cvt_pk_bf16_f32 v137, 0, v137
  v_sub_f32 v146, v202, v136
  v_sub_f32 v147, v203, v136
  v_sqrt_f32 v137, v137
  v_cvt_pk_bf16_f32 v140, 0, v140
  v_cvt_pk_bf16_f32 v141, 0, v141
  v_cvt_pk_bf16_f32 v137, 0, v137
  v_cvt_pk_bf16_f32 v142, 0, v142
  v_cvt_pk_bf16_f32 v143, 0, v143
  v_rcp_f32 v137, v137
  v_cvt_pk_bf16_f32 v144, 0, v144
  v_cvt_pk_bf16_f32 v145, 0, v145
  v_cvt_pk_bf16_f32 v146, 0, v146
  v_cvt_pk_bf16_f32 v147, 0, v147
  v_mul_f32 v140, v140, v137
  v_mul_f32 v141, v141, v137
  v_mul_f32 v142, v142, v137
  v_mul_f32 v143, v143, v137
  v_mul_f32 v144, v144, v137
  v_mul_f32 v145, v145, v137
  v_mul_f32 v146, v146, v137
  v_mul_f32 v147, v147, v137
  v_cvt_pk_bf16_f32 v132, v140, v141
  v_cvt_pk_bf16_f32 v133, v142, v143
  v_cvt_pk_bf16_f32 v134, v144, v145
  v_cvt_pk_bf16_f32 v135, v146, v147
  buffer_store_dwordx4 v[132:135], v0, s[4:7], s93 offen sc1
  v_cvt_pk_bf16_f32 v188, 0, v188
  v_ashrrev_i32 v189, 31, v188
  v_or_b32 v189, 0x80000000, v189
  v_xor_b32 v188, v188, v189
  s_sub_u32 s92, 4095, s90
  v_and_b32 v188, 0xffff0000, v188
  v_or_b32 v38, s92, v188
  s_bfe_u32 s92, s65, 196625
  s_lshl_b32 s92, s92, 18
  s_lshl_b32 s93, s90, 7
  s_add_u32 s92, s92, s93
  s_add_u32 s84, s92, 243269632
  s_waitcnt vmcnt(0)
  s_mov_b64 exec, 1
  buffer_store_dword v38, off, s[4:7], s84 sc1
  s_mov_b64 exec, -1
  s_mov_b32 s84, 268435456
  s_branch o_fd_211
o_rt_215:
  s_mov_b32 s67, 0
o_rl_217:
  s_lshl_b32 s94, s43, 14
  s_add_u32 s94, s94, s86
  buffer_load_dwordx4 v[120:123], v5, s[4:7], s94 offen offset:0 sc1
  buffer_load_dwordx4 v[124:127], v5, s[4:7], s94 offen offset:512 sc1
  buffer_load_dwordx4 v[128:131], v5, s[4:7], s94 offen offset:256 sc1
  buffer_load_dwordx4 v[132:135], v5, s[4:7], s94 offen offset:768 sc1
  s_add_u32 s94, s94, 4096
  buffer_load_dwordx4 v[136:139], v5, s[4:7], s94 offen offset:0 sc1
  buffer_load_dwordx4 v[140:143], v5, s[4:7], s94 offen offset:512 sc1
  buffer_load_dwordx4 v[144:147], v5, s[4:7], s94 offen offset:256 sc1
  buffer_load_dwordx4 v[148:151], v5, s[4:7], s94 offen offset:768 sc1
  s_add_u32 s94, s94, 4096
  buffer_load_dwordx4 v[152:155], v5, s[4:7], s94 offen offset:0 sc1
  buffer_load_dwordx4 v[156:159], v5, s[4:7], s94 offen offset:512 sc1
  buffer_load_dwordx4 v[160:163], v5, s[4:7], s94 offen offset:256 sc1
  buffer_load_dwordx4 v[164:167], v5, s[4:7], s94 offen offset:768 sc1
  s_add_u32 s94, s94, 4096
  buffer_load_dwordx4 v[168:171], v5, s[4:7], s94 offen offset:0 sc1
  buffer_load_dwordx4 v[172:175], v5, s[4:7], s94 offen offset:512 sc1
  buffer_load_dwordx4 v[176:179], v5, s[4:7], s94 offen offset:256 sc1
  buffer_load_dwordx4 v[180:183], v5, s[4:7], s94 offen offset:768 sc1
  s_add_u32 s67, s67, 1
  s_cmp_gt_u32 s67, 1048576
  s_cbranch_scc1 L_end
  s_waitcnt vmcnt(0)
  v_xor_b32 v7, s96, v120
  v_bitop3_b32 v7, v7, v124, s96 bitop3:0xf6
  v_bitop3_b32 v7, v7, v128, s96 bitop3:0xf6
  v_bitop3_b32 v7, v7, v132, s96 bitop3:0xf6
  v_bitop3_b32 v7, v7, v136, s96 bitop3:0xf6
  v_bitop3_b32 v7, v7, v140, s96 bitop3:0xf6
  v_bitop3_b32 v7, v7, v144, s96 bitop3:0xf6
  v_bitop3_b32 v7, v7, v148, s96 bitop3:0xf6
  v_bitop3_b32 v7, v7, v152, s96 bitop3:0xf6
  v_bitop3_b32 v7, v7, v156, s96 bitop3:0xf6
  v_bitop3_b32 v7, v7, v160, s96 bitop3:0xf6
  v_bitop3_b32 v7, v7, v164, s96 bitop3:0xf6
  v_bitop3_b32 v7, v7, v168, s96 bitop3:0xf6
  v_bitop3_b32 v7, v7, v172, s96 bitop3:0xf6
  v_bitop3_b32 v7, v7, v176, s96 bitop3:0xf6
  v_bitop3_b32 v7, v7, v180, s96 bitop3:0xf6
  v_and_b32 v7, v254, v7
  v_cmp_ne_u32 vcc, 0, v7
  s_cbranch_vccnz o_rl_217
  s_branch o_bk_216
o_f2_212:
  s_lshl_b32 s94, s43, 14
  s_add_u32 s94, s94, s86
  buffer_load_dwordx4 v[120:123], v5, s[4:7], s94 offen offset:0 sc1
  buffer_load_dwordx4 v[124:127], v5, s[4:7], s94 offen offset:512 sc1
  buffer_load_dwordx4 v[128:131], v5, s[4:7], s94 offen offset:256 sc1
  buffer_load_dwordx4 v[132:135], v5, s[4:7], s94 offen offset:768 sc1
  s_add_u32 s94, s94, 4096
  buffer_load_dwordx4 v[136:139], v5, s[4:7], s94 offen offset:0 sc1
  buffer_load_dwordx4 v[140:143], v5, s[4:7], s94 offen offset:512 sc1
  buffer_load_dwordx4 v[144:147], v5, s[4:7], s94 offen offset:256 sc1
  buffer_load_dwordx4 v[148:151], v5, s[4:7], s94 offen offset:768 sc1
  s_add_u32 s94, s94, 4096
  buffer_load_dwordx4 v[152:155], v5, s[4:7], s94 offen offset:0 sc1
  buffer_load_dwordx4 v[156:159], v5, s[4:7], s94 offen offset:512 sc1
  buffer_load_dwordx4 v[160:163], v5, s[4:7], s94 offen offset:256 sc1
  buffer_load_dwordx4 v[164:167], v5, s[4:7], s94 offen offset:768 sc1
  s_add_u32 s94, s94, 4096
  buffer_load_dwordx4 v[168:171], v5, s[4:7], s94 offen offset:0 sc1
  buffer_load_dwordx4 v[172:175], v5, s[4:7], s94 offen offset:512 sc1
  buffer_load_dwordx4 v[176:179], v5, s[4:7], s94 offen offset:256 sc1
  buffer_load_dwordx4 v[180:183], v5, s[4:7], s94 offen offset:768 sc1
  v_mov_b64 v[188:189], 0
  v_mov_b64 v[190:191], 0
  v_mov_b64 v[192:193], 0
  v_mov_b64 v[194:195], 0
  s_waitcnt vmcnt(12)
  v_xor_b32 v7, s96, v120
  v_bitop3_b32 v7, v7, v124, s96 bitop3:0xf6
  v_bitop3_b32 v7, v7, v128, s96 bitop3:0xf6
  v_bitop3_b32 v7, v7, v132, s96 bitop3:0xf6
  s_waitcnt vmcnt(8)
  v_bitop3_b32 v7, v7, v136, s96 bitop3:0xf6
  v_bitop3_b32 v7, v7, v140, s96 bitop3:0xf6
  v_bitop3_b32 v7, v7, v144, s96 bitop3:0xf6
  v_bitop3_b32 v7, v7, v148, s96 bitop3:0xf6
  s_waitcnt vmcnt(4)
  v_bitop3_b32 v7, v7, v152, s96 bitop3:0xf6
  v_bitop3_b32 v7, v7, v156, s96 bitop3:0xf6
  v_bitop3_b32 v7, v7, v160, s96 bitop3:0xf6
  v_bitop3_b32 v7, v7, v164, s96 bitop3:0xf6
  s_waitcnt vmcnt(0)
  v_bitop3_b32 v7, v7, v168, s96 bitop3:0xf6
  v_bitop3_b32 v7, v7, v172, s96 bitop3:0xf6
  v_bitop3_b32 v7, v7, v176, s96 bitop3:0xf6
  v_bitop3_b32 v7, v7, v180, s96 bitop3:0xf6
  v_and_b32 v7, v254, v7
  v_cmp_ne_u32 vcc, 0, v7
  s_cbranch_vccnz o_rt_218
o_bk_219:
  v_smfmac_f32_16x16x64_bf16 v[188:191], v[16:19], v[120:127], v20
  v_lshlrev_b32 v196, 16, v184
  v_smfmac_f32_16x16x64_bf16 v[192:195], v[16:19], v[128:135], v20
  v_and_b32 v197, 0xffff0000, v184
  v_smfmac_f32_16x16x64_bf16 v[188:191], v[16:19], v[136:143], v20
  v_lshlrev_b32 v198, 16, v185
  v_smfmac_f32_16x16x64_bf16 v[192:195], v[16:19], v[144:151], v20
  v_and_b32 v199, 0xffff0000, v185
  v_smfmac_f32_16x16x64_bf16 v[188:191], v[16:19], v[152:159], v20
  v_lshlrev_b32 v200, 16, v186
  v_smfmac_f32_16x16x64_bf16 v[192:195], v[16:19], v[160:167], v20
  v_and_b32 v201, 0xffff0000, v186
  v_smfmac_f32_16x16x64_bf16 v[188:191], v[16:19], v[168:175], v20
  v_lshlrev_b32 v202, 16, v187
  v_smfmac_f32_16x16x64_bf16 v[192:195], v[16:19], v[176:183], v20
  v_and_b32 v203, 0xffff0000, v187
  s_bfe_u32 s92, s65, 131086
  s_lshl_b32 s92, s92, 21
  s_add_u32 s92, s92, s91
  s_add_u32 s93, s92, 27262976
  s_add_u32 s92, s92, 20971520
  s_nop 1
  v_permlane16_swap_b32 v188, v192
  v_permlane16_swap_b32 v189, v193
  v_permlane16_swap_b32 v190, v194
  v_permlane16_swap_b32 v191, v195
  v_cvt_pk_bf16_f32 v188, 0, v188
  v_cvt_pk_bf16_f32 v189, 0, v189
  v_cvt_pk_bf16_f32 v190, 0, v190
  v_cvt_pk_bf16_f32 v191, 0, v191
  v_cvt_pk_bf16_f32 v192, 0, v192
  v_cvt_pk_bf16_f32 v193, 0, v193
  v_cvt_pk_bf16_f32 v194, 0, v194
  v_cvt_pk_bf16_f32 v195, 0, v195
  v_add_f32 v196, v196, v188
  v_add_f32 v197, v197, v189
  v_add_f32 v198, v198, v190
  v_add_f32 v199, v199, v191
  v_add_f32 v200, v200, v192
  v_add_f32 v201, v201, v193
  v_add_f32 v202, v202, v194
  v_add_f32 v203, v203, v195
  v_cvt_pk_bf16_f32 v120, v196, v197
  v_cvt_pk_bf16_f32 v121, v198, v199
  v_cvt_pk_bf16_f32 v122, v200, v201
  v_cvt_pk_bf16_f32 v123, v202, v203
  v_lshlrev_b32 v196, 16, v120
  v_and_b32 v197, 0xffff0000, v120
  v_lshlrev_b32 v198, 16, v121
  v_and_b32 v199, 0xffff0000, v121
  v_lshlrev_b32 v200, 16, v122
  v_and_b32 v201, 0xffff0000, v122
  v_lshlrev_b32 v202, 16, v123
  v_and_b32 v203, 0xffff0000, v123
  buffer_store_dwordx4 v[120:123], v0, s[4:7], s92 offen sc1
  v_add_f32 v136, v196, v197
  v_mul_f32 v137, v196, v196
  v_add_f32 v138, v198, v199
  v_mul_f32 v139, v197, v197
  v_fmac_f32 v137, v198, v198
  v_fmac_f32 v139, v199, v199
  v_add_f32 v136, v136, v200
  v_fmac_f32 v137, v200, v200
  v_add_f32 v138, v138, v201
  v_fmac_f32 v139, v201, v201
  v_add_f32 v136, v136, v202
  v_fmac_f32 v137, v202, v202
  v_add_f32 v138, v138, v203
  v_fmac_f32 v139, v203, v203
  v_add_f32 v136, v136, v138
  v_add_f32 v137, v137, v139
  s_nop 0
  v_add_f32_dpp v136, v136, v136 row_ror:8 row_mask:0xf bank_mask:0xf
  v_add_f32_dpp v137, v137, v137 row_ror:8 row_mask:0xf bank_mask:0xf
  s_nop 0
  v_add_f32_dpp v136, v136, v136 row_ror:4 row_mask:0xf bank_mask:0xf
  v_add_f32_dpp v137, v137, v137 row_ror:4 row_mask:0xf bank_mask:0xf
  s_nop 0
  v_add_f32_dpp v136, v136, v136 row_ror:2 row_mask:0xf bank_mask:0xf
  v_add_f32_dpp v137, v137, v137 row_ror:2 row_mask:0xf bank_mask:0xf
  s_nop 0
  v_add_f32_dpp v136, v136, v136 row_ror:1 row_mask:0xf bank_mask:0xf
  v_add_f32_dpp v137, v137, v137 row_ror:1 row_mask:0xf bank_mask:0xf
  v_mov_b32 v140, v136
  v_mov_b32 v141, v137
  s_nop 0
  v_permlane16_swap_b32 v136, v140
  v_permlane16_swap_b32 v137, v141
  v_add_f32 v136, v136, v140
  v_add_f32 v137, v137, v141
  v_mov_b32 v140, v136
  v_mov_b32 v141, v137
  s_nop 0
  v_permlane32_swap_b32 v136, v140
  v_permlane32_swap_b32 v137, v141
  v_add_f32 v136, v136, v140
  v_add_f32 v137, v137, v141
  v_mul_f32 v136, 0x3b000000, v136
  v_mul_f32 v137, 0x3b000000, v137
  v_fma_f32 v137, -v136, v136, v137
  v_cvt_pk_bf16_f32 v136, 0, v136
  v_max_f32 v137, 0, v137
  v_sub_f32 v140, v196, v136
  v_sub_f32 v141, v197, v136
  v_cvt_pk_bf16_f32 v137, 0, v137
  v_sub_f32 v142, v198, v136
  v_sub_f32 v143, v199, v136
  v_add_f32 v137, 0x3727c5ac, v137
  v_sub_f32 v144, v200, v136
  v_sub_f32 v145, v201, v136
  v_cvt_pk_bf16_f32 v137, 0, v137
  v_sub_f32 v146, v202, v136
  v_sub_f32 v147, v203, v136
  v_sqrt_f32 v137, v137
  v_cvt_pk_bf16_f32 v140, 0, v140
  v_cvt_pk_bf16_f32 v141, 0, v141
  v_cvt_pk_bf16_f32 v137, 0, v137
  v_cvt_pk_bf16_f32 v142, 0, v142
  v_cvt_pk_bf16_f32 v143, 0, v143
  v_rcp_f32 v137, v137
  v_cvt_pk_bf16_f32 v144, 0, v144
  v_cvt_pk_bf16_f32 v145, 0, v145
  v_cvt_pk_bf16_f32 v146, 0, v146
  v_cvt_pk_bf16_f32 v147, 0, v147
  v_mul_f32 v140, v140, v137
  v_mul_f32 v141, v141, v137
  v_mul_f32 v142, v142, v137
  v_mul_f32 v143, v143, v137
  v_mul_f32 v144, v144, v137
  v_mul_f32 v145, v145, v137
  v_mul_f32 v146, v146, v137
  v_mul_f32 v147, v147, v137
  v_cvt_pk_bf16_f32 v124, v140, v141
  v_cvt_pk_bf16_f32 v125, v142, v143
  v_cvt_pk_bf16_f32 v126, v144, v145
  v_cvt_pk_bf16_f32 v127, v146, v147
  v_lshlrev_b32 v204, 16, v124
  v_and_b32 v205, 0xffff0000, v124
  v_lshlrev_b32 v206, 16, v125
  v_and_b32 v207, 0xffff0000, v125
  v_lshlrev_b32 v208, 16, v126
  v_and_b32 v209, 0xffff0000, v126
  v_lshlrev_b32 v210, 16, v127
  v_and_b32 v211, 0xffff0000, v127
  buffer_store_dwordx4 v[124:127], v0, s[4:7], s93 offen sc1
  v_add_f32 v196, v196, v204
  v_add_f32 v197, v197, v205
  v_add_f32 v198, v198, v206
  v_add_f32 v199, v199, v207
  v_add_f32 v200, v200, v208
  v_add_f32 v201, v201, v209
  v_add_f32 v202, v202, v210
  v_add_f32 v203, v203, v211
  v_cvt_pk_bf16_f32 v128, v196, v197
  v_cvt_pk_bf16_f32 v129, v198, v199
  v_cvt_pk_bf16_f32 v130, v200, v201
  v_cvt_pk_bf16_f32 v131, v202, v203
  v_mul_f32 v188, v204, v8
  v_mul_f32 v189, v205, v9
  v_fmac_f32 v188, v206, v10
  v_fmac_f32 v189, v207, v11
  v_fmac_f32 v188, v208, v12
  v_fmac_f32 v189, v209, v13
  v_fmac_f32 v188, v210, v14
  v_fmac_f32 v189, v211, v15
  v_add_f32 v188, v188, v189
  buffer_store_dwordx4 v[128:131], v0, s[68:71], s91 offen sc1
  s_nop 0
  v_add_f32_dpp v188, v188, v188 row_ror:8 row_mask:0xf bank_mask:0xf
  s_nop 1
  v_add_f32_dpp v188, v188, v188 row_ror:4 row_mask:0xf bank_mask:0xf
  s_nop 1
  v_add_f32_dpp v188, v188, v188 row_ror:2 row_mask:0xf bank_mask:0xf
  s_nop 1
  v_add_f32_dpp v188, v188, v188 row_ror:1 row_mask:0xf bank_mask:0xf
  v_mov_b32 v189, v188
  s_nop 0
  s_nop 0
  v_permlane16_swap_b32 v188, v189
  v_add_f32 v188, v188, v189
  v_mov_b32 v189, v188
  s_nop 0
  s_nop 0
  v_permlane32_swap_b32 v188, v189
  v_add_f32 v188, v188, v189
  v_cvt_pk_bf16_f32 v188, 0, v188
  v_ashrrev_i32 v189, 31, v188
  v_or_b32 v189, 0x80000000, v189
  v_xor_b32 v188, v188, v189
  s_sub_u32 s92, 4095, s90
  v_and_b32 v188, 0xffff0000, v188
  v_or_b32 v38, s92, v188
  s_bfe_u32 s92, s65, 196625
  s_lshl_b32 s92, s92, 18
  s_lshl_b32 s93, s90, 7
  s_add_u32 s92, s92, s93
  s_add_u32 s84, s92, 243269632
  s_waitcnt vmcnt(0)
  s_mov_b64 exec, 1
  buffer_store_dword v38, off, s[4:7], s84 sc1
  s_mov_b64 exec, -1
  s_mov_b32 s84, 268435456
  s_branch o_fd_211
o_rt_218:
  s_mov_b32 s67, 0
o_rl_220:
  s_lshl_b32 s94, s43, 14
  s_add_u32 s94, s94, s86
  buffer_load_dwordx4 v[120:123], v5, s[4:7], s94 offen offset:0 sc1
  buffer_load_dwordx4 v[124:127], v5, s[4:7], s94 offen offset:512 sc1
  buffer_load_dwordx4 v[128:131], v5, s[4:7], s94 offen offset:256 sc1
  buffer_load_dwordx4 v[132:135], v5, s[4:7], s94 offen offset:768 sc1
  s_add_u32 s94, s94, 4096
  buffer_load_dwordx4 v[136:139], v5, s[4:7], s94 offen offset:0 sc1
  buffer_load_dwordx4 v[140:143], v5, s[4:7], s94 offen offset:512 sc1
  buffer_load_dwordx4 v[144:147], v5, s[4:7], s94 offen offset:256 sc1
  buffer_load_dwordx4 v[148:151], v5, s[4:7], s94 offen offset:768 sc1
  s_add_u32 s94, s94, 4096
  buffer_load_dwordx4 v[152:155], v5, s[4:7], s94 offen offset:0 sc1
  buffer_load_dwordx4 v[156:159], v5, s[4:7], s94 offen offset:512 sc1
  buffer_load_dwordx4 v[160:163], v5, s[4:7], s94 offen offset:256 sc1
  buffer_load_dwordx4 v[164:167], v5, s[4:7], s94 offen offset:768 sc1
  s_add_u32 s94, s94, 4096
  buffer_load_dwordx4 v[168:171], v5, s[4:7], s94 offen offset:0 sc1
  buffer_load_dwordx4 v[172:175], v5, s[4:7], s94 offen offset:512 sc1
  buffer_load_dwordx4 v[176:179], v5, s[4:7], s94 offen offset:256 sc1
  buffer_load_dwordx4 v[180:183], v5, s[4:7], s94 offen offset:768 sc1
  s_add_u32 s67, s67, 1
  s_cmp_gt_u32 s67, 1048576
  s_cbranch_scc1 L_end
  s_waitcnt vmcnt(0)
  v_xor_b32 v7, s96, v120
  v_bitop3_b32 v7, v7, v124, s96 bitop3:0xf6
  v_bitop3_b32 v7, v7, v128, s96 bitop3:0xf6
  v_bitop3_b32 v7, v7, v132, s96 bitop3:0xf6
  v_bitop3_b32 v7, v7, v136, s96 bitop3:0xf6
  v_bitop3_b32 v7, v7, v140, s96 bitop3:0xf6
  v_bitop3_b32 v7, v7, v144, s96 bitop3:0xf6
  v_bitop3_b32 v7, v7, v148, s96 bitop3:0xf6
  v_bitop3_b32 v7, v7, v152, s96 bitop3:0xf6
  v_bitop3_b32 v7, v7, v156, s96 bitop3:0xf6
  v_bitop3_b32 v7, v7, v160, s96 bitop3:0xf6
  v_bitop3_b32 v7, v7, v164, s96 bitop3:0xf6
  v_bitop3_b32 v7, v7, v168, s96 bitop3:0xf6
  v_bitop3_b32 v7, v7, v172, s96 bitop3:0xf6
  v_bitop3_b32 v7, v7, v176, s96 bitop3:0xf6
  v_bitop3_b32 v7, v7, v180, s96 bitop3:0xf6
  v_and_b32 v7, v254, v7
  v_cmp_ne_u32 vcc, 0, v7
  s_cbranch_vccnz o_rl_220
  s_branch o_bk_219
o_fd_211:
  s_mov_b32 s65, 0
o_nofl_171:
  s_mov_b32 s63, s64
  s_cmp_lg_u32 s51, 0
  s_cbranch_scc1 o_pick_173
  s_cmp_eq_u32 s50, 0
  s_cbranch_scc1 L_end
o_adv_179:
  s_add_u32 s49, s49, 4
  s_branch o_round_169
o_dl_181:
  s_and_b32 s26, s55, s54
  s_andn2_b32 s27, s56, s54
  s_or_b32 s26, s26, s27
  s_andn2_b32 s26, s58, s26
  s_bcnt1_i32_b32 s27, s26
  s_add_u32 s27, s27, 0
  s_mul_i32 s27, s27, 86
  s_lshr_b32 s27, s27, 8
o_dl1_182:
  s_cbranch_scc0 o_dl2_183
  s_ff1_i32_b32 s28, s26
  s_bitset0_b32 s26, s28
  s_bitset0_b32 s58, s28
  s_sub_u32 s27, s27, 1
  s_cmp_lg_u32 s27, 0
  s_branch o_dl1_182
o_dl2_183:
  s_xor_b32 s26, s58, 0x8000ffff
  s_lshl_b32 s27, s60, 7
  s_add_u32 s27, s27, 243269696
  s_cmp_lg_u32 s43, 0
  s_cbranch_scc1 o_pick_173
  v_mov_b32 v162, s26
  v_mov_b32 v163, s46
  s_mov_b64 exec, 1
  buffer_store_dwordx2 v[162:163], off, s[4:7], s27 sc1
  s_mov_b64 exec, -1
  s_branch o_pick_173
o_help_180:
  s_lshl_b32 s60, s60, 1
  s_and_b32 s60, s60, 2
  s_lshl_b32 s27, s60, 7
  s_add_u32 s27, s27, 243269696
  s_mov_b32 s67, 0
o_help_180_w:
  buffer_load_dwordx2 v[162:163], off, s[4:7], s27 sc1
  buffer_load_dword v164, off, s[4:7], s27 offset:128 sc1
  s_add_u32 s67, s67, 1
  s_cmp_gt_u32 s67, 1048576
  s_cbranch_scc1 L_end
  s_waitcnt vmcnt(0)
  v_readfirstlane_b32 s28, v162
  v_readfirstlane_b32 s30, v164
  v_readfirstlane_b32 s46, v163
  s_and_b32 s26, s28, s30
  s_bitcmp1_b32 s26, 31
  s_cbranch_scc0 o_help_180_w
  s_bitreplicate_b64_b32 s[28:29], s28
  s_bitreplicate_b64_b32 s[30:31], s30
  s_and_b32 s28, s28, 0x55555555
  s_and_b32 s30, s30, 0xaaaaaaaa
  s_or_b32 s58, s28, s30
  s_andn2_b32 s52, 0xfff, s46
  s_lshr_b32 s52, s52, 5
  s_sub_u32 s26, s52, s60
  s_add_u32 s27, s26, 3
  s_add_u32 s26, s26, 2
  s_lshr_b32 s27, s27, 2
  s_lshr_b32 s26, s26, 2
  s_add_u32 s26, s26, s27
  s_bfm_b64 s[28:29], s26, 0
  s_mov_b32 s54, s28
  s_mov_b32 s53, 0
  s_mov_b32 s63, 0
  s_mov_b32 s49, 72
  s_mov_b32 s59, 64
  s_mov_b32 s50, 0
  s_mov_b32 s89, 0
  s_branch o_pick_173

.section .rodata,"a"
.p2align 6
.amdhsa_kernel interleave_layers__memory_aug_recurrent_mem_tr__moe_arch_mod__prompt_kernel
  .amdhsa_next_free_vgpr 512
  .amdhsa_next_free_sgpr 102
  .amdhsa_accum_offset 256
  .amdhsa_group_segment_fixed_size 0
  .amdhsa_kernarg_size 120
  .amdhsa_user_sgpr_count 2
  .amdhsa_user_sgpr_kernarg_segment_ptr 1
  .amdhsa_system_sgpr_workgroup_id_x 1
  .amdhsa_float_denorm_mode_32 3
.end_amdhsa_kernel
```

```asm
; @launch grid=(256,1,1) block=(256,1,1) lds=163840
.amdgcn_target "amdgcn-amd-amdhsa--gfx950"
.text
.globl interleave_layers__memory_aug_recurrent_mem_tr__moe_arch_mod__prompt_kernel
.p2align 8
.type interleave_layers__memory_aug_recurrent_mem_tr__moe_arch_mod__prompt_kernel,@function
interleave_layers__memory_aug_recurrent_mem_tr__moe_arch_mod__prompt_kernel:
  s_cmp_ge_u32 s2, 256
  s_cbranch_scc1 L_end
  s_mov_b32 s6, 268435456
  s_mov_b32 s7, 0x20000
  s_mov_b32 s11, 0x20000
  s_getreg_b32 s89, hwreg(HW_REG_XCC_ID)
  s_and_b32 s89, s89, 7
  v_lshrrev_b32 v1, 6, v0
  s_and_b32 s91, s2, 7
  s_lshr_b32 s90, s2, 3
  v_readfirstlane_b32 s17, v1
  s_lshl_b32 s100, s91, 5
  s_add_u32 s100, s100, s90
  s_lshl_b32 s100, s100, 2
  s_add_u32 s100, s100, s17
  s_lshl_b32 s100, s100, 12
  s_add_u32 s100, s100, 37748736
  s_cmp_lt_u32 s91, 3
  s_cbranch_scc1 L_chain
  s_cmp_eq_u32 s91, 7
  s_cbranch_scc1 L_qkv
  s_bitcmp1_b32 s90, 4
  s_cbranch_scc1 L_qkv
  s_branch L_o
L_end:
  s_endpgm
L_chain:
  s_load_dwordx2 s[4:5], s[0:1], 112
  s_load_dwordx2 s[12:13], s[0:1], 104
  s_mov_b32 s16, s90
  s_mov_b32 s60, s91
  s_min_u32 s61, s91, 1
  v_lshrrev_b32 v18, 6, v0
  v_and_b32 v19, 63, v0
  v_readfirstlane_b32 s17, v18
  v_and_b32 v7, 15, v19
  v_lshrrev_b32 v17, 4, v19
  v_lshlrev_b32 v0, 4, v19
  s_load_dwordx2 s[56:57], s[0:1], 8
  s_mov_b32 s44, 0x05040100
  s_mov_b32 s45, 0x07060302
  s_mov_b32 s18, 0xcccccccc
  s_mov_b32 s19, 0xcccccccc
  s_mov_b32 s24, 0x3e0293ee
  s_lshl_b32 s26, s17, 10
  v_add_u32 v8, s26, v0
  v_xor_b32 v9, 1024, v8
  v_xor_b32 v10, 2048, v8
  v_xor_b32 v11, 3072, v8
  s_mov_b32 s14, 0x3f803f80
  s_mov_b32 s15, 0x3f803f80
  s_mul_i32 s27, s17, 24576
  s_add_u32 s27, s27, 65536
  v_add_u32 v1, s27, v0
  v_lshrrev_b32 v20, 2, v7
  v_xor_b32 v21, v17, v20
  v_lshlrev_b32 v22, 5, v7
  v_add_u32 v22, s26, v22
  v_lshl_add_u32 v2, v21, 3, v22
  v_and_b32 v21, 3, v7
  v_xor_b32 v21, v21, v17
  v_lshl_add_u32 v22, v17, 2, v20
  v_lshlrev_b32 v22, 5, v22
  v_lshl_add_u32 v3, v21, 3, v22
  v_add_u32 v12, s26, v3
  v_xor_b32 v13, 1024, v12
  v_xor_b32 v14, 2048, v12
  v_xor_b32 v15, 3072, v12
  v_lshlrev_b32 v21, 13, v20
  v_and_b32 v22, 3, v7
  v_lshl_add_u32 v22, v17, 2, v22
  v_lshl_add_u32 v21, v22, 4, v21
  s_lshl_b32 s27, s17, 16
  s_lshl_b32 s28, s16, 8
  s_add_u32 s27, s27, s28
  v_add_u32 v4, s27, v21
  v_and_b32 v21, 1, v7
  v_lshl_add_u32 v21, v17, 2, v21
  v_bfe_u32 v22, v7, 2, 1
  v_lshl_add_u32 v21, v22, 1, v21
  v_lshlrev_b32 v21, 4, v21
  v_bfe_u32 v22, v7, 1, 1
  v_lshl_add_u32 v21, v22, 3, v21
  v_add_u32 v5, s28, v21
  v_cmp_lt_u32 vcc, 7, v7
  v_mov_b32 v22, 0x7ff00000
  s_nop 0
  v_cndmask_b32 v5, v5, v22, vcc
  v_mov_b32 v21, 0x4444
  v_mov_b32 v22, 0xeeee
  v_cndmask_b32 v6, v21, v22, s[18:19]
  s_lshl_b32 s40, s60, 20
  s_add_u32 s40, s40, 0
  s_add_u32 s41, s40, 32768
  s_lshl_b32 s62, s60, 16
  s_add_u32 s62, s62, 4194304
  v_mov_b32 v24, -1
  v_mov_b32 v25, -1
  v_mov_b32 v26, -1
  v_mov_b32 v27, -1
  s_waitcnt lgkmcnt(0)
  buffer_store_dwordx4 v[24:27], v4, s[4:7], s40 offen sc1
  buffer_store_dwordx4 v[24:27], v4, s[4:7], s41 offen sc1
  s_add_u32 s27, s62, 0
  buffer_store_dwordx2 v[24:25], v5, s[4:7], s27 offen sc1
  s_add_u32 s27, s62, 8192
  buffer_store_dwordx2 v[24:25], v5, s[4:7], s27 offen sc1
  s_add_u32 s27, s62, 16384
  buffer_store_dwordx2 v[24:25], v5, s[4:7], s27 offen sc1
  s_add_u32 s27, s62, 24576
  buffer_store_dwordx2 v[24:25], v5, s[4:7], s27 offen sc1
  v_mov_b64 v[28:29], 0
  v_mov_b64 v[30:31], 0
  s_lshl_b32 s26, s16, 12
  s_cmp_eq_u32 s91, 0
  s_cbranch_scc1 L_ch1
  s_cmp_eq_u32 s91, 2
  s_cbranch_scc1 L_ch2
  s_add_u32 s27, s26, 243269632
  buffer_store_dwordx4 v[28:31], v8, s[4:7], s27 offen sc1
  s_add_u32 s27, s26, 243400704
  buffer_store_dwordx4 v[28:31], v8, s[4:7], s27 offen sc1
  s_add_u32 s27, s26, 243531776
  buffer_store_dwordx4 v[28:31], v8, s[4:7], s27 offen sc1
  s_add_u32 s27, s26, 243662848
  buffer_store_dwordx4 v[28:31], v8, s[4:7], s27 offen sc1
  s_add_u32 s27, s26, 243793920
  buffer_store_dwordx4 v[28:31], v8, s[4:7], s27 offen sc1
  s_add_u32 s27, s26, 243924992
  buffer_store_dwordx4 v[28:31], v8, s[4:7], s27 offen sc1
  s_add_u32 s27, s26, 244056064
  buffer_store_dwordx4 v[28:31], v8, s[4:7], s27 offen sc1
  s_add_u32 s27, s26, 244187136
  buffer_store_dwordx4 v[28:31], v8, s[4:7], s27 offen sc1
  s_add_u32 s27, s26, 244318208
  buffer_store_dwordx4 v[28:31], v8, s[4:7], s27 offen sc1
  s_add_u32 s27, s26, 244449280
  buffer_store_dwordx4 v[28:31], v8, s[4:7], s27 offen sc1
  s_add_u32 s27, s26, 244580352
  buffer_store_dwordx4 v[28:31], v8, s[4:7], s27 offen sc1
  s_add_u32 s27, s26, 244711424
  buffer_store_dwordx4 v[28:31], v8, s[4:7], s27 offen sc1
  s_add_u32 s27, s26, 244842496
  buffer_store_dwordx4 v[28:31], v8, s[4:7], s27 offen sc1
  s_add_u32 s27, s26, 244973568
  buffer_store_dwordx4 v[28:31], v8, s[4:7], s27 offen sc1
  s_add_u32 s27, s26, 245104640
  buffer_store_dwordx4 v[28:31], v8, s[4:7], s27 offen sc1
  s_add_u32 s27, s26, 245235712
  buffer_store_dwordx4 v[28:31], v8, s[4:7], s27 offen sc1
  s_add_u32 s27, s26, 245366784
  buffer_store_dwordx4 v[28:31], v8, s[4:7], s27 offen sc1
  s_branch L_ch0
L_ch2:
  s_add_u32 s27, s26, 245891072
  buffer_store_dwordx4 v[24:27], v8, s[4:7], s27 offen sc1
  s_add_u32 s27, s26, 246022144
  buffer_store_dwordx4 v[24:27], v8, s[4:7], s27 offen sc1
  s_add_u32 s27, s26, 246153216
  buffer_store_dwordx4 v[24:27], v8, s[4:7], s27 offen sc1
  s_add_u32 s27, s26, 246284288
  buffer_store_dwordx4 v[24:27], v8, s[4:7], s27 offen sc1
  s_add_u32 s27, s26, 246415360
  buffer_store_dwordx4 v[24:27], v8, s[4:7], s27 offen sc1
  s_add_u32 s27, s26, 246546432
  buffer_store_dwordx4 v[24:27], v8, s[4:7], s27 offen sc1
  s_add_u32 s27, s26, 246677504
  buffer_store_dwordx4 v[24:27], v8, s[4:7], s27 offen sc1
  s_add_u32 s27, s26, 246808576
  buffer_store_dwordx4 v[24:27], v8, s[4:7], s27 offen sc1
  s_add_u32 s27, s26, 246939648
  buffer_store_dwordx4 v[24:27], v8, s[4:7], s27 offen sc1
  s_add_u32 s27, s26, 247070720
  buffer_store_dwordx4 v[24:27], v8, s[4:7], s27 offen sc1
  s_add_u32 s27, s26, 247201792
  buffer_store_dwordx4 v[24:27], v8, s[4:7], s27 offen sc1
  s_add_u32 s27, s26, 247332864
  buffer_store_dwordx4 v[24:27], v8, s[4:7], s27 offen sc1
  s_add_u32 s27, s26, 247463936
  buffer_store_dwordx4 v[24:27], v8, s[4:7], s27 offen sc1
  s_add_u32 s27, s26, 247595008
  buffer_store_dwordx4 v[24:27], v8, s[4:7], s27 offen sc1
  s_add_u32 s27, s26, 247726080
  buffer_store_dwordx4 v[24:27], v8, s[4:7], s27 offen sc1
  s_add_u32 s27, s26, 247857152
  buffer_store_dwordx4 v[24:27], v8, s[4:7], s27 offen sc1
  s_add_u32 s27, s26, 247988224
  buffer_store_dwordx4 v[24:27], v8, s[4:7], s27 offen sc1
  s_add_u32 s27, s26, 248119296
  buffer_store_dwordx4 v[24:27], v8, s[4:7], s27 offen sc1
  s_add_u32 s27, s26, 248250368
  buffer_store_dwordx4 v[24:27], v8, s[4:7], s27 offen sc1
  s_add_u32 s27, s26, 248381440
  buffer_store_dwordx4 v[24:27], v8, s[4:7], s27 offen sc1
  s_add_u32 s27, s26, 248512512
  buffer_store_dwordx4 v[24:27], v8, s[4:7], s27 offen sc1
  s_add_u32 s27, s26, 248643584
  buffer_store_dwordx4 v[24:27], v8, s[4:7], s27 offen sc1
  s_add_u32 s27, s26, 16777216
  buffer_store_dwordx4 v[28:31], v8, s[4:7], s27 offen sc1
  s_add_u32 s27, s26, 16908288
  buffer_store_dwordx4 v[28:31], v8, s[4:7], s27 offen sc1
  s_add_u32 s27, s26, 17039360
  buffer_store_dwordx4 v[28:31], v8, s[4:7], s27 offen sc1
  s_add_u32 s27, s26, 17170432
  buffer_store_dwordx4 v[28:31], v8, s[4:7], s27 offen sc1
  s_add_u32 s27, s26, 17301504
  buffer_store_dwordx4 v[28:31], v8, s[4:7], s27 offen sc1
  s_add_u32 s27, s26, 17432576
  buffer_store_dwordx4 v[28:31], v8, s[4:7], s27 offen sc1
  s_add_u32 s27, s26, 17563648
  buffer_store_dwordx4 v[28:31], v8, s[4:7], s27 offen sc1
  s_add_u32 s27, s26, 17694720
  buffer_store_dwordx4 v[28:31], v8, s[4:7], s27 offen sc1
  s_add_u32 s27, s26, 17825792
  buffer_store_dwordx4 v[28:31], v8, s[4:7], s27 offen sc1
  s_add_u32 s27, s26, 17956864
  buffer_store_dwordx4 v[28:31], v8, s[4:7], s27 offen sc1
  s_add_u32 s27, s26, 18087936
  buffer_store_dwordx4 v[28:31], v8, s[4:7], s27 offen sc1
  s_add_u32 s27, s26, 18219008
  buffer_store_dwordx4 v[28:31], v8, s[4:7], s27 offen sc1
  s_add_u32 s27, s26, 18350080
  buffer_store_dwordx4 v[28:31], v8, s[4:7], s27 offen sc1
  s_add_u32 s27, s26, 18481152
  buffer_store_dwordx4 v[28:31], v8, s[4:7], s27 offen sc1
  s_add_u32 s27, s26, 18612224
  buffer_store_dwordx4 v[28:31], v8, s[4:7], s27 offen sc1
  s_add_u32 s27, s26, 18743296
  buffer_store_dwordx4 v[28:31], v8, s[4:7], s27 offen sc1
L_ch0:
  s_waitcnt vmcnt(0)
  s_barrier
  s_cmp_lg_u32 s17, 0
  s_cbranch_scc1 g_ar_1
  s_lshl_b32 s36, s89, 3
  s_lshl_b64 s[36:37], 1, s36
  v_lshlrev_b32 v124, 3, s91
  v_mov_b32 v120, s36
  v_mov_b32 v121, s37
  s_mov_b64 exec, 1
  global_atomic_add_x2 v[122:123], v124, v[120:121], s[12:13] sc0
  s_mov_b64 exec, -1
g_ar_1:
  s_waitcnt vmcnt(0)
  s_cmp_lg_u32 s17, 0
  s_cbranch_scc1 g_af_2
  v_readfirstlane_b32 s36, v122
  v_readfirstlane_b32 s37, v123
  s_add_u32 s38, s36, s37
  s_mul_i32 s38, s38, 0x01010101
  s_lshr_b32 s38, s38, 24
  s_cmp_lg_u32 s38, 31
  s_cbranch_scc1 g_af_2
  s_lshl_b32 s38, s89, 3
  s_lshr_b64 s[36:37], s[36:37], s38
  s_and_b32 s36, s36, 0xff
  s_cmp_eq_u32 s36, 31
  s_cselect_b32 s36, 1, 2
  v_mov_b32 v120, s36
  v_lshrrev_b32 v124, 1, v124
  s_mov_b64 exec, 1
  global_store_dword v124, v120, s[12:13] offset:128 sc1
  s_mov_b64 exec, -1
g_af_2:
L_ch1:
  s_mov_b32 s58, 8192
  s_mov_b32 s59, 0x20000
  v_and_b32 v21, 1, v7
  v_lshl_add_u32 v21, v17, 1, v21
  v_lshlrev_b32 v21, 10, v21
  v_bfe_u32 v22, v7, 1, 2
  v_lshl_add_u32 v21, v22, 1, v21
  s_lshr_b32 s27, s16, 3
  s_lshl_b32 s27, s27, 8
  s_and_b32 s28, s16, 3
  s_lshl_b32 s28, s28, 6
  s_add_u32 s27, s27, s28
  s_and_b32 s28, s16, 4
  s_lshl_b32 s28, s28, 1
  s_add_u32 s27, s27, s28
  s_waitcnt lgkmcnt(0)
  buffer_load_ushort v28, v21, s[56:59], s27 offen offset:0
  buffer_load_ushort v29, v21, s[56:59], s27 offen offset:16
  buffer_load_ushort v30, v21, s[56:59], s27 offen offset:32
  buffer_load_ushort v31, v21, s[56:59], s27 offen offset:48
  s_cmp_eq_u32 s91, 0
  s_cbranch_scc1 L_ha
  v_mbcnt_lo_u32_b32 v116, -1, 0
  v_and_b32 v116, 0, v116
  v_add_lshl_u32 v116, v116, 1, 2
  s_mov_b32 s26, 0
g_wt_3:
  global_load_dword v117, v116, s[12:13] offset:128 sc1
  s_add_u32 s26, s26, 1
  s_cmp_gt_u32 s26, 1048576
  s_cbranch_scc1 L_end
  s_waitcnt vmcnt(0)
  v_cmp_eq_u32 vcc, 0, v117
  v_readfirstlane_b32 s27, v117
  s_cbranch_vccnz g_wt_3
  s_and_b32 s28, s16, 28
  s_or_b32 s28, s28, 1
  s_lshl_b32 s27, s28, 6
  s_add_u32 s27, s27, 245104640
  s_mov_b32 s26, 0
g_h_4:
  buffer_load_dwordx2 v[116:117], off, s[4:7], s27 sc1
  s_add_u32 s26, s26, 1
  s_cmp_gt_u32 s26, 1048576
  s_cbranch_scc1 L_end
  s_waitcnt vmcnt(0)
  v_and_or_b32 v116, v117, -1, v116
  v_cmp_eq_u32 vcc, 0, v116
  s_cbranch_vccnz g_h_4
L_ha:
  s_load_dwordx2 s[8:9], s[0:1], 40
  s_load_dwordx2 s[52:53], s[0:1], 16
  s_load_dwordx2 s[32:33], s[0:1], 24
  s_load_dwordx2 s[48:49], s[0:1], 32
  s_mov_b32 s10, 4194304
  s_mov_b32 s11, 0x20000
  s_mov_b32 s54, 4194304
  s_mov_b32 s55, 0x20000
  s_mov_b32 s34, 4194304
  s_mov_b32 s35, 0x20000
  s_mov_b32 s50, 4194304
  s_mov_b32 s51, 0x20000
  v_and_b32 v20, 1, v17
  v_lshlrev_b32 v20, 5, v20
  v_lshrrev_b32 v21, 1, v17
  v_lshl_add_u32 v20, v21, 2, v20
  v_lshlrev_b32 v20, 10, v20
  v_lshl_add_u32 v20, v7, 4, v20
  s_lshl_b32 s26, s16, 17
  s_lshl_b32 s27, s17, 8
  s_add_u32 s26, s26, s27
  s_waitcnt lgkmcnt(0)
  s_add_u32 s27, s26, 0
  buffer_load_dwordx4 v[128:131], v20, s[8:11], s27 offen
  s_add_u32 s27, s26, 1024
  buffer_load_dwordx4 v[132:135], v20, s[8:11], s27 offen
  s_add_u32 s27, s26, 16384
  buffer_load_dwordx4 v[136:139], v20, s[8:11], s27 offen
  s_add_u32 s27, s26, 17408
  buffer_load_dwordx4 v[140:143], v20, s[8:11], s27 offen
  s_add_u32 s27, s26, 2048
  buffer_load_dwordx4 v[144:147], v20, s[8:11], s27 offen
  s_add_u32 s27, s26, 3072
  buffer_load_dwordx4 v[148:151], v20, s[8:11], s27 offen
  s_add_u32 s27, s26, 18432
  buffer_load_dwordx4 v[152:155], v20, s[8:11], s27 offen
  s_add_u32 s27, s26, 19456
  buffer_load_dwordx4 v[156:159], v20, s[8:11], s27 offen
  s_add_u32 s27, s26, 8192
  buffer_load_dwordx4 v[160:163], v20, s[8:11], s27 offen
  s_add_u32 s27, s26, 9216
  buffer_load_dwordx4 v[164:167], v20, s[8:11], s27 offen
  s_add_u32 s27, s26, 24576
  buffer_load_dwordx4 v[168:171], v20, s[8:11], s27 offen
  s_add_u32 s27, s26, 25600
  buffer_load_dwordx4 v[172:175], v20, s[8:11], s27 offen
  s_add_u32 s27, s26, 10240
  buffer_load_dwordx4 v[176:179], v20, s[8:11], s27 offen
  s_add_u32 s27, s26, 11264
  buffer_load_dwordx4 v[180:183], v20, s[8:11], s27 offen
  s_add_u32 s27, s26, 26624
  buffer_load_dwordx4 v[184:187], v20, s[8:11], s27 offen
  s_add_u32 s27, s26, 27648
  buffer_load_dwordx4 v[188:191], v20, s[8:11], s27 offen
  s_add_u32 s27, s26, 65536
  buffer_load_dwordx4 v[192:195], v20, s[8:11], s27 offen
  s_add_u32 s27, s26, 66560
  buffer_load_dwordx4 v[196:199], v20, s[8:11], s27 offen
  s_add_u32 s27, s26, 81920
  buffer_load_dwordx4 v[200:203], v20, s[8:11], s27 offen
  s_add_u32 s27, s26, 82944
  buffer_load_dwordx4 v[204:207], v20, s[8:11], s27 offen
  s_add_u32 s27, s26, 67584
  buffer_load_dwordx4 v[208:211], v20, s[8:11], s27 offen
  s_add_u32 s27, s26, 68608
  buffer_load_dwordx4 v[212:215], v20, s[8:11], s27 offen
  s_add_u32 s27, s26, 83968
  buffer_load_dwordx4 v[216:219], v20, s[8:11], s27 offen
  s_add_u32 s27, s26, 84992
  buffer_load_dwordx4 v[220:223], v20, s[8:11], s27 offen
  s_add_u32 s27, s26, 73728
  buffer_load_dwordx4 v[224:227], v20, s[8:11], s27 offen
  s_add_u32 s27, s26, 74752
  buffer_load_dwordx4 v[228:231], v20, s[8:11], s27 offen
  s_add_u32 s27, s26, 90112
  buffer_load_dwordx4 v[232:235], v20, s[8:11], s27 offen
  s_add_u32 s27, s26, 91136
  buffer_load_dwordx4 v[236:239], v20, s[8:11], s27 offen
  s_add_u32 s27, s26, 75776
  buffer_load_dwordx4 v[240:243], v20, s[8:11], s27 offen
  s_add_u32 s27, s26, 76800
  buffer_load_dwordx4 v[244:247], v20, s[8:11], s27 offen
  s_add_u32 s27, s26, 92160
  buffer_load_dwordx4 v[248:251], v20, s[8:11], s27 offen
  s_add_u32 s27, s26, 93184
  buffer_load_dwordx4 v[252:255], v20, s[8:11], s27 offen
  v_lshrrev_b32 v20, 8, v0
  v_and_b32 v22, 0xf0, v0
  v_lshlrev_b32 v23, 6, v20
  v_xor_b32 v22, v22, v23
  v_lshl_add_u32 v22, v20, 13, v22
  v_xor_b32 v23, 32, v22
  s_lshr_b32 s26, s17, 1
  s_lshl_b32 s26, s26, 20
  s_and_b32 s27, s17, 1
  s_lshl_b32 s27, s27, 18
  s_add_u32 s26, s26, s27
  s_lshl_b32 s27, s16, 8
  s_add_u32 s26, s26, s27
  s_lshl_b32 s28, s17, 13
  s_add_u32 s27, s26, 0
  s_add_u32 m0, s28, 65536
  s_nop 0
  buffer_load_dwordx4 v22, s[32:35], s27 offen lds
  s_add_u32 m0, s28, 66560
  s_add_u32 s27, s27, 32768
  buffer_load_dwordx4 v22, s[32:35], s27 offen lds
  s_add_u32 m0, s28, 67584
  s_add_u32 s27, s27, 32768
  buffer_load_dwordx4 v23, s[32:35], s27 offen lds
  s_add_u32 m0, s28, 68608
  s_add_u32 s27, s27, 32768
  buffer_load_dwordx4 v23, s[32:35], s27 offen lds
  s_add_u32 m0, s28, 69632
  s_add_u32 s27, s27, 32768
  buffer_load_dwordx4 v22, s[32:35], s27 offen lds
  s_add_u32 m0, s28, 70656
  s_add_u32 s27, s27, 32768
  buffer_load_dwordx4 v22, s[32:35], s27 offen lds
  s_add_u32 m0, s28, 71680
  s_add_u32 s27, s27, 32768
  buffer_load_dwordx4 v23, s[32:35], s27 offen lds
  s_add_u32 m0, s28, 72704
  s_add_u32 s27, s27, 32768
  buffer_load_dwordx4 v23, s[32:35], s27 offen lds
  s_add_u32 s27, s26, 524288
  s_add_u32 m0, s28, 98304
  s_nop 0
  buffer_load_dwordx4 v22, s[32:35], s27 offen lds
  s_add_u32 m0, s28, 99328
  s_add_u32 s27, s27, 32768
  buffer_load_dwordx4 v22, s[32:35], s27 offen lds
  s_add_u32 m0, s28, 100352
  s_add_u32 s27, s27, 32768
  buffer_load_dwordx4 v23, s[32:35], s27 offen lds
  s_add_u32 m0, s28, 101376
  s_add_u32 s27, s27, 32768
  buffer_load_dwordx4 v23, s[32:35], s27 offen lds
  s_add_u32 m0, s28, 102400
  s_add_u32 s27, s27, 32768
  buffer_load_dwordx4 v22, s[32:35], s27 offen lds
  s_add_u32 m0, s28, 103424
  s_add_u32 s27, s27, 32768
  buffer_load_dwordx4 v22, s[32:35], s27 offen lds
  s_add_u32 m0, s28, 104448
  s_add_u32 s27, s27, 32768
  buffer_load_dwordx4 v23, s[32:35], s27 offen lds
  s_add_u32 m0, s28, 105472
  s_add_u32 s27, s27, 32768
  buffer_load_dwordx4 v23, s[32:35], s27 offen lds
  s_waitcnt vmcnt(48)
  v_lshl_or_b32 v28, v29, 16, v28
  v_lshl_or_b32 v29, v31, 16, v30
  v_min_u32 v28, -2, v28
  v_min_u32 v29, -2, v29
  buffer_store_dwordx2 v[28:29], v5, s[4:7], s62 offen sc1
  s_add_u32 s27, s26, 2097152
  s_add_u32 m0, s28, 131072
  s_nop 0
  buffer_load_dwordx4 v22, s[32:35], s27 offen lds
  s_add_u32 m0, s28, 132096
  s_add_u32 s27, s27, 32768
  buffer_load_dwordx4 v22, s[32:35], s27 offen lds
  s_add_u32 m0, s28, 133120
  s_add_u32 s27, s27, 32768
  buffer_load_dwordx4 v23, s[32:35], s27 offen lds
  s_add_u32 m0, s28, 134144
  s_add_u32 s27, s27, 32768
  buffer_load_dwordx4 v23, s[32:35], s27 offen lds
  s_add_u32 m0, s28, 135168
  s_add_u32 s27, s27, 32768
  buffer_load_dwordx4 v22, s[32:35], s27 offen lds
  s_add_u32 m0, s28, 136192
  s_add_u32 s27, s27, 32768
  buffer_load_dwordx4 v22, s[32:35], s27 offen lds
  s_add_u32 m0, s28, 137216
  s_add_u32 s27, s27, 32768
  buffer_load_dwordx4 v23, s[32:35], s27 offen lds
  s_add_u32 m0, s28, 138240
  s_add_u32 s27, s27, 32768
  buffer_load_dwordx4 v23, s[32:35], s27 offen lds
  v_bfe_u32 v20, v7, 2, 1
  v_lshrrev_b32 v21, 3, v7
  v_and_b32 v104, 1, v17
  v_lshl_add_u32 v21, v21, 1, v104
  v_lshl_add_u32 v104, v20, 3, v21
  v_lshrrev_b32 v105, 1, v17
  v_lshl_add_u32 v104, v105, 5, v104
  v_lshl_add_u32 v20, v21, 1, v20
  s_lshl_b32 s29, s17, 1
  v_xor_b32 v20, s29, v20
  v_lshlrev_b32 v20, 5, v20
  v_lshl_add_u32 v20, v104, 8, v20
  v_and_b32 v21, 3, v7
  v_lshl_add_u32 v20, v21, 3, v20
  s_lshr_b32 s29, s17, 1
  s_lshl_b32 s29, s29, 14
  s_and_b32 s30, s17, 1
  s_lshl_b32 s30, s30, 10
  s_add_u32 s29, s29, s30
  s_add_u32 s29, s29, 65536
  v_add_u32 v20, s29, v20
  v_xor_b32 v104, 0, v20
  v_xor_b32 v105, 32, v20
  v_xor_b32 v106, 1024, v20
  v_xor_b32 v107, 1056, v20
  v_xor_b32 v108, 16384, v20
  v_xor_b32 v109, 16416, v20
  v_xor_b32 v110, 17408, v20
  v_xor_b32 v111, 17440, v20
  s_waitcnt vmcnt(49)
  v_perm_b32 v120, v132, v128, s44
  v_perm_b32 v121, v140, v136, s44
  v_perm_b32 v122, v148, v144, s44
  v_perm_b32 v123, v156, v152, s44
  v_accvgpr_write_b32 a248, v120
  v_accvgpr_write_b32 a249, v121
  v_accvgpr_write_b32 a250, v122
  v_accvgpr_write_b32 a251, v123
  v_perm_b32 v124, v132, v128, s45
  v_perm_b32 v125, v140, v136, s45
  v_perm_b32 v126, v148, v144, s45
  v_perm_b32 v127, v156, v152, s45
  v_accvgpr_write_b32 a232, v124
  v_accvgpr_write_b32 a233, v125
  v_accvgpr_write_b32 a234, v126
  v_accvgpr_write_b32 a235, v127
  v_perm_b32 v120, v133, v129, s44
  v_perm_b32 v121, v141, v137, s44
  v_perm_b32 v122, v149, v145, s44
  v_perm_b32 v123, v157, v153, s44
  v_accvgpr_write_b32 a216, v120
  v_accvgpr_write_b32 a217, v121
  v_accvgpr_write_b32 a218, v122
  v_accvgpr_write_b32 a219, v123
  v_perm_b32 v124, v133, v129, s45
  v_perm_b32 v125, v141, v137, s45
  v_perm_b32 v126, v149, v145, s45
  v_perm_b32 v127, v157, v153, s45
  v_accvgpr_write_b32 a200, v124
  v_accvgpr_write_b32 a201, v125
  v_accvgpr_write_b32 a202, v126
  v_accvgpr_write_b32 a203, v127
  v_perm_b32 v120, v134, v130, s44
  v_perm_b32 v121, v142, v138, s44
  v_perm_b32 v122, v150, v146, s44
  v_perm_b32 v123, v158, v154, s44
  v_accvgpr_write_b32 a184, v120
  v_accvgpr_write_b32 a185, v121
  v_accvgpr_write_b32 a186, v122
  v_accvgpr_write_b32 a187, v123
  v_perm_b32 v24, v134, v130, s45
  v_perm_b32 v25, v142, v138, s45
  v_perm_b32 v26, v150, v146, s45
  v_perm_b32 v27, v158, v154, s45
  v_perm_b32 v40, v135, v131, s44
  v_perm_b32 v41, v143, v139, s44
  v_perm_b32 v42, v151, v147, s44
  v_perm_b32 v43, v159, v155, s44
  v_perm_b32 v56, v135, v131, s45
  v_perm_b32 v57, v143, v139, s45
  v_perm_b32 v58, v151, v147, s45
  v_perm_b32 v59, v159, v155, s45
  s_waitcnt vmcnt(41)
  v_perm_b32 v120, v164, v160, s44
  v_perm_b32 v121, v172, v168, s44
  v_perm_b32 v122, v180, v176, s44
  v_perm_b32 v123, v188, v184, s44
  v_accvgpr_write_b32 a252, v120
  v_accvgpr_write_b32 a253, v121
  v_accvgpr_write_b32 a254, v122
  v_accvgpr_write_b32 a255, v123
  v_perm_b32 v124, v164, v160, s45
  v_perm_b32 v125, v172, v168, s45
  v_perm_b32 v126, v180, v176, s45
  v_perm_b32 v127, v188, v184, s45
  v_accvgpr_write_b32 a236, v124
  v_accvgpr_write_b32 a237, v125
  v_accvgpr_write_b32 a238, v126
  v_accvgpr_write_b32 a239, v127
  v_perm_b32 v120, v165, v161, s44
  v_perm_b32 v121, v173, v169, s44
  v_perm_b32 v122, v181, v177, s44
  v_perm_b32 v123, v189, v185, s44
  v_accvgpr_write_b32 a220, v120
  v_accvgpr_write_b32 a221, v121
  v_accvgpr_write_b32 a222, v122
  v_accvgpr_write_b32 a223, v123
  v_perm_b32 v124, v165, v161, s45
  v_perm_b32 v125, v173, v169, s45
  v_perm_b32 v126, v181, v177, s45
  v_perm_b32 v127, v189, v185, s45
  v_accvgpr_write_b32 a204, v124
  v_accvgpr_write_b32 a205, v125
  v_accvgpr_write_b32 a206, v126
  v_accvgpr_write_b32 a207, v127
  v_perm_b32 v120, v166, v162, s44
  v_perm_b32 v121, v174, v170, s44
  v_perm_b32 v122, v182, v178, s44
  v_perm_b32 v123, v190, v186, s44
  v_accvgpr_write_b32 a188, v120
  v_accvgpr_write_b32 a189, v121
  v_accvgpr_write_b32 a190, v122
  v_accvgpr_write_b32 a191, v123
  v_perm_b32 v28, v166, v162, s45
  v_perm_b32 v29, v174, v170, s45
  v_perm_b32 v30, v182, v178, s45
  v_perm_b32 v31, v190, v186, s45
  v_perm_b32 v44, v167, v163, s44
  v_perm_b32 v45, v175, v171, s44
  v_perm_b32 v46, v183, v179, s44
  v_perm_b32 v47, v191, v187, s44
  v_perm_b32 v60, v167, v163, s45
  v_perm_b32 v61, v175, v171, s45
  v_perm_b32 v62, v183, v179, s45
  v_perm_b32 v63, v191, v187, s45
  s_waitcnt vmcnt(33)
  v_perm_b32 v120, v196, v192, s44
  v_perm_b32 v121, v204, v200, s44
  v_perm_b32 v122, v212, v208, s44
  v_perm_b32 v123, v220, v216, s44
  v_accvgpr_write_b32 a240, v120
  v_accvgpr_write_b32 a241, v121
  v_accvgpr_write_b32 a242, v122
  v_accvgpr_write_b32 a243, v123
  v_perm_b32 v124, v196, v192, s45
  v_perm_b32 v125, v204, v200, s45
  v_perm_b32 v126, v212, v208, s45
  v_perm_b32 v127, v220, v216, s45
  v_accvgpr_write_b32 a224, v124
  v_accvgpr_write_b32 a225, v125
  v_accvgpr_write_b32 a226, v126
  v_accvgpr_write_b32 a227, v127
  v_perm_b32 v120, v197, v193, s44
  v_perm_b32 v121, v205, v201, s44
  v_perm_b32 v122, v213, v209, s44
  v_perm_b32 v123, v221, v217, s44
  v_accvgpr_write_b32 a208, v120
  v_accvgpr_write_b32 a209, v121
  v_accvgpr_write_b32 a210, v122
  v_accvgpr_write_b32 a211, v123
  v_perm_b32 v124, v197, v193, s45
  v_perm_b32 v125, v205, v201, s45
  v_perm_b32 v126, v213, v209, s45
  v_perm_b32 v127, v221, v217, s45
  v_accvgpr_write_b32 a192, v124
  v_accvgpr_write_b32 a193, v125
  v_accvgpr_write_b32 a194, v126
  v_accvgpr_write_b32 a195, v127
  v_perm_b32 v120, v198, v194, s44
  v_perm_b32 v121, v206, v202, s44
  v_perm_b32 v122, v214, v210, s44
  v_perm_b32 v123, v222, v218, s44
  v_accvgpr_write_b32 a176, v120
  v_accvgpr_write_b32 a177, v121
  v_accvgpr_write_b32 a178, v122
  v_accvgpr_write_b32 a179, v123
  v_perm_b32 v32, v198, v194, s45
  v_perm_b32 v33, v206, v202, s45
  v_perm_b32 v34, v214, v210, s45
  v_perm_b32 v35, v222, v218, s45
  v_perm_b32 v48, v199, v195, s44
  v_perm_b32 v49, v207, v203, s44
  v_perm_b32 v50, v215, v211, s44
  v_perm_b32 v51, v223, v219, s44
  v_perm_b32 v64, v199, v195, s45
  v_perm_b32 v65, v207, v203, s45
  v_perm_b32 v66, v215, v211, s45
  v_perm_b32 v67, v223, v219, s45
  s_waitcnt vmcnt(25)
  v_perm_b32 v120, v228, v224, s44
  v_perm_b32 v121, v236, v232, s44
  v_perm_b32 v122, v244, v240, s44
  v_perm_b32 v123, v252, v248, s44
  v_accvgpr_write_b32 a244, v120
  v_accvgpr_write_b32 a245, v121
  v_accvgpr_write_b32 a246, v122
  v_accvgpr_write_b32 a247, v123
  v_perm_b32 v124, v228, v224, s45
  v_perm_b32 v125, v236, v232, s45
  v_perm_b32 v126, v244, v240, s45
  v_perm_b32 v127, v252, v248, s45
  v_accvgpr_write_b32 a228, v124
  v_accvgpr_write_b32 a229, v125
  v_accvgpr_write_b32 a230, v126
  v_accvgpr_write_b32 a231, v127
  v_perm_b32 v120, v229, v225, s44
  v_perm_b32 v121, v237, v233, s44
  v_perm_b32 v122, v245, v241, s44
  v_perm_b32 v123, v253, v249, s44
  v_accvgpr_write_b32 a212, v120
  v_accvgpr_write_b32 a213, v121
  v_accvgpr_write_b32 a214, v122
  v_accvgpr_write_b32 a215, v123
  v_perm_b32 v124, v229, v225, s45
  v_perm_b32 v125, v237, v233, s45
  v_perm_b32 v126, v245, v241, s45
  v_perm_b32 v127, v253, v249, s45
  v_accvgpr_write_b32 a196, v124
  v_accvgpr_write_b32 a197, v125
  v_accvgpr_write_b32 a198, v126
  v_accvgpr_write_b32 a199, v127
  v_perm_b32 v120, v230, v226, s44
  v_perm_b32 v121, v238, v234, s44
  v_perm_b32 v122, v246, v242, s44
  v_perm_b32 v123, v254, v250, s44
  v_accvgpr_write_b32 a180, v120
  v_accvgpr_write_b32 a181, v121
  v_accvgpr_write_b32 a182, v122
  v_accvgpr_write_b32 a183, v123
  v_perm_b32 v36, v230, v226, s45
  v_perm_b32 v37, v238, v234, s45
  v_perm_b32 v38, v246, v242, s45
  v_perm_b32 v39, v254, v250, s45
  v_perm_b32 v52, v231, v227, s44
  v_perm_b32 v53, v239, v235, s44
  v_perm_b32 v54, v247, v243, s44
  v_perm_b32 v55, v255, v251, s44
  v_perm_b32 v68, v231, v227, s45
  v_perm_b32 v69, v239, v235, s45
  v_perm_b32 v70, v247, v243, s45
  v_perm_b32 v71, v255, v251, s45
  v_mov_b64 v[128:129], v[24:25]
  v_mov_b64 v[130:131], v[26:27]
  v_mov_b64 v[132:133], v[28:29]
  v_mov_b64 v[134:135], v[30:31]
  v_mov_b64 v[136:137], v[32:33]
  v_mov_b64 v[138:139], v[34:35]
  v_mov_b64 v[140:141], v[36:37]
  v_mov_b64 v[142:143], v[38:39]
  v_mov_b64 v[144:145], v[40:41]
  v_mov_b64 v[146:147], v[42:43]
  v_mov_b64 v[148:149], v[44:45]
  v_mov_b64 v[150:151], v[46:47]
  v_mov_b64 v[152:153], v[48:49]
  v_mov_b64 v[154:155], v[50:51]
  v_mov_b64 v[156:157], v[52:53]
  v_mov_b64 v[158:159], v[54:55]
  v_mov_b64 v[184:185], v[56:57]
  v_mov_b64 v[186:187], v[58:59]
  v_mov_b64 v[188:189], v[60:61]
  v_mov_b64 v[190:191], v[62:63]
  v_mov_b64 v[192:193], v[64:65]
  v_mov_b64 v[194:195], v[66:67]
  v_mov_b64 v[196:197], v[68:69]
  v_mov_b64 v[198:199], v[70:71]
  s_waitcnt vmcnt(17)
  s_barrier
  s_add_u32 s27, s26, 2621440
  s_add_u32 m0, s28, 0
  s_nop 0
  buffer_load_dwordx4 v22, s[32:35], s27 offen lds
  s_add_u32 m0, s28, 1024
  s_add_u32 s27, s27, 32768
  buffer_load_dwordx4 v22, s[32:35], s27 offen lds
  s_add_u32 m0, s28, 2048
  s_add_u32 s27, s27, 32768
  buffer_load_dwordx4 v23, s[32:35], s27 offen lds
  s_add_u32 m0, s28, 3072
  s_add_u32 s27, s27, 32768
  buffer_load_dwordx4 v23, s[32:35], s27 offen lds
  s_add_u32 m0, s28, 4096
  s_add_u32 s27, s27, 32768
  buffer_load_dwordx4 v22, s[32:35], s27 offen lds
  s_add_u32 m0, s28, 5120
  s_add_u32 s27, s27, 32768
  buffer_load_dwordx4 v22, s[32:35], s27 offen lds
  s_add_u32 m0, s28, 6144
  s_add_u32 s27, s27, 32768
  buffer_load_dwordx4 v23, s[32:35], s27 offen lds
  s_add_u32 m0, s28, 7168
  s_add_u32 s27, s27, 32768
  buffer_load_dwordx4 v23, s[32:35], s27 offen lds
  s_cmp_lg_u32 s91, 0
  s_cbranch_scc1 g_o0_5
  s_cmp_lg_u32 s17, 0
  s_cbranch_scc1 g_ar_6
  s_lshl_b32 s36, s89, 3
  s_lshl_b64 s[36:37], 1, s36
  v_lshlrev_b32 v124, 3, 0
  v_mov_b32 v120, s36
  v_mov_b32 v121, s37
  s_mov_b64 exec, 1
  global_atomic_add_x2 v[122:123], v124, v[120:121], s[12:13] sc0
  s_mov_b64 exec, -1
g_ar_6:
g_o0_5:
  ds_read_b64_tr_b16 v[40:41], v104 offset:0
  ds_read_b64_tr_b16 v[42:43], v104 offset:4096
  ds_read_b64_tr_b16 v[48:49], v105 offset:0
  ds_read_b64_tr_b16 v[50:51], v105 offset:4096
  ds_read_b64_tr_b16 a[72:73], v106 offset:0
  ds_read_b64_tr_b16 a[74:75], v106 offset:4096
  ds_read_b64_tr_b16 a[24:25], v107 offset:0
  ds_read_b64_tr_b16 a[26:27], v107 offset:4096
  ds_read_b64_tr_b16 a[64:65], v108 offset:0
  ds_read_b64_tr_b16 a[66:67], v108 offset:4096
  ds_read_b64_tr_b16 a[16:17], v109 offset:0
  ds_read_b64_tr_b16 a[18:19], v109 offset:4096
  ds_read_b64_tr_b16 a[56:57], v110 offset:0
  ds_read_b64_tr_b16 a[58:59], v110 offset:4096
  ds_read_b64_tr_b16 a[8:9], v111 offset:0
  ds_read_b64_tr_b16 a[10:11], v111 offset:4096
  s_waitcnt lgkmcnt(0)
  s_waitcnt vmcnt(17)
  s_barrier
  s_add_u32 s27, s26, 0
  s_add_u32 m0, s28, 32768
  s_nop 0
  buffer_load_dwordx4 v22, s[52:55], s27 offen lds
  s_add_u32 m0, s28, 33792
  s_add_u32 s27, s27, 32768
  buffer_load_dwordx4 v22, s[52:55], s27 offen lds
  s_add_u32 m0, s28, 34816
  s_add_u32 s27, s27, 32768
  buffer_load_dwordx4 v23, s[52:55], s27 offen lds
  s_add_u32 m0, s28, 35840
  s_add_u32 s27, s27, 32768
  buffer_load_dwordx4 v23, s[52:55], s27 offen lds
  s_add_u32 m0, s28, 36864
  s_add_u32 s27, s27, 32768
  buffer_load_dwordx4 v22, s[52:55], s27 offen lds
  s_add_u32 m0, s28, 37888
  s_add_u32 s27, s27, 32768
  buffer_load_dwordx4 v22, s[52:55], s27 offen lds
  s_add_u32 m0, s28, 38912
  s_add_u32 s27, s27, 32768
  buffer_load_dwordx4 v23, s[52:55], s27 offen lds
  s_add_u32 m0, s28, 39936
  s_add_u32 s27, s27, 32768
  buffer_load_dwordx4 v23, s[52:55], s27 offen lds
  ds_read_b64_tr_b16 v[44:45], v104 offset:32768
  ds_read_b64_tr_b16 v[46:47], v104 offset:36864
  ds_read_b64_tr_b16 v[52:53], v105 offset:32768
  ds_read_b64_tr_b16 v[54:55], v105 offset:36864
  ds_read_b64_tr_b16 a[76:77], v106 offset:32768
  ds_read_b64_tr_b16 a[78:79], v106 offset:36864
  ds_read_b64_tr_b16 a[28:29], v107 offset:32768
  ds_read_b64_tr_b16 a[30:31], v107 offset:36864
  ds_read_b64_tr_b16 a[68:69], v108 offset:32768
  ds_read_b64_tr_b16 a[70:71], v108 offset:36864
  ds_read_b64_tr_b16 a[20:21], v109 offset:32768
  ds_read_b64_tr_b16 a[22:23], v109 offset:36864
  ds_read_b64_tr_b16 a[60:61], v110 offset:32768
  ds_read_b64_tr_b16 a[62:63], v110 offset:36864
  ds_read_b64_tr_b16 a[12:13], v111 offset:32768
  ds_read_b64_tr_b16 a[14:15], v111 offset:36864
  s_waitcnt lgkmcnt(0)
  v_add_u32 v104, 65536, v104
  v_add_u32 v105, 65536, v105
  v_add_u32 v106, 65536, v106
  v_add_u32 v107, 65536, v107
  v_add_u32 v108, 65536, v108
  v_add_u32 v109, 65536, v109
  v_add_u32 v110, 65536, v110
  v_add_u32 v111, 65536, v111
  s_waitcnt vmcnt(16)
  s_barrier
  s_add_u32 s27, s26, 524288
  s_add_u32 m0, s28, 65536
  s_nop 0
  buffer_load_dwordx4 v22, s[52:55], s27 offen lds
  s_add_u32 m0, s28, 66560
  s_add_u32 s27, s27, 32768
  buffer_load_dwordx4 v22, s[52:55], s27 offen lds
  s_add_u32 m0, s28, 67584
  s_add_u32 s27, s27, 32768
  buffer_load_dwordx4 v23, s[52:55], s27 offen lds
  s_add_u32 m0, s28, 68608
  s_add_u32 s27, s27, 32768
  buffer_load_dwordx4 v23, s[52:55], s27 offen lds
  s_add_u32 m0, s28, 69632
  s_add_u32 s27, s27, 32768
  buffer_load_dwordx4 v22, s[52:55], s27 offen lds
  s_add_u32 m0, s28, 70656
  s_add_u32 s27, s27, 32768
  buffer_load_dwordx4 v22, s[52:55], s27 offen lds
  s_add_u32 m0, s28, 71680
  s_add_u32 s27, s27, 32768
  buffer_load_dwordx4 v23, s[52:55], s27 offen lds
  s_add_u32 m0, s28, 72704
  s_add_u32 s27, s27, 32768
  buffer_load_dwordx4 v23, s[52:55], s27 offen lds
  ds_read_b64_tr_b16 v[72:73], v104 offset:0
  ds_read_b64_tr_b16 v[74:75], v104 offset:4096
  ds_read_b64_tr_b16 v[80:81], v105 offset:0
  ds_read_b64_tr_b16 v[82:83], v105 offset:4096
  ds_read_b64_tr_b16 a[48:49], v106 offset:0
  ds_read_b64_tr_b16 a[50:51], v106 offset:4096
  ds_read_b64_tr_b16 a[0:1], v107 offset:0
  ds_read_b64_tr_b16 a[2:3], v107 offset:4096
  ds_read_b64_tr_b16 a[40:41], v108 offset:0
  ds_read_b64_tr_b16 a[42:43], v108 offset:4096
  ds_read_b64_tr_b16 v[248:249], v109 offset:0
  ds_read_b64_tr_b16 v[250:251], v109 offset:4096
  ds_read_b64_tr_b16 a[32:33], v110 offset:0
  ds_read_b64_tr_b16 a[34:35], v110 offset:4096
  ds_read_b64_tr_b16 v[240:241], v111 offset:0
  ds_read_b64_tr_b16 v[242:243], v111 offset:4096
  s_waitcnt lgkmcnt(0)
  v_add_u32 v104, -131072, v104
  v_add_u32 v105, -131072, v105
  v_add_u32 v106, -131072, v106
  v_add_u32 v107, -131072, v107
  v_add_u32 v108, -131072, v108
  v_add_u32 v109, -131072, v109
  v_add_u32 v110, -131072, v110
  v_add_u32 v111, -131072, v111
  s_waitcnt vmcnt(16)
  s_barrier
  s_add_u32 s27, s26, 2097152
  s_add_u32 m0, s28, 98304
  s_nop 0
  buffer_load_dwordx4 v22, s[52:55], s27 offen lds
  s_add_u32 m0, s28, 99328
  s_add_u32 s27, s27, 32768
  buffer_load_dwordx4 v22, s[52:55], s27 offen lds
  s_add_u32 m0, s28, 100352
  s_add_u32 s27, s27, 32768
  buffer_load_dwordx4 v23, s[52:55], s27 offen lds
  s_add_u32 m0, s28, 101376
  s_add_u32 s27, s27, 32768
  buffer_load_dwordx4 v23, s[52:55], s27 offen lds
  s_add_u32 m0, s28, 102400
  s_add_u32 s27, s27, 32768
  buffer_load_dwordx4 v22, s[52:55], s27 offen lds
  s_add_u32 m0, s28, 103424
  s_add_u32 s27, s27, 32768
  buffer_load_dwordx4 v22, s[52:55], s27 offen lds
  s_add_u32 m0, s28, 104448
  s_add_u32 s27, s27, 32768
  buffer_load_dwordx4 v23, s[52:55], s27 offen lds
  s_add_u32 m0, s28, 105472
  s_add_u32 s27, s27, 32768
  buffer_load_dwordx4 v23, s[52:55], s27 offen lds
  ds_read_b64_tr_b16 v[76:77], v104 offset:0
  ds_read_b64_tr_b16 v[78:79], v104 offset:4096
  ds_read_b64_tr_b16 v[84:85], v105 offset:0
  ds_read_b64_tr_b16 v[86:87], v105 offset:4096
  ds_read_b64_tr_b16 a[52:53], v106 offset:0
  ds_read_b64_tr_b16 a[54:55], v106 offset:4096
  ds_read_b64_tr_b16 a[4:5], v107 offset:0
  ds_read_b64_tr_b16 a[6:7], v107 offset:4096
  ds_read_b64_tr_b16 a[44:45], v108 offset:0
  ds_read_b64_tr_b16 a[46:47], v108 offset:4096
  ds_read_b64_tr_b16 v[252:253], v109 offset:0
  ds_read_b64_tr_b16 v[254:255], v109 offset:4096
  ds_read_b64_tr_b16 a[36:37], v110 offset:0
  ds_read_b64_tr_b16 a[38:39], v110 offset:4096
  ds_read_b64_tr_b16 v[244:245], v111 offset:0
  ds_read_b64_tr_b16 v[246:247], v111 offset:4096
  s_waitcnt lgkmcnt(0)
  s_waitcnt vmcnt(16)
  s_barrier
  s_add_u32 s27, s26, 2621440
  s_add_u32 m0, s28, 131072
  s_nop 0
  buffer_load_dwordx4 v22, s[52:55], s27 offen lds
  s_add_u32 m0, s28, 132096
  s_add_u32 s27, s27, 32768
  buffer_load_dwordx4 v22, s[52:55], s27 offen lds
  s_add_u32 m0, s28, 133120
  s_add_u32 s27, s27, 32768
  buffer_load_dwordx4 v23, s[52:55], s27 offen lds
  s_add_u32 m0, s28, 134144
  s_add_u32 s27, s27, 32768
  buffer_load_dwordx4 v23, s[52:55], s27 offen lds
  s_add_u32 m0, s28, 135168
  s_add_u32 s27, s27, 32768
  buffer_load_dwordx4 v22, s[52:55], s27 offen lds
  s_add_u32 m0, s28, 136192
  s_add_u32 s27, s27, 32768
  buffer_load_dwordx4 v22, s[52:55], s27 offen lds
  s_add_u32 m0, s28, 137216
  s_add_u32 s27, s27, 32768
  buffer_load_dwordx4 v23, s[52:55], s27 offen lds
  s_add_u32 m0, s28, 138240
  s_add_u32 s27, s27, 32768
  buffer_load_dwordx4 v23, s[52:55], s27 offen lds
  s_cmp_lg_u32 s91, 0
  s_cbranch_scc1 g_o0_7
  s_cmp_lg_u32 s17, 0
  s_cbranch_scc1 g_af_8
  v_readfirstlane_b32 s36, v122
  v_readfirstlane_b32 s37, v123
  s_add_u32 s38, s36, s37
  s_mul_i32 s38, s38, 0x01010101
  s_lshr_b32 s38, s38, 24
  s_cmp_lg_u32 s38, 31
  s_cbranch_scc1 g_af_8
  s_lshl_b32 s38, s89, 3
  s_lshr_b64 s[36:37], s[36:37], s38
  s_and_b32 s36, s36, 0xff
  s_cmp_eq_u32 s36, 31
  s_cselect_b32 s36, 1, 2
  v_mov_b32 v120, s36
  v_lshrrev_b32 v124, 1, v124
  s_mov_b64 exec, 1
  global_store_dword v124, v120, s[12:13] offset:128 sc1
  s_mov_b64 exec, -1
g_af_8:
g_o0_7:
  ds_read_b64_tr_b16 v[24:25], v104 offset:32768
  ds_read_b64_tr_b16 v[26:27], v104 offset:36864
  ds_read_b64_tr_b16 v[32:33], v105 offset:32768
  ds_read_b64_tr_b16 v[34:35], v105 offset:36864
  ds_read_b64_tr_b16 a[168:169], v106 offset:32768
  ds_read_b64_tr_b16 a[170:171], v106 offset:36864
  ds_read_b64_tr_b16 a[120:121], v107 offset:32768
  ds_read_b64_tr_b16 a[122:123], v107 offset:36864
  ds_read_b64_tr_b16 a[160:161], v108 offset:32768
  ds_read_b64_tr_b16 a[162:163], v108 offset:36864
  ds_read_b64_tr_b16 a[112:113], v109 offset:32768
  ds_read_b64_tr_b16 a[114:115], v109 offset:36864
  ds_read_b64_tr_b16 a[152:153], v110 offset:32768
  ds_read_b64_tr_b16 a[154:155], v110 offset:36864
  ds_read_b64_tr_b16 a[104:105], v111 offset:32768
  ds_read_b64_tr_b16 a[106:107], v111 offset:36864
  s_waitcnt lgkmcnt(0)
  v_add_u32 v104, 65536, v104
  v_add_u32 v105, 65536, v105
  v_add_u32 v106, 65536, v106
  v_add_u32 v107, 65536, v107
  v_add_u32 v108, 65536, v108
  v_add_u32 v109, 65536, v109
  v_add_u32 v110, 65536, v110
  v_add_u32 v111, 65536, v111
  s_waitcnt vmcnt(16)
  s_barrier
  s_add_u32 s27, s26, 0
  s_add_u32 m0, s28, 0
  s_nop 0
  buffer_load_dwordx4 v22, s[48:51], s27 offen lds
  s_add_u32 m0, s28, 1024
  s_add_u32 s27, s27, 32768
  buffer_load_dwordx4 v22, s[48:51], s27 offen lds
  s_add_u32 m0, s28, 2048
  s_add_u32 s27, s27, 32768
  buffer_load_dwordx4 v23, s[48:51], s27 offen lds
  s_add_u32 m0, s28, 3072
  s_add_u32 s27, s27, 32768
  buffer_load_dwordx4 v23, s[48:51], s27 offen lds
  s_add_u32 m0, s28, 4096
  s_add_u32 s27, s27, 32768
  buffer_load_dwordx4 v22, s[48:51], s27 offen lds
  s_add_u32 m0, s28, 5120
  s_add_u32 s27, s27, 32768
  buffer_load_dwordx4 v22, s[48:51], s27 offen lds
  s_add_u32 m0, s28, 6144
  s_add_u32 s27, s27, 32768
  buffer_load_dwordx4 v23, s[48:51], s27 offen lds
  s_add_u32 m0, s28, 7168
  s_add_u32 s27, s27, 32768
  buffer_load_dwordx4 v23, s[48:51], s27 offen lds
  ds_read_b64_tr_b16 v[28:29], v104 offset:0
  ds_read_b64_tr_b16 v[30:31], v104 offset:4096
  ds_read_b64_tr_b16 v[36:37], v105 offset:0
  ds_read_b64_tr_b16 v[38:39], v105 offset:4096
  ds_read_b64_tr_b16 a[172:173], v106 offset:0
  ds_read_b64_tr_b16 a[174:175], v106 offset:4096
  ds_read_b64_tr_b16 a[124:125], v107 offset:0
  ds_read_b64_tr_b16 a[126:127], v107 offset:4096
  ds_read_b64_tr_b16 a[164:165], v108 offset:0
  ds_read_b64_tr_b16 a[166:167], v108 offset:4096
  ds_read_b64_tr_b16 a[116:117], v109 offset:0
  ds_read_b64_tr_b16 a[118:119], v109 offset:4096
  ds_read_b64_tr_b16 a[156:157], v110 offset:0
  ds_read_b64_tr_b16 a[158:159], v110 offset:4096
  ds_read_b64_tr_b16 a[108:109], v111 offset:0
  ds_read_b64_tr_b16 a[110:111], v111 offset:4096
  s_waitcnt lgkmcnt(0)
  s_waitcnt vmcnt(16)
  s_barrier
  s_add_u32 s27, s26, 524288
  s_add_u32 m0, s28, 32768
  s_nop 0
  buffer_load_dwordx4 v22, s[48:51], s27 offen lds
  s_add_u32 m0, s28, 33792
  s_add_u32 s27, s27, 32768
  buffer_load_dwordx4 v22, s[48:51], s27 offen lds
  s_add_u32 m0, s28, 34816
  s_add_u32 s27, s27, 32768
  buffer_load_dwordx4 v23, s[48:51], s27 offen lds
  s_add_u32 m0, s28, 35840
  s_add_u32 s27, s27, 32768
  buffer_load_dwordx4 v23, s[48:51], s27 offen lds
  s_add_u32 m0, s28, 36864
  s_add_u32 s27, s27, 32768
  buffer_load_dwordx4 v22, s[48:51], s27 offen lds
  s_add_u32 m0, s28, 37888
  s_add_u32 s27, s27, 32768
  buffer_load_dwordx4 v22, s[48:51], s27 offen lds
  s_add_u32 m0, s28, 38912
  s_add_u32 s27, s27, 32768
  buffer_load_dwordx4 v23, s[48:51], s27 offen lds
  s_add_u32 m0, s28, 39936
  s_add_u32 s27, s27, 32768
  buffer_load_dwordx4 v23, s[48:51], s27 offen lds
  v_mbcnt_lo_u32_b32 v116, -1, 0
  v_and_b32 v116, 1, v116
  v_lshlrev_b32 v118, 2, v116
  global_load_dword v117, v118, s[12:13] offset:128 sc1
  ds_read_b64_tr_b16 v[56:57], v104 offset:32768
  ds_read_b64_tr_b16 v[58:59], v104 offset:36864
  ds_read_b64_tr_b16 v[64:65], v105 offset:32768
  ds_read_b64_tr_b16 v[66:67], v105 offset:36864
  ds_read_b64_tr_b16 a[144:145], v106 offset:32768
  ds_read_b64_tr_b16 a[146:147], v106 offset:36864
  ds_read_b64_tr_b16 a[96:97], v107 offset:32768
  ds_read_b64_tr_b16 a[98:99], v107 offset:36864
  ds_read_b64_tr_b16 a[136:137], v108 offset:32768
  ds_read_b64_tr_b16 a[138:139], v108 offset:36864
  ds_read_b64_tr_b16 a[88:89], v109 offset:32768
  ds_read_b64_tr_b16 a[90:91], v109 offset:36864
  ds_read_b64_tr_b16 a[128:129], v110 offset:32768
  ds_read_b64_tr_b16 a[130:131], v110 offset:36864
  ds_read_b64_tr_b16 a[80:81], v111 offset:32768
  ds_read_b64_tr_b16 a[82:83], v111 offset:36864
  s_waitcnt lgkmcnt(0)
  v_add_u32 v104, 65536, v104
  v_add_u32 v105, 65536, v105
  v_add_u32 v106, 65536, v106
  v_add_u32 v107, 65536, v107
  v_add_u32 v108, 65536, v108
  v_add_u32 v109, 65536, v109
  v_add_u32 v110, 65536, v110
  v_add_u32 v111, 65536, v111
  s_waitcnt vmcnt(16)
  s_barrier
  s_add_u32 s27, s26, 2097152
  s_add_u32 m0, s28, 65536
  s_nop 0
  buffer_load_dwordx4 v22, s[48:51], s27 offen lds
  s_add_u32 m0, s28, 66560
  s_add_u32 s27, s27, 32768
  buffer_load_dwordx4 v22, s[48:51], s27 offen lds
  s_add_u32 m0, s28, 67584
  s_add_u32 s27, s27, 32768
  buffer_load_dwordx4 v23, s[48:51], s27 offen lds
  s_add_u32 m0, s28, 68608
  s_add_u32 s27, s27, 32768
  buffer_load_dwordx4 v23, s[48:51], s27 offen lds
  s_add_u32 m0, s28, 69632
  s_add_u32 s27, s27, 32768
  buffer_load_dwordx4 v22, s[48:51], s27 offen lds
  s_add_u32 m0, s28, 70656
  s_add_u32 s27, s27, 32768
  buffer_load_dwordx4 v22, s[48:51], s27 offen lds
  s_add_u32 m0, s28, 71680
  s_add_u32 s27, s27, 32768
  buffer_load_dwordx4 v23, s[48:51], s27 offen lds
  s_add_u32 m0, s28, 72704
  s_add_u32 s27, s27, 32768
  buffer_load_dwordx4 v23, s[48:51], s27 offen lds
  ds_read_b64_tr_b16 v[60:61], v104 offset:0
  ds_read_b64_tr_b16 v[62:63], v104 offset:4096
  ds_read_b64_tr_b16 v[68:69], v105 offset:0
  ds_read_b64_tr_b16 v[70:71], v105 offset:4096
  ds_read_b64_tr_b16 a[148:149], v106 offset:0
  ds_read_b64_tr_b16 a[150:151], v106 offset:4096
  ds_read_b64_tr_b16 a[100:101], v107 offset:0
  ds_read_b64_tr_b16 a[102:103], v107 offset:4096
  ds_read_b64_tr_b16 a[140:141], v108 offset:0
  ds_read_b64_tr_b16 a[142:143], v108 offset:4096
  ds_read_b64_tr_b16 a[92:93], v109 offset:0
  ds_read_b64_tr_b16 a[94:95], v109 offset:4096
  ds_read_b64_tr_b16 a[132:133], v110 offset:0
  ds_read_b64_tr_b16 a[134:135], v110 offset:4096
  ds_read_b64_tr_b16 a[84:85], v111 offset:0
  ds_read_b64_tr_b16 a[86:87], v111 offset:4096
  s_waitcnt lgkmcnt(0)
  v_add_u32 v104, -131072, v104
  v_add_u32 v105, -131072, v105
  v_add_u32 v106, -131072, v106
  v_add_u32 v107, -131072, v107
  v_add_u32 v108, -131072, v108
  v_add_u32 v109, -131072, v109
  v_add_u32 v110, -131072, v110
  v_add_u32 v111, -131072, v111
  s_waitcnt vmcnt(16)
  s_barrier
  s_add_u32 s27, s26, 2621440
  s_add_u32 m0, s28, 98304
  s_nop 0
  buffer_load_dwordx4 v22, s[48:51], s27 offen lds
  s_add_u32 m0, s28, 99328
  s_add_u32 s27, s27, 32768
  buffer_load_dwordx4 v22, s[48:51], s27 offen lds
  s_add_u32 m0, s28, 100352
  s_add_u32 s27, s27, 32768
  buffer_load_dwordx4 v23, s[48:51], s27 offen lds
  s_add_u32 m0, s28, 101376
  s_add_u32 s27, s27, 32768
  buffer_load_dwordx4 v23, s[48:51], s27 offen lds
  s_add_u32 m0, s28, 102400
  s_add_u32 s27, s27, 32768
  buffer_load_dwordx4 v22, s[48:51], s27 offen lds
  s_add_u32 m0, s28, 103424
  s_add_u32 s27, s27, 32768
  buffer_load_dwordx4 v22, s[48:51], s27 offen lds
  s_add_u32 m0, s28, 104448
  s_add_u32 s27, s27, 32768
  buffer_load_dwordx4 v23, s[48:51], s27 offen lds
  s_add_u32 m0, s28, 105472
  s_add_u32 s27, s27, 32768
  buffer_load_dwordx4 v23, s[48:51], s27 offen lds
  s_or_b32 s36, s91, s17
  s_cbranch_scc1 L_sig
  s_lshl_b32 s36, s16, 6
  s_add_u32 s36, s36, 245104644
  v_mov_b32 v120, 1
  s_mov_b64 exec, 1
  buffer_store_dword v120, off, s[4:7], s36 sc1
  s_mov_b64 exec, -1
L_sig:
  ds_read_b64_tr_b16 v[88:89], v104 offset:0
  ds_read_b64_tr_b16 v[90:91], v104 offset:4096
  ds_read_b64_tr_b16 v[96:97], v105 offset:0
  ds_read_b64_tr_b16 v[98:99], v105 offset:4096
  ds_read_b64_tr_b16 v[232:233], v106 offset:0
  ds_read_b64_tr_b16 v[234:235], v106 offset:4096
  ds_read_b64_tr_b16 v[176:177], v107 offset:0
  ds_read_b64_tr_b16 v[178:179], v107 offset:4096
  ds_read_b64_tr_b16 v[224:225], v108 offset:0
  ds_read_b64_tr_b16 v[226:227], v108 offset:4096
  ds_read_b64_tr_b16 v[168:169], v109 offset:0
  ds_read_b64_tr_b16 v[170:171], v109 offset:4096
  ds_read_b64_tr_b16 v[216:217], v110 offset:0
  ds_read_b64_tr_b16 v[218:219], v110 offset:4096
  ds_read_b64_tr_b16 v[160:161], v111 offset:0
  ds_read_b64_tr_b16 v[162:163], v111 offset:4096
  s_waitcnt lgkmcnt(0)
  s_waitcnt vmcnt(16)
  s_barrier
  ds_read_b64_tr_b16 v[92:93], v104 offset:32768
  ds_read_b64_tr_b16 v[94:95], v104 offset:36864
  ds_read_b64_tr_b16 v[100:101], v105 offset:32768
  ds_read_b64_tr_b16 v[102:103], v105 offset:36864
  ds_read_b64_tr_b16 v[236:237], v106 offset:32768
  ds_read_b64_tr_b16 v[238:239], v106 offset:36864
  ds_read_b64_tr_b16 v[180:181], v107 offset:32768
  ds_read_b64_tr_b16 v[182:183], v107 offset:36864
  ds_read_b64_tr_b16 v[228:229], v108 offset:32768
  ds_read_b64_tr_b16 v[230:231], v108 offset:36864
  ds_read_b64_tr_b16 v[172:173], v109 offset:32768
  ds_read_b64_tr_b16 v[174:175], v109 offset:36864
  ds_read_b64_tr_b16 v[220:221], v110 offset:32768
  ds_read_b64_tr_b16 v[222:223], v110 offset:36864
  ds_read_b64_tr_b16 v[164:165], v111 offset:32768
  ds_read_b64_tr_b16 v[166:167], v111 offset:36864
  s_waitcnt lgkmcnt(0)
  s_barrier
  v_add_u32 v104, 65536, v104
  v_add_u32 v105, 65536, v105
  v_add_u32 v106, 65536, v106
  v_add_u32 v107, 65536, v107
  v_add_u32 v108, 65536, v108
  v_add_u32 v109, 65536, v109
  v_add_u32 v110, 65536, v110
  v_add_u32 v111, 65536, v111
  ds_write_b128 v8, v[128:131] offset:16384
  ds_write_b128 v8, v[132:135] offset:20480
  ds_write_b128 v8, v[136:139] offset:24576
  ds_write_b128 v8, v[140:143] offset:28672
  ds_write_b128 v8, v[144:147] offset:32768
  ds_write_b128 v8, v[148:151] offset:36864
  ds_write_b128 v8, v[152:155] offset:40960
  ds_write_b128 v8, v[156:159] offset:45056
  ds_write_b128 v8, v[184:187] offset:49152
  ds_write_b128 v8, v[188:191] offset:53248
  ds_write_b128 v8, v[192:195] offset:57344
  ds_write_b128 v8, v[196:199] offset:61440
  s_waitcnt lgkmcnt(0)
  s_waitcnt vmcnt(8)
  s_barrier
  v_cmp_eq_u32 vcc, 0, v117
  v_lshlrev_b32 v116, 12, v116
  s_or_b32 s66, vcc_lo, s91
  s_cselect_b32 s66, 0, 1
  s_lshl2_add_u32 s36, s16, s17
  s_lshl_b32 s36, s36, 5
  s_add_u32 s36, s36, 244318208
  buffer_load_dword v118, v116, s[4:7], s36 offen sc1
  ds_read_b64_tr_b16 v[208:209], v104 offset:0
  ds_read_b64_tr_b16 v[210:211], v104 offset:4096
  ds_read_b64_tr_b16 v[152:153], v105 offset:0
  ds_read_b64_tr_b16 v[154:155], v105 offset:4096
  ds_read_b64_tr_b16 v[200:201], v106 offset:0
  ds_read_b64_tr_b16 v[202:203], v106 offset:4096
  ds_read_b64_tr_b16 v[144:145], v107 offset:0
  ds_read_b64_tr_b16 v[146:147], v107 offset:4096
  ds_read_b64_tr_b16 v[192:193], v108 offset:0
  ds_read_b64_tr_b16 v[194:195], v108 offset:4096
  ds_read_b64_tr_b16 v[136:137], v109 offset:0
  ds_read_b64_tr_b16 v[138:139], v109 offset:4096
  ds_read_b64_tr_b16 v[184:185], v110 offset:0
  ds_read_b64_tr_b16 v[186:187], v110 offset:4096
  ds_read_b64_tr_b16 v[128:129], v111 offset:0
  ds_read_b64_tr_b16 v[130:131], v111 offset:4096
  s_waitcnt lgkmcnt(0)
  s_waitcnt vmcnt(0)
  s_barrier
  ds_read_b64_tr_b16 v[212:213], v104 offset:32768
  ds_read_b64_tr_b16 v[214:215], v104 offset:36864
  ds_read_b64_tr_b16 v[156:157], v105 offset:32768
  ds_read_b64_tr_b16 v[158:159], v105 offset:36864
  ds_read_b64_tr_b16 v[204:205], v106 offset:32768
  ds_read_b64_tr_b16 v[206:207], v106 offset:36864
  ds_read_b64_tr_b16 v[148:149], v107 offset:32768
  ds_read_b64_tr_b16 v[150:151], v107 offset:36864
  ds_read_b64_tr_b16 v[196:197], v108 offset:32768
  ds_read_b64_tr_b16 v[198:199], v108 offset:36864
  ds_read_b64_tr_b16 v[140:141], v109 offset:32768
  ds_read_b64_tr_b16 v[142:143], v109 offset:36864
  ds_read_b64_tr_b16 v[188:189], v110 offset:32768
  ds_read_b64_tr_b16 v[190:191], v110 offset:36864
  ds_read_b64_tr_b16 v[132:133], v111 offset:32768
  ds_read_b64_tr_b16 v[134:135], v111 offset:36864
  s_waitcnt lgkmcnt(0)
  s_barrier
  s_waitcnt vmcnt(0)
  s_lshl_b32 s26, s16, 13
  s_add_u32 s26, s26, s40
  s_add_u32 s27, s26, 4096
  s_lshl_b32 s28, s17, 13
  s_add_u32 s28, s28, s62
  buffer_load_dwordx4 v[104:107], v8, s[4:7], s26 offen sc1
  buffer_load_dwordx4 v[104:107], v8, s[4:7], s27 offen sc1
  buffer_load_dwordx2 v[104:105], v5, s[4:7], s28 offen sc1
  ds_write_b128 v1, v[24:27] offset:0
  ds_write_b128 v1, v[28:31] offset:1024
  ds_write_b128 v1, v[32:35] offset:2048
  ds_write_b128 v1, v[36:39] offset:3072
  ds_write_b128 v1, v[40:43] offset:4096
  ds_write_b128 v1, v[44:47] offset:5120
  ds_write_b128 v1, v[48:51] offset:6144
  ds_write_b128 v1, v[52:55] offset:7168
  ds_write_b128 v1, v[56:59] offset:8192
  ds_write_b128 v1, v[60:63] offset:9216
  ds_write_b128 v1, v[64:67] offset:10240
  ds_write_b128 v1, v[68:71] offset:11264
  ds_write_b128 v1, v[72:75] offset:12288
  ds_write_b128 v1, v[76:79] offset:13312
  ds_write_b128 v1, v[80:83] offset:14336
  ds_write_b128 v1, v[84:87] offset:15360
  ds_write_b128 v1, v[88:91] offset:16384
  ds_write_b128 v1, v[92:95] offset:17408
  ds_write_b128 v1, v[96:99] offset:18432
  ds_write_b128 v1, v[100:103] offset:19456
  s_mul_i32 s27, s17, 24576
  s_add_u32 m0, s27, 86016
  s_waitcnt lgkmcnt(0)
  v_readlane_b32 s67, v118, 1
  v_readlane_b32 s26, v118, 0
  v_mov_b32 v21, v117
  s_and_b32 s66, s66, s26
  s_cbranch_scc1 L_pk
  v_mbcnt_lo_u32_b32 v20, -1, 0
  v_and_b32 v20, 1, v20
  v_add_lshl_u32 v20, v20, s61, 2
  s_mov_b32 s26, 0
g_wt_9:
  global_load_dword v21, v20, s[12:13] offset:128 sc1
  s_add_u32 s26, s26, 1
  s_cmp_gt_u32 s26, 1048576
  s_cbranch_scc1 L_end
  s_waitcnt vmcnt(0)
  v_cmp_eq_u32 vcc, 0, v21
  v_readfirstlane_b32 s27, v21
  s_cbranch_vccnz g_wt_9
L_pk:
  s_lshr_b32 s26, s91, 1
  s_nop 3
  v_readlane_b32 s27, v21, s26
  s_cmp_lg_u32 s27, 1
  s_cbranch_scc1 L_chain_x
  s_mov_b32 s22, 0
  s_mov_b32 s21, 0
  s_mov_b32 s42, s62
  s_add_u32 s43, s62, 4096
  s_mov_b32 s46, 0
  s_mov_b32 s47, 0
  s_lshl_b32 s26, s16, 2
  s_add_u32 s26, s26, s17
  s_lshl_b32 s27, s60, 13
  s_add_u32 s27, s27, s26
  s_lshr_b32 s25, s27, 2
  s_lshl_b32 s25, s25, 13
  s_add_u32 s25, s25, 192937984
  s_lshr_b32 s64, s27, 2
  s_lshl_b32 s64, s64, 6
  s_add_u32 s64, s64, 513538048
  s_cmp_eq_u32 s17, 3
  s_cselect_b32 s2, 268435456, 0
  s_lshl_b32 s27, s61, 13
  s_add_u32 s27, s27, s26
  s_lshl_b32 s23, s27, 12
  s_add_u32 s23, s23, 41943040
  s_lshl_b32 s63, s27, 5
  s_add_u32 s63, s63, 244318208
  s_mov_b32 s97, 268435456
  s_cmp_eq_u32 s60, 2
  s_cselect_b32 s20, 262144, s97
  s_cselect_b32 s93, 1, 3
  s_lshl_b32 s26, s17, 2
  s_add_u32 s26, s26, s60
  s_cmp_eq_u32 s26, 1
  s_cselect_b32 s97, 245891072, s97
  s_mov_b32 s95, 0
  s_mov_b32 s96, s23
  s_add_u32 s23, s23, 524288
  s_add_u32 s63, s63, 4096
  s_cmp_eq_u32 s66, 0
  s_cbranch_scc1 c_pk_18
  s_sub_u32 s96, s23, 524288
  s_mov_b32 s65, s67
  s_mov_b32 s94, 0
  buffer_load_dwordx4 v0, s[4:7], s96 offen offset:0  lds
  buffer_load_dwordx4 v0, s[4:7], s96 offen offset:1024  lds
  buffer_load_dwordx4 v0, s[4:7], s96 offen offset:2048  lds
  buffer_load_dwordx4 v0, s[4:7], s96 offen offset:3072  lds
  s_branch c_pk2_19
c_pk_18:
  s_mov_b32 s29, 0
  s_sub_u32 s92, s63, 4096
  s_sub_u32 s96, s23, 524288
  s_mov_b32 s95, 0
c_gw_20:
  buffer_load_dword v7, off, s[4:7], s92 sc1
  s_add_u32 s29, s29, 1
  s_cmp_gt_u32 s29, 1048576
  s_cbranch_scc1 c_fail_16
  s_waitcnt vmcnt(0) lgkmcnt(0)
  v_readfirstlane_b32 s65, v7
  s_cmp_eq_u32 s65, 0
  s_cbranch_scc1 c_gw_20
  s_and_b32 s65, s65, s93
  s_cbranch_scc1 c_kvx_22
  s_mov_b32 s95, 1
  s_add_u32 s96, s96, 33554432
  s_add_u32 s92, s92, 262144
c_kvw_21:
  buffer_load_dword v7, off, s[4:7], s92 sc1
  s_add_u32 s29, s29, 1
  s_cmp_gt_u32 s29, 1048576
  s_cbranch_scc1 c_fail_16
  s_waitcnt vmcnt(0) lgkmcnt(0)
  v_readfirstlane_b32 s65, v7
  s_cmp_eq_u32 s65, 0
  s_cbranch_scc1 c_kvw_21
c_kvx_22:
  buffer_load_dword v7, off, s[4:7], s63 sc1
  buffer_load_dwordx4 v0, s[4:7], s96 offen offset:0  lds
  buffer_load_dwordx4 v0, s[4:7], s96 offen offset:1024  lds
  buffer_load_dwordx4 v0, s[4:7], s96 offen offset:2048  lds
  buffer_load_dwordx4 v0, s[4:7], s96 offen offset:3072  lds
  s_waitcnt vmcnt(4)
  v_readfirstlane_b32 s65, v7
  s_mov_b32 s94, 0
c_pk2_19:
  s_waitcnt vmcnt(4)
  ds_read_b128 v[72:75], v1 offset:6144
  ds_read_b128 v[76:79], v1 offset:7168
  ds_read_b128 v[80:83], v1 offset:8192
  ds_read_b128 v[84:87], v1 offset:9216
  ds_read_b128 v[88:91], v1 offset:10240
  ds_read_b128 v[92:95], v1 offset:11264
  ds_read_b128 v[96:99], v1 offset:12288
  ds_read_b128 v[100:103], v1 offset:13312
  ds_read_b128 v[104:107], v1 offset:14336
  ds_read_b128 v[108:111], v1 offset:15360
  ds_read_b128 v[112:115], v1 offset:16384
  ds_read_b128 v[116:119], v1 offset:17408
  ds_read_b128 v[120:123], v1 offset:18432
  ds_read_b128 v[124:127], v1 offset:19456
  v_mov_b64 v[48:49], 0
  v_mov_b64 v[50:51], 0
  v_mov_b64 v[52:53], 0
  v_mov_b64 v[54:55], 0
  v_mov_b64 v[56:57], 0
  v_mov_b64 v[58:59], 0
  v_mov_b64 v[60:61], 0
  v_mov_b64 v[62:63], 0
  v_mov_b64 v[64:65], 0
  v_mov_b64 v[66:67], 0
  v_mov_b64 v[68:69], 0
  v_mov_b64 v[70:71], 0
  s_lshl_b32 s38, s16, 13
  s_add_u32 s38, s38, s40
  s_add_u32 s39, s38, 4096
  ds_read_b128 v[24:27], v1 offset:0
  ds_read_b128 v[28:31], v1 offset:1024
  ds_read_b128 v[32:35], v1 offset:2048
  ds_read_b128 v[36:39], v1 offset:3072
  ds_read_b128 v[40:43], v1 offset:4096
  ds_read_b128 v[44:47], v1 offset:5120
  s_waitcnt lgkmcnt(0)
c_loop_10:
  buffer_load_dwordx4 v[16:19], v8, s[4:7], s42 offen sc1
  buffer_load_dwordx4 v[20:23], v8, s[4:7], s43 offen sc1
  s_mov_b32 s28, 0
  v_mov_b64 v[48:49], 0
  v_mov_b64 v[50:51], 0
  v_mov_b64 v[52:53], 0
  v_mov_b64 v[54:55], 0
  v_mov_b64 v[56:57], 0
  v_mov_b64 v[58:59], 0
  v_mov_b64 v[60:61], 0
  v_mov_b64 v[62:63], 0
  v_mov_b64 v[64:65], 0
  v_mov_b64 v[66:67], 0
  v_mov_b64 v[68:69], 0
  v_mov_b64 v[70:71], 0
  buffer_load_dwordx4 v[16:19], v8, s[4:7], s42 offen sc1
  buffer_load_dwordx4 v[20:23], v8, s[4:7], s43 offen sc1
  s_waitcnt lgkmcnt(0)
  s_and_b32 s29, s65, s93
  s_cbranch_scc0 c_xb_25
c_xr_26:
  s_waitcnt vmcnt(3)
  v_max3_u32 v7, v16, v17, v18
  v_max_u32 v7, v7, v19
  ds_write_b128 v8, v[16:19] offset:4096
  v_smfmac_f32_16x16x64_bf16 v[48:51], v[16:19], v[24:31], v6
  s_waitcnt vmcnt(2)
  v_max3_u32 v7, v20, v21, v7
  v_max3_u32 v7, v22, v23, v7
  ds_write_b128 v8, v[20:23] offset:8192
  v_smfmac_f32_16x16x64_bf16 v[52:55], v[16:19], v[32:39], v6
  v_cmp_eq_u32 vcc, -1, v7
  v_smfmac_f32_16x16x64_bf16 v[56:59], v[16:19], v[40:47], v6
  s_cbranch_vccnz c_retry_11
c_got_12:
  v_smfmac_f32_16x16x64_bf16 v[60:63], v[16:19], v[72:79], v6
  ds_read_b128 v[72:75], v1 offset:20480
  s_and_b32 s65, s65, s93
  s_cselect_b32 s96, s23, 268435456
  v_smfmac_f32_16x16x64_bf16 v[48:51], v[20:23], v[80:87], v6
  ds_read_b128 v[76:79], v1 offset:21504
  v_mov_b32 v7, 1
  v_smfmac_f32_16x16x64_bf16 v[52:55], v[20:23], v[88:95], v6
  ds_read_b128 v[80:83], v1 offset:22528
  v_smfmac_f32_16x16x64_bf16 v[56:59], v[20:23], v[96:103], v6
  ds_read_b128 v[84:87], v1 offset:23552
  s_waitcnt lgkmcnt(4)
  s_barrier
  ds_read_b128 v[24:27], v9 offset:4096
  ds_read_b128 v[28:31], v10 offset:4096
  v_smfmac_f32_16x16x64_bf16 v[60:63], v[20:23], v[104:111], v6
  ds_read_b128 v[32:35], v11 offset:4096
  v_smfmac_f32_16x16x64_bf16 v[64:67], v[16:19], v[112:119], v6
  ds_read_b128 v[36:39], v9 offset:8192
  v_smfmac_f32_16x16x64_bf16 v[68:71], v[16:19], v[120:127], v6
  ds_read_b128 v[40:43], v10 offset:8192
  v_smfmac_f32_16x16x64_bf16 v[64:67], v[20:23], v[208:215], v6
  ds_read_b128 v[44:47], v11 offset:8192
  s_waitcnt lgkmcnt(5)
  v_smfmac_f32_16x16x64_bf16 v[48:51], v[24:27], a[168:175], v6
  buffer_load_dwordx4 v0, s[4:7], s96 offen offset:0  lds
  s_waitcnt lgkmcnt(4)
  v_smfmac_f32_16x16x64_bf16 v[48:51], v[28:31], a[160:167], v6
  ds_read_b128 v[104:107], v8 offset:16384
  s_waitcnt lgkmcnt(4)
  v_smfmac_f32_16x16x64_bf16 v[48:51], v[32:35], a[152:159], v6
  buffer_load_dwordx4 v0, s[4:7], s96 offen offset:1024  lds
  s_waitcnt lgkmcnt(3)
  v_smfmac_f32_16x16x64_bf16 v[48:51], v[36:39], a[144:151], v6
  ds_read_b128 v[108:111], v8 offset:20480
  s_waitcnt lgkmcnt(3)
  v_smfmac_f32_16x16x64_bf16 v[48:51], v[40:43], a[136:143], v6
  buffer_load_dwordx4 v0, s[4:7], s96 offen offset:2048  lds
  s_waitcnt lgkmcnt(2)
  v_smfmac_f32_16x16x64_bf16 v[48:51], v[44:47], a[128:135], v6
  v_smfmac_f32_16x16x64_bf16 v[52:55], v[24:27], a[120:127], v6
  buffer_load_dwordx4 v0, s[4:7], s96 offen offset:3072  lds
  v_smfmac_f32_16x16x64_bf16 v[52:55], v[28:31], a[112:119], v6
  ds_read_b64 v[100:101], v5 offset:4096
  v_add_f32 v48, v48, v50
  v_smfmac_f32_16x16x64_bf16 v[52:55], v[32:35], a[104:111], v6
  ds_read_b128 v[112:115], v8 offset:24576
  v_add_f32 v49, v49, v51
  v_smfmac_f32_16x16x64_bf16 v[52:55], v[36:39], a[96:103], v6
  ds_read_b128 v[116:119], v8 offset:28672
  v_cvt_pk_bf16_f32 v50, v48, v49
  v_smfmac_f32_16x16x64_bf16 v[52:55], v[40:43], a[88:95], v6
  ds_write2_b32 v2, v50, v50 offset0:0 offset1:1
  v_smfmac_f32_16x16x64_bf16 v[52:55], v[44:47], a[80:87], v6
  ds_read_b64_tr_b16 v[88:89], v12 offset:0
  v_smfmac_f32_16x16x64_bf16 v[56:59], v[24:27], a[72:79], v6
  s_mov_b64 exec, 1
  buffer_store_dword v7, off, s[4:7], s64 sc1
  s_mov_b64 exec, -1
  v_smfmac_f32_16x16x64_bf16 v[56:59], v[28:31], a[64:71], v6
  ds_read_b128 v[120:123], v8 offset:32768
  v_add_f32 v52, v52, v54
  v_smfmac_f32_16x16x64_bf16 v[56:59], v[32:35], a[56:63], v6
  ds_read_b128 v[124:127], v8 offset:36864
  v_add_f32 v53, v53, v55
  v_cvt_pk_bf16_f32 v54, v52, v53
  v_smfmac_f32_16x16x64_bf16 v[56:59], v[36:39], a[48:55], v6
  ds_write2_b32 v2, v54, v54 offset0:128 offset1:129
  ds_read_b64_tr_b16 v[90:91], v12 offset:512
  v_smfmac_f32_16x16x64_bf16 v[56:59], v[40:43], a[40:47], v6
  v_smfmac_f32_16x16x64_bf16 v[56:59], v[44:47], a[32:39], v6
  v_smfmac_f32_16x16x64_bf16 v[60:63], v[24:27], a[24:31], v6
  v_smfmac_f32_16x16x64_bf16 v[60:63], v[28:31], a[16:23], v6
  s_waitcnt lgkmcnt(0)
  v_add_f32 v56, v56, v58
  v_mfma_f32_16x16x32_bf16 v[92:95], v[72:75], v[88:91], 0
  buffer_store_dwordx2 v[100:101], v5, s[4:7], s97 offen sc1
  v_add_f32 v57, v57, v59
  v_cvt_pk_bf16_f32 v58, v56, v57
  v_mfma_f32_16x16x32_bf16 v[96:99], v[76:79], v[88:91], 0
  ds_write_b32 v2, v58
  v_smfmac_f32_16x16x64_bf16 v[60:63], v[32:35], a[8:15], v6
  v_mov_b32 v76, 0
  v_smfmac_f32_16x16x64_bf16 v[60:63], v[36:39], a[0:7], v6
  v_cndmask_b32 v48, v92, v96, s[18:19]
  v_smfmac_f32_16x16x64_bf16 v[60:63], v[40:43], v[248:255], v6
  v_cndmask_b32 v49, v93, v97, s[18:19]
  v_smfmac_f32_16x16x64_bf16 v[60:63], v[44:47], v[240:247], v6
  v_cndmask_b32 v50, v94, v98, s[18:19]
  v_smfmac_f32_16x16x64_bf16 v[68:71], v[20:23], v[152:159], v6
  v_cndmask_b32 v51, v95, v99, s[18:19]
  v_smfmac_f32_16x16x64_bf16 v[64:67], v[24:27], v[232:239], v6
  ds_write_b128 v8, v[48:51] offset:12288
  v_add_f32 v60, v60, v62
  v_add_f32 v61, v61, v63
  v_cvt_pk_bf16_f32 v62, v60, v61
  v_smfmac_f32_16x16x64_bf16 v[64:67], v[28:31], v[224:231], v6
  ds_write_b32 v2, v62 offset:512
  s_waitcnt vmcnt(6)
  v_mov_b32 v79, 0
  v_smfmac_f32_16x16x64_bf16 v[64:67], v[32:35], v[216:223], v6
  v_mov_b64 v[20:21], s[14:15]
  v_smfmac_f32_16x16x64_bf16 v[64:67], v[36:39], v[200:207], v6
  v_mov_b64 v[22:23], s[14:15]
  v_smfmac_f32_16x16x64_bf16 v[64:67], v[40:43], v[192:199], v6
  s_waitcnt lgkmcnt(0)
  s_barrier
  ds_read_b128 v[52:55], v9 offset:12288
  ds_read_b128 v[56:59], v10 offset:12288
  v_smfmac_f32_16x16x64_bf16 v[64:67], v[44:47], v[184:191], v6
  ds_read_b128 v[60:63], v11 offset:12288
  v_smfmac_f32_16x16x64_bf16 v[68:71], v[24:27], v[176:183], v6
  ds_read_b64_tr_b16 v[88:89], v12 offset:0
  ds_read_b64_tr_b16 v[90:91], v12 offset:512
  v_smfmac_f32_16x16x64_bf16 v[68:71], v[28:31], v[168:175], v6
  ds_read_b64_tr_b16 v[92:93], v13 offset:0
  ds_read_b64_tr_b16 v[94:95], v13 offset:512
  v_add_f32 v64, v64, v66
  v_smfmac_f32_16x16x64_bf16 v[68:71], v[32:35], v[160:167], v6
  ds_read_b64_tr_b16 v[96:97], v14 offset:0
  ds_read_b64_tr_b16 v[98:99], v14 offset:512
  v_add_f32 v65, v65, v67
  v_smfmac_f32_16x16x64_bf16 v[68:71], v[36:39], v[144:151], v6
  ds_read_b64_tr_b16 v[100:101], v15 offset:0
  ds_read_b64_tr_b16 v[102:103], v15 offset:512
  s_waitcnt lgkmcnt(8)
  v_cvt_pk_bf16_f32 v66, v64, v65
  v_smfmac_f32_16x16x64_bf16 v[68:71], v[40:43], v[136:143], v6
  v_add_f32 v48, v48, v52
  v_smfmac_f32_16x16x64_bf16 v[68:71], v[44:47], v[128:135], v6
  s_waitcnt lgkmcnt(4)
  v_add_f32 v49, v49, v53
  v_mfma_f32_16x16x32_bf16 v[16:19], v[88:91], v[88:91], 0
  buffer_store_dwordx4 v[88:91], v8, s[4:7], s25 offen sc1
  v_add_f32 v50, v50, v54
  v_add_f32 v51, v51, v55
  v_mfma_f32_16x16x32_bf16 v[16:19], v[92:95], v[92:95], v[16:19]
  s_waitcnt lgkmcnt(0)
  v_add_f32 v56, v56, v60
  v_add_f32 v57, v57, v61
  v_mfma_f32_16x16x32_bf16 v[16:19], v[96:99], v[96:99], v[16:19]
  v_add_f32 v58, v58, v62
  v_add_f32 v59, v59, v63
  v_mfma_f32_16x16x32_bf16 v[16:19], v[100:103], v[100:103], v[16:19]
  v_add_f32 v48, v48, v56
  v_add_f32 v49, v49, v57
  v_add_f32 v50, v50, v58
  v_add_f32 v51, v51, v59
  v_exp_f32 v24, v48
  v_exp_f32 v25, v49
  v_exp_f32 v26, v50
  v_exp_f32 v27, v51
  v_cvt_pk_bf16_f32 v24, v24, v25
  v_mul_f32 v16, s24, v16
  v_cvt_pk_bf16_f32 v25, v26, v27
  v_cndmask_b32 v72, v24, 0, s[18:19]
  v_cndmask_b32 v73, v25, 0, s[18:19]
  v_cndmask_b32 v74, 0, v24, s[18:19]
  v_cndmask_b32 v75, 0, v25, s[18:19]
  v_mul_f32 v17, s24, v17
  v_exp_f32 v28, v16
  v_mfma_f32_16x16x32_bf16 v[60:63], v[72:75], v[20:23], 0
  v_exp_f32 v29, v17
  v_add_f32 v68, v68, v70
  v_mfma_f32_16x16x32_bf16 v[52:55], v[72:75], v[80:83], 0
  s_add_u32 s30, s25, 4096
  v_cvt_pk_bf16_f32 v28, v28, v29
  v_add_f32 v69, v69, v71
  v_mfma_f32_16x16x32_bf16 v[56:59], v[72:75], v[84:87], 0
  v_cndmask_b32 v77, 0, v28, s[18:19]
  v_cndmask_b32 v78, 0, v28, s[18:19]
  v_cvt_pk_bf16_f32 v67, v68, v69
  v_lshrrev_b32 v92, 1, v8
  v_mfma_f32_16x16x16_bf16 v[60:63], v[76:77], v[20:21], v[60:63]
  buffer_store_dwordx2 v[66:67], v92, s[4:7], s30 offen sc1
  v_max3_f32 v7, |v48|, |v49|, |v50|
  v_max_f32 v26, |v16|, |v17|
  v_mfma_f32_16x16x16_bf16 v[52:55], v[78:79], v[66:67], v[52:55]
  v_cndmask_b32 v26, 0, v26, s[18:19]
  v_max3_f32 v7, |v51|, v26, v7
  v_mfma_f32_16x16x16_bf16 v[56:59], v[76:77], v[66:67], v[56:59]
  v_cmp_lt_f32 vcc, 0x42700000, v7
  v_mov_b64 v[44:45], 0
  v_add_f32 v60, v60, v62
  v_add_f32 v61, v61, v63
  s_cbranch_vccnz c_fb_14
c_fbr_15:
  v_rcp_f32 v60, v60
  v_rcp_f32 v61, v61
  v_pk_add_f32 v[52:53], v[52:53], v[54:55]
  v_pk_add_f32 v[56:57], v[56:57], v[58:59]
  v_pk_mul_f32 v[52:53], v[52:53], v[60:61]
  v_pk_mul_f32 v[56:57], v[56:57], v[60:61]
  v_cvt_pk_bf16_f32 v54, v52, v53
  v_cvt_pk_bf16_f32 v55, v56, v57
  ds_write_b64 v2, v[54:55] offset:4096
  v_mov_b64 v[46:47], 0
  v_mov_b64 v[40:41], 0
  v_mov_b64 v[42:43], 0
  v_mov_b64 v[36:37], 0
  v_mov_b64 v[38:39], 0
  v_mov_b64 v[32:33], 0
  v_mov_b64 v[34:35], 0
  v_mov_b64 v[28:29], 0
  v_mov_b64 v[30:31], 0
  v_mov_b64 v[24:25], 0
  v_mov_b64 v[26:27], 0
  v_mov_b64 v[80:81], 0
  v_mov_b64 v[82:83], 0
  v_mov_b64 v[84:85], 0
  v_mov_b64 v[86:87], 0
  s_waitcnt lgkmcnt(0)
  s_barrier
  ds_read_b64_tr_b16 v[72:73], v3 offset:4096
  ds_read_b64_tr_b16 v[74:75], v3 offset:5120
  ds_read_b64_tr_b16 v[76:77], v3 offset:6144
  ds_read_b64_tr_b16 v[78:79], v3 offset:7168
  s_and_b32 s3, s21, 1
  s_add_u32 s21, s21, 1
  s_add_u32 s22, s22, 1
  s_and_b32 s42, s21, 3
  s_lshl_b32 s42, s42, 13
  s_cmp_eq_u32 s22, 64
  s_cbranch_scc1 c_last_17
  s_waitcnt lgkmcnt(2)
  v_smfmac_f32_16x16x64_bf16 v[44:47], v[72:75], a[248:255], v6
  s_waitcnt lgkmcnt(0)
  ds_read_b128 v[16:19], v8 offset:40960
  v_smfmac_f32_16x16x64_bf16 v[44:47], v[76:79], a[240:247], v6
  ds_read_b128 v[20:23], v8 offset:45056
  v_smfmac_f32_16x16x64_bf16 v[40:43], v[72:75], a[232:239], v6
  ds_read_b128 v[88:91], v8 offset:49152
  v_smfmac_f32_16x16x64_bf16 v[40:43], v[76:79], a[224:231], v6
  ds_read_b128 v[92:95], v8 offset:53248
  v_add_f32 v44, v44, v46
  v_add_f32 v45, v45, v47
  v_smfmac_f32_16x16x64_bf16 v[36:39], v[72:75], a[216:223], v6
  ds_read_b128 v[96:99], v8 offset:57344
  v_cvt_pk_bf16_f32 v48, v44, v45
  v_and_or_b32 v48, v48, -2, s3
  v_smfmac_f32_16x16x64_bf16 v[36:39], v[76:79], a[208:215], v6
  ds_read_b128 v[100:103], v8 offset:61440
  v_add_f32 v40, v40, v42
  v_add_f32 v41, v41, v43
  v_smfmac_f32_16x16x64_bf16 v[32:35], v[72:75], a[200:207], v6
  v_cvt_pk_bf16_f32 v49, v40, v41
  v_smfmac_f32_16x16x64_bf16 v[32:35], v[76:79], a[192:199], v6
  v_add_f32 v36, v36, v38
  v_add_f32 v37, v37, v39
  v_smfmac_f32_16x16x64_bf16 v[28:31], v[72:75], a[184:191], v6
  v_cvt_pk_bf16_f32 v50, v36, v37
  v_smfmac_f32_16x16x64_bf16 v[28:31], v[76:79], a[176:183], v6
  v_add_f32 v32, v32, v34
  v_add_f32 v33, v33, v35
  v_smfmac_f32_16x16x64_bf16 v[24:27], v[72:75], v[104:111], v6
  v_cvt_pk_bf16_f32 v51, v32, v33
  v_smfmac_f32_16x16x64_bf16 v[24:27], v[76:79], v[112:119], v6
  buffer_store_dwordx4 v[48:51], v4, s[4:7], s40 offen
  v_add_f32 v28, v28, v30
  v_add_f32 v29, v29, v31
  v_smfmac_f32_16x16x64_bf16 v[80:83], v[72:75], v[120:127], v6
  s_waitcnt lgkmcnt(0)
  v_cvt_pk_bf16_f32 v52, v28, v29
  v_and_or_b32 v52, v52, -2, s3
  v_smfmac_f32_16x16x64_bf16 v[80:83], v[76:79], v[16:23], v6
  v_add_f32 v24, v24, v26
  v_add_f32 v25, v25, v27
  v_smfmac_f32_16x16x64_bf16 v[84:87], v[72:75], v[88:95], v6
  v_cvt_pk_bf16_f32 v53, v24, v25
  v_smfmac_f32_16x16x64_bf16 v[84:87], v[76:79], v[96:103], v6
  v_add_f32 v80, v80, v82
  v_add_f32 v81, v81, v83
  v_cvt_pk_bf16_f32 v54, v80, v81
  s_nop 0
  s_nop 3
  v_pk_add_f32 v[84:85], v[84:85], v[86:87]
  v_cvt_pk_bf16_f32 v55, v84, v85
  buffer_store_dwordx4 v[52:55], v4, s[4:7], s41 offen
  s_add_u32 s42, s42, s62
  s_add_u32 s43, s42, 4096
  s_add_u32 s23, s23, 524288
  s_add_u32 s25, s25, 262144
  s_add_u32 s63, s63, 4096
  s_add_u32 s64, s64, 2048
  s_andn2_b32 s64, s64, s2
  s_add_u32 s97, s97, 8192
  s_add_u32 s92, s63, s20
  s_cmp_lg_u32 s17, 0
  s_cbranch_scc1 c_oth_29
  s_mov_b32 s28, 0
  s_add_u32 s46, s46, 1
  v_mov_b64 v[64:65], -1
  s_xor_b32 s34, s42, 16384
  buffer_store_dwordx2 v[64:65], v5, s[4:7], s34 offen
  s_mov_b32 vcc_lo, 0xaaaaaaaa
  s_mov_b32 vcc_hi, 0xaaaaaaaa
  v_mov_b32 v7, 0x3f80
  v_cndmask_b32 v7, v7, 1.0, vcc
  s_mov_b32 vcc_lo, 0x30003
  s_mov_b32 vcc_hi, 0x30003
  v_cndmask_b32 v68, 0, v7, vcc
  s_mov_b32 vcc_lo, 0xc000c
  s_mov_b32 vcc_hi, 0xc000c
  v_cndmask_b32 v69, 0, v7, vcc
  s_mov_b32 vcc_lo, 0x300030
  s_mov_b32 vcc_hi, 0x300030
  v_cndmask_b32 v70, 0, v7, vcc
  s_mov_b32 vcc_lo, 0xc000c0
  s_mov_b32 vcc_hi, 0xc000c0
  v_cndmask_b32 v71, 0, v7, vcc
  ds_read_b128 v[104:107], v1 offset:14336
  ds_read_b128 v[108:111], v1 offset:15360
  s_waitcnt lgkmcnt(0)
  ds_read_b128 v[112:115], v1 offset:16384
  ds_read_b128 v[116:119], v1 offset:17408
  ds_read_b128 v[120:123], v1 offset:18432
  ds_read_b128 v[124:127], v1 offset:19456
  s_waitcnt lgkmcnt(0)
  buffer_load_dwordx4 v[16:19], v0, s[4:7], s38 offen offset:0 sc1
  buffer_load_dwordx4 v[20:23], v0, s[4:7], s38 offen offset:1024 sc1
  buffer_load_dwordx4 v[24:27], v0, s[4:7], s38 offen offset:2048 sc1
  buffer_load_dwordx4 v[28:31], v0, s[4:7], s38 offen offset:3072 sc1
  buffer_load_dwordx4 v[32:35], v0, s[4:7], s39 offen offset:0 sc1
  buffer_load_dwordx4 v[36:39], v0, s[4:7], s39 offen offset:1024 sc1
  buffer_load_dwordx4 v[40:43], v0, s[4:7], s39 offen offset:2048 sc1
  buffer_load_dwordx4 v[44:47], v0, s[4:7], s39 offen offset:3072 sc1
  buffer_load_dwordx4 v[72:75], v0, s[4:7], s38 offen offset:0 sc1
  buffer_load_dwordx4 v[76:79], v0, s[4:7], s38 offen offset:1024 sc1
  buffer_load_dwordx4 v[80:83], v0, s[4:7], s38 offen offset:2048 sc1
  buffer_load_dwordx4 v[84:87], v0, s[4:7], s38 offen offset:3072 sc1
  buffer_load_dwordx4 v[88:91], v0, s[4:7], s39 offen offset:0 sc1
  buffer_load_dwordx4 v[92:95], v0, s[4:7], s39 offen offset:1024 sc1
  buffer_load_dwordx4 v[96:99], v0, s[4:7], s39 offen offset:2048 sc1
  buffer_load_dwordx4 v[100:103], v0, s[4:7], s39 offen offset:3072 sc1
  s_buffer_load_dword s65, s[4:7], s63
  s_waitcnt vmcnt(15)
  v_mfma_f32_16x16x32_bf16 v[64:67], v[16:19], v[68:71], 0
  v_xor_b32 v7, s3, v16
  s_waitcnt vmcnt(14)
  v_mfma_f32_16x16x32_bf16 v[64:67], v[20:23], v[68:71], v[64:67]
  v_bitop3_b32 v7, v7, v20, s3 bitop3:0xf6
  s_waitcnt vmcnt(13)
  v_mfma_f32_16x16x32_bf16 v[64:67], v[24:27], v[68:71], v[64:67]
  v_bitop3_b32 v7, v7, v24, s3 bitop3:0xf6
  s_waitcnt vmcnt(12)
  v_mfma_f32_16x16x32_bf16 v[64:67], v[28:31], v[68:71], v[64:67]
  v_bitop3_b32 v7, v7, v28, s3 bitop3:0xf6
  s_waitcnt vmcnt(11)
  v_mfma_f32_16x16x32_bf16 v[64:67], v[32:35], v[68:71], v[64:67]
  v_bitop3_b32 v7, v7, v32, s3 bitop3:0xf6
  s_waitcnt vmcnt(10)
  v_mfma_f32_16x16x32_bf16 v[64:67], v[36:39], v[68:71], v[64:67]
  v_bitop3_b32 v7, v7, v36, s3 bitop3:0xf6
  s_waitcnt vmcnt(9)
  v_mfma_f32_16x16x32_bf16 v[64:67], v[40:43], v[68:71], v[64:67]
  v_bitop3_b32 v7, v7, v40, s3 bitop3:0xf6
  s_waitcnt vmcnt(8)
  v_mfma_f32_16x16x32_bf16 v[64:67], v[44:47], v[68:71], v[64:67]
  v_bitop3_b32 v7, v7, v44, s3 bitop3:0xf6
  v_and_b32 v7, 1, v7
  v_cmp_ne_u32 vcc, 0, v7
  v_mov_b32 v7, 0
  v_mov_b32 v7, 0
  s_cbranch_vccnz c_p1r_30
c_publ_31:
  s_nop 1
  s_nop 0
  v_cvt_pk_bf16_f32 v64, v64, v65
  v_cvt_pk_bf16_f32 v65, v66, v67
  v_min_u32 v64, -2, v64
  v_min_u32 v65, -2, v65
  buffer_store_dwordx2 v[64:65], v5, s[4:7], s42 offen
  s_waitcnt vmcnt(1)
  ds_read_b128 v[24:27], v1 offset:0
  ds_read_b128 v[28:31], v1 offset:1024
  ds_read_b128 v[32:35], v1 offset:2048
  ds_read_b128 v[36:39], v1 offset:3072
  ds_read_b128 v[40:43], v1 offset:4096
  ds_read_b128 v[44:47], v1 offset:5120
  ds_read_b128 v[72:75], v1 offset:6144
  ds_read_b128 v[76:79], v1 offset:7168
  ds_read_b128 v[80:83], v1 offset:8192
  ds_read_b128 v[84:87], v1 offset:9216
  ds_read_b128 v[88:91], v1 offset:10240
  ds_read_b128 v[92:95], v1 offset:11264
  ds_read_b128 v[96:99], v1 offset:12288
  ds_read_b128 v[100:103], v1 offset:13312
c_hop2_13:
  s_barrier
  s_cmp_le_u32 s96, s23
  s_cbranch_scc1 c_loop_10
  s_cmp_lg_u32 s96, 268435456
  s_cbranch_scc1 c_fk0_32
  buffer_store_dwordx2 v[64:65], v5, s[4:7], s97 offen sc1
  s_mov_b32 s29, 0
  s_sub_u32 s92, s63, 4096
  s_sub_u32 s96, s23, 524288
  s_mov_b32 s95, 0
c_gw_33:
  buffer_load_dword v7, off, s[4:7], s92 sc1
  s_add_u32 s29, s29, 1
  s_cmp_gt_u32 s29, 1048576
  s_cbranch_scc1 c_fail_16
  s_waitcnt vmcnt(0) lgkmcnt(0)
  v_readfirstlane_b32 s65, v7
  s_cmp_eq_u32 s65, 0
  s_cbranch_scc1 c_gw_33
  s_and_b32 s65, s65, s93
  s_cbranch_scc1 c_kvx_35
  s_mov_b32 s95, 1
  s_add_u32 s96, s96, 33554432
  s_add_u32 s92, s92, 262144
c_kvw_34:
  buffer_load_dword v7, off, s[4:7], s92 sc1
  s_add_u32 s29, s29, 1
  s_cmp_gt_u32 s29, 1048576
  s_cbranch_scc1 c_fail_16
  s_waitcnt vmcnt(0) lgkmcnt(0)
  v_readfirstlane_b32 s65, v7
  s_cmp_eq_u32 s65, 0
  s_cbranch_scc1 c_kvw_34
c_kvx_35:
  buffer_load_dword v7, off, s[4:7], s63 sc1
  buffer_load_dwordx4 v0, s[4:7], s96 offen offset:0  lds
  buffer_load_dwordx4 v0, s[4:7], s96 offen offset:1024  lds
  buffer_load_dwordx4 v0, s[4:7], s96 offen offset:2048  lds
  buffer_load_dwordx4 v0, s[4:7], s96 offen offset:3072  lds
  s_waitcnt vmcnt(4)
  v_readfirstlane_b32 s65, v7
  s_mov_b32 s94, 0
  s_cmp_eq_u32 s95, 0
  s_cbranch_scc1 c_loop_10
c_fk0_32:
  s_mov_b32 s29, 0
c_fk_36:
  buffer_load_dwordx4 v[16:19], v8, s[4:7], s42 offen sc1
  buffer_load_dwordx4 v[20:23], v8, s[4:7], s43 offen sc1
  s_add_u32 s29, s29, 1
  s_cmp_gt_u32 s29, 1048576
  s_cbranch_scc1 c_fail_16
  s_waitcnt vmcnt(0)
  v_max3_u32 v7, v16, v17, v18
  v_max3_u32 v7, v19, v20, v7
  v_max3_u32 v7, v21, v22, v7
  v_max_u32 v7, v7, v23
  v_cmp_eq_u32 vcc, -1, v7
  s_cbranch_vccnz c_fk_36
c_fk1_37:
  s_lshl_b32 s42, s22, 13
  s_add_u32 s42, s42, 245891072
  s_add_u32 s43, s42, 4096
  s_mov_b32 s95, 0
  s_branch c_loop_10
c_xb_25:
  s_cmp_lg_u32 s93, 1
  s_cbranch_scc1 c_xr_26
  s_cmp_ge_u32 s22, 63
  s_cbranch_scc1 c_xr_26
c_xp_38:
  s_cmp_lg_u32 s65, 0
  s_cbranch_scc1 c_xs_39
  buffer_load_dword v7, off, s[4:7], s63 sc1
  s_add_u32 s29, s29, 1
  s_cmp_gt_u32 s29, 1048576
  s_cbranch_scc1 c_fail_16
  s_waitcnt vmcnt(0)
  v_readfirstlane_b32 s65, v7
  s_branch c_xp_38
c_xs_39:
  s_cmp_eq_u32 s65, 1
  s_cbranch_scc1 c_xr_26
  s_mov_b32 s29, 0
c_xw_40:
  buffer_load_dwordx4 v[16:19], v8, s[4:7], s42 offen sc1
  buffer_load_dwordx4 v[20:23], v8, s[4:7], s43 offen sc1
  s_add_u32 s29, s29, 1
  s_cmp_gt_u32 s29, 1048576
  s_cbranch_scc1 c_fail_16
  s_waitcnt vmcnt(0)
  v_max3_u32 v7, v16, v17, v18
  v_max3_u32 v7, v19, v20, v7
  v_max3_u32 v7, v21, v22, v7
  v_max_u32 v7, v7, v23
  v_cmp_eq_u32 vcc, -1, v7
  s_cbranch_vccnz c_xw_40
  v_mov_b32 v7, 1
  s_barrier
  s_mov_b64 exec, 1
  buffer_store_dword v7, off, s[4:7], s64 sc1
  s_mov_b64 exec, -1
  s_add_u32 s22, s22, 1
  s_add_u32 s23, s23, 524288
  s_add_u32 s25, s25, 262144
  s_add_u32 s63, s63, 4096
  s_add_u32 s64, s64, 2048
  s_andn2_b32 s64, s64, s2
  s_mov_b32 s29, 0
  s_sub_u32 s92, s63, 4096
  s_sub_u32 s96, s23, 524288
  s_mov_b32 s95, 0
  s_mov_b32 s95, 1
  s_add_u32 s96, s96, 33554432
  s_add_u32 s92, s92, 262144
c_kvw_42:
  buffer_load_dword v7, off, s[4:7], s92 sc1
  s_add_u32 s29, s29, 1
  s_cmp_gt_u32 s29, 1048576
  s_cbranch_scc1 c_fail_16
  s_waitcnt vmcnt(0) lgkmcnt(0)
  v_readfirstlane_b32 s65, v7
  s_cmp_eq_u32 s65, 0
  s_cbranch_scc1 c_kvw_42
c_kvx_43:
  buffer_load_dword v7, off, s[4:7], s63 sc1
  buffer_load_dwordx4 v0, s[4:7], s96 offen offset:0  lds
  buffer_load_dwordx4 v0, s[4:7], s96 offen offset:1024  lds
  buffer_load_dwordx4 v0, s[4:7], s96 offen offset:2048  lds
  buffer_load_dwordx4 v0, s[4:7], s96 offen offset:3072  lds
  s_waitcnt vmcnt(4)
  v_readfirstlane_b32 s65, v7
  s_mov_b32 s94, 0
  s_branch c_fk1_37
c_last_17:
  s_add_u32 s64, s64, 2048
  v_mov_b32 v7, 1
  s_waitcnt vmcnt(0)
  s_barrier
  s_mov_b64 exec, 1
  buffer_store_dword v7, off, s[4:7], s64 sc1
  s_mov_b64 exec, -1
  s_branch L_chdone
c_oth_29:
  s_buffer_load_dword s65, s[4:7], s63
  ds_read_b128 v[24:27], v1 offset:0
  ds_read_b128 v[28:31], v1 offset:1024
  ds_read_b128 v[32:35], v1 offset:2048
  ds_read_b128 v[36:39], v1 offset:3072
  ds_read_b128 v[40:43], v1 offset:4096
  ds_read_b128 v[44:47], v1 offset:5120
  ds_read_b128 v[72:75], v1 offset:6144
  ds_read_b128 v[76:79], v1 offset:7168
  ds_read_b128 v[80:83], v1 offset:8192
  ds_read_b128 v[84:87], v1 offset:9216
  ds_read_b128 v[88:91], v1 offset:10240
  ds_read_b128 v[92:95], v1 offset:11264
  ds_read_b128 v[96:99], v1 offset:12288
  ds_read_b128 v[100:103], v1 offset:13312
  ds_read_b128 v[104:107], v1 offset:14336
  ds_read_b128 v[108:111], v1 offset:15360
  ds_read_b128 v[112:115], v1 offset:16384
  ds_read_b128 v[116:119], v1 offset:17408
  ds_read_b128 v[120:123], v1 offset:18432
  ds_read_b128 v[124:127], v1 offset:19456
  s_branch c_hop2_13
c_p1r_30:
  s_waitcnt vmcnt(7)
  s_nop 0
  v_mfma_f32_16x16x32_bf16 v[64:67], v[72:75], v[68:71], 0
  v_xor_b32 v7, s3, v72
  s_waitcnt vmcnt(6)
  v_mfma_f32_16x16x32_bf16 v[64:67], v[76:79], v[68:71], v[64:67]
  v_bitop3_b32 v7, v7, v76, s3 bitop3:0xf6
  s_waitcnt vmcnt(5)
  v_mfma_f32_16x16x32_bf16 v[64:67], v[80:83], v[68:71], v[64:67]
  v_bitop3_b32 v7, v7, v80, s3 bitop3:0xf6
  s_waitcnt vmcnt(4)
  v_mfma_f32_16x16x32_bf16 v[64:67], v[84:87], v[68:71], v[64:67]
  v_bitop3_b32 v7, v7, v84, s3 bitop3:0xf6
  s_waitcnt vmcnt(3)
  v_mfma_f32_16x16x32_bf16 v[64:67], v[88:91], v[68:71], v[64:67]
  v_bitop3_b32 v7, v7, v88, s3 bitop3:0xf6
  s_waitcnt vmcnt(2)
  v_mfma_f32_16x16x32_bf16 v[64:67], v[92:95], v[68:71], v[64:67]
  v_bitop3_b32 v7, v7, v92, s3 bitop3:0xf6
  s_waitcnt vmcnt(1)
  v_mfma_f32_16x16x32_bf16 v[64:67], v[96:99], v[68:71], v[64:67]
  v_bitop3_b32 v7, v7, v96, s3 bitop3:0xf6
  s_waitcnt vmcnt(0)
  v_mfma_f32_16x16x32_bf16 v[64:67], v[100:103], v[68:71], v[64:67]
  v_bitop3_b32 v7, v7, v100, s3 bitop3:0xf6
  v_and_b32 v7, 1, v7
  v_cmp_ne_u32 vcc, 0, v7
  s_add_u32 s46, s46, 1
  s_cbranch_vccz c_publ_31
  buffer_load_dwordx4 v[72:75], v0, s[4:7], s38 offen offset:0 sc1
  buffer_load_dwordx4 v[76:79], v0, s[4:7], s38 offen offset:1024 sc1
  buffer_load_dwordx4 v[80:83], v0, s[4:7], s38 offen offset:2048 sc1
  buffer_load_dwordx4 v[84:87], v0, s[4:7], s38 offen offset:3072 sc1
  buffer_load_dwordx4 v[88:91], v0, s[4:7], s39 offen offset:0 sc1
  buffer_load_dwordx4 v[92:95], v0, s[4:7], s39 offen offset:1024 sc1
  buffer_load_dwordx4 v[96:99], v0, s[4:7], s39 offen offset:2048 sc1
  buffer_load_dwordx4 v[100:103], v0, s[4:7], s39 offen offset:3072 sc1
  s_add_u32 s28, s28, 1
  s_cmp_gt_u32 s28, 1048576
  s_cbranch_scc0 c_p1r_30
  s_branch c_fail_16
c_retry_11:
  v_mov_b64 v[48:49], 0
  v_mov_b64 v[50:51], 0
  s_nop 0
  v_mov_b64 v[52:53], 0
  v_mov_b64 v[54:55], 0
  s_nop 1
  v_mov_b64 v[56:57], 0
  v_mov_b64 v[58:59], 0
c_rl_44:
  buffer_load_dwordx4 v[16:19], v8, s[4:7], s42 offen sc1
  buffer_load_dwordx4 v[20:23], v8, s[4:7], s43 offen sc1
  s_add_u32 s28, s28, 1
  s_add_u32 s47, s47, 1
  s_cmp_gt_u32 s28, 1048576
  s_cbranch_scc1 c_fail_16
  s_waitcnt vmcnt(2)
  v_max3_u32 v7, v16, v17, v18
  v_max3_u32 v7, v19, v20, v7
  v_max3_u32 v7, v21, v22, v7
  v_max_u32 v7, v7, v23
  v_cmp_eq_u32 vcc, -1, v7
  s_cbranch_vccnz c_rl_44
  ds_write_b128 v8, v[16:19] offset:4096
  v_smfmac_f32_16x16x64_bf16 v[48:51], v[16:19], v[24:31], v6
  ds_write_b128 v8, v[20:23] offset:8192
  v_smfmac_f32_16x16x64_bf16 v[52:55], v[16:19], v[32:39], v6
  v_smfmac_f32_16x16x64_bf16 v[56:59], v[16:19], v[40:47], v6
  s_branch c_got_12
c_fb_14:
  v_max3_f32 v7, v48, v49, v50
  v_max_f32 v7, v51, v7
  s_mov_b64 exec, s[18:19]
  v_max3_f32 v7, v16, v17, v7
  s_mov_b64 exec, -1
  s_nop 0
  v_max_f32_dpp v7, v7, v7 quad_perm:[2,3,0,1] row_mask:0xf bank_mask:0xf
  v_mov_b32 v24, v7
  s_nop 0
  s_nop 0
  v_permlane16_swap_b32 v7, v24
  v_max_f32 v7, v7, v24
  v_mov_b32 v24, v7
  s_nop 0
  s_nop 0
  v_permlane32_swap_b32 v7, v24
  v_max_f32 v7, v7, v24
  v_sub_f32 v24, v48, v7
  v_sub_f32 v25, v49, v7
  v_sub_f32 v26, v50, v7
  v_sub_f32 v27, v51, v7
  v_sub_f32 v28, v16, v7
  v_sub_f32 v29, v17, v7
  v_exp_f32 v24, v24
  v_exp_f32 v25, v25
  v_exp_f32 v26, v26
  v_exp_f32 v27, v27
  v_exp_f32 v28, v28
  v_exp_f32 v29, v29
  v_cvt_pk_bf16_f32 v24, v24, v25
  v_cvt_pk_bf16_f32 v25, v26, v27
  v_cvt_pk_bf16_f32 v28, v28, v29
  v_cndmask_b32 v72, v24, 0, s[18:19]
  v_cndmask_b32 v73, v25, 0, s[18:19]
  v_cndmask_b32 v74, 0, v24, s[18:19]
  v_cndmask_b32 v75, 0, v25, s[18:19]
  v_cndmask_b32 v77, 0, v28, s[18:19]
  v_cndmask_b32 v78, 0, v28, s[18:19]
  v_mfma_f32_16x16x32_bf16 v[60:63], v[72:75], v[20:23], 0
  v_mfma_f32_16x16x32_bf16 v[52:55], v[72:75], v[80:83], 0
  v_mfma_f32_16x16x32_bf16 v[56:59], v[72:75], v[84:87], 0
  v_mfma_f32_16x16x16_bf16 v[60:63], v[76:77], v[20:21], v[60:63]
  v_mfma_f32_16x16x16_bf16 v[52:55], v[78:79], v[66:67], v[52:55]
  s_nop 2
  v_mfma_f32_16x16x16_bf16 v[56:59], v[76:77], v[66:67], v[56:59]
  s_nop 7
  v_add_f32 v60, v60, v62
  v_add_f32 v61, v61, v63
  s_branch c_fbr_15
c_fail_16:
  s_endpgm
L_chain_x:
  s_mov_b32 s22, 0
  s_mov_b32 s21, 0
  s_mov_b32 s42, s62
  s_add_u32 s43, s62, 4096
  s_mov_b32 s46, 0
  s_mov_b32 s47, 0
  s_lshl_b32 s26, s16, 2
  s_add_u32 s26, s26, s17
  s_lshl_b32 s27, s60, 13
  s_add_u32 s27, s27, s26
  s_lshr_b32 s25, s27, 2
  s_lshl_b32 s25, s25, 13
  s_add_u32 s25, s25, 192937984
  s_lshr_b32 s64, s27, 2
  s_lshl_b32 s64, s64, 6
  s_add_u32 s64, s64, 513538048
  s_cmp_eq_u32 s17, 3
  s_cselect_b32 s2, 268435456, 0
  s_lshl_b32 s27, s61, 13
  s_add_u32 s27, s27, s26
  s_lshl_b32 s23, s27, 12
  s_add_u32 s23, s23, 41943040
  s_lshl_b32 s63, s27, 5
  s_add_u32 s63, s63, 244318208
  s_mov_b32 s97, 268435456
  s_cmp_eq_u32 s60, 2
  s_cselect_b32 s20, 262144, s97
  s_cselect_b32 s93, 1, 3
  s_lshl_b32 s26, s17, 2
  s_add_u32 s26, s26, s60
  s_cmp_eq_u32 s26, 1
  s_cselect_b32 s97, 245891072, s97
  s_mov_b32 s95, 0
  s_mov_b32 s96, s23
  s_add_u32 s23, s23, 524288
  s_add_u32 s63, s63, 4096
  s_cmp_eq_u32 s66, 0
  s_cbranch_scc1 c_pk_53
  s_sub_u32 s96, s23, 524288
  s_mov_b32 s65, s67
  s_mov_b32 s94, 0
  buffer_load_dwordx4 v0, s[4:7], s96 offen offset:0  lds
  buffer_load_dwordx4 v0, s[4:7], s96 offen offset:1024  lds
  buffer_load_dwordx4 v0, s[4:7], s96 offen offset:2048  lds
  buffer_load_dwordx4 v0, s[4:7], s96 offen offset:3072  lds
  s_branch c_pk2_54
c_pk_53:
  s_mov_b32 s29, 0
  s_sub_u32 s92, s63, 4096
  s_sub_u32 s96, s23, 524288
  s_mov_b32 s95, 0
c_gw_55:
  buffer_load_dword v7, off, s[4:7], s92 sc1
  s_add_u32 s29, s29, 1
  s_cmp_gt_u32 s29, 1048576
  s_cbranch_scc1 c_fail_51
  s_waitcnt vmcnt(0) lgkmcnt(0)
  v_readfirstlane_b32 s65, v7
  s_cmp_eq_u32 s65, 0
  s_cbranch_scc1 c_gw_55
  s_and_b32 s65, s65, s93
  s_cbranch_scc1 c_kvx_57
  s_mov_b32 s95, 1
  s_add_u32 s96, s96, 33554432
  s_add_u32 s92, s92, 262144
c_kvw_56:
  buffer_load_dword v7, off, s[4:7], s92 sc1
  s_add_u32 s29, s29, 1
  s_cmp_gt_u32 s29, 1048576
  s_cbranch_scc1 c_fail_51
  s_waitcnt vmcnt(0) lgkmcnt(0)
  v_readfirstlane_b32 s65, v7
  s_cmp_eq_u32 s65, 0
  s_cbranch_scc1 c_kvw_56
c_kvx_57:
  buffer_load_dword v7, off, s[4:7], s63 sc1
  buffer_load_dwordx4 v0, s[4:7], s96 offen offset:0  lds
  buffer_load_dwordx4 v0, s[4:7], s96 offen offset:1024  lds
  buffer_load_dwordx4 v0, s[4:7], s96 offen offset:2048  lds
  buffer_load_dwordx4 v0, s[4:7], s96 offen offset:3072  lds
  s_waitcnt vmcnt(4)
  v_readfirstlane_b32 s65, v7
  s_mov_b32 s94, 0
c_pk2_54:
  s_waitcnt vmcnt(4)
  ds_read_b128 v[72:75], v1 offset:6144
  ds_read_b128 v[76:79], v1 offset:7168
  ds_read_b128 v[80:83], v1 offset:8192
  ds_read_b128 v[84:87], v1 offset:9216
  ds_read_b128 v[88:91], v1 offset:10240
  ds_read_b128 v[92:95], v1 offset:11264
  ds_read_b128 v[96:99], v1 offset:12288
  ds_read_b128 v[100:103], v1 offset:13312
  ds_read_b128 v[104:107], v1 offset:14336
  ds_read_b128 v[108:111], v1 offset:15360
  ds_read_b128 v[112:115], v1 offset:16384
  ds_read_b128 v[116:119], v1 offset:17408
  ds_read_b128 v[120:123], v1 offset:18432
  ds_read_b128 v[124:127], v1 offset:19456
  v_mov_b64 v[48:49], 0
  v_mov_b64 v[50:51], 0
  v_mov_b64 v[52:53], 0
  v_mov_b64 v[54:55], 0
  v_mov_b64 v[56:57], 0
  v_mov_b64 v[58:59], 0
  v_mov_b64 v[60:61], 0
  v_mov_b64 v[62:63], 0
  v_mov_b64 v[64:65], 0
  v_mov_b64 v[66:67], 0
  v_mov_b64 v[68:69], 0
  v_mov_b64 v[70:71], 0
  s_lshl_b32 s38, s16, 13
  s_add_u32 s38, s38, s40
  s_add_u32 s39, s38, 4096
  ds_read_b128 v[24:27], v1 offset:0
  ds_read_b128 v[28:31], v1 offset:1024
  ds_read_b128 v[32:35], v1 offset:2048
  ds_read_b128 v[36:39], v1 offset:3072
  ds_read_b128 v[40:43], v1 offset:4096
  ds_read_b128 v[44:47], v1 offset:5120
  s_waitcnt lgkmcnt(0)
c_loop_45:
  buffer_load_dwordx4 v[16:19], v8, s[4:7], s42 offen sc1
  buffer_load_dwordx4 v[20:23], v8, s[4:7], s43 offen sc1
  s_mov_b32 s28, 0
  v_mov_b64 v[48:49], 0
  v_mov_b64 v[50:51], 0
  v_mov_b64 v[52:53], 0
  v_mov_b64 v[54:55], 0
  v_mov_b64 v[56:57], 0
  v_mov_b64 v[58:59], 0
  v_mov_b64 v[60:61], 0
  v_mov_b64 v[62:63], 0
  v_mov_b64 v[64:65], 0
  v_mov_b64 v[66:67], 0
  v_mov_b64 v[68:69], 0
  v_mov_b64 v[70:71], 0
  buffer_load_dwordx4 v[16:19], v8, s[4:7], s42 offen sc1
  buffer_load_dwordx4 v[20:23], v8, s[4:7], s43 offen sc1
  s_waitcnt lgkmcnt(0)
  s_and_b32 s29, s65, s93
  s_cbranch_scc0 c_xb_60
c_xr_61:
  s_waitcnt vmcnt(3)
  v_max3_u32 v7, v16, v17, v18
  v_max_u32 v7, v7, v19
  ds_write_b128 v8, v[16:19] offset:4096
  v_smfmac_f32_16x16x64_bf16 v[48:51], v[16:19], v[24:31], v6
  s_waitcnt vmcnt(2)
  v_max3_u32 v7, v20, v21, v7
  v_max3_u32 v7, v22, v23, v7
  ds_write_b128 v8, v[20:23] offset:8192
  v_smfmac_f32_16x16x64_bf16 v[52:55], v[16:19], v[32:39], v6
  v_cmp_eq_u32 vcc, -1, v7
  v_smfmac_f32_16x16x64_bf16 v[56:59], v[16:19], v[40:47], v6
  s_cbranch_vccnz c_retry_46
c_got_47:
  v_smfmac_f32_16x16x64_bf16 v[60:63], v[16:19], v[72:79], v6
  ds_read_b128 v[72:75], v1 offset:20480
  s_and_b32 s65, s65, s93
  s_cselect_b32 s96, s23, 268435456
  v_smfmac_f32_16x16x64_bf16 v[48:51], v[20:23], v[80:87], v6
  ds_read_b128 v[76:79], v1 offset:21504
  v_mov_b32 v7, 1
  v_smfmac_f32_16x16x64_bf16 v[52:55], v[20:23], v[88:95], v6
  ds_read_b128 v[80:83], v1 offset:22528
  v_smfmac_f32_16x16x64_bf16 v[56:59], v[20:23], v[96:103], v6
  ds_read_b128 v[84:87], v1 offset:23552
  s_waitcnt lgkmcnt(4)
  s_barrier
  ds_read_b128 v[24:27], v9 offset:4096
  ds_read_b128 v[28:31], v10 offset:4096
  v_smfmac_f32_16x16x64_bf16 v[60:63], v[20:23], v[104:111], v6
  ds_read_b128 v[32:35], v11 offset:4096
  v_smfmac_f32_16x16x64_bf16 v[64:67], v[16:19], v[112:119], v6
  ds_read_b128 v[36:39], v9 offset:8192
  v_smfmac_f32_16x16x64_bf16 v[68:71], v[16:19], v[120:127], v6
  ds_read_b128 v[40:43], v10 offset:8192
  v_smfmac_f32_16x16x64_bf16 v[64:67], v[20:23], v[208:215], v6
  ds_read_b128 v[44:47], v11 offset:8192
  s_waitcnt lgkmcnt(5)
  v_smfmac_f32_16x16x64_bf16 v[48:51], v[24:27], a[168:175], v6
  buffer_load_dwordx4 v0, s[4:7], s96 offen offset:0  lds
  s_waitcnt lgkmcnt(4)
  v_smfmac_f32_16x16x64_bf16 v[48:51], v[28:31], a[160:167], v6
  ds_read_b128 v[104:107], v8 offset:16384
  s_waitcnt lgkmcnt(4)
  v_smfmac_f32_16x16x64_bf16 v[48:51], v[32:35], a[152:159], v6
  buffer_load_dwordx4 v0, s[4:7], s96 offen offset:1024  lds
  s_waitcnt lgkmcnt(3)
  v_smfmac_f32_16x16x64_bf16 v[48:51], v[36:39], a[144:151], v6
  ds_read_b128 v[108:111], v8 offset:20480
  s_waitcnt lgkmcnt(3)
  v_smfmac_f32_16x16x64_bf16 v[48:51], v[40:43], a[136:143], v6
  buffer_load_dwordx4 v0, s[4:7], s96 offen offset:2048  lds
  s_waitcnt lgkmcnt(2)
  v_smfmac_f32_16x16x64_bf16 v[48:51], v[44:47], a[128:135], v6
  v_smfmac_f32_16x16x64_bf16 v[52:55], v[24:27], a[120:127], v6
  buffer_load_dwordx4 v0, s[4:7], s96 offen offset:3072  lds
  v_smfmac_f32_16x16x64_bf16 v[52:55], v[28:31], a[112:119], v6
  ds_read_b64 v[100:101], v5 offset:4096
  v_add_f32 v48, v48, v50
  v_smfmac_f32_16x16x64_bf16 v[52:55], v[32:35], a[104:111], v6
  ds_read_b128 v[112:115], v8 offset:24576
  v_add_f32 v49, v49, v51
  v_smfmac_f32_16x16x64_bf16 v[52:55], v[36:39], a[96:103], v6
  ds_read_b128 v[116:119], v8 offset:28672
  v_cvt_pk_bf16_f32 v50, v48, v49
  v_smfmac_f32_16x16x64_bf16 v[52:55], v[40:43], a[88:95], v6
  ds_write2_b32 v2, v50, v50 offset0:0 offset1:1
  v_smfmac_f32_16x16x64_bf16 v[52:55], v[44:47], a[80:87], v6
  ds_read_b64_tr_b16 v[88:89], v12 offset:0
  v_smfmac_f32_16x16x64_bf16 v[56:59], v[24:27], a[72:79], v6
  s_mov_b64 exec, 1
  buffer_store_dword v7, off, s[4:7], s64 sc1
  s_mov_b64 exec, -1
  v_smfmac_f32_16x16x64_bf16 v[56:59], v[28:31], a[64:71], v6
  ds_read_b128 v[120:123], v8 offset:32768
  v_add_f32 v52, v52, v54
  v_smfmac_f32_16x16x64_bf16 v[56:59], v[32:35], a[56:63], v6
  ds_read_b128 v[124:127], v8 offset:36864
  v_add_f32 v53, v53, v55
  v_cvt_pk_bf16_f32 v54, v52, v53
  v_smfmac_f32_16x16x64_bf16 v[56:59], v[36:39], a[48:55], v6
  ds_write2_b32 v2, v54, v54 offset0:128 offset1:129
  ds_read_b64_tr_b16 v[90:91], v12 offset:512
  v_smfmac_f32_16x16x64_bf16 v[56:59], v[40:43], a[40:47], v6
  v_smfmac_f32_16x16x64_bf16 v[56:59], v[44:47], a[32:39], v6
  v_smfmac_f32_16x16x64_bf16 v[60:63], v[24:27], a[24:31], v6
  v_smfmac_f32_16x16x64_bf16 v[60:63], v[28:31], a[16:23], v6
  s_waitcnt lgkmcnt(0)
  v_add_f32 v56, v56, v58
  v_mfma_f32_16x16x32_bf16 v[92:95], v[72:75], v[88:91], 0
  buffer_store_dwordx2 v[100:101], v5, s[4:7], s97 offen sc1
  v_add_f32 v57, v57, v59
  v_cvt_pk_bf16_f32 v58, v56, v57
  v_mfma_f32_16x16x32_bf16 v[96:99], v[76:79], v[88:91], 0
  ds_write_b32 v2, v58
  v_smfmac_f32_16x16x64_bf16 v[60:63], v[32:35], a[8:15], v6
  v_mov_b32 v76, 0
  v_smfmac_f32_16x16x64_bf16 v[60:63], v[36:39], a[0:7], v6
  v_cndmask_b32 v48, v92, v96, s[18:19]
  v_smfmac_f32_16x16x64_bf16 v[60:63], v[40:43], v[248:255], v6
  v_cndmask_b32 v49, v93, v97, s[18:19]
  v_smfmac_f32_16x16x64_bf16 v[60:63], v[44:47], v[240:247], v6
  v_cndmask_b32 v50, v94, v98, s[18:19]
  v_smfmac_f32_16x16x64_bf16 v[68:71], v[20:23], v[152:159], v6
  v_cndmask_b32 v51, v95, v99, s[18:19]
  v_smfmac_f32_16x16x64_bf16 v[64:67], v[24:27], v[232:239], v6
  ds_write_b128 v8, v[48:51] offset:12288
  v_add_f32 v60, v60, v62
  v_add_f32 v61, v61, v63
  v_cvt_pk_bf16_f32 v62, v60, v61
  v_smfmac_f32_16x16x64_bf16 v[64:67], v[28:31], v[224:231], v6
  ds_write_b32 v2, v62 offset:512
  s_waitcnt vmcnt(6)
  v_mov_b32 v79, 0
  v_smfmac_f32_16x16x64_bf16 v[64:67], v[32:35], v[216:223], v6
  v_mov_b64 v[20:21], s[14:15]
  v_smfmac_f32_16x16x64_bf16 v[64:67], v[36:39], v[200:207], v6
  v_mov_b64 v[22:23], s[14:15]
  v_smfmac_f32_16x16x64_bf16 v[64:67], v[40:43], v[192:199], v6
  s_waitcnt lgkmcnt(0)
  s_barrier
  ds_read_b128 v[52:55], v9 offset:12288
  ds_read_b128 v[56:59], v10 offset:12288
  v_smfmac_f32_16x16x64_bf16 v[64:67], v[44:47], v[184:191], v6
  ds_read_b128 v[60:63], v11 offset:12288
  v_smfmac_f32_16x16x64_bf16 v[68:71], v[24:27], v[176:183], v6
  ds_read_b64_tr_b16 v[88:89], v12 offset:0
  ds_read_b64_tr_b16 v[90:91], v12 offset:512
  v_smfmac_f32_16x16x64_bf16 v[68:71], v[28:31], v[168:175], v6
  ds_read_b64_tr_b16 v[92:93], v13 offset:0
  ds_read_b64_tr_b16 v[94:95], v13 offset:512
  v_add_f32 v64, v64, v66
  v_smfmac_f32_16x16x64_bf16 v[68:71], v[32:35], v[160:167], v6
  ds_read_b64_tr_b16 v[96:97], v14 offset:0
  ds_read_b64_tr_b16 v[98:99], v14 offset:512
  v_add_f32 v65, v65, v67
  v_smfmac_f32_16x16x64_bf16 v[68:71], v[36:39], v[144:151], v6
  ds_read_b64_tr_b16 v[100:101], v15 offset:0
  ds_read_b64_tr_b16 v[102:103], v15 offset:512
  s_waitcnt lgkmcnt(8)
  v_cvt_pk_bf16_f32 v66, v64, v65
  v_smfmac_f32_16x16x64_bf16 v[68:71], v[40:43], v[136:143], v6
  v_add_f32 v48, v48, v52
  v_smfmac_f32_16x16x64_bf16 v[68:71], v[44:47], v[128:135], v6
  s_waitcnt lgkmcnt(4)
  v_add_f32 v49, v49, v53
  v_mfma_f32_16x16x32_bf16 v[16:19], v[88:91], v[88:91], 0
  buffer_store_dwordx4 v[88:91], v8, s[4:7], s25 offen sc1
  v_add_f32 v50, v50, v54
  v_add_f32 v51, v51, v55
  v_mfma_f32_16x16x32_bf16 v[16:19], v[92:95], v[92:95], v[16:19]
  s_waitcnt lgkmcnt(0)
  v_add_f32 v56, v56, v60
  v_add_f32 v57, v57, v61
  v_mfma_f32_16x16x32_bf16 v[16:19], v[96:99], v[96:99], v[16:19]
  v_add_f32 v58, v58, v62
  v_add_f32 v59, v59, v63
  v_mfma_f32_16x16x32_bf16 v[16:19], v[100:103], v[100:103], v[16:19]
  v_add_f32 v48, v48, v56
  v_add_f32 v49, v49, v57
  v_add_f32 v50, v50, v58
  v_add_f32 v51, v51, v59
  v_exp_f32 v24, v48
  v_exp_f32 v25, v49
  v_exp_f32 v26, v50
  v_exp_f32 v27, v51
  v_cvt_pk_bf16_f32 v24, v24, v25
  v_mul_f32 v16, s24, v16
  v_cvt_pk_bf16_f32 v25, v26, v27
  v_cndmask_b32 v72, v24, 0, s[18:19]
  v_cndmask_b32 v73, v25, 0, s[18:19]
  v_cndmask_b32 v74, 0, v24, s[18:19]
  v_cndmask_b32 v75, 0, v25, s[18:19]
  v_mul_f32 v17, s24, v17
  v_exp_f32 v28, v16
  v_mfma_f32_16x16x32_bf16 v[60:63], v[72:75], v[20:23], 0
  v_exp_f32 v29, v17
  v_add_f32 v68, v68, v70
  v_mfma_f32_16x16x32_bf16 v[52:55], v[72:75], v[80:83], 0
  s_add_u32 s30, s25, 4096
  v_cvt_pk_bf16_f32 v28, v28, v29
  v_add_f32 v69, v69, v71
  v_mfma_f32_16x16x32_bf16 v[56:59], v[72:75], v[84:87], 0
  v_cndmask_b32 v77, 0, v28, s[18:19]
  v_cndmask_b32 v78, 0, v28, s[18:19]
  v_cvt_pk_bf16_f32 v67, v68, v69
  v_lshrrev_b32 v92, 1, v8
  v_mfma_f32_16x16x16_bf16 v[60:63], v[76:77], v[20:21], v[60:63]
  buffer_store_dwordx2 v[66:67], v92, s[4:7], s30 offen sc1
  v_max3_f32 v7, |v48|, |v49|, |v50|
  v_max_f32 v26, |v16|, |v17|
  v_mfma_f32_16x16x16_bf16 v[52:55], v[78:79], v[66:67], v[52:55]
  v_cndmask_b32 v26, 0, v26, s[18:19]
  v_max3_f32 v7, |v51|, v26, v7
  v_mfma_f32_16x16x16_bf16 v[56:59], v[76:77], v[66:67], v[56:59]
  v_cmp_lt_f32 vcc, 0x42700000, v7
  v_mov_b64 v[44:45], 0
  v_add_f32 v60, v60, v62
  v_add_f32 v61, v61, v63
  s_cbranch_vccnz c_fb_49
c_fbr_50:
  v_rcp_f32 v60, v60
  v_rcp_f32 v61, v61
  v_pk_add_f32 v[52:53], v[52:53], v[54:55]
  v_pk_add_f32 v[56:57], v[56:57], v[58:59]
  v_pk_mul_f32 v[52:53], v[52:53], v[60:61]
  v_pk_mul_f32 v[56:57], v[56:57], v[60:61]
  v_cvt_pk_bf16_f32 v54, v52, v53
  v_cvt_pk_bf16_f32 v55, v56, v57
  ds_write_b64 v2, v[54:55] offset:4096
  v_mov_b64 v[46:47], 0
  v_mov_b64 v[40:41], 0
  v_mov_b64 v[42:43], 0
  v_mov_b64 v[36:37], 0
  v_mov_b64 v[38:39], 0
  v_mov_b64 v[32:33], 0
  v_mov_b64 v[34:35], 0
  v_mov_b64 v[28:29], 0
  v_mov_b64 v[30:31], 0
  v_mov_b64 v[24:25], 0
  v_mov_b64 v[26:27], 0
  v_mov_b64 v[80:81], 0
  v_mov_b64 v[82:83], 0
  v_mov_b64 v[84:85], 0
  v_mov_b64 v[86:87], 0
  s_waitcnt lgkmcnt(0)
  s_barrier
  ds_read_b64_tr_b16 v[72:73], v3 offset:4096
  ds_read_b64_tr_b16 v[74:75], v3 offset:5120
  ds_read_b64_tr_b16 v[76:77], v3 offset:6144
  ds_read_b64_tr_b16 v[78:79], v3 offset:7168
  s_and_b32 s3, s21, 1
  s_add_u32 s21, s21, 1
  s_add_u32 s22, s22, 1
  s_and_b32 s42, s21, 3
  s_lshl_b32 s42, s42, 13
  s_cmp_eq_u32 s22, 64
  s_cbranch_scc1 c_last_52
  s_waitcnt lgkmcnt(2)
  v_smfmac_f32_16x16x64_bf16 v[44:47], v[72:75], a[248:255], v6
  s_waitcnt lgkmcnt(0)
  ds_read_b128 v[16:19], v8 offset:40960
  v_smfmac_f32_16x16x64_bf16 v[44:47], v[76:79], a[240:247], v6
  ds_read_b128 v[20:23], v8 offset:45056
  v_smfmac_f32_16x16x64_bf16 v[40:43], v[72:75], a[232:239], v6
  ds_read_b128 v[88:91], v8 offset:49152
  v_smfmac_f32_16x16x64_bf16 v[40:43], v[76:79], a[224:231], v6
  ds_read_b128 v[92:95], v8 offset:53248
  v_add_f32 v44, v44, v46
  v_add_f32 v45, v45, v47
  v_smfmac_f32_16x16x64_bf16 v[36:39], v[72:75], a[216:223], v6
  ds_read_b128 v[96:99], v8 offset:57344
  v_cvt_pk_bf16_f32 v48, v44, v45
  v_and_or_b32 v48, v48, -2, s3
  v_smfmac_f32_16x16x64_bf16 v[36:39], v[76:79], a[208:215], v6
  ds_read_b128 v[100:103], v8 offset:61440
  v_add_f32 v40, v40, v42
  v_add_f32 v41, v41, v43
  v_smfmac_f32_16x16x64_bf16 v[32:35], v[72:75], a[200:207], v6
  v_cvt_pk_bf16_f32 v49, v40, v41
  v_smfmac_f32_16x16x64_bf16 v[32:35], v[76:79], a[192:199], v6
  v_add_f32 v36, v36, v38
  v_add_f32 v37, v37, v39
  v_smfmac_f32_16x16x64_bf16 v[28:31], v[72:75], a[184:191], v6
  v_cvt_pk_bf16_f32 v50, v36, v37
  v_smfmac_f32_16x16x64_bf16 v[28:31], v[76:79], a[176:183], v6
  v_add_f32 v32, v32, v34
  v_add_f32 v33, v33, v35
  v_smfmac_f32_16x16x64_bf16 v[24:27], v[72:75], v[104:111], v6
  v_cvt_pk_bf16_f32 v51, v32, v33
  v_smfmac_f32_16x16x64_bf16 v[24:27], v[76:79], v[112:119], v6
  buffer_store_dwordx4 v[48:51], v4, s[4:7], s40 offen sc1
  v_add_f32 v28, v28, v30
  v_add_f32 v29, v29, v31
  v_smfmac_f32_16x16x64_bf16 v[80:83], v[72:75], v[120:127], v6
  s_waitcnt lgkmcnt(0)
  v_cvt_pk_bf16_f32 v52, v28, v29
  v_and_or_b32 v52, v52, -2, s3
  v_smfmac_f32_16x16x64_bf16 v[80:83], v[76:79], v[16:23], v6
  v_add_f32 v24, v24, v26
  v_add_f32 v25, v25, v27
  v_smfmac_f32_16x16x64_bf16 v[84:87], v[72:75], v[88:95], v6
  v_cvt_pk_bf16_f32 v53, v24, v25
  v_smfmac_f32_16x16x64_bf16 v[84:87], v[76:79], v[96:103], v6
  v_add_f32 v80, v80, v82
  v_add_f32 v81, v81, v83
  v_cvt_pk_bf16_f32 v54, v80, v81
  s_nop 0
  s_nop 3
  v_pk_add_f32 v[84:85], v[84:85], v[86:87]
  v_cvt_pk_bf16_f32 v55, v84, v85
  buffer_store_dwordx4 v[52:55], v4, s[4:7], s41 offen sc1
  s_add_u32 s42, s42, s62
  s_add_u32 s43, s42, 4096
  s_add_u32 s23, s23, 524288
  s_add_u32 s25, s25, 262144
  s_add_u32 s63, s63, 4096
  s_add_u32 s64, s64, 2048
  s_andn2_b32 s64, s64, s2
  s_add_u32 s97, s97, 8192
  s_add_u32 s92, s63, s20
  s_cmp_lg_u32 s17, 0
  s_cbranch_scc1 c_oth_64
  s_mov_b32 s28, 0
  s_add_u32 s46, s46, 1
  v_mov_b64 v[64:65], -1
  s_xor_b32 s34, s42, 16384
  buffer_store_dwordx2 v[64:65], v5, s[4:7], s34 offen sc1
  s_mov_b32 vcc_lo, 0xaaaaaaaa
  s_mov_b32 vcc_hi, 0xaaaaaaaa
  v_mov_b32 v7, 0x3f80
  v_cndmask_b32 v7, v7, 1.0, vcc
  s_mov_b32 vcc_lo, 0x30003
  s_mov_b32 vcc_hi, 0x30003
  v_cndmask_b32 v68, 0, v7, vcc
  s_mov_b32 vcc_lo, 0xc000c
  s_mov_b32 vcc_hi, 0xc000c
  v_cndmask_b32 v69, 0, v7, vcc
  s_mov_b32 vcc_lo, 0x300030
  s_mov_b32 vcc_hi, 0x300030
  v_cndmask_b32 v70, 0, v7, vcc
  s_mov_b32 vcc_lo, 0xc000c0
  s_mov_b32 vcc_hi, 0xc000c0
  v_cndmask_b32 v71, 0, v7, vcc
  ds_read_b128 v[104:107], v1 offset:14336
  ds_read_b128 v[108:111], v1 offset:15360
  s_waitcnt lgkmcnt(0)
  ds_read_b128 v[112:115], v1 offset:16384
  ds_read_b128 v[116:119], v1 offset:17408
  ds_read_b128 v[120:123], v1 offset:18432
  ds_read_b128 v[124:127], v1 offset:19456
  s_waitcnt lgkmcnt(0)
  buffer_load_dwordx4 v[16:19], v0, s[4:7], s38 offen offset:0 sc1
  buffer_load_dwordx4 v[20:23], v0, s[4:7], s38 offen offset:1024 sc1
  buffer_load_dwordx4 v[24:27], v0, s[4:7], s38 offen offset:2048 sc1
  buffer_load_dwordx4 v[28:31], v0, s[4:7], s38 offen offset:3072 sc1
  buffer_load_dwordx4 v[32:35], v0, s[4:7], s39 offen offset:0 sc1
  buffer_load_dwordx4 v[36:39], v0, s[4:7], s39 offen offset:1024 sc1
  buffer_load_dwordx4 v[40:43], v0, s[4:7], s39 offen offset:2048 sc1
  buffer_load_dwordx4 v[44:47], v0, s[4:7], s39 offen offset:3072 sc1
  buffer_load_dwordx4 v[72:75], v0, s[4:7], s38 offen offset:0 sc1
  buffer_load_dwordx4 v[76:79], v0, s[4:7], s38 offen offset:1024 sc1
  buffer_load_dwordx4 v[80:83], v0, s[4:7], s38 offen offset:2048 sc1
  buffer_load_dwordx4 v[84:87], v0, s[4:7], s38 offen offset:3072 sc1
  buffer_load_dwordx4 v[88:91], v0, s[4:7], s39 offen offset:0 sc1
  buffer_load_dwordx4 v[92:95], v0, s[4:7], s39 offen offset:1024 sc1
  buffer_load_dwordx4 v[96:99], v0, s[4:7], s39 offen offset:2048 sc1
  buffer_load_dwordx4 v[100:103], v0, s[4:7], s39 offen offset:3072 sc1
  s_buffer_load_dword s65, s[4:7], s63
  s_waitcnt vmcnt(15)
  v_mfma_f32_16x16x32_bf16 v[64:67], v[16:19], v[68:71], 0
  v_xor_b32 v7, s3, v16
  s_waitcnt vmcnt(14)
  v_mfma_f32_16x16x32_bf16 v[64:67], v[20:23], v[68:71], v[64:67]
  v_bitop3_b32 v7, v7, v20, s3 bitop3:0xf6
  s_waitcnt vmcnt(13)
  v_mfma_f32_16x16x32_bf16 v[64:67], v[24:27], v[68:71], v[64:67]
  v_bitop3_b32 v7, v7, v24, s3 bitop3:0xf6
  s_waitcnt vmcnt(12)
  v_mfma_f32_16x16x32_bf16 v[64:67], v[28:31], v[68:71], v[64:67]
  v_bitop3_b32 v7, v7, v28, s3 bitop3:0xf6
  s_waitcnt vmcnt(11)
  v_mfma_f32_16x16x32_bf16 v[64:67], v[32:35], v[68:71], v[64:67]
  v_bitop3_b32 v7, v7, v32, s3 bitop3:0xf6
  s_waitcnt vmcnt(10)
  v_mfma_f32_16x16x32_bf16 v[64:67], v[36:39], v[68:71], v[64:67]
  v_bitop3_b32 v7, v7, v36, s3 bitop3:0xf6
  s_waitcnt vmcnt(9)
  v_mfma_f32_16x16x32_bf16 v[64:67], v[40:43], v[68:71], v[64:67]
  v_bitop3_b32 v7, v7, v40, s3 bitop3:0xf6
  s_waitcnt vmcnt(8)
  v_mfma_f32_16x16x32_bf16 v[64:67], v[44:47], v[68:71], v[64:67]
  v_bitop3_b32 v7, v7, v44, s3 bitop3:0xf6
  v_and_b32 v7, 1, v7
  v_cmp_ne_u32 vcc, 0, v7
  v_mov_b32 v7, 0
  v_mov_b32 v7, 0
  s_cbranch_vccnz c_p1r_65
c_publ_66:
  s_nop 1
  s_nop 0
  v_cvt_pk_bf16_f32 v64, v64, v65
  v_cvt_pk_bf16_f32 v65, v66, v67
  v_min_u32 v64, -2, v64
  v_min_u32 v65, -2, v65
  buffer_store_dwordx2 v[64:65], v5, s[4:7], s42 offen sc1
  s_waitcnt vmcnt(1)
  ds_read_b128 v[24:27], v1 offset:0
  ds_read_b128 v[28:31], v1 offset:1024
  ds_read_b128 v[32:35], v1 offset:2048
  ds_read_b128 v[36:39], v1 offset:3072
  ds_read_b128 v[40:43], v1 offset:4096
  ds_read_b128 v[44:47], v1 offset:5120
  ds_read_b128 v[72:75], v1 offset:6144
  ds_read_b128 v[76:79], v1 offset:7168
  ds_read_b128 v[80:83], v1 offset:8192
  ds_read_b128 v[84:87], v1 offset:9216
  ds_read_b128 v[88:91], v1 offset:10240
  ds_read_b128 v[92:95], v1 offset:11264
  ds_read_b128 v[96:99], v1 offset:12288
  ds_read_b128 v[100:103], v1 offset:13312
c_hop2_48:
  s_barrier
  s_cmp_le_u32 s96, s23
  s_cbranch_scc1 c_loop_45
  s_cmp_lg_u32 s96, 268435456
  s_cbranch_scc1 c_fk0_67
  buffer_store_dwordx2 v[64:65], v5, s[4:7], s97 offen sc1
  s_mov_b32 s29, 0
  s_sub_u32 s92, s63, 4096
  s_sub_u32 s96, s23, 524288
  s_mov_b32 s95, 0
c_gw_68:
  buffer_load_dword v7, off, s[4:7], s92 sc1
  s_add_u32 s29, s29, 1
  s_cmp_gt_u32 s29, 1048576
  s_cbranch_scc1 c_fail_51
  s_waitcnt vmcnt(0) lgkmcnt(0)
  v_readfirstlane_b32 s65, v7
  s_cmp_eq_u32 s65, 0
  s_cbranch_scc1 c_gw_68
  s_and_b32 s65, s65, s93
  s_cbranch_scc1 c_kvx_70
  s_mov_b32 s95, 1
  s_add_u32 s96, s96, 33554432
  s_add_u32 s92, s92, 262144
c_kvw_69:
  buffer_load_dword v7, off, s[4:7], s92 sc1
  s_add_u32 s29, s29, 1
  s_cmp_gt_u32 s29, 1048576
  s_cbranch_scc1 c_fail_51
  s_waitcnt vmcnt(0) lgkmcnt(0)
  v_readfirstlane_b32 s65, v7
  s_cmp_eq_u32 s65, 0
  s_cbranch_scc1 c_kvw_69
c_kvx_70:
  buffer_load_dword v7, off, s[4:7], s63 sc1
  buffer_load_dwordx4 v0, s[4:7], s96 offen offset:0  lds
  buffer_load_dwordx4 v0, s[4:7], s96 offen offset:1024  lds
  buffer_load_dwordx4 v0, s[4:7], s96 offen offset:2048  lds
  buffer_load_dwordx4 v0, s[4:7], s96 offen offset:3072  lds
  s_waitcnt vmcnt(4)
  v_readfirstlane_b32 s65, v7
  s_mov_b32 s94, 0
  s_cmp_eq_u32 s95, 0
  s_cbranch_scc1 c_loop_45
c_fk0_67:
  s_mov_b32 s29, 0
c_fk_71:
  buffer_load_dwordx4 v[16:19], v8, s[4:7], s42 offen sc1
  buffer_load_dwordx4 v[20:23], v8, s[4:7], s43 offen sc1
  s_add_u32 s29, s29, 1
  s_cmp_gt_u32 s29, 1048576
  s_cbranch_scc1 c_fail_51
  s_waitcnt vmcnt(0)
  v_max3_u32 v7, v16, v17, v18
  v_max3_u32 v7, v19, v20, v7
  v_max3_u32 v7, v21, v22, v7
  v_max_u32 v7, v7, v23
  v_cmp_eq_u32 vcc, -1, v7
  s_cbranch_vccnz c_fk_71
c_fk1_72:
  s_lshl_b32 s42, s22, 13
  s_add_u32 s42, s42, 245891072
  s_add_u32 s43, s42, 4096
  s_mov_b32 s95, 0
  s_branch c_loop_45
c_xb_60:
  s_cmp_lg_u32 s93, 1
  s_cbranch_scc1 c_xr_61
  s_cmp_ge_u32 s22, 63
  s_cbranch_scc1 c_xr_61
c_xp_73:
  s_cmp_lg_u32 s65, 0
  s_cbranch_scc1 c_xs_74
  buffer_load_dword v7, off, s[4:7], s63 sc1
  s_add_u32 s29, s29, 1
  s_cmp_gt_u32 s29, 1048576
  s_cbranch_scc1 c_fail_51
  s_waitcnt vmcnt(0)
  v_readfirstlane_b32 s65, v7
  s_branch c_xp_73
c_xs_74:
  s_cmp_eq_u32 s65, 1
  s_cbranch_scc1 c_xr_61
  s_mov_b32 s29, 0
c_xw_75:
  buffer_load_dwordx4 v[16:19], v8, s[4:7], s42 offen sc1
  buffer_load_dwordx4 v[20:23], v8, s[4:7], s43 offen sc1
  s_add_u32 s29, s29, 1
  s_cmp_gt_u32 s29, 1048576
  s_cbranch_scc1 c_fail_51
  s_waitcnt vmcnt(0)
  v_max3_u32 v7, v16, v17, v18
  v_max3_u32 v7, v19, v20, v7
  v_max3_u32 v7, v21, v22, v7
  v_max_u32 v7, v7, v23
  v_cmp_eq_u32 vcc, -1, v7
  s_cbranch_vccnz c_xw_75
  v_mov_b32 v7, 1
  s_barrier
  s_mov_b64 exec, 1
  buffer_store_dword v7, off, s[4:7], s64 sc1
  s_mov_b64 exec, -1
  s_add_u32 s22, s22, 1
  s_add_u32 s23, s23, 524288
  s_add_u32 s25, s25, 262144
  s_add_u32 s63, s63, 4096
  s_add_u32 s64, s64, 2048
  s_andn2_b32 s64, s64, s2
  s_mov_b32 s29, 0
  s_sub_u32 s92, s63, 4096
  s_sub_u32 s96, s23, 524288
  s_mov_b32 s95, 0
  s_mov_b32 s95, 1
  s_add_u32 s96, s96, 33554432
  s_add_u32 s92, s92, 262144
c_kvw_77:
  buffer_load_dword v7, off, s[4:7], s92 sc1
  s_add_u32 s29, s29, 1
  s_cmp_gt_u32 s29, 1048576
  s_cbranch_scc1 c_fail_51
  s_waitcnt vmcnt(0) lgkmcnt(0)
  v_readfirstlane_b32 s65, v7
  s_cmp_eq_u32 s65, 0
  s_cbranch_scc1 c_kvw_77
c_kvx_78:
  buffer_load_dword v7, off, s[4:7], s63 sc1
  buffer_load_dwordx4 v0, s[4:7], s96 offen offset:0  lds
  buffer_load_dwordx4 v0, s[4:7], s96 offen offset:1024  lds
  buffer_load_dwordx4 v0, s[4:7], s96 offen offset:2048  lds
  buffer_load_dwordx4 v0, s[4:7], s96 offen offset:3072  lds
  s_waitcnt vmcnt(4)
  v_readfirstlane_b32 s65, v7
  s_mov_b32 s94, 0
  s_branch c_fk1_72
c_last_52:
  s_add_u32 s64, s64, 2048
  v_mov_b32 v7, 1
  s_waitcnt vmcnt(0)
  s_barrier
  s_mov_b64 exec, 1
  buffer_store_dword v7, off, s[4:7], s64 sc1
  s_mov_b64 exec, -1
  s_branch L_chdone
c_oth_64:
  s_buffer_load_dword s65, s[4:7], s63
  ds_read_b128 v[24:27], v1 offset:0
  ds_read_b128 v[28:31], v1 offset:1024
  ds_read_b128 v[32:35], v1 offset:2048
  ds_read_b128 v[36:39], v1 offset:3072
  ds_read_b128 v[40:43], v1 offset:4096
  ds_read_b128 v[44:47], v1 offset:5120
  ds_read_b128 v[72:75], v1 offset:6144
  ds_read_b128 v[76:79], v1 offset:7168
  ds_read_b128 v[80:83], v1 offset:8192
  ds_read_b128 v[84:87], v1 offset:9216
  ds_read_b128 v[88:91], v1 offset:10240
  ds_read_b128 v[92:95], v1 offset:11264
  ds_read_b128 v[96:99], v1 offset:12288
  ds_read_b128 v[100:103], v1 offset:13312
  ds_read_b128 v[104:107], v1 offset:14336
  ds_read_b128 v[108:111], v1 offset:15360
  ds_read_b128 v[112:115], v1 offset:16384
  ds_read_b128 v[116:119], v1 offset:17408
  ds_read_b128 v[120:123], v1 offset:18432
  ds_read_b128 v[124:127], v1 offset:19456
  s_branch c_hop2_48
c_p1r_65:
  s_waitcnt vmcnt(7)
  s_nop 0
  v_mfma_f32_16x16x32_bf16 v[64:67], v[72:75], v[68:71], 0
  v_xor_b32 v7, s3, v72
  s_waitcnt vmcnt(6)
  v_mfma_f32_16x16x32_bf16 v[64:67], v[76:79], v[68:71], v[64:67]
  v_bitop3_b32 v7, v7, v76, s3 bitop3:0xf6
  s_waitcnt vmcnt(5)
  v_mfma_f32_16x16x32_bf16 v[64:67], v[80:83], v[68:71], v[64:67]
  v_bitop3_b32 v7, v7, v80, s3 bitop3:0xf6
  s_waitcnt vmcnt(4)
  v_mfma_f32_16x16x32_bf16 v[64:67], v[84:87], v[68:71], v[64:67]
  v_bitop3_b32 v7, v7, v84, s3 bitop3:0xf6
  s_waitcnt vmcnt(3)
  v_mfma_f32_16x16x32_bf16 v[64:67], v[88:91], v[68:71], v[64:67]
  v_bitop3_b32 v7, v7, v88, s3 bitop3:0xf6
  s_waitcnt vmcnt(2)
  v_mfma_f32_16x16x32_bf16 v[64:67], v[92:95], v[68:71], v[64:67]
  v_bitop3_b32 v7, v7, v92, s3 bitop3:0xf6
  s_waitcnt vmcnt(1)
  v_mfma_f32_16x16x32_bf16 v[64:67], v[96:99], v[68:71], v[64:67]
  v_bitop3_b32 v7, v7, v96, s3 bitop3:0xf6
  s_waitcnt vmcnt(0)
  v_mfma_f32_16x16x32_bf16 v[64:67], v[100:103], v[68:71], v[64:67]
  v_bitop3_b32 v7, v7, v100, s3 bitop3:0xf6
  v_and_b32 v7, 1, v7
  v_cmp_ne_u32 vcc, 0, v7
  s_add_u32 s46, s46, 1
  s_cbranch_vccz c_publ_66
  buffer_load_dwordx4 v[72:75], v0, s[4:7], s38 offen offset:0 sc1
  buffer_load_dwordx4 v[76:79], v0, s[4:7], s38 offen offset:1024 sc1
  buffer_load_dwordx4 v[80:83], v0, s[4:7], s38 offen offset:2048 sc1
  buffer_load_dwordx4 v[84:87], v0, s[4:7], s38 offen offset:3072 sc1
  buffer_load_dwordx4 v[88:91], v0, s[4:7], s39 offen offset:0 sc1
  buffer_load_dwordx4 v[92:95], v0, s[4:7], s39 offen offset:1024 sc1
  buffer_load_dwordx4 v[96:99], v0, s[4:7], s39 offen offset:2048 sc1
  buffer_load_dwordx4 v[100:103], v0, s[4:7], s39 offen offset:3072 sc1
  s_add_u32 s28, s28, 1
  s_cmp_gt_u32 s28, 1048576
  s_cbranch_scc0 c_p1r_65
  s_branch c_fail_51
c_retry_46:
  v_mov_b64 v[48:49], 0
  v_mov_b64 v[50:51], 0
  s_nop 0
  v_mov_b64 v[52:53], 0
  v_mov_b64 v[54:55], 0
  s_nop 1
  v_mov_b64 v[56:57], 0
  v_mov_b64 v[58:59], 0
c_rl_79:
  buffer_load_dwordx4 v[16:19], v8, s[4:7], s42 offen sc1
  buffer_load_dwordx4 v[20:23], v8, s[4:7], s43 offen sc1
  s_add_u32 s28, s28, 1
  s_add_u32 s47, s47, 1
  s_cmp_gt_u32 s28, 1048576
  s_cbranch_scc1 c_fail_51
  s_waitcnt vmcnt(2)
  v_max3_u32 v7, v16, v17, v18
  v_max3_u32 v7, v19, v20, v7
  v_max3_u32 v7, v21, v22, v7
  v_max_u32 v7, v7, v23
  v_cmp_eq_u32 vcc, -1, v7
  s_cbranch_vccnz c_rl_79
  ds_write_b128 v8, v[16:19] offset:4096
  v_smfmac_f32_16x16x64_bf16 v[48:51], v[16:19], v[24:31], v6
  ds_write_b128 v8, v[20:23] offset:8192
  v_smfmac_f32_16x16x64_bf16 v[52:55], v[16:19], v[32:39], v6
  v_smfmac_f32_16x16x64_bf16 v[56:59], v[16:19], v[40:47], v6
  s_branch c_got_47
c_fb_49:
  v_max3_f32 v7, v48, v49, v50
  v_max_f32 v7, v51, v7
  s_mov_b64 exec, s[18:19]
  v_max3_f32 v7, v16, v17, v7
  s_mov_b64 exec, -1
  s_nop 0
  v_max_f32_dpp v7, v7, v7 quad_perm:[2,3,0,1] row_mask:0xf bank_mask:0xf
  v_mov_b32 v24, v7
  s_nop 0
  s_nop 0
  v_permlane16_swap_b32 v7, v24
  v_max_f32 v7, v7, v24
  v_mov_b32 v24, v7
  s_nop 0
  s_nop 0
  v_permlane32_swap_b32 v7, v24
  v_max_f32 v7, v7, v24
  v_sub_f32 v24, v48, v7
  v_sub_f32 v25, v49, v7
  v_sub_f32 v26, v50, v7
  v_sub_f32 v27, v51, v7
  v_sub_f32 v28, v16, v7
  v_sub_f32 v29, v17, v7
  v_exp_f32 v24, v24
  v_exp_f32 v25, v25
  v_exp_f32 v26, v26
  v_exp_f32 v27, v27
  v_exp_f32 v28, v28
  v_exp_f32 v29, v29
  v_cvt_pk_bf16_f32 v24, v24, v25
  v_cvt_pk_bf16_f32 v25, v26, v27
  v_cvt_pk_bf16_f32 v28, v28, v29
  v_cndmask_b32 v72, v24, 0, s[18:19]
  v_cndmask_b32 v73, v25, 0, s[18:19]
  v_cndmask_b32 v74, 0, v24, s[18:19]
  v_cndmask_b32 v75, 0, v25, s[18:19]
  v_cndmask_b32 v77, 0, v28, s[18:19]
  v_cndmask_b32 v78, 0, v28, s[18:19]
  v_mfma_f32_16x16x32_bf16 v[60:63], v[72:75], v[20:23], 0
  v_mfma_f32_16x16x32_bf16 v[52:55], v[72:75], v[80:83], 0
  v_mfma_f32_16x16x32_bf16 v[56:59], v[72:75], v[84:87], 0
  v_mfma_f32_16x16x16_bf16 v[60:63], v[76:77], v[20:21], v[60:63]
  v_mfma_f32_16x16x16_bf16 v[52:55], v[78:79], v[66:67], v[52:55]
  s_nop 2
  v_mfma_f32_16x16x16_bf16 v[56:59], v[76:77], v[66:67], v[56:59]
  s_nop 7
  v_add_f32 v60, v60, v62
  v_add_f32 v61, v61, v63
  s_branch c_fbr_50
c_fail_51:
  s_endpgm
L_chdone:
  s_cmp_lg_u32 s91, 0
  s_cbranch_scc1 L_end
  s_lshr_b32 s91, s90, 4
  s_add_u32 s91, s91, 7
  v_lshrrev_b32 v0, 4, v0
  s_waitcnt vmcnt(0) lgkmcnt(0)
  v_mbcnt_lo_u32_b32 v20, -1, 0
  v_and_b32 v20, 3, v20
  v_add_lshl_u32 v20, v20, 0, 2
  s_mov_b32 s26, 0
g_wt_80:
  global_load_dword v21, v20, s[12:13] offset:128 sc1
  s_add_u32 s26, s26, 1
  s_cmp_gt_u32 s26, 1048576
  s_cbranch_scc1 L_end
  s_waitcnt vmcnt(0)
  v_cmp_eq_u32 vcc, 0, v21
  v_readfirstlane_b32 s27, v21
  s_cbranch_vccnz g_wt_80
  s_mov_b32 s89, s27
  s_branch L_o
L_qkv:
  s_mul_i32 s26, s91, 15
  s_add_u32 s26, s26, s90
  s_sub_u32 s26, s26, 61
  s_add_u32 s27, s91, 89
  s_cmp_eq_u32 s90, 31
  s_cselect_b32 s26, s27, s26
  s_add_u32 s27, s90, 60
  s_cmp_eq_u32 s91, 7
  s_cselect_b32 s26, s27, s26
  s_mul_i32 s16, s26, 171
  s_lshr_b32 s16, s16, 9
  s_mul_i32 s27, s16, 3
  s_sub_u32 s60, s26, s27
  s_add_u32 s16, s16, 4
  s_and_b32 s16, s16, 31
  v_and_b32 v19, 63, v0
  v_and_b32 v6, 15, v19
  v_lshrrev_b32 v7, 4, v19
  v_lshlrev_b32 v1, 2, v19
  v_lshlrev_b32 v0, 4, v19
  v_lshlrev_b32 v9, 7, v19
  s_mov_b32 s24, 0x3e0293ee
  s_lshl_b32 s57, s16, 2
  s_add_u32 s57, s57, s17
  v_and_b32 v24, 1, v7
  v_lshlrev_b32 v24, 10, v24
  v_lshl_add_u32 v24, v6, 4, v24
  v_lshrrev_b32 v25, 1, v7
  v_lshl_add_u32 v8, v25, 8, v24
  v_lshrrev_b32 v24, 9, v0
  v_lshlrev_b32 v24, 4, v24
  v_and_b32 v25, 0xf0, v0
  v_xor_b32 v24, v24, v25
  v_and_b32 v25, 0x1f0, v0
  v_lshl_add_u32 v24, v25, 6, v24
  v_xor_b32 v120, 0, v24
  v_xor_b32 v121, 32, v24
  v_xor_b32 v122, 64, v24
  v_xor_b32 v123, 96, v24
  v_xor_b32 v124, 128, v24
  v_xor_b32 v125, 160, v24
  v_xor_b32 v126, 192, v24
  v_xor_b32 v127, 224, v24
  s_and_b32 s26, s17, 1
  s_lshl_b32 s26, s26, 7
  v_xor_b32 v24, s26, v0
  v_xor_b32 v12, 0, v24
  v_xor_b32 v13, 16, v24
  v_xor_b32 v14, 32, v24
  v_xor_b32 v15, 48, v24
  v_xor_b32 v16, 64, v24
  v_xor_b32 v17, 80, v24
  v_xor_b32 v18, 96, v24
  v_xor_b32 v19, 112, v24
  s_lshl_b32 s26, s17, 2
  s_add_u32 s26, s26, 162816
  v_lshrrev_b32 v24, 7, v0
  v_lshl_add_u32 v118, v24, 4, s26
  v_and_b32 v24, 48, v0
  v_add_u32 v119, 162816, v24
  v_lshrrev_b32 v25, 8, v0
  v_and_b32 v20, 0xf0, v0
  v_lshlrev_b32 v21, 6, v25
  v_xor_b32 v20, v20, v21
  v_lshl_add_u32 v20, v25, 13, v20
  v_xor_b32 v21, 32, v20
  s_load_dwordx2 s[64:65], s[0:1], 24
  s_load_dwordx2 s[68:69], s[0:1], 32
  s_load_dwordx2 s[8:9], s[0:1], 16
  s_mov_b32 s10, 4194304
  s_mov_b32 s11, 0x20000
  s_mov_b32 s66, 4194304
  s_mov_b32 s67, 0x20000
  s_mov_b32 s70, 4194304
  s_mov_b32 s71, 0x20000
  v_lshrrev_b32 v25, 2, v6
  v_lshrrev_b32 v26, 1, v7
  v_lshl_add_u32 v27, v26, 3, v25
  v_lshlrev_b32 v27, 8, v27
  v_lshl_add_u32 v26, v25, 1, v26
  v_and_b32 v25, 1, v7
  v_xor_b32 v26, v26, v25
  s_lshl_b32 s26, s17, 1
  v_xor_b32 v26, s26, v26
  v_lshl_add_u32 v27, v26, 5, v27
  v_and_b32 v25, 3, v6
  v_lshl_add_u32 v22, v25, 3, v27
  v_add_u32 v23, 65536, v22
  v_add_u32 v24, 131072, v22
  s_lshl_b32 s28, s17, 13
  s_lshl_b32 s26, s17, 18
  s_lshl_b32 s27, s16, 8
  s_add_u32 s26, s26, s27
  s_waitcnt lgkmcnt(0)
  s_cmp_eq_u32 s60, 1
  s_cbranch_scc1 q_ld_82
  s_cmp_eq_u32 s60, 2
  s_cbranch_scc1 q_ld_83
q_ld_81:
  s_add_u32 s27, s26, 0
  s_add_u32 m0, s28, 0
  s_nop 0
  buffer_load_dwordx4 v20, s[64:67], s27 offen lds
  s_add_u32 m0, s28, 1024
  s_add_u32 s27, s27, 32768
  buffer_load_dwordx4 v20, s[64:67], s27 offen lds
  s_add_u32 m0, s28, 2048
  s_add_u32 s27, s27, 32768
  buffer_load_dwordx4 v21, s[64:67], s27 offen lds
  s_add_u32 m0, s28, 3072
  s_add_u32 s27, s27, 32768
  buffer_load_dwordx4 v21, s[64:67], s27 offen lds
  s_add_u32 m0, s28, 4096
  s_add_u32 s27, s27, 32768
  buffer_load_dwordx4 v20, s[64:67], s27 offen lds
  s_add_u32 m0, s28, 5120
  s_add_u32 s27, s27, 32768
  buffer_load_dwordx4 v20, s[64:67], s27 offen lds
  s_add_u32 m0, s28, 6144
  s_add_u32 s27, s27, 32768
  buffer_load_dwordx4 v21, s[64:67], s27 offen lds
  s_add_u32 m0, s28, 7168
  s_add_u32 s27, s27, 32768
  buffer_load_dwordx4 v21, s[64:67], s27 offen lds
  s_add_u32 s27, s26, 1048576
  s_add_u32 m0, s28, 32768
  s_nop 0
  buffer_load_dwordx4 v20, s[64:67], s27 offen lds
  s_add_u32 m0, s28, 33792
  s_add_u32 s27, s27, 32768
  buffer_load_dwordx4 v20, s[64:67], s27 offen lds
  s_add_u32 m0, s28, 34816
  s_add_u32 s27, s27, 32768
  buffer_load_dwordx4 v21, s[64:67], s27 offen lds
  s_add_u32 m0, s28, 35840
  s_add_u32 s27, s27, 32768
  buffer_load_dwordx4 v21, s[64:67], s27 offen lds
  s_add_u32 m0, s28, 36864
  s_add_u32 s27, s27, 32768
  buffer_load_dwordx4 v20, s[64:67], s27 offen lds
  s_add_u32 m0, s28, 37888
  s_add_u32 s27, s27, 32768
  buffer_load_dwordx4 v20, s[64:67], s27 offen lds
  s_add_u32 m0, s28, 38912
  s_add_u32 s27, s27, 32768
  buffer_load_dwordx4 v21, s[64:67], s27 offen lds
  s_add_u32 m0, s28, 39936
  s_add_u32 s27, s27, 32768
  buffer_load_dwordx4 v21, s[64:67], s27 offen lds
  s_add_u32 s27, s26, 2097152
  s_add_u32 m0, s28, 65536
  s_nop 0
  buffer_load_dwordx4 v20, s[64:67], s27 offen lds
  s_add_u32 m0, s28, 66560
  s_add_u32 s27, s27, 32768
  buffer_load_dwordx4 v20, s[64:67], s27 offen lds
  s_add_u32 m0, s28, 67584
  s_add_u32 s27, s27, 32768
  buffer_load_dwordx4 v21, s[64:67], s27 offen lds
  s_add_u32 m0, s28, 68608
  s_add_u32 s27, s27, 32768
  buffer_load_dwordx4 v21, s[64:67], s27 offen lds
  s_add_u32 m0, s28, 69632
  s_add_u32 s27, s27, 32768
  buffer_load_dwordx4 v20, s[64:67], s27 offen lds
  s_add_u32 m0, s28, 70656
  s_add_u32 s27, s27, 32768
  buffer_load_dwordx4 v20, s[64:67], s27 offen lds
  s_add_u32 m0, s28, 71680
  s_add_u32 s27, s27, 32768
  buffer_load_dwordx4 v21, s[64:67], s27 offen lds
  s_add_u32 m0, s28, 72704
  s_add_u32 s27, s27, 32768
  buffer_load_dwordx4 v21, s[64:67], s27 offen lds
  s_load_dwordx2 s[4:5], s[0:1], 112
  s_load_dwordx2 s[12:13], s[0:1], 104
  s_waitcnt vmcnt(16)
  s_barrier
  s_add_u32 s27, s26, 3145728
  s_add_u32 m0, s28, 98304
  s_nop 0
  buffer_load_dwordx4 v20, s[64:67], s27 offen lds
  s_add_u32 m0, s28, 99328
  s_add_u32 s27, s27, 32768
  buffer_load_dwordx4 v20, s[64:67], s27 offen lds
  s_add_u32 m0, s28, 100352
  s_add_u32 s27, s27, 32768
  buffer_load_dwordx4 v21, s[64:67], s27 offen lds
  s_add_u32 m0, s28, 101376
  s_add_u32 s27, s27, 32768
  buffer_load_dwordx4 v21, s[64:67], s27 offen lds
  s_add_u32 m0, s28, 102400
  s_add_u32 s27, s27, 32768
  buffer_load_dwordx4 v20, s[64:67], s27 offen lds
  s_add_u32 m0, s28, 103424
  s_add_u32 s27, s27, 32768
  buffer_load_dwordx4 v20, s[64:67], s27 offen lds
  s_add_u32 m0, s28, 104448
  s_add_u32 s27, s27, 32768
  buffer_load_dwordx4 v21, s[64:67], s27 offen lds
  s_add_u32 m0, s28, 105472
  s_add_u32 s27, s27, 32768
  buffer_load_dwordx4 v21, s[64:67], s27 offen lds
  ds_read_b64_tr_b16 v[128:129], v22 offset:0
  ds_read_b64_tr_b16 v[130:131], v22 offset:1024
  ds_read_b64_tr_b16 v[132:133], v22 offset:4096
  ds_read_b64_tr_b16 v[134:135], v22 offset:5120
  ds_read_b64_tr_b16 v[136:137], v22 offset:8192
  ds_read_b64_tr_b16 v[138:139], v22 offset:9216
  ds_read_b64_tr_b16 v[140:141], v22 offset:12288
  ds_read_b64_tr_b16 v[142:143], v22 offset:13312
  ds_read_b64_tr_b16 v[144:145], v22 offset:16384
  ds_read_b64_tr_b16 v[146:147], v22 offset:17408
  ds_read_b64_tr_b16 v[148:149], v22 offset:20480
  ds_read_b64_tr_b16 v[150:151], v22 offset:21504
  ds_read_b64_tr_b16 v[152:153], v22 offset:24576
  ds_read_b64_tr_b16 v[154:155], v22 offset:25600
  ds_read_b64_tr_b16 v[156:157], v22 offset:28672
  ds_read_b64_tr_b16 v[158:159], v22 offset:29696
  s_waitcnt lgkmcnt(0)
  s_waitcnt vmcnt(16)
  s_barrier
  s_add_u32 s27, s26, 0
  s_add_u32 m0, s28, 131072
  s_nop 0
  buffer_load_dwordx4 v20, s[68:71], s27 offen lds
  s_add_u32 m0, s28, 132096
  s_add_u32 s27, s27, 32768
  buffer_load_dwordx4 v20, s[68:71], s27 offen lds
  s_add_u32 m0, s28, 133120
  s_add_u32 s27, s27, 32768
  buffer_load_dwordx4 v21, s[68:71], s27 offen lds
  s_add_u32 m0, s28, 134144
  s_add_u32 s27, s27, 32768
  buffer_load_dwordx4 v21, s[68:71], s27 offen lds
  s_add_u32 m0, s28, 135168
  s_add_u32 s27, s27, 32768
  buffer_load_dwordx4 v20, s[68:71], s27 offen lds
  s_add_u32 m0, s28, 136192
  s_add_u32 s27, s27, 32768
  buffer_load_dwordx4 v20, s[68:71], s27 offen lds
  s_add_u32 m0, s28, 137216
  s_add_u32 s27, s27, 32768
  buffer_load_dwordx4 v21, s[68:71], s27 offen lds
  s_add_u32 m0, s28, 138240
  s_add_u32 s27, s27, 32768
  buffer_load_dwordx4 v21, s[68:71], s27 offen lds
  ds_read_b64_tr_b16 v[160:161], v22 offset:32768
  ds_read_b64_tr_b16 v[162:163], v22 offset:33792
  ds_read_b64_tr_b16 v[164:165], v22 offset:36864
  ds_read_b64_tr_b16 v[166:167], v22 offset:37888
  ds_read_b64_tr_b16 v[168:169], v22 offset:40960
  ds_read_b64_tr_b16 v[170:171], v22 offset:41984
  ds_read_b64_tr_b16 v[172:173], v22 offset:45056
  ds_read_b64_tr_b16 v[174:175], v22 offset:46080
  ds_read_b64_tr_b16 v[176:177], v22 offset:49152
  ds_read_b64_tr_b16 v[178:179], v22 offset:50176
  ds_read_b64_tr_b16 v[180:181], v22 offset:53248
  ds_read_b64_tr_b16 v[182:183], v22 offset:54272
  ds_read_b64_tr_b16 v[184:185], v22 offset:57344
  ds_read_b64_tr_b16 v[186:187], v22 offset:58368
  ds_read_b64_tr_b16 v[188:189], v22 offset:61440
  ds_read_b64_tr_b16 v[190:191], v22 offset:62464
  s_waitcnt lgkmcnt(0)
  s_waitcnt vmcnt(16)
  s_barrier
  s_add_u32 s27, s26, 1048576
  s_add_u32 m0, s28, 0
  s_nop 0
  buffer_load_dwordx4 v20, s[68:71], s27 offen lds
  s_add_u32 m0, s28, 1024
  s_add_u32 s27, s27, 32768
  buffer_load_dwordx4 v20, s[68:71], s27 offen lds
  s_add_u32 m0, s28, 2048
  s_add_u32 s27, s27, 32768
  buffer_load_dwordx4 v21, s[68:71], s27 offen lds
  s_add_u32 m0, s28, 3072
  s_add_u32 s27, s27, 32768
  buffer_load_dwordx4 v21, s[68:71], s27 offen lds
  s_add_u32 m0, s28, 4096
  s_add_u32 s27, s27, 32768
  buffer_load_dwordx4 v20, s[68:71], s27 offen lds
  s_add_u32 m0, s28, 5120
  s_add_u32 s27, s27, 32768
  buffer_load_dwordx4 v20, s[68:71], s27 offen lds
  s_add_u32 m0, s28, 6144
  s_add_u32 s27, s27, 32768
  buffer_load_dwordx4 v21, s[68:71], s27 offen lds
  s_add_u32 m0, s28, 7168
  s_add_u32 s27, s27, 32768
  buffer_load_dwordx4 v21, s[68:71], s27 offen lds
  ds_read_b64_tr_b16 v[192:193], v23 offset:0
  ds_read_b64_tr_b16 v[194:195], v23 offset:1024
  ds_read_b64_tr_b16 v[196:197], v23 offset:4096
  ds_read_b64_tr_b16 v[198:199], v23 offset:5120
  ds_read_b64_tr_b16 v[200:201], v23 offset:8192
  ds_read_b64_tr_b16 v[202:203], v23 offset:9216
  ds_read_b64_tr_b16 v[204:205], v23 offset:12288
  ds_read_b64_tr_b16 v[206:207], v23 offset:13312
  ds_read_b64_tr_b16 v[208:209], v23 offset:16384
  ds_read_b64_tr_b16 v[210:211], v23 offset:17408
  ds_read_b64_tr_b16 v[212:213], v23 offset:20480
  ds_read_b64_tr_b16 v[214:215], v23 offset:21504
  ds_read_b64_tr_b16 v[216:217], v23 offset:24576
  ds_read_b64_tr_b16 v[218:219], v23 offset:25600
  ds_read_b64_tr_b16 v[220:221], v23 offset:28672
  ds_read_b64_tr_b16 v[222:223], v23 offset:29696
  s_waitcnt lgkmcnt(0)
  s_waitcnt vmcnt(16)
  s_barrier
  s_add_u32 s27, s26, 2097152
  s_add_u32 m0, s28, 32768
  s_nop 0
  buffer_load_dwordx4 v20, s[68:71], s27 offen lds
  s_add_u32 m0, s28, 33792
  s_add_u32 s27, s27, 32768
  buffer_load_dwordx4 v20, s[68:71], s27 offen lds
  s_add_u32 m0, s28, 34816
  s_add_u32 s27, s27, 32768
  buffer_load_dwordx4 v21, s[68:71], s27 offen lds
  s_add_u32 m0, s28, 35840
  s_add_u32 s27, s27, 32768
  buffer_load_dwordx4 v21, s[68:71], s27 offen lds
  s_add_u32 m0, s28, 36864
  s_add_u32 s27, s27, 32768
  buffer_load_dwordx4 v20, s[68:71], s27 offen lds
  s_add_u32 m0, s28, 37888
  s_add_u32 s27, s27, 32768
  buffer_load_dwordx4 v20, s[68:71], s27 offen lds
  s_add_u32 m0, s28, 38912
  s_add_u32 s27, s27, 32768
  buffer_load_dwordx4 v21, s[68:71], s27 offen lds
  s_add_u32 m0, s28, 39936
  s_add_u32 s27, s27, 32768
  buffer_load_dwordx4 v21, s[68:71], s27 offen lds
  ds_read_b64_tr_b16 v[224:225], v23 offset:32768
  ds_read_b64_tr_b16 v[226:227], v23 offset:33792
  ds_read_b64_tr_b16 v[228:229], v23 offset:36864
  ds_read_b64_tr_b16 v[230:231], v23 offset:37888
  ds_read_b64_tr_b16 v[232:233], v23 offset:40960
  ds_read_b64_tr_b16 v[234:235], v23 offset:41984
  ds_read_b64_tr_b16 v[236:237], v23 offset:45056
  ds_read_b64_tr_b16 v[238:239], v23 offset:46080
  ds_read_b64_tr_b16 v[240:241], v23 offset:49152
  ds_read_b64_tr_b16 v[242:243], v23 offset:50176
  ds_read_b64_tr_b16 v[244:245], v23 offset:53248
  ds_read_b64_tr_b16 v[246:247], v23 offset:54272
  ds_read_b64_tr_b16 v[248:249], v23 offset:57344
  ds_read_b64_tr_b16 v[250:251], v23 offset:58368
  ds_read_b64_tr_b16 v[252:253], v23 offset:61440
  ds_read_b64_tr_b16 v[254:255], v23 offset:62464
  s_waitcnt lgkmcnt(0)
  s_waitcnt vmcnt(16)
  s_barrier
  s_add_u32 s27, s26, 3145728
  s_add_u32 m0, s28, 65536
  s_nop 0
  buffer_load_dwordx4 v20, s[68:71], s27 offen lds
  s_add_u32 m0, s28, 66560
  s_add_u32 s27, s27, 32768
  buffer_load_dwordx4 v20, s[68:71], s27 offen lds
  s_add_u32 m0, s28, 67584
  s_add_u32 s27, s27, 32768
  buffer_load_dwordx4 v21, s[68:71], s27 offen lds
  s_add_u32 m0, s28, 68608
  s_add_u32 s27, s27, 32768
  buffer_load_dwordx4 v21, s[68:71], s27 offen lds
  s_add_u32 m0, s28, 69632
  s_add_u32 s27, s27, 32768
  buffer_load_dwordx4 v20, s[68:71], s27 offen lds
  s_add_u32 m0, s28, 70656
  s_add_u32 s27, s27, 32768
  buffer_load_dwordx4 v20, s[68:71], s27 offen lds
  s_add_u32 m0, s28, 71680
  s_add_u32 s27, s27, 32768
  buffer_load_dwordx4 v21, s[68:71], s27 offen lds
  s_add_u32 m0, s28, 72704
  s_add_u32 s27, s27, 32768
  buffer_load_dwordx4 v21, s[68:71], s27 offen lds
  ds_read_b64_tr_b16 a[0:1], v24 offset:0
  ds_read_b64_tr_b16 a[2:3], v24 offset:1024
  ds_read_b64_tr_b16 a[4:5], v24 offset:4096
  ds_read_b64_tr_b16 a[6:7], v24 offset:5120
  ds_read_b64_tr_b16 a[8:9], v24 offset:8192
  ds_read_b64_tr_b16 a[10:11], v24 offset:9216
  ds_read_b64_tr_b16 a[12:13], v24 offset:12288
  ds_read_b64_tr_b16 a[14:15], v24 offset:13312
  ds_read_b64_tr_b16 a[16:17], v24 offset:16384
  ds_read_b64_tr_b16 a[18:19], v24 offset:17408
  ds_read_b64_tr_b16 a[20:21], v24 offset:20480
  ds_read_b64_tr_b16 a[22:23], v24 offset:21504
  ds_read_b64_tr_b16 a[24:25], v24 offset:24576
  ds_read_b64_tr_b16 a[26:27], v24 offset:25600
  ds_read_b64_tr_b16 a[28:29], v24 offset:28672
  ds_read_b64_tr_b16 a[30:31], v24 offset:29696
  s_waitcnt lgkmcnt(0)
  s_waitcnt vmcnt(16)
  s_barrier
  s_add_u32 s27, s26, 0
  s_add_u32 m0, s28, 98304
  s_nop 0
  buffer_load_dwordx4 v20, s[8:11], s27 offen lds
  s_add_u32 m0, s28, 99328
  s_add_u32 s27, s27, 32768
  buffer_load_dwordx4 v20, s[8:11], s27 offen lds
  s_add_u32 m0, s28, 100352
  s_add_u32 s27, s27, 32768
  buffer_load_dwordx4 v21, s[8:11], s27 offen lds
  s_add_u32 m0, s28, 101376
  s_add_u32 s27, s27, 32768
  buffer_load_dwordx4 v21, s[8:11], s27 offen lds
  s_add_u32 m0, s28, 102400
  s_add_u32 s27, s27, 32768
  buffer_load_dwordx4 v20, s[8:11], s27 offen lds
  s_add_u32 m0, s28, 103424
  s_add_u32 s27, s27, 32768
  buffer_load_dwordx4 v20, s[8:11], s27 offen lds
  s_add_u32 m0, s28, 104448
  s_add_u32 s27, s27, 32768
  buffer_load_dwordx4 v21, s[8:11], s27 offen lds
  s_add_u32 m0, s28, 105472
  s_add_u32 s27, s27, 32768
  buffer_load_dwordx4 v21, s[8:11], s27 offen lds
  ds_read_b64_tr_b16 a[32:33], v22 offset:0
  ds_read_b64_tr_b16 a[34:35], v22 offset:1024
  ds_read_b64_tr_b16 a[36:37], v22 offset:4096
  ds_read_b64_tr_b16 a[38:39], v22 offset:5120
  ds_read_b64_tr_b16 a[40:41], v22 offset:8192
  ds_read_b64_tr_b16 a[42:43], v22 offset:9216
  ds_read_b64_tr_b16 a[44:45], v22 offset:12288
  ds_read_b64_tr_b16 a[46:47], v22 offset:13312
  ds_read_b64_tr_b16 a[48:49], v22 offset:16384
  ds_read_b64_tr_b16 a[50:51], v22 offset:17408
  ds_read_b64_tr_b16 a[52:53], v22 offset:20480
  ds_read_b64_tr_b16 a[54:55], v22 offset:21504
  ds_read_b64_tr_b16 a[56:57], v22 offset:24576
  ds_read_b64_tr_b16 a[58:59], v22 offset:25600
  ds_read_b64_tr_b16 a[60:61], v22 offset:28672
  ds_read_b64_tr_b16 a[62:63], v22 offset:29696
  s_waitcnt lgkmcnt(0)
  s_waitcnt vmcnt(16)
  s_barrier
  s_add_u32 s27, s26, 1048576
  s_add_u32 m0, s28, 131072
  s_nop 0
  buffer_load_dwordx4 v20, s[8:11], s27 offen lds
  s_add_u32 m0, s28, 132096
  s_add_u32 s27, s27, 32768
  buffer_load_dwordx4 v20, s[8:11], s27 offen lds
  s_add_u32 m0, s28, 133120
  s_add_u32 s27, s27, 32768
  buffer_load_dwordx4 v21, s[8:11], s27 offen lds
  s_add_u32 m0, s28, 134144
  s_add_u32 s27, s27, 32768
  buffer_load_dwordx4 v21, s[8:11], s27 offen lds
  s_add_u32 m0, s28, 135168
  s_add_u32 s27, s27, 32768
  buffer_load_dwordx4 v20, s[8:11], s27 offen lds
  s_add_u32 m0, s28, 136192
  s_add_u32 s27, s27, 32768
  buffer_load_dwordx4 v20, s[8:11], s27 offen lds
  s_add_u32 m0, s28, 137216
  s_add_u32 s27, s27, 32768
  buffer_load_dwordx4 v21, s[8:11], s27 offen lds
  s_add_u32 m0, s28, 138240
  s_add_u32 s27, s27, 32768
  buffer_load_dwordx4 v21, s[8:11], s27 offen lds
  ds_read_b64_tr_b16 a[64:65], v22 offset:32768
  ds_read_b64_tr_b16 a[66:67], v22 offset:33792
  ds_read_b64_tr_b16 a[68:69], v22 offset:36864
  ds_read_b64_tr_b16 a[70:71], v22 offset:37888
  ds_read_b64_tr_b16 a[72:73], v22 offset:40960
  ds_read_b64_tr_b16 a[74:75], v22 offset:41984
  ds_read_b64_tr_b16 a[76:77], v22 offset:45056
  ds_read_b64_tr_b16 a[78:79], v22 offset:46080
  ds_read_b64_tr_b16 a[80:81], v22 offset:49152
  ds_read_b64_tr_b16 a[82:83], v22 offset:50176
  ds_read_b64_tr_b16 a[84:85], v22 offset:53248
  ds_read_b64_tr_b16 a[86:87], v22 offset:54272
  ds_read_b64_tr_b16 a[88:89], v22 offset:57344
  ds_read_b64_tr_b16 a[90:91], v22 offset:58368
  ds_read_b64_tr_b16 a[92:93], v22 offset:61440
  ds_read_b64_tr_b16 a[94:95], v22 offset:62464
  s_waitcnt lgkmcnt(0)
  s_waitcnt vmcnt(16)
  s_barrier
  s_add_u32 s27, s26, 2097152
  s_add_u32 m0, s28, 0
  s_nop 0
  buffer_load_dwordx4 v20, s[8:11], s27 offen lds
  s_add_u32 m0, s28, 1024
  s_add_u32 s27, s27, 32768
  buffer_load_dwordx4 v20, s[8:11], s27 offen lds
  s_add_u32 m0, s28, 2048
  s_add_u32 s27, s27, 32768
  buffer_load_dwordx4 v21, s[8:11], s27 offen lds
  s_add_u32 m0, s28, 3072
  s_add_u32 s27, s27, 32768
  buffer_load_dwordx4 v21, s[8:11], s27 offen lds
  s_add_u32 m0, s28, 4096
  s_add_u32 s27, s27, 32768
  buffer_load_dwordx4 v20, s[8:11], s27 offen lds
  s_add_u32 m0, s28, 5120
  s_add_u32 s27, s27, 32768
  buffer_load_dwordx4 v20, s[8:11], s27 offen lds
  s_add_u32 m0, s28, 6144
  s_add_u32 s27, s27, 32768
  buffer_load_dwordx4 v21, s[8:11], s27 offen lds
  s_add_u32 m0, s28, 7168
  s_add_u32 s27, s27, 32768
  buffer_load_dwordx4 v21, s[8:11], s27 offen lds
  ds_read_b64_tr_b16 a[96:97], v23 offset:0
  ds_read_b64_tr_b16 a[98:99], v23 offset:1024
  ds_read_b64_tr_b16 a[100:101], v23 offset:4096
  ds_read_b64_tr_b16 a[102:103], v23 offset:5120
  ds_read_b64_tr_b16 a[104:105], v23 offset:8192
  ds_read_b64_tr_b16 a[106:107], v23 offset:9216
  ds_read_b64_tr_b16 a[108:109], v23 offset:12288
  ds_read_b64_tr_b16 a[110:111], v23 offset:13312
  ds_read_b64_tr_b16 a[112:113], v23 offset:16384
  ds_read_b64_tr_b16 a[114:115], v23 offset:17408
  ds_read_b64_tr_b16 a[116:117], v23 offset:20480
  ds_read_b64_tr_b16 a[118:119], v23 offset:21504
  ds_read_b64_tr_b16 a[120:121], v23 offset:24576
  ds_read_b64_tr_b16 a[122:123], v23 offset:25600
  ds_read_b64_tr_b16 a[124:125], v23 offset:28672
  ds_read_b64_tr_b16 a[126:127], v23 offset:29696
  s_waitcnt lgkmcnt(0)
  s_waitcnt vmcnt(16)
  s_barrier
  s_add_u32 s27, s26, 3145728
  s_add_u32 m0, s28, 32768
  s_nop 0
  buffer_load_dwordx4 v20, s[8:11], s27 offen lds
  s_add_u32 m0, s28, 33792
  s_add_u32 s27, s27, 32768
  buffer_load_dwordx4 v20, s[8:11], s27 offen lds
  s_add_u32 m0, s28, 34816
  s_add_u32 s27, s27, 32768
  buffer_load_dwordx4 v21, s[8:11], s27 offen lds
  s_add_u32 m0, s28, 35840
  s_add_u32 s27, s27, 32768
  buffer_load_dwordx4 v21, s[8:11], s27 offen lds
  s_add_u32 m0, s28, 36864
  s_add_u32 s27, s27, 32768
  buffer_load_dwordx4 v20, s[8:11], s27 offen lds
  s_add_u32 m0, s28, 37888
  s_add_u32 s27, s27, 32768
  buffer_load_dwordx4 v20, s[8:11], s27 offen lds
  s_add_u32 m0, s28, 38912
  s_add_u32 s27, s27, 32768
  buffer_load_dwordx4 v21, s[8:11], s27 offen lds
  s_add_u32 m0, s28, 39936
  s_add_u32 s27, s27, 32768
  buffer_load_dwordx4 v21, s[8:11], s27 offen lds
  ds_read_b64_tr_b16 a[128:129], v23 offset:32768
  ds_read_b64_tr_b16 a[130:131], v23 offset:33792
  ds_read_b64_tr_b16 a[132:133], v23 offset:36864
  ds_read_b64_tr_b16 a[134:135], v23 offset:37888
  ds_read_b64_tr_b16 a[136:137], v23 offset:40960
  ds_read_b64_tr_b16 a[138:139], v23 offset:41984
  ds_read_b64_tr_b16 a[140:141], v23 offset:45056
  ds_read_b64_tr_b16 a[142:143], v23 offset:46080
  ds_read_b64_tr_b16 a[144:145], v23 offset:49152
  ds_read_b64_tr_b16 a[146:147], v23 offset:50176
  ds_read_b64_tr_b16 a[148:149], v23 offset:53248
  ds_read_b64_tr_b16 a[150:151], v23 offset:54272
  ds_read_b64_tr_b16 a[152:153], v23 offset:57344
  ds_read_b64_tr_b16 a[154:155], v23 offset:58368
  ds_read_b64_tr_b16 a[156:157], v23 offset:61440
  ds_read_b64_tr_b16 a[158:159], v23 offset:62464
  s_waitcnt lgkmcnt(0)
  s_waitcnt vmcnt(16)
  s_barrier
  ds_read_b64_tr_b16 a[160:161], v24 offset:0
  ds_read_b64_tr_b16 a[162:163], v24 offset:1024
  ds_read_b64_tr_b16 a[164:165], v24 offset:4096
  ds_read_b64_tr_b16 a[166:167], v24 offset:5120
  ds_read_b64_tr_b16 a[168:169], v24 offset:8192
  ds_read_b64_tr_b16 a[170:171], v24 offset:9216
  ds_read_b64_tr_b16 a[172:173], v24 offset:12288
  ds_read_b64_tr_b16 a[174:175], v24 offset:13312
  ds_read_b64_tr_b16 a[176:177], v24 offset:16384
  ds_read_b64_tr_b16 a[178:179], v24 offset:17408
  ds_read_b64_tr_b16 a[180:181], v24 offset:20480
  ds_read_b64_tr_b16 a[182:183], v24 offset:21504
  ds_read_b64_tr_b16 a[184:185], v24 offset:24576
  ds_read_b64_tr_b16 a[186:187], v24 offset:25600
  ds_read_b64_tr_b16 a[188:189], v24 offset:28672
  ds_read_b64_tr_b16 a[190:191], v24 offset:29696
  s_waitcnt lgkmcnt(0)
  s_waitcnt vmcnt(8)
  s_barrier
  ds_read_b64_tr_b16 a[192:193], v22 offset:0
  ds_read_b64_tr_b16 a[194:195], v22 offset:1024
  ds_read_b64_tr_b16 a[196:197], v22 offset:4096
  ds_read_b64_tr_b16 a[198:199], v22 offset:5120
  ds_read_b64_tr_b16 a[200:201], v22 offset:8192
  ds_read_b64_tr_b16 a[202:203], v22 offset:9216
  ds_read_b64_tr_b16 a[204:205], v22 offset:12288
  ds_read_b64_tr_b16 a[206:207], v22 offset:13312
  ds_read_b64_tr_b16 a[208:209], v22 offset:16384
  ds_read_b64_tr_b16 a[210:211], v22 offset:17408
  ds_read_b64_tr_b16 a[212:213], v22 offset:20480
  ds_read_b64_tr_b16 a[214:215], v22 offset:21504
  ds_read_b64_tr_b16 a[216:217], v22 offset:24576
  ds_read_b64_tr_b16 a[218:219], v22 offset:25600
  ds_read_b64_tr_b16 a[220:221], v22 offset:28672
  ds_read_b64_tr_b16 a[222:223], v22 offset:29696
  s_waitcnt lgkmcnt(0)
  s_waitcnt vmcnt(0)
  s_barrier
  ds_read_b64_tr_b16 a[224:225], v22 offset:32768
  ds_read_b64_tr_b16 a[226:227], v22 offset:33792
  ds_read_b64_tr_b16 a[228:229], v22 offset:36864
  ds_read_b64_tr_b16 a[230:231], v22 offset:37888
  ds_read_b64_tr_b16 a[232:233], v22 offset:40960
  ds_read_b64_tr_b16 a[234:235], v22 offset:41984
  ds_read_b64_tr_b16 a[236:237], v22 offset:45056
  ds_read_b64_tr_b16 a[238:239], v22 offset:46080
  ds_read_b64_tr_b16 a[240:241], v22 offset:49152
  ds_read_b64_tr_b16 a[242:243], v22 offset:50176
  ds_read_b64_tr_b16 a[244:245], v22 offset:53248
  ds_read_b64_tr_b16 a[246:247], v22 offset:54272
  ds_read_b64_tr_b16 a[248:249], v22 offset:57344
  ds_read_b64_tr_b16 a[250:251], v22 offset:58368
  ds_read_b64_tr_b16 a[252:253], v22 offset:61440
  ds_read_b64_tr_b16 a[254:255], v22 offset:62464
  s_waitcnt lgkmcnt(0)
  s_branch q_ld_84
q_ld_82:
  s_add_u32 s27, s26, 0
  s_add_u32 m0, s28, 0
  s_nop 0
  buffer_load_dwordx4 v20, s[68:71], s27 offen lds
  s_add_u32 m0, s28, 1024
  s_add_u32 s27, s27, 32768
  buffer_load_dwordx4 v20, s[68:71], s27 offen lds
  s_add_u32 m0, s28, 2048
  s_add_u32 s27, s27, 32768
  buffer_load_dwordx4 v21, s[68:71], s27 offen lds
  s_add_u32 m0, s28, 3072
  s_add_u32 s27, s27, 32768
  buffer_load_dwordx4 v21, s[68:71], s27 offen lds
  s_add_u32 m0, s28, 4096
  s_add_u32 s27, s27, 32768
  buffer_load_dwordx4 v20, s[68:71], s27 offen lds
  s_add_u32 m0, s28, 5120
  s_add_u32 s27, s27, 32768
  buffer_load_dwordx4 v20, s[68:71], s27 offen lds
  s_add_u32 m0, s28, 6144
  s_add_u32 s27, s27, 32768
  buffer_load_dwordx4 v21, s[68:71], s27 offen lds
  s_add_u32 m0, s28, 7168
  s_add_u32 s27, s27, 32768
  buffer_load_dwordx4 v21, s[68:71], s27 offen lds
  s_add_u32 s27, s26, 1048576
  s_add_u32 m0, s28, 32768
  s_nop 0
  buffer_load_dwordx4 v20, s[68:71], s27 offen lds
  s_add_u32 m0, s28, 33792
  s_add_u32 s27, s27, 32768
  buffer_load_dwordx4 v20, s[68:71], s27 offen lds
  s_add_u32 m0, s28, 34816
  s_add_u32 s27, s27, 32768
  buffer_load_dwordx4 v21, s[68:71], s27 offen lds
  s_add_u32 m0, s28, 35840
  s_add_u32 s27, s27, 32768
  buffer_load_dwordx4 v21, s[68:71], s27 offen lds
  s_add_u32 m0, s28, 36864
  s_add_u32 s27, s27, 32768
  buffer_load_dwordx4 v20, s[68:71], s27 offen lds
  s_add_u32 m0, s28, 37888
  s_add_u32 s27, s27, 32768
  buffer_load_dwordx4 v20, s[68:71], s27 offen lds
  s_add_u32 m0, s28, 38912
  s_add_u32 s27, s27, 32768
  buffer_load_dwordx4 v21, s[68:71], s27 offen lds
  s_add_u32 m0, s28, 39936
  s_add_u32 s27, s27, 32768
  buffer_load_dwordx4 v21, s[68:71], s27 offen lds
  s_add_u32 s27, s26, 2097152
  s_add_u32 m0, s28, 65536
  s_nop 0
  buffer_load_dwordx4 v20, s[68:71], s27 offen lds
  s_add_u32 m0, s28, 66560
  s_add_u32 s27, s27, 32768
  buffer_load_dwordx4 v20, s[68:71], s27 offen lds
  s_add_u32 m0, s28, 67584
  s_add_u32 s27, s27, 32768
  buffer_load_dwordx4 v21, s[68:71], s27 offen lds
  s_add_u32 m0, s28, 68608
  s_add_u32 s27, s27, 32768
  buffer_load_dwordx4 v21, s[68:71], s27 offen lds
  s_add_u32 m0, s28, 69632
  s_add_u32 s27, s27, 32768
  buffer_load_dwordx4 v20, s[68:71], s27 offen lds
  s_add_u32 m0, s28, 70656
  s_add_u32 s27, s27, 32768
  buffer_load_dwordx4 v20, s[68:71], s27 offen lds
  s_add_u32 m0, s28, 71680
  s_add_u32 s27, s27, 32768
  buffer_load_dwordx4 v21, s[68:71], s27 offen lds
  s_add_u32 m0, s28, 72704
  s_add_u32 s27, s27, 32768
  buffer_load_dwordx4 v21, s[68:71], s27 offen lds
  s_load_dwordx2 s[4:5], s[0:1], 112
  s_load_dwordx2 s[12:13], s[0:1], 104
  s_waitcnt vmcnt(16)
  s_barrier
  s_add_u32 s27, s26, 3145728
  s_add_u32 m0, s28, 98304
  s_nop 0
  buffer_load_dwordx4 v20, s[68:71], s27 offen lds
  s_add_u32 m0, s28, 99328
  s_add_u32 s27, s27, 32768
  buffer_load_dwordx4 v20, s[68:71], s27 offen lds
  s_add_u32 m0, s28, 100352
  s_add_u32 s27, s27, 32768
  buffer_load_dwordx4 v21, s[68:71], s27 offen lds
  s_add_u32 m0, s28, 101376
  s_add_u32 s27, s27, 32768
  buffer_load_dwordx4 v21, s[68:71], s27 offen lds
  s_add_u32 m0, s28, 102400
  s_add_u32 s27, s27, 32768
  buffer_load_dwordx4 v20, s[68:71], s27 offen lds
  s_add_u32 m0, s28, 103424
  s_add_u32 s27, s27, 32768
  buffer_load_dwordx4 v20, s[68:71], s27 offen lds
  s_add_u32 m0, s28, 104448
  s_add_u32 s27, s27, 32768
  buffer_load_dwordx4 v21, s[68:71], s27 offen lds
  s_add_u32 m0, s28, 105472
  s_add_u32 s27, s27, 32768
  buffer_load_dwordx4 v21, s[68:71], s27 offen lds
  ds_read_b64_tr_b16 a[0:1], v22 offset:0
  ds_read_b64_tr_b16 a[2:3], v22 offset:1024
  ds_read_b64_tr_b16 a[4:5], v22 offset:4096
  ds_read_b64_tr_b16 a[6:7], v22 offset:5120
  ds_read_b64_tr_b16 a[8:9], v22 offset:8192
  ds_read_b64_tr_b16 a[10:11], v22 offset:9216
  ds_read_b64_tr_b16 a[12:13], v22 offset:12288
  ds_read_b64_tr_b16 a[14:15], v22 offset:13312
  ds_read_b64_tr_b16 a[16:17], v22 offset:16384
  ds_read_b64_tr_b16 a[18:19], v22 offset:17408
  ds_read_b64_tr_b16 a[20:21], v22 offset:20480
  ds_read_b64_tr_b16 a[22:23], v22 offset:21504
  ds_read_b64_tr_b16 a[24:25], v22 offset:24576
  ds_read_b64_tr_b16 a[26:27], v22 offset:25600
  ds_read_b64_tr_b16 a[28:29], v22 offset:28672
  ds_read_b64_tr_b16 a[30:31], v22 offset:29696
  s_waitcnt lgkmcnt(0)
  s_waitcnt vmcnt(16)
  s_barrier
  s_add_u32 s27, s26, 0
  s_add_u32 m0, s28, 131072
  s_nop 0
  buffer_load_dwordx4 v20, s[8:11], s27 offen lds
  s_add_u32 m0, s28, 132096
  s_add_u32 s27, s27, 32768
  buffer_load_dwordx4 v20, s[8:11], s27 offen lds
  s_add_u32 m0, s28, 133120
  s_add_u32 s27, s27, 32768
  buffer_load_dwordx4 v21, s[8:11], s27 offen lds
  s_add_u32 m0, s28, 134144
  s_add_u32 s27, s27, 32768
  buffer_load_dwordx4 v21, s[8:11], s27 offen lds
  s_add_u32 m0, s28, 135168
  s_add_u32 s27, s27, 32768
  buffer_load_dwordx4 v20, s[8:11], s27 offen lds
  s_add_u32 m0, s28, 136192
  s_add_u32 s27, s27, 32768
  buffer_load_dwordx4 v20, s[8:11], s27 offen lds
  s_add_u32 m0, s28, 137216
  s_add_u32 s27, s27, 32768
  buffer_load_dwordx4 v21, s[8:11], s27 offen lds
  s_add_u32 m0, s28, 138240
  s_add_u32 s27, s27, 32768
  buffer_load_dwordx4 v21, s[8:11], s27 offen lds
  ds_read_b64_tr_b16 a[32:33], v22 offset:32768
  ds_read_b64_tr_b16 a[34:35], v22 offset:33792
  ds_read_b64_tr_b16 a[36:37], v22 offset:36864
  ds_read_b64_tr_b16 a[38:39], v22 offset:37888
  ds_read_b64_tr_b16 a[40:41], v22 offset:40960
  ds_read_b64_tr_b16 a[42:43], v22 offset:41984
  ds_read_b64_tr_b16 a[44:45], v22 offset:45056
  ds_read_b64_tr_b16 a[46:47], v22 offset:46080
  ds_read_b64_tr_b16 a[48:49], v22 offset:49152
  ds_read_b64_tr_b16 a[50:51], v22 offset:50176
  ds_read_b64_tr_b16 a[52:53], v22 offset:53248
  ds_read_b64_tr_b16 a[54:55], v22 offset:54272
  ds_read_b64_tr_b16 a[56:57], v22 offset:57344
  ds_read_b64_tr_b16 a[58:59], v22 offset:58368
  ds_read_b64_tr_b16 a[60:61], v22 offset:61440
  ds_read_b64_tr_b16 a[62:63], v22 offset:62464
  s_waitcnt lgkmcnt(0)
  s_waitcnt vmcnt(16)
  s_barrier
  s_add_u32 s27, s26, 1048576
  s_add_u32 m0, s28, 0
  s_nop 0
  buffer_load_dwordx4 v20, s[8:11], s27 offen lds
  s_add_u32 m0, s28, 1024
  s_add_u32 s27, s27, 32768
  buffer_load_dwordx4 v20, s[8:11], s27 offen lds
  s_add_u32 m0, s28, 2048
  s_add_u32 s27, s27, 32768
  buffer_load_dwordx4 v21, s[8:11], s27 offen lds
  s_add_u32 m0, s28, 3072
  s_add_u32 s27, s27, 32768
  buffer_load_dwordx4 v21, s[8:11], s27 offen lds
  s_add_u32 m0, s28, 4096
  s_add_u32 s27, s27, 32768
  buffer_load_dwordx4 v20, s[8:11], s27 offen lds
  s_add_u32 m0, s28, 5120
  s_add_u32 s27, s27, 32768
  buffer_load_dwordx4 v20, s[8:11], s27 offen lds
  s_add_u32 m0, s28, 6144
  s_add_u32 s27, s27, 32768
  buffer_load_dwordx4 v21, s[8:11], s27 offen lds
  s_add_u32 m0, s28, 7168
  s_add_u32 s27, s27, 32768
  buffer_load_dwordx4 v21, s[8:11], s27 offen lds
  ds_read_b64_tr_b16 a[64:65], v23 offset:0
  ds_read_b64_tr_b16 a[66:67], v23 offset:1024
  ds_read_b64_tr_b16 a[68:69], v23 offset:4096
  ds_read_b64_tr_b16 a[70:71], v23 offset:5120
  ds_read_b64_tr_b16 a[72:73], v23 offset:8192
  ds_read_b64_tr_b16 a[74:75], v23 offset:9216
  ds_read_b64_tr_b16 a[76:77], v23 offset:12288
  ds_read_b64_tr_b16 a[78:79], v23 offset:13312
  ds_read_b64_tr_b16 a[80:81], v23 offset:16384
  ds_read_b64_tr_b16 a[82:83], v23 offset:17408
  ds_read_b64_tr_b16 a[84:85], v23 offset:20480
  ds_read_b64_tr_b16 a[86:87], v23 offset:21504
  ds_read_b64_tr_b16 a[88:89], v23 offset:24576
  ds_read_b64_tr_b16 a[90:91], v23 offset:25600
  ds_read_b64_tr_b16 a[92:93], v23 offset:28672
  ds_read_b64_tr_b16 a[94:95], v23 offset:29696
  s_waitcnt lgkmcnt(0)
  s_waitcnt vmcnt(16)
  s_barrier
  s_add_u32 s27, s26, 2097152
  s_add_u32 m0, s28, 32768
  s_nop 0
  buffer_load_dwordx4 v20, s[8:11], s27 offen lds
  s_add_u32 m0, s28, 33792
  s_add_u32 s27, s27, 32768
  buffer_load_dwordx4 v20, s[8:11], s27 offen lds
  s_add_u32 m0, s28, 34816
  s_add_u32 s27, s27, 32768
  buffer_load_dwordx4 v21, s[8:11], s27 offen lds
  s_add_u32 m0, s28, 35840
  s_add_u32 s27, s27, 32768
  buffer_load_dwordx4 v21, s[8:11], s27 offen lds
  s_add_u32 m0, s28, 36864
  s_add_u32 s27, s27, 32768
  buffer_load_dwordx4 v20, s[8:11], s27 offen lds
  s_add_u32 m0, s28, 37888
  s_add_u32 s27, s27, 32768
  buffer_load_dwordx4 v20, s[8:11], s27 offen lds
  s_add_u32 m0, s28, 38912
  s_add_u32 s27, s27, 32768
  buffer_load_dwordx4 v21, s[8:11], s27 offen lds
  s_add_u32 m0, s28, 39936
  s_add_u32 s27, s27, 32768
  buffer_load_dwordx4 v21, s[8:11], s27 offen lds
  ds_read_b64_tr_b16 a[96:97], v23 offset:32768
  ds_read_b64_tr_b16 a[98:99], v23 offset:33792
  ds_read_b64_tr_b16 a[100:101], v23 offset:36864
  ds_read_b64_tr_b16 a[102:103], v23 offset:37888
  ds_read_b64_tr_b16 a[104:105], v23 offset:40960
  ds_read_b64_tr_b16 a[106:107], v23 offset:41984
  ds_read_b64_tr_b16 a[108:109], v23 offset:45056
  ds_read_b64_tr_b16 a[110:111], v23 offset:46080
  ds_read_b64_tr_b16 a[112:113], v23 offset:49152
  ds_read_b64_tr_b16 a[114:115], v23 offset:50176
  ds_read_b64_tr_b16 a[116:117], v23 offset:53248
  ds_read_b64_tr_b16 a[118:119], v23 offset:54272
  ds_read_b64_tr_b16 a[120:121], v23 offset:57344
  ds_read_b64_tr_b16 a[122:123], v23 offset:58368
  ds_read_b64_tr_b16 a[124:125], v23 offset:61440
  ds_read_b64_tr_b16 a[126:127], v23 offset:62464
  s_waitcnt lgkmcnt(0)
  s_waitcnt vmcnt(16)
  s_barrier
  s_add_u32 s27, s26, 3145728
  s_add_u32 m0, s28, 65536
  s_nop 0
  buffer_load_dwordx4 v20, s[8:11], s27 offen lds
  s_add_u32 m0, s28, 66560
  s_add_u32 s27, s27, 32768
  buffer_load_dwordx4 v20, s[8:11], s27 offen lds
  s_add_u32 m0, s28, 67584
  s_add_u32 s27, s27, 32768
  buffer_load_dwordx4 v21, s[8:11], s27 offen lds
  s_add_u32 m0, s28, 68608
  s_add_u32 s27, s27, 32768
  buffer_load_dwordx4 v21, s[8:11], s27 offen lds
  s_add_u32 m0, s28, 69632
  s_add_u32 s27, s27, 32768
  buffer_load_dwordx4 v20, s[8:11], s27 offen lds
  s_add_u32 m0, s28, 70656
  s_add_u32 s27, s27, 32768
  buffer_load_dwordx4 v20, s[8:11], s27 offen lds
  s_add_u32 m0, s28, 71680
  s_add_u32 s27, s27, 32768
  buffer_load_dwordx4 v21, s[8:11], s27 offen lds
  s_add_u32 m0, s28, 72704
  s_add_u32 s27, s27, 32768
  buffer_load_dwordx4 v21, s[8:11], s27 offen lds
  ds_read_b64_tr_b16 a[128:129], v24 offset:0
  ds_read_b64_tr_b16 a[130:131], v24 offset:1024
  ds_read_b64_tr_b16 a[132:133], v24 offset:4096
  ds_read_b64_tr_b16 a[134:135], v24 offset:5120
  ds_read_b64_tr_b16 a[136:137], v24 offset:8192
  ds_read_b64_tr_b16 a[138:139], v24 offset:9216
  ds_read_b64_tr_b16 a[140:141], v24 offset:12288
  ds_read_b64_tr_b16 a[142:143], v24 offset:13312
  ds_read_b64_tr_b16 a[144:145], v24 offset:16384
  ds_read_b64_tr_b16 a[146:147], v24 offset:17408
  ds_read_b64_tr_b16 a[148:149], v24 offset:20480
  ds_read_b64_tr_b16 a[150:151], v24 offset:21504
  ds_read_b64_tr_b16 a[152:153], v24 offset:24576
  ds_read_b64_tr_b16 a[154:155], v24 offset:25600
  ds_read_b64_tr_b16 a[156:157], v24 offset:28672
  ds_read_b64_tr_b16 a[158:159], v24 offset:29696
  s_waitcnt lgkmcnt(0)
  s_waitcnt vmcnt(16)
  s_barrier
  s_add_u32 s27, s26, 0
  s_add_u32 m0, s28, 98304
  s_nop 0
  buffer_load_dwordx4 v20, s[64:67], s27 offen lds
  s_add_u32 m0, s28, 99328
  s_add_u32 s27, s27, 32768
  buffer_load_dwordx4 v20, s[64:67], s27 offen lds
  s_add_u32 m0, s28, 100352
  s_add_u32 s27, s27, 32768
  buffer_load_dwordx4 v21, s[64:67], s27 offen lds
  s_add_u32 m0, s28, 101376
  s_add_u32 s27, s27, 32768
  buffer_load_dwordx4 v21, s[64:67], s27 offen lds
  s_add_u32 m0, s28, 102400
  s_add_u32 s27, s27, 32768
  buffer_load_dwordx4 v20, s[64:67], s27 offen lds
  s_add_u32 m0, s28, 103424
  s_add_u32 s27, s27, 32768
  buffer_load_dwordx4 v20, s[64:67], s27 offen lds
  s_add_u32 m0, s28, 104448
  s_add_u32 s27, s27, 32768
  buffer_load_dwordx4 v21, s[64:67], s27 offen lds
  s_add_u32 m0, s28, 105472
  s_add_u32 s27, s27, 32768
  buffer_load_dwordx4 v21, s[64:67], s27 offen lds
  ds_read_b64_tr_b16 a[160:161], v22 offset:0
  ds_read_b64_tr_b16 a[162:163], v22 offset:1024
  ds_read_b64_tr_b16 a[164:165], v22 offset:4096
  ds_read_b64_tr_b16 a[166:167], v22 offset:5120
  ds_read_b64_tr_b16 a[168:169], v22 offset:8192
  ds_read_b64_tr_b16 a[170:171], v22 offset:9216
  ds_read_b64_tr_b16 a[172:173], v22 offset:12288
  ds_read_b64_tr_b16 a[174:175], v22 offset:13312
  ds_read_b64_tr_b16 a[176:177], v22 offset:16384
  ds_read_b64_tr_b16 a[178:179], v22 offset:17408
  ds_read_b64_tr_b16 a[180:181], v22 offset:20480
  ds_read_b64_tr_b16 a[182:183], v22 offset:21504
  ds_read_b64_tr_b16 a[184:185], v22 offset:24576
  ds_read_b64_tr_b16 a[186:187], v22 offset:25600
  ds_read_b64_tr_b16 a[188:189], v22 offset:28672
  ds_read_b64_tr_b16 a[190:191], v22 offset:29696
  s_waitcnt lgkmcnt(0)
  s_waitcnt vmcnt(16)
  s_barrier
  s_add_u32 s27, s26, 1048576
  s_add_u32 m0, s28, 131072
  s_nop 0
  buffer_load_dwordx4 v20, s[64:67], s27 offen lds
  s_add_u32 m0, s28, 132096
  s_add_u32 s27, s27, 32768
  buffer_load_dwordx4 v20, s[64:67], s27 offen lds
  s_add_u32 m0, s28, 133120
  s_add_u32 s27, s27, 32768
  buffer_load_dwordx4 v21, s[64:67], s27 offen lds
  s_add_u32 m0, s28, 134144
  s_add_u32 s27, s27, 32768
  buffer_load_dwordx4 v21, s[64:67], s27 offen lds
  s_add_u32 m0, s28, 135168
  s_add_u32 s27, s27, 32768
  buffer_load_dwordx4 v20, s[64:67], s27 offen lds
  s_add_u32 m0, s28, 136192
  s_add_u32 s27, s27, 32768
  buffer_load_dwordx4 v20, s[64:67], s27 offen lds
  s_add_u32 m0, s28, 137216
  s_add_u32 s27, s27, 32768
  buffer_load_dwordx4 v21, s[64:67], s27 offen lds
  s_add_u32 m0, s28, 138240
  s_add_u32 s27, s27, 32768
  buffer_load_dwordx4 v21, s[64:67], s27 offen lds
  ds_read_b64_tr_b16 a[192:193], v22 offset:32768
  ds_read_b64_tr_b16 a[194:195], v22 offset:33792
  ds_read_b64_tr_b16 a[196:197], v22 offset:36864
  ds_read_b64_tr_b16 a[198:199], v22 offset:37888
  ds_read_b64_tr_b16 a[200:201], v22 offset:40960
  ds_read_b64_tr_b16 a[202:203], v22 offset:41984
  ds_read_b64_tr_b16 a[204:205], v22 offset:45056
  ds_read_b64_tr_b16 a[206:207], v22 offset:46080
  ds_read_b64_tr_b16 a[208:209], v22 offset:49152
  ds_read_b64_tr_b16 a[210:211], v22 offset:50176
  ds_read_b64_tr_b16 a[212:213], v22 offset:53248
  ds_read_b64_tr_b16 a[214:215], v22 offset:54272
  ds_read_b64_tr_b16 a[216:217], v22 offset:57344
  ds_read_b64_tr_b16 a[218:219], v22 offset:58368
  ds_read_b64_tr_b16 a[220:221], v22 offset:61440
  ds_read_b64_tr_b16 a[222:223], v22 offset:62464
  s_waitcnt lgkmcnt(0)
  s_waitcnt vmcnt(16)
  s_barrier
  s_add_u32 s27, s26, 2097152
  s_add_u32 m0, s28, 0
  s_nop 0
  buffer_load_dwordx4 v20, s[64:67], s27 offen lds
  s_add_u32 m0, s28, 1024
  s_add_u32 s27, s27, 32768
  buffer_load_dwordx4 v20, s[64:67], s27 offen lds
  s_add_u32 m0, s28, 2048
  s_add_u32 s27, s27, 32768
  buffer_load_dwordx4 v21, s[64:67], s27 offen lds
  s_add_u32 m0, s28, 3072
  s_add_u32 s27, s27, 32768
  buffer_load_dwordx4 v21, s[64:67], s27 offen lds
  s_add_u32 m0, s28, 4096
  s_add_u32 s27, s27, 32768
  buffer_load_dwordx4 v20, s[64:67], s27 offen lds
  s_add_u32 m0, s28, 5120
  s_add_u32 s27, s27, 32768
  buffer_load_dwordx4 v20, s[64:67], s27 offen lds
  s_add_u32 m0, s28, 6144
  s_add_u32 s27, s27, 32768
  buffer_load_dwordx4 v21, s[64:67], s27 offen lds
  s_add_u32 m0, s28, 7168
  s_add_u32 s27, s27, 32768
  buffer_load_dwordx4 v21, s[64:67], s27 offen lds
  ds_read_b64_tr_b16 a[224:225], v23 offset:0
  ds_read_b64_tr_b16 a[226:227], v23 offset:1024
  ds_read_b64_tr_b16 a[228:229], v23 offset:4096
  ds_read_b64_tr_b16 a[230:231], v23 offset:5120
  ds_read_b64_tr_b16 a[232:233], v23 offset:8192
  ds_read_b64_tr_b16 a[234:235], v23 offset:9216
  ds_read_b64_tr_b16 a[236:237], v23 offset:12288
  ds_read_b64_tr_b16 a[238:239], v23 offset:13312
  ds_read_b64_tr_b16 a[240:241], v23 offset:16384
  ds_read_b64_tr_b16 a[242:243], v23 offset:17408
  ds_read_b64_tr_b16 a[244:245], v23 offset:20480
  ds_read_b64_tr_b16 a[246:247], v23 offset:21504
  ds_read_b64_tr_b16 a[248:249], v23 offset:24576
  ds_read_b64_tr_b16 a[250:251], v23 offset:25600
  ds_read_b64_tr_b16 a[252:253], v23 offset:28672
  ds_read_b64_tr_b16 a[254:255], v23 offset:29696
  s_waitcnt lgkmcnt(0)
  s_waitcnt vmcnt(16)
  s_barrier
  s_add_u32 s27, s26, 3145728
  s_add_u32 m0, s28, 32768
  s_nop 0
  buffer_load_dwordx4 v20, s[64:67], s27 offen lds
  s_add_u32 m0, s28, 33792
  s_add_u32 s27, s27, 32768
  buffer_load_dwordx4 v20, s[64:67], s27 offen lds
  s_add_u32 m0, s28, 34816
  s_add_u32 s27, s27, 32768
  buffer_load_dwordx4 v21, s[64:67], s27 offen lds
  s_add_u32 m0, s28, 35840
  s_add_u32 s27, s27, 32768
  buffer_load_dwordx4 v21, s[64:67], s27 offen lds
  s_add_u32 m0, s28, 36864
  s_add_u32 s27, s27, 32768
  buffer_load_dwordx4 v20, s[64:67], s27 offen lds
  s_add_u32 m0, s28, 37888
  s_add_u32 s27, s27, 32768
  buffer_load_dwordx4 v20, s[64:67], s27 offen lds
  s_add_u32 m0, s28, 38912
  s_add_u32 s27, s27, 32768
  buffer_load_dwordx4 v21, s[64:67], s27 offen lds
  s_add_u32 m0, s28, 39936
  s_add_u32 s27, s27, 32768
  buffer_load_dwordx4 v21, s[64:67], s27 offen lds
  ds_read_b64_tr_b16 v[128:129], v23 offset:32768
  ds_read_b64_tr_b16 v[130:131], v23 offset:33792
  ds_read_b64_tr_b16 v[132:133], v23 offset:36864
  ds_read_b64_tr_b16 v[134:135], v23 offset:37888
  ds_read_b64_tr_b16 v[136:137], v23 offset:40960
  ds_read_b64_tr_b16 v[138:139], v23 offset:41984
  ds_read_b64_tr_b16 v[140:141], v23 offset:45056
  ds_read_b64_tr_b16 v[142:143], v23 offset:46080
  ds_read_b64_tr_b16 v[144:145], v23 offset:49152
  ds_read_b64_tr_b16 v[146:147], v23 offset:50176
  ds_read_b64_tr_b16 v[148:149], v23 offset:53248
  ds_read_b64_tr_b16 v[150:151], v23 offset:54272
  ds_read_b64_tr_b16 v[152:153], v23 offset:57344
  ds_read_b64_tr_b16 v[154:155], v23 offset:58368
  ds_read_b64_tr_b16 v[156:157], v23 offset:61440
  ds_read_b64_tr_b16 v[158:159], v23 offset:62464
  s_waitcnt lgkmcnt(0)
  s_waitcnt vmcnt(16)
  s_barrier
  ds_read_b64_tr_b16 v[160:161], v24 offset:0
  ds_read_b64_tr_b16 v[162:163], v24 offset:1024
  ds_read_b64_tr_b16 v[164:165], v24 offset:4096
  ds_read_b64_tr_b16 v[166:167], v24 offset:5120
  ds_read_b64_tr_b16 v[168:169], v24 offset:8192
  ds_read_b64_tr_b16 v[170:171], v24 offset:9216
  ds_read_b64_tr_b16 v[172:173], v24 offset:12288
  ds_read_b64_tr_b16 v[174:175], v24 offset:13312
  ds_read_b64_tr_b16 v[176:177], v24 offset:16384
  ds_read_b64_tr_b16 v[178:179], v24 offset:17408
  ds_read_b64_tr_b16 v[180:181], v24 offset:20480
  ds_read_b64_tr_b16 v[182:183], v24 offset:21504
  ds_read_b64_tr_b16 v[184:185], v24 offset:24576
  ds_read_b64_tr_b16 v[186:187], v24 offset:25600
  ds_read_b64_tr_b16 v[188:189], v24 offset:28672
  ds_read_b64_tr_b16 v[190:191], v24 offset:29696
  s_waitcnt lgkmcnt(0)
  s_waitcnt vmcnt(8)
  s_barrier
  ds_read_b64_tr_b16 v[192:193], v22 offset:0
  ds_read_b64_tr_b16 v[194:195], v22 offset:1024
  ds_read_b64_tr_b16 v[196:197], v22 offset:4096
  ds_read_b64_tr_b16 v[198:199], v22 offset:5120
  ds_read_b64_tr_b16 v[200:201], v22 offset:8192
  ds_read_b64_tr_b16 v[202:203], v22 offset:9216
  ds_read_b64_tr_b16 v[204:205], v22 offset:12288
  ds_read_b64_tr_b16 v[206:207], v22 offset:13312
  ds_read_b64_tr_b16 v[208:209], v22 offset:16384
  ds_read_b64_tr_b16 v[210:211], v22 offset:17408
  ds_read_b64_tr_b16 v[212:213], v22 offset:20480
  ds_read_b64_tr_b16 v[214:215], v22 offset:21504
  ds_read_b64_tr_b16 v[216:217], v22 offset:24576
  ds_read_b64_tr_b16 v[218:219], v22 offset:25600
  ds_read_b64_tr_b16 v[220:221], v22 offset:28672
  ds_read_b64_tr_b16 v[222:223], v22 offset:29696
  s_waitcnt lgkmcnt(0)
  s_waitcnt vmcnt(0)
  s_barrier
  ds_read_b64_tr_b16 v[224:225], v22 offset:32768
  ds_read_b64_tr_b16 v[226:227], v22 offset:33792
  ds_read_b64_tr_b16 v[228:229], v22 offset:36864
  ds_read_b64_tr_b16 v[230:231], v22 offset:37888
  ds_read_b64_tr_b16 v[232:233], v22 offset:40960
  ds_read_b64_tr_b16 v[234:235], v22 offset:41984
  ds_read_b64_tr_b16 v[236:237], v22 offset:45056
  ds_read_b64_tr_b16 v[238:239], v22 offset:46080
  ds_read_b64_tr_b16 v[240:241], v22 offset:49152
  ds_read_b64_tr_b16 v[242:243], v22 offset:50176
  ds_read_b64_tr_b16 v[244:245], v22 offset:53248
  ds_read_b64_tr_b16 v[246:247], v22 offset:54272
  ds_read_b64_tr_b16 v[248:249], v22 offset:57344
  ds_read_b64_tr_b16 v[250:251], v22 offset:58368
  ds_read_b64_tr_b16 v[252:253], v22 offset:61440
  ds_read_b64_tr_b16 v[254:255], v22 offset:62464
  s_waitcnt lgkmcnt(0)
  s_branch q_ld_84
q_ld_83:
  s_add_u32 s27, s26, 0
  s_add_u32 m0, s28, 0
  s_nop 0
  buffer_load_dwordx4 v20, s[8:11], s27 offen lds
  s_add_u32 m0, s28, 1024
  s_add_u32 s27, s27, 32768
  buffer_load_dwordx4 v20, s[8:11], s27 offen lds
  s_add_u32 m0, s28, 2048
  s_add_u32 s27, s27, 32768
  buffer_load_dwordx4 v21, s[8:11], s27 offen lds
  s_add_u32 m0, s28, 3072
  s_add_u32 s27, s27, 32768
  buffer_load_dwordx4 v21, s[8:11], s27 offen lds
  s_add_u32 m0, s28, 4096
  s_add_u32 s27, s27, 32768
  buffer_load_dwordx4 v20, s[8:11], s27 offen lds
  s_add_u32 m0, s28, 5120
  s_add_u32 s27, s27, 32768
  buffer_load_dwordx4 v20, s[8:11], s27 offen lds
  s_add_u32 m0, s28, 6144
  s_add_u32 s27, s27, 32768
  buffer_load_dwordx4 v21, s[8:11], s27 offen lds
  s_add_u32 m0, s28, 7168
  s_add_u32 s27, s27, 32768
  buffer_load_dwordx4 v21, s[8:11], s27 offen lds
  s_add_u32 s27, s26, 1048576
  s_add_u32 m0, s28, 32768
  s_nop 0
  buffer_load_dwordx4 v20, s[8:11], s27 offen lds
  s_add_u32 m0, s28, 33792
  s_add_u32 s27, s27, 32768
  buffer_load_dwordx4 v20, s[8:11], s27 offen lds
  s_add_u32 m0, s28, 34816
  s_add_u32 s27, s27, 32768
  buffer_load_dwordx4 v21, s[8:11], s27 offen lds
  s_add_u32 m0, s28, 35840
  s_add_u32 s27, s27, 32768
  buffer_load_dwordx4 v21, s[8:11], s27 offen lds
  s_add_u32 m0, s28, 36864
  s_add_u32 s27, s27, 32768
  buffer_load_dwordx4 v20, s[8:11], s27 offen lds
  s_add_u32 m0, s28, 37888
  s_add_u32 s27, s27, 32768
  buffer_load_dwordx4 v20, s[8:11], s27 offen lds
  s_add_u32 m0, s28, 38912
  s_add_u32 s27, s27, 32768
  buffer_load_dwordx4 v21, s[8:11], s27 offen lds
  s_add_u32 m0, s28, 39936
  s_add_u32 s27, s27, 32768
  buffer_load_dwordx4 v21, s[8:11], s27 offen lds
  s_add_u32 s27, s26, 2097152
  s_add_u32 m0, s28, 65536
  s_nop 0
  buffer_load_dwordx4 v20, s[8:11], s27 offen lds
  s_add_u32 m0, s28, 66560
  s_add_u32 s27, s27, 32768
  buffer_load_dwordx4 v20, s[8:11], s27 offen lds
  s_add_u32 m0, s28, 67584
  s_add_u32 s27, s27, 32768
  buffer_load_dwordx4 v21, s[8:11], s27 offen lds
  s_add_u32 m0, s28, 68608
  s_add_u32 s27, s27, 32768
  buffer_load_dwordx4 v21, s[8:11], s27 offen lds
  s_add_u32 m0, s28, 69632
  s_add_u32 s27, s27, 32768
  buffer_load_dwordx4 v20, s[8:11], s27 offen lds
  s_add_u32 m0, s28, 70656
  s_add_u32 s27, s27, 32768
  buffer_load_dwordx4 v20, s[8:11], s27 offen lds
  s_add_u32 m0, s28, 71680
  s_add_u32 s27, s27, 32768
  buffer_load_dwordx4 v21, s[8:11], s27 offen lds
  s_add_u32 m0, s28, 72704
  s_add_u32 s27, s27, 32768
  buffer_load_dwordx4 v21, s[8:11], s27 offen lds
  s_load_dwordx2 s[4:5], s[0:1], 112
  s_load_dwordx2 s[12:13], s[0:1], 104
  s_waitcnt vmcnt(16)
  s_barrier
  s_add_u32 s27, s26, 3145728
  s_add_u32 m0, s28, 98304
  s_nop 0
  buffer_load_dwordx4 v20, s[8:11], s27 offen lds
  s_add_u32 m0, s28, 99328
  s_add_u32 s27, s27, 32768
  buffer_load_dwordx4 v20, s[8:11], s27 offen lds
  s_add_u32 m0, s28, 100352
  s_add_u32 s27, s27, 32768
  buffer_load_dwordx4 v21, s[8:11], s27 offen lds
  s_add_u32 m0, s28, 101376
  s_add_u32 s27, s27, 32768
  buffer_load_dwordx4 v21, s[8:11], s27 offen lds
  s_add_u32 m0, s28, 102400
  s_add_u32 s27, s27, 32768
  buffer_load_dwordx4 v20, s[8:11], s27 offen lds
  s_add_u32 m0, s28, 103424
  s_add_u32 s27, s27, 32768
  buffer_load_dwordx4 v20, s[8:11], s27 offen lds
  s_add_u32 m0, s28, 104448
  s_add_u32 s27, s27, 32768
  buffer_load_dwordx4 v21, s[8:11], s27 offen lds
  s_add_u32 m0, s28, 105472
  s_add_u32 s27, s27, 32768
  buffer_load_dwordx4 v21, s[8:11], s27 offen lds
  ds_read_b64_tr_b16 a[128:129], v22 offset:0
  ds_read_b64_tr_b16 a[130:131], v22 offset:1024
  ds_read_b64_tr_b16 a[132:133], v22 offset:4096
  ds_read_b64_tr_b16 a[134:135], v22 offset:5120
  ds_read_b64_tr_b16 a[136:137], v22 offset:8192
  ds_read_b64_tr_b16 a[138:139], v22 offset:9216
  ds_read_b64_tr_b16 a[140:141], v22 offset:12288
  ds_read_b64_tr_b16 a[142:143], v22 offset:13312
  ds_read_b64_tr_b16 a[144:145], v22 offset:16384
  ds_read_b64_tr_b16 a[146:147], v22 offset:17408
  ds_read_b64_tr_b16 a[148:149], v22 offset:20480
  ds_read_b64_tr_b16 a[150:151], v22 offset:21504
  ds_read_b64_tr_b16 a[152:153], v22 offset:24576
  ds_read_b64_tr_b16 a[154:155], v22 offset:25600
  ds_read_b64_tr_b16 a[156:157], v22 offset:28672
  ds_read_b64_tr_b16 a[158:159], v22 offset:29696
  s_waitcnt lgkmcnt(0)
  s_waitcnt vmcnt(16)
  s_barrier
  s_add_u32 s27, s26, 0
  s_add_u32 m0, s28, 131072
  s_nop 0
  buffer_load_dwordx4 v20, s[64:67], s27 offen lds
  s_add_u32 m0, s28, 132096
  s_add_u32 s27, s27, 32768
  buffer_load_dwordx4 v20, s[64:67], s27 offen lds
  s_add_u32 m0, s28, 133120
  s_add_u32 s27, s27, 32768
  buffer_load_dwordx4 v21, s[64:67], s27 offen lds
  s_add_u32 m0, s28, 134144
  s_add_u32 s27, s27, 32768
  buffer_load_dwordx4 v21, s[64:67], s27 offen lds
  s_add_u32 m0, s28, 135168
  s_add_u32 s27, s27, 32768
  buffer_load_dwordx4 v20, s[64:67], s27 offen lds
  s_add_u32 m0, s28, 136192
  s_add_u32 s27, s27, 32768
  buffer_load_dwordx4 v20, s[64:67], s27 offen lds
  s_add_u32 m0, s28, 137216
  s_add_u32 s27, s27, 32768
  buffer_load_dwordx4 v21, s[64:67], s27 offen lds
  s_add_u32 m0, s28, 138240
  s_add_u32 s27, s27, 32768
  buffer_load_dwordx4 v21, s[64:67], s27 offen lds
  ds_read_b64_tr_b16 a[160:161], v22 offset:32768
  ds_read_b64_tr_b16 a[162:163], v22 offset:33792
  ds_read_b64_tr_b16 a[164:165], v22 offset:36864
  ds_read_b64_tr_b16 a[166:167], v22 offset:37888
  ds_read_b64_tr_b16 a[168:169], v22 offset:40960
  ds_read_b64_tr_b16 a[170:171], v22 offset:41984
  ds_read_b64_tr_b16 a[172:173], v22 offset:45056
  ds_read_b64_tr_b16 a[174:175], v22 offset:46080
  ds_read_b64_tr_b16 a[176:177], v22 offset:49152
  ds_read_b64_tr_b16 a[178:179], v22 offset:50176
  ds_read_b64_tr_b16 a[180:181], v22 offset:53248
  ds_read_b64_tr_b16 a[182:183], v22 offset:54272
  ds_read_b64_tr_b16 a[184:185], v22 offset:57344
  ds_read_b64_tr_b16 a[186:187], v22 offset:58368
  ds_read_b64_tr_b16 a[188:189], v22 offset:61440
  ds_read_b64_tr_b16 a[190:191], v22 offset:62464
  s_waitcnt lgkmcnt(0)
  s_waitcnt vmcnt(16)
  s_barrier
  s_add_u32 s27, s26, 1048576
  s_add_u32 m0, s28, 0
  s_nop 0
  buffer_load_dwordx4 v20, s[64:67], s27 offen lds
  s_add_u32 m0, s28, 1024
  s_add_u32 s27, s27, 32768
  buffer_load_dwordx4 v20, s[64:67], s27 offen lds
  s_add_u32 m0, s28, 2048
  s_add_u32 s27, s27, 32768
  buffer_load_dwordx4 v21, s[64:67], s27 offen lds
  s_add_u32 m0, s28, 3072
  s_add_u32 s27, s27, 32768
  buffer_load_dwordx4 v21, s[64:67], s27 offen lds
  s_add_u32 m0, s28, 4096
  s_add_u32 s27, s27, 32768
  buffer_load_dwordx4 v20, s[64:67], s27 offen lds
  s_add_u32 m0, s28, 5120
  s_add_u32 s27, s27, 32768
  buffer_load_dwordx4 v20, s[64:67], s27 offen lds
  s_add_u32 m0, s28, 6144
  s_add_u32 s27, s27, 32768
  buffer_load_dwordx4 v21, s[64:67], s27 offen lds
  s_add_u32 m0, s28, 7168
  s_add_u32 s27, s27, 32768
  buffer_load_dwordx4 v21, s[64:67], s27 offen lds
  ds_read_b64_tr_b16 a[192:193], v23 offset:0
  ds_read_b64_tr_b16 a[194:195], v23 offset:1024
  ds_read_b64_tr_b16 a[196:197], v23 offset:4096
  ds_read_b64_tr_b16 a[198:199], v23 offset:5120
  ds_read_b64_tr_b16 a[200:201], v23 offset:8192
  ds_read_b64_tr_b16 a[202:203], v23 offset:9216
  ds_read_b64_tr_b16 a[204:205], v23 offset:12288
  ds_read_b64_tr_b16 a[206:207], v23 offset:13312
  ds_read_b64_tr_b16 a[208:209], v23 offset:16384
  ds_read_b64_tr_b16 a[210:211], v23 offset:17408
  ds_read_b64_tr_b16 a[212:213], v23 offset:20480
  ds_read_b64_tr_b16 a[214:215], v23 offset:21504
  ds_read_b64_tr_b16 a[216:217], v23 offset:24576
  ds_read_b64_tr_b16 a[218:219], v23 offset:25600
  ds_read_b64_tr_b16 a[220:221], v23 offset:28672
  ds_read_b64_tr_b16 a[222:223], v23 offset:29696
  s_waitcnt lgkmcnt(0)
  s_waitcnt vmcnt(16)
  s_barrier
  s_add_u32 s27, s26, 2097152
  s_add_u32 m0, s28, 32768
  s_nop 0
  buffer_load_dwordx4 v20, s[64:67], s27 offen lds
  s_add_u32 m0, s28, 33792
  s_add_u32 s27, s27, 32768
  buffer_load_dwordx4 v20, s[64:67], s27 offen lds
  s_add_u32 m0, s28, 34816
  s_add_u32 s27, s27, 32768
  buffer_load_dwordx4 v21, s[64:67], s27 offen lds
  s_add_u32 m0, s28, 35840
  s_add_u32 s27, s27, 32768
  buffer_load_dwordx4 v21, s[64:67], s27 offen lds
  s_add_u32 m0, s28, 36864
  s_add_u32 s27, s27, 32768
  buffer_load_dwordx4 v20, s[64:67], s27 offen lds
  s_add_u32 m0, s28, 37888
  s_add_u32 s27, s27, 32768
  buffer_load_dwordx4 v20, s[64:67], s27 offen lds
  s_add_u32 m0, s28, 38912
  s_add_u32 s27, s27, 32768
  buffer_load_dwordx4 v21, s[64:67], s27 offen lds
  s_add_u32 m0, s28, 39936
  s_add_u32 s27, s27, 32768
  buffer_load_dwordx4 v21, s[64:67], s27 offen lds
  ds_read_b64_tr_b16 a[224:225], v23 offset:32768
  ds_read_b64_tr_b16 a[226:227], v23 offset:33792
  ds_read_b64_tr_b16 a[228:229], v23 offset:36864
  ds_read_b64_tr_b16 a[230:231], v23 offset:37888
  ds_read_b64_tr_b16 a[232:233], v23 offset:40960
  ds_read_b64_tr_b16 a[234:235], v23 offset:41984
  ds_read_b64_tr_b16 a[236:237], v23 offset:45056
  ds_read_b64_tr_b16 a[238:239], v23 offset:46080
  ds_read_b64_tr_b16 a[240:241], v23 offset:49152
  ds_read_b64_tr_b16 a[242:243], v23 offset:50176
  ds_read_b64_tr_b16 a[244:245], v23 offset:53248
  ds_read_b64_tr_b16 a[246:247], v23 offset:54272
  ds_read_b64_tr_b16 a[248:249], v23 offset:57344
  ds_read_b64_tr_b16 a[250:251], v23 offset:58368
  ds_read_b64_tr_b16 a[252:253], v23 offset:61440
  ds_read_b64_tr_b16 a[254:255], v23 offset:62464
  s_waitcnt lgkmcnt(0)
  s_waitcnt vmcnt(16)
  s_barrier
  s_add_u32 s27, s26, 3145728
  s_add_u32 m0, s28, 65536
  s_nop 0
  buffer_load_dwordx4 v20, s[64:67], s27 offen lds
  s_add_u32 m0, s28, 66560
  s_add_u32 s27, s27, 32768
  buffer_load_dwordx4 v20, s[64:67], s27 offen lds
  s_add_u32 m0, s28, 67584
  s_add_u32 s27, s27, 32768
  buffer_load_dwordx4 v21, s[64:67], s27 offen lds
  s_add_u32 m0, s28, 68608
  s_add_u32 s27, s27, 32768
  buffer_load_dwordx4 v21, s[64:67], s27 offen lds
  s_add_u32 m0, s28, 69632
  s_add_u32 s27, s27, 32768
  buffer_load_dwordx4 v20, s[64:67], s27 offen lds
  s_add_u32 m0, s28, 70656
  s_add_u32 s27, s27, 32768
  buffer_load_dwordx4 v20, s[64:67], s27 offen lds
  s_add_u32 m0, s28, 71680
  s_add_u32 s27, s27, 32768
  buffer_load_dwordx4 v21, s[64:67], s27 offen lds
  s_add_u32 m0, s28, 72704
  s_add_u32 s27, s27, 32768
  buffer_load_dwordx4 v21, s[64:67], s27 offen lds
  ds_read_b64_tr_b16 v[128:129], v24 offset:0
  ds_read_b64_tr_b16 v[130:131], v24 offset:1024
  ds_read_b64_tr_b16 v[132:133], v24 offset:4096
  ds_read_b64_tr_b16 v[134:135], v24 offset:5120
  ds_read_b64_tr_b16 v[136:137], v24 offset:8192
  ds_read_b64_tr_b16 v[138:139], v24 offset:9216
  ds_read_b64_tr_b16 v[140:141], v24 offset:12288
  ds_read_b64_tr_b16 v[142:143], v24 offset:13312
  ds_read_b64_tr_b16 v[144:145], v24 offset:16384
  ds_read_b64_tr_b16 v[146:147], v24 offset:17408
  ds_read_b64_tr_b16 v[148:149], v24 offset:20480
  ds_read_b64_tr_b16 v[150:151], v24 offset:21504
  ds_read_b64_tr_b16 v[152:153], v24 offset:24576
  ds_read_b64_tr_b16 v[154:155], v24 offset:25600
  ds_read_b64_tr_b16 v[156:157], v24 offset:28672
  ds_read_b64_tr_b16 v[158:159], v24 offset:29696
  s_waitcnt lgkmcnt(0)
  s_waitcnt vmcnt(16)
  s_barrier
  s_add_u32 s27, s26, 0
  s_add_u32 m0, s28, 98304
  s_nop 0
  buffer_load_dwordx4 v20, s[68:71], s27 offen lds
  s_add_u32 m0, s28, 99328
  s_add_u32 s27, s27, 32768
  buffer_load_dwordx4 v20, s[68:71], s27 offen lds
  s_add_u32 m0, s28, 100352
  s_add_u32 s27, s27, 32768
  buffer_load_dwordx4 v21, s[68:71], s27 offen lds
  s_add_u32 m0, s28, 101376
  s_add_u32 s27, s27, 32768
  buffer_load_dwordx4 v21, s[68:71], s27 offen lds
  s_add_u32 m0, s28, 102400
  s_add_u32 s27, s27, 32768
  buffer_load_dwordx4 v20, s[68:71], s27 offen lds
  s_add_u32 m0, s28, 103424
  s_add_u32 s27, s27, 32768
  buffer_load_dwordx4 v20, s[68:71], s27 offen lds
  s_add_u32 m0, s28, 104448
  s_add_u32 s27, s27, 32768
  buffer_load_dwordx4 v21, s[68:71], s27 offen lds
  s_add_u32 m0, s28, 105472
  s_add_u32 s27, s27, 32768
  buffer_load_dwordx4 v21, s[68:71], s27 offen lds
  ds_read_b64_tr_b16 v[160:161], v22 offset:0
  ds_read_b64_tr_b16 v[162:163], v22 offset:1024
  ds_read_b64_tr_b16 v[164:165], v22 offset:4096
  ds_read_b64_tr_b16 v[166:167], v22 offset:5120
  ds_read_b64_tr_b16 v[168:169], v22 offset:8192
  ds_read_b64_tr_b16 v[170:171], v22 offset:9216
  ds_read_b64_tr_b16 v[172:173], v22 offset:12288
  ds_read_b64_tr_b16 v[174:175], v22 offset:13312
  ds_read_b64_tr_b16 v[176:177], v22 offset:16384
  ds_read_b64_tr_b16 v[178:179], v22 offset:17408
  ds_read_b64_tr_b16 v[180:181], v22 offset:20480
  ds_read_b64_tr_b16 v[182:183], v22 offset:21504
  ds_read_b64_tr_b16 v[184:185], v22 offset:24576
  ds_read_b64_tr_b16 v[186:187], v22 offset:25600
  ds_read_b64_tr_b16 v[188:189], v22 offset:28672
  ds_read_b64_tr_b16 v[190:191], v22 offset:29696
  s_waitcnt lgkmcnt(0)
  s_waitcnt vmcnt(16)
  s_barrier
  s_add_u32 s27, s26, 1048576
  s_add_u32 m0, s28, 131072
  s_nop 0
  buffer_load_dwordx4 v20, s[68:71], s27 offen lds
  s_add_u32 m0, s28, 132096
  s_add_u32 s27, s27, 32768
  buffer_load_dwordx4 v20, s[68:71], s27 offen lds
  s_add_u32 m0, s28, 133120
  s_add_u32 s27, s27, 32768
  buffer_load_dwordx4 v21, s[68:71], s27 offen lds
  s_add_u32 m0, s28, 134144
  s_add_u32 s27, s27, 32768
  buffer_load_dwordx4 v21, s[68:71], s27 offen lds
  s_add_u32 m0, s28, 135168
  s_add_u32 s27, s27, 32768
  buffer_load_dwordx4 v20, s[68:71], s27 offen lds
  s_add_u32 m0, s28, 136192
  s_add_u32 s27, s27, 32768
  buffer_load_dwordx4 v20, s[68:71], s27 offen lds
  s_add_u32 m0, s28, 137216
  s_add_u32 s27, s27, 32768
  buffer_load_dwordx4 v21, s[68:71], s27 offen lds
  s_add_u32 m0, s28, 138240
  s_add_u32 s27, s27, 32768
  buffer_load_dwordx4 v21, s[68:71], s27 offen lds
  ds_read_b64_tr_b16 v[192:193], v22 offset:32768
  ds_read_b64_tr_b16 v[194:195], v22 offset:33792
  ds_read_b64_tr_b16 v[196:197], v22 offset:36864
  ds_read_b64_tr_b16 v[198:199], v22 offset:37888
  ds_read_b64_tr_b16 v[200:201], v22 offset:40960
  ds_read_b64_tr_b16 v[202:203], v22 offset:41984
  ds_read_b64_tr_b16 v[204:205], v22 offset:45056
  ds_read_b64_tr_b16 v[206:207], v22 offset:46080
  ds_read_b64_tr_b16 v[208:209], v22 offset:49152
  ds_read_b64_tr_b16 v[210:211], v22 offset:50176
  ds_read_b64_tr_b16 v[212:213], v22 offset:53248
  ds_read_b64_tr_b16 v[214:215], v22 offset:54272
  ds_read_b64_tr_b16 v[216:217], v22 offset:57344
  ds_read_b64_tr_b16 v[218:219], v22 offset:58368
  ds_read_b64_tr_b16 v[220:221], v22 offset:61440
  ds_read_b64_tr_b16 v[222:223], v22 offset:62464
  s_waitcnt lgkmcnt(0)
  s_waitcnt vmcnt(16)
  s_barrier
  s_add_u32 s27, s26, 2097152
  s_add_u32 m0, s28, 0
  s_nop 0
  buffer_load_dwordx4 v20, s[68:71], s27 offen lds
  s_add_u32 m0, s28, 1024
  s_add_u32 s27, s27, 32768
  buffer_load_dwordx4 v20, s[68:71], s27 offen lds
  s_add_u32 m0, s28, 2048
  s_add_u32 s27, s27, 32768
  buffer_load_dwordx4 v21, s[68:71], s27 offen lds
  s_add_u32 m0, s28, 3072
  s_add_u32 s27, s27, 32768
  buffer_load_dwordx4 v21, s[68:71], s27 offen lds
  s_add_u32 m0, s28, 4096
  s_add_u32 s27, s27, 32768
  buffer_load_dwordx4 v20, s[68:71], s27 offen lds
  s_add_u32 m0, s28, 5120
  s_add_u32 s27, s27, 32768
  buffer_load_dwordx4 v20, s[68:71], s27 offen lds
  s_add_u32 m0, s28, 6144
  s_add_u32 s27, s27, 32768
  buffer_load_dwordx4 v21, s[68:71], s27 offen lds
  s_add_u32 m0, s28, 7168
  s_add_u32 s27, s27, 32768
  buffer_load_dwordx4 v21, s[68:71], s27 offen lds
  ds_read_b64_tr_b16 v[224:225], v23 offset:0
  ds_read_b64_tr_b16 v[226:227], v23 offset:1024
  ds_read_b64_tr_b16 v[228:229], v23 offset:4096
  ds_read_b64_tr_b16 v[230:231], v23 offset:5120
  ds_read_b64_tr_b16 v[232:233], v23 offset:8192
  ds_read_b64_tr_b16 v[234:235], v23 offset:9216
  ds_read_b64_tr_b16 v[236:237], v23 offset:12288
  ds_read_b64_tr_b16 v[238:239], v23 offset:13312
  ds_read_b64_tr_b16 v[240:241], v23 offset:16384
  ds_read_b64_tr_b16 v[242:243], v23 offset:17408
  ds_read_b64_tr_b16 v[244:245], v23 offset:20480
  ds_read_b64_tr_b16 v[246:247], v23 offset:21504
  ds_read_b64_tr_b16 v[248:249], v23 offset:24576
  ds_read_b64_tr_b16 v[250:251], v23 offset:25600
  ds_read_b64_tr_b16 v[252:253], v23 offset:28672
  ds_read_b64_tr_b16 v[254:255], v23 offset:29696
  s_waitcnt lgkmcnt(0)
  s_waitcnt vmcnt(16)
  s_barrier
  s_add_u32 s27, s26, 3145728
  s_add_u32 m0, s28, 32768
  s_nop 0
  buffer_load_dwordx4 v20, s[68:71], s27 offen lds
  s_add_u32 m0, s28, 33792
  s_add_u32 s27, s27, 32768
  buffer_load_dwordx4 v20, s[68:71], s27 offen lds
  s_add_u32 m0, s28, 34816
  s_add_u32 s27, s27, 32768
  buffer_load_dwordx4 v21, s[68:71], s27 offen lds
  s_add_u32 m0, s28, 35840
  s_add_u32 s27, s27, 32768
  buffer_load_dwordx4 v21, s[68:71], s27 offen lds
  s_add_u32 m0, s28, 36864
  s_add_u32 s27, s27, 32768
  buffer_load_dwordx4 v20, s[68:71], s27 offen lds
  s_add_u32 m0, s28, 37888
  s_add_u32 s27, s27, 32768
  buffer_load_dwordx4 v20, s[68:71], s27 offen lds
  s_add_u32 m0, s28, 38912
  s_add_u32 s27, s27, 32768
  buffer_load_dwordx4 v21, s[68:71], s27 offen lds
  s_add_u32 m0, s28, 39936
  s_add_u32 s27, s27, 32768
  buffer_load_dwordx4 v21, s[68:71], s27 offen lds
  ds_read_b64_tr_b16 a[0:1], v23 offset:32768
  ds_read_b64_tr_b16 a[2:3], v23 offset:33792
  ds_read_b64_tr_b16 a[4:5], v23 offset:36864
  ds_read_b64_tr_b16 a[6:7], v23 offset:37888
  ds_read_b64_tr_b16 a[8:9], v23 offset:40960
  ds_read_b64_tr_b16 a[10:11], v23 offset:41984
  ds_read_b64_tr_b16 a[12:13], v23 offset:45056
  ds_read_b64_tr_b16 a[14:15], v23 offset:46080
  ds_read_b64_tr_b16 a[16:17], v23 offset:49152
  ds_read_b64_tr_b16 a[18:19], v23 offset:50176
  ds_read_b64_tr_b16 a[20:21], v23 offset:53248
  ds_read_b64_tr_b16 a[22:23], v23 offset:54272
  ds_read_b64_tr_b16 a[24:25], v23 offset:57344
  ds_read_b64_tr_b16 a[26:27], v23 offset:58368
  ds_read_b64_tr_b16 a[28:29], v23 offset:61440
  ds_read_b64_tr_b16 a[30:31], v23 offset:62464
  s_waitcnt lgkmcnt(0)
  s_waitcnt vmcnt(16)
  s_barrier
  ds_read_b64_tr_b16 a[32:33], v24 offset:0
  ds_read_b64_tr_b16 a[34:35], v24 offset:1024
  ds_read_b64_tr_b16 a[36:37], v24 offset:4096
  ds_read_b64_tr_b16 a[38:39], v24 offset:5120
  ds_read_b64_tr_b16 a[40:41], v24 offset:8192
  ds_read_b64_tr_b16 a[42:43], v24 offset:9216
  ds_read_b64_tr_b16 a[44:45], v24 offset:12288
  ds_read_b64_tr_b16 a[46:47], v24 offset:13312
  ds_read_b64_tr_b16 a[48:49], v24 offset:16384
  ds_read_b64_tr_b16 a[50:51], v24 offset:17408
  ds_read_b64_tr_b16 a[52:53], v24 offset:20480
  ds_read_b64_tr_b16 a[54:55], v24 offset:21504
  ds_read_b64_tr_b16 a[56:57], v24 offset:24576
  ds_read_b64_tr_b16 a[58:59], v24 offset:25600
  ds_read_b64_tr_b16 a[60:61], v24 offset:28672
  ds_read_b64_tr_b16 a[62:63], v24 offset:29696
  s_waitcnt lgkmcnt(0)
  s_waitcnt vmcnt(8)
  s_barrier
  ds_read_b64_tr_b16 a[64:65], v22 offset:0
  ds_read_b64_tr_b16 a[66:67], v22 offset:1024
  ds_read_b64_tr_b16 a[68:69], v22 offset:4096
  ds_read_b64_tr_b16 a[70:71], v22 offset:5120
  ds_read_b64_tr_b16 a[72:73], v22 offset:8192
  ds_read_b64_tr_b16 a[74:75], v22 offset:9216
  ds_read_b64_tr_b16 a[76:77], v22 offset:12288
  ds_read_b64_tr_b16 a[78:79], v22 offset:13312
  ds_read_b64_tr_b16 a[80:81], v22 offset:16384
  ds_read_b64_tr_b16 a[82:83], v22 offset:17408
  ds_read_b64_tr_b16 a[84:85], v22 offset:20480
  ds_read_b64_tr_b16 a[86:87], v22 offset:21504
  ds_read_b64_tr_b16 a[88:89], v22 offset:24576
  ds_read_b64_tr_b16 a[90:91], v22 offset:25600
  ds_read_b64_tr_b16 a[92:93], v22 offset:28672
  ds_read_b64_tr_b16 a[94:95], v22 offset:29696
  s_waitcnt lgkmcnt(0)
  s_waitcnt vmcnt(0)
  s_barrier
  ds_read_b64_tr_b16 a[96:97], v22 offset:32768
  ds_read_b64_tr_b16 a[98:99], v22 offset:33792
  ds_read_b64_tr_b16 a[100:101], v22 offset:36864
  ds_read_b64_tr_b16 a[102:103], v22 offset:37888
  ds_read_b64_tr_b16 a[104:105], v22 offset:40960
  ds_read_b64_tr_b16 a[106:107], v22 offset:41984
  ds_read_b64_tr_b16 a[108:109], v22 offset:45056
  ds_read_b64_tr_b16 a[110:111], v22 offset:46080
  ds_read_b64_tr_b16 a[112:113], v22 offset:49152
  ds_read_b64_tr_b16 a[114:115], v22 offset:50176
  ds_read_b64_tr_b16 a[116:117], v22 offset:53248
  ds_read_b64_tr_b16 a[118:119], v22 offset:54272
  ds_read_b64_tr_b16 a[120:121], v22 offset:57344
  ds_read_b64_tr_b16 a[122:123], v22 offset:58368
  ds_read_b64_tr_b16 a[124:125], v22 offset:61440
  ds_read_b64_tr_b16 a[126:127], v22 offset:62464
  s_waitcnt lgkmcnt(0)
q_ld_84:
  s_waitcnt lgkmcnt(0)
  s_barrier
  v_mbcnt_lo_u32_b32 v20, -1, 0
  v_and_b32 v20, 0, v20
  v_add_lshl_u32 v20, v20, 1, 2
  s_mov_b32 s26, 0
g_wt_85:
  global_load_dword v21, v20, s[12:13] offset:128 sc1
  s_add_u32 s26, s26, 1
  s_cmp_gt_u32 s26, 1048576
  s_cbranch_scc1 L_end
  s_waitcnt vmcnt(0)
  v_cmp_eq_u32 vcc, 0, v21
  v_readfirstlane_b32 s27, v21
  s_cbranch_vccnz g_wt_85
  v_lshrrev_b32 v7, 7, v0
  v_lshlrev_b32 v7, 12, v7
  v_and_b32 v2, 1023, v9
  s_lshl_b32 s26, s17, 10
  v_add3_u32 v7, v7, v2, s26
  v_mov_b32 v116, 0
  s_mov_b32 s47, s60
  s_add_u32 s76, s60, 3
  s_add_u32 s41, s60, 64
  s_mov_b32 s40, 18
  s_mov_b32 s48, 0
  s_mov_b32 s49, 268435456
  s_mov_b32 s43, 268435456
  s_mov_b32 s50, 32768
  s_mov_b32 s56, 1
  s_mov_b32 s61, 0
  s_mov_b32 s62, 0
  s_lshl_b32 s54, s17, 13
  s_mov_b32 s50, 0
  v_mov_b32 v4, 1
q_slow_86:
  s_nop 1
  s_nop 7
  v_cvt_pk_bf16_f32 v100, v52, v53
  v_cvt_pk_bf16_f32 v101, v54, v55
  v_cvt_pk_bf16_f32 v102, v60, v61
  v_cvt_pk_bf16_f32 v103, v62, v63
  buffer_store_dwordx4 v[100:103], v8, s[4:7], s43 offen offset:0 sc1
  v_cvt_pk_bf16_f32 v104, v56, v57
  v_cvt_pk_bf16_f32 v105, v58, v59
  v_cvt_pk_bf16_f32 v106, v64, v65
  v_cvt_pk_bf16_f32 v107, v66, v67
  buffer_store_dwordx4 v[104:107], v8, s[4:7], s43 offen offset:512 sc1
  s_mov_b32 s43, 268435456
  s_xor_b32 s50, s50, 32768
q_nxt_96:
  s_cmp_ge_u32 s47, 128
  s_cbranch_scc1 q_end_87
  s_cmp_lg_u32 s48, 0
  s_cbranch_scc1 q_have_88
  s_mov_b32 s53, 0
q_poll_89:
  s_cmp_lt_u32 s47, 64
  s_cselect_b32 s26, 2, 0
  s_add_u32 s26, s26, s47
  s_lshl_b32 s26, s26, 12
  s_add_u32 s26, s26, 243261440
  s_mov_b64 exec, 0xffffff
  buffer_load_dword v116, v7, s[4:7], s26 offen sc1
  s_mov_b64 exec, -1
  s_add_u32 s53, s53, 1
  s_cmp_gt_u32 s53, 1048576
  s_cbranch_scc1 q_fail_90
  s_waitcnt vmcnt(0)
  s_mov_b64 exec, 1
  buffer_store_dword v4, off, s[4:7], s49 sc1
  s_mov_b64 exec, -1
  s_mov_b32 s49, 268435456
  v_cmp_eq_u32 vcc, 0, v116
  s_nop 0
  s_and_b32 s26, vcc_lo, 0xffffff
  s_cbranch_scc1 q_poll_89
  s_and_b32 s63, s47, 127
  s_lshl_b32 s63, s63, 15
  s_xor_b32 s27, s50, 32768
  s_add_u32 m0, s27, s54
  s_add_u32 s63, s63, s54
  s_add_u32 s63, s63, 6291456
  buffer_load_dwordx4 v12, s[4:7], s63 offen offset:0 sc1 lds
  buffer_load_dwordx4 v13, s[4:7], s63 offen offset:1024 sc1 lds
  buffer_load_dwordx4 v14, s[4:7], s63 offen offset:2048 sc1 lds
  buffer_load_dwordx4 v15, s[4:7], s63 offen offset:3072 sc1 lds
  s_add_u32 m0, m0, 4096
  s_add_u32 s63, s63, 4096
  buffer_load_dwordx4 v16, s[4:7], s63 offen offset:0 sc1 lds
  buffer_load_dwordx4 v17, s[4:7], s63 offen offset:1024 sc1 lds
  buffer_load_dwordx4 v18, s[4:7], s63 offen offset:2048 sc1 lds
  buffer_load_dwordx4 v19, s[4:7], s63 offen offset:3072 sc1 lds
  v_cmp_eq_u32 vcc, 0, v116
  v_max_u32_dpp v117, v116, v116 quad_perm:[1,0,3,2] row_mask:0xf bank_mask:0xf
  s_and_b32 s48, vcc_lo, 0xffffff
  s_cselect_b32 s48, 0, -1
  v_max_u32_dpp v117, v117, v117 quad_perm:[2,3,0,1] row_mask:0xf bank_mask:0xf
  s_nop 1
  v_max_u32_dpp v117, v117, v117 row_half_mirror row_mask:0xf bank_mask:0xf
  v_and_b32 v117, s48, v117
q_have_88:
  ds_write_b32 v118, v117 offset:256
  s_xor_b32 s50, s50, 32768
  s_waitcnt lgkmcnt(0)
  s_barrier
  ds_read_b128 v[108:111], v119 offset:256
  s_cmp_lt_u32 s47, 64
  s_cbranch_scc1 q_nopre_92
  s_waitcnt lgkmcnt(0)
  v_min3_u32 v112, v108, v109, v110
  v_max3_u32 v108, v108, v109, v110
  v_min_u32 v112, v112, v111
  v_max_u32 v108, v108, v111
  v_readfirstlane_b32 s45, v112
  v_readlane_b32 s28, v108, 0
  v_readlane_b32 s29, v108, 1
  v_readlane_b32 s30, v108, 2
  s_cmp_gt_u32 s28, s56
  s_cselect_b32 s26, s40, 0
  s_max_u32 s56, s56, s28
  s_cmp_gt_u32 s26, 10
  s_subb_u32 s40, s40, 0
  s_cmp_gt_u32 s29, s56
  s_cselect_b32 s26, s40, 0
  s_max_u32 s56, s56, s29
  s_cmp_gt_u32 s26, 10
  s_subb_u32 s40, s40, 0
  s_cmp_gt_u32 s30, s56
  s_cselect_b32 s26, s40, 0
  s_max_u32 s56, s56, s30
  s_add_u32 s76, s47, s40
  s_add_u32 s41, s47, 3
  s_sub_u32 s76, s76, 64
  s_cmp_gt_u32 s26, 10
  s_cselect_b32 s76, 64, s76
  s_subb_u32 s40, s40, 0
  s_cmp_lt_u32 s76, 64
  s_cselect_b32 s76, s76, s41
  s_cmp_lg_u32 s26, 0
  s_cbranch_scc1 q_fork_93
q_nopre_92:
  s_waitcnt vmcnt(0)
  s_sub_u32 s26, s47, s60
  s_cmp_lg_u32 s26, 15
  s_cbranch_scc1 q_cold_94
  v_mbcnt_lo_u32_b32 v20, -1, 0
  v_and_b32 v20, 0, v20
  v_add_lshl_u32 v20, v20, 2, 2
  s_mov_b32 s26, 0
g_wt_101:
  global_load_dword v21, v20, s[12:13] offset:128 sc1
  s_add_u32 s26, s26, 1
  s_cmp_gt_u32 s26, 1048576
  s_cbranch_scc1 L_end
  s_waitcnt vmcnt(0)
  v_cmp_eq_u32 vcc, 0, v21
  v_readfirstlane_b32 s27, v21
  s_cbranch_vccnz g_wt_101
  s_load_dwordx2 s[64:65], s[0:1], 72
  s_load_dwordx2 s[68:69], s[0:1], 80
  s_load_dwordx2 s[8:9], s[0:1], 88
  s_mov_b32 s66, 1835008
  s_mov_b32 s70, 1835008
  s_mov_b32 s10, 1835008
  v_lshrrev_b32 v2, 7, v0
  v_and_b32 v3, 0x70, v0
  v_mul_u32_u24 v6, 57344, v2
  v_add_u32 v6, v6, v3
  v_cmp_eq_u32 vcc, 0x70, v3
  v_mov_b32 v3, 0x7ff00000
  s_nop 0
  v_cndmask_b32 v6, v6, v3, vcc
  v_lshrrev_b32 v2, 8, v0
  v_mul_u32_u24 v7, 14336, v2
  v_and_b32 v3, 0xf0, v0
  v_add_u32 v7, v7, v3
  s_mul_i32 s34, s17, 458752
  s_mul_i32 s27, s16, 112
  s_add_u32 s34, s34, s27
  s_mul_i32 s35, s16, 57344
  s_lshl_b32 s27, s17, 8
  s_add_u32 s35, s35, s27
  s_waitcnt lgkmcnt(0)
  s_mul_i32 s26, s17, 23552
  s_add_u32 m0, s26, 65536
  s_add_u32 s36, s34, 0
  buffer_load_dwordx4 v6, s[64:67], s36 offen lds
  s_add_u32 m0, m0, 1024
  s_add_u32 s36, s34, 0
  buffer_load_dwordx4 v6, s[68:71], s36 offen lds
  s_add_u32 m0, m0, 1024
  s_add_u32 s36, s34, 3584
  buffer_load_dwordx4 v6, s[64:67], s36 offen lds
  s_add_u32 m0, m0, 1024
  s_add_u32 s36, s34, 3584
  buffer_load_dwordx4 v6, s[68:71], s36 offen lds
  s_add_u32 m0, m0, 1024
  s_add_u32 s36, s34, 7168
  buffer_load_dwordx4 v6, s[64:67], s36 offen lds
  s_add_u32 m0, m0, 1024
  s_add_u32 s36, s34, 7168
  buffer_load_dwordx4 v6, s[68:71], s36 offen lds
  s_add_u32 m0, m0, 1024
  s_add_u32 s36, s34, 10752
  buffer_load_dwordx4 v6, s[64:67], s36 offen lds
  s_add_u32 m0, m0, 1024
  s_add_u32 s36, s34, 10752
  buffer_load_dwordx4 v6, s[68:71], s36 offen lds
  s_add_u32 m0, m0, 1024
  s_add_u32 s36, s34, 14336
  buffer_load_dwordx4 v6, s[64:67], s36 offen lds
  s_add_u32 m0, m0, 1024
  s_add_u32 s36, s34, 14336
  buffer_load_dwordx4 v6, s[68:71], s36 offen lds
  s_add_u32 m0, m0, 1024
  s_add_u32 s36, s34, 17920
  buffer_load_dwordx4 v6, s[64:67], s36 offen lds
  s_add_u32 m0, m0, 1024
  s_add_u32 s36, s34, 17920
  buffer_load_dwordx4 v6, s[68:71], s36 offen lds
  s_add_u32 m0, m0, 1024
  s_add_u32 s36, s34, 21504
  buffer_load_dwordx4 v6, s[64:67], s36 offen lds
  s_add_u32 m0, m0, 1024
  s_add_u32 s36, s34, 21504
  buffer_load_dwordx4 v6, s[68:71], s36 offen lds
  s_add_u32 m0, m0, 1024
  s_add_u32 s36, s34, 25088
  buffer_load_dwordx4 v6, s[64:67], s36 offen lds
  s_add_u32 m0, m0, 1024
  s_add_u32 s36, s34, 25088
  buffer_load_dwordx4 v6, s[68:71], s36 offen lds
  s_add_u32 m0, m0, 1024
  s_add_u32 s36, s34, 28672
  buffer_load_dwordx4 v6, s[64:67], s36 offen lds
  s_add_u32 m0, m0, 1024
  s_add_u32 s36, s34, 28672
  buffer_load_dwordx4 v6, s[68:71], s36 offen lds
  s_add_u32 m0, m0, 1024
  s_add_u32 s36, s34, 32256
  buffer_load_dwordx4 v6, s[64:67], s36 offen lds
  s_add_u32 m0, m0, 1024
  s_add_u32 s36, s34, 32256
  buffer_load_dwordx4 v6, s[68:71], s36 offen lds
  s_add_u32 m0, m0, 1024
  s_add_u32 s36, s34, 35840
  buffer_load_dwordx4 v6, s[64:67], s36 offen lds
  s_add_u32 m0, m0, 1024
  s_add_u32 s36, s34, 35840
  buffer_load_dwordx4 v6, s[68:71], s36 offen lds
  s_add_u32 m0, m0, 1024
  s_add_u32 s36, s34, 39424
  buffer_load_dwordx4 v6, s[64:67], s36 offen lds
  s_add_u32 m0, m0, 1024
  v_lshrrev_b32 v7, 7, v0
  v_lshlrev_b32 v7, 12, v7
  v_and_b32 v2, 1023, v9
  s_lshl_b32 s26, s17, 10
  v_add3_u32 v7, v7, v2, s26
  v_mov_b32 v116, 0
q_cold_94:
  s_waitcnt lgkmcnt(0)
  s_barrier
  s_cmp_lg_u32 s50, 0
  s_cbranch_scc1 q_c1_98
q_c0_97:
  ds_read_b128 v[68:71], v120 offset:0
  ds_read_b128 v[72:75], v121 offset:0
  ds_read_b128 v[76:79], v122 offset:0
q_w0_99:
  s_waitcnt lgkmcnt(2)
  v_mfma_f32_32x32x16_bf16 v[20:35], v[128:131], v[68:71], 0
  ds_read_b128 v[80:83], v123 offset:0
  s_mov_b32 s46, s47
  s_mov_b32 s47, s76
  s_lshl_b32 s52, s46, 7
  s_add_u32 s52, s52, s57
  s_lshl_b32 s44, s52, 12
  v_mfma_f32_32x32x16_bf16 v[36:51], v[68:71], a[0:3], 0
  s_add_u32 s44, s44, 41943040
  v_cvt_pk_bf16_f32 v100, v52, v53
  v_cvt_pk_bf16_f32 v101, v54, v55
  v_cvt_pk_bf16_f32 v102, v60, v61
  v_cvt_pk_bf16_f32 v103, v62, v63
  s_waitcnt lgkmcnt(2)
  v_mfma_f32_32x32x16_bf16 v[20:35], v[132:135], v[72:75], v[20:35]
  ds_read_b128 v[84:87], v124 offset:0
  buffer_store_dwordx4 v[100:103], v8, s[4:7], s43 offen offset:0 sc1
  v_cvt_pk_bf16_f32 v104, v56, v57
  v_cvt_pk_bf16_f32 v105, v58, v59
  v_mfma_f32_32x32x16_bf16 v[36:51], v[72:75], a[4:7], v[36:51]
  v_cvt_pk_bf16_f32 v106, v64, v65
  v_cvt_pk_bf16_f32 v107, v66, v67
  s_waitcnt lgkmcnt(2)
  v_mfma_f32_32x32x16_bf16 v[20:35], v[136:139], v[76:79], v[20:35]
  ds_read_b128 v[88:91], v125 offset:0
  buffer_store_dwordx4 v[104:107], v8, s[4:7], s43 offen offset:512 sc1
  s_lshl_b32 s43, s52, 11
  s_add_u32 s43, s43, 142606336
  v_mfma_f32_32x32x16_bf16 v[36:51], v[76:79], a[8:11], v[36:51]
  s_lshl_b32 s51, s52, 5
  s_add_u32 s51, s51, 244318208
  s_lshr_b32 s55, s47, 7
  s_sub_u32 s27, s47, s60
  s_cmp_eq_u32 s27, 15
  s_cselect_b32 s55, 1, s55
  s_waitcnt lgkmcnt(2)
  v_mfma_f32_32x32x16_bf16 v[20:35], v[140:143], v[80:83], v[20:35]
  ds_read_b128 v[92:95], v126 offset:0
  s_add_u32 s76, s47, 3
  s_cmp_lt_u32 s76, 18
  s_cselect_b32 s76, s76, s41
  v_mfma_f32_32x32x16_bf16 v[36:51], v[80:83], a[12:15], v[36:51]
  s_waitcnt lgkmcnt(2)
  v_mfma_f32_32x32x16_bf16 v[20:35], v[144:147], v[84:87], v[20:35]
  ds_read_b128 v[96:99], v127 offset:0
  v_mfma_f32_32x32x16_bf16 v[36:51], v[84:87], a[16:19], v[36:51]
  s_waitcnt lgkmcnt(2)
  v_mfma_f32_32x32x16_bf16 v[20:35], v[148:151], v[88:91], v[20:35]
  ds_read_b128 v[68:71], v120 offset:256
  v_mfma_f32_32x32x16_bf16 v[36:51], v[88:91], a[20:23], v[36:51]
  s_waitcnt lgkmcnt(2)
  v_mfma_f32_32x32x16_bf16 v[20:35], v[152:155], v[92:95], v[20:35]
  ds_read_b128 v[72:75], v121 offset:256
  s_cmp_lt_u32 s47, 64
  s_cselect_b32 s26, 2, 0
  s_add_u32 s26, s26, s47
  s_lshl_b32 s26, s26, 12
  s_add_u32 s26, s26, 243261440
  v_mfma_f32_32x32x16_bf16 v[36:51], v[92:95], a[24:27], v[36:51]
  s_mov_b64 exec, 0xffffff
  buffer_load_dword v116, v7, s[4:7], s26 offen sc1
  s_mov_b64 exec, -1
  s_waitcnt lgkmcnt(2)
  v_mfma_f32_32x32x16_bf16 v[20:35], v[156:159], v[96:99], v[20:35]
  ds_read_b128 v[76:79], v122 offset:256
  v_mfma_f32_32x32x16_bf16 v[36:51], v[96:99], a[28:31], v[36:51]
  s_waitcnt lgkmcnt(2)
  v_mfma_f32_32x32x16_bf16 v[20:35], v[160:163], v[68:71], v[20:35]
  ds_read_b128 v[80:83], v123 offset:256
  v_mfma_f32_32x32x16_bf16 v[36:51], v[68:71], a[32:35], v[36:51]
  s_waitcnt lgkmcnt(2)
  v_mfma_f32_32x32x16_bf16 v[20:35], v[164:167], v[72:75], v[20:35]
  ds_read_b128 v[84:87], v124 offset:256
  v_mfma_f32_32x32x16_bf16 v[36:51], v[72:75], a[36:39], v[36:51]
  s_waitcnt lgkmcnt(2)
  v_mfma_f32_32x32x16_bf16 v[20:35], v[168:171], v[76:79], v[20:35]
  ds_read_b128 v[88:91], v125 offset:256
  v_mfma_f32_32x32x16_bf16 v[36:51], v[76:79], a[40:43], v[36:51]
  s_waitcnt lgkmcnt(2)
  v_mfma_f32_32x32x16_bf16 v[20:35], v[172:175], v[80:83], v[20:35]
  ds_read_b128 v[92:95], v126 offset:256
  v_mfma_f32_32x32x16_bf16 v[36:51], v[80:83], a[44:47], v[36:51]
  s_waitcnt lgkmcnt(2)
  v_mfma_f32_32x32x16_bf16 v[20:35], v[176:179], v[84:87], v[20:35]
  ds_read_b128 v[96:99], v127 offset:256
  v_mfma_f32_32x32x16_bf16 v[36:51], v[84:87], a[48:51], v[36:51]
  s_waitcnt lgkmcnt(2)
  v_mfma_f32_32x32x16_bf16 v[20:35], v[180:183], v[88:91], v[20:35]
  ds_read_b128 v[68:71], v120 offset:512
  v_mfma_f32_32x32x16_bf16 v[36:51], v[88:91], a[52:55], v[36:51]
  s_waitcnt lgkmcnt(2)
  v_mfma_f32_32x32x16_bf16 v[20:35], v[184:187], v[92:95], v[20:35]
  ds_read_b128 v[72:75], v121 offset:512
  v_mfma_f32_32x32x16_bf16 v[36:51], v[92:95], a[56:59], v[36:51]
  s_waitcnt lgkmcnt(2)
  v_mfma_f32_32x32x16_bf16 v[20:35], v[188:191], v[96:99], v[20:35]
  ds_read_b128 v[76:79], v122 offset:512
  v_mfma_f32_32x32x16_bf16 v[36:51], v[96:99], a[60:63], v[36:51]
  s_waitcnt lgkmcnt(2)
  v_mfma_f32_32x32x16_bf16 v[20:35], v[192:195], v[68:71], v[20:35]
  ds_read_b128 v[80:83], v123 offset:512
  v_mfma_f32_32x32x16_bf16 v[36:51], v[68:71], a[64:67], v[36:51]
  s_waitcnt lgkmcnt(2)
  v_mfma_f32_32x32x16_bf16 v[20:35], v[196:199], v[72:75], v[20:35]
  ds_read_b128 v[84:87], v124 offset:512
  v_mfma_f32_32x32x16_bf16 v[36:51], v[72:75], a[68:71], v[36:51]
  s_waitcnt lgkmcnt(2)
  v_mfma_f32_32x32x16_bf16 v[20:35], v[200:203], v[76:79], v[20:35]
  ds_read_b128 v[88:91], v125 offset:512
  v_mfma_f32_32x32x16_bf16 v[36:51], v[76:79], a[72:75], v[36:51]
  s_waitcnt lgkmcnt(2)
  v_mfma_f32_32x32x16_bf16 v[20:35], v[204:207], v[80:83], v[20:35]
  ds_read_b128 v[92:95], v126 offset:512
  s_waitcnt vmcnt(0)
  s_mov_b64 exec, 1
  buffer_store_dword v4, off, s[4:7], s49 sc1
  s_mov_b64 exec, -1
  v_mfma_f32_32x32x16_bf16 v[36:51], v[80:83], a[76:79], v[36:51]
  v_cmp_eq_u32 vcc, 0, v116
  v_max_u32_dpp v117, v116, v116 quad_perm:[1,0,3,2] row_mask:0xf bank_mask:0xf
  s_and_b32 s48, vcc_lo, 0xffffff
  s_cselect_b32 s48, 0, -1
  v_max_u32_dpp v117, v117, v117 quad_perm:[2,3,0,1] row_mask:0xf bank_mask:0xf
  s_nop 1
  s_waitcnt lgkmcnt(2)
  v_mfma_f32_32x32x16_bf16 v[20:35], v[208:211], v[84:87], v[20:35]
  ds_read_b128 v[96:99], v127 offset:512
  v_max_u32_dpp v117, v117, v117 row_half_mirror row_mask:0xf bank_mask:0xf
  v_and_b32 v117, s48, v117
  s_cmp_lg_u32 s48, 0
  s_cselect_b32 s28, s47, s46
  s_and_b32 s63, s28, 127
  v_mfma_f32_32x32x16_bf16 v[36:51], v[84:87], a[80:83], v[36:51]
  s_lshl_b32 s63, s63, 15
  s_xor_b32 s27, s50, 32768
  s_add_u32 m0, s27, s54
  s_add_u32 s63, s63, s54
  s_add_u32 s63, s63, 6291456
  s_waitcnt lgkmcnt(2)
  v_mfma_f32_32x32x16_bf16 v[20:35], v[212:215], v[88:91], v[20:35]
  ds_read_b128 v[68:71], v120 offset:768
  buffer_load_dwordx4 v12, s[4:7], s63 offen offset:0 sc1 lds
  v_mfma_f32_32x32x16_bf16 v[36:51], v[88:91], a[84:87], v[36:51]
  s_waitcnt lgkmcnt(2)
  v_mfma_f32_32x32x16_bf16 v[20:35], v[216:219], v[92:95], v[20:35]
  ds_read_b128 v[72:75], v121 offset:768
  buffer_load_dwordx4 v13, s[4:7], s63 offen offset:1024 sc1 lds
  v_mfma_f32_32x32x16_bf16 v[36:51], v[92:95], a[88:91], v[36:51]
  s_waitcnt lgkmcnt(2)
  v_mfma_f32_32x32x16_bf16 v[20:35], v[220:223], v[96:99], v[20:35]
  ds_read_b128 v[76:79], v122 offset:768
  buffer_load_dwordx4 v14, s[4:7], s63 offen offset:2048 sc1 lds
  v_mfma_f32_32x32x16_bf16 v[36:51], v[96:99], a[92:95], v[36:51]
  s_waitcnt lgkmcnt(2)
  v_mfma_f32_32x32x16_bf16 v[20:35], v[224:227], v[68:71], v[20:35]
  ds_read_b128 v[80:83], v123 offset:768
  buffer_load_dwordx4 v15, s[4:7], s63 offen offset:3072 sc1 lds
  s_add_u32 m0, m0, 4096
  s_add_u32 s63, s63, 4096
  v_mfma_f32_32x32x16_bf16 v[36:51], v[68:71], a[96:99], v[36:51]
  s_waitcnt lgkmcnt(2)
  v_mfma_f32_32x32x16_bf16 v[20:35], v[228:231], v[72:75], v[20:35]
  ds_read_b128 v[84:87], v124 offset:768
  buffer_load_dwordx4 v16, s[4:7], s63 offen offset:0 sc1 lds
  v_mfma_f32_32x32x16_bf16 v[36:51], v[72:75], a[100:103], v[36:51]
  s_waitcnt lgkmcnt(2)
  v_mfma_f32_32x32x16_bf16 v[20:35], v[232:235], v[76:79], v[20:35]
  ds_read_b128 v[88:91], v125 offset:768
  buffer_load_dwordx4 v17, s[4:7], s63 offen offset:1024 sc1 lds
  v_mfma_f32_32x32x16_bf16 v[36:51], v[76:79], a[104:107], v[36:51]
  s_waitcnt lgkmcnt(2)
  v_mfma_f32_32x32x16_bf16 v[20:35], v[236:239], v[80:83], v[20:35]
  ds_read_b128 v[92:95], v126 offset:768
  buffer_load_dwordx4 v18, s[4:7], s63 offen offset:2048 sc1 lds
  v_mfma_f32_32x32x16_bf16 v[36:51], v[80:83], a[108:111], v[36:51]
  s_waitcnt lgkmcnt(2)
  v_mfma_f32_32x32x16_bf16 v[20:35], v[240:243], v[84:87], v[20:35]
  ds_read_b128 v[96:99], v127 offset:768
  buffer_load_dwordx4 v19, s[4:7], s63 offen offset:3072 sc1 lds
  s_add_u32 s49, s51, 16
  ds_write_b32 v118, v117 offset:0
  v_mfma_f32_32x32x16_bf16 v[36:51], v[84:87], a[112:115], v[36:51]
  s_waitcnt lgkmcnt(3)
  v_mfma_f32_32x32x16_bf16 v[20:35], v[244:247], v[88:91], v[20:35]
  ds_read_b128 v[68:71], v120 offset:0
  v_mfma_f32_32x32x16_bf16 v[36:51], v[88:91], a[116:119], v[36:51]
  ds_read_b128 v[72:75], v121 offset:0
  s_waitcnt lgkmcnt(4)
  v_mfma_f32_32x32x16_bf16 v[20:35], v[248:251], v[92:95], v[20:35]
  ds_read_b128 v[76:79], v122 offset:0
  v_mfma_f32_32x32x16_bf16 v[36:51], v[92:95], a[120:123], v[36:51]
  ds_read_b128 v[80:83], v123 offset:0
  s_waitcnt lgkmcnt(5)
  v_mfma_f32_32x32x16_bf16 v[20:35], v[252:255], v[96:99], v[20:35]
  ds_read_b128 v[84:87], v124 offset:0
  v_mfma_f32_32x32x16_bf16 v[36:51], v[96:99], a[124:127], v[36:51]
  ds_read_b128 v[88:91], v125 offset:0
  s_waitcnt lgkmcnt(4)
  v_mfma_f32_32x32x16_bf16 v[52:67], a[128:131], v[68:71], 0
  ds_read_b128 v[92:95], v126 offset:0
  v_mfma_f32_32x32x16_bf16 v[52:67], a[132:135], v[72:75], v[52:67]
  ds_read_b128 v[96:99], v127 offset:0
  v_mul_f32 v20, s24, v20
  v_mul_f32 v21, s24, v21
  v_mul_f32 v22, s24, v22
  v_mul_f32 v23, s24, v23
  v_mul_f32 v24, s24, v24
  s_waitcnt lgkmcnt(4)
  v_mfma_f32_32x32x16_bf16 v[52:67], a[136:139], v[76:79], v[52:67]
  ds_read_b128 v[68:71], v120 offset:256
  v_mul_f32 v25, s24, v25
  v_cvt_pk_bf16_f32 v100, v36, v37
  v_cvt_pk_bf16_f32 v101, v38, v39
  v_cvt_pk_bf16_f32 v102, v44, v45
  v_cvt_pk_bf16_f32 v103, v46, v47
  v_mfma_f32_32x32x16_bf16 v[52:67], a[140:143], v[80:83], v[52:67]
  ds_read_b128 v[72:75], v121 offset:256
  buffer_store_dwordx4 v[100:103], v8, s[4:7], s44 offen offset:2048 sc1
  v_cvt_pk_bf16_f32 v104, v40, v41
  v_cvt_pk_bf16_f32 v105, v42, v43
  s_waitcnt lgkmcnt(4)
  v_mfma_f32_32x32x16_bf16 v[52:67], a[144:147], v[84:87], v[52:67]
  ds_read_b128 v[76:79], v122 offset:256
  v_cvt_pk_bf16_f32 v106, v48, v49
  v_cvt_pk_bf16_f32 v107, v50, v51
  buffer_store_dwordx4 v[104:107], v8, s[4:7], s44 offen offset:2560 sc1
  v_mfma_f32_32x32x16_bf16 v[52:67], a[148:151], v[88:91], v[52:67]
  ds_read_b128 v[80:83], v123 offset:256
  v_mul_f32 v26, s24, v26
  v_mul_f32 v27, s24, v27
  v_mul_f32 v28, s24, v28
  v_mul_f32 v29, s24, v29
  v_mul_f32 v30, s24, v30
  s_waitcnt lgkmcnt(4)
  v_mfma_f32_32x32x16_bf16 v[52:67], a[152:155], v[92:95], v[52:67]
  ds_read_b128 v[84:87], v124 offset:256
  v_mul_f32 v31, s24, v31
  v_mul_f32 v32, s24, v32
  v_mul_f32 v33, s24, v33
  v_mul_f32 v34, s24, v34
  v_mul_f32 v35, s24, v35
  v_mfma_f32_32x32x16_bf16 v[52:67], a[156:159], v[96:99], v[52:67]
  ds_read_b128 v[88:91], v125 offset:256
  v_cvt_pk_bf16_f32 v108, v20, v21
  v_cvt_pk_bf16_f32 v109, v22, v23
  v_cvt_pk_bf16_f32 v110, v28, v29
  v_cvt_pk_bf16_f32 v111, v30, v31
  buffer_store_dwordx4 v[108:111], v8, s[4:7], s44 offen offset:0 sc1
  s_waitcnt lgkmcnt(4)
  v_mfma_f32_32x32x16_bf16 v[52:67], a[160:163], v[68:71], v[52:67]
  ds_read_b128 v[92:95], v126 offset:256
  v_cvt_pk_bf16_f32 v112, v24, v25
  v_cvt_pk_bf16_f32 v113, v26, v27
  v_cvt_pk_bf16_f32 v114, v32, v33
  v_cvt_pk_bf16_f32 v115, v34, v35
  buffer_store_dwordx4 v[112:115], v8, s[4:7], s44 offen offset:512 sc1
  v_mfma_f32_32x32x16_bf16 v[52:67], a[164:167], v[72:75], v[52:67]
  ds_read_b128 v[96:99], v127 offset:256
  s_waitcnt lgkmcnt(4)
  v_mfma_f32_32x32x16_bf16 v[52:67], a[168:171], v[76:79], v[52:67]
  ds_read_b128 v[68:71], v120 offset:512
  v_mfma_f32_32x32x16_bf16 v[52:67], a[172:175], v[80:83], v[52:67]
  ds_read_b128 v[72:75], v121 offset:512
  s_waitcnt lgkmcnt(4)
  v_mfma_f32_32x32x16_bf16 v[52:67], a[176:179], v[84:87], v[52:67]
  ds_read_b128 v[76:79], v122 offset:512
  v_mfma_f32_32x32x16_bf16 v[52:67], a[180:183], v[88:91], v[52:67]
  ds_read_b128 v[80:83], v123 offset:512
  s_waitcnt lgkmcnt(4)
  v_mfma_f32_32x32x16_bf16 v[52:67], a[184:187], v[92:95], v[52:67]
  ds_read_b128 v[84:87], v124 offset:512
  v_mfma_f32_32x32x16_bf16 v[52:67], a[188:191], v[96:99], v[52:67]
  ds_read_b128 v[88:91], v125 offset:512
  s_waitcnt lgkmcnt(4)
  v_mfma_f32_32x32x16_bf16 v[52:67], a[192:195], v[68:71], v[52:67]
  ds_read_b128 v[92:95], v126 offset:512
  v_mfma_f32_32x32x16_bf16 v[52:67], a[196:199], v[72:75], v[52:67]
  ds_read_b128 v[96:99], v127 offset:512
  s_waitcnt lgkmcnt(4)
  v_mfma_f32_32x32x16_bf16 v[52:67], a[200:203], v[76:79], v[52:67]
  ds_read_b128 v[68:71], v120 offset:768
  v_mfma_f32_32x32x16_bf16 v[52:67], a[204:207], v[80:83], v[52:67]
  ds_read_b128 v[72:75], v121 offset:768
  s_waitcnt lgkmcnt(4)
  v_mfma_f32_32x32x16_bf16 v[52:67], a[208:211], v[84:87], v[52:67]
  ds_read_b128 v[76:79], v122 offset:768
  ds_read_b128 v[80:83], v123 offset:768
  v_mfma_f32_32x32x16_bf16 v[52:67], a[212:215], v[88:91], v[52:67]
  ds_read_b128 v[84:87], v124 offset:768
  ds_read_b128 v[88:91], v125 offset:768
  s_waitcnt lgkmcnt(6)
  v_mfma_f32_32x32x16_bf16 v[52:67], a[216:219], v[92:95], v[52:67]
  ds_read_b128 v[92:95], v126 offset:768
  v_mfma_f32_32x32x16_bf16 v[52:67], a[220:223], v[96:99], v[52:67]
  ds_read_b128 v[96:99], v127 offset:768
  s_waitcnt lgkmcnt(6)
  v_mfma_f32_32x32x16_bf16 v[52:67], a[224:227], v[68:71], v[52:67]
  v_mfma_f32_32x32x16_bf16 v[52:67], a[228:231], v[72:75], v[52:67]
  s_waitcnt vmcnt(4) lgkmcnt(0)
  s_barrier
  ds_read_b128 v[100:103], v119 offset:0
  v_mfma_f32_32x32x16_bf16 v[52:67], a[232:235], v[76:79], v[52:67]
  ds_read_b128 v[68:71], v120 offset:32768
  v_mfma_f32_32x32x16_bf16 v[52:67], a[236:239], v[80:83], v[52:67]
  ds_read_b128 v[72:75], v121 offset:32768
  s_xor_b32 s50, s50, 32768
  v_mfma_f32_32x32x16_bf16 v[52:67], a[240:243], v[84:87], v[52:67]
  ds_read_b128 v[76:79], v122 offset:32768
  s_waitcnt vmcnt(0)
  s_mov_b64 exec, 1
  buffer_store_dword v4, off, s[4:7], s51 sc1
  s_mov_b64 exec, -1
  v_mfma_f32_32x32x16_bf16 v[52:67], a[244:247], v[88:91], v[52:67]
  s_waitcnt lgkmcnt(3)
  v_min3_u32 v104, v100, v101, v102
  v_max3_u32 v100, v100, v101, v102
  v_min_u32 v104, v104, v103
  v_max_u32 v100, v100, v103
  v_readfirstlane_b32 s45, v104
  v_mfma_f32_32x32x16_bf16 v[52:67], a[248:251], v[92:95], v[52:67]
  v_readlane_b32 s28, v100, 0
  v_readlane_b32 s29, v100, 1
  v_readlane_b32 s30, v100, 2
  s_cmp_gt_u32 s55, 0
  s_cselect_b32 s45, 0, s45
  v_mfma_f32_32x32x16_bf16 v[52:67], a[252:255], v[96:99], v[52:67]
  s_cmp_eq_u32 s45, 0
  s_cbranch_scc1 q_slow_86
  s_cmp_lt_u32 s47, 64
  s_cbranch_scc1 q_w1_100
  s_cmp_gt_u32 s28, s56
  s_cselect_b32 s26, s40, 0
  s_max_u32 s56, s56, s28
  s_cmp_gt_u32 s26, 10
  s_subb_u32 s40, s40, 0
  s_cmp_gt_u32 s29, s56
  s_cselect_b32 s26, s40, 0
  s_max_u32 s56, s56, s29
  s_cmp_gt_u32 s26, 10
  s_subb_u32 s40, s40, 0
  s_cmp_gt_u32 s30, s56
  s_cselect_b32 s26, s40, 0
  s_max_u32 s56, s56, s30
  s_add_u32 s76, s47, s40
  s_add_u32 s41, s47, 3
  s_sub_u32 s76, s76, 64
  s_cmp_gt_u32 s26, 10
  s_cselect_b32 s76, 64, s76
  s_subb_u32 s40, s40, 0
  s_cmp_lt_u32 s76, 64
  s_cselect_b32 s76, s76, s41
  s_cmp_lg_u32 s26, 0
  s_cbranch_scc0 q_w1_100
  s_branch q_forkw_95
q_c1_98:
  ds_read_b128 v[68:71], v120 offset:32768
  ds_read_b128 v[72:75], v121 offset:32768
  ds_read_b128 v[76:79], v122 offset:32768
q_w1_100:
  s_waitcnt lgkmcnt(2)
  v_mfma_f32_32x32x16_bf16 v[20:35], v[128:131], v[68:71], 0
  ds_read_b128 v[80:83], v123 offset:32768
  s_mov_b32 s46, s47
  s_mov_b32 s47, s76
  s_lshl_b32 s52, s46, 7
  s_add_u32 s52, s52, s57
  s_lshl_b32 s44, s52, 12
  v_mfma_f32_32x32x16_bf16 v[36:51], v[68:71], a[0:3], 0
  s_add_u32 s44, s44, 41943040
  v_cvt_pk_bf16_f32 v100, v52, v53
  v_cvt_pk_bf16_f32 v101, v54, v55
  v_cvt_pk_bf16_f32 v102, v60, v61
  v_cvt_pk_bf16_f32 v103, v62, v63
  s_waitcnt lgkmcnt(2)
  v_mfma_f32_32x32x16_bf16 v[20:35], v[132:135], v[72:75], v[20:35]
  ds_read_b128 v[84:87], v124 offset:32768
  buffer_store_dwordx4 v[100:103], v8, s[4:7], s43 offen offset:0 sc1
  v_cvt_pk_bf16_f32 v104, v56, v57
  v_cvt_pk_bf16_f32 v105, v58, v59
  v_mfma_f32_32x32x16_bf16 v[36:51], v[72:75], a[4:7], v[36:51]
  v_cvt_pk_bf16_f32 v106, v64, v65
  v_cvt_pk_bf16_f32 v107, v66, v67
  s_waitcnt lgkmcnt(2)
  v_mfma_f32_32x32x16_bf16 v[20:35], v[136:139], v[76:79], v[20:35]
  ds_read_b128 v[88:91], v125 offset:32768
  buffer_store_dwordx4 v[104:107], v8, s[4:7], s43 offen offset:512 sc1
  s_lshl_b32 s43, s52, 11
  s_add_u32 s43, s43, 142606336
  v_mfma_f32_32x32x16_bf16 v[36:51], v[76:79], a[8:11], v[36:51]
  s_lshl_b32 s51, s52, 5
  s_add_u32 s51, s51, 244318208
  s_lshr_b32 s55, s47, 7
  s_sub_u32 s27, s47, s60
  s_cmp_eq_u32 s27, 15
  s_cselect_b32 s55, 1, s55
  s_waitcnt lgkmcnt(2)
  v_mfma_f32_32x32x16_bf16 v[20:35], v[140:143], v[80:83], v[20:35]
  ds_read_b128 v[92:95], v126 offset:32768
  s_add_u32 s76, s47, 3
  s_cmp_lt_u32 s76, 18
  s_cselect_b32 s76, s76, s41
  v_mfma_f32_32x32x16_bf16 v[36:51], v[80:83], a[12:15], v[36:51]
  s_waitcnt lgkmcnt(2)
  v_mfma_f32_32x32x16_bf16 v[20:35], v[144:147], v[84:87], v[20:35]
  ds_read_b128 v[96:99], v127 offset:32768
  v_mfma_f32_32x32x16_bf16 v[36:51], v[84:87], a[16:19], v[36:51]
  s_waitcnt lgkmcnt(2)
  v_mfma_f32_32x32x16_bf16 v[20:35], v[148:151], v[88:91], v[20:35]
  ds_read_b128 v[68:71], v120 offset:33024
  v_mfma_f32_32x32x16_bf16 v[36:51], v[88:91], a[20:23], v[36:51]
  s_waitcnt lgkmcnt(2)
  v_mfma_f32_32x32x16_bf16 v[20:35], v[152:155], v[92:95], v[20:35]
  ds_read_b128 v[72:75], v121 offset:33024
  s_cmp_lt_u32 s47, 64
  s_cselect_b32 s26, 2, 0
  s_add_u32 s26, s26, s47
  s_lshl_b32 s26, s26, 12
  s_add_u32 s26, s26, 243261440
  v_mfma_f32_32x32x16_bf16 v[36:51], v[92:95], a[24:27], v[36:51]
  s_mov_b64 exec, 0xffffff
  buffer_load_dword v116, v7, s[4:7], s26 offen sc1
  s_mov_b64 exec, -1
  s_waitcnt lgkmcnt(2)
  v_mfma_f32_32x32x16_bf16 v[20:35], v[156:159], v[96:99], v[20:35]
  ds_read_b128 v[76:79], v122 offset:33024
  v_mfma_f32_32x32x16_bf16 v[36:51], v[96:99], a[28:31], v[36:51]
  s_waitcnt lgkmcnt(2)
  v_mfma_f32_32x32x16_bf16 v[20:35], v[160:163], v[68:71], v[20:35]
  ds_read_b128 v[80:83], v123 offset:33024
  v_mfma_f32_32x32x16_bf16 v[36:51], v[68:71], a[32:35], v[36:51]
  s_waitcnt lgkmcnt(2)
  v_mfma_f32_32x32x16_bf16 v[20:35], v[164:167], v[72:75], v[20:35]
  ds_read_b128 v[84:87], v124 offset:33024
  v_mfma_f32_32x32x16_bf16 v[36:51], v[72:75], a[36:39], v[36:51]
  s_waitcnt lgkmcnt(2)
  v_mfma_f32_32x32x16_bf16 v[20:35], v[168:171], v[76:79], v[20:35]
  ds_read_b128 v[88:91], v125 offset:33024
  v_mfma_f32_32x32x16_bf16 v[36:51], v[76:79], a[40:43], v[36:51]
  s_waitcnt lgkmcnt(2)
  v_mfma_f32_32x32x16_bf16 v[20:35], v[172:175], v[80:83], v[20:35]
  ds_read_b128 v[92:95], v126 offset:33024
  v_mfma_f32_32x32x16_bf16 v[36:51], v[80:83], a[44:47], v[36:51]
  s_waitcnt lgkmcnt(2)
  v_mfma_f32_32x32x16_bf16 v[20:35], v[176:179], v[84:87], v[20:35]
  ds_read_b128 v[96:99], v127 offset:33024
  v_mfma_f32_32x32x16_bf16 v[36:51], v[84:87], a[48:51], v[36:51]
  s_waitcnt lgkmcnt(2)
  v_mfma_f32_32x32x16_bf16 v[20:35], v[180:183], v[88:91], v[20:35]
  ds_read_b128 v[68:71], v120 offset:33280
  v_mfma_f32_32x32x16_bf16 v[36:51], v[88:91], a[52:55], v[36:51]
  s_waitcnt lgkmcnt(2)
  v_mfma_f32_32x32x16_bf16 v[20:35], v[184:187], v[92:95], v[20:35]
  ds_read_b128 v[72:75], v121 offset:33280
  v_mfma_f32_32x32x16_bf16 v[36:51], v[92:95], a[56:59], v[36:51]
  s_waitcnt lgkmcnt(2)
  v_mfma_f32_32x32x16_bf16 v[20:35], v[188:191], v[96:99], v[20:35]
  ds_read_b128 v[76:79], v122 offset:33280
  v_mfma_f32_32x32x16_bf16 v[36:51], v[96:99], a[60:63], v[36:51]
  s_waitcnt lgkmcnt(2)
  v_mfma_f32_32x32x16_bf16 v[20:35], v[192:195], v[68:71], v[20:35]
  ds_read_b128 v[80:83], v123 offset:33280
  v_mfma_f32_32x32x16_bf16 v[36:51], v[68:71], a[64:67], v[36:51]
  s_waitcnt lgkmcnt(2)
  v_mfma_f32_32x32x16_bf16 v[20:35], v[196:199], v[72:75], v[20:35]
  ds_read_b128 v[84:87], v124 offset:33280
  v_mfma_f32_32x32x16_bf16 v[36:51], v[72:75], a[68:71], v[36:51]
  s_waitcnt lgkmcnt(2)
  v_mfma_f32_32x32x16_bf16 v[20:35], v[200:203], v[76:79], v[20:35]
  ds_read_b128 v[88:91], v125 offset:33280
  v_mfma_f32_32x32x16_bf16 v[36:51], v[76:79], a[72:75], v[36:51]
  s_waitcnt lgkmcnt(2)
  v_mfma_f32_32x32x16_bf16 v[20:35], v[204:207], v[80:83], v[20:35]
  ds_read_b128 v[92:95], v126 offset:33280
  s_waitcnt vmcnt(0)
  s_mov_b64 exec, 1
  buffer_store_dword v4, off, s[4:7], s49 sc1
  s_mov_b64 exec, -1
  v_mfma_f32_32x32x16_bf16 v[36:51], v[80:83], a[76:79], v[36:51]
  v_cmp_eq_u32 vcc, 0, v116
  v_max_u32_dpp v117, v116, v116 quad_perm:[1,0,3,2] row_mask:0xf bank_mask:0xf
  s_and_b32 s48, vcc_lo, 0xffffff
  s_cselect_b32 s48, 0, -1
  v_max_u32_dpp v117, v117, v117 quad_perm:[2,3,0,1] row_mask:0xf bank_mask:0xf
  s_nop 1
  s_waitcnt lgkmcnt(2)
  v_mfma_f32_32x32x16_bf16 v[20:35], v[208:211], v[84:87], v[20:35]
  ds_read_b128 v[96:99], v127 offset:33280
  v_max_u32_dpp v117, v117, v117 row_half_mirror row_mask:0xf bank_mask:0xf
  v_and_b32 v117, s48, v117
  s_cmp_lg_u32 s48, 0
  s_cselect_b32 s28, s47, s46
  s_and_b32 s63, s28, 127
  v_mfma_f32_32x32x16_bf16 v[36:51], v[84:87], a[80:83], v[36:51]
  s_lshl_b32 s63, s63, 15
  s_xor_b32 s27, s50, 32768
  s_add_u32 m0, s27, s54
  s_add_u32 s63, s63, s54
  s_add_u32 s63, s63, 6291456
  s_waitcnt lgkmcnt(2)
  v_mfma_f32_32x32x16_bf16 v[20:35], v[212:215], v[88:91], v[20:35]
  ds_read_b128 v[68:71], v120 offset:33536
  buffer_load_dwordx4 v12, s[4:7], s63 offen offset:0 sc1 lds
  v_mfma_f32_32x32x16_bf16 v[36:51], v[88:91], a[84:87], v[36:51]
  s_waitcnt lgkmcnt(2)
  v_mfma_f32_32x32x16_bf16 v[20:35], v[216:219], v[92:95], v[20:35]
  ds_read_b128 v[72:75], v121 offset:33536
  buffer_load_dwordx4 v13, s[4:7], s63 offen offset:1024 sc1 lds
  v_mfma_f32_32x32x16_bf16 v[36:51], v[92:95], a[88:91], v[36:51]
  s_waitcnt lgkmcnt(2)
  v_mfma_f32_32x32x16_bf16 v[20:35], v[220:223], v[96:99], v[20:35]
  ds_read_b128 v[76:79], v122 offset:33536
  buffer_load_dwordx4 v14, s[4:7], s63 offen offset:2048 sc1 lds
  v_mfma_f32_32x32x16_bf16 v[36:51], v[96:99], a[92:95], v[36:51]
  s_waitcnt lgkmcnt(2)
  v_mfma_f32_32x32x16_bf16 v[20:35], v[224:227], v[68:71], v[20:35]
  ds_read_b128 v[80:83], v123 offset:33536
  buffer_load_dwordx4 v15, s[4:7], s63 offen offset:3072 sc1 lds
  s_add_u32 m0, m0, 4096
  s_add_u32 s63, s63, 4096
  v_mfma_f32_32x32x16_bf16 v[36:51], v[68:71], a[96:99], v[36:51]
  s_waitcnt lgkmcnt(2)
  v_mfma_f32_32x32x16_bf16 v[20:35], v[228:231], v[72:75], v[20:35]
  ds_read_b128 v[84:87], v124 offset:33536
  buffer_load_dwordx4 v16, s[4:7], s63 offen offset:0 sc1 lds
  v_mfma_f32_32x32x16_bf16 v[36:51], v[72:75], a[100:103], v[36:51]
  s_waitcnt lgkmcnt(2)
  v_mfma_f32_32x32x16_bf16 v[20:35], v[232:235], v[76:79], v[20:35]
  ds_read_b128 v[88:91], v125 offset:33536
  buffer_load_dwordx4 v17, s[4:7], s63 offen offset:1024 sc1 lds
  v_mfma_f32_32x32x16_bf16 v[36:51], v[76:79], a[104:107], v[36:51]
  s_waitcnt lgkmcnt(2)
  v_mfma_f32_32x32x16_bf16 v[20:35], v[236:239], v[80:83], v[20:35]
  ds_read_b128 v[92:95], v126 offset:33536
  buffer_load_dwordx4 v18, s[4:7], s63 offen offset:2048 sc1 lds
  v_mfma_f32_32x32x16_bf16 v[36:51], v[80:83], a[108:111], v[36:51]
  s_waitcnt lgkmcnt(2)
  v_mfma_f32_32x32x16_bf16 v[20:35], v[240:243], v[84:87], v[20:35]
  ds_read_b128 v[96:99], v127 offset:33536
  buffer_load_dwordx4 v19, s[4:7], s63 offen offset:3072 sc1 lds
  s_add_u32 s49, s51, 16
  ds_write_b32 v118, v117 offset:128
  v_mfma_f32_32x32x16_bf16 v[36:51], v[84:87], a[112:115], v[36:51]
  s_waitcnt lgkmcnt(3)
  v_mfma_f32_32x32x16_bf16 v[20:35], v[244:247], v[88:91], v[20:35]
  ds_read_b128 v[68:71], v120 offset:32768
  v_mfma_f32_32x32x16_bf16 v[36:51], v[88:91], a[116:119], v[36:51]
  ds_read_b128 v[72:75], v121 offset:32768
  s_waitcnt lgkmcnt(4)
  v_mfma_f32_32x32x16_bf16 v[20:35], v[248:251], v[92:95], v[20:35]
  ds_read_b128 v[76:79], v122 offset:32768
  v_mfma_f32_32x32x16_bf16 v[36:51], v[92:95], a[120:123], v[36:51]
  ds_read_b128 v[80:83], v123 offset:32768
  s_waitcnt lgkmcnt(5)
  v_mfma_f32_32x32x16_bf16 v[20:35], v[252:255], v[96:99], v[20:35]
  ds_read_b128 v[84:87], v124 offset:32768
  v_mfma_f32_32x32x16_bf16 v[36:51], v[96:99], a[124:127], v[36:51]
  ds_read_b128 v[88:91], v125 offset:32768
  s_waitcnt lgkmcnt(4)
  v_mfma_f32_32x32x16_bf16 v[52:67], a[128:131], v[68:71], 0
  ds_read_b128 v[92:95], v126 offset:32768
  v_mfma_f32_32x32x16_bf16 v[52:67], a[132:135], v[72:75], v[52:67]
  ds_read_b128 v[96:99], v127 offset:32768
  v_mul_f32 v20, s24, v20
  v_mul_f32 v21, s24, v21
  v_mul_f32 v22, s24, v22
  v_mul_f32 v23, s24, v23
  v_mul_f32 v24, s24, v24
  s_waitcnt lgkmcnt(4)
  v_mfma_f32_32x32x16_bf16 v[52:67], a[136:139], v[76:79], v[52:67]
  ds_read_b128 v[68:71], v120 offset:33024
  v_mul_f32 v25, s24, v25
  v_cvt_pk_bf16_f32 v100, v36, v37
  v_cvt_pk_bf16_f32 v101, v38, v39
  v_cvt_pk_bf16_f32 v102, v44, v45
  v_cvt_pk_bf16_f32 v103, v46, v47
  v_mfma_f32_32x32x16_bf16 v[52:67], a[140:143], v[80:83], v[52:67]
  ds_read_b128 v[72:75], v121 offset:33024
  buffer_store_dwordx4 v[100:103], v8, s[4:7], s44 offen offset:2048 sc1
  v_cvt_pk_bf16_f32 v104, v40, v41
  v_cvt_pk_bf16_f32 v105, v42, v43
  s_waitcnt lgkmcnt(4)
  v_mfma_f32_32x32x16_bf16 v[52:67], a[144:147], v[84:87], v[52:67]
  ds_read_b128 v[76:79], v122 offset:33024
  v_cvt_pk_bf16_f32 v106, v48, v49
  v_cvt_pk_bf16_f32 v107, v50, v51
  buffer_store_dwordx4 v[104:107], v8, s[4:7], s44 offen offset:2560 sc1
  v_mfma_f32_32x32x16_bf16 v[52:67], a[148:151], v[88:91], v[52:67]
  ds_read_b128 v[80:83], v123 offset:33024
  v_mul_f32 v26, s24, v26
  v_mul_f32 v27, s24, v27
  v_mul_f32 v28, s24, v28
  v_mul_f32 v29, s24, v29
  v_mul_f32 v30, s24, v30
  s_waitcnt lgkmcnt(4)
  v_mfma_f32_32x32x16_bf16 v[52:67], a[152:155], v[92:95], v[52:67]
  ds_read_b128 v[84:87], v124 offset:33024
  v_mul_f32 v31, s24, v31
  v_mul_f32 v32, s24, v32
  v_mul_f32 v33, s24, v33
  v_mul_f32 v34, s24, v34
  v_mul_f32 v35, s24, v35
  v_mfma_f32_32x32x16_bf16 v[52:67], a[156:159], v[96:99], v[52:67]
  ds_read_b128 v[88:91], v125 offset:33024
  v_cvt_pk_bf16_f32 v108, v20, v21
  v_cvt_pk_bf16_f32 v109, v22, v23
  v_cvt_pk_bf16_f32 v110, v28, v29
  v_cvt_pk_bf16_f32 v111, v30, v31
  buffer_store_dwordx4 v[108:111], v8, s[4:7], s44 offen offset:0 sc1
  s_waitcnt lgkmcnt(4)
  v_mfma_f32_32x32x16_bf16 v[52:67], a[160:163], v[68:71], v[52:67]
  ds_read_b128 v[92:95], v126 offset:33024
  v_cvt_pk_bf16_f32 v112, v24, v25
  v_cvt_pk_bf16_f32 v113, v26, v27
  v_cvt_pk_bf16_f32 v114, v32, v33
  v_cvt_pk_bf16_f32 v115, v34, v35
  buffer_store_dwordx4 v[112:115], v8, s[4:7], s44 offen offset:512 sc1
  v_mfma_f32_32x32x16_bf16 v[52:67], a[164:167], v[72:75], v[52:67]
  ds_read_b128 v[96:99], v127 offset:33024
  s_waitcnt lgkmcnt(4)
  v_mfma_f32_32x32x16_bf16 v[52:67], a[168:171], v[76:79], v[52:67]
  ds_read_b128 v[68:71], v120 offset:33280
  v_mfma_f32_32x32x16_bf16 v[52:67], a[172:175], v[80:83], v[52:67]
  ds_read_b128 v[72:75], v121 offset:33280
  s_waitcnt lgkmcnt(4)
  v_mfma_f32_32x32x16_bf16 v[52:67], a[176:179], v[84:87], v[52:67]
  ds_read_b128 v[76:79], v122 offset:33280
  v_mfma_f32_32x32x16_bf16 v[52:67], a[180:183], v[88:91], v[52:67]
  ds_read_b128 v[80:83], v123 offset:33280
  s_waitcnt lgkmcnt(4)
  v_mfma_f32_32x32x16_bf16 v[52:67], a[184:187], v[92:95], v[52:67]
  ds_read_b128 v[84:87], v124 offset:33280
  v_mfma_f32_32x32x16_bf16 v[52:67], a[188:191], v[96:99], v[52:67]
  ds_read_b128 v[88:91], v125 offset:33280
  s_waitcnt lgkmcnt(4)
  v_mfma_f32_32x32x16_bf16 v[52:67], a[192:195], v[68:71], v[52:67]
  ds_read_b128 v[92:95], v126 offset:33280
  v_mfma_f32_32x32x16_bf16 v[52:67], a[196:199], v[72:75], v[52:67]
  ds_read_b128 v[96:99], v127 offset:33280
  s_waitcnt lgkmcnt(4)
  v_mfma_f32_32x32x16_bf16 v[52:67], a[200:203], v[76:79], v[52:67]
  ds_read_b128 v[68:71], v120 offset:33536
  v_mfma_f32_32x32x16_bf16 v[52:67], a[204:207], v[80:83], v[52:67]
  ds_read_b128 v[72:75], v121 offset:33536
  s_waitcnt lgkmcnt(4)
  v_mfma_f32_32x32x16_bf16 v[52:67], a[208:211], v[84:87], v[52:67]
  ds_read_b128 v[76:79], v122 offset:33536
  ds_read_b128 v[80:83], v123 offset:33536
  v_mfma_f32_32x32x16_bf16 v[52:67], a[212:215], v[88:91], v[52:67]
  ds_read_b128 v[84:87], v124 offset:33536
  ds_read_b128 v[88:91], v125 offset:33536
  s_waitcnt lgkmcnt(6)
  v_mfma_f32_32x32x16_bf16 v[52:67], a[216:219], v[92:95], v[52:67]
  ds_read_b128 v[92:95], v126 offset:33536
  v_mfma_f32_32x32x16_bf16 v[52:67], a[220:223], v[96:99], v[52:67]
  ds_read_b128 v[96:99], v127 offset:33536
  s_waitcnt lgkmcnt(6)
  v_mfma_f32_32x32x16_bf16 v[52:67], a[224:227], v[68:71], v[52:67]
  v_mfma_f32_32x32x16_bf16 v[52:67], a[228:231], v[72:75], v[52:67]
  s_waitcnt vmcnt(4) lgkmcnt(0)
  s_barrier
  ds_read_b128 v[100:103], v119 offset:128
  v_mfma_f32_32x32x16_bf16 v[52:67], a[232:235], v[76:79], v[52:67]
  ds_read_b128 v[68:71], v120 offset:0
  v_mfma_f32_32x32x16_bf16 v[52:67], a[236:239], v[80:83], v[52:67]
  ds_read_b128 v[72:75], v121 offset:0
  s_xor_b32 s50, s50, 32768
  v_mfma_f32_32x32x16_bf16 v[52:67], a[240:243], v[84:87], v[52:67]
  ds_read_b128 v[76:79], v122 offset:0
  s_waitcnt vmcnt(0)
  s_mov_b64 exec, 1
  buffer_store_dword v4, off, s[4:7], s51 sc1
  s_mov_b64 exec, -1
  v_mfma_f32_32x32x16_bf16 v[52:67], a[244:247], v[88:91], v[52:67]
  s_waitcnt lgkmcnt(3)
  v_min3_u32 v104, v100, v101, v102
  v_max3_u32 v100, v100, v101, v102
  v_min_u32 v104, v104, v103
  v_max_u32 v100, v100, v103
  v_readfirstlane_b32 s45, v104
  v_mfma_f32_32x32x16_bf16 v[52:67], a[248:251], v[92:95], v[52:67]
  v_readlane_b32 s28, v100, 0
  v_readlane_b32 s29, v100, 1
  v_readlane_b32 s30, v100, 2
  s_cmp_gt_u32 s55, 0
  s_cselect_b32 s45, 0, s45
  v_mfma_f32_32x32x16_bf16 v[52:67], a[252:255], v[96:99], v[52:67]
  s_cmp_eq_u32 s45, 0
  s_cbranch_scc1 q_slow_86
  s_cmp_lt_u32 s47, 64
  s_cbranch_scc1 q_w0_99
  s_cmp_gt_u32 s28, s56
  s_cselect_b32 s26, s40, 0
  s_max_u32 s56, s56, s28
  s_cmp_gt_u32 s26, 10
  s_subb_u32 s40, s40, 0
  s_cmp_gt_u32 s29, s56
  s_cselect_b32 s26, s40, 0
  s_max_u32 s56, s56, s29
  s_cmp_gt_u32 s26, 10
  s_subb_u32 s40, s40, 0
  s_cmp_gt_u32 s30, s56
  s_cselect_b32 s26, s40, 0
  s_max_u32 s56, s56, s30
  s_add_u32 s76, s47, s40
  s_add_u32 s41, s47, 3
  s_sub_u32 s76, s76, 64
  s_cmp_gt_u32 s26, 10
  s_cselect_b32 s76, 64, s76
  s_subb_u32 s40, s40, 0
  s_cmp_lt_u32 s76, 64
  s_cselect_b32 s76, s76, s41
  s_cmp_lg_u32 s26, 0
  s_cbranch_scc0 q_w0_99
  s_branch q_forkw_95
q_forkw_95:
  v_cvt_pk_bf16_f32 v100, v52, v53
  v_cvt_pk_bf16_f32 v101, v54, v55
  v_cvt_pk_bf16_f32 v102, v60, v61
  v_cvt_pk_bf16_f32 v103, v62, v63
  buffer_store_dwordx4 v[100:103], v8, s[4:7], s43 offen offset:0 sc1
  v_cvt_pk_bf16_f32 v104, v56, v57
  v_cvt_pk_bf16_f32 v105, v58, v59
  v_cvt_pk_bf16_f32 v106, v64, v65
  v_cvt_pk_bf16_f32 v107, v66, v67
  buffer_store_dwordx4 v[104:107], v8, s[4:7], s43 offen offset:512 sc1
  s_mov_b32 s43, 268435456
  s_waitcnt lgkmcnt(0)
q_fork_93:
  s_mov_b32 s58, s56
  s_mov_b32 s46, s47
  s_mov_b32 s47, s76
  s_add_u32 s76, s47, 3
  s_cmp_lt_u32 s76, 18
  s_cselect_b32 s76, s76, s41
  s_andn2_b32 s59, 0xfff, s58
  s_lshl_b32 s26, s61, 21
  s_lshl_b32 s27, s59, 10
  s_add_u32 s26, s26, s27
  s_lshl_b32 s27, s17, 8
  s_add_u32 s26, s26, s27
  s_add_u32 s26, s26, 27262976
  v_lshrrev_b32 v5, 7, v0
  v_lshlrev_b32 v5, 5, v5
  buffer_load_dwordx4 v[52:55], v5, s[4:7], s26 offen offset:0 sc1
  buffer_load_dwordx4 v[56:59], v5, s[4:7], s26 offen offset:16 sc1
  s_load_dwordx2 s[64:65], s[0:1], 72
  s_load_dwordx2 s[68:69], s[0:1], 80
  s_load_dwordx2 s[8:9], s[0:1], 88
  s_mov_b32 s66, 1835008
  s_mov_b32 s70, 1835008
  s_mov_b32 s10, 1835008
  v_lshrrev_b32 v2, 7, v0
  v_and_b32 v3, 0x70, v0
  v_mul_u32_u24 v6, 57344, v2
  v_add_u32 v6, v6, v3
  v_cmp_eq_u32 vcc, 0x70, v3
  v_mov_b32 v3, 0x7ff00000
  s_nop 0
  v_cndmask_b32 v6, v6, v3, vcc
  v_lshrrev_b32 v2, 8, v0
  v_mul_u32_u24 v7, 14336, v2
  v_and_b32 v3, 0xf0, v0
  v_add_u32 v7, v7, v3
  s_mul_i32 s34, s17, 458752
  s_mul_i32 s27, s16, 112
  s_add_u32 s34, s34, s27
  s_mul_i32 s35, s16, 57344
  s_lshl_b32 s27, s17, 8
  s_add_u32 s35, s35, s27
  s_waitcnt lgkmcnt(0)
  s_xor_b32 s37, s50, 32768
  s_add_u32 s37, s37, s54
  s_mov_b32 m0, s37
  s_add_u32 s36, s34, 39424
  buffer_load_dwordx4 v6, s[68:71], s36 offen lds
  s_add_u32 m0, m0, 1024
  s_add_u32 s36, s34, 43008
  buffer_load_dwordx4 v6, s[64:67], s36 offen lds
  s_add_u32 m0, m0, 1024
  s_add_u32 s36, s34, 43008
  buffer_load_dwordx4 v6, s[68:71], s36 offen lds
  s_add_u32 m0, m0, 1024
  s_add_u32 s36, s34, 46592
  buffer_load_dwordx4 v6, s[64:67], s36 offen lds
  s_add_u32 m0, m0, 1024
  s_add_u32 s36, s34, 46592
  buffer_load_dwordx4 v6, s[68:71], s36 offen lds
  s_add_u32 m0, m0, 1024
  s_add_u32 s36, s34, 50176
  buffer_load_dwordx4 v6, s[64:67], s36 offen lds
  s_add_u32 m0, m0, 1024
  s_add_u32 s36, s34, 50176
  buffer_load_dwordx4 v6, s[68:71], s36 offen lds
  s_add_u32 m0, m0, 1024
  s_add_u32 s36, s34, 53760
  buffer_load_dwordx4 v6, s[64:67], s36 offen lds
  s_add_u32 m0, m0, 1024
  s_add_u32 s36, s34, 53760
  buffer_load_dwordx4 v[60:63], v6, s[68:71], s36 offen
  buffer_load_dwordx4 v[64:67], v7, s[8:11], s35 offen offset:0
  v_add_u32 v120, s50, v120
  v_add_u32 v121, s50, v121
  v_add_u32 v122, s50, v122
  v_add_u32 v123, s50, v123
  v_add_u32 v124, s50, v124
  v_add_u32 v125, s50, v125
  v_add_u32 v126, s50, v126
  v_add_u32 v127, s50, v127
  s_lshl_b32 s52, s46, 7
  s_add_u32 s52, s52, s57
  s_lshl_b32 s77, s52, 12
  s_add_u32 s44, s77, 75497472
  s_add_u32 s77, s77, 41943040
  s_lshl_b32 s51, s52, 5
  s_add_u32 s51, s51, 244318208
  s_waitcnt vmcnt(12)
  s_barrier
  s_mov_b64 exec, 1
  buffer_store_dword v4, off, s[4:7], s49 sc1
  s_mov_b64 exec, -1
  v_mov_b32 v4, 2
  s_add_u32 s49, s51, 16
  ds_read_b128 v[68:71], v120 offset:0
  ds_read_b128 v[72:75], v121 offset:0
  ds_read_b128 v[76:79], v122 offset:0
  ds_read_b128 v[80:83], v123 offset:0
  s_waitcnt lgkmcnt(3)
  v_mfma_f32_32x32x16_bf16 v[20:35], v[128:131], v[68:71], 0
  v_mfma_f32_32x32x16_bf16 v[36:51], v[68:71], a[0:3], 0
  s_waitcnt lgkmcnt(2)
  v_mfma_f32_32x32x16_bf16 v[20:35], v[132:135], v[72:75], v[20:35]
  ds_read_b128 v[84:87], v124 offset:0
  v_mfma_f32_32x32x16_bf16 v[36:51], v[72:75], a[4:7], v[36:51]
  s_waitcnt lgkmcnt(2)
  v_mfma_f32_32x32x16_bf16 v[20:35], v[136:139], v[76:79], v[20:35]
  ds_read_b128 v[88:91], v125 offset:0
  v_mfma_f32_32x32x16_bf16 v[36:51], v[76:79], a[8:11], v[36:51]
  s_waitcnt lgkmcnt(2)
  v_mfma_f32_32x32x16_bf16 v[20:35], v[140:143], v[80:83], v[20:35]
  ds_read_b128 v[92:95], v126 offset:0
  v_mfma_f32_32x32x16_bf16 v[36:51], v[80:83], a[12:15], v[36:51]
  s_waitcnt lgkmcnt(2)
  v_mfma_f32_32x32x16_bf16 v[20:35], v[144:147], v[84:87], v[20:35]
  ds_read_b128 v[96:99], v127 offset:0
  v_mfma_f32_32x32x16_bf16 v[36:51], v[84:87], a[16:19], v[36:51]
  s_waitcnt lgkmcnt(2)
  v_mfma_f32_32x32x16_bf16 v[20:35], v[148:151], v[88:91], v[20:35]
  ds_read_b128 v[68:71], v120 offset:256
  v_mfma_f32_32x32x16_bf16 v[36:51], v[88:91], a[20:23], v[36:51]
  s_waitcnt lgkmcnt(2)
  v_mfma_f32_32x32x16_bf16 v[20:35], v[152:155], v[92:95], v[20:35]
  ds_read_b128 v[72:75], v121 offset:256
  v_mfma_f32_32x32x16_bf16 v[36:51], v[92:95], a[24:27], v[36:51]
  s_waitcnt lgkmcnt(2)
  v_mfma_f32_32x32x16_bf16 v[20:35], v[156:159], v[96:99], v[20:35]
  ds_read_b128 v[76:79], v122 offset:256
  v_mfma_f32_32x32x16_bf16 v[36:51], v[96:99], a[28:31], v[36:51]
  s_waitcnt lgkmcnt(2)
  v_mfma_f32_32x32x16_bf16 v[20:35], v[160:163], v[68:71], v[20:35]
  ds_read_b128 v[80:83], v123 offset:256
  v_mfma_f32_32x32x16_bf16 v[36:51], v[68:71], a[32:35], v[36:51]
  s_waitcnt lgkmcnt(2)
  v_mfma_f32_32x32x16_bf16 v[20:35], v[164:167], v[72:75], v[20:35]
  ds_read_b128 v[84:87], v124 offset:256
  v_mfma_f32_32x32x16_bf16 v[36:51], v[72:75], a[36:39], v[36:51]
  s_waitcnt lgkmcnt(2)
  v_mfma_f32_32x32x16_bf16 v[20:35], v[168:171], v[76:79], v[20:35]
  ds_read_b128 v[88:91], v125 offset:256
  v_mfma_f32_32x32x16_bf16 v[36:51], v[76:79], a[40:43], v[36:51]
  s_waitcnt lgkmcnt(2)
  v_mfma_f32_32x32x16_bf16 v[20:35], v[172:175], v[80:83], v[20:35]
  ds_read_b128 v[92:95], v126 offset:256
  v_mfma_f32_32x32x16_bf16 v[36:51], v[80:83], a[44:47], v[36:51]
  s_waitcnt lgkmcnt(2)
  v_mfma_f32_32x32x16_bf16 v[20:35], v[176:179], v[84:87], v[20:35]
  ds_read_b128 v[96:99], v127 offset:256
  v_mfma_f32_32x32x16_bf16 v[36:51], v[84:87], a[48:51], v[36:51]
  s_waitcnt lgkmcnt(2)
  v_mfma_f32_32x32x16_bf16 v[20:35], v[180:183], v[88:91], v[20:35]
  ds_read_b128 v[68:71], v120 offset:512
  v_mfma_f32_32x32x16_bf16 v[36:51], v[88:91], a[52:55], v[36:51]
  s_waitcnt lgkmcnt(2)
  v_mfma_f32_32x32x16_bf16 v[20:35], v[184:187], v[92:95], v[20:35]
  ds_read_b128 v[72:75], v121 offset:512
  v_mfma_f32_32x32x16_bf16 v[36:51], v[92:95], a[56:59], v[36:51]
  s_waitcnt lgkmcnt(2)
  v_mfma_f32_32x32x16_bf16 v[20:35], v[188:191], v[96:99], v[20:35]
  ds_read_b128 v[76:79], v122 offset:512
  v_mfma_f32_32x32x16_bf16 v[36:51], v[96:99], a[60:63], v[36:51]
  s_waitcnt lgkmcnt(2)
  v_mfma_f32_32x32x16_bf16 v[20:35], v[192:195], v[68:71], v[20:35]
  ds_read_b128 v[80:83], v123 offset:512
  v_mfma_f32_32x32x16_bf16 v[36:51], v[68:71], a[64:67], v[36:51]
  s_waitcnt lgkmcnt(2)
  v_mfma_f32_32x32x16_bf16 v[20:35], v[196:199], v[72:75], v[20:35]
  ds_read_b128 v[84:87], v124 offset:512
  v_mfma_f32_32x32x16_bf16 v[36:51], v[72:75], a[68:71], v[36:51]
  s_waitcnt lgkmcnt(2)
  v_mfma_f32_32x32x16_bf16 v[20:35], v[200:203], v[76:79], v[20:35]
  ds_read_b128 v[88:91], v125 offset:512
  v_mfma_f32_32x32x16_bf16 v[36:51], v[76:79], a[72:75], v[36:51]
  s_waitcnt lgkmcnt(2)
  v_mfma_f32_32x32x16_bf16 v[20:35], v[204:207], v[80:83], v[20:35]
  ds_read_b128 v[92:95], v126 offset:512
  v_mfma_f32_32x32x16_bf16 v[36:51], v[80:83], a[76:79], v[36:51]
  s_waitcnt lgkmcnt(2)
  v_mfma_f32_32x32x16_bf16 v[20:35], v[208:211], v[84:87], v[20:35]
  ds_read_b128 v[96:99], v127 offset:512
  v_mfma_f32_32x32x16_bf16 v[36:51], v[84:87], a[80:83], v[36:51]
  s_waitcnt lgkmcnt(2)
  v_mfma_f32_32x32x16_bf16 v[20:35], v[212:215], v[88:91], v[20:35]
  ds_read_b128 v[68:71], v120 offset:768
  v_mfma_f32_32x32x16_bf16 v[36:51], v[88:91], a[84:87], v[36:51]
  s_waitcnt lgkmcnt(2)
  v_mfma_f32_32x32x16_bf16 v[20:35], v[216:219], v[92:95], v[20:35]
  ds_read_b128 v[72:75], v121 offset:768
  v_mfma_f32_32x32x16_bf16 v[36:51], v[92:95], a[88:91], v[36:51]
  s_waitcnt lgkmcnt(2)
  v_mfma_f32_32x32x16_bf16 v[20:35], v[220:223], v[96:99], v[20:35]
  ds_read_b128 v[76:79], v122 offset:768
  v_mfma_f32_32x32x16_bf16 v[36:51], v[96:99], a[92:95], v[36:51]
  s_waitcnt lgkmcnt(2)
  v_mfma_f32_32x32x16_bf16 v[20:35], v[224:227], v[68:71], v[20:35]
  ds_read_b128 v[80:83], v123 offset:768
  v_mfma_f32_32x32x16_bf16 v[36:51], v[68:71], a[96:99], v[36:51]
  s_waitcnt lgkmcnt(2)
  v_mfma_f32_32x32x16_bf16 v[20:35], v[228:231], v[72:75], v[20:35]
  ds_read_b128 v[84:87], v124 offset:768
  v_mfma_f32_32x32x16_bf16 v[36:51], v[72:75], a[100:103], v[36:51]
  s_waitcnt lgkmcnt(2)
  v_mfma_f32_32x32x16_bf16 v[20:35], v[232:235], v[76:79], v[20:35]
  ds_read_b128 v[88:91], v125 offset:768
  v_mfma_f32_32x32x16_bf16 v[36:51], v[76:79], a[104:107], v[36:51]
  s_waitcnt lgkmcnt(2)
  v_mfma_f32_32x32x16_bf16 v[20:35], v[236:239], v[80:83], v[20:35]
  ds_read_b128 v[92:95], v126 offset:768
  v_mfma_f32_32x32x16_bf16 v[36:51], v[80:83], a[108:111], v[36:51]
  s_waitcnt lgkmcnt(2)
  v_mfma_f32_32x32x16_bf16 v[20:35], v[240:243], v[84:87], v[20:35]
  ds_read_b128 v[96:99], v127 offset:768
  v_mfma_f32_32x32x16_bf16 v[36:51], v[84:87], a[112:115], v[36:51]
  s_waitcnt lgkmcnt(2)
  v_mfma_f32_32x32x16_bf16 v[20:35], v[244:247], v[88:91], v[20:35]
  v_mfma_f32_32x32x16_bf16 v[36:51], v[88:91], a[116:119], v[36:51]
  s_waitcnt lgkmcnt(1)
  v_mfma_f32_32x32x16_bf16 v[20:35], v[248:251], v[92:95], v[20:35]
  v_mfma_f32_32x32x16_bf16 v[36:51], v[92:95], a[120:123], v[36:51]
  s_waitcnt lgkmcnt(0)
  v_mfma_f32_32x32x16_bf16 v[20:35], v[252:255], v[96:99], v[20:35]
  v_mfma_f32_32x32x16_bf16 v[36:51], v[96:99], a[124:127], v[36:51]
  s_nop 3
  v_mul_f32 v20, s24, v20
  v_mul_f32 v21, s24, v21
  v_mul_f32 v22, s24, v22
  v_mul_f32 v23, s24, v23
  v_mul_f32 v24, s24, v24
  v_mul_f32 v25, s24, v25
  v_mul_f32 v26, s24, v26
  v_mul_f32 v27, s24, v27
  v_mul_f32 v28, s24, v28
  v_mul_f32 v29, s24, v29
  v_mul_f32 v30, s24, v30
  v_mul_f32 v31, s24, v31
  v_mul_f32 v32, s24, v32
  v_mul_f32 v33, s24, v33
  v_mul_f32 v34, s24, v34
  v_mul_f32 v35, s24, v35
  v_cvt_pk_bf16_f32 v108, v20, v21
  v_cvt_pk_bf16_f32 v109, v22, v23
  v_cvt_pk_bf16_f32 v110, v28, v29
  v_cvt_pk_bf16_f32 v111, v30, v31
  buffer_store_dwordx4 v[108:111], v8, s[4:7], s77 offen offset:0 sc1
  v_cvt_pk_bf16_f32 v112, v24, v25
  v_cvt_pk_bf16_f32 v113, v26, v27
  v_cvt_pk_bf16_f32 v114, v32, v33
  v_cvt_pk_bf16_f32 v115, v34, v35
  buffer_store_dwordx4 v[112:115], v8, s[4:7], s77 offen offset:512 sc1
  v_cvt_pk_bf16_f32 v100, v36, v37
  v_cvt_pk_bf16_f32 v101, v38, v39
  v_cvt_pk_bf16_f32 v102, v44, v45
  v_cvt_pk_bf16_f32 v103, v46, v47
  buffer_store_dwordx4 v[100:103], v8, s[4:7], s77 offen offset:2048 sc1
  v_cvt_pk_bf16_f32 v104, v40, v41
  v_cvt_pk_bf16_f32 v105, v42, v43
  v_cvt_pk_bf16_f32 v106, v48, v49
  v_cvt_pk_bf16_f32 v107, v50, v51
  buffer_store_dwordx4 v[104:107], v8, s[4:7], s77 offen offset:2560 sc1
  buffer_store_dwordx4 v[108:111], v8, s[4:7], s44 offen offset:0 sc1
  buffer_store_dwordx4 v[112:115], v8, s[4:7], s44 offen offset:512 sc1
  buffer_store_dwordx4 v[100:103], v8, s[4:7], s44 offen offset:2048 sc1
  buffer_store_dwordx4 v[104:107], v8, s[4:7], s44 offen offset:2560 sc1
  buffer_load_dwordx4 v[68:71], v7, s[8:11], s35 offen offset:1024
  buffer_load_dwordx4 v[72:75], v7, s[8:11], s35 offen offset:2048
  buffer_load_dwordx4 v[76:79], v7, s[8:11], s35 offen offset:3072
  s_add_u32 s35, s35, 4096
  buffer_load_dwordx4 v[80:83], v7, s[8:11], s35 offen offset:0
  buffer_load_dwordx4 v[84:87], v7, s[8:11], s35 offen offset:1024
  buffer_load_dwordx4 v[88:91], v7, s[8:11], s35 offen offset:2048
  buffer_load_dwordx4 v[92:95], v7, s[8:11], s35 offen offset:3072
  s_add_u32 s35, s35, 4096
  buffer_load_dwordx4 v[96:99], v7, s[8:11], s35 offen offset:0
  buffer_load_dwordx4 v[100:103], v7, s[8:11], s35 offen offset:1024
  buffer_load_dwordx4 v[104:107], v7, s[8:11], s35 offen offset:2048
  buffer_load_dwordx4 v[108:111], v7, s[8:11], s35 offen offset:3072
  s_add_u32 s35, s35, 4096
  buffer_load_dwordx4 v[112:115], v7, s[8:11], s35 offen offset:0
  buffer_load_dwordx4 v[48:51], v7, s[8:11], s35 offen offset:1024
  s_mov_b32 vcc_lo, 0xaaaaaaaa
  s_mov_b32 vcc_hi, 0xaaaaaaaa
  v_mov_b32 v3, 0xffff
  v_mov_b32 v24, 0xffff0000
  v_cndmask_b32 v3, v3, v24, vcc
  s_mov_b32 vcc_lo, 0x3030303
  s_mov_b32 vcc_hi, 0x3030303
  v_cndmask_b32 v24, 0, v3, vcc
  s_mov_b32 vcc_lo, 0xc0c0c0c
  s_mov_b32 vcc_hi, 0xc0c0c0c
  v_cndmask_b32 v25, 0, v3, vcc
  s_mov_b32 vcc_lo, 0x30303030
  s_mov_b32 vcc_hi, 0x30303030
  v_cndmask_b32 v26, 0, v3, vcc
  s_mov_b32 vcc_lo, 0xc0c0c0c0
  s_mov_b32 vcc_hi, 0xc0c0c0c0
  v_cndmask_b32 v27, 0, v3, vcc
  s_mov_b32 s30, 0x01000100
  s_mov_b32 s31, 0x03020302
  s_mul_i32 s26, s17, 23552
  s_add_u32 s26, s26, 65536
  v_add_u32 v5, s26, v0
  v_add_u32 v2, s37, v0
  ds_read_b128 v[36:39], v5 offset:0
  ds_read_b128 v[40:43], v5 offset:1024
  ds_read_b128 v[44:47], v5 offset:2048
  ds_read_b128 v[12:15], v5 offset:3072
  ds_read_b128 v[16:19], v5 offset:4096
  ds_read_b128 v[120:123], v5 offset:5120
  ds_read_b128 v[124:127], v5 offset:6144
  s_waitcnt vmcnt(32)
  s_waitcnt vmcnt(17)
  s_mov_b64 exec, 1
  buffer_store_dword v4, off, s[4:7], s51 sc1
  s_mov_b64 exec, -1
  v_perm_b32 v3, v52, v52, s30
  v_and_b32 v20, v24, v3
  v_and_b32 v21, v25, v3
  v_and_b32 v22, v26, v3
  v_and_b32 v23, v27, v3
  s_waitcnt lgkmcnt(5)
  s_nop 0
  v_mfma_f32_16x16x32_bf16 v[28:31], v[20:23], v[36:39], 0
  ds_read_b128 v[36:39], v5 offset:7168
  v_mfma_f32_16x16x32_bf16 v[32:35], v[20:23], v[40:43], 0
  ds_read_b128 v[40:43], v5 offset:8192
  v_perm_b32 v3, v52, v52, s31
  v_and_b32 v20, v24, v3
  v_and_b32 v21, v25, v3
  v_and_b32 v22, v26, v3
  v_and_b32 v23, v27, v3
  s_waitcnt lgkmcnt(5)
  s_nop 0
  v_mfma_f32_16x16x32_bf16 v[28:31], v[20:23], v[44:47], v[28:31]
  ds_read_b128 v[44:47], v5 offset:9216
  v_mfma_f32_16x16x32_bf16 v[32:35], v[20:23], v[12:15], v[32:35]
  ds_read_b128 v[12:15], v5 offset:10240
  v_perm_b32 v3, v53, v53, s30
  v_and_b32 v20, v24, v3
  v_and_b32 v21, v25, v3
  v_and_b32 v22, v26, v3
  v_and_b32 v23, v27, v3
  s_waitcnt lgkmcnt(5)
  s_nop 0
  v_mfma_f32_16x16x32_bf16 v[28:31], v[20:23], v[16:19], v[28:31]
  ds_read_b128 v[16:19], v5 offset:11264
  v_mfma_f32_16x16x32_bf16 v[32:35], v[20:23], v[120:123], v[32:35]
  ds_read_b128 v[120:123], v5 offset:12288
  v_perm_b32 v3, v53, v53, s31
  v_and_b32 v20, v24, v3
  v_and_b32 v21, v25, v3
  v_and_b32 v22, v26, v3
  v_and_b32 v23, v27, v3
  s_waitcnt lgkmcnt(5)
  s_nop 0
  v_mfma_f32_16x16x32_bf16 v[28:31], v[20:23], v[124:127], v[28:31]
  ds_read_b128 v[124:127], v5 offset:13312
  v_mfma_f32_16x16x32_bf16 v[32:35], v[20:23], v[36:39], v[32:35]
  ds_read_b128 v[36:39], v5 offset:14336
  v_perm_b32 v3, v54, v54, s30
  v_and_b32 v20, v24, v3
  v_and_b32 v21, v25, v3
  v_and_b32 v22, v26, v3
  v_and_b32 v23, v27, v3
  s_waitcnt lgkmcnt(5)
  s_nop 0
  v_mfma_f32_16x16x32_bf16 v[28:31], v[20:23], v[40:43], v[28:31]
  ds_read_b128 v[40:43], v5 offset:15360
  v_mfma_f32_16x16x32_bf16 v[32:35], v[20:23], v[44:47], v[32:35]
  ds_read_b128 v[44:47], v5 offset:16384
  v_perm_b32 v3, v54, v54, s31
  v_and_b32 v20, v24, v3
  v_and_b32 v21, v25, v3
  v_and_b32 v22, v26, v3
  v_and_b32 v23, v27, v3
  s_waitcnt lgkmcnt(5)
  s_nop 0
  v_mfma_f32_16x16x32_bf16 v[28:31], v[20:23], v[12:15], v[28:31]
  ds_read_b128 v[12:15], v5 offset:17408
  v_mfma_f32_16x16x32_bf16 v[32:35], v[20:23], v[16:19], v[32:35]
  ds_read_b128 v[16:19], v5 offset:18432
  v_perm_b32 v3, v55, v55, s30
  v_and_b32 v20, v24, v3
  v_and_b32 v21, v25, v3
  v_and_b32 v22, v26, v3
  v_and_b32 v23, v27, v3
  s_waitcnt lgkmcnt(5)
  s_nop 0
  v_mfma_f32_16x16x32_bf16 v[28:31], v[20:23], v[120:123], v[28:31]
  ds_read_b128 v[120:123], v5 offset:19456
  v_mfma_f32_16x16x32_bf16 v[32:35], v[20:23], v[124:127], v[32:35]
  ds_read_b128 v[124:127], v5 offset:20480
  v_perm_b32 v3, v55, v55, s31
  v_and_b32 v20, v24, v3
  v_and_b32 v21, v25, v3
  v_and_b32 v22, v26, v3
  v_and_b32 v23, v27, v3
  s_waitcnt lgkmcnt(5)
  s_nop 0
  v_mfma_f32_16x16x32_bf16 v[28:31], v[20:23], v[36:39], v[28:31]
  ds_read_b128 v[36:39], v5 offset:21504
  v_mfma_f32_16x16x32_bf16 v[32:35], v[20:23], v[40:43], v[32:35]
  ds_read_b128 v[40:43], v5 offset:22528
  v_perm_b32 v3, v56, v56, s30
  v_and_b32 v20, v24, v3
  v_and_b32 v21, v25, v3
  v_and_b32 v22, v26, v3
  v_and_b32 v23, v27, v3
  s_waitcnt lgkmcnt(5)
  s_nop 0
  v_mfma_f32_16x16x32_bf16 v[28:31], v[20:23], v[44:47], v[28:31]
  ds_read_b128 v[44:47], v2 offset:0
  v_mfma_f32_16x16x32_bf16 v[32:35], v[20:23], v[12:15], v[32:35]
  ds_read_b128 v[12:15], v2 offset:1024
  v_perm_b32 v3, v56, v56, s31
  v_and_b32 v20, v24, v3
  v_and_b32 v21, v25, v3
  v_and_b32 v22, v26, v3
  v_and_b32 v23, v27, v3
  s_waitcnt lgkmcnt(5)
  s_nop 0
  v_mfma_f32_16x16x32_bf16 v[28:31], v[20:23], v[16:19], v[28:31]
  ds_read_b128 v[16:19], v2 offset:2048
  v_mfma_f32_16x16x32_bf16 v[32:35], v[20:23], v[120:123], v[32:35]
  ds_read_b128 v[120:123], v2 offset:3072
  v_perm_b32 v3, v57, v57, s30
  v_and_b32 v20, v24, v3
  v_and_b32 v21, v25, v3
  v_and_b32 v22, v26, v3
  v_and_b32 v23, v27, v3
  s_waitcnt lgkmcnt(5)
  s_nop 0
  v_mfma_f32_16x16x32_bf16 v[28:31], v[20:23], v[124:127], v[28:31]
  ds_read_b128 v[124:127], v2 offset:4096
  v_mfma_f32_16x16x32_bf16 v[32:35], v[20:23], v[36:39], v[32:35]
  ds_read_b128 v[36:39], v2 offset:5120
  v_perm_b32 v3, v57, v57, s31
  v_and_b32 v20, v24, v3
  v_and_b32 v21, v25, v3
  v_and_b32 v22, v26, v3
  v_and_b32 v23, v27, v3
  s_waitcnt lgkmcnt(5)
  s_nop 0
  v_mfma_f32_16x16x32_bf16 v[28:31], v[20:23], v[40:43], v[28:31]
  ds_read_b128 v[40:43], v2 offset:6144
  v_mfma_f32_16x16x32_bf16 v[32:35], v[20:23], v[44:47], v[32:35]
  ds_read_b128 v[44:47], v2 offset:7168
  v_perm_b32 v3, v58, v58, s30
  v_and_b32 v20, v24, v3
  v_and_b32 v21, v25, v3
  v_and_b32 v22, v26, v3
  v_and_b32 v23, v27, v3
  s_waitcnt lgkmcnt(5)
  s_nop 0
  v_mfma_f32_16x16x32_bf16 v[28:31], v[20:23], v[12:15], v[28:31]
  v_mfma_f32_16x16x32_bf16 v[32:35], v[20:23], v[16:19], v[32:35]
  v_perm_b32 v3, v58, v58, s31
  v_and_b32 v20, v24, v3
  v_and_b32 v21, v25, v3
  v_and_b32 v22, v26, v3
  v_and_b32 v23, v27, v3
  s_waitcnt lgkmcnt(3)
  s_nop 0
  v_mfma_f32_16x16x32_bf16 v[28:31], v[20:23], v[120:123], v[28:31]
  v_mfma_f32_16x16x32_bf16 v[32:35], v[20:23], v[124:127], v[32:35]
  v_perm_b32 v3, v59, v59, s30
  v_and_b32 v20, v24, v3
  v_and_b32 v21, v25, v3
  v_and_b32 v22, v26, v3
  v_and_b32 v23, v27, v3
  s_waitcnt lgkmcnt(1)
  s_nop 0
  v_mfma_f32_16x16x32_bf16 v[28:31], v[20:23], v[36:39], v[28:31]
  v_mfma_f32_16x16x32_bf16 v[32:35], v[20:23], v[40:43], v[32:35]
  v_perm_b32 v3, v59, v59, s31
  v_and_b32 v20, v24, v3
  v_and_b32 v21, v25, v3
  v_and_b32 v22, v26, v3
  v_and_b32 v23, v27, v3
  s_waitcnt lgkmcnt(0)
  s_nop 0
  v_mfma_f32_16x16x32_bf16 v[28:31], v[20:23], v[44:47], v[28:31]
  v_mfma_f32_16x16x32_bf16 v[32:35], v[20:23], v[60:63], v[32:35]
  v_lshrrev_b32 v2, 8, v0
  v_and_b32 v3, 0xf0, v0
  v_lshlrev_b32 v3, 1, v3
  v_and_b32 v5, 1, v2
  v_lshl_add_u32 v5, v5, 4, v3
  v_add_u32 v5, s37, v5
  s_mov_b32 exec_lo, 0x00ff00ff
  s_mov_b32 exec_hi, 0xff00ff00
  ds_write_b128 v5, v[28:31]
  ds_write_b128 v5, v[32:35] offset:512
  s_mov_b64 exec, -1
  s_xor_b32 s26, s50, 32768
  v_add_u32 v5, s26, v1
  v_lshl_add_u32 v3, v2, 4, v3
  s_waitcnt lgkmcnt(0)
  s_barrier
  ds_read2st64_b32 v[36:37], v5 offset0:0 offset1:1
  ds_read2st64_b32 v[52:53], v5 offset0:2 offset1:3
  ds_read2st64_b32 v[38:39], v5 offset0:32 offset1:33
  ds_read2st64_b32 v[54:55], v5 offset0:34 offset1:35
  ds_read2st64_b32 v[40:41], v5 offset0:64 offset1:65
  ds_read2st64_b32 v[56:57], v5 offset0:66 offset1:67
  ds_read2st64_b32 v[42:43], v5 offset0:96 offset1:97
  ds_read2st64_b32 v[58:59], v5 offset0:98 offset1:99
  s_waitcnt lgkmcnt(0)
  v_add_f32 v36, v36, v40
  v_add_f32 v37, v37, v41
  v_add_f32 v38, v38, v42
  v_add_f32 v39, v39, v43
  v_add_f32 v52, v52, v56
  v_add_f32 v53, v53, v57
  v_add_f32 v54, v54, v58
  v_add_f32 v55, v55, v59
  v_add_f32 v36, v36, v38
  v_add_f32 v37, v37, v39
  v_add_f32 v52, v52, v54
  v_add_f32 v53, v53, v55
  v_add_f32 v36, v36, v37
  v_add_f32 v52, v52, v53
  v_cvt_pk_bf16_f32 v36, 0, v36
  v_cvt_pk_bf16_f32 v52, 0, v52
  v_mul_f32 v40, 0xbfb8aa3b, v36
  v_exp_f32 v40, v40
  s_nop 0
  v_add_f32 v40, 1.0, v40
  v_rcp_f32 v40, v40
  s_nop 0
  v_mul_f32 v36, v36, v40
  v_cvt_pk_bf16_f32 v36, 0, v36
  v_mul_f32 v36, v36, v52
  v_cvt_pk_bf16_f32 v36, v36, v36
  s_lshl_b32 s26, s17, 8
  s_add_u32 s26, s26, 161792
  v_add_u32 v5, s26, v1
  ds_write_b32 v5, v36
  v_mul_u32_u24 v5, 56, v2
  v_add_u32 v5, s26, v5
  ds_read_b64 v[36:37], v5 offset:0
  ds_read_b64 v[38:39], v5 offset:8
  ds_read_b64 v[40:41], v5 offset:16
  ds_read_b64 v[42:43], v5 offset:24
  ds_read_b64 v[44:45], v5 offset:32
  ds_read_b64 v[46:47], v5 offset:40
  ds_read_b64 v[52:53], v5 offset:48
  s_waitcnt lgkmcnt(0)
  v_and_b32 v20, v24, v36
  v_and_b32 v21, v25, v36
  v_and_b32 v22, v26, v36
  v_and_b32 v23, v27, v36
  s_nop 0
  s_nop 0
  v_mfma_f32_16x16x32_bf16 v[28:31], v[20:23], v[64:67], 0
  v_and_b32 v32, v24, v37
  v_and_b32 v33, v25, v37
  v_and_b32 v34, v26, v37
  v_and_b32 v35, v27, v37
  s_waitcnt vmcnt(13)
  s_nop 0
  v_mfma_f32_16x16x32_bf16 v[28:31], v[32:35], v[68:71], v[28:31]
  v_and_b32 v20, v24, v38
  v_and_b32 v21, v25, v38
  v_and_b32 v22, v26, v38
  v_and_b32 v23, v27, v38
  s_waitcnt vmcnt(12)
  s_nop 0
  v_mfma_f32_16x16x32_bf16 v[28:31], v[20:23], v[72:75], v[28:31]
  v_and_b32 v32, v24, v39
  v_and_b32 v33, v25, v39
  v_and_b32 v34, v26, v39
  v_and_b32 v35, v27, v39
  s_waitcnt vmcnt(11)
  s_nop 0
  v_mfma_f32_16x16x32_bf16 v[28:31], v[32:35], v[76:79], v[28:31]
  v_and_b32 v20, v24, v40
  v_and_b32 v21, v25, v40
  v_and_b32 v22, v26, v40
  v_and_b32 v23, v27, v40
  s_waitcnt vmcnt(10)
  s_nop 0
  v_mfma_f32_16x16x32_bf16 v[28:31], v[20:23], v[80:83], v[28:31]
  v_and_b32 v32, v24, v41
  v_and_b32 v33, v25, v41
  v_and_b32 v34, v26, v41
  v_and_b32 v35, v27, v41
  s_waitcnt vmcnt(9)
  s_nop 0
  v_mfma_f32_16x16x32_bf16 v[28:31], v[32:35], v[84:87], v[28:31]
  v_and_b32 v20, v24, v42
  v_and_b32 v21, v25, v42
  v_and_b32 v22, v26, v42
  v_and_b32 v23, v27, v42
  s_waitcnt vmcnt(8)
  s_nop 0
  v_mfma_f32_16x16x32_bf16 v[28:31], v[20:23], v[88:91], v[28:31]
  v_and_b32 v32, v24, v43
  v_and_b32 v33, v25, v43
  v_and_b32 v34, v26, v43
  v_and_b32 v35, v27, v43
  s_waitcnt vmcnt(7)
  s_nop 0
  v_mfma_f32_16x16x32_bf16 v[28:31], v[32:35], v[92:95], v[28:31]
  v_and_b32 v20, v24, v44
  v_and_b32 v21, v25, v44
  v_and_b32 v22, v26, v44
  v_and_b32 v23, v27, v44
  s_waitcnt vmcnt(6)
  s_nop 0
  v_mfma_f32_16x16x32_bf16 v[28:31], v[20:23], v[96:99], v[28:31]
  v_and_b32 v32, v24, v45
  v_and_b32 v33, v25, v45
  v_and_b32 v34, v26, v45
  v_and_b32 v35, v27, v45
  s_waitcnt vmcnt(5)
  s_nop 0
  v_mfma_f32_16x16x32_bf16 v[28:31], v[32:35], v[100:103], v[28:31]
  v_and_b32 v20, v24, v46
  v_and_b32 v21, v25, v46
  v_and_b32 v22, v26, v46
  v_and_b32 v23, v27, v46
  s_waitcnt vmcnt(4)
  s_nop 0
  v_mfma_f32_16x16x32_bf16 v[28:31], v[20:23], v[104:107], v[28:31]
  v_and_b32 v32, v24, v47
  v_and_b32 v33, v25, v47
  v_and_b32 v34, v26, v47
  v_and_b32 v35, v27, v47
  s_waitcnt vmcnt(3)
  s_nop 0
  v_mfma_f32_16x16x32_bf16 v[28:31], v[32:35], v[108:111], v[28:31]
  v_and_b32 v20, v24, v52
  v_and_b32 v21, v25, v52
  v_and_b32 v22, v26, v52
  v_and_b32 v23, v27, v52
  s_waitcnt vmcnt(2)
  s_nop 0
  v_mfma_f32_16x16x32_bf16 v[28:31], v[20:23], v[112:115], v[28:31]
  v_and_b32 v32, v24, v53
  v_and_b32 v33, v25, v53
  v_and_b32 v34, v26, v53
  v_and_b32 v35, v27, v53
  s_waitcnt vmcnt(1)
  s_nop 0
  v_mfma_f32_16x16x32_bf16 v[28:31], v[32:35], v[48:51], v[28:31]
  v_lshrrev_b32 v3, 1, v3
  s_lshl_b32 s26, s46, 7
  s_add_u32 s26, s26, s57
  s_lshl_b32 s26, s26, 8
  s_add_u32 s26, s26, 244318208
  s_nop 2
  v_cvt_pk_bf16_f32 v28, v28, v29
  v_cvt_pk_bf16_f32 v29, v30, v31
  v_min_u32 v28, -2, v28
  v_min_u32 v29, -2, v29
  s_mov_b32 exec_hi, 0
  buffer_store_dwordx2 v[28:29], v3, s[4:7], s26 offen sc1
  s_mov_b32 exec_hi, -1
  v_lshrrev_b32 v7, 7, v0
  v_lshlrev_b32 v7, 12, v7
  v_and_b32 v2, 1023, v9
  s_lshl_b32 s26, s17, 10
  v_add3_u32 v7, v7, v2, s26
  v_mov_b32 v116, 0
  v_lshrrev_b32 v24, 9, v0
  v_lshlrev_b32 v24, 4, v24
  v_and_b32 v25, 0xf0, v0
  v_xor_b32 v24, v24, v25
  v_and_b32 v25, 0x1f0, v0
  v_lshl_add_u32 v24, v25, 6, v24
  v_add_u32 v24, s50, v24
  v_xor_b32 v120, 0, v24
  v_xor_b32 v121, 32, v24
  v_xor_b32 v122, 64, v24
  v_xor_b32 v123, 96, v24
  v_xor_b32 v124, 128, v24
  v_xor_b32 v125, 160, v24
  v_xor_b32 v126, 192, v24
  v_xor_b32 v127, 224, v24
  s_and_b32 s26, s17, 1
  s_lshl_b32 s26, s26, 7
  v_xor_b32 v24, s26, v0
  v_xor_b32 v12, 0, v24
  v_xor_b32 v13, 16, v24
  v_xor_b32 v14, 32, v24
  v_xor_b32 v15, 48, v24
  v_xor_b32 v16, 64, v24
  v_xor_b32 v17, 80, v24
  v_xor_b32 v18, 96, v24
  v_xor_b32 v19, 112, v24
  ds_read_b128 v[68:71], v120 offset:0
  ds_read_b128 v[72:75], v121 offset:0
  ds_read_b128 v[76:79], v122 offset:0
  ds_read_b128 v[80:83], v123 offset:0
  s_waitcnt lgkmcnt(2)
  v_mfma_f32_32x32x16_bf16 v[52:67], a[128:131], v[68:71], 0
  ds_read_b128 v[84:87], v124 offset:0
  ds_read_b128 v[88:91], v125 offset:0
  ds_read_b128 v[92:95], v126 offset:0
  v_mfma_f32_32x32x16_bf16 v[52:67], a[132:135], v[72:75], v[52:67]
  ds_read_b128 v[96:99], v127 offset:0
  s_waitcnt lgkmcnt(4)
  v_mfma_f32_32x32x16_bf16 v[52:67], a[136:139], v[76:79], v[52:67]
  ds_read_b128 v[68:71], v120 offset:256
  v_mfma_f32_32x32x16_bf16 v[52:67], a[140:143], v[80:83], v[52:67]
  ds_read_b128 v[72:75], v121 offset:256
  s_waitcnt lgkmcnt(4)
  v_mfma_f32_32x32x16_bf16 v[52:67], a[144:147], v[84:87], v[52:67]
  ds_read_b128 v[76:79], v122 offset:256
  v_mfma_f32_32x32x16_bf16 v[52:67], a[148:151], v[88:91], v[52:67]
  ds_read_b128 v[80:83], v123 offset:256
  s_waitcnt lgkmcnt(4)
  v_mfma_f32_32x32x16_bf16 v[52:67], a[152:155], v[92:95], v[52:67]
  ds_read_b128 v[84:87], v124 offset:256
  v_mfma_f32_32x32x16_bf16 v[52:67], a[156:159], v[96:99], v[52:67]
  ds_read_b128 v[88:91], v125 offset:256
  s_waitcnt lgkmcnt(4)
  v_mfma_f32_32x32x16_bf16 v[52:67], a[160:163], v[68:71], v[52:67]
  ds_read_b128 v[92:95], v126 offset:256
  v_mfma_f32_32x32x16_bf16 v[52:67], a[164:167], v[72:75], v[52:67]
  ds_read_b128 v[96:99], v127 offset:256
  s_waitcnt lgkmcnt(4)
  v_mfma_f32_32x32x16_bf16 v[52:67], a[168:171], v[76:79], v[52:67]
  ds_read_b128 v[68:71], v120 offset:512
  v_mfma_f32_32x32x16_bf16 v[52:67], a[172:175], v[80:83], v[52:67]
  ds_read_b128 v[72:75], v121 offset:512
  s_waitcnt lgkmcnt(4)
  v_mfma_f32_32x32x16_bf16 v[52:67], a[176:179], v[84:87], v[52:67]
  ds_read_b128 v[76:79], v122 offset:512
  v_mfma_f32_32x32x16_bf16 v[52:67], a[180:183], v[88:91], v[52:67]
  ds_read_b128 v[80:83], v123 offset:512
  s_waitcnt lgkmcnt(4)
  v_mfma_f32_32x32x16_bf16 v[52:67], a[184:187], v[92:95], v[52:67]
  ds_read_b128 v[84:87], v124 offset:512
  v_mfma_f32_32x32x16_bf16 v[52:67], a[188:191], v[96:99], v[52:67]
  ds_read_b128 v[88:91], v125 offset:512
  s_waitcnt lgkmcnt(4)
  v_mfma_f32_32x32x16_bf16 v[52:67], a[192:195], v[68:71], v[52:67]
  ds_read_b128 v[92:95], v126 offset:512
  v_mfma_f32_32x32x16_bf16 v[52:67], a[196:199], v[72:75], v[52:67]
  ds_read_b128 v[96:99], v127 offset:512
  s_waitcnt lgkmcnt(4)
  v_mfma_f32_32x32x16_bf16 v[52:67], a[200:203], v[76:79], v[52:67]
  ds_read_b128 v[68:71], v120 offset:768
  v_mfma_f32_32x32x16_bf16 v[52:67], a[204:207], v[80:83], v[52:67]
  ds_read_b128 v[72:75], v121 offset:768
  s_waitcnt lgkmcnt(4)
  v_mfma_f32_32x32x16_bf16 v[52:67], a[208:211], v[84:87], v[52:67]
  ds_read_b128 v[76:79], v122 offset:768
  v_mfma_f32_32x32x16_bf16 v[52:67], a[212:215], v[88:91], v[52:67]
  ds_read_b128 v[80:83], v123 offset:768
  s_waitcnt lgkmcnt(4)
  v_mfma_f32_32x32x16_bf16 v[52:67], a[216:219], v[92:95], v[52:67]
  ds_read_b128 v[84:87], v124 offset:768
  v_mfma_f32_32x32x16_bf16 v[52:67], a[220:223], v[96:99], v[52:67]
  ds_read_b128 v[88:91], v125 offset:768
  s_waitcnt lgkmcnt(4)
  v_mfma_f32_32x32x16_bf16 v[52:67], a[224:227], v[68:71], v[52:67]
  ds_read_b128 v[92:95], v126 offset:768
  v_mfma_f32_32x32x16_bf16 v[52:67], a[228:231], v[72:75], v[52:67]
  ds_read_b128 v[96:99], v127 offset:768
  s_waitcnt lgkmcnt(4)
  v_mfma_f32_32x32x16_bf16 v[52:67], a[232:235], v[76:79], v[52:67]
  v_mfma_f32_32x32x16_bf16 v[52:67], a[236:239], v[80:83], v[52:67]
  s_waitcnt lgkmcnt(2)
  v_mfma_f32_32x32x16_bf16 v[52:67], a[240:243], v[84:87], v[52:67]
  v_mfma_f32_32x32x16_bf16 v[52:67], a[244:247], v[88:91], v[52:67]
  s_waitcnt lgkmcnt(0)
  v_mfma_f32_32x32x16_bf16 v[52:67], a[248:251], v[92:95], v[52:67]
  v_mfma_f32_32x32x16_bf16 v[52:67], a[252:255], v[96:99], v[52:67]
  s_lshl_b32 s28, s52, 11
  s_add_u32 s77, s28, 159383552
  s_add_u32 s28, s28, 142606336
  s_add_u32 s51, s51, 262144
  s_mov_b32 s48, 0
  v_lshrrev_b32 v24, 9, v0
  v_lshlrev_b32 v24, 4, v24
  v_and_b32 v25, 0xf0, v0
  v_xor_b32 v24, v24, v25
  v_and_b32 v25, 0x1f0, v0
  v_lshl_add_u32 v24, v25, 6, v24
  v_xor_b32 v120, 0, v24
  v_xor_b32 v121, 32, v24
  v_xor_b32 v122, 64, v24
  v_xor_b32 v123, 96, v24
  v_xor_b32 v124, 128, v24
  v_xor_b32 v125, 160, v24
  v_xor_b32 v126, 192, v24
  v_xor_b32 v127, 224, v24
  s_and_b32 s26, s17, 1
  s_lshl_b32 s26, s26, 7
  v_xor_b32 v24, s26, v0
  v_xor_b32 v12, 0, v24
  v_xor_b32 v13, 16, v24
  v_xor_b32 v14, 32, v24
  v_xor_b32 v15, 48, v24
  v_xor_b32 v16, 64, v24
  v_xor_b32 v17, 80, v24
  v_xor_b32 v18, 96, v24
  v_xor_b32 v19, 112, v24
  v_cvt_pk_bf16_f32 v100, v52, v53
  v_cvt_pk_bf16_f32 v101, v54, v55
  v_cvt_pk_bf16_f32 v102, v60, v61
  v_cvt_pk_bf16_f32 v103, v62, v63
  buffer_store_dwordx4 v[100:103], v8, s[4:7], s28 offen offset:0 sc1
  buffer_store_dwordx4 v[100:103], v8, s[4:7], s77 offen offset:0 sc1
  v_cvt_pk_bf16_f32 v104, v56, v57
  v_cvt_pk_bf16_f32 v105, v58, v59
  v_cvt_pk_bf16_f32 v106, v64, v65
  v_cvt_pk_bf16_f32 v107, v66, v67
  buffer_store_dwordx4 v[104:107], v8, s[4:7], s28 offen offset:512 sc1
  buffer_store_dwordx4 v[104:107], v8, s[4:7], s77 offen offset:512 sc1
  s_cmp_lt_u32 s47, 64
  s_cselect_b32 s26, 2, 0
  s_add_u32 s26, s26, s47
  s_lshl_b32 s26, s26, 12
  s_add_u32 s26, s26, 243261440
  s_mov_b64 exec, 0xffffff
  buffer_load_dword v116, v7, s[4:7], s26 offen sc1
  s_mov_b64 exec, -1
  s_lshl_b32 s26, s61, 21
  s_lshl_b32 s27, s59, 10
  s_add_u32 s26, s26, s27
  s_add_u32 s27, s26, 20971520
  s_add_u32 s28, s26, 27262976
  s_lshl_b32 s26, s46, 7
  s_add_u32 s26, s26, s17
  s_lshl_b32 s26, s26, 8
  s_add_u32 s26, s26, 244318208
  v_lshrrev_b32 v2, 8, v0
  v_and_b32 v3, 0xf0, v0
  v_lshl_add_u32 v5, v2, 10, v3
  buffer_load_dwordx4 v[36:39], v0, s[4:7], s27 offen sc1
  buffer_load_dwordx4 v[40:43], v0, s[4:7], s28 offen sc1
  s_mov_b32 s53, 0
m_w_103:
  s_add_u32 s27, s26, 0
  buffer_load_dwordx4 v[60:63], v5, s[4:7], s27 offen sc1
  s_add_u32 s27, s26, 4096
  buffer_load_dwordx4 v[64:67], v5, s[4:7], s27 offen sc1
  s_add_u32 s27, s26, 8192
  buffer_load_dwordx4 v[68:71], v5, s[4:7], s27 offen sc1
  s_add_u32 s27, s26, 12288
  buffer_load_dwordx4 v[72:75], v5, s[4:7], s27 offen sc1
  s_add_u32 s27, s26, 16384
  buffer_load_dwordx4 v[76:79], v5, s[4:7], s27 offen sc1
  s_add_u32 s27, s26, 20480
  buffer_load_dwordx4 v[80:83], v5, s[4:7], s27 offen sc1
  s_add_u32 s27, s26, 24576
  buffer_load_dwordx4 v[84:87], v5, s[4:7], s27 offen sc1
  s_add_u32 s27, s26, 28672
  buffer_load_dwordx4 v[88:91], v5, s[4:7], s27 offen sc1
  s_add_u32 s53, s53, 1
  s_cmp_gt_u32 s53, 1048576
  s_cbranch_scc1 q_fail_90
  s_mov_b32 vcc_lo, 0xaaaaaaaa
  s_mov_b32 vcc_hi, 0xaaaaaaaa
  v_mov_b32 v28, 0x3f80
  v_mov_b32 v20, 1.0
  v_cndmask_b32 v28, v28, v20, vcc
  s_mov_b32 vcc_lo, 0x30003
  s_mov_b32 vcc_hi, 0x30003
  v_cndmask_b32 v20, 0, v28, vcc
  s_mov_b32 vcc_lo, 0xc000c
  s_mov_b32 vcc_hi, 0xc000c
  v_cndmask_b32 v21, 0, v28, vcc
  s_mov_b32 vcc_lo, 0x300030
  s_mov_b32 vcc_hi, 0x300030
  v_cndmask_b32 v22, 0, v28, vcc
  s_mov_b32 vcc_lo, 0xc000c0
  s_mov_b32 vcc_hi, 0xc000c0
  v_cndmask_b32 v23, 0, v28, vcc
  s_waitcnt vmcnt(7)
  s_nop 0
  v_mfma_f32_16x16x32_bf16 v[28:31], v[20:23], v[60:63], 0
  v_max3_u32 v44, v60, v61, 0
  v_max3_u32 v44, v62, v63, v44
  s_waitcnt vmcnt(6)
  v_mfma_f32_16x16x32_bf16 v[28:31], v[20:23], v[64:67], v[28:31]
  v_max3_u32 v44, v64, v65, v44
  v_max3_u32 v44, v66, v67, v44
  s_waitcnt vmcnt(5)
  v_mfma_f32_16x16x32_bf16 v[28:31], v[20:23], v[68:71], v[28:31]
  v_max3_u32 v44, v68, v69, v44
  v_max3_u32 v44, v70, v71, v44
  s_waitcnt vmcnt(4)
  v_mfma_f32_16x16x32_bf16 v[28:31], v[20:23], v[72:75], v[28:31]
  v_max3_u32 v44, v72, v73, v44
  v_max3_u32 v44, v74, v75, v44
  s_waitcnt vmcnt(3)
  v_mfma_f32_16x16x32_bf16 v[28:31], v[20:23], v[76:79], v[28:31]
  v_max3_u32 v44, v76, v77, v44
  v_max3_u32 v44, v78, v79, v44
  s_waitcnt vmcnt(2)
  v_mfma_f32_16x16x32_bf16 v[28:31], v[20:23], v[80:83], v[28:31]
  v_max3_u32 v44, v80, v81, v44
  v_max3_u32 v44, v82, v83, v44
  s_waitcnt vmcnt(1)
  v_mfma_f32_16x16x32_bf16 v[28:31], v[20:23], v[84:87], v[28:31]
  v_max3_u32 v44, v84, v85, v44
  v_max3_u32 v44, v86, v87, v44
  s_waitcnt vmcnt(0)
  v_mfma_f32_16x16x32_bf16 v[28:31], v[20:23], v[88:91], v[28:31]
  v_max3_u32 v44, v88, v89, v44
  v_max3_u32 v44, v90, v91, v44
  v_cmp_eq_u32 vcc, -1, v44
  s_cbranch_vccnz m_w_103
  v_lshlrev_b32 v3, 1, v3
  v_lshl_add_u32 v3, v2, 4, v3
  s_lshl_b32 s26, s17, 9
  s_add_u32 s26, s26, 159744
  v_add_u32 v3, s26, v3
  s_mov_b32 exec_hi, 0
  ds_write_b128 v3, v[28:31]
  s_mov_b32 exec_hi, -1
  v_lshlrev_b32 v3, 1, v0
  v_add_u32 v3, 159744, v3
  v_lshlrev_b32 v44, 16, v36
  v_and_b32 v45, 0xffff0000, v36
  v_lshlrev_b32 v46, 16, v37
  v_and_b32 v47, 0xffff0000, v37
  v_lshlrev_b32 v48, 16, v38
  v_and_b32 v49, 0xffff0000, v38
  v_lshlrev_b32 v50, 16, v39
  v_and_b32 v51, 0xffff0000, v39
  v_lshlrev_b32 v52, 16, v40
  v_and_b32 v53, 0xffff0000, v40
  v_lshlrev_b32 v54, 16, v41
  v_and_b32 v55, 0xffff0000, v41
  v_lshlrev_b32 v56, 16, v42
  v_and_b32 v57, 0xffff0000, v42
  v_lshlrev_b32 v58, 16, v43
  v_and_b32 v59, 0xffff0000, v43
  s_waitcnt lgkmcnt(0)
  s_barrier
  s_cmp_lg_u32 s17, 0
  s_cbranch_scc1 m_done_102
  ds_read_b128 v[28:31], v3
  ds_read_b128 v[32:35], v3 offset:16
  s_and_b32 s29, s58, 0xffff0000
  s_xor_b32 s27, s29, 0x80000000
  s_xor_b32 s28, s29, 0xffff0000
  s_bitcmp1_b32 s29, 31
  s_cselect_b32 s29, s27, s28
  v_mov_b32 v36, s29
  v_mul_f32 v36, 0xbfb8aa3b, v36
  v_exp_f32 v36, v36
  s_nop 0
  v_add_f32 v36, 1.0, v36
  v_rcp_f32 v36, v36
  s_nop 0
  v_cvt_pk_bf16_f32 v36, 0, v36
  s_waitcnt lgkmcnt(0)
  v_cvt_pk_bf16_f32 v28, 0, v28
  v_cvt_pk_bf16_f32 v29, 0, v29
  v_cvt_pk_bf16_f32 v30, 0, v30
  v_cvt_pk_bf16_f32 v31, 0, v31
  v_cvt_pk_bf16_f32 v32, 0, v32
  v_cvt_pk_bf16_f32 v33, 0, v33
  v_cvt_pk_bf16_f32 v34, 0, v34
  v_cvt_pk_bf16_f32 v35, 0, v35
  v_mul_f32 v28, v28, v36
  v_mul_f32 v29, v29, v36
  v_mul_f32 v30, v30, v36
  v_mul_f32 v31, v31, v36
  v_mul_f32 v32, v32, v36
  v_mul_f32 v33, v33, v36
  v_mul_f32 v34, v34, v36
  v_mul_f32 v35, v35, v36
  v_cvt_pk_bf16_f32 v28, 0, v28
  v_cvt_pk_bf16_f32 v29, 0, v29
  v_cvt_pk_bf16_f32 v30, 0, v30
  v_cvt_pk_bf16_f32 v31, 0, v31
  v_cvt_pk_bf16_f32 v32, 0, v32
  v_cvt_pk_bf16_f32 v33, 0, v33
  v_cvt_pk_bf16_f32 v34, 0, v34
  v_cvt_pk_bf16_f32 v35, 0, v35
  v_add_f32 v28, v28, v52
  v_add_f32 v29, v29, v53
  v_add_f32 v30, v30, v54
  v_add_f32 v31, v31, v55
  v_add_f32 v32, v32, v56
  v_add_f32 v33, v33, v57
  v_add_f32 v34, v34, v58
  v_add_f32 v35, v35, v59
  v_cvt_pk_bf16_f32 v28, 0, v28
  v_cvt_pk_bf16_f32 v29, 0, v29
  v_cvt_pk_bf16_f32 v30, 0, v30
  v_cvt_pk_bf16_f32 v31, 0, v31
  v_cvt_pk_bf16_f32 v32, 0, v32
  v_cvt_pk_bf16_f32 v33, 0, v33
  v_cvt_pk_bf16_f32 v34, 0, v34
  v_cvt_pk_bf16_f32 v35, 0, v35
  v_add_f32 v44, v44, v28
  v_add_f32 v45, v45, v29
  v_add_f32 v46, v46, v30
  v_add_f32 v47, v47, v31
  v_add_f32 v48, v48, v32
  v_add_f32 v49, v49, v33
  v_add_f32 v50, v50, v34
  v_add_f32 v51, v51, v35
  v_cvt_pk_bf16_f32 v40, v44, v45
  v_cvt_pk_bf16_f32 v41, v46, v47
  v_cvt_pk_bf16_f32 v42, v48, v49
  v_cvt_pk_bf16_f32 v43, v50, v51
  v_lshlrev_b32 v44, 16, v40
  v_and_b32 v45, 0xffff0000, v40
  v_lshlrev_b32 v46, 16, v41
  v_and_b32 v47, 0xffff0000, v41
  v_lshlrev_b32 v48, 16, v42
  v_and_b32 v49, 0xffff0000, v42
  v_lshlrev_b32 v50, 16, v43
  v_and_b32 v51, 0xffff0000, v43
  s_lshl_b32 s27, s46, 5
  s_add_u32 s27, s27, s16
  s_lshl_b32 s27, s27, 10
  s_add_u32 s27, s27, 33554432
  buffer_store_dwordx4 v[40:43], v0, s[4:7], s27 offen sc1
  v_add_f32 v60, v44, v45
  v_mul_f32 v61, v44, v44
  v_add_f32 v62, v46, v47
  v_mul_f32 v63, v45, v45
  v_fmac_f32 v61, v46, v46
  v_fmac_f32 v63, v47, v47
  v_add_f32 v60, v60, v48
  v_fmac_f32 v61, v48, v48
  v_add_f32 v62, v62, v49
  v_fmac_f32 v63, v49, v49
  v_add_f32 v60, v60, v50
  v_fmac_f32 v61, v50, v50
  v_add_f32 v62, v62, v51
  v_fmac_f32 v63, v51, v51
  v_add_f32 v60, v60, v62
  v_add_f32 v61, v61, v63
  s_nop 0
  v_add_f32_dpp v60, v60, v60 row_ror:8 row_mask:0xf bank_mask:0xf
  v_add_f32_dpp v61, v61, v61 row_ror:8 row_mask:0xf bank_mask:0xf
  s_nop 0
  v_add_f32_dpp v60, v60, v60 row_ror:4 row_mask:0xf bank_mask:0xf
  v_add_f32_dpp v61, v61, v61 row_ror:4 row_mask:0xf bank_mask:0xf
  s_nop 0
  v_add_f32_dpp v60, v60, v60 row_ror:2 row_mask:0xf bank_mask:0xf
  v_add_f32_dpp v61, v61, v61 row_ror:2 row_mask:0xf bank_mask:0xf
  s_nop 0
  v_add_f32_dpp v60, v60, v60 row_ror:1 row_mask:0xf bank_mask:0xf
  v_add_f32_dpp v61, v61, v61 row_ror:1 row_mask:0xf bank_mask:0xf
  v_mov_b32 v64, v60
  v_mov_b32 v65, v61
  s_nop 0
  v_permlane16_swap_b32 v60, v64
  v_permlane16_swap_b32 v61, v65
  v_add_f32 v60, v60, v64
  v_add_f32 v61, v61, v65
  v_mov_b32 v64, v60
  v_mov_b32 v65, v61
  s_nop 0
  v_permlane32_swap_b32 v60, v64
  v_permlane32_swap_b32 v61, v65
  v_add_f32 v60, v60, v64
  v_add_f32 v61, v61, v65
  v_mul_f32 v60, 0x3b000000, v60
  v_mul_f32 v61, 0x3b000000, v61
  v_fma_f32 v61, -v60, v60, v61
  v_cvt_pk_bf16_f32 v60, 0, v60
  v_max_f32 v61, 0, v61
  v_sub_f32 v64, v44, v60
  v_sub_f32 v65, v45, v60
  v_cvt_pk_bf16_f32 v61, 0, v61
  v_sub_f32 v66, v46, v60
  v_sub_f32 v67, v47, v60
  v_add_f32 v61, 0x3727c5ac, v61
  v_sub_f32 v68, v48, v60
  v_sub_f32 v69, v49, v60
  v_cvt_pk_bf16_f32 v61, 0, v61
  v_sub_f32 v70, v50, v60
  v_sub_f32 v71, v51, v60
  v_sqrt_f32 v61, v61
  v_cvt_pk_bf16_f32 v64, 0, v64
  v_cvt_pk_bf16_f32 v65, 0, v65
  v_cvt_pk_bf16_f32 v61, 0, v61
  v_cvt_pk_bf16_f32 v66, 0, v66
  v_cvt_pk_bf16_f32 v67, 0, v67
  v_rcp_f32 v61, v61
  v_cvt_pk_bf16_f32 v68, 0, v68
  v_cvt_pk_bf16_f32 v69, 0, v69
  v_cvt_pk_bf16_f32 v70, 0, v70
  v_cvt_pk_bf16_f32 v71, 0, v71
  v_mul_f32 v64, v64, v61
  v_mul_f32 v65, v65, v61
  v_mul_f32 v66, v66, v61
  v_mul_f32 v67, v67, v61
  v_mul_f32 v68, v68, v61
  v_mul_f32 v69, v69, v61
  v_mul_f32 v70, v70, v61
  v_mul_f32 v71, v71, v61
  v_cvt_pk_bf16_f32 v72, v64, v65
  v_cvt_pk_bf16_f32 v73, v66, v67
  v_cvt_pk_bf16_f32 v74, v68, v69
  v_cvt_pk_bf16_f32 v75, v70, v71
  v_lshl_add_u32 v3, v0, 2, s50
  v_mov_b64 v[60:61], 0
  v_mov_b64 v[64:65], 0
  v_mov_b64 v[68:69], 0
  v_mov_b32 v62, v72
  v_mov_b32 v63, v74
  v_mov_b32 v66, v73
  v_mov_b32 v67, v75
  ds_write_b128 v3, v[62:65] offset:4096
  ds_write_b128 v3, v[60:63] offset:4112
  ds_write_b128 v3, v[66:69] offset:4128
  ds_write_b128 v3, v[64:67] offset:4144
m_done_102:
  s_mov_b64 exec, 1
  buffer_store_dword v4, off, s[4:7], s49 sc1
  s_mov_b64 exec, -1
  s_mov_b32 s49, 268435456
  v_mov_b32 v4, 1
  v_cmp_eq_u32 vcc, 0, v116
  v_max_u32_dpp v117, v116, v116 quad_perm:[1,0,3,2] row_mask:0xf bank_mask:0xf
  s_and_b32 s48, vcc_lo, 0xffffff
  s_cselect_b32 s48, 0, -1
  v_max_u32_dpp v117, v117, v117 quad_perm:[2,3,0,1] row_mask:0xf bank_mask:0xf
  s_nop 1
  v_max_u32_dpp v117, v117, v117 row_half_mirror row_mask:0xf bank_mask:0xf
  v_and_b32 v117, s48, v117
  s_cmp_eq_u32 s48, 0
  s_cbranch_scc1 q_nb_104
  s_and_b32 s63, s47, 127
  s_lshl_b32 s63, s63, 15
  s_xor_b32 s27, s50, 32768
  s_add_u32 m0, s27, s54
  s_add_u32 s63, s63, s54
  s_add_u32 s63, s63, 6291456
  buffer_load_dwordx4 v12, s[4:7], s63 offen offset:0 sc1 lds
  buffer_load_dwordx4 v13, s[4:7], s63 offen offset:1024 sc1 lds
  buffer_load_dwordx4 v14, s[4:7], s63 offen offset:2048 sc1 lds
  buffer_load_dwordx4 v15, s[4:7], s63 offen offset:3072 sc1 lds
  s_add_u32 m0, m0, 4096
  s_add_u32 s63, s63, 4096
  buffer_load_dwordx4 v16, s[4:7], s63 offen offset:0 sc1 lds
  buffer_load_dwordx4 v17, s[4:7], s63 offen offset:1024 sc1 lds
  buffer_load_dwordx4 v18, s[4:7], s63 offen offset:2048 sc1 lds
  buffer_load_dwordx4 v19, s[4:7], s63 offen offset:3072 sc1 lds
q_nb_104:
  v_lshrrev_b32 v2, 8, v0
  v_and_b32 v3, 48, v0
  v_lshl_add_u32 v3, v2, 6, v3
  v_add_u32 v3, s50, v3
  s_mov_b32 vcc_lo, 0xcccccccc
  s_mov_b32 vcc_hi, 0xcccccccc
  v_mov_b32 v32, 0x4444
  v_mov_b32 v33, 0xeeee
  v_cndmask_b32 v32, v32, v33, vcc
  s_waitcnt lgkmcnt(0)
  s_barrier
  ds_read_b128 v[36:39], v3 offset:4096
  ds_read_b128 v[40:43], v3 offset:4352
  ds_read_b128 v[44:47], v3 offset:4608
  ds_read_b128 v[48:51], v3 offset:4864
  ds_read_b128 v[52:55], v3 offset:5120
  ds_read_b128 v[56:59], v3 offset:5376
  ds_read_b128 v[60:63], v3 offset:5632
  ds_read_b128 v[64:67], v3 offset:5888
  v_mov_b64 v[20:21], 0
  v_mov_b64 v[22:23], 0
  v_mov_b64 v[24:25], 0
  v_mov_b64 v[26:27], 0
  v_mov_b64 v[28:29], 0
  v_mov_b64 v[30:31], 0
  s_waitcnt lgkmcnt(7)
  v_smfmac_f32_16x16x64_bf16 v[20:23], v[36:39], v[128:135], v32
  ds_read_b128 v[68:71], v3 offset:6144
  v_smfmac_f32_16x16x64_bf16 v[24:27], v[36:39], a[0:7], v32
  s_and_b32 s26, s59, 16
  v_smfmac_f32_16x16x64_bf16 v[28:31], v[36:39], a[128:135], v32
  s_lshl_b32 s27, s26, 6
  s_waitcnt lgkmcnt(7)
  v_smfmac_f32_16x16x64_bf16 v[20:23], v[40:43], v[136:143], v32
  ds_read_b128 v[72:75], v3 offset:6400
  v_smfmac_f32_16x16x64_bf16 v[24:27], v[40:43], a[8:15], v32
  s_and_b32 s28, s59, 15
  v_smfmac_f32_16x16x64_bf16 v[28:31], v[40:43], a[136:143], v32
  s_lshl4_add_u32 s27, s28, s27
  s_waitcnt lgkmcnt(7)
  v_smfmac_f32_16x16x64_bf16 v[20:23], v[44:47], v[144:151], v32
  ds_read_b128 v[76:79], v3 offset:6656
  v_smfmac_f32_16x16x64_bf16 v[24:27], v[44:47], a[16:23], v32
  s_add_u32 s77, s77, s27
  v_smfmac_f32_16x16x64_bf16 v[28:31], v[44:47], a[144:151], v32
  s_add_u32 s27, s27, s44
  s_waitcnt lgkmcnt(7)
  v_smfmac_f32_16x16x64_bf16 v[20:23], v[48:51], v[152:159], v32
  ds_read_b128 v[80:83], v3 offset:6912
  v_smfmac_f32_16x16x64_bf16 v[24:27], v[48:51], a[24:31], v32
  s_lshr_b32 s26, s26, 1
  v_smfmac_f32_16x16x64_bf16 v[28:31], v[48:51], a[152:159], v32
  s_and_b32 s28, s59, 3
  s_waitcnt lgkmcnt(7)
  v_smfmac_f32_16x16x64_bf16 v[20:23], v[52:55], v[160:167], v32
  ds_read_b128 v[84:87], v3 offset:7168
  v_smfmac_f32_16x16x64_bf16 v[24:27], v[52:55], a[32:39], v32
  s_lshl1_add_u32 s26, s28, s26
  v_smfmac_f32_16x16x64_bf16 v[28:31], v[52:55], a[160:167], v32
  s_and_b32 s28, s59, 12
  s_waitcnt lgkmcnt(7)
  v_smfmac_f32_16x16x64_bf16 v[20:23], v[56:59], v[168:175], v32
  ds_read_b128 v[88:91], v3 offset:7424
  v_smfmac_f32_16x16x64_bf16 v[24:27], v[56:59], a[40:47], v32
  s_lshl_b32 s28, s28, 6
  v_smfmac_f32_16x16x64_bf16 v[28:31], v[56:59], a[168:175], v32
  s_add_u32 s26, s26, s28
  s_waitcnt lgkmcnt(7)
  v_smfmac_f32_16x16x64_bf16 v[20:23], v[60:63], v[176:183], v32
  ds_read_b128 v[92:95], v3 offset:7680
  v_smfmac_f32_16x16x64_bf16 v[24:27], v[60:63], a[48:55], v32
  s_add_u32 s26, s26, s44
  v_smfmac_f32_16x16x64_bf16 v[28:31], v[60:63], a[176:183], v32
  v_and_b32 v2, 0xc0, v0
  s_waitcnt lgkmcnt(7)
  v_smfmac_f32_16x16x64_bf16 v[20:23], v[64:67], v[184:191], v32
  ds_read_b128 v[96:99], v3 offset:7936
  v_smfmac_f32_16x16x64_bf16 v[24:27], v[64:67], a[56:63], v32
  v_and_b32 v5, 12, v1
  v_smfmac_f32_16x16x64_bf16 v[28:31], v[64:67], a[184:191], v32
  v_lshrrev_b32 v5, 1, v5
  s_waitcnt lgkmcnt(7)
  v_smfmac_f32_16x16x64_bf16 v[20:23], v[68:71], v[192:199], v32
  v_lshl_add_u32 v2, v2, 2, v5
  v_smfmac_f32_16x16x64_bf16 v[24:27], v[68:71], a[64:71], v32
  v_smfmac_f32_16x16x64_bf16 v[28:31], v[68:71], a[192:199], v32
  s_waitcnt lgkmcnt(6)
  v_smfmac_f32_16x16x64_bf16 v[20:23], v[72:75], v[200:207], v32
  v_smfmac_f32_16x16x64_bf16 v[24:27], v[72:75], a[72:79], v32
  v_smfmac_f32_16x16x64_bf16 v[28:31], v[72:75], a[200:207], v32
  s_waitcnt lgkmcnt(5)
  v_smfmac_f32_16x16x64_bf16 v[20:23], v[76:79], v[208:215], v32
  v_smfmac_f32_16x16x64_bf16 v[24:27], v[76:79], a[80:87], v32
  v_smfmac_f32_16x16x64_bf16 v[28:31], v[76:79], a[208:215], v32
  s_waitcnt lgkmcnt(4)
  v_smfmac_f32_16x16x64_bf16 v[20:23], v[80:83], v[216:223], v32
  v_smfmac_f32_16x16x64_bf16 v[24:27], v[80:83], a[88:95], v32
  v_smfmac_f32_16x16x64_bf16 v[28:31], v[80:83], a[216:223], v32
  s_waitcnt lgkmcnt(3)
  v_smfmac_f32_16x16x64_bf16 v[20:23], v[84:87], v[224:231], v32
  v_smfmac_f32_16x16x64_bf16 v[24:27], v[84:87], a[96:103], v32
  v_smfmac_f32_16x16x64_bf16 v[28:31], v[84:87], a[224:231], v32
  s_waitcnt lgkmcnt(2)
  v_smfmac_f32_16x16x64_bf16 v[20:23], v[88:91], v[232:239], v32
  v_smfmac_f32_16x16x64_bf16 v[24:27], v[88:91], a[104:111], v32
  v_smfmac_f32_16x16x64_bf16 v[28:31], v[88:91], a[232:239], v32
  s_waitcnt lgkmcnt(1)
  v_smfmac_f32_16x16x64_bf16 v[20:23], v[92:95], v[240:247], v32
  v_smfmac_f32_16x16x64_bf16 v[24:27], v[92:95], a[112:119], v32
  v_smfmac_f32_16x16x64_bf16 v[28:31], v[92:95], a[240:247], v32
  s_waitcnt lgkmcnt(0)
  v_smfmac_f32_16x16x64_bf16 v[20:23], v[96:99], v[248:255], v32
  v_smfmac_f32_16x16x64_bf16 v[24:27], v[96:99], a[120:127], v32
  v_smfmac_f32_16x16x64_bf16 v[28:31], v[96:99], a[248:255], v32
  v_add_f32 v20, v20, v22
  v_add_f32 v21, v21, v23
  s_nop 1
  v_add_f32 v24, v24, v26
  v_add_f32 v25, v25, v27
  s_nop 1
  v_add_f32 v28, v28, v30
  v_add_f32 v29, v29, v31
  v_mul_f32 v20, s24, v20
  v_mul_f32 v21, s24, v21
  v_cvt_pk_bf16_f32 v20, v20, v21
  v_cvt_pk_bf16_f32 v24, v24, v25
  v_cvt_pk_bf16_f32 v28, v28, v29
  s_mov_b64 exec, 0xffff
  buffer_store_short v20, v2, s[4:7], s27 offen sc1
  buffer_store_short_d16_hi v20, v2, s[4:7], s27 offen offset:8 sc1
  buffer_store_short v24, v0, s[4:7], s26 offen offset:2048 sc1
  buffer_store_short_d16_hi v24, v0, s[4:7], s26 offen offset:3072 sc1
  buffer_store_short v28, v2, s[4:7], s77 offen sc1
  buffer_store_short_d16_hi v28, v2, s[4:7], s77 offen offset:8 sc1
  s_mov_b64 exec, 3
  s_waitcnt vmcnt(0)
  buffer_store_dword v4, v0, s[4:7], s51 offen sc1
  s_mov_b64 exec, -1
  s_branch q_nxt_96
q_end_87:
  s_waitcnt vmcnt(0)
  s_mov_b64 exec, 1
  buffer_store_dword v4, off, s[4:7], s49 sc1
  s_mov_b64 exec, -1
  s_cmp_lg_u32 s60, 0
  s_cbranch_scc1 q_fail_90
  s_load_dwordx2 s[72:73], s[0:1], 96
  s_mov_b32 s74, 2097152
  s_mov_b32 s75, 0x20000
  s_mov_b32 s58, 0
  s_cmp_eq_u32 s17, 3
  s_cselect_b32 s48, 7, 15
k_fin_105:
  s_load_dwordx2 s[64:65], s[0:1], 72
  s_load_dwordx2 s[68:69], s[0:1], 80
  s_load_dwordx2 s[8:9], s[0:1], 88
  s_mov_b32 s66, 1835008
  s_mov_b32 s70, 1835008
  s_mov_b32 s10, 1835008
  v_lshrrev_b32 v2, 7, v0
  v_and_b32 v3, 0x70, v0
  v_mul_u32_u24 v6, 57344, v2
  v_add_u32 v6, v6, v3
  v_cmp_eq_u32 vcc, 0x70, v3
  v_mov_b32 v3, 0x7ff00000
  s_nop 0
  v_cndmask_b32 v6, v6, v3, vcc
  v_lshrrev_b32 v2, 8, v0
  v_mul_u32_u24 v7, 14336, v2
  v_and_b32 v3, 0xf0, v0
  v_add_u32 v7, v7, v3
  s_mul_i32 s34, s17, 458752
  s_mul_i32 s27, s16, 112
  s_add_u32 s34, s34, s27
  s_mul_i32 s35, s16, 57344
  s_lshl_b32 s27, s17, 8
  s_add_u32 s35, s35, s27
  s_waitcnt lgkmcnt(0)
  s_xor_b32 s37, s50, 32768
  s_add_u32 s37, s37, s54
  s_mov_b32 m0, s37
  s_add_u32 s36, s34, 39424
  buffer_load_dwordx4 v6, s[68:71], s36 offen lds
  s_add_u32 m0, m0, 1024
  s_add_u32 s36, s34, 43008
  buffer_load_dwordx4 v6, s[64:67], s36 offen lds
  s_add_u32 m0, m0, 1024
  s_add_u32 s36, s34, 43008
  buffer_load_dwordx4 v6, s[68:71], s36 offen lds
  s_add_u32 m0, m0, 1024
  s_add_u32 s36, s34, 46592
  buffer_load_dwordx4 v6, s[64:67], s36 offen lds
  s_add_u32 m0, m0, 1024
  s_add_u32 s36, s34, 46592
  buffer_load_dwordx4 v6, s[68:71], s36 offen lds
  s_add_u32 m0, m0, 1024
  s_add_u32 s36, s34, 50176
  buffer_load_dwordx4 v6, s[64:67], s36 offen lds
  s_add_u32 m0, m0, 1024
  s_add_u32 s36, s34, 50176
  buffer_load_dwordx4 v6, s[68:71], s36 offen lds
  s_add_u32 m0, m0, 1024
  s_add_u32 s36, s34, 53760
  buffer_load_dwordx4 v6, s[64:67], s36 offen lds
  s_add_u32 m0, m0, 1024
  s_add_u32 s36, s34, 53760
  buffer_load_dwordx4 v[60:63], v6, s[68:71], s36 offen
  buffer_load_dwordx4 v[64:67], v7, s[8:11], s35 offen offset:0
  buffer_load_dwordx4 v[68:71], v7, s[8:11], s35 offen offset:1024
  buffer_load_dwordx4 v[72:75], v7, s[8:11], s35 offen offset:2048
  buffer_load_dwordx4 v[76:79], v7, s[8:11], s35 offen offset:3072
  s_add_u32 s35, s35, 4096
  buffer_load_dwordx4 v[80:83], v7, s[8:11], s35 offen offset:0
  buffer_load_dwordx4 v[84:87], v7, s[8:11], s35 offen offset:1024
  buffer_load_dwordx4 v[88:91], v7, s[8:11], s35 offen offset:2048
  buffer_load_dwordx4 v[92:95], v7, s[8:11], s35 offen offset:3072
  s_add_u32 s35, s35, 4096
  buffer_load_dwordx4 v[96:99], v7, s[8:11], s35 offen offset:0
  buffer_load_dwordx4 v[100:103], v7, s[8:11], s35 offen offset:1024
  buffer_load_dwordx4 v[104:107], v7, s[8:11], s35 offen offset:2048
  buffer_load_dwordx4 v[108:111], v7, s[8:11], s35 offen offset:3072
  s_add_u32 s35, s35, 4096
  buffer_load_dwordx4 v[112:115], v7, s[8:11], s35 offen offset:0
  buffer_load_dwordx4 v[48:51], v7, s[8:11], s35 offen offset:1024
  s_andn2_b32 s28, 0xfe0, s56
  s_lshl_b32 s28, s28, 7
  s_mov_b32 s29, 243793920
  v_mov_b32 v24, 262144
  s_mov_b32 s53, 0
  s_mov_b32 s33, 3
  v_mov_b32 v53, s58
  s_and_b32 s32, s48, 15
  s_cbranch_scc0 k_x_108
k_w_107:
  s_add_u32 s33, s33, 1
  s_and_b32 s33, s33, 3
  s_bitcmp1_b32 s32, s33
  s_cbranch_scc0 k_w_107
  s_lshl2_add_u32 s26, s33, s17
  s_lshl_b32 s26, s26, 14
  s_add_u32 s27, s26, 8192
  v_add_u32 v22, s26, v9
  v_cmp_le_u32 vcc, s28, v22
  s_nop 1
  v_cndmask_b32 v25, 0, v24, vcc
  v_add_u32 v22, v22, v25
  buffer_load_dword v20, v22, s[4:7], s29 offen sc1
  v_add_u32 v23, s27, v9
  v_cmp_le_u32 vcc, s28, v23
  s_nop 1
  v_cndmask_b32 v25, 0, v24, vcc
  v_add_u32 v23, v23, v25
  buffer_load_dword v21, v23, s[4:7], s29 offen sc1
  s_add_u32 s53, s53, 1
  s_cmp_gt_u32 s53, 1048576
  s_cbranch_scc1 q_fail_90
  s_waitcnt vmcnt(0)
  v_min_u32 v52, v20, v21
  v_max3_u32 v53, v20, v21, v53
  v_cmp_eq_u32 vcc, 0, v52
  s_cbranch_vccnz k_w_107
  s_bitset0_b32 s32, s33
  s_cmp_lg_u32 s32, 0
  s_cbranch_scc1 k_w_107
  v_max_u32_dpp v53, v53, v53 row_ror:8 row_mask:0xf bank_mask:0xf
  s_nop 1
  v_max_u32_dpp v53, v53, v53 row_ror:4 row_mask:0xf bank_mask:0xf
  s_nop 1
  v_max_u32_dpp v53, v53, v53 row_ror:2 row_mask:0xf bank_mask:0xf
  s_nop 1
  v_max_u32_dpp v53, v53, v53 row_ror:1 row_mask:0xf bank_mask:0xf
  v_mov_b32 v52, v53
  s_nop 0
  s_nop 0
  v_permlane16_swap_b32 v53, v52
  v_max_u32 v53, v53, v52
  v_mov_b32 v52, v53
  s_nop 0
  s_nop 0
  v_permlane32_swap_b32 v53, v52
  v_max_u32 v53, v53, v52
k_x_108:
  ds_write_b32 v118, v53 offset:256
  s_waitcnt vmcnt(0) lgkmcnt(0)
  s_barrier
  ds_read_b128 v[20:23], v119 offset:256
  s_waitcnt lgkmcnt(0)
  v_max3_u32 v20, v20, v21, v22
  v_max_u32 v20, v20, v23
  s_nop 0
  v_readfirstlane_b32 s26, v20
  s_cmp_eq_u32 s26, s58
  s_cbranch_scc1 q_fail_90
  s_cmp_eq_u32 s58, 0
  s_mov_b32 s58, s26
  s_cbranch_scc1 k_r_109
  s_cmp_lg_u32 s57, 0
  s_cbranch_scc1 k_r_109
  s_lshl_b32 s26, s59, 10
  buffer_store_dwordx4 a[0:3], v0, s[72:75], s26 offen sc1
k_r_109:
  s_andn2_b32 s26, 0xfe0, s56
  s_andn2_b32 s27, 0xfe0, s58
  s_cmp_lt_u32 s27, s26
  s_cselect_b32 s61, 1, 2
  s_andn2_b32 s59, 0xfff, s58
  s_lshl_b32 s26, s61, 21
  s_lshl_b32 s27, s59, 10
  s_add_u32 s26, s26, s27
  s_lshl_b32 s27, s17, 8
  s_add_u32 s26, s26, s27
  s_add_u32 s26, s26, 27262976
  v_lshrrev_b32 v5, 7, v0
  v_lshlrev_b32 v5, 5, v5
  buffer_load_dwordx4 v[52:55], v5, s[4:7], s26 offen offset:0 sc1
  buffer_load_dwordx4 v[56:59], v5, s[4:7], s26 offen offset:16 sc1
  s_mov_b32 vcc_lo, 0xaaaaaaaa
  s_mov_b32 vcc_hi, 0xaaaaaaaa
  v_mov_b32 v3, 0xffff
  v_mov_b32 v24, 0xffff0000
  v_cndmask_b32 v3, v3, v24, vcc
  s_mov_b32 vcc_lo, 0x3030303
  s_mov_b32 vcc_hi, 0x3030303
  v_cndmask_b32 v24, 0, v3, vcc
  s_mov_b32 vcc_lo, 0xc0c0c0c
  s_mov_b32 vcc_hi, 0xc0c0c0c
  v_cndmask_b32 v25, 0, v3, vcc
  s_mov_b32 vcc_lo, 0x30303030
  s_mov_b32 vcc_hi, 0x30303030
  v_cndmask_b32 v26, 0, v3, vcc
  s_mov_b32 vcc_lo, 0xc0c0c0c0
  s_mov_b32 vcc_hi, 0xc0c0c0c0
  v_cndmask_b32 v27, 0, v3, vcc
  s_mov_b32 s30, 0x01000100
  s_mov_b32 s31, 0x03020302
  s_mul_i32 s26, s17, 23552
  s_add_u32 s26, s26, 65536
  v_add_u32 v5, s26, v0
  v_add_u32 v2, s37, v0
  ds_read_b128 v[36:39], v5 offset:0
  ds_read_b128 v[40:43], v5 offset:1024
  ds_read_b128 v[44:47], v5 offset:2048
  ds_read_b128 v[12:15], v5 offset:3072
  ds_read_b128 v[16:19], v5 offset:4096
  ds_read_b128 v[120:123], v5 offset:5120
  ds_read_b128 v[124:127], v5 offset:6144
  s_waitcnt vmcnt(0)
  v_perm_b32 v3, v52, v52, s30
  v_and_b32 v20, v24, v3
  v_and_b32 v21, v25, v3
  v_and_b32 v22, v26, v3
  v_and_b32 v23, v27, v3
  s_waitcnt lgkmcnt(5)
  s_nop 0
  v_mfma_f32_16x16x32_bf16 v[28:31], v[20:23], v[36:39], 0
  ds_read_b128 v[36:39], v5 offset:7168
  v_mfma_f32_16x16x32_bf16 v[32:35], v[20:23], v[40:43], 0
  ds_read_b128 v[40:43], v5 offset:8192
  v_perm_b32 v3, v52, v52, s31
  v_and_b32 v20, v24, v3
  v_and_b32 v21, v25, v3
  v_and_b32 v22, v26, v3
  v_and_b32 v23, v27, v3
  s_waitcnt lgkmcnt(5)
  s_nop 0
  v_mfma_f32_16x16x32_bf16 v[28:31], v[20:23], v[44:47], v[28:31]
  ds_read_b128 v[44:47], v5 offset:9216
  v_mfma_f32_16x16x32_bf16 v[32:35], v[20:23], v[12:15], v[32:35]
  ds_read_b128 v[12:15], v5 offset:10240
  v_perm_b32 v3, v53, v53, s30
  v_and_b32 v20, v24, v3
  v_and_b32 v21, v25, v3
  v_and_b32 v22, v26, v3
  v_and_b32 v23, v27, v3
  s_waitcnt lgkmcnt(5)
  s_nop 0
  v_mfma_f32_16x16x32_bf16 v[28:31], v[20:23], v[16:19], v[28:31]
  ds_read_b128 v[16:19], v5 offset:11264
  v_mfma_f32_16x16x32_bf16 v[32:35], v[20:23], v[120:123], v[32:35]
  ds_read_b128 v[120:123], v5 offset:12288
  v_perm_b32 v3, v53, v53, s31
  v_and_b32 v20, v24, v3
  v_and_b32 v21, v25, v3
  v_and_b32 v22, v26, v3
  v_and_b32 v23, v27, v3
  s_waitcnt lgkmcnt(5)
  s_nop 0
  v_mfma_f32_16x16x32_bf16 v[28:31], v[20:23], v[124:127], v[28:31]
  ds_read_b128 v[124:127], v5 offset:13312
  v_mfma_f32_16x16x32_bf16 v[32:35], v[20:23], v[36:39], v[32:35]
  ds_read_b128 v[36:39], v5 offset:14336
  v_perm_b32 v3, v54, v54, s30
  v_and_b32 v20, v24, v3
  v_and_b32 v21, v25, v3
  v_and_b32 v22, v26, v3
  v_and_b32 v23, v27, v3
  s_waitcnt lgkmcnt(5)
  s_nop 0
  v_mfma_f32_16x16x32_bf16 v[28:31], v[20:23], v[40:43], v[28:31]
  ds_read_b128 v[40:43], v5 offset:15360
  v_mfma_f32_16x16x32_bf16 v[32:35], v[20:23], v[44:47], v[32:35]
  ds_read_b128 v[44:47], v5 offset:16384
  v_perm_b32 v3, v54, v54, s31
  v_and_b32 v20, v24, v3
  v_and_b32 v21, v25, v3
  v_and_b32 v22, v26, v3
  v_and_b32 v23, v27, v3
  s_waitcnt lgkmcnt(5)
  s_nop 0
  v_mfma_f32_16x16x32_bf16 v[28:31], v[20:23], v[12:15], v[28:31]
  ds_read_b128 v[12:15], v5 offset:17408
  v_mfma_f32_16x16x32_bf16 v[32:35], v[20:23], v[16:19], v[32:35]
  ds_read_b128 v[16:19], v5 offset:18432
  v_perm_b32 v3, v55, v55, s30
  v_and_b32 v20, v24, v3
  v_and_b32 v21, v25, v3
  v_and_b32 v22, v26, v3
  v_and_b32 v23, v27, v3
  s_waitcnt lgkmcnt(5)
  s_nop 0
  v_mfma_f32_16x16x32_bf16 v[28:31], v[20:23], v[120:123], v[28:31]
  ds_read_b128 v[120:123], v5 offset:19456
  v_mfma_f32_16x16x32_bf16 v[32:35], v[20:23], v[124:127], v[32:35]
  ds_read_b128 v[124:127], v5 offset:20480
  v_perm_b32 v3, v55, v55, s31
  v_and_b32 v20, v24, v3
  v_and_b32 v21, v25, v3
  v_and_b32 v22, v26, v3
  v_and_b32 v23, v27, v3
  s_waitcnt lgkmcnt(5)
  s_nop 0
  v_mfma_f32_16x16x32_bf16 v[28:31], v[20:23], v[36:39], v[28:31]
  ds_read_b128 v[36:39], v5 offset:21504
  v_mfma_f32_16x16x32_bf16 v[32:35], v[20:23], v[40:43], v[32:35]
  ds_read_b128 v[40:43], v5 offset:22528
  v_perm_b32 v3, v56, v56, s30
  v_and_b32 v20, v24, v3
  v_and_b32 v21, v25, v3
  v_and_b32 v22, v26, v3
  v_and_b32 v23, v27, v3
  s_waitcnt lgkmcnt(5)
  s_nop 0
  v_mfma_f32_16x16x32_bf16 v[28:31], v[20:23], v[44:47], v[28:31]
  ds_read_b128 v[44:47], v2 offset:0
  v_mfma_f32_16x16x32_bf16 v[32:35], v[20:23], v[12:15], v[32:35]
  ds_read_b128 v[12:15], v2 offset:1024
  v_perm_b32 v3, v56, v56, s31
  v_and_b32 v20, v24, v3
  v_and_b32 v21, v25, v3
  v_and_b32 v22, v26, v3
  v_and_b32 v23, v27, v3
  s_waitcnt lgkmcnt(5)
  s_nop 0
  v_mfma_f32_16x16x32_bf16 v[28:31], v[20:23], v[16:19], v[28:31]
  ds_read_b128 v[16:19], v2 offset:2048
  v_mfma_f32_16x16x32_bf16 v[32:35], v[20:23], v[120:123], v[32:35]
  ds_read_b128 v[120:123], v2 offset:3072
  v_perm_b32 v3, v57, v57, s30
  v_and_b32 v20, v24, v3
  v_and_b32 v21, v25, v3
  v_and_b32 v22, v26, v3
  v_and_b32 v23, v27, v3
  s_waitcnt lgkmcnt(5)
  s_nop 0
  v_mfma_f32_16x16x32_bf16 v[28:31], v[20:23], v[124:127], v[28:31]
  ds_read_b128 v[124:127], v2 offset:4096
  v_mfma_f32_16x16x32_bf16 v[32:35], v[20:23], v[36:39], v[32:35]
  ds_read_b128 v[36:39], v2 offset:5120
  v_perm_b32 v3, v57, v57, s31
  v_and_b32 v20, v24, v3
  v_and_b32 v21, v25, v3
  v_and_b32 v22, v26, v3
  v_and_b32 v23, v27, v3
  s_waitcnt lgkmcnt(5)
  s_nop 0
  v_mfma_f32_16x16x32_bf16 v[28:31], v[20:23], v[40:43], v[28:31]
  ds_read_b128 v[40:43], v2 offset:6144
  v_mfma_f32_16x16x32_bf16 v[32:35], v[20:23], v[44:47], v[32:35]
  ds_read_b128 v[44:47], v2 offset:7168
  v_perm_b32 v3, v58, v58, s30
  v_and_b32 v20, v24, v3
  v_and_b32 v21, v25, v3
  v_and_b32 v22, v26, v3
  v_and_b32 v23, v27, v3
  s_waitcnt lgkmcnt(5)
  s_nop 0
  v_mfma_f32_16x16x32_bf16 v[28:31], v[20:23], v[12:15], v[28:31]
  v_mfma_f32_16x16x32_bf16 v[32:35], v[20:23], v[16:19], v[32:35]
  v_perm_b32 v3, v58, v58, s31
  v_and_b32 v20, v24, v3
  v_and_b32 v21, v25, v3
  v_and_b32 v22, v26, v3
  v_and_b32 v23, v27, v3
  s_waitcnt lgkmcnt(3)
  s_nop 0
  v_mfma_f32_16x16x32_bf16 v[28:31], v[20:23], v[120:123], v[28:31]
  v_mfma_f32_16x16x32_bf16 v[32:35], v[20:23], v[124:127], v[32:35]
  v_perm_b32 v3, v59, v59, s30
  v_and_b32 v20, v24, v3
  v_and_b32 v21, v25, v3
  v_and_b32 v22, v26, v3
  v_and_b32 v23, v27, v3
  s_waitcnt lgkmcnt(1)
  s_nop 0
  v_mfma_f32_16x16x32_bf16 v[28:31], v[20:23], v[36:39], v[28:31]
  v_mfma_f32_16x16x32_bf16 v[32:35], v[20:23], v[40:43], v[32:35]
  v_perm_b32 v3, v59, v59, s31
  v_and_b32 v20, v24, v3
  v_and_b32 v21, v25, v3
  v_and_b32 v22, v26, v3
  v_and_b32 v23, v27, v3
  s_waitcnt lgkmcnt(0)
  s_nop 0
  v_mfma_f32_16x16x32_bf16 v[28:31], v[20:23], v[44:47], v[28:31]
  v_mfma_f32_16x16x32_bf16 v[32:35], v[20:23], v[60:63], v[32:35]
  v_lshrrev_b32 v2, 8, v0
  v_and_b32 v3, 0xf0, v0
  v_lshlrev_b32 v3, 1, v3
  v_and_b32 v5, 1, v2
  v_lshl_add_u32 v5, v5, 4, v3
  v_add_u32 v5, s37, v5
  s_mov_b32 exec_lo, 0x00ff00ff
  s_mov_b32 exec_hi, 0xff00ff00
  ds_write_b128 v5, v[28:31]
  ds_write_b128 v5, v[32:35] offset:512
  s_mov_b64 exec, -1
  s_xor_b32 s26, s50, 32768
  v_add_u32 v5, s26, v1
  v_lshl_add_u32 v3, v2, 4, v3
  s_waitcnt lgkmcnt(0)
  s_barrier
  ds_read2st64_b32 v[36:37], v5 offset0:0 offset1:1
  ds_read2st64_b32 v[52:53], v5 offset0:2 offset1:3
  ds_read2st64_b32 v[38:39], v5 offset0:32 offset1:33
  ds_read2st64_b32 v[54:55], v5 offset0:34 offset1:35
  ds_read2st64_b32 v[40:41], v5 offset0:64 offset1:65
  ds_read2st64_b32 v[56:57], v5 offset0:66 offset1:67
  ds_read2st64_b32 v[42:43], v5 offset0:96 offset1:97
  ds_read2st64_b32 v[58:59], v5 offset0:98 offset1:99
  s_waitcnt lgkmcnt(0)
  v_add_f32 v36, v36, v40
  v_add_f32 v37, v37, v41
  v_add_f32 v38, v38, v42
  v_add_f32 v39, v39, v43
  v_add_f32 v52, v52, v56
  v_add_f32 v53, v53, v57
  v_add_f32 v54, v54, v58
  v_add_f32 v55, v55, v59
  v_add_f32 v36, v36, v38
  v_add_f32 v37, v37, v39
  v_add_f32 v52, v52, v54
  v_add_f32 v53, v53, v55
  v_add_f32 v36, v36, v37
  v_add_f32 v52, v52, v53
  v_cvt_pk_bf16_f32 v36, 0, v36
  v_cvt_pk_bf16_f32 v52, 0, v52
  v_mul_f32 v40, 0xbfb8aa3b, v36
  v_exp_f32 v40, v40
  s_nop 0
  v_add_f32 v40, 1.0, v40
  v_rcp_f32 v40, v40
  s_nop 0
  v_mul_f32 v36, v36, v40
  v_cvt_pk_bf16_f32 v36, 0, v36
  v_mul_f32 v36, v36, v52
  v_cvt_pk_bf16_f32 v36, v36, v36
  s_lshl_b32 s26, s17, 8
  s_add_u32 s26, s26, 161792
  v_add_u32 v5, s26, v1
  ds_write_b32 v5, v36
  v_mul_u32_u24 v5, 56, v2
  v_add_u32 v5, s26, v5
  ds_read_b64 v[36:37], v5 offset:0
  ds_read_b64 v[38:39], v5 offset:8
  ds_read_b64 v[40:41], v5 offset:16
  ds_read_b64 v[42:43], v5 offset:24
  ds_read_b64 v[44:45], v5 offset:32
  ds_read_b64 v[46:47], v5 offset:40
  ds_read_b64 v[52:53], v5 offset:48
  s_waitcnt lgkmcnt(0)
  v_and_b32 v20, v24, v36
  v_and_b32 v21, v25, v36
  v_and_b32 v22, v26, v36
  v_and_b32 v23, v27, v36
  s_nop 0
  s_nop 0
  v_mfma_f32_16x16x32_bf16 v[28:31], v[20:23], v[64:67], 0
  v_and_b32 v32, v24, v37
  v_and_b32 v33, v25, v37
  v_and_b32 v34, v26, v37
  v_and_b32 v35, v27, v37
  s_nop 0
  s_nop 0
  v_mfma_f32_16x16x32_bf16 v[28:31], v[32:35], v[68:71], v[28:31]
  v_and_b32 v20, v24, v38
  v_and_b32 v21, v25, v38
  v_and_b32 v22, v26, v38
  v_and_b32 v23, v27, v38
  s_nop 0
  s_nop 0
  v_mfma_f32_16x16x32_bf16 v[28:31], v[20:23], v[72:75], v[28:31]
  v_and_b32 v32, v24, v39
  v_and_b32 v33, v25, v39
  v_and_b32 v34, v26, v39
  v_and_b32 v35, v27, v39
  s_nop 0
  s_nop 0
  v_mfma_f32_16x16x32_bf16 v[28:31], v[32:35], v[76:79], v[28:31]
  v_and_b32 v20, v24, v40
  v_and_b32 v21, v25, v40
  v_and_b32 v22, v26, v40
  v_and_b32 v23, v27, v40
  s_nop 0
  s_nop 0
  v_mfma_f32_16x16x32_bf16 v[28:31], v[20:23], v[80:83], v[28:31]
  v_and_b32 v32, v24, v41
  v_and_b32 v33, v25, v41
  v_and_b32 v34, v26, v41
  v_and_b32 v35, v27, v41
  s_nop 0
  s_nop 0
  v_mfma_f32_16x16x32_bf16 v[28:31], v[32:35], v[84:87], v[28:31]
  v_and_b32 v20, v24, v42
  v_and_b32 v21, v25, v42
  v_and_b32 v22, v26, v42
  v_and_b32 v23, v27, v42
  s_nop 0
  s_nop 0
  v_mfma_f32_16x16x32_bf16 v[28:31], v[20:23], v[88:91], v[28:31]
  v_and_b32 v32, v24, v43
  v_and_b32 v33, v25, v43
  v_and_b32 v34, v26, v43
  v_and_b32 v35, v27, v43
  s_nop 0
  s_nop 0
  v_mfma_f32_16x16x32_bf16 v[28:31], v[32:35], v[92:95], v[28:31]
  v_and_b32 v20, v24, v44
  v_and_b32 v21, v25, v44
  v_and_b32 v22, v26, v44
  v_and_b32 v23, v27, v44
  s_nop 0
  s_nop 0
  v_mfma_f32_16x16x32_bf16 v[28:31], v[20:23], v[96:99], v[28:31]
  v_and_b32 v32, v24, v45
  v_and_b32 v33, v25, v45
  v_and_b32 v34, v26, v45
  v_and_b32 v35, v27, v45
  s_nop 0
  s_nop 0
  v_mfma_f32_16x16x32_bf16 v[28:31], v[32:35], v[100:103], v[28:31]
  v_and_b32 v20, v24, v46
  v_and_b32 v21, v25, v46
  v_and_b32 v22, v26, v46
  v_and_b32 v23, v27, v46
  s_nop 0
  s_nop 0
  v_mfma_f32_16x16x32_bf16 v[28:31], v[20:23], v[104:107], v[28:31]
  v_and_b32 v32, v24, v47
  v_and_b32 v33, v25, v47
  v_and_b32 v34, v26, v47
  v_and_b32 v35, v27, v47
  s_nop 0
  s_nop 0
  v_mfma_f32_16x16x32_bf16 v[28:31], v[32:35], v[108:111], v[28:31]
  v_and_b32 v20, v24, v52
  v_and_b32 v21, v25, v52
  v_and_b32 v22, v26, v52
  v_and_b32 v23, v27, v52
  s_nop 0
  s_nop 0
  v_mfma_f32_16x16x32_bf16 v[28:31], v[20:23], v[112:115], v[28:31]
  v_and_b32 v32, v24, v53
  v_and_b32 v33, v25, v53
  v_and_b32 v34, v26, v53
  v_and_b32 v35, v27, v53
  s_nop 0
  s_nop 0
  v_mfma_f32_16x16x32_bf16 v[28:31], v[32:35], v[48:51], v[28:31]
  v_lshrrev_b32 v3, 1, v3
  s_lshl_b32 s26, s47, 7
  s_add_u32 s26, s26, s57
  s_lshl_b32 s26, s26, 8
  s_add_u32 s26, s26, 244318208
  s_nop 2
  v_cvt_pk_bf16_f32 v28, v28, v29
  v_cvt_pk_bf16_f32 v29, v30, v31
  v_min_u32 v28, -2, v28
  v_min_u32 v29, -2, v29
  s_mov_b32 exec_hi, 0
  buffer_store_dwordx2 v[28:29], v3, s[4:7], s26 offen sc1
  s_mov_b32 exec_hi, -1
  s_cmp_lg_u32 s16, 0
  s_cbranch_scc1 k_nx_106
  s_barrier
  s_lshl_b32 s26, s61, 21
  s_lshl_b32 s27, s59, 10
  s_add_u32 s26, s26, s27
  s_add_u32 s27, s26, 20971520
  s_add_u32 s28, s26, 27262976
  s_lshl_b32 s26, s47, 7
  s_add_u32 s26, s26, s17
  s_lshl_b32 s26, s26, 8
  s_add_u32 s26, s26, 244318208
  v_lshrrev_b32 v2, 8, v0
  v_and_b32 v3, 0xf0, v0
  v_lshl_add_u32 v5, v2, 10, v3
  buffer_load_dwordx4 v[36:39], v0, s[4:7], s27 offen sc1
  buffer_load_dwordx4 v[40:43], v0, s[4:7], s28 offen sc1
  s_mov_b32 s53, 0
m_w_111:
  s_add_u32 s27, s26, 0
  buffer_load_dwordx4 v[60:63], v5, s[4:7], s27 offen sc1
  s_add_u32 s27, s26, 4096
  buffer_load_dwordx4 v[64:67], v5, s[4:7], s27 offen sc1
  s_add_u32 s27, s26, 8192
  buffer_load_dwordx4 v[68:71], v5, s[4:7], s27 offen sc1
  s_add_u32 s27, s26, 12288
  buffer_load_dwordx4 v[72:75], v5, s[4:7], s27 offen sc1
  s_add_u32 s27, s26, 16384
  buffer_load_dwordx4 v[76:79], v5, s[4:7], s27 offen sc1
  s_add_u32 s27, s26, 20480
  buffer_load_dwordx4 v[80:83], v5, s[4:7], s27 offen sc1
  s_add_u32 s27, s26, 24576
  buffer_load_dwordx4 v[84:87], v5, s[4:7], s27 offen sc1
  s_add_u32 s27, s26, 28672
  buffer_load_dwordx4 v[88:91], v5, s[4:7], s27 offen sc1
  s_add_u32 s53, s53, 1
  s_cmp_gt_u32 s53, 1048576
  s_cbranch_scc1 q_fail_90
  s_mov_b32 vcc_lo, 0xaaaaaaaa
  s_mov_b32 vcc_hi, 0xaaaaaaaa
  v_mov_b32 v28, 0x3f80
  v_mov_b32 v20, 1.0
  v_cndmask_b32 v28, v28, v20, vcc
  s_mov_b32 vcc_lo, 0x30003
  s_mov_b32 vcc_hi, 0x30003
  v_cndmask_b32 v20, 0, v28, vcc
  s_mov_b32 vcc_lo, 0xc000c
  s_mov_b32 vcc_hi, 0xc000c
  v_cndmask_b32 v21, 0, v28, vcc
  s_mov_b32 vcc_lo, 0x300030
  s_mov_b32 vcc_hi, 0x300030
  v_cndmask_b32 v22, 0, v28, vcc
  s_mov_b32 vcc_lo, 0xc000c0
  s_mov_b32 vcc_hi, 0xc000c0
  v_cndmask_b32 v23, 0, v28, vcc
  s_waitcnt vmcnt(7)
  s_nop 0
  v_mfma_f32_16x16x32_bf16 v[28:31], v[20:23], v[60:63], 0
  v_max3_u32 v44, v60, v61, 0
  v_max3_u32 v44, v62, v63, v44
  s_waitcnt vmcnt(6)
  v_mfma_f32_16x16x32_bf16 v[28:31], v[20:23], v[64:67], v[28:31]
  v_max3_u32 v44, v64, v65, v44
  v_max3_u32 v44, v66, v67, v44
  s_waitcnt vmcnt(5)
  v_mfma_f32_16x16x32_bf16 v[28:31], v[20:23], v[68:71], v[28:31]
  v_max3_u32 v44, v68, v69, v44
  v_max3_u32 v44, v70, v71, v44
  s_waitcnt vmcnt(4)
  v_mfma_f32_16x16x32_bf16 v[28:31], v[20:23], v[72:75], v[28:31]
  v_max3_u32 v44, v72, v73, v44
  v_max3_u32 v44, v74, v75, v44
  s_waitcnt vmcnt(3)
  v_mfma_f32_16x16x32_bf16 v[28:31], v[20:23], v[76:79], v[28:31]
  v_max3_u32 v44, v76, v77, v44
  v_max3_u32 v44, v78, v79, v44
  s_waitcnt vmcnt(2)
  v_mfma_f32_16x16x32_bf16 v[28:31], v[20:23], v[80:83], v[28:31]
  v_max3_u32 v44, v80, v81, v44
  v_max3_u32 v44, v82, v83, v44
  s_waitcnt vmcnt(1)
  v_mfma_f32_16x16x32_bf16 v[28:31], v[20:23], v[84:87], v[28:31]
  v_max3_u32 v44, v84, v85, v44
  v_max3_u32 v44, v86, v87, v44
  s_waitcnt vmcnt(0)
  v_mfma_f32_16x16x32_bf16 v[28:31], v[20:23], v[88:91], v[28:31]
  v_max3_u32 v44, v88, v89, v44
  v_max3_u32 v44, v90, v91, v44
  v_cmp_eq_u32 vcc, -1, v44
  s_cbranch_vccnz m_w_111
  v_lshlrev_b32 v3, 1, v3
  v_lshl_add_u32 v3, v2, 4, v3
  s_lshl_b32 s26, s17, 9
  s_add_u32 s26, s26, 159744
  v_add_u32 v3, s26, v3
  s_mov_b32 exec_hi, 0
  ds_write_b128 v3, v[28:31]
  s_mov_b32 exec_hi, -1
  v_lshlrev_b32 v3, 1, v0
  v_add_u32 v3, 159744, v3
  v_lshlrev_b32 v44, 16, v36
  v_and_b32 v45, 0xffff0000, v36
  v_lshlrev_b32 v46, 16, v37
  v_and_b32 v47, 0xffff0000, v37
  v_lshlrev_b32 v48, 16, v38
  v_and_b32 v49, 0xffff0000, v38
  v_lshlrev_b32 v50, 16, v39
  v_and_b32 v51, 0xffff0000, v39
  v_lshlrev_b32 v52, 16, v40
  v_and_b32 v53, 0xffff0000, v40
  v_lshlrev_b32 v54, 16, v41
  v_and_b32 v55, 0xffff0000, v41
  v_lshlrev_b32 v56, 16, v42
  v_and_b32 v57, 0xffff0000, v42
  v_lshlrev_b32 v58, 16, v43
  v_and_b32 v59, 0xffff0000, v43
  s_waitcnt lgkmcnt(0)
  s_barrier
  s_cmp_lg_u32 s17, 0
  s_cbranch_scc1 m_done_110
  ds_read_b128 v[28:31], v3
  ds_read_b128 v[32:35], v3 offset:16
  s_and_b32 s29, s58, 0xffff0000
  s_xor_b32 s27, s29, 0x80000000
  s_xor_b32 s28, s29, 0xffff0000
  s_bitcmp1_b32 s29, 31
  s_cselect_b32 s29, s27, s28
  v_mov_b32 v36, s29
  v_mul_f32 v36, 0xbfb8aa3b, v36
  v_exp_f32 v36, v36
  s_nop 0
  v_add_f32 v36, 1.0, v36
  v_rcp_f32 v36, v36
  s_nop 0
  v_cvt_pk_bf16_f32 v36, 0, v36
  v_add_f32 v60, v44, v52
  v_add_f32 v61, v45, v53
  v_add_f32 v62, v46, v54
  v_add_f32 v63, v47, v55
  v_add_f32 v64, v48, v56
  v_add_f32 v65, v49, v57
  v_add_f32 v66, v50, v58
  v_add_f32 v67, v51, v59
  v_cvt_pk_bf16_f32 v68, v60, v61
  v_cvt_pk_bf16_f32 v69, v62, v63
  v_cvt_pk_bf16_f32 v70, v64, v65
  v_cvt_pk_bf16_f32 v71, v66, v67
  v_accvgpr_write_b32 a0, v68
  v_accvgpr_write_b32 a1, v69
  v_accvgpr_write_b32 a2, v70
  v_accvgpr_write_b32 a3, v71
  s_waitcnt lgkmcnt(0)
  v_cvt_pk_bf16_f32 v28, 0, v28
  v_cvt_pk_bf16_f32 v29, 0, v29
  v_cvt_pk_bf16_f32 v30, 0, v30
  v_cvt_pk_bf16_f32 v31, 0, v31
  v_cvt_pk_bf16_f32 v32, 0, v32
  v_cvt_pk_bf16_f32 v33, 0, v33
  v_cvt_pk_bf16_f32 v34, 0, v34
  v_cvt_pk_bf16_f32 v35, 0, v35
  v_mul_f32 v28, v28, v36
  v_mul_f32 v29, v29, v36
  v_mul_f32 v30, v30, v36
  v_mul_f32 v31, v31, v36
  v_mul_f32 v32, v32, v36
  v_mul_f32 v33, v33, v36
  v_mul_f32 v34, v34, v36
  v_mul_f32 v35, v35, v36
  v_cvt_pk_bf16_f32 v28, 0, v28
  v_cvt_pk_bf16_f32 v29, 0, v29
  v_cvt_pk_bf16_f32 v30, 0, v30
  v_cvt_pk_bf16_f32 v31, 0, v31
  v_cvt_pk_bf16_f32 v32, 0, v32
  v_cvt_pk_bf16_f32 v33, 0, v33
  v_cvt_pk_bf16_f32 v34, 0, v34
  v_cvt_pk_bf16_f32 v35, 0, v35
  v_add_f32 v28, v28, v52
  v_add_f32 v29, v29, v53
  v_add_f32 v30, v30, v54
  v_add_f32 v31, v31, v55
  v_add_f32 v32, v32, v56
  v_add_f32 v33, v33, v57
  v_add_f32 v34, v34, v58
  v_add_f32 v35, v35, v59
  v_cvt_pk_bf16_f32 v28, 0, v28
  v_cvt_pk_bf16_f32 v29, 0, v29
  v_cvt_pk_bf16_f32 v30, 0, v30
  v_cvt_pk_bf16_f32 v31, 0, v31
  v_cvt_pk_bf16_f32 v32, 0, v32
  v_cvt_pk_bf16_f32 v33, 0, v33
  v_cvt_pk_bf16_f32 v34, 0, v34
  v_cvt_pk_bf16_f32 v35, 0, v35
  v_add_f32 v44, v44, v28
  v_add_f32 v45, v45, v29
  v_add_f32 v46, v46, v30
  v_add_f32 v47, v47, v31
  v_add_f32 v48, v48, v32
  v_add_f32 v49, v49, v33
  v_add_f32 v50, v50, v34
  v_add_f32 v51, v51, v35
  v_cvt_pk_bf16_f32 v40, v44, v45
  v_cvt_pk_bf16_f32 v41, v46, v47
  v_cvt_pk_bf16_f32 v42, v48, v49
  v_cvt_pk_bf16_f32 v43, v50, v51
  v_lshlrev_b32 v44, 16, v40
  v_and_b32 v45, 0xffff0000, v40
  v_lshlrev_b32 v46, 16, v41
  v_and_b32 v47, 0xffff0000, v41
  v_lshlrev_b32 v48, 16, v42
  v_and_b32 v49, 0xffff0000, v42
  v_lshlrev_b32 v50, 16, v43
  v_and_b32 v51, 0xffff0000, v43
  s_lshl_b32 s26, s59, 10
  buffer_store_dwordx4 v[40:43], v0, s[72:75], s26 offen sc1
m_done_110:
k_nx_106:
  s_add_u32 s47, s47, 3
  s_xor_b32 s48, s48, 31
  s_andn2_b32 s28, 0xfe0, s56
  s_lshl_b32 s28, s28, 7
  s_mov_b32 s29, 243793920
  v_mov_b32 v24, 262144
  s_mov_b32 s53, 0
  s_mov_b32 s33, 3
  v_mov_b32 v53, s58
  s_and_b32 s32, s48, 15
  s_cbranch_scc0 k_x_113
k_w_112:
  s_add_u32 s33, s33, 1
  s_and_b32 s33, s33, 3
  s_bitcmp1_b32 s32, s33
  s_cbranch_scc0 k_w_112
  s_lshl2_add_u32 s26, s33, s17
  s_lshl_b32 s26, s26, 14
  s_add_u32 s27, s26, 8192
  v_add_u32 v22, s26, v9
  v_cmp_le_u32 vcc, s28, v22
  s_nop 1
  v_cndmask_b32 v25, 0, v24, vcc
  v_add_u32 v22, v22, v25
  buffer_load_dword v20, v22, s[4:7], s29 offen sc1
  v_add_u32 v23, s27, v9
  v_cmp_le_u32 vcc, s28, v23
  s_nop 1
  v_cndmask_b32 v25, 0, v24, vcc
  v_add_u32 v23, v23, v25
  buffer_load_dword v21, v23, s[4:7], s29 offen sc1
  s_add_u32 s53, s53, 1
  s_cmp_gt_u32 s53, 1048576
  s_cbranch_scc1 q_fail_90
  s_waitcnt vmcnt(0)
  v_min_u32 v52, v20, v21
  v_max3_u32 v53, v20, v21, v53
  v_cmp_eq_u32 vcc, 0, v52
  s_cbranch_vccnz k_w_112
  s_bitset0_b32 s32, s33
  s_cmp_lg_u32 s32, 0
  s_cbranch_scc1 k_w_112
  v_max_u32_dpp v53, v53, v53 row_ror:8 row_mask:0xf bank_mask:0xf
  s_nop 1
  v_max_u32_dpp v53, v53, v53 row_ror:4 row_mask:0xf bank_mask:0xf
  s_nop 1
  v_max_u32_dpp v53, v53, v53 row_ror:2 row_mask:0xf bank_mask:0xf
  s_nop 1
  v_max_u32_dpp v53, v53, v53 row_ror:1 row_mask:0xf bank_mask:0xf
  v_mov_b32 v52, v53
  s_nop 0
  s_nop 0
  v_permlane16_swap_b32 v53, v52
  v_max_u32 v53, v53, v52
  v_mov_b32 v52, v53
  s_nop 0
  s_nop 0
  v_permlane32_swap_b32 v53, v52
  v_max_u32 v53, v53, v52
k_x_113:
  ds_write_b32 v118, v53 offset:256
  s_waitcnt vmcnt(0) lgkmcnt(0)
  s_barrier
  ds_read_b128 v[20:23], v119 offset:256
  s_waitcnt lgkmcnt(0)
  v_max3_u32 v20, v20, v21, v22
  v_max_u32 v20, v20, v23
  s_nop 0
  v_readfirstlane_b32 s26, v20
  s_cmp_eq_u32 s26, s58
  s_cbranch_scc1 q_fail_90
  s_cmp_eq_u32 s58, 0
  s_mov_b32 s58, s26
  s_cbranch_scc1 k_r_114
  s_cmp_lg_u32 s57, 0
  s_cbranch_scc1 k_r_114
  s_lshl_b32 s26, s59, 10
  buffer_store_dwordx4 a[0:3], v0, s[72:75], s26 offen sc1
k_r_114:
  s_andn2_b32 s26, 0xfe0, s56
  s_andn2_b32 s27, 0xfe0, s58
  s_cmp_lt_u32 s27, s26
  s_cselect_b32 s61, 1, 2
  s_andn2_b32 s59, 0xfff, s58
  s_lshl_b32 s26, s61, 21
  s_lshl_b32 s27, s59, 10
  s_add_u32 s26, s26, s27
  s_lshl_b32 s27, s17, 8
  s_add_u32 s26, s26, s27
  s_add_u32 s26, s26, 27262976
  v_lshrrev_b32 v5, 7, v0
  v_lshlrev_b32 v5, 5, v5
  buffer_load_dwordx4 v[52:55], v5, s[4:7], s26 offen offset:0 sc1
  buffer_load_dwordx4 v[56:59], v5, s[4:7], s26 offen offset:16 sc1
  s_load_dwordx2 s[64:65], s[0:1], 72
  s_load_dwordx2 s[68:69], s[0:1], 80
  s_load_dwordx2 s[8:9], s[0:1], 88
  s_mov_b32 s66, 1835008
  s_mov_b32 s70, 1835008
  s_mov_b32 s10, 1835008
  v_lshrrev_b32 v2, 7, v0
  v_and_b32 v3, 0x70, v0
  v_mul_u32_u24 v6, 57344, v2
  v_add_u32 v6, v6, v3
  v_cmp_eq_u32 vcc, 0x70, v3
  v_mov_b32 v3, 0x7ff00000
  s_nop 0
  v_cndmask_b32 v6, v6, v3, vcc
  v_lshrrev_b32 v2, 8, v0
  v_mul_u32_u24 v7, 14336, v2
  v_and_b32 v3, 0xf0, v0
  v_add_u32 v7, v7, v3
  s_mul_i32 s34, s17, 458752
  s_mul_i32 s27, s16, 112
  s_add_u32 s34, s34, s27
  s_mul_i32 s35, s16, 57344
  s_lshl_b32 s27, s17, 8
  s_add_u32 s35, s35, s27
  s_waitcnt lgkmcnt(0)
  s_xor_b32 s37, s50, 32768
  s_add_u32 s37, s37, s54
  s_mov_b32 m0, s37
  s_add_u32 s36, s34, 39424
  buffer_load_dwordx4 v6, s[68:71], s36 offen lds
  s_add_u32 m0, m0, 1024
  s_add_u32 s36, s34, 43008
  buffer_load_dwordx4 v6, s[64:67], s36 offen lds
  s_add_u32 m0, m0, 1024
  s_add_u32 s36, s34, 43008
  buffer_load_dwordx4 v6, s[68:71], s36 offen lds
  s_add_u32 m0, m0, 1024
  s_add_u32 s36, s34, 46592
  buffer_load_dwordx4 v6, s[64:67], s36 offen lds
  s_add_u32 m0, m0, 1024
  s_add_u32 s36, s34, 46592
  buffer_load_dwordx4 v6, s[68:71], s36 offen lds
  s_add_u32 m0, m0, 1024
  s_add_u32 s36, s34, 50176
  buffer_load_dwordx4 v6, s[64:67], s36 offen lds
  s_add_u32 m0, m0, 1024
  s_add_u32 s36, s34, 50176
  buffer_load_dwordx4 v6, s[68:71], s36 offen lds
  s_add_u32 m0, m0, 1024
  s_add_u32 s36, s34, 53760
  buffer_load_dwordx4 v6, s[64:67], s36 offen lds
  s_add_u32 m0, m0, 1024
  s_add_u32 s36, s34, 53760
  buffer_load_dwordx4 v[60:63], v6, s[68:71], s36 offen
  buffer_load_dwordx4 v[64:67], v7, s[8:11], s35 offen offset:0
  buffer_load_dwordx4 v[68:71], v7, s[8:11], s35 offen offset:1024
  buffer_load_dwordx4 v[72:75], v7, s[8:11], s35 offen offset:2048
  buffer_load_dwordx4 v[76:79], v7, s[8:11], s35 offen offset:3072
  s_add_u32 s35, s35, 4096
  buffer_load_dwordx4 v[80:83], v7, s[8:11], s35 offen offset:0
  buffer_load_dwordx4 v[84:87], v7, s[8:11], s35 offen offset:1024
  buffer_load_dwordx4 v[88:91], v7, s[8:11], s35 offen offset:2048
  buffer_load_dwordx4 v[92:95], v7, s[8:11], s35 offen offset:3072
  s_add_u32 s35, s35, 4096
  buffer_load_dwordx4 v[96:99], v7, s[8:11], s35 offen offset:0
  buffer_load_dwordx4 v[100:103], v7, s[8:11], s35 offen offset:1024
  buffer_load_dwordx4 v[104:107], v7, s[8:11], s35 offen offset:2048
  buffer_load_dwordx4 v[108:111], v7, s[8:11], s35 offen offset:3072
  s_add_u32 s35, s35, 4096
  buffer_load_dwordx4 v[112:115], v7, s[8:11], s35 offen offset:0
  buffer_load_dwordx4 v[48:51], v7, s[8:11], s35 offen offset:1024
  s_mov_b32 vcc_lo, 0xaaaaaaaa
  s_mov_b32 vcc_hi, 0xaaaaaaaa
  v_mov_b32 v3, 0xffff
  v_mov_b32 v24, 0xffff0000
  v_cndmask_b32 v3, v3, v24, vcc
  s_mov_b32 vcc_lo, 0x3030303
  s_mov_b32 vcc_hi, 0x3030303
  v_cndmask_b32 v24, 0, v3, vcc
  s_mov_b32 vcc_lo, 0xc0c0c0c
  s_mov_b32 vcc_hi, 0xc0c0c0c
  v_cndmask_b32 v25, 0, v3, vcc
  s_mov_b32 vcc_lo, 0x30303030
  s_mov_b32 vcc_hi, 0x30303030
  v_cndmask_b32 v26, 0, v3, vcc
  s_mov_b32 vcc_lo, 0xc0c0c0c0
  s_mov_b32 vcc_hi, 0xc0c0c0c0
  v_cndmask_b32 v27, 0, v3, vcc
  s_mov_b32 s30, 0x01000100
  s_mov_b32 s31, 0x03020302
  s_mul_i32 s26, s17, 23552
  s_add_u32 s26, s26, 65536
  v_add_u32 v5, s26, v0
  v_add_u32 v2, s37, v0
  ds_read_b128 v[36:39], v5 offset:0
  ds_read_b128 v[40:43], v5 offset:1024
  ds_read_b128 v[44:47], v5 offset:2048
  ds_read_b128 v[12:15], v5 offset:3072
  ds_read_b128 v[16:19], v5 offset:4096
  ds_read_b128 v[120:123], v5 offset:5120
  ds_read_b128 v[124:127], v5 offset:6144
  s_waitcnt vmcnt(23)
  v_perm_b32 v3, v52, v52, s30
  v_and_b32 v20, v24, v3
  v_and_b32 v21, v25, v3
  v_and_b32 v22, v26, v3
  v_and_b32 v23, v27, v3
  s_waitcnt lgkmcnt(5)
  s_nop 0
  v_mfma_f32_16x16x32_bf16 v[28:31], v[20:23], v[36:39], 0
  ds_read_b128 v[36:39], v5 offset:7168
  v_mfma_f32_16x16x32_bf16 v[32:35], v[20:23], v[40:43], 0
  ds_read_b128 v[40:43], v5 offset:8192
  v_perm_b32 v3, v52, v52, s31
  v_and_b32 v20, v24, v3
  v_and_b32 v21, v25, v3
  v_and_b32 v22, v26, v3
  v_and_b32 v23, v27, v3
  s_waitcnt lgkmcnt(5)
  s_nop 0
  v_mfma_f32_16x16x32_bf16 v[28:31], v[20:23], v[44:47], v[28:31]
  ds_read_b128 v[44:47], v5 offset:9216
  v_mfma_f32_16x16x32_bf16 v[32:35], v[20:23], v[12:15], v[32:35]
  ds_read_b128 v[12:15], v5 offset:10240
  v_perm_b32 v3, v53, v53, s30
  v_and_b32 v20, v24, v3
  v_and_b32 v21, v25, v3
  v_and_b32 v22, v26, v3
  v_and_b32 v23, v27, v3
  s_waitcnt lgkmcnt(5)
  s_nop 0
  v_mfma_f32_16x16x32_bf16 v[28:31], v[20:23], v[16:19], v[28:31]
  ds_read_b128 v[16:19], v5 offset:11264
  v_mfma_f32_16x16x32_bf16 v[32:35], v[20:23], v[120:123], v[32:35]
  ds_read_b128 v[120:123], v5 offset:12288
  v_perm_b32 v3, v53, v53, s31
  v_and_b32 v20, v24, v3
  v_and_b32 v21, v25, v3
  v_and_b32 v22, v26, v3
  v_and_b32 v23, v27, v3
  s_waitcnt lgkmcnt(5)
  s_nop 0
  v_mfma_f32_16x16x32_bf16 v[28:31], v[20:23], v[124:127], v[28:31]
  ds_read_b128 v[124:127], v5 offset:13312
  v_mfma_f32_16x16x32_bf16 v[32:35], v[20:23], v[36:39], v[32:35]
  ds_read_b128 v[36:39], v5 offset:14336
  v_perm_b32 v3, v54, v54, s30
  v_and_b32 v20, v24, v3
  v_and_b32 v21, v25, v3
  v_and_b32 v22, v26, v3
  v_and_b32 v23, v27, v3
  s_waitcnt lgkmcnt(5)
  s_nop 0
  v_mfma_f32_16x16x32_bf16 v[28:31], v[20:23], v[40:43], v[28:31]
  ds_read_b128 v[40:43], v5 offset:15360
  v_mfma_f32_16x16x32_bf16 v[32:35], v[20:23], v[44:47], v[32:35]
  ds_read_b128 v[44:47], v5 offset:16384
  v_perm_b32 v3, v54, v54, s31
  v_and_b32 v20, v24, v3
  v_and_b32 v21, v25, v3
  v_and_b32 v22, v26, v3
  v_and_b32 v23, v27, v3
  s_waitcnt lgkmcnt(5)
  s_nop 0
  v_mfma_f32_16x16x32_bf16 v[28:31], v[20:23], v[12:15], v[28:31]
  ds_read_b128 v[12:15], v5 offset:17408
  v_mfma_f32_16x16x32_bf16 v[32:35], v[20:23], v[16:19], v[32:35]
  ds_read_b128 v[16:19], v5 offset:18432
  v_perm_b32 v3, v55, v55, s30
  v_and_b32 v20, v24, v3
  v_and_b32 v21, v25, v3
  v_and_b32 v22, v26, v3
  v_and_b32 v23, v27, v3
  s_waitcnt lgkmcnt(5)
  s_nop 0
  v_mfma_f32_16x16x32_bf16 v[28:31], v[20:23], v[120:123], v[28:31]
  ds_read_b128 v[120:123], v5 offset:19456
  v_mfma_f32_16x16x32_bf16 v[32:35], v[20:23], v[124:127], v[32:35]
  ds_read_b128 v[124:127], v5 offset:20480
  v_perm_b32 v3, v55, v55, s31
  v_and_b32 v20, v24, v3
  v_and_b32 v21, v25, v3
  v_and_b32 v22, v26, v3
  v_and_b32 v23, v27, v3
  s_waitcnt lgkmcnt(5)
  s_nop 0
  v_mfma_f32_16x16x32_bf16 v[28:31], v[20:23], v[36:39], v[28:31]
  ds_read_b128 v[36:39], v5 offset:21504
  v_mfma_f32_16x16x32_bf16 v[32:35], v[20:23], v[40:43], v[32:35]
  ds_read_b128 v[40:43], v5 offset:22528
  v_perm_b32 v3, v56, v56, s30
  v_and_b32 v20, v24, v3
  v_and_b32 v21, v25, v3
  v_and_b32 v22, v26, v3
  v_and_b32 v23, v27, v3
  s_waitcnt lgkmcnt(5)
  s_nop 0
  v_mfma_f32_16x16x32_bf16 v[28:31], v[20:23], v[44:47], v[28:31]
  s_waitcnt vmcnt(22)
  ds_read_b128 v[44:47], v2 offset:0
  v_mfma_f32_16x16x32_bf16 v[32:35], v[20:23], v[12:15], v[32:35]
  s_waitcnt vmcnt(21)
  ds_read_b128 v[12:15], v2 offset:1024
  v_perm_b32 v3, v56, v56, s31
  v_and_b32 v20, v24, v3
  v_and_b32 v21, v25, v3
  v_and_b32 v22, v26, v3
  v_and_b32 v23, v27, v3
  s_waitcnt lgkmcnt(5)
  s_nop 0
  v_mfma_f32_16x16x32_bf16 v[28:31], v[20:23], v[16:19], v[28:31]
  s_waitcnt vmcnt(20)
  ds_read_b128 v[16:19], v2 offset:2048
  v_mfma_f32_16x16x32_bf16 v[32:35], v[20:23], v[120:123], v[32:35]
  s_waitcnt vmcnt(19)
  ds_read_b128 v[120:123], v2 offset:3072
  v_perm_b32 v3, v57, v57, s30
  v_and_b32 v20, v24, v3
  v_and_b32 v21, v25, v3
  v_and_b32 v22, v26, v3
  v_and_b32 v23, v27, v3
  s_waitcnt lgkmcnt(5)
  s_nop 0
  v_mfma_f32_16x16x32_bf16 v[28:31], v[20:23], v[124:127], v[28:31]
  s_waitcnt vmcnt(18)
  ds_read_b128 v[124:127], v2 offset:4096
  v_mfma_f32_16x16x32_bf16 v[32:35], v[20:23], v[36:39], v[32:35]
  s_waitcnt vmcnt(17)
  ds_read_b128 v[36:39], v2 offset:5120
  v_perm_b32 v3, v57, v57, s31
  v_and_b32 v20, v24, v3
  v_and_b32 v21, v25, v3
  v_and_b32 v22, v26, v3
  v_and_b32 v23, v27, v3
  s_waitcnt lgkmcnt(5)
  s_nop 0
  v_mfma_f32_16x16x32_bf16 v[28:31], v[20:23], v[40:43], v[28:31]
  s_waitcnt vmcnt(16)
  ds_read_b128 v[40:43], v2 offset:6144
  v_mfma_f32_16x16x32_bf16 v[32:35], v[20:23], v[44:47], v[32:35]
  s_waitcnt vmcnt(15)
  ds_read_b128 v[44:47], v2 offset:7168
  v_perm_b32 v3, v58, v58, s30
  v_and_b32 v20, v24, v3
  v_and_b32 v21, v25, v3
  v_and_b32 v22, v26, v3
  v_and_b32 v23, v27, v3
  s_waitcnt lgkmcnt(5)
  s_nop 0
  v_mfma_f32_16x16x32_bf16 v[28:31], v[20:23], v[12:15], v[28:31]
  v_mfma_f32_16x16x32_bf16 v[32:35], v[20:23], v[16:19], v[32:35]
  v_perm_b32 v3, v58, v58, s31
  v_and_b32 v20, v24, v3
  v_and_b32 v21, v25, v3
  v_and_b32 v22, v26, v3
  v_and_b32 v23, v27, v3
  s_waitcnt lgkmcnt(3)
  s_nop 0
  v_mfma_f32_16x16x32_bf16 v[28:31], v[20:23], v[120:123], v[28:31]
  v_mfma_f32_16x16x32_bf16 v[32:35], v[20:23], v[124:127], v[32:35]
  v_perm_b32 v3, v59, v59, s30
  v_and_b32 v20, v24, v3
  v_and_b32 v21, v25, v3
  v_and_b32 v22, v26, v3
  v_and_b32 v23, v27, v3
  s_waitcnt lgkmcnt(1)
  s_nop 0
  v_mfma_f32_16x16x32_bf16 v[28:31], v[20:23], v[36:39], v[28:31]
  v_mfma_f32_16x16x32_bf16 v[32:35], v[20:23], v[40:43], v[32:35]
  v_perm_b32 v3, v59, v59, s31
  v_and_b32 v20, v24, v3
  v_and_b32 v21, v25, v3
  v_and_b32 v22, v26, v3
  v_and_b32 v23, v27, v3
  s_waitcnt lgkmcnt(0)
  s_waitcnt vmcnt(14)
  v_mfma_f32_16x16x32_bf16 v[28:31], v[20:23], v[44:47], v[28:31]
  v_mfma_f32_16x16x32_bf16 v[32:35], v[20:23], v[60:63], v[32:35]
  v_lshrrev_b32 v2, 8, v0
  v_and_b32 v3, 0xf0, v0
  v_lshlrev_b32 v3, 1, v3
  v_and_b32 v5, 1, v2
  v_lshl_add_u32 v5, v5, 4, v3
  v_add_u32 v5, s37, v5
  s_mov_b32 exec_lo, 0x00ff00ff
  s_mov_b32 exec_hi, 0xff00ff00
  ds_write_b128 v5, v[28:31]
  ds_write_b128 v5, v[32:35] offset:512
  s_mov_b64 exec, -1
  s_xor_b32 s26, s50, 32768
  v_add_u32 v5, s26, v1
  v_lshl_add_u32 v3, v2, 4, v3
  s_waitcnt lgkmcnt(0)
  s_barrier
  ds_read2st64_b32 v[36:37], v5 offset0:0 offset1:1
  ds_read2st64_b32 v[52:53], v5 offset0:2 offset1:3
  ds_read2st64_b32 v[38:39], v5 offset0:32 offset1:33
  ds_read2st64_b32 v[54:55], v5 offset0:34 offset1:35
  ds_read2st64_b32 v[40:41], v5 offset0:64 offset1:65
  ds_read2st64_b32 v[56:57], v5 offset0:66 offset1:67
  ds_read2st64_b32 v[42:43], v5 offset0:96 offset1:97
  ds_read2st64_b32 v[58:59], v5 offset0:98 offset1:99
  s_waitcnt lgkmcnt(0)
  v_add_f32 v36, v36, v40
  v_add_f32 v37, v37, v41
  v_add_f32 v38, v38, v42
  v_add_f32 v39, v39, v43
  v_add_f32 v52, v52, v56
  v_add_f32 v53, v53, v57
  v_add_f32 v54, v54, v58
  v_add_f32 v55, v55, v59
  v_add_f32 v36, v36, v38
  v_add_f32 v37, v37, v39
  v_add_f32 v52, v52, v54
  v_add_f32 v53, v53, v55
  v_add_f32 v36, v36, v37
  v_add_f32 v52, v52, v53
  v_cvt_pk_bf16_f32 v36, 0, v36
  v_cvt_pk_bf16_f32 v52, 0, v52
  v_mul_f32 v40, 0xbfb8aa3b, v36
  v_exp_f32 v40, v40
  s_nop 0
  v_add_f32 v40, 1.0, v40
  v_rcp_f32 v40, v40
  s_nop 0
  v_mul_f32 v36, v36, v40
  v_cvt_pk_bf16_f32 v36, 0, v36
  v_mul_f32 v36, v36, v52
  v_cvt_pk_bf16_f32 v36, v36, v36
  s_lshl_b32 s26, s17, 8
  s_add_u32 s26, s26, 161792
  v_add_u32 v5, s26, v1
  ds_write_b32 v5, v36
  v_mul_u32_u24 v5, 56, v2
  v_add_u32 v5, s26, v5
  ds_read_b64 v[36:37], v5 offset:0
  ds_read_b64 v[38:39], v5 offset:8
  ds_read_b64 v[40:41], v5 offset:16
  ds_read_b64 v[42:43], v5 offset:24
  ds_read_b64 v[44:45], v5 offset:32
  ds_read_b64 v[46:47], v5 offset:40
  ds_read_b64 v[52:53], v5 offset:48
  s_waitcnt lgkmcnt(0)
  v_and_b32 v20, v24, v36
  v_and_b32 v21, v25, v36
  v_and_b32 v22, v26, v36
  v_and_b32 v23, v27, v36
  s_waitcnt vmcnt(13)
  s_nop 0
  v_mfma_f32_16x16x32_bf16 v[28:31], v[20:23], v[64:67], 0
  v_and_b32 v32, v24, v37
  v_and_b32 v33, v25, v37
  v_and_b32 v34, v26, v37
  v_and_b32 v35, v27, v37
  s_waitcnt vmcnt(12)
  s_nop 0
  v_mfma_f32_16x16x32_bf16 v[28:31], v[32:35], v[68:71], v[28:31]
  v_and_b32 v20, v24, v38
  v_and_b32 v21, v25, v38
  v_and_b32 v22, v26, v38
  v_and_b32 v23, v27, v38
  s_waitcnt vmcnt(11)
  s_nop 0
  v_mfma_f32_16x16x32_bf16 v[28:31], v[20:23], v[72:75], v[28:31]
  v_and_b32 v32, v24, v39
  v_and_b32 v33, v25, v39
  v_and_b32 v34, v26, v39
  v_and_b32 v35, v27, v39
  s_waitcnt vmcnt(10)
  s_nop 0
  v_mfma_f32_16x16x32_bf16 v[28:31], v[32:35], v[76:79], v[28:31]
  v_and_b32 v20, v24, v40
  v_and_b32 v21, v25, v40
  v_and_b32 v22, v26, v40
  v_and_b32 v23, v27, v40
  s_waitcnt vmcnt(9)
  s_nop 0
  v_mfma_f32_16x16x32_bf16 v[28:31], v[20:23], v[80:83], v[28:31]
  v_and_b32 v32, v24, v41
  v_and_b32 v33, v25, v41
  v_and_b32 v34, v26, v41
  v_and_b32 v35, v27, v41
  s_waitcnt vmcnt(8)
  s_nop 0
  v_mfma_f32_16x16x32_bf16 v[28:31], v[32:35], v[84:87], v[28:31]
  v_and_b32 v20, v24, v42
  v_and_b32 v21, v25, v42
  v_and_b32 v22, v26, v42
  v_and_b32 v23, v27, v42
  s_waitcnt vmcnt(7)
  s_nop 0
  v_mfma_f32_16x16x32_bf16 v[28:31], v[20:23], v[88:91], v[28:31]
  v_and_b32 v32, v24, v43
  v_and_b32 v33, v25, v43
  v_and_b32 v34, v26, v43
  v_and_b32 v35, v27, v43
  s_waitcnt vmcnt(6)
  s_nop 0
  v_mfma_f32_16x16x32_bf16 v[28:31], v[32:35], v[92:95], v[28:31]
  v_and_b32 v20, v24, v44
  v_and_b32 v21, v25, v44
  v_and_b32 v22, v26, v44
  v_and_b32 v23, v27, v44
  s_waitcnt vmcnt(5)
  s_nop 0
  v_mfma_f32_16x16x32_bf16 v[28:31], v[20:23], v[96:99], v[28:31]
  v_and_b32 v32, v24, v45
  v_and_b32 v33, v25, v45
  v_and_b32 v34, v26, v45
  v_and_b32 v35, v27, v45
  s_waitcnt vmcnt(4)
  s_nop 0
  v_mfma_f32_16x16x32_bf16 v[28:31], v[32:35], v[100:103], v[28:31]
  v_and_b32 v20, v24, v46
  v_and_b32 v21, v25, v46
  v_and_b32 v22, v26, v46
  v_and_b32 v23, v27, v46
  s_waitcnt vmcnt(3)
  s_nop 0
  v_mfma_f32_16x16x32_bf16 v[28:31], v[20:23], v[104:107], v[28:31]
  v_and_b32 v32, v24, v47
  v_and_b32 v33, v25, v47
  v_and_b32 v34, v26, v47
  v_and_b32 v35, v27, v47
  s_waitcnt vmcnt(2)
  s_nop 0
  v_mfma_f32_16x16x32_bf16 v[28:31], v[32:35], v[108:111], v[28:31]
  v_and_b32 v20, v24, v52
  v_and_b32 v21, v25, v52
  v_and_b32 v22, v26, v52
  v_and_b32 v23, v27, v52
  s_waitcnt vmcnt(1)
  s_nop 0
  v_mfma_f32_16x16x32_bf16 v[28:31], v[20:23], v[112:115], v[28:31]
  v_and_b32 v32, v24, v53
  v_and_b32 v33, v25, v53
  v_and_b32 v34, v26, v53
  v_and_b32 v35, v27, v53
  s_waitcnt vmcnt(0)
  s_nop 0
  v_mfma_f32_16x16x32_bf16 v[28:31], v[32:35], v[48:51], v[28:31]
  v_lshrrev_b32 v3, 1, v3
  s_lshl_b32 s26, s47, 7
  s_add_u32 s26, s26, s57
  s_lshl_b32 s26, s26, 8
  s_add_u32 s26, s26, 244318208
  s_nop 2
  v_cvt_pk_bf16_f32 v28, v28, v29
  v_cvt_pk_bf16_f32 v29, v30, v31
  v_min_u32 v28, -2, v28
  v_min_u32 v29, -2, v29
  s_mov_b32 exec_hi, 0
  buffer_store_dwordx2 v[28:29], v3, s[4:7], s26 offen sc1
  s_mov_b32 exec_hi, -1
  s_cmp_lg_u32 s16, 0
  s_cbranch_scc1 q_fail_90
  s_barrier
  s_lshl_b32 s26, s61, 21
  s_lshl_b32 s27, s59, 10
  s_add_u32 s26, s26, s27
  s_add_u32 s27, s26, 20971520
  s_add_u32 s28, s26, 27262976
  s_lshl_b32 s26, s47, 7
  s_add_u32 s26, s26, s17
  s_lshl_b32 s26, s26, 8
  s_add_u32 s26, s26, 244318208
  v_lshrrev_b32 v2, 8, v0
  v_and_b32 v3, 0xf0, v0
  v_lshl_add_u32 v5, v2, 10, v3
  buffer_load_dwordx4 v[36:39], v0, s[4:7], s27 offen sc1
  buffer_load_dwordx4 v[40:43], v0, s[4:7], s28 offen sc1
  s_mov_b32 s53, 0
m_w_116:
  s_add_u32 s27, s26, 0
  buffer_load_dwordx4 v[60:63], v5, s[4:7], s27 offen sc1
  s_add_u32 s27, s26, 4096
  buffer_load_dwordx4 v[64:67], v5, s[4:7], s27 offen sc1
  s_add_u32 s27, s26, 8192
  buffer_load_dwordx4 v[68:71], v5, s[4:7], s27 offen sc1
  s_add_u32 s27, s26, 12288
  buffer_load_dwordx4 v[72:75], v5, s[4:7], s27 offen sc1
  s_add_u32 s27, s26, 16384
  buffer_load_dwordx4 v[76:79], v5, s[4:7], s27 offen sc1
  s_add_u32 s27, s26, 20480
  buffer_load_dwordx4 v[80:83], v5, s[4:7], s27 offen sc1
  s_add_u32 s27, s26, 24576
  buffer_load_dwordx4 v[84:87], v5, s[4:7], s27 offen sc1
  s_add_u32 s27, s26, 28672
  buffer_load_dwordx4 v[88:91], v5, s[4:7], s27 offen sc1
  s_add_u32 s53, s53, 1
  s_cmp_gt_u32 s53, 1048576
  s_cbranch_scc1 q_fail_90
  s_mov_b32 vcc_lo, 0xaaaaaaaa
  s_mov_b32 vcc_hi, 0xaaaaaaaa
  v_mov_b32 v28, 0x3f80
  v_mov_b32 v20, 1.0
  v_cndmask_b32 v28, v28, v20, vcc
  s_mov_b32 vcc_lo, 0x30003
  s_mov_b32 vcc_hi, 0x30003
  v_cndmask_b32 v20, 0, v28, vcc
  s_mov_b32 vcc_lo, 0xc000c
  s_mov_b32 vcc_hi, 0xc000c
  v_cndmask_b32 v21, 0, v28, vcc
  s_mov_b32 vcc_lo, 0x300030
  s_mov_b32 vcc_hi, 0x300030
  v_cndmask_b32 v22, 0, v28, vcc
  s_mov_b32 vcc_lo, 0xc000c0
  s_mov_b32 vcc_hi, 0xc000c0
  v_cndmask_b32 v23, 0, v28, vcc
  s_waitcnt vmcnt(7)
  s_nop 0
  v_mfma_f32_16x16x32_bf16 v[28:31], v[20:23], v[60:63], 0
  v_max3_u32 v44, v60, v61, 0
  v_max3_u32 v44, v62, v63, v44
  s_waitcnt vmcnt(6)
  v_mfma_f32_16x16x32_bf16 v[28:31], v[20:23], v[64:67], v[28:31]
  v_max3_u32 v44, v64, v65, v44
  v_max3_u32 v44, v66, v67, v44
  s_waitcnt vmcnt(5)
  v_mfma_f32_16x16x32_bf16 v[28:31], v[20:23], v[68:71], v[28:31]
  v_max3_u32 v44, v68, v69, v44
  v_max3_u32 v44, v70, v71, v44
  s_waitcnt vmcnt(4)
  v_mfma_f32_16x16x32_bf16 v[28:31], v[20:23], v[72:75], v[28:31]
  v_max3_u32 v44, v72, v73, v44
  v_max3_u32 v44, v74, v75, v44
  s_waitcnt vmcnt(3)
  v_mfma_f32_16x16x32_bf16 v[28:31], v[20:23], v[76:79], v[28:31]
  v_max3_u32 v44, v76, v77, v44
  v_max3_u32 v44, v78, v79, v44
  s_waitcnt vmcnt(2)
  v_mfma_f32_16x16x32_bf16 v[28:31], v[20:23], v[80:83], v[28:31]
  v_max3_u32 v44, v80, v81, v44
  v_max3_u32 v44, v82, v83, v44
  s_waitcnt vmcnt(1)
  v_mfma_f32_16x16x32_bf16 v[28:31], v[20:23], v[84:87], v[28:31]
  v_max3_u32 v44, v84, v85, v44
  v_max3_u32 v44, v86, v87, v44
  s_waitcnt vmcnt(0)
  v_mfma_f32_16x16x32_bf16 v[28:31], v[20:23], v[88:91], v[28:31]
  v_max3_u32 v44, v88, v89, v44
  v_max3_u32 v44, v90, v91, v44
  v_cmp_eq_u32 vcc, -1, v44
  s_cbranch_vccnz m_w_116
  v_lshlrev_b32 v3, 1, v3
  v_lshl_add_u32 v3, v2, 4, v3
  s_lshl_b32 s26, s17, 9
  s_add_u32 s26, s26, 159744
  v_add_u32 v3, s26, v3
  s_mov_b32 exec_hi, 0
  ds_write_b128 v3, v[28:31]
  s_mov_b32 exec_hi, -1
  v_lshlrev_b32 v3, 1, v0
  v_add_u32 v3, 159744, v3
  v_lshlrev_b32 v44, 16, v36
  v_and_b32 v45, 0xffff0000, v36
  v_lshlrev_b32 v46, 16, v37
  v_and_b32 v47, 0xffff0000, v37
  v_lshlrev_b32 v48, 16, v38
  v_and_b32 v49, 0xffff0000, v38
  v_lshlrev_b32 v50, 16, v39
  v_and_b32 v51, 0xffff0000, v39
  v_lshlrev_b32 v52, 16, v40
  v_and_b32 v53, 0xffff0000, v40
  v_lshlrev_b32 v54, 16, v41
  v_and_b32 v55, 0xffff0000, v41
  v_lshlrev_b32 v56, 16, v42
  v_and_b32 v57, 0xffff0000, v42
  v_lshlrev_b32 v58, 16, v43
  v_and_b32 v59, 0xffff0000, v43
  s_waitcnt lgkmcnt(0)
  s_barrier
  s_cmp_lg_u32 s17, 0
  s_cbranch_scc1 m_done_115
  ds_read_b128 v[28:31], v3
  ds_read_b128 v[32:35], v3 offset:16
  s_and_b32 s29, s58, 0xffff0000
  s_xor_b32 s27, s29, 0x80000000
  s_xor_b32 s28, s29, 0xffff0000
  s_bitcmp1_b32 s29, 31
  s_cselect_b32 s29, s27, s28
  v_mov_b32 v36, s29
  v_mul_f32 v36, 0xbfb8aa3b, v36
  v_exp_f32 v36, v36
  s_nop 0
  v_add_f32 v36, 1.0, v36
  v_rcp_f32 v36, v36
  s_nop 0
  v_cvt_pk_bf16_f32 v36, 0, v36
  s_waitcnt lgkmcnt(0)
  v_cvt_pk_bf16_f32 v28, 0, v28
  v_cvt_pk_bf16_f32 v29, 0, v29
  v_cvt_pk_bf16_f32 v30, 0, v30
  v_cvt_pk_bf16_f32 v31, 0, v31
  v_cvt_pk_bf16_f32 v32, 0, v32
  v_cvt_pk_bf16_f32 v33, 0, v33
  v_cvt_pk_bf16_f32 v34, 0, v34
  v_cvt_pk_bf16_f32 v35, 0, v35
  v_mul_f32 v28, v28, v36
  v_mul_f32 v29, v29, v36
  v_mul_f32 v30, v30, v36
  v_mul_f32 v31, v31, v36
  v_mul_f32 v32, v32, v36
  v_mul_f32 v33, v33, v36
  v_mul_f32 v34, v34, v36
  v_mul_f32 v35, v35, v36
  v_cvt_pk_bf16_f32 v28, 0, v28
  v_cvt_pk_bf16_f32 v29, 0, v29
  v_cvt_pk_bf16_f32 v30, 0, v30
  v_cvt_pk_bf16_f32 v31, 0, v31
  v_cvt_pk_bf16_f32 v32, 0, v32
  v_cvt_pk_bf16_f32 v33, 0, v33
  v_cvt_pk_bf16_f32 v34, 0, v34
  v_cvt_pk_bf16_f32 v35, 0, v35
  v_add_f32 v28, v28, v52
  v_add_f32 v29, v29, v53
  v_add_f32 v30, v30, v54
  v_add_f32 v31, v31, v55
  v_add_f32 v32, v32, v56
  v_add_f32 v33, v33, v57
  v_add_f32 v34, v34, v58
  v_add_f32 v35, v35, v59
  v_cvt_pk_bf16_f32 v28, 0, v28
  v_cvt_pk_bf16_f32 v29, 0, v29
  v_cvt_pk_bf16_f32 v30, 0, v30
  v_cvt_pk_bf16_f32 v31, 0, v31
  v_cvt_pk_bf16_f32 v32, 0, v32
  v_cvt_pk_bf16_f32 v33, 0, v33
  v_cvt_pk_bf16_f32 v34, 0, v34
  v_cvt_pk_bf16_f32 v35, 0, v35
  v_add_f32 v44, v44, v28
  v_add_f32 v45, v45, v29
  v_add_f32 v46, v46, v30
  v_add_f32 v47, v47, v31
  v_add_f32 v48, v48, v32
  v_add_f32 v49, v49, v33
  v_add_f32 v50, v50, v34
  v_add_f32 v51, v51, v35
  v_cvt_pk_bf16_f32 v40, v44, v45
  v_cvt_pk_bf16_f32 v41, v46, v47
  v_cvt_pk_bf16_f32 v42, v48, v49
  v_cvt_pk_bf16_f32 v43, v50, v51
  v_lshlrev_b32 v44, 16, v40
  v_and_b32 v45, 0xffff0000, v40
  v_lshlrev_b32 v46, 16, v41
  v_and_b32 v47, 0xffff0000, v41
  v_lshlrev_b32 v48, 16, v42
  v_and_b32 v49, 0xffff0000, v42
  v_lshlrev_b32 v50, 16, v43
  v_and_b32 v51, 0xffff0000, v43
  s_lshl_b32 s26, s59, 10
  buffer_store_dwordx4 v[40:43], v0, s[72:75], s26 offen sc1
m_done_115:
q_fail_90:
  s_endpgm
L_o:
  s_sub_u32 s60, s91, 3
  s_and_b32 s61, s90, 15
  s_load_dwordx2 s[80:81], s[0:1], 40
  s_load_dwordx2 s[72:73], s[0:1], 0
  s_mov_b32 s82, 4194304
  v_and_b32 v42, 63, v0
  v_and_b32 v40, 15, v42
  v_lshrrev_b32 v41, 4, v42
  v_lshlrev_b32 v1, 3, v42
  v_lshlrev_b32 v2, 2, v42
  v_lshlrev_b32 v0, 4, v42
  s_mov_b32 s24, 0x3e0293ee
  s_mov_b32 s44, 0x05040100
  s_mov_b32 s45, 0x07060302
  s_and_b32 s26, s17, 1
  s_lshl_b32 s26, s26, 4
  v_lshlrev_b32 v43, 2, v41
  v_sub_u32 v43, v40, v43
  v_add_u32 v43, s26, v43
  v_mov_b32 v7, 0xfe000000
  v_cmp_le_i32 vcc, 0, v43
  s_nop 1
  v_cndmask_b32 v24, v7, 0, vcc
  v_cmp_le_i32 vcc, 1, v43
  s_nop 1
  v_cndmask_b32 v25, v7, 0, vcc
  v_cmp_le_i32 vcc, 2, v43
  s_nop 1
  v_cndmask_b32 v26, v7, 0, vcc
  v_cmp_le_i32 vcc, 3, v43
  s_nop 1
  v_cndmask_b32 v27, v7, 0, vcc
  v_cmp_le_i32 vcc, 16, v43
  s_nop 1
  v_cndmask_b32 v28, v7, 0, vcc
  v_cmp_le_i32 vcc, 17, v43
  s_nop 1
  v_cndmask_b32 v29, v7, 0, vcc
  v_cmp_le_i32 vcc, 18, v43
  s_nop 1
  v_cndmask_b32 v30, v7, 0, vcc
  v_cmp_le_i32 vcc, 19, v43
  s_nop 1
  v_cndmask_b32 v31, v7, 0, vcc
  v_lshrrev_b32 v43, 5, v42
  v_lshlrev_b32 v43, 16, v43
  v_and_b32 v4, 1, v41
  v_lshl_add_u32 v43, v4, 14, v43
  v_lshl_add_u32 v43, v40, 4, v43
  s_lshl_b32 s26, s61, 10
  s_lshl_b32 s27, s17, 8
  s_add_u32 s26, s26, s27
  v_add_u32 v4, s26, v43
  v_lshlrev_b32 v43, 10, v41
  v_lshl_add_u32 v5, v40, 4, v43
  s_lshl_b32 s26, s17, 12
  v_add_u32 v6, s26, v0
  v_and_b32 v43, 1, v41
  v_lshlrev_b32 v43, 12, v43
  v_lshl_add_u32 v43, v40, 4, v43
  v_lshrrev_b32 v3, 1, v41
  v_lshl_add_u32 v3, v3, 8, v43
  s_lshr_b32 s26, s17, 1
  s_lshl_b32 s27, s26, 14
  s_add_u32 s27, s27, 16384
  v_add_u32 v32, s27, v0
  s_lshl_b32 s27, s26, 13
  s_and_b32 s28, s17, 1
  s_lshl_b32 s28, s28, 10
  s_add_u32 s28, s28, s27
  s_add_u32 s28, s28, 49152
  v_add_u32 v33, s28, v0
  s_add_u32 s27, s27, 65536
  v_add_u32 v34, s27, v0
  v_add_u32 v35, s27, v1
  v_and_b32 v36, 0xf0, v0
  v_and_b32 v252, 64, v0
  v_mov_b32 v248, 0
  v_lshlrev_b32 v255, 4, v0
  v_and_b32 v43, 1, v42
  v_xor_b32 v254, 1, v43
  s_lshl_b32 s26, s17, 3
  s_add_u32 s26, s26, 81920
  v_mov_b32 v39, s26
  s_mov_b32 vcc_lo, 0xaaaaaaaa
  s_mov_b32 vcc_hi, 0xaaaaaaaa
  v_mov_b32 v43, 0x3f80
  v_cndmask_b32 v43, v43, 1.0, vcc
  s_mov_b32 vcc_lo, 0xf000f
  s_mov_b32 vcc_hi, 0xf000f00
  v_cndmask_b32 v16, 0, v43, vcc
  v_cndmask_b32 v18, 0, v43, vcc
  s_mov_b32 vcc_lo, 0xf000f0
  s_mov_b32 vcc_hi, 0xf000f000
  v_cndmask_b32 v17, 0, v43, vcc
  v_cndmask_b32 v19, 0, v43, vcc
  s_mov_b32 vcc_lo, 0xcccccccc
  s_mov_b32 vcc_hi, 0xcccccccc
  v_mov_b32 v43, 0x4444
  v_mov_b32 v20, 0xeeee
  v_cndmask_b32 v20, v43, v20, vcc
  s_mov_b32 s70, 2097152
  s_mov_b32 s71, 0x20000
  s_mov_b32 s74, 2097152
  s_mov_b32 s75, 0x20000
  s_mov_b32 s10, 1024
  s_mov_b32 s83, 0x20000
  s_lshr_b32 s85, s17, 1
  s_lshl_b32 s26, s61, 1
  s_add_u32 s85, s85, s26
  s_add_u32 s43, s26, s17
  s_lshl_b32 s14, s61, 8
  s_lshl_b32 s15, s61, 7
  s_add_u32 s15, s15, 245104640
  s_add_u32 s14, s14, 244318208
  s_lshl_b32 s26, s61, 2
  s_add_u32 s26, s26, s17
  s_lshl_b32 s18, s26, 13
  s_add_u32 s18, s18, 41943040
  s_lshl_b32 s19, s26, 12
  s_add_u32 s19, s19, 142606336
  s_lshl_b32 s20, s85, 13
  s_add_u32 s20, s20, 192937984
  s_and_b32 s26, s17, 1
  s_mul_i32 s26, s26, 3072
  s_add_u32 s21, s20, s26
  s_lshr_b32 s40, s17, 1
  s_lshl_b32 s40, s40, 13
  s_add_u32 s40, s40, s26
  s_add_u32 s40, s40, 65536
  s_lshl_b32 s22, s17, 12
  s_add_u32 s22, s22, 49152
  s_lshl_b32 s23, s17, 13
  s_add_u32 s23, s23, 16384
  s_lshl_b32 s41, s60, 20
  s_add_u32 s41, s41, 12582912
  v_lshlrev_b32 v246, 3, v0
  s_mov_b32 s11, 0x20000
  s_waitcnt lgkmcnt(0)
  s_lshl_b32 s77, s60, 4
  s_add_u32 s77, s77, s61
  s_lshl_b32 s77, s77, 2
  s_add_u32 s77, s77, s17
  s_lshl_b32 s26, s77, 10
  buffer_load_dwordx4 v[176:179], v0, s[72:75], s26 offen
  s_add_u32 s26, s26, 262144
  buffer_load_dwordx4 v[180:183], v0, s[72:75], s26 offen
  s_add_u32 s26, s26, 262144
  buffer_load_dwordx4 v[184:187], v0, s[72:75], s26 offen
  s_add_u32 s26, s26, 262144
  buffer_load_dwordx4 v[188:191], v0, s[72:75], s26 offen
  s_add_u32 s26, s26, 262144
  buffer_load_dwordx4 v[192:195], v0, s[72:75], s26 offen
  s_add_u32 s26, s26, 262144
  buffer_load_dwordx4 v[196:199], v0, s[72:75], s26 offen
  s_add_u32 s26, s26, 262144
  buffer_load_dwordx4 v[200:203], v0, s[72:75], s26 offen
  s_add_u32 s26, s26, 262144
  buffer_load_dwordx4 v[204:207], v0, s[72:75], s26 offen
  s_add_u32 s26, s26, 262144
  v_lshrrev_b32 v44, 9, v0
  v_lshlrev_b32 v44, 12, v44
  v_and_b32 v45, 0xf0, v0
  v_add_u32 v44, v44, v45
  v_bfe_u32 v45, v0, 8, 1
  v_lshl_add_u32 v44, v45, 3, v44
  s_lshl_b32 s30, s61, 18
  s_lshl_b32 s27, s17, 8
  s_add_u32 s30, s30, s27
  s_add_u32 s27, s30, 0
  buffer_load_dwordx2 v[64:65], v44, s[80:83], s27 offen
  s_add_u32 s27, s30, 1024
  buffer_load_dwordx2 v[66:67], v44, s[80:83], s27 offen
  s_add_u32 s27, s30, 2048
  buffer_load_dwordx2 v[68:69], v44, s[80:83], s27 offen
  s_add_u32 s27, s30, 3072
  buffer_load_dwordx2 v[70:71], v44, s[80:83], s27 offen
  s_add_u32 s27, s30, 16384
  buffer_load_dwordx2 v[72:73], v44, s[80:83], s27 offen
  s_add_u32 s27, s30, 17408
  buffer_load_dwordx2 v[74:75], v44, s[80:83], s27 offen
  s_add_u32 s27, s30, 18432
  buffer_load_dwordx2 v[76:77], v44, s[80:83], s27 offen
  s_add_u32 s27, s30, 19456
  buffer_load_dwordx2 v[78:79], v44, s[80:83], s27 offen
  s_add_u32 s27, s30, 8192
  buffer_load_dwordx2 v[80:81], v44, s[80:83], s27 offen
  s_add_u32 s27, s30, 9216
  buffer_load_dwordx2 v[82:83], v44, s[80:83], s27 offen
  s_add_u32 s27, s30, 10240
  buffer_load_dwordx2 v[84:85], v44, s[80:83], s27 offen
  s_add_u32 s27, s30, 11264
  buffer_load_dwordx2 v[86:87], v44, s[80:83], s27 offen
  s_add_u32 s27, s30, 24576
  buffer_load_dwordx2 v[88:89], v44, s[80:83], s27 offen
  s_add_u32 s27, s30, 25600
  buffer_load_dwordx2 v[90:91], v44, s[80:83], s27 offen
  s_add_u32 s27, s30, 26624
  buffer_load_dwordx2 v[92:93], v44, s[80:83], s27 offen
  s_add_u32 s27, s30, 27648
  buffer_load_dwordx2 v[94:95], v44, s[80:83], s27 offen
  s_add_u32 s27, s30, 32768
  buffer_load_dwordx2 v[96:97], v44, s[80:83], s27 offen
  s_add_u32 s27, s30, 33792
  buffer_load_dwordx2 v[98:99], v44, s[80:83], s27 offen
  s_add_u32 s27, s30, 34816
  buffer_load_dwordx2 v[100:101], v44, s[80:83], s27 offen
  s_add_u32 s27, s30, 35840
  buffer_load_dwordx2 v[102:103], v44, s[80:83], s27 offen
  s_add_u32 s27, s30, 49152
  buffer_load_dwordx2 v[104:105], v44, s[80:83], s27 offen
  s_add_u32 s27, s30, 50176
  buffer_load_dwordx2 v[106:107], v44, s[80:83], s27 offen
  s_add_u32 s27, s30, 51200
  buffer_load_dwordx2 v[108:109], v44, s[80:83], s27 offen
  s_add_u32 s27, s30, 52224
  buffer_load_dwordx2 v[110:111], v44, s[80:83], s27 offen
  s_add_u32 s27, s30, 40960
  buffer_load_dwordx2 v[112:113], v44, s[80:83], s27 offen
  s_add_u32 s27, s30, 41984
  buffer_load_dwordx2 v[114:115], v44, s[80:83], s27 offen
  s_add_u32 s27, s30, 43008
  buffer_load_dwordx2 v[116:117], v44, s[80:83], s27 offen
  s_add_u32 s27, s30, 44032
  buffer_load_dwordx2 v[118:119], v44, s[80:83], s27 offen
  s_add_u32 s27, s30, 57344
  buffer_load_dwordx2 v[120:121], v44, s[80:83], s27 offen
  s_add_u32 s27, s30, 58368
  buffer_load_dwordx2 v[122:123], v44, s[80:83], s27 offen
  s_add_u32 s27, s30, 59392
  buffer_load_dwordx2 v[124:125], v44, s[80:83], s27 offen
  s_add_u32 s27, s30, 60416
  buffer_load_dwordx2 v[126:127], v44, s[80:83], s27 offen
  s_load_dwordx2 s[4:5], s[0:1], 112
  s_load_dwordx2 s[12:13], s[0:1], 104
  s_load_dwordx2 s[68:69], s[0:1], 96
  s_load_dwordx2 s[8:9], s[0:1], 64
  s_waitcnt lgkmcnt(0)
  buffer_load_dwordx4 v[56:59], v0, s[8:11], 0 offen
  s_lshl_b32 s29, s77, 10
  s_add_u32 s29, s29, 6291456
  s_cmp_lt_u32 s60, 4
  s_cbranch_scc1 o_s1_117
  s_waitcnt vmcnt(0)
  s_branch o_s2_118
o_s1_117:
  s_waitcnt vmcnt(40)
  v_lshlrev_b32 v212, 16, v176
  v_and_b32 v213, 0xffff0000, v176
  v_lshlrev_b32 v214, 16, v177
  v_and_b32 v215, 0xffff0000, v177
  v_lshlrev_b32 v216, 16, v178
  v_and_b32 v217, 0xffff0000, v178
  v_lshlrev_b32 v218, 16, v179
  v_and_b32 v219, 0xffff0000, v179
  v_add_f32 v220, v212, v213
  v_add_f32 v221, v214, v215
  v_add_f32 v222, v216, v217
  v_add_f32 v223, v218, v219
  v_add_f32 v220, v220, v221
  v_add_f32 v222, v222, v223
  v_add_f32 v220, v220, v222
  s_nop 1
  v_add_f32_dpp v220, v220, v220 row_ror:8 row_mask:0xf bank_mask:0xf
  s_nop 1
  v_add_f32_dpp v220, v220, v220 row_ror:4 row_mask:0xf bank_mask:0xf
  s_nop 1
  v_add_f32_dpp v220, v220, v220 row_ror:2 row_mask:0xf bank_mask:0xf
  s_nop 1
  v_add_f32_dpp v220, v220, v220 row_ror:1 row_mask:0xf bank_mask:0xf
  v_mov_b32 v222, v220
  s_nop 0
  s_nop 0
  v_permlane16_swap_b32 v220, v222
  v_add_f32 v220, v220, v222
  v_mov_b32 v222, v220
  s_nop 0
  s_nop 0
  v_permlane32_swap_b32 v220, v222
  v_add_f32 v220, v220, v222
  v_mul_f32 v220, 0x3b000000, v220
  v_sub_f32 v224, v212, v220
  v_sub_f32 v225, v213, v220
  v_sub_f32 v226, v214, v220
  v_sub_f32 v227, v215, v220
  v_sub_f32 v228, v216, v220
  v_sub_f32 v229, v217, v220
  v_sub_f32 v230, v218, v220
  v_sub_f32 v231, v219, v220
  v_mul_f32 v221, v224, v224
  v_mul_f32 v222, v225, v225
  v_fmac_f32 v221, v226, v226
  v_fmac_f32 v222, v227, v227
  v_fmac_f32 v221, v228, v228
  v_fmac_f32 v222, v229, v229
  v_fmac_f32 v221, v230, v230
  v_fmac_f32 v222, v231, v231
  v_add_f32 v221, v221, v222
  v_cvt_pk_bf16_f32 v220, 0, v220
  s_nop 0
  v_add_f32_dpp v221, v221, v221 row_ror:8 row_mask:0xf bank_mask:0xf
  v_sub_f32 v224, v212, v220
  v_sub_f32 v225, v213, v220
  v_add_f32_dpp v221, v221, v221 row_ror:4 row_mask:0xf bank_mask:0xf
  v_sub_f32 v226, v214, v220
  v_sub_f32 v227, v215, v220
  v_add_f32_dpp v221, v221, v221 row_ror:2 row_mask:0xf bank_mask:0xf
  v_sub_f32 v228, v216, v220
  v_sub_f32 v229, v217, v220
  v_add_f32_dpp v221, v221, v221 row_ror:1 row_mask:0xf bank_mask:0xf
  v_sub_f32 v230, v218, v220
  v_sub_f32 v231, v219, v220
  v_mov_b32 v222, v221
  v_cvt_pk_bf16_f32 v224, 0, v224
  v_cvt_pk_bf16_f32 v225, 0, v225
  v_permlane16_swap_b32 v221, v222
  v_cvt_pk_bf16_f32 v226, 0, v226
  v_cvt_pk_bf16_f32 v227, 0, v227
  v_add_f32 v221, v221, v222
  v_cvt_pk_bf16_f32 v228, 0, v228
  v_cvt_pk_bf16_f32 v229, 0, v229
  v_mov_b32 v222, v221
  v_cvt_pk_bf16_f32 v230, 0, v230
  v_cvt_pk_bf16_f32 v231, 0, v231
  v_permlane32_swap_b32 v221, v222
  v_add_f32 v221, v221, v222
  v_mul_f32 v221, 0x3b000000, v221
  v_cvt_pk_bf16_f32 v221, 0, v221
  v_add_f32 v221, 0x3727c5ac, v221
  v_cvt_pk_bf16_f32 v221, 0, v221
  v_sqrt_f32 v221, v221
  s_nop 0
  v_cvt_pk_bf16_f32 v221, 0, v221
  v_rcp_f32 v221, v221
  s_nop 0
  v_mul_f32 v224, v224, v221
  v_mul_f32 v225, v225, v221
  v_mul_f32 v226, v226, v221
  v_mul_f32 v227, v227, v221
  v_mul_f32 v228, v228, v221
  v_mul_f32 v229, v229, v221
  v_mul_f32 v230, v230, v221
  v_mul_f32 v231, v231, v221
  v_cvt_pk_bf16_f32 v176, v224, v225
  v_cvt_pk_bf16_f32 v177, v226, v227
  v_cvt_pk_bf16_f32 v178, v228, v229
  v_cvt_pk_bf16_f32 v179, v230, v231
  buffer_store_dwordx4 v[176:179], v0, s[4:7], s29 offen sc1
  s_add_u32 s29, s29, 262144
  s_waitcnt vmcnt(40)
  v_lshlrev_b32 v212, 16, v180
  v_and_b32 v213, 0xffff0000, v180
  v_lshlrev_b32 v214, 16, v181
  v_and_b32 v215, 0xffff0000, v181
  v_lshlrev_b32 v216, 16, v182
  v_and_b32 v217, 0xffff0000, v182
  v_lshlrev_b32 v218, 16, v183
  v_and_b32 v219, 0xffff0000, v183
  v_add_f32 v220, v212, v213
  v_add_f32 v221, v214, v215
  v_add_f32 v222, v216, v217
  v_add_f32 v223, v218, v219
  v_add_f32 v220, v220, v221
  v_add_f32 v222, v222, v223
  v_add_f32 v220, v220, v222
  s_nop 1
  v_add_f32_dpp v220, v220, v220 row_ror:8 row_mask:0xf bank_mask:0xf
  s_nop 1
  v_add_f32_dpp v220, v220, v220 row_ror:4 row_mask:0xf bank_mask:0xf
  s_nop 1
  v_add_f32_dpp v220, v220, v220 row_ror:2 row_mask:0xf bank_mask:0xf
  s_nop 1
  v_add_f32_dpp v220, v220, v220 row_ror:1 row_mask:0xf bank_mask:0xf
  v_mov_b32 v222, v220
  s_nop 0
  s_nop 0
  v_permlane16_swap_b32 v220, v222
  v_add_f32 v220, v220, v222
  v_mov_b32 v222, v220
  s_nop 0
  s_nop 0
  v_permlane32_swap_b32 v220, v222
  v_add_f32 v220, v220, v222
  v_mul_f32 v220, 0x3b000000, v220
  v_sub_f32 v224, v212, v220
  v_sub_f32 v225, v213, v220
  v_sub_f32 v226, v214, v220
  v_sub_f32 v227, v215, v220
  v_sub_f32 v228, v216, v220
  v_sub_f32 v229, v217, v220
  v_sub_f32 v230, v218, v220
  v_sub_f32 v231, v219, v220
  v_mul_f32 v221, v224, v224
  v_mul_f32 v222, v225, v225
  v_fmac_f32 v221, v226, v226
  v_fmac_f32 v222, v227, v227
  v_fmac_f32 v221, v228, v228
  v_fmac_f32 v222, v229, v229
  v_fmac_f32 v221, v230, v230
  v_fmac_f32 v222, v231, v231
  v_add_f32 v221, v221, v222
  v_cvt_pk_bf16_f32 v220, 0, v220
  s_nop 0
  v_add_f32_dpp v221, v221, v221 row_ror:8 row_mask:0xf bank_mask:0xf
  v_sub_f32 v224, v212, v220
  v_sub_f32 v225, v213, v220
  v_add_f32_dpp v221, v221, v221 row_ror:4 row_mask:0xf bank_mask:0xf
  v_sub_f32 v226, v214, v220
  v_sub_f32 v227, v215, v220
  v_add_f32_dpp v221, v221, v221 row_ror:2 row_mask:0xf bank_mask:0xf
  v_sub_f32 v228, v216, v220
  v_sub_f32 v229, v217, v220
  v_add_f32_dpp v221, v221, v221 row_ror:1 row_mask:0xf bank_mask:0xf
  v_sub_f32 v230, v218, v220
  v_sub_f32 v231, v219, v220
  v_mov_b32 v222, v221
  v_cvt_pk_bf16_f32 v224, 0, v224
  v_cvt_pk_bf16_f32 v225, 0, v225
  v_permlane16_swap_b32 v221, v222
  v_cvt_pk_bf16_f32 v226, 0, v226
  v_cvt_pk_bf16_f32 v227, 0, v227
  v_add_f32 v221, v221, v222
  v_cvt_pk_bf16_f32 v228, 0, v228
  v_cvt_pk_bf16_f32 v229, 0, v229
  v_mov_b32 v222, v221
  v_cvt_pk_bf16_f32 v230, 0, v230
  v_cvt_pk_bf16_f32 v231, 0, v231
  v_permlane32_swap_b32 v221, v222
  v_add_f32 v221, v221, v222
  v_mul_f32 v221, 0x3b000000, v221
  v_cvt_pk_bf16_f32 v221, 0, v221
  v_add_f32 v221, 0x3727c5ac, v221
  v_cvt_pk_bf16_f32 v221, 0, v221
  v_sqrt_f32 v221, v221
  s_nop 0
  v_cvt_pk_bf16_f32 v221, 0, v221
  v_rcp_f32 v221, v221
  s_nop 0
  v_mul_f32 v224, v224, v221
  v_mul_f32 v225, v225, v221
  v_mul_f32 v226, v226, v221
  v_mul_f32 v227, v227, v221
  v_mul_f32 v228, v228, v221
  v_mul_f32 v229, v229, v221
  v_mul_f32 v230, v230, v221
  v_mul_f32 v231, v231, v221
  v_cvt_pk_bf16_f32 v180, v224, v225
  v_cvt_pk_bf16_f32 v181, v226, v227
  v_cvt_pk_bf16_f32 v182, v228, v229
  v_cvt_pk_bf16_f32 v183, v230, v231
  buffer_store_dwordx4 v[180:183], v0, s[4:7], s29 offen sc1
  s_add_u32 s29, s29, 262144
  s_waitcnt vmcnt(40)
  v_lshlrev_b32 v212, 16, v184
  v_and_b32 v213, 0xffff0000, v184
  v_lshlrev_b32 v214, 16, v185
  v_and_b32 v215, 0xffff0000, v185
  v_lshlrev_b32 v216, 16, v186
  v_and_b32 v217, 0xffff0000, v186
  v_lshlrev_b32 v218, 16, v187
  v_and_b32 v219, 0xffff0000, v187
  v_add_f32 v220, v212, v213
  v_add_f32 v221, v214, v215
  v_add_f32 v222, v216, v217
  v_add_f32 v223, v218, v219
  v_add_f32 v220, v220, v221
  v_add_f32 v222, v222, v223
  v_add_f32 v220, v220, v222
  s_nop 1
  v_add_f32_dpp v220, v220, v220 row_ror:8 row_mask:0xf bank_mask:0xf
  s_nop 1
  v_add_f32_dpp v220, v220, v220 row_ror:4 row_mask:0xf bank_mask:0xf
  s_nop 1
  v_add_f32_dpp v220, v220, v220 row_ror:2 row_mask:0xf bank_mask:0xf
  s_nop 1
  v_add_f32_dpp v220, v220, v220 row_ror:1 row_mask:0xf bank_mask:0xf
  v_mov_b32 v222, v220
  s_nop 0
  s_nop 0
  v_permlane16_swap_b32 v220, v222
  v_add_f32 v220, v220, v222
  v_mov_b32 v222, v220
  s_nop 0
  s_nop 0
  v_permlane32_swap_b32 v220, v222
  v_add_f32 v220, v220, v222
  v_mul_f32 v220, 0x3b000000, v220
  v_sub_f32 v224, v212, v220
  v_sub_f32 v225, v213, v220
  v_sub_f32 v226, v214, v220
  v_sub_f32 v227, v215, v220
  v_sub_f32 v228, v216, v220
  v_sub_f32 v229, v217, v220
  v_sub_f32 v230, v218, v220
  v_sub_f32 v231, v219, v220
  v_mul_f32 v221, v224, v224
  v_mul_f32 v222, v225, v225
  v_fmac_f32 v221, v226, v226
  v_fmac_f32 v222, v227, v227
  v_fmac_f32 v221, v228, v228
  v_fmac_f32 v222, v229, v229
  v_fmac_f32 v221, v230, v230
  v_fmac_f32 v222, v231, v231
  v_add_f32 v221, v221, v222
  v_cvt_pk_bf16_f32 v220, 0, v220
  s_nop 0
  v_add_f32_dpp v221, v221, v221 row_ror:8 row_mask:0xf bank_mask:0xf
  v_sub_f32 v224, v212, v220
  v_sub_f32 v225, v213, v220
  v_add_f32_dpp v221, v221, v221 row_ror:4 row_mask:0xf bank_mask:0xf
  v_sub_f32 v226, v214, v220
  v_sub_f32 v227, v215, v220
  v_add_f32_dpp v221, v221, v221 row_ror:2 row_mask:0xf bank_mask:0xf
  v_sub_f32 v228, v216, v220
  v_sub_f32 v229, v217, v220
  v_add_f32_dpp v221, v221, v221 row_ror:1 row_mask:0xf bank_mask:0xf
  v_sub_f32 v230, v218, v220
  v_sub_f32 v231, v219, v220
  v_mov_b32 v222, v221
  v_cvt_pk_bf16_f32 v224, 0, v224
  v_cvt_pk_bf16_f32 v225, 0, v225
  v_permlane16_swap_b32 v221, v222
  v_cvt_pk_bf16_f32 v226, 0, v226
  v_cvt_pk_bf16_f32 v227, 0, v227
  v_add_f32 v221, v221, v222
  v_cvt_pk_bf16_f32 v228, 0, v228
  v_cvt_pk_bf16_f32 v229, 0, v229
  v_mov_b32 v222, v221
  v_cvt_pk_bf16_f32 v230, 0, v230
  v_cvt_pk_bf16_f32 v231, 0, v231
  v_permlane32_swap_b32 v221, v222
  v_add_f32 v221, v221, v222
  v_mul_f32 v221, 0x3b000000, v221
  v_cvt_pk_bf16_f32 v221, 0, v221
  v_add_f32 v221, 0x3727c5ac, v221
  v_cvt_pk_bf16_f32 v221, 0, v221
  v_sqrt_f32 v221, v221
  s_nop 0
  v_cvt_pk_bf16_f32 v221, 0, v221
  v_rcp_f32 v221, v221
  s_nop 0
  v_mul_f32 v224, v224, v221
  v_mul_f32 v225, v225, v221
  v_mul_f32 v226, v226, v221
  v_mul_f32 v227, v227, v221
  v_mul_f32 v228, v228, v221
  v_mul_f32 v229, v229, v221
  v_mul_f32 v230, v230, v221
  v_mul_f32 v231, v231, v221
  v_cvt_pk_bf16_f32 v184, v224, v225
  v_cvt_pk_bf16_f32 v185, v226, v227
  v_cvt_pk_bf16_f32 v186, v228, v229
  v_cvt_pk_bf16_f32 v187, v230, v231
  buffer_store_dwordx4 v[184:187], v0, s[4:7], s29 offen sc1
  s_add_u32 s29, s29, 262144
  s_waitcnt vmcnt(40)
  v_lshlrev_b32 v212, 16, v188
  v_and_b32 v213, 0xffff0000, v188
  v_lshlrev_b32 v214, 16, v189
  v_and_b32 v215, 0xffff0000, v189
  v_lshlrev_b32 v216, 16, v190
  v_and_b32 v217, 0xffff0000, v190
  v_lshlrev_b32 v218, 16, v191
  v_and_b32 v219, 0xffff0000, v191
  v_add_f32 v220, v212, v213
  v_add_f32 v221, v214, v215
  v_add_f32 v222, v216, v217
  v_add_f32 v223, v218, v219
  v_add_f32 v220, v220, v221
  v_add_f32 v222, v222, v223
  v_add_f32 v220, v220, v222
  s_nop 1
  v_add_f32_dpp v220, v220, v220 row_ror:8 row_mask:0xf bank_mask:0xf
  s_nop 1
  v_add_f32_dpp v220, v220, v220 row_ror:4 row_mask:0xf bank_mask:0xf
  s_nop 1
  v_add_f32_dpp v220, v220, v220 row_ror:2 row_mask:0xf bank_mask:0xf
  s_nop 1
  v_add_f32_dpp v220, v220, v220 row_ror:1 row_mask:0xf bank_mask:0xf
  v_mov_b32 v222, v220
  s_nop 0
  s_nop 0
  v_permlane16_swap_b32 v220, v222
  v_add_f32 v220, v220, v222
  v_mov_b32 v222, v220
  s_nop 0
  s_nop 0
  v_permlane32_swap_b32 v220, v222
  v_add_f32 v220, v220, v222
  v_mul_f32 v220, 0x3b000000, v220
  v_sub_f32 v224, v212, v220
  v_sub_f32 v225, v213, v220
  v_sub_f32 v226, v214, v220
  v_sub_f32 v227, v215, v220
  v_sub_f32 v228, v216, v220
  v_sub_f32 v229, v217, v220
  v_sub_f32 v230, v218, v220
  v_sub_f32 v231, v219, v220
  v_mul_f32 v221, v224, v224
  v_mul_f32 v222, v225, v225
  v_fmac_f32 v221, v226, v226
  v_fmac_f32 v222, v227, v227
  v_fmac_f32 v221, v228, v228
  v_fmac_f32 v222, v229, v229
  v_fmac_f32 v221, v230, v230
  v_fmac_f32 v222, v231, v231
  v_add_f32 v221, v221, v222
  v_cvt_pk_bf16_f32 v220, 0, v220
  s_nop 0
  v_add_f32_dpp v221, v221, v221 row_ror:8 row_mask:0xf bank_mask:0xf
  v_sub_f32 v224, v212, v220
  v_sub_f32 v225, v213, v220
  v_add_f32_dpp v221, v221, v221 row_ror:4 row_mask:0xf bank_mask:0xf
  v_sub_f32 v226, v214, v220
  v_sub_f32 v227, v215, v220
  v_add_f32_dpp v221, v221, v221 row_ror:2 row_mask:0xf bank_mask:0xf
  v_sub_f32 v228, v216, v220
  v_sub_f32 v229, v217, v220
  v_add_f32_dpp v221, v221, v221 row_ror:1 row_mask:0xf bank_mask:0xf
  v_sub_f32 v230, v218, v220
  v_sub_f32 v231, v219, v220
  v_mov_b32 v222, v221
  v_cvt_pk_bf16_f32 v224, 0, v224
  v_cvt_pk_bf16_f32 v225, 0, v225
  v_permlane16_swap_b32 v221, v222
  v_cvt_pk_bf16_f32 v226, 0, v226
  v_cvt_pk_bf16_f32 v227, 0, v227
  v_add_f32 v221, v221, v222
  v_cvt_pk_bf16_f32 v228, 0, v228
  v_cvt_pk_bf16_f32 v229, 0, v229
  v_mov_b32 v222, v221
  v_cvt_pk_bf16_f32 v230, 0, v230
  v_cvt_pk_bf16_f32 v231, 0, v231
  v_permlane32_swap_b32 v221, v222
  v_add_f32 v221, v221, v222
  v_mul_f32 v221, 0x3b000000, v221
  v_cvt_pk_bf16_f32 v221, 0, v221
  v_add_f32 v221, 0x3727c5ac, v221
  v_cvt_pk_bf16_f32 v221, 0, v221
  v_sqrt_f32 v221, v221
  s_nop 0
  v_cvt_pk_bf16_f32 v221, 0, v221
  v_rcp_f32 v221, v221
  s_nop 0
  v_mul_f32 v224, v224, v221
  v_mul_f32 v225, v225, v221
  v_mul_f32 v226, v226, v221
  v_mul_f32 v227, v227, v221
  v_mul_f32 v228, v228, v221
  v_mul_f32 v229, v229, v221
  v_mul_f32 v230, v230, v221
  v_mul_f32 v231, v231, v221
  v_cvt_pk_bf16_f32 v188, v224, v225
  v_cvt_pk_bf16_f32 v189, v226, v227
  v_cvt_pk_bf16_f32 v190, v228, v229
  v_cvt_pk_bf16_f32 v191, v230, v231
  buffer_store_dwordx4 v[188:191], v0, s[4:7], s29 offen sc1
  s_add_u32 s29, s29, 262144
  s_waitcnt vmcnt(40)
  v_lshlrev_b32 v212, 16, v192
  v_and_b32 v213, 0xffff0000, v192
  v_lshlrev_b32 v214, 16, v193
  v_and_b32 v215, 0xffff0000, v193
  v_lshlrev_b32 v216, 16, v194
  v_and_b32 v217, 0xffff0000, v194
  v_lshlrev_b32 v218, 16, v195
  v_and_b32 v219, 0xffff0000, v195
  v_add_f32 v220, v212, v213
  v_add_f32 v221, v214, v215
  v_add_f32 v222, v216, v217
  v_add_f32 v223, v218, v219
  v_add_f32 v220, v220, v221
  v_add_f32 v222, v222, v223
  v_add_f32 v220, v220, v222
  s_nop 1
  v_add_f32_dpp v220, v220, v220 row_ror:8 row_mask:0xf bank_mask:0xf
  s_nop 1
  v_add_f32_dpp v220, v220, v220 row_ror:4 row_mask:0xf bank_mask:0xf
  s_nop 1
  v_add_f32_dpp v220, v220, v220 row_ror:2 row_mask:0xf bank_mask:0xf
  s_nop 1
  v_add_f32_dpp v220, v220, v220 row_ror:1 row_mask:0xf bank_mask:0xf
  v_mov_b32 v222, v220
  s_nop 0
  s_nop 0
  v_permlane16_swap_b32 v220, v222
  v_add_f32 v220, v220, v222
  v_mov_b32 v222, v220
  s_nop 0
  s_nop 0
  v_permlane32_swap_b32 v220, v222
  v_add_f32 v220, v220, v222
  v_mul_f32 v220, 0x3b000000, v220
  v_sub_f32 v224, v212, v220
  v_sub_f32 v225, v213, v220
  v_sub_f32 v226, v214, v220
  v_sub_f32 v227, v215, v220
  v_sub_f32 v228, v216, v220
  v_sub_f32 v229, v217, v220
  v_sub_f32 v230, v218, v220
  v_sub_f32 v231, v219, v220
  v_mul_f32 v221, v224, v224
  v_mul_f32 v222, v225, v225
  v_fmac_f32 v221, v226, v226
  v_fmac_f32 v222, v227, v227
  v_fmac_f32 v221, v228, v228
  v_fmac_f32 v222, v229, v229
  v_fmac_f32 v221, v230, v230
  v_fmac_f32 v222, v231, v231
  v_add_f32 v221, v221, v222
  v_cvt_pk_bf16_f32 v220, 0, v220
  s_nop 0
  v_add_f32_dpp v221, v221, v221 row_ror:8 row_mask:0xf bank_mask:0xf
  v_sub_f32 v224, v212, v220
  v_sub_f32 v225, v213, v220
  v_add_f32_dpp v221, v221, v221 row_ror:4 row_mask:0xf bank_mask:0xf
  v_sub_f32 v226, v214, v220
  v_sub_f32 v227, v215, v220
  v_add_f32_dpp v221, v221, v221 row_ror:2 row_mask:0xf bank_mask:0xf
  v_sub_f32 v228, v216, v220
  v_sub_f32 v229, v217, v220
  v_add_f32_dpp v221, v221, v221 row_ror:1 row_mask:0xf bank_mask:0xf
  v_sub_f32 v230, v218, v220
  v_sub_f32 v231, v219, v220
  v_mov_b32 v222, v221
  v_cvt_pk_bf16_f32 v224, 0, v224
  v_cvt_pk_bf16_f32 v225, 0, v225
  v_permlane16_swap_b32 v221, v222
  v_cvt_pk_bf16_f32 v226, 0, v226
  v_cvt_pk_bf16_f32 v227, 0, v227
  v_add_f32 v221, v221, v222
  v_cvt_pk_bf16_f32 v228, 0, v228
  v_cvt_pk_bf16_f32 v229, 0, v229
  v_mov_b32 v222, v221
  v_cvt_pk_bf16_f32 v230, 0, v230
  v_cvt_pk_bf16_f32 v231, 0, v231
  v_permlane32_swap_b32 v221, v222
  v_add_f32 v221, v221, v222
  v_mul_f32 v221, 0x3b000000, v221
  v_cvt_pk_bf16_f32 v221, 0, v221
  v_add_f32 v221, 0x3727c5ac, v221
  v_cvt_pk_bf16_f32 v221, 0, v221
  v_sqrt_f32 v221, v221
  s_nop 0
  v_cvt_pk_bf16_f32 v221, 0, v221
  v_rcp_f32 v221, v221
  s_nop 0
  v_mul_f32 v224, v224, v221
  v_mul_f32 v225, v225, v221
  v_mul_f32 v226, v226, v221
  v_mul_f32 v227, v227, v221
  v_mul_f32 v228, v228, v221
  v_mul_f32 v229, v229, v221
  v_mul_f32 v230, v230, v221
  v_mul_f32 v231, v231, v221
  v_cvt_pk_bf16_f32 v192, v224, v225
  v_cvt_pk_bf16_f32 v193, v226, v227
  v_cvt_pk_bf16_f32 v194, v228, v229
  v_cvt_pk_bf16_f32 v195, v230, v231
  buffer_store_dwordx4 v[192:195], v0, s[4:7], s29 offen sc1
  s_add_u32 s29, s29, 262144
  s_waitcnt vmcnt(40)
  v_lshlrev_b32 v212, 16, v196
  v_and_b32 v213, 0xffff0000, v196
  v_lshlrev_b32 v214, 16, v197
  v_and_b32 v215, 0xffff0000, v197
  v_lshlrev_b32 v216, 16, v198
  v_and_b32 v217, 0xffff0000, v198
  v_lshlrev_b32 v218, 16, v199
  v_and_b32 v219, 0xffff0000, v199
  v_add_f32 v220, v212, v213
  v_add_f32 v221, v214, v215
  v_add_f32 v222, v216, v217
  v_add_f32 v223, v218, v219
  v_add_f32 v220, v220, v221
  v_add_f32 v222, v222, v223
  v_add_f32 v220, v220, v222
  s_nop 1
  v_add_f32_dpp v220, v220, v220 row_ror:8 row_mask:0xf bank_mask:0xf
  s_nop 1
  v_add_f32_dpp v220, v220, v220 row_ror:4 row_mask:0xf bank_mask:0xf
  s_nop 1
  v_add_f32_dpp v220, v220, v220 row_ror:2 row_mask:0xf bank_mask:0xf
  s_nop 1
  v_add_f32_dpp v220, v220, v220 row_ror:1 row_mask:0xf bank_mask:0xf
  v_mov_b32 v222, v220
  s_nop 0
  s_nop 0
  v_permlane16_swap_b32 v220, v222
  v_add_f32 v220, v220, v222
  v_mov_b32 v222, v220
  s_nop 0
  s_nop 0
  v_permlane32_swap_b32 v220, v222
  v_add_f32 v220, v220, v222
  v_mul_f32 v220, 0x3b000000, v220
  v_sub_f32 v224, v212, v220
  v_sub_f32 v225, v213, v220
  v_sub_f32 v226, v214, v220
  v_sub_f32 v227, v215, v220
  v_sub_f32 v228, v216, v220
  v_sub_f32 v229, v217, v220
  v_sub_f32 v230, v218, v220
  v_sub_f32 v231, v219, v220
  v_mul_f32 v221, v224, v224
  v_mul_f32 v222, v225, v225
  v_fmac_f32 v221, v226, v226
  v_fmac_f32 v222, v227, v227
  v_fmac_f32 v221, v228, v228
  v_fmac_f32 v222, v229, v229
  v_fmac_f32 v221, v230, v230
  v_fmac_f32 v222, v231, v231
  v_add_f32 v221, v221, v222
  v_cvt_pk_bf16_f32 v220, 0, v220
  s_nop 0
  v_add_f32_dpp v221, v221, v221 row_ror:8 row_mask:0xf bank_mask:0xf
  v_sub_f32 v224, v212, v220
  v_sub_f32 v225, v213, v220
  v_add_f32_dpp v221, v221, v221 row_ror:4 row_mask:0xf bank_mask:0xf
  v_sub_f32 v226, v214, v220
  v_sub_f32 v227, v215, v220
  v_add_f32_dpp v221, v221, v221 row_ror:2 row_mask:0xf bank_mask:0xf
  v_sub_f32 v228, v216, v220
  v_sub_f32 v229, v217, v220
  v_add_f32_dpp v221, v221, v221 row_ror:1 row_mask:0xf bank_mask:0xf
  v_sub_f32 v230, v218, v220
  v_sub_f32 v231, v219, v220
  v_mov_b32 v222, v221
  v_cvt_pk_bf16_f32 v224, 0, v224
  v_cvt_pk_bf16_f32 v225, 0, v225
  v_permlane16_swap_b32 v221, v222
  v_cvt_pk_bf16_f32 v226, 0, v226
  v_cvt_pk_bf16_f32 v227, 0, v227
  v_add_f32 v221, v221, v222
  v_cvt_pk_bf16_f32 v228, 0, v228
  v_cvt_pk_bf16_f32 v229, 0, v229
  v_mov_b32 v222, v221
  v_cvt_pk_bf16_f32 v230, 0, v230
  v_cvt_pk_bf16_f32 v231, 0, v231
  v_permlane32_swap_b32 v221, v222
  v_add_f32 v221, v221, v222
  v_mul_f32 v221, 0x3b000000, v221
  v_cvt_pk_bf16_f32 v221, 0, v221
  v_add_f32 v221, 0x3727c5ac, v221
  v_cvt_pk_bf16_f32 v221, 0, v221
  v_sqrt_f32 v221, v221
  s_nop 0
  v_cvt_pk_bf16_f32 v221, 0, v221
  v_rcp_f32 v221, v221
  s_nop 0
  v_mul_f32 v224, v224, v221
  v_mul_f32 v225, v225, v221
  v_mul_f32 v226, v226, v221
  v_mul_f32 v227, v227, v221
  v_mul_f32 v228, v228, v221
  v_mul_f32 v229, v229, v221
  v_mul_f32 v230, v230, v221
  v_mul_f32 v231, v231, v221
  v_cvt_pk_bf16_f32 v196, v224, v225
  v_cvt_pk_bf16_f32 v197, v226, v227
  v_cvt_pk_bf16_f32 v198, v228, v229
  v_cvt_pk_bf16_f32 v199, v230, v231
  buffer_store_dwordx4 v[196:199], v0, s[4:7], s29 offen sc1
  s_add_u32 s29, s29, 262144
  s_waitcnt vmcnt(40)
  v_lshlrev_b32 v212, 16, v200
  v_and_b32 v213, 0xffff0000, v200
  v_lshlrev_b32 v214, 16, v201
  v_and_b32 v215, 0xffff0000, v201
  v_lshlrev_b32 v216, 16, v202
  v_and_b32 v217, 0xffff0000, v202
  v_lshlrev_b32 v218, 16, v203
  v_and_b32 v219, 0xffff0000, v203
  v_add_f32 v220, v212, v213
  v_add_f32 v221, v214, v215
  v_add_f32 v222, v216, v217
  v_add_f32 v223, v218, v219
  v_add_f32 v220, v220, v221
  v_add_f32 v222, v222, v223
  v_add_f32 v220, v220, v222
  s_nop 1
  v_add_f32_dpp v220, v220, v220 row_ror:8 row_mask:0xf bank_mask:0xf
  s_nop 1
  v_add_f32_dpp v220, v220, v220 row_ror:4 row_mask:0xf bank_mask:0xf
  s_nop 1
  v_add_f32_dpp v220, v220, v220 row_ror:2 row_mask:0xf bank_mask:0xf
  s_nop 1
  v_add_f32_dpp v220, v220, v220 row_ror:1 row_mask:0xf bank_mask:0xf
  v_mov_b32 v222, v220
  s_nop 0
  s_nop 0
  v_permlane16_swap_b32 v220, v222
  v_add_f32 v220, v220, v222
  v_mov_b32 v222, v220
  s_nop 0
  s_nop 0
  v_permlane32_swap_b32 v220, v222
  v_add_f32 v220, v220, v222
  v_mul_f32 v220, 0x3b000000, v220
  v_sub_f32 v224, v212, v220
  v_sub_f32 v225, v213, v220
  v_sub_f32 v226, v214, v220
  v_sub_f32 v227, v215, v220
  v_sub_f32 v228, v216, v220
  v_sub_f32 v229, v217, v220
  v_sub_f32 v230, v218, v220
  v_sub_f32 v231, v219, v220
  v_mul_f32 v221, v224, v224
  v_mul_f32 v222, v225, v225
  v_fmac_f32 v221, v226, v226
  v_fmac_f32 v222, v227, v227
  v_fmac_f32 v221, v228, v228
  v_fmac_f32 v222, v229, v229
  v_fmac_f32 v221, v230, v230
  v_fmac_f32 v222, v231, v231
  v_add_f32 v221, v221, v222
  v_cvt_pk_bf16_f32 v220, 0, v220
  s_nop 0
  v_add_f32_dpp v221, v221, v221 row_ror:8 row_mask:0xf bank_mask:0xf
  v_sub_f32 v224, v212, v220
  v_sub_f32 v225, v213, v220
  v_add_f32_dpp v221, v221, v221 row_ror:4 row_mask:0xf bank_mask:0xf
  v_sub_f32 v226, v214, v220
  v_sub_f32 v227, v215, v220
  v_add_f32_dpp v221, v221, v221 row_ror:2 row_mask:0xf bank_mask:0xf
  v_sub_f32 v228, v216, v220
  v_sub_f32 v229, v217, v220
  v_add_f32_dpp v221, v221, v221 row_ror:1 row_mask:0xf bank_mask:0xf
  v_sub_f32 v230, v218, v220
  v_sub_f32 v231, v219, v220
  v_mov_b32 v222, v221
  v_cvt_pk_bf16_f32 v224, 0, v224
  v_cvt_pk_bf16_f32 v225, 0, v225
  v_permlane16_swap_b32 v221, v222
  v_cvt_pk_bf16_f32 v226, 0, v226
  v_cvt_pk_bf16_f32 v227, 0, v227
  v_add_f32 v221, v221, v222
  v_cvt_pk_bf16_f32 v228, 0, v228
  v_cvt_pk_bf16_f32 v229, 0, v229
  v_mov_b32 v222, v221
  v_cvt_pk_bf16_f32 v230, 0, v230
  v_cvt_pk_bf16_f32 v231, 0, v231
  v_permlane32_swap_b32 v221, v222
  v_add_f32 v221, v221, v222
  v_mul_f32 v221, 0x3b000000, v221
  v_cvt_pk_bf16_f32 v221, 0, v221
  v_add_f32 v221, 0x3727c5ac, v221
  v_cvt_pk_bf16_f32 v221, 0, v221
  v_sqrt_f32 v221, v221
  s_nop 0
  v_cvt_pk_bf16_f32 v221, 0, v221
  v_rcp_f32 v221, v221
  s_nop 0
  v_mul_f32 v224, v224, v221
  v_mul_f32 v225, v225, v221
  v_mul_f32 v226, v226, v221
  v_mul_f32 v227, v227, v221
  v_mul_f32 v228, v228, v221
  v_mul_f32 v229, v229, v221
  v_mul_f32 v230, v230, v221
  v_mul_f32 v231, v231, v221
  v_cvt_pk_bf16_f32 v200, v224, v225
  v_cvt_pk_bf16_f32 v201, v226, v227
  v_cvt_pk_bf16_f32 v202, v228, v229
  v_cvt_pk_bf16_f32 v203, v230, v231
  buffer_store_dwordx4 v[200:203], v0, s[4:7], s29 offen sc1
  s_add_u32 s29, s29, 262144
  s_waitcnt vmcnt(40)
  v_lshlrev_b32 v212, 16, v204
  v_and_b32 v213, 0xffff0000, v204
  v_lshlrev_b32 v214, 16, v205
  v_and_b32 v215, 0xffff0000, v205
  v_lshlrev_b32 v216, 16, v206
  v_and_b32 v217, 0xffff0000, v206
  v_lshlrev_b32 v218, 16, v207
  v_and_b32 v219, 0xffff0000, v207
  v_add_f32 v220, v212, v213
  v_add_f32 v221, v214, v215
  v_add_f32 v222, v216, v217
  v_add_f32 v223, v218, v219
  v_add_f32 v220, v220, v221
  v_add_f32 v222, v222, v223
  v_add_f32 v220, v220, v222
  s_nop 1
  v_add_f32_dpp v220, v220, v220 row_ror:8 row_mask:0xf bank_mask:0xf
  s_nop 1
  v_add_f32_dpp v220, v220, v220 row_ror:4 row_mask:0xf bank_mask:0xf
  s_nop 1
  v_add_f32_dpp v220, v220, v220 row_ror:2 row_mask:0xf bank_mask:0xf
  s_nop 1
  v_add_f32_dpp v220, v220, v220 row_ror:1 row_mask:0xf bank_mask:0xf
  v_mov_b32 v222, v220
  s_nop 0
  s_nop 0
  v_permlane16_swap_b32 v220, v222
  v_add_f32 v220, v220, v222
  v_mov_b32 v222, v220
  s_nop 0
  s_nop 0
  v_permlane32_swap_b32 v220, v222
  v_add_f32 v220, v220, v222
  v_mul_f32 v220, 0x3b000000, v220
  v_sub_f32 v224, v212, v220
  v_sub_f32 v225, v213, v220
  v_sub_f32 v226, v214, v220
  v_sub_f32 v227, v215, v220
  v_sub_f32 v228, v216, v220
  v_sub_f32 v229, v217, v220
  v_sub_f32 v230, v218, v220
  v_sub_f32 v231, v219, v220
  v_mul_f32 v221, v224, v224
  v_mul_f32 v222, v225, v225
  v_fmac_f32 v221, v226, v226
  v_fmac_f32 v222, v227, v227
  v_fmac_f32 v221, v228, v228
  v_fmac_f32 v222, v229, v229
  v_fmac_f32 v221, v230, v230
  v_fmac_f32 v222, v231, v231
  v_add_f32 v221, v221, v222
  v_cvt_pk_bf16_f32 v220, 0, v220
  s_nop 0
  v_add_f32_dpp v221, v221, v221 row_ror:8 row_mask:0xf bank_mask:0xf
  v_sub_f32 v224, v212, v220
  v_sub_f32 v225, v213, v220
  v_add_f32_dpp v221, v221, v221 row_ror:4 row_mask:0xf bank_mask:0xf
  v_sub_f32 v226, v214, v220
  v_sub_f32 v227, v215, v220
  v_add_f32_dpp v221, v221, v221 row_ror:2 row_mask:0xf bank_mask:0xf
  v_sub_f32 v228, v216, v220
  v_sub_f32 v229, v217, v220
  v_add_f32_dpp v221, v221, v221 row_ror:1 row_mask:0xf bank_mask:0xf
  v_sub_f32 v230, v218, v220
  v_sub_f32 v231, v219, v220
  v_mov_b32 v222, v221
  v_cvt_pk_bf16_f32 v224, 0, v224
  v_cvt_pk_bf16_f32 v225, 0, v225
  v_permlane16_swap_b32 v221, v222
  v_cvt_pk_bf16_f32 v226, 0, v226
  v_cvt_pk_bf16_f32 v227, 0, v227
  v_add_f32 v221, v221, v222
  v_cvt_pk_bf16_f32 v228, 0, v228
  v_cvt_pk_bf16_f32 v229, 0, v229
  v_mov_b32 v222, v221
  v_cvt_pk_bf16_f32 v230, 0, v230
  v_cvt_pk_bf16_f32 v231, 0, v231
  v_permlane32_swap_b32 v221, v222
  v_add_f32 v221, v221, v222
  v_mul_f32 v221, 0x3b000000, v221
  v_cvt_pk_bf16_f32 v221, 0, v221
  v_add_f32 v221, 0x3727c5ac, v221
  v_cvt_pk_bf16_f32 v221, 0, v221
  v_sqrt_f32 v221, v221
  s_nop 0
  v_cvt_pk_bf16_f32 v221, 0, v221
  v_rcp_f32 v221, v221
  s_nop 0
  v_mul_f32 v224, v224, v221
  v_mul_f32 v225, v225, v221
  v_mul_f32 v226, v226, v221
  v_mul_f32 v227, v227, v221
  v_mul_f32 v228, v228, v221
  v_mul_f32 v229, v229, v221
  v_mul_f32 v230, v230, v221
  v_mul_f32 v231, v231, v221
  v_cvt_pk_bf16_f32 v204, v224, v225
  v_cvt_pk_bf16_f32 v205, v226, v227
  v_cvt_pk_bf16_f32 v206, v228, v229
  v_cvt_pk_bf16_f32 v207, v230, v231
  buffer_store_dwordx4 v[204:207], v0, s[4:7], s29 offen sc1
  s_add_u32 s29, s29, 262144
o_s2_118:
  s_waitcnt vmcnt(33)
  v_perm_b32 v48, v66, v64, s44
  v_perm_b32 v49, v70, v68, s44
  v_perm_b32 v50, v74, v72, s44
  v_perm_b32 v51, v78, v76, s44
  v_accvgpr_write_b32 a0, v48
  v_accvgpr_write_b32 a1, v49
  v_accvgpr_write_b32 a2, v50
  v_accvgpr_write_b32 a3, v51
  v_perm_b32 v52, v66, v64, s45
  v_perm_b32 v53, v70, v68, s45
  v_perm_b32 v54, v74, v72, s45
  v_perm_b32 v55, v78, v76, s45
  v_accvgpr_write_b32 a4, v52
  v_accvgpr_write_b32 a5, v53
  v_accvgpr_write_b32 a6, v54
  v_accvgpr_write_b32 a7, v55
  v_perm_b32 v48, v67, v65, s44
  v_perm_b32 v49, v71, v69, s44
  v_perm_b32 v50, v75, v73, s44
  v_perm_b32 v51, v79, v77, s44
  v_accvgpr_write_b32 a8, v48
  v_accvgpr_write_b32 a9, v49
  v_accvgpr_write_b32 a10, v50
  v_accvgpr_write_b32 a11, v51
  v_perm_b32 v52, v67, v65, s45
  v_perm_b32 v53, v71, v69, s45
  v_perm_b32 v54, v75, v73, s45
  v_perm_b32 v55, v79, v77, s45
  v_accvgpr_write_b32 a12, v52
  v_accvgpr_write_b32 a13, v53
  v_accvgpr_write_b32 a14, v54
  v_accvgpr_write_b32 a15, v55
  s_waitcnt vmcnt(25)
  v_perm_b32 v48, v82, v80, s44
  v_perm_b32 v49, v86, v84, s44
  v_perm_b32 v50, v90, v88, s44
  v_perm_b32 v51, v94, v92, s44
  v_accvgpr_write_b32 a16, v48
  v_accvgpr_write_b32 a17, v49
  v_accvgpr_write_b32 a18, v50
  v_accvgpr_write_b32 a19, v51
  v_perm_b32 v52, v82, v80, s45
  v_perm_b32 v53, v86, v84, s45
  v_perm_b32 v54, v90, v88, s45
  v_perm_b32 v55, v94, v92, s45
  v_accvgpr_write_b32 a20, v52
  v_accvgpr_write_b32 a21, v53
  v_accvgpr_write_b32 a22, v54
  v_accvgpr_write_b32 a23, v55
  v_perm_b32 v48, v83, v81, s44
  v_perm_b32 v49, v87, v85, s44
  v_perm_b32 v50, v91, v89, s44
  v_perm_b32 v51, v95, v93, s44
  v_accvgpr_write_b32 a24, v48
  v_accvgpr_write_b32 a25, v49
  v_accvgpr_write_b32 a26, v50
  v_accvgpr_write_b32 a27, v51
  v_perm_b32 v52, v83, v81, s45
  v_perm_b32 v53, v87, v85, s45
  v_perm_b32 v54, v91, v89, s45
  v_perm_b32 v55, v95, v93, s45
  v_accvgpr_write_b32 a28, v52
  v_accvgpr_write_b32 a29, v53
  v_accvgpr_write_b32 a30, v54
  v_accvgpr_write_b32 a31, v55
  s_waitcnt vmcnt(17)
  v_perm_b32 v48, v98, v96, s44
  v_perm_b32 v49, v102, v100, s44
  v_perm_b32 v50, v106, v104, s44
  v_perm_b32 v51, v110, v108, s44
  v_accvgpr_write_b32 a32, v48
  v_accvgpr_write_b32 a33, v49
  v_accvgpr_write_b32 a34, v50
  v_accvgpr_write_b32 a35, v51
  v_perm_b32 v52, v98, v96, s45
  v_perm_b32 v53, v102, v100, s45
  v_perm_b32 v54, v106, v104, s45
  v_perm_b32 v55, v110, v108, s45
  v_accvgpr_write_b32 a36, v52
  v_accvgpr_write_b32 a37, v53
  v_accvgpr_write_b32 a38, v54
  v_accvgpr_write_b32 a39, v55
  v_perm_b32 v48, v99, v97, s44
  v_perm_b32 v49, v103, v101, s44
  v_perm_b32 v50, v107, v105, s44
  v_perm_b32 v51, v111, v109, s44
  v_accvgpr_write_b32 a40, v48
  v_accvgpr_write_b32 a41, v49
  v_accvgpr_write_b32 a42, v50
  v_accvgpr_write_b32 a43, v51
  v_perm_b32 v52, v99, v97, s45
  v_perm_b32 v53, v103, v101, s45
  v_perm_b32 v54, v107, v105, s45
  v_perm_b32 v55, v111, v109, s45
  v_accvgpr_write_b32 a44, v52
  v_accvgpr_write_b32 a45, v53
  v_accvgpr_write_b32 a46, v54
  v_accvgpr_write_b32 a47, v55
  s_waitcnt vmcnt(9)
  v_perm_b32 v48, v114, v112, s44
  v_perm_b32 v49, v118, v116, s44
  v_perm_b32 v50, v122, v120, s44
  v_perm_b32 v51, v126, v124, s44
  v_accvgpr_write_b32 a48, v48
  v_accvgpr_write_b32 a49, v49
  v_accvgpr_write_b32 a50, v50
  v_accvgpr_write_b32 a51, v51
  v_perm_b32 v52, v114, v112, s45
  v_perm_b32 v53, v118, v116, s45
  v_perm_b32 v54, v122, v120, s45
  v_perm_b32 v55, v126, v124, s45
  v_accvgpr_write_b32 a52, v52
  v_accvgpr_write_b32 a53, v53
  v_accvgpr_write_b32 a54, v54
  v_accvgpr_write_b32 a55, v55
  v_perm_b32 v48, v115, v113, s44
  v_perm_b32 v49, v119, v117, s44
  v_perm_b32 v50, v123, v121, s44
  v_perm_b32 v51, v127, v125, s44
  v_accvgpr_write_b32 a56, v48
  v_accvgpr_write_b32 a57, v49
  v_accvgpr_write_b32 a58, v50
  v_accvgpr_write_b32 a59, v51
  v_perm_b32 v52, v115, v113, s45
  v_perm_b32 v53, v119, v117, s45
  v_perm_b32 v54, v123, v121, s45
  v_perm_b32 v55, v127, v125, s45
  v_accvgpr_write_b32 a60, v52
  v_accvgpr_write_b32 a61, v53
  v_accvgpr_write_b32 a62, v54
  v_accvgpr_write_b32 a63, v55
  s_cmp_ge_u32 s60, 4
  s_cbranch_scc1 o_s3_119
  v_mbcnt_lo_u32_b32 v60, -1, 0
  v_and_b32 v60, 0, v60
  v_add_lshl_u32 v60, v60, 1, 2
  s_mov_b32 s26, 0
g_wt_120:
  global_load_dword v61, v60, s[12:13] offset:128 sc1
  s_add_u32 s26, s26, 1
  s_cmp_gt_u32 s26, 1048576
  s_cbranch_scc1 L_end
  s_waitcnt vmcnt(0)
  v_cmp_eq_u32 vcc, 0, v61
  v_readfirstlane_b32 s27, v61
  s_cbranch_vccnz g_wt_120
  s_lshl_b32 s27, s77, 7
  s_add_u32 s27, s27, 243269632
  v_lshlrev_b32 v61, 11, v0
  v_mov_b32 v60, 1
  s_mov_b64 exec, 255
  buffer_store_dword v60, v61, s[4:7], s27 offen sc1
  s_mov_b64 exec, -1
o_s3_119:
  s_add_u32 s27, s30, 65536
  buffer_load_dwordx2 v[128:129], v44, s[80:83], s27 offen
  s_add_u32 s27, s30, 66560
  buffer_load_dwordx2 v[130:131], v44, s[80:83], s27 offen
  s_add_u32 s27, s30, 67584
  buffer_load_dwordx2 v[132:133], v44, s[80:83], s27 offen
  s_add_u32 s27, s30, 68608
  buffer_load_dwordx2 v[134:135], v44, s[80:83], s27 offen
  s_add_u32 s27, s30, 81920
  buffer_load_dwordx2 v[136:137], v44, s[80:83], s27 offen
  s_add_u32 s27, s30, 82944
  buffer_load_dwordx2 v[138:139], v44, s[80:83], s27 offen
  s_add_u32 s27, s30, 83968
  buffer_load_dwordx2 v[140:141], v44, s[80:83], s27 offen
  s_add_u32 s27, s30, 84992
  buffer_load_dwordx2 v[142:143], v44, s[80:83], s27 offen
  s_add_u32 s27, s30, 73728
  buffer_load_dwordx2 v[144:145], v44, s[80:83], s27 offen
  s_add_u32 s27, s30, 74752
  buffer_load_dwordx2 v[146:147], v44, s[80:83], s27 offen
  s_add_u32 s27, s30, 75776
  buffer_load_dwordx2 v[148:149], v44, s[80:83], s27 offen
  s_add_u32 s27, s30, 76800
  buffer_load_dwordx2 v[150:151], v44, s[80:83], s27 offen
  s_add_u32 s27, s30, 90112
  buffer_load_dwordx2 v[152:153], v44, s[80:83], s27 offen
  s_add_u32 s27, s30, 91136
  buffer_load_dwordx2 v[154:155], v44, s[80:83], s27 offen
  s_add_u32 s27, s30, 92160
  buffer_load_dwordx2 v[156:157], v44, s[80:83], s27 offen
  s_add_u32 s27, s30, 93184
  buffer_load_dwordx2 v[158:159], v44, s[80:83], s27 offen
  s_add_u32 s27, s30, 98304
  buffer_load_dwordx2 v[160:161], v44, s[80:83], s27 offen
  s_add_u32 s27, s30, 99328
  buffer_load_dwordx2 v[162:163], v44, s[80:83], s27 offen
  s_add_u32 s27, s30, 100352
  buffer_load_dwordx2 v[164:165], v44, s[80:83], s27 offen
  s_add_u32 s27, s30, 101376
  buffer_load_dwordx2 v[166:167], v44, s[80:83], s27 offen
  s_add_u32 s27, s30, 114688
  buffer_load_dwordx2 v[168:169], v44, s[80:83], s27 offen
  s_add_u32 s27, s30, 115712
  buffer_load_dwordx2 v[170:171], v44, s[80:83], s27 offen
  s_add_u32 s27, s30, 116736
  buffer_load_dwordx2 v[172:173], v44, s[80:83], s27 offen
  s_add_u32 s27, s30, 117760
  buffer_load_dwordx2 v[174:175], v44, s[80:83], s27 offen
  s_add_u32 s27, s30, 106496
  buffer_load_dwordx2 v[64:65], v44, s[80:83], s27 offen
  s_add_u32 s27, s30, 107520
  buffer_load_dwordx2 v[66:67], v44, s[80:83], s27 offen
  s_add_u32 s27, s30, 108544
  buffer_load_dwordx2 v[68:69], v44, s[80:83], s27 offen
  s_add_u32 s27, s30, 109568
  buffer_load_dwordx2 v[70:71], v44, s[80:83], s27 offen
  s_add_u32 s27, s30, 122880
  buffer_load_dwordx2 v[72:73], v44, s[80:83], s27 offen
  s_add_u32 s27, s30, 123904
  buffer_load_dwordx2 v[74:75], v44, s[80:83], s27 offen
  s_add_u32 s27, s30, 124928
  buffer_load_dwordx2 v[76:77], v44, s[80:83], s27 offen
  s_add_u32 s27, s30, 125952
  buffer_load_dwordx2 v[78:79], v44, s[80:83], s27 offen
  s_add_u32 s27, s30, 131072
  buffer_load_dwordx2 v[80:81], v44, s[80:83], s27 offen
  s_add_u32 s27, s30, 132096
  buffer_load_dwordx2 v[82:83], v44, s[80:83], s27 offen
  s_add_u32 s27, s30, 133120
  buffer_load_dwordx2 v[84:85], v44, s[80:83], s27 offen
  s_add_u32 s27, s30, 134144
  buffer_load_dwordx2 v[86:87], v44, s[80:83], s27 offen
  s_add_u32 s27, s30, 147456
  buffer_load_dwordx2 v[88:89], v44, s[80:83], s27 offen
  s_add_u32 s27, s30, 148480
  buffer_load_dwordx2 v[90:91], v44, s[80:83], s27 offen
  s_add_u32 s27, s30, 149504
  buffer_load_dwordx2 v[92:93], v44, s[80:83], s27 offen
  s_add_u32 s27, s30, 150528
  buffer_load_dwordx2 v[94:95], v44, s[80:83], s27 offen
  s_add_u32 s27, s30, 139264
  buffer_load_dwordx2 v[96:97], v44, s[80:83], s27 offen
  s_add_u32 s27, s30, 140288
  buffer_load_dwordx2 v[98:99], v44, s[80:83], s27 offen
  s_add_u32 s27, s30, 141312
  buffer_load_dwordx2 v[100:101], v44, s[80:83], s27 offen
  s_add_u32 s27, s30, 142336
  buffer_load_dwordx2 v[102:103], v44, s[80:83], s27 offen
  s_add_u32 s27, s30, 155648
  buffer_load_dwordx2 v[104:105], v44, s[80:83], s27 offen
  s_add_u32 s27, s30, 156672
  buffer_load_dwordx2 v[106:107], v44, s[80:83], s27 offen
  s_add_u32 s27, s30, 157696
  buffer_load_dwordx2 v[108:109], v44, s[80:83], s27 offen
  s_add_u32 s27, s30, 158720
  buffer_load_dwordx2 v[110:111], v44, s[80:83], s27 offen
  s_add_u32 s27, s30, 163840
  buffer_load_dwordx2 v[112:113], v44, s[80:83], s27 offen
  s_add_u32 s27, s30, 164864
  buffer_load_dwordx2 v[114:115], v44, s[80:83], s27 offen
  s_add_u32 s27, s30, 165888
  buffer_load_dwordx2 v[116:117], v44, s[80:83], s27 offen
  s_add_u32 s27, s30, 166912
  buffer_load_dwordx2 v[118:119], v44, s[80:83], s27 offen
  s_add_u32 s27, s30, 180224
  buffer_load_dwordx2 v[120:121], v44, s[80:83], s27 offen
  s_add_u32 s27, s30, 181248
  buffer_load_dwordx2 v[122:123], v44, s[80:83], s27 offen
  s_add_u32 s27, s30, 182272
  buffer_load_dwordx2 v[124:125], v44, s[80:83], s27 offen
  s_add_u32 s27, s30, 183296
  buffer_load_dwordx2 v[126:127], v44, s[80:83], s27 offen
  v_lshlrev_b32 v8, 16, v56
  v_and_b32 v9, 0xffff0000, v56
  v_lshlrev_b32 v10, 16, v57
  v_and_b32 v11, 0xffff0000, v57
  v_lshlrev_b32 v12, 16, v58
  v_and_b32 v13, 0xffff0000, v58
  v_lshlrev_b32 v14, 16, v59
  v_and_b32 v15, 0xffff0000, v59
  v_mul_f32 v56, v8, v8
  v_fmac_f32 v56, v9, v9
  v_fmac_f32 v56, v10, v10
  v_fmac_f32 v56, v11, v11
  v_fmac_f32 v56, v12, v12
  v_fmac_f32 v56, v13, v13
  v_fmac_f32 v56, v14, v14
  v_fmac_f32 v56, v15, v15
  s_nop 0
  s_nop 0
  v_add_f32_dpp v56, v56, v56 row_ror:8 row_mask:0xf bank_mask:0xf
  s_nop 1
  v_add_f32_dpp v56, v56, v56 row_ror:4 row_mask:0xf bank_mask:0xf
  s_nop 1
  v_add_f32_dpp v56, v56, v56 row_ror:2 row_mask:0xf bank_mask:0xf
  s_nop 1
  v_add_f32_dpp v56, v56, v56 row_ror:1 row_mask:0xf bank_mask:0xf
  v_mov_b32 v57, v56
  s_nop 0
  s_nop 0
  v_permlane16_swap_b32 v56, v57
  v_add_f32 v56, v56, v57
  v_mov_b32 v57, v56
  s_nop 0
  s_nop 0
  v_permlane32_swap_b32 v56, v57
  v_add_f32 v56, v56, v57
  v_sqrt_f32 v56, v56
  s_mov_b32 s28, 0x40598569
  v_writelane_b32 v247, s28, 0
  s_mov_b32 s28, 0x40598569
  v_writelane_b32 v247, s28, 1
  s_mov_b32 s28, 0x4058ade7
  v_writelane_b32 v247, s28, 2
  s_mov_b32 s28, 0x40577c32
  v_writelane_b32 v247, s28, 3
  s_mov_b32 s28, 0x40563297
  v_writelane_b32 v247, s28, 4
  s_mov_b32 s28, 0x4054cd28
  v_writelane_b32 v247, s28, 5
  s_mov_b32 s28, 0x405346f2
  v_writelane_b32 v247, s28, 6
  s_mov_b32 s28, 0x40519992
  v_writelane_b32 v247, s28, 7
  s_mov_b32 s28, 0x404fbc99
  v_writelane_b32 v247, s28, 8
  s_mov_b32 s28, 0x404da49a
  v_writelane_b32 v247, s28, 9
  s_mov_b32 s28, 0x404b418a
  v_writelane_b32 v247, s28, 10
  s_mov_b32 s28, 0x40487bed
  v_writelane_b32 v247, s28, 11
  s_mov_b32 s28, 0x40452f68
  v_writelane_b32 v247, s28, 12
  s_mov_b32 s28, 0x40411f69
  v_writelane_b32 v247, s28, 13
  s_mov_b32 s28, 0x403bdbac
  v_writelane_b32 v247, s28, 14
  s_mov_b32 s28, 0x40346eae
  v_writelane_b32 v247, s28, 15
  s_mov_b32 s28, 0x4028005c
  v_writelane_b32 v247, s28, 16
  s_mov_b32 s28, 0x4001516e
  v_writelane_b32 v247, s28, 17
  s_mov_b32 s28, 0x4001516e
  v_writelane_b32 v247, s28, 18
  v_mul_f32 v247, v247, v56
  v_or_b32 v247, 0x80000000, v247
  s_lshl_b32 s29, s61, 2
  s_add_u32 s29, s29, s17
  s_lshl_b32 s29, s29, 13
  s_add_u32 s29, s29, s41
  s_cmp_ge_u32 s60, 4
  s_cselect_b32 s29, 268435456, s29
  v_mov_b64 v[208:209], 0
  v_mov_b64 v[210:211], 0
  s_waitcnt vmcnt(48)
  v_perm_b32 v48, v130, v128, s44
  v_perm_b32 v49, v134, v132, s44
  v_perm_b32 v50, v138, v136, s44
  v_perm_b32 v51, v142, v140, s44
  v_accvgpr_write_b32 a64, v48
  v_accvgpr_write_b32 a65, v49
  v_accvgpr_write_b32 a66, v50
  v_accvgpr_write_b32 a67, v51
  v_perm_b32 v52, v130, v128, s45
  v_perm_b32 v53, v134, v132, s45
  v_perm_b32 v54, v138, v136, s45
  v_perm_b32 v55, v142, v140, s45
  v_accvgpr_write_b32 a68, v52
  v_accvgpr_write_b32 a69, v53
  v_accvgpr_write_b32 a70, v54
  v_accvgpr_write_b32 a71, v55
  v_perm_b32 v48, v131, v129, s44
  v_perm_b32 v49, v135, v133, s44
  v_perm_b32 v50, v139, v137, s44
  v_perm_b32 v51, v143, v141, s44
  v_accvgpr_write_b32 a72, v48
  v_accvgpr_write_b32 a73, v49
  v_accvgpr_write_b32 a74, v50
  v_accvgpr_write_b32 a75, v51
  v_perm_b32 v52, v131, v129, s45
  v_perm_b32 v53, v135, v133, s45
  v_perm_b32 v54, v139, v137, s45
  v_perm_b32 v55, v143, v141, s45
  v_accvgpr_write_b32 a76, v52
  v_accvgpr_write_b32 a77, v53
  v_accvgpr_write_b32 a78, v54
  v_accvgpr_write_b32 a79, v55
  s_add_u32 s27, s30, 172032
  buffer_load_dwordx2 v[128:129], v44, s[80:83], s27 offen
  s_add_u32 s27, s30, 173056
  buffer_load_dwordx2 v[130:131], v44, s[80:83], s27 offen
  s_add_u32 s27, s30, 174080
  buffer_load_dwordx2 v[132:133], v44, s[80:83], s27 offen
  s_add_u32 s27, s30, 175104
  buffer_load_dwordx2 v[134:135], v44, s[80:83], s27 offen
  s_add_u32 s27, s30, 188416
  buffer_load_dwordx2 v[136:137], v44, s[80:83], s27 offen
  s_add_u32 s27, s30, 189440
  buffer_load_dwordx2 v[138:139], v44, s[80:83], s27 offen
  s_add_u32 s27, s30, 190464
  buffer_load_dwordx2 v[140:141], v44, s[80:83], s27 offen
  s_add_u32 s27, s30, 191488
  buffer_load_dwordx2 v[142:143], v44, s[80:83], s27 offen
  s_waitcnt vmcnt(48)
  v_perm_b32 v48, v146, v144, s44
  v_perm_b32 v49, v150, v148, s44
  v_perm_b32 v50, v154, v152, s44
  v_perm_b32 v51, v158, v156, s44
  v_accvgpr_write_b32 a80, v48
  v_accvgpr_write_b32 a81, v49
  v_accvgpr_write_b32 a82, v50
  v_accvgpr_write_b32 a83, v51
  v_perm_b32 v52, v146, v144, s45
  v_perm_b32 v53, v150, v148, s45
  v_perm_b32 v54, v154, v152, s45
  v_perm_b32 v55, v158, v156, s45
  v_accvgpr_write_b32 a84, v52
  v_accvgpr_write_b32 a85, v53
  v_accvgpr_write_b32 a86, v54
  v_accvgpr_write_b32 a87, v55
  v_perm_b32 v48, v147, v145, s44
  v_perm_b32 v49, v151, v149, s44
  v_perm_b32 v50, v155, v153, s44
  v_perm_b32 v51, v159, v157, s44
  v_accvgpr_write_b32 a88, v48
  v_accvgpr_write_b32 a89, v49
  v_accvgpr_write_b32 a90, v50
  v_accvgpr_write_b32 a91, v51
  v_perm_b32 v52, v147, v145, s45
  v_perm_b32 v53, v151, v149, s45
  v_perm_b32 v54, v155, v153, s45
  v_perm_b32 v55, v159, v157, s45
  v_accvgpr_write_b32 a92, v52
  v_accvgpr_write_b32 a93, v53
  v_accvgpr_write_b32 a94, v54
  v_accvgpr_write_b32 a95, v55
  s_add_u32 s27, s30, 196608
  buffer_load_dwordx2 v[144:145], v44, s[80:83], s27 offen
  s_add_u32 s27, s30, 197632
  buffer_load_dwordx2 v[146:147], v44, s[80:83], s27 offen
  s_add_u32 s27, s30, 198656
  buffer_load_dwordx2 v[148:149], v44, s[80:83], s27 offen
  s_add_u32 s27, s30, 199680
  buffer_load_dwordx2 v[150:151], v44, s[80:83], s27 offen
  s_add_u32 s27, s30, 212992
  buffer_load_dwordx2 v[152:153], v44, s[80:83], s27 offen
  s_add_u32 s27, s30, 214016
  buffer_load_dwordx2 v[154:155], v44, s[80:83], s27 offen
  s_add_u32 s27, s30, 215040
  buffer_load_dwordx2 v[156:157], v44, s[80:83], s27 offen
  s_add_u32 s27, s30, 216064
  buffer_load_dwordx2 v[158:159], v44, s[80:83], s27 offen
  s_waitcnt vmcnt(48)
  v_perm_b32 v48, v162, v160, s44
  v_perm_b32 v49, v166, v164, s44
  v_perm_b32 v50, v170, v168, s44
  v_perm_b32 v51, v174, v172, s44
  v_accvgpr_write_b32 a96, v48
  v_accvgpr_write_b32 a97, v49
  v_accvgpr_write_b32 a98, v50
  v_accvgpr_write_b32 a99, v51
  v_perm_b32 v52, v162, v160, s45
  v_perm_b32 v53, v166, v164, s45
  v_perm_b32 v54, v170, v168, s45
  v_perm_b32 v55, v174, v172, s45
  v_accvgpr_write_b32 a100, v52
  v_accvgpr_write_b32 a101, v53
  v_accvgpr_write_b32 a102, v54
  v_accvgpr_write_b32 a103, v55
  v_perm_b32 v48, v163, v161, s44
  v_perm_b32 v49, v167, v165, s44
  v_perm_b32 v50, v171, v169, s44
  v_perm_b32 v51, v175, v173, s44
  v_accvgpr_write_b32 a104, v48
  v_accvgpr_write_b32 a105, v49
  v_accvgpr_write_b32 a106, v50
  v_accvgpr_write_b32 a107, v51
  v_perm_b32 v52, v163, v161, s45
  v_perm_b32 v53, v167, v165, s45
  v_perm_b32 v54, v171, v169, s45
  v_perm_b32 v55, v175, v173, s45
  v_accvgpr_write_b32 a108, v52
  v_accvgpr_write_b32 a109, v53
  v_accvgpr_write_b32 a110, v54
  v_accvgpr_write_b32 a111, v55
  s_add_u32 s27, s30, 204800
  buffer_load_dwordx2 v[160:161], v44, s[80:83], s27 offen
  s_add_u32 s27, s30, 205824
  buffer_load_dwordx2 v[162:163], v44, s[80:83], s27 offen
  s_add_u32 s27, s30, 206848
  buffer_load_dwordx2 v[164:165], v44, s[80:83], s27 offen
  s_add_u32 s27, s30, 207872
  buffer_load_dwordx2 v[166:167], v44, s[80:83], s27 offen
  s_add_u32 s27, s30, 221184
  buffer_load_dwordx2 v[168:169], v44, s[80:83], s27 offen
  s_add_u32 s27, s30, 222208
  buffer_load_dwordx2 v[170:171], v44, s[80:83], s27 offen
  s_add_u32 s27, s30, 223232
  buffer_load_dwordx2 v[172:173], v44, s[80:83], s27 offen
  s_add_u32 s27, s30, 224256
  buffer_load_dwordx2 v[174:175], v44, s[80:83], s27 offen
  s_waitcnt vmcnt(48)
  v_perm_b32 v48, v66, v64, s44
  v_perm_b32 v49, v70, v68, s44
  v_perm_b32 v50, v74, v72, s44
  v_perm_b32 v51, v78, v76, s44
  v_accvgpr_write_b32 a112, v48
  v_accvgpr_write_b32 a113, v49
  v_accvgpr_write_b32 a114, v50
  v_accvgpr_write_b32 a115, v51
  v_perm_b32 v52, v66, v64, s45
  v_perm_b32 v53, v70, v68, s45
  v_perm_b32 v54, v74, v72, s45
  v_perm_b32 v55, v78, v76, s45
  v_accvgpr_write_b32 a116, v52
  v_accvgpr_write_b32 a117, v53
  v_accvgpr_write_b32 a118, v54
  v_accvgpr_write_b32 a119, v55
  v_perm_b32 v48, v67, v65, s44
  v_perm_b32 v49, v71, v69, s44
  v_perm_b32 v50, v75, v73, s44
  v_perm_b32 v51, v79, v77, s44
  v_accvgpr_write_b32 a120, v48
  v_accvgpr_write_b32 a121, v49
  v_accvgpr_write_b32 a122, v50
  v_accvgpr_write_b32 a123, v51
  v_perm_b32 v52, v67, v65, s45
  v_perm_b32 v53, v71, v69, s45
  v_perm_b32 v54, v75, v73, s45
  v_perm_b32 v55, v79, v77, s45
  v_accvgpr_write_b32 a124, v52
  v_accvgpr_write_b32 a125, v53
  v_accvgpr_write_b32 a126, v54
  v_accvgpr_write_b32 a127, v55
  s_add_u32 s27, s30, 229376
  buffer_load_dwordx2 v[64:65], v44, s[80:83], s27 offen
  s_add_u32 s27, s30, 230400
  buffer_load_dwordx2 v[66:67], v44, s[80:83], s27 offen
  s_add_u32 s27, s30, 231424
  buffer_load_dwordx2 v[68:69], v44, s[80:83], s27 offen
  s_add_u32 s27, s30, 232448
  buffer_load_dwordx2 v[70:71], v44, s[80:83], s27 offen
  s_add_u32 s27, s30, 245760
  buffer_load_dwordx2 v[72:73], v44, s[80:83], s27 offen
  s_add_u32 s27, s30, 246784
  buffer_load_dwordx2 v[74:75], v44, s[80:83], s27 offen
  s_add_u32 s27, s30, 247808
  buffer_load_dwordx2 v[76:77], v44, s[80:83], s27 offen
  s_add_u32 s27, s30, 248832
  buffer_load_dwordx2 v[78:79], v44, s[80:83], s27 offen
  s_waitcnt vmcnt(48)
  v_perm_b32 v48, v82, v80, s44
  v_perm_b32 v49, v86, v84, s44
  v_perm_b32 v50, v90, v88, s44
  v_perm_b32 v51, v94, v92, s44
  v_accvgpr_write_b32 a128, v48
  v_accvgpr_write_b32 a129, v49
  v_accvgpr_write_b32 a130, v50
  v_accvgpr_write_b32 a131, v51
  v_perm_b32 v52, v82, v80, s45
  v_perm_b32 v53, v86, v84, s45
  v_perm_b32 v54, v90, v88, s45
  v_perm_b32 v55, v94, v92, s45
  v_accvgpr_write_b32 a132, v52
  v_accvgpr_write_b32 a133, v53
  v_accvgpr_write_b32 a134, v54
  v_accvgpr_write_b32 a135, v55
  v_perm_b32 v48, v83, v81, s44
  v_perm_b32 v49, v87, v85, s44
  v_perm_b32 v50, v91, v89, s44
  v_perm_b32 v51, v95, v93, s44
  v_accvgpr_write_b32 a136, v48
  v_accvgpr_write_b32 a137, v49
  v_accvgpr_write_b32 a138, v50
  v_accvgpr_write_b32 a139, v51
  v_perm_b32 v52, v83, v81, s45
  v_perm_b32 v53, v87, v85, s45
  v_perm_b32 v54, v91, v89, s45
  v_perm_b32 v55, v95, v93, s45
  v_accvgpr_write_b32 a140, v52
  v_accvgpr_write_b32 a141, v53
  v_accvgpr_write_b32 a142, v54
  v_accvgpr_write_b32 a143, v55
  s_add_u32 s27, s30, 237568
  buffer_load_dwordx2 v[80:81], v44, s[80:83], s27 offen
  s_add_u32 s27, s30, 238592
  buffer_load_dwordx2 v[82:83], v44, s[80:83], s27 offen
  s_add_u32 s27, s30, 239616
  buffer_load_dwordx2 v[84:85], v44, s[80:83], s27 offen
  s_add_u32 s27, s30, 240640
  buffer_load_dwordx2 v[86:87], v44, s[80:83], s27 offen
  s_add_u32 s27, s30, 253952
  buffer_load_dwordx2 v[88:89], v44, s[80:83], s27 offen
  s_add_u32 s27, s30, 254976
  buffer_load_dwordx2 v[90:91], v44, s[80:83], s27 offen
  s_add_u32 s27, s30, 256000
  buffer_load_dwordx2 v[92:93], v44, s[80:83], s27 offen
  s_add_u32 s27, s30, 257024
  buffer_load_dwordx2 v[94:95], v44, s[80:83], s27 offen
  s_waitcnt vmcnt(48)
  v_perm_b32 v48, v98, v96, s44
  v_perm_b32 v49, v102, v100, s44
  v_perm_b32 v50, v106, v104, s44
  v_perm_b32 v51, v110, v108, s44
  v_accvgpr_write_b32 a144, v48
  v_accvgpr_write_b32 a145, v49
  v_accvgpr_write_b32 a146, v50
  v_accvgpr_write_b32 a147, v51
  v_perm_b32 v52, v98, v96, s45
  v_perm_b32 v53, v102, v100, s45
  v_perm_b32 v54, v106, v104, s45
  v_perm_b32 v55, v110, v108, s45
  v_accvgpr_write_b32 a148, v52
  v_accvgpr_write_b32 a149, v53
  v_accvgpr_write_b32 a150, v54
  v_accvgpr_write_b32 a151, v55
  v_perm_b32 v48, v99, v97, s44
  v_perm_b32 v49, v103, v101, s44
  v_perm_b32 v50, v107, v105, s44
  v_perm_b32 v51, v111, v109, s44
  v_accvgpr_write_b32 a152, v48
  v_accvgpr_write_b32 a153, v49
  v_accvgpr_write_b32 a154, v50
  v_accvgpr_write_b32 a155, v51
  v_perm_b32 v52, v99, v97, s45
  v_perm_b32 v53, v103, v101, s45
  v_perm_b32 v54, v107, v105, s45
  v_perm_b32 v55, v111, v109, s45
  v_accvgpr_write_b32 a156, v52
  v_accvgpr_write_b32 a157, v53
  v_accvgpr_write_b32 a158, v54
  v_accvgpr_write_b32 a159, v55
  buffer_store_dwordx4 v[208:211], v0, s[4:7], s29 offen offset:0 sc1
  buffer_store_dwordx4 v[208:211], v0, s[4:7], s29 offen offset:1024 sc1
  buffer_store_dwordx4 v[208:211], v0, s[4:7], s29 offen offset:2048 sc1
  buffer_store_dwordx4 v[208:211], v0, s[4:7], s29 offen offset:3072 sc1
  s_add_u32 s29, s29, 4096
  s_waitcnt vmcnt(44)
  v_perm_b32 v48, v114, v112, s44
  v_perm_b32 v49, v118, v116, s44
  v_perm_b32 v50, v122, v120, s44
  v_perm_b32 v51, v126, v124, s44
  v_accvgpr_write_b32 a160, v48
  v_accvgpr_write_b32 a161, v49
  v_accvgpr_write_b32 a162, v50
  v_accvgpr_write_b32 a163, v51
  v_perm_b32 v52, v114, v112, s45
  v_perm_b32 v53, v118, v116, s45
  v_perm_b32 v54, v122, v120, s45
  v_perm_b32 v55, v126, v124, s45
  v_accvgpr_write_b32 a164, v52
  v_accvgpr_write_b32 a165, v53
  v_accvgpr_write_b32 a166, v54
  v_accvgpr_write_b32 a167, v55
  v_perm_b32 v48, v115, v113, s44
  v_perm_b32 v49, v119, v117, s44
  v_perm_b32 v50, v123, v121, s44
  v_perm_b32 v51, v127, v125, s44
  v_accvgpr_write_b32 a168, v48
  v_accvgpr_write_b32 a169, v49
  v_accvgpr_write_b32 a170, v50
  v_accvgpr_write_b32 a171, v51
  v_perm_b32 v52, v115, v113, s45
  v_perm_b32 v53, v119, v117, s45
  v_perm_b32 v54, v123, v121, s45
  v_perm_b32 v55, v127, v125, s45
  v_accvgpr_write_b32 a172, v52
  v_accvgpr_write_b32 a173, v53
  v_accvgpr_write_b32 a174, v54
  v_accvgpr_write_b32 a175, v55
  buffer_store_dwordx4 v[208:211], v0, s[4:7], s29 offen offset:0 sc1
  buffer_store_dwordx4 v[208:211], v0, s[4:7], s29 offen offset:1024 sc1
  buffer_store_dwordx4 v[208:211], v0, s[4:7], s29 offen offset:2048 sc1
  buffer_store_dwordx4 v[208:211], v0, s[4:7], s29 offen offset:3072 sc1
  s_add_u32 s29, s29, 520192
  s_waitcnt vmcnt(40)
  v_perm_b32 v48, v130, v128, s44
  v_perm_b32 v49, v134, v132, s44
  v_perm_b32 v50, v138, v136, s44
  v_perm_b32 v51, v142, v140, s44
  v_accvgpr_write_b32 a176, v48
  v_accvgpr_write_b32 a177, v49
  v_accvgpr_write_b32 a178, v50
  v_accvgpr_write_b32 a179, v51
  v_perm_b32 v52, v130, v128, s45
  v_perm_b32 v53, v134, v132, s45
  v_perm_b32 v54, v138, v136, s45
  v_perm_b32 v55, v142, v140, s45
  v_accvgpr_write_b32 a180, v52
  v_accvgpr_write_b32 a181, v53
  v_accvgpr_write_b32 a182, v54
  v_accvgpr_write_b32 a183, v55
  v_perm_b32 v48, v131, v129, s44
  v_perm_b32 v49, v135, v133, s44
  v_perm_b32 v50, v139, v137, s44
  v_perm_b32 v51, v143, v141, s44
  v_accvgpr_write_b32 a184, v48
  v_accvgpr_write_b32 a185, v49
  v_accvgpr_write_b32 a186, v50
  v_accvgpr_write_b32 a187, v51
  v_perm_b32 v52, v131, v129, s45
  v_perm_b32 v53, v135, v133, s45
  v_perm_b32 v54, v139, v137, s45
  v_perm_b32 v55, v143, v141, s45
  v_accvgpr_write_b32 a188, v52
  v_accvgpr_write_b32 a189, v53
  v_accvgpr_write_b32 a190, v54
  v_accvgpr_write_b32 a191, v55
  buffer_store_dwordx4 v[208:211], v0, s[4:7], s29 offen offset:0 sc1
  buffer_store_dwordx4 v[208:211], v0, s[4:7], s29 offen offset:1024 sc1
  buffer_store_dwordx4 v[208:211], v0, s[4:7], s29 offen offset:2048 sc1
  buffer_store_dwordx4 v[208:211], v0, s[4:7], s29 offen offset:3072 sc1
  s_add_u32 s29, s29, 4096
  s_waitcnt vmcnt(36)
  v_perm_b32 v48, v146, v144, s44
  v_perm_b32 v49, v150, v148, s44
  v_perm_b32 v50, v154, v152, s44
  v_perm_b32 v51, v158, v156, s44
  v_accvgpr_write_b32 a192, v48
  v_accvgpr_write_b32 a193, v49
  v_accvgpr_write_b32 a194, v50
  v_accvgpr_write_b32 a195, v51
  v_perm_b32 v52, v146, v144, s45
  v_perm_b32 v53, v150, v148, s45
  v_perm_b32 v54, v154, v152, s45
  v_perm_b32 v55, v158, v156, s45
  v_accvgpr_write_b32 a196, v52
  v_accvgpr_write_b32 a197, v53
  v_accvgpr_write_b32 a198, v54
  v_accvgpr_write_b32 a199, v55
  v_perm_b32 v48, v147, v145, s44
  v_perm_b32 v49, v151, v149, s44
  v_perm_b32 v50, v155, v153, s44
  v_perm_b32 v51, v159, v157, s44
  v_accvgpr_write_b32 a200, v48
  v_accvgpr_write_b32 a201, v49
  v_accvgpr_write_b32 a202, v50
  v_accvgpr_write_b32 a203, v51
  v_perm_b32 v52, v147, v145, s45
  v_perm_b32 v53, v151, v149, s45
  v_perm_b32 v54, v155, v153, s45
  v_perm_b32 v55, v159, v157, s45
  v_accvgpr_write_b32 a204, v52
  v_accvgpr_write_b32 a205, v53
  v_accvgpr_write_b32 a206, v54
  v_accvgpr_write_b32 a207, v55
  buffer_store_dwordx4 v[208:211], v0, s[4:7], s29 offen offset:0 sc1
  buffer_store_dwordx4 v[208:211], v0, s[4:7], s29 offen offset:1024 sc1
  buffer_store_dwordx4 v[208:211], v0, s[4:7], s29 offen offset:2048 sc1
  buffer_store_dwordx4 v[208:211], v0, s[4:7], s29 offen offset:3072 sc1
  s_add_u32 s29, s29, 4096
  s_waitcnt vmcnt(32)
  v_perm_b32 v48, v162, v160, s44
  v_perm_b32 v49, v166, v164, s44
  v_perm_b32 v50, v170, v168, s44
  v_perm_b32 v51, v174, v172, s44
  v_accvgpr_write_b32 a208, v48
  v_accvgpr_write_b32 a209, v49
  v_accvgpr_write_b32 a210, v50
  v_accvgpr_write_b32 a211, v51
  v_perm_b32 v52, v162, v160, s45
  v_perm_b32 v53, v166, v164, s45
  v_perm_b32 v54, v170, v168, s45
  v_perm_b32 v55, v174, v172, s45
  v_accvgpr_write_b32 a212, v52
  v_accvgpr_write_b32 a213, v53
  v_accvgpr_write_b32 a214, v54
  v_accvgpr_write_b32 a215, v55
  v_perm_b32 v48, v163, v161, s44
  v_perm_b32 v49, v167, v165, s44
  v_perm_b32 v50, v171, v169, s44
  v_perm_b32 v51, v175, v173, s44
  v_accvgpr_write_b32 a216, v48
  v_accvgpr_write_b32 a217, v49
  v_accvgpr_write_b32 a218, v50
  v_accvgpr_write_b32 a219, v51
  v_perm_b32 v52, v163, v161, s45
  v_perm_b32 v53, v167, v165, s45
  v_perm_b32 v54, v171, v169, s45
  v_perm_b32 v55, v175, v173, s45
  v_accvgpr_write_b32 a220, v52
  v_accvgpr_write_b32 a221, v53
  v_accvgpr_write_b32 a222, v54
  v_accvgpr_write_b32 a223, v55
  s_waitcnt vmcnt(24)
  v_perm_b32 v48, v66, v64, s44
  v_perm_b32 v49, v70, v68, s44
  v_perm_b32 v50, v74, v72, s44
  v_perm_b32 v51, v78, v76, s44
  v_accvgpr_write_b32 a224, v48
  v_accvgpr_write_b32 a225, v49
  v_accvgpr_write_b32 a226, v50
  v_accvgpr_write_b32 a227, v51
  v_perm_b32 v52, v66, v64, s45
  v_perm_b32 v53, v70, v68, s45
  v_perm_b32 v54, v74, v72, s45
  v_perm_b32 v55, v78, v76, s45
  v_accvgpr_write_b32 a228, v52
  v_accvgpr_write_b32 a229, v53
  v_accvgpr_write_b32 a230, v54
  v_accvgpr_write_b32 a231, v55
  v_perm_b32 v48, v67, v65, s44
  v_perm_b32 v49, v71, v69, s44
  v_perm_b32 v50, v75, v73, s44
  v_perm_b32 v51, v79, v77, s44
  v_accvgpr_write_b32 a232, v48
  v_accvgpr_write_b32 a233, v49
  v_accvgpr_write_b32 a234, v50
  v_accvgpr_write_b32 a235, v51
  v_perm_b32 v52, v67, v65, s45
  v_perm_b32 v53, v71, v69, s45
  v_perm_b32 v54, v75, v73, s45
  v_perm_b32 v55, v79, v77, s45
  v_accvgpr_write_b32 a236, v52
  v_accvgpr_write_b32 a237, v53
  v_accvgpr_write_b32 a238, v54
  v_accvgpr_write_b32 a239, v55
  s_waitcnt vmcnt(16)
  v_perm_b32 v48, v82, v80, s44
  v_perm_b32 v49, v86, v84, s44
  v_perm_b32 v50, v90, v88, s44
  v_perm_b32 v51, v94, v92, s44
  v_accvgpr_write_b32 a240, v48
  v_accvgpr_write_b32 a241, v49
  v_accvgpr_write_b32 a242, v50
  v_accvgpr_write_b32 a243, v51
  v_perm_b32 v52, v82, v80, s45
  v_perm_b32 v53, v86, v84, s45
  v_perm_b32 v54, v90, v88, s45
  v_perm_b32 v55, v94, v92, s45
  v_accvgpr_write_b32 a244, v52
  v_accvgpr_write_b32 a245, v53
  v_accvgpr_write_b32 a246, v54
  v_accvgpr_write_b32 a247, v55
  v_perm_b32 v48, v83, v81, s44
  v_perm_b32 v49, v87, v85, s44
  v_perm_b32 v50, v91, v89, s44
  v_perm_b32 v51, v95, v93, s44
  v_accvgpr_write_b32 a248, v48
  v_accvgpr_write_b32 a249, v49
  v_accvgpr_write_b32 a250, v50
  v_accvgpr_write_b32 a251, v51
  v_perm_b32 v52, v83, v81, s45
  v_perm_b32 v53, v87, v85, s45
  v_perm_b32 v54, v91, v89, s45
  v_perm_b32 v55, v95, v93, s45
  v_accvgpr_write_b32 a252, v52
  v_accvgpr_write_b32 a253, v53
  v_accvgpr_write_b32 a254, v54
  v_accvgpr_write_b32 a255, v55
  s_waitcnt vmcnt(0)
  s_barrier
  s_cmp_ge_u32 s60, 4
  s_cbranch_scc1 L_oh
  s_cmp_lg_u32 s17, 0
  s_cbranch_scc1 g_ar_121
  s_lshl_b32 s36, s89, 3
  s_lshl_b64 s[36:37], 1, s36
  v_lshlrev_b32 v52, 3, s91
  v_mov_b32 v48, s36
  v_mov_b32 v49, s37
  s_mov_b64 exec, 1
  global_atomic_add_x2 v[50:51], v52, v[48:49], s[12:13] sc0
  s_mov_b64 exec, -1
g_ar_121:
  s_waitcnt vmcnt(0)
  s_cmp_lg_u32 s17, 0
  s_cbranch_scc1 g_af_122
  v_readfirstlane_b32 s36, v50
  v_readfirstlane_b32 s37, v51
  s_add_u32 s38, s36, s37
  s_mul_i32 s38, s38, 0x01010101
  s_lshr_b32 s38, s38, 24
  s_cmp_lg_u32 s38, 15
  s_cbranch_scc1 g_af_122
  s_lshl_b32 s38, s89, 3
  s_lshr_b64 s[36:37], s[36:37], s38
  s_and_b32 s36, s36, 0xff
  s_cmp_eq_u32 s36, 15
  s_cselect_b32 s36, 1, 2
  v_mov_b32 v48, s36
  v_lshrrev_b32 v52, 1, v52
  s_mov_b64 exec, 1
  global_store_dword v52, v48, s[12:13] offset:128 sc1
  s_mov_b64 exec, -1
g_af_122:
  s_lshr_b32 s26, s60, 1
  s_cmp_lg_u32 s26, 1
  s_cbranch_scc1 L_ow
  s_and_b32 s28, s85, 28
  s_or_b32 s28, s28, 1
  s_lshl_b32 s27, s28, 6
  s_add_u32 s27, s27, 245104640
  s_mov_b32 s26, 0
g_h_123:
  buffer_load_dwordx2 v[60:61], off, s[4:7], s27 sc1
  s_add_u32 s26, s26, 1
  s_cmp_gt_u32 s26, 1048576
  s_cbranch_scc1 L_end
  s_waitcnt vmcnt(0)
  v_and_or_b32 v60, v61, -1, v60
  v_cmp_eq_u32 vcc, 0, v60
  s_cbranch_vccnz g_h_123
  s_mov_b32 s10, 1835008
  s_load_dwordx2 s[8:9], s[0:1], 72
  s_mul_i32 s26, s77, 14336
  s_sub_u32 s26, s26, 1835008
  s_waitcnt lgkmcnt(0)
  buffer_load_dwordx4 v[64:67], v0, s[8:11], s26 offen offset:0
  buffer_load_dwordx4 v[64:67], v0, s[8:11], s26 offen offset:1024
  buffer_load_dwordx4 v[64:67], v0, s[8:11], s26 offen offset:2048
  buffer_load_dwordx4 v[64:67], v0, s[8:11], s26 offen offset:3072
  s_add_u32 s26, s26, 4096
  buffer_load_dwordx4 v[64:67], v0, s[8:11], s26 offen offset:0
  buffer_load_dwordx4 v[64:67], v0, s[8:11], s26 offen offset:1024
  buffer_load_dwordx4 v[64:67], v0, s[8:11], s26 offen offset:2048
  buffer_load_dwordx4 v[64:67], v0, s[8:11], s26 offen offset:3072
  s_add_u32 s26, s26, 4096
  buffer_load_dwordx4 v[64:67], v0, s[8:11], s26 offen offset:0
  buffer_load_dwordx4 v[64:67], v0, s[8:11], s26 offen offset:1024
  buffer_load_dwordx4 v[64:67], v0, s[8:11], s26 offen offset:2048
  buffer_load_dwordx4 v[64:67], v0, s[8:11], s26 offen offset:3072
  s_add_u32 s26, s26, 4096
  buffer_load_dwordx4 v[64:67], v0, s[8:11], s26 offen offset:0
  buffer_load_dwordx4 v[64:67], v0, s[8:11], s26 offen offset:1024
  s_load_dwordx2 s[8:9], s[0:1], 80
  s_mul_i32 s26, s77, 14336
  s_sub_u32 s26, s26, 1835008
  s_waitcnt lgkmcnt(0)
  buffer_load_dwordx4 v[64:67], v0, s[8:11], s26 offen offset:0
  buffer_load_dwordx4 v[64:67], v0, s[8:11], s26 offen offset:1024
  buffer_load_dwordx4 v[64:67], v0, s[8:11], s26 offen offset:2048
  buffer_load_dwordx4 v[64:67], v0, s[8:11], s26 offen offset:3072
  s_add_u32 s26, s26, 4096
  buffer_load_dwordx4 v[64:67], v0, s[8:11], s26 offen offset:0
  buffer_load_dwordx4 v[64:67], v0, s[8:11], s26 offen offset:1024
  buffer_load_dwordx4 v[64:67], v0, s[8:11], s26 offen offset:2048
  buffer_load_dwordx4 v[64:67], v0, s[8:11], s26 offen offset:3072
  s_add_u32 s26, s26, 4096
  buffer_load_dwordx4 v[64:67], v0, s[8:11], s26 offen offset:0
  buffer_load_dwordx4 v[64:67], v0, s[8:11], s26 offen offset:1024
  buffer_load_dwordx4 v[64:67], v0, s[8:11], s26 offen offset:2048
  buffer_load_dwordx4 v[64:67], v0, s[8:11], s26 offen offset:3072
  s_add_u32 s26, s26, 4096
  buffer_load_dwordx4 v[64:67], v0, s[8:11], s26 offen offset:0
  buffer_load_dwordx4 v[64:67], v0, s[8:11], s26 offen offset:1024
  s_load_dwordx2 s[8:9], s[0:1], 88
  s_mul_i32 s26, s77, 14336
  s_sub_u32 s26, s26, 1835008
  s_waitcnt lgkmcnt(0)
  buffer_load_dwordx4 v[64:67], v0, s[8:11], s26 offen offset:0
  buffer_load_dwordx4 v[64:67], v0, s[8:11], s26 offen offset:1024
  buffer_load_dwordx4 v[64:67], v0, s[8:11], s26 offen offset:2048
  buffer_load_dwordx4 v[64:67], v0, s[8:11], s26 offen offset:3072
  s_add_u32 s26, s26, 4096
  buffer_load_dwordx4 v[64:67], v0, s[8:11], s26 offen offset:0
  buffer_load_dwordx4 v[64:67], v0, s[8:11], s26 offen offset:1024
  buffer_load_dwordx4 v[64:67], v0, s[8:11], s26 offen offset:2048
  buffer_load_dwordx4 v[64:67], v0, s[8:11], s26 offen offset:3072
  s_add_u32 s26, s26, 4096
  buffer_load_dwordx4 v[64:67], v0, s[8:11], s26 offen offset:0
  buffer_load_dwordx4 v[64:67], v0, s[8:11], s26 offen offset:1024
  buffer_load_dwordx4 v[64:67], v0, s[8:11], s26 offen offset:2048
  buffer_load_dwordx4 v[64:67], v0, s[8:11], s26 offen offset:3072
  s_add_u32 s26, s26, 4096
  buffer_load_dwordx4 v[64:67], v0, s[8:11], s26 offen offset:0
  buffer_load_dwordx4 v[64:67], v0, s[8:11], s26 offen offset:1024
L_ow:
  v_mbcnt_lo_u32_b32 v60, -1, 0
  v_and_b32 v60, 0, v60
  v_add_lshl_u32 v60, v60, s91, 2
  s_mov_b32 s26, 0
g_wt_124:
  global_load_dword v61, v60, s[12:13] offset:128 sc1
  s_add_u32 s26, s26, 1
  s_cmp_gt_u32 s26, 1048576
  s_cbranch_scc1 L_end
  s_waitcnt vmcnt(0)
  v_cmp_eq_u32 vcc, 0, v61
  v_readfirstlane_b32 s27, v61
  s_cbranch_vccnz g_wt_124
  s_mov_b32 s89, s27
L_oh:
  s_cmp_lg_u32 s89, 1
  s_cbranch_scc1 L_o_x
  s_mov_b32 s62, 1
  s_mov_b32 s42, 0
  s_mov_b32 s3, 0
  s_mov_b32 s46, 0
  s_mov_b32 s65, 0
  s_mov_b32 s66, 0
  s_mov_b32 s76, 0
  s_mov_b32 s55, 0
  s_mov_b32 s48, 0
  s_mov_b32 s56, 0
  s_mov_b32 s84, 268435456
  s_mov_b32 s86, s41
  s_mov_b32 s49, s60
  s_mul_i32 s63, s49, 257
  s_or_b32 s63, s63, 1179648
  s_lshr_b32 s57, s60, 2
  s_cbranch_scc1 o_help_136
o_round_125:
  s_max_u32 s46, s46, s3
  s_cmp_lg_u32 s3, 0
  s_mov_b32 s3, 0
  s_cbranch_scc1 d_g_141
  s_mov_b32 s67, 0
d_w_140:
  s_min_u32 s26, s49, 71
  s_lshl_b32 s26, s26, 12
  s_add_u32 s27, s26, 243494912
  s_add_u32 s26, s26, 243486720
  buffer_load_dword v248, v246, s[4:7], s26 offen sc1
  buffer_load_dword v249, v246, s[4:7], s27 offen sc1
  s_add_u32 s67, s67, 1
  s_cmp_gt_u32 s67, 1048576
  s_cbranch_scc1 L_end
  s_waitcnt vmcnt(0)
  s_mov_b64 exec, 1
  buffer_store_dword v38, off, s[4:7], s84 sc1
  s_mov_b64 exec, -1
  s_mov_b32 s84, 268435456
  v_min_u32 v162, v248, v249
  v_max_u32 v163, v248, v249
  v_cmp_eq_u32 vcc, 0, v162
  s_cbranch_vccnz d_w_140
  v_max_u32_dpp v163, v163, v163 row_ror:8 row_mask:0xf bank_mask:0xf
  s_nop 1
  v_max_u32_dpp v163, v163, v163 row_ror:4 row_mask:0xf bank_mask:0xf
  s_nop 1
  v_max_u32_dpp v163, v163, v163 row_ror:2 row_mask:0xf bank_mask:0xf
  s_nop 1
  v_max_u32_dpp v163, v163, v163 row_ror:1 row_mask:0xf bank_mask:0xf
  s_nop 0
  v_readlane_b32 s28, v163, 0
  v_readlane_b32 s29, v163, 16
  v_readlane_b32 s30, v163, 32
  v_readlane_b32 s31, v163, 48
  s_max_u32 s28, s28, s29
  s_max_u32 s30, s30, s31
  s_max_u32 s46, s46, s28
  s_max_u32 s46, s46, s30
d_g_141:
  s_lshr_b32 s27, s49, 2
  s_andn2_b32 s52, 0xfff, s46
  s_lshr_b32 s52, s52, 5
  s_min_u32 s52, s52, 64
  s_add_u32 s26, s52, 3
  v_readlane_b32 s89, v247, s27
  s_sub_u32 s26, s26, s60
  s_lshr_b32 s26, s26, 2
  s_bfm_b32 s54, s26, 0
  s_add_u32 s53, s63, 1028
  s_cmp_lt_u32 s49, 60
  s_cselect_b32 s53, s53, 0
  s_cmp_lt_u32 s49, 64
  s_cselect_b32 s26, 2, 1
  s_sub_i32 s26, s27, s26
  s_max_i32 s26, s26, 0
  s_min_u32 s26, s26, 16
  s_bfm_b32 s58, s26, 0
  s_cmp_eq_u32 s27, 16
  s_cselect_b32 s59, 1, 1
  s_cmp_eq_u32 s27, 17
  s_cselect_b32 s59, 0, s59
  s_cmp_eq_u32 s27, 18
  s_cselect_b32 s59, 64, s59
  s_cselect_b32 s50, 0, -1
  s_cselect_b32 s89, 0, s89
  s_cbranch_scc1 o_dl_137
  s_cmp_eq_u32 s27, 16
  s_cbranch_scc1 o_dl_137_a
o_pick_129:
  s_cmp_eq_u32 s59, 0
  s_cbranch_scc1 o_none_133
  s_sub_u32 s59, s59, 1
  s_andn2_b32 s26, s58, s55
  s_and_b32 s26, s26, s54
  s_cbranch_scc1 o_ga_130
  s_and_b32 s26, s55, s50
  s_or_b32 s26, s26, s56
  s_or_b32 s26, s26, s54
  s_andn2_b32 s26, s58, s26
  s_cbranch_scc0 o_none_133
  s_cmp_ge_u32 s46, s89
  s_cbranch_scc1 o_gb_131
o_ga_130:
  s_ff1_i32_b32 s26, s26
  s_bitset1_b32 s55, s26
  s_mov_b32 s64, 1327168
  s_mov_b32 s27, s64
  s_branch o_gd_132
o_none_133:
  s_cmp_lt_u32 s49, 60
  s_cbranch_scc1 o_nn_134
  s_cmp_eq_u32 s50, 0
  s_cbranch_scc1 o_nn_134
  s_and_b32 s26, s63, 1097728
  s_cmp_eq_u32 s26, 1048576
  s_cbranch_scc1 o_nn_134
  s_cmp_lt_u32 s49, 64
  s_cbranch_scc1 o_adv_135
  s_and_b32 s26, s65, 1097728
  s_cmp_lg_u32 s26, 1048576
  s_cbranch_scc1 o_adv_135
o_nn_134:
  s_mov_b32 s64, s53
  s_mov_b32 s51, 0
  s_branch o_task_126
o_gb_131:
  s_ff1_i32_b32 s26, s26
  s_bitset1_b32 s56, s26
  s_andn2_b32 s27, 31, s46
  s_or_b32 s27, s27, 32
  s_lshl_b32 s27, s27, 22
  s_or_b32 s27, s27, 1474688
  s_mov_b32 s64, 1474624
o_gd_132:
  s_lshl4_add_u32 s48, s48, s26
  s_and_b32 s28, s26, s57
  s_lshr_b32 s26, s26, s57
  s_lshl2_add_u32 s26, s26, s60
  s_add_u32 s26, s26, s28
  s_cmp_eq_u32 s26, s52
  s_cselect_b32 s64, s27, s64
  s_mul_i32 s26, s26, 257
  s_or_b32 s64, s64, s26
  s_mov_b32 s51, 1
o_task_126:
  s_cmp_eq_u32 s63, 0
  s_cbranch_scc1 o_nofl_127
  s_cmp_lg_u32 s66, 0
  s_cbranch_scc1 o_have_143
  s_mov_b32 s67, 0
o_w1_142:
  s_and_b32 s32, s63, 0xff
  s_lshl_b32 s32, s32, 12
  s_add_u32 s32, s32, s14
  buffer_load_dword v37, v36, s[4:7], s32 offen sc1
  s_add_u32 s67, s67, 1
  s_cmp_gt_u32 s67, 1048576
  s_cbranch_scc1 L_end
  s_waitcnt vmcnt(0)
  s_mov_b64 exec, 1
  buffer_store_dword v38, off, s[4:7], s84 sc1
  s_mov_b64 exec, -1
  s_mov_b32 s84, 268435456
  v_cmp_eq_u32 vcc, 0, v37
  s_cbranch_vccnz o_w1_142
  s_and_b32 s87, s63, 0xff
  s_lshl_b32 s33, s87, 18
  s_lshl_b32 s32, s87, 19
  s_add_u32 m0, s22, 0
  s_add_u32 s33, s33, s19
  buffer_load_dwordx4 v0, s[4:7], s33 offen offset:0 sc1 lds
  buffer_load_dwordx4 v0, s[4:7], s33 offen offset:1024 sc1 lds
  buffer_load_dwordx4 v0, s[4:7], s33 offen offset:2048 sc1 lds
  buffer_load_dwordx4 v0, s[4:7], s33 offen offset:3072 sc1 lds
  s_add_u32 m0, s23, 0
  s_add_u32 s32, s32, s18
  buffer_load_dwordx4 v0, s[4:7], s32 offen offset:0 sc1 lds
  buffer_load_dwordx4 v0, s[4:7], s32 offen offset:1024 sc1 lds
  buffer_load_dwordx4 v0, s[4:7], s32 offen offset:2048 sc1 lds
  buffer_load_dwordx4 v0, s[4:7], s32 offen offset:3072 sc1 lds
  s_add_u32 m0, m0, 4096
  s_add_u32 s32, s32, 4096
  buffer_load_dwordx4 v0, s[4:7], s32 offen offset:0 sc1 lds
  buffer_load_dwordx4 v0, s[4:7], s32 offen offset:1024 sc1 lds
  buffer_load_dwordx4 v0, s[4:7], s32 offen offset:2048 sc1 lds
  buffer_load_dwordx4 v0, s[4:7], s32 offen offset:3072 sc1 lds
  s_waitcnt vmcnt(0)
  s_barrier
o_have_143:
  ds_read_b128 v[120:123], v33 offset:0
  ds_read_b128 v[40:43], v32 offset:0
  ds_read_b128 v[56:59], v32 offset:1024
  ds_read_b128 v[124:127], v33 offset:2048
  ds_read_b128 v[44:47], v32 offset:4096
  ds_read_b128 v[60:63], v32 offset:5120
  ds_read_b128 v[128:131], v33 offset:4096
  ds_read_b128 v[48:51], v32 offset:8192
  ds_read_b128 v[64:67], v32 offset:9216
  ds_read_b128 v[132:135], v33 offset:6144
  ds_read_b128 v[52:55], v32 offset:12288
  ds_read_b128 v[68:71], v32 offset:13312
  s_cmp_lt_u32 s17, 2
  s_cselect_b32 s65, s65, 0
  s_cmp_lg_u32 s65, 0
  s_cselect_b64 s[44:45], -1, 0
  s_mov_b32 s95, s86
  s_mov_b32 s96, s42
  s_lshl_b32 s97, s43, 14
  s_add_u32 s97, s97, s95
  s_and_b32 s87, s64, 0xff
  s_lshl_b32 s87, s87, 12
  s_add_u32 s87, s87, s14
  s_and_b32 s88, s63, 0xff00
  s_lshl_b32 s88, s88, 3
  s_add_u32 s88, s88, s15
  s_and_b32 s91, s65, 63
  s_lshl_b32 s90, s91, 5
  s_add_u32 s94, s90, s85
  s_add_u32 s90, s90, s43
  s_lshl_b32 s94, s94, 10
  s_lshr_b32 s92, s65, 22
  s_xor_b32 s93, s43, 32
  s_lshl_b32 s91, s90, 10
  s_add_u32 s94, s94, 25165824
  s_cmp_eq_u32 s92, s93
  s_cselect_b32 s92, s94, s91
  s_add_u32 s92, s92, 10485760
  s_and_b32 s93, s65, 49152
  s_cselect_b32 s92, s92, s91
  s_cselect_b64 s[80:81], s[4:5], s[72:73]
  s_cselect_b32 s82, s6, s74
  s_waitcnt lgkmcnt(9)
  v_mfma_f32_16x16x32_bf16 v[104:107], v[40:43], v[120:123], v[24:27]
  v_mfma_f32_16x16x32_bf16 v[108:111], v[56:59], v[120:123], v[28:31]
  s_mov_b64 exec, s[44:45]
  buffer_load_dword v7, v255, s[4:7], s97 offen sc1
  buffer_load_dwordx4 v[184:187], v0, s[80:83], s92 offen sc1
  s_not_b64 exec, exec
  buffer_load_dword v37, v36, s[4:7], s87 offen sc1
  s_mov_b64 exec, -1
  buffer_load_dword v244, v252, s[4:7], s88 offen sc1
  s_waitcnt lgkmcnt(6)
  v_mfma_f32_16x16x32_bf16 v[104:107], v[44:47], v[124:127], v[104:107]
  v_mfma_f32_16x16x32_bf16 v[108:111], v[60:63], v[124:127], v[108:111]
  s_waitcnt lgkmcnt(3)
  v_mfma_f32_16x16x32_bf16 v[104:107], v[48:51], v[128:131], v[104:107]
  v_mfma_f32_16x16x32_bf16 v[108:111], v[64:67], v[128:131], v[108:111]
  s_waitcnt lgkmcnt(0)
  v_mfma_f32_16x16x32_bf16 v[104:107], v[52:55], v[132:135], v[104:107]
  v_mfma_f32_16x16x32_bf16 v[108:111], v[68:71], v[132:135], v[108:111]
  s_cmp_lg_u32 s76, 0
  s_cbranch_scc1 o_klds_146
  v_mov_b32 v196, 0
  v_mov_b32 v199, 0
  v_exp_f32 v56, v104
  v_exp_f32 v57, v105
  v_exp_f32 v58, v106
  v_exp_f32 v59, v107
  v_exp_f32 v60, v108
  v_exp_f32 v61, v109
  v_exp_f32 v62, v110
  v_exp_f32 v63, v111
  v_max3_f32 v116, v104, v105, v106
  v_max3_f32 v116, v107, v108, v116
  v_max3_f32 v116, v109, v110, v116
  v_add_f32 v117, v56, v57
  v_add_f32 v118, v58, v59
  v_add_f32 v117, v117, v60
  v_add_f32 v118, v118, v61
  v_add_f32 v117, v117, v62
  v_add_f32 v118, v118, v63
  s_mov_b32 s67, 0
  s_and_b32 s32, s63, 0xff00
  s_lshl_b32 s32, s32, 10
  s_add_u32 s32, s32, s20
  s_add_u32 s33, s32, 4096
o_w2_144:
  s_waitcnt vmcnt(0)
  v_cmp_eq_u32 vcc, 0, v244
  s_cbranch_vccz o_kgo_154
  s_mov_b64 exec, 1
  buffer_store_dword v38, off, s[4:7], s84 sc1
  s_mov_b64 exec, -1
  s_mov_b32 s84, 268435456
  buffer_load_dword v244, v252, s[4:7], s88 offen sc1
  s_add_u32 s67, s67, 1
  s_cmp_gt_u32 s67, 1048576
  s_cbranch_scc1 L_end
  s_branch o_w2_144
o_kgo_154:
  buffer_load_dwordx4 v[136:139], v0, s[4:7], s32 offen offset:0 sc1
  buffer_load_dwordx4 v[140:143], v0, s[4:7], s32 offen offset:1024 sc1
  buffer_load_dwordx4 v[144:147], v0, s[4:7], s32 offen offset:2048 sc1
  buffer_load_dwordx4 v[148:151], v0, s[4:7], s32 offen offset:3072 sc1
  buffer_load_dwordx2 v[200:201], v1, s[4:7], s33 offen offset:0 sc1
  buffer_load_dwordx2 v[202:203], v1, s[4:7], s33 offen offset:512 sc1
  buffer_load_dwordx2 v[204:205], v1, s[4:7], s33 offen offset:1024 sc1
  buffer_load_dwordx2 v[206:207], v1, s[4:7], s33 offen offset:1536 sc1
  buffer_load_dword v37, v36, s[4:7], s87 offen sc1
  buffer_load_dword v244, v252, s[4:7], s88 offen sc1
  s_barrier
  ds_read_b128 v[152:155], v32 offset:2048
  ds_read_b128 v[156:159], v32 offset:3072
  ds_read_b128 v[160:163], v32 offset:6144
  ds_read_b128 v[164:167], v32 offset:7168
  ds_read_b128 v[168:171], v32 offset:10240
  ds_read_b128 v[172:175], v32 offset:11264
  ds_read_b128 v[176:179], v32 offset:14336
  ds_read_b128 v[180:183], v32 offset:15360
  s_waitcnt vmcnt(9)
  v_mfma_f32_16x16x32_bf16 v[112:115], v[136:139], v[120:123], 0
  s_waitcnt vmcnt(8)
  v_mfma_f32_16x16x32_bf16 v[112:115], v[140:143], v[124:127], v[112:115]
  s_waitcnt vmcnt(7)
  v_mfma_f32_16x16x32_bf16 v[112:115], v[144:147], v[128:131], v[112:115]
  s_waitcnt vmcnt(6)
  v_mfma_f32_16x16x32_bf16 v[112:115], v[148:151], v[132:135], v[112:115]
  s_waitcnt vmcnt(2)
  s_branch o_havek_145
o_klds_146:
  s_waitcnt vmcnt(12)
  s_barrier
  ds_read_b128 v[136:139], v34 offset:0
  ds_read_b128 v[140:143], v34 offset:1024
  ds_read_b128 v[144:147], v34 offset:2048
  ds_read_b128 v[148:151], v34 offset:3072
  ds_read_b64 v[200:201], v35 offset:4096
  ds_read_b64 v[202:203], v35 offset:4608
  ds_read_b64 v[204:205], v35 offset:5120
  ds_read_b64 v[206:207], v35 offset:5632
  v_mov_b32 v196, 0
  v_mov_b32 v199, 0
  v_exp_f32 v56, v104
  v_exp_f32 v57, v105
  v_exp_f32 v58, v106
  v_exp_f32 v59, v107
  v_exp_f32 v60, v108
  v_exp_f32 v61, v109
  v_exp_f32 v62, v110
  v_exp_f32 v63, v111
  v_max3_f32 v116, v104, v105, v106
  v_max3_f32 v116, v107, v108, v116
  v_max3_f32 v116, v109, v110, v116
  s_waitcnt lgkmcnt(4)
  v_mfma_f32_16x16x32_bf16 v[112:115], v[136:139], v[120:123], 0
  ds_read_b128 v[152:155], v32 offset:2048
  ds_read_b128 v[156:159], v32 offset:3072
  v_mfma_f32_16x16x32_bf16 v[112:115], v[140:143], v[124:127], v[112:115]
  ds_read_b128 v[160:163], v32 offset:6144
  ds_read_b128 v[164:167], v32 offset:7168
  v_mfma_f32_16x16x32_bf16 v[112:115], v[144:147], v[128:131], v[112:115]
  ds_read_b128 v[168:171], v32 offset:10240
  ds_read_b128 v[172:175], v32 offset:11264
  v_mfma_f32_16x16x32_bf16 v[112:115], v[148:151], v[132:135], v[112:115]
  ds_read_b128 v[176:179], v32 offset:14336
  ds_read_b128 v[180:183], v32 offset:15360
  v_add_f32 v117, v56, v57
  v_add_f32 v118, v58, v59
  v_add_f32 v117, v117, v60
  v_add_f32 v118, v118, v61
  v_add_f32 v117, v117, v62
  v_add_f32 v118, v118, v63
o_havek_145:
  s_cmp_lg_u32 s65, 0
  s_cbranch_scc1 o_wr1_151
  s_nop 3
  v_mul_f32 v112, s24, v112
  v_mul_f32 v113, s24, v113
  v_exp_f32 v64, v112
  v_exp_f32 v65, v113
  v_max_f32 v116, v111, v116
  v_max3_f32 v116, v112, v113, v116
  v_add_f32 v117, v117, v64
  v_add_f32 v118, v118, v65
  v_add_f32 v117, v117, v118
  s_mov_b32 s28, 0x21800000
  v_mov_b32 v118, v117
  s_nop 1
  v_permlane16_swap_b32 v117, v118
  v_add_f32 v117, v117, v118
  v_mov_b32 v118, v117
  s_nop 0
  s_nop 0
  v_permlane32_swap_b32 v117, v118
  v_add_f32 v117, v117, v118
  v_cmp_lt_f32 vcc, 0x42700000, v116
  v_cmp_gt_f32 s[30:31], s28, v117
  v_rcp_f32 v117, v117
  s_or_b64 vcc, vcc, s[30:31]
  s_cbranch_vccnz o_fb_155
o_fbr_156:
  v_pk_mul_f32 v[56:57], v[56:57], v[116:117] op_sel:[0,1] op_sel_hi:[1,1]
  v_pk_mul_f32 v[58:59], v[58:59], v[116:117] op_sel:[0,1] op_sel_hi:[1,1]
  v_pk_mul_f32 v[60:61], v[60:61], v[116:117] op_sel:[0,1] op_sel_hi:[1,1]
  v_pk_mul_f32 v[62:63], v[62:63], v[116:117] op_sel:[0,1] op_sel_hi:[1,1]
  v_pk_mul_f32 v[64:65], v[64:65], v[116:117] op_sel:[0,1] op_sel_hi:[1,1]
  v_cvt_pk_bf16_f32 v116, v56, v57
  v_cvt_pk_bf16_f32 v117, v58, v59
  v_cvt_pk_bf16_f32 v118, v60, v61
  v_cvt_pk_bf16_f32 v119, v62, v63
  s_waitcnt lgkmcnt(0)
  s_nop 0
  v_mfma_f32_16x16x32_bf16 v[72:75], v[152:155], v[116:119], 0
  s_add_u32 s62, s62, 1
  v_cvt_pk_bf16_f32 v197, v64, v65
  v_cvt_pk_bf16_f32 v198, v64, v65
  v_mfma_f32_16x16x32_bf16 v[76:79], v[156:159], v[116:119], 0
  s_xor_b32 s86, s86, 524288
  v_mfma_f32_16x16x32_bf16 v[80:83], v[160:163], v[116:119], 0
  s_bfe_u32 s42, s62, 0x10001
  v_mfma_f32_16x16x32_bf16 v[84:87], v[164:167], v[116:119], 0
  s_bfe_u32 s26, s64, 65556
  v_mfma_f32_16x16x32_bf16 v[88:91], v[168:171], v[116:119], 0
  s_and_b32 s87, s64, 0xff
  v_mfma_f32_16x16x32_bf16 v[92:95], v[172:175], v[116:119], 0
  s_bfe_u32 s88, s64, 0x80008
  v_mfma_f32_16x16x32_bf16 v[96:99], v[176:179], v[116:119], 0
  s_nop 0
  v_mfma_f32_16x16x32_bf16 v[100:103], v[180:183], v[116:119], 0
  s_nop 0
  v_mfma_f32_16x16x16_bf16 v[72:75], v[200:201], v[198:199], v[72:75]
  s_nop 1
  v_mfma_f32_16x16x16_bf16 v[76:79], v[200:201], v[196:197], v[76:79]
  s_nop 1
  v_mfma_f32_16x16x16_bf16 v[80:83], v[202:203], v[198:199], v[80:83]
  s_nop 1
  v_mfma_f32_16x16x16_bf16 v[84:87], v[202:203], v[196:197], v[84:87]
  s_nop 1
  v_mfma_f32_16x16x16_bf16 v[88:91], v[204:205], v[198:199], v[88:91]
  s_nop 0
  v_cvt_pk_bf16_f32 v40, v72, v73
  v_cvt_pk_bf16_f32 v41, v74, v75
  v_mfma_f32_16x16x16_bf16 v[92:95], v[204:205], v[196:197], v[92:95]
  s_nop 0
  v_cvt_pk_bf16_f32 v42, v76, v77
  v_cvt_pk_bf16_f32 v43, v78, v79
  v_mfma_f32_16x16x16_bf16 v[96:99], v[206:207], v[198:199], v[96:99]
  s_nop 0
  ds_write_b128 v6, v[40:43] offset:0
  v_cvt_pk_bf16_f32 v44, v80, v81
  v_mfma_f32_16x16x16_bf16 v[100:103], v[206:207], v[196:197], v[100:103]
  s_nop 0
  v_cvt_pk_bf16_f32 v45, v82, v83
  v_cvt_pk_bf16_f32 v46, v84, v85
  v_cvt_pk_bf16_f32 v47, v86, v87
  ds_write_b128 v6, v[44:47] offset:1024
  v_cvt_pk_bf16_f32 v48, v88, v89
  v_cvt_pk_bf16_f32 v49, v90, v91
  v_cvt_pk_bf16_f32 v50, v92, v93
  v_cvt_pk_bf16_f32 v51, v94, v95
  ds_write_b128 v6, v[48:51] offset:2048
  v_cvt_pk_bf16_f32 v52, v96, v97
  v_cvt_pk_bf16_f32 v53, v98, v99
  v_cvt_pk_bf16_f32 v54, v100, v101
  v_cvt_pk_bf16_f32 v55, v102, v103
  ds_write_b128 v6, v[52:55] offset:3072
  s_cmp_lt_u32 s17, 2
  s_cbranch_scc1 o_wr0_150
  s_waitcnt lgkmcnt(0)
  s_barrier
  ds_read_b128 v[104:107], v3 offset:0
  ds_read_b128 v[108:111], v3 offset:512
  ds_read_b128 v[112:115], v3 offset:1024
  s_waitcnt lgkmcnt(2)
  v_mfma_f32_32x32x16_bf16 v[40:55], v[104:107], a[0:3], 0
  s_waitcnt vmcnt(0)
  v_cmp_eq_u32 vcc, 0, v37
  s_cmp_eq_u64 vcc, 0
  s_cselect_b32 s66, s26, 0
  s_cmp_eq_u32 s66, 1
  s_cselect_b32 s87, s87, 1024
  s_cselect_b32 s34, 0, 0x28000
  v_mfma_f32_32x32x16_bf16 v[56:71], v[104:107], a[4:7], 0
  ds_read_b128 v[116:119], v3 offset:1536
  s_lshl_b32 s33, s87, 18
  s_lshl_b32 s32, s87, 19
  s_add_u32 m0, s22, s34
  s_add_u32 s33, s33, s19
  s_min_u32 s28, s49, 67
  v_mfma_f32_32x32x16_bf16 v[72:87], v[104:107], a[8:11], 0
  s_lshl1_add_u32 s28, s17, s28
  s_lshl_b32 s28, s28, 12
  s_add_u32 s28, s28, 243486720
  v_mfma_f32_32x32x16_bf16 v[88:103], v[104:107], a[12:15], 0
  buffer_load_dword v249, v246, s[4:7], s28 offen sc1
  s_waitcnt lgkmcnt(2)
  v_mfma_f32_32x32x16_bf16 v[40:55], v[108:111], a[16:19], v[40:55]
  buffer_load_dwordx4 v0, s[4:7], s33 offen offset:0 sc1 lds
  v_mfma_f32_32x32x16_bf16 v[56:71], v[108:111], a[20:23], v[56:71]
  ds_read_b128 v[104:107], v3 offset:2048
  v_mfma_f32_32x32x16_bf16 v[72:87], v[108:111], a[24:27], v[72:87]
  buffer_load_dwordx4 v0, s[4:7], s33 offen offset:1024 sc1 lds
  v_mfma_f32_32x32x16_bf16 v[88:103], v[108:111], a[28:31], v[88:103]
  buffer_load_dwordx4 v0, s[4:7], s33 offen offset:2048 sc1 lds
  s_waitcnt lgkmcnt(2)
  v_mfma_f32_32x32x16_bf16 v[40:55], v[112:115], a[32:35], v[40:55]
  v_mfma_f32_32x32x16_bf16 v[56:71], v[112:115], a[36:39], v[56:71]
  ds_read_b128 v[108:111], v3 offset:2560
  buffer_load_dwordx4 v0, s[4:7], s33 offen offset:3072 sc1 lds
  s_sub_u32 m0, m0, 8192
  s_sub_u32 s33, s33, 8192
  v_mfma_f32_32x32x16_bf16 v[72:87], v[112:115], a[40:43], v[72:87]
  buffer_load_dwordx4 v0, s[4:7], s33 offen offset:0 sc1 lds
  v_mfma_f32_32x32x16_bf16 v[88:103], v[112:115], a[44:47], v[88:103]
  s_waitcnt lgkmcnt(2)
  v_mfma_f32_32x32x16_bf16 v[40:55], v[116:119], a[48:51], v[40:55]
  buffer_load_dwordx4 v0, s[4:7], s33 offen offset:1024 sc1 lds
  v_mfma_f32_32x32x16_bf16 v[56:71], v[116:119], a[52:55], v[56:71]
  ds_read_b128 v[112:115], v3 offset:3072
  buffer_load_dwordx4 v0, s[4:7], s33 offen offset:2048 sc1 lds
  v_mfma_f32_32x32x16_bf16 v[72:87], v[116:119], a[56:59], v[72:87]
  v_mfma_f32_32x32x16_bf16 v[88:103], v[116:119], a[60:63], v[88:103]
  buffer_load_dwordx4 v0, s[4:7], s33 offen offset:3072 sc1 lds
  s_add_u32 m0, s23, s34
  s_add_u32 s32, s32, s18
  s_waitcnt lgkmcnt(2)
  v_mfma_f32_32x32x16_bf16 v[40:55], v[104:107], a[64:67], v[40:55]
  buffer_load_dwordx4 v0, s[4:7], s32 offen offset:0 sc1 lds
  v_mfma_f32_32x32x16_bf16 v[56:71], v[104:107], a[68:71], v[56:71]
  ds_read_b128 v[116:119], v3 offset:3584
  v_mfma_f32_32x32x16_bf16 v[72:87], v[104:107], a[72:75], v[72:87]
  buffer_load_dwordx4 v0, s[4:7], s32 offen offset:1024 sc1 lds
  s_add_i32 m0, m0, 4096
  s_add_i32 s32, s32, 4096
  v_mfma_f32_32x32x16_bf16 v[88:103], v[104:107], a[76:79], v[88:103]
  buffer_load_dwordx4 v0, s[4:7], s32 offen offset:0 sc1 lds
  s_waitcnt lgkmcnt(2)
  v_mfma_f32_32x32x16_bf16 v[40:55], v[108:111], a[80:83], v[40:55]
  v_mfma_f32_32x32x16_bf16 v[56:71], v[108:111], a[84:87], v[56:71]
  ds_read_b128 v[104:107], v3 offset:8192
  buffer_load_dwordx4 v0, s[4:7], s32 offen offset:1024 sc1 lds
  s_add_i32 m0, m0, -16384
  s_add_i32 s32, s32, -16384
  v_mfma_f32_32x32x16_bf16 v[72:87], v[108:111], a[88:91], v[72:87]
  s_and_b32 s29, s64, 0xff00
  s_lshl_b32 s29, s29, 3
  s_add_u32 s29, s29, s15
  buffer_load_dword v245, v252, s[4:7], s29 offen sc1
  v_mfma_f32_32x32x16_bf16 v[88:103], v[108:111], a[92:95], v[88:103]
  s_waitcnt lgkmcnt(2)
  v_mfma_f32_32x32x16_bf16 v[40:55], v[112:115], a[96:99], v[40:55]
  buffer_load_dwordx4 v0, s[4:7], s32 offen offset:0 sc1 lds
  v_mfma_f32_32x32x16_bf16 v[56:71], v[112:115], a[100:103], v[56:71]
  ds_read_b128 v[108:111], v3 offset:8704
  buffer_load_dwordx4 v0, s[4:7], s32 offen offset:1024 sc1 lds
  s_add_i32 m0, m0, -4096
  s_add_i32 s32, s32, -4096
  v_mfma_f32_32x32x16_bf16 v[72:87], v[112:115], a[104:107], v[72:87]
  v_mfma_f32_32x32x16_bf16 v[88:103], v[112:115], a[108:111], v[88:103]
  buffer_load_dwordx4 v0, s[4:7], s32 offen offset:0 sc1 lds
  s_waitcnt lgkmcnt(2)
  v_mfma_f32_32x32x16_bf16 v[40:55], v[116:119], a[112:115], v[40:55]
  buffer_load_dwordx4 v0, s[4:7], s32 offen offset:1024 sc1 lds
  v_mfma_f32_32x32x16_bf16 v[56:71], v[116:119], a[116:119], v[56:71]
  ds_read_b128 v[112:115], v3 offset:9216
  v_mfma_f32_32x32x16_bf16 v[72:87], v[116:119], a[120:123], v[72:87]
  buffer_load_dwordx4 v0, s[4:7], s32 offen offset:2048 sc1 lds
  v_mfma_f32_32x32x16_bf16 v[88:103], v[116:119], a[124:127], v[88:103]
  buffer_load_dwordx4 v0, s[4:7], s32 offen offset:3072 sc1 lds
  s_add_i32 m0, m0, 4096
  s_add_i32 s32, s32, 4096
  s_waitcnt lgkmcnt(2)
  v_mfma_f32_32x32x16_bf16 v[40:55], v[104:107], a[128:131], v[40:55]
  v_mfma_f32_32x32x16_bf16 v[56:71], v[104:107], a[132:135], v[56:71]
  ds_read_b128 v[116:119], v3 offset:9728
  buffer_load_dwordx4 v0, s[4:7], s32 offen offset:2048 sc1 lds
  v_mfma_f32_32x32x16_bf16 v[72:87], v[104:107], a[136:139], v[72:87]
  buffer_load_dwordx4 v0, s[4:7], s32 offen offset:3072 sc1 lds
  s_add_i32 m0, m0, 16384
  s_add_i32 s32, s32, 16384
  v_mfma_f32_32x32x16_bf16 v[88:103], v[104:107], a[140:143], v[88:103]
  s_waitcnt lgkmcnt(2)
  v_mfma_f32_32x32x16_bf16 v[40:55], v[108:111], a[144:147], v[40:55]
  buffer_load_dwordx4 v0, s[4:7], s32 offen offset:2048 sc1 lds
  v_mfma_f32_32x32x16_bf16 v[56:71], v[108:111], a[148:151], v[56:71]
  ds_read_b128 v[104:107], v3 offset:10240
  buffer_load_dwordx4 v0, s[4:7], s32 offen offset:3072 sc1 lds
  s_add_i32 m0, m0, -4096
  s_add_i32 s32, s32, -4096
  v_mfma_f32_32x32x16_bf16 v[72:87], v[108:111], a[152:155], v[72:87]
  v_mfma_f32_32x32x16_bf16 v[88:103], v[108:111], a[156:159], v[88:103]
  buffer_load_dwordx4 v0, s[4:7], s32 offen offset:2048 sc1 lds
  s_waitcnt lgkmcnt(2)
  v_mfma_f32_32x32x16_bf16 v[40:55], v[112:115], a[160:163], v[40:55]
  buffer_load_dwordx4 v0, s[4:7], s32 offen offset:3072 sc1 lds
  v_mfma_f32_32x32x16_bf16 v[56:71], v[112:115], a[164:167], v[56:71]
  ds_read_b128 v[108:111], v3 offset:10752
  v_mfma_f32_32x32x16_bf16 v[72:87], v[112:115], a[168:171], v[72:87]
  v_mfma_f32_32x32x16_bf16 v[88:103], v[112:115], a[172:175], v[88:103]
  s_waitcnt lgkmcnt(2)
  v_mfma_f32_32x32x16_bf16 v[40:55], v[116:119], a[176:179], v[40:55]
  v_mfma_f32_32x32x16_bf16 v[56:71], v[116:119], a[180:183], v[56:71]
  ds_read_b128 v[112:115], v3 offset:11264
  v_mfma_f32_32x32x16_bf16 v[72:87], v[116:119], a[184:187], v[72:87]
  v_mfma_f32_32x32x16_bf16 v[88:103], v[116:119], a[188:191], v[88:103]
  s_waitcnt lgkmcnt(2)
  v_mfma_f32_32x32x16_bf16 v[40:55], v[104:107], a[192:195], v[40:55]
  v_mfma_f32_32x32x16_bf16 v[56:71], v[104:107], a[196:199], v[56:71]
  ds_read_b128 v[116:119], v3 offset:11776
  s_waitcnt vmcnt(12)
  v_cmp_eq_u32 vcc, 0, v245
  s_cmp_eq_u64 vcc, 0
  s_cselect_b32 s76, s26, 0
  s_and_b32 s76, s76, 1
  s_cselect_b32 s88, s88, 1024
  s_waitcnt lgkmcnt(2)
  v_mfma_f32_32x32x16_bf16 v[40:55], v[108:111], a[208:211], v[40:55]
  s_lshl_b32 s32, s88, 18
  s_mov_b32 m0, s40
  s_add_u32 s32, s32, s21
  buffer_load_dwordx4 v0, s[4:7], s32 offen offset:0 sc1 lds
  v_mfma_f32_32x32x16_bf16 v[56:71], v[108:111], a[212:215], v[56:71]
  buffer_load_dwordx4 v0, s[4:7], s32 offen offset:1024 sc1 lds
  s_waitcnt lgkmcnt(1)
  v_mfma_f32_32x32x16_bf16 v[40:55], v[112:115], a[224:227], v[40:55]
  buffer_load_dwordx4 v0, s[4:7], s32 offen offset:2048 sc1 lds
  s_sub_u32 m0, m0, 8192
  s_sub_u32 s32, s32, 8192
  v_mfma_f32_32x32x16_bf16 v[56:71], v[112:115], a[228:231], v[56:71]
  buffer_load_dwordx4 v0, s[4:7], s32 offen offset:0 sc1 lds
  s_waitcnt lgkmcnt(0)
  v_mfma_f32_32x32x16_bf16 v[40:55], v[116:119], a[240:243], v[40:55]
  buffer_load_dwordx4 v0, s[4:7], s32 offen offset:1024 sc1 lds
  v_mfma_f32_32x32x16_bf16 v[56:71], v[116:119], a[244:247], v[56:71]
  buffer_load_dwordx4 v0, s[4:7], s32 offen offset:2048 sc1 lds
  v_cmp_eq_u32 vcc, 0, v249
  v_max_u32_dpp v249, v249, v249 row_ror:8 row_mask:0xf bank_mask:0xf
  s_nop 0
  v_mfma_f32_32x32x16_bf16 v[72:87], v[104:107], a[200:203], v[72:87]
  v_max_u32_dpp v249, v249, v249 row_ror:4 row_mask:0xf bank_mask:0xf
  s_nop 0
  s_nop 0
  v_max_u32_dpp v249, v249, v249 row_ror:2 row_mask:0xf bank_mask:0xf
  s_nop 0
  s_nop 0
  v_max_u32_dpp v249, v249, v249 row_ror:1 row_mask:0xf bank_mask:0xf
  s_nop 0
  v_mfma_f32_32x32x16_bf16 v[88:103], v[104:107], a[204:207], v[88:103]
  v_mov_b32 v248, v249
  s_nop 0
  s_nop 0
  v_permlane16_swap_b32 v249, v248
  v_max_u32 v249, v249, v248
  v_mfma_f32_32x32x16_bf16 v[72:87], v[108:111], a[216:219], v[72:87]
  v_mov_b32 v248, v249
  s_nop 0
  s_nop 0
  v_permlane32_swap_b32 v249, v248
  v_max_u32 v249, v249, v248
  s_cmp_eq_u64 vcc, 0
  s_cselect_b32 s28, 4, 0
  v_mfma_f32_32x32x16_bf16 v[88:103], v[108:111], a[220:223], v[88:103]
  s_lshl_b32 s26, s76, 1
  s_or_b32 s26, s26, s66
  s_or_b32 s26, s26, s28
  v_mov_b32 v248, s26
  ds_write_b64 v39, v[248:249]
  v_mfma_f32_32x32x16_bf16 v[72:87], v[112:115], a[232:235], v[72:87]
  v_cvt_pk_bf16_f32 v212, v40, v56
  v_cvt_pk_bf16_f32 v214, v41, v57
  v_cvt_pk_bf16_f32 v216, v42, v58
  v_cvt_pk_bf16_f32 v218, v43, v59
  v_permlane16_swap_b32 v212, v214
  v_mfma_f32_32x32x16_bf16 v[88:103], v[112:115], a[236:239], v[88:103]
  v_cvt_pk_bf16_f32 v220, v44, v60
  v_cvt_pk_bf16_f32 v222, v45, v61
  v_permlane16_swap_b32 v216, v218
  v_bfi_b32 v212, v254, s42, v212
  v_mfma_f32_32x32x16_bf16 v[72:87], v[116:119], a[248:251], v[72:87]
  v_cvt_pk_bf16_f32 v224, v46, v62
  v_cvt_pk_bf16_f32 v226, v47, v63
  v_permlane16_swap_b32 v220, v222
  v_bfi_b32 v216, v254, s42, v216
  v_cvt_pk_bf16_f32 v228, v48, v64
  v_mfma_f32_32x32x16_bf16 v[88:103], v[116:119], a[252:255], v[88:103]
  v_cvt_pk_bf16_f32 v230, v49, v65
  v_permlane16_swap_b32 v224, v226
  v_bfi_b32 v220, v254, s42, v220
  v_cvt_pk_bf16_f32 v232, v50, v66
  v_cvt_pk_bf16_f32 v234, v51, v67
  v_permlane16_swap_b32 v228, v230
  v_bfi_b32 v224, v254, s42, v224
  v_cvt_pk_bf16_f32 v236, v52, v68
  v_cvt_pk_bf16_f32 v238, v53, v69
  v_permlane16_swap_b32 v232, v234
  v_bfi_b32 v228, v254, s42, v228
  v_cvt_pk_bf16_f32 v240, v54, v70
  v_cvt_pk_bf16_f32 v242, v55, v71
  v_permlane16_swap_b32 v236, v238
  v_bfi_b32 v232, v254, s42, v232
  v_permlane16_swap_b32 v240, v242
  v_bfi_b32 v236, v254, s42, v236
  v_bfi_b32 v240, v254, s42, v240
  v_cvt_pk_bf16_f32 v213, v72, v88
  v_cvt_pk_bf16_f32 v215, v73, v89
  v_cvt_pk_bf16_f32 v217, v74, v90
  v_cvt_pk_bf16_f32 v219, v75, v91
  s_add_u32 s78, s86, 0
  v_permlane16_swap_b32 v213, v215
  buffer_store_dwordx4 v[212:215], v4, s[4:7], s78 offen
  v_cvt_pk_bf16_f32 v221, v76, v92
  v_cvt_pk_bf16_f32 v223, v77, v93
  s_add_u32 s78, s86, 32768
  v_permlane16_swap_b32 v217, v219
  buffer_store_dwordx4 v[216:219], v4, s[4:7], s78 offen
  v_cvt_pk_bf16_f32 v225, v78, v94
  v_cvt_pk_bf16_f32 v227, v79, v95
  s_add_u32 s78, s86, 131072
  v_permlane16_swap_b32 v221, v223
  buffer_store_dwordx4 v[220:223], v4, s[4:7], s78 offen
  v_cvt_pk_bf16_f32 v229, v80, v96
  v_cvt_pk_bf16_f32 v231, v81, v97
  s_add_u32 s78, s86, 163840
  v_permlane16_swap_b32 v225, v227
  buffer_store_dwordx4 v[224:227], v4, s[4:7], s78 offen
  v_cvt_pk_bf16_f32 v233, v82, v98
  v_cvt_pk_bf16_f32 v235, v83, v99
  s_add_u32 s78, s86, 262144
  v_permlane16_swap_b32 v229, v231
  buffer_store_dwordx4 v[228:231], v4, s[4:7], s78 offen
  v_cvt_pk_bf16_f32 v237, v84, v100
  v_cvt_pk_bf16_f32 v239, v85, v101
  s_add_u32 s78, s86, 294912
  v_permlane16_swap_b32 v233, v235
  buffer_store_dwordx4 v[232:235], v4, s[4:7], s78 offen
  v_cvt_pk_bf16_f32 v241, v86, v102
  v_cvt_pk_bf16_f32 v243, v87, v103
  s_add_u32 s78, s86, 393216
  v_permlane16_swap_b32 v237, v239
  buffer_store_dwordx4 v[236:239], v4, s[4:7], s78 offen
  s_add_u32 s78, s86, 425984
  v_permlane16_swap_b32 v241, v243
  buffer_store_dwordx4 v[240:243], v4, s[4:7], s78 offen
  s_waitcnt vmcnt(22)
  s_branch o_we_153
o_wr0_150:
  s_waitcnt lgkmcnt(0)
  s_barrier
  ds_read_b128 v[104:107], v3 offset:0
  ds_read_b128 v[108:111], v3 offset:512
  ds_read_b128 v[112:115], v3 offset:1024
  s_waitcnt lgkmcnt(2)
  v_mfma_f32_32x32x16_bf16 v[40:55], v[104:107], a[0:3], 0
  v_mfma_f32_32x32x16_bf16 v[56:71], v[104:107], a[4:7], 0
  ds_read_b128 v[116:119], v3 offset:1536
  v_mfma_f32_32x32x16_bf16 v[72:87], v[104:107], a[8:11], 0
  v_mfma_f32_32x32x16_bf16 v[88:103], v[104:107], a[12:15], 0
  s_waitcnt lgkmcnt(2)
  v_mfma_f32_32x32x16_bf16 v[40:55], v[108:111], a[16:19], v[40:55]
  v_mfma_f32_32x32x16_bf16 v[56:71], v[108:111], a[20:23], v[56:71]
  ds_read_b128 v[104:107], v3 offset:2048
  v_mfma_f32_32x32x16_bf16 v[72:87], v[108:111], a[24:27], v[72:87]
  v_mfma_f32_32x32x16_bf16 v[88:103], v[108:111], a[28:31], v[88:103]
  s_waitcnt lgkmcnt(2)
  v_mfma_f32_32x32x16_bf16 v[40:55], v[112:115], a[32:35], v[40:55]
  v_mfma_f32_32x32x16_bf16 v[56:71], v[112:115], a[36:39], v[56:71]
  ds_read_b128 v[108:111], v3 offset:2560
  v_mfma_f32_32x32x16_bf16 v[72:87], v[112:115], a[40:43], v[72:87]
  v_mfma_f32_32x32x16_bf16 v[88:103], v[112:115], a[44:47], v[88:103]
  s_waitcnt lgkmcnt(2)
  v_mfma_f32_32x32x16_bf16 v[40:55], v[116:119], a[48:51], v[40:55]
  v_mfma_f32_32x32x16_bf16 v[56:71], v[116:119], a[52:55], v[56:71]
  ds_read_b128 v[112:115], v3 offset:3072
  v_mfma_f32_32x32x16_bf16 v[72:87], v[116:119], a[56:59], v[72:87]
  v_mfma_f32_32x32x16_bf16 v[88:103], v[116:119], a[60:63], v[88:103]
  s_waitcnt lgkmcnt(2)
  v_mfma_f32_32x32x16_bf16 v[40:55], v[104:107], a[64:67], v[40:55]
  v_mfma_f32_32x32x16_bf16 v[56:71], v[104:107], a[68:71], v[56:71]
  ds_read_b128 v[116:119], v3 offset:3584
  v_mfma_f32_32x32x16_bf16 v[72:87], v[104:107], a[72:75], v[72:87]
  v_mfma_f32_32x32x16_bf16 v[88:103], v[104:107], a[76:79], v[88:103]
  s_waitcnt lgkmcnt(2)
  v_mfma_f32_32x32x16_bf16 v[40:55], v[108:111], a[80:83], v[40:55]
  v_mfma_f32_32x32x16_bf16 v[56:71], v[108:111], a[84:87], v[56:71]
  ds_read_b128 v[104:107], v3 offset:8192
  v_mfma_f32_32x32x16_bf16 v[72:87], v[108:111], a[88:91], v[72:87]
  v_mfma_f32_32x32x16_bf16 v[88:103], v[108:111], a[92:95], v[88:103]
  s_waitcnt lgkmcnt(2)
  v_mfma_f32_32x32x16_bf16 v[40:55], v[112:115], a[96:99], v[40:55]
  v_mfma_f32_32x32x16_bf16 v[56:71], v[112:115], a[100:103], v[56:71]
  ds_read_b128 v[108:111], v3 offset:8704
  v_mfma_f32_32x32x16_bf16 v[72:87], v[112:115], a[104:107], v[72:87]
  v_mfma_f32_32x32x16_bf16 v[88:103], v[112:115], a[108:111], v[88:103]
  s_waitcnt lgkmcnt(2)
  v_mfma_f32_32x32x16_bf16 v[40:55], v[116:119], a[112:115], v[40:55]
  v_mfma_f32_32x32x16_bf16 v[56:71], v[116:119], a[116:119], v[56:71]
  ds_read_b128 v[112:115], v3 offset:9216
  v_mfma_f32_32x32x16_bf16 v[72:87], v[116:119], a[120:123], v[72:87]
  v_mfma_f32_32x32x16_bf16 v[88:103], v[116:119], a[124:127], v[88:103]
  s_waitcnt lgkmcnt(2)
  v_mfma_f32_32x32x16_bf16 v[40:55], v[104:107], a[128:131], v[40:55]
  v_mfma_f32_32x32x16_bf16 v[56:71], v[104:107], a[132:135], v[56:71]
  ds_read_b128 v[116:119], v3 offset:9728
  v_mfma_f32_32x32x16_bf16 v[72:87], v[104:107], a[136:139], v[72:87]
  v_mfma_f32_32x32x16_bf16 v[88:103], v[104:107], a[140:143], v[88:103]
  s_waitcnt lgkmcnt(2)
  v_mfma_f32_32x32x16_bf16 v[40:55], v[108:111], a[144:147], v[40:55]
  v_mfma_f32_32x32x16_bf16 v[56:71], v[108:111], a[148:151], v[56:71]
  ds_read_b128 v[104:107], v3 offset:10240
  v_mfma_f32_32x32x16_bf16 v[72:87], v[108:111], a[152:155], v[72:87]
  v_mfma_f32_32x32x16_bf16 v[88:103], v[108:111], a[156:159], v[88:103]
  s_waitcnt lgkmcnt(2)
  v_mfma_f32_32x32x16_bf16 v[40:55], v[112:115], a[160:163], v[40:55]
  v_mfma_f32_32x32x16_bf16 v[56:71], v[112:115], a[164:167], v[56:71]
  ds_read_b128 v[108:111], v3 offset:10752
  v_mfma_f32_32x32x16_bf16 v[72:87], v[112:115], a[168:171], v[72:87]
  v_mfma_f32_32x32x16_bf16 v[88:103], v[112:115], a[172:175], v[88:103]
  s_waitcnt lgkmcnt(2)
  v_mfma_f32_32x32x16_bf16 v[40:55], v[116:119], a[176:179], v[40:55]
  v_mfma_f32_32x32x16_bf16 v[56:71], v[116:119], a[180:183], v[56:71]
  ds_read_b128 v[112:115], v3 offset:11264
  v_mfma_f32_32x32x16_bf16 v[72:87], v[116:119], a[184:187], v[72:87]
  v_mfma_f32_32x32x16_bf16 v[88:103], v[116:119], a[188:191], v[88:103]
  s_waitcnt lgkmcnt(2)
  v_mfma_f32_32x32x16_bf16 v[40:55], v[104:107], a[192:195], v[40:55]
  v_mfma_f32_32x32x16_bf16 v[56:71], v[104:107], a[196:199], v[56:71]
  ds_read_b128 v[116:119], v3 offset:11776
  s_waitcnt lgkmcnt(2)
  v_mfma_f32_32x32x16_bf16 v[40:55], v[108:111], a[208:211], v[40:55]
  v_mfma_f32_32x32x16_bf16 v[56:71], v[108:111], a[212:215], v[56:71]
  s_waitcnt lgkmcnt(1)
  v_mfma_f32_32x32x16_bf16 v[40:55], v[112:115], a[224:227], v[40:55]
  v_mfma_f32_32x32x16_bf16 v[56:71], v[112:115], a[228:231], v[56:71]
  s_waitcnt lgkmcnt(0)
  v_mfma_f32_32x32x16_bf16 v[40:55], v[116:119], a[240:243], v[40:55]
  v_mfma_f32_32x32x16_bf16 v[56:71], v[116:119], a[244:247], v[56:71]
  v_mfma_f32_32x32x16_bf16 v[72:87], v[104:107], a[200:203], v[72:87]
  v_mfma_f32_32x32x16_bf16 v[88:103], v[104:107], a[204:207], v[88:103]
  v_cvt_pk_bf16_f32 v212, v40, v56
  v_cvt_pk_bf16_f32 v214, v41, v57
  v_cvt_pk_bf16_f32 v216, v42, v58
  v_cvt_pk_bf16_f32 v218, v43, v59
  v_permlane16_swap_b32 v212, v214
  v_mfma_f32_32x32x16_bf16 v[72:87], v[108:111], a[216:219], v[72:87]
  v_cvt_pk_bf16_f32 v220, v44, v60
  v_cvt_pk_bf16_f32 v222, v45, v61
  v_permlane16_swap_b32 v216, v218
  v_bfi_b32 v212, v254, s42, v212
  v_cvt_pk_bf16_f32 v224, v46, v62
  v_mfma_f32_32x32x16_bf16 v[88:103], v[108:111], a[220:223], v[88:103]
  v_cvt_pk_bf16_f32 v226, v47, v63
  v_permlane16_swap_b32 v220, v222
  v_bfi_b32 v216, v254, s42, v216
  v_cvt_pk_bf16_f32 v228, v48, v64
  v_mfma_f32_32x32x16_bf16 v[72:87], v[112:115], a[232:235], v[72:87]
  v_cvt_pk_bf16_f32 v230, v49, v65
  v_permlane16_swap_b32 v224, v226
  v_bfi_b32 v220, v254, s42, v220
  v_cvt_pk_bf16_f32 v232, v50, v66
  v_cvt_pk_bf16_f32 v234, v51, v67
  v_mfma_f32_32x32x16_bf16 v[88:103], v[112:115], a[236:239], v[88:103]
  v_permlane16_swap_b32 v228, v230
  v_bfi_b32 v224, v254, s42, v224
  v_cvt_pk_bf16_f32 v236, v52, v68
  v_cvt_pk_bf16_f32 v238, v53, v69
  v_mfma_f32_32x32x16_bf16 v[72:87], v[116:119], a[248:251], v[72:87]
  v_permlane16_swap_b32 v232, v234
  v_bfi_b32 v228, v254, s42, v228
  v_cvt_pk_bf16_f32 v240, v54, v70
  v_cvt_pk_bf16_f32 v242, v55, v71
  v_permlane16_swap_b32 v236, v238
  v_mfma_f32_32x32x16_bf16 v[88:103], v[116:119], a[252:255], v[88:103]
  v_bfi_b32 v232, v254, s42, v232
  v_permlane16_swap_b32 v240, v242
  v_bfi_b32 v236, v254, s42, v236
  v_bfi_b32 v240, v254, s42, v240
  s_nop 7
  v_cvt_pk_bf16_f32 v213, v72, v88
  v_cvt_pk_bf16_f32 v215, v73, v89
  v_cvt_pk_bf16_f32 v217, v74, v90
  v_cvt_pk_bf16_f32 v219, v75, v91
  s_add_u32 s78, s86, 0
  v_permlane16_swap_b32 v213, v215
  buffer_store_dwordx4 v[212:215], v4, s[4:7], s78 offen
  v_cvt_pk_bf16_f32 v221, v76, v92
  v_cvt_pk_bf16_f32 v223, v77, v93
  s_add_u32 s78, s86, 32768
  v_permlane16_swap_b32 v217, v219
  buffer_store_dwordx4 v[216:219], v4, s[4:7], s78 offen
  v_cvt_pk_bf16_f32 v225, v78, v94
  v_cvt_pk_bf16_f32 v227, v79, v95
  s_add_u32 s78, s86, 131072
  v_permlane16_swap_b32 v221, v223
  buffer_store_dwordx4 v[220:223], v4, s[4:7], s78 offen
  v_cvt_pk_bf16_f32 v229, v80, v96
  v_cvt_pk_bf16_f32 v231, v81, v97
  s_add_u32 s78, s86, 163840
  v_permlane16_swap_b32 v225, v227
  buffer_store_dwordx4 v[224:227], v4, s[4:7], s78 offen
  v_cvt_pk_bf16_f32 v233, v82, v98
  v_cvt_pk_bf16_f32 v235, v83, v99
  s_add_u32 s78, s86, 262144
  v_permlane16_swap_b32 v229, v231
  buffer_store_dwordx4 v[228:231], v4, s[4:7], s78 offen
  v_cvt_pk_bf16_f32 v237, v84, v100
  v_cvt_pk_bf16_f32 v239, v85, v101
  s_add_u32 s78, s86, 294912
  v_permlane16_swap_b32 v233, v235
  buffer_store_dwordx4 v[232:235], v4, s[4:7], s78 offen
  v_cvt_pk_bf16_f32 v241, v86, v102
  v_cvt_pk_bf16_f32 v243, v87, v103
  s_add_u32 s78, s86, 393216
  v_permlane16_swap_b32 v237, v239
  buffer_store_dwordx4 v[236:239], v4, s[4:7], s78 offen
  s_add_u32 s78, s86, 425984
  v_permlane16_swap_b32 v241, v243
  buffer_store_dwordx4 v[240:243], v4, s[4:7], s78 offen
  s_branch o_we_153
o_wr1_151:
  s_nop 3
  v_mul_f32 v112, s24, v112
  v_mul_f32 v113, s24, v113
  v_exp_f32 v64, v112
  v_exp_f32 v65, v113
  v_max_f32 v116, v111, v116
  v_max3_f32 v116, v112, v113, v116
  v_add_f32 v117, v117, v64
  v_add_f32 v118, v118, v65
  v_add_f32 v117, v117, v118
  s_mov_b32 s28, 0x21800000
  v_mov_b32 v118, v117
  s_nop 1
  v_permlane16_swap_b32 v117, v118
  v_add_f32 v117, v117, v118
  v_mov_b32 v118, v117
  s_nop 0
  s_nop 0
  v_permlane32_swap_b32 v117, v118
  v_add_f32 v117, v117, v118
  s_mov_b32 s67, 0
  s_mov_b64 vcc, 0
  s_waitcnt vmcnt(3)
o_pl_159:
  v_and_b32 v7, 1, v7
  v_cmp_ne_u32 vcc, s96, v7
  s_cbranch_vccz o_pk_160
  buffer_load_dword v7, v255, s[4:7], s97 offen sc1
  s_add_u32 s67, s67, 1
  s_cmp_gt_u32 s67, 1048576
  s_cbranch_scc1 L_end
  s_waitcnt vmcnt(0)
  s_branch o_pl_159
o_pk_160:
  s_lshl_b32 s94, s43, 14
  s_add_u32 s94, s94, s95
  buffer_load_dwordx4 v[120:123], v5, s[4:7], s94 offen offset:0 sc1
  v_cmp_lt_f32 vcc, 0x42700000, v116
  v_cmp_gt_f32 s[30:31], s28, v117
  v_rcp_f32 v117, v117
  buffer_load_dwordx4 v[124:127], v5, s[4:7], s94 offen offset:512 sc1
  s_or_b64 vcc, vcc, s[30:31]
  s_cbranch_vccnz o_fb_157
o_fbr_158:
  buffer_load_dwordx4 v[128:131], v5, s[4:7], s94 offen offset:256 sc1
  v_pk_mul_f32 v[56:57], v[56:57], v[116:117] op_sel:[0,1] op_sel_hi:[1,1]
  v_pk_mul_f32 v[58:59], v[58:59], v[116:117] op_sel:[0,1] op_sel_hi:[1,1]
  v_pk_mul_f32 v[60:61], v[60:61], v[116:117] op_sel:[0,1] op_sel_hi:[1,1]
  v_pk_mul_f32 v[62:63], v[62:63], v[116:117] op_sel:[0,1] op_sel_hi:[1,1]
  v_pk_mul_f32 v[64:65], v[64:65], v[116:117] op_sel:[0,1] op_sel_hi:[1,1]
  buffer_load_dwordx4 v[132:135], v5, s[4:7], s94 offen offset:768 sc1
  v_cvt_pk_bf16_f32 v116, v56, v57
  v_cvt_pk_bf16_f32 v117, v58, v59
  v_cvt_pk_bf16_f32 v118, v60, v61
  v_cvt_pk_bf16_f32 v119, v62, v63
  s_waitcnt lgkmcnt(0)
  s_nop 0
  v_mfma_f32_16x16x32_bf16 v[72:75], v[152:155], v[116:119], 0
  s_add_u32 s62, s62, 1
  v_cvt_pk_bf16_f32 v197, v64, v65
  v_cvt_pk_bf16_f32 v198, v64, v65
  v_mfma_f32_16x16x32_bf16 v[76:79], v[156:159], v[116:119], 0
  s_add_u32 s94, s94, 4096
  buffer_load_dwordx4 v[136:139], v5, s[4:7], s94 offen offset:0 sc1
  s_xor_b32 s86, s86, 524288
  v_mfma_f32_16x16x32_bf16 v[80:83], v[160:163], v[116:119], 0
  s_bfe_u32 s42, s62, 0x10001
  v_mfma_f32_16x16x32_bf16 v[84:87], v[164:167], v[116:119], 0
  buffer_load_dwordx4 v[140:143], v5, s[4:7], s94 offen offset:512 sc1
  v_mfma_f32_16x16x32_bf16 v[88:91], v[168:171], v[116:119], 0
  v_mfma_f32_16x16x32_bf16 v[92:95], v[172:175], v[116:119], 0
  buffer_load_dwordx4 v[144:147], v5, s[4:7], s94 offen offset:256 sc1
  v_mfma_f32_16x16x32_bf16 v[96:99], v[176:179], v[116:119], 0
  v_mfma_f32_16x16x32_bf16 v[100:103], v[180:183], v[116:119], 0
  buffer_load_dwordx4 v[148:151], v5, s[4:7], s94 offen offset:768 sc1
  v_mfma_f32_16x16x16_bf16 v[72:75], v[200:201], v[198:199], v[72:75]
  s_nop 1
  v_mfma_f32_16x16x16_bf16 v[76:79], v[200:201], v[196:197], v[76:79]
  s_add_u32 s94, s94, 4096
  buffer_load_dwordx4 v[152:155], v5, s[4:7], s94 offen offset:0 sc1
  v_mfma_f32_16x16x16_bf16 v[80:83], v[202:203], v[198:199], v[80:83]
  s_nop 1
  v_mfma_f32_16x16x16_bf16 v[84:87], v[202:203], v[196:197], v[84:87]
  buffer_load_dwordx4 v[156:159], v5, s[4:7], s94 offen offset:512 sc1
  v_mfma_f32_16x16x16_bf16 v[88:91], v[204:205], v[198:199], v[88:91]
  s_nop 0
  v_cvt_pk_bf16_f32 v40, v72, v73
  v_cvt_pk_bf16_f32 v41, v74, v75
  v_mfma_f32_16x16x16_bf16 v[92:95], v[204:205], v[196:197], v[92:95]
  buffer_load_dwordx4 v[160:163], v5, s[4:7], s94 offen offset:256 sc1
  v_cvt_pk_bf16_f32 v42, v76, v77
  v_cvt_pk_bf16_f32 v43, v78, v79
  v_mfma_f32_16x16x16_bf16 v[96:99], v[206:207], v[198:199], v[96:99]
  s_nop 0
  ds_write_b128 v6, v[40:43] offset:0
  v_cvt_pk_bf16_f32 v44, v80, v81
  v_mfma_f32_16x16x16_bf16 v[100:103], v[206:207], v[196:197], v[100:103]
  buffer_load_dwordx4 v[164:167], v5, s[4:7], s94 offen offset:768 sc1
  v_cvt_pk_bf16_f32 v45, v82, v83
  v_cvt_pk_bf16_f32 v46, v84, v85
  v_cvt_pk_bf16_f32 v47, v86, v87
  ds_write_b128 v6, v[44:47] offset:1024
  v_cvt_pk_bf16_f32 v48, v88, v89
  v_cvt_pk_bf16_f32 v49, v90, v91
  v_cvt_pk_bf16_f32 v50, v92, v93
  v_cvt_pk_bf16_f32 v51, v94, v95
  s_add_u32 s94, s94, 4096
  buffer_load_dwordx4 v[168:171], v5, s[4:7], s94 offen offset:0 sc1
  ds_write_b128 v6, v[48:51] offset:2048
  v_cvt_pk_bf16_f32 v52, v96, v97
  v_cvt_pk_bf16_f32 v53, v98, v99
  v_cvt_pk_bf16_f32 v54, v100, v101
  v_cvt_pk_bf16_f32 v55, v102, v103
  ds_write_b128 v6, v[52:55] offset:3072
  buffer_load_dwordx4 v[172:175], v5, s[4:7], s94 offen offset:512 sc1
  s_and_b32 s26, s65, 49152
  s_cbranch_scc1 o_wr2_152
  s_waitcnt lgkmcnt(0)
  s_barrier
  ds_read_b128 v[104:107], v3 offset:0
  ds_read_b128 v[108:111], v3 offset:512
  ds_read_b128 v[112:115], v3 offset:1024
  buffer_load_dwordx4 v[176:179], v5, s[4:7], s94 offen offset:256 sc1
  buffer_load_dwordx4 v[180:183], v5, s[4:7], s94 offen offset:768 sc1
  s_waitcnt lgkmcnt(2)
  v_mfma_f32_32x32x16_bf16 v[40:55], v[104:107], a[0:3], 0
  v_mov_b64 v[188:189], 0
  v_mov_b64 v[190:191], 0
  v_mov_b64 v[192:193], 0
  v_mov_b64 v[194:195], 0
  s_mov_b64 exec, 1
  buffer_store_dword v38, off, s[4:7], s84 sc1
  s_mov_b64 exec, -1
  s_mov_b32 s84, 268435456
  v_mfma_f32_32x32x16_bf16 v[56:71], v[104:107], a[4:7], 0
  ds_read_b128 v[116:119], v3 offset:1536
  v_mfma_f32_32x32x16_bf16 v[72:87], v[104:107], a[8:11], 0
  v_mfma_f32_32x32x16_bf16 v[88:103], v[104:107], a[12:15], 0
  s_waitcnt vmcnt(13)
  v_xor_b32 v7, s96, v120
  v_bitop3_b32 v7, v7, v124, s96 bitop3:0xf6
  v_bitop3_b32 v7, v7, v128, s96 bitop3:0xf6
  v_bitop3_b32 v7, v7, v132, s96 bitop3:0xf6
  s_waitcnt lgkmcnt(2)
  v_mfma_f32_32x32x16_bf16 v[40:55], v[108:111], a[16:19], v[40:55]
  s_waitcnt vmcnt(9)
  v_bitop3_b32 v7, v7, v136, s96 bitop3:0xf6
  v_bitop3_b32 v7, v7, v140, s96 bitop3:0xf6
  v_bitop3_b32 v7, v7, v144, s96 bitop3:0xf6
  v_bitop3_b32 v7, v7, v148, s96 bitop3:0xf6
  s_waitcnt vmcnt(5)
  v_mfma_f32_32x32x16_bf16 v[56:71], v[108:111], a[20:23], v[56:71]
  ds_read_b128 v[104:107], v3 offset:2048
  v_bitop3_b32 v7, v7, v152, s96 bitop3:0xf6
  v_bitop3_b32 v7, v7, v156, s96 bitop3:0xf6
  v_bitop3_b32 v7, v7, v160, s96 bitop3:0xf6
  v_bitop3_b32 v7, v7, v164, s96 bitop3:0xf6
  s_waitcnt vmcnt(1)
  v_mfma_f32_32x32x16_bf16 v[72:87], v[108:111], a[24:27], v[72:87]
  v_bitop3_b32 v7, v7, v168, s96 bitop3:0xf6
  v_bitop3_b32 v7, v7, v172, s96 bitop3:0xf6
  v_bitop3_b32 v7, v7, v176, s96 bitop3:0xf6
  v_bitop3_b32 v7, v7, v180, s96 bitop3:0xf6
  v_and_b32 v7, v254, v7
  v_cmp_ne_u32 vcc, 0, v7
  s_cbranch_vccnz o_rt_161
o_bk_162:
  v_mfma_f32_32x32x16_bf16 v[88:103], v[108:111], a[28:31], v[88:103]
  v_smfmac_f32_16x16x64_bf16 v[188:191], v[16:19], v[120:127], v20
  v_lshlrev_b32 v196, 16, v184
  v_smfmac_f32_16x16x64_bf16 v[192:195], v[16:19], v[128:135], v20
  v_and_b32 v197, 0xffff0000, v184
  v_smfmac_f32_16x16x64_bf16 v[188:191], v[16:19], v[136:143], v20
  v_lshlrev_b32 v198, 16, v185
  s_waitcnt lgkmcnt(2)
  v_mfma_f32_32x32x16_bf16 v[40:55], v[112:115], a[32:35], v[40:55]
  v_smfmac_f32_16x16x64_bf16 v[192:195], v[16:19], v[144:151], v20
  v_and_b32 v199, 0xffff0000, v185
  v_smfmac_f32_16x16x64_bf16 v[188:191], v[16:19], v[152:159], v20
  v_lshlrev_b32 v200, 16, v186
  v_smfmac_f32_16x16x64_bf16 v[192:195], v[16:19], v[160:167], v20
  v_and_b32 v201, 0xffff0000, v186
  v_mfma_f32_32x32x16_bf16 v[56:71], v[112:115], a[36:39], v[56:71]
  ds_read_b128 v[108:111], v3 offset:2560
  v_smfmac_f32_16x16x64_bf16 v[188:191], v[16:19], v[168:175], v20
  v_lshlrev_b32 v202, 16, v187
  v_smfmac_f32_16x16x64_bf16 v[192:195], v[16:19], v[176:183], v20
  v_and_b32 v203, 0xffff0000, v187
  s_bfe_u32 s92, s65, 131086
  v_mfma_f32_32x32x16_bf16 v[72:87], v[112:115], a[40:43], v[72:87]
  s_lshl_b32 s92, s92, 21
  s_add_u32 s92, s92, s91
  s_add_u32 s93, s92, 27262976
  s_add_u32 s92, s92, 20971520
  v_permlane16_swap_b32 v188, v192
  v_mfma_f32_32x32x16_bf16 v[88:103], v[112:115], a[44:47], v[88:103]
  v_permlane16_swap_b32 v189, v193
  v_permlane16_swap_b32 v190, v194
  v_permlane16_swap_b32 v191, v195
  s_waitcnt lgkmcnt(2)
  v_mfma_f32_32x32x16_bf16 v[40:55], v[116:119], a[48:51], v[40:55]
  v_cvt_pk_bf16_f32 v188, 0, v188
  v_cvt_pk_bf16_f32 v189, 0, v189
  v_cvt_pk_bf16_f32 v190, 0, v190
  v_cvt_pk_bf16_f32 v191, 0, v191
  v_cvt_pk_bf16_f32 v192, 0, v192
  v_cvt_pk_bf16_f32 v193, 0, v193
  v_mfma_f32_32x32x16_bf16 v[56:71], v[116:119], a[52:55], v[56:71]
  ds_read_b128 v[112:115], v3 offset:3072
  v_cvt_pk_bf16_f32 v194, 0, v194
  v_cvt_pk_bf16_f32 v195, 0, v195
  v_add_f32 v196, v196, v188
  v_add_f32 v197, v197, v189
  v_add_f32 v198, v198, v190
  v_mfma_f32_32x32x16_bf16 v[72:87], v[116:119], a[56:59], v[72:87]
  v_add_f32 v199, v199, v191
  v_add_f32 v200, v200, v192
  v_add_f32 v201, v201, v193
  v_add_f32 v202, v202, v194
  v_add_f32 v203, v203, v195
  v_cvt_pk_bf16_f32 v120, v196, v197
  v_mfma_f32_32x32x16_bf16 v[88:103], v[116:119], a[60:63], v[88:103]
  v_cvt_pk_bf16_f32 v121, v198, v199
  v_cvt_pk_bf16_f32 v122, v200, v201
  v_cvt_pk_bf16_f32 v123, v202, v203
  v_lshlrev_b32 v196, 16, v120
  v_and_b32 v197, 0xffff0000, v120
  s_waitcnt lgkmcnt(2)
  v_mfma_f32_32x32x16_bf16 v[40:55], v[104:107], a[64:67], v[40:55]
  v_lshlrev_b32 v198, 16, v121
  v_and_b32 v199, 0xffff0000, v121
  v_lshlrev_b32 v200, 16, v122
  v_and_b32 v201, 0xffff0000, v122
  v_lshlrev_b32 v202, 16, v123
  v_and_b32 v203, 0xffff0000, v123
  v_mfma_f32_32x32x16_bf16 v[56:71], v[104:107], a[68:71], v[56:71]
  ds_read_b128 v[116:119], v3 offset:3584
  buffer_store_dwordx4 v[120:123], v0, s[4:7], s92 offen sc1
  v_add_f32 v136, v196, v197
  v_mul_f32 v137, v196, v196
  v_mfma_f32_32x32x16_bf16 v[72:87], v[104:107], a[72:75], v[72:87]
  v_add_f32 v138, v198, v199
  v_mul_f32 v139, v197, v197
  v_fmac_f32 v137, v198, v198
  v_fmac_f32 v139, v199, v199
  v_add_f32 v136, v136, v200
  v_fmac_f32 v137, v200, v200
  v_mfma_f32_32x32x16_bf16 v[88:103], v[104:107], a[76:79], v[88:103]
  v_add_f32 v138, v138, v201
  v_fmac_f32 v139, v201, v201
  v_add_f32 v136, v136, v202
  v_fmac_f32 v137, v202, v202
  v_add_f32 v138, v138, v203
  s_waitcnt lgkmcnt(2)
  v_mfma_f32_32x32x16_bf16 v[40:55], v[108:111], a[80:83], v[40:55]
  v_fmac_f32 v139, v203, v203
  v_add_f32 v136, v136, v138
  v_add_f32 v137, v137, v139
  s_nop 0
  v_add_f32_dpp v136, v136, v136 row_ror:8 row_mask:0xf bank_mask:0xf
  v_add_f32_dpp v137, v137, v137 row_ror:8 row_mask:0xf bank_mask:0xf
  s_nop 0
  v_add_f32_dpp v136, v136, v136 row_ror:4 row_mask:0xf bank_mask:0xf
  v_mfma_f32_32x32x16_bf16 v[56:71], v[108:111], a[84:87], v[56:71]
  ds_read_b128 v[104:107], v3 offset:8192
  v_add_f32_dpp v137, v137, v137 row_ror:4 row_mask:0xf bank_mask:0xf
  v_add_f32_dpp v136, v136, v136 row_ror:2 row_mask:0xf bank_mask:0xf
  s_nop 0
  v_add_f32_dpp v137, v137, v137 row_ror:2 row_mask:0xf bank_mask:0xf
  v_add_f32_dpp v136, v136, v136 row_ror:1 row_mask:0xf bank_mask:0xf
  s_nop 0
  v_add_f32_dpp v137, v137, v137 row_ror:1 row_mask:0xf bank_mask:0xf
  v_mfma_f32_32x32x16_bf16 v[72:87], v[108:111], a[88:91], v[72:87]
  v_mov_b32 v140, v136
  v_mov_b32 v141, v137
  s_nop 0
  v_permlane16_swap_b32 v136, v140
  v_permlane16_swap_b32 v137, v141
  v_mfma_f32_32x32x16_bf16 v[88:103], v[108:111], a[92:95], v[88:103]
  v_add_f32 v136, v136, v140
  v_add_f32 v137, v137, v141
  v_mov_b32 v140, v136
  v_mov_b32 v141, v137
  s_nop 0
  v_permlane32_swap_b32 v136, v140
  s_waitcnt lgkmcnt(2)
  v_mfma_f32_32x32x16_bf16 v[40:55], v[112:115], a[96:99], v[40:55]
  v_permlane32_swap_b32 v137, v141
  v_add_f32 v136, v136, v140
  v_add_f32 v137, v137, v141
  v_mul_f32 v136, 0x3b000000, v136
  v_mul_f32 v137, 0x3b000000, v137
  v_mfma_f32_32x32x16_bf16 v[56:71], v[112:115], a[100:103], v[56:71]
  ds_read_b128 v[108:111], v3 offset:8704
  v_fma_f32 v137, -v136, v136, v137
  v_cvt_pk_bf16_f32 v136, 0, v136
  v_max_f32 v137, 0, v137
  v_sub_f32 v140, v196, v136
  v_sub_f32 v141, v197, v136
  v_mfma_f32_32x32x16_bf16 v[72:87], v[112:115], a[104:107], v[72:87]
  v_cvt_pk_bf16_f32 v137, 0, v137
  v_sub_f32 v142, v198, v136
  v_sub_f32 v143, v199, v136
  v_add_f32 v137, 0x3727c5ac, v137
  v_sub_f32 v144, v200, v136
  v_sub_f32 v145, v201, v136
  v_mfma_f32_32x32x16_bf16 v[88:103], v[112:115], a[108:111], v[88:103]
  v_cvt_pk_bf16_f32 v137, 0, v137
  v_sub_f32 v146, v202, v136
  v_sub_f32 v147, v203, v136
  v_sqrt_f32 v137, v137
  s_waitcnt lgkmcnt(2)
  v_mfma_f32_32x32x16_bf16 v[40:55], v[116:119], a[112:115], v[40:55]
  v_cvt_pk_bf16_f32 v140, 0, v140
  v_cvt_pk_bf16_f32 v141, 0, v141
  v_cvt_pk_bf16_f32 v137, 0, v137
  v_cvt_pk_bf16_f32 v142, 0, v142
  v_cvt_pk_bf16_f32 v143, 0, v143
  v_rcp_f32 v137, v137
  v_mfma_f32_32x32x16_bf16 v[56:71], v[116:119], a[116:119], v[56:71]
  ds_read_b128 v[112:115], v3 offset:9216
  v_cvt_pk_bf16_f32 v144, 0, v144
  v_cvt_pk_bf16_f32 v145, 0, v145
  v_cvt_pk_bf16_f32 v146, 0, v146
  v_cvt_pk_bf16_f32 v147, 0, v147
  v_mul_f32 v140, v140, v137
  v_mfma_f32_32x32x16_bf16 v[72:87], v[116:119], a[120:123], v[72:87]
  v_mul_f32 v141, v141, v137
  v_mul_f32 v142, v142, v137
  v_mul_f32 v143, v143, v137
  v_mul_f32 v144, v144, v137
  v_mul_f32 v145, v145, v137
  v_mul_f32 v146, v146, v137
  v_mfma_f32_32x32x16_bf16 v[88:103], v[116:119], a[124:127], v[88:103]
  v_mul_f32 v147, v147, v137
  v_cvt_pk_bf16_f32 v124, v140, v141
  v_cvt_pk_bf16_f32 v125, v142, v143
  v_cvt_pk_bf16_f32 v126, v144, v145
  v_cvt_pk_bf16_f32 v127, v146, v147
  s_waitcnt lgkmcnt(2)
  v_mfma_f32_32x32x16_bf16 v[40:55], v[104:107], a[128:131], v[40:55]
  v_lshlrev_b32 v204, 16, v124
  v_and_b32 v205, 0xffff0000, v124
  v_lshlrev_b32 v206, 16, v125
  v_and_b32 v207, 0xffff0000, v125
  v_lshlrev_b32 v208, 16, v126
  v_and_b32 v209, 0xffff0000, v126
  v_mfma_f32_32x32x16_bf16 v[56:71], v[104:107], a[132:135], v[56:71]
  ds_read_b128 v[116:119], v3 offset:9728
  v_lshlrev_b32 v210, 16, v127
  v_and_b32 v211, 0xffff0000, v127
  buffer_store_dwordx4 v[124:127], v0, s[4:7], s93 offen sc1
  v_mfma_f32_32x32x16_bf16 v[72:87], v[104:107], a[136:139], v[72:87]
  v_add_f32 v196, v196, v204
  v_add_f32 v197, v197, v205
  v_add_f32 v198, v198, v206
  v_add_f32 v199, v199, v207
  v_add_f32 v200, v200, v208
  v_add_f32 v201, v201, v209
  v_mfma_f32_32x32x16_bf16 v[88:103], v[104:107], a[140:143], v[88:103]
  v_add_f32 v202, v202, v210
  v_add_f32 v203, v203, v211
  v_cvt_pk_bf16_f32 v128, v196, v197
  v_cvt_pk_bf16_f32 v129, v198, v199
  v_cvt_pk_bf16_f32 v130, v200, v201
  s_waitcnt lgkmcnt(2)
  v_mfma_f32_32x32x16_bf16 v[40:55], v[108:111], a[144:147], v[40:55]
  v_cvt_pk_bf16_f32 v131, v202, v203
  v_mul_f32 v188, v204, v8
  v_mul_f32 v189, v205, v9
  v_fmac_f32 v188, v206, v10
  v_fmac_f32 v189, v207, v11
  v_fmac_f32 v188, v208, v12
  v_mfma_f32_32x32x16_bf16 v[56:71], v[108:111], a[148:151], v[56:71]
  ds_read_b128 v[104:107], v3 offset:10240
  v_fmac_f32 v189, v209, v13
  v_fmac_f32 v188, v210, v14
  v_fmac_f32 v189, v211, v15
  v_add_f32 v188, v188, v189
  s_add_u32 s92, s91, 10485760
  v_mfma_f32_32x32x16_bf16 v[72:87], v[108:111], a[152:155], v[72:87]
  s_add_u32 s93, s91, 8388608
  buffer_store_dwordx4 v[128:131], v0, s[4:7], s92 offen sc1
  v_lshlrev_b32 v196, 16, v128
  v_and_b32 v197, 0xffff0000, v128
  v_mfma_f32_32x32x16_bf16 v[88:103], v[108:111], a[156:159], v[88:103]
  v_lshlrev_b32 v198, 16, v129
  v_and_b32 v199, 0xffff0000, v129
  v_lshlrev_b32 v200, 16, v130
  v_and_b32 v201, 0xffff0000, v130
  v_lshlrev_b32 v202, 16, v131
  s_waitcnt lgkmcnt(2)
  v_mfma_f32_32x32x16_bf16 v[40:55], v[112:115], a[160:163], v[40:55]
  v_and_b32 v203, 0xffff0000, v131
  v_add_f32 v136, v196, v197
  v_mul_f32 v137, v196, v196
  v_add_f32 v138, v198, v199
  v_mul_f32 v139, v197, v197
  v_fmac_f32 v137, v198, v198
  v_mfma_f32_32x32x16_bf16 v[56:71], v[112:115], a[164:167], v[56:71]
  ds_read_b128 v[108:111], v3 offset:10752
  v_fmac_f32 v139, v199, v199
  v_add_f32 v136, v136, v200
  v_fmac_f32 v137, v200, v200
  v_add_f32 v138, v138, v201
  v_fmac_f32 v139, v201, v201
  v_mfma_f32_32x32x16_bf16 v[72:87], v[112:115], a[168:171], v[72:87]
  v_add_f32 v136, v136, v202
  v_fmac_f32 v137, v202, v202
  v_add_f32 v138, v138, v203
  v_fmac_f32 v139, v203, v203
  v_add_f32 v136, v136, v138
  v_add_f32 v137, v137, v139
  v_mfma_f32_32x32x16_bf16 v[88:103], v[112:115], a[172:175], v[88:103]
  v_add_f32_dpp v136, v136, v136 row_ror:8 row_mask:0xf bank_mask:0xf
  v_add_f32_dpp v137, v137, v137 row_ror:8 row_mask:0xf bank_mask:0xf
  v_add_f32_dpp v188, v188, v188 row_ror:8 row_mask:0xf bank_mask:0xf
  v_add_f32_dpp v136, v136, v136 row_ror:4 row_mask:0xf bank_mask:0xf
  v_add_f32_dpp v137, v137, v137 row_ror:4 row_mask:0xf bank_mask:0xf
  s_waitcnt lgkmcnt(2)
  v_mfma_f32_32x32x16_bf16 v[40:55], v[116:119], a[176:179], v[40:55]
  v_add_f32_dpp v188, v188, v188 row_ror:4 row_mask:0xf bank_mask:0xf
  v_add_f32_dpp v136, v136, v136 row_ror:2 row_mask:0xf bank_mask:0xf
  v_add_f32_dpp v137, v137, v137 row_ror:2 row_mask:0xf bank_mask:0xf
  v_add_f32_dpp v188, v188, v188 row_ror:2 row_mask:0xf bank_mask:0xf
  v_add_f32_dpp v136, v136, v136 row_ror:1 row_mask:0xf bank_mask:0xf
  v_add_f32_dpp v137, v137, v137 row_ror:1 row_mask:0xf bank_mask:0xf
  v_mfma_f32_32x32x16_bf16 v[56:71], v[116:119], a[180:183], v[56:71]
  ds_read_b128 v[112:115], v3 offset:11264
  v_add_f32_dpp v188, v188, v188 row_ror:1 row_mask:0xf bank_mask:0xf
  v_mov_b32 v140, v136
  v_mov_b32 v141, v137
  v_mov_b32 v142, v188
  v_permlane16_swap_b32 v136, v140
  v_mfma_f32_32x32x16_bf16 v[72:87], v[116:119], a[184:187], v[72:87]
  v_permlane16_swap_b32 v137, v141
  v_permlane16_swap_b32 v188, v142
  v_add_f32 v136, v136, v140
  v_add_f32 v137, v137, v141
  v_mfma_f32_32x32x16_bf16 v[88:103], v[116:119], a[188:191], v[88:103]
  v_add_f32 v188, v188, v142
  v_mov_b32 v140, v136
  v_mov_b32 v141, v137
  v_mov_b32 v142, v188
  v_permlane32_swap_b32 v136, v140
  s_waitcnt lgkmcnt(2)
  v_mfma_f32_32x32x16_bf16 v[40:55], v[104:107], a[192:195], v[40:55]
  v_permlane32_swap_b32 v137, v141
  v_permlane32_swap_b32 v188, v142
  v_add_f32 v136, v136, v140
  v_add_f32 v137, v137, v141
  v_mfma_f32_32x32x16_bf16 v[56:71], v[104:107], a[196:199], v[56:71]
  ds_read_b128 v[116:119], v3 offset:11776
  v_add_f32 v188, v188, v142
  v_mul_f32 v136, 0x3b000000, v136
  v_mul_f32 v137, 0x3b000000, v137
  v_fma_f32 v137, -v136, v136, v137
  v_cvt_pk_bf16_f32 v136, 0, v136
  s_waitcnt lgkmcnt(2)
  v_mfma_f32_32x32x16_bf16 v[40:55], v[108:111], a[208:211], v[40:55]
  v_max_f32 v137, 0, v137
  v_sub_f32 v140, v196, v136
  v_sub_f32 v141, v197, v136
  v_cvt_pk_bf16_f32 v137, 0, v137
  v_sub_f32 v142, v198, v136
  v_sub_f32 v143, v199, v136
  v_mfma_f32_32x32x16_bf16 v[56:71], v[108:111], a[212:215], v[56:71]
  v_add_f32 v137, 0x3727c5ac, v137
  v_sub_f32 v144, v200, v136
  v_sub_f32 v145, v201, v136
  v_cvt_pk_bf16_f32 v137, 0, v137
  v_sub_f32 v146, v202, v136
  v_sub_f32 v147, v203, v136
  s_waitcnt lgkmcnt(1)
  v_mfma_f32_32x32x16_bf16 v[40:55], v[112:115], a[224:227], v[40:55]
  v_sqrt_f32 v137, v137
  v_cvt_pk_bf16_f32 v140, 0, v140
  v_cvt_pk_bf16_f32 v141, 0, v141
  v_cvt_pk_bf16_f32 v137, 0, v137
  v_cvt_pk_bf16_f32 v142, 0, v142
  v_mfma_f32_32x32x16_bf16 v[56:71], v[112:115], a[228:231], v[56:71]
  v_cvt_pk_bf16_f32 v143, 0, v143
  v_rcp_f32 v137, v137
  v_cvt_pk_bf16_f32 v144, 0, v144
  v_cvt_pk_bf16_f32 v145, 0, v145
  v_cvt_pk_bf16_f32 v146, 0, v146
  s_waitcnt lgkmcnt(0)
  v_mfma_f32_32x32x16_bf16 v[40:55], v[116:119], a[240:243], v[40:55]
  v_cvt_pk_bf16_f32 v147, 0, v147
  v_mul_f32 v140, v140, v137
  v_mul_f32 v141, v141, v137
  v_mul_f32 v142, v142, v137
  v_mul_f32 v143, v143, v137
  v_mul_f32 v144, v144, v137
  v_mfma_f32_32x32x16_bf16 v[56:71], v[116:119], a[244:247], v[56:71]
  v_mul_f32 v145, v145, v137
  v_mul_f32 v146, v146, v137
  v_mul_f32 v147, v147, v137
  v_cvt_pk_bf16_f32 v132, v140, v141
  v_cvt_pk_bf16_f32 v133, v142, v143
  v_cvt_pk_bf16_f32 v134, v144, v145
  v_mfma_f32_32x32x16_bf16 v[72:87], v[104:107], a[200:203], v[72:87]
  v_cvt_pk_bf16_f32 v135, v146, v147
  buffer_store_dwordx4 v[132:135], v0, s[4:7], s93 offen sc1
  v_cvt_pk_bf16_f32 v188, 0, v188
  v_ashrrev_i32 v189, 31, v188
  v_mfma_f32_32x32x16_bf16 v[88:103], v[104:107], a[204:207], v[88:103]
  v_or_b32 v189, 0x80000000, v189
  v_xor_b32 v188, v188, v189
  s_sub_u32 s92, 4095, s90
  v_and_b32 v188, 0xffff0000, v188
  v_or_b32 v38, s92, v188
  v_mfma_f32_32x32x16_bf16 v[72:87], v[108:111], a[216:219], v[72:87]
  s_bfe_u32 s92, s65, 196625
  s_lshl_b32 s92, s92, 18
  s_lshl_b32 s93, s90, 7
  s_add_u32 s92, s92, s93
  s_add_u32 s84, s92, 243269632
  v_cvt_pk_bf16_f32 v212, v40, v56
  v_mfma_f32_32x32x16_bf16 v[88:103], v[108:111], a[220:223], v[88:103]
  v_cvt_pk_bf16_f32 v214, v41, v57
  v_cvt_pk_bf16_f32 v216, v42, v58
  v_cvt_pk_bf16_f32 v218, v43, v59
  v_permlane16_swap_b32 v212, v214
  v_mfma_f32_32x32x16_bf16 v[72:87], v[112:115], a[232:235], v[72:87]
  v_cvt_pk_bf16_f32 v220, v44, v60
  v_cvt_pk_bf16_f32 v222, v45, v61
  v_permlane16_swap_b32 v216, v218
  v_bfi_b32 v212, v254, s42, v212
  v_cvt_pk_bf16_f32 v224, v46, v62
  v_mfma_f32_32x32x16_bf16 v[88:103], v[112:115], a[236:239], v[88:103]
  v_cvt_pk_bf16_f32 v226, v47, v63
  v_permlane16_swap_b32 v220, v222
  v_bfi_b32 v216, v254, s42, v216
  v_cvt_pk_bf16_f32 v228, v48, v64
  v_mfma_f32_32x32x16_bf16 v[72:87], v[116:119], a[248:251], v[72:87]
  v_cvt_pk_bf16_f32 v230, v49, v65
  v_permlane16_swap_b32 v224, v226
  v_bfi_b32 v220, v254, s42, v220
  v_cvt_pk_bf16_f32 v232, v50, v66
  v_cvt_pk_bf16_f32 v234, v51, v67
  v_mfma_f32_32x32x16_bf16 v[88:103], v[116:119], a[252:255], v[88:103]
  v_permlane16_swap_b32 v228, v230
  v_bfi_b32 v224, v254, s42, v224
  v_cvt_pk_bf16_f32 v236, v52, v68
  v_cvt_pk_bf16_f32 v238, v53, v69
  v_permlane16_swap_b32 v232, v234
  v_bfi_b32 v228, v254, s42, v228
  v_cvt_pk_bf16_f32 v240, v54, v70
  v_cvt_pk_bf16_f32 v242, v55, v71
  v_permlane16_swap_b32 v236, v238
  v_bfi_b32 v232, v254, s42, v232
  v_permlane16_swap_b32 v240, v242
  v_bfi_b32 v236, v254, s42, v236
  v_bfi_b32 v240, v254, s42, v240
  v_cvt_pk_bf16_f32 v213, v72, v88
  v_cvt_pk_bf16_f32 v215, v73, v89
  v_cvt_pk_bf16_f32 v217, v74, v90
  v_cvt_pk_bf16_f32 v219, v75, v91
  s_add_u32 s78, s86, 0
  v_permlane16_swap_b32 v213, v215
  buffer_store_dwordx4 v[212:215], v4, s[4:7], s78 offen
  v_cvt_pk_bf16_f32 v221, v76, v92
  v_cvt_pk_bf16_f32 v223, v77, v93
  s_add_u32 s78, s86, 32768
  v_permlane16_swap_b32 v217, v219
  buffer_store_dwordx4 v[216:219], v4, s[4:7], s78 offen
  v_cvt_pk_bf16_f32 v225, v78, v94
  v_cvt_pk_bf16_f32 v227, v79, v95
  s_add_u32 s78, s86, 131072
  v_permlane16_swap_b32 v221, v223
  buffer_store_dwordx4 v[220:223], v4, s[4:7], s78 offen
  v_cvt_pk_bf16_f32 v229, v80, v96
  v_cvt_pk_bf16_f32 v231, v81, v97
  s_add_u32 s78, s86, 163840
  v_permlane16_swap_b32 v225, v227
  buffer_store_dwordx4 v[224:227], v4, s[4:7], s78 offen
  v_cvt_pk_bf16_f32 v233, v82, v98
  v_cvt_pk_bf16_f32 v235, v83, v99
  s_add_u32 s78, s86, 262144
  v_permlane16_swap_b32 v229, v231
  buffer_store_dwordx4 v[228:231], v4, s[4:7], s78 offen
  v_cvt_pk_bf16_f32 v237, v84, v100
  v_cvt_pk_bf16_f32 v239, v85, v101
  s_add_u32 s78, s86, 294912
  v_permlane16_swap_b32 v233, v235
  buffer_store_dwordx4 v[232:235], v4, s[4:7], s78 offen
  v_cvt_pk_bf16_f32 v241, v86, v102
  v_cvt_pk_bf16_f32 v243, v87, v103
  s_add_u32 s78, s86, 393216
  v_permlane16_swap_b32 v237, v239
  buffer_store_dwordx4 v[236:239], v4, s[4:7], s78 offen
  s_add_u32 s78, s86, 425984
  v_permlane16_swap_b32 v241, v243
  buffer_store_dwordx4 v[240:243], v4, s[4:7], s78 offen
  s_waitcnt vmcnt(8)
  s_mov_b64 exec, 1
  buffer_store_dword v38, off, s[4:7], s84 sc1
  s_mov_b64 exec, -1
  s_mov_b32 s84, 268435456
  s_branch o_we_153
o_rt_161:
  s_mov_b32 s67, 0
o_rl_165:
  s_lshl_b32 s94, s43, 14
  s_add_u32 s94, s94, s95
  buffer_load_dwordx4 v[120:123], v5, s[4:7], s94 offen offset:0 sc1
  buffer_load_dwordx4 v[124:127], v5, s[4:7], s94 offen offset:512 sc1
  buffer_load_dwordx4 v[128:131], v5, s[4:7], s94 offen offset:256 sc1
  buffer_load_dwordx4 v[132:135], v5, s[4:7], s94 offen offset:768 sc1
  s_add_u32 s94, s94, 4096
  buffer_load_dwordx4 v[136:139], v5, s[4:7], s94 offen offset:0 sc1
  buffer_load_dwordx4 v[140:143], v5, s[4:7], s94 offen offset:512 sc1
  buffer_load_dwordx4 v[144:147], v5, s[4:7], s94 offen offset:256 sc1
  buffer_load_dwordx4 v[148:151], v5, s[4:7], s94 offen offset:768 sc1
  s_add_u32 s94, s94, 4096
  buffer_load_dwordx4 v[152:155], v5, s[4:7], s94 offen offset:0 sc1
  buffer_load_dwordx4 v[156:159], v5, s[4:7], s94 offen offset:512 sc1
  buffer_load_dwordx4 v[160:163], v5, s[4:7], s94 offen offset:256 sc1
  buffer_load_dwordx4 v[164:167], v5, s[4:7], s94 offen offset:768 sc1
  s_add_u32 s94, s94, 4096
  buffer_load_dwordx4 v[168:171], v5, s[4:7], s94 offen offset:0 sc1
  buffer_load_dwordx4 v[172:175], v5, s[4:7], s94 offen offset:512 sc1
  buffer_load_dwordx4 v[176:179], v5, s[4:7], s94 offen offset:256 sc1
  buffer_load_dwordx4 v[180:183], v5, s[4:7], s94 offen offset:768 sc1
  s_add_u32 s67, s67, 1
  s_cmp_gt_u32 s67, 1048576
  s_cbranch_scc1 L_end
  s_waitcnt vmcnt(0)
  v_xor_b32 v7, s96, v120
  v_bitop3_b32 v7, v7, v124, s96 bitop3:0xf6
  v_bitop3_b32 v7, v7, v128, s96 bitop3:0xf6
  v_bitop3_b32 v7, v7, v132, s96 bitop3:0xf6
  v_bitop3_b32 v7, v7, v136, s96 bitop3:0xf6
  v_bitop3_b32 v7, v7, v140, s96 bitop3:0xf6
  v_bitop3_b32 v7, v7, v144, s96 bitop3:0xf6
  v_bitop3_b32 v7, v7, v148, s96 bitop3:0xf6
  v_bitop3_b32 v7, v7, v152, s96 bitop3:0xf6
  v_bitop3_b32 v7, v7, v156, s96 bitop3:0xf6
  v_bitop3_b32 v7, v7, v160, s96 bitop3:0xf6
  v_bitop3_b32 v7, v7, v164, s96 bitop3:0xf6
  v_bitop3_b32 v7, v7, v168, s96 bitop3:0xf6
  v_bitop3_b32 v7, v7, v172, s96 bitop3:0xf6
  v_bitop3_b32 v7, v7, v176, s96 bitop3:0xf6
  v_bitop3_b32 v7, v7, v180, s96 bitop3:0xf6
  v_and_b32 v7, v254, v7
  v_cmp_ne_u32 vcc, 0, v7
  s_cbranch_vccnz o_rl_165
  s_branch o_bk_162
o_rt_163:
  s_mov_b32 s67, 0
o_rl_166:
  s_lshl_b32 s94, s43, 14
  s_add_u32 s94, s94, s95
  buffer_load_dwordx4 v[120:123], v5, s[4:7], s94 offen offset:0 sc1
  buffer_load_dwordx4 v[124:127], v5, s[4:7], s94 offen offset:512 sc1
  buffer_load_dwordx4 v[128:131], v5, s[4:7], s94 offen offset:256 sc1
  buffer_load_dwordx4 v[132:135], v5, s[4:7], s94 offen offset:768 sc1
  s_add_u32 s94, s94, 4096
  buffer_load_dwordx4 v[136:139], v5, s[4:7], s94 offen offset:0 sc1
  buffer_load_dwordx4 v[140:143], v5, s[4:7], s94 offen offset:512 sc1
  buffer_load_dwordx4 v[144:147], v5, s[4:7], s94 offen offset:256 sc1
  buffer_load_dwordx4 v[148:151], v5, s[4:7], s94 offen offset:768 sc1
  s_add_u32 s94, s94, 4096
  buffer_load_dwordx4 v[152:155], v5, s[4:7], s94 offen offset:0 sc1
  buffer_load_dwordx4 v[156:159], v5, s[4:7], s94 offen offset:512 sc1
  buffer_load_dwordx4 v[160:163], v5, s[4:7], s94 offen offset:256 sc1
  buffer_load_dwordx4 v[164:167], v5, s[4:7], s94 offen offset:768 sc1
  s_add_u32 s94, s94, 4096
  buffer_load_dwordx4 v[168:171], v5, s[4:7], s94 offen offset:0 sc1
  buffer_load_dwordx4 v[172:175], v5, s[4:7], s94 offen offset:512 sc1
  buffer_load_dwordx4 v[176:179], v5, s[4:7], s94 offen offset:256 sc1
  buffer_load_dwordx4 v[180:183], v5, s[4:7], s94 offen offset:768 sc1
  s_add_u32 s67, s67, 1
  s_cmp_gt_u32 s67, 1048576
  s_cbranch_scc1 L_end
  s_waitcnt vmcnt(0)
  v_xor_b32 v7, s96, v120
  v_bitop3_b32 v7, v7, v124, s96 bitop3:0xf6
  v_bitop3_b32 v7, v7, v128, s96 bitop3:0xf6
  v_bitop3_b32 v7, v7, v132, s96 bitop3:0xf6
  v_bitop3_b32 v7, v7, v136, s96 bitop3:0xf6
  v_bitop3_b32 v7, v7, v140, s96 bitop3:0xf6
  v_bitop3_b32 v7, v7, v144, s96 bitop3:0xf6
  v_bitop3_b32 v7, v7, v148, s96 bitop3:0xf6
  v_bitop3_b32 v7, v7, v152, s96 bitop3:0xf6
  v_bitop3_b32 v7, v7, v156, s96 bitop3:0xf6
  v_bitop3_b32 v7, v7, v160, s96 bitop3:0xf6
  v_bitop3_b32 v7, v7, v164, s96 bitop3:0xf6
  v_bitop3_b32 v7, v7, v168, s96 bitop3:0xf6
  v_bitop3_b32 v7, v7, v172, s96 bitop3:0xf6
  v_bitop3_b32 v7, v7, v176, s96 bitop3:0xf6
  v_bitop3_b32 v7, v7, v180, s96 bitop3:0xf6
  v_and_b32 v7, v254, v7
  v_cmp_ne_u32 vcc, 0, v7
  s_cbranch_vccnz o_rl_166
  s_branch o_bk_164
o_fb_155:
  v_mov_b32 v118, v116
  s_nop 1
  v_permlane16_swap_b32 v116, v118
  v_max_f32 v116, v116, v118
  v_mov_b32 v118, v116
  s_nop 0
  s_nop 0
  v_permlane32_swap_b32 v116, v118
  v_max_f32 v116, v116, v118
  v_sub_f32 v56, v104, v116
  v_sub_f32 v57, v105, v116
  v_sub_f32 v58, v106, v116
  v_sub_f32 v59, v107, v116
  v_sub_f32 v60, v108, v116
  v_sub_f32 v61, v109, v116
  v_sub_f32 v62, v110, v116
  v_sub_f32 v63, v111, v116
  v_sub_f32 v64, v112, v116
  v_sub_f32 v65, v113, v116
  v_exp_f32 v56, v56
  v_exp_f32 v57, v57
  v_exp_f32 v58, v58
  v_exp_f32 v59, v59
  v_exp_f32 v60, v60
  v_exp_f32 v61, v61
  v_exp_f32 v62, v62
  v_exp_f32 v63, v63
  v_exp_f32 v64, v64
  v_exp_f32 v65, v65
  v_add_f32 v117, v56, v57
  v_add_f32 v117, v117, v58
  v_add_f32 v117, v117, v59
  v_add_f32 v117, v117, v60
  v_add_f32 v117, v117, v61
  v_add_f32 v117, v117, v62
  v_add_f32 v117, v117, v63
  v_add_f32 v117, v117, v64
  v_add_f32 v117, v117, v65
  v_mov_b32 v118, v117
  s_nop 0
  s_nop 0
  v_permlane16_swap_b32 v117, v118
  v_add_f32 v117, v117, v118
  v_mov_b32 v118, v117
  s_nop 0
  s_nop 0
  v_permlane32_swap_b32 v117, v118
  v_add_f32 v117, v117, v118
  v_rcp_f32 v117, v117
  s_branch o_fbr_156
o_fb_157:
  v_mov_b32 v118, v116
  s_nop 1
  v_permlane16_swap_b32 v116, v118
  v_max_f32 v116, v116, v118
  v_mov_b32 v118, v116
  s_nop 0
  s_nop 0
  v_permlane32_swap_b32 v116, v118
  v_max_f32 v116, v116, v118
  v_sub_f32 v56, v104, v116
  v_sub_f32 v57, v105, v116
  v_sub_f32 v58, v106, v116
  v_sub_f32 v59, v107, v116
  v_sub_f32 v60, v108, v116
  v_sub_f32 v61, v109, v116
  v_sub_f32 v62, v110, v116
  v_sub_f32 v63, v111, v116
  v_sub_f32 v64, v112, v116
  v_sub_f32 v65, v113, v116
  v_exp_f32 v56, v56
  v_exp_f32 v57, v57
  v_exp_f32 v58, v58
  v_exp_f32 v59, v59
  v_exp_f32 v60, v60
  v_exp_f32 v61, v61
  v_exp_f32 v62, v62
  v_exp_f32 v63, v63
  v_exp_f32 v64, v64
  v_exp_f32 v65, v65
  v_add_f32 v117, v56, v57
  v_add_f32 v117, v117, v58
  v_add_f32 v117, v117, v59
  v_add_f32 v117, v117, v60
  v_add_f32 v117, v117, v61
  v_add_f32 v117, v117, v62
  v_add_f32 v117, v117, v63
  v_add_f32 v117, v117, v64
  v_add_f32 v117, v117, v65
  v_mov_b32 v118, v117
  s_nop 0
  s_nop 0
  v_permlane16_swap_b32 v117, v118
  v_add_f32 v117, v117, v118
  v_mov_b32 v118, v117
  s_nop 0
  s_nop 0
  v_permlane32_swap_b32 v117, v118
  v_add_f32 v117, v117, v118
  v_rcp_f32 v117, v117
  s_branch o_fbr_158
o_wr2_152:
  s_waitcnt lgkmcnt(0)
  s_barrier
  ds_read_b128 v[104:107], v3 offset:0
  ds_read_b128 v[108:111], v3 offset:512
  ds_read_b128 v[112:115], v3 offset:1024
  buffer_load_dwordx4 v[176:179], v5, s[4:7], s94 offen offset:256 sc1
  buffer_load_dwordx4 v[180:183], v5, s[4:7], s94 offen offset:768 sc1
  s_waitcnt lgkmcnt(2)
  v_mfma_f32_32x32x16_bf16 v[40:55], v[104:107], a[0:3], 0
  v_mov_b64 v[188:189], 0
  v_mov_b64 v[190:191], 0
  v_mov_b64 v[192:193], 0
  v_mov_b64 v[194:195], 0
  s_mov_b64 exec, 1
  buffer_store_dword v38, off, s[4:7], s84 sc1
  s_mov_b64 exec, -1
  s_mov_b32 s84, 268435456
  v_mfma_f32_32x32x16_bf16 v[56:71], v[104:107], a[4:7], 0
  ds_read_b128 v[116:119], v3 offset:1536
  v_mfma_f32_32x32x16_bf16 v[72:87], v[104:107], a[8:11], 0
  v_mfma_f32_32x32x16_bf16 v[88:103], v[104:107], a[12:15], 0
  s_waitcnt vmcnt(13)
  v_xor_b32 v7, s96, v120
  v_bitop3_b32 v7, v7, v124, s96 bitop3:0xf6
  v_bitop3_b32 v7, v7, v128, s96 bitop3:0xf6
  v_bitop3_b32 v7, v7, v132, s96 bitop3:0xf6
  s_waitcnt lgkmcnt(2)
  v_mfma_f32_32x32x16_bf16 v[40:55], v[108:111], a[16:19], v[40:55]
  s_waitcnt vmcnt(9)
  v_bitop3_b32 v7, v7, v136, s96 bitop3:0xf6
  v_bitop3_b32 v7, v7, v140, s96 bitop3:0xf6
  v_bitop3_b32 v7, v7, v144, s96 bitop3:0xf6
  v_bitop3_b32 v7, v7, v148, s96 bitop3:0xf6
  s_waitcnt vmcnt(5)
  v_mfma_f32_32x32x16_bf16 v[56:71], v[108:111], a[20:23], v[56:71]
  ds_read_b128 v[104:107], v3 offset:2048
  v_bitop3_b32 v7, v7, v152, s96 bitop3:0xf6
  v_bitop3_b32 v7, v7, v156, s96 bitop3:0xf6
  v_bitop3_b32 v7, v7, v160, s96 bitop3:0xf6
  v_bitop3_b32 v7, v7, v164, s96 bitop3:0xf6
  s_waitcnt vmcnt(1)
  v_mfma_f32_32x32x16_bf16 v[72:87], v[108:111], a[24:27], v[72:87]
  v_bitop3_b32 v7, v7, v168, s96 bitop3:0xf6
  v_bitop3_b32 v7, v7, v172, s96 bitop3:0xf6
  v_bitop3_b32 v7, v7, v176, s96 bitop3:0xf6
  v_bitop3_b32 v7, v7, v180, s96 bitop3:0xf6
  v_and_b32 v7, v254, v7
  v_cmp_ne_u32 vcc, 0, v7
  s_cbranch_vccnz o_rt_163
o_bk_164:
  v_mfma_f32_32x32x16_bf16 v[88:103], v[108:111], a[28:31], v[88:103]
  v_smfmac_f32_16x16x64_bf16 v[188:191], v[16:19], v[120:127], v20
  v_lshlrev_b32 v196, 16, v184
  v_smfmac_f32_16x16x64_bf16 v[192:195], v[16:19], v[128:135], v20
  v_and_b32 v197, 0xffff0000, v184
  v_smfmac_f32_16x16x64_bf16 v[188:191], v[16:19], v[136:143], v20
  v_lshlrev_b32 v198, 16, v185
  s_waitcnt lgkmcnt(2)
  v_mfma_f32_32x32x16_bf16 v[40:55], v[112:115], a[32:35], v[40:55]
  v_smfmac_f32_16x16x64_bf16 v[192:195], v[16:19], v[144:151], v20
  v_and_b32 v199, 0xffff0000, v185
  v_smfmac_f32_16x16x64_bf16 v[188:191], v[16:19], v[152:159], v20
  v_lshlrev_b32 v200, 16, v186
  v_smfmac_f32_16x16x64_bf16 v[192:195], v[16:19], v[160:167], v20
  v_and_b32 v201, 0xffff0000, v186
  v_mfma_f32_32x32x16_bf16 v[56:71], v[112:115], a[36:39], v[56:71]
  ds_read_b128 v[108:111], v3 offset:2560
  v_smfmac_f32_16x16x64_bf16 v[188:191], v[16:19], v[168:175], v20
  v_lshlrev_b32 v202, 16, v187
  v_smfmac_f32_16x16x64_bf16 v[192:195], v[16:19], v[176:183], v20
  v_and_b32 v203, 0xffff0000, v187
  s_bfe_u32 s92, s65, 131086
  v_mfma_f32_32x32x16_bf16 v[72:87], v[112:115], a[40:43], v[72:87]
  s_lshl_b32 s92, s92, 21
  s_add_u32 s92, s92, s91
  s_add_u32 s93, s92, 27262976
  s_add_u32 s92, s92, 20971520
  v_permlane16_swap_b32 v188, v192
  v_mfma_f32_32x32x16_bf16 v[88:103], v[112:115], a[44:47], v[88:103]
  v_permlane16_swap_b32 v189, v193
  v_permlane16_swap_b32 v190, v194
  v_permlane16_swap_b32 v191, v195
  s_waitcnt lgkmcnt(2)
  v_mfma_f32_32x32x16_bf16 v[40:55], v[116:119], a[48:51], v[40:55]
  v_cvt_pk_bf16_f32 v188, 0, v188
  v_cvt_pk_bf16_f32 v189, 0, v189
  v_cvt_pk_bf16_f32 v190, 0, v190
  v_cvt_pk_bf16_f32 v191, 0, v191
  v_cvt_pk_bf16_f32 v192, 0, v192
  v_cvt_pk_bf16_f32 v193, 0, v193
  v_mfma_f32_32x32x16_bf16 v[56:71], v[116:119], a[52:55], v[56:71]
  ds_read_b128 v[112:115], v3 offset:3072
  v_cvt_pk_bf16_f32 v194, 0, v194
  v_cvt_pk_bf16_f32 v195, 0, v195
  v_add_f32 v196, v196, v188
  v_add_f32 v197, v197, v189
  v_add_f32 v198, v198, v190
  v_mfma_f32_32x32x16_bf16 v[72:87], v[116:119], a[56:59], v[72:87]
  v_add_f32 v199, v199, v191
  v_add_f32 v200, v200, v192
  v_add_f32 v201, v201, v193
  v_add_f32 v202, v202, v194
  v_add_f32 v203, v203, v195
  v_cvt_pk_bf16_f32 v120, v196, v197
  v_mfma_f32_32x32x16_bf16 v[88:103], v[116:119], a[60:63], v[88:103]
  v_cvt_pk_bf16_f32 v121, v198, v199
  v_cvt_pk_bf16_f32 v122, v200, v201
  v_cvt_pk_bf16_f32 v123, v202, v203
  v_lshlrev_b32 v196, 16, v120
  v_and_b32 v197, 0xffff0000, v120
  s_waitcnt lgkmcnt(2)
  v_mfma_f32_32x32x16_bf16 v[40:55], v[104:107], a[64:67], v[40:55]
  v_lshlrev_b32 v198, 16, v121
  v_and_b32 v199, 0xffff0000, v121
  v_lshlrev_b32 v200, 16, v122
  v_and_b32 v201, 0xffff0000, v122
  v_lshlrev_b32 v202, 16, v123
  v_and_b32 v203, 0xffff0000, v123
  v_mfma_f32_32x32x16_bf16 v[56:71], v[104:107], a[68:71], v[56:71]
  ds_read_b128 v[116:119], v3 offset:3584
  buffer_store_dwordx4 v[120:123], v0, s[4:7], s92 offen sc1
  v_add_f32 v136, v196, v197
  v_mul_f32 v137, v196, v196
  v_mfma_f32_32x32x16_bf16 v[72:87], v[104:107], a[72:75], v[72:87]
  v_add_f32 v138, v198, v199
  v_mul_f32 v139, v197, v197
  v_fmac_f32 v137, v198, v198
  v_fmac_f32 v139, v199, v199
  v_add_f32 v136, v136, v200
  v_fmac_f32 v137, v200, v200
  v_mfma_f32_32x32x16_bf16 v[88:103], v[104:107], a[76:79], v[88:103]
  v_add_f32 v138, v138, v201
  v_fmac_f32 v139, v201, v201
  v_add_f32 v136, v136, v202
  v_fmac_f32 v137, v202, v202
  v_add_f32 v138, v138, v203
  s_waitcnt lgkmcnt(2)
  v_mfma_f32_32x32x16_bf16 v[40:55], v[108:111], a[80:83], v[40:55]
  v_fmac_f32 v139, v203, v203
  v_add_f32 v136, v136, v138
  v_add_f32 v137, v137, v139
  s_nop 0
  v_add_f32_dpp v136, v136, v136 row_ror:8 row_mask:0xf bank_mask:0xf
  v_add_f32_dpp v137, v137, v137 row_ror:8 row_mask:0xf bank_mask:0xf
  s_nop 0
  v_add_f32_dpp v136, v136, v136 row_ror:4 row_mask:0xf bank_mask:0xf
  v_mfma_f32_32x32x16_bf16 v[56:71], v[108:111], a[84:87], v[56:71]
  ds_read_b128 v[104:107], v3 offset:8192
  v_add_f32_dpp v137, v137, v137 row_ror:4 row_mask:0xf bank_mask:0xf
  v_add_f32_dpp v136, v136, v136 row_ror:2 row_mask:0xf bank_mask:0xf
  s_nop 0
  v_add_f32_dpp v137, v137, v137 row_ror:2 row_mask:0xf bank_mask:0xf
  v_add_f32_dpp v136, v136, v136 row_ror:1 row_mask:0xf bank_mask:0xf
  s_nop 0
  v_add_f32_dpp v137, v137, v137 row_ror:1 row_mask:0xf bank_mask:0xf
  v_mfma_f32_32x32x16_bf16 v[72:87], v[108:111], a[88:91], v[72:87]
  v_mov_b32 v140, v136
  v_mov_b32 v141, v137
  s_nop 0
  v_permlane16_swap_b32 v136, v140
  v_permlane16_swap_b32 v137, v141
  v_mfma_f32_32x32x16_bf16 v[88:103], v[108:111], a[92:95], v[88:103]
  v_add_f32 v136, v136, v140
  v_add_f32 v137, v137, v141
  v_mov_b32 v140, v136
  v_mov_b32 v141, v137
  s_nop 0
  v_permlane32_swap_b32 v136, v140
  s_waitcnt lgkmcnt(2)
  v_mfma_f32_32x32x16_bf16 v[40:55], v[112:115], a[96:99], v[40:55]
  v_permlane32_swap_b32 v137, v141
  v_add_f32 v136, v136, v140
  v_add_f32 v137, v137, v141
  v_mul_f32 v136, 0x3b000000, v136
  v_mul_f32 v137, 0x3b000000, v137
  v_mfma_f32_32x32x16_bf16 v[56:71], v[112:115], a[100:103], v[56:71]
  ds_read_b128 v[108:111], v3 offset:8704
  v_fma_f32 v137, -v136, v136, v137
  v_cvt_pk_bf16_f32 v136, 0, v136
  v_max_f32 v137, 0, v137
  v_sub_f32 v140, v196, v136
  v_sub_f32 v141, v197, v136
  v_mfma_f32_32x32x16_bf16 v[72:87], v[112:115], a[104:107], v[72:87]
  v_cvt_pk_bf16_f32 v137, 0, v137
  v_sub_f32 v142, v198, v136
  v_sub_f32 v143, v199, v136
  v_add_f32 v137, 0x3727c5ac, v137
  v_sub_f32 v144, v200, v136
  v_sub_f32 v145, v201, v136
  v_mfma_f32_32x32x16_bf16 v[88:103], v[112:115], a[108:111], v[88:103]
  v_cvt_pk_bf16_f32 v137, 0, v137
  v_sub_f32 v146, v202, v136
  v_sub_f32 v147, v203, v136
  v_sqrt_f32 v137, v137
  s_waitcnt lgkmcnt(2)
  v_mfma_f32_32x32x16_bf16 v[40:55], v[116:119], a[112:115], v[40:55]
  v_cvt_pk_bf16_f32 v140, 0, v140
  v_cvt_pk_bf16_f32 v141, 0, v141
  v_cvt_pk_bf16_f32 v137, 0, v137
  v_cvt_pk_bf16_f32 v142, 0, v142
  v_cvt_pk_bf16_f32 v143, 0, v143
  v_rcp_f32 v137, v137
  v_mfma_f32_32x32x16_bf16 v[56:71], v[116:119], a[116:119], v[56:71]
  ds_read_b128 v[112:115], v3 offset:9216
  v_cvt_pk_bf16_f32 v144, 0, v144
  v_cvt_pk_bf16_f32 v145, 0, v145
  v_cvt_pk_bf16_f32 v146, 0, v146
  v_cvt_pk_bf16_f32 v147, 0, v147
  v_mul_f32 v140, v140, v137
  v_mfma_f32_32x32x16_bf16 v[72:87], v[116:119], a[120:123], v[72:87]
  v_mul_f32 v141, v141, v137
  v_mul_f32 v142, v142, v137
  v_mul_f32 v143, v143, v137
  v_mul_f32 v144, v144, v137
  v_mul_f32 v145, v145, v137
  v_mul_f32 v146, v146, v137
  v_mfma_f32_32x32x16_bf16 v[88:103], v[116:119], a[124:127], v[88:103]
  v_mul_f32 v147, v147, v137
  v_cvt_pk_bf16_f32 v124, v140, v141
  v_cvt_pk_bf16_f32 v125, v142, v143
  v_cvt_pk_bf16_f32 v126, v144, v145
  v_cvt_pk_bf16_f32 v127, v146, v147
  s_waitcnt lgkmcnt(2)
  v_mfma_f32_32x32x16_bf16 v[40:55], v[104:107], a[128:131], v[40:55]
  v_lshlrev_b32 v204, 16, v124
  v_and_b32 v205, 0xffff0000, v124
  v_lshlrev_b32 v206, 16, v125
  v_and_b32 v207, 0xffff0000, v125
  v_lshlrev_b32 v208, 16, v126
  v_and_b32 v209, 0xffff0000, v126
  v_mfma_f32_32x32x16_bf16 v[56:71], v[104:107], a[132:135], v[56:71]
  ds_read_b128 v[116:119], v3 offset:9728
  v_lshlrev_b32 v210, 16, v127
  v_and_b32 v211, 0xffff0000, v127
  buffer_store_dwordx4 v[124:127], v0, s[4:7], s93 offen sc1
  v_mfma_f32_32x32x16_bf16 v[72:87], v[104:107], a[136:139], v[72:87]
  v_add_f32 v196, v196, v204
  v_add_f32 v197, v197, v205
  v_add_f32 v198, v198, v206
  v_add_f32 v199, v199, v207
  v_add_f32 v200, v200, v208
  v_add_f32 v201, v201, v209
  v_mfma_f32_32x32x16_bf16 v[88:103], v[104:107], a[140:143], v[88:103]
  v_add_f32 v202, v202, v210
  v_add_f32 v203, v203, v211
  v_cvt_pk_bf16_f32 v128, v196, v197
  v_cvt_pk_bf16_f32 v129, v198, v199
  v_cvt_pk_bf16_f32 v130, v200, v201
  s_waitcnt lgkmcnt(2)
  v_mfma_f32_32x32x16_bf16 v[40:55], v[108:111], a[144:147], v[40:55]
  v_cvt_pk_bf16_f32 v131, v202, v203
  v_mul_f32 v188, v204, v8
  v_mul_f32 v189, v205, v9
  v_fmac_f32 v188, v206, v10
  v_fmac_f32 v189, v207, v11
  v_fmac_f32 v188, v208, v12
  v_mfma_f32_32x32x16_bf16 v[56:71], v[108:111], a[148:151], v[56:71]
  ds_read_b128 v[104:107], v3 offset:10240
  v_fmac_f32 v189, v209, v13
  v_fmac_f32 v188, v210, v14
  v_fmac_f32 v189, v211, v15
  v_add_f32 v188, v188, v189
  buffer_store_dwordx4 v[128:131], v0, s[68:71], s91 offen sc1
  v_mfma_f32_32x32x16_bf16 v[72:87], v[108:111], a[152:155], v[72:87]
  v_add_f32_dpp v188, v188, v188 row_ror:8 row_mask:0xf bank_mask:0xf
  s_nop 1
  v_add_f32_dpp v188, v188, v188 row_ror:4 row_mask:0xf bank_mask:0xf
  s_nop 1
  v_add_f32_dpp v188, v188, v188 row_ror:2 row_mask:0xf bank_mask:0xf
  s_nop 1
  v_add_f32_dpp v188, v188, v188 row_ror:1 row_mask:0xf bank_mask:0xf
  v_mov_b32 v189, v188
  s_nop 0
  s_nop 0
  v_permlane16_swap_b32 v188, v189
  v_mfma_f32_32x32x16_bf16 v[88:103], v[108:111], a[156:159], v[88:103]
  v_add_f32 v188, v188, v189
  v_mov_b32 v189, v188
  s_nop 0
  s_nop 0
  v_permlane32_swap_b32 v188, v189
  v_add_f32 v188, v188, v189
  s_waitcnt lgkmcnt(2)
  v_mfma_f32_32x32x16_bf16 v[40:55], v[112:115], a[160:163], v[40:55]
  v_cvt_pk_bf16_f32 v188, 0, v188
  v_ashrrev_i32 v189, 31, v188
  v_or_b32 v189, 0x80000000, v189
  v_xor_b32 v188, v188, v189
  s_sub_u32 s92, 4095, s90
  v_and_b32 v188, 0xffff0000, v188
  v_mfma_f32_32x32x16_bf16 v[56:71], v[112:115], a[164:167], v[56:71]
  ds_read_b128 v[108:111], v3 offset:10752
  v_or_b32 v38, s92, v188
  s_bfe_u32 s92, s65, 196625
  s_lshl_b32 s92, s92, 18
  s_lshl_b32 s93, s90, 7
  s_add_u32 s92, s92, s93
  v_mfma_f32_32x32x16_bf16 v[72:87], v[112:115], a[168:171], v[72:87]
  s_add_u32 s84, s92, 243269632
  v_mfma_f32_32x32x16_bf16 v[88:103], v[112:115], a[172:175], v[88:103]
  s_waitcnt lgkmcnt(2)
  v_mfma_f32_32x32x16_bf16 v[40:55], v[116:119], a[176:179], v[40:55]
  v_mfma_f32_32x32x16_bf16 v[56:71], v[116:119], a[180:183], v[56:71]
  ds_read_b128 v[112:115], v3 offset:11264
  v_mfma_f32_32x32x16_bf16 v[72:87], v[116:119], a[184:187], v[72:87]
  v_mfma_f32_32x32x16_bf16 v[88:103], v[116:119], a[188:191], v[88:103]
  s_waitcnt lgkmcnt(2)
  v_mfma_f32_32x32x16_bf16 v[40:55], v[104:107], a[192:195], v[40:55]
  v_mfma_f32_32x32x16_bf16 v[56:71], v[104:107], a[196:199], v[56:71]
  ds_read_b128 v[116:119], v3 offset:11776
  s_waitcnt lgkmcnt(2)
  v_mfma_f32_32x32x16_bf16 v[40:55], v[108:111], a[208:211], v[40:55]
  v_mfma_f32_32x32x16_bf16 v[56:71], v[108:111], a[212:215], v[56:71]
  s_waitcnt lgkmcnt(1)
  v_mfma_f32_32x32x16_bf16 v[40:55], v[112:115], a[224:227], v[40:55]
  v_mfma_f32_32x32x16_bf16 v[56:71], v[112:115], a[228:231], v[56:71]
  s_waitcnt lgkmcnt(0)
  v_mfma_f32_32x32x16_bf16 v[40:55], v[116:119], a[240:243], v[40:55]
  v_mfma_f32_32x32x16_bf16 v[56:71], v[116:119], a[244:247], v[56:71]
  v_mfma_f32_32x32x16_bf16 v[72:87], v[104:107], a[200:203], v[72:87]
  v_mfma_f32_32x32x16_bf16 v[88:103], v[104:107], a[204:207], v[88:103]
  v_cvt_pk_bf16_f32 v212, v40, v56
  v_cvt_pk_bf16_f32 v214, v41, v57
  v_cvt_pk_bf16_f32 v216, v42, v58
  v_cvt_pk_bf16_f32 v218, v43, v59
  v_permlane16_swap_b32 v212, v214
  v_mfma_f32_32x32x16_bf16 v[72:87], v[108:111], a[216:219], v[72:87]
  v_cvt_pk_bf16_f32 v220, v44, v60
  v_cvt_pk_bf16_f32 v222, v45, v61
  v_permlane16_swap_b32 v216, v218
  v_bfi_b32 v212, v254, s42, v212
  v_cvt_pk_bf16_f32 v224, v46, v62
  v_mfma_f32_32x32x16_bf16 v[88:103], v[108:111], a[220:223], v[88:103]
  v_cvt_pk_bf16_f32 v226, v47, v63
  v_permlane16_swap_b32 v220, v222
  v_bfi_b32 v216, v254, s42, v216
  v_cvt_pk_bf16_f32 v228, v48, v64
  v_mfma_f32_32x32x16_bf16 v[72:87], v[112:115], a[232:235], v[72:87]
  v_cvt_pk_bf16_f32 v230, v49, v65
  v_permlane16_swap_b32 v224, v226
  v_bfi_b32 v220, v254, s42, v220
  v_cvt_pk_bf16_f32 v232, v50, v66
  v_cvt_pk_bf16_f32 v234, v51, v67
  v_mfma_f32_32x32x16_bf16 v[88:103], v[112:115], a[236:239], v[88:103]
  v_permlane16_swap_b32 v228, v230
  v_bfi_b32 v224, v254, s42, v224
  v_cvt_pk_bf16_f32 v236, v52, v68
  v_cvt_pk_bf16_f32 v238, v53, v69
  v_mfma_f32_32x32x16_bf16 v[72:87], v[116:119], a[248:251], v[72:87]
  v_permlane16_swap_b32 v232, v234
  v_bfi_b32 v228, v254, s42, v228
  v_cvt_pk_bf16_f32 v240, v54, v70
  v_cvt_pk_bf16_f32 v242, v55, v71
  v_permlane16_swap_b32 v236, v238
  v_mfma_f32_32x32x16_bf16 v[88:103], v[116:119], a[252:255], v[88:103]
  v_bfi_b32 v232, v254, s42, v232
  v_permlane16_swap_b32 v240, v242
  v_bfi_b32 v236, v254, s42, v236
  v_bfi_b32 v240, v254, s42, v240
  s_nop 7
  v_cvt_pk_bf16_f32 v213, v72, v88
  v_cvt_pk_bf16_f32 v215, v73, v89
  v_cvt_pk_bf16_f32 v217, v74, v90
  v_cvt_pk_bf16_f32 v219, v75, v91
  s_add_u32 s78, s86, 0
  v_permlane16_swap_b32 v213, v215
  buffer_store_dwordx4 v[212:215], v4, s[4:7], s78 offen
  v_cvt_pk_bf16_f32 v221, v76, v92
  v_cvt_pk_bf16_f32 v223, v77, v93
  s_add_u32 s78, s86, 32768
  v_permlane16_swap_b32 v217, v219
  buffer_store_dwordx4 v[216:219], v4, s[4:7], s78 offen
  v_cvt_pk_bf16_f32 v225, v78, v94
  v_cvt_pk_bf16_f32 v227, v79, v95
  s_add_u32 s78, s86, 131072
  v_permlane16_swap_b32 v221, v223
  buffer_store_dwordx4 v[220:223], v4, s[4:7], s78 offen
  v_cvt_pk_bf16_f32 v229, v80, v96
  v_cvt_pk_bf16_f32 v231, v81, v97
  s_add_u32 s78, s86, 163840
  v_permlane16_swap_b32 v225, v227
  buffer_store_dwordx4 v[224:227], v4, s[4:7], s78 offen
  v_cvt_pk_bf16_f32 v233, v82, v98
  v_cvt_pk_bf16_f32 v235, v83, v99
  s_add_u32 s78, s86, 262144
  v_permlane16_swap_b32 v229, v231
  buffer_store_dwordx4 v[228:231], v4, s[4:7], s78 offen
  v_cvt_pk_bf16_f32 v237, v84, v100
  v_cvt_pk_bf16_f32 v239, v85, v101
  s_add_u32 s78, s86, 294912
  v_permlane16_swap_b32 v233, v235
  buffer_store_dwordx4 v[232:235], v4, s[4:7], s78 offen
  v_cvt_pk_bf16_f32 v241, v86, v102
  v_cvt_pk_bf16_f32 v243, v87, v103
  s_add_u32 s78, s86, 393216
  v_permlane16_swap_b32 v237, v239
  buffer_store_dwordx4 v[236:239], v4, s[4:7], s78 offen
  s_add_u32 s78, s86, 425984
  v_permlane16_swap_b32 v241, v243
  buffer_store_dwordx4 v[240:243], v4, s[4:7], s78 offen
o_we_153:
  v_and_b32 v37, -32, v39
  s_waitcnt lgkmcnt(0)
  s_barrier
  ds_read_b128 v[104:107], v37 offset:16
  s_mov_b32 s65, s63
  s_waitcnt lgkmcnt(0)
  v_and_b32 v104, v104, v106
  v_max_u32 v105, v105, v107
  v_readfirstlane_b32 s26, v104
  v_readfirstlane_b32 s3, v105
  s_and_b32 s66, s26, 1
  s_and_b32 s76, s26, 2
  s_bitcmp1_b32 s26, 2
  s_cselect_b32 s3, s3, 0
  s_cmp_lg_u32 s76, 0
  s_cbranch_scc1 o_nofl_127
  s_and_b32 s26, s63, 49152
  s_cbranch_scc0 o_fl_128
  s_and_b32 s26, s64, s50
  s_cbranch_scc1 o_nofl_127
o_fl_128:
  s_cmp_ge_u32 s17, 2
  s_cbranch_scc1 o_fd_167
  s_cmp_eq_u32 s65, 0
  s_cbranch_scc1 o_fd_167
  s_mov_b32 s96, s42
  s_waitcnt vmcnt(0)
  s_mov_b64 exec, 1
  buffer_store_dword v38, off, s[4:7], s84 sc1
  s_mov_b64 exec, -1
  s_mov_b32 s84, 268435456
  s_lshl_b32 s97, s43, 14
  s_add_u32 s97, s97, s86
  buffer_load_dword v7, v255, s[4:7], s97 offen sc1
  s_and_b32 s91, s65, 63
  s_lshl_b32 s90, s91, 5
  s_add_u32 s94, s90, s85
  s_add_u32 s90, s90, s43
  s_lshl_b32 s94, s94, 10
  s_lshr_b32 s92, s65, 22
  s_xor_b32 s93, s43, 32
  s_lshl_b32 s91, s90, 10
  s_add_u32 s94, s94, 25165824
  s_cmp_eq_u32 s92, s93
  s_cselect_b32 s92, s94, s91
  s_add_u32 s92, s92, 10485760
  s_and_b32 s93, s65, 49152
  s_cselect_b32 s92, s92, s91
  s_cselect_b64 s[80:81], s[4:5], s[72:73]
  s_cselect_b32 s82, s6, s74
  buffer_load_dwordx4 v[184:187], v0, s[80:83], s92 offen sc1
  s_mov_b32 s67, 0
  s_mov_b64 vcc, 0
  s_waitcnt vmcnt(1)
o_pl_169:
  v_and_b32 v7, 1, v7
  v_cmp_ne_u32 vcc, s96, v7
  s_cbranch_vccz o_pk_170
  buffer_load_dword v7, v255, s[4:7], s97 offen sc1
  s_add_u32 s67, s67, 1
  s_cmp_gt_u32 s67, 1048576
  s_cbranch_scc1 L_end
  s_waitcnt vmcnt(0)
  s_branch o_pl_169
o_pk_170:
  s_and_b32 s26, s65, 49152
  s_cbranch_scc1 o_f2_168
  s_lshl_b32 s94, s43, 14
  s_add_u32 s94, s94, s86
  buffer_load_dwordx4 v[120:123], v5, s[4:7], s94 offen offset:0 sc1
  buffer_load_dwordx4 v[124:127], v5, s[4:7], s94 offen offset:512 sc1
  buffer_load_dwordx4 v[128:131], v5, s[4:7], s94 offen offset:256 sc1
  buffer_load_dwordx4 v[132:135], v5, s[4:7], s94 offen offset:768 sc1
  s_add_u32 s94, s94, 4096
  buffer_load_dwordx4 v[136:139], v5, s[4:7], s94 offen offset:0 sc1
  buffer_load_dwordx4 v[140:143], v5, s[4:7], s94 offen offset:512 sc1
  buffer_load_dwordx4 v[144:147], v5, s[4:7], s94 offen offset:256 sc1
  buffer_load_dwordx4 v[148:151], v5, s[4:7], s94 offen offset:768 sc1
  s_add_u32 s94, s94, 4096
  buffer_load_dwordx4 v[152:155], v5, s[4:7], s94 offen offset:0 sc1
  buffer_load_dwordx4 v[156:159], v5, s[4:7], s94 offen offset:512 sc1
  buffer_load_dwordx4 v[160:163], v5, s[4:7], s94 offen offset:256 sc1
  buffer_load_dwordx4 v[164:167], v5, s[4:7], s94 offen offset:768 sc1
  s_add_u32 s94, s94, 4096
  buffer_load_dwordx4 v[168:171], v5, s[4:7], s94 offen offset:0 sc1
  buffer_load_dwordx4 v[172:175], v5, s[4:7], s94 offen offset:512 sc1
  buffer_load_dwordx4 v[176:179], v5, s[4:7], s94 offen offset:256 sc1
  buffer_load_dwordx4 v[180:183], v5, s[4:7], s94 offen offset:768 sc1
  v_mov_b64 v[188:189], 0
  v_mov_b64 v[190:191], 0
  v_mov_b64 v[192:193], 0
  v_mov_b64 v[194:195], 0
  s_waitcnt vmcnt(12)
  v_xor_b32 v7, s96, v120
  v_bitop3_b32 v7, v7, v124, s96 bitop3:0xf6
  v_bitop3_b32 v7, v7, v128, s96 bitop3:0xf6
  v_bitop3_b32 v7, v7, v132, s96 bitop3:0xf6
  s_waitcnt vmcnt(8)
  v_bitop3_b32 v7, v7, v136, s96 bitop3:0xf6
  v_bitop3_b32 v7, v7, v140, s96 bitop3:0xf6
  v_bitop3_b32 v7, v7, v144, s96 bitop3:0xf6
  v_bitop3_b32 v7, v7, v148, s96 bitop3:0xf6
  s_waitcnt vmcnt(4)
  v_bitop3_b32 v7, v7, v152, s96 bitop3:0xf6
  v_bitop3_b32 v7, v7, v156, s96 bitop3:0xf6
  v_bitop3_b32 v7, v7, v160, s96 bitop3:0xf6
  v_bitop3_b32 v7, v7, v164, s96 bitop3:0xf6
  s_waitcnt vmcnt(0)
  v_bitop3_b32 v7, v7, v168, s96 bitop3:0xf6
  v_bitop3_b32 v7, v7, v172, s96 bitop3:0xf6
  v_bitop3_b32 v7, v7, v176, s96 bitop3:0xf6
  v_bitop3_b32 v7, v7, v180, s96 bitop3:0xf6
  v_and_b32 v7, v254, v7
  v_cmp_ne_u32 vcc, 0, v7
  s_cbranch_vccnz o_rt_171
o_bk_172:
  v_smfmac_f32_16x16x64_bf16 v[188:191], v[16:19], v[120:127], v20
  v_lshlrev_b32 v196, 16, v184
  v_smfmac_f32_16x16x64_bf16 v[192:195], v[16:19], v[128:135], v20
  v_and_b32 v197, 0xffff0000, v184
  v_smfmac_f32_16x16x64_bf16 v[188:191], v[16:19], v[136:143], v20
  v_lshlrev_b32 v198, 16, v185
  v_smfmac_f32_16x16x64_bf16 v[192:195], v[16:19], v[144:151], v20
  v_and_b32 v199, 0xffff0000, v185
  v_smfmac_f32_16x16x64_bf16 v[188:191], v[16:19], v[152:159], v20
  v_lshlrev_b32 v200, 16, v186
  v_smfmac_f32_16x16x64_bf16 v[192:195], v[16:19], v[160:167], v20
  v_and_b32 v201, 0xffff0000, v186
  v_smfmac_f32_16x16x64_bf16 v[188:191], v[16:19], v[168:175], v20
  v_lshlrev_b32 v202, 16, v187
  v_smfmac_f32_16x16x64_bf16 v[192:195], v[16:19], v[176:183], v20
  v_and_b32 v203, 0xffff0000, v187
  s_bfe_u32 s92, s65, 131086
  s_lshl_b32 s92, s92, 21
  s_add_u32 s92, s92, s91
  s_add_u32 s93, s92, 27262976
  s_add_u32 s92, s92, 20971520
  s_nop 1
  v_permlane16_swap_b32 v188, v192
  v_permlane16_swap_b32 v189, v193
  v_permlane16_swap_b32 v190, v194
  v_permlane16_swap_b32 v191, v195
  v_cvt_pk_bf16_f32 v188, 0, v188
  v_cvt_pk_bf16_f32 v189, 0, v189
  v_cvt_pk_bf16_f32 v190, 0, v190
  v_cvt_pk_bf16_f32 v191, 0, v191
  v_cvt_pk_bf16_f32 v192, 0, v192
  v_cvt_pk_bf16_f32 v193, 0, v193
  v_cvt_pk_bf16_f32 v194, 0, v194
  v_cvt_pk_bf16_f32 v195, 0, v195
  v_add_f32 v196, v196, v188
  v_add_f32 v197, v197, v189
  v_add_f32 v198, v198, v190
  v_add_f32 v199, v199, v191
  v_add_f32 v200, v200, v192
  v_add_f32 v201, v201, v193
  v_add_f32 v202, v202, v194
  v_add_f32 v203, v203, v195
  v_cvt_pk_bf16_f32 v120, v196, v197
  v_cvt_pk_bf16_f32 v121, v198, v199
  v_cvt_pk_bf16_f32 v122, v200, v201
  v_cvt_pk_bf16_f32 v123, v202, v203
  v_lshlrev_b32 v196, 16, v120
  v_and_b32 v197, 0xffff0000, v120
  v_lshlrev_b32 v198, 16, v121
  v_and_b32 v199, 0xffff0000, v121
  v_lshlrev_b32 v200, 16, v122
  v_and_b32 v201, 0xffff0000, v122
  v_lshlrev_b32 v202, 16, v123
  v_and_b32 v203, 0xffff0000, v123
  buffer_store_dwordx4 v[120:123], v0, s[4:7], s92 offen sc1
  v_add_f32 v136, v196, v197
  v_mul_f32 v137, v196, v196
  v_add_f32 v138, v198, v199
  v_mul_f32 v139, v197, v197
  v_fmac_f32 v137, v198, v198
  v_fmac_f32 v139, v199, v199
  v_add_f32 v136, v136, v200
  v_fmac_f32 v137, v200, v200
  v_add_f32 v138, v138, v201
  v_fmac_f32 v139, v201, v201
  v_add_f32 v136, v136, v202
  v_fmac_f32 v137, v202, v202
  v_add_f32 v138, v138, v203
  v_fmac_f32 v139, v203, v203
  v_add_f32 v136, v136, v138
  v_add_f32 v137, v137, v139
  s_nop 0
  v_add_f32_dpp v136, v136, v136 row_ror:8 row_mask:0xf bank_mask:0xf
  v_add_f32_dpp v137, v137, v137 row_ror:8 row_mask:0xf bank_mask:0xf
  s_nop 0
  v_add_f32_dpp v136, v136, v136 row_ror:4 row_mask:0xf bank_mask:0xf
  v_add_f32_dpp v137, v137, v137 row_ror:4 row_mask:0xf bank_mask:0xf
  s_nop 0
  v_add_f32_dpp v136, v136, v136 row_ror:2 row_mask:0xf bank_mask:0xf
  v_add_f32_dpp v137, v137, v137 row_ror:2 row_mask:0xf bank_mask:0xf
  s_nop 0
  v_add_f32_dpp v136, v136, v136 row_ror:1 row_mask:0xf bank_mask:0xf
  v_add_f32_dpp v137, v137, v137 row_ror:1 row_mask:0xf bank_mask:0xf
  v_mov_b32 v140, v136
  v_mov_b32 v141, v137
  s_nop 0
  v_permlane16_swap_b32 v136, v140
  v_permlane16_swap_b32 v137, v141
  v_add_f32 v136, v136, v140
  v_add_f32 v137, v137, v141
  v_mov_b32 v140, v136
  v_mov_b32 v141, v137
  s_nop 0
  v_permlane32_swap_b32 v136, v140
  v_permlane32_swap_b32 v137, v141
  v_add_f32 v136, v136, v140
  v_add_f32 v137, v137, v141
  v_mul_f32 v136, 0x3b000000, v136
  v_mul_f32 v137, 0x3b000000, v137
  v_fma_f32 v137, -v136, v136, v137
  v_cvt_pk_bf16_f32 v136, 0, v136
  v_max_f32 v137, 0, v137
  v_sub_f32 v140, v196, v136
  v_sub_f32 v141, v197, v136
  v_cvt_pk_bf16_f32 v137, 0, v137
  v_sub_f32 v142, v198, v136
  v_sub_f32 v143, v199, v136
  v_add_f32 v137, 0x3727c5ac, v137
  v_sub_f32 v144, v200, v136
  v_sub_f32 v145, v201, v136
  v_cvt_pk_bf16_f32 v137, 0, v137
  v_sub_f32 v146, v202, v136
  v_sub_f32 v147, v203, v136
  v_sqrt_f32 v137, v137
  v_cvt_pk_bf16_f32 v140, 0, v140
  v_cvt_pk_bf16_f32 v141, 0, v141
  v_cvt_pk_bf16_f32 v137, 0, v137
  v_cvt_pk_bf16_f32 v142, 0, v142
  v_cvt_pk_bf16_f32 v143, 0, v143
  v_rcp_f32 v137, v137
  v_cvt_pk_bf16_f32 v144, 0, v144
  v_cvt_pk_bf16_f32 v145, 0, v145
  v_cvt_pk_bf16_f32 v146, 0, v146
  v_cvt_pk_bf16_f32 v147, 0, v147
  v_mul_f32 v140, v140, v137
  v_mul_f32 v141, v141, v137
  v_mul_f32 v142, v142, v137
  v_mul_f32 v143, v143, v137
  v_mul_f32 v144, v144, v137
  v_mul_f32 v145, v145, v137
  v_mul_f32 v146, v146, v137
  v_mul_f32 v147, v147, v137
  v_cvt_pk_bf16_f32 v124, v140, v141
  v_cvt_pk_bf16_f32 v125, v142, v143
  v_cvt_pk_bf16_f32 v126, v144, v145
  v_cvt_pk_bf16_f32 v127, v146, v147
  v_lshlrev_b32 v204, 16, v124
  v_and_b32 v205, 0xffff0000, v124
  v_lshlrev_b32 v206, 16, v125
  v_and_b32 v207, 0xffff0000, v125
  v_lshlrev_b32 v208, 16, v126
  v_and_b32 v209, 0xffff0000, v126
  v_lshlrev_b32 v210, 16, v127
  v_and_b32 v211, 0xffff0000, v127
  buffer_store_dwordx4 v[124:127], v0, s[4:7], s93 offen sc1
  v_add_f32 v196, v196, v204
  v_add_f32 v197, v197, v205
  v_add_f32 v198, v198, v206
  v_add_f32 v199, v199, v207
  v_add_f32 v200, v200, v208
  v_add_f32 v201, v201, v209
  v_add_f32 v202, v202, v210
  v_add_f32 v203, v203, v211
  v_cvt_pk_bf16_f32 v128, v196, v197
  v_cvt_pk_bf16_f32 v129, v198, v199
  v_cvt_pk_bf16_f32 v130, v200, v201
  v_cvt_pk_bf16_f32 v131, v202, v203
  v_mul_f32 v188, v204, v8
  v_mul_f32 v189, v205, v9
  v_fmac_f32 v188, v206, v10
  v_fmac_f32 v189, v207, v11
  v_fmac_f32 v188, v208, v12
  v_fmac_f32 v189, v209, v13
  v_fmac_f32 v188, v210, v14
  v_fmac_f32 v189, v211, v15
  v_add_f32 v188, v188, v189
  s_add_u32 s92, s91, 10485760
  s_add_u32 s93, s91, 8388608
  buffer_store_dwordx4 v[128:131], v0, s[4:7], s92 offen sc1
  v_lshlrev_b32 v196, 16, v128
  v_and_b32 v197, 0xffff0000, v128
  v_lshlrev_b32 v198, 16, v129
  v_and_b32 v199, 0xffff0000, v129
  v_lshlrev_b32 v200, 16, v130
  v_and_b32 v201, 0xffff0000, v130
  v_lshlrev_b32 v202, 16, v131
  v_and_b32 v203, 0xffff0000, v131
  v_add_f32 v136, v196, v197
  v_mul_f32 v137, v196, v196
  v_add_f32 v138, v198, v199
  v_mul_f32 v139, v197, v197
  v_fmac_f32 v137, v198, v198
  v_fmac_f32 v139, v199, v199
  v_add_f32 v136, v136, v200
  v_fmac_f32 v137, v200, v200
  v_add_f32 v138, v138, v201
  v_fmac_f32 v139, v201, v201
  v_add_f32 v136, v136, v202
  v_fmac_f32 v137, v202, v202
  v_add_f32 v138, v138, v203
  v_fmac_f32 v139, v203, v203
  v_add_f32 v136, v136, v138
  v_add_f32 v137, v137, v139
  s_nop 0
  v_add_f32_dpp v136, v136, v136 row_ror:8 row_mask:0xf bank_mask:0xf
  v_add_f32_dpp v137, v137, v137 row_ror:8 row_mask:0xf bank_mask:0xf
  v_add_f32_dpp v188, v188, v188 row_ror:8 row_mask:0xf bank_mask:0xf
  v_add_f32_dpp v136, v136, v136 row_ror:4 row_mask:0xf bank_mask:0xf
  v_add_f32_dpp v137, v137, v137 row_ror:4 row_mask:0xf bank_mask:0xf
  v_add_f32_dpp v188, v188, v188 row_ror:4 row_mask:0xf bank_mask:0xf
  v_add_f32_dpp v136, v136, v136 row_ror:2 row_mask:0xf bank_mask:0xf
  v_add_f32_dpp v137, v137, v137 row_ror:2 row_mask:0xf bank_mask:0xf
  v_add_f32_dpp v188, v188, v188 row_ror:2 row_mask:0xf bank_mask:0xf
  v_add_f32_dpp v136, v136, v136 row_ror:1 row_mask:0xf bank_mask:0xf
  v_add_f32_dpp v137, v137, v137 row_ror:1 row_mask:0xf bank_mask:0xf
  v_add_f32_dpp v188, v188, v188 row_ror:1 row_mask:0xf bank_mask:0xf
  v_mov_b32 v140, v136
  v_mov_b32 v141, v137
  v_mov_b32 v142, v188
  v_permlane16_swap_b32 v136, v140
  v_permlane16_swap_b32 v137, v141
  v_permlane16_swap_b32 v188, v142
  v_add_f32 v136, v136, v140
  v_add_f32 v137, v137, v141
  v_add_f32 v188, v188, v142
  v_mov_b32 v140, v136
  v_mov_b32 v141, v137
  v_mov_b32 v142, v188
  v_permlane32_swap_b32 v136, v140
  v_permlane32_swap_b32 v137, v141
  v_permlane32_swap_b32 v188, v142
  v_add_f32 v136, v136, v140
  v_add_f32 v137, v137, v141
  v_add_f32 v188, v188, v142
  v_mul_f32 v136, 0x3b000000, v136
  v_mul_f32 v137, 0x3b000000, v137
  v_fma_f32 v137, -v136, v136, v137
  v_cvt_pk_bf16_f32 v136, 0, v136
  v_max_f32 v137, 0, v137
  v_sub_f32 v140, v196, v136
  v_sub_f32 v141, v197, v136
  v_cvt_pk_bf16_f32 v137, 0, v137
  v_sub_f32 v142, v198, v136
  v_sub_f32 v143, v199, v136
  v_add_f32 v137, 0x3727c5ac, v137
  v_sub_f32 v144, v200, v136
  v_sub_f32 v145, v201, v136
  v_cvt_pk_bf16_f32 v137, 0, v137
  v_sub_f32 v146, v202, v136
  v_sub_f32 v147, v203, v136
  v_sqrt_f32 v137, v137
  v_cvt_pk_bf16_f32 v140, 0, v140
  v_cvt_pk_bf16_f32 v141, 0, v141
  v_cvt_pk_bf16_f32 v137, 0, v137
  v_cvt_pk_bf16_f32 v142, 0, v142
  v_cvt_pk_bf16_f32 v143, 0, v143
  v_rcp_f32 v137, v137
  v_cvt_pk_bf16_f32 v144, 0, v144
  v_cvt_pk_bf16_f32 v145, 0, v145
  v_cvt_pk_bf16_f32 v146, 0, v146
  v_cvt_pk_bf16_f32 v147, 0, v147
  v_mul_f32 v140, v140, v137
  v_mul_f32 v141, v141, v137
  v_mul_f32 v142, v142, v137
  v_mul_f32 v143, v143, v137
  v_mul_f32 v144, v144, v137
  v_mul_f32 v145, v145, v137
  v_mul_f32 v146, v146, v137
  v_mul_f32 v147, v147, v137
  v_cvt_pk_bf16_f32 v132, v140, v141
  v_cvt_pk_bf16_f32 v133, v142, v143
  v_cvt_pk_bf16_f32 v134, v144, v145
  v_cvt_pk_bf16_f32 v135, v146, v147
  buffer_store_dwordx4 v[132:135], v0, s[4:7], s93 offen sc1
  v_cvt_pk_bf16_f32 v188, 0, v188
  v_ashrrev_i32 v189, 31, v188
  v_or_b32 v189, 0x80000000, v189
  v_xor_b32 v188, v188, v189
  s_sub_u32 s92, 4095, s90
  v_and_b32 v188, 0xffff0000, v188
  v_or_b32 v38, s92, v188
  s_bfe_u32 s92, s65, 196625
  s_lshl_b32 s92, s92, 18
  s_lshl_b32 s93, s90, 7
  s_add_u32 s92, s92, s93
  s_add_u32 s84, s92, 243269632
  s_waitcnt vmcnt(0)
  s_mov_b64 exec, 1
  buffer_store_dword v38, off, s[4:7], s84 sc1
  s_mov_b64 exec, -1
  s_mov_b32 s84, 268435456
  s_branch o_fd_167
o_rt_171:
  s_mov_b32 s67, 0
o_rl_173:
  s_lshl_b32 s94, s43, 14
  s_add_u32 s94, s94, s86
  buffer_load_dwordx4 v[120:123], v5, s[4:7], s94 offen offset:0 sc1
  buffer_load_dwordx4 v[124:127], v5, s[4:7], s94 offen offset:512 sc1
  buffer_load_dwordx4 v[128:131], v5, s[4:7], s94 offen offset:256 sc1
  buffer_load_dwordx4 v[132:135], v5, s[4:7], s94 offen offset:768 sc1
  s_add_u32 s94, s94, 4096
  buffer_load_dwordx4 v[136:139], v5, s[4:7], s94 offen offset:0 sc1
  buffer_load_dwordx4 v[140:143], v5, s[4:7], s94 offen offset:512 sc1
  buffer_load_dwordx4 v[144:147], v5, s[4:7], s94 offen offset:256 sc1
  buffer_load_dwordx4 v[148:151], v5, s[4:7], s94 offen offset:768 sc1
  s_add_u32 s94, s94, 4096
  buffer_load_dwordx4 v[152:155], v5, s[4:7], s94 offen offset:0 sc1
  buffer_load_dwordx4 v[156:159], v5, s[4:7], s94 offen offset:512 sc1
  buffer_load_dwordx4 v[160:163], v5, s[4:7], s94 offen offset:256 sc1
  buffer_load_dwordx4 v[164:167], v5, s[4:7], s94 offen offset:768 sc1
  s_add_u32 s94, s94, 4096
  buffer_load_dwordx4 v[168:171], v5, s[4:7], s94 offen offset:0 sc1
  buffer_load_dwordx4 v[172:175], v5, s[4:7], s94 offen offset:512 sc1
  buffer_load_dwordx4 v[176:179], v5, s[4:7], s94 offen offset:256 sc1
  buffer_load_dwordx4 v[180:183], v5, s[4:7], s94 offen offset:768 sc1
  s_add_u32 s67, s67, 1
  s_cmp_gt_u32 s67, 1048576
  s_cbranch_scc1 L_end
  s_waitcnt vmcnt(0)
  v_xor_b32 v7, s96, v120
  v_bitop3_b32 v7, v7, v124, s96 bitop3:0xf6
  v_bitop3_b32 v7, v7, v128, s96 bitop3:0xf6
  v_bitop3_b32 v7, v7, v132, s96 bitop3:0xf6
  v_bitop3_b32 v7, v7, v136, s96 bitop3:0xf6
  v_bitop3_b32 v7, v7, v140, s96 bitop3:0xf6
  v_bitop3_b32 v7, v7, v144, s96 bitop3:0xf6
  v_bitop3_b32 v7, v7, v148, s96 bitop3:0xf6
  v_bitop3_b32 v7, v7, v152, s96 bitop3:0xf6
  v_bitop3_b32 v7, v7, v156, s96 bitop3:0xf6
  v_bitop3_b32 v7, v7, v160, s96 bitop3:0xf6
  v_bitop3_b32 v7, v7, v164, s96 bitop3:0xf6
  v_bitop3_b32 v7, v7, v168, s96 bitop3:0xf6
  v_bitop3_b32 v7, v7, v172, s96 bitop3:0xf6
  v_bitop3_b32 v7, v7, v176, s96 bitop3:0xf6
  v_bitop3_b32 v7, v7, v180, s96 bitop3:0xf6
  v_and_b32 v7, v254, v7
  v_cmp_ne_u32 vcc, 0, v7
  s_cbranch_vccnz o_rl_173
  s_branch o_bk_172
o_f2_168:
  s_lshl_b32 s94, s43, 14
  s_add_u32 s94, s94, s86
  buffer_load_dwordx4 v[120:123], v5, s[4:7], s94 offen offset:0 sc1
  buffer_load_dwordx4 v[124:127], v5, s[4:7], s94 offen offset:512 sc1
  buffer_load_dwordx4 v[128:131], v5, s[4:7], s94 offen offset:256 sc1
  buffer_load_dwordx4 v[132:135], v5, s[4:7], s94 offen offset:768 sc1
  s_add_u32 s94, s94, 4096
  buffer_load_dwordx4 v[136:139], v5, s[4:7], s94 offen offset:0 sc1
  buffer_load_dwordx4 v[140:143], v5, s[4:7], s94 offen offset:512 sc1
  buffer_load_dwordx4 v[144:147], v5, s[4:7], s94 offen offset:256 sc1
  buffer_load_dwordx4 v[148:151], v5, s[4:7], s94 offen offset:768 sc1
  s_add_u32 s94, s94, 4096
  buffer_load_dwordx4 v[152:155], v5, s[4:7], s94 offen offset:0 sc1
  buffer_load_dwordx4 v[156:159], v5, s[4:7], s94 offen offset:512 sc1
  buffer_load_dwordx4 v[160:163], v5, s[4:7], s94 offen offset:256 sc1
  buffer_load_dwordx4 v[164:167], v5, s[4:7], s94 offen offset:768 sc1
  s_add_u32 s94, s94, 4096
  buffer_load_dwordx4 v[168:171], v5, s[4:7], s94 offen offset:0 sc1
  buffer_load_dwordx4 v[172:175], v5, s[4:7], s94 offen offset:512 sc1
  buffer_load_dwordx4 v[176:179], v5, s[4:7], s94 offen offset:256 sc1
  buffer_load_dwordx4 v[180:183], v5, s[4:7], s94 offen offset:768 sc1
  v_mov_b64 v[188:189], 0
  v_mov_b64 v[190:191], 0
  v_mov_b64 v[192:193], 0
  v_mov_b64 v[194:195], 0
  s_waitcnt vmcnt(12)
  v_xor_b32 v7, s96, v120
  v_bitop3_b32 v7, v7, v124, s96 bitop3:0xf6
  v_bitop3_b32 v7, v7, v128, s96 bitop3:0xf6
  v_bitop3_b32 v7, v7, v132, s96 bitop3:0xf6
  s_waitcnt vmcnt(8)
  v_bitop3_b32 v7, v7, v136, s96 bitop3:0xf6
  v_bitop3_b32 v7, v7, v140, s96 bitop3:0xf6
  v_bitop3_b32 v7, v7, v144, s96 bitop3:0xf6
  v_bitop3_b32 v7, v7, v148, s96 bitop3:0xf6
  s_waitcnt vmcnt(4)
  v_bitop3_b32 v7, v7, v152, s96 bitop3:0xf6
  v_bitop3_b32 v7, v7, v156, s96 bitop3:0xf6
  v_bitop3_b32 v7, v7, v160, s96 bitop3:0xf6
  v_bitop3_b32 v7, v7, v164, s96 bitop3:0xf6
  s_waitcnt vmcnt(0)
  v_bitop3_b32 v7, v7, v168, s96 bitop3:0xf6
  v_bitop3_b32 v7, v7, v172, s96 bitop3:0xf6
  v_bitop3_b32 v7, v7, v176, s96 bitop3:0xf6
  v_bitop3_b32 v7, v7, v180, s96 bitop3:0xf6
  v_and_b32 v7, v254, v7
  v_cmp_ne_u32 vcc, 0, v7
  s_cbranch_vccnz o_rt_174
o_bk_175:
  v_smfmac_f32_16x16x64_bf16 v[188:191], v[16:19], v[120:127], v20
  v_lshlrev_b32 v196, 16, v184
  v_smfmac_f32_16x16x64_bf16 v[192:195], v[16:19], v[128:135], v20
  v_and_b32 v197, 0xffff0000, v184
  v_smfmac_f32_16x16x64_bf16 v[188:191], v[16:19], v[136:143], v20
  v_lshlrev_b32 v198, 16, v185
  v_smfmac_f32_16x16x64_bf16 v[192:195], v[16:19], v[144:151], v20
  v_and_b32 v199, 0xffff0000, v185
  v_smfmac_f32_16x16x64_bf16 v[188:191], v[16:19], v[152:159], v20
  v_lshlrev_b32 v200, 16, v186
  v_smfmac_f32_16x16x64_bf16 v[192:195], v[16:19], v[160:167], v20
  v_and_b32 v201, 0xffff0000, v186
  v_smfmac_f32_16x16x64_bf16 v[188:191], v[16:19], v[168:175], v20
  v_lshlrev_b32 v202, 16, v187
  v_smfmac_f32_16x16x64_bf16 v[192:195], v[16:19], v[176:183], v20
  v_and_b32 v203, 0xffff0000, v187
  s_bfe_u32 s92, s65, 131086
  s_lshl_b32 s92, s92, 21
  s_add_u32 s92, s92, s91
  s_add_u32 s93, s92, 27262976
  s_add_u32 s92, s92, 20971520
  s_nop 1
  v_permlane16_swap_b32 v188, v192
  v_permlane16_swap_b32 v189, v193
  v_permlane16_swap_b32 v190, v194
  v_permlane16_swap_b32 v191, v195
  v_cvt_pk_bf16_f32 v188, 0, v188
  v_cvt_pk_bf16_f32 v189, 0, v189
  v_cvt_pk_bf16_f32 v190, 0, v190
  v_cvt_pk_bf16_f32 v191, 0, v191
  v_cvt_pk_bf16_f32 v192, 0, v192
  v_cvt_pk_bf16_f32 v193, 0, v193
  v_cvt_pk_bf16_f32 v194, 0, v194
  v_cvt_pk_bf16_f32 v195, 0, v195
  v_add_f32 v196, v196, v188
  v_add_f32 v197, v197, v189
  v_add_f32 v198, v198, v190
  v_add_f32 v199, v199, v191
  v_add_f32 v200, v200, v192
  v_add_f32 v201, v201, v193
  v_add_f32 v202, v202, v194
  v_add_f32 v203, v203, v195
  v_cvt_pk_bf16_f32 v120, v196, v197
  v_cvt_pk_bf16_f32 v121, v198, v199
  v_cvt_pk_bf16_f32 v122, v200, v201
  v_cvt_pk_bf16_f32 v123, v202, v203
  v_lshlrev_b32 v196, 16, v120
  v_and_b32 v197, 0xffff0000, v120
  v_lshlrev_b32 v198, 16, v121
  v_and_b32 v199, 0xffff0000, v121
  v_lshlrev_b32 v200, 16, v122
  v_and_b32 v201, 0xffff0000, v122
  v_lshlrev_b32 v202, 16, v123
  v_and_b32 v203, 0xffff0000, v123
  buffer_store_dwordx4 v[120:123], v0, s[4:7], s92 offen sc1
  v_add_f32 v136, v196, v197
  v_mul_f32 v137, v196, v196
  v_add_f32 v138, v198, v199
  v_mul_f32 v139, v197, v197
  v_fmac_f32 v137, v198, v198
  v_fmac_f32 v139, v199, v199
  v_add_f32 v136, v136, v200
  v_fmac_f32 v137, v200, v200
  v_add_f32 v138, v138, v201
  v_fmac_f32 v139, v201, v201
  v_add_f32 v136, v136, v202
  v_fmac_f32 v137, v202, v202
  v_add_f32 v138, v138, v203
  v_fmac_f32 v139, v203, v203
  v_add_f32 v136, v136, v138
  v_add_f32 v137, v137, v139
  s_nop 0
  v_add_f32_dpp v136, v136, v136 row_ror:8 row_mask:0xf bank_mask:0xf
  v_add_f32_dpp v137, v137, v137 row_ror:8 row_mask:0xf bank_mask:0xf
  s_nop 0
  v_add_f32_dpp v136, v136, v136 row_ror:4 row_mask:0xf bank_mask:0xf
  v_add_f32_dpp v137, v137, v137 row_ror:4 row_mask:0xf bank_mask:0xf
  s_nop 0
  v_add_f32_dpp v136, v136, v136 row_ror:2 row_mask:0xf bank_mask:0xf
  v_add_f32_dpp v137, v137, v137 row_ror:2 row_mask:0xf bank_mask:0xf
  s_nop 0
  v_add_f32_dpp v136, v136, v136 row_ror:1 row_mask:0xf bank_mask:0xf
  v_add_f32_dpp v137, v137, v137 row_ror:1 row_mask:0xf bank_mask:0xf
  v_mov_b32 v140, v136
  v_mov_b32 v141, v137
  s_nop 0
  v_permlane16_swap_b32 v136, v140
  v_permlane16_swap_b32 v137, v141
  v_add_f32 v136, v136, v140
  v_add_f32 v137, v137, v141
  v_mov_b32 v140, v136
  v_mov_b32 v141, v137
  s_nop 0
  v_permlane32_swap_b32 v136, v140
  v_permlane32_swap_b32 v137, v141
  v_add_f32 v136, v136, v140
  v_add_f32 v137, v137, v141
  v_mul_f32 v136, 0x3b000000, v136
  v_mul_f32 v137, 0x3b000000, v137
  v_fma_f32 v137, -v136, v136, v137
  v_cvt_pk_bf16_f32 v136, 0, v136
  v_max_f32 v137, 0, v137
  v_sub_f32 v140, v196, v136
  v_sub_f32 v141, v197, v136
  v_cvt_pk_bf16_f32 v137, 0, v137
  v_sub_f32 v142, v198, v136
  v_sub_f32 v143, v199, v136
  v_add_f32 v137, 0x3727c5ac, v137
  v_sub_f32 v144, v200, v136
  v_sub_f32 v145, v201, v136
  v_cvt_pk_bf16_f32 v137, 0, v137
  v_sub_f32 v146, v202, v136
  v_sub_f32 v147, v203, v136
  v_sqrt_f32 v137, v137
  v_cvt_pk_bf16_f32 v140, 0, v140
  v_cvt_pk_bf16_f32 v141, 0, v141
  v_cvt_pk_bf16_f32 v137, 0, v137
  v_cvt_pk_bf16_f32 v142, 0, v142
  v_cvt_pk_bf16_f32 v143, 0, v143
  v_rcp_f32 v137, v137
  v_cvt_pk_bf16_f32 v144, 0, v144
  v_cvt_pk_bf16_f32 v145, 0, v145
  v_cvt_pk_bf16_f32 v146, 0, v146
  v_cvt_pk_bf16_f32 v147, 0, v147
  v_mul_f32 v140, v140, v137
  v_mul_f32 v141, v141, v137
  v_mul_f32 v142, v142, v137
  v_mul_f32 v143, v143, v137
  v_mul_f32 v144, v144, v137
  v_mul_f32 v145, v145, v137
  v_mul_f32 v146, v146, v137
  v_mul_f32 v147, v147, v137
  v_cvt_pk_bf16_f32 v124, v140, v141
  v_cvt_pk_bf16_f32 v125, v142, v143
  v_cvt_pk_bf16_f32 v126, v144, v145
  v_cvt_pk_bf16_f32 v127, v146, v147
  v_lshlrev_b32 v204, 16, v124
  v_and_b32 v205, 0xffff0000, v124
  v_lshlrev_b32 v206, 16, v125
  v_and_b32 v207, 0xffff0000, v125
  v_lshlrev_b32 v208, 16, v126
  v_and_b32 v209, 0xffff0000, v126
  v_lshlrev_b32 v210, 16, v127
  v_and_b32 v211, 0xffff0000, v127
  buffer_store_dwordx4 v[124:127], v0, s[4:7], s93 offen sc1
  v_add_f32 v196, v196, v204
  v_add_f32 v197, v197, v205
  v_add_f32 v198, v198, v206
  v_add_f32 v199, v199, v207
  v_add_f32 v200, v200, v208
  v_add_f32 v201, v201, v209
  v_add_f32 v202, v202, v210
  v_add_f32 v203, v203, v211
  v_cvt_pk_bf16_f32 v128, v196, v197
  v_cvt_pk_bf16_f32 v129, v198, v199
  v_cvt_pk_bf16_f32 v130, v200, v201
  v_cvt_pk_bf16_f32 v131, v202, v203
  v_mul_f32 v188, v204, v8
  v_mul_f32 v189, v205, v9
  v_fmac_f32 v188, v206, v10
  v_fmac_f32 v189, v207, v11
  v_fmac_f32 v188, v208, v12
  v_fmac_f32 v189, v209, v13
  v_fmac_f32 v188, v210, v14
  v_fmac_f32 v189, v211, v15
  v_add_f32 v188, v188, v189
  buffer_store_dwordx4 v[128:131], v0, s[68:71], s91 offen sc1
  s_nop 0
  v_add_f32_dpp v188, v188, v188 row_ror:8 row_mask:0xf bank_mask:0xf
  s_nop 1
  v_add_f32_dpp v188, v188, v188 row_ror:4 row_mask:0xf bank_mask:0xf
  s_nop 1
  v_add_f32_dpp v188, v188, v188 row_ror:2 row_mask:0xf bank_mask:0xf
  s_nop 1
  v_add_f32_dpp v188, v188, v188 row_ror:1 row_mask:0xf bank_mask:0xf
  v_mov_b32 v189, v188
  s_nop 0
  s_nop 0
  v_permlane16_swap_b32 v188, v189
  v_add_f32 v188, v188, v189
  v_mov_b32 v189, v188
  s_nop 0
  s_nop 0
  v_permlane32_swap_b32 v188, v189
  v_add_f32 v188, v188, v189
  v_cvt_pk_bf16_f32 v188, 0, v188
  v_ashrrev_i32 v189, 31, v188
  v_or_b32 v189, 0x80000000, v189
  v_xor_b32 v188, v188, v189
  s_sub_u32 s92, 4095, s90
  v_and_b32 v188, 0xffff0000, v188
  v_or_b32 v38, s92, v188
  s_bfe_u32 s92, s65, 196625
  s_lshl_b32 s92, s92, 18
  s_lshl_b32 s93, s90, 7
  s_add_u32 s92, s92, s93
  s_add_u32 s84, s92, 243269632
  s_waitcnt vmcnt(0)
  s_mov_b64 exec, 1
  buffer_store_dword v38, off, s[4:7], s84 sc1
  s_mov_b64 exec, -1
  s_mov_b32 s84, 268435456
  s_branch o_fd_167
o_rt_174:
  s_mov_b32 s67, 0
o_rl_176:
  s_lshl_b32 s94, s43, 14
  s_add_u32 s94, s94, s86
  buffer_load_dwordx4 v[120:123], v5, s[4:7], s94 offen offset:0 sc1
  buffer_load_dwordx4 v[124:127], v5, s[4:7], s94 offen offset:512 sc1
  buffer_load_dwordx4 v[128:131], v5, s[4:7], s94 offen offset:256 sc1
  buffer_load_dwordx4 v[132:135], v5, s[4:7], s94 offen offset:768 sc1
  s_add_u32 s94, s94, 4096
  buffer_load_dwordx4 v[136:139], v5, s[4:7], s94 offen offset:0 sc1
  buffer_load_dwordx4 v[140:143], v5, s[4:7], s94 offen offset:512 sc1
  buffer_load_dwordx4 v[144:147], v5, s[4:7], s94 offen offset:256 sc1
  buffer_load_dwordx4 v[148:151], v5, s[4:7], s94 offen offset:768 sc1
  s_add_u32 s94, s94, 4096
  buffer_load_dwordx4 v[152:155], v5, s[4:7], s94 offen offset:0 sc1
  buffer_load_dwordx4 v[156:159], v5, s[4:7], s94 offen offset:512 sc1
  buffer_load_dwordx4 v[160:163], v5, s[4:7], s94 offen offset:256 sc1
  buffer_load_dwordx4 v[164:167], v5, s[4:7], s94 offen offset:768 sc1
  s_add_u32 s94, s94, 4096
  buffer_load_dwordx4 v[168:171], v5, s[4:7], s94 offen offset:0 sc1
  buffer_load_dwordx4 v[172:175], v5, s[4:7], s94 offen offset:512 sc1
  buffer_load_dwordx4 v[176:179], v5, s[4:7], s94 offen offset:256 sc1
  buffer_load_dwordx4 v[180:183], v5, s[4:7], s94 offen offset:768 sc1
  s_add_u32 s67, s67, 1
  s_cmp_gt_u32 s67, 1048576
  s_cbranch_scc1 L_end
  s_waitcnt vmcnt(0)
  v_xor_b32 v7, s96, v120
  v_bitop3_b32 v7, v7, v124, s96 bitop3:0xf6
  v_bitop3_b32 v7, v7, v128, s96 bitop3:0xf6
  v_bitop3_b32 v7, v7, v132, s96 bitop3:0xf6
  v_bitop3_b32 v7, v7, v136, s96 bitop3:0xf6
  v_bitop3_b32 v7, v7, v140, s96 bitop3:0xf6
  v_bitop3_b32 v7, v7, v144, s96 bitop3:0xf6
  v_bitop3_b32 v7, v7, v148, s96 bitop3:0xf6
  v_bitop3_b32 v7, v7, v152, s96 bitop3:0xf6
  v_bitop3_b32 v7, v7, v156, s96 bitop3:0xf6
  v_bitop3_b32 v7, v7, v160, s96 bitop3:0xf6
  v_bitop3_b32 v7, v7, v164, s96 bitop3:0xf6
  v_bitop3_b32 v7, v7, v168, s96 bitop3:0xf6
  v_bitop3_b32 v7, v7, v172, s96 bitop3:0xf6
  v_bitop3_b32 v7, v7, v176, s96 bitop3:0xf6
  v_bitop3_b32 v7, v7, v180, s96 bitop3:0xf6
  v_and_b32 v7, v254, v7
  v_cmp_ne_u32 vcc, 0, v7
  s_cbranch_vccnz o_rl_176
  s_branch o_bk_175
o_fd_167:
  s_mov_b32 s65, 0
o_nofl_127:
  s_mov_b32 s63, s64
  s_cmp_lg_u32 s51, 0
  s_cbranch_scc1 o_pick_129
  s_cmp_eq_u32 s50, 0
  s_cbranch_scc1 o_help_136_n
o_adv_135:
  s_add_u32 s49, s49, 4
  s_branch o_round_125
o_dl_137_a:
  s_andn2_b32 s26, s58, s55
  s_and_b32 s29, s26, s54
  s_bcnt1_i32_b32 s27, s29
  s_add_u32 s27, s27, 2
  s_max_u32 s27, s27, 4
  s_andn2_b32 s26, s26, s56
  s_and_b32 s26, s26, 0x3fff
  s_or_b32 s26, s26, s29
  s_cselect_b32 s27, s27, 0
  s_mul_i32 s27, s27, 0
  s_cmp_ge_u32 s46, s89
  s_cselect_b32 s30, s54, -1
  s_mov_b32 s31, 243269696
  s_branch o_dl_137_b
o_dl_137:
  s_and_b32 s26, s55, s54
  s_andn2_b32 s27, s56, s54
  s_or_b32 s26, s26, s27
  s_andn2_b32 s26, s58, s26
  s_bcnt1_i32_b32 s27, s26
  s_bcnt1_i32_b32 s28, s47
  s_mul_i32 s28, s28, -5
  s_lshl1_add_u32 s27, s27, s28
  s_add_i32 s27, s27, 1
  s_max_i32 s27, s27, 0
  s_mul_i32 s27, s27, 37
  s_mov_b32 s30, s54
  s_mov_b32 s31, 243269704
  s_and_b32 s29, s26, s47
  s_andn2_b32 s26, s26, s29
  s_branch o_dl_137_c
o_dl_137_b:
  s_mov_b32 s29, 0
o_dl_137_c:
  s_bfe_u32 s28, s48, 262144
  s_bitset0_b32 s26, s28
  s_bfe_u32 s28, s48, 262148
  s_bitset0_b32 s26, s28
  s_bfe_u32 s28, s48, 262152
  s_bitset0_b32 s26, s28
  s_bfe_u32 s28, s48, 262156
  s_bitset0_b32 s26, s28
  s_lshr_b32 s27, s27, 8
o_dl1_138:
  s_cbranch_scc0 o_dl2_139
  s_ff1_i32_b32 s28, s26
  s_bitset0_b32 s26, s28
  s_bitset1_b32 s29, s28
  s_sub_u32 s27, s27, 1
  s_cmp_lg_u32 s27, 0
  s_branch o_dl1_138
o_dl2_139:
  s_and_b32 s47, s29, 0xffff
  s_and_b32 s30, s30, s47
  s_or_b32 s55, s55, s30
  s_andn2_b32 s26, s47, s30
  s_or_b32 s56, s56, s26
  s_pack_ll_b32_b16 s26, s47, s30
  s_lshl_b32 s27, s60, 7
  s_add_u32 s27, s27, s31
  s_cmp_lg_u32 s43, 0
  s_cbranch_scc1 o_pick_129
  v_mov_b32 v162, s26
  v_mov_b32 v163, s46
  s_mov_b64 exec, 1
  buffer_store_dwordx2 v[162:163], off, s[4:7], s27 sc1
  s_mov_b64 exec, -1
  s_branch o_pick_129
o_help_136:
  s_lshl_b32 s60, s60, 1
  s_and_b32 s60, s60, 2
  s_lshl_b32 s47, s60, 7
  s_add_u32 s47, s47, 243269688
o_help_136_n:
  s_add_u32 s47, s47, 8
  s_lshr_b32 s26, s47, 4
  s_andn2_b32 s26, s57, s26
  s_cbranch_scc0 L_end
  s_mov_b32 s67, 0
o_help_136_w:
  buffer_load_dwordx2 v[162:163], off, s[4:7], s47 sc1
  buffer_load_dwordx2 v[164:165], off, s[4:7], s47 offset:128 sc1
  s_add_u32 s67, s67, 1
  s_cmp_gt_u32 s67, 1048576
  s_cbranch_scc1 L_end
  s_waitcnt vmcnt(0)
  v_readfirstlane_b32 s28, v162
  v_readfirstlane_b32 s30, v164
  v_readfirstlane_b32 s46, v163
  v_readfirstlane_b32 s27, v165
  s_min_u32 s26, s46, s27
  s_cmp_eq_u32 s26, 0
  s_cbranch_scc1 o_help_136_w
  s_max_u32 s46, s46, s27
  s_bitreplicate_b64_b32 s[28:29], s28
  s_bitreplicate_b64_b32 s[30:31], s30
  s_mov_b32 s26, 0x55555555
  s_mov_b32 s27, 0x55555555
  s_and_b64 s[28:29], s[28:29], s[26:27]
  s_andn2_b64 s[30:31], s[30:31], s[26:27]
  s_or_b32 s58, s28, s30
  s_or_b32 s54, s29, s31
  s_andn2_b32 s52, 0xfff, s46
  s_lshr_b32 s52, s52, 5
  s_mov_b32 s53, 0
  s_mov_b32 s63, 0
  s_mov_b32 s49, 72
  s_mov_b32 s59, 64
  s_mov_b32 s50, 0
  s_mov_b32 s89, 0
  s_branch o_pick_129
L_o_x:
  s_mov_b32 s62, 1
  s_mov_b32 s42, 0
  s_mov_b32 s3, 0
  s_mov_b32 s46, 0
  s_mov_b32 s65, 0
  s_mov_b32 s66, 0
  s_mov_b32 s76, 0
  s_mov_b32 s55, 0
  s_mov_b32 s48, 0
  s_mov_b32 s56, 0
  s_mov_b32 s84, 268435456
  s_mov_b32 s86, s41
  s_mov_b32 s49, s60
  s_mul_i32 s63, s49, 257
  s_or_b32 s63, s63, 1179648
  s_lshr_b32 s57, s60, 2
  s_cbranch_scc1 o_help_188
o_round_177:
  s_max_u32 s46, s46, s3
  s_cmp_lg_u32 s3, 0
  s_mov_b32 s3, 0
  s_cbranch_scc1 d_g_193
  s_mov_b32 s67, 0
d_w_192:
  s_min_u32 s26, s49, 71
  s_lshl_b32 s26, s26, 12
  s_add_u32 s27, s26, 243494912
  s_add_u32 s26, s26, 243486720
  buffer_load_dword v248, v246, s[4:7], s26 offen sc1
  buffer_load_dword v249, v246, s[4:7], s27 offen sc1
  s_add_u32 s67, s67, 1
  s_cmp_gt_u32 s67, 1048576
  s_cbranch_scc1 L_end
  s_waitcnt vmcnt(0)
  s_mov_b64 exec, 1
  buffer_store_dword v38, off, s[4:7], s84 sc1
  s_mov_b64 exec, -1
  s_mov_b32 s84, 268435456
  v_min_u32 v162, v248, v249
  v_max_u32 v163, v248, v249
  v_cmp_eq_u32 vcc, 0, v162
  s_cbranch_vccnz d_w_192
  v_max_u32_dpp v163, v163, v163 row_ror:8 row_mask:0xf bank_mask:0xf
  s_nop 1
  v_max_u32_dpp v163, v163, v163 row_ror:4 row_mask:0xf bank_mask:0xf
  s_nop 1
  v_max_u32_dpp v163, v163, v163 row_ror:2 row_mask:0xf bank_mask:0xf
  s_nop 1
  v_max_u32_dpp v163, v163, v163 row_ror:1 row_mask:0xf bank_mask:0xf
  s_nop 0
  v_readlane_b32 s28, v163, 0
  v_readlane_b32 s29, v163, 16
  v_readlane_b32 s30, v163, 32
  v_readlane_b32 s31, v163, 48
  s_max_u32 s28, s28, s29
  s_max_u32 s30, s30, s31
  s_max_u32 s46, s46, s28
  s_max_u32 s46, s46, s30
d_g_193:
  s_lshr_b32 s27, s49, 2
  s_andn2_b32 s52, 0xfff, s46
  s_lshr_b32 s52, s52, 5
  s_min_u32 s52, s52, 64
  s_add_u32 s26, s52, 3
  v_readlane_b32 s89, v247, s27
  s_sub_u32 s26, s26, s60
  s_lshr_b32 s26, s26, 2
  s_bfm_b32 s54, s26, 0
  s_add_u32 s53, s63, 1028
  s_cmp_lt_u32 s49, 60
  s_cselect_b32 s53, s53, 0
  s_cmp_lt_u32 s49, 64
  s_cselect_b32 s26, 2, 1
  s_sub_i32 s26, s27, s26
  s_max_i32 s26, s26, 0
  s_min_u32 s26, s26, 16
  s_bfm_b32 s58, s26, 0
  s_cmp_eq_u32 s27, 16
  s_cselect_b32 s59, 1, 1
  s_cmp_eq_u32 s27, 17
  s_cselect_b32 s59, 0, s59
  s_cmp_eq_u32 s27, 18
  s_cselect_b32 s59, 64, s59
  s_cselect_b32 s50, 0, -1
  s_cselect_b32 s89, 0, s89
  s_cbranch_scc1 o_dl_189
  s_cmp_eq_u32 s27, 16
  s_cbranch_scc1 o_dl_189_a
o_pick_181:
  s_cmp_eq_u32 s59, 0
  s_cbranch_scc1 o_none_185
  s_sub_u32 s59, s59, 1
  s_andn2_b32 s26, s58, s55
  s_and_b32 s26, s26, s54
  s_cbranch_scc1 o_ga_182
  s_and_b32 s26, s55, s50
  s_or_b32 s26, s26, s56
  s_or_b32 s26, s26, s54
  s_andn2_b32 s26, s58, s26
  s_cbranch_scc0 o_none_185
  s_cmp_ge_u32 s46, s89
  s_cbranch_scc1 o_gb_183
o_ga_182:
  s_ff1_i32_b32 s26, s26
  s_bitset1_b32 s55, s26
  s_mov_b32 s64, 1327168
  s_mov_b32 s27, s64
  s_branch o_gd_184
o_none_185:
  s_cmp_lt_u32 s49, 60
  s_cbranch_scc1 o_nn_186
  s_cmp_eq_u32 s50, 0
  s_cbranch_scc1 o_nn_186
  s_and_b32 s26, s63, 1097728
  s_cmp_eq_u32 s26, 1048576
  s_cbranch_scc1 o_nn_186
  s_cmp_lt_u32 s49, 64
  s_cbranch_scc1 o_adv_187
  s_and_b32 s26, s65, 1097728
  s_cmp_lg_u32 s26, 1048576
  s_cbranch_scc1 o_adv_187
o_nn_186:
  s_mov_b32 s64, s53
  s_mov_b32 s51, 0
  s_branch o_task_178
o_gb_183:
  s_ff1_i32_b32 s26, s26
  s_bitset1_b32 s56, s26
  s_andn2_b32 s27, 31, s46
  s_or_b32 s27, s27, 32
  s_lshl_b32 s27, s27, 22
  s_or_b32 s27, s27, 1474688
  s_mov_b32 s64, 1474624
o_gd_184:
  s_lshl4_add_u32 s48, s48, s26
  s_and_b32 s28, s26, s57
  s_lshr_b32 s26, s26, s57
  s_lshl2_add_u32 s26, s26, s60
  s_add_u32 s26, s26, s28
  s_cmp_eq_u32 s26, s52
  s_cselect_b32 s64, s27, s64
  s_mul_i32 s26, s26, 257
  s_or_b32 s64, s64, s26
  s_mov_b32 s51, 1
o_task_178:
  s_cmp_eq_u32 s63, 0
  s_cbranch_scc1 o_nofl_179
  s_cmp_lg_u32 s66, 0
  s_cbranch_scc1 o_have_195
  s_mov_b32 s67, 0
o_w1_194:
  s_and_b32 s32, s63, 0xff
  s_lshl_b32 s32, s32, 12
  s_add_u32 s32, s32, s14
  buffer_load_dword v37, v36, s[4:7], s32 offen sc1
  s_add_u32 s67, s67, 1
  s_cmp_gt_u32 s67, 1048576
  s_cbranch_scc1 L_end
  s_waitcnt vmcnt(0)
  s_mov_b64 exec, 1
  buffer_store_dword v38, off, s[4:7], s84 sc1
  s_mov_b64 exec, -1
  s_mov_b32 s84, 268435456
  v_cmp_eq_u32 vcc, 0, v37
  s_cbranch_vccnz o_w1_194
  s_and_b32 s87, s63, 0xff
  s_lshl_b32 s33, s87, 18
  s_lshl_b32 s32, s87, 19
  s_add_u32 m0, s22, 0
  s_add_u32 s33, s33, s19
  buffer_load_dwordx4 v0, s[4:7], s33 offen offset:0 sc1 lds
  buffer_load_dwordx4 v0, s[4:7], s33 offen offset:1024 sc1 lds
  buffer_load_dwordx4 v0, s[4:7], s33 offen offset:2048 sc1 lds
  buffer_load_dwordx4 v0, s[4:7], s33 offen offset:3072 sc1 lds
  s_add_u32 m0, s23, 0
  s_add_u32 s32, s32, s18
  buffer_load_dwordx4 v0, s[4:7], s32 offen offset:0 sc1 lds
  buffer_load_dwordx4 v0, s[4:7], s32 offen offset:1024 sc1 lds
  buffer_load_dwordx4 v0, s[4:7], s32 offen offset:2048 sc1 lds
  buffer_load_dwordx4 v0, s[4:7], s32 offen offset:3072 sc1 lds
  s_add_u32 m0, m0, 4096
  s_add_u32 s32, s32, 4096
  buffer_load_dwordx4 v0, s[4:7], s32 offen offset:0 sc1 lds
  buffer_load_dwordx4 v0, s[4:7], s32 offen offset:1024 sc1 lds
  buffer_load_dwordx4 v0, s[4:7], s32 offen offset:2048 sc1 lds
  buffer_load_dwordx4 v0, s[4:7], s32 offen offset:3072 sc1 lds
  s_waitcnt vmcnt(0)
  s_barrier
o_have_195:
  ds_read_b128 v[120:123], v33 offset:0
  ds_read_b128 v[40:43], v32 offset:0
  ds_read_b128 v[56:59], v32 offset:1024
  ds_read_b128 v[124:127], v33 offset:2048
  ds_read_b128 v[44:47], v32 offset:4096
  ds_read_b128 v[60:63], v32 offset:5120
  ds_read_b128 v[128:131], v33 offset:4096
  ds_read_b128 v[48:51], v32 offset:8192
  ds_read_b128 v[64:67], v32 offset:9216
  ds_read_b128 v[132:135], v33 offset:6144
  ds_read_b128 v[52:55], v32 offset:12288
  ds_read_b128 v[68:71], v32 offset:13312
  s_cmp_lt_u32 s17, 2
  s_cselect_b32 s65, s65, 0
  s_cmp_lg_u32 s65, 0
  s_cselect_b64 s[44:45], -1, 0
  s_mov_b32 s95, s86
  s_mov_b32 s96, s42
  s_lshl_b32 s97, s43, 14
  s_add_u32 s97, s97, s95
  s_and_b32 s87, s64, 0xff
  s_lshl_b32 s87, s87, 12
  s_add_u32 s87, s87, s14
  s_and_b32 s88, s63, 0xff00
  s_lshl_b32 s88, s88, 3
  s_add_u32 s88, s88, s15
  s_and_b32 s91, s65, 63
  s_lshl_b32 s90, s91, 5
  s_add_u32 s94, s90, s85
  s_add_u32 s90, s90, s43
  s_lshl_b32 s94, s94, 10
  s_lshr_b32 s92, s65, 22
  s_xor_b32 s93, s43, 32
  s_lshl_b32 s91, s90, 10
  s_add_u32 s94, s94, 25165824
  s_cmp_eq_u32 s92, s93
  s_cselect_b32 s92, s94, s91
  s_add_u32 s92, s92, 10485760
  s_and_b32 s93, s65, 49152
  s_cselect_b32 s92, s92, s91
  s_cselect_b64 s[80:81], s[4:5], s[72:73]
  s_cselect_b32 s82, s6, s74
  s_waitcnt lgkmcnt(9)
  v_mfma_f32_16x16x32_bf16 v[104:107], v[40:43], v[120:123], v[24:27]
  v_mfma_f32_16x16x32_bf16 v[108:111], v[56:59], v[120:123], v[28:31]
  s_mov_b64 exec, s[44:45]
  buffer_load_dword v7, v255, s[4:7], s97 offen sc1
  buffer_load_dwordx4 v[184:187], v0, s[80:83], s92 offen sc1
  s_not_b64 exec, exec
  buffer_load_dword v37, v36, s[4:7], s87 offen sc1
  s_mov_b64 exec, -1
  buffer_load_dword v244, v252, s[4:7], s88 offen sc1
  s_waitcnt lgkmcnt(6)
  v_mfma_f32_16x16x32_bf16 v[104:107], v[44:47], v[124:127], v[104:107]
  v_mfma_f32_16x16x32_bf16 v[108:111], v[60:63], v[124:127], v[108:111]
  s_waitcnt lgkmcnt(3)
  v_mfma_f32_16x16x32_bf16 v[104:107], v[48:51], v[128:131], v[104:107]
  v_mfma_f32_16x16x32_bf16 v[108:111], v[64:67], v[128:131], v[108:111]
  s_waitcnt lgkmcnt(0)
  v_mfma_f32_16x16x32_bf16 v[104:107], v[52:55], v[132:135], v[104:107]
  v_mfma_f32_16x16x32_bf16 v[108:111], v[68:71], v[132:135], v[108:111]
  s_cmp_lg_u32 s76, 0
  s_cbranch_scc1 o_klds_198
  v_mov_b32 v196, 0
  v_mov_b32 v199, 0
  v_exp_f32 v56, v104
  v_exp_f32 v57, v105
  v_exp_f32 v58, v106
  v_exp_f32 v59, v107
  v_exp_f32 v60, v108
  v_exp_f32 v61, v109
  v_exp_f32 v62, v110
  v_exp_f32 v63, v111
  v_max3_f32 v116, v104, v105, v106
  v_max3_f32 v116, v107, v108, v116
  v_max3_f32 v116, v109, v110, v116
  v_add_f32 v117, v56, v57
  v_add_f32 v118, v58, v59
  v_add_f32 v117, v117, v60
  v_add_f32 v118, v118, v61
  v_add_f32 v117, v117, v62
  v_add_f32 v118, v118, v63
  s_mov_b32 s67, 0
  s_and_b32 s32, s63, 0xff00
  s_lshl_b32 s32, s32, 10
  s_add_u32 s32, s32, s20
  s_add_u32 s33, s32, 4096
o_w2_196:
  s_waitcnt vmcnt(0)
  v_cmp_eq_u32 vcc, 0, v244
  s_cbranch_vccz o_kgo_206
  s_mov_b64 exec, 1
  buffer_store_dword v38, off, s[4:7], s84 sc1
  s_mov_b64 exec, -1
  s_mov_b32 s84, 268435456
  buffer_load_dword v244, v252, s[4:7], s88 offen sc1
  s_add_u32 s67, s67, 1
  s_cmp_gt_u32 s67, 1048576
  s_cbranch_scc1 L_end
  s_branch o_w2_196
o_kgo_206:
  buffer_load_dwordx4 v[136:139], v0, s[4:7], s32 offen offset:0 sc1
  buffer_load_dwordx4 v[140:143], v0, s[4:7], s32 offen offset:1024 sc1
  buffer_load_dwordx4 v[144:147], v0, s[4:7], s32 offen offset:2048 sc1
  buffer_load_dwordx4 v[148:151], v0, s[4:7], s32 offen offset:3072 sc1
  buffer_load_dwordx2 v[200:201], v1, s[4:7], s33 offen offset:0 sc1
  buffer_load_dwordx2 v[202:203], v1, s[4:7], s33 offen offset:512 sc1
  buffer_load_dwordx2 v[204:205], v1, s[4:7], s33 offen offset:1024 sc1
  buffer_load_dwordx2 v[206:207], v1, s[4:7], s33 offen offset:1536 sc1
  buffer_load_dword v37, v36, s[4:7], s87 offen sc1
  buffer_load_dword v244, v252, s[4:7], s88 offen sc1
  s_barrier
  ds_read_b128 v[152:155], v32 offset:2048
  ds_read_b128 v[156:159], v32 offset:3072
  ds_read_b128 v[160:163], v32 offset:6144
  ds_read_b128 v[164:167], v32 offset:7168
  ds_read_b128 v[168:171], v32 offset:10240
  ds_read_b128 v[172:175], v32 offset:11264
  ds_read_b128 v[176:179], v32 offset:14336
  ds_read_b128 v[180:183], v32 offset:15360
  s_waitcnt vmcnt(9)
  v_mfma_f32_16x16x32_bf16 v[112:115], v[136:139], v[120:123], 0
  s_waitcnt vmcnt(8)
  v_mfma_f32_16x16x32_bf16 v[112:115], v[140:143], v[124:127], v[112:115]
  s_waitcnt vmcnt(7)
  v_mfma_f32_16x16x32_bf16 v[112:115], v[144:147], v[128:131], v[112:115]
  s_waitcnt vmcnt(6)
  v_mfma_f32_16x16x32_bf16 v[112:115], v[148:151], v[132:135], v[112:115]
  s_waitcnt vmcnt(2)
  s_branch o_havek_197
o_klds_198:
  s_waitcnt vmcnt(12)
  s_barrier
  ds_read_b128 v[136:139], v34 offset:0
  ds_read_b128 v[140:143], v34 offset:1024
  ds_read_b128 v[144:147], v34 offset:2048
  ds_read_b128 v[148:151], v34 offset:3072
  ds_read_b64 v[200:201], v35 offset:4096
  ds_read_b64 v[202:203], v35 offset:4608
  ds_read_b64 v[204:205], v35 offset:5120
  ds_read_b64 v[206:207], v35 offset:5632
  v_mov_b32 v196, 0
  v_mov_b32 v199, 0
  v_exp_f32 v56, v104
  v_exp_f32 v57, v105
  v_exp_f32 v58, v106
  v_exp_f32 v59, v107
  v_exp_f32 v60, v108
  v_exp_f32 v61, v109
  v_exp_f32 v62, v110
  v_exp_f32 v63, v111
  v_max3_f32 v116, v104, v105, v106
  v_max3_f32 v116, v107, v108, v116
  v_max3_f32 v116, v109, v110, v116
  s_waitcnt lgkmcnt(4)
  v_mfma_f32_16x16x32_bf16 v[112:115], v[136:139], v[120:123], 0
  ds_read_b128 v[152:155], v32 offset:2048
  ds_read_b128 v[156:159], v32 offset:3072
  v_mfma_f32_16x16x32_bf16 v[112:115], v[140:143], v[124:127], v[112:115]
  ds_read_b128 v[160:163], v32 offset:6144
  ds_read_b128 v[164:167], v32 offset:7168
  v_mfma_f32_16x16x32_bf16 v[112:115], v[144:147], v[128:131], v[112:115]
  ds_read_b128 v[168:171], v32 offset:10240
  ds_read_b128 v[172:175], v32 offset:11264
  v_mfma_f32_16x16x32_bf16 v[112:115], v[148:151], v[132:135], v[112:115]
  ds_read_b128 v[176:179], v32 offset:14336
  ds_read_b128 v[180:183], v32 offset:15360
  v_add_f32 v117, v56, v57
  v_add_f32 v118, v58, v59
  v_add_f32 v117, v117, v60
  v_add_f32 v118, v118, v61
  v_add_f32 v117, v117, v62
  v_add_f32 v118, v118, v63
o_havek_197:
  s_cmp_lg_u32 s65, 0
  s_cbranch_scc1 o_wr1_203
  s_nop 3
  v_mul_f32 v112, s24, v112
  v_mul_f32 v113, s24, v113
  v_exp_f32 v64, v112
  v_exp_f32 v65, v113
  v_max_f32 v116, v111, v116
  v_max3_f32 v116, v112, v113, v116
  v_add_f32 v117, v117, v64
  v_add_f32 v118, v118, v65
  v_add_f32 v117, v117, v118
  s_mov_b32 s28, 0x21800000
  v_mov_b32 v118, v117
  s_nop 1
  v_permlane16_swap_b32 v117, v118
  v_add_f32 v117, v117, v118
  v_mov_b32 v118, v117
  s_nop 0
  s_nop 0
  v_permlane32_swap_b32 v117, v118
  v_add_f32 v117, v117, v118
  v_cmp_lt_f32 vcc, 0x42700000, v116
  v_cmp_gt_f32 s[30:31], s28, v117
  v_rcp_f32 v117, v117
  s_or_b64 vcc, vcc, s[30:31]
  s_cbranch_vccnz o_fb_207
o_fbr_208:
  v_pk_mul_f32 v[56:57], v[56:57], v[116:117] op_sel:[0,1] op_sel_hi:[1,1]
  v_pk_mul_f32 v[58:59], v[58:59], v[116:117] op_sel:[0,1] op_sel_hi:[1,1]
  v_pk_mul_f32 v[60:61], v[60:61], v[116:117] op_sel:[0,1] op_sel_hi:[1,1]
  v_pk_mul_f32 v[62:63], v[62:63], v[116:117] op_sel:[0,1] op_sel_hi:[1,1]
  v_pk_mul_f32 v[64:65], v[64:65], v[116:117] op_sel:[0,1] op_sel_hi:[1,1]
  v_cvt_pk_bf16_f32 v116, v56, v57
  v_cvt_pk_bf16_f32 v117, v58, v59
  v_cvt_pk_bf16_f32 v118, v60, v61
  v_cvt_pk_bf16_f32 v119, v62, v63
  s_waitcnt lgkmcnt(0)
  s_nop 0
  v_mfma_f32_16x16x32_bf16 v[72:75], v[152:155], v[116:119], 0
  s_add_u32 s62, s62, 1
  v_cvt_pk_bf16_f32 v197, v64, v65
  v_cvt_pk_bf16_f32 v198, v64, v65
  v_mfma_f32_16x16x32_bf16 v[76:79], v[156:159], v[116:119], 0
  s_xor_b32 s86, s86, 524288
  v_mfma_f32_16x16x32_bf16 v[80:83], v[160:163], v[116:119], 0
  s_bfe_u32 s42, s62, 0x10001
  v_mfma_f32_16x16x32_bf16 v[84:87], v[164:167], v[116:119], 0
  s_bfe_u32 s26, s64, 65556
  v_mfma_f32_16x16x32_bf16 v[88:91], v[168:171], v[116:119], 0
  s_and_b32 s87, s64, 0xff
  v_mfma_f32_16x16x32_bf16 v[92:95], v[172:175], v[116:119], 0
  s_bfe_u32 s88, s64, 0x80008
  v_mfma_f32_16x16x32_bf16 v[96:99], v[176:179], v[116:119], 0
  s_nop 0
  v_mfma_f32_16x16x32_bf16 v[100:103], v[180:183], v[116:119], 0
  s_nop 0
  v_mfma_f32_16x16x16_bf16 v[72:75], v[200:201], v[198:199], v[72:75]
  s_nop 1
  v_mfma_f32_16x16x16_bf16 v[76:79], v[200:201], v[196:197], v[76:79]
  s_nop 1
  v_mfma_f32_16x16x16_bf16 v[80:83], v[202:203], v[198:199], v[80:83]
  s_nop 1
  v_mfma_f32_16x16x16_bf16 v[84:87], v[202:203], v[196:197], v[84:87]
  s_nop 1
  v_mfma_f32_16x16x16_bf16 v[88:91], v[204:205], v[198:199], v[88:91]
  s_nop 0
  v_cvt_pk_bf16_f32 v40, v72, v73
  v_cvt_pk_bf16_f32 v41, v74, v75
  v_mfma_f32_16x16x16_bf16 v[92:95], v[204:205], v[196:197], v[92:95]
  s_nop 0
  v_cvt_pk_bf16_f32 v42, v76, v77
  v_cvt_pk_bf16_f32 v43, v78, v79
  v_mfma_f32_16x16x16_bf16 v[96:99], v[206:207], v[198:199], v[96:99]
  s_nop 0
  ds_write_b128 v6, v[40:43] offset:0
  v_cvt_pk_bf16_f32 v44, v80, v81
  v_mfma_f32_16x16x16_bf16 v[100:103], v[206:207], v[196:197], v[100:103]
  s_nop 0
  v_cvt_pk_bf16_f32 v45, v82, v83
  v_cvt_pk_bf16_f32 v46, v84, v85
  v_cvt_pk_bf16_f32 v47, v86, v87
  ds_write_b128 v6, v[44:47] offset:1024
  v_cvt_pk_bf16_f32 v48, v88, v89
  v_cvt_pk_bf16_f32 v49, v90, v91
  v_cvt_pk_bf16_f32 v50, v92, v93
  v_cvt_pk_bf16_f32 v51, v94, v95
  ds_write_b128 v6, v[48:51] offset:2048
  v_cvt_pk_bf16_f32 v52, v96, v97
  v_cvt_pk_bf16_f32 v53, v98, v99
  v_cvt_pk_bf16_f32 v54, v100, v101
  v_cvt_pk_bf16_f32 v55, v102, v103
  ds_write_b128 v6, v[52:55] offset:3072
  s_cmp_lt_u32 s17, 2
  s_cbranch_scc1 o_wr0_202
  s_waitcnt lgkmcnt(0)
  s_barrier
  ds_read_b128 v[104:107], v3 offset:0
  ds_read_b128 v[108:111], v3 offset:512
  ds_read_b128 v[112:115], v3 offset:1024
  s_waitcnt lgkmcnt(2)
  v_mfma_f32_32x32x16_bf16 v[40:55], v[104:107], a[0:3], 0
  s_waitcnt vmcnt(0)
  v_cmp_eq_u32 vcc, 0, v37
  s_cmp_eq_u64 vcc, 0
  s_cselect_b32 s66, s26, 0
  s_cmp_eq_u32 s66, 1
  s_cselect_b32 s87, s87, 1024
  s_cselect_b32 s34, 0, 0x28000
  v_mfma_f32_32x32x16_bf16 v[56:71], v[104:107], a[4:7], 0
  ds_read_b128 v[116:119], v3 offset:1536
  s_lshl_b32 s33, s87, 18
  s_lshl_b32 s32, s87, 19
  s_add_u32 m0, s22, s34
  s_add_u32 s33, s33, s19
  s_min_u32 s28, s49, 67
  v_mfma_f32_32x32x16_bf16 v[72:87], v[104:107], a[8:11], 0
  s_lshl1_add_u32 s28, s17, s28
  s_lshl_b32 s28, s28, 12
  s_add_u32 s28, s28, 243486720
  v_mfma_f32_32x32x16_bf16 v[88:103], v[104:107], a[12:15], 0
  buffer_load_dword v249, v246, s[4:7], s28 offen sc1
  s_waitcnt lgkmcnt(2)
  v_mfma_f32_32x32x16_bf16 v[40:55], v[108:111], a[16:19], v[40:55]
  buffer_load_dwordx4 v0, s[4:7], s33 offen offset:0 sc1 lds
  v_mfma_f32_32x32x16_bf16 v[56:71], v[108:111], a[20:23], v[56:71]
  ds_read_b128 v[104:107], v3 offset:2048
  v_mfma_f32_32x32x16_bf16 v[72:87], v[108:111], a[24:27], v[72:87]
  buffer_load_dwordx4 v0, s[4:7], s33 offen offset:1024 sc1 lds
  v_mfma_f32_32x32x16_bf16 v[88:103], v[108:111], a[28:31], v[88:103]
  buffer_load_dwordx4 v0, s[4:7], s33 offen offset:2048 sc1 lds
  s_waitcnt lgkmcnt(2)
  v_mfma_f32_32x32x16_bf16 v[40:55], v[112:115], a[32:35], v[40:55]
  v_mfma_f32_32x32x16_bf16 v[56:71], v[112:115], a[36:39], v[56:71]
  ds_read_b128 v[108:111], v3 offset:2560
  buffer_load_dwordx4 v0, s[4:7], s33 offen offset:3072 sc1 lds
  s_sub_u32 m0, m0, 8192
  s_sub_u32 s33, s33, 8192
  v_mfma_f32_32x32x16_bf16 v[72:87], v[112:115], a[40:43], v[72:87]
  buffer_load_dwordx4 v0, s[4:7], s33 offen offset:0 sc1 lds
  v_mfma_f32_32x32x16_bf16 v[88:103], v[112:115], a[44:47], v[88:103]
  s_waitcnt lgkmcnt(2)
  v_mfma_f32_32x32x16_bf16 v[40:55], v[116:119], a[48:51], v[40:55]
  buffer_load_dwordx4 v0, s[4:7], s33 offen offset:1024 sc1 lds
  v_mfma_f32_32x32x16_bf16 v[56:71], v[116:119], a[52:55], v[56:71]
  ds_read_b128 v[112:115], v3 offset:3072
  buffer_load_dwordx4 v0, s[4:7], s33 offen offset:2048 sc1 lds
  v_mfma_f32_32x32x16_bf16 v[72:87], v[116:119], a[56:59], v[72:87]
  v_mfma_f32_32x32x16_bf16 v[88:103], v[116:119], a[60:63], v[88:103]
  buffer_load_dwordx4 v0, s[4:7], s33 offen offset:3072 sc1 lds
  s_add_u32 m0, s23, s34
  s_add_u32 s32, s32, s18
  s_waitcnt lgkmcnt(2)
  v_mfma_f32_32x32x16_bf16 v[40:55], v[104:107], a[64:67], v[40:55]
  buffer_load_dwordx4 v0, s[4:7], s32 offen offset:0 sc1 lds
  v_mfma_f32_32x32x16_bf16 v[56:71], v[104:107], a[68:71], v[56:71]
  ds_read_b128 v[116:119], v3 offset:3584
  v_mfma_f32_32x32x16_bf16 v[72:87], v[104:107], a[72:75], v[72:87]
  buffer_load_dwordx4 v0, s[4:7], s32 offen offset:1024 sc1 lds
  s_add_i32 m0, m0, 4096
  s_add_i32 s32, s32, 4096
  v_mfma_f32_32x32x16_bf16 v[88:103], v[104:107], a[76:79], v[88:103]
  buffer_load_dwordx4 v0, s[4:7], s32 offen offset:0 sc1 lds
  s_waitcnt lgkmcnt(2)
  v_mfma_f32_32x32x16_bf16 v[40:55], v[108:111], a[80:83], v[40:55]
  v_mfma_f32_32x32x16_bf16 v[56:71], v[108:111], a[84:87], v[56:71]
  ds_read_b128 v[104:107], v3 offset:8192
  buffer_load_dwordx4 v0, s[4:7], s32 offen offset:1024 sc1 lds
  s_add_i32 m0, m0, -16384
  s_add_i32 s32, s32, -16384
  v_mfma_f32_32x32x16_bf16 v[72:87], v[108:111], a[88:91], v[72:87]
  s_and_b32 s29, s64, 0xff00
  s_lshl_b32 s29, s29, 3
  s_add_u32 s29, s29, s15
  buffer_load_dword v245, v252, s[4:7], s29 offen sc1
  v_mfma_f32_32x32x16_bf16 v[88:103], v[108:111], a[92:95], v[88:103]
  s_waitcnt lgkmcnt(2)
  v_mfma_f32_32x32x16_bf16 v[40:55], v[112:115], a[96:99], v[40:55]
  buffer_load_dwordx4 v0, s[4:7], s32 offen offset:0 sc1 lds
  v_mfma_f32_32x32x16_bf16 v[56:71], v[112:115], a[100:103], v[56:71]
  ds_read_b128 v[108:111], v3 offset:8704
  buffer_load_dwordx4 v0, s[4:7], s32 offen offset:1024 sc1 lds
  s_add_i32 m0, m0, -4096
  s_add_i32 s32, s32, -4096
  v_mfma_f32_32x32x16_bf16 v[72:87], v[112:115], a[104:107], v[72:87]
  v_mfma_f32_32x32x16_bf16 v[88:103], v[112:115], a[108:111], v[88:103]
  buffer_load_dwordx4 v0, s[4:7], s32 offen offset:0 sc1 lds
  s_waitcnt lgkmcnt(2)
  v_mfma_f32_32x32x16_bf16 v[40:55], v[116:119], a[112:115], v[40:55]
  buffer_load_dwordx4 v0, s[4:7], s32 offen offset:1024 sc1 lds
  v_mfma_f32_32x32x16_bf16 v[56:71], v[116:119], a[116:119], v[56:71]
  ds_read_b128 v[112:115], v3 offset:9216
  v_mfma_f32_32x32x16_bf16 v[72:87], v[116:119], a[120:123], v[72:87]
  buffer_load_dwordx4 v0, s[4:7], s32 offen offset:2048 sc1 lds
  v_mfma_f32_32x32x16_bf16 v[88:103], v[116:119], a[124:127], v[88:103]
  buffer_load_dwordx4 v0, s[4:7], s32 offen offset:3072 sc1 lds
  s_add_i32 m0, m0, 4096
  s_add_i32 s32, s32, 4096
  s_waitcnt lgkmcnt(2)
  v_mfma_f32_32x32x16_bf16 v[40:55], v[104:107], a[128:131], v[40:55]
  v_mfma_f32_32x32x16_bf16 v[56:71], v[104:107], a[132:135], v[56:71]
  ds_read_b128 v[116:119], v3 offset:9728
  buffer_load_dwordx4 v0, s[4:7], s32 offen offset:2048 sc1 lds
  v_mfma_f32_32x32x16_bf16 v[72:87], v[104:107], a[136:139], v[72:87]
  buffer_load_dwordx4 v0, s[4:7], s32 offen offset:3072 sc1 lds
  s_add_i32 m0, m0, 16384
  s_add_i32 s32, s32, 16384
  v_mfma_f32_32x32x16_bf16 v[88:103], v[104:107], a[140:143], v[88:103]
  s_waitcnt lgkmcnt(2)
  v_mfma_f32_32x32x16_bf16 v[40:55], v[108:111], a[144:147], v[40:55]
  buffer_load_dwordx4 v0, s[4:7], s32 offen offset:2048 sc1 lds
  v_mfma_f32_32x32x16_bf16 v[56:71], v[108:111], a[148:151], v[56:71]
  ds_read_b128 v[104:107], v3 offset:10240
  buffer_load_dwordx4 v0, s[4:7], s32 offen offset:3072 sc1 lds
  s_add_i32 m0, m0, -4096
  s_add_i32 s32, s32, -4096
  v_mfma_f32_32x32x16_bf16 v[72:87], v[108:111], a[152:155], v[72:87]
  v_mfma_f32_32x32x16_bf16 v[88:103], v[108:111], a[156:159], v[88:103]
  buffer_load_dwordx4 v0, s[4:7], s32 offen offset:2048 sc1 lds
  s_waitcnt lgkmcnt(2)
  v_mfma_f32_32x32x16_bf16 v[40:55], v[112:115], a[160:163], v[40:55]
  buffer_load_dwordx4 v0, s[4:7], s32 offen offset:3072 sc1 lds
  v_mfma_f32_32x32x16_bf16 v[56:71], v[112:115], a[164:167], v[56:71]
  ds_read_b128 v[108:111], v3 offset:10752
  v_mfma_f32_32x32x16_bf16 v[72:87], v[112:115], a[168:171], v[72:87]
  v_mfma_f32_32x32x16_bf16 v[88:103], v[112:115], a[172:175], v[88:103]
  s_waitcnt lgkmcnt(2)
  v_mfma_f32_32x32x16_bf16 v[40:55], v[116:119], a[176:179], v[40:55]
  v_mfma_f32_32x32x16_bf16 v[56:71], v[116:119], a[180:183], v[56:71]
  ds_read_b128 v[112:115], v3 offset:11264
  v_mfma_f32_32x32x16_bf16 v[72:87], v[116:119], a[184:187], v[72:87]
  v_mfma_f32_32x32x16_bf16 v[88:103], v[116:119], a[188:191], v[88:103]
  s_waitcnt lgkmcnt(2)
  v_mfma_f32_32x32x16_bf16 v[40:55], v[104:107], a[192:195], v[40:55]
  v_mfma_f32_32x32x16_bf16 v[56:71], v[104:107], a[196:199], v[56:71]
  ds_read_b128 v[116:119], v3 offset:11776
  s_waitcnt vmcnt(12)
  v_cmp_eq_u32 vcc, 0, v245
  s_cmp_eq_u64 vcc, 0
  s_cselect_b32 s76, s26, 0
  s_and_b32 s76, s76, 1
  s_cselect_b32 s88, s88, 1024
  s_waitcnt lgkmcnt(2)
  v_mfma_f32_32x32x16_bf16 v[40:55], v[108:111], a[208:211], v[40:55]
  s_lshl_b32 s32, s88, 18
  s_mov_b32 m0, s40
  s_add_u32 s32, s32, s21
  buffer_load_dwordx4 v0, s[4:7], s32 offen offset:0 sc1 lds
  v_mfma_f32_32x32x16_bf16 v[56:71], v[108:111], a[212:215], v[56:71]
  buffer_load_dwordx4 v0, s[4:7], s32 offen offset:1024 sc1 lds
  s_waitcnt lgkmcnt(1)
  v_mfma_f32_32x32x16_bf16 v[40:55], v[112:115], a[224:227], v[40:55]
  buffer_load_dwordx4 v0, s[4:7], s32 offen offset:2048 sc1 lds
  s_sub_u32 m0, m0, 8192
  s_sub_u32 s32, s32, 8192
  v_mfma_f32_32x32x16_bf16 v[56:71], v[112:115], a[228:231], v[56:71]
  buffer_load_dwordx4 v0, s[4:7], s32 offen offset:0 sc1 lds
  s_waitcnt lgkmcnt(0)
  v_mfma_f32_32x32x16_bf16 v[40:55], v[116:119], a[240:243], v[40:55]
  buffer_load_dwordx4 v0, s[4:7], s32 offen offset:1024 sc1 lds
  v_mfma_f32_32x32x16_bf16 v[56:71], v[116:119], a[244:247], v[56:71]
  buffer_load_dwordx4 v0, s[4:7], s32 offen offset:2048 sc1 lds
  v_cmp_eq_u32 vcc, 0, v249
  v_max_u32_dpp v249, v249, v249 row_ror:8 row_mask:0xf bank_mask:0xf
  s_nop 0
  v_mfma_f32_32x32x16_bf16 v[72:87], v[104:107], a[200:203], v[72:87]
  v_max_u32_dpp v249, v249, v249 row_ror:4 row_mask:0xf bank_mask:0xf
  s_nop 0
  s_nop 0
  v_max_u32_dpp v249, v249, v249 row_ror:2 row_mask:0xf bank_mask:0xf
  s_nop 0
  s_nop 0
  v_max_u32_dpp v249, v249, v249 row_ror:1 row_mask:0xf bank_mask:0xf
  s_nop 0
  v_mfma_f32_32x32x16_bf16 v[88:103], v[104:107], a[204:207], v[88:103]
  v_mov_b32 v248, v249
  s_nop 0
  s_nop 0
  v_permlane16_swap_b32 v249, v248
  v_max_u32 v249, v249, v248
  v_mfma_f32_32x32x16_bf16 v[72:87], v[108:111], a[216:219], v[72:87]
  v_mov_b32 v248, v249
  s_nop 0
  s_nop 0
  v_permlane32_swap_b32 v249, v248
  v_max_u32 v249, v249, v248
  s_cmp_eq_u64 vcc, 0
  s_cselect_b32 s28, 4, 0
  v_mfma_f32_32x32x16_bf16 v[88:103], v[108:111], a[220:223], v[88:103]
  s_lshl_b32 s26, s76, 1
  s_or_b32 s26, s26, s66
  s_or_b32 s26, s26, s28
  v_mov_b32 v248, s26
  ds_write_b64 v39, v[248:249]
  v_mfma_f32_32x32x16_bf16 v[72:87], v[112:115], a[232:235], v[72:87]
  v_cvt_pk_bf16_f32 v212, v40, v56
  v_cvt_pk_bf16_f32 v214, v41, v57
  v_cvt_pk_bf16_f32 v216, v42, v58
  v_cvt_pk_bf16_f32 v218, v43, v59
  v_permlane16_swap_b32 v212, v214
  v_mfma_f32_32x32x16_bf16 v[88:103], v[112:115], a[236:239], v[88:103]
  v_cvt_pk_bf16_f32 v220, v44, v60
  v_cvt_pk_bf16_f32 v222, v45, v61
  v_permlane16_swap_b32 v216, v218
  v_bfi_b32 v212, v254, s42, v212
  v_mfma_f32_32x32x16_bf16 v[72:87], v[116:119], a[248:251], v[72:87]
  v_cvt_pk_bf16_f32 v224, v46, v62
  v_cvt_pk_bf16_f32 v226, v47, v63
  v_permlane16_swap_b32 v220, v222
  v_bfi_b32 v216, v254, s42, v216
  v_cvt_pk_bf16_f32 v228, v48, v64
  v_mfma_f32_32x32x16_bf16 v[88:103], v[116:119], a[252:255], v[88:103]
  v_cvt_pk_bf16_f32 v230, v49, v65
  v_permlane16_swap_b32 v224, v226
  v_bfi_b32 v220, v254, s42, v220
  v_cvt_pk_bf16_f32 v232, v50, v66
  v_cvt_pk_bf16_f32 v234, v51, v67
  v_permlane16_swap_b32 v228, v230
  v_bfi_b32 v224, v254, s42, v224
  v_cvt_pk_bf16_f32 v236, v52, v68
  v_cvt_pk_bf16_f32 v238, v53, v69
  v_permlane16_swap_b32 v232, v234
  v_bfi_b32 v228, v254, s42, v228
  v_cvt_pk_bf16_f32 v240, v54, v70
  v_cvt_pk_bf16_f32 v242, v55, v71
  v_permlane16_swap_b32 v236, v238
  v_bfi_b32 v232, v254, s42, v232
  v_permlane16_swap_b32 v240, v242
  v_bfi_b32 v236, v254, s42, v236
  v_bfi_b32 v240, v254, s42, v240
  v_cvt_pk_bf16_f32 v213, v72, v88
  v_cvt_pk_bf16_f32 v215, v73, v89
  v_cvt_pk_bf16_f32 v217, v74, v90
  v_cvt_pk_bf16_f32 v219, v75, v91
  s_add_u32 s78, s86, 0
  v_permlane16_swap_b32 v213, v215
  buffer_store_dwordx4 v[212:215], v4, s[4:7], s78 offen sc1
  v_cvt_pk_bf16_f32 v221, v76, v92
  v_cvt_pk_bf16_f32 v223, v77, v93
  s_add_u32 s78, s86, 32768
  v_permlane16_swap_b32 v217, v219
  buffer_store_dwordx4 v[216:219], v4, s[4:7], s78 offen sc1
  v_cvt_pk_bf16_f32 v225, v78, v94
  v_cvt_pk_bf16_f32 v227, v79, v95
  s_add_u32 s78, s86, 131072
  v_permlane16_swap_b32 v221, v223
  buffer_store_dwordx4 v[220:223], v4, s[4:7], s78 offen sc1
  v_cvt_pk_bf16_f32 v229, v80, v96
  v_cvt_pk_bf16_f32 v231, v81, v97
  s_add_u32 s78, s86, 163840
  v_permlane16_swap_b32 v225, v227
  buffer_store_dwordx4 v[224:227], v4, s[4:7], s78 offen sc1
  v_cvt_pk_bf16_f32 v233, v82, v98
  v_cvt_pk_bf16_f32 v235, v83, v99
  s_add_u32 s78, s86, 262144
  v_permlane16_swap_b32 v229, v231
  buffer_store_dwordx4 v[228:231], v4, s[4:7], s78 offen sc1
  v_cvt_pk_bf16_f32 v237, v84, v100
  v_cvt_pk_bf16_f32 v239, v85, v101
  s_add_u32 s78, s86, 294912
  v_permlane16_swap_b32 v233, v235
  buffer_store_dwordx4 v[232:235], v4, s[4:7], s78 offen sc1
  v_cvt_pk_bf16_f32 v241, v86, v102
  v_cvt_pk_bf16_f32 v243, v87, v103
  s_add_u32 s78, s86, 393216
  v_permlane16_swap_b32 v237, v239
  buffer_store_dwordx4 v[236:239], v4, s[4:7], s78 offen sc1
  s_add_u32 s78, s86, 425984
  v_permlane16_swap_b32 v241, v243
  buffer_store_dwordx4 v[240:243], v4, s[4:7], s78 offen sc1
  s_waitcnt vmcnt(22)
  s_branch o_we_205
o_wr0_202:
  s_waitcnt lgkmcnt(0)
  s_barrier
  ds_read_b128 v[104:107], v3 offset:0
  ds_read_b128 v[108:111], v3 offset:512
  ds_read_b128 v[112:115], v3 offset:1024
  s_waitcnt lgkmcnt(2)
  v_mfma_f32_32x32x16_bf16 v[40:55], v[104:107], a[0:3], 0
  v_mfma_f32_32x32x16_bf16 v[56:71], v[104:107], a[4:7], 0
  ds_read_b128 v[116:119], v3 offset:1536
  v_mfma_f32_32x32x16_bf16 v[72:87], v[104:107], a[8:11], 0
  v_mfma_f32_32x32x16_bf16 v[88:103], v[104:107], a[12:15], 0
  s_waitcnt lgkmcnt(2)
  v_mfma_f32_32x32x16_bf16 v[40:55], v[108:111], a[16:19], v[40:55]
  v_mfma_f32_32x32x16_bf16 v[56:71], v[108:111], a[20:23], v[56:71]
  ds_read_b128 v[104:107], v3 offset:2048
  v_mfma_f32_32x32x16_bf16 v[72:87], v[108:111], a[24:27], v[72:87]
  v_mfma_f32_32x32x16_bf16 v[88:103], v[108:111], a[28:31], v[88:103]
  s_waitcnt lgkmcnt(2)
  v_mfma_f32_32x32x16_bf16 v[40:55], v[112:115], a[32:35], v[40:55]
  v_mfma_f32_32x32x16_bf16 v[56:71], v[112:115], a[36:39], v[56:71]
  ds_read_b128 v[108:111], v3 offset:2560
  v_mfma_f32_32x32x16_bf16 v[72:87], v[112:115], a[40:43], v[72:87]
  v_mfma_f32_32x32x16_bf16 v[88:103], v[112:115], a[44:47], v[88:103]
  s_waitcnt lgkmcnt(2)
  v_mfma_f32_32x32x16_bf16 v[40:55], v[116:119], a[48:51], v[40:55]
  v_mfma_f32_32x32x16_bf16 v[56:71], v[116:119], a[52:55], v[56:71]
  ds_read_b128 v[112:115], v3 offset:3072
  v_mfma_f32_32x32x16_bf16 v[72:87], v[116:119], a[56:59], v[72:87]
  v_mfma_f32_32x32x16_bf16 v[88:103], v[116:119], a[60:63], v[88:103]
  s_waitcnt lgkmcnt(2)
  v_mfma_f32_32x32x16_bf16 v[40:55], v[104:107], a[64:67], v[40:55]
  v_mfma_f32_32x32x16_bf16 v[56:71], v[104:107], a[68:71], v[56:71]
  ds_read_b128 v[116:119], v3 offset:3584
  v_mfma_f32_32x32x16_bf16 v[72:87], v[104:107], a[72:75], v[72:87]
  v_mfma_f32_32x32x16_bf16 v[88:103], v[104:107], a[76:79], v[88:103]
  s_waitcnt lgkmcnt(2)
  v_mfma_f32_32x32x16_bf16 v[40:55], v[108:111], a[80:83], v[40:55]
  v_mfma_f32_32x32x16_bf16 v[56:71], v[108:111], a[84:87], v[56:71]
  ds_read_b128 v[104:107], v3 offset:8192
  v_mfma_f32_32x32x16_bf16 v[72:87], v[108:111], a[88:91], v[72:87]
  v_mfma_f32_32x32x16_bf16 v[88:103], v[108:111], a[92:95], v[88:103]
  s_waitcnt lgkmcnt(2)
  v_mfma_f32_32x32x16_bf16 v[40:55], v[112:115], a[96:99], v[40:55]
  v_mfma_f32_32x32x16_bf16 v[56:71], v[112:115], a[100:103], v[56:71]
  ds_read_b128 v[108:111], v3 offset:8704
  v_mfma_f32_32x32x16_bf16 v[72:87], v[112:115], a[104:107], v[72:87]
  v_mfma_f32_32x32x16_bf16 v[88:103], v[112:115], a[108:111], v[88:103]
  s_waitcnt lgkmcnt(2)
  v_mfma_f32_32x32x16_bf16 v[40:55], v[116:119], a[112:115], v[40:55]
  v_mfma_f32_32x32x16_bf16 v[56:71], v[116:119], a[116:119], v[56:71]
  ds_read_b128 v[112:115], v3 offset:9216
  v_mfma_f32_32x32x16_bf16 v[72:87], v[116:119], a[120:123], v[72:87]
  v_mfma_f32_32x32x16_bf16 v[88:103], v[116:119], a[124:127], v[88:103]
  s_waitcnt lgkmcnt(2)
  v_mfma_f32_32x32x16_bf16 v[40:55], v[104:107], a[128:131], v[40:55]
  v_mfma_f32_32x32x16_bf16 v[56:71], v[104:107], a[132:135], v[56:71]
  ds_read_b128 v[116:119], v3 offset:9728
  v_mfma_f32_32x32x16_bf16 v[72:87], v[104:107], a[136:139], v[72:87]
  v_mfma_f32_32x32x16_bf16 v[88:103], v[104:107], a[140:143], v[88:103]
  s_waitcnt lgkmcnt(2)
  v_mfma_f32_32x32x16_bf16 v[40:55], v[108:111], a[144:147], v[40:55]
  v_mfma_f32_32x32x16_bf16 v[56:71], v[108:111], a[148:151], v[56:71]
  ds_read_b128 v[104:107], v3 offset:10240
  v_mfma_f32_32x32x16_bf16 v[72:87], v[108:111], a[152:155], v[72:87]
  v_mfma_f32_32x32x16_bf16 v[88:103], v[108:111], a[156:159], v[88:103]
  s_waitcnt lgkmcnt(2)
  v_mfma_f32_32x32x16_bf16 v[40:55], v[112:115], a[160:163], v[40:55]
  v_mfma_f32_32x32x16_bf16 v[56:71], v[112:115], a[164:167], v[56:71]
  ds_read_b128 v[108:111], v3 offset:10752
  v_mfma_f32_32x32x16_bf16 v[72:87], v[112:115], a[168:171], v[72:87]
  v_mfma_f32_32x32x16_bf16 v[88:103], v[112:115], a[172:175], v[88:103]
  s_waitcnt lgkmcnt(2)
  v_mfma_f32_32x32x16_bf16 v[40:55], v[116:119], a[176:179], v[40:55]
  v_mfma_f32_32x32x16_bf16 v[56:71], v[116:119], a[180:183], v[56:71]
  ds_read_b128 v[112:115], v3 offset:11264
  v_mfma_f32_32x32x16_bf16 v[72:87], v[116:119], a[184:187], v[72:87]
  v_mfma_f32_32x32x16_bf16 v[88:103], v[116:119], a[188:191], v[88:103]
  s_waitcnt lgkmcnt(2)
  v_mfma_f32_32x32x16_bf16 v[40:55], v[104:107], a[192:195], v[40:55]
  v_mfma_f32_32x32x16_bf16 v[56:71], v[104:107], a[196:199], v[56:71]
  ds_read_b128 v[116:119], v3 offset:11776
  s_waitcnt lgkmcnt(2)
  v_mfma_f32_32x32x16_bf16 v[40:55], v[108:111], a[208:211], v[40:55]
  v_mfma_f32_32x32x16_bf16 v[56:71], v[108:111], a[212:215], v[56:71]
  s_waitcnt lgkmcnt(1)
  v_mfma_f32_32x32x16_bf16 v[40:55], v[112:115], a[224:227], v[40:55]
  v_mfma_f32_32x32x16_bf16 v[56:71], v[112:115], a[228:231], v[56:71]
  s_waitcnt lgkmcnt(0)
  v_mfma_f32_32x32x16_bf16 v[40:55], v[116:119], a[240:243], v[40:55]
  v_mfma_f32_32x32x16_bf16 v[56:71], v[116:119], a[244:247], v[56:71]
  v_mfma_f32_32x32x16_bf16 v[72:87], v[104:107], a[200:203], v[72:87]
  v_mfma_f32_32x32x16_bf16 v[88:103], v[104:107], a[204:207], v[88:103]
  v_cvt_pk_bf16_f32 v212, v40, v56
  v_cvt_pk_bf16_f32 v214, v41, v57
  v_cvt_pk_bf16_f32 v216, v42, v58
  v_cvt_pk_bf16_f32 v218, v43, v59
  v_permlane16_swap_b32 v212, v214
  v_mfma_f32_32x32x16_bf16 v[72:87], v[108:111], a[216:219], v[72:87]
  v_cvt_pk_bf16_f32 v220, v44, v60
  v_cvt_pk_bf16_f32 v222, v45, v61
  v_permlane16_swap_b32 v216, v218
  v_bfi_b32 v212, v254, s42, v212
  v_cvt_pk_bf16_f32 v224, v46, v62
  v_mfma_f32_32x32x16_bf16 v[88:103], v[108:111], a[220:223], v[88:103]
  v_cvt_pk_bf16_f32 v226, v47, v63
  v_permlane16_swap_b32 v220, v222
  v_bfi_b32 v216, v254, s42, v216
  v_cvt_pk_bf16_f32 v228, v48, v64
  v_mfma_f32_32x32x16_bf16 v[72:87], v[112:115], a[232:235], v[72:87]
  v_cvt_pk_bf16_f32 v230, v49, v65
  v_permlane16_swap_b32 v224, v226
  v_bfi_b32 v220, v254, s42, v220
  v_cvt_pk_bf16_f32 v232, v50, v66
  v_cvt_pk_bf16_f32 v234, v51, v67
  v_mfma_f32_32x32x16_bf16 v[88:103], v[112:115], a[236:239], v[88:103]
  v_permlane16_swap_b32 v228, v230
  v_bfi_b32 v224, v254, s42, v224
  v_cvt_pk_bf16_f32 v236, v52, v68
  v_cvt_pk_bf16_f32 v238, v53, v69
  v_mfma_f32_32x32x16_bf16 v[72:87], v[116:119], a[248:251], v[72:87]
  v_permlane16_swap_b32 v232, v234
  v_bfi_b32 v228, v254, s42, v228
  v_cvt_pk_bf16_f32 v240, v54, v70
  v_cvt_pk_bf16_f32 v242, v55, v71
  v_permlane16_swap_b32 v236, v238
  v_mfma_f32_32x32x16_bf16 v[88:103], v[116:119], a[252:255], v[88:103]
  v_bfi_b32 v232, v254, s42, v232
  v_permlane16_swap_b32 v240, v242
  v_bfi_b32 v236, v254, s42, v236
  v_bfi_b32 v240, v254, s42, v240
  s_nop 7
  v_cvt_pk_bf16_f32 v213, v72, v88
  v_cvt_pk_bf16_f32 v215, v73, v89
  v_cvt_pk_bf16_f32 v217, v74, v90
  v_cvt_pk_bf16_f32 v219, v75, v91
  s_add_u32 s78, s86, 0
  v_permlane16_swap_b32 v213, v215
  buffer_store_dwordx4 v[212:215], v4, s[4:7], s78 offen sc1
  v_cvt_pk_bf16_f32 v221, v76, v92
  v_cvt_pk_bf16_f32 v223, v77, v93
  s_add_u32 s78, s86, 32768
  v_permlane16_swap_b32 v217, v219
  buffer_store_dwordx4 v[216:219], v4, s[4:7], s78 offen sc1
  v_cvt_pk_bf16_f32 v225, v78, v94
  v_cvt_pk_bf16_f32 v227, v79, v95
  s_add_u32 s78, s86, 131072
  v_permlane16_swap_b32 v221, v223
  buffer_store_dwordx4 v[220:223], v4, s[4:7], s78 offen sc1
  v_cvt_pk_bf16_f32 v229, v80, v96
  v_cvt_pk_bf16_f32 v231, v81, v97
  s_add_u32 s78, s86, 163840
  v_permlane16_swap_b32 v225, v227
  buffer_store_dwordx4 v[224:227], v4, s[4:7], s78 offen sc1
  v_cvt_pk_bf16_f32 v233, v82, v98
  v_cvt_pk_bf16_f32 v235, v83, v99
  s_add_u32 s78, s86, 262144
  v_permlane16_swap_b32 v229, v231
  buffer_store_dwordx4 v[228:231], v4, s[4:7], s78 offen sc1
  v_cvt_pk_bf16_f32 v237, v84, v100
  v_cvt_pk_bf16_f32 v239, v85, v101
  s_add_u32 s78, s86, 294912
  v_permlane16_swap_b32 v233, v235
  buffer_store_dwordx4 v[232:235], v4, s[4:7], s78 offen sc1
  v_cvt_pk_bf16_f32 v241, v86, v102
  v_cvt_pk_bf16_f32 v243, v87, v103
  s_add_u32 s78, s86, 393216
  v_permlane16_swap_b32 v237, v239
  buffer_store_dwordx4 v[236:239], v4, s[4:7], s78 offen sc1
  s_add_u32 s78, s86, 425984
  v_permlane16_swap_b32 v241, v243
  buffer_store_dwordx4 v[240:243], v4, s[4:7], s78 offen sc1
  s_branch o_we_205
o_wr1_203:
  s_nop 3
  v_mul_f32 v112, s24, v112
  v_mul_f32 v113, s24, v113
  v_exp_f32 v64, v112
  v_exp_f32 v65, v113
  v_max_f32 v116, v111, v116
  v_max3_f32 v116, v112, v113, v116
  v_add_f32 v117, v117, v64
  v_add_f32 v118, v118, v65
  v_add_f32 v117, v117, v118
  s_mov_b32 s28, 0x21800000
  v_mov_b32 v118, v117
  s_nop 1
  v_permlane16_swap_b32 v117, v118
  v_add_f32 v117, v117, v118
  v_mov_b32 v118, v117
  s_nop 0
  s_nop 0
  v_permlane32_swap_b32 v117, v118
  v_add_f32 v117, v117, v118
  s_mov_b32 s67, 0
  s_mov_b64 vcc, 0
  s_waitcnt vmcnt(3)
o_pl_211:
  v_and_b32 v7, 1, v7
  v_cmp_ne_u32 vcc, s96, v7
  s_cbranch_vccz o_pk_212
  buffer_load_dword v7, v255, s[4:7], s97 offen sc1
  s_add_u32 s67, s67, 1
  s_cmp_gt_u32 s67, 1048576
  s_cbranch_scc1 L_end
  s_waitcnt vmcnt(0)
  s_branch o_pl_211
o_pk_212:
  s_lshl_b32 s94, s43, 14
  s_add_u32 s94, s94, s95
  buffer_load_dwordx4 v[120:123], v5, s[4:7], s94 offen offset:0 sc1
  v_cmp_lt_f32 vcc, 0x42700000, v116
  v_cmp_gt_f32 s[30:31], s28, v117
  v_rcp_f32 v117, v117
  buffer_load_dwordx4 v[124:127], v5, s[4:7], s94 offen offset:512 sc1
  s_or_b64 vcc, vcc, s[30:31]
  s_cbranch_vccnz o_fb_209
o_fbr_210:
  buffer_load_dwordx4 v[128:131], v5, s[4:7], s94 offen offset:256 sc1
  v_pk_mul_f32 v[56:57], v[56:57], v[116:117] op_sel:[0,1] op_sel_hi:[1,1]
  v_pk_mul_f32 v[58:59], v[58:59], v[116:117] op_sel:[0,1] op_sel_hi:[1,1]
  v_pk_mul_f32 v[60:61], v[60:61], v[116:117] op_sel:[0,1] op_sel_hi:[1,1]
  v_pk_mul_f32 v[62:63], v[62:63], v[116:117] op_sel:[0,1] op_sel_hi:[1,1]
  v_pk_mul_f32 v[64:65], v[64:65], v[116:117] op_sel:[0,1] op_sel_hi:[1,1]
  buffer_load_dwordx4 v[132:135], v5, s[4:7], s94 offen offset:768 sc1
  v_cvt_pk_bf16_f32 v116, v56, v57
  v_cvt_pk_bf16_f32 v117, v58, v59
  v_cvt_pk_bf16_f32 v118, v60, v61
  v_cvt_pk_bf16_f32 v119, v62, v63
  s_waitcnt lgkmcnt(0)
  s_nop 0
  v_mfma_f32_16x16x32_bf16 v[72:75], v[152:155], v[116:119], 0
  s_add_u32 s62, s62, 1
  v_cvt_pk_bf16_f32 v197, v64, v65
  v_cvt_pk_bf16_f32 v198, v64, v65
  v_mfma_f32_16x16x32_bf16 v[76:79], v[156:159], v[116:119], 0
  s_add_u32 s94, s94, 4096
  buffer_load_dwordx4 v[136:139], v5, s[4:7], s94 offen offset:0 sc1
  s_xor_b32 s86, s86, 524288
  v_mfma_f32_16x16x32_bf16 v[80:83], v[160:163], v[116:119], 0
  s_bfe_u32 s42, s62, 0x10001
  v_mfma_f32_16x16x32_bf16 v[84:87], v[164:167], v[116:119], 0
  buffer_load_dwordx4 v[140:143], v5, s[4:7], s94 offen offset:512 sc1
  v_mfma_f32_16x16x32_bf16 v[88:91], v[168:171], v[116:119], 0
  v_mfma_f32_16x16x32_bf16 v[92:95], v[172:175], v[116:119], 0
  buffer_load_dwordx4 v[144:147], v5, s[4:7], s94 offen offset:256 sc1
  v_mfma_f32_16x16x32_bf16 v[96:99], v[176:179], v[116:119], 0
  v_mfma_f32_16x16x32_bf16 v[100:103], v[180:183], v[116:119], 0
  buffer_load_dwordx4 v[148:151], v5, s[4:7], s94 offen offset:768 sc1
  v_mfma_f32_16x16x16_bf16 v[72:75], v[200:201], v[198:199], v[72:75]
  s_nop 1
  v_mfma_f32_16x16x16_bf16 v[76:79], v[200:201], v[196:197], v[76:79]
  s_add_u32 s94, s94, 4096
  buffer_load_dwordx4 v[152:155], v5, s[4:7], s94 offen offset:0 sc1
  v_mfma_f32_16x16x16_bf16 v[80:83], v[202:203], v[198:199], v[80:83]
  s_nop 1
  v_mfma_f32_16x16x16_bf16 v[84:87], v[202:203], v[196:197], v[84:87]
  buffer_load_dwordx4 v[156:159], v5, s[4:7], s94 offen offset:512 sc1
  v_mfma_f32_16x16x16_bf16 v[88:91], v[204:205], v[198:199], v[88:91]
  s_nop 0
  v_cvt_pk_bf16_f32 v40, v72, v73
  v_cvt_pk_bf16_f32 v41, v74, v75
  v_mfma_f32_16x16x16_bf16 v[92:95], v[204:205], v[196:197], v[92:95]
  buffer_load_dwordx4 v[160:163], v5, s[4:7], s94 offen offset:256 sc1
  v_cvt_pk_bf16_f32 v42, v76, v77
  v_cvt_pk_bf16_f32 v43, v78, v79
  v_mfma_f32_16x16x16_bf16 v[96:99], v[206:207], v[198:199], v[96:99]
  s_nop 0
  ds_write_b128 v6, v[40:43] offset:0
  v_cvt_pk_bf16_f32 v44, v80, v81
  v_mfma_f32_16x16x16_bf16 v[100:103], v[206:207], v[196:197], v[100:103]
  buffer_load_dwordx4 v[164:167], v5, s[4:7], s94 offen offset:768 sc1
  v_cvt_pk_bf16_f32 v45, v82, v83
  v_cvt_pk_bf16_f32 v46, v84, v85
  v_cvt_pk_bf16_f32 v47, v86, v87
  ds_write_b128 v6, v[44:47] offset:1024
  v_cvt_pk_bf16_f32 v48, v88, v89
  v_cvt_pk_bf16_f32 v49, v90, v91
  v_cvt_pk_bf16_f32 v50, v92, v93
  v_cvt_pk_bf16_f32 v51, v94, v95
  s_add_u32 s94, s94, 4096
  buffer_load_dwordx4 v[168:171], v5, s[4:7], s94 offen offset:0 sc1
  ds_write_b128 v6, v[48:51] offset:2048
  v_cvt_pk_bf16_f32 v52, v96, v97
  v_cvt_pk_bf16_f32 v53, v98, v99
  v_cvt_pk_bf16_f32 v54, v100, v101
  v_cvt_pk_bf16_f32 v55, v102, v103
  ds_write_b128 v6, v[52:55] offset:3072
  buffer_load_dwordx4 v[172:175], v5, s[4:7], s94 offen offset:512 sc1
  s_and_b32 s26, s65, 49152
  s_cbranch_scc1 o_wr2_204
  s_waitcnt lgkmcnt(0)
  s_barrier
  ds_read_b128 v[104:107], v3 offset:0
  ds_read_b128 v[108:111], v3 offset:512
  ds_read_b128 v[112:115], v3 offset:1024
  buffer_load_dwordx4 v[176:179], v5, s[4:7], s94 offen offset:256 sc1
  buffer_load_dwordx4 v[180:183], v5, s[4:7], s94 offen offset:768 sc1
  s_waitcnt lgkmcnt(2)
  v_mfma_f32_32x32x16_bf16 v[40:55], v[104:107], a[0:3], 0
  v_mov_b64 v[188:189], 0
  v_mov_b64 v[190:191], 0
  v_mov_b64 v[192:193], 0
  v_mov_b64 v[194:195], 0
  s_mov_b64 exec, 1
  buffer_store_dword v38, off, s[4:7], s84 sc1
  s_mov_b64 exec, -1
  s_mov_b32 s84, 268435456
  v_mfma_f32_32x32x16_bf16 v[56:71], v[104:107], a[4:7], 0
  ds_read_b128 v[116:119], v3 offset:1536
  v_mfma_f32_32x32x16_bf16 v[72:87], v[104:107], a[8:11], 0
  v_mfma_f32_32x32x16_bf16 v[88:103], v[104:107], a[12:15], 0
  s_waitcnt vmcnt(13)
  v_xor_b32 v7, s96, v120
  v_bitop3_b32 v7, v7, v124, s96 bitop3:0xf6
  v_bitop3_b32 v7, v7, v128, s96 bitop3:0xf6
  v_bitop3_b32 v7, v7, v132, s96 bitop3:0xf6
  s_waitcnt lgkmcnt(2)
  v_mfma_f32_32x32x16_bf16 v[40:55], v[108:111], a[16:19], v[40:55]
  s_waitcnt vmcnt(9)
  v_bitop3_b32 v7, v7, v136, s96 bitop3:0xf6
  v_bitop3_b32 v7, v7, v140, s96 bitop3:0xf6
  v_bitop3_b32 v7, v7, v144, s96 bitop3:0xf6
  v_bitop3_b32 v7, v7, v148, s96 bitop3:0xf6
  s_waitcnt vmcnt(5)
  v_mfma_f32_32x32x16_bf16 v[56:71], v[108:111], a[20:23], v[56:71]
  ds_read_b128 v[104:107], v3 offset:2048
  v_bitop3_b32 v7, v7, v152, s96 bitop3:0xf6
  v_bitop3_b32 v7, v7, v156, s96 bitop3:0xf6
  v_bitop3_b32 v7, v7, v160, s96 bitop3:0xf6
  v_bitop3_b32 v7, v7, v164, s96 bitop3:0xf6
  s_waitcnt vmcnt(1)
  v_mfma_f32_32x32x16_bf16 v[72:87], v[108:111], a[24:27], v[72:87]
  v_bitop3_b32 v7, v7, v168, s96 bitop3:0xf6
  v_bitop3_b32 v7, v7, v172, s96 bitop3:0xf6
  v_bitop3_b32 v7, v7, v176, s96 bitop3:0xf6
  v_bitop3_b32 v7, v7, v180, s96 bitop3:0xf6
  v_and_b32 v7, v254, v7
  v_cmp_ne_u32 vcc, 0, v7
  s_cbranch_vccnz o_rt_213
o_bk_214:
  v_mfma_f32_32x32x16_bf16 v[88:103], v[108:111], a[28:31], v[88:103]
  v_smfmac_f32_16x16x64_bf16 v[188:191], v[16:19], v[120:127], v20
  v_lshlrev_b32 v196, 16, v184
  v_smfmac_f32_16x16x64_bf16 v[192:195], v[16:19], v[128:135], v20
  v_and_b32 v197, 0xffff0000, v184
  v_smfmac_f32_16x16x64_bf16 v[188:191], v[16:19], v[136:143], v20
  v_lshlrev_b32 v198, 16, v185
  s_waitcnt lgkmcnt(2)
  v_mfma_f32_32x32x16_bf16 v[40:55], v[112:115], a[32:35], v[40:55]
  v_smfmac_f32_16x16x64_bf16 v[192:195], v[16:19], v[144:151], v20
  v_and_b32 v199, 0xffff0000, v185
  v_smfmac_f32_16x16x64_bf16 v[188:191], v[16:19], v[152:159], v20
  v_lshlrev_b32 v200, 16, v186
  v_smfmac_f32_16x16x64_bf16 v[192:195], v[16:19], v[160:167], v20
  v_and_b32 v201, 0xffff0000, v186
  v_mfma_f32_32x32x16_bf16 v[56:71], v[112:115], a[36:39], v[56:71]
  ds_read_b128 v[108:111], v3 offset:2560
  v_smfmac_f32_16x16x64_bf16 v[188:191], v[16:19], v[168:175], v20
  v_lshlrev_b32 v202, 16, v187
  v_smfmac_f32_16x16x64_bf16 v[192:195], v[16:19], v[176:183], v20
  v_and_b32 v203, 0xffff0000, v187
  s_bfe_u32 s92, s65, 131086
  v_mfma_f32_32x32x16_bf16 v[72:87], v[112:115], a[40:43], v[72:87]
  s_lshl_b32 s92, s92, 21
  s_add_u32 s92, s92, s91
  s_add_u32 s93, s92, 27262976
  s_add_u32 s92, s92, 20971520
  v_permlane16_swap_b32 v188, v192
  v_mfma_f32_32x32x16_bf16 v[88:103], v[112:115], a[44:47], v[88:103]
  v_permlane16_swap_b32 v189, v193
  v_permlane16_swap_b32 v190, v194
  v_permlane16_swap_b32 v191, v195
  s_waitcnt lgkmcnt(2)
  v_mfma_f32_32x32x16_bf16 v[40:55], v[116:119], a[48:51], v[40:55]
  v_cvt_pk_bf16_f32 v188, 0, v188
  v_cvt_pk_bf16_f32 v189, 0, v189
  v_cvt_pk_bf16_f32 v190, 0, v190
  v_cvt_pk_bf16_f32 v191, 0, v191
  v_cvt_pk_bf16_f32 v192, 0, v192
  v_cvt_pk_bf16_f32 v193, 0, v193
  v_mfma_f32_32x32x16_bf16 v[56:71], v[116:119], a[52:55], v[56:71]
  ds_read_b128 v[112:115], v3 offset:3072
  v_cvt_pk_bf16_f32 v194, 0, v194
  v_cvt_pk_bf16_f32 v195, 0, v195
  v_add_f32 v196, v196, v188
  v_add_f32 v197, v197, v189
  v_add_f32 v198, v198, v190
  v_mfma_f32_32x32x16_bf16 v[72:87], v[116:119], a[56:59], v[72:87]
  v_add_f32 v199, v199, v191
  v_add_f32 v200, v200, v192
  v_add_f32 v201, v201, v193
  v_add_f32 v202, v202, v194
  v_add_f32 v203, v203, v195
  v_cvt_pk_bf16_f32 v120, v196, v197
  v_mfma_f32_32x32x16_bf16 v[88:103], v[116:119], a[60:63], v[88:103]
  v_cvt_pk_bf16_f32 v121, v198, v199
  v_cvt_pk_bf16_f32 v122, v200, v201
  v_cvt_pk_bf16_f32 v123, v202, v203
  v_lshlrev_b32 v196, 16, v120
  v_and_b32 v197, 0xffff0000, v120
  s_waitcnt lgkmcnt(2)
  v_mfma_f32_32x32x16_bf16 v[40:55], v[104:107], a[64:67], v[40:55]
  v_lshlrev_b32 v198, 16, v121
  v_and_b32 v199, 0xffff0000, v121
  v_lshlrev_b32 v200, 16, v122
  v_and_b32 v201, 0xffff0000, v122
  v_lshlrev_b32 v202, 16, v123
  v_and_b32 v203, 0xffff0000, v123
  v_mfma_f32_32x32x16_bf16 v[56:71], v[104:107], a[68:71], v[56:71]
  ds_read_b128 v[116:119], v3 offset:3584
  buffer_store_dwordx4 v[120:123], v0, s[4:7], s92 offen sc1
  v_add_f32 v136, v196, v197
  v_mul_f32 v137, v196, v196
  v_mfma_f32_32x32x16_bf16 v[72:87], v[104:107], a[72:75], v[72:87]
  v_add_f32 v138, v198, v199
  v_mul_f32 v139, v197, v197
  v_fmac_f32 v137, v198, v198
  v_fmac_f32 v139, v199, v199
  v_add_f32 v136, v136, v200
  v_fmac_f32 v137, v200, v200
  v_mfma_f32_32x32x16_bf16 v[88:103], v[104:107], a[76:79], v[88:103]
  v_add_f32 v138, v138, v201
  v_fmac_f32 v139, v201, v201
  v_add_f32 v136, v136, v202
  v_fmac_f32 v137, v202, v202
  v_add_f32 v138, v138, v203
  s_waitcnt lgkmcnt(2)
  v_mfma_f32_32x32x16_bf16 v[40:55], v[108:111], a[80:83], v[40:55]
  v_fmac_f32 v139, v203, v203
  v_add_f32 v136, v136, v138
  v_add_f32 v137, v137, v139
  s_nop 0
  v_add_f32_dpp v136, v136, v136 row_ror:8 row_mask:0xf bank_mask:0xf
  v_add_f32_dpp v137, v137, v137 row_ror:8 row_mask:0xf bank_mask:0xf
  s_nop 0
  v_add_f32_dpp v136, v136, v136 row_ror:4 row_mask:0xf bank_mask:0xf
  v_mfma_f32_32x32x16_bf16 v[56:71], v[108:111], a[84:87], v[56:71]
  ds_read_b128 v[104:107], v3 offset:8192
  v_add_f32_dpp v137, v137, v137 row_ror:4 row_mask:0xf bank_mask:0xf
  v_add_f32_dpp v136, v136, v136 row_ror:2 row_mask:0xf bank_mask:0xf
  s_nop 0
  v_add_f32_dpp v137, v137, v137 row_ror:2 row_mask:0xf bank_mask:0xf
  v_add_f32_dpp v136, v136, v136 row_ror:1 row_mask:0xf bank_mask:0xf
  s_nop 0
  v_add_f32_dpp v137, v137, v137 row_ror:1 row_mask:0xf bank_mask:0xf
  v_mfma_f32_32x32x16_bf16 v[72:87], v[108:111], a[88:91], v[72:87]
  v_mov_b32 v140, v136
  v_mov_b32 v141, v137
  s_nop 0
  v_permlane16_swap_b32 v136, v140
  v_permlane16_swap_b32 v137, v141
  v_mfma_f32_32x32x16_bf16 v[88:103], v[108:111], a[92:95], v[88:103]
  v_add_f32 v136, v136, v140
  v_add_f32 v137, v137, v141
  v_mov_b32 v140, v136
  v_mov_b32 v141, v137
  s_nop 0
  v_permlane32_swap_b32 v136, v140
  s_waitcnt lgkmcnt(2)
  v_mfma_f32_32x32x16_bf16 v[40:55], v[112:115], a[96:99], v[40:55]
  v_permlane32_swap_b32 v137, v141
  v_add_f32 v136, v136, v140
  v_add_f32 v137, v137, v141
  v_mul_f32 v136, 0x3b000000, v136
  v_mul_f32 v137, 0x3b000000, v137
  v_mfma_f32_32x32x16_bf16 v[56:71], v[112:115], a[100:103], v[56:71]
  ds_read_b128 v[108:111], v3 offset:8704
  v_fma_f32 v137, -v136, v136, v137
  v_cvt_pk_bf16_f32 v136, 0, v136
  v_max_f32 v137, 0, v137
  v_sub_f32 v140, v196, v136
  v_sub_f32 v141, v197, v136
  v_mfma_f32_32x32x16_bf16 v[72:87], v[112:115], a[104:107], v[72:87]
  v_cvt_pk_bf16_f32 v137, 0, v137
  v_sub_f32 v142, v198, v136
  v_sub_f32 v143, v199, v136
  v_add_f32 v137, 0x3727c5ac, v137
  v_sub_f32 v144, v200, v136
  v_sub_f32 v145, v201, v136
  v_mfma_f32_32x32x16_bf16 v[88:103], v[112:115], a[108:111], v[88:103]
  v_cvt_pk_bf16_f32 v137, 0, v137
  v_sub_f32 v146, v202, v136
  v_sub_f32 v147, v203, v136
  v_sqrt_f32 v137, v137
  s_waitcnt lgkmcnt(2)
  v_mfma_f32_32x32x16_bf16 v[40:55], v[116:119], a[112:115], v[40:55]
  v_cvt_pk_bf16_f32 v140, 0, v140
  v_cvt_pk_bf16_f32 v141, 0, v141
  v_cvt_pk_bf16_f32 v137, 0, v137
  v_cvt_pk_bf16_f32 v142, 0, v142
  v_cvt_pk_bf16_f32 v143, 0, v143
  v_rcp_f32 v137, v137
  v_mfma_f32_32x32x16_bf16 v[56:71], v[116:119], a[116:119], v[56:71]
  ds_read_b128 v[112:115], v3 offset:9216
  v_cvt_pk_bf16_f32 v144, 0, v144
  v_cvt_pk_bf16_f32 v145, 0, v145
  v_cvt_pk_bf16_f32 v146, 0, v146
  v_cvt_pk_bf16_f32 v147, 0, v147
  v_mul_f32 v140, v140, v137
  v_mfma_f32_32x32x16_bf16 v[72:87], v[116:119], a[120:123], v[72:87]
  v_mul_f32 v141, v141, v137
  v_mul_f32 v142, v142, v137
  v_mul_f32 v143, v143, v137
  v_mul_f32 v144, v144, v137
  v_mul_f32 v145, v145, v137
  v_mul_f32 v146, v146, v137
  v_mfma_f32_32x32x16_bf16 v[88:103], v[116:119], a[124:127], v[88:103]
  v_mul_f32 v147, v147, v137
  v_cvt_pk_bf16_f32 v124, v140, v141
  v_cvt_pk_bf16_f32 v125, v142, v143
  v_cvt_pk_bf16_f32 v126, v144, v145
  v_cvt_pk_bf16_f32 v127, v146, v147
  s_waitcnt lgkmcnt(2)
  v_mfma_f32_32x32x16_bf16 v[40:55], v[104:107], a[128:131], v[40:55]
  v_lshlrev_b32 v204, 16, v124
  v_and_b32 v205, 0xffff0000, v124
  v_lshlrev_b32 v206, 16, v125
  v_and_b32 v207, 0xffff0000, v125
  v_lshlrev_b32 v208, 16, v126
  v_and_b32 v209, 0xffff0000, v126
  v_mfma_f32_32x32x16_bf16 v[56:71], v[104:107], a[132:135], v[56:71]
  ds_read_b128 v[116:119], v3 offset:9728
  v_lshlrev_b32 v210, 16, v127
  v_and_b32 v211, 0xffff0000, v127
  buffer_store_dwordx4 v[124:127], v0, s[4:7], s93 offen sc1
  v_mfma_f32_32x32x16_bf16 v[72:87], v[104:107], a[136:139], v[72:87]
  v_add_f32 v196, v196, v204
  v_add_f32 v197, v197, v205
  v_add_f32 v198, v198, v206
  v_add_f32 v199, v199, v207
  v_add_f32 v200, v200, v208
  v_add_f32 v201, v201, v209
  v_mfma_f32_32x32x16_bf16 v[88:103], v[104:107], a[140:143], v[88:103]
  v_add_f32 v202, v202, v210
  v_add_f32 v203, v203, v211
  v_cvt_pk_bf16_f32 v128, v196, v197
  v_cvt_pk_bf16_f32 v129, v198, v199
  v_cvt_pk_bf16_f32 v130, v200, v201
  s_waitcnt lgkmcnt(2)
  v_mfma_f32_32x32x16_bf16 v[40:55], v[108:111], a[144:147], v[40:55]
  v_cvt_pk_bf16_f32 v131, v202, v203
  v_mul_f32 v188, v204, v8
  v_mul_f32 v189, v205, v9
  v_fmac_f32 v188, v206, v10
  v_fmac_f32 v189, v207, v11
  v_fmac_f32 v188, v208, v12
  v_mfma_f32_32x32x16_bf16 v[56:71], v[108:111], a[148:151], v[56:71]
  ds_read_b128 v[104:107], v3 offset:10240
  v_fmac_f32 v189, v209, v13
  v_fmac_f32 v188, v210, v14
  v_fmac_f32 v189, v211, v15
  v_add_f32 v188, v188, v189
  s_add_u32 s92, s91, 10485760
  v_mfma_f32_32x32x16_bf16 v[72:87], v[108:111], a[152:155], v[72:87]
  s_add_u32 s93, s91, 8388608
  buffer_store_dwordx4 v[128:131], v0, s[4:7], s92 offen sc1
  v_lshlrev_b32 v196, 16, v128
  v_and_b32 v197, 0xffff0000, v128
  v_mfma_f32_32x32x16_bf16 v[88:103], v[108:111], a[156:159], v[88:103]
  v_lshlrev_b32 v198, 16, v129
  v_and_b32 v199, 0xffff0000, v129
  v_lshlrev_b32 v200, 16, v130
  v_and_b32 v201, 0xffff0000, v130
  v_lshlrev_b32 v202, 16, v131
  s_waitcnt lgkmcnt(2)
  v_mfma_f32_32x32x16_bf16 v[40:55], v[112:115], a[160:163], v[40:55]
  v_and_b32 v203, 0xffff0000, v131
  v_add_f32 v136, v196, v197
  v_mul_f32 v137, v196, v196
  v_add_f32 v138, v198, v199
  v_mul_f32 v139, v197, v197
  v_fmac_f32 v137, v198, v198
  v_mfma_f32_32x32x16_bf16 v[56:71], v[112:115], a[164:167], v[56:71]
  ds_read_b128 v[108:111], v3 offset:10752
  v_fmac_f32 v139, v199, v199
  v_add_f32 v136, v136, v200
  v_fmac_f32 v137, v200, v200
  v_add_f32 v138, v138, v201
  v_fmac_f32 v139, v201, v201
  v_mfma_f32_32x32x16_bf16 v[72:87], v[112:115], a[168:171], v[72:87]
  v_add_f32 v136, v136, v202
  v_fmac_f32 v137, v202, v202
  v_add_f32 v138, v138, v203
  v_fmac_f32 v139, v203, v203
  v_add_f32 v136, v136, v138
  v_add_f32 v137, v137, v139
  v_mfma_f32_32x32x16_bf16 v[88:103], v[112:115], a[172:175], v[88:103]
  v_add_f32_dpp v136, v136, v136 row_ror:8 row_mask:0xf bank_mask:0xf
  v_add_f32_dpp v137, v137, v137 row_ror:8 row_mask:0xf bank_mask:0xf
  v_add_f32_dpp v188, v188, v188 row_ror:8 row_mask:0xf bank_mask:0xf
  v_add_f32_dpp v136, v136, v136 row_ror:4 row_mask:0xf bank_mask:0xf
  v_add_f32_dpp v137, v137, v137 row_ror:4 row_mask:0xf bank_mask:0xf
  s_waitcnt lgkmcnt(2)
  v_mfma_f32_32x32x16_bf16 v[40:55], v[116:119], a[176:179], v[40:55]
  v_add_f32_dpp v188, v188, v188 row_ror:4 row_mask:0xf bank_mask:0xf
  v_add_f32_dpp v136, v136, v136 row_ror:2 row_mask:0xf bank_mask:0xf
  v_add_f32_dpp v137, v137, v137 row_ror:2 row_mask:0xf bank_mask:0xf
  v_add_f32_dpp v188, v188, v188 row_ror:2 row_mask:0xf bank_mask:0xf
  v_add_f32_dpp v136, v136, v136 row_ror:1 row_mask:0xf bank_mask:0xf
  v_add_f32_dpp v137, v137, v137 row_ror:1 row_mask:0xf bank_mask:0xf
  v_mfma_f32_32x32x16_bf16 v[56:71], v[116:119], a[180:183], v[56:71]
  ds_read_b128 v[112:115], v3 offset:11264
  v_add_f32_dpp v188, v188, v188 row_ror:1 row_mask:0xf bank_mask:0xf
  v_mov_b32 v140, v136
  v_mov_b32 v141, v137
  v_mov_b32 v142, v188
  v_permlane16_swap_b32 v136, v140
  v_mfma_f32_32x32x16_bf16 v[72:87], v[116:119], a[184:187], v[72:87]
  v_permlane16_swap_b32 v137, v141
  v_permlane16_swap_b32 v188, v142
  v_add_f32 v136, v136, v140
  v_add_f32 v137, v137, v141
  v_mfma_f32_32x32x16_bf16 v[88:103], v[116:119], a[188:191], v[88:103]
  v_add_f32 v188, v188, v142
  v_mov_b32 v140, v136
  v_mov_b32 v141, v137
  v_mov_b32 v142, v188
  v_permlane32_swap_b32 v136, v140
  s_waitcnt lgkmcnt(2)
  v_mfma_f32_32x32x16_bf16 v[40:55], v[104:107], a[192:195], v[40:55]
  v_permlane32_swap_b32 v137, v141
  v_permlane32_swap_b32 v188, v142
  v_add_f32 v136, v136, v140
  v_add_f32 v137, v137, v141
  v_mfma_f32_32x32x16_bf16 v[56:71], v[104:107], a[196:199], v[56:71]
  ds_read_b128 v[116:119], v3 offset:11776
  v_add_f32 v188, v188, v142
  v_mul_f32 v136, 0x3b000000, v136
  v_mul_f32 v137, 0x3b000000, v137
  v_fma_f32 v137, -v136, v136, v137
  v_cvt_pk_bf16_f32 v136, 0, v136
  s_waitcnt lgkmcnt(2)
  v_mfma_f32_32x32x16_bf16 v[40:55], v[108:111], a[208:211], v[40:55]
  v_max_f32 v137, 0, v137
  v_sub_f32 v140, v196, v136
  v_sub_f32 v141, v197, v136
  v_cvt_pk_bf16_f32 v137, 0, v137
  v_sub_f32 v142, v198, v136
  v_sub_f32 v143, v199, v136
  v_mfma_f32_32x32x16_bf16 v[56:71], v[108:111], a[212:215], v[56:71]
  v_add_f32 v137, 0x3727c5ac, v137
  v_sub_f32 v144, v200, v136
  v_sub_f32 v145, v201, v136
  v_cvt_pk_bf16_f32 v137, 0, v137
  v_sub_f32 v146, v202, v136
  v_sub_f32 v147, v203, v136
  s_waitcnt lgkmcnt(1)
  v_mfma_f32_32x32x16_bf16 v[40:55], v[112:115], a[224:227], v[40:55]
  v_sqrt_f32 v137, v137
  v_cvt_pk_bf16_f32 v140, 0, v140
  v_cvt_pk_bf16_f32 v141, 0, v141
  v_cvt_pk_bf16_f32 v137, 0, v137
  v_cvt_pk_bf16_f32 v142, 0, v142
  v_mfma_f32_32x32x16_bf16 v[56:71], v[112:115], a[228:231], v[56:71]
  v_cvt_pk_bf16_f32 v143, 0, v143
  v_rcp_f32 v137, v137
  v_cvt_pk_bf16_f32 v144, 0, v144
  v_cvt_pk_bf16_f32 v145, 0, v145
  v_cvt_pk_bf16_f32 v146, 0, v146
  s_waitcnt lgkmcnt(0)
  v_mfma_f32_32x32x16_bf16 v[40:55], v[116:119], a[240:243], v[40:55]
  v_cvt_pk_bf16_f32 v147, 0, v147
  v_mul_f32 v140, v140, v137
  v_mul_f32 v141, v141, v137
  v_mul_f32 v142, v142, v137
  v_mul_f32 v143, v143, v137
  v_mul_f32 v144, v144, v137
  v_mfma_f32_32x32x16_bf16 v[56:71], v[116:119], a[244:247], v[56:71]
  v_mul_f32 v145, v145, v137
  v_mul_f32 v146, v146, v137
  v_mul_f32 v147, v147, v137
  v_cvt_pk_bf16_f32 v132, v140, v141
  v_cvt_pk_bf16_f32 v133, v142, v143
  v_cvt_pk_bf16_f32 v134, v144, v145
  v_mfma_f32_32x32x16_bf16 v[72:87], v[104:107], a[200:203], v[72:87]
  v_cvt_pk_bf16_f32 v135, v146, v147
  buffer_store_dwordx4 v[132:135], v0, s[4:7], s93 offen sc1
  v_cvt_pk_bf16_f32 v188, 0, v188
  v_ashrrev_i32 v189, 31, v188
  v_mfma_f32_32x32x16_bf16 v[88:103], v[104:107], a[204:207], v[88:103]
  v_or_b32 v189, 0x80000000, v189
  v_xor_b32 v188, v188, v189
  s_sub_u32 s92, 4095, s90
  v_and_b32 v188, 0xffff0000, v188
  v_or_b32 v38, s92, v188
  v_mfma_f32_32x32x16_bf16 v[72:87], v[108:111], a[216:219], v[72:87]
  s_bfe_u32 s92, s65, 196625
  s_lshl_b32 s92, s92, 18
  s_lshl_b32 s93, s90, 7
  s_add_u32 s92, s92, s93
  s_add_u32 s84, s92, 243269632
  v_cvt_pk_bf16_f32 v212, v40, v56
  v_mfma_f32_32x32x16_bf16 v[88:103], v[108:111], a[220:223], v[88:103]
  v_cvt_pk_bf16_f32 v214, v41, v57
  v_cvt_pk_bf16_f32 v216, v42, v58
  v_cvt_pk_bf16_f32 v218, v43, v59
  v_permlane16_swap_b32 v212, v214
  v_mfma_f32_32x32x16_bf16 v[72:87], v[112:115], a[232:235], v[72:87]
  v_cvt_pk_bf16_f32 v220, v44, v60
  v_cvt_pk_bf16_f32 v222, v45, v61
  v_permlane16_swap_b32 v216, v218
  v_bfi_b32 v212, v254, s42, v212
  v_cvt_pk_bf16_f32 v224, v46, v62
  v_mfma_f32_32x32x16_bf16 v[88:103], v[112:115], a[236:239], v[88:103]
  v_cvt_pk_bf16_f32 v226, v47, v63
  v_permlane16_swap_b32 v220, v222
  v_bfi_b32 v216, v254, s42, v216
  v_cvt_pk_bf16_f32 v228, v48, v64
  v_mfma_f32_32x32x16_bf16 v[72:87], v[116:119], a[248:251], v[72:87]
  v_cvt_pk_bf16_f32 v230, v49, v65
  v_permlane16_swap_b32 v224, v226
  v_bfi_b32 v220, v254, s42, v220
  v_cvt_pk_bf16_f32 v232, v50, v66
  v_cvt_pk_bf16_f32 v234, v51, v67
  v_mfma_f32_32x32x16_bf16 v[88:103], v[116:119], a[252:255], v[88:103]
  v_permlane16_swap_b32 v228, v230
  v_bfi_b32 v224, v254, s42, v224
  v_cvt_pk_bf16_f32 v236, v52, v68
  v_cvt_pk_bf16_f32 v238, v53, v69
  v_permlane16_swap_b32 v232, v234
  v_bfi_b32 v228, v254, s42, v228
  v_cvt_pk_bf16_f32 v240, v54, v70
  v_cvt_pk_bf16_f32 v242, v55, v71
  v_permlane16_swap_b32 v236, v238
  v_bfi_b32 v232, v254, s42, v232
  v_permlane16_swap_b32 v240, v242
  v_bfi_b32 v236, v254, s42, v236
  v_bfi_b32 v240, v254, s42, v240
  v_cvt_pk_bf16_f32 v213, v72, v88
  v_cvt_pk_bf16_f32 v215, v73, v89
  v_cvt_pk_bf16_f32 v217, v74, v90
  v_cvt_pk_bf16_f32 v219, v75, v91
  s_add_u32 s78, s86, 0
  v_permlane16_swap_b32 v213, v215
  buffer_store_dwordx4 v[212:215], v4, s[4:7], s78 offen sc1
  v_cvt_pk_bf16_f32 v221, v76, v92
  v_cvt_pk_bf16_f32 v223, v77, v93
  s_add_u32 s78, s86, 32768
  v_permlane16_swap_b32 v217, v219
  buffer_store_dwordx4 v[216:219], v4, s[4:7], s78 offen sc1
  v_cvt_pk_bf16_f32 v225, v78, v94
  v_cvt_pk_bf16_f32 v227, v79, v95
  s_add_u32 s78, s86, 131072
  v_permlane16_swap_b32 v221, v223
  buffer_store_dwordx4 v[220:223], v4, s[4:7], s78 offen sc1
  v_cvt_pk_bf16_f32 v229, v80, v96
  v_cvt_pk_bf16_f32 v231, v81, v97
  s_add_u32 s78, s86, 163840
  v_permlane16_swap_b32 v225, v227
  buffer_store_dwordx4 v[224:227], v4, s[4:7], s78 offen sc1
  v_cvt_pk_bf16_f32 v233, v82, v98
  v_cvt_pk_bf16_f32 v235, v83, v99
  s_add_u32 s78, s86, 262144
  v_permlane16_swap_b32 v229, v231
  buffer_store_dwordx4 v[228:231], v4, s[4:7], s78 offen sc1
  v_cvt_pk_bf16_f32 v237, v84, v100
  v_cvt_pk_bf16_f32 v239, v85, v101
  s_add_u32 s78, s86, 294912
  v_permlane16_swap_b32 v233, v235
  buffer_store_dwordx4 v[232:235], v4, s[4:7], s78 offen sc1
  v_cvt_pk_bf16_f32 v241, v86, v102
  v_cvt_pk_bf16_f32 v243, v87, v103
  s_add_u32 s78, s86, 393216
  v_permlane16_swap_b32 v237, v239
  buffer_store_dwordx4 v[236:239], v4, s[4:7], s78 offen sc1
  s_add_u32 s78, s86, 425984
  v_permlane16_swap_b32 v241, v243
  buffer_store_dwordx4 v[240:243], v4, s[4:7], s78 offen sc1
  s_waitcnt vmcnt(8)
  s_mov_b64 exec, 1
  buffer_store_dword v38, off, s[4:7], s84 sc1
  s_mov_b64 exec, -1
  s_mov_b32 s84, 268435456
  s_branch o_we_205
o_rt_213:
  s_mov_b32 s67, 0
o_rl_217:
  s_lshl_b32 s94, s43, 14
  s_add_u32 s94, s94, s95
  buffer_load_dwordx4 v[120:123], v5, s[4:7], s94 offen offset:0 sc1
  buffer_load_dwordx4 v[124:127], v5, s[4:7], s94 offen offset:512 sc1
  buffer_load_dwordx4 v[128:131], v5, s[4:7], s94 offen offset:256 sc1
  buffer_load_dwordx4 v[132:135], v5, s[4:7], s94 offen offset:768 sc1
  s_add_u32 s94, s94, 4096
  buffer_load_dwordx4 v[136:139], v5, s[4:7], s94 offen offset:0 sc1
  buffer_load_dwordx4 v[140:143], v5, s[4:7], s94 offen offset:512 sc1
  buffer_load_dwordx4 v[144:147], v5, s[4:7], s94 offen offset:256 sc1
  buffer_load_dwordx4 v[148:151], v5, s[4:7], s94 offen offset:768 sc1
  s_add_u32 s94, s94, 4096
  buffer_load_dwordx4 v[152:155], v5, s[4:7], s94 offen offset:0 sc1
  buffer_load_dwordx4 v[156:159], v5, s[4:7], s94 offen offset:512 sc1
  buffer_load_dwordx4 v[160:163], v5, s[4:7], s94 offen offset:256 sc1
  buffer_load_dwordx4 v[164:167], v5, s[4:7], s94 offen offset:768 sc1
  s_add_u32 s94, s94, 4096
  buffer_load_dwordx4 v[168:171], v5, s[4:7], s94 offen offset:0 sc1
  buffer_load_dwordx4 v[172:175], v5, s[4:7], s94 offen offset:512 sc1
  buffer_load_dwordx4 v[176:179], v5, s[4:7], s94 offen offset:256 sc1
  buffer_load_dwordx4 v[180:183], v5, s[4:7], s94 offen offset:768 sc1
  s_add_u32 s67, s67, 1
  s_cmp_gt_u32 s67, 1048576
  s_cbranch_scc1 L_end
  s_waitcnt vmcnt(0)
  v_xor_b32 v7, s96, v120
  v_bitop3_b32 v7, v7, v124, s96 bitop3:0xf6
  v_bitop3_b32 v7, v7, v128, s96 bitop3:0xf6
  v_bitop3_b32 v7, v7, v132, s96 bitop3:0xf6
  v_bitop3_b32 v7, v7, v136, s96 bitop3:0xf6
  v_bitop3_b32 v7, v7, v140, s96 bitop3:0xf6
  v_bitop3_b32 v7, v7, v144, s96 bitop3:0xf6
  v_bitop3_b32 v7, v7, v148, s96 bitop3:0xf6
  v_bitop3_b32 v7, v7, v152, s96 bitop3:0xf6
  v_bitop3_b32 v7, v7, v156, s96 bitop3:0xf6
  v_bitop3_b32 v7, v7, v160, s96 bitop3:0xf6
  v_bitop3_b32 v7, v7, v164, s96 bitop3:0xf6
  v_bitop3_b32 v7, v7, v168, s96 bitop3:0xf6
  v_bitop3_b32 v7, v7, v172, s96 bitop3:0xf6
  v_bitop3_b32 v7, v7, v176, s96 bitop3:0xf6
  v_bitop3_b32 v7, v7, v180, s96 bitop3:0xf6
  v_and_b32 v7, v254, v7
  v_cmp_ne_u32 vcc, 0, v7
  s_cbranch_vccnz o_rl_217
  s_branch o_bk_214
o_rt_215:
  s_mov_b32 s67, 0
o_rl_218:
  s_lshl_b32 s94, s43, 14
  s_add_u32 s94, s94, s95
  buffer_load_dwordx4 v[120:123], v5, s[4:7], s94 offen offset:0 sc1
  buffer_load_dwordx4 v[124:127], v5, s[4:7], s94 offen offset:512 sc1
  buffer_load_dwordx4 v[128:131], v5, s[4:7], s94 offen offset:256 sc1
  buffer_load_dwordx4 v[132:135], v5, s[4:7], s94 offen offset:768 sc1
  s_add_u32 s94, s94, 4096
  buffer_load_dwordx4 v[136:139], v5, s[4:7], s94 offen offset:0 sc1
  buffer_load_dwordx4 v[140:143], v5, s[4:7], s94 offen offset:512 sc1
  buffer_load_dwordx4 v[144:147], v5, s[4:7], s94 offen offset:256 sc1
  buffer_load_dwordx4 v[148:151], v5, s[4:7], s94 offen offset:768 sc1
  s_add_u32 s94, s94, 4096
  buffer_load_dwordx4 v[152:155], v5, s[4:7], s94 offen offset:0 sc1
  buffer_load_dwordx4 v[156:159], v5, s[4:7], s94 offen offset:512 sc1
  buffer_load_dwordx4 v[160:163], v5, s[4:7], s94 offen offset:256 sc1
  buffer_load_dwordx4 v[164:167], v5, s[4:7], s94 offen offset:768 sc1
  s_add_u32 s94, s94, 4096
  buffer_load_dwordx4 v[168:171], v5, s[4:7], s94 offen offset:0 sc1
  buffer_load_dwordx4 v[172:175], v5, s[4:7], s94 offen offset:512 sc1
  buffer_load_dwordx4 v[176:179], v5, s[4:7], s94 offen offset:256 sc1
  buffer_load_dwordx4 v[180:183], v5, s[4:7], s94 offen offset:768 sc1
  s_add_u32 s67, s67, 1
  s_cmp_gt_u32 s67, 1048576
  s_cbranch_scc1 L_end
  s_waitcnt vmcnt(0)
  v_xor_b32 v7, s96, v120
  v_bitop3_b32 v7, v7, v124, s96 bitop3:0xf6
  v_bitop3_b32 v7, v7, v128, s96 bitop3:0xf6
  v_bitop3_b32 v7, v7, v132, s96 bitop3:0xf6
  v_bitop3_b32 v7, v7, v136, s96 bitop3:0xf6
  v_bitop3_b32 v7, v7, v140, s96 bitop3:0xf6
  v_bitop3_b32 v7, v7, v144, s96 bitop3:0xf6
  v_bitop3_b32 v7, v7, v148, s96 bitop3:0xf6
  v_bitop3_b32 v7, v7, v152, s96 bitop3:0xf6
  v_bitop3_b32 v7, v7, v156, s96 bitop3:0xf6
  v_bitop3_b32 v7, v7, v160, s96 bitop3:0xf6
  v_bitop3_b32 v7, v7, v164, s96 bitop3:0xf6
  v_bitop3_b32 v7, v7, v168, s96 bitop3:0xf6
  v_bitop3_b32 v7, v7, v172, s96 bitop3:0xf6
  v_bitop3_b32 v7, v7, v176, s96 bitop3:0xf6
  v_bitop3_b32 v7, v7, v180, s96 bitop3:0xf6
  v_and_b32 v7, v254, v7
  v_cmp_ne_u32 vcc, 0, v7
  s_cbranch_vccnz o_rl_218
  s_branch o_bk_216
o_fb_207:
  v_mov_b32 v118, v116
  s_nop 1
  v_permlane16_swap_b32 v116, v118
  v_max_f32 v116, v116, v118
  v_mov_b32 v118, v116
  s_nop 0
  s_nop 0
  v_permlane32_swap_b32 v116, v118
  v_max_f32 v116, v116, v118
  v_sub_f32 v56, v104, v116
  v_sub_f32 v57, v105, v116
  v_sub_f32 v58, v106, v116
  v_sub_f32 v59, v107, v116
  v_sub_f32 v60, v108, v116
  v_sub_f32 v61, v109, v116
  v_sub_f32 v62, v110, v116
  v_sub_f32 v63, v111, v116
  v_sub_f32 v64, v112, v116
  v_sub_f32 v65, v113, v116
  v_exp_f32 v56, v56
  v_exp_f32 v57, v57
  v_exp_f32 v58, v58
  v_exp_f32 v59, v59
  v_exp_f32 v60, v60
  v_exp_f32 v61, v61
  v_exp_f32 v62, v62
  v_exp_f32 v63, v63
  v_exp_f32 v64, v64
  v_exp_f32 v65, v65
  v_add_f32 v117, v56, v57
  v_add_f32 v117, v117, v58
  v_add_f32 v117, v117, v59
  v_add_f32 v117, v117, v60
  v_add_f32 v117, v117, v61
  v_add_f32 v117, v117, v62
  v_add_f32 v117, v117, v63
  v_add_f32 v117, v117, v64
  v_add_f32 v117, v117, v65
  v_mov_b32 v118, v117
  s_nop 0
  s_nop 0
  v_permlane16_swap_b32 v117, v118
  v_add_f32 v117, v117, v118
  v_mov_b32 v118, v117
  s_nop 0
  s_nop 0
  v_permlane32_swap_b32 v117, v118
  v_add_f32 v117, v117, v118
  v_rcp_f32 v117, v117
  s_branch o_fbr_208
o_fb_209:
  v_mov_b32 v118, v116
  s_nop 1
  v_permlane16_swap_b32 v116, v118
  v_max_f32 v116, v116, v118
  v_mov_b32 v118, v116
  s_nop 0
  s_nop 0
  v_permlane32_swap_b32 v116, v118
  v_max_f32 v116, v116, v118
  v_sub_f32 v56, v104, v116
  v_sub_f32 v57, v105, v116
  v_sub_f32 v58, v106, v116
  v_sub_f32 v59, v107, v116
  v_sub_f32 v60, v108, v116
  v_sub_f32 v61, v109, v116
  v_sub_f32 v62, v110, v116
  v_sub_f32 v63, v111, v116
  v_sub_f32 v64, v112, v116
  v_sub_f32 v65, v113, v116
  v_exp_f32 v56, v56
  v_exp_f32 v57, v57
  v_exp_f32 v58, v58
  v_exp_f32 v59, v59
  v_exp_f32 v60, v60
  v_exp_f32 v61, v61
  v_exp_f32 v62, v62
  v_exp_f32 v63, v63
  v_exp_f32 v64, v64
  v_exp_f32 v65, v65
  v_add_f32 v117, v56, v57
  v_add_f32 v117, v117, v58
  v_add_f32 v117, v117, v59
  v_add_f32 v117, v117, v60
  v_add_f32 v117, v117, v61
  v_add_f32 v117, v117, v62
  v_add_f32 v117, v117, v63
  v_add_f32 v117, v117, v64
  v_add_f32 v117, v117, v65
  v_mov_b32 v118, v117
  s_nop 0
  s_nop 0
  v_permlane16_swap_b32 v117, v118
  v_add_f32 v117, v117, v118
  v_mov_b32 v118, v117
  s_nop 0
  s_nop 0
  v_permlane32_swap_b32 v117, v118
  v_add_f32 v117, v117, v118
  v_rcp_f32 v117, v117
  s_branch o_fbr_210
o_wr2_204:
  s_waitcnt lgkmcnt(0)
  s_barrier
  ds_read_b128 v[104:107], v3 offset:0
  ds_read_b128 v[108:111], v3 offset:512
  ds_read_b128 v[112:115], v3 offset:1024
  buffer_load_dwordx4 v[176:179], v5, s[4:7], s94 offen offset:256 sc1
  buffer_load_dwordx4 v[180:183], v5, s[4:7], s94 offen offset:768 sc1
  s_waitcnt lgkmcnt(2)
  v_mfma_f32_32x32x16_bf16 v[40:55], v[104:107], a[0:3], 0
  v_mov_b64 v[188:189], 0
  v_mov_b64 v[190:191], 0
  v_mov_b64 v[192:193], 0
  v_mov_b64 v[194:195], 0
  s_mov_b64 exec, 1
  buffer_store_dword v38, off, s[4:7], s84 sc1
  s_mov_b64 exec, -1
  s_mov_b32 s84, 268435456
  v_mfma_f32_32x32x16_bf16 v[56:71], v[104:107], a[4:7], 0
  ds_read_b128 v[116:119], v3 offset:1536
  v_mfma_f32_32x32x16_bf16 v[72:87], v[104:107], a[8:11], 0
  v_mfma_f32_32x32x16_bf16 v[88:103], v[104:107], a[12:15], 0
  s_waitcnt vmcnt(13)
  v_xor_b32 v7, s96, v120
  v_bitop3_b32 v7, v7, v124, s96 bitop3:0xf6
  v_bitop3_b32 v7, v7, v128, s96 bitop3:0xf6
  v_bitop3_b32 v7, v7, v132, s96 bitop3:0xf6
  s_waitcnt lgkmcnt(2)
  v_mfma_f32_32x32x16_bf16 v[40:55], v[108:111], a[16:19], v[40:55]
  s_waitcnt vmcnt(9)
  v_bitop3_b32 v7, v7, v136, s96 bitop3:0xf6
  v_bitop3_b32 v7, v7, v140, s96 bitop3:0xf6
  v_bitop3_b32 v7, v7, v144, s96 bitop3:0xf6
  v_bitop3_b32 v7, v7, v148, s96 bitop3:0xf6
  s_waitcnt vmcnt(5)
  v_mfma_f32_32x32x16_bf16 v[56:71], v[108:111], a[20:23], v[56:71]
  ds_read_b128 v[104:107], v3 offset:2048
  v_bitop3_b32 v7, v7, v152, s96 bitop3:0xf6
  v_bitop3_b32 v7, v7, v156, s96 bitop3:0xf6
  v_bitop3_b32 v7, v7, v160, s96 bitop3:0xf6
  v_bitop3_b32 v7, v7, v164, s96 bitop3:0xf6
  s_waitcnt vmcnt(1)
  v_mfma_f32_32x32x16_bf16 v[72:87], v[108:111], a[24:27], v[72:87]
  v_bitop3_b32 v7, v7, v168, s96 bitop3:0xf6
  v_bitop3_b32 v7, v7, v172, s96 bitop3:0xf6
  v_bitop3_b32 v7, v7, v176, s96 bitop3:0xf6
  v_bitop3_b32 v7, v7, v180, s96 bitop3:0xf6
  v_and_b32 v7, v254, v7
  v_cmp_ne_u32 vcc, 0, v7
  s_cbranch_vccnz o_rt_215
o_bk_216:
  v_mfma_f32_32x32x16_bf16 v[88:103], v[108:111], a[28:31], v[88:103]
  v_smfmac_f32_16x16x64_bf16 v[188:191], v[16:19], v[120:127], v20
  v_lshlrev_b32 v196, 16, v184
  v_smfmac_f32_16x16x64_bf16 v[192:195], v[16:19], v[128:135], v20
  v_and_b32 v197, 0xffff0000, v184
  v_smfmac_f32_16x16x64_bf16 v[188:191], v[16:19], v[136:143], v20
  v_lshlrev_b32 v198, 16, v185
  s_waitcnt lgkmcnt(2)
  v_mfma_f32_32x32x16_bf16 v[40:55], v[112:115], a[32:35], v[40:55]
  v_smfmac_f32_16x16x64_bf16 v[192:195], v[16:19], v[144:151], v20
  v_and_b32 v199, 0xffff0000, v185
  v_smfmac_f32_16x16x64_bf16 v[188:191], v[16:19], v[152:159], v20
  v_lshlrev_b32 v200, 16, v186
  v_smfmac_f32_16x16x64_bf16 v[192:195], v[16:19], v[160:167], v20
  v_and_b32 v201, 0xffff0000, v186
  v_mfma_f32_32x32x16_bf16 v[56:71], v[112:115], a[36:39], v[56:71]
  ds_read_b128 v[108:111], v3 offset:2560
  v_smfmac_f32_16x16x64_bf16 v[188:191], v[16:19], v[168:175], v20
  v_lshlrev_b32 v202, 16, v187
  v_smfmac_f32_16x16x64_bf16 v[192:195], v[16:19], v[176:183], v20
  v_and_b32 v203, 0xffff0000, v187
  s_bfe_u32 s92, s65, 131086
  v_mfma_f32_32x32x16_bf16 v[72:87], v[112:115], a[40:43], v[72:87]
  s_lshl_b32 s92, s92, 21
  s_add_u32 s92, s92, s91
  s_add_u32 s93, s92, 27262976
  s_add_u32 s92, s92, 20971520
  v_permlane16_swap_b32 v188, v192
  v_mfma_f32_32x32x16_bf16 v[88:103], v[112:115], a[44:47], v[88:103]
  v_permlane16_swap_b32 v189, v193
  v_permlane16_swap_b32 v190, v194
  v_permlane16_swap_b32 v191, v195
  s_waitcnt lgkmcnt(2)
  v_mfma_f32_32x32x16_bf16 v[40:55], v[116:119], a[48:51], v[40:55]
  v_cvt_pk_bf16_f32 v188, 0, v188
  v_cvt_pk_bf16_f32 v189, 0, v189
  v_cvt_pk_bf16_f32 v190, 0, v190
  v_cvt_pk_bf16_f32 v191, 0, v191
  v_cvt_pk_bf16_f32 v192, 0, v192
  v_cvt_pk_bf16_f32 v193, 0, v193
  v_mfma_f32_32x32x16_bf16 v[56:71], v[116:119], a[52:55], v[56:71]
  ds_read_b128 v[112:115], v3 offset:3072
  v_cvt_pk_bf16_f32 v194, 0, v194
  v_cvt_pk_bf16_f32 v195, 0, v195
  v_add_f32 v196, v196, v188
  v_add_f32 v197, v197, v189
  v_add_f32 v198, v198, v190
  v_mfma_f32_32x32x16_bf16 v[72:87], v[116:119], a[56:59], v[72:87]
  v_add_f32 v199, v199, v191
  v_add_f32 v200, v200, v192
  v_add_f32 v201, v201, v193
  v_add_f32 v202, v202, v194
  v_add_f32 v203, v203, v195
  v_cvt_pk_bf16_f32 v120, v196, v197
  v_mfma_f32_32x32x16_bf16 v[88:103], v[116:119], a[60:63], v[88:103]
  v_cvt_pk_bf16_f32 v121, v198, v199
  v_cvt_pk_bf16_f32 v122, v200, v201
  v_cvt_pk_bf16_f32 v123, v202, v203
  v_lshlrev_b32 v196, 16, v120
  v_and_b32 v197, 0xffff0000, v120
  s_waitcnt lgkmcnt(2)
  v_mfma_f32_32x32x16_bf16 v[40:55], v[104:107], a[64:67], v[40:55]
  v_lshlrev_b32 v198, 16, v121
  v_and_b32 v199, 0xffff0000, v121
  v_lshlrev_b32 v200, 16, v122
  v_and_b32 v201, 0xffff0000, v122
  v_lshlrev_b32 v202, 16, v123
  v_and_b32 v203, 0xffff0000, v123
  v_mfma_f32_32x32x16_bf16 v[56:71], v[104:107], a[68:71], v[56:71]
  ds_read_b128 v[116:119], v3 offset:3584
  buffer_store_dwordx4 v[120:123], v0, s[4:7], s92 offen sc1
  v_add_f32 v136, v196, v197
  v_mul_f32 v137, v196, v196
  v_mfma_f32_32x32x16_bf16 v[72:87], v[104:107], a[72:75], v[72:87]
  v_add_f32 v138, v198, v199
  v_mul_f32 v139, v197, v197
  v_fmac_f32 v137, v198, v198
  v_fmac_f32 v139, v199, v199
  v_add_f32 v136, v136, v200
  v_fmac_f32 v137, v200, v200
  v_mfma_f32_32x32x16_bf16 v[88:103], v[104:107], a[76:79], v[88:103]
  v_add_f32 v138, v138, v201
  v_fmac_f32 v139, v201, v201
  v_add_f32 v136, v136, v202
  v_fmac_f32 v137, v202, v202
  v_add_f32 v138, v138, v203
  s_waitcnt lgkmcnt(2)
  v_mfma_f32_32x32x16_bf16 v[40:55], v[108:111], a[80:83], v[40:55]
  v_fmac_f32 v139, v203, v203
  v_add_f32 v136, v136, v138
  v_add_f32 v137, v137, v139
  s_nop 0
  v_add_f32_dpp v136, v136, v136 row_ror:8 row_mask:0xf bank_mask:0xf
  v_add_f32_dpp v137, v137, v137 row_ror:8 row_mask:0xf bank_mask:0xf
  s_nop 0
  v_add_f32_dpp v136, v136, v136 row_ror:4 row_mask:0xf bank_mask:0xf
  v_mfma_f32_32x32x16_bf16 v[56:71], v[108:111], a[84:87], v[56:71]
  ds_read_b128 v[104:107], v3 offset:8192
  v_add_f32_dpp v137, v137, v137 row_ror:4 row_mask:0xf bank_mask:0xf
  v_add_f32_dpp v136, v136, v136 row_ror:2 row_mask:0xf bank_mask:0xf
  s_nop 0
  v_add_f32_dpp v137, v137, v137 row_ror:2 row_mask:0xf bank_mask:0xf
  v_add_f32_dpp v136, v136, v136 row_ror:1 row_mask:0xf bank_mask:0xf
  s_nop 0
  v_add_f32_dpp v137, v137, v137 row_ror:1 row_mask:0xf bank_mask:0xf
  v_mfma_f32_32x32x16_bf16 v[72:87], v[108:111], a[88:91], v[72:87]
  v_mov_b32 v140, v136
  v_mov_b32 v141, v137
  s_nop 0
  v_permlane16_swap_b32 v136, v140
  v_permlane16_swap_b32 v137, v141
  v_mfma_f32_32x32x16_bf16 v[88:103], v[108:111], a[92:95], v[88:103]
  v_add_f32 v136, v136, v140
  v_add_f32 v137, v137, v141
  v_mov_b32 v140, v136
  v_mov_b32 v141, v137
  s_nop 0
  v_permlane32_swap_b32 v136, v140
  s_waitcnt lgkmcnt(2)
  v_mfma_f32_32x32x16_bf16 v[40:55], v[112:115], a[96:99], v[40:55]
  v_permlane32_swap_b32 v137, v141
  v_add_f32 v136, v136, v140
  v_add_f32 v137, v137, v141
  v_mul_f32 v136, 0x3b000000, v136
  v_mul_f32 v137, 0x3b000000, v137
  v_mfma_f32_32x32x16_bf16 v[56:71], v[112:115], a[100:103], v[56:71]
  ds_read_b128 v[108:111], v3 offset:8704
  v_fma_f32 v137, -v136, v136, v137
  v_cvt_pk_bf16_f32 v136, 0, v136
  v_max_f32 v137, 0, v137
  v_sub_f32 v140, v196, v136
  v_sub_f32 v141, v197, v136
  v_mfma_f32_32x32x16_bf16 v[72:87], v[112:115], a[104:107], v[72:87]
  v_cvt_pk_bf16_f32 v137, 0, v137
  v_sub_f32 v142, v198, v136
  v_sub_f32 v143, v199, v136
  v_add_f32 v137, 0x3727c5ac, v137
  v_sub_f32 v144, v200, v136
  v_sub_f32 v145, v201, v136
  v_mfma_f32_32x32x16_bf16 v[88:103], v[112:115], a[108:111], v[88:103]
  v_cvt_pk_bf16_f32 v137, 0, v137
  v_sub_f32 v146, v202, v136
  v_sub_f32 v147, v203, v136
  v_sqrt_f32 v137, v137
  s_waitcnt lgkmcnt(2)
  v_mfma_f32_32x32x16_bf16 v[40:55], v[116:119], a[112:115], v[40:55]
  v_cvt_pk_bf16_f32 v140, 0, v140
  v_cvt_pk_bf16_f32 v141, 0, v141
  v_cvt_pk_bf16_f32 v137, 0, v137
  v_cvt_pk_bf16_f32 v142, 0, v142
  v_cvt_pk_bf16_f32 v143, 0, v143
  v_rcp_f32 v137, v137
  v_mfma_f32_32x32x16_bf16 v[56:71], v[116:119], a[116:119], v[56:71]
  ds_read_b128 v[112:115], v3 offset:9216
  v_cvt_pk_bf16_f32 v144, 0, v144
  v_cvt_pk_bf16_f32 v145, 0, v145
  v_cvt_pk_bf16_f32 v146, 0, v146
  v_cvt_pk_bf16_f32 v147, 0, v147
  v_mul_f32 v140, v140, v137
  v_mfma_f32_32x32x16_bf16 v[72:87], v[116:119], a[120:123], v[72:87]
  v_mul_f32 v141, v141, v137
  v_mul_f32 v142, v142, v137
  v_mul_f32 v143, v143, v137
  v_mul_f32 v144, v144, v137
  v_mul_f32 v145, v145, v137
  v_mul_f32 v146, v146, v137
  v_mfma_f32_32x32x16_bf16 v[88:103], v[116:119], a[124:127], v[88:103]
  v_mul_f32 v147, v147, v137
  v_cvt_pk_bf16_f32 v124, v140, v141
  v_cvt_pk_bf16_f32 v125, v142, v143
  v_cvt_pk_bf16_f32 v126, v144, v145
  v_cvt_pk_bf16_f32 v127, v146, v147
  s_waitcnt lgkmcnt(2)
  v_mfma_f32_32x32x16_bf16 v[40:55], v[104:107], a[128:131], v[40:55]
  v_lshlrev_b32 v204, 16, v124
  v_and_b32 v205, 0xffff0000, v124
  v_lshlrev_b32 v206, 16, v125
  v_and_b32 v207, 0xffff0000, v125
  v_lshlrev_b32 v208, 16, v126
  v_and_b32 v209, 0xffff0000, v126
  v_mfma_f32_32x32x16_bf16 v[56:71], v[104:107], a[132:135], v[56:71]
  ds_read_b128 v[116:119], v3 offset:9728
  v_lshlrev_b32 v210, 16, v127
  v_and_b32 v211, 0xffff0000, v127
  buffer_store_dwordx4 v[124:127], v0, s[4:7], s93 offen sc1
  v_mfma_f32_32x32x16_bf16 v[72:87], v[104:107], a[136:139], v[72:87]
  v_add_f32 v196, v196, v204
  v_add_f32 v197, v197, v205
  v_add_f32 v198, v198, v206
  v_add_f32 v199, v199, v207
  v_add_f32 v200, v200, v208
  v_add_f32 v201, v201, v209
  v_mfma_f32_32x32x16_bf16 v[88:103], v[104:107], a[140:143], v[88:103]
  v_add_f32 v202, v202, v210
  v_add_f32 v203, v203, v211
  v_cvt_pk_bf16_f32 v128, v196, v197
  v_cvt_pk_bf16_f32 v129, v198, v199
  v_cvt_pk_bf16_f32 v130, v200, v201
  s_waitcnt lgkmcnt(2)
  v_mfma_f32_32x32x16_bf16 v[40:55], v[108:111], a[144:147], v[40:55]
  v_cvt_pk_bf16_f32 v131, v202, v203
  v_mul_f32 v188, v204, v8
  v_mul_f32 v189, v205, v9
  v_fmac_f32 v188, v206, v10
  v_fmac_f32 v189, v207, v11
  v_fmac_f32 v188, v208, v12
  v_mfma_f32_32x32x16_bf16 v[56:71], v[108:111], a[148:151], v[56:71]
  ds_read_b128 v[104:107], v3 offset:10240
  v_fmac_f32 v189, v209, v13
  v_fmac_f32 v188, v210, v14
  v_fmac_f32 v189, v211, v15
  v_add_f32 v188, v188, v189
  buffer_store_dwordx4 v[128:131], v0, s[68:71], s91 offen sc1
  v_mfma_f32_32x32x16_bf16 v[72:87], v[108:111], a[152:155], v[72:87]
  v_add_f32_dpp v188, v188, v188 row_ror:8 row_mask:0xf bank_mask:0xf
  s_nop 1
  v_add_f32_dpp v188, v188, v188 row_ror:4 row_mask:0xf bank_mask:0xf
  s_nop 1
  v_add_f32_dpp v188, v188, v188 row_ror:2 row_mask:0xf bank_mask:0xf
  s_nop 1
  v_add_f32_dpp v188, v188, v188 row_ror:1 row_mask:0xf bank_mask:0xf
  v_mov_b32 v189, v188
  s_nop 0
  s_nop 0
  v_permlane16_swap_b32 v188, v189
  v_mfma_f32_32x32x16_bf16 v[88:103], v[108:111], a[156:159], v[88:103]
  v_add_f32 v188, v188, v189
  v_mov_b32 v189, v188
  s_nop 0
  s_nop 0
  v_permlane32_swap_b32 v188, v189
  v_add_f32 v188, v188, v189
  s_waitcnt lgkmcnt(2)
  v_mfma_f32_32x32x16_bf16 v[40:55], v[112:115], a[160:163], v[40:55]
  v_cvt_pk_bf16_f32 v188, 0, v188
  v_ashrrev_i32 v189, 31, v188
  v_or_b32 v189, 0x80000000, v189
  v_xor_b32 v188, v188, v189
  s_sub_u32 s92, 4095, s90
  v_and_b32 v188, 0xffff0000, v188
  v_mfma_f32_32x32x16_bf16 v[56:71], v[112:115], a[164:167], v[56:71]
  ds_read_b128 v[108:111], v3 offset:10752
  v_or_b32 v38, s92, v188
  s_bfe_u32 s92, s65, 196625
  s_lshl_b32 s92, s92, 18
  s_lshl_b32 s93, s90, 7
  s_add_u32 s92, s92, s93
  v_mfma_f32_32x32x16_bf16 v[72:87], v[112:115], a[168:171], v[72:87]
  s_add_u32 s84, s92, 243269632
  v_mfma_f32_32x32x16_bf16 v[88:103], v[112:115], a[172:175], v[88:103]
  s_waitcnt lgkmcnt(2)
  v_mfma_f32_32x32x16_bf16 v[40:55], v[116:119], a[176:179], v[40:55]
  v_mfma_f32_32x32x16_bf16 v[56:71], v[116:119], a[180:183], v[56:71]
  ds_read_b128 v[112:115], v3 offset:11264
  v_mfma_f32_32x32x16_bf16 v[72:87], v[116:119], a[184:187], v[72:87]
  v_mfma_f32_32x32x16_bf16 v[88:103], v[116:119], a[188:191], v[88:103]
  s_waitcnt lgkmcnt(2)
  v_mfma_f32_32x32x16_bf16 v[40:55], v[104:107], a[192:195], v[40:55]
  v_mfma_f32_32x32x16_bf16 v[56:71], v[104:107], a[196:199], v[56:71]
  ds_read_b128 v[116:119], v3 offset:11776
  s_waitcnt lgkmcnt(2)
  v_mfma_f32_32x32x16_bf16 v[40:55], v[108:111], a[208:211], v[40:55]
  v_mfma_f32_32x32x16_bf16 v[56:71], v[108:111], a[212:215], v[56:71]
  s_waitcnt lgkmcnt(1)
  v_mfma_f32_32x32x16_bf16 v[40:55], v[112:115], a[224:227], v[40:55]
  v_mfma_f32_32x32x16_bf16 v[56:71], v[112:115], a[228:231], v[56:71]
  s_waitcnt lgkmcnt(0)
  v_mfma_f32_32x32x16_bf16 v[40:55], v[116:119], a[240:243], v[40:55]
  v_mfma_f32_32x32x16_bf16 v[56:71], v[116:119], a[244:247], v[56:71]
  v_mfma_f32_32x32x16_bf16 v[72:87], v[104:107], a[200:203], v[72:87]
  v_mfma_f32_32x32x16_bf16 v[88:103], v[104:107], a[204:207], v[88:103]
  v_cvt_pk_bf16_f32 v212, v40, v56
  v_cvt_pk_bf16_f32 v214, v41, v57
  v_cvt_pk_bf16_f32 v216, v42, v58
  v_cvt_pk_bf16_f32 v218, v43, v59
  v_permlane16_swap_b32 v212, v214
  v_mfma_f32_32x32x16_bf16 v[72:87], v[108:111], a[216:219], v[72:87]
  v_cvt_pk_bf16_f32 v220, v44, v60
  v_cvt_pk_bf16_f32 v222, v45, v61
  v_permlane16_swap_b32 v216, v218
  v_bfi_b32 v212, v254, s42, v212
  v_cvt_pk_bf16_f32 v224, v46, v62
  v_mfma_f32_32x32x16_bf16 v[88:103], v[108:111], a[220:223], v[88:103]
  v_cvt_pk_bf16_f32 v226, v47, v63
  v_permlane16_swap_b32 v220, v222
  v_bfi_b32 v216, v254, s42, v216
  v_cvt_pk_bf16_f32 v228, v48, v64
  v_mfma_f32_32x32x16_bf16 v[72:87], v[112:115], a[232:235], v[72:87]
  v_cvt_pk_bf16_f32 v230, v49, v65
  v_permlane16_swap_b32 v224, v226
  v_bfi_b32 v220, v254, s42, v220
  v_cvt_pk_bf16_f32 v232, v50, v66
  v_cvt_pk_bf16_f32 v234, v51, v67
  v_mfma_f32_32x32x16_bf16 v[88:103], v[112:115], a[236:239], v[88:103]
  v_permlane16_swap_b32 v228, v230
  v_bfi_b32 v224, v254, s42, v224
  v_cvt_pk_bf16_f32 v236, v52, v68
  v_cvt_pk_bf16_f32 v238, v53, v69
  v_mfma_f32_32x32x16_bf16 v[72:87], v[116:119], a[248:251], v[72:87]
  v_permlane16_swap_b32 v232, v234
  v_bfi_b32 v228, v254, s42, v228
  v_cvt_pk_bf16_f32 v240, v54, v70
  v_cvt_pk_bf16_f32 v242, v55, v71
  v_permlane16_swap_b32 v236, v238
  v_mfma_f32_32x32x16_bf16 v[88:103], v[116:119], a[252:255], v[88:103]
  v_bfi_b32 v232, v254, s42, v232
  v_permlane16_swap_b32 v240, v242
  v_bfi_b32 v236, v254, s42, v236
  v_bfi_b32 v240, v254, s42, v240
  s_nop 7
  v_cvt_pk_bf16_f32 v213, v72, v88
  v_cvt_pk_bf16_f32 v215, v73, v89
  v_cvt_pk_bf16_f32 v217, v74, v90
  v_cvt_pk_bf16_f32 v219, v75, v91
  s_add_u32 s78, s86, 0
  v_permlane16_swap_b32 v213, v215
  buffer_store_dwordx4 v[212:215], v4, s[4:7], s78 offen sc1
  v_cvt_pk_bf16_f32 v221, v76, v92
  v_cvt_pk_bf16_f32 v223, v77, v93
  s_add_u32 s78, s86, 32768
  v_permlane16_swap_b32 v217, v219
  buffer_store_dwordx4 v[216:219], v4, s[4:7], s78 offen sc1
  v_cvt_pk_bf16_f32 v225, v78, v94
  v_cvt_pk_bf16_f32 v227, v79, v95
  s_add_u32 s78, s86, 131072
  v_permlane16_swap_b32 v221, v223
  buffer_store_dwordx4 v[220:223], v4, s[4:7], s78 offen sc1
  v_cvt_pk_bf16_f32 v229, v80, v96
  v_cvt_pk_bf16_f32 v231, v81, v97
  s_add_u32 s78, s86, 163840
  v_permlane16_swap_b32 v225, v227
  buffer_store_dwordx4 v[224:227], v4, s[4:7], s78 offen sc1
  v_cvt_pk_bf16_f32 v233, v82, v98
  v_cvt_pk_bf16_f32 v235, v83, v99
  s_add_u32 s78, s86, 262144
  v_permlane16_swap_b32 v229, v231
  buffer_store_dwordx4 v[228:231], v4, s[4:7], s78 offen sc1
  v_cvt_pk_bf16_f32 v237, v84, v100
  v_cvt_pk_bf16_f32 v239, v85, v101
  s_add_u32 s78, s86, 294912
  v_permlane16_swap_b32 v233, v235
  buffer_store_dwordx4 v[232:235], v4, s[4:7], s78 offen sc1
  v_cvt_pk_bf16_f32 v241, v86, v102
  v_cvt_pk_bf16_f32 v243, v87, v103
  s_add_u32 s78, s86, 393216
  v_permlane16_swap_b32 v237, v239
  buffer_store_dwordx4 v[236:239], v4, s[4:7], s78 offen sc1
  s_add_u32 s78, s86, 425984
  v_permlane16_swap_b32 v241, v243
  buffer_store_dwordx4 v[240:243], v4, s[4:7], s78 offen sc1
o_we_205:
  v_and_b32 v37, -32, v39
  s_waitcnt lgkmcnt(0)
  s_barrier
  ds_read_b128 v[104:107], v37 offset:16
  s_mov_b32 s65, s63
  s_waitcnt lgkmcnt(0)
  v_and_b32 v104, v104, v106
  v_max_u32 v105, v105, v107
  v_readfirstlane_b32 s26, v104
  v_readfirstlane_b32 s3, v105
  s_and_b32 s66, s26, 1
  s_and_b32 s76, s26, 2
  s_bitcmp1_b32 s26, 2
  s_cselect_b32 s3, s3, 0
  s_cmp_lg_u32 s76, 0
  s_cbranch_scc1 o_nofl_179
  s_and_b32 s26, s63, 49152
  s_cbranch_scc0 o_fl_180
  s_and_b32 s26, s64, s50
  s_cbranch_scc1 o_nofl_179
o_fl_180:
  s_cmp_ge_u32 s17, 2
  s_cbranch_scc1 o_fd_219
  s_cmp_eq_u32 s65, 0
  s_cbranch_scc1 o_fd_219
  s_mov_b32 s96, s42
  s_waitcnt vmcnt(0)
  s_mov_b64 exec, 1
  buffer_store_dword v38, off, s[4:7], s84 sc1
  s_mov_b64 exec, -1
  s_mov_b32 s84, 268435456
  s_lshl_b32 s97, s43, 14
  s_add_u32 s97, s97, s86
  buffer_load_dword v7, v255, s[4:7], s97 offen sc1
  s_and_b32 s91, s65, 63
  s_lshl_b32 s90, s91, 5
  s_add_u32 s94, s90, s85
  s_add_u32 s90, s90, s43
  s_lshl_b32 s94, s94, 10
  s_lshr_b32 s92, s65, 22
  s_xor_b32 s93, s43, 32
  s_lshl_b32 s91, s90, 10
  s_add_u32 s94, s94, 25165824
  s_cmp_eq_u32 s92, s93
  s_cselect_b32 s92, s94, s91
  s_add_u32 s92, s92, 10485760
  s_and_b32 s93, s65, 49152
  s_cselect_b32 s92, s92, s91
  s_cselect_b64 s[80:81], s[4:5], s[72:73]
  s_cselect_b32 s82, s6, s74
  buffer_load_dwordx4 v[184:187], v0, s[80:83], s92 offen sc1
  s_mov_b32 s67, 0
  s_mov_b64 vcc, 0
  s_waitcnt vmcnt(1)
o_pl_221:
  v_and_b32 v7, 1, v7
  v_cmp_ne_u32 vcc, s96, v7
  s_cbranch_vccz o_pk_222
  buffer_load_dword v7, v255, s[4:7], s97 offen sc1
  s_add_u32 s67, s67, 1
  s_cmp_gt_u32 s67, 1048576
  s_cbranch_scc1 L_end
  s_waitcnt vmcnt(0)
  s_branch o_pl_221
o_pk_222:
  s_and_b32 s26, s65, 49152
  s_cbranch_scc1 o_f2_220
  s_lshl_b32 s94, s43, 14
  s_add_u32 s94, s94, s86
  buffer_load_dwordx4 v[120:123], v5, s[4:7], s94 offen offset:0 sc1
  buffer_load_dwordx4 v[124:127], v5, s[4:7], s94 offen offset:512 sc1
  buffer_load_dwordx4 v[128:131], v5, s[4:7], s94 offen offset:256 sc1
  buffer_load_dwordx4 v[132:135], v5, s[4:7], s94 offen offset:768 sc1
  s_add_u32 s94, s94, 4096
  buffer_load_dwordx4 v[136:139], v5, s[4:7], s94 offen offset:0 sc1
  buffer_load_dwordx4 v[140:143], v5, s[4:7], s94 offen offset:512 sc1
  buffer_load_dwordx4 v[144:147], v5, s[4:7], s94 offen offset:256 sc1
  buffer_load_dwordx4 v[148:151], v5, s[4:7], s94 offen offset:768 sc1
  s_add_u32 s94, s94, 4096
  buffer_load_dwordx4 v[152:155], v5, s[4:7], s94 offen offset:0 sc1
  buffer_load_dwordx4 v[156:159], v5, s[4:7], s94 offen offset:512 sc1
  buffer_load_dwordx4 v[160:163], v5, s[4:7], s94 offen offset:256 sc1
  buffer_load_dwordx4 v[164:167], v5, s[4:7], s94 offen offset:768 sc1
  s_add_u32 s94, s94, 4096
  buffer_load_dwordx4 v[168:171], v5, s[4:7], s94 offen offset:0 sc1
  buffer_load_dwordx4 v[172:175], v5, s[4:7], s94 offen offset:512 sc1
  buffer_load_dwordx4 v[176:179], v5, s[4:7], s94 offen offset:256 sc1
  buffer_load_dwordx4 v[180:183], v5, s[4:7], s94 offen offset:768 sc1
  v_mov_b64 v[188:189], 0
  v_mov_b64 v[190:191], 0
  v_mov_b64 v[192:193], 0
  v_mov_b64 v[194:195], 0
  s_waitcnt vmcnt(12)
  v_xor_b32 v7, s96, v120
  v_bitop3_b32 v7, v7, v124, s96 bitop3:0xf6
  v_bitop3_b32 v7, v7, v128, s96 bitop3:0xf6
  v_bitop3_b32 v7, v7, v132, s96 bitop3:0xf6
  s_waitcnt vmcnt(8)
  v_bitop3_b32 v7, v7, v136, s96 bitop3:0xf6
  v_bitop3_b32 v7, v7, v140, s96 bitop3:0xf6
  v_bitop3_b32 v7, v7, v144, s96 bitop3:0xf6
  v_bitop3_b32 v7, v7, v148, s96 bitop3:0xf6
  s_waitcnt vmcnt(4)
  v_bitop3_b32 v7, v7, v152, s96 bitop3:0xf6
  v_bitop3_b32 v7, v7, v156, s96 bitop3:0xf6
  v_bitop3_b32 v7, v7, v160, s96 bitop3:0xf6
  v_bitop3_b32 v7, v7, v164, s96 bitop3:0xf6
  s_waitcnt vmcnt(0)
  v_bitop3_b32 v7, v7, v168, s96 bitop3:0xf6
  v_bitop3_b32 v7, v7, v172, s96 bitop3:0xf6
  v_bitop3_b32 v7, v7, v176, s96 bitop3:0xf6
  v_bitop3_b32 v7, v7, v180, s96 bitop3:0xf6
  v_and_b32 v7, v254, v7
  v_cmp_ne_u32 vcc, 0, v7
  s_cbranch_vccnz o_rt_223
o_bk_224:
  v_smfmac_f32_16x16x64_bf16 v[188:191], v[16:19], v[120:127], v20
  v_lshlrev_b32 v196, 16, v184
  v_smfmac_f32_16x16x64_bf16 v[192:195], v[16:19], v[128:135], v20
  v_and_b32 v197, 0xffff0000, v184
  v_smfmac_f32_16x16x64_bf16 v[188:191], v[16:19], v[136:143], v20
  v_lshlrev_b32 v198, 16, v185
  v_smfmac_f32_16x16x64_bf16 v[192:195], v[16:19], v[144:151], v20
  v_and_b32 v199, 0xffff0000, v185
  v_smfmac_f32_16x16x64_bf16 v[188:191], v[16:19], v[152:159], v20
  v_lshlrev_b32 v200, 16, v186
  v_smfmac_f32_16x16x64_bf16 v[192:195], v[16:19], v[160:167], v20
  v_and_b32 v201, 0xffff0000, v186
  v_smfmac_f32_16x16x64_bf16 v[188:191], v[16:19], v[168:175], v20
  v_lshlrev_b32 v202, 16, v187
  v_smfmac_f32_16x16x64_bf16 v[192:195], v[16:19], v[176:183], v20
  v_and_b32 v203, 0xffff0000, v187
  s_bfe_u32 s92, s65, 131086
  s_lshl_b32 s92, s92, 21
  s_add_u32 s92, s92, s91
  s_add_u32 s93, s92, 27262976
  s_add_u32 s92, s92, 20971520
  s_nop 1
  v_permlane16_swap_b32 v188, v192
  v_permlane16_swap_b32 v189, v193
  v_permlane16_swap_b32 v190, v194
  v_permlane16_swap_b32 v191, v195
  v_cvt_pk_bf16_f32 v188, 0, v188
  v_cvt_pk_bf16_f32 v189, 0, v189
  v_cvt_pk_bf16_f32 v190, 0, v190
  v_cvt_pk_bf16_f32 v191, 0, v191
  v_cvt_pk_bf16_f32 v192, 0, v192
  v_cvt_pk_bf16_f32 v193, 0, v193
  v_cvt_pk_bf16_f32 v194, 0, v194
  v_cvt_pk_bf16_f32 v195, 0, v195
  v_add_f32 v196, v196, v188
  v_add_f32 v197, v197, v189
  v_add_f32 v198, v198, v190
  v_add_f32 v199, v199, v191
  v_add_f32 v200, v200, v192
  v_add_f32 v201, v201, v193
  v_add_f32 v202, v202, v194
  v_add_f32 v203, v203, v195
  v_cvt_pk_bf16_f32 v120, v196, v197
  v_cvt_pk_bf16_f32 v121, v198, v199
  v_cvt_pk_bf16_f32 v122, v200, v201
  v_cvt_pk_bf16_f32 v123, v202, v203
  v_lshlrev_b32 v196, 16, v120
  v_and_b32 v197, 0xffff0000, v120
  v_lshlrev_b32 v198, 16, v121
  v_and_b32 v199, 0xffff0000, v121
  v_lshlrev_b32 v200, 16, v122
  v_and_b32 v201, 0xffff0000, v122
  v_lshlrev_b32 v202, 16, v123
  v_and_b32 v203, 0xffff0000, v123
  buffer_store_dwordx4 v[120:123], v0, s[4:7], s92 offen sc1
  v_add_f32 v136, v196, v197
  v_mul_f32 v137, v196, v196
  v_add_f32 v138, v198, v199
  v_mul_f32 v139, v197, v197
  v_fmac_f32 v137, v198, v198
  v_fmac_f32 v139, v199, v199
  v_add_f32 v136, v136, v200
  v_fmac_f32 v137, v200, v200
  v_add_f32 v138, v138, v201
  v_fmac_f32 v139, v201, v201
  v_add_f32 v136, v136, v202
  v_fmac_f32 v137, v202, v202
  v_add_f32 v138, v138, v203
  v_fmac_f32 v139, v203, v203
  v_add_f32 v136, v136, v138
  v_add_f32 v137, v137, v139
  s_nop 0
  v_add_f32_dpp v136, v136, v136 row_ror:8 row_mask:0xf bank_mask:0xf
  v_add_f32_dpp v137, v137, v137 row_ror:8 row_mask:0xf bank_mask:0xf
  s_nop 0
  v_add_f32_dpp v136, v136, v136 row_ror:4 row_mask:0xf bank_mask:0xf
  v_add_f32_dpp v137, v137, v137 row_ror:4 row_mask:0xf bank_mask:0xf
  s_nop 0
  v_add_f32_dpp v136, v136, v136 row_ror:2 row_mask:0xf bank_mask:0xf
  v_add_f32_dpp v137, v137, v137 row_ror:2 row_mask:0xf bank_mask:0xf
  s_nop 0
  v_add_f32_dpp v136, v136, v136 row_ror:1 row_mask:0xf bank_mask:0xf
  v_add_f32_dpp v137, v137, v137 row_ror:1 row_mask:0xf bank_mask:0xf
  v_mov_b32 v140, v136
  v_mov_b32 v141, v137
  s_nop 0
  v_permlane16_swap_b32 v136, v140
  v_permlane16_swap_b32 v137, v141
  v_add_f32 v136, v136, v140
  v_add_f32 v137, v137, v141
  v_mov_b32 v140, v136
  v_mov_b32 v141, v137
  s_nop 0
  v_permlane32_swap_b32 v136, v140
  v_permlane32_swap_b32 v137, v141
  v_add_f32 v136, v136, v140
  v_add_f32 v137, v137, v141
  v_mul_f32 v136, 0x3b000000, v136
  v_mul_f32 v137, 0x3b000000, v137
  v_fma_f32 v137, -v136, v136, v137
  v_cvt_pk_bf16_f32 v136, 0, v136
  v_max_f32 v137, 0, v137
  v_sub_f32 v140, v196, v136
  v_sub_f32 v141, v197, v136
  v_cvt_pk_bf16_f32 v137, 0, v137
  v_sub_f32 v142, v198, v136
  v_sub_f32 v143, v199, v136
  v_add_f32 v137, 0x3727c5ac, v137
  v_sub_f32 v144, v200, v136
  v_sub_f32 v145, v201, v136
  v_cvt_pk_bf16_f32 v137, 0, v137
  v_sub_f32 v146, v202, v136
  v_sub_f32 v147, v203, v136
  v_sqrt_f32 v137, v137
  v_cvt_pk_bf16_f32 v140, 0, v140
  v_cvt_pk_bf16_f32 v141, 0, v141
  v_cvt_pk_bf16_f32 v137, 0, v137
  v_cvt_pk_bf16_f32 v142, 0, v142
  v_cvt_pk_bf16_f32 v143, 0, v143
  v_rcp_f32 v137, v137
  v_cvt_pk_bf16_f32 v144, 0, v144
  v_cvt_pk_bf16_f32 v145, 0, v145
  v_cvt_pk_bf16_f32 v146, 0, v146
  v_cvt_pk_bf16_f32 v147, 0, v147
  v_mul_f32 v140, v140, v137
  v_mul_f32 v141, v141, v137
  v_mul_f32 v142, v142, v137
  v_mul_f32 v143, v143, v137
  v_mul_f32 v144, v144, v137
  v_mul_f32 v145, v145, v137
  v_mul_f32 v146, v146, v137
  v_mul_f32 v147, v147, v137
  v_cvt_pk_bf16_f32 v124, v140, v141
  v_cvt_pk_bf16_f32 v125, v142, v143
  v_cvt_pk_bf16_f32 v126, v144, v145
  v_cvt_pk_bf16_f32 v127, v146, v147
  v_lshlrev_b32 v204, 16, v124
  v_and_b32 v205, 0xffff0000, v124
  v_lshlrev_b32 v206, 16, v125
  v_and_b32 v207, 0xffff0000, v125
  v_lshlrev_b32 v208, 16, v126
  v_and_b32 v209, 0xffff0000, v126
  v_lshlrev_b32 v210, 16, v127
  v_and_b32 v211, 0xffff0000, v127
  buffer_store_dwordx4 v[124:127], v0, s[4:7], s93 offen sc1
  v_add_f32 v196, v196, v204
  v_add_f32 v197, v197, v205
  v_add_f32 v198, v198, v206
  v_add_f32 v199, v199, v207
  v_add_f32 v200, v200, v208
  v_add_f32 v201, v201, v209
  v_add_f32 v202, v202, v210
  v_add_f32 v203, v203, v211
  v_cvt_pk_bf16_f32 v128, v196, v197
  v_cvt_pk_bf16_f32 v129, v198, v199
  v_cvt_pk_bf16_f32 v130, v200, v201
  v_cvt_pk_bf16_f32 v131, v202, v203
  v_mul_f32 v188, v204, v8
  v_mul_f32 v189, v205, v9
  v_fmac_f32 v188, v206, v10
  v_fmac_f32 v189, v207, v11
  v_fmac_f32 v188, v208, v12
  v_fmac_f32 v189, v209, v13
  v_fmac_f32 v188, v210, v14
  v_fmac_f32 v189, v211, v15
  v_add_f32 v188, v188, v189
  s_add_u32 s92, s91, 10485760
  s_add_u32 s93, s91, 8388608
  buffer_store_dwordx4 v[128:131], v0, s[4:7], s92 offen sc1
  v_lshlrev_b32 v196, 16, v128
  v_and_b32 v197, 0xffff0000, v128
  v_lshlrev_b32 v198, 16, v129
  v_and_b32 v199, 0xffff0000, v129
  v_lshlrev_b32 v200, 16, v130
  v_and_b32 v201, 0xffff0000, v130
  v_lshlrev_b32 v202, 16, v131
  v_and_b32 v203, 0xffff0000, v131
  v_add_f32 v136, v196, v197
  v_mul_f32 v137, v196, v196
  v_add_f32 v138, v198, v199
  v_mul_f32 v139, v197, v197
  v_fmac_f32 v137, v198, v198
  v_fmac_f32 v139, v199, v199
  v_add_f32 v136, v136, v200
  v_fmac_f32 v137, v200, v200
  v_add_f32 v138, v138, v201
  v_fmac_f32 v139, v201, v201
  v_add_f32 v136, v136, v202
  v_fmac_f32 v137, v202, v202
  v_add_f32 v138, v138, v203
  v_fmac_f32 v139, v203, v203
  v_add_f32 v136, v136, v138
  v_add_f32 v137, v137, v139
  s_nop 0
  v_add_f32_dpp v136, v136, v136 row_ror:8 row_mask:0xf bank_mask:0xf
  v_add_f32_dpp v137, v137, v137 row_ror:8 row_mask:0xf bank_mask:0xf
  v_add_f32_dpp v188, v188, v188 row_ror:8 row_mask:0xf bank_mask:0xf
  v_add_f32_dpp v136, v136, v136 row_ror:4 row_mask:0xf bank_mask:0xf
  v_add_f32_dpp v137, v137, v137 row_ror:4 row_mask:0xf bank_mask:0xf
  v_add_f32_dpp v188, v188, v188 row_ror:4 row_mask:0xf bank_mask:0xf
  v_add_f32_dpp v136, v136, v136 row_ror:2 row_mask:0xf bank_mask:0xf
  v_add_f32_dpp v137, v137, v137 row_ror:2 row_mask:0xf bank_mask:0xf
  v_add_f32_dpp v188, v188, v188 row_ror:2 row_mask:0xf bank_mask:0xf
  v_add_f32_dpp v136, v136, v136 row_ror:1 row_mask:0xf bank_mask:0xf
  v_add_f32_dpp v137, v137, v137 row_ror:1 row_mask:0xf bank_mask:0xf
  v_add_f32_dpp v188, v188, v188 row_ror:1 row_mask:0xf bank_mask:0xf
  v_mov_b32 v140, v136
  v_mov_b32 v141, v137
  v_mov_b32 v142, v188
  v_permlane16_swap_b32 v136, v140
  v_permlane16_swap_b32 v137, v141
  v_permlane16_swap_b32 v188, v142
  v_add_f32 v136, v136, v140
  v_add_f32 v137, v137, v141
  v_add_f32 v188, v188, v142
  v_mov_b32 v140, v136
  v_mov_b32 v141, v137
  v_mov_b32 v142, v188
  v_permlane32_swap_b32 v136, v140
  v_permlane32_swap_b32 v137, v141
  v_permlane32_swap_b32 v188, v142
  v_add_f32 v136, v136, v140
  v_add_f32 v137, v137, v141
  v_add_f32 v188, v188, v142
  v_mul_f32 v136, 0x3b000000, v136
  v_mul_f32 v137, 0x3b000000, v137
  v_fma_f32 v137, -v136, v136, v137
  v_cvt_pk_bf16_f32 v136, 0, v136
  v_max_f32 v137, 0, v137
  v_sub_f32 v140, v196, v136
  v_sub_f32 v141, v197, v136
  v_cvt_pk_bf16_f32 v137, 0, v137
  v_sub_f32 v142, v198, v136
  v_sub_f32 v143, v199, v136
  v_add_f32 v137, 0x3727c5ac, v137
  v_sub_f32 v144, v200, v136
  v_sub_f32 v145, v201, v136
  v_cvt_pk_bf16_f32 v137, 0, v137
  v_sub_f32 v146, v202, v136
  v_sub_f32 v147, v203, v136
  v_sqrt_f32 v137, v137
  v_cvt_pk_bf16_f32 v140, 0, v140
  v_cvt_pk_bf16_f32 v141, 0, v141
  v_cvt_pk_bf16_f32 v137, 0, v137
  v_cvt_pk_bf16_f32 v142, 0, v142
  v_cvt_pk_bf16_f32 v143, 0, v143
  v_rcp_f32 v137, v137
  v_cvt_pk_bf16_f32 v144, 0, v144
  v_cvt_pk_bf16_f32 v145, 0, v145
  v_cvt_pk_bf16_f32 v146, 0, v146
  v_cvt_pk_bf16_f32 v147, 0, v147
  v_mul_f32 v140, v140, v137
  v_mul_f32 v141, v141, v137
  v_mul_f32 v142, v142, v137
  v_mul_f32 v143, v143, v137
  v_mul_f32 v144, v144, v137
  v_mul_f32 v145, v145, v137
  v_mul_f32 v146, v146, v137
  v_mul_f32 v147, v147, v137
  v_cvt_pk_bf16_f32 v132, v140, v141
  v_cvt_pk_bf16_f32 v133, v142, v143
  v_cvt_pk_bf16_f32 v134, v144, v145
  v_cvt_pk_bf16_f32 v135, v146, v147
  buffer_store_dwordx4 v[132:135], v0, s[4:7], s93 offen sc1
  v_cvt_pk_bf16_f32 v188, 0, v188
  v_ashrrev_i32 v189, 31, v188
  v_or_b32 v189, 0x80000000, v189
  v_xor_b32 v188, v188, v189
  s_sub_u32 s92, 4095, s90
  v_and_b32 v188, 0xffff0000, v188
  v_or_b32 v38, s92, v188
  s_bfe_u32 s92, s65, 196625
  s_lshl_b32 s92, s92, 18
  s_lshl_b32 s93, s90, 7
  s_add_u32 s92, s92, s93
  s_add_u32 s84, s92, 243269632
  s_waitcnt vmcnt(0)
  s_mov_b64 exec, 1
  buffer_store_dword v38, off, s[4:7], s84 sc1
  s_mov_b64 exec, -1
  s_mov_b32 s84, 268435456
  s_branch o_fd_219
o_rt_223:
  s_mov_b32 s67, 0
o_rl_225:
  s_lshl_b32 s94, s43, 14
  s_add_u32 s94, s94, s86
  buffer_load_dwordx4 v[120:123], v5, s[4:7], s94 offen offset:0 sc1
  buffer_load_dwordx4 v[124:127], v5, s[4:7], s94 offen offset:512 sc1
  buffer_load_dwordx4 v[128:131], v5, s[4:7], s94 offen offset:256 sc1
  buffer_load_dwordx4 v[132:135], v5, s[4:7], s94 offen offset:768 sc1
  s_add_u32 s94, s94, 4096
  buffer_load_dwordx4 v[136:139], v5, s[4:7], s94 offen offset:0 sc1
  buffer_load_dwordx4 v[140:143], v5, s[4:7], s94 offen offset:512 sc1
  buffer_load_dwordx4 v[144:147], v5, s[4:7], s94 offen offset:256 sc1
  buffer_load_dwordx4 v[148:151], v5, s[4:7], s94 offen offset:768 sc1
  s_add_u32 s94, s94, 4096
  buffer_load_dwordx4 v[152:155], v5, s[4:7], s94 offen offset:0 sc1
  buffer_load_dwordx4 v[156:159], v5, s[4:7], s94 offen offset:512 sc1
  buffer_load_dwordx4 v[160:163], v5, s[4:7], s94 offen offset:256 sc1
  buffer_load_dwordx4 v[164:167], v5, s[4:7], s94 offen offset:768 sc1
  s_add_u32 s94, s94, 4096
  buffer_load_dwordx4 v[168:171], v5, s[4:7], s94 offen offset:0 sc1
  buffer_load_dwordx4 v[172:175], v5, s[4:7], s94 offen offset:512 sc1
  buffer_load_dwordx4 v[176:179], v5, s[4:7], s94 offen offset:256 sc1
  buffer_load_dwordx4 v[180:183], v5, s[4:7], s94 offen offset:768 sc1
  s_add_u32 s67, s67, 1
  s_cmp_gt_u32 s67, 1048576
  s_cbranch_scc1 L_end
  s_waitcnt vmcnt(0)
  v_xor_b32 v7, s96, v120
  v_bitop3_b32 v7, v7, v124, s96 bitop3:0xf6
  v_bitop3_b32 v7, v7, v128, s96 bitop3:0xf6
  v_bitop3_b32 v7, v7, v132, s96 bitop3:0xf6
  v_bitop3_b32 v7, v7, v136, s96 bitop3:0xf6
  v_bitop3_b32 v7, v7, v140, s96 bitop3:0xf6
  v_bitop3_b32 v7, v7, v144, s96 bitop3:0xf6
  v_bitop3_b32 v7, v7, v148, s96 bitop3:0xf6
  v_bitop3_b32 v7, v7, v152, s96 bitop3:0xf6
  v_bitop3_b32 v7, v7, v156, s96 bitop3:0xf6
  v_bitop3_b32 v7, v7, v160, s96 bitop3:0xf6
  v_bitop3_b32 v7, v7, v164, s96 bitop3:0xf6
  v_bitop3_b32 v7, v7, v168, s96 bitop3:0xf6
  v_bitop3_b32 v7, v7, v172, s96 bitop3:0xf6
  v_bitop3_b32 v7, v7, v176, s96 bitop3:0xf6
  v_bitop3_b32 v7, v7, v180, s96 bitop3:0xf6
  v_and_b32 v7, v254, v7
  v_cmp_ne_u32 vcc, 0, v7
  s_cbranch_vccnz o_rl_225
  s_branch o_bk_224
o_f2_220:
  s_lshl_b32 s94, s43, 14
  s_add_u32 s94, s94, s86
  buffer_load_dwordx4 v[120:123], v5, s[4:7], s94 offen offset:0 sc1
  buffer_load_dwordx4 v[124:127], v5, s[4:7], s94 offen offset:512 sc1
  buffer_load_dwordx4 v[128:131], v5, s[4:7], s94 offen offset:256 sc1
  buffer_load_dwordx4 v[132:135], v5, s[4:7], s94 offen offset:768 sc1
  s_add_u32 s94, s94, 4096
  buffer_load_dwordx4 v[136:139], v5, s[4:7], s94 offen offset:0 sc1
  buffer_load_dwordx4 v[140:143], v5, s[4:7], s94 offen offset:512 sc1
  buffer_load_dwordx4 v[144:147], v5, s[4:7], s94 offen offset:256 sc1
  buffer_load_dwordx4 v[148:151], v5, s[4:7], s94 offen offset:768 sc1
  s_add_u32 s94, s94, 4096
  buffer_load_dwordx4 v[152:155], v5, s[4:7], s94 offen offset:0 sc1
  buffer_load_dwordx4 v[156:159], v5, s[4:7], s94 offen offset:512 sc1
  buffer_load_dwordx4 v[160:163], v5, s[4:7], s94 offen offset:256 sc1
  buffer_load_dwordx4 v[164:167], v5, s[4:7], s94 offen offset:768 sc1
  s_add_u32 s94, s94, 4096
  buffer_load_dwordx4 v[168:171], v5, s[4:7], s94 offen offset:0 sc1
  buffer_load_dwordx4 v[172:175], v5, s[4:7], s94 offen offset:512 sc1
  buffer_load_dwordx4 v[176:179], v5, s[4:7], s94 offen offset:256 sc1
  buffer_load_dwordx4 v[180:183], v5, s[4:7], s94 offen offset:768 sc1
  v_mov_b64 v[188:189], 0
  v_mov_b64 v[190:191], 0
  v_mov_b64 v[192:193], 0
  v_mov_b64 v[194:195], 0
  s_waitcnt vmcnt(12)
  v_xor_b32 v7, s96, v120
  v_bitop3_b32 v7, v7, v124, s96 bitop3:0xf6
  v_bitop3_b32 v7, v7, v128, s96 bitop3:0xf6
  v_bitop3_b32 v7, v7, v132, s96 bitop3:0xf6
  s_waitcnt vmcnt(8)
  v_bitop3_b32 v7, v7, v136, s96 bitop3:0xf6
  v_bitop3_b32 v7, v7, v140, s96 bitop3:0xf6
  v_bitop3_b32 v7, v7, v144, s96 bitop3:0xf6
  v_bitop3_b32 v7, v7, v148, s96 bitop3:0xf6
  s_waitcnt vmcnt(4)
  v_bitop3_b32 v7, v7, v152, s96 bitop3:0xf6
  v_bitop3_b32 v7, v7, v156, s96 bitop3:0xf6
  v_bitop3_b32 v7, v7, v160, s96 bitop3:0xf6
  v_bitop3_b32 v7, v7, v164, s96 bitop3:0xf6
  s_waitcnt vmcnt(0)
  v_bitop3_b32 v7, v7, v168, s96 bitop3:0xf6
  v_bitop3_b32 v7, v7, v172, s96 bitop3:0xf6
  v_bitop3_b32 v7, v7, v176, s96 bitop3:0xf6
  v_bitop3_b32 v7, v7, v180, s96 bitop3:0xf6
  v_and_b32 v7, v254, v7
  v_cmp_ne_u32 vcc, 0, v7
  s_cbranch_vccnz o_rt_226
o_bk_227:
  v_smfmac_f32_16x16x64_bf16 v[188:191], v[16:19], v[120:127], v20
  v_lshlrev_b32 v196, 16, v184
  v_smfmac_f32_16x16x64_bf16 v[192:195], v[16:19], v[128:135], v20
  v_and_b32 v197, 0xffff0000, v184
  v_smfmac_f32_16x16x64_bf16 v[188:191], v[16:19], v[136:143], v20
  v_lshlrev_b32 v198, 16, v185
  v_smfmac_f32_16x16x64_bf16 v[192:195], v[16:19], v[144:151], v20
  v_and_b32 v199, 0xffff0000, v185
  v_smfmac_f32_16x16x64_bf16 v[188:191], v[16:19], v[152:159], v20
  v_lshlrev_b32 v200, 16, v186
  v_smfmac_f32_16x16x64_bf16 v[192:195], v[16:19], v[160:167], v20
  v_and_b32 v201, 0xffff0000, v186
  v_smfmac_f32_16x16x64_bf16 v[188:191], v[16:19], v[168:175], v20
  v_lshlrev_b32 v202, 16, v187
  v_smfmac_f32_16x16x64_bf16 v[192:195], v[16:19], v[176:183], v20
  v_and_b32 v203, 0xffff0000, v187
  s_bfe_u32 s92, s65, 131086
  s_lshl_b32 s92, s92, 21
  s_add_u32 s92, s92, s91
  s_add_u32 s93, s92, 27262976
  s_add_u32 s92, s92, 20971520
  s_nop 1
  v_permlane16_swap_b32 v188, v192
  v_permlane16_swap_b32 v189, v193
  v_permlane16_swap_b32 v190, v194
  v_permlane16_swap_b32 v191, v195
  v_cvt_pk_bf16_f32 v188, 0, v188
  v_cvt_pk_bf16_f32 v189, 0, v189
  v_cvt_pk_bf16_f32 v190, 0, v190
  v_cvt_pk_bf16_f32 v191, 0, v191
  v_cvt_pk_bf16_f32 v192, 0, v192
  v_cvt_pk_bf16_f32 v193, 0, v193
  v_cvt_pk_bf16_f32 v194, 0, v194
  v_cvt_pk_bf16_f32 v195, 0, v195
  v_add_f32 v196, v196, v188
  v_add_f32 v197, v197, v189
  v_add_f32 v198, v198, v190
  v_add_f32 v199, v199, v191
  v_add_f32 v200, v200, v192
  v_add_f32 v201, v201, v193
  v_add_f32 v202, v202, v194
  v_add_f32 v203, v203, v195
  v_cvt_pk_bf16_f32 v120, v196, v197
  v_cvt_pk_bf16_f32 v121, v198, v199
  v_cvt_pk_bf16_f32 v122, v200, v201
  v_cvt_pk_bf16_f32 v123, v202, v203
  v_lshlrev_b32 v196, 16, v120
  v_and_b32 v197, 0xffff0000, v120
  v_lshlrev_b32 v198, 16, v121
  v_and_b32 v199, 0xffff0000, v121
  v_lshlrev_b32 v200, 16, v122
  v_and_b32 v201, 0xffff0000, v122
  v_lshlrev_b32 v202, 16, v123
  v_and_b32 v203, 0xffff0000, v123
  buffer_store_dwordx4 v[120:123], v0, s[4:7], s92 offen sc1
  v_add_f32 v136, v196, v197
  v_mul_f32 v137, v196, v196
  v_add_f32 v138, v198, v199
  v_mul_f32 v139, v197, v197
  v_fmac_f32 v137, v198, v198
  v_fmac_f32 v139, v199, v199
  v_add_f32 v136, v136, v200
  v_fmac_f32 v137, v200, v200
  v_add_f32 v138, v138, v201
  v_fmac_f32 v139, v201, v201
  v_add_f32 v136, v136, v202
  v_fmac_f32 v137, v202, v202
  v_add_f32 v138, v138, v203
  v_fmac_f32 v139, v203, v203
  v_add_f32 v136, v136, v138
  v_add_f32 v137, v137, v139
  s_nop 0
  v_add_f32_dpp v136, v136, v136 row_ror:8 row_mask:0xf bank_mask:0xf
  v_add_f32_dpp v137, v137, v137 row_ror:8 row_mask:0xf bank_mask:0xf
  s_nop 0
  v_add_f32_dpp v136, v136, v136 row_ror:4 row_mask:0xf bank_mask:0xf
  v_add_f32_dpp v137, v137, v137 row_ror:4 row_mask:0xf bank_mask:0xf
  s_nop 0
  v_add_f32_dpp v136, v136, v136 row_ror:2 row_mask:0xf bank_mask:0xf
  v_add_f32_dpp v137, v137, v137 row_ror:2 row_mask:0xf bank_mask:0xf
  s_nop 0
  v_add_f32_dpp v136, v136, v136 row_ror:1 row_mask:0xf bank_mask:0xf
  v_add_f32_dpp v137, v137, v137 row_ror:1 row_mask:0xf bank_mask:0xf
  v_mov_b32 v140, v136
  v_mov_b32 v141, v137
  s_nop 0
  v_permlane16_swap_b32 v136, v140
  v_permlane16_swap_b32 v137, v141
  v_add_f32 v136, v136, v140
  v_add_f32 v137, v137, v141
  v_mov_b32 v140, v136
  v_mov_b32 v141, v137
  s_nop 0
  v_permlane32_swap_b32 v136, v140
  v_permlane32_swap_b32 v137, v141
  v_add_f32 v136, v136, v140
  v_add_f32 v137, v137, v141
  v_mul_f32 v136, 0x3b000000, v136
  v_mul_f32 v137, 0x3b000000, v137
  v_fma_f32 v137, -v136, v136, v137
  v_cvt_pk_bf16_f32 v136, 0, v136
  v_max_f32 v137, 0, v137
  v_sub_f32 v140, v196, v136
  v_sub_f32 v141, v197, v136
  v_cvt_pk_bf16_f32 v137, 0, v137
  v_sub_f32 v142, v198, v136
  v_sub_f32 v143, v199, v136
  v_add_f32 v137, 0x3727c5ac, v137
  v_sub_f32 v144, v200, v136
  v_sub_f32 v145, v201, v136
  v_cvt_pk_bf16_f32 v137, 0, v137
  v_sub_f32 v146, v202, v136
  v_sub_f32 v147, v203, v136
  v_sqrt_f32 v137, v137
  v_cvt_pk_bf16_f32 v140, 0, v140
  v_cvt_pk_bf16_f32 v141, 0, v141
  v_cvt_pk_bf16_f32 v137, 0, v137
  v_cvt_pk_bf16_f32 v142, 0, v142
  v_cvt_pk_bf16_f32 v143, 0, v143
  v_rcp_f32 v137, v137
  v_cvt_pk_bf16_f32 v144, 0, v144
  v_cvt_pk_bf16_f32 v145, 0, v145
  v_cvt_pk_bf16_f32 v146, 0, v146
  v_cvt_pk_bf16_f32 v147, 0, v147
  v_mul_f32 v140, v140, v137
  v_mul_f32 v141, v141, v137
  v_mul_f32 v142, v142, v137
  v_mul_f32 v143, v143, v137
  v_mul_f32 v144, v144, v137
  v_mul_f32 v145, v145, v137
  v_mul_f32 v146, v146, v137
  v_mul_f32 v147, v147, v137
  v_cvt_pk_bf16_f32 v124, v140, v141
  v_cvt_pk_bf16_f32 v125, v142, v143
  v_cvt_pk_bf16_f32 v126, v144, v145
  v_cvt_pk_bf16_f32 v127, v146, v147
  v_lshlrev_b32 v204, 16, v124
  v_and_b32 v205, 0xffff0000, v124
  v_lshlrev_b32 v206, 16, v125
  v_and_b32 v207, 0xffff0000, v125
  v_lshlrev_b32 v208, 16, v126
  v_and_b32 v209, 0xffff0000, v126
  v_lshlrev_b32 v210, 16, v127
  v_and_b32 v211, 0xffff0000, v127
  buffer_store_dwordx4 v[124:127], v0, s[4:7], s93 offen sc1
  v_add_f32 v196, v196, v204
  v_add_f32 v197, v197, v205
  v_add_f32 v198, v198, v206
  v_add_f32 v199, v199, v207
  v_add_f32 v200, v200, v208
  v_add_f32 v201, v201, v209
  v_add_f32 v202, v202, v210
  v_add_f32 v203, v203, v211
  v_cvt_pk_bf16_f32 v128, v196, v197
  v_cvt_pk_bf16_f32 v129, v198, v199
  v_cvt_pk_bf16_f32 v130, v200, v201
  v_cvt_pk_bf16_f32 v131, v202, v203
  v_mul_f32 v188, v204, v8
  v_mul_f32 v189, v205, v9
  v_fmac_f32 v188, v206, v10
  v_fmac_f32 v189, v207, v11
  v_fmac_f32 v188, v208, v12
  v_fmac_f32 v189, v209, v13
  v_fmac_f32 v188, v210, v14
  v_fmac_f32 v189, v211, v15
  v_add_f32 v188, v188, v189
  buffer_store_dwordx4 v[128:131], v0, s[68:71], s91 offen sc1
  s_nop 0
  v_add_f32_dpp v188, v188, v188 row_ror:8 row_mask:0xf bank_mask:0xf
  s_nop 1
  v_add_f32_dpp v188, v188, v188 row_ror:4 row_mask:0xf bank_mask:0xf
  s_nop 1
  v_add_f32_dpp v188, v188, v188 row_ror:2 row_mask:0xf bank_mask:0xf
  s_nop 1
  v_add_f32_dpp v188, v188, v188 row_ror:1 row_mask:0xf bank_mask:0xf
  v_mov_b32 v189, v188
  s_nop 0
  s_nop 0
  v_permlane16_swap_b32 v188, v189
  v_add_f32 v188, v188, v189
  v_mov_b32 v189, v188
  s_nop 0
  s_nop 0
  v_permlane32_swap_b32 v188, v189
  v_add_f32 v188, v188, v189
  v_cvt_pk_bf16_f32 v188, 0, v188
  v_ashrrev_i32 v189, 31, v188
  v_or_b32 v189, 0x80000000, v189
  v_xor_b32 v188, v188, v189
  s_sub_u32 s92, 4095, s90
  v_and_b32 v188, 0xffff0000, v188
  v_or_b32 v38, s92, v188
  s_bfe_u32 s92, s65, 196625
  s_lshl_b32 s92, s92, 18
  s_lshl_b32 s93, s90, 7
  s_add_u32 s92, s92, s93
  s_add_u32 s84, s92, 243269632
  s_waitcnt vmcnt(0)
  s_mov_b64 exec, 1
  buffer_store_dword v38, off, s[4:7], s84 sc1
  s_mov_b64 exec, -1
  s_mov_b32 s84, 268435456
  s_branch o_fd_219
o_rt_226:
  s_mov_b32 s67, 0
o_rl_228:
  s_lshl_b32 s94, s43, 14
  s_add_u32 s94, s94, s86
  buffer_load_dwordx4 v[120:123], v5, s[4:7], s94 offen offset:0 sc1
  buffer_load_dwordx4 v[124:127], v5, s[4:7], s94 offen offset:512 sc1
  buffer_load_dwordx4 v[128:131], v5, s[4:7], s94 offen offset:256 sc1
  buffer_load_dwordx4 v[132:135], v5, s[4:7], s94 offen offset:768 sc1
  s_add_u32 s94, s94, 4096
  buffer_load_dwordx4 v[136:139], v5, s[4:7], s94 offen offset:0 sc1
  buffer_load_dwordx4 v[140:143], v5, s[4:7], s94 offen offset:512 sc1
  buffer_load_dwordx4 v[144:147], v5, s[4:7], s94 offen offset:256 sc1
  buffer_load_dwordx4 v[148:151], v5, s[4:7], s94 offen offset:768 sc1
  s_add_u32 s94, s94, 4096
  buffer_load_dwordx4 v[152:155], v5, s[4:7], s94 offen offset:0 sc1
  buffer_load_dwordx4 v[156:159], v5, s[4:7], s94 offen offset:512 sc1
  buffer_load_dwordx4 v[160:163], v5, s[4:7], s94 offen offset:256 sc1
  buffer_load_dwordx4 v[164:167], v5, s[4:7], s94 offen offset:768 sc1
  s_add_u32 s94, s94, 4096
  buffer_load_dwordx4 v[168:171], v5, s[4:7], s94 offen offset:0 sc1
  buffer_load_dwordx4 v[172:175], v5, s[4:7], s94 offen offset:512 sc1
  buffer_load_dwordx4 v[176:179], v5, s[4:7], s94 offen offset:256 sc1
  buffer_load_dwordx4 v[180:183], v5, s[4:7], s94 offen offset:768 sc1
  s_add_u32 s67, s67, 1
  s_cmp_gt_u32 s67, 1048576
  s_cbranch_scc1 L_end
  s_waitcnt vmcnt(0)
  v_xor_b32 v7, s96, v120
  v_bitop3_b32 v7, v7, v124, s96 bitop3:0xf6
  v_bitop3_b32 v7, v7, v128, s96 bitop3:0xf6
  v_bitop3_b32 v7, v7, v132, s96 bitop3:0xf6
  v_bitop3_b32 v7, v7, v136, s96 bitop3:0xf6
  v_bitop3_b32 v7, v7, v140, s96 bitop3:0xf6
  v_bitop3_b32 v7, v7, v144, s96 bitop3:0xf6
  v_bitop3_b32 v7, v7, v148, s96 bitop3:0xf6
  v_bitop3_b32 v7, v7, v152, s96 bitop3:0xf6
  v_bitop3_b32 v7, v7, v156, s96 bitop3:0xf6
  v_bitop3_b32 v7, v7, v160, s96 bitop3:0xf6
  v_bitop3_b32 v7, v7, v164, s96 bitop3:0xf6
  v_bitop3_b32 v7, v7, v168, s96 bitop3:0xf6
  v_bitop3_b32 v7, v7, v172, s96 bitop3:0xf6
  v_bitop3_b32 v7, v7, v176, s96 bitop3:0xf6
  v_bitop3_b32 v7, v7, v180, s96 bitop3:0xf6
  v_and_b32 v7, v254, v7
  v_cmp_ne_u32 vcc, 0, v7
  s_cbranch_vccnz o_rl_228
  s_branch o_bk_227
o_fd_219:
  s_mov_b32 s65, 0
o_nofl_179:
  s_mov_b32 s63, s64
  s_cmp_lg_u32 s51, 0
  s_cbranch_scc1 o_pick_181
  s_cmp_eq_u32 s50, 0
  s_cbranch_scc1 o_help_188_n
o_adv_187:
  s_add_u32 s49, s49, 4
  s_branch o_round_177
o_dl_189_a:
  s_andn2_b32 s26, s58, s55
  s_and_b32 s29, s26, s54
  s_bcnt1_i32_b32 s27, s29
  s_add_u32 s27, s27, 2
  s_max_u32 s27, s27, 4
  s_andn2_b32 s26, s26, s56
  s_and_b32 s26, s26, 0x3fff
  s_or_b32 s26, s26, s29
  s_cselect_b32 s27, s27, 0
  s_mul_i32 s27, s27, 0
  s_cmp_ge_u32 s46, s89
  s_cselect_b32 s30, s54, -1
  s_mov_b32 s31, 243269696
  s_branch o_dl_189_b
o_dl_189:
  s_and_b32 s26, s55, s54
  s_andn2_b32 s27, s56, s54
  s_or_b32 s26, s26, s27
  s_andn2_b32 s26, s58, s26
  s_bcnt1_i32_b32 s27, s26
  s_bcnt1_i32_b32 s28, s47
  s_mul_i32 s28, s28, -5
  s_lshl1_add_u32 s27, s27, s28
  s_add_i32 s27, s27, 1
  s_max_i32 s27, s27, 0
  s_mul_i32 s27, s27, 37
  s_mov_b32 s30, s54
  s_mov_b32 s31, 243269704
  s_and_b32 s29, s26, s47
  s_andn2_b32 s26, s26, s29
  s_branch o_dl_189_c
o_dl_189_b:
  s_mov_b32 s29, 0
o_dl_189_c:
  s_bfe_u32 s28, s48, 262144
  s_bitset0_b32 s26, s28
  s_bfe_u32 s28, s48, 262148
  s_bitset0_b32 s26, s28
  s_bfe_u32 s28, s48, 262152
  s_bitset0_b32 s26, s28
  s_bfe_u32 s28, s48, 262156
  s_bitset0_b32 s26, s28
  s_lshr_b32 s27, s27, 8
o_dl1_190:
  s_cbranch_scc0 o_dl2_191
  s_ff1_i32_b32 s28, s26
  s_bitset0_b32 s26, s28
  s_bitset1_b32 s29, s28
  s_sub_u32 s27, s27, 1
  s_cmp_lg_u32 s27, 0
  s_branch o_dl1_190
o_dl2_191:
  s_and_b32 s47, s29, 0xffff
  s_and_b32 s30, s30, s47
  s_or_b32 s55, s55, s30
  s_andn2_b32 s26, s47, s30
  s_or_b32 s56, s56, s26
  s_pack_ll_b32_b16 s26, s47, s30
  s_lshl_b32 s27, s60, 7
  s_add_u32 s27, s27, s31
  s_cmp_lg_u32 s43, 0
  s_cbranch_scc1 o_pick_181
  v_mov_b32 v162, s26
  v_mov_b32 v163, s46
  s_mov_b64 exec, 1
  buffer_store_dwordx2 v[162:163], off, s[4:7], s27 sc1
  s_mov_b64 exec, -1
  s_branch o_pick_181
o_help_188:
  s_lshl_b32 s60, s60, 1
  s_and_b32 s60, s60, 2
  s_lshl_b32 s47, s60, 7
  s_add_u32 s47, s47, 243269688
o_help_188_n:
  s_add_u32 s47, s47, 8
  s_lshr_b32 s26, s47, 4
  s_andn2_b32 s26, s57, s26
  s_cbranch_scc0 L_end
  s_mov_b32 s67, 0
o_help_188_w:
  buffer_load_dwordx2 v[162:163], off, s[4:7], s47 sc1
  buffer_load_dwordx2 v[164:165], off, s[4:7], s47 offset:128 sc1
  s_add_u32 s67, s67, 1
  s_cmp_gt_u32 s67, 1048576
  s_cbranch_scc1 L_end
  s_waitcnt vmcnt(0)
  v_readfirstlane_b32 s28, v162
  v_readfirstlane_b32 s30, v164
  v_readfirstlane_b32 s46, v163
  v_readfirstlane_b32 s27, v165
  s_min_u32 s26, s46, s27
  s_cmp_eq_u32 s26, 0
  s_cbranch_scc1 o_help_188_w
  s_max_u32 s46, s46, s27
  s_bitreplicate_b64_b32 s[28:29], s28
  s_bitreplicate_b64_b32 s[30:31], s30
  s_mov_b32 s26, 0x55555555
  s_mov_b32 s27, 0x55555555
  s_and_b64 s[28:29], s[28:29], s[26:27]
  s_andn2_b64 s[30:31], s[30:31], s[26:27]
  s_or_b32 s58, s28, s30
  s_or_b32 s54, s29, s31
  s_andn2_b32 s52, 0xfff, s46
  s_lshr_b32 s52, s52, 5
  s_mov_b32 s53, 0
  s_mov_b32 s63, 0
  s_mov_b32 s49, 72
  s_mov_b32 s59, 64
  s_mov_b32 s50, 0
  s_mov_b32 s89, 0
  s_branch o_pick_181

.section .rodata,"a"
.p2align 6
.amdhsa_kernel interleave_layers__memory_aug_recurrent_mem_tr__moe_arch_mod__prompt_kernel
  .amdhsa_next_free_vgpr 512
  .amdhsa_next_free_sgpr 102
  .amdhsa_accum_offset 256
  .amdhsa_group_segment_fixed_size 0
  .amdhsa_kernarg_size 120
  .amdhsa_user_sgpr_count 2
  .amdhsa_user_sgpr_kernarg_segment_ptr 1
  .amdhsa_system_sgpr_workgroup_id_x 1
  .amdhsa_float_denorm_mode_32 3
.end_amdhsa_kernel
```

```asm
; @launch grid=(256,1,1) block=(256,1,1) lds=163840
.amdgcn_target "amdgcn-amd-amdhsa--gfx950"
.text
.globl interleave_layers__memory_aug_recurrent_mem_tr__moe_arch_mod__prompt_kernel
.p2align 8
.type interleave_layers__memory_aug_recurrent_mem_tr__moe_arch_mod__prompt_kernel,@function
interleave_layers__memory_aug_recurrent_mem_tr__moe_arch_mod__prompt_kernel:
  s_cmp_ge_u32 s2, 256
  s_cbranch_scc1 L_end
  s_mov_b32 s6, 268435456
  s_mov_b32 s7, 0x20000
  s_mov_b32 s11, 0x20000
  s_getreg_b32 s89, hwreg(HW_REG_XCC_ID)
  s_and_b32 s89, s89, 7
  v_lshrrev_b32 v1, 6, v0
  s_and_b32 s91, s2, 7
  s_lshr_b32 s90, s2, 3
  v_readfirstlane_b32 s17, v1
  s_lshl_b32 s100, s91, 5
  s_add_u32 s100, s100, s90
  s_lshl_b32 s100, s100, 2
  s_add_u32 s100, s100, s17
  s_lshl_b32 s100, s100, 12
  s_add_u32 s100, s100, 37748736
  s_cmp_lt_u32 s91, 3
  s_cbranch_scc1 L_chain
  s_cmp_eq_u32 s91, 7
  s_cbranch_scc1 L_qkv
  s_bitcmp1_b32 s90, 4
  s_cbranch_scc1 L_qkv
  s_branch L_o
L_end:
  s_endpgm
L_chain:
  s_load_dwordx2 s[4:5], s[0:1], 112
  s_load_dwordx2 s[12:13], s[0:1], 104
  s_mov_b32 s16, s90
  s_mov_b32 s60, s91
  s_min_u32 s61, s91, 1
  v_lshrrev_b32 v18, 6, v0
  v_and_b32 v19, 63, v0
  v_readfirstlane_b32 s17, v18
  v_and_b32 v7, 15, v19
  v_lshrrev_b32 v17, 4, v19
  v_lshlrev_b32 v0, 4, v19
  s_load_dwordx2 s[56:57], s[0:1], 8
  s_mov_b32 s44, 0x05040100
  s_mov_b32 s45, 0x07060302
  s_mov_b32 s18, 0xcccccccc
  s_mov_b32 s19, 0xcccccccc
  s_mov_b32 s24, 0x3e0293ee
  s_lshl_b32 s26, s17, 10
  v_add_u32 v8, s26, v0
  v_xor_b32 v9, 1024, v8
  v_xor_b32 v10, 2048, v8
  v_xor_b32 v11, 3072, v8
  s_mov_b32 s14, 0x3f803f80
  s_mov_b32 s15, 0x3f803f80
  s_mul_i32 s27, s17, 24576
  s_add_u32 s27, s27, 65536
  v_add_u32 v1, s27, v0
  v_lshrrev_b32 v20, 2, v7
  v_xor_b32 v21, v17, v20
  v_lshlrev_b32 v22, 5, v7
  v_add_u32 v22, s26, v22
  v_lshl_add_u32 v2, v21, 3, v22
  v_and_b32 v21, 3, v7
  v_xor_b32 v21, v21, v17
  v_lshl_add_u32 v22, v17, 2, v20
  v_lshlrev_b32 v22, 5, v22
  v_lshl_add_u32 v3, v21, 3, v22
  v_add_u32 v12, s26, v3
  v_xor_b32 v13, 1024, v12
  v_xor_b32 v14, 2048, v12
  v_xor_b32 v15, 3072, v12
  v_lshlrev_b32 v21, 13, v20
  v_and_b32 v22, 3, v7
  v_lshl_add_u32 v22, v17, 2, v22
  v_lshl_add_u32 v21, v22, 4, v21
  s_lshl_b32 s27, s17, 16
  s_lshl_b32 s28, s16, 8
  s_add_u32 s27, s27, s28
  v_add_u32 v4, s27, v21
  v_and_b32 v21, 1, v7
  v_lshl_add_u32 v21, v17, 2, v21
  v_bfe_u32 v22, v7, 2, 1
  v_lshl_add_u32 v21, v22, 1, v21
  v_lshlrev_b32 v21, 4, v21
  v_bfe_u32 v22, v7, 1, 1
  v_lshl_add_u32 v21, v22, 3, v21
  v_add_u32 v5, s28, v21
  v_cmp_lt_u32 vcc, 7, v7
  v_mov_b32 v22, 0x7ff00000
  s_nop 0
  v_cndmask_b32 v5, v5, v22, vcc
  v_mov_b32 v21, 0x4444
  v_mov_b32 v22, 0xeeee
  v_cndmask_b32 v6, v21, v22, s[18:19]
  s_lshl_b32 s40, s60, 20
  s_add_u32 s40, s40, 0
  s_add_u32 s41, s40, 32768
  s_lshl_b32 s62, s60, 16
  s_add_u32 s62, s62, 4194304
  v_mov_b32 v24, -1
  v_mov_b32 v25, -1
  v_mov_b32 v26, -1
  v_mov_b32 v27, -1
  s_waitcnt lgkmcnt(0)
  buffer_store_dwordx4 v[24:27], v4, s[4:7], s40 offen sc1
  buffer_store_dwordx4 v[24:27], v4, s[4:7], s41 offen sc1
  s_add_u32 s27, s62, 0
  buffer_store_dwordx2 v[24:25], v5, s[4:7], s27 offen sc1
  s_add_u32 s27, s62, 8192
  buffer_store_dwordx2 v[24:25], v5, s[4:7], s27 offen sc1
  s_add_u32 s27, s62, 16384
  buffer_store_dwordx2 v[24:25], v5, s[4:7], s27 offen sc1
  s_add_u32 s27, s62, 24576
  buffer_store_dwordx2 v[24:25], v5, s[4:7], s27 offen sc1
  v_mov_b64 v[28:29], 0
  v_mov_b64 v[30:31], 0
  s_lshl_b32 s26, s16, 12
  s_cmp_eq_u32 s91, 0
  s_cbranch_scc1 L_ch1
  s_cmp_eq_u32 s91, 2
  s_cbranch_scc1 L_ch2
  s_add_u32 s27, s26, 243269632
  buffer_store_dwordx4 v[28:31], v8, s[4:7], s27 offen sc1
  s_add_u32 s27, s26, 243400704
  buffer_store_dwordx4 v[28:31], v8, s[4:7], s27 offen sc1
  s_add_u32 s27, s26, 243531776
  buffer_store_dwordx4 v[28:31], v8, s[4:7], s27 offen sc1
  s_add_u32 s27, s26, 243662848
  buffer_store_dwordx4 v[28:31], v8, s[4:7], s27 offen sc1
  s_add_u32 s27, s26, 243793920
  buffer_store_dwordx4 v[28:31], v8, s[4:7], s27 offen sc1
  s_add_u32 s27, s26, 243924992
  buffer_store_dwordx4 v[28:31], v8, s[4:7], s27 offen sc1
  s_add_u32 s27, s26, 244056064
  buffer_store_dwordx4 v[28:31], v8, s[4:7], s27 offen sc1
  s_add_u32 s27, s26, 244187136
  buffer_store_dwordx4 v[28:31], v8, s[4:7], s27 offen sc1
  s_add_u32 s27, s26, 244318208
  buffer_store_dwordx4 v[28:31], v8, s[4:7], s27 offen sc1
  s_add_u32 s27, s26, 244449280
  buffer_store_dwordx4 v[28:31], v8, s[4:7], s27 offen sc1
  s_add_u32 s27, s26, 244580352
  buffer_store_dwordx4 v[28:31], v8, s[4:7], s27 offen sc1
  s_add_u32 s27, s26, 244711424
  buffer_store_dwordx4 v[28:31], v8, s[4:7], s27 offen sc1
  s_add_u32 s27, s26, 244842496
  buffer_store_dwordx4 v[28:31], v8, s[4:7], s27 offen sc1
  s_add_u32 s27, s26, 244973568
  buffer_store_dwordx4 v[28:31], v8, s[4:7], s27 offen sc1
  s_add_u32 s27, s26, 245104640
  buffer_store_dwordx4 v[28:31], v8, s[4:7], s27 offen sc1
  s_add_u32 s27, s26, 245235712
  buffer_store_dwordx4 v[28:31], v8, s[4:7], s27 offen sc1
  s_add_u32 s27, s26, 245366784
  buffer_store_dwordx4 v[28:31], v8, s[4:7], s27 offen sc1
  s_branch L_ch0
L_ch2:
  s_add_u32 s27, s26, 245891072
  buffer_store_dwordx4 v[24:27], v8, s[4:7], s27 offen sc1
  s_add_u32 s27, s26, 246022144
  buffer_store_dwordx4 v[24:27], v8, s[4:7], s27 offen sc1
  s_add_u32 s27, s26, 246153216
  buffer_store_dwordx4 v[24:27], v8, s[4:7], s27 offen sc1
  s_add_u32 s27, s26, 246284288
  buffer_store_dwordx4 v[24:27], v8, s[4:7], s27 offen sc1
  s_add_u32 s27, s26, 246415360
  buffer_store_dwordx4 v[24:27], v8, s[4:7], s27 offen sc1
  s_add_u32 s27, s26, 246546432
  buffer_store_dwordx4 v[24:27], v8, s[4:7], s27 offen sc1
  s_add_u32 s27, s26, 246677504
  buffer_store_dwordx4 v[24:27], v8, s[4:7], s27 offen sc1
  s_add_u32 s27, s26, 246808576
  buffer_store_dwordx4 v[24:27], v8, s[4:7], s27 offen sc1
  s_add_u32 s27, s26, 246939648
  buffer_store_dwordx4 v[24:27], v8, s[4:7], s27 offen sc1
  s_add_u32 s27, s26, 247070720
  buffer_store_dwordx4 v[24:27], v8, s[4:7], s27 offen sc1
  s_add_u32 s27, s26, 247201792
  buffer_store_dwordx4 v[24:27], v8, s[4:7], s27 offen sc1
  s_add_u32 s27, s26, 247332864
  buffer_store_dwordx4 v[24:27], v8, s[4:7], s27 offen sc1
  s_add_u32 s27, s26, 247463936
  buffer_store_dwordx4 v[24:27], v8, s[4:7], s27 offen sc1
  s_add_u32 s27, s26, 247595008
  buffer_store_dwordx4 v[24:27], v8, s[4:7], s27 offen sc1
  s_add_u32 s27, s26, 247726080
  buffer_store_dwordx4 v[24:27], v8, s[4:7], s27 offen sc1
  s_add_u32 s27, s26, 247857152
  buffer_store_dwordx4 v[24:27], v8, s[4:7], s27 offen sc1
  s_add_u32 s27, s26, 247988224
  buffer_store_dwordx4 v[24:27], v8, s[4:7], s27 offen sc1
  s_add_u32 s27, s26, 248119296
  buffer_store_dwordx4 v[24:27], v8, s[4:7], s27 offen sc1
  s_add_u32 s27, s26, 248250368
  buffer_store_dwordx4 v[24:27], v8, s[4:7], s27 offen sc1
  s_add_u32 s27, s26, 248381440
  buffer_store_dwordx4 v[24:27], v8, s[4:7], s27 offen sc1
  s_add_u32 s27, s26, 248512512
  buffer_store_dwordx4 v[24:27], v8, s[4:7], s27 offen sc1
  s_add_u32 s27, s26, 248643584
  buffer_store_dwordx4 v[24:27], v8, s[4:7], s27 offen sc1
  s_add_u32 s27, s26, 16777216
  buffer_store_dwordx4 v[28:31], v8, s[4:7], s27 offen sc1
  s_add_u32 s27, s26, 16908288
  buffer_store_dwordx4 v[28:31], v8, s[4:7], s27 offen sc1
  s_add_u32 s27, s26, 17039360
  buffer_store_dwordx4 v[28:31], v8, s[4:7], s27 offen sc1
  s_add_u32 s27, s26, 17170432
  buffer_store_dwordx4 v[28:31], v8, s[4:7], s27 offen sc1
  s_add_u32 s27, s26, 17301504
  buffer_store_dwordx4 v[28:31], v8, s[4:7], s27 offen sc1
  s_add_u32 s27, s26, 17432576
  buffer_store_dwordx4 v[28:31], v8, s[4:7], s27 offen sc1
  s_add_u32 s27, s26, 17563648
  buffer_store_dwordx4 v[28:31], v8, s[4:7], s27 offen sc1
  s_add_u32 s27, s26, 17694720
  buffer_store_dwordx4 v[28:31], v8, s[4:7], s27 offen sc1
  s_add_u32 s27, s26, 17825792
  buffer_store_dwordx4 v[28:31], v8, s[4:7], s27 offen sc1
  s_add_u32 s27, s26, 17956864
  buffer_store_dwordx4 v[28:31], v8, s[4:7], s27 offen sc1
  s_add_u32 s27, s26, 18087936
  buffer_store_dwordx4 v[28:31], v8, s[4:7], s27 offen sc1
  s_add_u32 s27, s26, 18219008
  buffer_store_dwordx4 v[28:31], v8, s[4:7], s27 offen sc1
  s_add_u32 s27, s26, 18350080
  buffer_store_dwordx4 v[28:31], v8, s[4:7], s27 offen sc1
  s_add_u32 s27, s26, 18481152
  buffer_store_dwordx4 v[28:31], v8, s[4:7], s27 offen sc1
  s_add_u32 s27, s26, 18612224
  buffer_store_dwordx4 v[28:31], v8, s[4:7], s27 offen sc1
  s_add_u32 s27, s26, 18743296
  buffer_store_dwordx4 v[28:31], v8, s[4:7], s27 offen sc1
L_ch0:
  s_waitcnt vmcnt(0)
  s_barrier
  s_cmp_lg_u32 s17, 0
  s_cbranch_scc1 g_ar_1
  s_lshl_b32 s36, s89, 3
  s_lshl_b64 s[36:37], 1, s36
  v_lshlrev_b32 v124, 3, s91
  v_mov_b32 v120, s36
  v_mov_b32 v121, s37
  s_mov_b64 exec, 1
  global_atomic_add_x2 v[122:123], v124, v[120:121], s[12:13] sc0
  s_mov_b64 exec, -1
g_ar_1:
  s_waitcnt vmcnt(0)
  s_cmp_lg_u32 s17, 0
  s_cbranch_scc1 g_af_2
  v_readfirstlane_b32 s36, v122
  v_readfirstlane_b32 s37, v123
  s_add_u32 s38, s36, s37
  s_mul_i32 s38, s38, 0x01010101
  s_lshr_b32 s38, s38, 24
  s_cmp_lg_u32 s38, 31
  s_cbranch_scc1 g_af_2
  s_lshl_b32 s38, s89, 3
  s_lshr_b64 s[36:37], s[36:37], s38
  s_and_b32 s36, s36, 0xff
  s_cmp_eq_u32 s36, 31
  s_cselect_b32 s36, 1, 2
  v_mov_b32 v120, s36
  v_lshrrev_b32 v124, 1, v124
  s_mov_b64 exec, 1
  global_store_dword v124, v120, s[12:13] offset:128 sc1
  s_mov_b64 exec, -1
g_af_2:
L_ch1:
  s_mov_b32 s58, 8192
  s_mov_b32 s59, 0x20000
  v_and_b32 v21, 1, v7
  v_lshl_add_u32 v21, v17, 1, v21
  v_lshlrev_b32 v21, 10, v21
  v_bfe_u32 v22, v7, 1, 2
  v_lshl_add_u32 v21, v22, 1, v21
  s_lshr_b32 s27, s16, 3
  s_lshl_b32 s27, s27, 8
  s_and_b32 s28, s16, 3
  s_lshl_b32 s28, s28, 6
  s_add_u32 s27, s27, s28
  s_and_b32 s28, s16, 4
  s_lshl_b32 s28, s28, 1
  s_add_u32 s27, s27, s28
  s_waitcnt lgkmcnt(0)
  buffer_load_ushort v28, v21, s[56:59], s27 offen offset:0
  buffer_load_ushort v29, v21, s[56:59], s27 offen offset:16
  buffer_load_ushort v30, v21, s[56:59], s27 offen offset:32
  buffer_load_ushort v31, v21, s[56:59], s27 offen offset:48
  s_cmp_eq_u32 s91, 0
  s_cbranch_scc1 L_ha
  v_mbcnt_lo_u32_b32 v116, -1, 0
  v_and_b32 v116, 0, v116
  v_add_lshl_u32 v116, v116, 1, 2
  s_mov_b32 s26, 0
g_wt_3:
  global_load_dword v117, v116, s[12:13] offset:128 sc1
  s_add_u32 s26, s26, 1
  s_cmp_gt_u32 s26, 1048576
  s_cbranch_scc1 L_end
  s_waitcnt vmcnt(0)
  v_cmp_eq_u32 vcc, 0, v117
  v_readfirstlane_b32 s27, v117
  s_cbranch_vccnz g_wt_3
  s_and_b32 s28, s16, 28
  s_or_b32 s28, s28, 1
  s_lshl_b32 s27, s28, 6
  s_add_u32 s27, s27, 245104640
  s_mov_b32 s26, 0
g_h_4:
  buffer_load_dwordx2 v[116:117], off, s[4:7], s27 sc1
  s_add_u32 s26, s26, 1
  s_cmp_gt_u32 s26, 1048576
  s_cbranch_scc1 L_end
  s_waitcnt vmcnt(0)
  v_and_or_b32 v116, v117, -1, v116
  v_cmp_eq_u32 vcc, 0, v116
  s_cbranch_vccnz g_h_4
L_ha:
  s_load_dwordx2 s[8:9], s[0:1], 40
  s_load_dwordx2 s[52:53], s[0:1], 16
  s_load_dwordx2 s[32:33], s[0:1], 24
  s_load_dwordx2 s[48:49], s[0:1], 32
  s_mov_b32 s10, 4194304
  s_mov_b32 s11, 0x20000
  s_mov_b32 s54, 4194304
  s_mov_b32 s55, 0x20000
  s_mov_b32 s34, 4194304
  s_mov_b32 s35, 0x20000
  s_mov_b32 s50, 4194304
  s_mov_b32 s51, 0x20000
  v_and_b32 v20, 1, v17
  v_lshlrev_b32 v20, 5, v20
  v_lshrrev_b32 v21, 1, v17
  v_lshl_add_u32 v20, v21, 2, v20
  v_lshlrev_b32 v20, 10, v20
  v_lshl_add_u32 v20, v7, 4, v20
  s_lshl_b32 s26, s16, 17
  s_lshl_b32 s27, s17, 8
  s_add_u32 s26, s26, s27
  s_waitcnt lgkmcnt(0)
  s_add_u32 s27, s26, 0
  buffer_load_dwordx4 v[128:131], v20, s[8:11], s27 offen
  s_add_u32 s27, s26, 1024
  buffer_load_dwordx4 v[132:135], v20, s[8:11], s27 offen
  s_add_u32 s27, s26, 16384
  buffer_load_dwordx4 v[136:139], v20, s[8:11], s27 offen
  s_add_u32 s27, s26, 17408
  buffer_load_dwordx4 v[140:143], v20, s[8:11], s27 offen
  s_add_u32 s27, s26, 2048
  buffer_load_dwordx4 v[144:147], v20, s[8:11], s27 offen
  s_add_u32 s27, s26, 3072
  buffer_load_dwordx4 v[148:151], v20, s[8:11], s27 offen
  s_add_u32 s27, s26, 18432
  buffer_load_dwordx4 v[152:155], v20, s[8:11], s27 offen
  s_add_u32 s27, s26, 19456
  buffer_load_dwordx4 v[156:159], v20, s[8:11], s27 offen
  s_add_u32 s27, s26, 8192
  buffer_load_dwordx4 v[160:163], v20, s[8:11], s27 offen
  s_add_u32 s27, s26, 9216
  buffer_load_dwordx4 v[164:167], v20, s[8:11], s27 offen
  s_add_u32 s27, s26, 24576
  buffer_load_dwordx4 v[168:171], v20, s[8:11], s27 offen
  s_add_u32 s27, s26, 25600
  buffer_load_dwordx4 v[172:175], v20, s[8:11], s27 offen
  s_add_u32 s27, s26, 10240
  buffer_load_dwordx4 v[176:179], v20, s[8:11], s27 offen
  s_add_u32 s27, s26, 11264
  buffer_load_dwordx4 v[180:183], v20, s[8:11], s27 offen
  s_add_u32 s27, s26, 26624
  buffer_load_dwordx4 v[184:187], v20, s[8:11], s27 offen
  s_add_u32 s27, s26, 27648
  buffer_load_dwordx4 v[188:191], v20, s[8:11], s27 offen
  s_add_u32 s27, s26, 65536
  buffer_load_dwordx4 v[192:195], v20, s[8:11], s27 offen
  s_add_u32 s27, s26, 66560
  buffer_load_dwordx4 v[196:199], v20, s[8:11], s27 offen
  s_add_u32 s27, s26, 81920
  buffer_load_dwordx4 v[200:203], v20, s[8:11], s27 offen
  s_add_u32 s27, s26, 82944
  buffer_load_dwordx4 v[204:207], v20, s[8:11], s27 offen
  s_add_u32 s27, s26, 67584
  buffer_load_dwordx4 v[208:211], v20, s[8:11], s27 offen
  s_add_u32 s27, s26, 68608
  buffer_load_dwordx4 v[212:215], v20, s[8:11], s27 offen
  s_add_u32 s27, s26, 83968
  buffer_load_dwordx4 v[216:219], v20, s[8:11], s27 offen
  s_add_u32 s27, s26, 84992
  buffer_load_dwordx4 v[220:223], v20, s[8:11], s27 offen
  s_add_u32 s27, s26, 73728
  buffer_load_dwordx4 v[224:227], v20, s[8:11], s27 offen
  s_add_u32 s27, s26, 74752
  buffer_load_dwordx4 v[228:231], v20, s[8:11], s27 offen
  s_add_u32 s27, s26, 90112
  buffer_load_dwordx4 v[232:235], v20, s[8:11], s27 offen
  s_add_u32 s27, s26, 91136
  buffer_load_dwordx4 v[236:239], v20, s[8:11], s27 offen
  s_add_u32 s27, s26, 75776
  buffer_load_dwordx4 v[240:243], v20, s[8:11], s27 offen
  s_add_u32 s27, s26, 76800
  buffer_load_dwordx4 v[244:247], v20, s[8:11], s27 offen
  s_add_u32 s27, s26, 92160
  buffer_load_dwordx4 v[248:251], v20, s[8:11], s27 offen
  s_add_u32 s27, s26, 93184
  buffer_load_dwordx4 v[252:255], v20, s[8:11], s27 offen
  v_lshrrev_b32 v20, 8, v0
  v_and_b32 v22, 0xf0, v0
  v_lshlrev_b32 v23, 6, v20
  v_xor_b32 v22, v22, v23
  v_lshl_add_u32 v22, v20, 13, v22
  v_xor_b32 v23, 32, v22
  s_lshr_b32 s26, s17, 1
  s_lshl_b32 s26, s26, 20
  s_and_b32 s27, s17, 1
  s_lshl_b32 s27, s27, 18
  s_add_u32 s26, s26, s27
  s_lshl_b32 s27, s16, 8
  s_add_u32 s26, s26, s27
  s_lshl_b32 s28, s17, 13
  s_add_u32 s27, s26, 0
  s_add_u32 m0, s28, 65536
  s_nop 0
  buffer_load_dwordx4 v22, s[32:35], s27 offen lds
  s_add_u32 m0, s28, 66560
  s_add_u32 s27, s27, 32768
  buffer_load_dwordx4 v22, s[32:35], s27 offen lds
  s_add_u32 m0, s28, 67584
  s_add_u32 s27, s27, 32768
  buffer_load_dwordx4 v23, s[32:35], s27 offen lds
  s_add_u32 m0, s28, 68608
  s_add_u32 s27, s27, 32768
  buffer_load_dwordx4 v23, s[32:35], s27 offen lds
  s_add_u32 m0, s28, 69632
  s_add_u32 s27, s27, 32768
  buffer_load_dwordx4 v22, s[32:35], s27 offen lds
  s_add_u32 m0, s28, 70656
  s_add_u32 s27, s27, 32768
  buffer_load_dwordx4 v22, s[32:35], s27 offen lds
  s_add_u32 m0, s28, 71680
  s_add_u32 s27, s27, 32768
  buffer_load_dwordx4 v23, s[32:35], s27 offen lds
  s_add_u32 m0, s28, 72704
  s_add_u32 s27, s27, 32768
  buffer_load_dwordx4 v23, s[32:35], s27 offen lds
  s_add_u32 s27, s26, 524288
  s_add_u32 m0, s28, 98304
  s_nop 0
  buffer_load_dwordx4 v22, s[32:35], s27 offen lds
  s_add_u32 m0, s28, 99328
  s_add_u32 s27, s27, 32768
  buffer_load_dwordx4 v22, s[32:35], s27 offen lds
  s_add_u32 m0, s28, 100352
  s_add_u32 s27, s27, 32768
  buffer_load_dwordx4 v23, s[32:35], s27 offen lds
  s_add_u32 m0, s28, 101376
  s_add_u32 s27, s27, 32768
  buffer_load_dwordx4 v23, s[32:35], s27 offen lds
  s_add_u32 m0, s28, 102400
  s_add_u32 s27, s27, 32768
  buffer_load_dwordx4 v22, s[32:35], s27 offen lds
  s_add_u32 m0, s28, 103424
  s_add_u32 s27, s27, 32768
  buffer_load_dwordx4 v22, s[32:35], s27 offen lds
  s_add_u32 m0, s28, 104448
  s_add_u32 s27, s27, 32768
  buffer_load_dwordx4 v23, s[32:35], s27 offen lds
  s_add_u32 m0, s28, 105472
  s_add_u32 s27, s27, 32768
  buffer_load_dwordx4 v23, s[32:35], s27 offen lds
  s_waitcnt vmcnt(48)
  v_lshl_or_b32 v28, v29, 16, v28
  v_lshl_or_b32 v29, v31, 16, v30
  v_min_u32 v28, -2, v28
  v_min_u32 v29, -2, v29
  buffer_store_dwordx2 v[28:29], v5, s[4:7], s62 offen sc1
  s_add_u32 s27, s26, 2097152
  s_add_u32 m0, s28, 131072
  s_nop 0
  buffer_load_dwordx4 v22, s[32:35], s27 offen lds
  s_add_u32 m0, s28, 132096
  s_add_u32 s27, s27, 32768
  buffer_load_dwordx4 v22, s[32:35], s27 offen lds
  s_add_u32 m0, s28, 133120
  s_add_u32 s27, s27, 32768
  buffer_load_dwordx4 v23, s[32:35], s27 offen lds
  s_add_u32 m0, s28, 134144
  s_add_u32 s27, s27, 32768
  buffer_load_dwordx4 v23, s[32:35], s27 offen lds
  s_add_u32 m0, s28, 135168
  s_add_u32 s27, s27, 32768
  buffer_load_dwordx4 v22, s[32:35], s27 offen lds
  s_add_u32 m0, s28, 136192
  s_add_u32 s27, s27, 32768
  buffer_load_dwordx4 v22, s[32:35], s27 offen lds
  s_add_u32 m0, s28, 137216
  s_add_u32 s27, s27, 32768
  buffer_load_dwordx4 v23, s[32:35], s27 offen lds
  s_add_u32 m0, s28, 138240
  s_add_u32 s27, s27, 32768
  buffer_load_dwordx4 v23, s[32:35], s27 offen lds
  v_bfe_u32 v20, v7, 2, 1
  v_lshrrev_b32 v21, 3, v7
  v_and_b32 v104, 1, v17
  v_lshl_add_u32 v21, v21, 1, v104
  v_lshl_add_u32 v104, v20, 3, v21
  v_lshrrev_b32 v105, 1, v17
  v_lshl_add_u32 v104, v105, 5, v104
  v_lshl_add_u32 v20, v21, 1, v20
  s_lshl_b32 s29, s17, 1
  v_xor_b32 v20, s29, v20
  v_lshlrev_b32 v20, 5, v20
  v_lshl_add_u32 v20, v104, 8, v20
  v_and_b32 v21, 3, v7
  v_lshl_add_u32 v20, v21, 3, v20
  s_lshr_b32 s29, s17, 1
  s_lshl_b32 s29, s29, 14
  s_and_b32 s30, s17, 1
  s_lshl_b32 s30, s30, 10
  s_add_u32 s29, s29, s30
  s_add_u32 s29, s29, 65536
  v_add_u32 v20, s29, v20
  v_xor_b32 v104, 0, v20
  v_xor_b32 v105, 32, v20
  v_xor_b32 v106, 1024, v20
  v_xor_b32 v107, 1056, v20
  v_xor_b32 v108, 16384, v20
  v_xor_b32 v109, 16416, v20
  v_xor_b32 v110, 17408, v20
  v_xor_b32 v111, 17440, v20
  s_waitcnt vmcnt(49)
  v_perm_b32 v120, v132, v128, s44
  v_perm_b32 v121, v140, v136, s44
  v_perm_b32 v122, v148, v144, s44
  v_perm_b32 v123, v156, v152, s44
  v_accvgpr_write_b32 a248, v120
  v_accvgpr_write_b32 a249, v121
  v_accvgpr_write_b32 a250, v122
  v_accvgpr_write_b32 a251, v123
  v_perm_b32 v124, v132, v128, s45
  v_perm_b32 v125, v140, v136, s45
  v_perm_b32 v126, v148, v144, s45
  v_perm_b32 v127, v156, v152, s45
  v_accvgpr_write_b32 a232, v124
  v_accvgpr_write_b32 a233, v125
  v_accvgpr_write_b32 a234, v126
  v_accvgpr_write_b32 a235, v127
  v_perm_b32 v120, v133, v129, s44
  v_perm_b32 v121, v141, v137, s44
  v_perm_b32 v122, v149, v145, s44
  v_perm_b32 v123, v157, v153, s44
  v_accvgpr_write_b32 a216, v120
  v_accvgpr_write_b32 a217, v121
  v_accvgpr_write_b32 a218, v122
  v_accvgpr_write_b32 a219, v123
  v_perm_b32 v124, v133, v129, s45
  v_perm_b32 v125, v141, v137, s45
  v_perm_b32 v126, v149, v145, s45
  v_perm_b32 v127, v157, v153, s45
  v_accvgpr_write_b32 a200, v124
  v_accvgpr_write_b32 a201, v125
  v_accvgpr_write_b32 a202, v126
  v_accvgpr_write_b32 a203, v127
  v_perm_b32 v120, v134, v130, s44
  v_perm_b32 v121, v142, v138, s44
  v_perm_b32 v122, v150, v146, s44
  v_perm_b32 v123, v158, v154, s44
  v_accvgpr_write_b32 a184, v120
  v_accvgpr_write_b32 a185, v121
  v_accvgpr_write_b32 a186, v122
  v_accvgpr_write_b32 a187, v123
  v_perm_b32 v24, v134, v130, s45
  v_perm_b32 v25, v142, v138, s45
  v_perm_b32 v26, v150, v146, s45
  v_perm_b32 v27, v158, v154, s45
  v_perm_b32 v40, v135, v131, s44
  v_perm_b32 v41, v143, v139, s44
  v_perm_b32 v42, v151, v147, s44
  v_perm_b32 v43, v159, v155, s44
  v_perm_b32 v56, v135, v131, s45
  v_perm_b32 v57, v143, v139, s45
  v_perm_b32 v58, v151, v147, s45
  v_perm_b32 v59, v159, v155, s45
  s_waitcnt vmcnt(41)
  v_perm_b32 v120, v164, v160, s44
  v_perm_b32 v121, v172, v168, s44
  v_perm_b32 v122, v180, v176, s44
  v_perm_b32 v123, v188, v184, s44
  v_accvgpr_write_b32 a252, v120
  v_accvgpr_write_b32 a253, v121
  v_accvgpr_write_b32 a254, v122
  v_accvgpr_write_b32 a255, v123
  v_perm_b32 v124, v164, v160, s45
  v_perm_b32 v125, v172, v168, s45
  v_perm_b32 v126, v180, v176, s45
  v_perm_b32 v127, v188, v184, s45
  v_accvgpr_write_b32 a236, v124
  v_accvgpr_write_b32 a237, v125
  v_accvgpr_write_b32 a238, v126
  v_accvgpr_write_b32 a239, v127
  v_perm_b32 v120, v165, v161, s44
  v_perm_b32 v121, v173, v169, s44
  v_perm_b32 v122, v181, v177, s44
  v_perm_b32 v123, v189, v185, s44
  v_accvgpr_write_b32 a220, v120
  v_accvgpr_write_b32 a221, v121
  v_accvgpr_write_b32 a222, v122
  v_accvgpr_write_b32 a223, v123
  v_perm_b32 v124, v165, v161, s45
  v_perm_b32 v125, v173, v169, s45
  v_perm_b32 v126, v181, v177, s45
  v_perm_b32 v127, v189, v185, s45
  v_accvgpr_write_b32 a204, v124
  v_accvgpr_write_b32 a205, v125
  v_accvgpr_write_b32 a206, v126
  v_accvgpr_write_b32 a207, v127
  v_perm_b32 v120, v166, v162, s44
  v_perm_b32 v121, v174, v170, s44
  v_perm_b32 v122, v182, v178, s44
  v_perm_b32 v123, v190, v186, s44
  v_accvgpr_write_b32 a188, v120
  v_accvgpr_write_b32 a189, v121
  v_accvgpr_write_b32 a190, v122
  v_accvgpr_write_b32 a191, v123
  v_perm_b32 v28, v166, v162, s45
  v_perm_b32 v29, v174, v170, s45
  v_perm_b32 v30, v182, v178, s45
  v_perm_b32 v31, v190, v186, s45
  v_perm_b32 v44, v167, v163, s44
  v_perm_b32 v45, v175, v171, s44
  v_perm_b32 v46, v183, v179, s44
  v_perm_b32 v47, v191, v187, s44
  v_perm_b32 v60, v167, v163, s45
  v_perm_b32 v61, v175, v171, s45
  v_perm_b32 v62, v183, v179, s45
  v_perm_b32 v63, v191, v187, s45
  s_waitcnt vmcnt(33)
  v_perm_b32 v120, v196, v192, s44
  v_perm_b32 v121, v204, v200, s44
  v_perm_b32 v122, v212, v208, s44
  v_perm_b32 v123, v220, v216, s44
  v_accvgpr_write_b32 a240, v120
  v_accvgpr_write_b32 a241, v121
  v_accvgpr_write_b32 a242, v122
  v_accvgpr_write_b32 a243, v123
  v_perm_b32 v124, v196, v192, s45
  v_perm_b32 v125, v204, v200, s45
  v_perm_b32 v126, v212, v208, s45
  v_perm_b32 v127, v220, v216, s45
  v_accvgpr_write_b32 a224, v124
  v_accvgpr_write_b32 a225, v125
  v_accvgpr_write_b32 a226, v126
  v_accvgpr_write_b32 a227, v127
  v_perm_b32 v120, v197, v193, s44
  v_perm_b32 v121, v205, v201, s44
  v_perm_b32 v122, v213, v209, s44
  v_perm_b32 v123, v221, v217, s44
  v_accvgpr_write_b32 a208, v120
  v_accvgpr_write_b32 a209, v121
  v_accvgpr_write_b32 a210, v122
  v_accvgpr_write_b32 a211, v123
  v_perm_b32 v124, v197, v193, s45
  v_perm_b32 v125, v205, v201, s45
  v_perm_b32 v126, v213, v209, s45
  v_perm_b32 v127, v221, v217, s45
  v_accvgpr_write_b32 a192, v124
  v_accvgpr_write_b32 a193, v125
  v_accvgpr_write_b32 a194, v126
  v_accvgpr_write_b32 a195, v127
  v_perm_b32 v120, v198, v194, s44
  v_perm_b32 v121, v206, v202, s44
  v_perm_b32 v122, v214, v210, s44
  v_perm_b32 v123, v222, v218, s44
  v_accvgpr_write_b32 a176, v120
  v_accvgpr_write_b32 a177, v121
  v_accvgpr_write_b32 a178, v122
  v_accvgpr_write_b32 a179, v123
  v_perm_b32 v32, v198, v194, s45
  v_perm_b32 v33, v206, v202, s45
  v_perm_b32 v34, v214, v210, s45
  v_perm_b32 v35, v222, v218, s45
  v_perm_b32 v48, v199, v195, s44
  v_perm_b32 v49, v207, v203, s44
  v_perm_b32 v50, v215, v211, s44
  v_perm_b32 v51, v223, v219, s44
  v_perm_b32 v64, v199, v195, s45
  v_perm_b32 v65, v207, v203, s45
  v_perm_b32 v66, v215, v211, s45
  v_perm_b32 v67, v223, v219, s45
  s_waitcnt vmcnt(25)
  v_perm_b32 v120, v228, v224, s44
  v_perm_b32 v121, v236, v232, s44
  v_perm_b32 v122, v244, v240, s44
  v_perm_b32 v123, v252, v248, s44
  v_accvgpr_write_b32 a244, v120
  v_accvgpr_write_b32 a245, v121
  v_accvgpr_write_b32 a246, v122
  v_accvgpr_write_b32 a247, v123
  v_perm_b32 v124, v228, v224, s45
  v_perm_b32 v125, v236, v232, s45
  v_perm_b32 v126, v244, v240, s45
  v_perm_b32 v127, v252, v248, s45
  v_accvgpr_write_b32 a228, v124
  v_accvgpr_write_b32 a229, v125
  v_accvgpr_write_b32 a230, v126
  v_accvgpr_write_b32 a231, v127
  v_perm_b32 v120, v229, v225, s44
  v_perm_b32 v121, v237, v233, s44
  v_perm_b32 v122, v245, v241, s44
  v_perm_b32 v123, v253, v249, s44
  v_accvgpr_write_b32 a212, v120
  v_accvgpr_write_b32 a213, v121
  v_accvgpr_write_b32 a214, v122
  v_accvgpr_write_b32 a215, v123
  v_perm_b32 v124, v229, v225, s45
  v_perm_b32 v125, v237, v233, s45
  v_perm_b32 v126, v245, v241, s45
  v_perm_b32 v127, v253, v249, s45
  v_accvgpr_write_b32 a196, v124
  v_accvgpr_write_b32 a197, v125
  v_accvgpr_write_b32 a198, v126
  v_accvgpr_write_b32 a199, v127
  v_perm_b32 v120, v230, v226, s44
  v_perm_b32 v121, v238, v234, s44
  v_perm_b32 v122, v246, v242, s44
  v_perm_b32 v123, v254, v250, s44
  v_accvgpr_write_b32 a180, v120
  v_accvgpr_write_b32 a181, v121
  v_accvgpr_write_b32 a182, v122
  v_accvgpr_write_b32 a183, v123
  v_perm_b32 v36, v230, v226, s45
  v_perm_b32 v37, v238, v234, s45
  v_perm_b32 v38, v246, v242, s45
  v_perm_b32 v39, v254, v250, s45
  v_perm_b32 v52, v231, v227, s44
  v_perm_b32 v53, v239, v235, s44
  v_perm_b32 v54, v247, v243, s44
  v_perm_b32 v55, v255, v251, s44
  v_perm_b32 v68, v231, v227, s45
  v_perm_b32 v69, v239, v235, s45
  v_perm_b32 v70, v247, v243, s45
  v_perm_b32 v71, v255, v251, s45
  v_mov_b64 v[128:129], v[24:25]
  v_mov_b64 v[130:131], v[26:27]
  v_mov_b64 v[132:133], v[28:29]
  v_mov_b64 v[134:135], v[30:31]
  v_mov_b64 v[136:137], v[32:33]
  v_mov_b64 v[138:139], v[34:35]
  v_mov_b64 v[140:141], v[36:37]
  v_mov_b64 v[142:143], v[38:39]
  v_mov_b64 v[144:145], v[40:41]
  v_mov_b64 v[146:147], v[42:43]
  v_mov_b64 v[148:149], v[44:45]
  v_mov_b64 v[150:151], v[46:47]
  v_mov_b64 v[152:153], v[48:49]
  v_mov_b64 v[154:155], v[50:51]
  v_mov_b64 v[156:157], v[52:53]
  v_mov_b64 v[158:159], v[54:55]
  v_mov_b64 v[184:185], v[56:57]
  v_mov_b64 v[186:187], v[58:59]
  v_mov_b64 v[188:189], v[60:61]
  v_mov_b64 v[190:191], v[62:63]
  v_mov_b64 v[192:193], v[64:65]
  v_mov_b64 v[194:195], v[66:67]
  v_mov_b64 v[196:197], v[68:69]
  v_mov_b64 v[198:199], v[70:71]
  s_waitcnt vmcnt(17)
  s_barrier
  s_add_u32 s27, s26, 2621440
  s_add_u32 m0, s28, 0
  s_nop 0
  buffer_load_dwordx4 v22, s[32:35], s27 offen lds
  s_add_u32 m0, s28, 1024
  s_add_u32 s27, s27, 32768
  buffer_load_dwordx4 v22, s[32:35], s27 offen lds
  s_add_u32 m0, s28, 2048
  s_add_u32 s27, s27, 32768
  buffer_load_dwordx4 v23, s[32:35], s27 offen lds
  s_add_u32 m0, s28, 3072
  s_add_u32 s27, s27, 32768
  buffer_load_dwordx4 v23, s[32:35], s27 offen lds
  s_add_u32 m0, s28, 4096
  s_add_u32 s27, s27, 32768
  buffer_load_dwordx4 v22, s[32:35], s27 offen lds
  s_add_u32 m0, s28, 5120
  s_add_u32 s27, s27, 32768
  buffer_load_dwordx4 v22, s[32:35], s27 offen lds
  s_add_u32 m0, s28, 6144
  s_add_u32 s27, s27, 32768
  buffer_load_dwordx4 v23, s[32:35], s27 offen lds
  s_add_u32 m0, s28, 7168
  s_add_u32 s27, s27, 32768
  buffer_load_dwordx4 v23, s[32:35], s27 offen lds
  s_cmp_lg_u32 s91, 0
  s_cbranch_scc1 g_o0_5
  s_cmp_lg_u32 s17, 0
  s_cbranch_scc1 g_ar_6
  s_lshl_b32 s36, s89, 3
  s_lshl_b64 s[36:37], 1, s36
  v_lshlrev_b32 v124, 3, 0
  v_mov_b32 v120, s36
  v_mov_b32 v121, s37
  s_mov_b64 exec, 1
  global_atomic_add_x2 v[122:123], v124, v[120:121], s[12:13] sc0
  s_mov_b64 exec, -1
g_ar_6:
g_o0_5:
  ds_read_b64_tr_b16 v[40:41], v104 offset:0
  ds_read_b64_tr_b16 v[42:43], v104 offset:4096
  ds_read_b64_tr_b16 v[48:49], v105 offset:0
  ds_read_b64_tr_b16 v[50:51], v105 offset:4096
  ds_read_b64_tr_b16 a[72:73], v106 offset:0
  ds_read_b64_tr_b16 a[74:75], v106 offset:4096
  ds_read_b64_tr_b16 a[24:25], v107 offset:0
  ds_read_b64_tr_b16 a[26:27], v107 offset:4096
  ds_read_b64_tr_b16 a[64:65], v108 offset:0
  ds_read_b64_tr_b16 a[66:67], v108 offset:4096
  ds_read_b64_tr_b16 a[16:17], v109 offset:0
  ds_read_b64_tr_b16 a[18:19], v109 offset:4096
  ds_read_b64_tr_b16 a[56:57], v110 offset:0
  ds_read_b64_tr_b16 a[58:59], v110 offset:4096
  ds_read_b64_tr_b16 a[8:9], v111 offset:0
  ds_read_b64_tr_b16 a[10:11], v111 offset:4096
  s_waitcnt lgkmcnt(0)
  s_waitcnt vmcnt(17)
  s_barrier
  s_add_u32 s27, s26, 0
  s_add_u32 m0, s28, 32768
  s_nop 0
  buffer_load_dwordx4 v22, s[52:55], s27 offen lds
  s_add_u32 m0, s28, 33792
  s_add_u32 s27, s27, 32768
  buffer_load_dwordx4 v22, s[52:55], s27 offen lds
  s_add_u32 m0, s28, 34816
  s_add_u32 s27, s27, 32768
  buffer_load_dwordx4 v23, s[52:55], s27 offen lds
  s_add_u32 m0, s28, 35840
  s_add_u32 s27, s27, 32768
  buffer_load_dwordx4 v23, s[52:55], s27 offen lds
  s_add_u32 m0, s28, 36864
  s_add_u32 s27, s27, 32768
  buffer_load_dwordx4 v22, s[52:55], s27 offen lds
  s_add_u32 m0, s28, 37888
  s_add_u32 s27, s27, 32768
  buffer_load_dwordx4 v22, s[52:55], s27 offen lds
  s_add_u32 m0, s28, 38912
  s_add_u32 s27, s27, 32768
  buffer_load_dwordx4 v23, s[52:55], s27 offen lds
  s_add_u32 m0, s28, 39936
  s_add_u32 s27, s27, 32768
  buffer_load_dwordx4 v23, s[52:55], s27 offen lds
  ds_read_b64_tr_b16 v[44:45], v104 offset:32768
  ds_read_b64_tr_b16 v[46:47], v104 offset:36864
  ds_read_b64_tr_b16 v[52:53], v105 offset:32768
  ds_read_b64_tr_b16 v[54:55], v105 offset:36864
  ds_read_b64_tr_b16 a[76:77], v106 offset:32768
  ds_read_b64_tr_b16 a[78:79], v106 offset:36864
  ds_read_b64_tr_b16 a[28:29], v107 offset:32768
  ds_read_b64_tr_b16 a[30:31], v107 offset:36864
  ds_read_b64_tr_b16 a[68:69], v108 offset:32768
  ds_read_b64_tr_b16 a[70:71], v108 offset:36864
  ds_read_b64_tr_b16 a[20:21], v109 offset:32768
  ds_read_b64_tr_b16 a[22:23], v109 offset:36864
  ds_read_b64_tr_b16 a[60:61], v110 offset:32768
  ds_read_b64_tr_b16 a[62:63], v110 offset:36864
  ds_read_b64_tr_b16 a[12:13], v111 offset:32768
  ds_read_b64_tr_b16 a[14:15], v111 offset:36864
  s_waitcnt lgkmcnt(0)
  v_add_u32 v104, 65536, v104
  v_add_u32 v105, 65536, v105
  v_add_u32 v106, 65536, v106
  v_add_u32 v107, 65536, v107
  v_add_u32 v108, 65536, v108
  v_add_u32 v109, 65536, v109
  v_add_u32 v110, 65536, v110
  v_add_u32 v111, 65536, v111
  s_waitcnt vmcnt(16)
  s_barrier
  s_add_u32 s27, s26, 524288
  s_add_u32 m0, s28, 65536
  s_nop 0
  buffer_load_dwordx4 v22, s[52:55], s27 offen lds
  s_add_u32 m0, s28, 66560
  s_add_u32 s27, s27, 32768
  buffer_load_dwordx4 v22, s[52:55], s27 offen lds
  s_add_u32 m0, s28, 67584
  s_add_u32 s27, s27, 32768
  buffer_load_dwordx4 v23, s[52:55], s27 offen lds
  s_add_u32 m0, s28, 68608
  s_add_u32 s27, s27, 32768
  buffer_load_dwordx4 v23, s[52:55], s27 offen lds
  s_add_u32 m0, s28, 69632
  s_add_u32 s27, s27, 32768
  buffer_load_dwordx4 v22, s[52:55], s27 offen lds
  s_add_u32 m0, s28, 70656
  s_add_u32 s27, s27, 32768
  buffer_load_dwordx4 v22, s[52:55], s27 offen lds
  s_add_u32 m0, s28, 71680
  s_add_u32 s27, s27, 32768
  buffer_load_dwordx4 v23, s[52:55], s27 offen lds
  s_add_u32 m0, s28, 72704
  s_add_u32 s27, s27, 32768
  buffer_load_dwordx4 v23, s[52:55], s27 offen lds
  ds_read_b64_tr_b16 v[72:73], v104 offset:0
  ds_read_b64_tr_b16 v[74:75], v104 offset:4096
  ds_read_b64_tr_b16 v[80:81], v105 offset:0
  ds_read_b64_tr_b16 v[82:83], v105 offset:4096
  ds_read_b64_tr_b16 a[48:49], v106 offset:0
  ds_read_b64_tr_b16 a[50:51], v106 offset:4096
  ds_read_b64_tr_b16 a[0:1], v107 offset:0
  ds_read_b64_tr_b16 a[2:3], v107 offset:4096
  ds_read_b64_tr_b16 a[40:41], v108 offset:0
  ds_read_b64_tr_b16 a[42:43], v108 offset:4096
  ds_read_b64_tr_b16 v[248:249], v109 offset:0
  ds_read_b64_tr_b16 v[250:251], v109 offset:4096
  ds_read_b64_tr_b16 a[32:33], v110 offset:0
  ds_read_b64_tr_b16 a[34:35], v110 offset:4096
  ds_read_b64_tr_b16 v[240:241], v111 offset:0
  ds_read_b64_tr_b16 v[242:243], v111 offset:4096
  s_waitcnt lgkmcnt(0)
  v_add_u32 v104, -131072, v104
  v_add_u32 v105, -131072, v105
  v_add_u32 v106, -131072, v106
  v_add_u32 v107, -131072, v107
  v_add_u32 v108, -131072, v108
  v_add_u32 v109, -131072, v109
  v_add_u32 v110, -131072, v110
  v_add_u32 v111, -131072, v111
  s_waitcnt vmcnt(16)
  s_barrier
  s_add_u32 s27, s26, 2097152
  s_add_u32 m0, s28, 98304
  s_nop 0
  buffer_load_dwordx4 v22, s[52:55], s27 offen lds
  s_add_u32 m0, s28, 99328
  s_add_u32 s27, s27, 32768
  buffer_load_dwordx4 v22, s[52:55], s27 offen lds
  s_add_u32 m0, s28, 100352
  s_add_u32 s27, s27, 32768
  buffer_load_dwordx4 v23, s[52:55], s27 offen lds
  s_add_u32 m0, s28, 101376
  s_add_u32 s27, s27, 32768
  buffer_load_dwordx4 v23, s[52:55], s27 offen lds
  s_add_u32 m0, s28, 102400
  s_add_u32 s27, s27, 32768
  buffer_load_dwordx4 v22, s[52:55], s27 offen lds
  s_add_u32 m0, s28, 103424
  s_add_u32 s27, s27, 32768
  buffer_load_dwordx4 v22, s[52:55], s27 offen lds
  s_add_u32 m0, s28, 104448
  s_add_u32 s27, s27, 32768
  buffer_load_dwordx4 v23, s[52:55], s27 offen lds
  s_add_u32 m0, s28, 105472
  s_add_u32 s27, s27, 32768
  buffer_load_dwordx4 v23, s[52:55], s27 offen lds
  ds_read_b64_tr_b16 v[76:77], v104 offset:0
  ds_read_b64_tr_b16 v[78:79], v104 offset:4096
  ds_read_b64_tr_b16 v[84:85], v105 offset:0
  ds_read_b64_tr_b16 v[86:87], v105 offset:4096
  ds_read_b64_tr_b16 a[52:53], v106 offset:0
  ds_read_b64_tr_b16 a[54:55], v106 offset:4096
  ds_read_b64_tr_b16 a[4:5], v107 offset:0
  ds_read_b64_tr_b16 a[6:7], v107 offset:4096
  ds_read_b64_tr_b16 a[44:45], v108 offset:0
  ds_read_b64_tr_b16 a[46:47], v108 offset:4096
  ds_read_b64_tr_b16 v[252:253], v109 offset:0
  ds_read_b64_tr_b16 v[254:255], v109 offset:4096
  ds_read_b64_tr_b16 a[36:37], v110 offset:0
  ds_read_b64_tr_b16 a[38:39], v110 offset:4096
  ds_read_b64_tr_b16 v[244:245], v111 offset:0
  ds_read_b64_tr_b16 v[246:247], v111 offset:4096
  s_waitcnt lgkmcnt(0)
  s_waitcnt vmcnt(16)
  s_barrier
  s_add_u32 s27, s26, 2621440
  s_add_u32 m0, s28, 131072
  s_nop 0
  buffer_load_dwordx4 v22, s[52:55], s27 offen lds
  s_add_u32 m0, s28, 132096
  s_add_u32 s27, s27, 32768
  buffer_load_dwordx4 v22, s[52:55], s27 offen lds
  s_add_u32 m0, s28, 133120
  s_add_u32 s27, s27, 32768
  buffer_load_dwordx4 v23, s[52:55], s27 offen lds
  s_add_u32 m0, s28, 134144
  s_add_u32 s27, s27, 32768
  buffer_load_dwordx4 v23, s[52:55], s27 offen lds
  s_add_u32 m0, s28, 135168
  s_add_u32 s27, s27, 32768
  buffer_load_dwordx4 v22, s[52:55], s27 offen lds
  s_add_u32 m0, s28, 136192
  s_add_u32 s27, s27, 32768
  buffer_load_dwordx4 v22, s[52:55], s27 offen lds
  s_add_u32 m0, s28, 137216
  s_add_u32 s27, s27, 32768
  buffer_load_dwordx4 v23, s[52:55], s27 offen lds
  s_add_u32 m0, s28, 138240
  s_add_u32 s27, s27, 32768
  buffer_load_dwordx4 v23, s[52:55], s27 offen lds
  s_cmp_lg_u32 s91, 0
  s_cbranch_scc1 g_o0_7
  s_cmp_lg_u32 s17, 0
  s_cbranch_scc1 g_af_8
  v_readfirstlane_b32 s36, v122
  v_readfirstlane_b32 s37, v123
  s_add_u32 s38, s36, s37
  s_mul_i32 s38, s38, 0x01010101
  s_lshr_b32 s38, s38, 24
  s_cmp_lg_u32 s38, 31
  s_cbranch_scc1 g_af_8
  s_lshl_b32 s38, s89, 3
  s_lshr_b64 s[36:37], s[36:37], s38
  s_and_b32 s36, s36, 0xff
  s_cmp_eq_u32 s36, 31
  s_cselect_b32 s36, 1, 2
  v_mov_b32 v120, s36
  v_lshrrev_b32 v124, 1, v124
  s_mov_b64 exec, 1
  global_store_dword v124, v120, s[12:13] offset:128 sc1
  s_mov_b64 exec, -1
g_af_8:
g_o0_7:
  ds_read_b64_tr_b16 v[24:25], v104 offset:32768
  ds_read_b64_tr_b16 v[26:27], v104 offset:36864
  ds_read_b64_tr_b16 v[32:33], v105 offset:32768
  ds_read_b64_tr_b16 v[34:35], v105 offset:36864
  ds_read_b64_tr_b16 a[168:169], v106 offset:32768
  ds_read_b64_tr_b16 a[170:171], v106 offset:36864
  ds_read_b64_tr_b16 a[120:121], v107 offset:32768
  ds_read_b64_tr_b16 a[122:123], v107 offset:36864
  ds_read_b64_tr_b16 a[160:161], v108 offset:32768
  ds_read_b64_tr_b16 a[162:163], v108 offset:36864
  ds_read_b64_tr_b16 a[112:113], v109 offset:32768
  ds_read_b64_tr_b16 a[114:115], v109 offset:36864
  ds_read_b64_tr_b16 a[152:153], v110 offset:32768
  ds_read_b64_tr_b16 a[154:155], v110 offset:36864
  ds_read_b64_tr_b16 a[104:105], v111 offset:32768
  ds_read_b64_tr_b16 a[106:107], v111 offset:36864
  s_waitcnt lgkmcnt(0)
  v_add_u32 v104, 65536, v104
  v_add_u32 v105, 65536, v105
  v_add_u32 v106, 65536, v106
  v_add_u32 v107, 65536, v107
  v_add_u32 v108, 65536, v108
  v_add_u32 v109, 65536, v109
  v_add_u32 v110, 65536, v110
  v_add_u32 v111, 65536, v111
  s_waitcnt vmcnt(16)
  s_barrier
  s_add_u32 s27, s26, 0
  s_add_u32 m0, s28, 0
  s_nop 0
  buffer_load_dwordx4 v22, s[48:51], s27 offen lds
  s_add_u32 m0, s28, 1024
  s_add_u32 s27, s27, 32768
  buffer_load_dwordx4 v22, s[48:51], s27 offen lds
  s_add_u32 m0, s28, 2048
  s_add_u32 s27, s27, 32768
  buffer_load_dwordx4 v23, s[48:51], s27 offen lds
  s_add_u32 m0, s28, 3072
  s_add_u32 s27, s27, 32768
  buffer_load_dwordx4 v23, s[48:51], s27 offen lds
  s_add_u32 m0, s28, 4096
  s_add_u32 s27, s27, 32768
  buffer_load_dwordx4 v22, s[48:51], s27 offen lds
  s_add_u32 m0, s28, 5120
  s_add_u32 s27, s27, 32768
  buffer_load_dwordx4 v22, s[48:51], s27 offen lds
  s_add_u32 m0, s28, 6144
  s_add_u32 s27, s27, 32768
  buffer_load_dwordx4 v23, s[48:51], s27 offen lds
  s_add_u32 m0, s28, 7168
  s_add_u32 s27, s27, 32768
  buffer_load_dwordx4 v23, s[48:51], s27 offen lds
  ds_read_b64_tr_b16 v[28:29], v104 offset:0
  ds_read_b64_tr_b16 v[30:31], v104 offset:4096
  ds_read_b64_tr_b16 v[36:37], v105 offset:0
  ds_read_b64_tr_b16 v[38:39], v105 offset:4096
  ds_read_b64_tr_b16 a[172:173], v106 offset:0
  ds_read_b64_tr_b16 a[174:175], v106 offset:4096
  ds_read_b64_tr_b16 a[124:125], v107 offset:0
  ds_read_b64_tr_b16 a[126:127], v107 offset:4096
  ds_read_b64_tr_b16 a[164:165], v108 offset:0
  ds_read_b64_tr_b16 a[166:167], v108 offset:4096
  ds_read_b64_tr_b16 a[116:117], v109 offset:0
  ds_read_b64_tr_b16 a[118:119], v109 offset:4096
  ds_read_b64_tr_b16 a[156:157], v110 offset:0
  ds_read_b64_tr_b16 a[158:159], v110 offset:4096
  ds_read_b64_tr_b16 a[108:109], v111 offset:0
  ds_read_b64_tr_b16 a[110:111], v111 offset:4096
  s_waitcnt lgkmcnt(0)
  s_waitcnt vmcnt(16)
  s_barrier
  s_add_u32 s27, s26, 524288
  s_add_u32 m0, s28, 32768
  s_nop 0
  buffer_load_dwordx4 v22, s[48:51], s27 offen lds
  s_add_u32 m0, s28, 33792
  s_add_u32 s27, s27, 32768
  buffer_load_dwordx4 v22, s[48:51], s27 offen lds
  s_add_u32 m0, s28, 34816
  s_add_u32 s27, s27, 32768
  buffer_load_dwordx4 v23, s[48:51], s27 offen lds
  s_add_u32 m0, s28, 35840
  s_add_u32 s27, s27, 32768
  buffer_load_dwordx4 v23, s[48:51], s27 offen lds
  s_add_u32 m0, s28, 36864
  s_add_u32 s27, s27, 32768
  buffer_load_dwordx4 v22, s[48:51], s27 offen lds
  s_add_u32 m0, s28, 37888
  s_add_u32 s27, s27, 32768
  buffer_load_dwordx4 v22, s[48:51], s27 offen lds
  s_add_u32 m0, s28, 38912
  s_add_u32 s27, s27, 32768
  buffer_load_dwordx4 v23, s[48:51], s27 offen lds
  s_add_u32 m0, s28, 39936
  s_add_u32 s27, s27, 32768
  buffer_load_dwordx4 v23, s[48:51], s27 offen lds
  v_mbcnt_lo_u32_b32 v116, -1, 0
  v_and_b32 v116, 1, v116
  v_lshlrev_b32 v118, 2, v116
  global_load_dword v117, v118, s[12:13] offset:128 sc1
  ds_read_b64_tr_b16 v[56:57], v104 offset:32768
  ds_read_b64_tr_b16 v[58:59], v104 offset:36864
  ds_read_b64_tr_b16 v[64:65], v105 offset:32768
  ds_read_b64_tr_b16 v[66:67], v105 offset:36864
  ds_read_b64_tr_b16 a[144:145], v106 offset:32768
  ds_read_b64_tr_b16 a[146:147], v106 offset:36864
  ds_read_b64_tr_b16 a[96:97], v107 offset:32768
  ds_read_b64_tr_b16 a[98:99], v107 offset:36864
  ds_read_b64_tr_b16 a[136:137], v108 offset:32768
  ds_read_b64_tr_b16 a[138:139], v108 offset:36864
  ds_read_b64_tr_b16 a[88:89], v109 offset:32768
  ds_read_b64_tr_b16 a[90:91], v109 offset:36864
  ds_read_b64_tr_b16 a[128:129], v110 offset:32768
  ds_read_b64_tr_b16 a[130:131], v110 offset:36864
  ds_read_b64_tr_b16 a[80:81], v111 offset:32768
  ds_read_b64_tr_b16 a[82:83], v111 offset:36864
  s_waitcnt lgkmcnt(0)
  v_add_u32 v104, 65536, v104
  v_add_u32 v105, 65536, v105
  v_add_u32 v106, 65536, v106
  v_add_u32 v107, 65536, v107
  v_add_u32 v108, 65536, v108
  v_add_u32 v109, 65536, v109
  v_add_u32 v110, 65536, v110
  v_add_u32 v111, 65536, v111
  s_waitcnt vmcnt(16)
  s_barrier
  s_add_u32 s27, s26, 2097152
  s_add_u32 m0, s28, 65536
  s_nop 0
  buffer_load_dwordx4 v22, s[48:51], s27 offen lds
  s_add_u32 m0, s28, 66560
  s_add_u32 s27, s27, 32768
  buffer_load_dwordx4 v22, s[48:51], s27 offen lds
  s_add_u32 m0, s28, 67584
  s_add_u32 s27, s27, 32768
  buffer_load_dwordx4 v23, s[48:51], s27 offen lds
  s_add_u32 m0, s28, 68608
  s_add_u32 s27, s27, 32768
  buffer_load_dwordx4 v23, s[48:51], s27 offen lds
  s_add_u32 m0, s28, 69632
  s_add_u32 s27, s27, 32768
  buffer_load_dwordx4 v22, s[48:51], s27 offen lds
  s_add_u32 m0, s28, 70656
  s_add_u32 s27, s27, 32768
  buffer_load_dwordx4 v22, s[48:51], s27 offen lds
  s_add_u32 m0, s28, 71680
  s_add_u32 s27, s27, 32768
  buffer_load_dwordx4 v23, s[48:51], s27 offen lds
  s_add_u32 m0, s28, 72704
  s_add_u32 s27, s27, 32768
  buffer_load_dwordx4 v23, s[48:51], s27 offen lds
  ds_read_b64_tr_b16 v[60:61], v104 offset:0
  ds_read_b64_tr_b16 v[62:63], v104 offset:4096
  ds_read_b64_tr_b16 v[68:69], v105 offset:0
  ds_read_b64_tr_b16 v[70:71], v105 offset:4096
  ds_read_b64_tr_b16 a[148:149], v106 offset:0
  ds_read_b64_tr_b16 a[150:151], v106 offset:4096
  ds_read_b64_tr_b16 a[100:101], v107 offset:0
  ds_read_b64_tr_b16 a[102:103], v107 offset:4096
  ds_read_b64_tr_b16 a[140:141], v108 offset:0
  ds_read_b64_tr_b16 a[142:143], v108 offset:4096
  ds_read_b64_tr_b16 a[92:93], v109 offset:0
  ds_read_b64_tr_b16 a[94:95], v109 offset:4096
  ds_read_b64_tr_b16 a[132:133], v110 offset:0
  ds_read_b64_tr_b16 a[134:135], v110 offset:4096
  ds_read_b64_tr_b16 a[84:85], v111 offset:0
  ds_read_b64_tr_b16 a[86:87], v111 offset:4096
  s_waitcnt lgkmcnt(0)
  v_add_u32 v104, -131072, v104
  v_add_u32 v105, -131072, v105
  v_add_u32 v106, -131072, v106
  v_add_u32 v107, -131072, v107
  v_add_u32 v108, -131072, v108
  v_add_u32 v109, -131072, v109
  v_add_u32 v110, -131072, v110
  v_add_u32 v111, -131072, v111
  s_waitcnt vmcnt(16)
  s_barrier
  s_add_u32 s27, s26, 2621440
  s_add_u32 m0, s28, 98304
  s_nop 0
  buffer_load_dwordx4 v22, s[48:51], s27 offen lds
  s_add_u32 m0, s28, 99328
  s_add_u32 s27, s27, 32768
  buffer_load_dwordx4 v22, s[48:51], s27 offen lds
  s_add_u32 m0, s28, 100352
  s_add_u32 s27, s27, 32768
  buffer_load_dwordx4 v23, s[48:51], s27 offen lds
  s_add_u32 m0, s28, 101376
  s_add_u32 s27, s27, 32768
  buffer_load_dwordx4 v23, s[48:51], s27 offen lds
  s_add_u32 m0, s28, 102400
  s_add_u32 s27, s27, 32768
  buffer_load_dwordx4 v22, s[48:51], s27 offen lds
  s_add_u32 m0, s28, 103424
  s_add_u32 s27, s27, 32768
  buffer_load_dwordx4 v22, s[48:51], s27 offen lds
  s_add_u32 m0, s28, 104448
  s_add_u32 s27, s27, 32768
  buffer_load_dwordx4 v23, s[48:51], s27 offen lds
  s_add_u32 m0, s28, 105472
  s_add_u32 s27, s27, 32768
  buffer_load_dwordx4 v23, s[48:51], s27 offen lds
  s_or_b32 s36, s91, s17
  s_cbranch_scc1 L_sig
  s_lshl_b32 s36, s16, 6
  s_add_u32 s36, s36, 245104644
  v_mov_b32 v120, 1
  s_mov_b64 exec, 1
  buffer_store_dword v120, off, s[4:7], s36 sc1
  s_mov_b64 exec, -1
L_sig:
  ds_read_b64_tr_b16 v[88:89], v104 offset:0
  ds_read_b64_tr_b16 v[90:91], v104 offset:4096
  ds_read_b64_tr_b16 v[96:97], v105 offset:0
  ds_read_b64_tr_b16 v[98:99], v105 offset:4096
  ds_read_b64_tr_b16 v[232:233], v106 offset:0
  ds_read_b64_tr_b16 v[234:235], v106 offset:4096
  ds_read_b64_tr_b16 v[176:177], v107 offset:0
  ds_read_b64_tr_b16 v[178:179], v107 offset:4096
  ds_read_b64_tr_b16 v[224:225], v108 offset:0
  ds_read_b64_tr_b16 v[226:227], v108 offset:4096
  ds_read_b64_tr_b16 v[168:169], v109 offset:0
  ds_read_b64_tr_b16 v[170:171], v109 offset:4096
  ds_read_b64_tr_b16 v[216:217], v110 offset:0
  ds_read_b64_tr_b16 v[218:219], v110 offset:4096
  ds_read_b64_tr_b16 v[160:161], v111 offset:0
  ds_read_b64_tr_b16 v[162:163], v111 offset:4096
  s_waitcnt lgkmcnt(0)
  s_waitcnt vmcnt(16)
  s_barrier
  ds_read_b64_tr_b16 v[92:93], v104 offset:32768
  ds_read_b64_tr_b16 v[94:95], v104 offset:36864
  ds_read_b64_tr_b16 v[100:101], v105 offset:32768
  ds_read_b64_tr_b16 v[102:103], v105 offset:36864
  ds_read_b64_tr_b16 v[236:237], v106 offset:32768
  ds_read_b64_tr_b16 v[238:239], v106 offset:36864
  ds_read_b64_tr_b16 v[180:181], v107 offset:32768
  ds_read_b64_tr_b16 v[182:183], v107 offset:36864
  ds_read_b64_tr_b16 v[228:229], v108 offset:32768
  ds_read_b64_tr_b16 v[230:231], v108 offset:36864
  ds_read_b64_tr_b16 v[172:173], v109 offset:32768
  ds_read_b64_tr_b16 v[174:175], v109 offset:36864
  ds_read_b64_tr_b16 v[220:221], v110 offset:32768
  ds_read_b64_tr_b16 v[222:223], v110 offset:36864
  ds_read_b64_tr_b16 v[164:165], v111 offset:32768
  ds_read_b64_tr_b16 v[166:167], v111 offset:36864
  s_waitcnt lgkmcnt(0)
  s_barrier
  v_add_u32 v104, 65536, v104
  v_add_u32 v105, 65536, v105
  v_add_u32 v106, 65536, v106
  v_add_u32 v107, 65536, v107
  v_add_u32 v108, 65536, v108
  v_add_u32 v109, 65536, v109
  v_add_u32 v110, 65536, v110
  v_add_u32 v111, 65536, v111
  ds_write_b128 v8, v[128:131] offset:16384
  ds_write_b128 v8, v[132:135] offset:20480
  ds_write_b128 v8, v[136:139] offset:24576
  ds_write_b128 v8, v[140:143] offset:28672
  ds_write_b128 v8, v[144:147] offset:32768
  ds_write_b128 v8, v[148:151] offset:36864
  ds_write_b128 v8, v[152:155] offset:40960
  ds_write_b128 v8, v[156:159] offset:45056
  ds_write_b128 v8, v[184:187] offset:49152
  ds_write_b128 v8, v[188:191] offset:53248
  ds_write_b128 v8, v[192:195] offset:57344
  ds_write_b128 v8, v[196:199] offset:61440
  s_waitcnt lgkmcnt(0)
  s_waitcnt vmcnt(8)
  s_barrier
  v_cmp_eq_u32 vcc, 0, v117
  v_lshlrev_b32 v116, 12, v116
  s_or_b32 s66, vcc_lo, s91
  s_cselect_b32 s66, 0, 1
  s_lshl2_add_u32 s36, s16, s17
  s_lshl_b32 s36, s36, 5
  s_add_u32 s36, s36, 244318208
  buffer_load_dword v118, v116, s[4:7], s36 offen sc1
  ds_read_b64_tr_b16 v[208:209], v104 offset:0
  ds_read_b64_tr_b16 v[210:211], v104 offset:4096
  ds_read_b64_tr_b16 v[152:153], v105 offset:0
  ds_read_b64_tr_b16 v[154:155], v105 offset:4096
  ds_read_b64_tr_b16 v[200:201], v106 offset:0
  ds_read_b64_tr_b16 v[202:203], v106 offset:4096
  ds_read_b64_tr_b16 v[144:145], v107 offset:0
  ds_read_b64_tr_b16 v[146:147], v107 offset:4096
  ds_read_b64_tr_b16 v[192:193], v108 offset:0
  ds_read_b64_tr_b16 v[194:195], v108 offset:4096
  ds_read_b64_tr_b16 v[136:137], v109 offset:0
  ds_read_b64_tr_b16 v[138:139], v109 offset:4096
  ds_read_b64_tr_b16 v[184:185], v110 offset:0
  ds_read_b64_tr_b16 v[186:187], v110 offset:4096
  ds_read_b64_tr_b16 v[128:129], v111 offset:0
  ds_read_b64_tr_b16 v[130:131], v111 offset:4096
  s_waitcnt lgkmcnt(0)
  s_waitcnt vmcnt(0)
  s_barrier
  ds_read_b64_tr_b16 v[212:213], v104 offset:32768
  ds_read_b64_tr_b16 v[214:215], v104 offset:36864
  ds_read_b64_tr_b16 v[156:157], v105 offset:32768
  ds_read_b64_tr_b16 v[158:159], v105 offset:36864
  ds_read_b64_tr_b16 v[204:205], v106 offset:32768
  ds_read_b64_tr_b16 v[206:207], v106 offset:36864
  ds_read_b64_tr_b16 v[148:149], v107 offset:32768
  ds_read_b64_tr_b16 v[150:151], v107 offset:36864
  ds_read_b64_tr_b16 v[196:197], v108 offset:32768
  ds_read_b64_tr_b16 v[198:199], v108 offset:36864
  ds_read_b64_tr_b16 v[140:141], v109 offset:32768
  ds_read_b64_tr_b16 v[142:143], v109 offset:36864
  ds_read_b64_tr_b16 v[188:189], v110 offset:32768
  ds_read_b64_tr_b16 v[190:191], v110 offset:36864
  ds_read_b64_tr_b16 v[132:133], v111 offset:32768
  ds_read_b64_tr_b16 v[134:135], v111 offset:36864
  s_waitcnt lgkmcnt(0)
  s_barrier
  s_waitcnt vmcnt(0)
  s_lshl_b32 s26, s16, 13
  s_add_u32 s26, s26, s40
  s_add_u32 s27, s26, 4096
  s_lshl_b32 s28, s17, 13
  s_add_u32 s28, s28, s62
  buffer_load_dwordx4 v[104:107], v8, s[4:7], s26 offen sc1
  buffer_load_dwordx4 v[104:107], v8, s[4:7], s27 offen sc1
  buffer_load_dwordx2 v[104:105], v5, s[4:7], s28 offen sc1
  ds_write_b128 v1, v[24:27] offset:0
  ds_write_b128 v1, v[28:31] offset:1024
  ds_write_b128 v1, v[32:35] offset:2048
  ds_write_b128 v1, v[36:39] offset:3072
  ds_write_b128 v1, v[40:43] offset:4096
  ds_write_b128 v1, v[44:47] offset:5120
  ds_write_b128 v1, v[48:51] offset:6144
  ds_write_b128 v1, v[52:55] offset:7168
  ds_write_b128 v1, v[56:59] offset:8192
  ds_write_b128 v1, v[60:63] offset:9216
  ds_write_b128 v1, v[64:67] offset:10240
  ds_write_b128 v1, v[68:71] offset:11264
  ds_write_b128 v1, v[72:75] offset:12288
  ds_write_b128 v1, v[76:79] offset:13312
  ds_write_b128 v1, v[80:83] offset:14336
  ds_write_b128 v1, v[84:87] offset:15360
  ds_write_b128 v1, v[88:91] offset:16384
  ds_write_b128 v1, v[92:95] offset:17408
  ds_write_b128 v1, v[96:99] offset:18432
  ds_write_b128 v1, v[100:103] offset:19456
  s_mul_i32 s27, s17, 24576
  s_add_u32 m0, s27, 86016
  s_waitcnt lgkmcnt(0)
  v_readlane_b32 s67, v118, 1
  v_readlane_b32 s26, v118, 0
  v_mov_b32 v21, v117
  s_and_b32 s66, s66, s26
  s_cbranch_scc1 L_pk
  v_mbcnt_lo_u32_b32 v20, -1, 0
  v_and_b32 v20, 1, v20
  v_add_lshl_u32 v20, v20, s61, 2
  s_mov_b32 s26, 0
g_wt_9:
  global_load_dword v21, v20, s[12:13] offset:128 sc1
  s_add_u32 s26, s26, 1
  s_cmp_gt_u32 s26, 1048576
  s_cbranch_scc1 L_end
  s_waitcnt vmcnt(0)
  v_cmp_eq_u32 vcc, 0, v21
  v_readfirstlane_b32 s27, v21
  s_cbranch_vccnz g_wt_9
L_pk:
  s_lshr_b32 s26, s91, 1
  s_nop 3
  v_readlane_b32 s27, v21, s26
  s_cmp_lg_u32 s27, 1
  s_cbranch_scc1 L_chain_x
  s_mov_b32 s22, 0
  s_mov_b32 s21, 0
  s_mov_b32 s42, s62
  s_add_u32 s43, s62, 4096
  s_mov_b32 s46, 0
  s_mov_b32 s47, 0
  s_lshl_b32 s26, s16, 2
  s_add_u32 s26, s26, s17
  s_lshl_b32 s27, s60, 13
  s_add_u32 s27, s27, s26
  s_lshr_b32 s25, s27, 2
  s_lshl_b32 s25, s25, 13
  s_add_u32 s25, s25, 192937984
  s_lshr_b32 s64, s27, 2
  s_lshl_b32 s64, s64, 6
  s_add_u32 s64, s64, 513538048
  s_cmp_eq_u32 s17, 3
  s_cselect_b32 s2, 268435456, 0
  s_lshl_b32 s27, s61, 13
  s_add_u32 s27, s27, s26
  s_lshl_b32 s23, s27, 12
  s_add_u32 s23, s23, 41943040
  s_lshl_b32 s63, s27, 5
  s_add_u32 s63, s63, 244318208
  s_mov_b32 s97, 268435456
  s_cmp_eq_u32 s60, 2
  s_cselect_b32 s20, 262144, s97
  s_cselect_b32 s93, 1, 3
  s_lshl_b32 s26, s17, 2
  s_add_u32 s26, s26, s60
  s_cmp_eq_u32 s26, 1
  s_cselect_b32 s97, 245891072, s97
  s_mov_b32 s95, 0
  s_mov_b32 s96, s23
  s_add_u32 s23, s23, 524288
  s_add_u32 s63, s63, 4096
  s_cmp_eq_u32 s66, 0
  s_cbranch_scc1 c_pk_18
  s_sub_u32 s96, s23, 524288
  s_mov_b32 s65, s67
  s_mov_b32 s94, 0
  buffer_load_dwordx4 v0, s[4:7], s96 offen offset:0  lds
  buffer_load_dwordx4 v0, s[4:7], s96 offen offset:1024  lds
  buffer_load_dwordx4 v0, s[4:7], s96 offen offset:2048  lds
  buffer_load_dwordx4 v0, s[4:7], s96 offen offset:3072  lds
  s_branch c_pk2_19
c_pk_18:
  s_mov_b32 s29, 0
  s_sub_u32 s92, s63, 4096
  s_sub_u32 s96, s23, 524288
  s_mov_b32 s95, 0
c_gw_20:
  buffer_load_dword v7, off, s[4:7], s92 sc1
  s_add_u32 s29, s29, 1
  s_cmp_gt_u32 s29, 1048576
  s_cbranch_scc1 c_fail_16
  s_waitcnt vmcnt(0) lgkmcnt(0)
  v_readfirstlane_b32 s65, v7
  s_cmp_eq_u32 s65, 0
  s_cbranch_scc1 c_gw_20
  s_and_b32 s65, s65, s93
  s_cbranch_scc1 c_kvx_22
  s_mov_b32 s95, 1
  s_add_u32 s96, s96, 33554432
  s_add_u32 s92, s92, 262144
c_kvw_21:
  buffer_load_dword v7, off, s[4:7], s92 sc1
  s_add_u32 s29, s29, 1
  s_cmp_gt_u32 s29, 1048576
  s_cbranch_scc1 c_fail_16
  s_waitcnt vmcnt(0) lgkmcnt(0)
  v_readfirstlane_b32 s65, v7
  s_cmp_eq_u32 s65, 0
  s_cbranch_scc1 c_kvw_21
c_kvx_22:
  buffer_load_dword v7, off, s[4:7], s63 sc1
  buffer_load_dwordx4 v0, s[4:7], s96 offen offset:0  lds
  buffer_load_dwordx4 v0, s[4:7], s96 offen offset:1024  lds
  buffer_load_dwordx4 v0, s[4:7], s96 offen offset:2048  lds
  buffer_load_dwordx4 v0, s[4:7], s96 offen offset:3072  lds
  s_waitcnt vmcnt(4)
  v_readfirstlane_b32 s65, v7
  s_mov_b32 s94, 0
c_pk2_19:
  s_waitcnt vmcnt(4)
  ds_read_b128 v[72:75], v1 offset:6144
  ds_read_b128 v[76:79], v1 offset:7168
  ds_read_b128 v[80:83], v1 offset:8192
  ds_read_b128 v[84:87], v1 offset:9216
  ds_read_b128 v[88:91], v1 offset:10240
  ds_read_b128 v[92:95], v1 offset:11264
  ds_read_b128 v[96:99], v1 offset:12288
  ds_read_b128 v[100:103], v1 offset:13312
  ds_read_b128 v[104:107], v1 offset:14336
  ds_read_b128 v[108:111], v1 offset:15360
  ds_read_b128 v[112:115], v1 offset:16384
  ds_read_b128 v[116:119], v1 offset:17408
  ds_read_b128 v[120:123], v1 offset:18432
  ds_read_b128 v[124:127], v1 offset:19456
  v_mov_b64 v[48:49], 0
  v_mov_b64 v[50:51], 0
  v_mov_b64 v[52:53], 0
  v_mov_b64 v[54:55], 0
  v_mov_b64 v[56:57], 0
  v_mov_b64 v[58:59], 0
  v_mov_b64 v[60:61], 0
  v_mov_b64 v[62:63], 0
  v_mov_b64 v[64:65], 0
  v_mov_b64 v[66:67], 0
  v_mov_b64 v[68:69], 0
  v_mov_b64 v[70:71], 0
  s_lshl_b32 s38, s16, 13
  s_add_u32 s38, s38, s40
  s_add_u32 s39, s38, 4096
  ds_read_b128 v[24:27], v1 offset:0
  ds_read_b128 v[28:31], v1 offset:1024
  ds_read_b128 v[32:35], v1 offset:2048
  ds_read_b128 v[36:39], v1 offset:3072
  ds_read_b128 v[40:43], v1 offset:4096
  ds_read_b128 v[44:47], v1 offset:5120
  s_waitcnt lgkmcnt(0)
c_loop_10:
  buffer_load_dwordx4 v[16:19], v8, s[4:7], s42 offen sc1
  buffer_load_dwordx4 v[20:23], v8, s[4:7], s43 offen sc1
  s_mov_b32 s28, 0
  v_mov_b64 v[48:49], 0
  v_mov_b64 v[50:51], 0
  v_mov_b64 v[52:53], 0
  v_mov_b64 v[54:55], 0
  v_mov_b64 v[56:57], 0
  v_mov_b64 v[58:59], 0
  v_mov_b64 v[60:61], 0
  v_mov_b64 v[62:63], 0
  v_mov_b64 v[64:65], 0
  v_mov_b64 v[66:67], 0
  v_mov_b64 v[68:69], 0
  v_mov_b64 v[70:71], 0
  buffer_load_dwordx4 v[16:19], v8, s[4:7], s42 offen sc1
  buffer_load_dwordx4 v[20:23], v8, s[4:7], s43 offen sc1
  s_waitcnt lgkmcnt(0)
  s_and_b32 s29, s65, s93
  s_cbranch_scc0 c_xb_25
c_xr_26:
  s_waitcnt vmcnt(3)
  v_max3_u32 v7, v16, v17, v18
  v_max_u32 v7, v7, v19
  ds_write_b128 v8, v[16:19] offset:4096
  v_smfmac_f32_16x16x64_bf16 v[48:51], v[16:19], v[24:31], v6
  s_waitcnt vmcnt(2)
  v_max3_u32 v7, v20, v21, v7
  v_max3_u32 v7, v22, v23, v7
  ds_write_b128 v8, v[20:23] offset:8192
  v_smfmac_f32_16x16x64_bf16 v[52:55], v[16:19], v[32:39], v6
  v_cmp_eq_u32 vcc, -1, v7
  v_smfmac_f32_16x16x64_bf16 v[56:59], v[16:19], v[40:47], v6
  s_cbranch_vccnz c_retry_11
c_got_12:
  v_smfmac_f32_16x16x64_bf16 v[60:63], v[16:19], v[72:79], v6
  ds_read_b128 v[72:75], v1 offset:20480
  s_and_b32 s65, s65, s93
  s_cselect_b32 s96, s23, 268435456
  v_smfmac_f32_16x16x64_bf16 v[48:51], v[20:23], v[80:87], v6
  ds_read_b128 v[76:79], v1 offset:21504
  v_mov_b32 v7, 1
  v_smfmac_f32_16x16x64_bf16 v[52:55], v[20:23], v[88:95], v6
  ds_read_b128 v[80:83], v1 offset:22528
  v_smfmac_f32_16x16x64_bf16 v[56:59], v[20:23], v[96:103], v6
  ds_read_b128 v[84:87], v1 offset:23552
  s_waitcnt lgkmcnt(4)
  s_barrier
  ds_read_b128 v[24:27], v9 offset:4096
  ds_read_b128 v[28:31], v10 offset:4096
  v_smfmac_f32_16x16x64_bf16 v[60:63], v[20:23], v[104:111], v6
  ds_read_b128 v[32:35], v11 offset:4096
  v_smfmac_f32_16x16x64_bf16 v[64:67], v[16:19], v[112:119], v6
  ds_read_b128 v[36:39], v9 offset:8192
  v_smfmac_f32_16x16x64_bf16 v[68:71], v[16:19], v[120:127], v6
  ds_read_b128 v[40:43], v10 offset:8192
  v_smfmac_f32_16x16x64_bf16 v[64:67], v[20:23], v[208:215], v6
  ds_read_b128 v[44:47], v11 offset:8192
  s_waitcnt lgkmcnt(5)
  v_smfmac_f32_16x16x64_bf16 v[48:51], v[24:27], a[168:175], v6
  buffer_load_dwordx4 v0, s[4:7], s96 offen offset:0  lds
  s_waitcnt lgkmcnt(4)
  v_smfmac_f32_16x16x64_bf16 v[48:51], v[28:31], a[160:167], v6
  ds_read_b128 v[104:107], v8 offset:16384
  s_waitcnt lgkmcnt(4)
  v_smfmac_f32_16x16x64_bf16 v[48:51], v[32:35], a[152:159], v6
  buffer_load_dwordx4 v0, s[4:7], s96 offen offset:1024  lds
  s_waitcnt lgkmcnt(3)
  v_smfmac_f32_16x16x64_bf16 v[48:51], v[36:39], a[144:151], v6
  ds_read_b128 v[108:111], v8 offset:20480
  s_waitcnt lgkmcnt(3)
  v_smfmac_f32_16x16x64_bf16 v[48:51], v[40:43], a[136:143], v6
  buffer_load_dwordx4 v0, s[4:7], s96 offen offset:2048  lds
  s_waitcnt lgkmcnt(2)
  v_smfmac_f32_16x16x64_bf16 v[48:51], v[44:47], a[128:135], v6
  v_smfmac_f32_16x16x64_bf16 v[52:55], v[24:27], a[120:127], v6
  buffer_load_dwordx4 v0, s[4:7], s96 offen offset:3072  lds
  v_smfmac_f32_16x16x64_bf16 v[52:55], v[28:31], a[112:119], v6
  ds_read_b64 v[100:101], v5 offset:4096
  v_add_f32 v48, v48, v50
  v_smfmac_f32_16x16x64_bf16 v[52:55], v[32:35], a[104:111], v6
  ds_read_b128 v[112:115], v8 offset:24576
  v_add_f32 v49, v49, v51
  v_smfmac_f32_16x16x64_bf16 v[52:55], v[36:39], a[96:103], v6
  ds_read_b128 v[116:119], v8 offset:28672
  v_cvt_pk_bf16_f32 v50, v48, v49
  v_smfmac_f32_16x16x64_bf16 v[52:55], v[40:43], a[88:95], v6
  ds_write2_b32 v2, v50, v50 offset0:0 offset1:1
  v_smfmac_f32_16x16x64_bf16 v[52:55], v[44:47], a[80:87], v6
  ds_read_b64_tr_b16 v[88:89], v12 offset:0
  v_smfmac_f32_16x16x64_bf16 v[56:59], v[24:27], a[72:79], v6
  s_mov_b64 exec, 1
  buffer_store_dword v7, off, s[4:7], s64 sc1
  s_mov_b64 exec, -1
  v_smfmac_f32_16x16x64_bf16 v[56:59], v[28:31], a[64:71], v6
  ds_read_b128 v[120:123], v8 offset:32768
  v_add_f32 v52, v52, v54
  v_smfmac_f32_16x16x64_bf16 v[56:59], v[32:35], a[56:63], v6
  ds_read_b128 v[124:127], v8 offset:36864
  v_add_f32 v53, v53, v55
  v_cvt_pk_bf16_f32 v54, v52, v53
  v_smfmac_f32_16x16x64_bf16 v[56:59], v[36:39], a[48:55], v6
  ds_write2_b32 v2, v54, v54 offset0:128 offset1:129
  ds_read_b64_tr_b16 v[90:91], v12 offset:512
  v_smfmac_f32_16x16x64_bf16 v[56:59], v[40:43], a[40:47], v6
  v_smfmac_f32_16x16x64_bf16 v[56:59], v[44:47], a[32:39], v6
  v_smfmac_f32_16x16x64_bf16 v[60:63], v[24:27], a[24:31], v6
  v_smfmac_f32_16x16x64_bf16 v[60:63], v[28:31], a[16:23], v6
  s_waitcnt lgkmcnt(0)
  v_add_f32 v56, v56, v58
  v_mfma_f32_16x16x32_bf16 v[92:95], v[72:75], v[88:91], 0
  buffer_store_dwordx2 v[100:101], v5, s[4:7], s97 offen sc1
  v_add_f32 v57, v57, v59
  v_cvt_pk_bf16_f32 v58, v56, v57
  v_mfma_f32_16x16x32_bf16 v[96:99], v[76:79], v[88:91], 0
  ds_write_b32 v2, v58
  v_smfmac_f32_16x16x64_bf16 v[60:63], v[32:35], a[8:15], v6
  v_mov_b32 v76, 0
  v_smfmac_f32_16x16x64_bf16 v[60:63], v[36:39], a[0:7], v6
  v_cndmask_b32 v48, v92, v96, s[18:19]
  v_smfmac_f32_16x16x64_bf16 v[60:63], v[40:43], v[248:255], v6
  v_cndmask_b32 v49, v93, v97, s[18:19]
  v_smfmac_f32_16x16x64_bf16 v[60:63], v[44:47], v[240:247], v6
  v_cndmask_b32 v50, v94, v98, s[18:19]
  v_smfmac_f32_16x16x64_bf16 v[68:71], v[20:23], v[152:159], v6
  v_cndmask_b32 v51, v95, v99, s[18:19]
  v_smfmac_f32_16x16x64_bf16 v[64:67], v[24:27], v[232:239], v6
  ds_write_b128 v8, v[48:51] offset:12288
  v_add_f32 v60, v60, v62
  v_add_f32 v61, v61, v63
  v_cvt_pk_bf16_f32 v62, v60, v61
  v_smfmac_f32_16x16x64_bf16 v[64:67], v[28:31], v[224:231], v6
  ds_write_b32 v2, v62 offset:512
  s_waitcnt vmcnt(6)
  v_mov_b32 v79, 0
  v_smfmac_f32_16x16x64_bf16 v[64:67], v[32:35], v[216:223], v6
  v_mov_b64 v[20:21], s[14:15]
  v_smfmac_f32_16x16x64_bf16 v[64:67], v[36:39], v[200:207], v6
  v_mov_b64 v[22:23], s[14:15]
  v_smfmac_f32_16x16x64_bf16 v[64:67], v[40:43], v[192:199], v6
  s_waitcnt lgkmcnt(0)
  s_barrier
  ds_read_b128 v[52:55], v9 offset:12288
  ds_read_b128 v[56:59], v10 offset:12288
  v_smfmac_f32_16x16x64_bf16 v[64:67], v[44:47], v[184:191], v6
  ds_read_b128 v[60:63], v11 offset:12288
  v_smfmac_f32_16x16x64_bf16 v[68:71], v[24:27], v[176:183], v6
  ds_read_b64_tr_b16 v[88:89], v12 offset:0
  ds_read_b64_tr_b16 v[90:91], v12 offset:512
  v_smfmac_f32_16x16x64_bf16 v[68:71], v[28:31], v[168:175], v6
  ds_read_b64_tr_b16 v[92:93], v13 offset:0
  ds_read_b64_tr_b16 v[94:95], v13 offset:512
  v_add_f32 v64, v64, v66
  v_smfmac_f32_16x16x64_bf16 v[68:71], v[32:35], v[160:167], v6
  ds_read_b64_tr_b16 v[96:97], v14 offset:0
  ds_read_b64_tr_b16 v[98:99], v14 offset:512
  v_add_f32 v65, v65, v67
  v_smfmac_f32_16x16x64_bf16 v[68:71], v[36:39], v[144:151], v6
  ds_read_b64_tr_b16 v[100:101], v15 offset:0
  ds_read_b64_tr_b16 v[102:103], v15 offset:512
  s_waitcnt lgkmcnt(8)
  v_cvt_pk_bf16_f32 v66, v64, v65
  v_smfmac_f32_16x16x64_bf16 v[68:71], v[40:43], v[136:143], v6
  v_add_f32 v48, v48, v52
  v_smfmac_f32_16x16x64_bf16 v[68:71], v[44:47], v[128:135], v6
  s_waitcnt lgkmcnt(4)
  v_add_f32 v49, v49, v53
  v_mfma_f32_16x16x32_bf16 v[16:19], v[88:91], v[88:91], 0
  buffer_store_dwordx4 v[88:91], v8, s[4:7], s25 offen sc1
  v_add_f32 v50, v50, v54
  v_add_f32 v51, v51, v55
  v_mfma_f32_16x16x32_bf16 v[16:19], v[92:95], v[92:95], v[16:19]
  s_waitcnt lgkmcnt(0)
  v_add_f32 v56, v56, v60
  v_add_f32 v57, v57, v61
  v_mfma_f32_16x16x32_bf16 v[16:19], v[96:99], v[96:99], v[16:19]
  v_add_f32 v58, v58, v62
  v_add_f32 v59, v59, v63
  v_mfma_f32_16x16x32_bf16 v[16:19], v[100:103], v[100:103], v[16:19]
  v_add_f32 v48, v48, v56
  v_add_f32 v49, v49, v57
  v_add_f32 v50, v50, v58
  v_add_f32 v51, v51, v59
  v_exp_f32 v24, v48
  v_exp_f32 v25, v49
  v_exp_f32 v26, v50
  v_exp_f32 v27, v51
  v_cvt_pk_bf16_f32 v24, v24, v25
  v_mul_f32 v16, s24, v16
  v_cvt_pk_bf16_f32 v25, v26, v27
  v_cndmask_b32 v72, v24, 0, s[18:19]
  v_cndmask_b32 v73, v25, 0, s[18:19]
  v_cndmask_b32 v74, 0, v24, s[18:19]
  v_cndmask_b32 v75, 0, v25, s[18:19]
  v_mul_f32 v17, s24, v17
  v_exp_f32 v28, v16
  v_mfma_f32_16x16x32_bf16 v[60:63], v[72:75], v[20:23], 0
  v_exp_f32 v29, v17
  v_add_f32 v68, v68, v70
  v_mfma_f32_16x16x32_bf16 v[52:55], v[72:75], v[80:83], 0
  s_add_u32 s30, s25, 4096
  v_cvt_pk_bf16_f32 v28, v28, v29
  v_add_f32 v69, v69, v71
  v_mfma_f32_16x16x32_bf16 v[56:59], v[72:75], v[84:87], 0
  v_cndmask_b32 v77, 0, v28, s[18:19]
  v_cndmask_b32 v78, 0, v28, s[18:19]
  v_cvt_pk_bf16_f32 v67, v68, v69
  v_lshrrev_b32 v92, 1, v8
  v_mfma_f32_16x16x16_bf16 v[60:63], v[76:77], v[20:21], v[60:63]
  buffer_store_dwordx2 v[66:67], v92, s[4:7], s30 offen sc1
  v_max3_f32 v7, |v48|, |v49|, |v50|
  v_max_f32 v26, |v16|, |v17|
  v_mfma_f32_16x16x16_bf16 v[52:55], v[78:79], v[66:67], v[52:55]
  v_cndmask_b32 v26, 0, v26, s[18:19]
  v_max3_f32 v7, |v51|, v26, v7
  v_mfma_f32_16x16x16_bf16 v[56:59], v[76:77], v[66:67], v[56:59]
  v_cmp_lt_f32 vcc, 0x42700000, v7
  v_mov_b64 v[44:45], 0
  v_add_f32 v60, v60, v62
  v_add_f32 v61, v61, v63
  s_cbranch_vccnz c_fb_14
c_fbr_15:
  v_rcp_f32 v60, v60
  v_rcp_f32 v61, v61
  v_pk_add_f32 v[52:53], v[52:53], v[54:55]
  v_pk_add_f32 v[56:57], v[56:57], v[58:59]
  v_pk_mul_f32 v[52:53], v[52:53], v[60:61]
  v_pk_mul_f32 v[56:57], v[56:57], v[60:61]
  v_cvt_pk_bf16_f32 v54, v52, v53
  v_cvt_pk_bf16_f32 v55, v56, v57
  ds_write_b64 v2, v[54:55] offset:4096
  v_mov_b64 v[46:47], 0
  v_mov_b64 v[40:41], 0
  v_mov_b64 v[42:43], 0
  v_mov_b64 v[36:37], 0
  v_mov_b64 v[38:39], 0
  v_mov_b64 v[32:33], 0
  v_mov_b64 v[34:35], 0
  v_mov_b64 v[28:29], 0
  v_mov_b64 v[30:31], 0
  v_mov_b64 v[24:25], 0
  v_mov_b64 v[26:27], 0
  v_mov_b64 v[80:81], 0
  v_mov_b64 v[82:83], 0
  v_mov_b64 v[84:85], 0
  v_mov_b64 v[86:87], 0
  s_waitcnt lgkmcnt(0)
  s_barrier
  ds_read_b64_tr_b16 v[72:73], v3 offset:4096
  ds_read_b64_tr_b16 v[74:75], v3 offset:5120
  ds_read_b64_tr_b16 v[76:77], v3 offset:6144
  ds_read_b64_tr_b16 v[78:79], v3 offset:7168
  s_and_b32 s3, s21, 1
  s_add_u32 s21, s21, 1
  s_add_u32 s22, s22, 1
  s_and_b32 s42, s21, 3
  s_lshl_b32 s42, s42, 13
  s_cmp_eq_u32 s22, 64
  s_cbranch_scc1 c_last_17
  s_waitcnt lgkmcnt(2)
  v_smfmac_f32_16x16x64_bf16 v[44:47], v[72:75], a[248:255], v6
  s_waitcnt lgkmcnt(0)
  ds_read_b128 v[16:19], v8 offset:40960
  v_smfmac_f32_16x16x64_bf16 v[44:47], v[76:79], a[240:247], v6
  ds_read_b128 v[20:23], v8 offset:45056
  v_smfmac_f32_16x16x64_bf16 v[40:43], v[72:75], a[232:239], v6
  ds_read_b128 v[88:91], v8 offset:49152
  v_smfmac_f32_16x16x64_bf16 v[40:43], v[76:79], a[224:231], v6
  ds_read_b128 v[92:95], v8 offset:53248
  v_add_f32 v44, v44, v46
  v_add_f32 v45, v45, v47
  v_smfmac_f32_16x16x64_bf16 v[36:39], v[72:75], a[216:223], v6
  ds_read_b128 v[96:99], v8 offset:57344
  v_cvt_pk_bf16_f32 v48, v44, v45
  v_and_or_b32 v48, v48, -2, s3
  v_smfmac_f32_16x16x64_bf16 v[36:39], v[76:79], a[208:215], v6
  ds_read_b128 v[100:103], v8 offset:61440
  v_add_f32 v40, v40, v42
  v_add_f32 v41, v41, v43
  v_smfmac_f32_16x16x64_bf16 v[32:35], v[72:75], a[200:207], v6
  v_cvt_pk_bf16_f32 v49, v40, v41
  v_smfmac_f32_16x16x64_bf16 v[32:35], v[76:79], a[192:199], v6
  v_add_f32 v36, v36, v38
  v_add_f32 v37, v37, v39
  v_smfmac_f32_16x16x64_bf16 v[28:31], v[72:75], a[184:191], v6
  v_cvt_pk_bf16_f32 v50, v36, v37
  v_smfmac_f32_16x16x64_bf16 v[28:31], v[76:79], a[176:183], v6
  v_add_f32 v32, v32, v34
  v_add_f32 v33, v33, v35
  v_smfmac_f32_16x16x64_bf16 v[24:27], v[72:75], v[104:111], v6
  v_cvt_pk_bf16_f32 v51, v32, v33
  v_smfmac_f32_16x16x64_bf16 v[24:27], v[76:79], v[112:119], v6
  buffer_store_dwordx4 v[48:51], v4, s[4:7], s40 offen
  v_add_f32 v28, v28, v30
  v_add_f32 v29, v29, v31
  v_smfmac_f32_16x16x64_bf16 v[80:83], v[72:75], v[120:127], v6
  s_waitcnt lgkmcnt(0)
  v_cvt_pk_bf16_f32 v52, v28, v29
  v_and_or_b32 v52, v52, -2, s3
  v_smfmac_f32_16x16x64_bf16 v[80:83], v[76:79], v[16:23], v6
  v_add_f32 v24, v24, v26
  v_add_f32 v25, v25, v27
  v_smfmac_f32_16x16x64_bf16 v[84:87], v[72:75], v[88:95], v6
  v_cvt_pk_bf16_f32 v53, v24, v25
  v_smfmac_f32_16x16x64_bf16 v[84:87], v[76:79], v[96:103], v6
  v_add_f32 v80, v80, v82
  v_add_f32 v81, v81, v83
  v_cvt_pk_bf16_f32 v54, v80, v81
  s_nop 0
  s_nop 3
  v_pk_add_f32 v[84:85], v[84:85], v[86:87]
  v_cvt_pk_bf16_f32 v55, v84, v85
  buffer_store_dwordx4 v[52:55], v4, s[4:7], s41 offen
  s_add_u32 s42, s42, s62
  s_add_u32 s43, s42, 4096
  s_add_u32 s23, s23, 524288
  s_add_u32 s25, s25, 262144
  s_add_u32 s63, s63, 4096
  s_add_u32 s64, s64, 2048
  s_andn2_b32 s64, s64, s2
  s_add_u32 s97, s97, 8192
  s_add_u32 s92, s63, s20
  s_cmp_lg_u32 s17, 0
  s_cbranch_scc1 c_oth_29
  s_mov_b32 s28, 0
  s_add_u32 s46, s46, 1
  v_mov_b64 v[64:65], -1
  s_xor_b32 s34, s42, 16384
  buffer_store_dwordx2 v[64:65], v5, s[4:7], s34 offen
  s_mov_b32 vcc_lo, 0xaaaaaaaa
  s_mov_b32 vcc_hi, 0xaaaaaaaa
  v_mov_b32 v7, 0x3f80
  v_cndmask_b32 v7, v7, 1.0, vcc
  s_mov_b32 vcc_lo, 0x30003
  s_mov_b32 vcc_hi, 0x30003
  v_cndmask_b32 v68, 0, v7, vcc
  s_mov_b32 vcc_lo, 0xc000c
  s_mov_b32 vcc_hi, 0xc000c
  v_cndmask_b32 v69, 0, v7, vcc
  s_mov_b32 vcc_lo, 0x300030
  s_mov_b32 vcc_hi, 0x300030
  v_cndmask_b32 v70, 0, v7, vcc
  s_mov_b32 vcc_lo, 0xc000c0
  s_mov_b32 vcc_hi, 0xc000c0
  v_cndmask_b32 v71, 0, v7, vcc
  ds_read_b128 v[104:107], v1 offset:14336
  ds_read_b128 v[108:111], v1 offset:15360
  s_waitcnt lgkmcnt(0)
  ds_read_b128 v[112:115], v1 offset:16384
  ds_read_b128 v[116:119], v1 offset:17408
  ds_read_b128 v[120:123], v1 offset:18432
  ds_read_b128 v[124:127], v1 offset:19456
  s_waitcnt lgkmcnt(0)
  buffer_load_dwordx4 v[16:19], v0, s[4:7], s38 offen offset:0 sc1
  buffer_load_dwordx4 v[20:23], v0, s[4:7], s38 offen offset:1024 sc1
  buffer_load_dwordx4 v[24:27], v0, s[4:7], s38 offen offset:2048 sc1
  buffer_load_dwordx4 v[28:31], v0, s[4:7], s38 offen offset:3072 sc1
  buffer_load_dwordx4 v[32:35], v0, s[4:7], s39 offen offset:0 sc1
  buffer_load_dwordx4 v[36:39], v0, s[4:7], s39 offen offset:1024 sc1
  buffer_load_dwordx4 v[40:43], v0, s[4:7], s39 offen offset:2048 sc1
  buffer_load_dwordx4 v[44:47], v0, s[4:7], s39 offen offset:3072 sc1
  buffer_load_dwordx4 v[72:75], v0, s[4:7], s38 offen offset:0 sc1
  buffer_load_dwordx4 v[76:79], v0, s[4:7], s38 offen offset:1024 sc1
  buffer_load_dwordx4 v[80:83], v0, s[4:7], s38 offen offset:2048 sc1
  buffer_load_dwordx4 v[84:87], v0, s[4:7], s38 offen offset:3072 sc1
  buffer_load_dwordx4 v[88:91], v0, s[4:7], s39 offen offset:0 sc1
  buffer_load_dwordx4 v[92:95], v0, s[4:7], s39 offen offset:1024 sc1
  buffer_load_dwordx4 v[96:99], v0, s[4:7], s39 offen offset:2048 sc1
  buffer_load_dwordx4 v[100:103], v0, s[4:7], s39 offen offset:3072 sc1
  s_buffer_load_dword s65, s[4:7], s63
  s_waitcnt vmcnt(15)
  v_mfma_f32_16x16x32_bf16 v[64:67], v[16:19], v[68:71], 0
  v_xor_b32 v7, s3, v16
  s_waitcnt vmcnt(14)
  v_mfma_f32_16x16x32_bf16 v[64:67], v[20:23], v[68:71], v[64:67]
  v_bitop3_b32 v7, v7, v20, s3 bitop3:0xf6
  s_waitcnt vmcnt(13)
  v_mfma_f32_16x16x32_bf16 v[64:67], v[24:27], v[68:71], v[64:67]
  v_bitop3_b32 v7, v7, v24, s3 bitop3:0xf6
  s_waitcnt vmcnt(12)
  v_mfma_f32_16x16x32_bf16 v[64:67], v[28:31], v[68:71], v[64:67]
  v_bitop3_b32 v7, v7, v28, s3 bitop3:0xf6
  s_waitcnt vmcnt(11)
  v_mfma_f32_16x16x32_bf16 v[64:67], v[32:35], v[68:71], v[64:67]
  v_bitop3_b32 v7, v7, v32, s3 bitop3:0xf6
  s_waitcnt vmcnt(10)
  v_mfma_f32_16x16x32_bf16 v[64:67], v[36:39], v[68:71], v[64:67]
  v_bitop3_b32 v7, v7, v36, s3 bitop3:0xf6
  s_waitcnt vmcnt(9)
  v_mfma_f32_16x16x32_bf16 v[64:67], v[40:43], v[68:71], v[64:67]
  v_bitop3_b32 v7, v7, v40, s3 bitop3:0xf6
  s_waitcnt vmcnt(8)
  v_mfma_f32_16x16x32_bf16 v[64:67], v[44:47], v[68:71], v[64:67]
  v_bitop3_b32 v7, v7, v44, s3 bitop3:0xf6
  v_and_b32 v7, 1, v7
  v_cmp_ne_u32 vcc, 0, v7
  v_mov_b32 v7, 0
  v_mov_b32 v7, 0
  s_cbranch_vccnz c_p1r_30
c_publ_31:
  s_nop 1
  s_nop 0
  v_cvt_pk_bf16_f32 v64, v64, v65
  v_cvt_pk_bf16_f32 v65, v66, v67
  v_min_u32 v64, -2, v64
  v_min_u32 v65, -2, v65
  buffer_store_dwordx2 v[64:65], v5, s[4:7], s42 offen
  s_waitcnt vmcnt(1)
  ds_read_b128 v[24:27], v1 offset:0
  ds_read_b128 v[28:31], v1 offset:1024
  ds_read_b128 v[32:35], v1 offset:2048
  ds_read_b128 v[36:39], v1 offset:3072
  ds_read_b128 v[40:43], v1 offset:4096
  ds_read_b128 v[44:47], v1 offset:5120
  ds_read_b128 v[72:75], v1 offset:6144
  ds_read_b128 v[76:79], v1 offset:7168
  ds_read_b128 v[80:83], v1 offset:8192
  ds_read_b128 v[84:87], v1 offset:9216
  ds_read_b128 v[88:91], v1 offset:10240
  ds_read_b128 v[92:95], v1 offset:11264
  ds_read_b128 v[96:99], v1 offset:12288
  ds_read_b128 v[100:103], v1 offset:13312
c_hop2_13:
  s_barrier
  s_cmp_le_u32 s96, s23
  s_cbranch_scc1 c_loop_10
  s_cmp_lg_u32 s96, 268435456
  s_cbranch_scc1 c_fk0_32
  buffer_store_dwordx2 v[64:65], v5, s[4:7], s97 offen sc1
  s_mov_b32 s29, 0
  s_sub_u32 s92, s63, 4096
  s_sub_u32 s96, s23, 524288
  s_mov_b32 s95, 0
c_gw_33:
  buffer_load_dword v7, off, s[4:7], s92 sc1
  s_add_u32 s29, s29, 1
  s_cmp_gt_u32 s29, 1048576
  s_cbranch_scc1 c_fail_16
  s_waitcnt vmcnt(0) lgkmcnt(0)
  v_readfirstlane_b32 s65, v7
  s_cmp_eq_u32 s65, 0
  s_cbranch_scc1 c_gw_33
  s_and_b32 s65, s65, s93
  s_cbranch_scc1 c_kvx_35
  s_mov_b32 s95, 1
  s_add_u32 s96, s96, 33554432
  s_add_u32 s92, s92, 262144
c_kvw_34:
  buffer_load_dword v7, off, s[4:7], s92 sc1
  s_add_u32 s29, s29, 1
  s_cmp_gt_u32 s29, 1048576
  s_cbranch_scc1 c_fail_16
  s_waitcnt vmcnt(0) lgkmcnt(0)
  v_readfirstlane_b32 s65, v7
  s_cmp_eq_u32 s65, 0
  s_cbranch_scc1 c_kvw_34
c_kvx_35:
  buffer_load_dword v7, off, s[4:7], s63 sc1
  buffer_load_dwordx4 v0, s[4:7], s96 offen offset:0  lds
  buffer_load_dwordx4 v0, s[4:7], s96 offen offset:1024  lds
  buffer_load_dwordx4 v0, s[4:7], s96 offen offset:2048  lds
  buffer_load_dwordx4 v0, s[4:7], s96 offen offset:3072  lds
  s_waitcnt vmcnt(4)
  v_readfirstlane_b32 s65, v7
  s_mov_b32 s94, 0
  s_cmp_eq_u32 s95, 0
  s_cbranch_scc1 c_loop_10
c_fk0_32:
  s_mov_b32 s29, 0
c_fk_36:
  buffer_load_dwordx4 v[16:19], v8, s[4:7], s42 offen sc1
  buffer_load_dwordx4 v[20:23], v8, s[4:7], s43 offen sc1
  s_add_u32 s29, s29, 1
  s_cmp_gt_u32 s29, 1048576
  s_cbranch_scc1 c_fail_16
  s_waitcnt vmcnt(0)
  v_max3_u32 v7, v16, v17, v18
  v_max3_u32 v7, v19, v20, v7
  v_max3_u32 v7, v21, v22, v7
  v_max_u32 v7, v7, v23
  v_cmp_eq_u32 vcc, -1, v7
  s_cbranch_vccnz c_fk_36
c_fk1_37:
  s_lshl_b32 s42, s22, 13
  s_add_u32 s42, s42, 245891072
  s_add_u32 s43, s42, 4096
  s_mov_b32 s95, 0
  s_branch c_loop_10
c_xb_25:
  s_cmp_lg_u32 s93, 1
  s_cbranch_scc1 c_xr_26
  s_cmp_ge_u32 s22, 63
  s_cbranch_scc1 c_xr_26
c_xp_38:
  s_cmp_lg_u32 s65, 0
  s_cbranch_scc1 c_xs_39
  buffer_load_dword v7, off, s[4:7], s63 sc1
  s_add_u32 s29, s29, 1
  s_cmp_gt_u32 s29, 1048576
  s_cbranch_scc1 c_fail_16
  s_waitcnt vmcnt(0)
  v_readfirstlane_b32 s65, v7
  s_branch c_xp_38
c_xs_39:
  s_cmp_eq_u32 s65, 1
  s_cbranch_scc1 c_xr_26
  s_mov_b32 s29, 0
c_xw_40:
  buffer_load_dwordx4 v[16:19], v8, s[4:7], s42 offen sc1
  buffer_load_dwordx4 v[20:23], v8, s[4:7], s43 offen sc1
  s_add_u32 s29, s29, 1
  s_cmp_gt_u32 s29, 1048576
  s_cbranch_scc1 c_fail_16
  s_waitcnt vmcnt(0)
  v_max3_u32 v7, v16, v17, v18
  v_max3_u32 v7, v19, v20, v7
  v_max3_u32 v7, v21, v22, v7
  v_max_u32 v7, v7, v23
  v_cmp_eq_u32 vcc, -1, v7
  s_cbranch_vccnz c_xw_40
  v_mov_b32 v7, 1
  s_barrier
  s_mov_b64 exec, 1
  buffer_store_dword v7, off, s[4:7], s64 sc1
  s_mov_b64 exec, -1
  s_add_u32 s22, s22, 1
  s_add_u32 s23, s23, 524288
  s_add_u32 s25, s25, 262144
  s_add_u32 s63, s63, 4096
  s_add_u32 s64, s64, 2048
  s_andn2_b32 s64, s64, s2
  s_mov_b32 s29, 0
  s_sub_u32 s92, s63, 4096
  s_sub_u32 s96, s23, 524288
  s_mov_b32 s95, 0
  s_mov_b32 s95, 1
  s_add_u32 s96, s96, 33554432
  s_add_u32 s92, s92, 262144
c_kvw_42:
  buffer_load_dword v7, off, s[4:7], s92 sc1
  s_add_u32 s29, s29, 1
  s_cmp_gt_u32 s29, 1048576
  s_cbranch_scc1 c_fail_16
  s_waitcnt vmcnt(0) lgkmcnt(0)
  v_readfirstlane_b32 s65, v7
  s_cmp_eq_u32 s65, 0
  s_cbranch_scc1 c_kvw_42
c_kvx_43:
  buffer_load_dword v7, off, s[4:7], s63 sc1
  buffer_load_dwordx4 v0, s[4:7], s96 offen offset:0  lds
  buffer_load_dwordx4 v0, s[4:7], s96 offen offset:1024  lds
  buffer_load_dwordx4 v0, s[4:7], s96 offen offset:2048  lds
  buffer_load_dwordx4 v0, s[4:7], s96 offen offset:3072  lds
  s_waitcnt vmcnt(4)
  v_readfirstlane_b32 s65, v7
  s_mov_b32 s94, 0
  s_branch c_fk1_37
c_last_17:
  s_add_u32 s64, s64, 2048
  v_mov_b32 v7, 1
  s_waitcnt vmcnt(0)
  s_barrier
  s_mov_b64 exec, 1
  buffer_store_dword v7, off, s[4:7], s64 sc1
  s_mov_b64 exec, -1
  s_branch L_chdone
c_oth_29:
  s_buffer_load_dword s65, s[4:7], s63
  ds_read_b128 v[24:27], v1 offset:0
  ds_read_b128 v[28:31], v1 offset:1024
  ds_read_b128 v[32:35], v1 offset:2048
  ds_read_b128 v[36:39], v1 offset:3072
  ds_read_b128 v[40:43], v1 offset:4096
  ds_read_b128 v[44:47], v1 offset:5120
  ds_read_b128 v[72:75], v1 offset:6144
  ds_read_b128 v[76:79], v1 offset:7168
  ds_read_b128 v[80:83], v1 offset:8192
  ds_read_b128 v[84:87], v1 offset:9216
  ds_read_b128 v[88:91], v1 offset:10240
  ds_read_b128 v[92:95], v1 offset:11264
  ds_read_b128 v[96:99], v1 offset:12288
  ds_read_b128 v[100:103], v1 offset:13312
  ds_read_b128 v[104:107], v1 offset:14336
  ds_read_b128 v[108:111], v1 offset:15360
  ds_read_b128 v[112:115], v1 offset:16384
  ds_read_b128 v[116:119], v1 offset:17408
  ds_read_b128 v[120:123], v1 offset:18432
  ds_read_b128 v[124:127], v1 offset:19456
  s_branch c_hop2_13
c_p1r_30:
  s_waitcnt vmcnt(7)
  s_nop 0
  v_mfma_f32_16x16x32_bf16 v[64:67], v[72:75], v[68:71], 0
  v_xor_b32 v7, s3, v72
  s_waitcnt vmcnt(6)
  v_mfma_f32_16x16x32_bf16 v[64:67], v[76:79], v[68:71], v[64:67]
  v_bitop3_b32 v7, v7, v76, s3 bitop3:0xf6
  s_waitcnt vmcnt(5)
  v_mfma_f32_16x16x32_bf16 v[64:67], v[80:83], v[68:71], v[64:67]
  v_bitop3_b32 v7, v7, v80, s3 bitop3:0xf6
  s_waitcnt vmcnt(4)
  v_mfma_f32_16x16x32_bf16 v[64:67], v[84:87], v[68:71], v[64:67]
  v_bitop3_b32 v7, v7, v84, s3 bitop3:0xf6
  s_waitcnt vmcnt(3)
  v_mfma_f32_16x16x32_bf16 v[64:67], v[88:91], v[68:71], v[64:67]
  v_bitop3_b32 v7, v7, v88, s3 bitop3:0xf6
  s_waitcnt vmcnt(2)
  v_mfma_f32_16x16x32_bf16 v[64:67], v[92:95], v[68:71], v[64:67]
  v_bitop3_b32 v7, v7, v92, s3 bitop3:0xf6
  s_waitcnt vmcnt(1)
  v_mfma_f32_16x16x32_bf16 v[64:67], v[96:99], v[68:71], v[64:67]
  v_bitop3_b32 v7, v7, v96, s3 bitop3:0xf6
  s_waitcnt vmcnt(0)
  v_mfma_f32_16x16x32_bf16 v[64:67], v[100:103], v[68:71], v[64:67]
  v_bitop3_b32 v7, v7, v100, s3 bitop3:0xf6
  v_and_b32 v7, 1, v7
  v_cmp_ne_u32 vcc, 0, v7
  s_add_u32 s46, s46, 1
  s_cbranch_vccz c_publ_31
  buffer_load_dwordx4 v[72:75], v0, s[4:7], s38 offen offset:0 sc1
  buffer_load_dwordx4 v[76:79], v0, s[4:7], s38 offen offset:1024 sc1
  buffer_load_dwordx4 v[80:83], v0, s[4:7], s38 offen offset:2048 sc1
  buffer_load_dwordx4 v[84:87], v0, s[4:7], s38 offen offset:3072 sc1
  buffer_load_dwordx4 v[88:91], v0, s[4:7], s39 offen offset:0 sc1
  buffer_load_dwordx4 v[92:95], v0, s[4:7], s39 offen offset:1024 sc1
  buffer_load_dwordx4 v[96:99], v0, s[4:7], s39 offen offset:2048 sc1
  buffer_load_dwordx4 v[100:103], v0, s[4:7], s39 offen offset:3072 sc1
  s_add_u32 s28, s28, 1
  s_cmp_gt_u32 s28, 1048576
  s_cbranch_scc0 c_p1r_30
  s_branch c_fail_16
c_retry_11:
  v_mov_b64 v[48:49], 0
  v_mov_b64 v[50:51], 0
  s_nop 0
  v_mov_b64 v[52:53], 0
  v_mov_b64 v[54:55], 0
  s_nop 1
  v_mov_b64 v[56:57], 0
  v_mov_b64 v[58:59], 0
c_rl_44:
  buffer_load_dwordx4 v[16:19], v8, s[4:7], s42 offen sc1
  buffer_load_dwordx4 v[20:23], v8, s[4:7], s43 offen sc1
  s_add_u32 s28, s28, 1
  s_add_u32 s47, s47, 1
  s_cmp_gt_u32 s28, 1048576
  s_cbranch_scc1 c_fail_16
  s_waitcnt vmcnt(2)
  v_max3_u32 v7, v16, v17, v18
  v_max3_u32 v7, v19, v20, v7
  v_max3_u32 v7, v21, v22, v7
  v_max_u32 v7, v7, v23
  v_cmp_eq_u32 vcc, -1, v7
  s_cbranch_vccnz c_rl_44
  ds_write_b128 v8, v[16:19] offset:4096
  v_smfmac_f32_16x16x64_bf16 v[48:51], v[16:19], v[24:31], v6
  ds_write_b128 v8, v[20:23] offset:8192
  v_smfmac_f32_16x16x64_bf16 v[52:55], v[16:19], v[32:39], v6
  v_smfmac_f32_16x16x64_bf16 v[56:59], v[16:19], v[40:47], v6
  s_branch c_got_12
c_fb_14:
  v_max3_f32 v7, v48, v49, v50
  v_max_f32 v7, v51, v7
  s_mov_b64 exec, s[18:19]
  v_max3_f32 v7, v16, v17, v7
  s_mov_b64 exec, -1
  s_nop 0
  v_max_f32_dpp v7, v7, v7 quad_perm:[2,3,0,1] row_mask:0xf bank_mask:0xf
  v_mov_b32 v24, v7
  s_nop 0
  s_nop 0
  v_permlane16_swap_b32 v7, v24
  v_max_f32 v7, v7, v24
  v_mov_b32 v24, v7
  s_nop 0
  s_nop 0
  v_permlane32_swap_b32 v7, v24
  v_max_f32 v7, v7, v24
  v_sub_f32 v24, v48, v7
  v_sub_f32 v25, v49, v7
  v_sub_f32 v26, v50, v7
  v_sub_f32 v27, v51, v7
  v_sub_f32 v28, v16, v7
  v_sub_f32 v29, v17, v7
  v_exp_f32 v24, v24
  v_exp_f32 v25, v25
  v_exp_f32 v26, v26
  v_exp_f32 v27, v27
  v_exp_f32 v28, v28
  v_exp_f32 v29, v29
  v_cvt_pk_bf16_f32 v24, v24, v25
  v_cvt_pk_bf16_f32 v25, v26, v27
  v_cvt_pk_bf16_f32 v28, v28, v29
  v_cndmask_b32 v72, v24, 0, s[18:19]
  v_cndmask_b32 v73, v25, 0, s[18:19]
  v_cndmask_b32 v74, 0, v24, s[18:19]
  v_cndmask_b32 v75, 0, v25, s[18:19]
  v_cndmask_b32 v77, 0, v28, s[18:19]
  v_cndmask_b32 v78, 0, v28, s[18:19]
  v_mfma_f32_16x16x32_bf16 v[60:63], v[72:75], v[20:23], 0
  v_mfma_f32_16x16x32_bf16 v[52:55], v[72:75], v[80:83], 0
  v_mfma_f32_16x16x32_bf16 v[56:59], v[72:75], v[84:87], 0
  v_mfma_f32_16x16x16_bf16 v[60:63], v[76:77], v[20:21], v[60:63]
  v_mfma_f32_16x16x16_bf16 v[52:55], v[78:79], v[66:67], v[52:55]
  s_nop 2
  v_mfma_f32_16x16x16_bf16 v[56:59], v[76:77], v[66:67], v[56:59]
  s_nop 7
  v_add_f32 v60, v60, v62
  v_add_f32 v61, v61, v63
  s_branch c_fbr_15
c_fail_16:
  s_endpgm
L_chain_x:
  s_mov_b32 s22, 0
  s_mov_b32 s21, 0
  s_mov_b32 s42, s62
  s_add_u32 s43, s62, 4096
  s_mov_b32 s46, 0
  s_mov_b32 s47, 0
  s_lshl_b32 s26, s16, 2
  s_add_u32 s26, s26, s17
  s_lshl_b32 s27, s60, 13
  s_add_u32 s27, s27, s26
  s_lshr_b32 s25, s27, 2
  s_lshl_b32 s25, s25, 13
  s_add_u32 s25, s25, 192937984
  s_lshr_b32 s64, s27, 2
  s_lshl_b32 s64, s64, 6
  s_add_u32 s64, s64, 513538048
  s_cmp_eq_u32 s17, 3
  s_cselect_b32 s2, 268435456, 0
  s_lshl_b32 s27, s61, 13
  s_add_u32 s27, s27, s26
  s_lshl_b32 s23, s27, 12
  s_add_u32 s23, s23, 41943040
  s_lshl_b32 s63, s27, 5
  s_add_u32 s63, s63, 244318208
  s_mov_b32 s97, 268435456
  s_cmp_eq_u32 s60, 2
  s_cselect_b32 s20, 262144, s97
  s_cselect_b32 s93, 1, 3
  s_lshl_b32 s26, s17, 2
  s_add_u32 s26, s26, s60
  s_cmp_eq_u32 s26, 1
  s_cselect_b32 s97, 245891072, s97
  s_mov_b32 s95, 0
  s_mov_b32 s96, s23
  s_add_u32 s23, s23, 524288
  s_add_u32 s63, s63, 4096
  s_cmp_eq_u32 s66, 0
  s_cbranch_scc1 c_pk_53
  s_sub_u32 s96, s23, 524288
  s_mov_b32 s65, s67
  s_mov_b32 s94, 0
  buffer_load_dwordx4 v0, s[4:7], s96 offen offset:0  lds
  buffer_load_dwordx4 v0, s[4:7], s96 offen offset:1024  lds
  buffer_load_dwordx4 v0, s[4:7], s96 offen offset:2048  lds
  buffer_load_dwordx4 v0, s[4:7], s96 offen offset:3072  lds
  s_branch c_pk2_54
c_pk_53:
  s_mov_b32 s29, 0
  s_sub_u32 s92, s63, 4096
  s_sub_u32 s96, s23, 524288
  s_mov_b32 s95, 0
c_gw_55:
  buffer_load_dword v7, off, s[4:7], s92 sc1
  s_add_u32 s29, s29, 1
  s_cmp_gt_u32 s29, 1048576
  s_cbranch_scc1 c_fail_51
  s_waitcnt vmcnt(0) lgkmcnt(0)
  v_readfirstlane_b32 s65, v7
  s_cmp_eq_u32 s65, 0
  s_cbranch_scc1 c_gw_55
  s_and_b32 s65, s65, s93
  s_cbranch_scc1 c_kvx_57
  s_mov_b32 s95, 1
  s_add_u32 s96, s96, 33554432
  s_add_u32 s92, s92, 262144
c_kvw_56:
  buffer_load_dword v7, off, s[4:7], s92 sc1
  s_add_u32 s29, s29, 1
  s_cmp_gt_u32 s29, 1048576
  s_cbranch_scc1 c_fail_51
  s_waitcnt vmcnt(0) lgkmcnt(0)
  v_readfirstlane_b32 s65, v7
  s_cmp_eq_u32 s65, 0
  s_cbranch_scc1 c_kvw_56
c_kvx_57:
  buffer_load_dword v7, off, s[4:7], s63 sc1
  buffer_load_dwordx4 v0, s[4:7], s96 offen offset:0  lds
  buffer_load_dwordx4 v0, s[4:7], s96 offen offset:1024  lds
  buffer_load_dwordx4 v0, s[4:7], s96 offen offset:2048  lds
  buffer_load_dwordx4 v0, s[4:7], s96 offen offset:3072  lds
  s_waitcnt vmcnt(4)
  v_readfirstlane_b32 s65, v7
  s_mov_b32 s94, 0
c_pk2_54:
  s_waitcnt vmcnt(4)
  ds_read_b128 v[72:75], v1 offset:6144
  ds_read_b128 v[76:79], v1 offset:7168
  ds_read_b128 v[80:83], v1 offset:8192
  ds_read_b128 v[84:87], v1 offset:9216
  ds_read_b128 v[88:91], v1 offset:10240
  ds_read_b128 v[92:95], v1 offset:11264
  ds_read_b128 v[96:99], v1 offset:12288
  ds_read_b128 v[100:103], v1 offset:13312
  ds_read_b128 v[104:107], v1 offset:14336
  ds_read_b128 v[108:111], v1 offset:15360
  ds_read_b128 v[112:115], v1 offset:16384
  ds_read_b128 v[116:119], v1 offset:17408
  ds_read_b128 v[120:123], v1 offset:18432
  ds_read_b128 v[124:127], v1 offset:19456
  v_mov_b64 v[48:49], 0
  v_mov_b64 v[50:51], 0
  v_mov_b64 v[52:53], 0
  v_mov_b64 v[54:55], 0
  v_mov_b64 v[56:57], 0
  v_mov_b64 v[58:59], 0
  v_mov_b64 v[60:61], 0
  v_mov_b64 v[62:63], 0
  v_mov_b64 v[64:65], 0
  v_mov_b64 v[66:67], 0
  v_mov_b64 v[68:69], 0
  v_mov_b64 v[70:71], 0
  s_lshl_b32 s38, s16, 13
  s_add_u32 s38, s38, s40
  s_add_u32 s39, s38, 4096
  ds_read_b128 v[24:27], v1 offset:0
  ds_read_b128 v[28:31], v1 offset:1024
  ds_read_b128 v[32:35], v1 offset:2048
  ds_read_b128 v[36:39], v1 offset:3072
  ds_read_b128 v[40:43], v1 offset:4096
  ds_read_b128 v[44:47], v1 offset:5120
  s_waitcnt lgkmcnt(0)
c_loop_45:
  buffer_load_dwordx4 v[16:19], v8, s[4:7], s42 offen sc1
  buffer_load_dwordx4 v[20:23], v8, s[4:7], s43 offen sc1
  s_mov_b32 s28, 0
  v_mov_b64 v[48:49], 0
  v_mov_b64 v[50:51], 0
  v_mov_b64 v[52:53], 0
  v_mov_b64 v[54:55], 0
  v_mov_b64 v[56:57], 0
  v_mov_b64 v[58:59], 0
  v_mov_b64 v[60:61], 0
  v_mov_b64 v[62:63], 0
  v_mov_b64 v[64:65], 0
  v_mov_b64 v[66:67], 0
  v_mov_b64 v[68:69], 0
  v_mov_b64 v[70:71], 0
  buffer_load_dwordx4 v[16:19], v8, s[4:7], s42 offen sc1
  buffer_load_dwordx4 v[20:23], v8, s[4:7], s43 offen sc1
  s_waitcnt lgkmcnt(0)
  s_and_b32 s29, s65, s93
  s_cbranch_scc0 c_xb_60
c_xr_61:
  s_waitcnt vmcnt(3)
  v_max3_u32 v7, v16, v17, v18
  v_max_u32 v7, v7, v19
  ds_write_b128 v8, v[16:19] offset:4096
  v_smfmac_f32_16x16x64_bf16 v[48:51], v[16:19], v[24:31], v6
  s_waitcnt vmcnt(2)
  v_max3_u32 v7, v20, v21, v7
  v_max3_u32 v7, v22, v23, v7
  ds_write_b128 v8, v[20:23] offset:8192
  v_smfmac_f32_16x16x64_bf16 v[52:55], v[16:19], v[32:39], v6
  v_cmp_eq_u32 vcc, -1, v7
  v_smfmac_f32_16x16x64_bf16 v[56:59], v[16:19], v[40:47], v6
  s_cbranch_vccnz c_retry_46
c_got_47:
  v_smfmac_f32_16x16x64_bf16 v[60:63], v[16:19], v[72:79], v6
  ds_read_b128 v[72:75], v1 offset:20480
  s_and_b32 s65, s65, s93
  s_cselect_b32 s96, s23, 268435456
  v_smfmac_f32_16x16x64_bf16 v[48:51], v[20:23], v[80:87], v6
  ds_read_b128 v[76:79], v1 offset:21504
  v_mov_b32 v7, 1
  v_smfmac_f32_16x16x64_bf16 v[52:55], v[20:23], v[88:95], v6
  ds_read_b128 v[80:83], v1 offset:22528
  v_smfmac_f32_16x16x64_bf16 v[56:59], v[20:23], v[96:103], v6
  ds_read_b128 v[84:87], v1 offset:23552
  s_waitcnt lgkmcnt(4)
  s_barrier
  ds_read_b128 v[24:27], v9 offset:4096
  ds_read_b128 v[28:31], v10 offset:4096
  v_smfmac_f32_16x16x64_bf16 v[60:63], v[20:23], v[104:111], v6
  ds_read_b128 v[32:35], v11 offset:4096
  v_smfmac_f32_16x16x64_bf16 v[64:67], v[16:19], v[112:119], v6
  ds_read_b128 v[36:39], v9 offset:8192
  v_smfmac_f32_16x16x64_bf16 v[68:71], v[16:19], v[120:127], v6
  ds_read_b128 v[40:43], v10 offset:8192
  v_smfmac_f32_16x16x64_bf16 v[64:67], v[20:23], v[208:215], v6
  ds_read_b128 v[44:47], v11 offset:8192
  s_waitcnt lgkmcnt(5)
  v_smfmac_f32_16x16x64_bf16 v[48:51], v[24:27], a[168:175], v6
  buffer_load_dwordx4 v0, s[4:7], s96 offen offset:0  lds
  s_waitcnt lgkmcnt(4)
  v_smfmac_f32_16x16x64_bf16 v[48:51], v[28:31], a[160:167], v6
  ds_read_b128 v[104:107], v8 offset:16384
  s_waitcnt lgkmcnt(4)
  v_smfmac_f32_16x16x64_bf16 v[48:51], v[32:35], a[152:159], v6
  buffer_load_dwordx4 v0, s[4:7], s96 offen offset:1024  lds
  s_waitcnt lgkmcnt(3)
  v_smfmac_f32_16x16x64_bf16 v[48:51], v[36:39], a[144:151], v6
  ds_read_b128 v[108:111], v8 offset:20480
  s_waitcnt lgkmcnt(3)
  v_smfmac_f32_16x16x64_bf16 v[48:51], v[40:43], a[136:143], v6
  buffer_load_dwordx4 v0, s[4:7], s96 offen offset:2048  lds
  s_waitcnt lgkmcnt(2)
  v_smfmac_f32_16x16x64_bf16 v[48:51], v[44:47], a[128:135], v6
  v_smfmac_f32_16x16x64_bf16 v[52:55], v[24:27], a[120:127], v6
  buffer_load_dwordx4 v0, s[4:7], s96 offen offset:3072  lds
  v_smfmac_f32_16x16x64_bf16 v[52:55], v[28:31], a[112:119], v6
  ds_read_b64 v[100:101], v5 offset:4096
  v_add_f32 v48, v48, v50
  v_smfmac_f32_16x16x64_bf16 v[52:55], v[32:35], a[104:111], v6
  ds_read_b128 v[112:115], v8 offset:24576
  v_add_f32 v49, v49, v51
  v_smfmac_f32_16x16x64_bf16 v[52:55], v[36:39], a[96:103], v6
  ds_read_b128 v[116:119], v8 offset:28672
  v_cvt_pk_bf16_f32 v50, v48, v49
  v_smfmac_f32_16x16x64_bf16 v[52:55], v[40:43], a[88:95], v6
  ds_write2_b32 v2, v50, v50 offset0:0 offset1:1
  v_smfmac_f32_16x16x64_bf16 v[52:55], v[44:47], a[80:87], v6
  ds_read_b64_tr_b16 v[88:89], v12 offset:0
  v_smfmac_f32_16x16x64_bf16 v[56:59], v[24:27], a[72:79], v6
  s_mov_b64 exec, 1
  buffer_store_dword v7, off, s[4:7], s64 sc1
  s_mov_b64 exec, -1
  v_smfmac_f32_16x16x64_bf16 v[56:59], v[28:31], a[64:71], v6
  ds_read_b128 v[120:123], v8 offset:32768
  v_add_f32 v52, v52, v54
  v_smfmac_f32_16x16x64_bf16 v[56:59], v[32:35], a[56:63], v6
  ds_read_b128 v[124:127], v8 offset:36864
  v_add_f32 v53, v53, v55
  v_cvt_pk_bf16_f32 v54, v52, v53
  v_smfmac_f32_16x16x64_bf16 v[56:59], v[36:39], a[48:55], v6
  ds_write2_b32 v2, v54, v54 offset0:128 offset1:129
  ds_read_b64_tr_b16 v[90:91], v12 offset:512
  v_smfmac_f32_16x16x64_bf16 v[56:59], v[40:43], a[40:47], v6
  v_smfmac_f32_16x16x64_bf16 v[56:59], v[44:47], a[32:39], v6
  v_smfmac_f32_16x16x64_bf16 v[60:63], v[24:27], a[24:31], v6
  v_smfmac_f32_16x16x64_bf16 v[60:63], v[28:31], a[16:23], v6
  s_waitcnt lgkmcnt(0)
  v_add_f32 v56, v56, v58
  v_mfma_f32_16x16x32_bf16 v[92:95], v[72:75], v[88:91], 0
  buffer_store_dwordx2 v[100:101], v5, s[4:7], s97 offen sc1
  v_add_f32 v57, v57, v59
  v_cvt_pk_bf16_f32 v58, v56, v57
  v_mfma_f32_16x16x32_bf16 v[96:99], v[76:79], v[88:91], 0
  ds_write_b32 v2, v58
  v_smfmac_f32_16x16x64_bf16 v[60:63], v[32:35], a[8:15], v6
  v_mov_b32 v76, 0
  v_smfmac_f32_16x16x64_bf16 v[60:63], v[36:39], a[0:7], v6
  v_cndmask_b32 v48, v92, v96, s[18:19]
  v_smfmac_f32_16x16x64_bf16 v[60:63], v[40:43], v[248:255], v6
  v_cndmask_b32 v49, v93, v97, s[18:19]
  v_smfmac_f32_16x16x64_bf16 v[60:63], v[44:47], v[240:247], v6
  v_cndmask_b32 v50, v94, v98, s[18:19]
  v_smfmac_f32_16x16x64_bf16 v[68:71], v[20:23], v[152:159], v6
  v_cndmask_b32 v51, v95, v99, s[18:19]
  v_smfmac_f32_16x16x64_bf16 v[64:67], v[24:27], v[232:239], v6
  ds_write_b128 v8, v[48:51] offset:12288
  v_add_f32 v60, v60, v62
  v_add_f32 v61, v61, v63
  v_cvt_pk_bf16_f32 v62, v60, v61
  v_smfmac_f32_16x16x64_bf16 v[64:67], v[28:31], v[224:231], v6
  ds_write_b32 v2, v62 offset:512
  s_waitcnt vmcnt(6)
  v_mov_b32 v79, 0
  v_smfmac_f32_16x16x64_bf16 v[64:67], v[32:35], v[216:223], v6
  v_mov_b64 v[20:21], s[14:15]
  v_smfmac_f32_16x16x64_bf16 v[64:67], v[36:39], v[200:207], v6
  v_mov_b64 v[22:23], s[14:15]
  v_smfmac_f32_16x16x64_bf16 v[64:67], v[40:43], v[192:199], v6
  s_waitcnt lgkmcnt(0)
  s_barrier
  ds_read_b128 v[52:55], v9 offset:12288
  ds_read_b128 v[56:59], v10 offset:12288
  v_smfmac_f32_16x16x64_bf16 v[64:67], v[44:47], v[184:191], v6
  ds_read_b128 v[60:63], v11 offset:12288
  v_smfmac_f32_16x16x64_bf16 v[68:71], v[24:27], v[176:183], v6
  ds_read_b64_tr_b16 v[88:89], v12 offset:0
  ds_read_b64_tr_b16 v[90:91], v12 offset:512
  v_smfmac_f32_16x16x64_bf16 v[68:71], v[28:31], v[168:175], v6
  ds_read_b64_tr_b16 v[92:93], v13 offset:0
  ds_read_b64_tr_b16 v[94:95], v13 offset:512
  v_add_f32 v64, v64, v66
  v_smfmac_f32_16x16x64_bf16 v[68:71], v[32:35], v[160:167], v6
  ds_read_b64_tr_b16 v[96:97], v14 offset:0
  ds_read_b64_tr_b16 v[98:99], v14 offset:512
  v_add_f32 v65, v65, v67
  v_smfmac_f32_16x16x64_bf16 v[68:71], v[36:39], v[144:151], v6
  ds_read_b64_tr_b16 v[100:101], v15 offset:0
  ds_read_b64_tr_b16 v[102:103], v15 offset:512
  s_waitcnt lgkmcnt(8)
  v_cvt_pk_bf16_f32 v66, v64, v65
  v_smfmac_f32_16x16x64_bf16 v[68:71], v[40:43], v[136:143], v6
  v_add_f32 v48, v48, v52
  v_smfmac_f32_16x16x64_bf16 v[68:71], v[44:47], v[128:135], v6
  s_waitcnt lgkmcnt(4)
  v_add_f32 v49, v49, v53
  v_mfma_f32_16x16x32_bf16 v[16:19], v[88:91], v[88:91], 0
  buffer_store_dwordx4 v[88:91], v8, s[4:7], s25 offen sc1
  v_add_f32 v50, v50, v54
  v_add_f32 v51, v51, v55
  v_mfma_f32_16x16x32_bf16 v[16:19], v[92:95], v[92:95], v[16:19]
  s_waitcnt lgkmcnt(0)
  v_add_f32 v56, v56, v60
  v_add_f32 v57, v57, v61
  v_mfma_f32_16x16x32_bf16 v[16:19], v[96:99], v[96:99], v[16:19]
  v_add_f32 v58, v58, v62
  v_add_f32 v59, v59, v63
  v_mfma_f32_16x16x32_bf16 v[16:19], v[100:103], v[100:103], v[16:19]
  v_add_f32 v48, v48, v56
  v_add_f32 v49, v49, v57
  v_add_f32 v50, v50, v58
  v_add_f32 v51, v51, v59
  v_exp_f32 v24, v48
  v_exp_f32 v25, v49
  v_exp_f32 v26, v50
  v_exp_f32 v27, v51
  v_cvt_pk_bf16_f32 v24, v24, v25
  v_mul_f32 v16, s24, v16
  v_cvt_pk_bf16_f32 v25, v26, v27
  v_cndmask_b32 v72, v24, 0, s[18:19]
  v_cndmask_b32 v73, v25, 0, s[18:19]
  v_cndmask_b32 v74, 0, v24, s[18:19]
  v_cndmask_b32 v75, 0, v25, s[18:19]
  v_mul_f32 v17, s24, v17
  v_exp_f32 v28, v16
  v_mfma_f32_16x16x32_bf16 v[60:63], v[72:75], v[20:23], 0
  v_exp_f32 v29, v17
  v_add_f32 v68, v68, v70
  v_mfma_f32_16x16x32_bf16 v[52:55], v[72:75], v[80:83], 0
  s_add_u32 s30, s25, 4096
  v_cvt_pk_bf16_f32 v28, v28, v29
  v_add_f32 v69, v69, v71
  v_mfma_f32_16x16x32_bf16 v[56:59], v[72:75], v[84:87], 0
  v_cndmask_b32 v77, 0, v28, s[18:19]
  v_cndmask_b32 v78, 0, v28, s[18:19]
  v_cvt_pk_bf16_f32 v67, v68, v69
  v_lshrrev_b32 v92, 1, v8
  v_mfma_f32_16x16x16_bf16 v[60:63], v[76:77], v[20:21], v[60:63]
  buffer_store_dwordx2 v[66:67], v92, s[4:7], s30 offen sc1
  v_max3_f32 v7, |v48|, |v49|, |v50|
  v_max_f32 v26, |v16|, |v17|
  v_mfma_f32_16x16x16_bf16 v[52:55], v[78:79], v[66:67], v[52:55]
  v_cndmask_b32 v26, 0, v26, s[18:19]
  v_max3_f32 v7, |v51|, v26, v7
  v_mfma_f32_16x16x16_bf16 v[56:59], v[76:77], v[66:67], v[56:59]
  v_cmp_lt_f32 vcc, 0x42700000, v7
  v_mov_b64 v[44:45], 0
  v_add_f32 v60, v60, v62
  v_add_f32 v61, v61, v63
  s_cbranch_vccnz c_fb_49
c_fbr_50:
  v_rcp_f32 v60, v60
  v_rcp_f32 v61, v61
  v_pk_add_f32 v[52:53], v[52:53], v[54:55]
  v_pk_add_f32 v[56:57], v[56:57], v[58:59]
  v_pk_mul_f32 v[52:53], v[52:53], v[60:61]
  v_pk_mul_f32 v[56:57], v[56:57], v[60:61]
  v_cvt_pk_bf16_f32 v54, v52, v53
  v_cvt_pk_bf16_f32 v55, v56, v57
  ds_write_b64 v2, v[54:55] offset:4096
  v_mov_b64 v[46:47], 0
  v_mov_b64 v[40:41], 0
  v_mov_b64 v[42:43], 0
  v_mov_b64 v[36:37], 0
  v_mov_b64 v[38:39], 0
  v_mov_b64 v[32:33], 0
  v_mov_b64 v[34:35], 0
  v_mov_b64 v[28:29], 0
  v_mov_b64 v[30:31], 0
  v_mov_b64 v[24:25], 0
  v_mov_b64 v[26:27], 0
  v_mov_b64 v[80:81], 0
  v_mov_b64 v[82:83], 0
  v_mov_b64 v[84:85], 0
  v_mov_b64 v[86:87], 0
  s_waitcnt lgkmcnt(0)
  s_barrier
  ds_read_b64_tr_b16 v[72:73], v3 offset:4096
  ds_read_b64_tr_b16 v[74:75], v3 offset:5120
  ds_read_b64_tr_b16 v[76:77], v3 offset:6144
  ds_read_b64_tr_b16 v[78:79], v3 offset:7168
  s_and_b32 s3, s21, 1
  s_add_u32 s21, s21, 1
  s_add_u32 s22, s22, 1
  s_and_b32 s42, s21, 3
  s_lshl_b32 s42, s42, 13
  s_cmp_eq_u32 s22, 64
  s_cbranch_scc1 c_last_52
  s_waitcnt lgkmcnt(2)
  v_smfmac_f32_16x16x64_bf16 v[44:47], v[72:75], a[248:255], v6
  s_waitcnt lgkmcnt(0)
  ds_read_b128 v[16:19], v8 offset:40960
  v_smfmac_f32_16x16x64_bf16 v[44:47], v[76:79], a[240:247], v6
  ds_read_b128 v[20:23], v8 offset:45056
  v_smfmac_f32_16x16x64_bf16 v[40:43], v[72:75], a[232:239], v6
  ds_read_b128 v[88:91], v8 offset:49152
  v_smfmac_f32_16x16x64_bf16 v[40:43], v[76:79], a[224:231], v6
  ds_read_b128 v[92:95], v8 offset:53248
  v_add_f32 v44, v44, v46
  v_add_f32 v45, v45, v47
  v_smfmac_f32_16x16x64_bf16 v[36:39], v[72:75], a[216:223], v6
  ds_read_b128 v[96:99], v8 offset:57344
  v_cvt_pk_bf16_f32 v48, v44, v45
  v_and_or_b32 v48, v48, -2, s3
  v_smfmac_f32_16x16x64_bf16 v[36:39], v[76:79], a[208:215], v6
  ds_read_b128 v[100:103], v8 offset:61440
  v_add_f32 v40, v40, v42
  v_add_f32 v41, v41, v43
  v_smfmac_f32_16x16x64_bf16 v[32:35], v[72:75], a[200:207], v6
  v_cvt_pk_bf16_f32 v49, v40, v41
  v_smfmac_f32_16x16x64_bf16 v[32:35], v[76:79], a[192:199], v6
  v_add_f32 v36, v36, v38
  v_add_f32 v37, v37, v39
  v_smfmac_f32_16x16x64_bf16 v[28:31], v[72:75], a[184:191], v6
  v_cvt_pk_bf16_f32 v50, v36, v37
  v_smfmac_f32_16x16x64_bf16 v[28:31], v[76:79], a[176:183], v6
  v_add_f32 v32, v32, v34
  v_add_f32 v33, v33, v35
  v_smfmac_f32_16x16x64_bf16 v[24:27], v[72:75], v[104:111], v6
  v_cvt_pk_bf16_f32 v51, v32, v33
  v_smfmac_f32_16x16x64_bf16 v[24:27], v[76:79], v[112:119], v6
  buffer_store_dwordx4 v[48:51], v4, s[4:7], s40 offen sc1
  v_add_f32 v28, v28, v30
  v_add_f32 v29, v29, v31
  v_smfmac_f32_16x16x64_bf16 v[80:83], v[72:75], v[120:127], v6
  s_waitcnt lgkmcnt(0)
  v_cvt_pk_bf16_f32 v52, v28, v29
  v_and_or_b32 v52, v52, -2, s3
  v_smfmac_f32_16x16x64_bf16 v[80:83], v[76:79], v[16:23], v6
  v_add_f32 v24, v24, v26
  v_add_f32 v25, v25, v27
  v_smfmac_f32_16x16x64_bf16 v[84:87], v[72:75], v[88:95], v6
  v_cvt_pk_bf16_f32 v53, v24, v25
  v_smfmac_f32_16x16x64_bf16 v[84:87], v[76:79], v[96:103], v6
  v_add_f32 v80, v80, v82
  v_add_f32 v81, v81, v83
  v_cvt_pk_bf16_f32 v54, v80, v81
  s_nop 0
  s_nop 3
  v_pk_add_f32 v[84:85], v[84:85], v[86:87]
  v_cvt_pk_bf16_f32 v55, v84, v85
  buffer_store_dwordx4 v[52:55], v4, s[4:7], s41 offen sc1
  s_add_u32 s42, s42, s62
  s_add_u32 s43, s42, 4096
  s_add_u32 s23, s23, 524288
  s_add_u32 s25, s25, 262144
  s_add_u32 s63, s63, 4096
  s_add_u32 s64, s64, 2048
  s_andn2_b32 s64, s64, s2
  s_add_u32 s97, s97, 8192
  s_add_u32 s92, s63, s20
  s_cmp_lg_u32 s17, 0
  s_cbranch_scc1 c_oth_64
  s_mov_b32 s28, 0
  s_add_u32 s46, s46, 1
  v_mov_b64 v[64:65], -1
  s_xor_b32 s34, s42, 16384
  buffer_store_dwordx2 v[64:65], v5, s[4:7], s34 offen sc1
  s_mov_b32 vcc_lo, 0xaaaaaaaa
  s_mov_b32 vcc_hi, 0xaaaaaaaa
  v_mov_b32 v7, 0x3f80
  v_cndmask_b32 v7, v7, 1.0, vcc
  s_mov_b32 vcc_lo, 0x30003
  s_mov_b32 vcc_hi, 0x30003
  v_cndmask_b32 v68, 0, v7, vcc
  s_mov_b32 vcc_lo, 0xc000c
  s_mov_b32 vcc_hi, 0xc000c
  v_cndmask_b32 v69, 0, v7, vcc
  s_mov_b32 vcc_lo, 0x300030
  s_mov_b32 vcc_hi, 0x300030
  v_cndmask_b32 v70, 0, v7, vcc
  s_mov_b32 vcc_lo, 0xc000c0
  s_mov_b32 vcc_hi, 0xc000c0
  v_cndmask_b32 v71, 0, v7, vcc
  ds_read_b128 v[104:107], v1 offset:14336
  ds_read_b128 v[108:111], v1 offset:15360
  s_waitcnt lgkmcnt(0)
  ds_read_b128 v[112:115], v1 offset:16384
  ds_read_b128 v[116:119], v1 offset:17408
  ds_read_b128 v[120:123], v1 offset:18432
  ds_read_b128 v[124:127], v1 offset:19456
  s_waitcnt lgkmcnt(0)
  buffer_load_dwordx4 v[16:19], v0, s[4:7], s38 offen offset:0 sc1
  buffer_load_dwordx4 v[20:23], v0, s[4:7], s38 offen offset:1024 sc1
  buffer_load_dwordx4 v[24:27], v0, s[4:7], s38 offen offset:2048 sc1
  buffer_load_dwordx4 v[28:31], v0, s[4:7], s38 offen offset:3072 sc1
  buffer_load_dwordx4 v[32:35], v0, s[4:7], s39 offen offset:0 sc1
  buffer_load_dwordx4 v[36:39], v0, s[4:7], s39 offen offset:1024 sc1
  buffer_load_dwordx4 v[40:43], v0, s[4:7], s39 offen offset:2048 sc1
  buffer_load_dwordx4 v[44:47], v0, s[4:7], s39 offen offset:3072 sc1
  buffer_load_dwordx4 v[72:75], v0, s[4:7], s38 offen offset:0 sc1
  buffer_load_dwordx4 v[76:79], v0, s[4:7], s38 offen offset:1024 sc1
  buffer_load_dwordx4 v[80:83], v0, s[4:7], s38 offen offset:2048 sc1
  buffer_load_dwordx4 v[84:87], v0, s[4:7], s38 offen offset:3072 sc1
  buffer_load_dwordx4 v[88:91], v0, s[4:7], s39 offen offset:0 sc1
  buffer_load_dwordx4 v[92:95], v0, s[4:7], s39 offen offset:1024 sc1
  buffer_load_dwordx4 v[96:99], v0, s[4:7], s39 offen offset:2048 sc1
  buffer_load_dwordx4 v[100:103], v0, s[4:7], s39 offen offset:3072 sc1
  s_buffer_load_dword s65, s[4:7], s63
  s_waitcnt vmcnt(15)
  v_mfma_f32_16x16x32_bf16 v[64:67], v[16:19], v[68:71], 0
  v_xor_b32 v7, s3, v16
  s_waitcnt vmcnt(14)
  v_mfma_f32_16x16x32_bf16 v[64:67], v[20:23], v[68:71], v[64:67]
  v_bitop3_b32 v7, v7, v20, s3 bitop3:0xf6
  s_waitcnt vmcnt(13)
  v_mfma_f32_16x16x32_bf16 v[64:67], v[24:27], v[68:71], v[64:67]
  v_bitop3_b32 v7, v7, v24, s3 bitop3:0xf6
  s_waitcnt vmcnt(12)
  v_mfma_f32_16x16x32_bf16 v[64:67], v[28:31], v[68:71], v[64:67]
  v_bitop3_b32 v7, v7, v28, s3 bitop3:0xf6
  s_waitcnt vmcnt(11)
  v_mfma_f32_16x16x32_bf16 v[64:67], v[32:35], v[68:71], v[64:67]
  v_bitop3_b32 v7, v7, v32, s3 bitop3:0xf6
  s_waitcnt vmcnt(10)
  v_mfma_f32_16x16x32_bf16 v[64:67], v[36:39], v[68:71], v[64:67]
  v_bitop3_b32 v7, v7, v36, s3 bitop3:0xf6
  s_waitcnt vmcnt(9)
  v_mfma_f32_16x16x32_bf16 v[64:67], v[40:43], v[68:71], v[64:67]
  v_bitop3_b32 v7, v7, v40, s3 bitop3:0xf6
  s_waitcnt vmcnt(8)
  v_mfma_f32_16x16x32_bf16 v[64:67], v[44:47], v[68:71], v[64:67]
  v_bitop3_b32 v7, v7, v44, s3 bitop3:0xf6
  v_and_b32 v7, 1, v7
  v_cmp_ne_u32 vcc, 0, v7
  v_mov_b32 v7, 0
  v_mov_b32 v7, 0
  s_cbranch_vccnz c_p1r_65
c_publ_66:
  s_nop 1
  s_nop 0
  v_cvt_pk_bf16_f32 v64, v64, v65
  v_cvt_pk_bf16_f32 v65, v66, v67
  v_min_u32 v64, -2, v64
  v_min_u32 v65, -2, v65
  buffer_store_dwordx2 v[64:65], v5, s[4:7], s42 offen sc1
  s_waitcnt vmcnt(1)
  ds_read_b128 v[24:27], v1 offset:0
  ds_read_b128 v[28:31], v1 offset:1024
  ds_read_b128 v[32:35], v1 offset:2048
  ds_read_b128 v[36:39], v1 offset:3072
  ds_read_b128 v[40:43], v1 offset:4096
  ds_read_b128 v[44:47], v1 offset:5120
  ds_read_b128 v[72:75], v1 offset:6144
  ds_read_b128 v[76:79], v1 offset:7168
  ds_read_b128 v[80:83], v1 offset:8192
  ds_read_b128 v[84:87], v1 offset:9216
  ds_read_b128 v[88:91], v1 offset:10240
  ds_read_b128 v[92:95], v1 offset:11264
  ds_read_b128 v[96:99], v1 offset:12288
  ds_read_b128 v[100:103], v1 offset:13312
c_hop2_48:
  s_barrier
  s_cmp_le_u32 s96, s23
  s_cbranch_scc1 c_loop_45
  s_cmp_lg_u32 s96, 268435456
  s_cbranch_scc1 c_fk0_67
  buffer_store_dwordx2 v[64:65], v5, s[4:7], s97 offen sc1
  s_mov_b32 s29, 0
  s_sub_u32 s92, s63, 4096
  s_sub_u32 s96, s23, 524288
  s_mov_b32 s95, 0
c_gw_68:
  buffer_load_dword v7, off, s[4:7], s92 sc1
  s_add_u32 s29, s29, 1
  s_cmp_gt_u32 s29, 1048576
  s_cbranch_scc1 c_fail_51
  s_waitcnt vmcnt(0) lgkmcnt(0)
  v_readfirstlane_b32 s65, v7
  s_cmp_eq_u32 s65, 0
  s_cbranch_scc1 c_gw_68
  s_and_b32 s65, s65, s93
  s_cbranch_scc1 c_kvx_70
  s_mov_b32 s95, 1
  s_add_u32 s96, s96, 33554432
  s_add_u32 s92, s92, 262144
c_kvw_69:
  buffer_load_dword v7, off, s[4:7], s92 sc1
  s_add_u32 s29, s29, 1
  s_cmp_gt_u32 s29, 1048576
  s_cbranch_scc1 c_fail_51
  s_waitcnt vmcnt(0) lgkmcnt(0)
  v_readfirstlane_b32 s65, v7
  s_cmp_eq_u32 s65, 0
  s_cbranch_scc1 c_kvw_69
c_kvx_70:
  buffer_load_dword v7, off, s[4:7], s63 sc1
  buffer_load_dwordx4 v0, s[4:7], s96 offen offset:0  lds
  buffer_load_dwordx4 v0, s[4:7], s96 offen offset:1024  lds
  buffer_load_dwordx4 v0, s[4:7], s96 offen offset:2048  lds
  buffer_load_dwordx4 v0, s[4:7], s96 offen offset:3072  lds
  s_waitcnt vmcnt(4)
  v_readfirstlane_b32 s65, v7
  s_mov_b32 s94, 0
  s_cmp_eq_u32 s95, 0
  s_cbranch_scc1 c_loop_45
c_fk0_67:
  s_mov_b32 s29, 0
c_fk_71:
  buffer_load_dwordx4 v[16:19], v8, s[4:7], s42 offen sc1
  buffer_load_dwordx4 v[20:23], v8, s[4:7], s43 offen sc1
  s_add_u32 s29, s29, 1
  s_cmp_gt_u32 s29, 1048576
  s_cbranch_scc1 c_fail_51
  s_waitcnt vmcnt(0)
  v_max3_u32 v7, v16, v17, v18
  v_max3_u32 v7, v19, v20, v7
  v_max3_u32 v7, v21, v22, v7
  v_max_u32 v7, v7, v23
  v_cmp_eq_u32 vcc, -1, v7
  s_cbranch_vccnz c_fk_71
c_fk1_72:
  s_lshl_b32 s42, s22, 13
  s_add_u32 s42, s42, 245891072
  s_add_u32 s43, s42, 4096
  s_mov_b32 s95, 0
  s_branch c_loop_45
c_xb_60:
  s_cmp_lg_u32 s93, 1
  s_cbranch_scc1 c_xr_61
  s_cmp_ge_u32 s22, 63
  s_cbranch_scc1 c_xr_61
c_xp_73:
  s_cmp_lg_u32 s65, 0
  s_cbranch_scc1 c_xs_74
  buffer_load_dword v7, off, s[4:7], s63 sc1
  s_add_u32 s29, s29, 1
  s_cmp_gt_u32 s29, 1048576
  s_cbranch_scc1 c_fail_51
  s_waitcnt vmcnt(0)
  v_readfirstlane_b32 s65, v7
  s_branch c_xp_73
c_xs_74:
  s_cmp_eq_u32 s65, 1
  s_cbranch_scc1 c_xr_61
  s_mov_b32 s29, 0
c_xw_75:
  buffer_load_dwordx4 v[16:19], v8, s[4:7], s42 offen sc1
  buffer_load_dwordx4 v[20:23], v8, s[4:7], s43 offen sc1
  s_add_u32 s29, s29, 1
  s_cmp_gt_u32 s29, 1048576
  s_cbranch_scc1 c_fail_51
  s_waitcnt vmcnt(0)
  v_max3_u32 v7, v16, v17, v18
  v_max3_u32 v7, v19, v20, v7
  v_max3_u32 v7, v21, v22, v7
  v_max_u32 v7, v7, v23
  v_cmp_eq_u32 vcc, -1, v7
  s_cbranch_vccnz c_xw_75
  v_mov_b32 v7, 1
  s_barrier
  s_mov_b64 exec, 1
  buffer_store_dword v7, off, s[4:7], s64 sc1
  s_mov_b64 exec, -1
  s_add_u32 s22, s22, 1
  s_add_u32 s23, s23, 524288
  s_add_u32 s25, s25, 262144
  s_add_u32 s63, s63, 4096
  s_add_u32 s64, s64, 2048
  s_andn2_b32 s64, s64, s2
  s_mov_b32 s29, 0
  s_sub_u32 s92, s63, 4096
  s_sub_u32 s96, s23, 524288
  s_mov_b32 s95, 0
  s_mov_b32 s95, 1
  s_add_u32 s96, s96, 33554432
  s_add_u32 s92, s92, 262144
c_kvw_77:
  buffer_load_dword v7, off, s[4:7], s92 sc1
  s_add_u32 s29, s29, 1
  s_cmp_gt_u32 s29, 1048576
  s_cbranch_scc1 c_fail_51
  s_waitcnt vmcnt(0) lgkmcnt(0)
  v_readfirstlane_b32 s65, v7
  s_cmp_eq_u32 s65, 0
  s_cbranch_scc1 c_kvw_77
c_kvx_78:
  buffer_load_dword v7, off, s[4:7], s63 sc1
  buffer_load_dwordx4 v0, s[4:7], s96 offen offset:0  lds
  buffer_load_dwordx4 v0, s[4:7], s96 offen offset:1024  lds
  buffer_load_dwordx4 v0, s[4:7], s96 offen offset:2048  lds
  buffer_load_dwordx4 v0, s[4:7], s96 offen offset:3072  lds
  s_waitcnt vmcnt(4)
  v_readfirstlane_b32 s65, v7
  s_mov_b32 s94, 0
  s_branch c_fk1_72
c_last_52:
  s_add_u32 s64, s64, 2048
  v_mov_b32 v7, 1
  s_waitcnt vmcnt(0)
  s_barrier
  s_mov_b64 exec, 1
  buffer_store_dword v7, off, s[4:7], s64 sc1
  s_mov_b64 exec, -1
  s_branch L_chdone
c_oth_64:
  s_buffer_load_dword s65, s[4:7], s63
  ds_read_b128 v[24:27], v1 offset:0
  ds_read_b128 v[28:31], v1 offset:1024
  ds_read_b128 v[32:35], v1 offset:2048
  ds_read_b128 v[36:39], v1 offset:3072
  ds_read_b128 v[40:43], v1 offset:4096
  ds_read_b128 v[44:47], v1 offset:5120
  ds_read_b128 v[72:75], v1 offset:6144
  ds_read_b128 v[76:79], v1 offset:7168
  ds_read_b128 v[80:83], v1 offset:8192
  ds_read_b128 v[84:87], v1 offset:9216
  ds_read_b128 v[88:91], v1 offset:10240
  ds_read_b128 v[92:95], v1 offset:11264
  ds_read_b128 v[96:99], v1 offset:12288
  ds_read_b128 v[100:103], v1 offset:13312
  ds_read_b128 v[104:107], v1 offset:14336
  ds_read_b128 v[108:111], v1 offset:15360
  ds_read_b128 v[112:115], v1 offset:16384
  ds_read_b128 v[116:119], v1 offset:17408
  ds_read_b128 v[120:123], v1 offset:18432
  ds_read_b128 v[124:127], v1 offset:19456
  s_branch c_hop2_48
c_p1r_65:
  s_waitcnt vmcnt(7)
  s_nop 0
  v_mfma_f32_16x16x32_bf16 v[64:67], v[72:75], v[68:71], 0
  v_xor_b32 v7, s3, v72
  s_waitcnt vmcnt(6)
  v_mfma_f32_16x16x32_bf16 v[64:67], v[76:79], v[68:71], v[64:67]
  v_bitop3_b32 v7, v7, v76, s3 bitop3:0xf6
  s_waitcnt vmcnt(5)
  v_mfma_f32_16x16x32_bf16 v[64:67], v[80:83], v[68:71], v[64:67]
  v_bitop3_b32 v7, v7, v80, s3 bitop3:0xf6
  s_waitcnt vmcnt(4)
  v_mfma_f32_16x16x32_bf16 v[64:67], v[84:87], v[68:71], v[64:67]
  v_bitop3_b32 v7, v7, v84, s3 bitop3:0xf6
  s_waitcnt vmcnt(3)
  v_mfma_f32_16x16x32_bf16 v[64:67], v[88:91], v[68:71], v[64:67]
  v_bitop3_b32 v7, v7, v88, s3 bitop3:0xf6
  s_waitcnt vmcnt(2)
  v_mfma_f32_16x16x32_bf16 v[64:67], v[92:95], v[68:71], v[64:67]
  v_bitop3_b32 v7, v7, v92, s3 bitop3:0xf6
  s_waitcnt vmcnt(1)
  v_mfma_f32_16x16x32_bf16 v[64:67], v[96:99], v[68:71], v[64:67]
  v_bitop3_b32 v7, v7, v96, s3 bitop3:0xf6
  s_waitcnt vmcnt(0)
  v_mfma_f32_16x16x32_bf16 v[64:67], v[100:103], v[68:71], v[64:67]
  v_bitop3_b32 v7, v7, v100, s3 bitop3:0xf6
  v_and_b32 v7, 1, v7
  v_cmp_ne_u32 vcc, 0, v7
  s_add_u32 s46, s46, 1
  s_cbranch_vccz c_publ_66
  buffer_load_dwordx4 v[72:75], v0, s[4:7], s38 offen offset:0 sc1
  buffer_load_dwordx4 v[76:79], v0, s[4:7], s38 offen offset:1024 sc1
  buffer_load_dwordx4 v[80:83], v0, s[4:7], s38 offen offset:2048 sc1
  buffer_load_dwordx4 v[84:87], v0, s[4:7], s38 offen offset:3072 sc1
  buffer_load_dwordx4 v[88:91], v0, s[4:7], s39 offen offset:0 sc1
  buffer_load_dwordx4 v[92:95], v0, s[4:7], s39 offen offset:1024 sc1
  buffer_load_dwordx4 v[96:99], v0, s[4:7], s39 offen offset:2048 sc1
  buffer_load_dwordx4 v[100:103], v0, s[4:7], s39 offen offset:3072 sc1
  s_add_u32 s28, s28, 1
  s_cmp_gt_u32 s28, 1048576
  s_cbranch_scc0 c_p1r_65
  s_branch c_fail_51
c_retry_46:
  v_mov_b64 v[48:49], 0
  v_mov_b64 v[50:51], 0
  s_nop 0
  v_mov_b64 v[52:53], 0
  v_mov_b64 v[54:55], 0
  s_nop 1
  v_mov_b64 v[56:57], 0
  v_mov_b64 v[58:59], 0
c_rl_79:
  buffer_load_dwordx4 v[16:19], v8, s[4:7], s42 offen sc1
  buffer_load_dwordx4 v[20:23], v8, s[4:7], s43 offen sc1
  s_add_u32 s28, s28, 1
  s_add_u32 s47, s47, 1
  s_cmp_gt_u32 s28, 1048576
  s_cbranch_scc1 c_fail_51
  s_waitcnt vmcnt(2)
  v_max3_u32 v7, v16, v17, v18
  v_max3_u32 v7, v19, v20, v7
  v_max3_u32 v7, v21, v22, v7
  v_max_u32 v7, v7, v23
  v_cmp_eq_u32 vcc, -1, v7
  s_cbranch_vccnz c_rl_79
  ds_write_b128 v8, v[16:19] offset:4096
  v_smfmac_f32_16x16x64_bf16 v[48:51], v[16:19], v[24:31], v6
  ds_write_b128 v8, v[20:23] offset:8192
  v_smfmac_f32_16x16x64_bf16 v[52:55], v[16:19], v[32:39], v6
  v_smfmac_f32_16x16x64_bf16 v[56:59], v[16:19], v[40:47], v6
  s_branch c_got_47
c_fb_49:
  v_max3_f32 v7, v48, v49, v50
  v_max_f32 v7, v51, v7
  s_mov_b64 exec, s[18:19]
  v_max3_f32 v7, v16, v17, v7
  s_mov_b64 exec, -1
  s_nop 0
  v_max_f32_dpp v7, v7, v7 quad_perm:[2,3,0,1] row_mask:0xf bank_mask:0xf
  v_mov_b32 v24, v7
  s_nop 0
  s_nop 0
  v_permlane16_swap_b32 v7, v24
  v_max_f32 v7, v7, v24
  v_mov_b32 v24, v7
  s_nop 0
  s_nop 0
  v_permlane32_swap_b32 v7, v24
  v_max_f32 v7, v7, v24
  v_sub_f32 v24, v48, v7
  v_sub_f32 v25, v49, v7
  v_sub_f32 v26, v50, v7
  v_sub_f32 v27, v51, v7
  v_sub_f32 v28, v16, v7
  v_sub_f32 v29, v17, v7
  v_exp_f32 v24, v24
  v_exp_f32 v25, v25
  v_exp_f32 v26, v26
  v_exp_f32 v27, v27
  v_exp_f32 v28, v28
  v_exp_f32 v29, v29
  v_cvt_pk_bf16_f32 v24, v24, v25
  v_cvt_pk_bf16_f32 v25, v26, v27
  v_cvt_pk_bf16_f32 v28, v28, v29
  v_cndmask_b32 v72, v24, 0, s[18:19]
  v_cndmask_b32 v73, v25, 0, s[18:19]
  v_cndmask_b32 v74, 0, v24, s[18:19]
  v_cndmask_b32 v75, 0, v25, s[18:19]
  v_cndmask_b32 v77, 0, v28, s[18:19]
  v_cndmask_b32 v78, 0, v28, s[18:19]
  v_mfma_f32_16x16x32_bf16 v[60:63], v[72:75], v[20:23], 0
  v_mfma_f32_16x16x32_bf16 v[52:55], v[72:75], v[80:83], 0
  v_mfma_f32_16x16x32_bf16 v[56:59], v[72:75], v[84:87], 0
  v_mfma_f32_16x16x16_bf16 v[60:63], v[76:77], v[20:21], v[60:63]
  v_mfma_f32_16x16x16_bf16 v[52:55], v[78:79], v[66:67], v[52:55]
  s_nop 2
  v_mfma_f32_16x16x16_bf16 v[56:59], v[76:77], v[66:67], v[56:59]
  s_nop 7
  v_add_f32 v60, v60, v62
  v_add_f32 v61, v61, v63
  s_branch c_fbr_50
c_fail_51:
  s_endpgm
L_chdone:
  s_cmp_lg_u32 s91, 0
  s_cbranch_scc1 L_end
  s_lshr_b32 s91, s90, 4
  s_add_u32 s91, s91, 7
  v_lshrrev_b32 v0, 4, v0
  s_waitcnt vmcnt(0) lgkmcnt(0)
  v_mbcnt_lo_u32_b32 v20, -1, 0
  v_and_b32 v20, 3, v20
  v_add_lshl_u32 v20, v20, 0, 2
  s_mov_b32 s26, 0
g_wt_80:
  global_load_dword v21, v20, s[12:13] offset:128 sc1
  s_add_u32 s26, s26, 1
  s_cmp_gt_u32 s26, 1048576
  s_cbranch_scc1 L_end
  s_waitcnt vmcnt(0)
  v_cmp_eq_u32 vcc, 0, v21
  v_readfirstlane_b32 s27, v21
  s_cbranch_vccnz g_wt_80
  s_mov_b32 s89, s27
  s_branch L_o
L_qkv:
  s_mul_i32 s26, s91, 15
  s_add_u32 s26, s26, s90
  s_sub_u32 s26, s26, 61
  s_add_u32 s27, s91, 89
  s_cmp_eq_u32 s90, 31
  s_cselect_b32 s26, s27, s26
  s_add_u32 s27, s90, 60
  s_cmp_eq_u32 s91, 7
  s_cselect_b32 s26, s27, s26
  s_mul_i32 s16, s26, 171
  s_lshr_b32 s16, s16, 9
  s_mul_i32 s27, s16, 3
  s_sub_u32 s60, s26, s27
  s_add_u32 s16, s16, 4
  s_and_b32 s16, s16, 31
  v_and_b32 v19, 63, v0
  v_and_b32 v6, 15, v19
  v_lshrrev_b32 v7, 4, v19
  v_lshlrev_b32 v1, 2, v19
  v_lshlrev_b32 v0, 4, v19
  v_lshlrev_b32 v9, 7, v19
  s_mov_b32 s24, 0x3e0293ee
  s_lshl_b32 s57, s16, 2
  s_add_u32 s57, s57, s17
  v_and_b32 v24, 1, v7
  v_lshlrev_b32 v24, 10, v24
  v_lshl_add_u32 v24, v6, 4, v24
  v_lshrrev_b32 v25, 1, v7
  v_lshl_add_u32 v8, v25, 8, v24
  v_lshrrev_b32 v96, 9, v0
  v_lshlrev_b32 v96, 4, v96
  v_and_b32 v97, 0xf0, v0
  v_xor_b32 v96, v96, v97
  v_and_b32 v97, 0x1f0, v0
  v_lshl_add_u32 v96, v97, 6, v96
  v_xor_b32 v120, 0, v96
  v_xor_b32 v121, 32, v96
  v_xor_b32 v122, 64, v96
  v_xor_b32 v123, 96, v96
  v_xor_b32 v124, 128, v96
  v_xor_b32 v125, 160, v96
  v_xor_b32 v126, 192, v96
  v_xor_b32 v127, 224, v96
  s_and_b32 s26, s17, 1
  s_lshl_b32 s26, s26, 7
  v_xor_b32 v96, s26, v0
  v_xor_b32 v12, 0, v96
  v_xor_b32 v13, 16, v96
  v_xor_b32 v14, 32, v96
  v_xor_b32 v15, 48, v96
  v_xor_b32 v16, 64, v96
  v_xor_b32 v17, 80, v96
  v_xor_b32 v18, 96, v96
  v_xor_b32 v19, 112, v96
  s_lshl_b32 s26, s17, 2
  s_add_u32 s26, s26, 162816
  v_lshrrev_b32 v24, 7, v0
  v_lshl_add_u32 v118, v24, 4, s26
  v_and_b32 v24, 48, v0
  v_add_u32 v119, 162816, v24
  v_lshrrev_b32 v25, 8, v0
  v_and_b32 v20, 0xf0, v0
  v_lshlrev_b32 v21, 6, v25
  v_xor_b32 v20, v20, v21
  v_lshl_add_u32 v20, v25, 13, v20
  v_xor_b32 v21, 32, v20
  s_load_dwordx2 s[64:65], s[0:1], 24
  s_load_dwordx2 s[68:69], s[0:1], 32
  s_load_dwordx2 s[8:9], s[0:1], 16
  s_mov_b32 s10, 4194304
  s_mov_b32 s11, 0x20000
  s_mov_b32 s66, 4194304
  s_mov_b32 s67, 0x20000
  s_mov_b32 s70, 4194304
  s_mov_b32 s71, 0x20000
  v_lshrrev_b32 v25, 2, v6
  v_lshrrev_b32 v26, 1, v7
  v_lshl_add_u32 v27, v26, 3, v25
  v_lshlrev_b32 v27, 8, v27
  v_lshl_add_u32 v26, v25, 1, v26
  v_and_b32 v25, 1, v7
  v_xor_b32 v26, v26, v25
  s_lshl_b32 s26, s17, 1
  v_xor_b32 v26, s26, v26
  v_lshl_add_u32 v27, v26, 5, v27
  v_and_b32 v25, 3, v6
  v_lshl_add_u32 v22, v25, 3, v27
  v_add_u32 v23, 65536, v22
  v_add_u32 v24, 131072, v22
  s_lshl_b32 s28, s17, 13
  s_lshl_b32 s26, s17, 18
  s_lshl_b32 s27, s16, 8
  s_add_u32 s26, s26, s27
  s_waitcnt lgkmcnt(0)
  s_cmp_eq_u32 s60, 1
  s_cbranch_scc1 q_ld_82
  s_cmp_eq_u32 s60, 2
  s_cbranch_scc1 q_ld_83
q_ld_81:
  s_add_u32 s27, s26, 0
  s_add_u32 m0, s28, 0
  s_nop 0
  buffer_load_dwordx4 v20, s[64:67], s27 offen lds
  s_add_u32 m0, s28, 1024
  s_add_u32 s27, s27, 32768
  buffer_load_dwordx4 v20, s[64:67], s27 offen lds
  s_add_u32 m0, s28, 2048
  s_add_u32 s27, s27, 32768
  buffer_load_dwordx4 v21, s[64:67], s27 offen lds
  s_add_u32 m0, s28, 3072
  s_add_u32 s27, s27, 32768
  buffer_load_dwordx4 v21, s[64:67], s27 offen lds
  s_add_u32 m0, s28, 4096
  s_add_u32 s27, s27, 32768
  buffer_load_dwordx4 v20, s[64:67], s27 offen lds
  s_add_u32 m0, s28, 5120
  s_add_u32 s27, s27, 32768
  buffer_load_dwordx4 v20, s[64:67], s27 offen lds
  s_add_u32 m0, s28, 6144
  s_add_u32 s27, s27, 32768
  buffer_load_dwordx4 v21, s[64:67], s27 offen lds
  s_add_u32 m0, s28, 7168
  s_add_u32 s27, s27, 32768
  buffer_load_dwordx4 v21, s[64:67], s27 offen lds
  s_add_u32 s27, s26, 1048576
  s_add_u32 m0, s28, 32768
  s_nop 0
  buffer_load_dwordx4 v20, s[64:67], s27 offen lds
  s_add_u32 m0, s28, 33792
  s_add_u32 s27, s27, 32768
  buffer_load_dwordx4 v20, s[64:67], s27 offen lds
  s_add_u32 m0, s28, 34816
  s_add_u32 s27, s27, 32768
  buffer_load_dwordx4 v21, s[64:67], s27 offen lds
  s_add_u32 m0, s28, 35840
  s_add_u32 s27, s27, 32768
  buffer_load_dwordx4 v21, s[64:67], s27 offen lds
  s_add_u32 m0, s28, 36864
  s_add_u32 s27, s27, 32768
  buffer_load_dwordx4 v20, s[64:67], s27 offen lds
  s_add_u32 m0, s28, 37888
  s_add_u32 s27, s27, 32768
  buffer_load_dwordx4 v20, s[64:67], s27 offen lds
  s_add_u32 m0, s28, 38912
  s_add_u32 s27, s27, 32768
  buffer_load_dwordx4 v21, s[64:67], s27 offen lds
  s_add_u32 m0, s28, 39936
  s_add_u32 s27, s27, 32768
  buffer_load_dwordx4 v21, s[64:67], s27 offen lds
  s_add_u32 s27, s26, 2097152
  s_add_u32 m0, s28, 65536
  s_nop 0
  buffer_load_dwordx4 v20, s[64:67], s27 offen lds
  s_add_u32 m0, s28, 66560
  s_add_u32 s27, s27, 32768
  buffer_load_dwordx4 v20, s[64:67], s27 offen lds
  s_add_u32 m0, s28, 67584
  s_add_u32 s27, s27, 32768
  buffer_load_dwordx4 v21, s[64:67], s27 offen lds
  s_add_u32 m0, s28, 68608
  s_add_u32 s27, s27, 32768
  buffer_load_dwordx4 v21, s[64:67], s27 offen lds
  s_add_u32 m0, s28, 69632
  s_add_u32 s27, s27, 32768
  buffer_load_dwordx4 v20, s[64:67], s27 offen lds
  s_add_u32 m0, s28, 70656
  s_add_u32 s27, s27, 32768
  buffer_load_dwordx4 v20, s[64:67], s27 offen lds
  s_add_u32 m0, s28, 71680
  s_add_u32 s27, s27, 32768
  buffer_load_dwordx4 v21, s[64:67], s27 offen lds
  s_add_u32 m0, s28, 72704
  s_add_u32 s27, s27, 32768
  buffer_load_dwordx4 v21, s[64:67], s27 offen lds
  s_load_dwordx2 s[4:5], s[0:1], 112
  s_load_dwordx2 s[12:13], s[0:1], 104
  s_waitcnt vmcnt(16)
  s_barrier
  s_add_u32 s27, s26, 3145728
  s_add_u32 m0, s28, 98304
  s_nop 0
  buffer_load_dwordx4 v20, s[64:67], s27 offen lds
  s_add_u32 m0, s28, 99328
  s_add_u32 s27, s27, 32768
  buffer_load_dwordx4 v20, s[64:67], s27 offen lds
  s_add_u32 m0, s28, 100352
  s_add_u32 s27, s27, 32768
  buffer_load_dwordx4 v21, s[64:67], s27 offen lds
  s_add_u32 m0, s28, 101376
  s_add_u32 s27, s27, 32768
  buffer_load_dwordx4 v21, s[64:67], s27 offen lds
  s_add_u32 m0, s28, 102400
  s_add_u32 s27, s27, 32768
  buffer_load_dwordx4 v20, s[64:67], s27 offen lds
  s_add_u32 m0, s28, 103424
  s_add_u32 s27, s27, 32768
  buffer_load_dwordx4 v20, s[64:67], s27 offen lds
  s_add_u32 m0, s28, 104448
  s_add_u32 s27, s27, 32768
  buffer_load_dwordx4 v21, s[64:67], s27 offen lds
  s_add_u32 m0, s28, 105472
  s_add_u32 s27, s27, 32768
  buffer_load_dwordx4 v21, s[64:67], s27 offen lds
  ds_read_b64_tr_b16 v[128:129], v22 offset:0
  ds_read_b64_tr_b16 v[130:131], v22 offset:1024
  ds_read_b64_tr_b16 v[132:133], v22 offset:4096
  ds_read_b64_tr_b16 v[134:135], v22 offset:5120
  ds_read_b64_tr_b16 v[136:137], v22 offset:8192
  ds_read_b64_tr_b16 v[138:139], v22 offset:9216
  ds_read_b64_tr_b16 v[140:141], v22 offset:12288
  ds_read_b64_tr_b16 v[142:143], v22 offset:13312
  ds_read_b64_tr_b16 v[144:145], v22 offset:16384
  ds_read_b64_tr_b16 v[146:147], v22 offset:17408
  ds_read_b64_tr_b16 v[148:149], v22 offset:20480
  ds_read_b64_tr_b16 v[150:151], v22 offset:21504
  ds_read_b64_tr_b16 v[152:153], v22 offset:24576
  ds_read_b64_tr_b16 v[154:155], v22 offset:25600
  ds_read_b64_tr_b16 v[156:157], v22 offset:28672
  ds_read_b64_tr_b16 v[158:159], v22 offset:29696
  s_waitcnt lgkmcnt(0)
  s_waitcnt vmcnt(16)
  s_barrier
  s_add_u32 s27, s26, 0
  s_add_u32 m0, s28, 131072
  s_nop 0
  buffer_load_dwordx4 v20, s[68:71], s27 offen lds
  s_add_u32 m0, s28, 132096
  s_add_u32 s27, s27, 32768
  buffer_load_dwordx4 v20, s[68:71], s27 offen lds
  s_add_u32 m0, s28, 133120
  s_add_u32 s27, s27, 32768
  buffer_load_dwordx4 v21, s[68:71], s27 offen lds
  s_add_u32 m0, s28, 134144
  s_add_u32 s27, s27, 32768
  buffer_load_dwordx4 v21, s[68:71], s27 offen lds
  s_add_u32 m0, s28, 135168
  s_add_u32 s27, s27, 32768
  buffer_load_dwordx4 v20, s[68:71], s27 offen lds
  s_add_u32 m0, s28, 136192
  s_add_u32 s27, s27, 32768
  buffer_load_dwordx4 v20, s[68:71], s27 offen lds
  s_add_u32 m0, s28, 137216
  s_add_u32 s27, s27, 32768
  buffer_load_dwordx4 v21, s[68:71], s27 offen lds
  s_add_u32 m0, s28, 138240
  s_add_u32 s27, s27, 32768
  buffer_load_dwordx4 v21, s[68:71], s27 offen lds
  ds_read_b64_tr_b16 v[160:161], v22 offset:32768
  ds_read_b64_tr_b16 v[162:163], v22 offset:33792
  ds_read_b64_tr_b16 v[164:165], v22 offset:36864
  ds_read_b64_tr_b16 v[166:167], v22 offset:37888
  ds_read_b64_tr_b16 v[168:169], v22 offset:40960
  ds_read_b64_tr_b16 v[170:171], v22 offset:41984
  ds_read_b64_tr_b16 v[172:173], v22 offset:45056
  ds_read_b64_tr_b16 v[174:175], v22 offset:46080
  ds_read_b64_tr_b16 v[176:177], v22 offset:49152
  ds_read_b64_tr_b16 v[178:179], v22 offset:50176
  ds_read_b64_tr_b16 v[180:181], v22 offset:53248
  ds_read_b64_tr_b16 v[182:183], v22 offset:54272
  ds_read_b64_tr_b16 v[184:185], v22 offset:57344
  ds_read_b64_tr_b16 v[186:187], v22 offset:58368
  ds_read_b64_tr_b16 v[188:189], v22 offset:61440
  ds_read_b64_tr_b16 v[190:191], v22 offset:62464
  s_waitcnt lgkmcnt(0)
  s_waitcnt vmcnt(16)
  s_barrier
  s_add_u32 s27, s26, 1048576
  s_add_u32 m0, s28, 0
  s_nop 0
  buffer_load_dwordx4 v20, s[68:71], s27 offen lds
  s_add_u32 m0, s28, 1024
  s_add_u32 s27, s27, 32768
  buffer_load_dwordx4 v20, s[68:71], s27 offen lds
  s_add_u32 m0, s28, 2048
  s_add_u32 s27, s27, 32768
  buffer_load_dwordx4 v21, s[68:71], s27 offen lds
  s_add_u32 m0, s28, 3072
  s_add_u32 s27, s27, 32768
  buffer_load_dwordx4 v21, s[68:71], s27 offen lds
  s_add_u32 m0, s28, 4096
  s_add_u32 s27, s27, 32768
  buffer_load_dwordx4 v20, s[68:71], s27 offen lds
  s_add_u32 m0, s28, 5120
  s_add_u32 s27, s27, 32768
  buffer_load_dwordx4 v20, s[68:71], s27 offen lds
  s_add_u32 m0, s28, 6144
  s_add_u32 s27, s27, 32768
  buffer_load_dwordx4 v21, s[68:71], s27 offen lds
  s_add_u32 m0, s28, 7168
  s_add_u32 s27, s27, 32768
  buffer_load_dwordx4 v21, s[68:71], s27 offen lds
  ds_read_b64_tr_b16 v[192:193], v23 offset:0
  ds_read_b64_tr_b16 v[194:195], v23 offset:1024
  ds_read_b64_tr_b16 v[196:197], v23 offset:4096
  ds_read_b64_tr_b16 v[198:199], v23 offset:5120
  ds_read_b64_tr_b16 v[200:201], v23 offset:8192
  ds_read_b64_tr_b16 v[202:203], v23 offset:9216
  ds_read_b64_tr_b16 v[204:205], v23 offset:12288
  ds_read_b64_tr_b16 v[206:207], v23 offset:13312
  ds_read_b64_tr_b16 v[208:209], v23 offset:16384
  ds_read_b64_tr_b16 v[210:211], v23 offset:17408
  ds_read_b64_tr_b16 v[212:213], v23 offset:20480
  ds_read_b64_tr_b16 v[214:215], v23 offset:21504
  ds_read_b64_tr_b16 v[216:217], v23 offset:24576
  ds_read_b64_tr_b16 v[218:219], v23 offset:25600
  ds_read_b64_tr_b16 v[220:221], v23 offset:28672
  ds_read_b64_tr_b16 v[222:223], v23 offset:29696
  s_waitcnt lgkmcnt(0)
  s_waitcnt vmcnt(16)
  s_barrier
  s_add_u32 s27, s26, 2097152
  s_add_u32 m0, s28, 32768
  s_nop 0
  buffer_load_dwordx4 v20, s[68:71], s27 offen lds
  s_add_u32 m0, s28, 33792
  s_add_u32 s27, s27, 32768
  buffer_load_dwordx4 v20, s[68:71], s27 offen lds
  s_add_u32 m0, s28, 34816
  s_add_u32 s27, s27, 32768
  buffer_load_dwordx4 v21, s[68:71], s27 offen lds
  s_add_u32 m0, s28, 35840
  s_add_u32 s27, s27, 32768
  buffer_load_dwordx4 v21, s[68:71], s27 offen lds
  s_add_u32 m0, s28, 36864
  s_add_u32 s27, s27, 32768
  buffer_load_dwordx4 v20, s[68:71], s27 offen lds
  s_add_u32 m0, s28, 37888
  s_add_u32 s27, s27, 32768
  buffer_load_dwordx4 v20, s[68:71], s27 offen lds
  s_add_u32 m0, s28, 38912
  s_add_u32 s27, s27, 32768
  buffer_load_dwordx4 v21, s[68:71], s27 offen lds
  s_add_u32 m0, s28, 39936
  s_add_u32 s27, s27, 32768
  buffer_load_dwordx4 v21, s[68:71], s27 offen lds
  ds_read_b64_tr_b16 v[224:225], v23 offset:32768
  ds_read_b64_tr_b16 v[226:227], v23 offset:33792
  ds_read_b64_tr_b16 v[228:229], v23 offset:36864
  ds_read_b64_tr_b16 v[230:231], v23 offset:37888
  ds_read_b64_tr_b16 v[232:233], v23 offset:40960
  ds_read_b64_tr_b16 v[234:235], v23 offset:41984
  ds_read_b64_tr_b16 v[236:237], v23 offset:45056
  ds_read_b64_tr_b16 v[238:239], v23 offset:46080
  ds_read_b64_tr_b16 v[240:241], v23 offset:49152
  ds_read_b64_tr_b16 v[242:243], v23 offset:50176
  ds_read_b64_tr_b16 v[244:245], v23 offset:53248
  ds_read_b64_tr_b16 v[246:247], v23 offset:54272
  ds_read_b64_tr_b16 v[248:249], v23 offset:57344
  ds_read_b64_tr_b16 v[250:251], v23 offset:58368
  ds_read_b64_tr_b16 v[252:253], v23 offset:61440
  ds_read_b64_tr_b16 v[254:255], v23 offset:62464
  s_waitcnt lgkmcnt(0)
  s_waitcnt vmcnt(16)
  s_barrier
  s_add_u32 s27, s26, 3145728
  s_add_u32 m0, s28, 65536
  s_nop 0
  buffer_load_dwordx4 v20, s[68:71], s27 offen lds
  s_add_u32 m0, s28, 66560
  s_add_u32 s27, s27, 32768
  buffer_load_dwordx4 v20, s[68:71], s27 offen lds
  s_add_u32 m0, s28, 67584
  s_add_u32 s27, s27, 32768
  buffer_load_dwordx4 v21, s[68:71], s27 offen lds
  s_add_u32 m0, s28, 68608
  s_add_u32 s27, s27, 32768
  buffer_load_dwordx4 v21, s[68:71], s27 offen lds
  s_add_u32 m0, s28, 69632
  s_add_u32 s27, s27, 32768
  buffer_load_dwordx4 v20, s[68:71], s27 offen lds
  s_add_u32 m0, s28, 70656
  s_add_u32 s27, s27, 32768
  buffer_load_dwordx4 v20, s[68:71], s27 offen lds
  s_add_u32 m0, s28, 71680
  s_add_u32 s27, s27, 32768
  buffer_load_dwordx4 v21, s[68:71], s27 offen lds
  s_add_u32 m0, s28, 72704
  s_add_u32 s27, s27, 32768
  buffer_load_dwordx4 v21, s[68:71], s27 offen lds
  ds_read_b64_tr_b16 a[0:1], v24 offset:0
  ds_read_b64_tr_b16 a[2:3], v24 offset:1024
  ds_read_b64_tr_b16 a[4:5], v24 offset:4096
  ds_read_b64_tr_b16 a[6:7], v24 offset:5120
  ds_read_b64_tr_b16 a[8:9], v24 offset:8192
  ds_read_b64_tr_b16 a[10:11], v24 offset:9216
  ds_read_b64_tr_b16 a[12:13], v24 offset:12288
  ds_read_b64_tr_b16 a[14:15], v24 offset:13312
  ds_read_b64_tr_b16 a[16:17], v24 offset:16384
  ds_read_b64_tr_b16 a[18:19], v24 offset:17408
  ds_read_b64_tr_b16 a[20:21], v24 offset:20480
  ds_read_b64_tr_b16 a[22:23], v24 offset:21504
  ds_read_b64_tr_b16 a[24:25], v24 offset:24576
  ds_read_b64_tr_b16 a[26:27], v24 offset:25600
  ds_read_b64_tr_b16 a[28:29], v24 offset:28672
  ds_read_b64_tr_b16 a[30:31], v24 offset:29696
  s_waitcnt lgkmcnt(0)
  s_waitcnt vmcnt(16)
  s_barrier
  s_add_u32 s27, s26, 0
  s_add_u32 m0, s28, 98304
  s_nop 0
  buffer_load_dwordx4 v20, s[8:11], s27 offen lds
  s_add_u32 m0, s28, 99328
  s_add_u32 s27, s27, 32768
  buffer_load_dwordx4 v20, s[8:11], s27 offen lds
  s_add_u32 m0, s28, 100352
  s_add_u32 s27, s27, 32768
  buffer_load_dwordx4 v21, s[8:11], s27 offen lds
  s_add_u32 m0, s28, 101376
  s_add_u32 s27, s27, 32768
  buffer_load_dwordx4 v21, s[8:11], s27 offen lds
  s_add_u32 m0, s28, 102400
  s_add_u32 s27, s27, 32768
  buffer_load_dwordx4 v20, s[8:11], s27 offen lds
  s_add_u32 m0, s28, 103424
  s_add_u32 s27, s27, 32768
  buffer_load_dwordx4 v20, s[8:11], s27 offen lds
  s_add_u32 m0, s28, 104448
  s_add_u32 s27, s27, 32768
  buffer_load_dwordx4 v21, s[8:11], s27 offen lds
  s_add_u32 m0, s28, 105472
  s_add_u32 s27, s27, 32768
  buffer_load_dwordx4 v21, s[8:11], s27 offen lds
  ds_read_b64_tr_b16 a[32:33], v22 offset:0
  ds_read_b64_tr_b16 a[34:35], v22 offset:1024
  ds_read_b64_tr_b16 a[36:37], v22 offset:4096
  ds_read_b64_tr_b16 a[38:39], v22 offset:5120
  ds_read_b64_tr_b16 a[40:41], v22 offset:8192
  ds_read_b64_tr_b16 a[42:43], v22 offset:9216
  ds_read_b64_tr_b16 a[44:45], v22 offset:12288
  ds_read_b64_tr_b16 a[46:47], v22 offset:13312
  ds_read_b64_tr_b16 a[48:49], v22 offset:16384
  ds_read_b64_tr_b16 a[50:51], v22 offset:17408
  ds_read_b64_tr_b16 a[52:53], v22 offset:20480
  ds_read_b64_tr_b16 a[54:55], v22 offset:21504
  ds_read_b64_tr_b16 a[56:57], v22 offset:24576
  ds_read_b64_tr_b16 a[58:59], v22 offset:25600
  ds_read_b64_tr_b16 a[60:61], v22 offset:28672
  ds_read_b64_tr_b16 a[62:63], v22 offset:29696
  s_waitcnt lgkmcnt(0)
  s_waitcnt vmcnt(16)
  s_barrier
  s_add_u32 s27, s26, 1048576
  s_add_u32 m0, s28, 131072
  s_nop 0
  buffer_load_dwordx4 v20, s[8:11], s27 offen lds
  s_add_u32 m0, s28, 132096
  s_add_u32 s27, s27, 32768
  buffer_load_dwordx4 v20, s[8:11], s27 offen lds
  s_add_u32 m0, s28, 133120
  s_add_u32 s27, s27, 32768
  buffer_load_dwordx4 v21, s[8:11], s27 offen lds
  s_add_u32 m0, s28, 134144
  s_add_u32 s27, s27, 32768
  buffer_load_dwordx4 v21, s[8:11], s27 offen lds
  s_add_u32 m0, s28, 135168
  s_add_u32 s27, s27, 32768
  buffer_load_dwordx4 v20, s[8:11], s27 offen lds
  s_add_u32 m0, s28, 136192
  s_add_u32 s27, s27, 32768
  buffer_load_dwordx4 v20, s[8:11], s27 offen lds
  s_add_u32 m0, s28, 137216
  s_add_u32 s27, s27, 32768
  buffer_load_dwordx4 v21, s[8:11], s27 offen lds
  s_add_u32 m0, s28, 138240
  s_add_u32 s27, s27, 32768
  buffer_load_dwordx4 v21, s[8:11], s27 offen lds
  ds_read_b64_tr_b16 a[64:65], v22 offset:32768
  ds_read_b64_tr_b16 a[66:67], v22 offset:33792
  ds_read_b64_tr_b16 a[68:69], v22 offset:36864
  ds_read_b64_tr_b16 a[70:71], v22 offset:37888
  ds_read_b64_tr_b16 a[72:73], v22 offset:40960
  ds_read_b64_tr_b16 a[74:75], v22 offset:41984
  ds_read_b64_tr_b16 a[76:77], v22 offset:45056
  ds_read_b64_tr_b16 a[78:79], v22 offset:46080
  ds_read_b64_tr_b16 a[80:81], v22 offset:49152
  ds_read_b64_tr_b16 a[82:83], v22 offset:50176
  ds_read_b64_tr_b16 a[84:85], v22 offset:53248
  ds_read_b64_tr_b16 a[86:87], v22 offset:54272
  ds_read_b64_tr_b16 a[88:89], v22 offset:57344
  ds_read_b64_tr_b16 a[90:91], v22 offset:58368
  ds_read_b64_tr_b16 a[92:93], v22 offset:61440
  ds_read_b64_tr_b16 a[94:95], v22 offset:62464
  s_waitcnt lgkmcnt(0)
  s_waitcnt vmcnt(16)
  s_barrier
  s_add_u32 s27, s26, 2097152
  s_add_u32 m0, s28, 0
  s_nop 0
  buffer_load_dwordx4 v20, s[8:11], s27 offen lds
  s_add_u32 m0, s28, 1024
  s_add_u32 s27, s27, 32768
  buffer_load_dwordx4 v20, s[8:11], s27 offen lds
  s_add_u32 m0, s28, 2048
  s_add_u32 s27, s27, 32768
  buffer_load_dwordx4 v21, s[8:11], s27 offen lds
  s_add_u32 m0, s28, 3072
  s_add_u32 s27, s27, 32768
  buffer_load_dwordx4 v21, s[8:11], s27 offen lds
  s_add_u32 m0, s28, 4096
  s_add_u32 s27, s27, 32768
  buffer_load_dwordx4 v20, s[8:11], s27 offen lds
  s_add_u32 m0, s28, 5120
  s_add_u32 s27, s27, 32768
  buffer_load_dwordx4 v20, s[8:11], s27 offen lds
  s_add_u32 m0, s28, 6144
  s_add_u32 s27, s27, 32768
  buffer_load_dwordx4 v21, s[8:11], s27 offen lds
  s_add_u32 m0, s28, 7168
  s_add_u32 s27, s27, 32768
  buffer_load_dwordx4 v21, s[8:11], s27 offen lds
  ds_read_b64_tr_b16 a[96:97], v23 offset:0
  ds_read_b64_tr_b16 a[98:99], v23 offset:1024
  ds_read_b64_tr_b16 a[100:101], v23 offset:4096
  ds_read_b64_tr_b16 a[102:103], v23 offset:5120
  ds_read_b64_tr_b16 a[104:105], v23 offset:8192
  ds_read_b64_tr_b16 a[106:107], v23 offset:9216
  ds_read_b64_tr_b16 a[108:109], v23 offset:12288
  ds_read_b64_tr_b16 a[110:111], v23 offset:13312
  ds_read_b64_tr_b16 a[112:113], v23 offset:16384
  ds_read_b64_tr_b16 a[114:115], v23 offset:17408
  ds_read_b64_tr_b16 a[116:117], v23 offset:20480
  ds_read_b64_tr_b16 a[118:119], v23 offset:21504
  ds_read_b64_tr_b16 a[120:121], v23 offset:24576
  ds_read_b64_tr_b16 a[122:123], v23 offset:25600
  ds_read_b64_tr_b16 a[124:125], v23 offset:28672
  ds_read_b64_tr_b16 a[126:127], v23 offset:29696
  s_waitcnt lgkmcnt(0)
  s_waitcnt vmcnt(16)
  s_barrier
  s_add_u32 s27, s26, 3145728
  s_add_u32 m0, s28, 32768
  s_nop 0
  buffer_load_dwordx4 v20, s[8:11], s27 offen lds
  s_add_u32 m0, s28, 33792
  s_add_u32 s27, s27, 32768
  buffer_load_dwordx4 v20, s[8:11], s27 offen lds
  s_add_u32 m0, s28, 34816
  s_add_u32 s27, s27, 32768
  buffer_load_dwordx4 v21, s[8:11], s27 offen lds
  s_add_u32 m0, s28, 35840
  s_add_u32 s27, s27, 32768
  buffer_load_dwordx4 v21, s[8:11], s27 offen lds
  s_add_u32 m0, s28, 36864
  s_add_u32 s27, s27, 32768
  buffer_load_dwordx4 v20, s[8:11], s27 offen lds
  s_add_u32 m0, s28, 37888
  s_add_u32 s27, s27, 32768
  buffer_load_dwordx4 v20, s[8:11], s27 offen lds
  s_add_u32 m0, s28, 38912
  s_add_u32 s27, s27, 32768
  buffer_load_dwordx4 v21, s[8:11], s27 offen lds
  s_add_u32 m0, s28, 39936
  s_add_u32 s27, s27, 32768
  buffer_load_dwordx4 v21, s[8:11], s27 offen lds
  ds_read_b64_tr_b16 a[128:129], v23 offset:32768
  ds_read_b64_tr_b16 a[130:131], v23 offset:33792
  ds_read_b64_tr_b16 a[132:133], v23 offset:36864
  ds_read_b64_tr_b16 a[134:135], v23 offset:37888
  ds_read_b64_tr_b16 a[136:137], v23 offset:40960
  ds_read_b64_tr_b16 a[138:139], v23 offset:41984
  ds_read_b64_tr_b16 a[140:141], v23 offset:45056
  ds_read_b64_tr_b16 a[142:143], v23 offset:46080
  ds_read_b64_tr_b16 a[144:145], v23 offset:49152
  ds_read_b64_tr_b16 a[146:147], v23 offset:50176
  ds_read_b64_tr_b16 a[148:149], v23 offset:53248
  ds_read_b64_tr_b16 a[150:151], v23 offset:54272
  ds_read_b64_tr_b16 a[152:153], v23 offset:57344
  ds_read_b64_tr_b16 a[154:155], v23 offset:58368
  ds_read_b64_tr_b16 a[156:157], v23 offset:61440
  ds_read_b64_tr_b16 a[158:159], v23 offset:62464
  s_waitcnt lgkmcnt(0)
  s_waitcnt vmcnt(16)
  s_barrier
  ds_read_b64_tr_b16 a[160:161], v24 offset:0
  ds_read_b64_tr_b16 a[162:163], v24 offset:1024
  ds_read_b64_tr_b16 a[164:165], v24 offset:4096
  ds_read_b64_tr_b16 a[166:167], v24 offset:5120
  ds_read_b64_tr_b16 a[168:169], v24 offset:8192
  ds_read_b64_tr_b16 a[170:171], v24 offset:9216
  ds_read_b64_tr_b16 a[172:173], v24 offset:12288
  ds_read_b64_tr_b16 a[174:175], v24 offset:13312
  ds_read_b64_tr_b16 a[176:177], v24 offset:16384
  ds_read_b64_tr_b16 a[178:179], v24 offset:17408
  ds_read_b64_tr_b16 a[180:181], v24 offset:20480
  ds_read_b64_tr_b16 a[182:183], v24 offset:21504
  ds_read_b64_tr_b16 a[184:185], v24 offset:24576
  ds_read_b64_tr_b16 a[186:187], v24 offset:25600
  ds_read_b64_tr_b16 a[188:189], v24 offset:28672
  ds_read_b64_tr_b16 a[190:191], v24 offset:29696
  s_waitcnt lgkmcnt(0)
  s_waitcnt vmcnt(8)
  s_barrier
  ds_read_b64_tr_b16 a[192:193], v22 offset:0
  ds_read_b64_tr_b16 a[194:195], v22 offset:1024
  ds_read_b64_tr_b16 a[196:197], v22 offset:4096
  ds_read_b64_tr_b16 a[198:199], v22 offset:5120
  ds_read_b64_tr_b16 a[200:201], v22 offset:8192
  ds_read_b64_tr_b16 a[202:203], v22 offset:9216
  ds_read_b64_tr_b16 a[204:205], v22 offset:12288
  ds_read_b64_tr_b16 a[206:207], v22 offset:13312
  ds_read_b64_tr_b16 a[208:209], v22 offset:16384
  ds_read_b64_tr_b16 a[210:211], v22 offset:17408
  ds_read_b64_tr_b16 a[212:213], v22 offset:20480
  ds_read_b64_tr_b16 a[214:215], v22 offset:21504
  ds_read_b64_tr_b16 a[216:217], v22 offset:24576
  ds_read_b64_tr_b16 a[218:219], v22 offset:25600
  ds_read_b64_tr_b16 a[220:221], v22 offset:28672
  ds_read_b64_tr_b16 a[222:223], v22 offset:29696
  s_waitcnt lgkmcnt(0)
  s_waitcnt vmcnt(0)
  s_barrier
  ds_read_b64_tr_b16 a[224:225], v22 offset:32768
  ds_read_b64_tr_b16 a[226:227], v22 offset:33792
  ds_read_b64_tr_b16 a[228:229], v22 offset:36864
  ds_read_b64_tr_b16 a[230:231], v22 offset:37888
  ds_read_b64_tr_b16 a[232:233], v22 offset:40960
  ds_read_b64_tr_b16 a[234:235], v22 offset:41984
  ds_read_b64_tr_b16 a[236:237], v22 offset:45056
  ds_read_b64_tr_b16 a[238:239], v22 offset:46080
  ds_read_b64_tr_b16 a[240:241], v22 offset:49152
  ds_read_b64_tr_b16 a[242:243], v22 offset:50176
  ds_read_b64_tr_b16 a[244:245], v22 offset:53248
  ds_read_b64_tr_b16 a[246:247], v22 offset:54272
  ds_read_b64_tr_b16 a[248:249], v22 offset:57344
  ds_read_b64_tr_b16 a[250:251], v22 offset:58368
  ds_read_b64_tr_b16 a[252:253], v22 offset:61440
  ds_read_b64_tr_b16 a[254:255], v22 offset:62464
  s_waitcnt lgkmcnt(0)
  s_branch q_ld_84
q_ld_82:
  s_add_u32 s27, s26, 0
  s_add_u32 m0, s28, 0
  s_nop 0
  buffer_load_dwordx4 v20, s[68:71], s27 offen lds
  s_add_u32 m0, s28, 1024
  s_add_u32 s27, s27, 32768
  buffer_load_dwordx4 v20, s[68:71], s27 offen lds
  s_add_u32 m0, s28, 2048
  s_add_u32 s27, s27, 32768
  buffer_load_dwordx4 v21, s[68:71], s27 offen lds
  s_add_u32 m0, s28, 3072
  s_add_u32 s27, s27, 32768
  buffer_load_dwordx4 v21, s[68:71], s27 offen lds
  s_add_u32 m0, s28, 4096
  s_add_u32 s27, s27, 32768
  buffer_load_dwordx4 v20, s[68:71], s27 offen lds
  s_add_u32 m0, s28, 5120
  s_add_u32 s27, s27, 32768
  buffer_load_dwordx4 v20, s[68:71], s27 offen lds
  s_add_u32 m0, s28, 6144
  s_add_u32 s27, s27, 32768
  buffer_load_dwordx4 v21, s[68:71], s27 offen lds
  s_add_u32 m0, s28, 7168
  s_add_u32 s27, s27, 32768
  buffer_load_dwordx4 v21, s[68:71], s27 offen lds
  s_add_u32 s27, s26, 1048576
  s_add_u32 m0, s28, 32768
  s_nop 0
  buffer_load_dwordx4 v20, s[68:71], s27 offen lds
  s_add_u32 m0, s28, 33792
  s_add_u32 s27, s27, 32768
  buffer_load_dwordx4 v20, s[68:71], s27 offen lds
  s_add_u32 m0, s28, 34816
  s_add_u32 s27, s27, 32768
  buffer_load_dwordx4 v21, s[68:71], s27 offen lds
  s_add_u32 m0, s28, 35840
  s_add_u32 s27, s27, 32768
  buffer_load_dwordx4 v21, s[68:71], s27 offen lds
  s_add_u32 m0, s28, 36864
  s_add_u32 s27, s27, 32768
  buffer_load_dwordx4 v20, s[68:71], s27 offen lds
  s_add_u32 m0, s28, 37888
  s_add_u32 s27, s27, 32768
  buffer_load_dwordx4 v20, s[68:71], s27 offen lds
  s_add_u32 m0, s28, 38912
  s_add_u32 s27, s27, 32768
  buffer_load_dwordx4 v21, s[68:71], s27 offen lds
  s_add_u32 m0, s28, 39936
  s_add_u32 s27, s27, 32768
  buffer_load_dwordx4 v21, s[68:71], s27 offen lds
  s_add_u32 s27, s26, 2097152
  s_add_u32 m0, s28, 65536
  s_nop 0
  buffer_load_dwordx4 v20, s[68:71], s27 offen lds
  s_add_u32 m0, s28, 66560
  s_add_u32 s27, s27, 32768
  buffer_load_dwordx4 v20, s[68:71], s27 offen lds
  s_add_u32 m0, s28, 67584
  s_add_u32 s27, s27, 32768
  buffer_load_dwordx4 v21, s[68:71], s27 offen lds
  s_add_u32 m0, s28, 68608
  s_add_u32 s27, s27, 32768
  buffer_load_dwordx4 v21, s[68:71], s27 offen lds
  s_add_u32 m0, s28, 69632
  s_add_u32 s27, s27, 32768
  buffer_load_dwordx4 v20, s[68:71], s27 offen lds
  s_add_u32 m0, s28, 70656
  s_add_u32 s27, s27, 32768
  buffer_load_dwordx4 v20, s[68:71], s27 offen lds
  s_add_u32 m0, s28, 71680
  s_add_u32 s27, s27, 32768
  buffer_load_dwordx4 v21, s[68:71], s27 offen lds
  s_add_u32 m0, s28, 72704
  s_add_u32 s27, s27, 32768
  buffer_load_dwordx4 v21, s[68:71], s27 offen lds
  s_load_dwordx2 s[4:5], s[0:1], 112
  s_load_dwordx2 s[12:13], s[0:1], 104
  s_waitcnt vmcnt(16)
  s_barrier
  s_add_u32 s27, s26, 3145728
  s_add_u32 m0, s28, 98304
  s_nop 0
  buffer_load_dwordx4 v20, s[68:71], s27 offen lds
  s_add_u32 m0, s28, 99328
  s_add_u32 s27, s27, 32768
  buffer_load_dwordx4 v20, s[68:71], s27 offen lds
  s_add_u32 m0, s28, 100352
  s_add_u32 s27, s27, 32768
  buffer_load_dwordx4 v21, s[68:71], s27 offen lds
  s_add_u32 m0, s28, 101376
  s_add_u32 s27, s27, 32768
  buffer_load_dwordx4 v21, s[68:71], s27 offen lds
  s_add_u32 m0, s28, 102400
  s_add_u32 s27, s27, 32768
  buffer_load_dwordx4 v20, s[68:71], s27 offen lds
  s_add_u32 m0, s28, 103424
  s_add_u32 s27, s27, 32768
  buffer_load_dwordx4 v20, s[68:71], s27 offen lds
  s_add_u32 m0, s28, 104448
  s_add_u32 s27, s27, 32768
  buffer_load_dwordx4 v21, s[68:71], s27 offen lds
  s_add_u32 m0, s28, 105472
  s_add_u32 s27, s27, 32768
  buffer_load_dwordx4 v21, s[68:71], s27 offen lds
  ds_read_b64_tr_b16 a[0:1], v22 offset:0
  ds_read_b64_tr_b16 a[2:3], v22 offset:1024
  ds_read_b64_tr_b16 a[4:5], v22 offset:4096
  ds_read_b64_tr_b16 a[6:7], v22 offset:5120
  ds_read_b64_tr_b16 a[8:9], v22 offset:8192
  ds_read_b64_tr_b16 a[10:11], v22 offset:9216
  ds_read_b64_tr_b16 a[12:13], v22 offset:12288
  ds_read_b64_tr_b16 a[14:15], v22 offset:13312
  ds_read_b64_tr_b16 a[16:17], v22 offset:16384
  ds_read_b64_tr_b16 a[18:19], v22 offset:17408
  ds_read_b64_tr_b16 a[20:21], v22 offset:20480
  ds_read_b64_tr_b16 a[22:23], v22 offset:21504
  ds_read_b64_tr_b16 a[24:25], v22 offset:24576
  ds_read_b64_tr_b16 a[26:27], v22 offset:25600
  ds_read_b64_tr_b16 a[28:29], v22 offset:28672
  ds_read_b64_tr_b16 a[30:31], v22 offset:29696
  s_waitcnt lgkmcnt(0)
  s_waitcnt vmcnt(16)
  s_barrier
  s_add_u32 s27, s26, 0
  s_add_u32 m0, s28, 131072
  s_nop 0
  buffer_load_dwordx4 v20, s[8:11], s27 offen lds
  s_add_u32 m0, s28, 132096
  s_add_u32 s27, s27, 32768
  buffer_load_dwordx4 v20, s[8:11], s27 offen lds
  s_add_u32 m0, s28, 133120
  s_add_u32 s27, s27, 32768
  buffer_load_dwordx4 v21, s[8:11], s27 offen lds
  s_add_u32 m0, s28, 134144
  s_add_u32 s27, s27, 32768
  buffer_load_dwordx4 v21, s[8:11], s27 offen lds
  s_add_u32 m0, s28, 135168
  s_add_u32 s27, s27, 32768
  buffer_load_dwordx4 v20, s[8:11], s27 offen lds
  s_add_u32 m0, s28, 136192
  s_add_u32 s27, s27, 32768
  buffer_load_dwordx4 v20, s[8:11], s27 offen lds
  s_add_u32 m0, s28, 137216
  s_add_u32 s27, s27, 32768
  buffer_load_dwordx4 v21, s[8:11], s27 offen lds
  s_add_u32 m0, s28, 138240
  s_add_u32 s27, s27, 32768
  buffer_load_dwordx4 v21, s[8:11], s27 offen lds
  ds_read_b64_tr_b16 a[32:33], v22 offset:32768
  ds_read_b64_tr_b16 a[34:35], v22 offset:33792
  ds_read_b64_tr_b16 a[36:37], v22 offset:36864
  ds_read_b64_tr_b16 a[38:39], v22 offset:37888
  ds_read_b64_tr_b16 a[40:41], v22 offset:40960
  ds_read_b64_tr_b16 a[42:43], v22 offset:41984
  ds_read_b64_tr_b16 a[44:45], v22 offset:45056
  ds_read_b64_tr_b16 a[46:47], v22 offset:46080
  ds_read_b64_tr_b16 a[48:49], v22 offset:49152
  ds_read_b64_tr_b16 a[50:51], v22 offset:50176
  ds_read_b64_tr_b16 a[52:53], v22 offset:53248
  ds_read_b64_tr_b16 a[54:55], v22 offset:54272
  ds_read_b64_tr_b16 a[56:57], v22 offset:57344
  ds_read_b64_tr_b16 a[58:59], v22 offset:58368
  ds_read_b64_tr_b16 a[60:61], v22 offset:61440
  ds_read_b64_tr_b16 a[62:63], v22 offset:62464
  s_waitcnt lgkmcnt(0)
  s_waitcnt vmcnt(16)
  s_barrier
  s_add_u32 s27, s26, 1048576
  s_add_u32 m0, s28, 0
  s_nop 0
  buffer_load_dwordx4 v20, s[8:11], s27 offen lds
  s_add_u32 m0, s28, 1024
  s_add_u32 s27, s27, 32768
  buffer_load_dwordx4 v20, s[8:11], s27 offen lds
  s_add_u32 m0, s28, 2048
  s_add_u32 s27, s27, 32768
  buffer_load_dwordx4 v21, s[8:11], s27 offen lds
  s_add_u32 m0, s28, 3072
  s_add_u32 s27, s27, 32768
  buffer_load_dwordx4 v21, s[8:11], s27 offen lds
  s_add_u32 m0, s28, 4096
  s_add_u32 s27, s27, 32768
  buffer_load_dwordx4 v20, s[8:11], s27 offen lds
  s_add_u32 m0, s28, 5120
  s_add_u32 s27, s27, 32768
  buffer_load_dwordx4 v20, s[8:11], s27 offen lds
  s_add_u32 m0, s28, 6144
  s_add_u32 s27, s27, 32768
  buffer_load_dwordx4 v21, s[8:11], s27 offen lds
  s_add_u32 m0, s28, 7168
  s_add_u32 s27, s27, 32768
  buffer_load_dwordx4 v21, s[8:11], s27 offen lds
  ds_read_b64_tr_b16 a[64:65], v23 offset:0
  ds_read_b64_tr_b16 a[66:67], v23 offset:1024
  ds_read_b64_tr_b16 a[68:69], v23 offset:4096
  ds_read_b64_tr_b16 a[70:71], v23 offset:5120
  ds_read_b64_tr_b16 a[72:73], v23 offset:8192
  ds_read_b64_tr_b16 a[74:75], v23 offset:9216
  ds_read_b64_tr_b16 a[76:77], v23 offset:12288
  ds_read_b64_tr_b16 a[78:79], v23 offset:13312
  ds_read_b64_tr_b16 a[80:81], v23 offset:16384
  ds_read_b64_tr_b16 a[82:83], v23 offset:17408
  ds_read_b64_tr_b16 a[84:85], v23 offset:20480
  ds_read_b64_tr_b16 a[86:87], v23 offset:21504
  ds_read_b64_tr_b16 a[88:89], v23 offset:24576
  ds_read_b64_tr_b16 a[90:91], v23 offset:25600
  ds_read_b64_tr_b16 a[92:93], v23 offset:28672
  ds_read_b64_tr_b16 a[94:95], v23 offset:29696
  s_waitcnt lgkmcnt(0)
  s_waitcnt vmcnt(16)
  s_barrier
  s_add_u32 s27, s26, 2097152
  s_add_u32 m0, s28, 32768
  s_nop 0
  buffer_load_dwordx4 v20, s[8:11], s27 offen lds
  s_add_u32 m0, s28, 33792
  s_add_u32 s27, s27, 32768
  buffer_load_dwordx4 v20, s[8:11], s27 offen lds
  s_add_u32 m0, s28, 34816
  s_add_u32 s27, s27, 32768
  buffer_load_dwordx4 v21, s[8:11], s27 offen lds
  s_add_u32 m0, s28, 35840
  s_add_u32 s27, s27, 32768
  buffer_load_dwordx4 v21, s[8:11], s27 offen lds
  s_add_u32 m0, s28, 36864
  s_add_u32 s27, s27, 32768
  buffer_load_dwordx4 v20, s[8:11], s27 offen lds
  s_add_u32 m0, s28, 37888
  s_add_u32 s27, s27, 32768
  buffer_load_dwordx4 v20, s[8:11], s27 offen lds
  s_add_u32 m0, s28, 38912
  s_add_u32 s27, s27, 32768
  buffer_load_dwordx4 v21, s[8:11], s27 offen lds
  s_add_u32 m0, s28, 39936
  s_add_u32 s27, s27, 32768
  buffer_load_dwordx4 v21, s[8:11], s27 offen lds
  ds_read_b64_tr_b16 a[96:97], v23 offset:32768
  ds_read_b64_tr_b16 a[98:99], v23 offset:33792
  ds_read_b64_tr_b16 a[100:101], v23 offset:36864
  ds_read_b64_tr_b16 a[102:103], v23 offset:37888
  ds_read_b64_tr_b16 a[104:105], v23 offset:40960
  ds_read_b64_tr_b16 a[106:107], v23 offset:41984
  ds_read_b64_tr_b16 a[108:109], v23 offset:45056
  ds_read_b64_tr_b16 a[110:111], v23 offset:46080
  ds_read_b64_tr_b16 a[112:113], v23 offset:49152
  ds_read_b64_tr_b16 a[114:115], v23 offset:50176
  ds_read_b64_tr_b16 a[116:117], v23 offset:53248
  ds_read_b64_tr_b16 a[118:119], v23 offset:54272
  ds_read_b64_tr_b16 a[120:121], v23 offset:57344
  ds_read_b64_tr_b16 a[122:123], v23 offset:58368
  ds_read_b64_tr_b16 a[124:125], v23 offset:61440
  ds_read_b64_tr_b16 a[126:127], v23 offset:62464
  s_waitcnt lgkmcnt(0)
  s_waitcnt vmcnt(16)
  s_barrier
  s_add_u32 s27, s26, 3145728
  s_add_u32 m0, s28, 65536
  s_nop 0
  buffer_load_dwordx4 v20, s[8:11], s27 offen lds
  s_add_u32 m0, s28, 66560
  s_add_u32 s27, s27, 32768
  buffer_load_dwordx4 v20, s[8:11], s27 offen lds
  s_add_u32 m0, s28, 67584
  s_add_u32 s27, s27, 32768
  buffer_load_dwordx4 v21, s[8:11], s27 offen lds
  s_add_u32 m0, s28, 68608
  s_add_u32 s27, s27, 32768
  buffer_load_dwordx4 v21, s[8:11], s27 offen lds
  s_add_u32 m0, s28, 69632
  s_add_u32 s27, s27, 32768
  buffer_load_dwordx4 v20, s[8:11], s27 offen lds
  s_add_u32 m0, s28, 70656
  s_add_u32 s27, s27, 32768
  buffer_load_dwordx4 v20, s[8:11], s27 offen lds
  s_add_u32 m0, s28, 71680
  s_add_u32 s27, s27, 32768
  buffer_load_dwordx4 v21, s[8:11], s27 offen lds
  s_add_u32 m0, s28, 72704
  s_add_u32 s27, s27, 32768
  buffer_load_dwordx4 v21, s[8:11], s27 offen lds
  ds_read_b64_tr_b16 a[128:129], v24 offset:0
  ds_read_b64_tr_b16 a[130:131], v24 offset:1024
  ds_read_b64_tr_b16 a[132:133], v24 offset:4096
  ds_read_b64_tr_b16 a[134:135], v24 offset:5120
  ds_read_b64_tr_b16 a[136:137], v24 offset:8192
  ds_read_b64_tr_b16 a[138:139], v24 offset:9216
  ds_read_b64_tr_b16 a[140:141], v24 offset:12288
  ds_read_b64_tr_b16 a[142:143], v24 offset:13312
  ds_read_b64_tr_b16 a[144:145], v24 offset:16384
  ds_read_b64_tr_b16 a[146:147], v24 offset:17408
  ds_read_b64_tr_b16 a[148:149], v24 offset:20480
  ds_read_b64_tr_b16 a[150:151], v24 offset:21504
  ds_read_b64_tr_b16 a[152:153], v24 offset:24576
  ds_read_b64_tr_b16 a[154:155], v24 offset:25600
  ds_read_b64_tr_b16 a[156:157], v24 offset:28672
  ds_read_b64_tr_b16 a[158:159], v24 offset:29696
  s_waitcnt lgkmcnt(0)
  s_waitcnt vmcnt(16)
  s_barrier
  s_add_u32 s27, s26, 0
  s_add_u32 m0, s28, 98304
  s_nop 0
  buffer_load_dwordx4 v20, s[64:67], s27 offen lds
  s_add_u32 m0, s28, 99328
  s_add_u32 s27, s27, 32768
  buffer_load_dwordx4 v20, s[64:67], s27 offen lds
  s_add_u32 m0, s28, 100352
  s_add_u32 s27, s27, 32768
  buffer_load_dwordx4 v21, s[64:67], s27 offen lds
  s_add_u32 m0, s28, 101376
  s_add_u32 s27, s27, 32768
  buffer_load_dwordx4 v21, s[64:67], s27 offen lds
  s_add_u32 m0, s28, 102400
  s_add_u32 s27, s27, 32768
  buffer_load_dwordx4 v20, s[64:67], s27 offen lds
  s_add_u32 m0, s28, 103424
  s_add_u32 s27, s27, 32768
  buffer_load_dwordx4 v20, s[64:67], s27 offen lds
  s_add_u32 m0, s28, 104448
  s_add_u32 s27, s27, 32768
  buffer_load_dwordx4 v21, s[64:67], s27 offen lds
  s_add_u32 m0, s28, 105472
  s_add_u32 s27, s27, 32768
  buffer_load_dwordx4 v21, s[64:67], s27 offen lds
  ds_read_b64_tr_b16 a[160:161], v22 offset:0
  ds_read_b64_tr_b16 a[162:163], v22 offset:1024
  ds_read_b64_tr_b16 a[164:165], v22 offset:4096
  ds_read_b64_tr_b16 a[166:167], v22 offset:5120
  ds_read_b64_tr_b16 a[168:169], v22 offset:8192
  ds_read_b64_tr_b16 a[170:171], v22 offset:9216
  ds_read_b64_tr_b16 a[172:173], v22 offset:12288
  ds_read_b64_tr_b16 a[174:175], v22 offset:13312
  ds_read_b64_tr_b16 a[176:177], v22 offset:16384
  ds_read_b64_tr_b16 a[178:179], v22 offset:17408
  ds_read_b64_tr_b16 a[180:181], v22 offset:20480
  ds_read_b64_tr_b16 a[182:183], v22 offset:21504
  ds_read_b64_tr_b16 a[184:185], v22 offset:24576
  ds_read_b64_tr_b16 a[186:187], v22 offset:25600
  ds_read_b64_tr_b16 a[188:189], v22 offset:28672
  ds_read_b64_tr_b16 a[190:191], v22 offset:29696
  s_waitcnt lgkmcnt(0)
  s_waitcnt vmcnt(16)
  s_barrier
  s_add_u32 s27, s26, 1048576
  s_add_u32 m0, s28, 131072
  s_nop 0
  buffer_load_dwordx4 v20, s[64:67], s27 offen lds
  s_add_u32 m0, s28, 132096
  s_add_u32 s27, s27, 32768
  buffer_load_dwordx4 v20, s[64:67], s27 offen lds
  s_add_u32 m0, s28, 133120
  s_add_u32 s27, s27, 32768
  buffer_load_dwordx4 v21, s[64:67], s27 offen lds
  s_add_u32 m0, s28, 134144
  s_add_u32 s27, s27, 32768
  buffer_load_dwordx4 v21, s[64:67], s27 offen lds
  s_add_u32 m0, s28, 135168
  s_add_u32 s27, s27, 32768
  buffer_load_dwordx4 v20, s[64:67], s27 offen lds
  s_add_u32 m0, s28, 136192
  s_add_u32 s27, s27, 32768
  buffer_load_dwordx4 v20, s[64:67], s27 offen lds
  s_add_u32 m0, s28, 137216
  s_add_u32 s27, s27, 32768
  buffer_load_dwordx4 v21, s[64:67], s27 offen lds
  s_add_u32 m0, s28, 138240
  s_add_u32 s27, s27, 32768
  buffer_load_dwordx4 v21, s[64:67], s27 offen lds
  ds_read_b64_tr_b16 a[192:193], v22 offset:32768
  ds_read_b64_tr_b16 a[194:195], v22 offset:33792
  ds_read_b64_tr_b16 a[196:197], v22 offset:36864
  ds_read_b64_tr_b16 a[198:199], v22 offset:37888
  ds_read_b64_tr_b16 a[200:201], v22 offset:40960
  ds_read_b64_tr_b16 a[202:203], v22 offset:41984
  ds_read_b64_tr_b16 a[204:205], v22 offset:45056
  ds_read_b64_tr_b16 a[206:207], v22 offset:46080
  ds_read_b64_tr_b16 a[208:209], v22 offset:49152
  ds_read_b64_tr_b16 a[210:211], v22 offset:50176
  ds_read_b64_tr_b16 a[212:213], v22 offset:53248
  ds_read_b64_tr_b16 a[214:215], v22 offset:54272
  ds_read_b64_tr_b16 a[216:217], v22 offset:57344
  ds_read_b64_tr_b16 a[218:219], v22 offset:58368
  ds_read_b64_tr_b16 a[220:221], v22 offset:61440
  ds_read_b64_tr_b16 a[222:223], v22 offset:62464
  s_waitcnt lgkmcnt(0)
  s_waitcnt vmcnt(16)
  s_barrier
  s_add_u32 s27, s26, 2097152
  s_add_u32 m0, s28, 0
  s_nop 0
  buffer_load_dwordx4 v20, s[64:67], s27 offen lds
  s_add_u32 m0, s28, 1024
  s_add_u32 s27, s27, 32768
  buffer_load_dwordx4 v20, s[64:67], s27 offen lds
  s_add_u32 m0, s28, 2048
  s_add_u32 s27, s27, 32768
  buffer_load_dwordx4 v21, s[64:67], s27 offen lds
  s_add_u32 m0, s28, 3072
  s_add_u32 s27, s27, 32768
  buffer_load_dwordx4 v21, s[64:67], s27 offen lds
  s_add_u32 m0, s28, 4096
  s_add_u32 s27, s27, 32768
  buffer_load_dwordx4 v20, s[64:67], s27 offen lds
  s_add_u32 m0, s28, 5120
  s_add_u32 s27, s27, 32768
  buffer_load_dwordx4 v20, s[64:67], s27 offen lds
  s_add_u32 m0, s28, 6144
  s_add_u32 s27, s27, 32768
  buffer_load_dwordx4 v21, s[64:67], s27 offen lds
  s_add_u32 m0, s28, 7168
  s_add_u32 s27, s27, 32768
  buffer_load_dwordx4 v21, s[64:67], s27 offen lds
  ds_read_b64_tr_b16 a[224:225], v23 offset:0
  ds_read_b64_tr_b16 a[226:227], v23 offset:1024
  ds_read_b64_tr_b16 a[228:229], v23 offset:4096
  ds_read_b64_tr_b16 a[230:231], v23 offset:5120
  ds_read_b64_tr_b16 a[232:233], v23 offset:8192
  ds_read_b64_tr_b16 a[234:235], v23 offset:9216
  ds_read_b64_tr_b16 a[236:237], v23 offset:12288
  ds_read_b64_tr_b16 a[238:239], v23 offset:13312
  ds_read_b64_tr_b16 a[240:241], v23 offset:16384
  ds_read_b64_tr_b16 a[242:243], v23 offset:17408
  ds_read_b64_tr_b16 a[244:245], v23 offset:20480
  ds_read_b64_tr_b16 a[246:247], v23 offset:21504
  ds_read_b64_tr_b16 a[248:249], v23 offset:24576
  ds_read_b64_tr_b16 a[250:251], v23 offset:25600
  ds_read_b64_tr_b16 a[252:253], v23 offset:28672
  ds_read_b64_tr_b16 a[254:255], v23 offset:29696
  s_waitcnt lgkmcnt(0)
  s_waitcnt vmcnt(16)
  s_barrier
  s_add_u32 s27, s26, 3145728
  s_add_u32 m0, s28, 32768
  s_nop 0
  buffer_load_dwordx4 v20, s[64:67], s27 offen lds
  s_add_u32 m0, s28, 33792
  s_add_u32 s27, s27, 32768
  buffer_load_dwordx4 v20, s[64:67], s27 offen lds
  s_add_u32 m0, s28, 34816
  s_add_u32 s27, s27, 32768
  buffer_load_dwordx4 v21, s[64:67], s27 offen lds
  s_add_u32 m0, s28, 35840
  s_add_u32 s27, s27, 32768
  buffer_load_dwordx4 v21, s[64:67], s27 offen lds
  s_add_u32 m0, s28, 36864
  s_add_u32 s27, s27, 32768
  buffer_load_dwordx4 v20, s[64:67], s27 offen lds
  s_add_u32 m0, s28, 37888
  s_add_u32 s27, s27, 32768
  buffer_load_dwordx4 v20, s[64:67], s27 offen lds
  s_add_u32 m0, s28, 38912
  s_add_u32 s27, s27, 32768
  buffer_load_dwordx4 v21, s[64:67], s27 offen lds
  s_add_u32 m0, s28, 39936
  s_add_u32 s27, s27, 32768
  buffer_load_dwordx4 v21, s[64:67], s27 offen lds
  ds_read_b64_tr_b16 v[128:129], v23 offset:32768
  ds_read_b64_tr_b16 v[130:131], v23 offset:33792
  ds_read_b64_tr_b16 v[132:133], v23 offset:36864
  ds_read_b64_tr_b16 v[134:135], v23 offset:37888
  ds_read_b64_tr_b16 v[136:137], v23 offset:40960
  ds_read_b64_tr_b16 v[138:139], v23 offset:41984
  ds_read_b64_tr_b16 v[140:141], v23 offset:45056
  ds_read_b64_tr_b16 v[142:143], v23 offset:46080
  ds_read_b64_tr_b16 v[144:145], v23 offset:49152
  ds_read_b64_tr_b16 v[146:147], v23 offset:50176
  ds_read_b64_tr_b16 v[148:149], v23 offset:53248
  ds_read_b64_tr_b16 v[150:151], v23 offset:54272
  ds_read_b64_tr_b16 v[152:153], v23 offset:57344
  ds_read_b64_tr_b16 v[154:155], v23 offset:58368
  ds_read_b64_tr_b16 v[156:157], v23 offset:61440
  ds_read_b64_tr_b16 v[158:159], v23 offset:62464
  s_waitcnt lgkmcnt(0)
  s_waitcnt vmcnt(16)
  s_barrier
  ds_read_b64_tr_b16 v[160:161], v24 offset:0
  ds_read_b64_tr_b16 v[162:163], v24 offset:1024
  ds_read_b64_tr_b16 v[164:165], v24 offset:4096
  ds_read_b64_tr_b16 v[166:167], v24 offset:5120
  ds_read_b64_tr_b16 v[168:169], v24 offset:8192
  ds_read_b64_tr_b16 v[170:171], v24 offset:9216
  ds_read_b64_tr_b16 v[172:173], v24 offset:12288
  ds_read_b64_tr_b16 v[174:175], v24 offset:13312
  ds_read_b64_tr_b16 v[176:177], v24 offset:16384
  ds_read_b64_tr_b16 v[178:179], v24 offset:17408
  ds_read_b64_tr_b16 v[180:181], v24 offset:20480
  ds_read_b64_tr_b16 v[182:183], v24 offset:21504
  ds_read_b64_tr_b16 v[184:185], v24 offset:24576
  ds_read_b64_tr_b16 v[186:187], v24 offset:25600
  ds_read_b64_tr_b16 v[188:189], v24 offset:28672
  ds_read_b64_tr_b16 v[190:191], v24 offset:29696
  s_waitcnt lgkmcnt(0)
  s_waitcnt vmcnt(8)
  s_barrier
  ds_read_b64_tr_b16 v[192:193], v22 offset:0
  ds_read_b64_tr_b16 v[194:195], v22 offset:1024
  ds_read_b64_tr_b16 v[196:197], v22 offset:4096
  ds_read_b64_tr_b16 v[198:199], v22 offset:5120
  ds_read_b64_tr_b16 v[200:201], v22 offset:8192
  ds_read_b64_tr_b16 v[202:203], v22 offset:9216
  ds_read_b64_tr_b16 v[204:205], v22 offset:12288
  ds_read_b64_tr_b16 v[206:207], v22 offset:13312
  ds_read_b64_tr_b16 v[208:209], v22 offset:16384
  ds_read_b64_tr_b16 v[210:211], v22 offset:17408
  ds_read_b64_tr_b16 v[212:213], v22 offset:20480
  ds_read_b64_tr_b16 v[214:215], v22 offset:21504
  ds_read_b64_tr_b16 v[216:217], v22 offset:24576
  ds_read_b64_tr_b16 v[218:219], v22 offset:25600
  ds_read_b64_tr_b16 v[220:221], v22 offset:28672
  ds_read_b64_tr_b16 v[222:223], v22 offset:29696
  s_waitcnt lgkmcnt(0)
  s_waitcnt vmcnt(0)
  s_barrier
  ds_read_b64_tr_b16 v[224:225], v22 offset:32768
  ds_read_b64_tr_b16 v[226:227], v22 offset:33792
  ds_read_b64_tr_b16 v[228:229], v22 offset:36864
  ds_read_b64_tr_b16 v[230:231], v22 offset:37888
  ds_read_b64_tr_b16 v[232:233], v22 offset:40960
  ds_read_b64_tr_b16 v[234:235], v22 offset:41984
  ds_read_b64_tr_b16 v[236:237], v22 offset:45056
  ds_read_b64_tr_b16 v[238:239], v22 offset:46080
  ds_read_b64_tr_b16 v[240:241], v22 offset:49152
  ds_read_b64_tr_b16 v[242:243], v22 offset:50176
  ds_read_b64_tr_b16 v[244:245], v22 offset:53248
  ds_read_b64_tr_b16 v[246:247], v22 offset:54272
  ds_read_b64_tr_b16 v[248:249], v22 offset:57344
  ds_read_b64_tr_b16 v[250:251], v22 offset:58368
  ds_read_b64_tr_b16 v[252:253], v22 offset:61440
  ds_read_b64_tr_b16 v[254:255], v22 offset:62464
  s_waitcnt lgkmcnt(0)
  s_branch q_ld_84
q_ld_83:
  s_add_u32 s27, s26, 0
  s_add_u32 m0, s28, 0
  s_nop 0
  buffer_load_dwordx4 v20, s[8:11], s27 offen lds
  s_add_u32 m0, s28, 1024
  s_add_u32 s27, s27, 32768
  buffer_load_dwordx4 v20, s[8:11], s27 offen lds
  s_add_u32 m0, s28, 2048
  s_add_u32 s27, s27, 32768
  buffer_load_dwordx4 v21, s[8:11], s27 offen lds
  s_add_u32 m0, s28, 3072
  s_add_u32 s27, s27, 32768
  buffer_load_dwordx4 v21, s[8:11], s27 offen lds
  s_add_u32 m0, s28, 4096
  s_add_u32 s27, s27, 32768
  buffer_load_dwordx4 v20, s[8:11], s27 offen lds
  s_add_u32 m0, s28, 5120
  s_add_u32 s27, s27, 32768
  buffer_load_dwordx4 v20, s[8:11], s27 offen lds
  s_add_u32 m0, s28, 6144
  s_add_u32 s27, s27, 32768
  buffer_load_dwordx4 v21, s[8:11], s27 offen lds
  s_add_u32 m0, s28, 7168
  s_add_u32 s27, s27, 32768
  buffer_load_dwordx4 v21, s[8:11], s27 offen lds
  s_add_u32 s27, s26, 1048576
  s_add_u32 m0, s28, 32768
  s_nop 0
  buffer_load_dwordx4 v20, s[8:11], s27 offen lds
  s_add_u32 m0, s28, 33792
  s_add_u32 s27, s27, 32768
  buffer_load_dwordx4 v20, s[8:11], s27 offen lds
  s_add_u32 m0, s28, 34816
  s_add_u32 s27, s27, 32768
  buffer_load_dwordx4 v21, s[8:11], s27 offen lds
  s_add_u32 m0, s28, 35840
  s_add_u32 s27, s27, 32768
  buffer_load_dwordx4 v21, s[8:11], s27 offen lds
  s_add_u32 m0, s28, 36864
  s_add_u32 s27, s27, 32768
  buffer_load_dwordx4 v20, s[8:11], s27 offen lds
  s_add_u32 m0, s28, 37888
  s_add_u32 s27, s27, 32768
  buffer_load_dwordx4 v20, s[8:11], s27 offen lds
  s_add_u32 m0, s28, 38912
  s_add_u32 s27, s27, 32768
  buffer_load_dwordx4 v21, s[8:11], s27 offen lds
  s_add_u32 m0, s28, 39936
  s_add_u32 s27, s27, 32768
  buffer_load_dwordx4 v21, s[8:11], s27 offen lds
  s_add_u32 s27, s26, 2097152
  s_add_u32 m0, s28, 65536
  s_nop 0
  buffer_load_dwordx4 v20, s[8:11], s27 offen lds
  s_add_u32 m0, s28, 66560
  s_add_u32 s27, s27, 32768
  buffer_load_dwordx4 v20, s[8:11], s27 offen lds
  s_add_u32 m0, s28, 67584
  s_add_u32 s27, s27, 32768
  buffer_load_dwordx4 v21, s[8:11], s27 offen lds
  s_add_u32 m0, s28, 68608
  s_add_u32 s27, s27, 32768
  buffer_load_dwordx4 v21, s[8:11], s27 offen lds
  s_add_u32 m0, s28, 69632
  s_add_u32 s27, s27, 32768
  buffer_load_dwordx4 v20, s[8:11], s27 offen lds
  s_add_u32 m0, s28, 70656
  s_add_u32 s27, s27, 32768
  buffer_load_dwordx4 v20, s[8:11], s27 offen lds
  s_add_u32 m0, s28, 71680
  s_add_u32 s27, s27, 32768
  buffer_load_dwordx4 v21, s[8:11], s27 offen lds
  s_add_u32 m0, s28, 72704
  s_add_u32 s27, s27, 32768
  buffer_load_dwordx4 v21, s[8:11], s27 offen lds
  s_load_dwordx2 s[4:5], s[0:1], 112
  s_load_dwordx2 s[12:13], s[0:1], 104
  s_waitcnt vmcnt(16)
  s_barrier
  s_add_u32 s27, s26, 3145728
  s_add_u32 m0, s28, 98304
  s_nop 0
  buffer_load_dwordx4 v20, s[8:11], s27 offen lds
  s_add_u32 m0, s28, 99328
  s_add_u32 s27, s27, 32768
  buffer_load_dwordx4 v20, s[8:11], s27 offen lds
  s_add_u32 m0, s28, 100352
  s_add_u32 s27, s27, 32768
  buffer_load_dwordx4 v21, s[8:11], s27 offen lds
  s_add_u32 m0, s28, 101376
  s_add_u32 s27, s27, 32768
  buffer_load_dwordx4 v21, s[8:11], s27 offen lds
  s_add_u32 m0, s28, 102400
  s_add_u32 s27, s27, 32768
  buffer_load_dwordx4 v20, s[8:11], s27 offen lds
  s_add_u32 m0, s28, 103424
  s_add_u32 s27, s27, 32768
  buffer_load_dwordx4 v20, s[8:11], s27 offen lds
  s_add_u32 m0, s28, 104448
  s_add_u32 s27, s27, 32768
  buffer_load_dwordx4 v21, s[8:11], s27 offen lds
  s_add_u32 m0, s28, 105472
  s_add_u32 s27, s27, 32768
  buffer_load_dwordx4 v21, s[8:11], s27 offen lds
  ds_read_b64_tr_b16 a[128:129], v22 offset:0
  ds_read_b64_tr_b16 a[130:131], v22 offset:1024
  ds_read_b64_tr_b16 a[132:133], v22 offset:4096
  ds_read_b64_tr_b16 a[134:135], v22 offset:5120
  ds_read_b64_tr_b16 a[136:137], v22 offset:8192
  ds_read_b64_tr_b16 a[138:139], v22 offset:9216
  ds_read_b64_tr_b16 a[140:141], v22 offset:12288
  ds_read_b64_tr_b16 a[142:143], v22 offset:13312
  ds_read_b64_tr_b16 a[144:145], v22 offset:16384
  ds_read_b64_tr_b16 a[146:147], v22 offset:17408
  ds_read_b64_tr_b16 a[148:149], v22 offset:20480
  ds_read_b64_tr_b16 a[150:151], v22 offset:21504
  ds_read_b64_tr_b16 a[152:153], v22 offset:24576
  ds_read_b64_tr_b16 a[154:155], v22 offset:25600
  ds_read_b64_tr_b16 a[156:157], v22 offset:28672
  ds_read_b64_tr_b16 a[158:159], v22 offset:29696
  s_waitcnt lgkmcnt(0)
  s_waitcnt vmcnt(16)
  s_barrier
  s_add_u32 s27, s26, 0
  s_add_u32 m0, s28, 131072
  s_nop 0
  buffer_load_dwordx4 v20, s[64:67], s27 offen lds
  s_add_u32 m0, s28, 132096
  s_add_u32 s27, s27, 32768
  buffer_load_dwordx4 v20, s[64:67], s27 offen lds
  s_add_u32 m0, s28, 133120
  s_add_u32 s27, s27, 32768
  buffer_load_dwordx4 v21, s[64:67], s27 offen lds
  s_add_u32 m0, s28, 134144
  s_add_u32 s27, s27, 32768
  buffer_load_dwordx4 v21, s[64:67], s27 offen lds
  s_add_u32 m0, s28, 135168
  s_add_u32 s27, s27, 32768
  buffer_load_dwordx4 v20, s[64:67], s27 offen lds
  s_add_u32 m0, s28, 136192
  s_add_u32 s27, s27, 32768
  buffer_load_dwordx4 v20, s[64:67], s27 offen lds
  s_add_u32 m0, s28, 137216
  s_add_u32 s27, s27, 32768
  buffer_load_dwordx4 v21, s[64:67], s27 offen lds
  s_add_u32 m0, s28, 138240
  s_add_u32 s27, s27, 32768
  buffer_load_dwordx4 v21, s[64:67], s27 offen lds
  ds_read_b64_tr_b16 a[160:161], v22 offset:32768
  ds_read_b64_tr_b16 a[162:163], v22 offset:33792
  ds_read_b64_tr_b16 a[164:165], v22 offset:36864
  ds_read_b64_tr_b16 a[166:167], v22 offset:37888
  ds_read_b64_tr_b16 a[168:169], v22 offset:40960
  ds_read_b64_tr_b16 a[170:171], v22 offset:41984
  ds_read_b64_tr_b16 a[172:173], v22 offset:45056
  ds_read_b64_tr_b16 a[174:175], v22 offset:46080
  ds_read_b64_tr_b16 a[176:177], v22 offset:49152
  ds_read_b64_tr_b16 a[178:179], v22 offset:50176
  ds_read_b64_tr_b16 a[180:181], v22 offset:53248
  ds_read_b64_tr_b16 a[182:183], v22 offset:54272
  ds_read_b64_tr_b16 a[184:185], v22 offset:57344
  ds_read_b64_tr_b16 a[186:187], v22 offset:58368
  ds_read_b64_tr_b16 a[188:189], v22 offset:61440
  ds_read_b64_tr_b16 a[190:191], v22 offset:62464
  s_waitcnt lgkmcnt(0)
  s_waitcnt vmcnt(16)
  s_barrier
  s_add_u32 s27, s26, 1048576
  s_add_u32 m0, s28, 0
  s_nop 0
  buffer_load_dwordx4 v20, s[64:67], s27 offen lds
  s_add_u32 m0, s28, 1024
  s_add_u32 s27, s27, 32768
  buffer_load_dwordx4 v20, s[64:67], s27 offen lds
  s_add_u32 m0, s28, 2048
  s_add_u32 s27, s27, 32768
  buffer_load_dwordx4 v21, s[64:67], s27 offen lds
  s_add_u32 m0, s28, 3072
  s_add_u32 s27, s27, 32768
  buffer_load_dwordx4 v21, s[64:67], s27 offen lds
  s_add_u32 m0, s28, 4096
  s_add_u32 s27, s27, 32768
  buffer_load_dwordx4 v20, s[64:67], s27 offen lds
  s_add_u32 m0, s28, 5120
  s_add_u32 s27, s27, 32768
  buffer_load_dwordx4 v20, s[64:67], s27 offen lds
  s_add_u32 m0, s28, 6144
  s_add_u32 s27, s27, 32768
  buffer_load_dwordx4 v21, s[64:67], s27 offen lds
  s_add_u32 m0, s28, 7168
  s_add_u32 s27, s27, 32768
  buffer_load_dwordx4 v21, s[64:67], s27 offen lds
  ds_read_b64_tr_b16 a[192:193], v23 offset:0
  ds_read_b64_tr_b16 a[194:195], v23 offset:1024
  ds_read_b64_tr_b16 a[196:197], v23 offset:4096
  ds_read_b64_tr_b16 a[198:199], v23 offset:5120
  ds_read_b64_tr_b16 a[200:201], v23 offset:8192
  ds_read_b64_tr_b16 a[202:203], v23 offset:9216
  ds_read_b64_tr_b16 a[204:205], v23 offset:12288
  ds_read_b64_tr_b16 a[206:207], v23 offset:13312
  ds_read_b64_tr_b16 a[208:209], v23 offset:16384
  ds_read_b64_tr_b16 a[210:211], v23 offset:17408
  ds_read_b64_tr_b16 a[212:213], v23 offset:20480
  ds_read_b64_tr_b16 a[214:215], v23 offset:21504
  ds_read_b64_tr_b16 a[216:217], v23 offset:24576
  ds_read_b64_tr_b16 a[218:219], v23 offset:25600
  ds_read_b64_tr_b16 a[220:221], v23 offset:28672
  ds_read_b64_tr_b16 a[222:223], v23 offset:29696
  s_waitcnt lgkmcnt(0)
  s_waitcnt vmcnt(16)
  s_barrier
  s_add_u32 s27, s26, 2097152
  s_add_u32 m0, s28, 32768
  s_nop 0
  buffer_load_dwordx4 v20, s[64:67], s27 offen lds
  s_add_u32 m0, s28, 33792
  s_add_u32 s27, s27, 32768
  buffer_load_dwordx4 v20, s[64:67], s27 offen lds
  s_add_u32 m0, s28, 34816
  s_add_u32 s27, s27, 32768
  buffer_load_dwordx4 v21, s[64:67], s27 offen lds
  s_add_u32 m0, s28, 35840
  s_add_u32 s27, s27, 32768
  buffer_load_dwordx4 v21, s[64:67], s27 offen lds
  s_add_u32 m0, s28, 36864
  s_add_u32 s27, s27, 32768
  buffer_load_dwordx4 v20, s[64:67], s27 offen lds
  s_add_u32 m0, s28, 37888
  s_add_u32 s27, s27, 32768
  buffer_load_dwordx4 v20, s[64:67], s27 offen lds
  s_add_u32 m0, s28, 38912
  s_add_u32 s27, s27, 32768
  buffer_load_dwordx4 v21, s[64:67], s27 offen lds
  s_add_u32 m0, s28, 39936
  s_add_u32 s27, s27, 32768
  buffer_load_dwordx4 v21, s[64:67], s27 offen lds
  ds_read_b64_tr_b16 a[224:225], v23 offset:32768
  ds_read_b64_tr_b16 a[226:227], v23 offset:33792
  ds_read_b64_tr_b16 a[228:229], v23 offset:36864
  ds_read_b64_tr_b16 a[230:231], v23 offset:37888
  ds_read_b64_tr_b16 a[232:233], v23 offset:40960
  ds_read_b64_tr_b16 a[234:235], v23 offset:41984
  ds_read_b64_tr_b16 a[236:237], v23 offset:45056
  ds_read_b64_tr_b16 a[238:239], v23 offset:46080
  ds_read_b64_tr_b16 a[240:241], v23 offset:49152
  ds_read_b64_tr_b16 a[242:243], v23 offset:50176
  ds_read_b64_tr_b16 a[244:245], v23 offset:53248
  ds_read_b64_tr_b16 a[246:247], v23 offset:54272
  ds_read_b64_tr_b16 a[248:249], v23 offset:57344
  ds_read_b64_tr_b16 a[250:251], v23 offset:58368
  ds_read_b64_tr_b16 a[252:253], v23 offset:61440
  ds_read_b64_tr_b16 a[254:255], v23 offset:62464
  s_waitcnt lgkmcnt(0)
  s_waitcnt vmcnt(16)
  s_barrier
  s_add_u32 s27, s26, 3145728
  s_add_u32 m0, s28, 65536
  s_nop 0
  buffer_load_dwordx4 v20, s[64:67], s27 offen lds
  s_add_u32 m0, s28, 66560
  s_add_u32 s27, s27, 32768
  buffer_load_dwordx4 v20, s[64:67], s27 offen lds
  s_add_u32 m0, s28, 67584
  s_add_u32 s27, s27, 32768
  buffer_load_dwordx4 v21, s[64:67], s27 offen lds
  s_add_u32 m0, s28, 68608
  s_add_u32 s27, s27, 32768
  buffer_load_dwordx4 v21, s[64:67], s27 offen lds
  s_add_u32 m0, s28, 69632
  s_add_u32 s27, s27, 32768
  buffer_load_dwordx4 v20, s[64:67], s27 offen lds
  s_add_u32 m0, s28, 70656
  s_add_u32 s27, s27, 32768
  buffer_load_dwordx4 v20, s[64:67], s27 offen lds
  s_add_u32 m0, s28, 71680
  s_add_u32 s27, s27, 32768
  buffer_load_dwordx4 v21, s[64:67], s27 offen lds
  s_add_u32 m0, s28, 72704
  s_add_u32 s27, s27, 32768
  buffer_load_dwordx4 v21, s[64:67], s27 offen lds
  ds_read_b64_tr_b16 v[128:129], v24 offset:0
  ds_read_b64_tr_b16 v[130:131], v24 offset:1024
  ds_read_b64_tr_b16 v[132:133], v24 offset:4096
  ds_read_b64_tr_b16 v[134:135], v24 offset:5120
  ds_read_b64_tr_b16 v[136:137], v24 offset:8192
  ds_read_b64_tr_b16 v[138:139], v24 offset:9216
  ds_read_b64_tr_b16 v[140:141], v24 offset:12288
  ds_read_b64_tr_b16 v[142:143], v24 offset:13312
  ds_read_b64_tr_b16 v[144:145], v24 offset:16384
  ds_read_b64_tr_b16 v[146:147], v24 offset:17408
  ds_read_b64_tr_b16 v[148:149], v24 offset:20480
  ds_read_b64_tr_b16 v[150:151], v24 offset:21504
  ds_read_b64_tr_b16 v[152:153], v24 offset:24576
  ds_read_b64_tr_b16 v[154:155], v24 offset:25600
  ds_read_b64_tr_b16 v[156:157], v24 offset:28672
  ds_read_b64_tr_b16 v[158:159], v24 offset:29696
  s_waitcnt lgkmcnt(0)
  s_waitcnt vmcnt(16)
  s_barrier
  s_add_u32 s27, s26, 0
  s_add_u32 m0, s28, 98304
  s_nop 0
  buffer_load_dwordx4 v20, s[68:71], s27 offen lds
  s_add_u32 m0, s28, 99328
  s_add_u32 s27, s27, 32768
  buffer_load_dwordx4 v20, s[68:71], s27 offen lds
  s_add_u32 m0, s28, 100352
  s_add_u32 s27, s27, 32768
  buffer_load_dwordx4 v21, s[68:71], s27 offen lds
  s_add_u32 m0, s28, 101376
  s_add_u32 s27, s27, 32768
  buffer_load_dwordx4 v21, s[68:71], s27 offen lds
  s_add_u32 m0, s28, 102400
  s_add_u32 s27, s27, 32768
  buffer_load_dwordx4 v20, s[68:71], s27 offen lds
  s_add_u32 m0, s28, 103424
  s_add_u32 s27, s27, 32768
  buffer_load_dwordx4 v20, s[68:71], s27 offen lds
  s_add_u32 m0, s28, 104448
  s_add_u32 s27, s27, 32768
  buffer_load_dwordx4 v21, s[68:71], s27 offen lds
  s_add_u32 m0, s28, 105472
  s_add_u32 s27, s27, 32768
  buffer_load_dwordx4 v21, s[68:71], s27 offen lds
  ds_read_b64_tr_b16 v[160:161], v22 offset:0
  ds_read_b64_tr_b16 v[162:163], v22 offset:1024
  ds_read_b64_tr_b16 v[164:165], v22 offset:4096
  ds_read_b64_tr_b16 v[166:167], v22 offset:5120
  ds_read_b64_tr_b16 v[168:169], v22 offset:8192
  ds_read_b64_tr_b16 v[170:171], v22 offset:9216
  ds_read_b64_tr_b16 v[172:173], v22 offset:12288
  ds_read_b64_tr_b16 v[174:175], v22 offset:13312
  ds_read_b64_tr_b16 v[176:177], v22 offset:16384
  ds_read_b64_tr_b16 v[178:179], v22 offset:17408
  ds_read_b64_tr_b16 v[180:181], v22 offset:20480
  ds_read_b64_tr_b16 v[182:183], v22 offset:21504
  ds_read_b64_tr_b16 v[184:185], v22 offset:24576
  ds_read_b64_tr_b16 v[186:187], v22 offset:25600
  ds_read_b64_tr_b16 v[188:189], v22 offset:28672
  ds_read_b64_tr_b16 v[190:191], v22 offset:29696
  s_waitcnt lgkmcnt(0)
  s_waitcnt vmcnt(16)
  s_barrier
  s_add_u32 s27, s26, 1048576
  s_add_u32 m0, s28, 131072
  s_nop 0
  buffer_load_dwordx4 v20, s[68:71], s27 offen lds
  s_add_u32 m0, s28, 132096
  s_add_u32 s27, s27, 32768
  buffer_load_dwordx4 v20, s[68:71], s27 offen lds
  s_add_u32 m0, s28, 133120
  s_add_u32 s27, s27, 32768
  buffer_load_dwordx4 v21, s[68:71], s27 offen lds
  s_add_u32 m0, s28, 134144
  s_add_u32 s27, s27, 32768
  buffer_load_dwordx4 v21, s[68:71], s27 offen lds
  s_add_u32 m0, s28, 135168
  s_add_u32 s27, s27, 32768
  buffer_load_dwordx4 v20, s[68:71], s27 offen lds
  s_add_u32 m0, s28, 136192
  s_add_u32 s27, s27, 32768
  buffer_load_dwordx4 v20, s[68:71], s27 offen lds
  s_add_u32 m0, s28, 137216
  s_add_u32 s27, s27, 32768
  buffer_load_dwordx4 v21, s[68:71], s27 offen lds
  s_add_u32 m0, s28, 138240
  s_add_u32 s27, s27, 32768
  buffer_load_dwordx4 v21, s[68:71], s27 offen lds
  ds_read_b64_tr_b16 v[192:193], v22 offset:32768
  ds_read_b64_tr_b16 v[194:195], v22 offset:33792
  ds_read_b64_tr_b16 v[196:197], v22 offset:36864
  ds_read_b64_tr_b16 v[198:199], v22 offset:37888
  ds_read_b64_tr_b16 v[200:201], v22 offset:40960
  ds_read_b64_tr_b16 v[202:203], v22 offset:41984
  ds_read_b64_tr_b16 v[204:205], v22 offset:45056
  ds_read_b64_tr_b16 v[206:207], v22 offset:46080
  ds_read_b64_tr_b16 v[208:209], v22 offset:49152
  ds_read_b64_tr_b16 v[210:211], v22 offset:50176
  ds_read_b64_tr_b16 v[212:213], v22 offset:53248
  ds_read_b64_tr_b16 v[214:215], v22 offset:54272
  ds_read_b64_tr_b16 v[216:217], v22 offset:57344
  ds_read_b64_tr_b16 v[218:219], v22 offset:58368
  ds_read_b64_tr_b16 v[220:221], v22 offset:61440
  ds_read_b64_tr_b16 v[222:223], v22 offset:62464
  s_waitcnt lgkmcnt(0)
  s_waitcnt vmcnt(16)
  s_barrier
  s_add_u32 s27, s26, 2097152
  s_add_u32 m0, s28, 0
  s_nop 0
  buffer_load_dwordx4 v20, s[68:71], s27 offen lds
  s_add_u32 m0, s28, 1024
  s_add_u32 s27, s27, 32768
  buffer_load_dwordx4 v20, s[68:71], s27 offen lds
  s_add_u32 m0, s28, 2048
  s_add_u32 s27, s27, 32768
  buffer_load_dwordx4 v21, s[68:71], s27 offen lds
  s_add_u32 m0, s28, 3072
  s_add_u32 s27, s27, 32768
  buffer_load_dwordx4 v21, s[68:71], s27 offen lds
  s_add_u32 m0, s28, 4096
  s_add_u32 s27, s27, 32768
  buffer_load_dwordx4 v20, s[68:71], s27 offen lds
  s_add_u32 m0, s28, 5120
  s_add_u32 s27, s27, 32768
  buffer_load_dwordx4 v20, s[68:71], s27 offen lds
  s_add_u32 m0, s28, 6144
  s_add_u32 s27, s27, 32768
  buffer_load_dwordx4 v21, s[68:71], s27 offen lds
  s_add_u32 m0, s28, 7168
  s_add_u32 s27, s27, 32768
  buffer_load_dwordx4 v21, s[68:71], s27 offen lds
  ds_read_b64_tr_b16 v[224:225], v23 offset:0
  ds_read_b64_tr_b16 v[226:227], v23 offset:1024
  ds_read_b64_tr_b16 v[228:229], v23 offset:4096
  ds_read_b64_tr_b16 v[230:231], v23 offset:5120
  ds_read_b64_tr_b16 v[232:233], v23 offset:8192
  ds_read_b64_tr_b16 v[234:235], v23 offset:9216
  ds_read_b64_tr_b16 v[236:237], v23 offset:12288
  ds_read_b64_tr_b16 v[238:239], v23 offset:13312
  ds_read_b64_tr_b16 v[240:241], v23 offset:16384
  ds_read_b64_tr_b16 v[242:243], v23 offset:17408
  ds_read_b64_tr_b16 v[244:245], v23 offset:20480
  ds_read_b64_tr_b16 v[246:247], v23 offset:21504
  ds_read_b64_tr_b16 v[248:249], v23 offset:24576
  ds_read_b64_tr_b16 v[250:251], v23 offset:25600
  ds_read_b64_tr_b16 v[252:253], v23 offset:28672
  ds_read_b64_tr_b16 v[254:255], v23 offset:29696
  s_waitcnt lgkmcnt(0)
  s_waitcnt vmcnt(16)
  s_barrier
  s_add_u32 s27, s26, 3145728
  s_add_u32 m0, s28, 32768
  s_nop 0
  buffer_load_dwordx4 v20, s[68:71], s27 offen lds
  s_add_u32 m0, s28, 33792
  s_add_u32 s27, s27, 32768
  buffer_load_dwordx4 v20, s[68:71], s27 offen lds
  s_add_u32 m0, s28, 34816
  s_add_u32 s27, s27, 32768
  buffer_load_dwordx4 v21, s[68:71], s27 offen lds
  s_add_u32 m0, s28, 35840
  s_add_u32 s27, s27, 32768
  buffer_load_dwordx4 v21, s[68:71], s27 offen lds
  s_add_u32 m0, s28, 36864
  s_add_u32 s27, s27, 32768
  buffer_load_dwordx4 v20, s[68:71], s27 offen lds
  s_add_u32 m0, s28, 37888
  s_add_u32 s27, s27, 32768
  buffer_load_dwordx4 v20, s[68:71], s27 offen lds
  s_add_u32 m0, s28, 38912
  s_add_u32 s27, s27, 32768
  buffer_load_dwordx4 v21, s[68:71], s27 offen lds
  s_add_u32 m0, s28, 39936
  s_add_u32 s27, s27, 32768
  buffer_load_dwordx4 v21, s[68:71], s27 offen lds
  ds_read_b64_tr_b16 a[0:1], v23 offset:32768
  ds_read_b64_tr_b16 a[2:3], v23 offset:33792
  ds_read_b64_tr_b16 a[4:5], v23 offset:36864
  ds_read_b64_tr_b16 a[6:7], v23 offset:37888
  ds_read_b64_tr_b16 a[8:9], v23 offset:40960
  ds_read_b64_tr_b16 a[10:11], v23 offset:41984
  ds_read_b64_tr_b16 a[12:13], v23 offset:45056
  ds_read_b64_tr_b16 a[14:15], v23 offset:46080
  ds_read_b64_tr_b16 a[16:17], v23 offset:49152
  ds_read_b64_tr_b16 a[18:19], v23 offset:50176
  ds_read_b64_tr_b16 a[20:21], v23 offset:53248
  ds_read_b64_tr_b16 a[22:23], v23 offset:54272
  ds_read_b64_tr_b16 a[24:25], v23 offset:57344
  ds_read_b64_tr_b16 a[26:27], v23 offset:58368
  ds_read_b64_tr_b16 a[28:29], v23 offset:61440
  ds_read_b64_tr_b16 a[30:31], v23 offset:62464
  s_waitcnt lgkmcnt(0)
  s_waitcnt vmcnt(16)
  s_barrier
  ds_read_b64_tr_b16 a[32:33], v24 offset:0
  ds_read_b64_tr_b16 a[34:35], v24 offset:1024
  ds_read_b64_tr_b16 a[36:37], v24 offset:4096
  ds_read_b64_tr_b16 a[38:39], v24 offset:5120
  ds_read_b64_tr_b16 a[40:41], v24 offset:8192
  ds_read_b64_tr_b16 a[42:43], v24 offset:9216
  ds_read_b64_tr_b16 a[44:45], v24 offset:12288
  ds_read_b64_tr_b16 a[46:47], v24 offset:13312
  ds_read_b64_tr_b16 a[48:49], v24 offset:16384
  ds_read_b64_tr_b16 a[50:51], v24 offset:17408
  ds_read_b64_tr_b16 a[52:53], v24 offset:20480
  ds_read_b64_tr_b16 a[54:55], v24 offset:21504
  ds_read_b64_tr_b16 a[56:57], v24 offset:24576
  ds_read_b64_tr_b16 a[58:59], v24 offset:25600
  ds_read_b64_tr_b16 a[60:61], v24 offset:28672
  ds_read_b64_tr_b16 a[62:63], v24 offset:29696
  s_waitcnt lgkmcnt(0)
  s_waitcnt vmcnt(8)
  s_barrier
  ds_read_b64_tr_b16 a[64:65], v22 offset:0
  ds_read_b64_tr_b16 a[66:67], v22 offset:1024
  ds_read_b64_tr_b16 a[68:69], v22 offset:4096
  ds_read_b64_tr_b16 a[70:71], v22 offset:5120
  ds_read_b64_tr_b16 a[72:73], v22 offset:8192
  ds_read_b64_tr_b16 a[74:75], v22 offset:9216
  ds_read_b64_tr_b16 a[76:77], v22 offset:12288
  ds_read_b64_tr_b16 a[78:79], v22 offset:13312
  ds_read_b64_tr_b16 a[80:81], v22 offset:16384
  ds_read_b64_tr_b16 a[82:83], v22 offset:17408
  ds_read_b64_tr_b16 a[84:85], v22 offset:20480
  ds_read_b64_tr_b16 a[86:87], v22 offset:21504
  ds_read_b64_tr_b16 a[88:89], v22 offset:24576
  ds_read_b64_tr_b16 a[90:91], v22 offset:25600
  ds_read_b64_tr_b16 a[92:93], v22 offset:28672
  ds_read_b64_tr_b16 a[94:95], v22 offset:29696
  s_waitcnt lgkmcnt(0)
  s_waitcnt vmcnt(0)
  s_barrier
  ds_read_b64_tr_b16 a[96:97], v22 offset:32768
  ds_read_b64_tr_b16 a[98:99], v22 offset:33792
  ds_read_b64_tr_b16 a[100:101], v22 offset:36864
  ds_read_b64_tr_b16 a[102:103], v22 offset:37888
  ds_read_b64_tr_b16 a[104:105], v22 offset:40960
  ds_read_b64_tr_b16 a[106:107], v22 offset:41984
  ds_read_b64_tr_b16 a[108:109], v22 offset:45056
  ds_read_b64_tr_b16 a[110:111], v22 offset:46080
  ds_read_b64_tr_b16 a[112:113], v22 offset:49152
  ds_read_b64_tr_b16 a[114:115], v22 offset:50176
  ds_read_b64_tr_b16 a[116:117], v22 offset:53248
  ds_read_b64_tr_b16 a[118:119], v22 offset:54272
  ds_read_b64_tr_b16 a[120:121], v22 offset:57344
  ds_read_b64_tr_b16 a[122:123], v22 offset:58368
  ds_read_b64_tr_b16 a[124:125], v22 offset:61440
  ds_read_b64_tr_b16 a[126:127], v22 offset:62464
  s_waitcnt lgkmcnt(0)
q_ld_84:
  s_waitcnt lgkmcnt(0)
  s_barrier
  v_mbcnt_lo_u32_b32 v20, -1, 0
  v_and_b32 v20, 0, v20
  v_add_lshl_u32 v20, v20, 1, 2
  s_mov_b32 s26, 0
g_wt_85:
  global_load_dword v21, v20, s[12:13] offset:128 sc1
  s_add_u32 s26, s26, 1
  s_cmp_gt_u32 s26, 1048576
  s_cbranch_scc1 L_end
  s_waitcnt vmcnt(0)
  v_cmp_eq_u32 vcc, 0, v21
  v_readfirstlane_b32 s27, v21
  s_cbranch_vccnz g_wt_85
  v_lshrrev_b32 v7, 7, v0
  v_lshlrev_b32 v7, 12, v7
  v_and_b32 v2, 1023, v9
  s_lshl_b32 s26, s17, 10
  v_add3_u32 v7, v7, v2, s26
  v_mov_b32 v116, 0
  s_mov_b32 s47, s60
  s_add_u32 s76, s60, 3
  s_add_u32 s41, s60, 64
  s_mov_b32 s40, 18
  s_mov_b32 s48, 0
  s_mov_b32 s49, 268435456
  s_mov_b32 s43, 268435456
  s_mov_b32 s50, 32768
  s_mov_b32 s56, 1
  s_mov_b32 s61, 0
  s_mov_b32 s62, 0
  s_lshl_b32 s54, s17, 13
  s_mov_b32 s50, 0
  v_mov_b32 v4, 1
q_slow_86:
  s_nop 1
  s_nop 7
  v_cvt_pk_bf16_f32 v100, v52, v53
  v_cvt_pk_bf16_f32 v101, v54, v55
  v_cvt_pk_bf16_f32 v102, v60, v61
  v_cvt_pk_bf16_f32 v103, v62, v63
  buffer_store_dwordx4 v[100:103], v8, s[4:7], s43 offen offset:0 sc1
  v_cvt_pk_bf16_f32 v104, v56, v57
  v_cvt_pk_bf16_f32 v105, v58, v59
  v_cvt_pk_bf16_f32 v106, v64, v65
  v_cvt_pk_bf16_f32 v107, v66, v67
  buffer_store_dwordx4 v[104:107], v8, s[4:7], s43 offen offset:512 sc1
  s_mov_b32 s43, 268435456
  s_xor_b32 s50, s50, 32768
q_nxt_96:
  s_cmp_ge_u32 s47, 128
  s_cbranch_scc1 q_end_87
  s_cmp_lg_u32 s48, 0
  s_cbranch_scc1 q_have_88
  s_mov_b32 s53, 0
q_poll_89:
  s_cmp_lt_u32 s47, 64
  s_cselect_b32 s26, 2, 0
  s_add_u32 s26, s26, s47
  s_lshl_b32 s26, s26, 12
  s_add_u32 s26, s26, 243261440
  s_mov_b64 exec, 0xffffff
  buffer_load_dword v116, v7, s[4:7], s26 offen sc1
  s_mov_b64 exec, -1
  s_add_u32 s53, s53, 1
  s_cmp_gt_u32 s53, 1048576
  s_cbranch_scc1 q_fail_90
  s_waitcnt vmcnt(0)
  s_mov_b64 exec, 3
  buffer_store_dword v4, v0, s[4:7], s49 offen sc1
  s_mov_b64 exec, -1
  s_mov_b32 s49, 268435456
  v_cmp_eq_u32 vcc, 0, v116
  s_nop 0
  s_and_b32 s26, vcc_lo, 0xffffff
  s_cbranch_scc1 q_poll_89
  s_and_b32 s63, s47, 127
  s_lshl_b32 s63, s63, 15
  s_xor_b32 s27, s50, 32768
  s_add_u32 m0, s27, s54
  s_add_u32 s63, s63, s54
  s_add_u32 s63, s63, 6291456
  buffer_load_dwordx4 v12, s[4:7], s63 offen offset:0 sc1 lds
  buffer_load_dwordx4 v13, s[4:7], s63 offen offset:1024 sc1 lds
  buffer_load_dwordx4 v14, s[4:7], s63 offen offset:2048 sc1 lds
  buffer_load_dwordx4 v15, s[4:7], s63 offen offset:3072 sc1 lds
  s_add_u32 m0, m0, 4096
  s_add_u32 s63, s63, 4096
  buffer_load_dwordx4 v16, s[4:7], s63 offen offset:0 sc1 lds
  buffer_load_dwordx4 v17, s[4:7], s63 offen offset:1024 sc1 lds
  buffer_load_dwordx4 v18, s[4:7], s63 offen offset:2048 sc1 lds
  buffer_load_dwordx4 v19, s[4:7], s63 offen offset:3072 sc1 lds
  v_cmp_eq_u32 vcc, 0, v116
  v_max_u32_dpp v117, v116, v116 quad_perm:[1,0,3,2] row_mask:0xf bank_mask:0xf
  s_and_b32 s48, vcc_lo, 0xffffff
  s_cselect_b32 s48, 0, -1
  v_max_u32_dpp v117, v117, v117 quad_perm:[2,3,0,1] row_mask:0xf bank_mask:0xf
  s_nop 1
  v_max_u32_dpp v117, v117, v117 row_half_mirror row_mask:0xf bank_mask:0xf
  v_and_b32 v117, s48, v117
q_have_88:
  ds_write_b32 v118, v117 offset:256
  s_xor_b32 s50, s50, 32768
  s_waitcnt lgkmcnt(0)
  s_barrier
  ds_read_b128 v[108:111], v119 offset:256
  s_cmp_lt_u32 s47, 64
  s_cbranch_scc1 q_nopre_92
  s_waitcnt lgkmcnt(0)
  v_min3_u32 v112, v108, v109, v110
  v_max3_u32 v108, v108, v109, v110
  v_min_u32 v112, v112, v111
  v_max_u32 v108, v108, v111
  v_readfirstlane_b32 s45, v112
  v_readlane_b32 s28, v108, 0
  v_readlane_b32 s29, v108, 1
  v_readlane_b32 s30, v108, 2
  s_cmp_gt_u32 s28, s56
  s_cselect_b32 s26, s40, 0
  s_max_u32 s56, s56, s28
  s_cmp_gt_u32 s26, 10
  s_subb_u32 s40, s40, 0
  s_cmp_gt_u32 s29, s56
  s_cselect_b32 s26, s40, 0
  s_max_u32 s56, s56, s29
  s_cmp_gt_u32 s26, 10
  s_subb_u32 s40, s40, 0
  s_cmp_gt_u32 s30, s56
  s_cselect_b32 s26, s40, 0
  s_max_u32 s56, s56, s30
  s_add_u32 s76, s47, s40
  s_add_u32 s41, s47, 3
  s_sub_u32 s76, s76, 64
  s_cmp_gt_u32 s26, 10
  s_cselect_b32 s76, 64, s76
  s_subb_u32 s40, s40, 0
  s_cmp_lt_u32 s76, 64
  s_cselect_b32 s76, s76, s41
  s_cmp_lg_u32 s26, 0
  s_cbranch_scc1 q_fork_93
q_nopre_92:
  s_waitcnt vmcnt(0)
  s_sub_u32 s26, s47, s60
  s_cmp_lg_u32 s26, 15
  s_cbranch_scc1 q_cold_94
  v_mbcnt_lo_u32_b32 v20, -1, 0
  v_and_b32 v20, 0, v20
  v_add_lshl_u32 v20, v20, 2, 2
  s_mov_b32 s26, 0
g_wt_101:
  global_load_dword v21, v20, s[12:13] offset:128 sc1
  s_add_u32 s26, s26, 1
  s_cmp_gt_u32 s26, 1048576
  s_cbranch_scc1 L_end
  s_waitcnt vmcnt(0)
  v_cmp_eq_u32 vcc, 0, v21
  v_readfirstlane_b32 s27, v21
  s_cbranch_vccnz g_wt_101
  s_load_dwordx2 s[64:65], s[0:1], 72
  s_load_dwordx2 s[68:69], s[0:1], 80
  s_load_dwordx2 s[8:9], s[0:1], 88
  s_mov_b32 s66, 1835008
  s_mov_b32 s70, 1835008
  s_mov_b32 s10, 1835008
  v_lshrrev_b32 v2, 7, v0
  v_and_b32 v3, 0x70, v0
  v_mul_u32_u24 v6, 57344, v2
  v_add_u32 v6, v6, v3
  v_cmp_eq_u32 vcc, 0x70, v3
  v_mov_b32 v3, 0x7ff00000
  s_nop 0
  v_cndmask_b32 v6, v6, v3, vcc
  v_lshrrev_b32 v2, 8, v0
  v_mul_u32_u24 v7, 14336, v2
  v_and_b32 v3, 0xf0, v0
  v_add_u32 v7, v7, v3
  s_mul_i32 s34, s17, 458752
  s_mul_i32 s27, s16, 112
  s_add_u32 s34, s34, s27
  s_mul_i32 s35, s16, 57344
  s_lshl_b32 s27, s17, 8
  s_add_u32 s35, s35, s27
  s_waitcnt lgkmcnt(0)
  s_mul_i32 s26, s17, 23552
  s_add_u32 m0, s26, 65536
  s_add_u32 s36, s34, 0
  buffer_load_dwordx4 v6, s[64:67], s36 offen lds
  s_add_u32 m0, m0, 1024
  s_add_u32 s36, s34, 0
  buffer_load_dwordx4 v6, s[68:71], s36 offen lds
  s_add_u32 m0, m0, 1024
  s_add_u32 s36, s34, 3584
  buffer_load_dwordx4 v6, s[64:67], s36 offen lds
  s_add_u32 m0, m0, 1024
  s_add_u32 s36, s34, 3584
  buffer_load_dwordx4 v6, s[68:71], s36 offen lds
  s_add_u32 m0, m0, 1024
  s_add_u32 s36, s34, 7168
  buffer_load_dwordx4 v6, s[64:67], s36 offen lds
  s_add_u32 m0, m0, 1024
  s_add_u32 s36, s34, 7168
  buffer_load_dwordx4 v6, s[68:71], s36 offen lds
  s_add_u32 m0, m0, 1024
  s_add_u32 s36, s34, 10752
  buffer_load_dwordx4 v6, s[64:67], s36 offen lds
  s_add_u32 m0, m0, 1024
  s_add_u32 s36, s34, 10752
  buffer_load_dwordx4 v6, s[68:71], s36 offen lds
  s_add_u32 m0, m0, 1024
  s_add_u32 s36, s34, 14336
  buffer_load_dwordx4 v6, s[64:67], s36 offen lds
  s_add_u32 m0, m0, 1024
  s_add_u32 s36, s34, 14336
  buffer_load_dwordx4 v6, s[68:71], s36 offen lds
  s_add_u32 m0, m0, 1024
  s_add_u32 s36, s34, 17920
  buffer_load_dwordx4 v6, s[64:67], s36 offen lds
  s_add_u32 m0, m0, 1024
  s_add_u32 s36, s34, 17920
  buffer_load_dwordx4 v6, s[68:71], s36 offen lds
  s_add_u32 m0, m0, 1024
  s_add_u32 s36, s34, 21504
  buffer_load_dwordx4 v6, s[64:67], s36 offen lds
  s_add_u32 m0, m0, 1024
  s_add_u32 s36, s34, 21504
  buffer_load_dwordx4 v6, s[68:71], s36 offen lds
  s_add_u32 m0, m0, 1024
  s_add_u32 s36, s34, 25088
  buffer_load_dwordx4 v6, s[64:67], s36 offen lds
  s_add_u32 m0, m0, 1024
  s_add_u32 s36, s34, 25088
  buffer_load_dwordx4 v6, s[68:71], s36 offen lds
  s_add_u32 m0, m0, 1024
  s_add_u32 s36, s34, 28672
  buffer_load_dwordx4 v6, s[64:67], s36 offen lds
  s_add_u32 m0, m0, 1024
  s_add_u32 s36, s34, 28672
  buffer_load_dwordx4 v6, s[68:71], s36 offen lds
  s_add_u32 m0, m0, 1024
  s_add_u32 s36, s34, 32256
  buffer_load_dwordx4 v6, s[64:67], s36 offen lds
  s_add_u32 m0, m0, 1024
  s_add_u32 s36, s34, 32256
  buffer_load_dwordx4 v6, s[68:71], s36 offen lds
  s_add_u32 m0, m0, 1024
  s_add_u32 s36, s34, 35840
  buffer_load_dwordx4 v6, s[64:67], s36 offen lds
  s_add_u32 m0, m0, 1024
  s_add_u32 s36, s34, 35840
  buffer_load_dwordx4 v6, s[68:71], s36 offen lds
  s_add_u32 m0, m0, 1024
  s_add_u32 s36, s34, 39424
  buffer_load_dwordx4 v6, s[64:67], s36 offen lds
  s_add_u32 m0, m0, 1024
  v_lshrrev_b32 v7, 7, v0
  v_lshlrev_b32 v7, 12, v7
  v_and_b32 v2, 1023, v9
  s_lshl_b32 s26, s17, 10
  v_add3_u32 v7, v7, v2, s26
  v_mov_b32 v116, 0
q_cold_94:
  s_waitcnt lgkmcnt(0)
  s_barrier
  s_cmp_lg_u32 s50, 0
  s_cbranch_scc1 q_c1_98
q_c0_97:
  ds_read_b128 v[68:71], v120 offset:0
  ds_read_b128 v[72:75], v121 offset:0
  ds_read_b128 v[76:79], v122 offset:0
q_w0_99:
  s_waitcnt lgkmcnt(2)
  v_mfma_f32_32x32x16_bf16 v[20:35], v[128:131], v[68:71], 0
  ds_read_b128 v[80:83], v123 offset:0
  s_mov_b32 s46, s47
  s_mov_b32 s47, s76
  s_lshl_b32 s52, s46, 7
  s_add_u32 s52, s52, s57
  s_lshl_b32 s44, s52, 12
  v_mfma_f32_32x32x16_bf16 v[36:51], v[68:71], a[0:3], 0
  s_add_u32 s44, s44, 41943040
  v_cvt_pk_bf16_f32 v100, v52, v53
  v_cvt_pk_bf16_f32 v101, v54, v55
  v_cvt_pk_bf16_f32 v102, v60, v61
  v_cvt_pk_bf16_f32 v103, v62, v63
  s_waitcnt lgkmcnt(2)
  v_mfma_f32_32x32x16_bf16 v[20:35], v[132:135], v[72:75], v[20:35]
  ds_read_b128 v[84:87], v124 offset:0
  buffer_store_dwordx4 v[100:103], v8, s[4:7], s43 offen offset:0 sc1
  v_cvt_pk_bf16_f32 v104, v56, v57
  v_cvt_pk_bf16_f32 v105, v58, v59
  v_mfma_f32_32x32x16_bf16 v[36:51], v[72:75], a[4:7], v[36:51]
  v_cvt_pk_bf16_f32 v106, v64, v65
  v_cvt_pk_bf16_f32 v107, v66, v67
  s_waitcnt lgkmcnt(2)
  v_mfma_f32_32x32x16_bf16 v[20:35], v[136:139], v[76:79], v[20:35]
  ds_read_b128 v[88:91], v125 offset:0
  buffer_store_dwordx4 v[104:107], v8, s[4:7], s43 offen offset:512 sc1
  s_lshl_b32 s43, s52, 11
  s_add_u32 s43, s43, 142606336
  v_mfma_f32_32x32x16_bf16 v[36:51], v[76:79], a[8:11], v[36:51]
  s_lshl_b32 s51, s52, 5
  s_add_u32 s51, s51, 244318208
  s_lshr_b32 s55, s47, 7
  s_sub_u32 s27, s47, s60
  s_cmp_eq_u32 s27, 15
  s_cselect_b32 s55, 1, s55
  s_waitcnt lgkmcnt(2)
  v_mfma_f32_32x32x16_bf16 v[20:35], v[140:143], v[80:83], v[20:35]
  ds_read_b128 v[92:95], v126 offset:0
  s_add_u32 s76, s47, 3
  s_cmp_lt_u32 s76, 18
  s_cselect_b32 s76, s76, s41
  v_mfma_f32_32x32x16_bf16 v[36:51], v[80:83], a[12:15], v[36:51]
  s_waitcnt lgkmcnt(2)
  v_mfma_f32_32x32x16_bf16 v[20:35], v[144:147], v[84:87], v[20:35]
  ds_read_b128 v[96:99], v127 offset:0
  v_mfma_f32_32x32x16_bf16 v[36:51], v[84:87], a[16:19], v[36:51]
  s_waitcnt lgkmcnt(2)
  v_mfma_f32_32x32x16_bf16 v[20:35], v[148:151], v[88:91], v[20:35]
  ds_read_b128 v[68:71], v120 offset:256
  v_mfma_f32_32x32x16_bf16 v[36:51], v[88:91], a[20:23], v[36:51]
  s_waitcnt lgkmcnt(2)
  v_mfma_f32_32x32x16_bf16 v[20:35], v[152:155], v[92:95], v[20:35]
  ds_read_b128 v[72:75], v121 offset:256
  s_cmp_lt_u32 s47, 64
  s_cselect_b32 s26, 2, 0
  s_add_u32 s26, s26, s47
  s_lshl_b32 s26, s26, 12
  s_add_u32 s26, s26, 243261440
  v_mfma_f32_32x32x16_bf16 v[36:51], v[92:95], a[24:27], v[36:51]
  s_mov_b64 exec, 0xffffff
  buffer_load_dword v116, v7, s[4:7], s26 offen sc1
  s_mov_b64 exec, -1
  s_waitcnt lgkmcnt(2)
  v_mfma_f32_32x32x16_bf16 v[20:35], v[156:159], v[96:99], v[20:35]
  ds_read_b128 v[76:79], v122 offset:256
  v_mfma_f32_32x32x16_bf16 v[36:51], v[96:99], a[28:31], v[36:51]
  s_waitcnt lgkmcnt(2)
  v_mfma_f32_32x32x16_bf16 v[20:35], v[160:163], v[68:71], v[20:35]
  ds_read_b128 v[80:83], v123 offset:256
  v_mfma_f32_32x32x16_bf16 v[36:51], v[68:71], a[32:35], v[36:51]
  s_waitcnt lgkmcnt(2)
  v_mfma_f32_32x32x16_bf16 v[20:35], v[164:167], v[72:75], v[20:35]
  ds_read_b128 v[84:87], v124 offset:256
  v_mfma_f32_32x32x16_bf16 v[36:51], v[72:75], a[36:39], v[36:51]
  s_waitcnt lgkmcnt(2)
  v_mfma_f32_32x32x16_bf16 v[20:35], v[168:171], v[76:79], v[20:35]
  ds_read_b128 v[88:91], v125 offset:256
  v_mfma_f32_32x32x16_bf16 v[36:51], v[76:79], a[40:43], v[36:51]
  s_waitcnt lgkmcnt(2)
  v_mfma_f32_32x32x16_bf16 v[20:35], v[172:175], v[80:83], v[20:35]
  ds_read_b128 v[92:95], v126 offset:256
  v_mfma_f32_32x32x16_bf16 v[36:51], v[80:83], a[44:47], v[36:51]
  s_waitcnt lgkmcnt(2)
  v_mfma_f32_32x32x16_bf16 v[20:35], v[176:179], v[84:87], v[20:35]
  ds_read_b128 v[96:99], v127 offset:256
  v_mfma_f32_32x32x16_bf16 v[36:51], v[84:87], a[48:51], v[36:51]
  s_waitcnt lgkmcnt(2)
  v_mfma_f32_32x32x16_bf16 v[20:35], v[180:183], v[88:91], v[20:35]
  ds_read_b128 v[68:71], v120 offset:512
  v_mfma_f32_32x32x16_bf16 v[36:51], v[88:91], a[52:55], v[36:51]
  s_waitcnt lgkmcnt(2)
  v_mfma_f32_32x32x16_bf16 v[20:35], v[184:187], v[92:95], v[20:35]
  ds_read_b128 v[72:75], v121 offset:512
  v_mfma_f32_32x32x16_bf16 v[36:51], v[92:95], a[56:59], v[36:51]
  s_waitcnt lgkmcnt(2)
  v_mfma_f32_32x32x16_bf16 v[20:35], v[188:191], v[96:99], v[20:35]
  ds_read_b128 v[76:79], v122 offset:512
  v_mfma_f32_32x32x16_bf16 v[36:51], v[96:99], a[60:63], v[36:51]
  s_waitcnt lgkmcnt(2)
  v_mfma_f32_32x32x16_bf16 v[20:35], v[192:195], v[68:71], v[20:35]
  ds_read_b128 v[80:83], v123 offset:512
  v_mfma_f32_32x32x16_bf16 v[36:51], v[68:71], a[64:67], v[36:51]
  s_waitcnt lgkmcnt(2)
  v_mfma_f32_32x32x16_bf16 v[20:35], v[196:199], v[72:75], v[20:35]
  ds_read_b128 v[84:87], v124 offset:512
  v_mfma_f32_32x32x16_bf16 v[36:51], v[72:75], a[68:71], v[36:51]
  s_waitcnt lgkmcnt(2)
  v_mfma_f32_32x32x16_bf16 v[20:35], v[200:203], v[76:79], v[20:35]
  ds_read_b128 v[88:91], v125 offset:512
  v_mfma_f32_32x32x16_bf16 v[36:51], v[76:79], a[72:75], v[36:51]
  s_waitcnt lgkmcnt(2)
  v_mfma_f32_32x32x16_bf16 v[20:35], v[204:207], v[80:83], v[20:35]
  ds_read_b128 v[92:95], v126 offset:512
  s_waitcnt vmcnt(0)
  s_mov_b64 exec, 3
  buffer_store_dword v4, v0, s[4:7], s49 offen sc1
  s_mov_b64 exec, -1
  v_mfma_f32_32x32x16_bf16 v[36:51], v[80:83], a[76:79], v[36:51]
  v_cmp_eq_u32 vcc, 0, v116
  v_max_u32_dpp v117, v116, v116 quad_perm:[1,0,3,2] row_mask:0xf bank_mask:0xf
  s_and_b32 s48, vcc_lo, 0xffffff
  s_cselect_b32 s48, 0, -1
  v_max_u32_dpp v117, v117, v117 quad_perm:[2,3,0,1] row_mask:0xf bank_mask:0xf
  s_nop 1
  s_waitcnt lgkmcnt(2)
  v_mfma_f32_32x32x16_bf16 v[20:35], v[208:211], v[84:87], v[20:35]
  ds_read_b128 v[96:99], v127 offset:512
  v_max_u32_dpp v117, v117, v117 row_half_mirror row_mask:0xf bank_mask:0xf
  v_and_b32 v117, s48, v117
  s_cmp_lg_u32 s48, 0
  s_cselect_b32 s28, s47, s46
  s_and_b32 s63, s28, 127
  v_mfma_f32_32x32x16_bf16 v[36:51], v[84:87], a[80:83], v[36:51]
  s_lshl_b32 s63, s63, 15
  s_xor_b32 s27, s50, 32768
  s_add_u32 m0, s27, s54
  s_add_u32 s63, s63, s54
  s_add_u32 s63, s63, 6291456
  s_waitcnt lgkmcnt(2)
  v_mfma_f32_32x32x16_bf16 v[20:35], v[212:215], v[88:91], v[20:35]
  ds_read_b128 v[68:71], v120 offset:768
  buffer_load_dwordx4 v12, s[4:7], s63 offen offset:0 sc1 lds
  v_mfma_f32_32x32x16_bf16 v[36:51], v[88:91], a[84:87], v[36:51]
  s_waitcnt lgkmcnt(2)
  v_mfma_f32_32x32x16_bf16 v[20:35], v[216:219], v[92:95], v[20:35]
  ds_read_b128 v[72:75], v121 offset:768
  buffer_load_dwordx4 v13, s[4:7], s63 offen offset:1024 sc1 lds
  v_mfma_f32_32x32x16_bf16 v[36:51], v[92:95], a[88:91], v[36:51]
  s_waitcnt lgkmcnt(2)
  v_mfma_f32_32x32x16_bf16 v[20:35], v[220:223], v[96:99], v[20:35]
  ds_read_b128 v[76:79], v122 offset:768
  buffer_load_dwordx4 v14, s[4:7], s63 offen offset:2048 sc1 lds
  v_mfma_f32_32x32x16_bf16 v[36:51], v[96:99], a[92:95], v[36:51]
  s_waitcnt lgkmcnt(2)
  v_mfma_f32_32x32x16_bf16 v[20:35], v[224:227], v[68:71], v[20:35]
  ds_read_b128 v[80:83], v123 offset:768
  buffer_load_dwordx4 v15, s[4:7], s63 offen offset:3072 sc1 lds
  s_add_u32 m0, m0, 4096
  s_add_u32 s63, s63, 4096
  v_mfma_f32_32x32x16_bf16 v[36:51], v[68:71], a[96:99], v[36:51]
  s_waitcnt lgkmcnt(2)
  v_mfma_f32_32x32x16_bf16 v[20:35], v[228:231], v[72:75], v[20:35]
  ds_read_b128 v[84:87], v124 offset:768
  buffer_load_dwordx4 v16, s[4:7], s63 offen offset:0 sc1 lds
  v_mfma_f32_32x32x16_bf16 v[36:51], v[72:75], a[100:103], v[36:51]
  s_waitcnt lgkmcnt(2)
  v_mfma_f32_32x32x16_bf16 v[20:35], v[232:235], v[76:79], v[20:35]
  ds_read_b128 v[88:91], v125 offset:768
  buffer_load_dwordx4 v17, s[4:7], s63 offen offset:1024 sc1 lds
  v_mfma_f32_32x32x16_bf16 v[36:51], v[76:79], a[104:107], v[36:51]
  s_waitcnt lgkmcnt(2)
  v_mfma_f32_32x32x16_bf16 v[20:35], v[236:239], v[80:83], v[20:35]
  ds_read_b128 v[92:95], v126 offset:768
  buffer_load_dwordx4 v18, s[4:7], s63 offen offset:2048 sc1 lds
  v_mfma_f32_32x32x16_bf16 v[36:51], v[80:83], a[108:111], v[36:51]
  s_waitcnt lgkmcnt(2)
  v_mfma_f32_32x32x16_bf16 v[20:35], v[240:243], v[84:87], v[20:35]
  ds_read_b128 v[96:99], v127 offset:768
  buffer_load_dwordx4 v19, s[4:7], s63 offen offset:3072 sc1 lds
  s_mov_b32 s49, s51
  ds_write_b32 v118, v117 offset:0
  v_mfma_f32_32x32x16_bf16 v[36:51], v[84:87], a[112:115], v[36:51]
  s_waitcnt lgkmcnt(3)
  v_mfma_f32_32x32x16_bf16 v[20:35], v[244:247], v[88:91], v[20:35]
  ds_read_b128 v[68:71], v120 offset:0
  v_mfma_f32_32x32x16_bf16 v[36:51], v[88:91], a[116:119], v[36:51]
  ds_read_b128 v[72:75], v121 offset:0
  s_waitcnt lgkmcnt(4)
  v_mfma_f32_32x32x16_bf16 v[20:35], v[248:251], v[92:95], v[20:35]
  ds_read_b128 v[76:79], v122 offset:0
  v_mfma_f32_32x32x16_bf16 v[36:51], v[92:95], a[120:123], v[36:51]
  ds_read_b128 v[80:83], v123 offset:0
  s_waitcnt lgkmcnt(5)
  v_mfma_f32_32x32x16_bf16 v[20:35], v[252:255], v[96:99], v[20:35]
  ds_read_b128 v[84:87], v124 offset:0
  v_mfma_f32_32x32x16_bf16 v[36:51], v[96:99], a[124:127], v[36:51]
  ds_read_b128 v[88:91], v125 offset:0
  s_waitcnt lgkmcnt(4)
  v_mfma_f32_32x32x16_bf16 v[52:67], a[128:131], v[68:71], 0
  ds_read_b128 v[92:95], v126 offset:0
  v_mfma_f32_32x32x16_bf16 v[52:67], a[132:135], v[72:75], v[52:67]
  ds_read_b128 v[96:99], v127 offset:0
  v_mul_f32 v20, s24, v20
  v_mul_f32 v21, s24, v21
  v_mul_f32 v22, s24, v22
  v_mul_f32 v23, s24, v23
  v_mul_f32 v24, s24, v24
  s_waitcnt lgkmcnt(4)
  v_mfma_f32_32x32x16_bf16 v[52:67], a[136:139], v[76:79], v[52:67]
  ds_read_b128 v[68:71], v120 offset:256
  v_mul_f32 v25, s24, v25
  v_cvt_pk_bf16_f32 v100, v36, v37
  v_cvt_pk_bf16_f32 v101, v38, v39
  v_cvt_pk_bf16_f32 v102, v44, v45
  v_cvt_pk_bf16_f32 v103, v46, v47
  v_mfma_f32_32x32x16_bf16 v[52:67], a[140:143], v[80:83], v[52:67]
  ds_read_b128 v[72:75], v121 offset:256
  buffer_store_dwordx4 v[100:103], v8, s[4:7], s44 offen offset:2048 sc1
  v_cvt_pk_bf16_f32 v104, v40, v41
  v_cvt_pk_bf16_f32 v105, v42, v43
  s_waitcnt lgkmcnt(4)
  v_mfma_f32_32x32x16_bf16 v[52:67], a[144:147], v[84:87], v[52:67]
  ds_read_b128 v[76:79], v122 offset:256
  v_cvt_pk_bf16_f32 v106, v48, v49
  v_cvt_pk_bf16_f32 v107, v50, v51
  buffer_store_dwordx4 v[104:107], v8, s[4:7], s44 offen offset:2560 sc1
  v_mfma_f32_32x32x16_bf16 v[52:67], a[148:151], v[88:91], v[52:67]
  ds_read_b128 v[80:83], v123 offset:256
  v_mul_f32 v26, s24, v26
  v_mul_f32 v27, s24, v27
  v_mul_f32 v28, s24, v28
  v_mul_f32 v29, s24, v29
  v_mul_f32 v30, s24, v30
  s_waitcnt lgkmcnt(4)
  v_mfma_f32_32x32x16_bf16 v[52:67], a[152:155], v[92:95], v[52:67]
  ds_read_b128 v[84:87], v124 offset:256
  v_mul_f32 v31, s24, v31
  v_mul_f32 v32, s24, v32
  v_mul_f32 v33, s24, v33
  v_mul_f32 v34, s24, v34
  v_mul_f32 v35, s24, v35
  v_mfma_f32_32x32x16_bf16 v[52:67], a[156:159], v[96:99], v[52:67]
  ds_read_b128 v[88:91], v125 offset:256
  v_cvt_pk_bf16_f32 v108, v20, v21
  v_cvt_pk_bf16_f32 v109, v22, v23
  v_cvt_pk_bf16_f32 v110, v28, v29
  v_cvt_pk_bf16_f32 v111, v30, v31
  buffer_store_dwordx4 v[108:111], v8, s[4:7], s44 offen offset:0 sc1
  s_waitcnt lgkmcnt(4)
  v_mfma_f32_32x32x16_bf16 v[52:67], a[160:163], v[68:71], v[52:67]
  ds_read_b128 v[92:95], v126 offset:256
  v_cvt_pk_bf16_f32 v112, v24, v25
  v_cvt_pk_bf16_f32 v113, v26, v27
  v_cvt_pk_bf16_f32 v114, v32, v33
  v_cvt_pk_bf16_f32 v115, v34, v35
  buffer_store_dwordx4 v[112:115], v8, s[4:7], s44 offen offset:512 sc1
  v_mfma_f32_32x32x16_bf16 v[52:67], a[164:167], v[72:75], v[52:67]
  ds_read_b128 v[96:99], v127 offset:256
  s_waitcnt lgkmcnt(4)
  v_mfma_f32_32x32x16_bf16 v[52:67], a[168:171], v[76:79], v[52:67]
  ds_read_b128 v[68:71], v120 offset:512
  v_mfma_f32_32x32x16_bf16 v[52:67], a[172:175], v[80:83], v[52:67]
  ds_read_b128 v[72:75], v121 offset:512
  s_waitcnt lgkmcnt(4)
  v_mfma_f32_32x32x16_bf16 v[52:67], a[176:179], v[84:87], v[52:67]
  ds_read_b128 v[76:79], v122 offset:512
  v_mfma_f32_32x32x16_bf16 v[52:67], a[180:183], v[88:91], v[52:67]
  ds_read_b128 v[80:83], v123 offset:512
  s_waitcnt lgkmcnt(4)
  v_mfma_f32_32x32x16_bf16 v[52:67], a[184:187], v[92:95], v[52:67]
  ds_read_b128 v[84:87], v124 offset:512
  v_mfma_f32_32x32x16_bf16 v[52:67], a[188:191], v[96:99], v[52:67]
  ds_read_b128 v[88:91], v125 offset:512
  s_waitcnt lgkmcnt(4)
  v_mfma_f32_32x32x16_bf16 v[52:67], a[192:195], v[68:71], v[52:67]
  ds_read_b128 v[92:95], v126 offset:512
  v_mfma_f32_32x32x16_bf16 v[52:67], a[196:199], v[72:75], v[52:67]
  ds_read_b128 v[96:99], v127 offset:512
  s_waitcnt lgkmcnt(4)
  v_mfma_f32_32x32x16_bf16 v[52:67], a[200:203], v[76:79], v[52:67]
  ds_read_b128 v[68:71], v120 offset:768
  v_mfma_f32_32x32x16_bf16 v[52:67], a[204:207], v[80:83], v[52:67]
  ds_read_b128 v[72:75], v121 offset:768
  s_waitcnt lgkmcnt(4)
  v_mfma_f32_32x32x16_bf16 v[52:67], a[208:211], v[84:87], v[52:67]
  ds_read_b128 v[76:79], v122 offset:768
  ds_read_b128 v[80:83], v123 offset:768
  v_mfma_f32_32x32x16_bf16 v[52:67], a[212:215], v[88:91], v[52:67]
  ds_read_b128 v[84:87], v124 offset:768
  ds_read_b128 v[88:91], v125 offset:768
  s_waitcnt lgkmcnt(6)
  v_mfma_f32_32x32x16_bf16 v[52:67], a[216:219], v[92:95], v[52:67]
  ds_read_b128 v[92:95], v126 offset:768
  v_mfma_f32_32x32x16_bf16 v[52:67], a[220:223], v[96:99], v[52:67]
  ds_read_b128 v[96:99], v127 offset:768
  s_waitcnt lgkmcnt(6)
  v_mfma_f32_32x32x16_bf16 v[52:67], a[224:227], v[68:71], v[52:67]
  v_mfma_f32_32x32x16_bf16 v[52:67], a[228:231], v[72:75], v[52:67]
  s_waitcnt vmcnt(4) lgkmcnt(0)
  s_barrier
  ds_read_b128 v[100:103], v119 offset:0
  v_mfma_f32_32x32x16_bf16 v[52:67], a[232:235], v[76:79], v[52:67]
  ds_read_b128 v[68:71], v120 offset:32768
  v_mfma_f32_32x32x16_bf16 v[52:67], a[236:239], v[80:83], v[52:67]
  ds_read_b128 v[72:75], v121 offset:32768
  s_xor_b32 s50, s50, 32768
  v_mfma_f32_32x32x16_bf16 v[52:67], a[240:243], v[84:87], v[52:67]
  ds_read_b128 v[76:79], v122 offset:32768
  s_sub_u32 s26, s46, 3
  s_cmp_lt_u32 s26, 61
  s_cbranch_scc1 q_lz_102
  s_waitcnt vmcnt(0)
  s_mov_b64 exec, 1
  buffer_store_dword v4, off, s[4:7], s51 sc1
  s_mov_b64 exec, -1
q_lz_102:
  v_mfma_f32_32x32x16_bf16 v[52:67], a[244:247], v[88:91], v[52:67]
  s_waitcnt lgkmcnt(3)
  v_min3_u32 v104, v100, v101, v102
  v_max3_u32 v100, v100, v101, v102
  v_min_u32 v104, v104, v103
  v_max_u32 v100, v100, v103
  v_readfirstlane_b32 s45, v104
  v_mfma_f32_32x32x16_bf16 v[52:67], a[248:251], v[92:95], v[52:67]
  v_readlane_b32 s28, v100, 0
  v_readlane_b32 s29, v100, 1
  v_readlane_b32 s30, v100, 2
  s_cmp_gt_u32 s55, 0
  s_cselect_b32 s45, 0, s45
  v_mfma_f32_32x32x16_bf16 v[52:67], a[252:255], v[96:99], v[52:67]
  s_cmp_eq_u32 s45, 0
  s_cbranch_scc1 q_slow_86
  s_cmp_lt_u32 s47, 64
  s_cbranch_scc1 q_w1_100
  s_cmp_gt_u32 s28, s56
  s_cselect_b32 s26, s40, 0
  s_max_u32 s56, s56, s28
  s_cmp_gt_u32 s26, 10
  s_subb_u32 s40, s40, 0
  s_cmp_gt_u32 s29, s56
  s_cselect_b32 s26, s40, 0
  s_max_u32 s56, s56, s29
  s_cmp_gt_u32 s26, 10
  s_subb_u32 s40, s40, 0
  s_cmp_gt_u32 s30, s56
  s_cselect_b32 s26, s40, 0
  s_max_u32 s56, s56, s30
  s_add_u32 s76, s47, s40
  s_add_u32 s41, s47, 3
  s_sub_u32 s76, s76, 64
  s_cmp_gt_u32 s26, 10
  s_cselect_b32 s76, 64, s76
  s_subb_u32 s40, s40, 0
  s_cmp_lt_u32 s76, 64
  s_cselect_b32 s76, s76, s41
  s_cmp_lg_u32 s26, 0
  s_cbranch_scc0 q_w1_100
  s_branch q_forkw_95
q_c1_98:
  ds_read_b128 v[68:71], v120 offset:32768
  ds_read_b128 v[72:75], v121 offset:32768
  ds_read_b128 v[76:79], v122 offset:32768
q_w1_100:
  s_waitcnt lgkmcnt(2)
  v_mfma_f32_32x32x16_bf16 v[20:35], v[128:131], v[68:71], 0
  ds_read_b128 v[80:83], v123 offset:32768
  s_mov_b32 s46, s47
  s_mov_b32 s47, s76
  s_lshl_b32 s52, s46, 7
  s_add_u32 s52, s52, s57
  s_lshl_b32 s44, s52, 12
  v_mfma_f32_32x32x16_bf16 v[36:51], v[68:71], a[0:3], 0
  s_add_u32 s44, s44, 41943040
  v_cvt_pk_bf16_f32 v100, v52, v53
  v_cvt_pk_bf16_f32 v101, v54, v55
  v_cvt_pk_bf16_f32 v102, v60, v61
  v_cvt_pk_bf16_f32 v103, v62, v63
  s_waitcnt lgkmcnt(2)
  v_mfma_f32_32x32x16_bf16 v[20:35], v[132:135], v[72:75], v[20:35]
  ds_read_b128 v[84:87], v124 offset:32768
  buffer_store_dwordx4 v[100:103], v8, s[4:7], s43 offen offset:0 sc1
  v_cvt_pk_bf16_f32 v104, v56, v57
  v_cvt_pk_bf16_f32 v105, v58, v59
  v_mfma_f32_32x32x16_bf16 v[36:51], v[72:75], a[4:7], v[36:51]
  v_cvt_pk_bf16_f32 v106, v64, v65
  v_cvt_pk_bf16_f32 v107, v66, v67
  s_waitcnt lgkmcnt(2)
  v_mfma_f32_32x32x16_bf16 v[20:35], v[136:139], v[76:79], v[20:35]
  ds_read_b128 v[88:91], v125 offset:32768
  buffer_store_dwordx4 v[104:107], v8, s[4:7], s43 offen offset:512 sc1
  s_lshl_b32 s43, s52, 11
  s_add_u32 s43, s43, 142606336
  v_mfma_f32_32x32x16_bf16 v[36:51], v[76:79], a[8:11], v[36:51]
  s_lshl_b32 s51, s52, 5
  s_add_u32 s51, s51, 244318208
  s_lshr_b32 s55, s47, 7
  s_sub_u32 s27, s47, s60
  s_cmp_eq_u32 s27, 15
  s_cselect_b32 s55, 1, s55
  s_waitcnt lgkmcnt(2)
  v_mfma_f32_32x32x16_bf16 v[20:35], v[140:143], v[80:83], v[20:35]
  ds_read_b128 v[92:95], v126 offset:32768
  s_add_u32 s76, s47, 3
  s_cmp_lt_u32 s76, 18
  s_cselect_b32 s76, s76, s41
  v_mfma_f32_32x32x16_bf16 v[36:51], v[80:83], a[12:15], v[36:51]
  s_waitcnt lgkmcnt(2)
  v_mfma_f32_32x32x16_bf16 v[20:35], v[144:147], v[84:87], v[20:35]
  ds_read_b128 v[96:99], v127 offset:32768
  v_mfma_f32_32x32x16_bf16 v[36:51], v[84:87], a[16:19], v[36:51]
  s_waitcnt lgkmcnt(2)
  v_mfma_f32_32x32x16_bf16 v[20:35], v[148:151], v[88:91], v[20:35]
  ds_read_b128 v[68:71], v120 offset:33024
  v_mfma_f32_32x32x16_bf16 v[36:51], v[88:91], a[20:23], v[36:51]
  s_waitcnt lgkmcnt(2)
  v_mfma_f32_32x32x16_bf16 v[20:35], v[152:155], v[92:95], v[20:35]
  ds_read_b128 v[72:75], v121 offset:33024
  s_cmp_lt_u32 s47, 64
  s_cselect_b32 s26, 2, 0
  s_add_u32 s26, s26, s47
  s_lshl_b32 s26, s26, 12
  s_add_u32 s26, s26, 243261440
  v_mfma_f32_32x32x16_bf16 v[36:51], v[92:95], a[24:27], v[36:51]
  s_mov_b64 exec, 0xffffff
  buffer_load_dword v116, v7, s[4:7], s26 offen sc1
  s_mov_b64 exec, -1
  s_waitcnt lgkmcnt(2)
  v_mfma_f32_32x32x16_bf16 v[20:35], v[156:159], v[96:99], v[20:35]
  ds_read_b128 v[76:79], v122 offset:33024
  v_mfma_f32_32x32x16_bf16 v[36:51], v[96:99], a[28:31], v[36:51]
  s_waitcnt lgkmcnt(2)
  v_mfma_f32_32x32x16_bf16 v[20:35], v[160:163], v[68:71], v[20:35]
  ds_read_b128 v[80:83], v123 offset:33024
  v_mfma_f32_32x32x16_bf16 v[36:51], v[68:71], a[32:35], v[36:51]
  s_waitcnt lgkmcnt(2)
  v_mfma_f32_32x32x16_bf16 v[20:35], v[164:167], v[72:75], v[20:35]
  ds_read_b128 v[84:87], v124 offset:33024
  v_mfma_f32_32x32x16_bf16 v[36:51], v[72:75], a[36:39], v[36:51]
  s_waitcnt lgkmcnt(2)
  v_mfma_f32_32x32x16_bf16 v[20:35], v[168:171], v[76:79], v[20:35]
  ds_read_b128 v[88:91], v125 offset:33024
  v_mfma_f32_32x32x16_bf16 v[36:51], v[76:79], a[40:43], v[36:51]
  s_waitcnt lgkmcnt(2)
  v_mfma_f32_32x32x16_bf16 v[20:35], v[172:175], v[80:83], v[20:35]
  ds_read_b128 v[92:95], v126 offset:33024
  v_mfma_f32_32x32x16_bf16 v[36:51], v[80:83], a[44:47], v[36:51]
  s_waitcnt lgkmcnt(2)
  v_mfma_f32_32x32x16_bf16 v[20:35], v[176:179], v[84:87], v[20:35]
  ds_read_b128 v[96:99], v127 offset:33024
  v_mfma_f32_32x32x16_bf16 v[36:51], v[84:87], a[48:51], v[36:51]
  s_waitcnt lgkmcnt(2)
  v_mfma_f32_32x32x16_bf16 v[20:35], v[180:183], v[88:91], v[20:35]
  ds_read_b128 v[68:71], v120 offset:33280
  v_mfma_f32_32x32x16_bf16 v[36:51], v[88:91], a[52:55], v[36:51]
  s_waitcnt lgkmcnt(2)
  v_mfma_f32_32x32x16_bf16 v[20:35], v[184:187], v[92:95], v[20:35]
  ds_read_b128 v[72:75], v121 offset:33280
  v_mfma_f32_32x32x16_bf16 v[36:51], v[92:95], a[56:59], v[36:51]
  s_waitcnt lgkmcnt(2)
  v_mfma_f32_32x32x16_bf16 v[20:35], v[188:191], v[96:99], v[20:35]
  ds_read_b128 v[76:79], v122 offset:33280
  v_mfma_f32_32x32x16_bf16 v[36:51], v[96:99], a[60:63], v[36:51]
  s_waitcnt lgkmcnt(2)
  v_mfma_f32_32x32x16_bf16 v[20:35], v[192:195], v[68:71], v[20:35]
  ds_read_b128 v[80:83], v123 offset:33280
  v_mfma_f32_32x32x16_bf16 v[36:51], v[68:71], a[64:67], v[36:51]
  s_waitcnt lgkmcnt(2)
  v_mfma_f32_32x32x16_bf16 v[20:35], v[196:199], v[72:75], v[20:35]
  ds_read_b128 v[84:87], v124 offset:33280
  v_mfma_f32_32x32x16_bf16 v[36:51], v[72:75], a[68:71], v[36:51]
  s_waitcnt lgkmcnt(2)
  v_mfma_f32_32x32x16_bf16 v[20:35], v[200:203], v[76:79], v[20:35]
  ds_read_b128 v[88:91], v125 offset:33280
  v_mfma_f32_32x32x16_bf16 v[36:51], v[76:79], a[72:75], v[36:51]
  s_waitcnt lgkmcnt(2)
  v_mfma_f32_32x32x16_bf16 v[20:35], v[204:207], v[80:83], v[20:35]
  ds_read_b128 v[92:95], v126 offset:33280
  s_waitcnt vmcnt(0)
  s_mov_b64 exec, 3
  buffer_store_dword v4, v0, s[4:7], s49 offen sc1
  s_mov_b64 exec, -1
  v_mfma_f32_32x32x16_bf16 v[36:51], v[80:83], a[76:79], v[36:51]
  v_cmp_eq_u32 vcc, 0, v116
  v_max_u32_dpp v117, v116, v116 quad_perm:[1,0,3,2] row_mask:0xf bank_mask:0xf
  s_and_b32 s48, vcc_lo, 0xffffff
  s_cselect_b32 s48, 0, -1
  v_max_u32_dpp v117, v117, v117 quad_perm:[2,3,0,1] row_mask:0xf bank_mask:0xf
  s_nop 1
  s_waitcnt lgkmcnt(2)
  v_mfma_f32_32x32x16_bf16 v[20:35], v[208:211], v[84:87], v[20:35]
  ds_read_b128 v[96:99], v127 offset:33280
  v_max_u32_dpp v117, v117, v117 row_half_mirror row_mask:0xf bank_mask:0xf
  v_and_b32 v117, s48, v117
  s_cmp_lg_u32 s48, 0
  s_cselect_b32 s28, s47, s46
  s_and_b32 s63, s28, 127
  v_mfma_f32_32x32x16_bf16 v[36:51], v[84:87], a[80:83], v[36:51]
  s_lshl_b32 s63, s63, 15
  s_xor_b32 s27, s50, 32768
  s_add_u32 m0, s27, s54
  s_add_u32 s63, s63, s54
  s_add_u32 s63, s63, 6291456
  s_waitcnt lgkmcnt(2)
  v_mfma_f32_32x32x16_bf16 v[20:35], v[212:215], v[88:91], v[20:35]
  ds_read_b128 v[68:71], v120 offset:33536
  buffer_load_dwordx4 v12, s[4:7], s63 offen offset:0 sc1 lds
  v_mfma_f32_32x32x16_bf16 v[36:51], v[88:91], a[84:87], v[36:51]
  s_waitcnt lgkmcnt(2)
  v_mfma_f32_32x32x16_bf16 v[20:35], v[216:219], v[92:95], v[20:35]
  ds_read_b128 v[72:75], v121 offset:33536
  buffer_load_dwordx4 v13, s[4:7], s63 offen offset:1024 sc1 lds
  v_mfma_f32_32x32x16_bf16 v[36:51], v[92:95], a[88:91], v[36:51]
  s_waitcnt lgkmcnt(2)
  v_mfma_f32_32x32x16_bf16 v[20:35], v[220:223], v[96:99], v[20:35]
  ds_read_b128 v[76:79], v122 offset:33536
  buffer_load_dwordx4 v14, s[4:7], s63 offen offset:2048 sc1 lds
  v_mfma_f32_32x32x16_bf16 v[36:51], v[96:99], a[92:95], v[36:51]
  s_waitcnt lgkmcnt(2)
  v_mfma_f32_32x32x16_bf16 v[20:35], v[224:227], v[68:71], v[20:35]
  ds_read_b128 v[80:83], v123 offset:33536
  buffer_load_dwordx4 v15, s[4:7], s63 offen offset:3072 sc1 lds
  s_add_u32 m0, m0, 4096
  s_add_u32 s63, s63, 4096
  v_mfma_f32_32x32x16_bf16 v[36:51], v[68:71], a[96:99], v[36:51]
  s_waitcnt lgkmcnt(2)
  v_mfma_f32_32x32x16_bf16 v[20:35], v[228:231], v[72:75], v[20:35]
  ds_read_b128 v[84:87], v124 offset:33536
  buffer_load_dwordx4 v16, s[4:7], s63 offen offset:0 sc1 lds
  v_mfma_f32_32x32x16_bf16 v[36:51], v[72:75], a[100:103], v[36:51]
  s_waitcnt lgkmcnt(2)
  v_mfma_f32_32x32x16_bf16 v[20:35], v[232:235], v[76:79], v[20:35]
  ds_read_b128 v[88:91], v125 offset:33536
  buffer_load_dwordx4 v17, s[4:7], s63 offen offset:1024 sc1 lds
  v_mfma_f32_32x32x16_bf16 v[36:51], v[76:79], a[104:107], v[36:51]
  s_waitcnt lgkmcnt(2)
  v_mfma_f32_32x32x16_bf16 v[20:35], v[236:239], v[80:83], v[20:35]
  ds_read_b128 v[92:95], v126 offset:33536
  buffer_load_dwordx4 v18, s[4:7], s63 offen offset:2048 sc1 lds
  v_mfma_f32_32x32x16_bf16 v[36:51], v[80:83], a[108:111], v[36:51]
  s_waitcnt lgkmcnt(2)
  v_mfma_f32_32x32x16_bf16 v[20:35], v[240:243], v[84:87], v[20:35]
  ds_read_b128 v[96:99], v127 offset:33536
  buffer_load_dwordx4 v19, s[4:7], s63 offen offset:3072 sc1 lds
  s_mov_b32 s49, s51
  ds_write_b32 v118, v117 offset:128
  v_mfma_f32_32x32x16_bf16 v[36:51], v[84:87], a[112:115], v[36:51]
  s_waitcnt lgkmcnt(3)
  v_mfma_f32_32x32x16_bf16 v[20:35], v[244:247], v[88:91], v[20:35]
  ds_read_b128 v[68:71], v120 offset:32768
  v_mfma_f32_32x32x16_bf16 v[36:51], v[88:91], a[116:119], v[36:51]
  ds_read_b128 v[72:75], v121 offset:32768
  s_waitcnt lgkmcnt(4)
  v_mfma_f32_32x32x16_bf16 v[20:35], v[248:251], v[92:95], v[20:35]
  ds_read_b128 v[76:79], v122 offset:32768
  v_mfma_f32_32x32x16_bf16 v[36:51], v[92:95], a[120:123], v[36:51]
  ds_read_b128 v[80:83], v123 offset:32768
  s_waitcnt lgkmcnt(5)
  v_mfma_f32_32x32x16_bf16 v[20:35], v[252:255], v[96:99], v[20:35]
  ds_read_b128 v[84:87], v124 offset:32768
  v_mfma_f32_32x32x16_bf16 v[36:51], v[96:99], a[124:127], v[36:51]
  ds_read_b128 v[88:91], v125 offset:32768
  s_waitcnt lgkmcnt(4)
  v_mfma_f32_32x32x16_bf16 v[52:67], a[128:131], v[68:71], 0
  ds_read_b128 v[92:95], v126 offset:32768
  v_mfma_f32_32x32x16_bf16 v[52:67], a[132:135], v[72:75], v[52:67]
  ds_read_b128 v[96:99], v127 offset:32768
  v_mul_f32 v20, s24, v20
  v_mul_f32 v21, s24, v21
  v_mul_f32 v22, s24, v22
  v_mul_f32 v23, s24, v23
  v_mul_f32 v24, s24, v24
  s_waitcnt lgkmcnt(4)
  v_mfma_f32_32x32x16_bf16 v[52:67], a[136:139], v[76:79], v[52:67]
  ds_read_b128 v[68:71], v120 offset:33024
  v_mul_f32 v25, s24, v25
  v_cvt_pk_bf16_f32 v100, v36, v37
  v_cvt_pk_bf16_f32 v101, v38, v39
  v_cvt_pk_bf16_f32 v102, v44, v45
  v_cvt_pk_bf16_f32 v103, v46, v47
  v_mfma_f32_32x32x16_bf16 v[52:67], a[140:143], v[80:83], v[52:67]
  ds_read_b128 v[72:75], v121 offset:33024
  buffer_store_dwordx4 v[100:103], v8, s[4:7], s44 offen offset:2048 sc1
  v_cvt_pk_bf16_f32 v104, v40, v41
  v_cvt_pk_bf16_f32 v105, v42, v43
  s_waitcnt lgkmcnt(4)
  v_mfma_f32_32x32x16_bf16 v[52:67], a[144:147], v[84:87], v[52:67]
  ds_read_b128 v[76:79], v122 offset:33024
  v_cvt_pk_bf16_f32 v106, v48, v49
  v_cvt_pk_bf16_f32 v107, v50, v51
  buffer_store_dwordx4 v[104:107], v8, s[4:7], s44 offen offset:2560 sc1
  v_mfma_f32_32x32x16_bf16 v[52:67], a[148:151], v[88:91], v[52:67]
  ds_read_b128 v[80:83], v123 offset:33024
  v_mul_f32 v26, s24, v26
  v_mul_f32 v27, s24, v27
  v_mul_f32 v28, s24, v28
  v_mul_f32 v29, s24, v29
  v_mul_f32 v30, s24, v30
  s_waitcnt lgkmcnt(4)
  v_mfma_f32_32x32x16_bf16 v[52:67], a[152:155], v[92:95], v[52:67]
  ds_read_b128 v[84:87], v124 offset:33024
  v_mul_f32 v31, s24, v31
  v_mul_f32 v32, s24, v32
  v_mul_f32 v33, s24, v33
  v_mul_f32 v34, s24, v34
  v_mul_f32 v35, s24, v35
  v_mfma_f32_32x32x16_bf16 v[52:67], a[156:159], v[96:99], v[52:67]
  ds_read_b128 v[88:91], v125 offset:33024
  v_cvt_pk_bf16_f32 v108, v20, v21
  v_cvt_pk_bf16_f32 v109, v22, v23
  v_cvt_pk_bf16_f32 v110, v28, v29
  v_cvt_pk_bf16_f32 v111, v30, v31
  buffer_store_dwordx4 v[108:111], v8, s[4:7], s44 offen offset:0 sc1
  s_waitcnt lgkmcnt(4)
  v_mfma_f32_32x32x16_bf16 v[52:67], a[160:163], v[68:71], v[52:67]
  ds_read_b128 v[92:95], v126 offset:33024
  v_cvt_pk_bf16_f32 v112, v24, v25
  v_cvt_pk_bf16_f32 v113, v26, v27
  v_cvt_pk_bf16_f32 v114, v32, v33
  v_cvt_pk_bf16_f32 v115, v34, v35
  buffer_store_dwordx4 v[112:115], v8, s[4:7], s44 offen offset:512 sc1
  v_mfma_f32_32x32x16_bf16 v[52:67], a[164:167], v[72:75], v[52:67]
  ds_read_b128 v[96:99], v127 offset:33024
  s_waitcnt lgkmcnt(4)
  v_mfma_f32_32x32x16_bf16 v[52:67], a[168:171], v[76:79], v[52:67]
  ds_read_b128 v[68:71], v120 offset:33280
  v_mfma_f32_32x32x16_bf16 v[52:67], a[172:175], v[80:83], v[52:67]
  ds_read_b128 v[72:75], v121 offset:33280
  s_waitcnt lgkmcnt(4)
  v_mfma_f32_32x32x16_bf16 v[52:67], a[176:179], v[84:87], v[52:67]
  ds_read_b128 v[76:79], v122 offset:33280
  v_mfma_f32_32x32x16_bf16 v[52:67], a[180:183], v[88:91], v[52:67]
  ds_read_b128 v[80:83], v123 offset:33280
  s_waitcnt lgkmcnt(4)
  v_mfma_f32_32x32x16_bf16 v[52:67], a[184:187], v[92:95], v[52:67]
  ds_read_b128 v[84:87], v124 offset:33280
  v_mfma_f32_32x32x16_bf16 v[52:67], a[188:191], v[96:99], v[52:67]
  ds_read_b128 v[88:91], v125 offset:33280
  s_waitcnt lgkmcnt(4)
  v_mfma_f32_32x32x16_bf16 v[52:67], a[192:195], v[68:71], v[52:67]
  ds_read_b128 v[92:95], v126 offset:33280
  v_mfma_f32_32x32x16_bf16 v[52:67], a[196:199], v[72:75], v[52:67]
  ds_read_b128 v[96:99], v127 offset:33280
  s_waitcnt lgkmcnt(4)
  v_mfma_f32_32x32x16_bf16 v[52:67], a[200:203], v[76:79], v[52:67]
  ds_read_b128 v[68:71], v120 offset:33536
  v_mfma_f32_32x32x16_bf16 v[52:67], a[204:207], v[80:83], v[52:67]
  ds_read_b128 v[72:75], v121 offset:33536
  s_waitcnt lgkmcnt(4)
  v_mfma_f32_32x32x16_bf16 v[52:67], a[208:211], v[84:87], v[52:67]
  ds_read_b128 v[76:79], v122 offset:33536
  ds_read_b128 v[80:83], v123 offset:33536
  v_mfma_f32_32x32x16_bf16 v[52:67], a[212:215], v[88:91], v[52:67]
  ds_read_b128 v[84:87], v124 offset:33536
  ds_read_b128 v[88:91], v125 offset:33536
  s_waitcnt lgkmcnt(6)
  v_mfma_f32_32x32x16_bf16 v[52:67], a[216:219], v[92:95], v[52:67]
  ds_read_b128 v[92:95], v126 offset:33536
  v_mfma_f32_32x32x16_bf16 v[52:67], a[220:223], v[96:99], v[52:67]
  ds_read_b128 v[96:99], v127 offset:33536
  s_waitcnt lgkmcnt(6)
  v_mfma_f32_32x32x16_bf16 v[52:67], a[224:227], v[68:71], v[52:67]
  v_mfma_f32_32x32x16_bf16 v[52:67], a[228:231], v[72:75], v[52:67]
  s_waitcnt vmcnt(4) lgkmcnt(0)
  s_barrier
  ds_read_b128 v[100:103], v119 offset:128
  v_mfma_f32_32x32x16_bf16 v[52:67], a[232:235], v[76:79], v[52:67]
  ds_read_b128 v[68:71], v120 offset:0
  v_mfma_f32_32x32x16_bf16 v[52:67], a[236:239], v[80:83], v[52:67]
  ds_read_b128 v[72:75], v121 offset:0
  s_xor_b32 s50, s50, 32768
  v_mfma_f32_32x32x16_bf16 v[52:67], a[240:243], v[84:87], v[52:67]
  ds_read_b128 v[76:79], v122 offset:0
  s_sub_u32 s26, s46, 3
  s_cmp_lt_u32 s26, 61
  s_cbranch_scc1 q_lz_103
  s_waitcnt vmcnt(0)
  s_mov_b64 exec, 1
  buffer_store_dword v4, off, s[4:7], s51 sc1
  s_mov_b64 exec, -1
q_lz_103:
  v_mfma_f32_32x32x16_bf16 v[52:67], a[244:247], v[88:91], v[52:67]
  s_waitcnt lgkmcnt(3)
  v_min3_u32 v104, v100, v101, v102
  v_max3_u32 v100, v100, v101, v102
  v_min_u32 v104, v104, v103
  v_max_u32 v100, v100, v103
  v_readfirstlane_b32 s45, v104
  v_mfma_f32_32x32x16_bf16 v[52:67], a[248:251], v[92:95], v[52:67]
  v_readlane_b32 s28, v100, 0
  v_readlane_b32 s29, v100, 1
  v_readlane_b32 s30, v100, 2
  s_cmp_gt_u32 s55, 0
  s_cselect_b32 s45, 0, s45
  v_mfma_f32_32x32x16_bf16 v[52:67], a[252:255], v[96:99], v[52:67]
  s_cmp_eq_u32 s45, 0
  s_cbranch_scc1 q_slow_86
  s_cmp_lt_u32 s47, 64
  s_cbranch_scc1 q_w0_99
  s_cmp_gt_u32 s28, s56
  s_cselect_b32 s26, s40, 0
  s_max_u32 s56, s56, s28
  s_cmp_gt_u32 s26, 10
  s_subb_u32 s40, s40, 0
  s_cmp_gt_u32 s29, s56
  s_cselect_b32 s26, s40, 0
  s_max_u32 s56, s56, s29
  s_cmp_gt_u32 s26, 10
  s_subb_u32 s40, s40, 0
  s_cmp_gt_u32 s30, s56
  s_cselect_b32 s26, s40, 0
  s_max_u32 s56, s56, s30
  s_add_u32 s76, s47, s40
  s_add_u32 s41, s47, 3
  s_sub_u32 s76, s76, 64
  s_cmp_gt_u32 s26, 10
  s_cselect_b32 s76, 64, s76
  s_subb_u32 s40, s40, 0
  s_cmp_lt_u32 s76, 64
  s_cselect_b32 s76, s76, s41
  s_cmp_lg_u32 s26, 0
  s_cbranch_scc0 q_w0_99
  s_branch q_forkw_95
q_forkw_95:
  v_cvt_pk_bf16_f32 v100, v52, v53
  v_cvt_pk_bf16_f32 v101, v54, v55
  v_cvt_pk_bf16_f32 v102, v60, v61
  v_cvt_pk_bf16_f32 v103, v62, v63
  buffer_store_dwordx4 v[100:103], v8, s[4:7], s43 offen offset:0 sc1
  v_cvt_pk_bf16_f32 v104, v56, v57
  v_cvt_pk_bf16_f32 v105, v58, v59
  v_cvt_pk_bf16_f32 v106, v64, v65
  v_cvt_pk_bf16_f32 v107, v66, v67
  buffer_store_dwordx4 v[104:107], v8, s[4:7], s43 offen offset:512 sc1
  s_mov_b32 s43, 268435456
  s_waitcnt lgkmcnt(0)
q_fork_93:
  s_mov_b32 s58, s56
  s_mov_b32 s46, s47
  s_mov_b32 s47, s76
  s_add_u32 s76, s47, 3
  s_cmp_lt_u32 s76, 18
  s_cselect_b32 s76, s76, s41
  s_andn2_b32 s59, 0xfff, s58
  s_lshl_b32 s26, s61, 21
  s_lshl_b32 s27, s59, 10
  s_add_u32 s26, s26, s27
  s_lshl_b32 s27, s17, 8
  s_add_u32 s26, s26, s27
  s_add_u32 s26, s26, 27262976
  v_lshrrev_b32 v5, 7, v0
  v_lshlrev_b32 v5, 5, v5
  buffer_load_dwordx4 v[52:55], v5, s[4:7], s26 offen offset:0 sc1
  buffer_load_dwordx4 v[56:59], v5, s[4:7], s26 offen offset:16 sc1
  s_load_dwordx2 s[64:65], s[0:1], 72
  s_load_dwordx2 s[68:69], s[0:1], 80
  s_load_dwordx2 s[8:9], s[0:1], 88
  s_mov_b32 s66, 1835008
  s_mov_b32 s70, 1835008
  s_mov_b32 s10, 1835008
  v_lshrrev_b32 v2, 7, v0
  v_and_b32 v3, 0x70, v0
  v_mul_u32_u24 v6, 57344, v2
  v_add_u32 v6, v6, v3
  v_cmp_eq_u32 vcc, 0x70, v3
  v_mov_b32 v3, 0x7ff00000
  s_nop 0
  v_cndmask_b32 v6, v6, v3, vcc
  v_lshrrev_b32 v2, 8, v0
  v_mul_u32_u24 v7, 14336, v2
  v_and_b32 v3, 0xf0, v0
  v_add_u32 v7, v7, v3
  s_mul_i32 s34, s17, 458752
  s_mul_i32 s27, s16, 112
  s_add_u32 s34, s34, s27
  s_mul_i32 s35, s16, 57344
  s_lshl_b32 s27, s17, 8
  s_add_u32 s35, s35, s27
  s_waitcnt lgkmcnt(0)
  s_xor_b32 s37, s50, 32768
  s_add_u32 s37, s37, s54
  s_mov_b32 m0, s37
  s_add_u32 s36, s34, 39424
  buffer_load_dwordx4 v6, s[68:71], s36 offen lds
  s_add_u32 m0, m0, 1024
  s_add_u32 s36, s34, 43008
  buffer_load_dwordx4 v6, s[64:67], s36 offen lds
  s_add_u32 m0, m0, 1024
  s_add_u32 s36, s34, 43008
  buffer_load_dwordx4 v6, s[68:71], s36 offen lds
  s_add_u32 m0, m0, 1024
  s_add_u32 s36, s34, 46592
  buffer_load_dwordx4 v6, s[64:67], s36 offen lds
  s_add_u32 m0, m0, 1024
  s_add_u32 s36, s34, 46592
  buffer_load_dwordx4 v6, s[68:71], s36 offen lds
  s_add_u32 m0, m0, 1024
  s_add_u32 s36, s34, 50176
  buffer_load_dwordx4 v6, s[64:67], s36 offen lds
  s_add_u32 m0, m0, 1024
  s_add_u32 s36, s34, 50176
  buffer_load_dwordx4 v6, s[68:71], s36 offen lds
  s_add_u32 m0, m0, 1024
  s_add_u32 s36, s34, 53760
  buffer_load_dwordx4 v6, s[64:67], s36 offen lds
  s_add_u32 m0, m0, 1024
  s_add_u32 s36, s34, 53760
  buffer_load_dwordx4 v[60:63], v6, s[68:71], s36 offen
  buffer_load_dwordx4 v[64:67], v7, s[8:11], s35 offen offset:0
  v_add_u32 v120, s50, v120
  v_add_u32 v121, s50, v121
  v_add_u32 v122, s50, v122
  v_add_u32 v123, s50, v123
  v_add_u32 v124, s50, v124
  v_add_u32 v125, s50, v125
  v_add_u32 v126, s50, v126
  v_add_u32 v127, s50, v127
  s_lshl_b32 s52, s46, 7
  s_add_u32 s52, s52, s57
  s_lshl_b32 s77, s52, 12
  s_add_u32 s44, s77, 75497472
  s_add_u32 s77, s77, 41943040
  s_lshl_b32 s51, s52, 5
  s_add_u32 s51, s51, 244318208
  s_waitcnt vmcnt(12)
  s_barrier
  s_mov_b64 exec, 3
  buffer_store_dword v4, v0, s[4:7], s49 offen sc1
  s_mov_b64 exec, -1
  v_mov_b32 v4, 2
  s_mov_b32 s49, s51
  ds_read_b128 v[68:71], v120 offset:0
  ds_read_b128 v[72:75], v121 offset:0
  ds_read_b128 v[76:79], v122 offset:0
  ds_read_b128 v[80:83], v123 offset:0
  s_waitcnt lgkmcnt(3)
  v_mfma_f32_32x32x16_bf16 v[20:35], v[128:131], v[68:71], 0
  v_mfma_f32_32x32x16_bf16 v[36:51], v[68:71], a[0:3], 0
  s_waitcnt lgkmcnt(2)
  v_mfma_f32_32x32x16_bf16 v[20:35], v[132:135], v[72:75], v[20:35]
  ds_read_b128 v[84:87], v124 offset:0
  v_mfma_f32_32x32x16_bf16 v[36:51], v[72:75], a[4:7], v[36:51]
  s_waitcnt lgkmcnt(2)
  v_mfma_f32_32x32x16_bf16 v[20:35], v[136:139], v[76:79], v[20:35]
  ds_read_b128 v[88:91], v125 offset:0
  v_mfma_f32_32x32x16_bf16 v[36:51], v[76:79], a[8:11], v[36:51]
  s_waitcnt lgkmcnt(2)
  v_mfma_f32_32x32x16_bf16 v[20:35], v[140:143], v[80:83], v[20:35]
  ds_read_b128 v[92:95], v126 offset:0
  v_mfma_f32_32x32x16_bf16 v[36:51], v[80:83], a[12:15], v[36:51]
  s_waitcnt lgkmcnt(2)
  v_mfma_f32_32x32x16_bf16 v[20:35], v[144:147], v[84:87], v[20:35]
  ds_read_b128 v[96:99], v127 offset:0
  v_mfma_f32_32x32x16_bf16 v[36:51], v[84:87], a[16:19], v[36:51]
  s_waitcnt lgkmcnt(2)
  v_mfma_f32_32x32x16_bf16 v[20:35], v[148:151], v[88:91], v[20:35]
  ds_read_b128 v[68:71], v120 offset:256
  v_mfma_f32_32x32x16_bf16 v[36:51], v[88:91], a[20:23], v[36:51]
  s_waitcnt lgkmcnt(2)
  v_mfma_f32_32x32x16_bf16 v[20:35], v[152:155], v[92:95], v[20:35]
  ds_read_b128 v[72:75], v121 offset:256
  v_mfma_f32_32x32x16_bf16 v[36:51], v[92:95], a[24:27], v[36:51]
  s_waitcnt lgkmcnt(2)
  v_mfma_f32_32x32x16_bf16 v[20:35], v[156:159], v[96:99], v[20:35]
  ds_read_b128 v[76:79], v122 offset:256
  v_mfma_f32_32x32x16_bf16 v[36:51], v[96:99], a[28:31], v[36:51]
  s_waitcnt lgkmcnt(2)
  v_mfma_f32_32x32x16_bf16 v[20:35], v[160:163], v[68:71], v[20:35]
  ds_read_b128 v[80:83], v123 offset:256
  v_mfma_f32_32x32x16_bf16 v[36:51], v[68:71], a[32:35], v[36:51]
  s_waitcnt lgkmcnt(2)
  v_mfma_f32_32x32x16_bf16 v[20:35], v[164:167], v[72:75], v[20:35]
  ds_read_b128 v[84:87], v124 offset:256
  v_mfma_f32_32x32x16_bf16 v[36:51], v[72:75], a[36:39], v[36:51]
  s_waitcnt lgkmcnt(2)
  v_mfma_f32_32x32x16_bf16 v[20:35], v[168:171], v[76:79], v[20:35]
  ds_read_b128 v[88:91], v125 offset:256
  v_mfma_f32_32x32x16_bf16 v[36:51], v[76:79], a[40:43], v[36:51]
  s_waitcnt lgkmcnt(2)
  v_mfma_f32_32x32x16_bf16 v[20:35], v[172:175], v[80:83], v[20:35]
  ds_read_b128 v[92:95], v126 offset:256
  v_mfma_f32_32x32x16_bf16 v[36:51], v[80:83], a[44:47], v[36:51]
  s_waitcnt lgkmcnt(2)
  v_mfma_f32_32x32x16_bf16 v[20:35], v[176:179], v[84:87], v[20:35]
  ds_read_b128 v[96:99], v127 offset:256
  v_mfma_f32_32x32x16_bf16 v[36:51], v[84:87], a[48:51], v[36:51]
  s_waitcnt lgkmcnt(2)
  v_mfma_f32_32x32x16_bf16 v[20:35], v[180:183], v[88:91], v[20:35]
  ds_read_b128 v[68:71], v120 offset:512
  v_mfma_f32_32x32x16_bf16 v[36:51], v[88:91], a[52:55], v[36:51]
  s_waitcnt lgkmcnt(2)
  v_mfma_f32_32x32x16_bf16 v[20:35], v[184:187], v[92:95], v[20:35]
  ds_read_b128 v[72:75], v121 offset:512
  v_mfma_f32_32x32x16_bf16 v[36:51], v[92:95], a[56:59], v[36:51]
  s_waitcnt lgkmcnt(2)
  v_mfma_f32_32x32x16_bf16 v[20:35], v[188:191], v[96:99], v[20:35]
  ds_read_b128 v[76:79], v122 offset:512
  v_mfma_f32_32x32x16_bf16 v[36:51], v[96:99], a[60:63], v[36:51]
  s_waitcnt lgkmcnt(2)
  v_mfma_f32_32x32x16_bf16 v[20:35], v[192:195], v[68:71], v[20:35]
  ds_read_b128 v[80:83], v123 offset:512
  v_mfma_f32_32x32x16_bf16 v[36:51], v[68:71], a[64:67], v[36:51]
  s_waitcnt lgkmcnt(2)
  v_mfma_f32_32x32x16_bf16 v[20:35], v[196:199], v[72:75], v[20:35]
  ds_read_b128 v[84:87], v124 offset:512
  v_mfma_f32_32x32x16_bf16 v[36:51], v[72:75], a[68:71], v[36:51]
  s_waitcnt lgkmcnt(2)
  v_mfma_f32_32x32x16_bf16 v[20:35], v[200:203], v[76:79], v[20:35]
  ds_read_b128 v[88:91], v125 offset:512
  v_mfma_f32_32x32x16_bf16 v[36:51], v[76:79], a[72:75], v[36:51]
  s_waitcnt lgkmcnt(2)
  v_mfma_f32_32x32x16_bf16 v[20:35], v[204:207], v[80:83], v[20:35]
  ds_read_b128 v[92:95], v126 offset:512
  v_mfma_f32_32x32x16_bf16 v[36:51], v[80:83], a[76:79], v[36:51]
  s_waitcnt lgkmcnt(2)
  v_mfma_f32_32x32x16_bf16 v[20:35], v[208:211], v[84:87], v[20:35]
  ds_read_b128 v[96:99], v127 offset:512
  v_mfma_f32_32x32x16_bf16 v[36:51], v[84:87], a[80:83], v[36:51]
  s_waitcnt lgkmcnt(2)
  v_mfma_f32_32x32x16_bf16 v[20:35], v[212:215], v[88:91], v[20:35]
  ds_read_b128 v[68:71], v120 offset:768
  v_mfma_f32_32x32x16_bf16 v[36:51], v[88:91], a[84:87], v[36:51]
  s_waitcnt lgkmcnt(2)
  v_mfma_f32_32x32x16_bf16 v[20:35], v[216:219], v[92:95], v[20:35]
  ds_read_b128 v[72:75], v121 offset:768
  v_mfma_f32_32x32x16_bf16 v[36:51], v[92:95], a[88:91], v[36:51]
  s_waitcnt lgkmcnt(2)
  v_mfma_f32_32x32x16_bf16 v[20:35], v[220:223], v[96:99], v[20:35]
  ds_read_b128 v[76:79], v122 offset:768
  v_mfma_f32_32x32x16_bf16 v[36:51], v[96:99], a[92:95], v[36:51]
  s_waitcnt lgkmcnt(2)
  v_mfma_f32_32x32x16_bf16 v[20:35], v[224:227], v[68:71], v[20:35]
  ds_read_b128 v[80:83], v123 offset:768
  v_mfma_f32_32x32x16_bf16 v[36:51], v[68:71], a[96:99], v[36:51]
  s_waitcnt lgkmcnt(2)
  v_mfma_f32_32x32x16_bf16 v[20:35], v[228:231], v[72:75], v[20:35]
  ds_read_b128 v[84:87], v124 offset:768
  v_mfma_f32_32x32x16_bf16 v[36:51], v[72:75], a[100:103], v[36:51]
  s_waitcnt lgkmcnt(2)
  v_mfma_f32_32x32x16_bf16 v[20:35], v[232:235], v[76:79], v[20:35]
  ds_read_b128 v[88:91], v125 offset:768
  v_mfma_f32_32x32x16_bf16 v[36:51], v[76:79], a[104:107], v[36:51]
  s_waitcnt lgkmcnt(2)
  v_mfma_f32_32x32x16_bf16 v[20:35], v[236:239], v[80:83], v[20:35]
  ds_read_b128 v[92:95], v126 offset:768
  v_mfma_f32_32x32x16_bf16 v[36:51], v[80:83], a[108:111], v[36:51]
  s_waitcnt lgkmcnt(2)
  v_mfma_f32_32x32x16_bf16 v[20:35], v[240:243], v[84:87], v[20:35]
  ds_read_b128 v[96:99], v127 offset:768
  v_mfma_f32_32x32x16_bf16 v[36:51], v[84:87], a[112:115], v[36:51]
  s_waitcnt lgkmcnt(2)
  v_mfma_f32_32x32x16_bf16 v[20:35], v[244:247], v[88:91], v[20:35]
  v_mfma_f32_32x32x16_bf16 v[36:51], v[88:91], a[116:119], v[36:51]
  s_waitcnt lgkmcnt(1)
  v_mfma_f32_32x32x16_bf16 v[20:35], v[248:251], v[92:95], v[20:35]
  v_mfma_f32_32x32x16_bf16 v[36:51], v[92:95], a[120:123], v[36:51]
  s_waitcnt lgkmcnt(0)
  v_mfma_f32_32x32x16_bf16 v[20:35], v[252:255], v[96:99], v[20:35]
  v_mfma_f32_32x32x16_bf16 v[36:51], v[96:99], a[124:127], v[36:51]
  s_nop 3
  v_mul_f32 v20, s24, v20
  v_mul_f32 v21, s24, v21
  v_mul_f32 v22, s24, v22
  v_mul_f32 v23, s24, v23
  v_mul_f32 v24, s24, v24
  v_mul_f32 v25, s24, v25
  v_mul_f32 v26, s24, v26
  v_mul_f32 v27, s24, v27
  v_mul_f32 v28, s24, v28
  v_mul_f32 v29, s24, v29
  v_mul_f32 v30, s24, v30
  v_mul_f32 v31, s24, v31
  v_mul_f32 v32, s24, v32
  v_mul_f32 v33, s24, v33
  v_mul_f32 v34, s24, v34
  v_mul_f32 v35, s24, v35
  v_cvt_pk_bf16_f32 v108, v20, v21
  v_cvt_pk_bf16_f32 v109, v22, v23
  v_cvt_pk_bf16_f32 v110, v28, v29
  v_cvt_pk_bf16_f32 v111, v30, v31
  buffer_store_dwordx4 v[108:111], v8, s[4:7], s77 offen offset:0 sc1
  v_cvt_pk_bf16_f32 v112, v24, v25
  v_cvt_pk_bf16_f32 v113, v26, v27
  v_cvt_pk_bf16_f32 v114, v32, v33
  v_cvt_pk_bf16_f32 v115, v34, v35
  buffer_store_dwordx4 v[112:115], v8, s[4:7], s77 offen offset:512 sc1
  v_cvt_pk_bf16_f32 v100, v36, v37
  v_cvt_pk_bf16_f32 v101, v38, v39
  v_cvt_pk_bf16_f32 v102, v44, v45
  v_cvt_pk_bf16_f32 v103, v46, v47
  buffer_store_dwordx4 v[100:103], v8, s[4:7], s77 offen offset:2048 sc1
  v_cvt_pk_bf16_f32 v104, v40, v41
  v_cvt_pk_bf16_f32 v105, v42, v43
  v_cvt_pk_bf16_f32 v106, v48, v49
  v_cvt_pk_bf16_f32 v107, v50, v51
  buffer_store_dwordx4 v[104:107], v8, s[4:7], s77 offen offset:2560 sc1
  buffer_store_dwordx4 v[108:111], v8, s[4:7], s44 offen offset:0 sc1
  buffer_store_dwordx4 v[112:115], v8, s[4:7], s44 offen offset:512 sc1
  buffer_store_dwordx4 v[100:103], v8, s[4:7], s44 offen offset:2048 sc1
  buffer_store_dwordx4 v[104:107], v8, s[4:7], s44 offen offset:2560 sc1
  buffer_load_dwordx4 v[68:71], v7, s[8:11], s35 offen offset:1024
  buffer_load_dwordx4 v[72:75], v7, s[8:11], s35 offen offset:2048
  buffer_load_dwordx4 v[76:79], v7, s[8:11], s35 offen offset:3072
  s_add_u32 s35, s35, 4096
  buffer_load_dwordx4 v[80:83], v7, s[8:11], s35 offen offset:0
  buffer_load_dwordx4 v[84:87], v7, s[8:11], s35 offen offset:1024
  buffer_load_dwordx4 v[88:91], v7, s[8:11], s35 offen offset:2048
  buffer_load_dwordx4 v[92:95], v7, s[8:11], s35 offen offset:3072
  s_add_u32 s35, s35, 4096
  buffer_load_dwordx4 v[96:99], v7, s[8:11], s35 offen offset:0
  buffer_load_dwordx4 v[100:103], v7, s[8:11], s35 offen offset:1024
  buffer_load_dwordx4 v[104:107], v7, s[8:11], s35 offen offset:2048
  buffer_load_dwordx4 v[108:111], v7, s[8:11], s35 offen offset:3072
  s_add_u32 s35, s35, 4096
  buffer_load_dwordx4 v[112:115], v7, s[8:11], s35 offen offset:0
  buffer_load_dwordx4 v[48:51], v7, s[8:11], s35 offen offset:1024
  s_mov_b32 vcc_lo, 0xaaaaaaaa
  s_mov_b32 vcc_hi, 0xaaaaaaaa
  v_mov_b32 v3, 0xffff
  v_mov_b32 v24, 0xffff0000
  v_cndmask_b32 v3, v3, v24, vcc
  s_mov_b32 vcc_lo, 0x3030303
  s_mov_b32 vcc_hi, 0x3030303
  v_cndmask_b32 v24, 0, v3, vcc
  s_mov_b32 vcc_lo, 0xc0c0c0c
  s_mov_b32 vcc_hi, 0xc0c0c0c
  v_cndmask_b32 v25, 0, v3, vcc
  s_mov_b32 vcc_lo, 0x30303030
  s_mov_b32 vcc_hi, 0x30303030
  v_cndmask_b32 v26, 0, v3, vcc
  s_mov_b32 vcc_lo, 0xc0c0c0c0
  s_mov_b32 vcc_hi, 0xc0c0c0c0
  v_cndmask_b32 v27, 0, v3, vcc
  s_mov_b32 s30, 0x01000100
  s_mov_b32 s31, 0x03020302
  s_mul_i32 s26, s17, 23552
  s_add_u32 s26, s26, 65536
  v_add_u32 v5, s26, v0
  v_add_u32 v2, s37, v0
  ds_read_b128 v[36:39], v5 offset:0
  ds_read_b128 v[40:43], v5 offset:1024
  ds_read_b128 v[44:47], v5 offset:2048
  ds_read_b128 v[12:15], v5 offset:3072
  ds_read_b128 v[16:19], v5 offset:4096
  ds_read_b128 v[120:123], v5 offset:5120
  ds_read_b128 v[124:127], v5 offset:6144
  s_waitcnt vmcnt(32)
  s_waitcnt vmcnt(17)
  s_mov_b64 exec, 1
  buffer_store_dword v4, off, s[4:7], s51 sc1
  s_mov_b64 exec, -1
  v_perm_b32 v3, v52, v52, s30
  v_and_b32 v20, v24, v3
  v_and_b32 v21, v25, v3
  v_and_b32 v22, v26, v3
  v_and_b32 v23, v27, v3
  s_waitcnt lgkmcnt(5)
  s_nop 0
  v_mfma_f32_16x16x32_bf16 v[28:31], v[20:23], v[36:39], 0
  ds_read_b128 v[36:39], v5 offset:7168
  v_mfma_f32_16x16x32_bf16 v[32:35], v[20:23], v[40:43], 0
  ds_read_b128 v[40:43], v5 offset:8192
  v_perm_b32 v3, v52, v52, s31
  v_and_b32 v20, v24, v3
  v_and_b32 v21, v25, v3
  v_and_b32 v22, v26, v3
  v_and_b32 v23, v27, v3
  s_waitcnt lgkmcnt(5)
  s_nop 0
  v_mfma_f32_16x16x32_bf16 v[28:31], v[20:23], v[44:47], v[28:31]
  ds_read_b128 v[44:47], v5 offset:9216
  v_mfma_f32_16x16x32_bf16 v[32:35], v[20:23], v[12:15], v[32:35]
  ds_read_b128 v[12:15], v5 offset:10240
  v_perm_b32 v3, v53, v53, s30
  v_and_b32 v20, v24, v3
  v_and_b32 v21, v25, v3
  v_and_b32 v22, v26, v3
  v_and_b32 v23, v27, v3
  s_waitcnt lgkmcnt(5)
  s_nop 0
  v_mfma_f32_16x16x32_bf16 v[28:31], v[20:23], v[16:19], v[28:31]
  ds_read_b128 v[16:19], v5 offset:11264
  v_mfma_f32_16x16x32_bf16 v[32:35], v[20:23], v[120:123], v[32:35]
  ds_read_b128 v[120:123], v5 offset:12288
  v_perm_b32 v3, v53, v53, s31
  v_and_b32 v20, v24, v3
  v_and_b32 v21, v25, v3
  v_and_b32 v22, v26, v3
  v_and_b32 v23, v27, v3
  s_waitcnt lgkmcnt(5)
  s_nop 0
  v_mfma_f32_16x16x32_bf16 v[28:31], v[20:23], v[124:127], v[28:31]
  ds_read_b128 v[124:127], v5 offset:13312
  v_mfma_f32_16x16x32_bf16 v[32:35], v[20:23], v[36:39], v[32:35]
  ds_read_b128 v[36:39], v5 offset:14336
  v_perm_b32 v3, v54, v54, s30
  v_and_b32 v20, v24, v3
  v_and_b32 v21, v25, v3
  v_and_b32 v22, v26, v3
  v_and_b32 v23, v27, v3
  s_waitcnt lgkmcnt(5)
  s_nop 0
  v_mfma_f32_16x16x32_bf16 v[28:31], v[20:23], v[40:43], v[28:31]
  ds_read_b128 v[40:43], v5 offset:15360
  v_mfma_f32_16x16x32_bf16 v[32:35], v[20:23], v[44:47], v[32:35]
  ds_read_b128 v[44:47], v5 offset:16384
  v_perm_b32 v3, v54, v54, s31
  v_and_b32 v20, v24, v3
  v_and_b32 v21, v25, v3
  v_and_b32 v22, v26, v3
  v_and_b32 v23, v27, v3
  s_waitcnt lgkmcnt(5)
  s_nop 0
  v_mfma_f32_16x16x32_bf16 v[28:31], v[20:23], v[12:15], v[28:31]
  ds_read_b128 v[12:15], v5 offset:17408
  v_mfma_f32_16x16x32_bf16 v[32:35], v[20:23], v[16:19], v[32:35]
  ds_read_b128 v[16:19], v5 offset:18432
  v_perm_b32 v3, v55, v55, s30
  v_and_b32 v20, v24, v3
  v_and_b32 v21, v25, v3
  v_and_b32 v22, v26, v3
  v_and_b32 v23, v27, v3
  s_waitcnt lgkmcnt(5)
  s_nop 0
  v_mfma_f32_16x16x32_bf16 v[28:31], v[20:23], v[120:123], v[28:31]
  ds_read_b128 v[120:123], v5 offset:19456
  v_mfma_f32_16x16x32_bf16 v[32:35], v[20:23], v[124:127], v[32:35]
  ds_read_b128 v[124:127], v5 offset:20480
  v_perm_b32 v3, v55, v55, s31
  v_and_b32 v20, v24, v3
  v_and_b32 v21, v25, v3
  v_and_b32 v22, v26, v3
  v_and_b32 v23, v27, v3
  s_waitcnt lgkmcnt(5)
  s_nop 0
  v_mfma_f32_16x16x32_bf16 v[28:31], v[20:23], v[36:39], v[28:31]
  ds_read_b128 v[36:39], v5 offset:21504
  v_mfma_f32_16x16x32_bf16 v[32:35], v[20:23], v[40:43], v[32:35]
  ds_read_b128 v[40:43], v5 offset:22528
  v_perm_b32 v3, v56, v56, s30
  v_and_b32 v20, v24, v3
  v_and_b32 v21, v25, v3
  v_and_b32 v22, v26, v3
  v_and_b32 v23, v27, v3
  s_waitcnt lgkmcnt(5)
  s_nop 0
  v_mfma_f32_16x16x32_bf16 v[28:31], v[20:23], v[44:47], v[28:31]
  ds_read_b128 v[44:47], v2 offset:0
  v_mfma_f32_16x16x32_bf16 v[32:35], v[20:23], v[12:15], v[32:35]
  ds_read_b128 v[12:15], v2 offset:1024
  v_perm_b32 v3, v56, v56, s31
  v_and_b32 v20, v24, v3
  v_and_b32 v21, v25, v3
  v_and_b32 v22, v26, v3
  v_and_b32 v23, v27, v3
  s_waitcnt lgkmcnt(5)
  s_nop 0
  v_mfma_f32_16x16x32_bf16 v[28:31], v[20:23], v[16:19], v[28:31]
  ds_read_b128 v[16:19], v2 offset:2048
  v_mfma_f32_16x16x32_bf16 v[32:35], v[20:23], v[120:123], v[32:35]
  ds_read_b128 v[120:123], v2 offset:3072
  v_perm_b32 v3, v57, v57, s30
  v_and_b32 v20, v24, v3
  v_and_b32 v21, v25, v3
  v_and_b32 v22, v26, v3
  v_and_b32 v23, v27, v3
  s_waitcnt lgkmcnt(5)
  s_nop 0
  v_mfma_f32_16x16x32_bf16 v[28:31], v[20:23], v[124:127], v[28:31]
  ds_read_b128 v[124:127], v2 offset:4096
  v_mfma_f32_16x16x32_bf16 v[32:35], v[20:23], v[36:39], v[32:35]
  ds_read_b128 v[36:39], v2 offset:5120
  v_perm_b32 v3, v57, v57, s31
  v_and_b32 v20, v24, v3
  v_and_b32 v21, v25, v3
  v_and_b32 v22, v26, v3
  v_and_b32 v23, v27, v3
  s_waitcnt lgkmcnt(5)
  s_nop 0
  v_mfma_f32_16x16x32_bf16 v[28:31], v[20:23], v[40:43], v[28:31]
  ds_read_b128 v[40:43], v2 offset:6144
  v_mfma_f32_16x16x32_bf16 v[32:35], v[20:23], v[44:47], v[32:35]
  ds_read_b128 v[44:47], v2 offset:7168
  v_perm_b32 v3, v58, v58, s30
  v_and_b32 v20, v24, v3
  v_and_b32 v21, v25, v3
  v_and_b32 v22, v26, v3
  v_and_b32 v23, v27, v3
  s_waitcnt lgkmcnt(5)
  s_nop 0
  v_mfma_f32_16x16x32_bf16 v[28:31], v[20:23], v[12:15], v[28:31]
  v_mfma_f32_16x16x32_bf16 v[32:35], v[20:23], v[16:19], v[32:35]
  v_perm_b32 v3, v58, v58, s31
  v_and_b32 v20, v24, v3
  v_and_b32 v21, v25, v3
  v_and_b32 v22, v26, v3
  v_and_b32 v23, v27, v3
  s_waitcnt lgkmcnt(3)
  s_nop 0
  v_mfma_f32_16x16x32_bf16 v[28:31], v[20:23], v[120:123], v[28:31]
  v_mfma_f32_16x16x32_bf16 v[32:35], v[20:23], v[124:127], v[32:35]
  v_perm_b32 v3, v59, v59, s30
  v_and_b32 v20, v24, v3
  v_and_b32 v21, v25, v3
  v_and_b32 v22, v26, v3
  v_and_b32 v23, v27, v3
  s_waitcnt lgkmcnt(1)
  s_nop 0
  v_mfma_f32_16x16x32_bf16 v[28:31], v[20:23], v[36:39], v[28:31]
  v_mfma_f32_16x16x32_bf16 v[32:35], v[20:23], v[40:43], v[32:35]
  v_perm_b32 v3, v59, v59, s31
  v_and_b32 v20, v24, v3
  v_and_b32 v21, v25, v3
  v_and_b32 v22, v26, v3
  v_and_b32 v23, v27, v3
  s_waitcnt lgkmcnt(0)
  s_nop 0
  v_mfma_f32_16x16x32_bf16 v[28:31], v[20:23], v[44:47], v[28:31]
  v_mfma_f32_16x16x32_bf16 v[32:35], v[20:23], v[60:63], v[32:35]
  v_lshrrev_b32 v2, 8, v0
  v_and_b32 v3, 0xf0, v0
  v_lshlrev_b32 v3, 1, v3
  v_and_b32 v5, 1, v2
  v_lshl_add_u32 v5, v5, 4, v3
  v_add_u32 v5, s37, v5
  s_mov_b32 exec_lo, 0x00ff00ff
  s_mov_b32 exec_hi, 0xff00ff00
  ds_write_b128 v5, v[28:31]
  ds_write_b128 v5, v[32:35] offset:512
  s_mov_b64 exec, -1
  s_xor_b32 s26, s50, 32768
  v_add_u32 v5, s26, v1
  v_lshl_add_u32 v3, v2, 4, v3
  s_waitcnt lgkmcnt(0)
  s_barrier
  ds_read2st64_b32 v[36:37], v5 offset0:0 offset1:1
  ds_read2st64_b32 v[52:53], v5 offset0:2 offset1:3
  ds_read2st64_b32 v[38:39], v5 offset0:32 offset1:33
  ds_read2st64_b32 v[54:55], v5 offset0:34 offset1:35
  ds_read2st64_b32 v[40:41], v5 offset0:64 offset1:65
  ds_read2st64_b32 v[56:57], v5 offset0:66 offset1:67
  ds_read2st64_b32 v[42:43], v5 offset0:96 offset1:97
  ds_read2st64_b32 v[58:59], v5 offset0:98 offset1:99
  s_waitcnt lgkmcnt(0)
  v_add_f32 v36, v36, v40
  v_add_f32 v37, v37, v41
  v_add_f32 v38, v38, v42
  v_add_f32 v39, v39, v43
  v_add_f32 v52, v52, v56
  v_add_f32 v53, v53, v57
  v_add_f32 v54, v54, v58
  v_add_f32 v55, v55, v59
  v_add_f32 v36, v36, v38
  v_add_f32 v37, v37, v39
  v_add_f32 v52, v52, v54
  v_add_f32 v53, v53, v55
  v_add_f32 v36, v36, v37
  v_add_f32 v52, v52, v53
  v_cvt_pk_bf16_f32 v36, 0, v36
  v_cvt_pk_bf16_f32 v52, 0, v52
  v_mul_f32 v40, 0xbfb8aa3b, v36
  v_exp_f32 v40, v40
  s_nop 0
  v_add_f32 v40, 1.0, v40
  v_rcp_f32 v40, v40
  s_nop 0
  v_mul_f32 v36, v36, v40
  v_cvt_pk_bf16_f32 v36, 0, v36
  v_mul_f32 v36, v36, v52
  v_cvt_pk_bf16_f32 v36, v36, v36
  s_lshl_b32 s26, s17, 8
  s_add_u32 s26, s26, 161792
  v_add_u32 v5, s26, v1
  ds_write_b32 v5, v36
  v_mul_u32_u24 v5, 56, v2
  v_add_u32 v5, s26, v5
  ds_read_b64 v[36:37], v5 offset:0
  ds_read_b64 v[38:39], v5 offset:8
  ds_read_b64 v[40:41], v5 offset:16
  ds_read_b64 v[42:43], v5 offset:24
  ds_read_b64 v[44:45], v5 offset:32
  ds_read_b64 v[46:47], v5 offset:40
  ds_read_b64 v[52:53], v5 offset:48
  s_waitcnt lgkmcnt(0)
  v_and_b32 v20, v24, v36
  v_and_b32 v21, v25, v36
  v_and_b32 v22, v26, v36
  v_and_b32 v23, v27, v36
  s_nop 0
  s_nop 0
  v_mfma_f32_16x16x32_bf16 v[28:31], v[20:23], v[64:67], 0
  v_and_b32 v32, v24, v37
  v_and_b32 v33, v25, v37
  v_and_b32 v34, v26, v37
  v_and_b32 v35, v27, v37
  s_waitcnt vmcnt(13)
  s_nop 0
  v_mfma_f32_16x16x32_bf16 v[28:31], v[32:35], v[68:71], v[28:31]
  v_and_b32 v20, v24, v38
  v_and_b32 v21, v25, v38
  v_and_b32 v22, v26, v38
  v_and_b32 v23, v27, v38
  s_waitcnt vmcnt(12)
  s_nop 0
  v_mfma_f32_16x16x32_bf16 v[28:31], v[20:23], v[72:75], v[28:31]
  v_and_b32 v32, v24, v39
  v_and_b32 v33, v25, v39
  v_and_b32 v34, v26, v39
  v_and_b32 v35, v27, v39
  s_waitcnt vmcnt(11)
  s_nop 0
  v_mfma_f32_16x16x32_bf16 v[28:31], v[32:35], v[76:79], v[28:31]
  v_and_b32 v20, v24, v40
  v_and_b32 v21, v25, v40
  v_and_b32 v22, v26, v40
  v_and_b32 v23, v27, v40
  s_waitcnt vmcnt(10)
  s_nop 0
  v_mfma_f32_16x16x32_bf16 v[28:31], v[20:23], v[80:83], v[28:31]
  v_and_b32 v32, v24, v41
  v_and_b32 v33, v25, v41
  v_and_b32 v34, v26, v41
  v_and_b32 v35, v27, v41
  s_waitcnt vmcnt(9)
  s_nop 0
  v_mfma_f32_16x16x32_bf16 v[28:31], v[32:35], v[84:87], v[28:31]
  v_and_b32 v20, v24, v42
  v_and_b32 v21, v25, v42
  v_and_b32 v22, v26, v42
  v_and_b32 v23, v27, v42
  s_waitcnt vmcnt(8)
  s_nop 0
  v_mfma_f32_16x16x32_bf16 v[28:31], v[20:23], v[88:91], v[28:31]
  v_and_b32 v32, v24, v43
  v_and_b32 v33, v25, v43
  v_and_b32 v34, v26, v43
  v_and_b32 v35, v27, v43
  s_waitcnt vmcnt(7)
  s_nop 0
  v_mfma_f32_16x16x32_bf16 v[28:31], v[32:35], v[92:95], v[28:31]
  v_and_b32 v20, v24, v44
  v_and_b32 v21, v25, v44
  v_and_b32 v22, v26, v44
  v_and_b32 v23, v27, v44
  s_waitcnt vmcnt(6)
  s_nop 0
  v_mfma_f32_16x16x32_bf16 v[28:31], v[20:23], v[96:99], v[28:31]
  v_and_b32 v32, v24, v45
  v_and_b32 v33, v25, v45
  v_and_b32 v34, v26, v45
  v_and_b32 v35, v27, v45
  s_waitcnt vmcnt(5)
  s_nop 0
  v_mfma_f32_16x16x32_bf16 v[28:31], v[32:35], v[100:103], v[28:31]
  v_and_b32 v20, v24, v46
  v_and_b32 v21, v25, v46
  v_and_b32 v22, v26, v46
  v_and_b32 v23, v27, v46
  s_waitcnt vmcnt(4)
  s_nop 0
  v_mfma_f32_16x16x32_bf16 v[28:31], v[20:23], v[104:107], v[28:31]
  v_and_b32 v32, v24, v47
  v_and_b32 v33, v25, v47
  v_and_b32 v34, v26, v47
  v_and_b32 v35, v27, v47
  s_waitcnt vmcnt(3)
  s_nop 0
  v_mfma_f32_16x16x32_bf16 v[28:31], v[32:35], v[108:111], v[28:31]
  v_and_b32 v20, v24, v52
  v_and_b32 v21, v25, v52
  v_and_b32 v22, v26, v52
  v_and_b32 v23, v27, v52
  s_waitcnt vmcnt(2)
  s_nop 0
  v_mfma_f32_16x16x32_bf16 v[28:31], v[20:23], v[112:115], v[28:31]
  v_and_b32 v32, v24, v53
  v_and_b32 v33, v25, v53
  v_and_b32 v34, v26, v53
  v_and_b32 v35, v27, v53
  s_waitcnt vmcnt(1)
  s_nop 0
  v_mfma_f32_16x16x32_bf16 v[28:31], v[32:35], v[48:51], v[28:31]
  v_lshrrev_b32 v3, 1, v3
  s_lshl_b32 s26, s46, 7
  s_add_u32 s26, s26, s57
  s_lshl_b32 s26, s26, 8
  s_add_u32 s26, s26, 244318208
  s_nop 2
  v_cvt_pk_bf16_f32 v28, v28, v29
  v_cvt_pk_bf16_f32 v29, v30, v31
  v_min_u32 v28, -2, v28
  v_min_u32 v29, -2, v29
  s_mov_b32 exec_hi, 0
  buffer_store_dwordx2 v[28:29], v3, s[4:7], s26 offen sc1
  s_mov_b32 exec_hi, -1
  v_lshrrev_b32 v7, 7, v0
  v_lshlrev_b32 v7, 12, v7
  v_and_b32 v2, 1023, v9
  s_lshl_b32 s26, s17, 10
  v_add3_u32 v7, v7, v2, s26
  v_mov_b32 v116, 0
  v_lshrrev_b32 v96, 9, v0
  v_lshlrev_b32 v96, 4, v96
  v_and_b32 v97, 0xf0, v0
  v_xor_b32 v96, v96, v97
  v_and_b32 v97, 0x1f0, v0
  v_lshl_add_u32 v96, v97, 6, v96
  v_add_u32 v96, s50, v96
  v_xor_b32 v120, 0, v96
  v_xor_b32 v121, 32, v96
  v_xor_b32 v122, 64, v96
  v_xor_b32 v123, 96, v96
  v_xor_b32 v124, 128, v96
  v_xor_b32 v125, 160, v96
  v_xor_b32 v126, 192, v96
  v_xor_b32 v127, 224, v96
  s_and_b32 s26, s17, 1
  s_lshl_b32 s26, s26, 7
  v_xor_b32 v96, s26, v0
  v_xor_b32 v12, 0, v96
  v_xor_b32 v13, 16, v96
  v_xor_b32 v14, 32, v96
  v_xor_b32 v15, 48, v96
  v_xor_b32 v16, 64, v96
  v_xor_b32 v17, 80, v96
  v_xor_b32 v18, 96, v96
  v_xor_b32 v19, 112, v96
  s_cmp_lt_u32 s47, 64
  s_cselect_b32 s26, 2, 0
  s_add_u32 s26, s26, s47
  s_lshl_b32 s26, s26, 12
  s_add_u32 s26, s26, 243261440
  s_mov_b64 exec, 0xffffff
  buffer_load_dword v116, v7, s[4:7], s26 offen sc1
  s_mov_b64 exec, -1
  s_lshl_b32 s26, s61, 21
  s_lshl_b32 s27, s59, 10
  s_add_u32 s26, s26, s27
  s_add_u32 s27, s26, 20971520
  s_add_u32 s28, s26, 27262976
  s_lshl_b32 s26, s46, 7
  s_add_u32 s26, s26, s17
  s_lshl_b32 s26, s26, 8
  s_add_u32 s26, s26, 244318208
  v_lshrrev_b32 v2, 8, v0
  v_and_b32 v3, 0xf0, v0
  v_lshl_add_u32 v5, v2, 10, v3
  buffer_load_dwordx4 v[108:111], v0, s[4:7], s27 offen sc1
  buffer_load_dwordx4 v[112:115], v0, s[4:7], s28 offen sc1
  s_mov_b32 s53, 0
  ds_read_b128 v[68:71], v120 offset:0
  ds_read_b128 v[72:75], v121 offset:0
  ds_read_b128 v[76:79], v122 offset:0
  ds_read_b128 v[80:83], v123 offset:0
  s_waitcnt lgkmcnt(2)
  v_mfma_f32_32x32x16_bf16 v[52:67], a[128:131], v[68:71], 0
  ds_read_b128 v[84:87], v124 offset:0
  ds_read_b128 v[88:91], v125 offset:0
  ds_read_b128 v[92:95], v126 offset:0
  v_mfma_f32_32x32x16_bf16 v[52:67], a[132:135], v[72:75], v[52:67]
  ds_read_b128 v[96:99], v127 offset:0
  s_waitcnt lgkmcnt(4)
  v_mfma_f32_32x32x16_bf16 v[52:67], a[136:139], v[76:79], v[52:67]
  ds_read_b128 v[68:71], v120 offset:256
  v_mfma_f32_32x32x16_bf16 v[52:67], a[140:143], v[80:83], v[52:67]
  ds_read_b128 v[72:75], v121 offset:256
  s_waitcnt lgkmcnt(4)
  v_mfma_f32_32x32x16_bf16 v[52:67], a[144:147], v[84:87], v[52:67]
  ds_read_b128 v[76:79], v122 offset:256
  v_mfma_f32_32x32x16_bf16 v[52:67], a[148:151], v[88:91], v[52:67]
  ds_read_b128 v[80:83], v123 offset:256
  s_waitcnt lgkmcnt(4)
  v_mfma_f32_32x32x16_bf16 v[52:67], a[152:155], v[92:95], v[52:67]
  ds_read_b128 v[84:87], v124 offset:256
  v_mfma_f32_32x32x16_bf16 v[52:67], a[156:159], v[96:99], v[52:67]
  ds_read_b128 v[88:91], v125 offset:256
  s_waitcnt lgkmcnt(4)
  v_mfma_f32_32x32x16_bf16 v[52:67], a[160:163], v[68:71], v[52:67]
  ds_read_b128 v[92:95], v126 offset:256
  v_mfma_f32_32x32x16_bf16 v[52:67], a[164:167], v[72:75], v[52:67]
  ds_read_b128 v[96:99], v127 offset:256
  s_waitcnt lgkmcnt(4)
  v_mfma_f32_32x32x16_bf16 v[52:67], a[168:171], v[76:79], v[52:67]
  ds_read_b128 v[68:71], v120 offset:512
  v_mfma_f32_32x32x16_bf16 v[52:67], a[172:175], v[80:83], v[52:67]
  ds_read_b128 v[72:75], v121 offset:512
  s_waitcnt lgkmcnt(4)
  v_mfma_f32_32x32x16_bf16 v[52:67], a[176:179], v[84:87], v[52:67]
  ds_read_b128 v[76:79], v122 offset:512
  v_mfma_f32_32x32x16_bf16 v[52:67], a[180:183], v[88:91], v[52:67]
  ds_read_b128 v[80:83], v123 offset:512
  s_waitcnt lgkmcnt(4)
  v_mfma_f32_32x32x16_bf16 v[52:67], a[184:187], v[92:95], v[52:67]
  ds_read_b128 v[84:87], v124 offset:512
  v_mfma_f32_32x32x16_bf16 v[52:67], a[188:191], v[96:99], v[52:67]
  ds_read_b128 v[88:91], v125 offset:512
  s_waitcnt lgkmcnt(4)
  v_mfma_f32_32x32x16_bf16 v[52:67], a[192:195], v[68:71], v[52:67]
  ds_read_b128 v[92:95], v126 offset:512
  v_mfma_f32_32x32x16_bf16 v[52:67], a[196:199], v[72:75], v[52:67]
  ds_read_b128 v[96:99], v127 offset:512
  s_waitcnt lgkmcnt(4)
  v_mfma_f32_32x32x16_bf16 v[52:67], a[200:203], v[76:79], v[52:67]
  ds_read_b128 v[68:71], v120 offset:768
  v_mfma_f32_32x32x16_bf16 v[52:67], a[204:207], v[80:83], v[52:67]
  ds_read_b128 v[72:75], v121 offset:768
  s_waitcnt lgkmcnt(4)
  v_mfma_f32_32x32x16_bf16 v[52:67], a[208:211], v[84:87], v[52:67]
  ds_read_b128 v[76:79], v122 offset:768
  v_mfma_f32_32x32x16_bf16 v[52:67], a[212:215], v[88:91], v[52:67]
  ds_read_b128 v[80:83], v123 offset:768
  s_waitcnt lgkmcnt(4)
  v_mfma_f32_32x32x16_bf16 v[52:67], a[216:219], v[92:95], v[52:67]
  ds_read_b128 v[84:87], v124 offset:768
  v_mfma_f32_32x32x16_bf16 v[52:67], a[220:223], v[96:99], v[52:67]
  ds_read_b128 v[88:91], v125 offset:768
  s_waitcnt lgkmcnt(4)
  v_mfma_f32_32x32x16_bf16 v[52:67], a[224:227], v[68:71], v[52:67]
  ds_read_b128 v[92:95], v126 offset:768
  v_mfma_f32_32x32x16_bf16 v[52:67], a[228:231], v[72:75], v[52:67]
  ds_read_b128 v[96:99], v127 offset:768
  s_waitcnt lgkmcnt(4)
  v_mfma_f32_32x32x16_bf16 v[52:67], a[232:235], v[76:79], v[52:67]
  v_mfma_f32_32x32x16_bf16 v[52:67], a[236:239], v[80:83], v[52:67]
  s_waitcnt lgkmcnt(2)
  v_mfma_f32_32x32x16_bf16 v[52:67], a[240:243], v[84:87], v[52:67]
  v_mfma_f32_32x32x16_bf16 v[52:67], a[244:247], v[88:91], v[52:67]
  s_waitcnt lgkmcnt(0)
  v_mfma_f32_32x32x16_bf16 v[52:67], a[248:251], v[92:95], v[52:67]
  v_mfma_f32_32x32x16_bf16 v[52:67], a[252:255], v[96:99], v[52:67]
  s_lshl_b32 s28, s52, 11
  s_add_u32 s77, s28, 159383552
  s_add_u32 s28, s28, 142606336
  s_add_u32 s51, s51, 262144
  s_nop 7
  v_cvt_pk_bf16_f32 v100, v52, v53
  v_cvt_pk_bf16_f32 v101, v54, v55
  v_cvt_pk_bf16_f32 v102, v60, v61
  v_cvt_pk_bf16_f32 v103, v62, v63
  v_cvt_pk_bf16_f32 v104, v56, v57
  v_cvt_pk_bf16_f32 v105, v58, v59
  v_cvt_pk_bf16_f32 v106, v64, v65
  v_cvt_pk_bf16_f32 v107, v66, v67
m_w_105:
  s_add_u32 s27, s26, 0
  buffer_load_dwordx4 v[20:23], v5, s[4:7], s27 offen sc1
  s_add_u32 s27, s26, 4096
  buffer_load_dwordx4 v[24:27], v5, s[4:7], s27 offen sc1
  s_add_u32 s27, s26, 8192
  buffer_load_dwordx4 v[28:31], v5, s[4:7], s27 offen sc1
  s_add_u32 s27, s26, 12288
  buffer_load_dwordx4 v[32:35], v5, s[4:7], s27 offen sc1
  s_add_u32 s27, s26, 16384
  buffer_load_dwordx4 v[36:39], v5, s[4:7], s27 offen sc1
  s_add_u32 s27, s26, 20480
  buffer_load_dwordx4 v[40:43], v5, s[4:7], s27 offen sc1
  s_add_u32 s27, s26, 24576
  buffer_load_dwordx4 v[44:47], v5, s[4:7], s27 offen sc1
  s_add_u32 s27, s26, 28672
  buffer_load_dwordx4 v[48:51], v5, s[4:7], s27 offen sc1
  s_add_u32 s53, s53, 1
  s_cmp_gt_u32 s53, 1048576
  s_cbranch_scc1 q_fail_90
  s_mov_b32 vcc_lo, 0xaaaaaaaa
  s_mov_b32 vcc_hi, 0xaaaaaaaa
  v_mov_b32 v72, 0x3f80
  v_mov_b32 v68, 1.0
  v_cndmask_b32 v72, v72, v68, vcc
  s_mov_b32 vcc_lo, 0x30003
  s_mov_b32 vcc_hi, 0x30003
  v_cndmask_b32 v68, 0, v72, vcc
  s_mov_b32 vcc_lo, 0xc000c
  s_mov_b32 vcc_hi, 0xc000c
  v_cndmask_b32 v69, 0, v72, vcc
  s_mov_b32 vcc_lo, 0x300030
  s_mov_b32 vcc_hi, 0x300030
  v_cndmask_b32 v70, 0, v72, vcc
  s_mov_b32 vcc_lo, 0xc000c0
  s_mov_b32 vcc_hi, 0xc000c0
  v_cndmask_b32 v71, 0, v72, vcc
  s_waitcnt vmcnt(7)
  s_nop 0
  v_mfma_f32_16x16x32_bf16 v[72:75], v[68:71], v[20:23], 0
  v_max3_u32 v80, v20, v21, 0
  v_max3_u32 v80, v22, v23, v80
  s_waitcnt vmcnt(6)
  v_mfma_f32_16x16x32_bf16 v[72:75], v[68:71], v[24:27], v[72:75]
  v_max3_u32 v80, v24, v25, v80
  v_max3_u32 v80, v26, v27, v80
  s_waitcnt vmcnt(5)
  v_mfma_f32_16x16x32_bf16 v[72:75], v[68:71], v[28:31], v[72:75]
  v_max3_u32 v80, v28, v29, v80
  v_max3_u32 v80, v30, v31, v80
  s_waitcnt vmcnt(4)
  v_mfma_f32_16x16x32_bf16 v[72:75], v[68:71], v[32:35], v[72:75]
  v_max3_u32 v80, v32, v33, v80
  v_max3_u32 v80, v34, v35, v80
  s_waitcnt vmcnt(3)
  v_mfma_f32_16x16x32_bf16 v[72:75], v[68:71], v[36:39], v[72:75]
  v_max3_u32 v80, v36, v37, v80
  v_max3_u32 v80, v38, v39, v80
  s_waitcnt vmcnt(2)
  v_mfma_f32_16x16x32_bf16 v[72:75], v[68:71], v[40:43], v[72:75]
  v_max3_u32 v80, v40, v41, v80
  v_max3_u32 v80, v42, v43, v80
  s_waitcnt vmcnt(1)
  v_mfma_f32_16x16x32_bf16 v[72:75], v[68:71], v[44:47], v[72:75]
  v_max3_u32 v80, v44, v45, v80
  v_max3_u32 v80, v46, v47, v80
  s_waitcnt vmcnt(0)
  v_mfma_f32_16x16x32_bf16 v[72:75], v[68:71], v[48:51], v[72:75]
  v_max3_u32 v80, v48, v49, v80
  v_max3_u32 v80, v50, v51, v80
  v_cmp_eq_u32 vcc, -1, v80
  s_cbranch_vccnz m_w_105
  v_lshlrev_b32 v3, 1, v3
  v_lshl_add_u32 v3, v2, 4, v3
  s_lshl_b32 s26, s17, 9
  s_add_u32 s26, s26, 159744
  v_add_u32 v3, s26, v3
  s_mov_b32 exec_hi, 0
  ds_write_b128 v3, v[72:75]
  s_mov_b32 exec_hi, -1
  v_lshlrev_b32 v3, 1, v0
  v_add_u32 v3, 159744, v3
  buffer_store_dwordx4 v[100:103], v8, s[4:7], s77 offen offset:0 sc1
  buffer_store_dwordx4 v[104:107], v8, s[4:7], s77 offen offset:512 sc1
  buffer_store_dwordx4 v[100:103], v8, s[4:7], s28 offen offset:0 sc1
  buffer_store_dwordx4 v[104:107], v8, s[4:7], s28 offen offset:512 sc1
  v_lshlrev_b32 v80, 16, v108
  v_and_b32 v81, 0xffff0000, v108
  v_lshlrev_b32 v82, 16, v109
  v_and_b32 v83, 0xffff0000, v109
  v_lshlrev_b32 v84, 16, v110
  v_and_b32 v85, 0xffff0000, v110
  v_lshlrev_b32 v86, 16, v111
  v_and_b32 v87, 0xffff0000, v111
  v_lshlrev_b32 v88, 16, v112
  v_and_b32 v89, 0xffff0000, v112
  v_lshlrev_b32 v90, 16, v113
  v_and_b32 v91, 0xffff0000, v113
  v_lshlrev_b32 v92, 16, v114
  v_and_b32 v93, 0xffff0000, v114
  v_lshlrev_b32 v94, 16, v115
  v_and_b32 v95, 0xffff0000, v115
  s_waitcnt lgkmcnt(0)
  s_barrier
  s_cmp_lg_u32 s17, 0
  s_cbranch_scc1 m_done_104
  ds_read_b128 v[72:75], v3
  ds_read_b128 v[76:79], v3 offset:16
  s_and_b32 s29, s58, 0xffff0000
  s_xor_b32 s27, s29, 0x80000000
  s_xor_b32 s28, s29, 0xffff0000
  s_bitcmp1_b32 s29, 31
  s_cselect_b32 s29, s27, s28
  v_mov_b32 v108, s29
  v_mul_f32 v108, 0xbfb8aa3b, v108
  v_exp_f32 v108, v108
  s_nop 0
  v_add_f32 v108, 1.0, v108
  v_rcp_f32 v108, v108
  s_nop 0
  v_cvt_pk_bf16_f32 v108, 0, v108
  s_waitcnt lgkmcnt(0)
  v_cvt_pk_bf16_f32 v72, 0, v72
  v_cvt_pk_bf16_f32 v73, 0, v73
  v_cvt_pk_bf16_f32 v74, 0, v74
  v_cvt_pk_bf16_f32 v75, 0, v75
  v_cvt_pk_bf16_f32 v76, 0, v76
  v_cvt_pk_bf16_f32 v77, 0, v77
  v_cvt_pk_bf16_f32 v78, 0, v78
  v_cvt_pk_bf16_f32 v79, 0, v79
  v_mul_f32 v72, v72, v108
  v_mul_f32 v73, v73, v108
  v_mul_f32 v74, v74, v108
  v_mul_f32 v75, v75, v108
  v_mul_f32 v76, v76, v108
  v_mul_f32 v77, v77, v108
  v_mul_f32 v78, v78, v108
  v_mul_f32 v79, v79, v108
  v_cvt_pk_bf16_f32 v72, 0, v72
  v_cvt_pk_bf16_f32 v73, 0, v73
  v_cvt_pk_bf16_f32 v74, 0, v74
  v_cvt_pk_bf16_f32 v75, 0, v75
  v_cvt_pk_bf16_f32 v76, 0, v76
  v_cvt_pk_bf16_f32 v77, 0, v77
  v_cvt_pk_bf16_f32 v78, 0, v78
  v_cvt_pk_bf16_f32 v79, 0, v79
  v_add_f32 v72, v72, v88
  v_add_f32 v73, v73, v89
  v_add_f32 v74, v74, v90
  v_add_f32 v75, v75, v91
  v_add_f32 v76, v76, v92
  v_add_f32 v77, v77, v93
  v_add_f32 v78, v78, v94
  v_add_f32 v79, v79, v95
  v_cvt_pk_bf16_f32 v72, 0, v72
  v_cvt_pk_bf16_f32 v73, 0, v73
  v_cvt_pk_bf16_f32 v74, 0, v74
  v_cvt_pk_bf16_f32 v75, 0, v75
  v_cvt_pk_bf16_f32 v76, 0, v76
  v_cvt_pk_bf16_f32 v77, 0, v77
  v_cvt_pk_bf16_f32 v78, 0, v78
  v_cvt_pk_bf16_f32 v79, 0, v79
  v_add_f32 v80, v80, v72
  v_add_f32 v81, v81, v73
  v_add_f32 v82, v82, v74
  v_add_f32 v83, v83, v75
  v_add_f32 v84, v84, v76
  v_add_f32 v85, v85, v77
  v_add_f32 v86, v86, v78
  v_add_f32 v87, v87, v79
  v_cvt_pk_bf16_f32 v112, v80, v81
  v_cvt_pk_bf16_f32 v113, v82, v83
  v_cvt_pk_bf16_f32 v114, v84, v85
  v_cvt_pk_bf16_f32 v115, v86, v87
  v_lshlrev_b32 v80, 16, v112
  v_and_b32 v81, 0xffff0000, v112
  v_lshlrev_b32 v82, 16, v113
  v_and_b32 v83, 0xffff0000, v113
  v_lshlrev_b32 v84, 16, v114
  v_and_b32 v85, 0xffff0000, v114
  v_lshlrev_b32 v86, 16, v115
  v_and_b32 v87, 0xffff0000, v115
  s_lshl_b32 s27, s46, 5
  s_add_u32 s27, s27, s16
  s_lshl_b32 s27, s27, 10
  s_add_u32 s27, s27, 33554432
  buffer_store_dwordx4 v[112:115], v0, s[4:7], s27 offen sc1
  v_add_f32 v20, v80, v81
  v_mul_f32 v21, v80, v80
  v_add_f32 v22, v82, v83
  v_mul_f32 v23, v81, v81
  v_fmac_f32 v21, v82, v82
  v_fmac_f32 v23, v83, v83
  v_add_f32 v20, v20, v84
  v_fmac_f32 v21, v84, v84
  v_add_f32 v22, v22, v85
  v_fmac_f32 v23, v85, v85
  v_add_f32 v20, v20, v86
  v_fmac_f32 v21, v86, v86
  v_add_f32 v22, v22, v87
  v_fmac_f32 v23, v87, v87
  v_add_f32 v20, v20, v22
  v_add_f32 v21, v21, v23
  s_nop 0
  v_add_f32_dpp v20, v20, v20 row_ror:8 row_mask:0xf bank_mask:0xf
  v_add_f32_dpp v21, v21, v21 row_ror:8 row_mask:0xf bank_mask:0xf
  s_nop 0
  v_add_f32_dpp v20, v20, v20 row_ror:4 row_mask:0xf bank_mask:0xf
  v_add_f32_dpp v21, v21, v21 row_ror:4 row_mask:0xf bank_mask:0xf
  s_nop 0
  v_add_f32_dpp v20, v20, v20 row_ror:2 row_mask:0xf bank_mask:0xf
  v_add_f32_dpp v21, v21, v21 row_ror:2 row_mask:0xf bank_mask:0xf
  s_nop 0
  v_add_f32_dpp v20, v20, v20 row_ror:1 row_mask:0xf bank_mask:0xf
  v_add_f32_dpp v21, v21, v21 row_ror:1 row_mask:0xf bank_mask:0xf
  v_mov_b32 v24, v20
  v_mov_b32 v25, v21
  s_nop 0
  v_permlane16_swap_b32 v20, v24
  v_permlane16_swap_b32 v21, v25
  v_add_f32 v20, v20, v24
  v_add_f32 v21, v21, v25
  v_mov_b32 v24, v20
  v_mov_b32 v25, v21
  s_nop 0
  v_permlane32_swap_b32 v20, v24
  v_permlane32_swap_b32 v21, v25
  v_add_f32 v20, v20, v24
  v_add_f32 v21, v21, v25
  v_mul_f32 v20, 0x3b000000, v20
  v_mul_f32 v21, 0x3b000000, v21
  v_fma_f32 v21, -v20, v20, v21
  v_cvt_pk_bf16_f32 v20, 0, v20
  v_max_f32 v21, 0, v21
  v_sub_f32 v24, v80, v20
  v_sub_f32 v25, v81, v20
  v_cvt_pk_bf16_f32 v21, 0, v21
  v_sub_f32 v26, v82, v20
  v_sub_f32 v27, v83, v20
  v_add_f32 v21, 0x3727c5ac, v21
  v_sub_f32 v28, v84, v20
  v_sub_f32 v29, v85, v20
  v_cvt_pk_bf16_f32 v21, 0, v21
  v_sub_f32 v30, v86, v20
  v_sub_f32 v31, v87, v20
  v_sqrt_f32 v21, v21
  v_cvt_pk_bf16_f32 v24, 0, v24
  v_cvt_pk_bf16_f32 v25, 0, v25
  v_cvt_pk_bf16_f32 v21, 0, v21
  v_cvt_pk_bf16_f32 v26, 0, v26
  v_cvt_pk_bf16_f32 v27, 0, v27
  v_rcp_f32 v21, v21
  v_cvt_pk_bf16_f32 v28, 0, v28
  v_cvt_pk_bf16_f32 v29, 0, v29
  v_cvt_pk_bf16_f32 v30, 0, v30
  v_cvt_pk_bf16_f32 v31, 0, v31
  v_mul_f32 v24, v24, v21
  v_mul_f32 v25, v25, v21
  v_mul_f32 v26, v26, v21
  v_mul_f32 v27, v27, v21
  v_mul_f32 v28, v28, v21
  v_mul_f32 v29, v29, v21
  v_mul_f32 v30, v30, v21
  v_mul_f32 v31, v31, v21
  v_cvt_pk_bf16_f32 v32, v24, v25
  v_cvt_pk_bf16_f32 v33, v26, v27
  v_cvt_pk_bf16_f32 v34, v28, v29
  v_cvt_pk_bf16_f32 v35, v30, v31
  v_lshl_add_u32 v3, v0, 2, s50
  v_mov_b64 v[20:21], 0
  v_mov_b64 v[24:25], 0
  v_mov_b64 v[28:29], 0
  v_mov_b32 v22, v32
  v_mov_b32 v23, v34
  v_mov_b32 v26, v33
  v_mov_b32 v27, v35
  ds_write_b128 v3, v[22:25] offset:4096
  ds_write_b128 v3, v[20:23] offset:4112
  ds_write_b128 v3, v[26:29] offset:4128
  ds_write_b128 v3, v[24:27] offset:4144
m_done_104:
  v_lshrrev_b32 v96, 9, v0
  v_lshlrev_b32 v96, 4, v96
  v_and_b32 v97, 0xf0, v0
  v_xor_b32 v96, v96, v97
  v_and_b32 v97, 0x1f0, v0
  v_lshl_add_u32 v96, v97, 6, v96
  v_xor_b32 v120, 0, v96
  v_xor_b32 v121, 32, v96
  v_xor_b32 v122, 64, v96
  v_xor_b32 v123, 96, v96
  v_xor_b32 v124, 128, v96
  v_xor_b32 v125, 160, v96
  v_xor_b32 v126, 192, v96
  v_xor_b32 v127, 224, v96
  s_and_b32 s26, s17, 1
  s_lshl_b32 s26, s26, 7
  v_xor_b32 v96, s26, v0
  v_xor_b32 v12, 0, v96
  v_xor_b32 v13, 16, v96
  v_xor_b32 v14, 32, v96
  v_xor_b32 v15, 48, v96
  v_xor_b32 v16, 64, v96
  v_xor_b32 v17, 80, v96
  v_xor_b32 v18, 96, v96
  v_xor_b32 v19, 112, v96
  v_cmp_eq_u32 vcc, 0, v116
  v_max_u32_dpp v117, v116, v116 quad_perm:[1,0,3,2] row_mask:0xf bank_mask:0xf
  s_and_b32 s48, vcc_lo, 0xffffff
  s_cselect_b32 s48, 0, -1
  v_max_u32_dpp v117, v117, v117 quad_perm:[2,3,0,1] row_mask:0xf bank_mask:0xf
  s_nop 1
  v_max_u32_dpp v117, v117, v117 row_half_mirror row_mask:0xf bank_mask:0xf
  v_and_b32 v117, s48, v117
  s_cmp_eq_u32 s48, 0
  s_cbranch_scc1 q_nb_106
  s_and_b32 s63, s47, 127
  s_lshl_b32 s63, s63, 15
  s_xor_b32 s27, s50, 32768
  s_add_u32 m0, s27, s54
  s_add_u32 s63, s63, s54
  s_add_u32 s63, s63, 6291456
  buffer_load_dwordx4 v12, s[4:7], s63 offen offset:0 sc1 lds
  buffer_load_dwordx4 v13, s[4:7], s63 offen offset:1024 sc1 lds
  buffer_load_dwordx4 v14, s[4:7], s63 offen offset:2048 sc1 lds
  buffer_load_dwordx4 v15, s[4:7], s63 offen offset:3072 sc1 lds
  s_add_u32 m0, m0, 4096
  s_add_u32 s63, s63, 4096
  buffer_load_dwordx4 v16, s[4:7], s63 offen offset:0 sc1 lds
  buffer_load_dwordx4 v17, s[4:7], s63 offen offset:1024 sc1 lds
  buffer_load_dwordx4 v18, s[4:7], s63 offen offset:2048 sc1 lds
  buffer_load_dwordx4 v19, s[4:7], s63 offen offset:3072 sc1 lds
q_nb_106:
  v_lshrrev_b32 v2, 8, v0
  v_and_b32 v3, 48, v0
  v_lshl_add_u32 v3, v2, 6, v3
  v_add_u32 v3, s50, v3
  s_mov_b32 vcc_lo, 0xcccccccc
  s_mov_b32 vcc_hi, 0xcccccccc
  v_mov_b32 v32, 0x4444
  v_mov_b32 v33, 0xeeee
  v_cndmask_b32 v32, v32, v33, vcc
  s_waitcnt lgkmcnt(0)
  s_barrier
  ds_read_b128 v[36:39], v3 offset:4096
  ds_read_b128 v[40:43], v3 offset:4352
  ds_read_b128 v[44:47], v3 offset:4608
  ds_read_b128 v[48:51], v3 offset:4864
  ds_read_b128 v[52:55], v3 offset:5120
  ds_read_b128 v[56:59], v3 offset:5376
  ds_read_b128 v[60:63], v3 offset:5632
  ds_read_b128 v[64:67], v3 offset:5888
  v_mov_b64 v[20:21], 0
  v_mov_b64 v[22:23], 0
  v_mov_b64 v[24:25], 0
  v_mov_b64 v[26:27], 0
  v_mov_b64 v[28:29], 0
  v_mov_b64 v[30:31], 0
  s_waitcnt lgkmcnt(7)
  v_smfmac_f32_16x16x64_bf16 v[20:23], v[36:39], v[128:135], v32
  ds_read_b128 v[68:71], v3 offset:6144
  v_smfmac_f32_16x16x64_bf16 v[24:27], v[36:39], a[0:7], v32
  s_and_b32 s26, s59, 16
  v_smfmac_f32_16x16x64_bf16 v[28:31], v[36:39], a[128:135], v32
  s_lshl_b32 s27, s26, 6
  s_waitcnt lgkmcnt(7)
  v_smfmac_f32_16x16x64_bf16 v[20:23], v[40:43], v[136:143], v32
  ds_read_b128 v[72:75], v3 offset:6400
  v_smfmac_f32_16x16x64_bf16 v[24:27], v[40:43], a[8:15], v32
  s_and_b32 s28, s59, 15
  v_smfmac_f32_16x16x64_bf16 v[28:31], v[40:43], a[136:143], v32
  s_lshl4_add_u32 s27, s28, s27
  s_waitcnt lgkmcnt(7)
  v_smfmac_f32_16x16x64_bf16 v[20:23], v[44:47], v[144:151], v32
  ds_read_b128 v[76:79], v3 offset:6656
  v_smfmac_f32_16x16x64_bf16 v[24:27], v[44:47], a[16:23], v32
  s_add_u32 s77, s77, s27
  v_smfmac_f32_16x16x64_bf16 v[28:31], v[44:47], a[144:151], v32
  s_add_u32 s27, s27, s44
  s_waitcnt lgkmcnt(7)
  v_smfmac_f32_16x16x64_bf16 v[20:23], v[48:51], v[152:159], v32
  ds_read_b128 v[80:83], v3 offset:6912
  v_smfmac_f32_16x16x64_bf16 v[24:27], v[48:51], a[24:31], v32
  s_lshr_b32 s26, s26, 1
  v_smfmac_f32_16x16x64_bf16 v[28:31], v[48:51], a[152:159], v32
  s_and_b32 s28, s59, 3
  s_waitcnt lgkmcnt(7)
  v_smfmac_f32_16x16x64_bf16 v[20:23], v[52:55], v[160:167], v32
  ds_read_b128 v[84:87], v3 offset:7168
  v_smfmac_f32_16x16x64_bf16 v[24:27], v[52:55], a[32:39], v32
  s_lshl1_add_u32 s26, s28, s26
  v_smfmac_f32_16x16x64_bf16 v[28:31], v[52:55], a[160:167], v32
  s_and_b32 s28, s59, 12
  s_waitcnt lgkmcnt(7)
  v_smfmac_f32_16x16x64_bf16 v[20:23], v[56:59], v[168:175], v32
  ds_read_b128 v[88:91], v3 offset:7424
  v_smfmac_f32_16x16x64_bf16 v[24:27], v[56:59], a[40:47], v32
  s_lshl_b32 s28, s28, 6
  v_smfmac_f32_16x16x64_bf16 v[28:31], v[56:59], a[168:175], v32
  s_add_u32 s26, s26, s28
  s_waitcnt lgkmcnt(7)
  v_smfmac_f32_16x16x64_bf16 v[20:23], v[60:63], v[176:183], v32
  ds_read_b128 v[92:95], v3 offset:7680
  v_smfmac_f32_16x16x64_bf16 v[24:27], v[60:63], a[48:55], v32
  s_add_u32 s26, s26, s44
  v_smfmac_f32_16x16x64_bf16 v[28:31], v[60:63], a[176:183], v32
  v_and_b32 v2, 0xc0, v0
  s_waitcnt lgkmcnt(7)
  v_smfmac_f32_16x16x64_bf16 v[20:23], v[64:67], v[184:191], v32
  ds_read_b128 v[96:99], v3 offset:7936
  v_smfmac_f32_16x16x64_bf16 v[24:27], v[64:67], a[56:63], v32
  v_and_b32 v5, 12, v1
  v_smfmac_f32_16x16x64_bf16 v[28:31], v[64:67], a[184:191], v32
  v_lshrrev_b32 v5, 1, v5
  s_waitcnt lgkmcnt(7)
  v_smfmac_f32_16x16x64_bf16 v[20:23], v[68:71], v[192:199], v32
  v_lshl_add_u32 v2, v2, 2, v5
  v_smfmac_f32_16x16x64_bf16 v[24:27], v[68:71], a[64:71], v32
  v_smfmac_f32_16x16x64_bf16 v[28:31], v[68:71], a[192:199], v32
  s_waitcnt lgkmcnt(6)
  v_smfmac_f32_16x16x64_bf16 v[20:23], v[72:75], v[200:207], v32
  v_smfmac_f32_16x16x64_bf16 v[24:27], v[72:75], a[72:79], v32
  v_smfmac_f32_16x16x64_bf16 v[28:31], v[72:75], a[200:207], v32
  s_waitcnt lgkmcnt(5)
  v_smfmac_f32_16x16x64_bf16 v[20:23], v[76:79], v[208:215], v32
  v_smfmac_f32_16x16x64_bf16 v[24:27], v[76:79], a[80:87], v32
  v_smfmac_f32_16x16x64_bf16 v[28:31], v[76:79], a[208:215], v32
  s_waitcnt lgkmcnt(4)
  v_smfmac_f32_16x16x64_bf16 v[20:23], v[80:83], v[216:223], v32
  v_smfmac_f32_16x16x64_bf16 v[24:27], v[80:83], a[88:95], v32
  v_smfmac_f32_16x16x64_bf16 v[28:31], v[80:83], a[216:223], v32
  s_waitcnt lgkmcnt(3)
  v_smfmac_f32_16x16x64_bf16 v[20:23], v[84:87], v[224:231], v32
  v_smfmac_f32_16x16x64_bf16 v[24:27], v[84:87], a[96:103], v32
  v_smfmac_f32_16x16x64_bf16 v[28:31], v[84:87], a[224:231], v32
  s_waitcnt lgkmcnt(2)
  v_smfmac_f32_16x16x64_bf16 v[20:23], v[88:91], v[232:239], v32
  v_smfmac_f32_16x16x64_bf16 v[24:27], v[88:91], a[104:111], v32
  v_smfmac_f32_16x16x64_bf16 v[28:31], v[88:91], a[232:239], v32
  s_waitcnt lgkmcnt(1)
  v_smfmac_f32_16x16x64_bf16 v[20:23], v[92:95], v[240:247], v32
  v_smfmac_f32_16x16x64_bf16 v[24:27], v[92:95], a[112:119], v32
  v_smfmac_f32_16x16x64_bf16 v[28:31], v[92:95], a[240:247], v32
  s_waitcnt lgkmcnt(0)
  v_smfmac_f32_16x16x64_bf16 v[20:23], v[96:99], v[248:255], v32
  v_smfmac_f32_16x16x64_bf16 v[24:27], v[96:99], a[120:127], v32
  v_smfmac_f32_16x16x64_bf16 v[28:31], v[96:99], a[248:255], v32
  v_add_f32 v20, v20, v22
  v_add_f32 v21, v21, v23
  s_nop 1
  v_add_f32 v24, v24, v26
  v_add_f32 v25, v25, v27
  s_nop 1
  v_add_f32 v28, v28, v30
  v_add_f32 v29, v29, v31
  v_mul_f32 v20, s24, v20
  v_mul_f32 v21, s24, v21
  v_cvt_pk_bf16_f32 v20, v20, v21
  v_cvt_pk_bf16_f32 v24, v24, v25
  v_cvt_pk_bf16_f32 v28, v28, v29
  s_mov_b64 exec, 0xffff
  s_waitcnt vmcnt(0)
  buffer_store_short v20, v2, s[4:7], s27 offen sc1
  buffer_store_short_d16_hi v20, v2, s[4:7], s27 offen offset:8 sc1
  buffer_store_short v24, v0, s[4:7], s26 offen offset:2048 sc1
  buffer_store_short_d16_hi v24, v0, s[4:7], s26 offen offset:3072 sc1
  buffer_store_short v28, v2, s[4:7], s77 offen sc1
  buffer_store_short_d16_hi v28, v2, s[4:7], s77 offen offset:8 sc1
  s_mov_b64 exec, 3
  s_waitcnt vmcnt(0)
  buffer_store_dword v4, v0, s[4:7], s51 offen sc1
  s_mov_b64 exec, 3
  buffer_store_dword v4, v0, s[4:7], s49 offen sc1
  s_mov_b64 exec, -1
  s_mov_b32 s49, 268435456
  v_mov_b32 v4, 1
  s_branch q_nxt_96
q_end_87:
  s_waitcnt vmcnt(0)
  s_mov_b64 exec, 3
  buffer_store_dword v4, v0, s[4:7], s49 offen sc1
  s_mov_b64 exec, -1
  s_cmp_lg_u32 s60, 0
  s_cbranch_scc1 q_fail_90
  s_load_dwordx2 s[72:73], s[0:1], 96
  s_mov_b32 s74, 2097152
  s_mov_b32 s75, 0x20000
  s_mov_b32 s58, 0
  s_cmp_eq_u32 s17, 3
  s_cselect_b32 s48, 7, 15
k_fin_107:
  s_load_dwordx2 s[64:65], s[0:1], 72
  s_load_dwordx2 s[68:69], s[0:1], 80
  s_load_dwordx2 s[8:9], s[0:1], 88
  s_mov_b32 s66, 1835008
  s_mov_b32 s70, 1835008
  s_mov_b32 s10, 1835008
  v_lshrrev_b32 v2, 7, v0
  v_and_b32 v3, 0x70, v0
  v_mul_u32_u24 v6, 57344, v2
  v_add_u32 v6, v6, v3
  v_cmp_eq_u32 vcc, 0x70, v3
  v_mov_b32 v3, 0x7ff00000
  s_nop 0
  v_cndmask_b32 v6, v6, v3, vcc
  v_lshrrev_b32 v2, 8, v0
  v_mul_u32_u24 v7, 14336, v2
  v_and_b32 v3, 0xf0, v0
  v_add_u32 v7, v7, v3
  s_mul_i32 s34, s17, 458752
  s_mul_i32 s27, s16, 112
  s_add_u32 s34, s34, s27
  s_mul_i32 s35, s16, 57344
  s_lshl_b32 s27, s17, 8
  s_add_u32 s35, s35, s27
  s_waitcnt lgkmcnt(0)
  s_xor_b32 s37, s50, 32768
  s_add_u32 s37, s37, s54
  s_mov_b32 m0, s37
  s_add_u32 s36, s34, 39424
  buffer_load_dwordx4 v6, s[68:71], s36 offen lds
  s_add_u32 m0, m0, 1024
  s_add_u32 s36, s34, 43008
  buffer_load_dwordx4 v6, s[64:67], s36 offen lds
  s_add_u32 m0, m0, 1024
  s_add_u32 s36, s34, 43008
  buffer_load_dwordx4 v6, s[68:71], s36 offen lds
  s_add_u32 m0, m0, 1024
  s_add_u32 s36, s34, 46592
  buffer_load_dwordx4 v6, s[64:67], s36 offen lds
  s_add_u32 m0, m0, 1024
  s_add_u32 s36, s34, 46592
  buffer_load_dwordx4 v6, s[68:71], s36 offen lds
  s_add_u32 m0, m0, 1024
  s_add_u32 s36, s34, 50176
  buffer_load_dwordx4 v6, s[64:67], s36 offen lds
  s_add_u32 m0, m0, 1024
  s_add_u32 s36, s34, 50176
  buffer_load_dwordx4 v6, s[68:71], s36 offen lds
  s_add_u32 m0, m0, 1024
  s_add_u32 s36, s34, 53760
  buffer_load_dwordx4 v6, s[64:67], s36 offen lds
  s_add_u32 m0, m0, 1024
  s_add_u32 s36, s34, 53760
  buffer_load_dwordx4 v[60:63], v6, s[68:71], s36 offen
  buffer_load_dwordx4 v[64:67], v7, s[8:11], s35 offen offset:0
  buffer_load_dwordx4 v[68:71], v7, s[8:11], s35 offen offset:1024
  buffer_load_dwordx4 v[72:75], v7, s[8:11], s35 offen offset:2048
  buffer_load_dwordx4 v[76:79], v7, s[8:11], s35 offen offset:3072
  s_add_u32 s35, s35, 4096
  buffer_load_dwordx4 v[80:83], v7, s[8:11], s35 offen offset:0
  buffer_load_dwordx4 v[84:87], v7, s[8:11], s35 offen offset:1024
  buffer_load_dwordx4 v[88:91], v7, s[8:11], s35 offen offset:2048
  buffer_load_dwordx4 v[92:95], v7, s[8:11], s35 offen offset:3072
  s_add_u32 s35, s35, 4096
  buffer_load_dwordx4 v[96:99], v7, s[8:11], s35 offen offset:0
  buffer_load_dwordx4 v[100:103], v7, s[8:11], s35 offen offset:1024
  buffer_load_dwordx4 v[104:107], v7, s[8:11], s35 offen offset:2048
  buffer_load_dwordx4 v[108:111], v7, s[8:11], s35 offen offset:3072
  s_add_u32 s35, s35, 4096
  buffer_load_dwordx4 v[112:115], v7, s[8:11], s35 offen offset:0
  buffer_load_dwordx4 v[48:51], v7, s[8:11], s35 offen offset:1024
  s_andn2_b32 s28, 0xfe0, s56
  s_lshl_b32 s28, s28, 7
  s_mov_b32 s29, 243793920
  v_mov_b32 v24, 262144
  s_mov_b32 s53, 0
  s_mov_b32 s33, 3
  v_mov_b32 v53, s58
  s_and_b32 s32, s48, 15
  s_cbranch_scc0 k_x_110
k_w_109:
  s_add_u32 s33, s33, 1
  s_and_b32 s33, s33, 3
  s_bitcmp1_b32 s32, s33
  s_cbranch_scc0 k_w_109
  s_lshl2_add_u32 s26, s33, s17
  s_lshl_b32 s26, s26, 14
  s_add_u32 s27, s26, 8192
  v_add_u32 v22, s26, v9
  v_cmp_le_u32 vcc, s28, v22
  s_nop 1
  v_cndmask_b32 v25, 0, v24, vcc
  v_add_u32 v22, v22, v25
  buffer_load_dword v20, v22, s[4:7], s29 offen sc1
  v_add_u32 v23, s27, v9
  v_cmp_le_u32 vcc, s28, v23
  s_nop 1
  v_cndmask_b32 v25, 0, v24, vcc
  v_add_u32 v23, v23, v25
  buffer_load_dword v21, v23, s[4:7], s29 offen sc1
  s_add_u32 s53, s53, 1
  s_cmp_gt_u32 s53, 1048576
  s_cbranch_scc1 q_fail_90
  s_waitcnt vmcnt(0)
  v_min_u32 v52, v20, v21
  v_max3_u32 v53, v20, v21, v53
  v_cmp_eq_u32 vcc, 0, v52
  s_cbranch_vccnz k_w_109
  s_bitset0_b32 s32, s33
  s_cmp_lg_u32 s32, 0
  s_cbranch_scc1 k_w_109
  v_max_u32_dpp v53, v53, v53 row_ror:8 row_mask:0xf bank_mask:0xf
  s_nop 1
  v_max_u32_dpp v53, v53, v53 row_ror:4 row_mask:0xf bank_mask:0xf
  s_nop 1
  v_max_u32_dpp v53, v53, v53 row_ror:2 row_mask:0xf bank_mask:0xf
  s_nop 1
  v_max_u32_dpp v53, v53, v53 row_ror:1 row_mask:0xf bank_mask:0xf
  v_mov_b32 v52, v53
  s_nop 0
  s_nop 0
  v_permlane16_swap_b32 v53, v52
  v_max_u32 v53, v53, v52
  v_mov_b32 v52, v53
  s_nop 0
  s_nop 0
  v_permlane32_swap_b32 v53, v52
  v_max_u32 v53, v53, v52
k_x_110:
  ds_write_b32 v118, v53 offset:256
  s_waitcnt vmcnt(0) lgkmcnt(0)
  s_barrier
  ds_read_b128 v[20:23], v119 offset:256
  s_waitcnt lgkmcnt(0)
  v_max3_u32 v20, v20, v21, v22
  v_max_u32 v20, v20, v23
  s_nop 0
  v_readfirstlane_b32 s26, v20
  s_cmp_eq_u32 s26, s58
  s_cbranch_scc1 q_fail_90
  s_cmp_eq_u32 s58, 0
  s_mov_b32 s58, s26
  s_cbranch_scc1 k_r_111
  s_cmp_lg_u32 s57, 0
  s_cbranch_scc1 k_r_111
  s_lshl_b32 s26, s59, 10
  buffer_store_dwordx4 a[0:3], v0, s[72:75], s26 offen sc1
k_r_111:
  s_andn2_b32 s26, 0xfe0, s56
  s_andn2_b32 s27, 0xfe0, s58
  s_cmp_lt_u32 s27, s26
  s_cselect_b32 s61, 1, 2
  s_andn2_b32 s59, 0xfff, s58
  s_lshl_b32 s26, s61, 21
  s_lshl_b32 s27, s59, 10
  s_add_u32 s26, s26, s27
  s_lshl_b32 s27, s17, 8
  s_add_u32 s26, s26, s27
  s_add_u32 s26, s26, 27262976
  v_lshrrev_b32 v5, 7, v0
  v_lshlrev_b32 v5, 5, v5
  buffer_load_dwordx4 v[52:55], v5, s[4:7], s26 offen offset:0 sc1
  buffer_load_dwordx4 v[56:59], v5, s[4:7], s26 offen offset:16 sc1
  s_mov_b32 vcc_lo, 0xaaaaaaaa
  s_mov_b32 vcc_hi, 0xaaaaaaaa
  v_mov_b32 v3, 0xffff
  v_mov_b32 v24, 0xffff0000
  v_cndmask_b32 v3, v3, v24, vcc
  s_mov_b32 vcc_lo, 0x3030303
  s_mov_b32 vcc_hi, 0x3030303
  v_cndmask_b32 v24, 0, v3, vcc
  s_mov_b32 vcc_lo, 0xc0c0c0c
  s_mov_b32 vcc_hi, 0xc0c0c0c
  v_cndmask_b32 v25, 0, v3, vcc
  s_mov_b32 vcc_lo, 0x30303030
  s_mov_b32 vcc_hi, 0x30303030
  v_cndmask_b32 v26, 0, v3, vcc
  s_mov_b32 vcc_lo, 0xc0c0c0c0
  s_mov_b32 vcc_hi, 0xc0c0c0c0
  v_cndmask_b32 v27, 0, v3, vcc
  s_mov_b32 s30, 0x01000100
  s_mov_b32 s31, 0x03020302
  s_mul_i32 s26, s17, 23552
  s_add_u32 s26, s26, 65536
  v_add_u32 v5, s26, v0
  v_add_u32 v2, s37, v0
  ds_read_b128 v[36:39], v5 offset:0
  ds_read_b128 v[40:43], v5 offset:1024
  ds_read_b128 v[44:47], v5 offset:2048
  ds_read_b128 v[12:15], v5 offset:3072
  ds_read_b128 v[16:19], v5 offset:4096
  ds_read_b128 v[120:123], v5 offset:5120
  ds_read_b128 v[124:127], v5 offset:6144
  s_waitcnt vmcnt(0)
  v_perm_b32 v3, v52, v52, s30
  v_and_b32 v20, v24, v3
  v_and_b32 v21, v25, v3
  v_and_b32 v22, v26, v3
  v_and_b32 v23, v27, v3
  s_waitcnt lgkmcnt(5)
  s_nop 0
  v_mfma_f32_16x16x32_bf16 v[28:31], v[20:23], v[36:39], 0
  ds_read_b128 v[36:39], v5 offset:7168
  v_mfma_f32_16x16x32_bf16 v[32:35], v[20:23], v[40:43], 0
  ds_read_b128 v[40:43], v5 offset:8192
  v_perm_b32 v3, v52, v52, s31
  v_and_b32 v20, v24, v3
  v_and_b32 v21, v25, v3
  v_and_b32 v22, v26, v3
  v_and_b32 v23, v27, v3
  s_waitcnt lgkmcnt(5)
  s_nop 0
  v_mfma_f32_16x16x32_bf16 v[28:31], v[20:23], v[44:47], v[28:31]
  ds_read_b128 v[44:47], v5 offset:9216
  v_mfma_f32_16x16x32_bf16 v[32:35], v[20:23], v[12:15], v[32:35]
  ds_read_b128 v[12:15], v5 offset:10240
  v_perm_b32 v3, v53, v53, s30
  v_and_b32 v20, v24, v3
  v_and_b32 v21, v25, v3
  v_and_b32 v22, v26, v3
  v_and_b32 v23, v27, v3
  s_waitcnt lgkmcnt(5)
  s_nop 0
  v_mfma_f32_16x16x32_bf16 v[28:31], v[20:23], v[16:19], v[28:31]
  ds_read_b128 v[16:19], v5 offset:11264
  v_mfma_f32_16x16x32_bf16 v[32:35], v[20:23], v[120:123], v[32:35]
  ds_read_b128 v[120:123], v5 offset:12288
  v_perm_b32 v3, v53, v53, s31
  v_and_b32 v20, v24, v3
  v_and_b32 v21, v25, v3
  v_and_b32 v22, v26, v3
  v_and_b32 v23, v27, v3
  s_waitcnt lgkmcnt(5)
  s_nop 0
  v_mfma_f32_16x16x32_bf16 v[28:31], v[20:23], v[124:127], v[28:31]
  ds_read_b128 v[124:127], v5 offset:13312
  v_mfma_f32_16x16x32_bf16 v[32:35], v[20:23], v[36:39], v[32:35]
  ds_read_b128 v[36:39], v5 offset:14336
  v_perm_b32 v3, v54, v54, s30
  v_and_b32 v20, v24, v3
  v_and_b32 v21, v25, v3
  v_and_b32 v22, v26, v3
  v_and_b32 v23, v27, v3
  s_waitcnt lgkmcnt(5)
  s_nop 0
  v_mfma_f32_16x16x32_bf16 v[28:31], v[20:23], v[40:43], v[28:31]
  ds_read_b128 v[40:43], v5 offset:15360
  v_mfma_f32_16x16x32_bf16 v[32:35], v[20:23], v[44:47], v[32:35]
  ds_read_b128 v[44:47], v5 offset:16384
  v_perm_b32 v3, v54, v54, s31
  v_and_b32 v20, v24, v3
  v_and_b32 v21, v25, v3
  v_and_b32 v22, v26, v3
  v_and_b32 v23, v27, v3
  s_waitcnt lgkmcnt(5)
  s_nop 0
  v_mfma_f32_16x16x32_bf16 v[28:31], v[20:23], v[12:15], v[28:31]
  ds_read_b128 v[12:15], v5 offset:17408
  v_mfma_f32_16x16x32_bf16 v[32:35], v[20:23], v[16:19], v[32:35]
  ds_read_b128 v[16:19], v5 offset:18432
  v_perm_b32 v3, v55, v55, s30
  v_and_b32 v20, v24, v3
  v_and_b32 v21, v25, v3
  v_and_b32 v22, v26, v3
  v_and_b32 v23, v27, v3
  s_waitcnt lgkmcnt(5)
  s_nop 0
  v_mfma_f32_16x16x32_bf16 v[28:31], v[20:23], v[120:123], v[28:31]
  ds_read_b128 v[120:123], v5 offset:19456
  v_mfma_f32_16x16x32_bf16 v[32:35], v[20:23], v[124:127], v[32:35]
  ds_read_b128 v[124:127], v5 offset:20480
  v_perm_b32 v3, v55, v55, s31
  v_and_b32 v20, v24, v3
  v_and_b32 v21, v25, v3
  v_and_b32 v22, v26, v3
  v_and_b32 v23, v27, v3
  s_waitcnt lgkmcnt(5)
  s_nop 0
  v_mfma_f32_16x16x32_bf16 v[28:31], v[20:23], v[36:39], v[28:31]
  ds_read_b128 v[36:39], v5 offset:21504
  v_mfma_f32_16x16x32_bf16 v[32:35], v[20:23], v[40:43], v[32:35]
  ds_read_b128 v[40:43], v5 offset:22528
  v_perm_b32 v3, v56, v56, s30
  v_and_b32 v20, v24, v3
  v_and_b32 v21, v25, v3
  v_and_b32 v22, v26, v3
  v_and_b32 v23, v27, v3
  s_waitcnt lgkmcnt(5)
  s_nop 0
  v_mfma_f32_16x16x32_bf16 v[28:31], v[20:23], v[44:47], v[28:31]
  ds_read_b128 v[44:47], v2 offset:0
  v_mfma_f32_16x16x32_bf16 v[32:35], v[20:23], v[12:15], v[32:35]
  ds_read_b128 v[12:15], v2 offset:1024
  v_perm_b32 v3, v56, v56, s31
  v_and_b32 v20, v24, v3
  v_and_b32 v21, v25, v3
  v_and_b32 v22, v26, v3
  v_and_b32 v23, v27, v3
  s_waitcnt lgkmcnt(5)
  s_nop 0
  v_mfma_f32_16x16x32_bf16 v[28:31], v[20:23], v[16:19], v[28:31]
  ds_read_b128 v[16:19], v2 offset:2048
  v_mfma_f32_16x16x32_bf16 v[32:35], v[20:23], v[120:123], v[32:35]
  ds_read_b128 v[120:123], v2 offset:3072
  v_perm_b32 v3, v57, v57, s30
  v_and_b32 v20, v24, v3
  v_and_b32 v21, v25, v3
  v_and_b32 v22, v26, v3
  v_and_b32 v23, v27, v3
  s_waitcnt lgkmcnt(5)
  s_nop 0
  v_mfma_f32_16x16x32_bf16 v[28:31], v[20:23], v[124:127], v[28:31]
  ds_read_b128 v[124:127], v2 offset:4096
  v_mfma_f32_16x16x32_bf16 v[32:35], v[20:23], v[36:39], v[32:35]
  ds_read_b128 v[36:39], v2 offset:5120
  v_perm_b32 v3, v57, v57, s31
  v_and_b32 v20, v24, v3
  v_and_b32 v21, v25, v3
  v_and_b32 v22, v26, v3
  v_and_b32 v23, v27, v3
  s_waitcnt lgkmcnt(5)
  s_nop 0
  v_mfma_f32_16x16x32_bf16 v[28:31], v[20:23], v[40:43], v[28:31]
  ds_read_b128 v[40:43], v2 offset:6144
  v_mfma_f32_16x16x32_bf16 v[32:35], v[20:23], v[44:47], v[32:35]
  ds_read_b128 v[44:47], v2 offset:7168
  v_perm_b32 v3, v58, v58, s30
  v_and_b32 v20, v24, v3
  v_and_b32 v21, v25, v3
  v_and_b32 v22, v26, v3
  v_and_b32 v23, v27, v3
  s_waitcnt lgkmcnt(5)
  s_nop 0
  v_mfma_f32_16x16x32_bf16 v[28:31], v[20:23], v[12:15], v[28:31]
  v_mfma_f32_16x16x32_bf16 v[32:35], v[20:23], v[16:19], v[32:35]
  v_perm_b32 v3, v58, v58, s31
  v_and_b32 v20, v24, v3
  v_and_b32 v21, v25, v3
  v_and_b32 v22, v26, v3
  v_and_b32 v23, v27, v3
  s_waitcnt lgkmcnt(3)
  s_nop 0
  v_mfma_f32_16x16x32_bf16 v[28:31], v[20:23], v[120:123], v[28:31]
  v_mfma_f32_16x16x32_bf16 v[32:35], v[20:23], v[124:127], v[32:35]
  v_perm_b32 v3, v59, v59, s30
  v_and_b32 v20, v24, v3
  v_and_b32 v21, v25, v3
  v_and_b32 v22, v26, v3
  v_and_b32 v23, v27, v3
  s_waitcnt lgkmcnt(1)
  s_nop 0
  v_mfma_f32_16x16x32_bf16 v[28:31], v[20:23], v[36:39], v[28:31]
  v_mfma_f32_16x16x32_bf16 v[32:35], v[20:23], v[40:43], v[32:35]
  v_perm_b32 v3, v59, v59, s31
  v_and_b32 v20, v24, v3
  v_and_b32 v21, v25, v3
  v_and_b32 v22, v26, v3
  v_and_b32 v23, v27, v3
  s_waitcnt lgkmcnt(0)
  s_nop 0
  v_mfma_f32_16x16x32_bf16 v[28:31], v[20:23], v[44:47], v[28:31]
  v_mfma_f32_16x16x32_bf16 v[32:35], v[20:23], v[60:63], v[32:35]
  v_lshrrev_b32 v2, 8, v0
  v_and_b32 v3, 0xf0, v0
  v_lshlrev_b32 v3, 1, v3
  v_and_b32 v5, 1, v2
  v_lshl_add_u32 v5, v5, 4, v3
  v_add_u32 v5, s37, v5
  s_mov_b32 exec_lo, 0x00ff00ff
  s_mov_b32 exec_hi, 0xff00ff00
  ds_write_b128 v5, v[28:31]
  ds_write_b128 v5, v[32:35] offset:512
  s_mov_b64 exec, -1
  s_xor_b32 s26, s50, 32768
  v_add_u32 v5, s26, v1
  v_lshl_add_u32 v3, v2, 4, v3
  s_waitcnt lgkmcnt(0)
  s_barrier
  ds_read2st64_b32 v[36:37], v5 offset0:0 offset1:1
  ds_read2st64_b32 v[52:53], v5 offset0:2 offset1:3
  ds_read2st64_b32 v[38:39], v5 offset0:32 offset1:33
  ds_read2st64_b32 v[54:55], v5 offset0:34 offset1:35
  ds_read2st64_b32 v[40:41], v5 offset0:64 offset1:65
  ds_read2st64_b32 v[56:57], v5 offset0:66 offset1:67
  ds_read2st64_b32 v[42:43], v5 offset0:96 offset1:97
  ds_read2st64_b32 v[58:59], v5 offset0:98 offset1:99
  s_waitcnt lgkmcnt(0)
  v_add_f32 v36, v36, v40
  v_add_f32 v37, v37, v41
  v_add_f32 v38, v38, v42
  v_add_f32 v39, v39, v43
  v_add_f32 v52, v52, v56
  v_add_f32 v53, v53, v57
  v_add_f32 v54, v54, v58
  v_add_f32 v55, v55, v59
  v_add_f32 v36, v36, v38
  v_add_f32 v37, v37, v39
  v_add_f32 v52, v52, v54
  v_add_f32 v53, v53, v55
  v_add_f32 v36, v36, v37
  v_add_f32 v52, v52, v53
  v_cvt_pk_bf16_f32 v36, 0, v36
  v_cvt_pk_bf16_f32 v52, 0, v52
  v_mul_f32 v40, 0xbfb8aa3b, v36
  v_exp_f32 v40, v40
  s_nop 0
  v_add_f32 v40, 1.0, v40
  v_rcp_f32 v40, v40
  s_nop 0
  v_mul_f32 v36, v36, v40
  v_cvt_pk_bf16_f32 v36, 0, v36
  v_mul_f32 v36, v36, v52
  v_cvt_pk_bf16_f32 v36, v36, v36
  s_lshl_b32 s26, s17, 8
  s_add_u32 s26, s26, 161792
  v_add_u32 v5, s26, v1
  ds_write_b32 v5, v36
  v_mul_u32_u24 v5, 56, v2
  v_add_u32 v5, s26, v5
  ds_read_b64 v[36:37], v5 offset:0
  ds_read_b64 v[38:39], v5 offset:8
  ds_read_b64 v[40:41], v5 offset:16
  ds_read_b64 v[42:43], v5 offset:24
  ds_read_b64 v[44:45], v5 offset:32
  ds_read_b64 v[46:47], v5 offset:40
  ds_read_b64 v[52:53], v5 offset:48
  s_waitcnt lgkmcnt(0)
  v_and_b32 v20, v24, v36
  v_and_b32 v21, v25, v36
  v_and_b32 v22, v26, v36
  v_and_b32 v23, v27, v36
  s_nop 0
  s_nop 0
  v_mfma_f32_16x16x32_bf16 v[28:31], v[20:23], v[64:67], 0
  v_and_b32 v32, v24, v37
  v_and_b32 v33, v25, v37
  v_and_b32 v34, v26, v37
  v_and_b32 v35, v27, v37
  s_nop 0
  s_nop 0
  v_mfma_f32_16x16x32_bf16 v[28:31], v[32:35], v[68:71], v[28:31]
  v_and_b32 v20, v24, v38
  v_and_b32 v21, v25, v38
  v_and_b32 v22, v26, v38
  v_and_b32 v23, v27, v38
  s_nop 0
  s_nop 0
  v_mfma_f32_16x16x32_bf16 v[28:31], v[20:23], v[72:75], v[28:31]
  v_and_b32 v32, v24, v39
  v_and_b32 v33, v25, v39
  v_and_b32 v34, v26, v39
  v_and_b32 v35, v27, v39
  s_nop 0
  s_nop 0
  v_mfma_f32_16x16x32_bf16 v[28:31], v[32:35], v[76:79], v[28:31]
  v_and_b32 v20, v24, v40
  v_and_b32 v21, v25, v40
  v_and_b32 v22, v26, v40
  v_and_b32 v23, v27, v40
  s_nop 0
  s_nop 0
  v_mfma_f32_16x16x32_bf16 v[28:31], v[20:23], v[80:83], v[28:31]
  v_and_b32 v32, v24, v41
  v_and_b32 v33, v25, v41
  v_and_b32 v34, v26, v41
  v_and_b32 v35, v27, v41
  s_nop 0
  s_nop 0
  v_mfma_f32_16x16x32_bf16 v[28:31], v[32:35], v[84:87], v[28:31]
  v_and_b32 v20, v24, v42
  v_and_b32 v21, v25, v42
  v_and_b32 v22, v26, v42
  v_and_b32 v23, v27, v42
  s_nop 0
  s_nop 0
  v_mfma_f32_16x16x32_bf16 v[28:31], v[20:23], v[88:91], v[28:31]
  v_and_b32 v32, v24, v43
  v_and_b32 v33, v25, v43
  v_and_b32 v34, v26, v43
  v_and_b32 v35, v27, v43
  s_nop 0
  s_nop 0
  v_mfma_f32_16x16x32_bf16 v[28:31], v[32:35], v[92:95], v[28:31]
  v_and_b32 v20, v24, v44
  v_and_b32 v21, v25, v44
  v_and_b32 v22, v26, v44
  v_and_b32 v23, v27, v44
  s_nop 0
  s_nop 0
  v_mfma_f32_16x16x32_bf16 v[28:31], v[20:23], v[96:99], v[28:31]
  v_and_b32 v32, v24, v45
  v_and_b32 v33, v25, v45
  v_and_b32 v34, v26, v45
  v_and_b32 v35, v27, v45
  s_nop 0
  s_nop 0
  v_mfma_f32_16x16x32_bf16 v[28:31], v[32:35], v[100:103], v[28:31]
  v_and_b32 v20, v24, v46
  v_and_b32 v21, v25, v46
  v_and_b32 v22, v26, v46
  v_and_b32 v23, v27, v46
  s_nop 0
  s_nop 0
  v_mfma_f32_16x16x32_bf16 v[28:31], v[20:23], v[104:107], v[28:31]
  v_and_b32 v32, v24, v47
  v_and_b32 v33, v25, v47
  v_and_b32 v34, v26, v47
  v_and_b32 v35, v27, v47
  s_nop 0
  s_nop 0
  v_mfma_f32_16x16x32_bf16 v[28:31], v[32:35], v[108:111], v[28:31]
  v_and_b32 v20, v24, v52
  v_and_b32 v21, v25, v52
  v_and_b32 v22, v26, v52
  v_and_b32 v23, v27, v52
  s_nop 0
  s_nop 0
  v_mfma_f32_16x16x32_bf16 v[28:31], v[20:23], v[112:115], v[28:31]
  v_and_b32 v32, v24, v53
  v_and_b32 v33, v25, v53
  v_and_b32 v34, v26, v53
  v_and_b32 v35, v27, v53
  s_nop 0
  s_nop 0
  v_mfma_f32_16x16x32_bf16 v[28:31], v[32:35], v[48:51], v[28:31]
  v_lshrrev_b32 v3, 1, v3
  s_lshl_b32 s26, s47, 7
  s_add_u32 s26, s26, s57
  s_lshl_b32 s26, s26, 8
  s_add_u32 s26, s26, 244318208
  s_nop 2
  v_cvt_pk_bf16_f32 v28, v28, v29
  v_cvt_pk_bf16_f32 v29, v30, v31
  v_min_u32 v28, -2, v28
  v_min_u32 v29, -2, v29
  s_mov_b32 exec_hi, 0
  buffer_store_dwordx2 v[28:29], v3, s[4:7], s26 offen sc1
  s_mov_b32 exec_hi, -1
  s_cmp_lg_u32 s16, 0
  s_cbranch_scc1 k_nx_108
  s_barrier
  s_lshl_b32 s26, s61, 21
  s_lshl_b32 s27, s59, 10
  s_add_u32 s26, s26, s27
  s_add_u32 s27, s26, 20971520
  s_add_u32 s28, s26, 27262976
  s_lshl_b32 s26, s47, 7
  s_add_u32 s26, s26, s17
  s_lshl_b32 s26, s26, 8
  s_add_u32 s26, s26, 244318208
  v_lshrrev_b32 v2, 8, v0
  v_and_b32 v3, 0xf0, v0
  v_lshl_add_u32 v5, v2, 10, v3
  buffer_load_dwordx4 v[108:111], v0, s[4:7], s27 offen sc1
  buffer_load_dwordx4 v[112:115], v0, s[4:7], s28 offen sc1
  s_mov_b32 s53, 0
m_w_113:
  s_add_u32 s27, s26, 0
  buffer_load_dwordx4 v[20:23], v5, s[4:7], s27 offen sc1
  s_add_u32 s27, s26, 4096
  buffer_load_dwordx4 v[24:27], v5, s[4:7], s27 offen sc1
  s_add_u32 s27, s26, 8192
  buffer_load_dwordx4 v[28:31], v5, s[4:7], s27 offen sc1
  s_add_u32 s27, s26, 12288
  buffer_load_dwordx4 v[32:35], v5, s[4:7], s27 offen sc1
  s_add_u32 s27, s26, 16384
  buffer_load_dwordx4 v[36:39], v5, s[4:7], s27 offen sc1
  s_add_u32 s27, s26, 20480
  buffer_load_dwordx4 v[40:43], v5, s[4:7], s27 offen sc1
  s_add_u32 s27, s26, 24576
  buffer_load_dwordx4 v[44:47], v5, s[4:7], s27 offen sc1
  s_add_u32 s27, s26, 28672
  buffer_load_dwordx4 v[48:51], v5, s[4:7], s27 offen sc1
  s_add_u32 s53, s53, 1
  s_cmp_gt_u32 s53, 1048576
  s_cbranch_scc1 q_fail_90
  s_mov_b32 vcc_lo, 0xaaaaaaaa
  s_mov_b32 vcc_hi, 0xaaaaaaaa
  v_mov_b32 v72, 0x3f80
  v_mov_b32 v68, 1.0
  v_cndmask_b32 v72, v72, v68, vcc
  s_mov_b32 vcc_lo, 0x30003
  s_mov_b32 vcc_hi, 0x30003
  v_cndmask_b32 v68, 0, v72, vcc
  s_mov_b32 vcc_lo, 0xc000c
  s_mov_b32 vcc_hi, 0xc000c
  v_cndmask_b32 v69, 0, v72, vcc
  s_mov_b32 vcc_lo, 0x300030
  s_mov_b32 vcc_hi, 0x300030
  v_cndmask_b32 v70, 0, v72, vcc
  s_mov_b32 vcc_lo, 0xc000c0
  s_mov_b32 vcc_hi, 0xc000c0
  v_cndmask_b32 v71, 0, v72, vcc
  s_waitcnt vmcnt(7)
  s_nop 0
  v_mfma_f32_16x16x32_bf16 v[72:75], v[68:71], v[20:23], 0
  v_max3_u32 v80, v20, v21, 0
  v_max3_u32 v80, v22, v23, v80
  s_waitcnt vmcnt(6)
  v_mfma_f32_16x16x32_bf16 v[72:75], v[68:71], v[24:27], v[72:75]
  v_max3_u32 v80, v24, v25, v80
  v_max3_u32 v80, v26, v27, v80
  s_waitcnt vmcnt(5)
  v_mfma_f32_16x16x32_bf16 v[72:75], v[68:71], v[28:31], v[72:75]
  v_max3_u32 v80, v28, v29, v80
  v_max3_u32 v80, v30, v31, v80
  s_waitcnt vmcnt(4)
  v_mfma_f32_16x16x32_bf16 v[72:75], v[68:71], v[32:35], v[72:75]
  v_max3_u32 v80, v32, v33, v80
  v_max3_u32 v80, v34, v35, v80
  s_waitcnt vmcnt(3)
  v_mfma_f32_16x16x32_bf16 v[72:75], v[68:71], v[36:39], v[72:75]
  v_max3_u32 v80, v36, v37, v80
  v_max3_u32 v80, v38, v39, v80
  s_waitcnt vmcnt(2)
  v_mfma_f32_16x16x32_bf16 v[72:75], v[68:71], v[40:43], v[72:75]
  v_max3_u32 v80, v40, v41, v80
  v_max3_u32 v80, v42, v43, v80
  s_waitcnt vmcnt(1)
  v_mfma_f32_16x16x32_bf16 v[72:75], v[68:71], v[44:47], v[72:75]
  v_max3_u32 v80, v44, v45, v80
  v_max3_u32 v80, v46, v47, v80
  s_waitcnt vmcnt(0)
  v_mfma_f32_16x16x32_bf16 v[72:75], v[68:71], v[48:51], v[72:75]
  v_max3_u32 v80, v48, v49, v80
  v_max3_u32 v80, v50, v51, v80
  v_cmp_eq_u32 vcc, -1, v80
  s_cbranch_vccnz m_w_113
  v_lshlrev_b32 v3, 1, v3
  v_lshl_add_u32 v3, v2, 4, v3
  s_lshl_b32 s26, s17, 9
  s_add_u32 s26, s26, 159744
  v_add_u32 v3, s26, v3
  s_mov_b32 exec_hi, 0
  ds_write_b128 v3, v[72:75]
  s_mov_b32 exec_hi, -1
  v_lshlrev_b32 v3, 1, v0
  v_add_u32 v3, 159744, v3
  v_lshlrev_b32 v80, 16, v108
  v_and_b32 v81, 0xffff0000, v108
  v_lshlrev_b32 v82, 16, v109
  v_and_b32 v83, 0xffff0000, v109
  v_lshlrev_b32 v84, 16, v110
  v_and_b32 v85, 0xffff0000, v110
  v_lshlrev_b32 v86, 16, v111
  v_and_b32 v87, 0xffff0000, v111
  v_lshlrev_b32 v88, 16, v112
  v_and_b32 v89, 0xffff0000, v112
  v_lshlrev_b32 v90, 16, v113
  v_and_b32 v91, 0xffff0000, v113
  v_lshlrev_b32 v92, 16, v114
  v_and_b32 v93, 0xffff0000, v114
  v_lshlrev_b32 v94, 16, v115
  v_and_b32 v95, 0xffff0000, v115
  s_waitcnt lgkmcnt(0)
  s_barrier
  s_cmp_lg_u32 s17, 0
  s_cbranch_scc1 m_done_112
  ds_read_b128 v[72:75], v3
  ds_read_b128 v[76:79], v3 offset:16
  s_and_b32 s29, s58, 0xffff0000
  s_xor_b32 s27, s29, 0x80000000
  s_xor_b32 s28, s29, 0xffff0000
  s_bitcmp1_b32 s29, 31
  s_cselect_b32 s29, s27, s28
  v_mov_b32 v108, s29
  v_mul_f32 v108, 0xbfb8aa3b, v108
  v_exp_f32 v108, v108
  s_nop 0
  v_add_f32 v108, 1.0, v108
  v_rcp_f32 v108, v108
  s_nop 0
  v_cvt_pk_bf16_f32 v108, 0, v108
  v_add_f32 v20, v80, v88
  v_add_f32 v21, v81, v89
  v_add_f32 v22, v82, v90
  v_add_f32 v23, v83, v91
  v_add_f32 v24, v84, v92
  v_add_f32 v25, v85, v93
  v_add_f32 v26, v86, v94
  v_add_f32 v27, v87, v95
  v_cvt_pk_bf16_f32 v28, v20, v21
  v_cvt_pk_bf16_f32 v29, v22, v23
  v_cvt_pk_bf16_f32 v30, v24, v25
  v_cvt_pk_bf16_f32 v31, v26, v27
  v_accvgpr_write_b32 a0, v28
  v_accvgpr_write_b32 a1, v29
  v_accvgpr_write_b32 a2, v30
  v_accvgpr_write_b32 a3, v31
  s_waitcnt lgkmcnt(0)
  v_cvt_pk_bf16_f32 v72, 0, v72
  v_cvt_pk_bf16_f32 v73, 0, v73
  v_cvt_pk_bf16_f32 v74, 0, v74
  v_cvt_pk_bf16_f32 v75, 0, v75
  v_cvt_pk_bf16_f32 v76, 0, v76
  v_cvt_pk_bf16_f32 v77, 0, v77
  v_cvt_pk_bf16_f32 v78, 0, v78
  v_cvt_pk_bf16_f32 v79, 0, v79
  v_mul_f32 v72, v72, v108
  v_mul_f32 v73, v73, v108
  v_mul_f32 v74, v74, v108
  v_mul_f32 v75, v75, v108
  v_mul_f32 v76, v76, v108
  v_mul_f32 v77, v77, v108
  v_mul_f32 v78, v78, v108
  v_mul_f32 v79, v79, v108
  v_cvt_pk_bf16_f32 v72, 0, v72
  v_cvt_pk_bf16_f32 v73, 0, v73
  v_cvt_pk_bf16_f32 v74, 0, v74
  v_cvt_pk_bf16_f32 v75, 0, v75
  v_cvt_pk_bf16_f32 v76, 0, v76
  v_cvt_pk_bf16_f32 v77, 0, v77
  v_cvt_pk_bf16_f32 v78, 0, v78
  v_cvt_pk_bf16_f32 v79, 0, v79
  v_add_f32 v72, v72, v88
  v_add_f32 v73, v73, v89
  v_add_f32 v74, v74, v90
  v_add_f32 v75, v75, v91
  v_add_f32 v76, v76, v92
  v_add_f32 v77, v77, v93
  v_add_f32 v78, v78, v94
  v_add_f32 v79, v79, v95
  v_cvt_pk_bf16_f32 v72, 0, v72
  v_cvt_pk_bf16_f32 v73, 0, v73
  v_cvt_pk_bf16_f32 v74, 0, v74
  v_cvt_pk_bf16_f32 v75, 0, v75
  v_cvt_pk_bf16_f32 v76, 0, v76
  v_cvt_pk_bf16_f32 v77, 0, v77
  v_cvt_pk_bf16_f32 v78, 0, v78
  v_cvt_pk_bf16_f32 v79, 0, v79
  v_add_f32 v80, v80, v72
  v_add_f32 v81, v81, v73
  v_add_f32 v82, v82, v74
  v_add_f32 v83, v83, v75
  v_add_f32 v84, v84, v76
  v_add_f32 v85, v85, v77
  v_add_f32 v86, v86, v78
  v_add_f32 v87, v87, v79
  v_cvt_pk_bf16_f32 v112, v80, v81
  v_cvt_pk_bf16_f32 v113, v82, v83
  v_cvt_pk_bf16_f32 v114, v84, v85
  v_cvt_pk_bf16_f32 v115, v86, v87
  v_lshlrev_b32 v80, 16, v112
  v_and_b32 v81, 0xffff0000, v112
  v_lshlrev_b32 v82, 16, v113
  v_and_b32 v83, 0xffff0000, v113
  v_lshlrev_b32 v84, 16, v114
  v_and_b32 v85, 0xffff0000, v114
  v_lshlrev_b32 v86, 16, v115
  v_and_b32 v87, 0xffff0000, v115
  s_lshl_b32 s26, s59, 10
  buffer_store_dwordx4 v[112:115], v0, s[72:75], s26 offen sc1
m_done_112:
k_nx_108:
  s_add_u32 s47, s47, 3
  s_xor_b32 s48, s48, 31
  s_andn2_b32 s28, 0xfe0, s56
  s_lshl_b32 s28, s28, 7
  s_mov_b32 s29, 243793920
  v_mov_b32 v24, 262144
  s_mov_b32 s53, 0
  s_mov_b32 s33, 3
  v_mov_b32 v53, s58
  s_and_b32 s32, s48, 15
  s_cbranch_scc0 k_x_115
k_w_114:
  s_add_u32 s33, s33, 1
  s_and_b32 s33, s33, 3
  s_bitcmp1_b32 s32, s33
  s_cbranch_scc0 k_w_114
  s_lshl2_add_u32 s26, s33, s17
  s_lshl_b32 s26, s26, 14
  s_add_u32 s27, s26, 8192
  v_add_u32 v22, s26, v9
  v_cmp_le_u32 vcc, s28, v22
  s_nop 1
  v_cndmask_b32 v25, 0, v24, vcc
  v_add_u32 v22, v22, v25
  buffer_load_dword v20, v22, s[4:7], s29 offen sc1
  v_add_u32 v23, s27, v9
  v_cmp_le_u32 vcc, s28, v23
  s_nop 1
  v_cndmask_b32 v25, 0, v24, vcc
  v_add_u32 v23, v23, v25
  buffer_load_dword v21, v23, s[4:7], s29 offen sc1
  s_add_u32 s53, s53, 1
  s_cmp_gt_u32 s53, 1048576
  s_cbranch_scc1 q_fail_90
  s_waitcnt vmcnt(0)
  v_min_u32 v52, v20, v21
  v_max3_u32 v53, v20, v21, v53
  v_cmp_eq_u32 vcc, 0, v52
  s_cbranch_vccnz k_w_114
  s_bitset0_b32 s32, s33
  s_cmp_lg_u32 s32, 0
  s_cbranch_scc1 k_w_114
  v_max_u32_dpp v53, v53, v53 row_ror:8 row_mask:0xf bank_mask:0xf
  s_nop 1
  v_max_u32_dpp v53, v53, v53 row_ror:4 row_mask:0xf bank_mask:0xf
  s_nop 1
  v_max_u32_dpp v53, v53, v53 row_ror:2 row_mask:0xf bank_mask:0xf
  s_nop 1
  v_max_u32_dpp v53, v53, v53 row_ror:1 row_mask:0xf bank_mask:0xf
  v_mov_b32 v52, v53
  s_nop 0
  s_nop 0
  v_permlane16_swap_b32 v53, v52
  v_max_u32 v53, v53, v52
  v_mov_b32 v52, v53
  s_nop 0
  s_nop 0
  v_permlane32_swap_b32 v53, v52
  v_max_u32 v53, v53, v52
k_x_115:
  ds_write_b32 v118, v53 offset:256
  s_waitcnt vmcnt(0) lgkmcnt(0)
  s_barrier
  ds_read_b128 v[20:23], v119 offset:256
  s_waitcnt lgkmcnt(0)
  v_max3_u32 v20, v20, v21, v22
  v_max_u32 v20, v20, v23
  s_nop 0
  v_readfirstlane_b32 s26, v20
  s_cmp_eq_u32 s26, s58
  s_cbranch_scc1 q_fail_90
  s_cmp_eq_u32 s58, 0
  s_mov_b32 s58, s26
  s_cbranch_scc1 k_r_116
  s_cmp_lg_u32 s57, 0
  s_cbranch_scc1 k_r_116
  s_lshl_b32 s26, s59, 10
  buffer_store_dwordx4 a[0:3], v0, s[72:75], s26 offen sc1
k_r_116:
  s_andn2_b32 s26, 0xfe0, s56
  s_andn2_b32 s27, 0xfe0, s58
  s_cmp_lt_u32 s27, s26
  s_cselect_b32 s61, 1, 2
  s_andn2_b32 s59, 0xfff, s58
  s_lshl_b32 s26, s61, 21
  s_lshl_b32 s27, s59, 10
  s_add_u32 s26, s26, s27
  s_lshl_b32 s27, s17, 8
  s_add_u32 s26, s26, s27
  s_add_u32 s26, s26, 27262976
  v_lshrrev_b32 v5, 7, v0
  v_lshlrev_b32 v5, 5, v5
  buffer_load_dwordx4 v[52:55], v5, s[4:7], s26 offen offset:0 sc1
  buffer_load_dwordx4 v[56:59], v5, s[4:7], s26 offen offset:16 sc1
  s_load_dwordx2 s[64:65], s[0:1], 72
  s_load_dwordx2 s[68:69], s[0:1], 80
  s_load_dwordx2 s[8:9], s[0:1], 88
  s_mov_b32 s66, 1835008
  s_mov_b32 s70, 1835008
  s_mov_b32 s10, 1835008
  v_lshrrev_b32 v2, 7, v0
  v_and_b32 v3, 0x70, v0
  v_mul_u32_u24 v6, 57344, v2
  v_add_u32 v6, v6, v3
  v_cmp_eq_u32 vcc, 0x70, v3
  v_mov_b32 v3, 0x7ff00000
  s_nop 0
  v_cndmask_b32 v6, v6, v3, vcc
  v_lshrrev_b32 v2, 8, v0
  v_mul_u32_u24 v7, 14336, v2
  v_and_b32 v3, 0xf0, v0
  v_add_u32 v7, v7, v3
  s_mul_i32 s34, s17, 458752
  s_mul_i32 s27, s16, 112
  s_add_u32 s34, s34, s27
  s_mul_i32 s35, s16, 57344
  s_lshl_b32 s27, s17, 8
  s_add_u32 s35, s35, s27
  s_waitcnt lgkmcnt(0)
  s_xor_b32 s37, s50, 32768
  s_add_u32 s37, s37, s54
  s_mov_b32 m0, s37
  s_add_u32 s36, s34, 39424
  buffer_load_dwordx4 v6, s[68:71], s36 offen lds
  s_add_u32 m0, m0, 1024
  s_add_u32 s36, s34, 43008
  buffer_load_dwordx4 v6, s[64:67], s36 offen lds
  s_add_u32 m0, m0, 1024
  s_add_u32 s36, s34, 43008
  buffer_load_dwordx4 v6, s[68:71], s36 offen lds
  s_add_u32 m0, m0, 1024
  s_add_u32 s36, s34, 46592
  buffer_load_dwordx4 v6, s[64:67], s36 offen lds
  s_add_u32 m0, m0, 1024
  s_add_u32 s36, s34, 46592
  buffer_load_dwordx4 v6, s[68:71], s36 offen lds
  s_add_u32 m0, m0, 1024
  s_add_u32 s36, s34, 50176
  buffer_load_dwordx4 v6, s[64:67], s36 offen lds
  s_add_u32 m0, m0, 1024
  s_add_u32 s36, s34, 50176
  buffer_load_dwordx4 v6, s[68:71], s36 offen lds
  s_add_u32 m0, m0, 1024
  s_add_u32 s36, s34, 53760
  buffer_load_dwordx4 v6, s[64:67], s36 offen lds
  s_add_u32 m0, m0, 1024
  s_add_u32 s36, s34, 53760
  buffer_load_dwordx4 v[60:63], v6, s[68:71], s36 offen
  buffer_load_dwordx4 v[64:67], v7, s[8:11], s35 offen offset:0
  buffer_load_dwordx4 v[68:71], v7, s[8:11], s35 offen offset:1024
  buffer_load_dwordx4 v[72:75], v7, s[8:11], s35 offen offset:2048
  buffer_load_dwordx4 v[76:79], v7, s[8:11], s35 offen offset:3072
  s_add_u32 s35, s35, 4096
  buffer_load_dwordx4 v[80:83], v7, s[8:11], s35 offen offset:0
  buffer_load_dwordx4 v[84:87], v7, s[8:11], s35 offen offset:1024
  buffer_load_dwordx4 v[88:91], v7, s[8:11], s35 offen offset:2048
  buffer_load_dwordx4 v[92:95], v7, s[8:11], s35 offen offset:3072
  s_add_u32 s35, s35, 4096
  buffer_load_dwordx4 v[96:99], v7, s[8:11], s35 offen offset:0
  buffer_load_dwordx4 v[100:103], v7, s[8:11], s35 offen offset:1024
  buffer_load_dwordx4 v[104:107], v7, s[8:11], s35 offen offset:2048
  buffer_load_dwordx4 v[108:111], v7, s[8:11], s35 offen offset:3072
  s_add_u32 s35, s35, 4096
  buffer_load_dwordx4 v[112:115], v7, s[8:11], s35 offen offset:0
  buffer_load_dwordx4 v[48:51], v7, s[8:11], s35 offen offset:1024
  s_mov_b32 vcc_lo, 0xaaaaaaaa
  s_mov_b32 vcc_hi, 0xaaaaaaaa
  v_mov_b32 v3, 0xffff
  v_mov_b32 v24, 0xffff0000
  v_cndmask_b32 v3, v3, v24, vcc
  s_mov_b32 vcc_lo, 0x3030303
  s_mov_b32 vcc_hi, 0x3030303
  v_cndmask_b32 v24, 0, v3, vcc
  s_mov_b32 vcc_lo, 0xc0c0c0c
  s_mov_b32 vcc_hi, 0xc0c0c0c
  v_cndmask_b32 v25, 0, v3, vcc
  s_mov_b32 vcc_lo, 0x30303030
  s_mov_b32 vcc_hi, 0x30303030
  v_cndmask_b32 v26, 0, v3, vcc
  s_mov_b32 vcc_lo, 0xc0c0c0c0
  s_mov_b32 vcc_hi, 0xc0c0c0c0
  v_cndmask_b32 v27, 0, v3, vcc
  s_mov_b32 s30, 0x01000100
  s_mov_b32 s31, 0x03020302
  s_mul_i32 s26, s17, 23552
  s_add_u32 s26, s26, 65536
  v_add_u32 v5, s26, v0
  v_add_u32 v2, s37, v0
  ds_read_b128 v[36:39], v5 offset:0
  ds_read_b128 v[40:43], v5 offset:1024
  ds_read_b128 v[44:47], v5 offset:2048
  ds_read_b128 v[12:15], v5 offset:3072
  ds_read_b128 v[16:19], v5 offset:4096
  ds_read_b128 v[120:123], v5 offset:5120
  ds_read_b128 v[124:127], v5 offset:6144
  s_waitcnt vmcnt(23)
  v_perm_b32 v3, v52, v52, s30
  v_and_b32 v20, v24, v3
  v_and_b32 v21, v25, v3
  v_and_b32 v22, v26, v3
  v_and_b32 v23, v27, v3
  s_waitcnt lgkmcnt(5)
  s_nop 0
  v_mfma_f32_16x16x32_bf16 v[28:31], v[20:23], v[36:39], 0
  ds_read_b128 v[36:39], v5 offset:7168
  v_mfma_f32_16x16x32_bf16 v[32:35], v[20:23], v[40:43], 0
  ds_read_b128 v[40:43], v5 offset:8192
  v_perm_b32 v3, v52, v52, s31
  v_and_b32 v20, v24, v3
  v_and_b32 v21, v25, v3
  v_and_b32 v22, v26, v3
  v_and_b32 v23, v27, v3
  s_waitcnt lgkmcnt(5)
  s_nop 0
  v_mfma_f32_16x16x32_bf16 v[28:31], v[20:23], v[44:47], v[28:31]
  ds_read_b128 v[44:47], v5 offset:9216
  v_mfma_f32_16x16x32_bf16 v[32:35], v[20:23], v[12:15], v[32:35]
  ds_read_b128 v[12:15], v5 offset:10240
  v_perm_b32 v3, v53, v53, s30
  v_and_b32 v20, v24, v3
  v_and_b32 v21, v25, v3
  v_and_b32 v22, v26, v3
  v_and_b32 v23, v27, v3
  s_waitcnt lgkmcnt(5)
  s_nop 0
  v_mfma_f32_16x16x32_bf16 v[28:31], v[20:23], v[16:19], v[28:31]
  ds_read_b128 v[16:19], v5 offset:11264
  v_mfma_f32_16x16x32_bf16 v[32:35], v[20:23], v[120:123], v[32:35]
  ds_read_b128 v[120:123], v5 offset:12288
  v_perm_b32 v3, v53, v53, s31
  v_and_b32 v20, v24, v3
  v_and_b32 v21, v25, v3
  v_and_b32 v22, v26, v3
  v_and_b32 v23, v27, v3
  s_waitcnt lgkmcnt(5)
  s_nop 0
  v_mfma_f32_16x16x32_bf16 v[28:31], v[20:23], v[124:127], v[28:31]
  ds_read_b128 v[124:127], v5 offset:13312
  v_mfma_f32_16x16x32_bf16 v[32:35], v[20:23], v[36:39], v[32:35]
  ds_read_b128 v[36:39], v5 offset:14336
  v_perm_b32 v3, v54, v54, s30
  v_and_b32 v20, v24, v3
  v_and_b32 v21, v25, v3
  v_and_b32 v22, v26, v3
  v_and_b32 v23, v27, v3
  s_waitcnt lgkmcnt(5)
  s_nop 0
  v_mfma_f32_16x16x32_bf16 v[28:31], v[20:23], v[40:43], v[28:31]
  ds_read_b128 v[40:43], v5 offset:15360
  v_mfma_f32_16x16x32_bf16 v[32:35], v[20:23], v[44:47], v[32:35]
  ds_read_b128 v[44:47], v5 offset:16384
  v_perm_b32 v3, v54, v54, s31
  v_and_b32 v20, v24, v3
  v_and_b32 v21, v25, v3
  v_and_b32 v22, v26, v3
  v_and_b32 v23, v27, v3
  s_waitcnt lgkmcnt(5)
  s_nop 0
  v_mfma_f32_16x16x32_bf16 v[28:31], v[20:23], v[12:15], v[28:31]
  ds_read_b128 v[12:15], v5 offset:17408
  v_mfma_f32_16x16x32_bf16 v[32:35], v[20:23], v[16:19], v[32:35]
  ds_read_b128 v[16:19], v5 offset:18432
  v_perm_b32 v3, v55, v55, s30
  v_and_b32 v20, v24, v3
  v_and_b32 v21, v25, v3
  v_and_b32 v22, v26, v3
  v_and_b32 v23, v27, v3
  s_waitcnt lgkmcnt(5)
  s_nop 0
  v_mfma_f32_16x16x32_bf16 v[28:31], v[20:23], v[120:123], v[28:31]
  ds_read_b128 v[120:123], v5 offset:19456
  v_mfma_f32_16x16x32_bf16 v[32:35], v[20:23], v[124:127], v[32:35]
  ds_read_b128 v[124:127], v5 offset:20480
  v_perm_b32 v3, v55, v55, s31
  v_and_b32 v20, v24, v3
  v_and_b32 v21, v25, v3
  v_and_b32 v22, v26, v3
  v_and_b32 v23, v27, v3
  s_waitcnt lgkmcnt(5)
  s_nop 0
  v_mfma_f32_16x16x32_bf16 v[28:31], v[20:23], v[36:39], v[28:31]
  ds_read_b128 v[36:39], v5 offset:21504
  v_mfma_f32_16x16x32_bf16 v[32:35], v[20:23], v[40:43], v[32:35]
  ds_read_b128 v[40:43], v5 offset:22528
  v_perm_b32 v3, v56, v56, s30
  v_and_b32 v20, v24, v3
  v_and_b32 v21, v25, v3
  v_and_b32 v22, v26, v3
  v_and_b32 v23, v27, v3
  s_waitcnt lgkmcnt(5)
  s_nop 0
  v_mfma_f32_16x16x32_bf16 v[28:31], v[20:23], v[44:47], v[28:31]
  s_waitcnt vmcnt(22)
  ds_read_b128 v[44:47], v2 offset:0
  v_mfma_f32_16x16x32_bf16 v[32:35], v[20:23], v[12:15], v[32:35]
  s_waitcnt vmcnt(21)
  ds_read_b128 v[12:15], v2 offset:1024
  v_perm_b32 v3, v56, v56, s31
  v_and_b32 v20, v24, v3
  v_and_b32 v21, v25, v3
  v_and_b32 v22, v26, v3
  v_and_b32 v23, v27, v3
  s_waitcnt lgkmcnt(5)
  s_nop 0
  v_mfma_f32_16x16x32_bf16 v[28:31], v[20:23], v[16:19], v[28:31]
  s_waitcnt vmcnt(20)
  ds_read_b128 v[16:19], v2 offset:2048
  v_mfma_f32_16x16x32_bf16 v[32:35], v[20:23], v[120:123], v[32:35]
  s_waitcnt vmcnt(19)
  ds_read_b128 v[120:123], v2 offset:3072
  v_perm_b32 v3, v57, v57, s30
  v_and_b32 v20, v24, v3
  v_and_b32 v21, v25, v3
  v_and_b32 v22, v26, v3
  v_and_b32 v23, v27, v3
  s_waitcnt lgkmcnt(5)
  s_nop 0
  v_mfma_f32_16x16x32_bf16 v[28:31], v[20:23], v[124:127], v[28:31]
  s_waitcnt vmcnt(18)
  ds_read_b128 v[124:127], v2 offset:4096
  v_mfma_f32_16x16x32_bf16 v[32:35], v[20:23], v[36:39], v[32:35]
  s_waitcnt vmcnt(17)
  ds_read_b128 v[36:39], v2 offset:5120
  v_perm_b32 v3, v57, v57, s31
  v_and_b32 v20, v24, v3
  v_and_b32 v21, v25, v3
  v_and_b32 v22, v26, v3
  v_and_b32 v23, v27, v3
  s_waitcnt lgkmcnt(5)
  s_nop 0
  v_mfma_f32_16x16x32_bf16 v[28:31], v[20:23], v[40:43], v[28:31]
  s_waitcnt vmcnt(16)
  ds_read_b128 v[40:43], v2 offset:6144
  v_mfma_f32_16x16x32_bf16 v[32:35], v[20:23], v[44:47], v[32:35]
  s_waitcnt vmcnt(15)
  ds_read_b128 v[44:47], v2 offset:7168
  v_perm_b32 v3, v58, v58, s30
  v_and_b32 v20, v24, v3
  v_and_b32 v21, v25, v3
  v_and_b32 v22, v26, v3
  v_and_b32 v23, v27, v3
  s_waitcnt lgkmcnt(5)
  s_nop 0
  v_mfma_f32_16x16x32_bf16 v[28:31], v[20:23], v[12:15], v[28:31]
  v_mfma_f32_16x16x32_bf16 v[32:35], v[20:23], v[16:19], v[32:35]
  v_perm_b32 v3, v58, v58, s31
  v_and_b32 v20, v24, v3
  v_and_b32 v21, v25, v3
  v_and_b32 v22, v26, v3
  v_and_b32 v23, v27, v3
  s_waitcnt lgkmcnt(3)
  s_nop 0
  v_mfma_f32_16x16x32_bf16 v[28:31], v[20:23], v[120:123], v[28:31]
  v_mfma_f32_16x16x32_bf16 v[32:35], v[20:23], v[124:127], v[32:35]
  v_perm_b32 v3, v59, v59, s30
  v_and_b32 v20, v24, v3
  v_and_b32 v21, v25, v3
  v_and_b32 v22, v26, v3
  v_and_b32 v23, v27, v3
  s_waitcnt lgkmcnt(1)
  s_nop 0
  v_mfma_f32_16x16x32_bf16 v[28:31], v[20:23], v[36:39], v[28:31]
  v_mfma_f32_16x16x32_bf16 v[32:35], v[20:23], v[40:43], v[32:35]
  v_perm_b32 v3, v59, v59, s31
  v_and_b32 v20, v24, v3
  v_and_b32 v21, v25, v3
  v_and_b32 v22, v26, v3
  v_and_b32 v23, v27, v3
  s_waitcnt lgkmcnt(0)
  s_waitcnt vmcnt(14)
  v_mfma_f32_16x16x32_bf16 v[28:31], v[20:23], v[44:47], v[28:31]
  v_mfma_f32_16x16x32_bf16 v[32:35], v[20:23], v[60:63], v[32:35]
  v_lshrrev_b32 v2, 8, v0
  v_and_b32 v3, 0xf0, v0
  v_lshlrev_b32 v3, 1, v3
  v_and_b32 v5, 1, v2
  v_lshl_add_u32 v5, v5, 4, v3
  v_add_u32 v5, s37, v5
  s_mov_b32 exec_lo, 0x00ff00ff
  s_mov_b32 exec_hi, 0xff00ff00
  ds_write_b128 v5, v[28:31]
  ds_write_b128 v5, v[32:35] offset:512
  s_mov_b64 exec, -1
  s_xor_b32 s26, s50, 32768
  v_add_u32 v5, s26, v1
  v_lshl_add_u32 v3, v2, 4, v3
  s_waitcnt lgkmcnt(0)
  s_barrier
  ds_read2st64_b32 v[36:37], v5 offset0:0 offset1:1
  ds_read2st64_b32 v[52:53], v5 offset0:2 offset1:3
  ds_read2st64_b32 v[38:39], v5 offset0:32 offset1:33
  ds_read2st64_b32 v[54:55], v5 offset0:34 offset1:35
  ds_read2st64_b32 v[40:41], v5 offset0:64 offset1:65
  ds_read2st64_b32 v[56:57], v5 offset0:66 offset1:67
  ds_read2st64_b32 v[42:43], v5 offset0:96 offset1:97
  ds_read2st64_b32 v[58:59], v5 offset0:98 offset1:99
  s_waitcnt lgkmcnt(0)
  v_add_f32 v36, v36, v40
  v_add_f32 v37, v37, v41
  v_add_f32 v38, v38, v42
  v_add_f32 v39, v39, v43
  v_add_f32 v52, v52, v56
  v_add_f32 v53, v53, v57
  v_add_f32 v54, v54, v58
  v_add_f32 v55, v55, v59
  v_add_f32 v36, v36, v38
  v_add_f32 v37, v37, v39
  v_add_f32 v52, v52, v54
  v_add_f32 v53, v53, v55
  v_add_f32 v36, v36, v37
  v_add_f32 v52, v52, v53
  v_cvt_pk_bf16_f32 v36, 0, v36
  v_cvt_pk_bf16_f32 v52, 0, v52
  v_mul_f32 v40, 0xbfb8aa3b, v36
  v_exp_f32 v40, v40
  s_nop 0
  v_add_f32 v40, 1.0, v40
  v_rcp_f32 v40, v40
  s_nop 0
  v_mul_f32 v36, v36, v40
  v_cvt_pk_bf16_f32 v36, 0, v36
  v_mul_f32 v36, v36, v52
  v_cvt_pk_bf16_f32 v36, v36, v36
  s_lshl_b32 s26, s17, 8
  s_add_u32 s26, s26, 161792
  v_add_u32 v5, s26, v1
  ds_write_b32 v5, v36
  v_mul_u32_u24 v5, 56, v2
  v_add_u32 v5, s26, v5
  ds_read_b64 v[36:37], v5 offset:0
  ds_read_b64 v[38:39], v5 offset:8
  ds_read_b64 v[40:41], v5 offset:16
  ds_read_b64 v[42:43], v5 offset:24
  ds_read_b64 v[44:45], v5 offset:32
  ds_read_b64 v[46:47], v5 offset:40
  ds_read_b64 v[52:53], v5 offset:48
  s_waitcnt lgkmcnt(0)
  v_and_b32 v20, v24, v36
  v_and_b32 v21, v25, v36
  v_and_b32 v22, v26, v36
  v_and_b32 v23, v27, v36
  s_waitcnt vmcnt(13)
  s_nop 0
  v_mfma_f32_16x16x32_bf16 v[28:31], v[20:23], v[64:67], 0
  v_and_b32 v32, v24, v37
  v_and_b32 v33, v25, v37
  v_and_b32 v34, v26, v37
  v_and_b32 v35, v27, v37
  s_waitcnt vmcnt(12)
  s_nop 0
  v_mfma_f32_16x16x32_bf16 v[28:31], v[32:35], v[68:71], v[28:31]
  v_and_b32 v20, v24, v38
  v_and_b32 v21, v25, v38
  v_and_b32 v22, v26, v38
  v_and_b32 v23, v27, v38
  s_waitcnt vmcnt(11)
  s_nop 0
  v_mfma_f32_16x16x32_bf16 v[28:31], v[20:23], v[72:75], v[28:31]
  v_and_b32 v32, v24, v39
  v_and_b32 v33, v25, v39
  v_and_b32 v34, v26, v39
  v_and_b32 v35, v27, v39
  s_waitcnt vmcnt(10)
  s_nop 0
  v_mfma_f32_16x16x32_bf16 v[28:31], v[32:35], v[76:79], v[28:31]
  v_and_b32 v20, v24, v40
  v_and_b32 v21, v25, v40
  v_and_b32 v22, v26, v40
  v_and_b32 v23, v27, v40
  s_waitcnt vmcnt(9)
  s_nop 0
  v_mfma_f32_16x16x32_bf16 v[28:31], v[20:23], v[80:83], v[28:31]
  v_and_b32 v32, v24, v41
  v_and_b32 v33, v25, v41
  v_and_b32 v34, v26, v41
  v_and_b32 v35, v27, v41
  s_waitcnt vmcnt(8)
  s_nop 0
  v_mfma_f32_16x16x32_bf16 v[28:31], v[32:35], v[84:87], v[28:31]
  v_and_b32 v20, v24, v42
  v_and_b32 v21, v25, v42
  v_and_b32 v22, v26, v42
  v_and_b32 v23, v27, v42
  s_waitcnt vmcnt(7)
  s_nop 0
  v_mfma_f32_16x16x32_bf16 v[28:31], v[20:23], v[88:91], v[28:31]
  v_and_b32 v32, v24, v43
  v_and_b32 v33, v25, v43
  v_and_b32 v34, v26, v43
  v_and_b32 v35, v27, v43
  s_waitcnt vmcnt(6)
  s_nop 0
  v_mfma_f32_16x16x32_bf16 v[28:31], v[32:35], v[92:95], v[28:31]
  v_and_b32 v20, v24, v44
  v_and_b32 v21, v25, v44
  v_and_b32 v22, v26, v44
  v_and_b32 v23, v27, v44
  s_waitcnt vmcnt(5)
  s_nop 0
  v_mfma_f32_16x16x32_bf16 v[28:31], v[20:23], v[96:99], v[28:31]
  v_and_b32 v32, v24, v45
  v_and_b32 v33, v25, v45
  v_and_b32 v34, v26, v45
  v_and_b32 v35, v27, v45
  s_waitcnt vmcnt(4)
  s_nop 0
  v_mfma_f32_16x16x32_bf16 v[28:31], v[32:35], v[100:103], v[28:31]
  v_and_b32 v20, v24, v46
  v_and_b32 v21, v25, v46
  v_and_b32 v22, v26, v46
  v_and_b32 v23, v27, v46
  s_waitcnt vmcnt(3)
  s_nop 0
  v_mfma_f32_16x16x32_bf16 v[28:31], v[20:23], v[104:107], v[28:31]
  v_and_b32 v32, v24, v47
  v_and_b32 v33, v25, v47
  v_and_b32 v34, v26, v47
  v_and_b32 v35, v27, v47
  s_waitcnt vmcnt(2)
  s_nop 0
  v_mfma_f32_16x16x32_bf16 v[28:31], v[32:35], v[108:111], v[28:31]
  v_and_b32 v20, v24, v52
  v_and_b32 v21, v25, v52
  v_and_b32 v22, v26, v52
  v_and_b32 v23, v27, v52
  s_waitcnt vmcnt(1)
  s_nop 0
  v_mfma_f32_16x16x32_bf16 v[28:31], v[20:23], v[112:115], v[28:31]
  v_and_b32 v32, v24, v53
  v_and_b32 v33, v25, v53
  v_and_b32 v34, v26, v53
  v_and_b32 v35, v27, v53
  s_waitcnt vmcnt(0)
  s_nop 0
  v_mfma_f32_16x16x32_bf16 v[28:31], v[32:35], v[48:51], v[28:31]
  v_lshrrev_b32 v3, 1, v3
  s_lshl_b32 s26, s47, 7
  s_add_u32 s26, s26, s57
  s_lshl_b32 s26, s26, 8
  s_add_u32 s26, s26, 244318208
  s_nop 2
  v_cvt_pk_bf16_f32 v28, v28, v29
  v_cvt_pk_bf16_f32 v29, v30, v31
  v_min_u32 v28, -2, v28
  v_min_u32 v29, -2, v29
  s_mov_b32 exec_hi, 0
  buffer_store_dwordx2 v[28:29], v3, s[4:7], s26 offen sc1
  s_mov_b32 exec_hi, -1
  s_cmp_lg_u32 s16, 0
  s_cbranch_scc1 q_fail_90
  s_barrier
  s_lshl_b32 s26, s61, 21
  s_lshl_b32 s27, s59, 10
  s_add_u32 s26, s26, s27
  s_add_u32 s27, s26, 20971520
  s_add_u32 s28, s26, 27262976
  s_lshl_b32 s26, s47, 7
  s_add_u32 s26, s26, s17
  s_lshl_b32 s26, s26, 8
  s_add_u32 s26, s26, 244318208
  v_lshrrev_b32 v2, 8, v0
  v_and_b32 v3, 0xf0, v0
  v_lshl_add_u32 v5, v2, 10, v3
  buffer_load_dwordx4 v[108:111], v0, s[4:7], s27 offen sc1
  buffer_load_dwordx4 v[112:115], v0, s[4:7], s28 offen sc1
  s_mov_b32 s53, 0
m_w_118:
  s_add_u32 s27, s26, 0
  buffer_load_dwordx4 v[20:23], v5, s[4:7], s27 offen sc1
  s_add_u32 s27, s26, 4096
  buffer_load_dwordx4 v[24:27], v5, s[4:7], s27 offen sc1
  s_add_u32 s27, s26, 8192
  buffer_load_dwordx4 v[28:31], v5, s[4:7], s27 offen sc1
  s_add_u32 s27, s26, 12288
  buffer_load_dwordx4 v[32:35], v5, s[4:7], s27 offen sc1
  s_add_u32 s27, s26, 16384
  buffer_load_dwordx4 v[36:39], v5, s[4:7], s27 offen sc1
  s_add_u32 s27, s26, 20480
  buffer_load_dwordx4 v[40:43], v5, s[4:7], s27 offen sc1
  s_add_u32 s27, s26, 24576
  buffer_load_dwordx4 v[44:47], v5, s[4:7], s27 offen sc1
  s_add_u32 s27, s26, 28672
  buffer_load_dwordx4 v[48:51], v5, s[4:7], s27 offen sc1
  s_add_u32 s53, s53, 1
  s_cmp_gt_u32 s53, 1048576
  s_cbranch_scc1 q_fail_90
  s_mov_b32 vcc_lo, 0xaaaaaaaa
  s_mov_b32 vcc_hi, 0xaaaaaaaa
  v_mov_b32 v72, 0x3f80
  v_mov_b32 v68, 1.0
  v_cndmask_b32 v72, v72, v68, vcc
  s_mov_b32 vcc_lo, 0x30003
  s_mov_b32 vcc_hi, 0x30003
  v_cndmask_b32 v68, 0, v72, vcc
  s_mov_b32 vcc_lo, 0xc000c
  s_mov_b32 vcc_hi, 0xc000c
  v_cndmask_b32 v69, 0, v72, vcc
  s_mov_b32 vcc_lo, 0x300030
  s_mov_b32 vcc_hi, 0x300030
  v_cndmask_b32 v70, 0, v72, vcc
  s_mov_b32 vcc_lo, 0xc000c0
  s_mov_b32 vcc_hi, 0xc000c0
  v_cndmask_b32 v71, 0, v72, vcc
  s_waitcnt vmcnt(7)
  s_nop 0
  v_mfma_f32_16x16x32_bf16 v[72:75], v[68:71], v[20:23], 0
  v_max3_u32 v80, v20, v21, 0
  v_max3_u32 v80, v22, v23, v80
  s_waitcnt vmcnt(6)
  v_mfma_f32_16x16x32_bf16 v[72:75], v[68:71], v[24:27], v[72:75]
  v_max3_u32 v80, v24, v25, v80
  v_max3_u32 v80, v26, v27, v80
  s_waitcnt vmcnt(5)
  v_mfma_f32_16x16x32_bf16 v[72:75], v[68:71], v[28:31], v[72:75]
  v_max3_u32 v80, v28, v29, v80
  v_max3_u32 v80, v30, v31, v80
  s_waitcnt vmcnt(4)
  v_mfma_f32_16x16x32_bf16 v[72:75], v[68:71], v[32:35], v[72:75]
  v_max3_u32 v80, v32, v33, v80
  v_max3_u32 v80, v34, v35, v80
  s_waitcnt vmcnt(3)
  v_mfma_f32_16x16x32_bf16 v[72:75], v[68:71], v[36:39], v[72:75]
  v_max3_u32 v80, v36, v37, v80
  v_max3_u32 v80, v38, v39, v80
  s_waitcnt vmcnt(2)
  v_mfma_f32_16x16x32_bf16 v[72:75], v[68:71], v[40:43], v[72:75]
  v_max3_u32 v80, v40, v41, v80
  v_max3_u32 v80, v42, v43, v80
  s_waitcnt vmcnt(1)
  v_mfma_f32_16x16x32_bf16 v[72:75], v[68:71], v[44:47], v[72:75]
  v_max3_u32 v80, v44, v45, v80
  v_max3_u32 v80, v46, v47, v80
  s_waitcnt vmcnt(0)
  v_mfma_f32_16x16x32_bf16 v[72:75], v[68:71], v[48:51], v[72:75]
  v_max3_u32 v80, v48, v49, v80
  v_max3_u32 v80, v50, v51, v80
  v_cmp_eq_u32 vcc, -1, v80
  s_cbranch_vccnz m_w_118
  v_lshlrev_b32 v3, 1, v3
  v_lshl_add_u32 v3, v2, 4, v3
  s_lshl_b32 s26, s17, 9
  s_add_u32 s26, s26, 159744
  v_add_u32 v3, s26, v3
  s_mov_b32 exec_hi, 0
  ds_write_b128 v3, v[72:75]
  s_mov_b32 exec_hi, -1
  v_lshlrev_b32 v3, 1, v0
  v_add_u32 v3, 159744, v3
  v_lshlrev_b32 v80, 16, v108
  v_and_b32 v81, 0xffff0000, v108
  v_lshlrev_b32 v82, 16, v109
  v_and_b32 v83, 0xffff0000, v109
  v_lshlrev_b32 v84, 16, v110
  v_and_b32 v85, 0xffff0000, v110
  v_lshlrev_b32 v86, 16, v111
  v_and_b32 v87, 0xffff0000, v111
  v_lshlrev_b32 v88, 16, v112
  v_and_b32 v89, 0xffff0000, v112
  v_lshlrev_b32 v90, 16, v113
  v_and_b32 v91, 0xffff0000, v113
  v_lshlrev_b32 v92, 16, v114
  v_and_b32 v93, 0xffff0000, v114
  v_lshlrev_b32 v94, 16, v115
  v_and_b32 v95, 0xffff0000, v115
  s_waitcnt lgkmcnt(0)
  s_barrier
  s_cmp_lg_u32 s17, 0
  s_cbranch_scc1 m_done_117
  ds_read_b128 v[72:75], v3
  ds_read_b128 v[76:79], v3 offset:16
  s_and_b32 s29, s58, 0xffff0000
  s_xor_b32 s27, s29, 0x80000000
  s_xor_b32 s28, s29, 0xffff0000
  s_bitcmp1_b32 s29, 31
  s_cselect_b32 s29, s27, s28
  v_mov_b32 v108, s29
  v_mul_f32 v108, 0xbfb8aa3b, v108
  v_exp_f32 v108, v108
  s_nop 0
  v_add_f32 v108, 1.0, v108
  v_rcp_f32 v108, v108
  s_nop 0
  v_cvt_pk_bf16_f32 v108, 0, v108
  s_waitcnt lgkmcnt(0)
  v_cvt_pk_bf16_f32 v72, 0, v72
  v_cvt_pk_bf16_f32 v73, 0, v73
  v_cvt_pk_bf16_f32 v74, 0, v74
  v_cvt_pk_bf16_f32 v75, 0, v75
  v_cvt_pk_bf16_f32 v76, 0, v76
  v_cvt_pk_bf16_f32 v77, 0, v77
  v_cvt_pk_bf16_f32 v78, 0, v78
  v_cvt_pk_bf16_f32 v79, 0, v79
  v_mul_f32 v72, v72, v108
  v_mul_f32 v73, v73, v108
  v_mul_f32 v74, v74, v108
  v_mul_f32 v75, v75, v108
  v_mul_f32 v76, v76, v108
  v_mul_f32 v77, v77, v108
  v_mul_f32 v78, v78, v108
  v_mul_f32 v79, v79, v108
  v_cvt_pk_bf16_f32 v72, 0, v72
  v_cvt_pk_bf16_f32 v73, 0, v73
  v_cvt_pk_bf16_f32 v74, 0, v74
  v_cvt_pk_bf16_f32 v75, 0, v75
  v_cvt_pk_bf16_f32 v76, 0, v76
  v_cvt_pk_bf16_f32 v77, 0, v77
  v_cvt_pk_bf16_f32 v78, 0, v78
  v_cvt_pk_bf16_f32 v79, 0, v79
  v_add_f32 v72, v72, v88
  v_add_f32 v73, v73, v89
  v_add_f32 v74, v74, v90
  v_add_f32 v75, v75, v91
  v_add_f32 v76, v76, v92
  v_add_f32 v77, v77, v93
  v_add_f32 v78, v78, v94
  v_add_f32 v79, v79, v95
  v_cvt_pk_bf16_f32 v72, 0, v72
  v_cvt_pk_bf16_f32 v73, 0, v73
  v_cvt_pk_bf16_f32 v74, 0, v74
  v_cvt_pk_bf16_f32 v75, 0, v75
  v_cvt_pk_bf16_f32 v76, 0, v76
  v_cvt_pk_bf16_f32 v77, 0, v77
  v_cvt_pk_bf16_f32 v78, 0, v78
  v_cvt_pk_bf16_f32 v79, 0, v79
  v_add_f32 v80, v80, v72
  v_add_f32 v81, v81, v73
  v_add_f32 v82, v82, v74
  v_add_f32 v83, v83, v75
  v_add_f32 v84, v84, v76
  v_add_f32 v85, v85, v77
  v_add_f32 v86, v86, v78
  v_add_f32 v87, v87, v79
  v_cvt_pk_bf16_f32 v112, v80, v81
  v_cvt_pk_bf16_f32 v113, v82, v83
  v_cvt_pk_bf16_f32 v114, v84, v85
  v_cvt_pk_bf16_f32 v115, v86, v87
  v_lshlrev_b32 v80, 16, v112
  v_and_b32 v81, 0xffff0000, v112
  v_lshlrev_b32 v82, 16, v113
  v_and_b32 v83, 0xffff0000, v113
  v_lshlrev_b32 v84, 16, v114
  v_and_b32 v85, 0xffff0000, v114
  v_lshlrev_b32 v86, 16, v115
  v_and_b32 v87, 0xffff0000, v115
  s_lshl_b32 s26, s59, 10
  buffer_store_dwordx4 v[112:115], v0, s[72:75], s26 offen sc1
m_done_117:
q_fail_90:
  s_endpgm
L_o:
  s_sub_u32 s60, s91, 3
  s_and_b32 s61, s90, 15
  s_load_dwordx2 s[80:81], s[0:1], 40
  s_load_dwordx2 s[72:73], s[0:1], 0
  s_mov_b32 s82, 4194304
  v_and_b32 v42, 63, v0
  v_and_b32 v40, 15, v42
  v_lshrrev_b32 v41, 4, v42
  v_lshlrev_b32 v1, 3, v42
  v_lshlrev_b32 v2, 2, v42
  v_lshlrev_b32 v0, 4, v42
  s_mov_b32 s24, 0x3e0293ee
  s_mov_b32 s44, 0x05040100
  s_mov_b32 s45, 0x07060302
  s_and_b32 s26, s17, 1
  s_lshl_b32 s26, s26, 4
  v_lshlrev_b32 v43, 2, v41
  v_sub_u32 v43, v40, v43
  v_add_u32 v43, s26, v43
  v_mov_b32 v7, 0xfe000000
  v_cmp_le_i32 vcc, 0, v43
  s_nop 1
  v_cndmask_b32 v24, v7, 0, vcc
  v_cmp_le_i32 vcc, 1, v43
  s_nop 1
  v_cndmask_b32 v25, v7, 0, vcc
  v_cmp_le_i32 vcc, 2, v43
  s_nop 1
  v_cndmask_b32 v26, v7, 0, vcc
  v_cmp_le_i32 vcc, 3, v43
  s_nop 1
  v_cndmask_b32 v27, v7, 0, vcc
  v_cmp_le_i32 vcc, 16, v43
  s_nop 1
  v_cndmask_b32 v28, v7, 0, vcc
  v_cmp_le_i32 vcc, 17, v43
  s_nop 1
  v_cndmask_b32 v29, v7, 0, vcc
  v_cmp_le_i32 vcc, 18, v43
  s_nop 1
  v_cndmask_b32 v30, v7, 0, vcc
  v_cmp_le_i32 vcc, 19, v43
  s_nop 1
  v_cndmask_b32 v31, v7, 0, vcc
  v_lshrrev_b32 v43, 5, v42
  v_lshlrev_b32 v43, 16, v43
  v_and_b32 v4, 1, v41
  v_lshl_add_u32 v43, v4, 14, v43
  v_lshl_add_u32 v43, v40, 4, v43
  s_lshl_b32 s26, s61, 10
  s_lshl_b32 s27, s17, 8
  s_add_u32 s26, s26, s27
  v_add_u32 v4, s26, v43
  v_lshlrev_b32 v43, 10, v41
  v_lshl_add_u32 v5, v40, 4, v43
  s_lshl_b32 s26, s17, 12
  v_add_u32 v6, s26, v0
  v_and_b32 v43, 1, v41
  v_lshlrev_b32 v43, 12, v43
  v_lshl_add_u32 v43, v40, 4, v43
  v_lshrrev_b32 v3, 1, v41
  v_lshl_add_u32 v3, v3, 8, v43
  s_lshr_b32 s26, s17, 1
  s_lshl_b32 s27, s26, 14
  s_add_u32 s27, s27, 16384
  v_add_u32 v32, s27, v0
  s_lshl_b32 s27, s26, 13
  s_and_b32 s28, s17, 1
  s_lshl_b32 s28, s28, 10
  s_add_u32 s28, s28, s27
  s_add_u32 s28, s28, 49152
  v_add_u32 v33, s28, v0
  s_add_u32 s27, s27, 65536
  v_add_u32 v34, s27, v0
  v_add_u32 v35, s27, v1
  v_and_b32 v36, 0xf0, v0
  v_and_b32 v252, 64, v0
  v_mov_b32 v248, 0
  v_lshlrev_b32 v255, 4, v0
  v_and_b32 v43, 1, v42
  v_xor_b32 v254, 1, v43
  s_lshl_b32 s26, s17, 3
  s_add_u32 s26, s26, 81920
  v_mov_b32 v39, s26
  s_mov_b32 vcc_lo, 0xaaaaaaaa
  s_mov_b32 vcc_hi, 0xaaaaaaaa
  v_mov_b32 v43, 0x3f80
  v_cndmask_b32 v43, v43, 1.0, vcc
  s_mov_b32 vcc_lo, 0xf000f
  s_mov_b32 vcc_hi, 0xf000f00
  v_cndmask_b32 v16, 0, v43, vcc
  v_cndmask_b32 v18, 0, v43, vcc
  s_mov_b32 vcc_lo, 0xf000f0
  s_mov_b32 vcc_hi, 0xf000f000
  v_cndmask_b32 v17, 0, v43, vcc
  v_cndmask_b32 v19, 0, v43, vcc
  s_mov_b32 vcc_lo, 0xcccccccc
  s_mov_b32 vcc_hi, 0xcccccccc
  v_mov_b32 v43, 0x4444
  v_mov_b32 v20, 0xeeee
  v_cndmask_b32 v20, v43, v20, vcc
  s_mov_b32 s70, 2097152
  s_mov_b32 s71, 0x20000
  s_mov_b32 s74, 2097152
  s_mov_b32 s75, 0x20000
  s_mov_b32 s10, 1024
  s_mov_b32 s83, 0x20000
  s_lshr_b32 s85, s17, 1
  s_lshl_b32 s26, s61, 1
  s_add_u32 s85, s85, s26
  s_add_u32 s43, s26, s17
  s_lshl_b32 s14, s61, 8
  s_lshl_b32 s15, s61, 7
  s_add_u32 s15, s15, 245104640
  s_add_u32 s14, s14, 244318208
  s_lshl_b32 s26, s61, 2
  s_add_u32 s26, s26, s17
  s_lshl_b32 s18, s26, 13
  s_add_u32 s18, s18, 41943040
  s_lshl_b32 s19, s26, 12
  s_add_u32 s19, s19, 142606336
  s_lshl_b32 s20, s85, 13
  s_add_u32 s20, s20, 192937984
  s_and_b32 s26, s17, 1
  s_mul_i32 s26, s26, 3072
  s_add_u32 s21, s20, s26
  s_lshr_b32 s40, s17, 1
  s_lshl_b32 s40, s40, 13
  s_add_u32 s40, s40, s26
  s_add_u32 s40, s40, 65536
  s_lshl_b32 s22, s17, 12
  s_add_u32 s22, s22, 49152
  s_lshl_b32 s23, s17, 13
  s_add_u32 s23, s23, 16384
  s_lshl_b32 s41, s60, 20
  s_add_u32 s41, s41, 12582912
  v_lshlrev_b32 v246, 3, v0
  s_mov_b32 s11, 0x20000
  s_waitcnt lgkmcnt(0)
  s_lshl_b32 s77, s60, 4
  s_add_u32 s77, s77, s61
  s_lshl_b32 s77, s77, 2
  s_add_u32 s77, s77, s17
  s_lshl_b32 s26, s77, 10
  buffer_load_dwordx4 v[176:179], v0, s[72:75], s26 offen
  s_add_u32 s26, s26, 262144
  buffer_load_dwordx4 v[180:183], v0, s[72:75], s26 offen
  s_add_u32 s26, s26, 262144
  buffer_load_dwordx4 v[184:187], v0, s[72:75], s26 offen
  s_add_u32 s26, s26, 262144
  buffer_load_dwordx4 v[188:191], v0, s[72:75], s26 offen
  s_add_u32 s26, s26, 262144
  buffer_load_dwordx4 v[192:195], v0, s[72:75], s26 offen
  s_add_u32 s26, s26, 262144
  buffer_load_dwordx4 v[196:199], v0, s[72:75], s26 offen
  s_add_u32 s26, s26, 262144
  buffer_load_dwordx4 v[200:203], v0, s[72:75], s26 offen
  s_add_u32 s26, s26, 262144
  buffer_load_dwordx4 v[204:207], v0, s[72:75], s26 offen
  s_add_u32 s26, s26, 262144
  v_lshrrev_b32 v44, 9, v0
  v_lshlrev_b32 v44, 12, v44
  v_and_b32 v45, 0xf0, v0
  v_add_u32 v44, v44, v45
  v_bfe_u32 v45, v0, 8, 1
  v_lshl_add_u32 v44, v45, 3, v44
  s_lshl_b32 s30, s61, 18
  s_lshl_b32 s27, s17, 8
  s_add_u32 s30, s30, s27
  s_add_u32 s27, s30, 0
  buffer_load_dwordx2 v[64:65], v44, s[80:83], s27 offen
  s_add_u32 s27, s30, 1024
  buffer_load_dwordx2 v[66:67], v44, s[80:83], s27 offen
  s_add_u32 s27, s30, 2048
  buffer_load_dwordx2 v[68:69], v44, s[80:83], s27 offen
  s_add_u32 s27, s30, 3072
  buffer_load_dwordx2 v[70:71], v44, s[80:83], s27 offen
  s_add_u32 s27, s30, 16384
  buffer_load_dwordx2 v[72:73], v44, s[80:83], s27 offen
  s_add_u32 s27, s30, 17408
  buffer_load_dwordx2 v[74:75], v44, s[80:83], s27 offen
  s_add_u32 s27, s30, 18432
  buffer_load_dwordx2 v[76:77], v44, s[80:83], s27 offen
  s_add_u32 s27, s30, 19456
  buffer_load_dwordx2 v[78:79], v44, s[80:83], s27 offen
  s_add_u32 s27, s30, 8192
  buffer_load_dwordx2 v[80:81], v44, s[80:83], s27 offen
  s_add_u32 s27, s30, 9216
  buffer_load_dwordx2 v[82:83], v44, s[80:83], s27 offen
  s_add_u32 s27, s30, 10240
  buffer_load_dwordx2 v[84:85], v44, s[80:83], s27 offen
  s_add_u32 s27, s30, 11264
  buffer_load_dwordx2 v[86:87], v44, s[80:83], s27 offen
  s_add_u32 s27, s30, 24576
  buffer_load_dwordx2 v[88:89], v44, s[80:83], s27 offen
  s_add_u32 s27, s30, 25600
  buffer_load_dwordx2 v[90:91], v44, s[80:83], s27 offen
  s_add_u32 s27, s30, 26624
  buffer_load_dwordx2 v[92:93], v44, s[80:83], s27 offen
  s_add_u32 s27, s30, 27648
  buffer_load_dwordx2 v[94:95], v44, s[80:83], s27 offen
  s_add_u32 s27, s30, 32768
  buffer_load_dwordx2 v[96:97], v44, s[80:83], s27 offen
  s_add_u32 s27, s30, 33792
  buffer_load_dwordx2 v[98:99], v44, s[80:83], s27 offen
  s_add_u32 s27, s30, 34816
  buffer_load_dwordx2 v[100:101], v44, s[80:83], s27 offen
  s_add_u32 s27, s30, 35840
  buffer_load_dwordx2 v[102:103], v44, s[80:83], s27 offen
  s_add_u32 s27, s30, 49152
  buffer_load_dwordx2 v[104:105], v44, s[80:83], s27 offen
  s_add_u32 s27, s30, 50176
  buffer_load_dwordx2 v[106:107], v44, s[80:83], s27 offen
  s_add_u32 s27, s30, 51200
  buffer_load_dwordx2 v[108:109], v44, s[80:83], s27 offen
  s_add_u32 s27, s30, 52224
  buffer_load_dwordx2 v[110:111], v44, s[80:83], s27 offen
  s_add_u32 s27, s30, 40960
  buffer_load_dwordx2 v[112:113], v44, s[80:83], s27 offen
  s_add_u32 s27, s30, 41984
  buffer_load_dwordx2 v[114:115], v44, s[80:83], s27 offen
  s_add_u32 s27, s30, 43008
  buffer_load_dwordx2 v[116:117], v44, s[80:83], s27 offen
  s_add_u32 s27, s30, 44032
  buffer_load_dwordx2 v[118:119], v44, s[80:83], s27 offen
  s_add_u32 s27, s30, 57344
  buffer_load_dwordx2 v[120:121], v44, s[80:83], s27 offen
  s_add_u32 s27, s30, 58368
  buffer_load_dwordx2 v[122:123], v44, s[80:83], s27 offen
  s_add_u32 s27, s30, 59392
  buffer_load_dwordx2 v[124:125], v44, s[80:83], s27 offen
  s_add_u32 s27, s30, 60416
  buffer_load_dwordx2 v[126:127], v44, s[80:83], s27 offen
  s_load_dwordx2 s[4:5], s[0:1], 112
  s_load_dwordx2 s[12:13], s[0:1], 104
  s_load_dwordx2 s[68:69], s[0:1], 96
  s_load_dwordx2 s[8:9], s[0:1], 64
  s_waitcnt lgkmcnt(0)
  buffer_load_dwordx4 v[56:59], v0, s[8:11], 0 offen
  s_lshl_b32 s29, s77, 10
  s_add_u32 s29, s29, 6291456
  s_cmp_lt_u32 s60, 4
  s_cbranch_scc1 o_s1_119
  s_waitcnt vmcnt(0)
  s_branch o_s2_120
o_s1_119:
  s_waitcnt vmcnt(40)
  v_lshlrev_b32 v212, 16, v176
  v_and_b32 v213, 0xffff0000, v176
  v_lshlrev_b32 v214, 16, v177
  v_and_b32 v215, 0xffff0000, v177
  v_lshlrev_b32 v216, 16, v178
  v_and_b32 v217, 0xffff0000, v178
  v_lshlrev_b32 v218, 16, v179
  v_and_b32 v219, 0xffff0000, v179
  v_add_f32 v220, v212, v213
  v_add_f32 v221, v214, v215
  v_add_f32 v222, v216, v217
  v_add_f32 v223, v218, v219
  v_add_f32 v220, v220, v221
  v_add_f32 v222, v222, v223
  v_add_f32 v220, v220, v222
  s_nop 1
  v_add_f32_dpp v220, v220, v220 row_ror:8 row_mask:0xf bank_mask:0xf
  s_nop 1
  v_add_f32_dpp v220, v220, v220 row_ror:4 row_mask:0xf bank_mask:0xf
  s_nop 1
  v_add_f32_dpp v220, v220, v220 row_ror:2 row_mask:0xf bank_mask:0xf
  s_nop 1
  v_add_f32_dpp v220, v220, v220 row_ror:1 row_mask:0xf bank_mask:0xf
  v_mov_b32 v222, v220
  s_nop 0
  s_nop 0
  v_permlane16_swap_b32 v220, v222
  v_add_f32 v220, v220, v222
  v_mov_b32 v222, v220
  s_nop 0
  s_nop 0
  v_permlane32_swap_b32 v220, v222
  v_add_f32 v220, v220, v222
  v_mul_f32 v220, 0x3b000000, v220
  v_sub_f32 v224, v212, v220
  v_sub_f32 v225, v213, v220
  v_sub_f32 v226, v214, v220
  v_sub_f32 v227, v215, v220
  v_sub_f32 v228, v216, v220
  v_sub_f32 v229, v217, v220
  v_sub_f32 v230, v218, v220
  v_sub_f32 v231, v219, v220
  v_mul_f32 v221, v224, v224
  v_mul_f32 v222, v225, v225
  v_fmac_f32 v221, v226, v226
  v_fmac_f32 v222, v227, v227
  v_fmac_f32 v221, v228, v228
  v_fmac_f32 v222, v229, v229
  v_fmac_f32 v221, v230, v230
  v_fmac_f32 v222, v231, v231
  v_add_f32 v221, v221, v222
  v_cvt_pk_bf16_f32 v220, 0, v220
  s_nop 0
  v_add_f32_dpp v221, v221, v221 row_ror:8 row_mask:0xf bank_mask:0xf
  v_sub_f32 v224, v212, v220
  v_sub_f32 v225, v213, v220
  v_add_f32_dpp v221, v221, v221 row_ror:4 row_mask:0xf bank_mask:0xf
  v_sub_f32 v226, v214, v220
  v_sub_f32 v227, v215, v220
  v_add_f32_dpp v221, v221, v221 row_ror:2 row_mask:0xf bank_mask:0xf
  v_sub_f32 v228, v216, v220
  v_sub_f32 v229, v217, v220
  v_add_f32_dpp v221, v221, v221 row_ror:1 row_mask:0xf bank_mask:0xf
  v_sub_f32 v230, v218, v220
  v_sub_f32 v231, v219, v220
  v_mov_b32 v222, v221
  v_cvt_pk_bf16_f32 v224, 0, v224
  v_cvt_pk_bf16_f32 v225, 0, v225
  v_permlane16_swap_b32 v221, v222
  v_cvt_pk_bf16_f32 v226, 0, v226
  v_cvt_pk_bf16_f32 v227, 0, v227
  v_add_f32 v221, v221, v222
  v_cvt_pk_bf16_f32 v228, 0, v228
  v_cvt_pk_bf16_f32 v229, 0, v229
  v_mov_b32 v222, v221
  v_cvt_pk_bf16_f32 v230, 0, v230
  v_cvt_pk_bf16_f32 v231, 0, v231
  v_permlane32_swap_b32 v221, v222
  v_add_f32 v221, v221, v222
  v_mul_f32 v221, 0x3b000000, v221
  v_cvt_pk_bf16_f32 v221, 0, v221
  v_add_f32 v221, 0x3727c5ac, v221
  v_cvt_pk_bf16_f32 v221, 0, v221
  v_sqrt_f32 v221, v221
  s_nop 0
  v_cvt_pk_bf16_f32 v221, 0, v221
  v_rcp_f32 v221, v221
  s_nop 0
  v_mul_f32 v224, v224, v221
  v_mul_f32 v225, v225, v221
  v_mul_f32 v226, v226, v221
  v_mul_f32 v227, v227, v221
  v_mul_f32 v228, v228, v221
  v_mul_f32 v229, v229, v221
  v_mul_f32 v230, v230, v221
  v_mul_f32 v231, v231, v221
  v_cvt_pk_bf16_f32 v176, v224, v225
  v_cvt_pk_bf16_f32 v177, v226, v227
  v_cvt_pk_bf16_f32 v178, v228, v229
  v_cvt_pk_bf16_f32 v179, v230, v231
  buffer_store_dwordx4 v[176:179], v0, s[4:7], s29 offen sc1
  s_add_u32 s29, s29, 262144
  s_waitcnt vmcnt(40)
  v_lshlrev_b32 v212, 16, v180
  v_and_b32 v213, 0xffff0000, v180
  v_lshlrev_b32 v214, 16, v181
  v_and_b32 v215, 0xffff0000, v181
  v_lshlrev_b32 v216, 16, v182
  v_and_b32 v217, 0xffff0000, v182
  v_lshlrev_b32 v218, 16, v183
  v_and_b32 v219, 0xffff0000, v183
  v_add_f32 v220, v212, v213
  v_add_f32 v221, v214, v215
  v_add_f32 v222, v216, v217
  v_add_f32 v223, v218, v219
  v_add_f32 v220, v220, v221
  v_add_f32 v222, v222, v223
  v_add_f32 v220, v220, v222
  s_nop 1
  v_add_f32_dpp v220, v220, v220 row_ror:8 row_mask:0xf bank_mask:0xf
  s_nop 1
  v_add_f32_dpp v220, v220, v220 row_ror:4 row_mask:0xf bank_mask:0xf
  s_nop 1
  v_add_f32_dpp v220, v220, v220 row_ror:2 row_mask:0xf bank_mask:0xf
  s_nop 1
  v_add_f32_dpp v220, v220, v220 row_ror:1 row_mask:0xf bank_mask:0xf
  v_mov_b32 v222, v220
  s_nop 0
  s_nop 0
  v_permlane16_swap_b32 v220, v222
  v_add_f32 v220, v220, v222
  v_mov_b32 v222, v220
  s_nop 0
  s_nop 0
  v_permlane32_swap_b32 v220, v222
  v_add_f32 v220, v220, v222
  v_mul_f32 v220, 0x3b000000, v220
  v_sub_f32 v224, v212, v220
  v_sub_f32 v225, v213, v220
  v_sub_f32 v226, v214, v220
  v_sub_f32 v227, v215, v220
  v_sub_f32 v228, v216, v220
  v_sub_f32 v229, v217, v220
  v_sub_f32 v230, v218, v220
  v_sub_f32 v231, v219, v220
  v_mul_f32 v221, v224, v224
  v_mul_f32 v222, v225, v225
  v_fmac_f32 v221, v226, v226
  v_fmac_f32 v222, v227, v227
  v_fmac_f32 v221, v228, v228
  v_fmac_f32 v222, v229, v229
  v_fmac_f32 v221, v230, v230
  v_fmac_f32 v222, v231, v231
  v_add_f32 v221, v221, v222
  v_cvt_pk_bf16_f32 v220, 0, v220
  s_nop 0
  v_add_f32_dpp v221, v221, v221 row_ror:8 row_mask:0xf bank_mask:0xf
  v_sub_f32 v224, v212, v220
  v_sub_f32 v225, v213, v220
  v_add_f32_dpp v221, v221, v221 row_ror:4 row_mask:0xf bank_mask:0xf
  v_sub_f32 v226, v214, v220
  v_sub_f32 v227, v215, v220
  v_add_f32_dpp v221, v221, v221 row_ror:2 row_mask:0xf bank_mask:0xf
  v_sub_f32 v228, v216, v220
  v_sub_f32 v229, v217, v220
  v_add_f32_dpp v221, v221, v221 row_ror:1 row_mask:0xf bank_mask:0xf
  v_sub_f32 v230, v218, v220
  v_sub_f32 v231, v219, v220
  v_mov_b32 v222, v221
  v_cvt_pk_bf16_f32 v224, 0, v224
  v_cvt_pk_bf16_f32 v225, 0, v225
  v_permlane16_swap_b32 v221, v222
  v_cvt_pk_bf16_f32 v226, 0, v226
  v_cvt_pk_bf16_f32 v227, 0, v227
  v_add_f32 v221, v221, v222
  v_cvt_pk_bf16_f32 v228, 0, v228
  v_cvt_pk_bf16_f32 v229, 0, v229
  v_mov_b32 v222, v221
  v_cvt_pk_bf16_f32 v230, 0, v230
  v_cvt_pk_bf16_f32 v231, 0, v231
  v_permlane32_swap_b32 v221, v222
  v_add_f32 v221, v221, v222
  v_mul_f32 v221, 0x3b000000, v221
  v_cvt_pk_bf16_f32 v221, 0, v221
  v_add_f32 v221, 0x3727c5ac, v221
  v_cvt_pk_bf16_f32 v221, 0, v221
  v_sqrt_f32 v221, v221
  s_nop 0
  v_cvt_pk_bf16_f32 v221, 0, v221
  v_rcp_f32 v221, v221
  s_nop 0
  v_mul_f32 v224, v224, v221
  v_mul_f32 v225, v225, v221
  v_mul_f32 v226, v226, v221
  v_mul_f32 v227, v227, v221
  v_mul_f32 v228, v228, v221
  v_mul_f32 v229, v229, v221
  v_mul_f32 v230, v230, v221
  v_mul_f32 v231, v231, v221
  v_cvt_pk_bf16_f32 v180, v224, v225
  v_cvt_pk_bf16_f32 v181, v226, v227
  v_cvt_pk_bf16_f32 v182, v228, v229
  v_cvt_pk_bf16_f32 v183, v230, v231
  buffer_store_dwordx4 v[180:183], v0, s[4:7], s29 offen sc1
  s_add_u32 s29, s29, 262144
  s_waitcnt vmcnt(40)
  v_lshlrev_b32 v212, 16, v184
  v_and_b32 v213, 0xffff0000, v184
  v_lshlrev_b32 v214, 16, v185
  v_and_b32 v215, 0xffff0000, v185
  v_lshlrev_b32 v216, 16, v186
  v_and_b32 v217, 0xffff0000, v186
  v_lshlrev_b32 v218, 16, v187
  v_and_b32 v219, 0xffff0000, v187
  v_add_f32 v220, v212, v213
  v_add_f32 v221, v214, v215
  v_add_f32 v222, v216, v217
  v_add_f32 v223, v218, v219
  v_add_f32 v220, v220, v221
  v_add_f32 v222, v222, v223
  v_add_f32 v220, v220, v222
  s_nop 1
  v_add_f32_dpp v220, v220, v220 row_ror:8 row_mask:0xf bank_mask:0xf
  s_nop 1
  v_add_f32_dpp v220, v220, v220 row_ror:4 row_mask:0xf bank_mask:0xf
  s_nop 1
  v_add_f32_dpp v220, v220, v220 row_ror:2 row_mask:0xf bank_mask:0xf
  s_nop 1
  v_add_f32_dpp v220, v220, v220 row_ror:1 row_mask:0xf bank_mask:0xf
  v_mov_b32 v222, v220
  s_nop 0
  s_nop 0
  v_permlane16_swap_b32 v220, v222
  v_add_f32 v220, v220, v222
  v_mov_b32 v222, v220
  s_nop 0
  s_nop 0
  v_permlane32_swap_b32 v220, v222
  v_add_f32 v220, v220, v222
  v_mul_f32 v220, 0x3b000000, v220
  v_sub_f32 v224, v212, v220
  v_sub_f32 v225, v213, v220
  v_sub_f32 v226, v214, v220
  v_sub_f32 v227, v215, v220
  v_sub_f32 v228, v216, v220
  v_sub_f32 v229, v217, v220
  v_sub_f32 v230, v218, v220
  v_sub_f32 v231, v219, v220
  v_mul_f32 v221, v224, v224
  v_mul_f32 v222, v225, v225
  v_fmac_f32 v221, v226, v226
  v_fmac_f32 v222, v227, v227
  v_fmac_f32 v221, v228, v228
  v_fmac_f32 v222, v229, v229
  v_fmac_f32 v221, v230, v230
  v_fmac_f32 v222, v231, v231
  v_add_f32 v221, v221, v222
  v_cvt_pk_bf16_f32 v220, 0, v220
  s_nop 0
  v_add_f32_dpp v221, v221, v221 row_ror:8 row_mask:0xf bank_mask:0xf
  v_sub_f32 v224, v212, v220
  v_sub_f32 v225, v213, v220
  v_add_f32_dpp v221, v221, v221 row_ror:4 row_mask:0xf bank_mask:0xf
  v_sub_f32 v226, v214, v220
  v_sub_f32 v227, v215, v220
  v_add_f32_dpp v221, v221, v221 row_ror:2 row_mask:0xf bank_mask:0xf
  v_sub_f32 v228, v216, v220
  v_sub_f32 v229, v217, v220
  v_add_f32_dpp v221, v221, v221 row_ror:1 row_mask:0xf bank_mask:0xf
  v_sub_f32 v230, v218, v220
  v_sub_f32 v231, v219, v220
  v_mov_b32 v222, v221
  v_cvt_pk_bf16_f32 v224, 0, v224
  v_cvt_pk_bf16_f32 v225, 0, v225
  v_permlane16_swap_b32 v221, v222
  v_cvt_pk_bf16_f32 v226, 0, v226
  v_cvt_pk_bf16_f32 v227, 0, v227
  v_add_f32 v221, v221, v222
  v_cvt_pk_bf16_f32 v228, 0, v228
  v_cvt_pk_bf16_f32 v229, 0, v229
  v_mov_b32 v222, v221
  v_cvt_pk_bf16_f32 v230, 0, v230
  v_cvt_pk_bf16_f32 v231, 0, v231
  v_permlane32_swap_b32 v221, v222
  v_add_f32 v221, v221, v222
  v_mul_f32 v221, 0x3b000000, v221
  v_cvt_pk_bf16_f32 v221, 0, v221
  v_add_f32 v221, 0x3727c5ac, v221
  v_cvt_pk_bf16_f32 v221, 0, v221
  v_sqrt_f32 v221, v221
  s_nop 0
  v_cvt_pk_bf16_f32 v221, 0, v221
  v_rcp_f32 v221, v221
  s_nop 0
  v_mul_f32 v224, v224, v221
  v_mul_f32 v225, v225, v221
  v_mul_f32 v226, v226, v221
  v_mul_f32 v227, v227, v221
  v_mul_f32 v228, v228, v221
  v_mul_f32 v229, v229, v221
  v_mul_f32 v230, v230, v221
  v_mul_f32 v231, v231, v221
  v_cvt_pk_bf16_f32 v184, v224, v225
  v_cvt_pk_bf16_f32 v185, v226, v227
  v_cvt_pk_bf16_f32 v186, v228, v229
  v_cvt_pk_bf16_f32 v187, v230, v231
  buffer_store_dwordx4 v[184:187], v0, s[4:7], s29 offen sc1
  s_add_u32 s29, s29, 262144
  s_waitcnt vmcnt(40)
  v_lshlrev_b32 v212, 16, v188
  v_and_b32 v213, 0xffff0000, v188
  v_lshlrev_b32 v214, 16, v189
  v_and_b32 v215, 0xffff0000, v189
  v_lshlrev_b32 v216, 16, v190
  v_and_b32 v217, 0xffff0000, v190
  v_lshlrev_b32 v218, 16, v191
  v_and_b32 v219, 0xffff0000, v191
  v_add_f32 v220, v212, v213
  v_add_f32 v221, v214, v215
  v_add_f32 v222, v216, v217
  v_add_f32 v223, v218, v219
  v_add_f32 v220, v220, v221
  v_add_f32 v222, v222, v223
  v_add_f32 v220, v220, v222
  s_nop 1
  v_add_f32_dpp v220, v220, v220 row_ror:8 row_mask:0xf bank_mask:0xf
  s_nop 1
  v_add_f32_dpp v220, v220, v220 row_ror:4 row_mask:0xf bank_mask:0xf
  s_nop 1
  v_add_f32_dpp v220, v220, v220 row_ror:2 row_mask:0xf bank_mask:0xf
  s_nop 1
  v_add_f32_dpp v220, v220, v220 row_ror:1 row_mask:0xf bank_mask:0xf
  v_mov_b32 v222, v220
  s_nop 0
  s_nop 0
  v_permlane16_swap_b32 v220, v222
  v_add_f32 v220, v220, v222
  v_mov_b32 v222, v220
  s_nop 0
  s_nop 0
  v_permlane32_swap_b32 v220, v222
  v_add_f32 v220, v220, v222
  v_mul_f32 v220, 0x3b000000, v220
  v_sub_f32 v224, v212, v220
  v_sub_f32 v225, v213, v220
  v_sub_f32 v226, v214, v220
  v_sub_f32 v227, v215, v220
  v_sub_f32 v228, v216, v220
  v_sub_f32 v229, v217, v220
  v_sub_f32 v230, v218, v220
  v_sub_f32 v231, v219, v220
  v_mul_f32 v221, v224, v224
  v_mul_f32 v222, v225, v225
  v_fmac_f32 v221, v226, v226
  v_fmac_f32 v222, v227, v227
  v_fmac_f32 v221, v228, v228
  v_fmac_f32 v222, v229, v229
  v_fmac_f32 v221, v230, v230
  v_fmac_f32 v222, v231, v231
  v_add_f32 v221, v221, v222
  v_cvt_pk_bf16_f32 v220, 0, v220
  s_nop 0
  v_add_f32_dpp v221, v221, v221 row_ror:8 row_mask:0xf bank_mask:0xf
  v_sub_f32 v224, v212, v220
  v_sub_f32 v225, v213, v220
  v_add_f32_dpp v221, v221, v221 row_ror:4 row_mask:0xf bank_mask:0xf
  v_sub_f32 v226, v214, v220
  v_sub_f32 v227, v215, v220
  v_add_f32_dpp v221, v221, v221 row_ror:2 row_mask:0xf bank_mask:0xf
  v_sub_f32 v228, v216, v220
  v_sub_f32 v229, v217, v220
  v_add_f32_dpp v221, v221, v221 row_ror:1 row_mask:0xf bank_mask:0xf
  v_sub_f32 v230, v218, v220
  v_sub_f32 v231, v219, v220
  v_mov_b32 v222, v221
  v_cvt_pk_bf16_f32 v224, 0, v224
  v_cvt_pk_bf16_f32 v225, 0, v225
  v_permlane16_swap_b32 v221, v222
  v_cvt_pk_bf16_f32 v226, 0, v226
  v_cvt_pk_bf16_f32 v227, 0, v227
  v_add_f32 v221, v221, v222
  v_cvt_pk_bf16_f32 v228, 0, v228
  v_cvt_pk_bf16_f32 v229, 0, v229
  v_mov_b32 v222, v221
  v_cvt_pk_bf16_f32 v230, 0, v230
  v_cvt_pk_bf16_f32 v231, 0, v231
  v_permlane32_swap_b32 v221, v222
  v_add_f32 v221, v221, v222
  v_mul_f32 v221, 0x3b000000, v221
  v_cvt_pk_bf16_f32 v221, 0, v221
  v_add_f32 v221, 0x3727c5ac, v221
  v_cvt_pk_bf16_f32 v221, 0, v221
  v_sqrt_f32 v221, v221
  s_nop 0
  v_cvt_pk_bf16_f32 v221, 0, v221
  v_rcp_f32 v221, v221
  s_nop 0
  v_mul_f32 v224, v224, v221
  v_mul_f32 v225, v225, v221
  v_mul_f32 v226, v226, v221
  v_mul_f32 v227, v227, v221
  v_mul_f32 v228, v228, v221
  v_mul_f32 v229, v229, v221
  v_mul_f32 v230, v230, v221
  v_mul_f32 v231, v231, v221
  v_cvt_pk_bf16_f32 v188, v224, v225
  v_cvt_pk_bf16_f32 v189, v226, v227
  v_cvt_pk_bf16_f32 v190, v228, v229
  v_cvt_pk_bf16_f32 v191, v230, v231
  buffer_store_dwordx4 v[188:191], v0, s[4:7], s29 offen sc1
  s_add_u32 s29, s29, 262144
  s_waitcnt vmcnt(40)
  v_lshlrev_b32 v212, 16, v192
  v_and_b32 v213, 0xffff0000, v192
  v_lshlrev_b32 v214, 16, v193
  v_and_b32 v215, 0xffff0000, v193
  v_lshlrev_b32 v216, 16, v194
  v_and_b32 v217, 0xffff0000, v194
  v_lshlrev_b32 v218, 16, v195
  v_and_b32 v219, 0xffff0000, v195
  v_add_f32 v220, v212, v213
  v_add_f32 v221, v214, v215
  v_add_f32 v222, v216, v217
  v_add_f32 v223, v218, v219
  v_add_f32 v220, v220, v221
  v_add_f32 v222, v222, v223
  v_add_f32 v220, v220, v222
  s_nop 1
  v_add_f32_dpp v220, v220, v220 row_ror:8 row_mask:0xf bank_mask:0xf
  s_nop 1
  v_add_f32_dpp v220, v220, v220 row_ror:4 row_mask:0xf bank_mask:0xf
  s_nop 1
  v_add_f32_dpp v220, v220, v220 row_ror:2 row_mask:0xf bank_mask:0xf
  s_nop 1
  v_add_f32_dpp v220, v220, v220 row_ror:1 row_mask:0xf bank_mask:0xf
  v_mov_b32 v222, v220
  s_nop 0
  s_nop 0
  v_permlane16_swap_b32 v220, v222
  v_add_f32 v220, v220, v222
  v_mov_b32 v222, v220
  s_nop 0
  s_nop 0
  v_permlane32_swap_b32 v220, v222
  v_add_f32 v220, v220, v222
  v_mul_f32 v220, 0x3b000000, v220
  v_sub_f32 v224, v212, v220
  v_sub_f32 v225, v213, v220
  v_sub_f32 v226, v214, v220
  v_sub_f32 v227, v215, v220
  v_sub_f32 v228, v216, v220
  v_sub_f32 v229, v217, v220
  v_sub_f32 v230, v218, v220
  v_sub_f32 v231, v219, v220
  v_mul_f32 v221, v224, v224
  v_mul_f32 v222, v225, v225
  v_fmac_f32 v221, v226, v226
  v_fmac_f32 v222, v227, v227
  v_fmac_f32 v221, v228, v228
  v_fmac_f32 v222, v229, v229
  v_fmac_f32 v221, v230, v230
  v_fmac_f32 v222, v231, v231
  v_add_f32 v221, v221, v222
  v_cvt_pk_bf16_f32 v220, 0, v220
  s_nop 0
  v_add_f32_dpp v221, v221, v221 row_ror:8 row_mask:0xf bank_mask:0xf
  v_sub_f32 v224, v212, v220
  v_sub_f32 v225, v213, v220
  v_add_f32_dpp v221, v221, v221 row_ror:4 row_mask:0xf bank_mask:0xf
  v_sub_f32 v226, v214, v220
  v_sub_f32 v227, v215, v220
  v_add_f32_dpp v221, v221, v221 row_ror:2 row_mask:0xf bank_mask:0xf
  v_sub_f32 v228, v216, v220
  v_sub_f32 v229, v217, v220
  v_add_f32_dpp v221, v221, v221 row_ror:1 row_mask:0xf bank_mask:0xf
  v_sub_f32 v230, v218, v220
  v_sub_f32 v231, v219, v220
  v_mov_b32 v222, v221
  v_cvt_pk_bf16_f32 v224, 0, v224
  v_cvt_pk_bf16_f32 v225, 0, v225
  v_permlane16_swap_b32 v221, v222
  v_cvt_pk_bf16_f32 v226, 0, v226
  v_cvt_pk_bf16_f32 v227, 0, v227
  v_add_f32 v221, v221, v222
  v_cvt_pk_bf16_f32 v228, 0, v228
  v_cvt_pk_bf16_f32 v229, 0, v229
  v_mov_b32 v222, v221
  v_cvt_pk_bf16_f32 v230, 0, v230
  v_cvt_pk_bf16_f32 v231, 0, v231
  v_permlane32_swap_b32 v221, v222
  v_add_f32 v221, v221, v222
  v_mul_f32 v221, 0x3b000000, v221
  v_cvt_pk_bf16_f32 v221, 0, v221
  v_add_f32 v221, 0x3727c5ac, v221
  v_cvt_pk_bf16_f32 v221, 0, v221
  v_sqrt_f32 v221, v221
  s_nop 0
  v_cvt_pk_bf16_f32 v221, 0, v221
  v_rcp_f32 v221, v221
  s_nop 0
  v_mul_f32 v224, v224, v221
  v_mul_f32 v225, v225, v221
  v_mul_f32 v226, v226, v221
  v_mul_f32 v227, v227, v221
  v_mul_f32 v228, v228, v221
  v_mul_f32 v229, v229, v221
  v_mul_f32 v230, v230, v221
  v_mul_f32 v231, v231, v221
  v_cvt_pk_bf16_f32 v192, v224, v225
  v_cvt_pk_bf16_f32 v193, v226, v227
  v_cvt_pk_bf16_f32 v194, v228, v229
  v_cvt_pk_bf16_f32 v195, v230, v231
  buffer_store_dwordx4 v[192:195], v0, s[4:7], s29 offen sc1
  s_add_u32 s29, s29, 262144
  s_waitcnt vmcnt(40)
  v_lshlrev_b32 v212, 16, v196
  v_and_b32 v213, 0xffff0000, v196
  v_lshlrev_b32 v214, 16, v197
  v_and_b32 v215, 0xffff0000, v197
  v_lshlrev_b32 v216, 16, v198
  v_and_b32 v217, 0xffff0000, v198
  v_lshlrev_b32 v218, 16, v199
  v_and_b32 v219, 0xffff0000, v199
  v_add_f32 v220, v212, v213
  v_add_f32 v221, v214, v215
  v_add_f32 v222, v216, v217
  v_add_f32 v223, v218, v219
  v_add_f32 v220, v220, v221
  v_add_f32 v222, v222, v223
  v_add_f32 v220, v220, v222
  s_nop 1
  v_add_f32_dpp v220, v220, v220 row_ror:8 row_mask:0xf bank_mask:0xf
  s_nop 1
  v_add_f32_dpp v220, v220, v220 row_ror:4 row_mask:0xf bank_mask:0xf
  s_nop 1
  v_add_f32_dpp v220, v220, v220 row_ror:2 row_mask:0xf bank_mask:0xf
  s_nop 1
  v_add_f32_dpp v220, v220, v220 row_ror:1 row_mask:0xf bank_mask:0xf
  v_mov_b32 v222, v220
  s_nop 0
  s_nop 0
  v_permlane16_swap_b32 v220, v222
  v_add_f32 v220, v220, v222
  v_mov_b32 v222, v220
  s_nop 0
  s_nop 0
  v_permlane32_swap_b32 v220, v222
  v_add_f32 v220, v220, v222
  v_mul_f32 v220, 0x3b000000, v220
  v_sub_f32 v224, v212, v220
  v_sub_f32 v225, v213, v220
  v_sub_f32 v226, v214, v220
  v_sub_f32 v227, v215, v220
  v_sub_f32 v228, v216, v220
  v_sub_f32 v229, v217, v220
  v_sub_f32 v230, v218, v220
  v_sub_f32 v231, v219, v220
  v_mul_f32 v221, v224, v224
  v_mul_f32 v222, v225, v225
  v_fmac_f32 v221, v226, v226
  v_fmac_f32 v222, v227, v227
  v_fmac_f32 v221, v228, v228
  v_fmac_f32 v222, v229, v229
  v_fmac_f32 v221, v230, v230
  v_fmac_f32 v222, v231, v231
  v_add_f32 v221, v221, v222
  v_cvt_pk_bf16_f32 v220, 0, v220
  s_nop 0
  v_add_f32_dpp v221, v221, v221 row_ror:8 row_mask:0xf bank_mask:0xf
  v_sub_f32 v224, v212, v220
  v_sub_f32 v225, v213, v220
  v_add_f32_dpp v221, v221, v221 row_ror:4 row_mask:0xf bank_mask:0xf
  v_sub_f32 v226, v214, v220
  v_sub_f32 v227, v215, v220
  v_add_f32_dpp v221, v221, v221 row_ror:2 row_mask:0xf bank_mask:0xf
  v_sub_f32 v228, v216, v220
  v_sub_f32 v229, v217, v220
  v_add_f32_dpp v221, v221, v221 row_ror:1 row_mask:0xf bank_mask:0xf
  v_sub_f32 v230, v218, v220
  v_sub_f32 v231, v219, v220
  v_mov_b32 v222, v221
  v_cvt_pk_bf16_f32 v224, 0, v224
  v_cvt_pk_bf16_f32 v225, 0, v225
  v_permlane16_swap_b32 v221, v222
  v_cvt_pk_bf16_f32 v226, 0, v226
  v_cvt_pk_bf16_f32 v227, 0, v227
  v_add_f32 v221, v221, v222
  v_cvt_pk_bf16_f32 v228, 0, v228
  v_cvt_pk_bf16_f32 v229, 0, v229
  v_mov_b32 v222, v221
  v_cvt_pk_bf16_f32 v230, 0, v230
  v_cvt_pk_bf16_f32 v231, 0, v231
  v_permlane32_swap_b32 v221, v222
  v_add_f32 v221, v221, v222
  v_mul_f32 v221, 0x3b000000, v221
  v_cvt_pk_bf16_f32 v221, 0, v221
  v_add_f32 v221, 0x3727c5ac, v221
  v_cvt_pk_bf16_f32 v221, 0, v221
  v_sqrt_f32 v221, v221
  s_nop 0
  v_cvt_pk_bf16_f32 v221, 0, v221
  v_rcp_f32 v221, v221
  s_nop 0
  v_mul_f32 v224, v224, v221
  v_mul_f32 v225, v225, v221
  v_mul_f32 v226, v226, v221
  v_mul_f32 v227, v227, v221
  v_mul_f32 v228, v228, v221
  v_mul_f32 v229, v229, v221
  v_mul_f32 v230, v230, v221
  v_mul_f32 v231, v231, v221
  v_cvt_pk_bf16_f32 v196, v224, v225
  v_cvt_pk_bf16_f32 v197, v226, v227
  v_cvt_pk_bf16_f32 v198, v228, v229
  v_cvt_pk_bf16_f32 v199, v230, v231
  buffer_store_dwordx4 v[196:199], v0, s[4:7], s29 offen sc1
  s_add_u32 s29, s29, 262144
  s_waitcnt vmcnt(40)
  v_lshlrev_b32 v212, 16, v200
  v_and_b32 v213, 0xffff0000, v200
  v_lshlrev_b32 v214, 16, v201
  v_and_b32 v215, 0xffff0000, v201
  v_lshlrev_b32 v216, 16, v202
  v_and_b32 v217, 0xffff0000, v202
  v_lshlrev_b32 v218, 16, v203
  v_and_b32 v219, 0xffff0000, v203
  v_add_f32 v220, v212, v213
  v_add_f32 v221, v214, v215
  v_add_f32 v222, v216, v217
  v_add_f32 v223, v218, v219
  v_add_f32 v220, v220, v221
  v_add_f32 v222, v222, v223
  v_add_f32 v220, v220, v222
  s_nop 1
  v_add_f32_dpp v220, v220, v220 row_ror:8 row_mask:0xf bank_mask:0xf
  s_nop 1
  v_add_f32_dpp v220, v220, v220 row_ror:4 row_mask:0xf bank_mask:0xf
  s_nop 1
  v_add_f32_dpp v220, v220, v220 row_ror:2 row_mask:0xf bank_mask:0xf
  s_nop 1
  v_add_f32_dpp v220, v220, v220 row_ror:1 row_mask:0xf bank_mask:0xf
  v_mov_b32 v222, v220
  s_nop 0
  s_nop 0
  v_permlane16_swap_b32 v220, v222
  v_add_f32 v220, v220, v222
  v_mov_b32 v222, v220
  s_nop 0
  s_nop 0
  v_permlane32_swap_b32 v220, v222
  v_add_f32 v220, v220, v222
  v_mul_f32 v220, 0x3b000000, v220
  v_sub_f32 v224, v212, v220
  v_sub_f32 v225, v213, v220
  v_sub_f32 v226, v214, v220
  v_sub_f32 v227, v215, v220
  v_sub_f32 v228, v216, v220
  v_sub_f32 v229, v217, v220
  v_sub_f32 v230, v218, v220
  v_sub_f32 v231, v219, v220
  v_mul_f32 v221, v224, v224
  v_mul_f32 v222, v225, v225
  v_fmac_f32 v221, v226, v226
  v_fmac_f32 v222, v227, v227
  v_fmac_f32 v221, v228, v228
  v_fmac_f32 v222, v229, v229
  v_fmac_f32 v221, v230, v230
  v_fmac_f32 v222, v231, v231
  v_add_f32 v221, v221, v222
  v_cvt_pk_bf16_f32 v220, 0, v220
  s_nop 0
  v_add_f32_dpp v221, v221, v221 row_ror:8 row_mask:0xf bank_mask:0xf
  v_sub_f32 v224, v212, v220
  v_sub_f32 v225, v213, v220
  v_add_f32_dpp v221, v221, v221 row_ror:4 row_mask:0xf bank_mask:0xf
  v_sub_f32 v226, v214, v220
  v_sub_f32 v227, v215, v220
  v_add_f32_dpp v221, v221, v221 row_ror:2 row_mask:0xf bank_mask:0xf
  v_sub_f32 v228, v216, v220
  v_sub_f32 v229, v217, v220
  v_add_f32_dpp v221, v221, v221 row_ror:1 row_mask:0xf bank_mask:0xf
  v_sub_f32 v230, v218, v220
  v_sub_f32 v231, v219, v220
  v_mov_b32 v222, v221
  v_cvt_pk_bf16_f32 v224, 0, v224
  v_cvt_pk_bf16_f32 v225, 0, v225
  v_permlane16_swap_b32 v221, v222
  v_cvt_pk_bf16_f32 v226, 0, v226
  v_cvt_pk_bf16_f32 v227, 0, v227
  v_add_f32 v221, v221, v222
  v_cvt_pk_bf16_f32 v228, 0, v228
  v_cvt_pk_bf16_f32 v229, 0, v229
  v_mov_b32 v222, v221
  v_cvt_pk_bf16_f32 v230, 0, v230
  v_cvt_pk_bf16_f32 v231, 0, v231
  v_permlane32_swap_b32 v221, v222
  v_add_f32 v221, v221, v222
  v_mul_f32 v221, 0x3b000000, v221
  v_cvt_pk_bf16_f32 v221, 0, v221
  v_add_f32 v221, 0x3727c5ac, v221
  v_cvt_pk_bf16_f32 v221, 0, v221
  v_sqrt_f32 v221, v221
  s_nop 0
  v_cvt_pk_bf16_f32 v221, 0, v221
  v_rcp_f32 v221, v221
  s_nop 0
  v_mul_f32 v224, v224, v221
  v_mul_f32 v225, v225, v221
  v_mul_f32 v226, v226, v221
  v_mul_f32 v227, v227, v221
  v_mul_f32 v228, v228, v221
  v_mul_f32 v229, v229, v221
  v_mul_f32 v230, v230, v221
  v_mul_f32 v231, v231, v221
  v_cvt_pk_bf16_f32 v200, v224, v225
  v_cvt_pk_bf16_f32 v201, v226, v227
  v_cvt_pk_bf16_f32 v202, v228, v229
  v_cvt_pk_bf16_f32 v203, v230, v231
  buffer_store_dwordx4 v[200:203], v0, s[4:7], s29 offen sc1
  s_add_u32 s29, s29, 262144
  s_waitcnt vmcnt(40)
  v_lshlrev_b32 v212, 16, v204
  v_and_b32 v213, 0xffff0000, v204
  v_lshlrev_b32 v214, 16, v205
  v_and_b32 v215, 0xffff0000, v205
  v_lshlrev_b32 v216, 16, v206
  v_and_b32 v217, 0xffff0000, v206
  v_lshlrev_b32 v218, 16, v207
  v_and_b32 v219, 0xffff0000, v207
  v_add_f32 v220, v212, v213
  v_add_f32 v221, v214, v215
  v_add_f32 v222, v216, v217
  v_add_f32 v223, v218, v219
  v_add_f32 v220, v220, v221
  v_add_f32 v222, v222, v223
  v_add_f32 v220, v220, v222
  s_nop 1
  v_add_f32_dpp v220, v220, v220 row_ror:8 row_mask:0xf bank_mask:0xf
  s_nop 1
  v_add_f32_dpp v220, v220, v220 row_ror:4 row_mask:0xf bank_mask:0xf
  s_nop 1
  v_add_f32_dpp v220, v220, v220 row_ror:2 row_mask:0xf bank_mask:0xf
  s_nop 1
  v_add_f32_dpp v220, v220, v220 row_ror:1 row_mask:0xf bank_mask:0xf
  v_mov_b32 v222, v220
  s_nop 0
  s_nop 0
  v_permlane16_swap_b32 v220, v222
  v_add_f32 v220, v220, v222
  v_mov_b32 v222, v220
  s_nop 0
  s_nop 0
  v_permlane32_swap_b32 v220, v222
  v_add_f32 v220, v220, v222
  v_mul_f32 v220, 0x3b000000, v220
  v_sub_f32 v224, v212, v220
  v_sub_f32 v225, v213, v220
  v_sub_f32 v226, v214, v220
  v_sub_f32 v227, v215, v220
  v_sub_f32 v228, v216, v220
  v_sub_f32 v229, v217, v220
  v_sub_f32 v230, v218, v220
  v_sub_f32 v231, v219, v220
  v_mul_f32 v221, v224, v224
  v_mul_f32 v222, v225, v225
  v_fmac_f32 v221, v226, v226
  v_fmac_f32 v222, v227, v227
  v_fmac_f32 v221, v228, v228
  v_fmac_f32 v222, v229, v229
  v_fmac_f32 v221, v230, v230
  v_fmac_f32 v222, v231, v231
  v_add_f32 v221, v221, v222
  v_cvt_pk_bf16_f32 v220, 0, v220
  s_nop 0
  v_add_f32_dpp v221, v221, v221 row_ror:8 row_mask:0xf bank_mask:0xf
  v_sub_f32 v224, v212, v220
  v_sub_f32 v225, v213, v220
  v_add_f32_dpp v221, v221, v221 row_ror:4 row_mask:0xf bank_mask:0xf
  v_sub_f32 v226, v214, v220
  v_sub_f32 v227, v215, v220
  v_add_f32_dpp v221, v221, v221 row_ror:2 row_mask:0xf bank_mask:0xf
  v_sub_f32 v228, v216, v220
  v_sub_f32 v229, v217, v220
  v_add_f32_dpp v221, v221, v221 row_ror:1 row_mask:0xf bank_mask:0xf
  v_sub_f32 v230, v218, v220
  v_sub_f32 v231, v219, v220
  v_mov_b32 v222, v221
  v_cvt_pk_bf16_f32 v224, 0, v224
  v_cvt_pk_bf16_f32 v225, 0, v225
  v_permlane16_swap_b32 v221, v222
  v_cvt_pk_bf16_f32 v226, 0, v226
  v_cvt_pk_bf16_f32 v227, 0, v227
  v_add_f32 v221, v221, v222
  v_cvt_pk_bf16_f32 v228, 0, v228
  v_cvt_pk_bf16_f32 v229, 0, v229
  v_mov_b32 v222, v221
  v_cvt_pk_bf16_f32 v230, 0, v230
  v_cvt_pk_bf16_f32 v231, 0, v231
  v_permlane32_swap_b32 v221, v222
  v_add_f32 v221, v221, v222
  v_mul_f32 v221, 0x3b000000, v221
  v_cvt_pk_bf16_f32 v221, 0, v221
  v_add_f32 v221, 0x3727c5ac, v221
  v_cvt_pk_bf16_f32 v221, 0, v221
  v_sqrt_f32 v221, v221
  s_nop 0
  v_cvt_pk_bf16_f32 v221, 0, v221
  v_rcp_f32 v221, v221
  s_nop 0
  v_mul_f32 v224, v224, v221
  v_mul_f32 v225, v225, v221
  v_mul_f32 v226, v226, v221
  v_mul_f32 v227, v227, v221
  v_mul_f32 v228, v228, v221
  v_mul_f32 v229, v229, v221
  v_mul_f32 v230, v230, v221
  v_mul_f32 v231, v231, v221
  v_cvt_pk_bf16_f32 v204, v224, v225
  v_cvt_pk_bf16_f32 v205, v226, v227
  v_cvt_pk_bf16_f32 v206, v228, v229
  v_cvt_pk_bf16_f32 v207, v230, v231
  buffer_store_dwordx4 v[204:207], v0, s[4:7], s29 offen sc1
  s_add_u32 s29, s29, 262144
o_s2_120:
  s_waitcnt vmcnt(33)
  v_perm_b32 v48, v66, v64, s44
  v_perm_b32 v49, v70, v68, s44
  v_perm_b32 v50, v74, v72, s44
  v_perm_b32 v51, v78, v76, s44
  v_accvgpr_write_b32 a0, v48
  v_accvgpr_write_b32 a1, v49
  v_accvgpr_write_b32 a2, v50
  v_accvgpr_write_b32 a3, v51
  v_perm_b32 v52, v66, v64, s45
  v_perm_b32 v53, v70, v68, s45
  v_perm_b32 v54, v74, v72, s45
  v_perm_b32 v55, v78, v76, s45
  v_accvgpr_write_b32 a4, v52
  v_accvgpr_write_b32 a5, v53
  v_accvgpr_write_b32 a6, v54
  v_accvgpr_write_b32 a7, v55
  v_perm_b32 v48, v67, v65, s44
  v_perm_b32 v49, v71, v69, s44
  v_perm_b32 v50, v75, v73, s44
  v_perm_b32 v51, v79, v77, s44
  v_accvgpr_write_b32 a8, v48
  v_accvgpr_write_b32 a9, v49
  v_accvgpr_write_b32 a10, v50
  v_accvgpr_write_b32 a11, v51
  v_perm_b32 v52, v67, v65, s45
  v_perm_b32 v53, v71, v69, s45
  v_perm_b32 v54, v75, v73, s45
  v_perm_b32 v55, v79, v77, s45
  v_accvgpr_write_b32 a12, v52
  v_accvgpr_write_b32 a13, v53
  v_accvgpr_write_b32 a14, v54
  v_accvgpr_write_b32 a15, v55
  s_waitcnt vmcnt(25)
  v_perm_b32 v48, v82, v80, s44
  v_perm_b32 v49, v86, v84, s44
  v_perm_b32 v50, v90, v88, s44
  v_perm_b32 v51, v94, v92, s44
  v_accvgpr_write_b32 a16, v48
  v_accvgpr_write_b32 a17, v49
  v_accvgpr_write_b32 a18, v50
  v_accvgpr_write_b32 a19, v51
  v_perm_b32 v52, v82, v80, s45
  v_perm_b32 v53, v86, v84, s45
  v_perm_b32 v54, v90, v88, s45
  v_perm_b32 v55, v94, v92, s45
  v_accvgpr_write_b32 a20, v52
  v_accvgpr_write_b32 a21, v53
  v_accvgpr_write_b32 a22, v54
  v_accvgpr_write_b32 a23, v55
  v_perm_b32 v48, v83, v81, s44
  v_perm_b32 v49, v87, v85, s44
  v_perm_b32 v50, v91, v89, s44
  v_perm_b32 v51, v95, v93, s44
  v_accvgpr_write_b32 a24, v48
  v_accvgpr_write_b32 a25, v49
  v_accvgpr_write_b32 a26, v50
  v_accvgpr_write_b32 a27, v51
  v_perm_b32 v52, v83, v81, s45
  v_perm_b32 v53, v87, v85, s45
  v_perm_b32 v54, v91, v89, s45
  v_perm_b32 v55, v95, v93, s45
  v_accvgpr_write_b32 a28, v52
  v_accvgpr_write_b32 a29, v53
  v_accvgpr_write_b32 a30, v54
  v_accvgpr_write_b32 a31, v55
  s_waitcnt vmcnt(17)
  v_perm_b32 v48, v98, v96, s44
  v_perm_b32 v49, v102, v100, s44
  v_perm_b32 v50, v106, v104, s44
  v_perm_b32 v51, v110, v108, s44
  v_accvgpr_write_b32 a32, v48
  v_accvgpr_write_b32 a33, v49
  v_accvgpr_write_b32 a34, v50
  v_accvgpr_write_b32 a35, v51
  v_perm_b32 v52, v98, v96, s45
  v_perm_b32 v53, v102, v100, s45
  v_perm_b32 v54, v106, v104, s45
  v_perm_b32 v55, v110, v108, s45
  v_accvgpr_write_b32 a36, v52
  v_accvgpr_write_b32 a37, v53
  v_accvgpr_write_b32 a38, v54
  v_accvgpr_write_b32 a39, v55
  v_perm_b32 v48, v99, v97, s44
  v_perm_b32 v49, v103, v101, s44
  v_perm_b32 v50, v107, v105, s44
  v_perm_b32 v51, v111, v109, s44
  v_accvgpr_write_b32 a40, v48
  v_accvgpr_write_b32 a41, v49
  v_accvgpr_write_b32 a42, v50
  v_accvgpr_write_b32 a43, v51
  v_perm_b32 v52, v99, v97, s45
  v_perm_b32 v53, v103, v101, s45
  v_perm_b32 v54, v107, v105, s45
  v_perm_b32 v55, v111, v109, s45
  v_accvgpr_write_b32 a44, v52
  v_accvgpr_write_b32 a45, v53
  v_accvgpr_write_b32 a46, v54
  v_accvgpr_write_b32 a47, v55
  s_waitcnt vmcnt(9)
  v_perm_b32 v48, v114, v112, s44
  v_perm_b32 v49, v118, v116, s44
  v_perm_b32 v50, v122, v120, s44
  v_perm_b32 v51, v126, v124, s44
  v_accvgpr_write_b32 a48, v48
  v_accvgpr_write_b32 a49, v49
  v_accvgpr_write_b32 a50, v50
  v_accvgpr_write_b32 a51, v51
  v_perm_b32 v52, v114, v112, s45
  v_perm_b32 v53, v118, v116, s45
  v_perm_b32 v54, v122, v120, s45
  v_perm_b32 v55, v126, v124, s45
  v_accvgpr_write_b32 a52, v52
  v_accvgpr_write_b32 a53, v53
  v_accvgpr_write_b32 a54, v54
  v_accvgpr_write_b32 a55, v55
  v_perm_b32 v48, v115, v113, s44
  v_perm_b32 v49, v119, v117, s44
  v_perm_b32 v50, v123, v121, s44
  v_perm_b32 v51, v127, v125, s44
  v_accvgpr_write_b32 a56, v48
  v_accvgpr_write_b32 a57, v49
  v_accvgpr_write_b32 a58, v50
  v_accvgpr_write_b32 a59, v51
  v_perm_b32 v52, v115, v113, s45
  v_perm_b32 v53, v119, v117, s45
  v_perm_b32 v54, v123, v121, s45
  v_perm_b32 v55, v127, v125, s45
  v_accvgpr_write_b32 a60, v52
  v_accvgpr_write_b32 a61, v53
  v_accvgpr_write_b32 a62, v54
  v_accvgpr_write_b32 a63, v55
  s_cmp_ge_u32 s60, 4
  s_cbranch_scc1 o_s3_121
  v_mbcnt_lo_u32_b32 v60, -1, 0
  v_and_b32 v60, 0, v60
  v_add_lshl_u32 v60, v60, 1, 2
  s_mov_b32 s26, 0
g_wt_122:
  global_load_dword v61, v60, s[12:13] offset:128 sc1
  s_add_u32 s26, s26, 1
  s_cmp_gt_u32 s26, 1048576
  s_cbranch_scc1 L_end
  s_waitcnt vmcnt(0)
  v_cmp_eq_u32 vcc, 0, v61
  v_readfirstlane_b32 s27, v61
  s_cbranch_vccnz g_wt_122
  s_lshl_b32 s27, s77, 7
  s_add_u32 s27, s27, 243269632
  v_lshlrev_b32 v61, 11, v0
  v_mov_b32 v60, 1
  s_mov_b64 exec, 255
  buffer_store_dword v60, v61, s[4:7], s27 offen sc1
  s_mov_b64 exec, -1
o_s3_121:
  s_add_u32 s27, s30, 65536
  buffer_load_dwordx2 v[128:129], v44, s[80:83], s27 offen
  s_add_u32 s27, s30, 66560
  buffer_load_dwordx2 v[130:131], v44, s[80:83], s27 offen
  s_add_u32 s27, s30, 67584
  buffer_load_dwordx2 v[132:133], v44, s[80:83], s27 offen
  s_add_u32 s27, s30, 68608
  buffer_load_dwordx2 v[134:135], v44, s[80:83], s27 offen
  s_add_u32 s27, s30, 81920
  buffer_load_dwordx2 v[136:137], v44, s[80:83], s27 offen
  s_add_u32 s27, s30, 82944
  buffer_load_dwordx2 v[138:139], v44, s[80:83], s27 offen
  s_add_u32 s27, s30, 83968
  buffer_load_dwordx2 v[140:141], v44, s[80:83], s27 offen
  s_add_u32 s27, s30, 84992
  buffer_load_dwordx2 v[142:143], v44, s[80:83], s27 offen
  s_add_u32 s27, s30, 73728
  buffer_load_dwordx2 v[144:145], v44, s[80:83], s27 offen
  s_add_u32 s27, s30, 74752
  buffer_load_dwordx2 v[146:147], v44, s[80:83], s27 offen
  s_add_u32 s27, s30, 75776
  buffer_load_dwordx2 v[148:149], v44, s[80:83], s27 offen
  s_add_u32 s27, s30, 76800
  buffer_load_dwordx2 v[150:151], v44, s[80:83], s27 offen
  s_add_u32 s27, s30, 90112
  buffer_load_dwordx2 v[152:153], v44, s[80:83], s27 offen
  s_add_u32 s27, s30, 91136
  buffer_load_dwordx2 v[154:155], v44, s[80:83], s27 offen
  s_add_u32 s27, s30, 92160
  buffer_load_dwordx2 v[156:157], v44, s[80:83], s27 offen
  s_add_u32 s27, s30, 93184
  buffer_load_dwordx2 v[158:159], v44, s[80:83], s27 offen
  s_add_u32 s27, s30, 98304
  buffer_load_dwordx2 v[160:161], v44, s[80:83], s27 offen
  s_add_u32 s27, s30, 99328
  buffer_load_dwordx2 v[162:163], v44, s[80:83], s27 offen
  s_add_u32 s27, s30, 100352
  buffer_load_dwordx2 v[164:165], v44, s[80:83], s27 offen
  s_add_u32 s27, s30, 101376
  buffer_load_dwordx2 v[166:167], v44, s[80:83], s27 offen
  s_add_u32 s27, s30, 114688
  buffer_load_dwordx2 v[168:169], v44, s[80:83], s27 offen
  s_add_u32 s27, s30, 115712
  buffer_load_dwordx2 v[170:171], v44, s[80:83], s27 offen
  s_add_u32 s27, s30, 116736
  buffer_load_dwordx2 v[172:173], v44, s[80:83], s27 offen
  s_add_u32 s27, s30, 117760
  buffer_load_dwordx2 v[174:175], v44, s[80:83], s27 offen
  s_add_u32 s27, s30, 106496
  buffer_load_dwordx2 v[64:65], v44, s[80:83], s27 offen
  s_add_u32 s27, s30, 107520
  buffer_load_dwordx2 v[66:67], v44, s[80:83], s27 offen
  s_add_u32 s27, s30, 108544
  buffer_load_dwordx2 v[68:69], v44, s[80:83], s27 offen
  s_add_u32 s27, s30, 109568
  buffer_load_dwordx2 v[70:71], v44, s[80:83], s27 offen
  s_add_u32 s27, s30, 122880
  buffer_load_dwordx2 v[72:73], v44, s[80:83], s27 offen
  s_add_u32 s27, s30, 123904
  buffer_load_dwordx2 v[74:75], v44, s[80:83], s27 offen
  s_add_u32 s27, s30, 124928
  buffer_load_dwordx2 v[76:77], v44, s[80:83], s27 offen
  s_add_u32 s27, s30, 125952
  buffer_load_dwordx2 v[78:79], v44, s[80:83], s27 offen
  s_add_u32 s27, s30, 131072
  buffer_load_dwordx2 v[80:81], v44, s[80:83], s27 offen
  s_add_u32 s27, s30, 132096
  buffer_load_dwordx2 v[82:83], v44, s[80:83], s27 offen
  s_add_u32 s27, s30, 133120
  buffer_load_dwordx2 v[84:85], v44, s[80:83], s27 offen
  s_add_u32 s27, s30, 134144
  buffer_load_dwordx2 v[86:87], v44, s[80:83], s27 offen
  s_add_u32 s27, s30, 147456
  buffer_load_dwordx2 v[88:89], v44, s[80:83], s27 offen
  s_add_u32 s27, s30, 148480
  buffer_load_dwordx2 v[90:91], v44, s[80:83], s27 offen
  s_add_u32 s27, s30, 149504
  buffer_load_dwordx2 v[92:93], v44, s[80:83], s27 offen
  s_add_u32 s27, s30, 150528
  buffer_load_dwordx2 v[94:95], v44, s[80:83], s27 offen
  s_add_u32 s27, s30, 139264
  buffer_load_dwordx2 v[96:97], v44, s[80:83], s27 offen
  s_add_u32 s27, s30, 140288
  buffer_load_dwordx2 v[98:99], v44, s[80:83], s27 offen
  s_add_u32 s27, s30, 141312
  buffer_load_dwordx2 v[100:101], v44, s[80:83], s27 offen
  s_add_u32 s27, s30, 142336
  buffer_load_dwordx2 v[102:103], v44, s[80:83], s27 offen
  s_add_u32 s27, s30, 155648
  buffer_load_dwordx2 v[104:105], v44, s[80:83], s27 offen
  s_add_u32 s27, s30, 156672
  buffer_load_dwordx2 v[106:107], v44, s[80:83], s27 offen
  s_add_u32 s27, s30, 157696
  buffer_load_dwordx2 v[108:109], v44, s[80:83], s27 offen
  s_add_u32 s27, s30, 158720
  buffer_load_dwordx2 v[110:111], v44, s[80:83], s27 offen
  s_add_u32 s27, s30, 163840
  buffer_load_dwordx2 v[112:113], v44, s[80:83], s27 offen
  s_add_u32 s27, s30, 164864
  buffer_load_dwordx2 v[114:115], v44, s[80:83], s27 offen
  s_add_u32 s27, s30, 165888
  buffer_load_dwordx2 v[116:117], v44, s[80:83], s27 offen
  s_add_u32 s27, s30, 166912
  buffer_load_dwordx2 v[118:119], v44, s[80:83], s27 offen
  s_add_u32 s27, s30, 180224
  buffer_load_dwordx2 v[120:121], v44, s[80:83], s27 offen
  s_add_u32 s27, s30, 181248
  buffer_load_dwordx2 v[122:123], v44, s[80:83], s27 offen
  s_add_u32 s27, s30, 182272
  buffer_load_dwordx2 v[124:125], v44, s[80:83], s27 offen
  s_add_u32 s27, s30, 183296
  buffer_load_dwordx2 v[126:127], v44, s[80:83], s27 offen
  v_lshlrev_b32 v8, 16, v56
  v_and_b32 v9, 0xffff0000, v56
  v_lshlrev_b32 v10, 16, v57
  v_and_b32 v11, 0xffff0000, v57
  v_lshlrev_b32 v12, 16, v58
  v_and_b32 v13, 0xffff0000, v58
  v_lshlrev_b32 v14, 16, v59
  v_and_b32 v15, 0xffff0000, v59
  v_mul_f32 v56, v8, v8
  v_fmac_f32 v56, v9, v9
  v_fmac_f32 v56, v10, v10
  v_fmac_f32 v56, v11, v11
  v_fmac_f32 v56, v12, v12
  v_fmac_f32 v56, v13, v13
  v_fmac_f32 v56, v14, v14
  v_fmac_f32 v56, v15, v15
  s_nop 0
  s_nop 0
  v_add_f32_dpp v56, v56, v56 row_ror:8 row_mask:0xf bank_mask:0xf
  s_nop 1
  v_add_f32_dpp v56, v56, v56 row_ror:4 row_mask:0xf bank_mask:0xf
  s_nop 1
  v_add_f32_dpp v56, v56, v56 row_ror:2 row_mask:0xf bank_mask:0xf
  s_nop 1
  v_add_f32_dpp v56, v56, v56 row_ror:1 row_mask:0xf bank_mask:0xf
  v_mov_b32 v57, v56
  s_nop 0
  s_nop 0
  v_permlane16_swap_b32 v56, v57
  v_add_f32 v56, v56, v57
  v_mov_b32 v57, v56
  s_nop 0
  s_nop 0
  v_permlane32_swap_b32 v56, v57
  v_add_f32 v56, v56, v57
  v_sqrt_f32 v56, v56
  s_mov_b32 s28, 0x40598569
  v_writelane_b32 v247, s28, 0
  s_mov_b32 s28, 0x40598569
  v_writelane_b32 v247, s28, 1
  s_mov_b32 s28, 0x4058ade7
  v_writelane_b32 v247, s28, 2
  s_mov_b32 s28, 0x40577c32
  v_writelane_b32 v247, s28, 3
  s_mov_b32 s28, 0x40563297
  v_writelane_b32 v247, s28, 4
  s_mov_b32 s28, 0x4054cd28
  v_writelane_b32 v247, s28, 5
  s_mov_b32 s28, 0x405346f2
  v_writelane_b32 v247, s28, 6
  s_mov_b32 s28, 0x40519992
  v_writelane_b32 v247, s28, 7
  s_mov_b32 s28, 0x404fbc99
  v_writelane_b32 v247, s28, 8
  s_mov_b32 s28, 0x404da49a
  v_writelane_b32 v247, s28, 9
  s_mov_b32 s28, 0x404b418a
  v_writelane_b32 v247, s28, 10
  s_mov_b32 s28, 0x40487bed
  v_writelane_b32 v247, s28, 11
  s_mov_b32 s28, 0x40452f68
  v_writelane_b32 v247, s28, 12
  s_mov_b32 s28, 0x40411f69
  v_writelane_b32 v247, s28, 13
  s_mov_b32 s28, 0x403bdbac
  v_writelane_b32 v247, s28, 14
  s_mov_b32 s28, 0x40346eae
  v_writelane_b32 v247, s28, 15
  s_mov_b32 s28, 0x4028005c
  v_writelane_b32 v247, s28, 16
  s_mov_b32 s28, 0x4001516e
  v_writelane_b32 v247, s28, 17
  s_mov_b32 s28, 0x4001516e
  v_writelane_b32 v247, s28, 18
  v_mul_f32 v247, v247, v56
  v_or_b32 v247, 0x80000000, v247
  s_lshl_b32 s29, s61, 2
  s_add_u32 s29, s29, s17
  s_lshl_b32 s29, s29, 13
  s_add_u32 s29, s29, s41
  s_cmp_ge_u32 s60, 4
  s_cselect_b32 s29, 268435456, s29
  v_mov_b64 v[208:209], 0
  v_mov_b64 v[210:211], 0
  s_waitcnt vmcnt(48)
  v_perm_b32 v48, v130, v128, s44
  v_perm_b32 v49, v134, v132, s44
  v_perm_b32 v50, v138, v136, s44
  v_perm_b32 v51, v142, v140, s44
  v_accvgpr_write_b32 a64, v48
  v_accvgpr_write_b32 a65, v49
  v_accvgpr_write_b32 a66, v50
  v_accvgpr_write_b32 a67, v51
  v_perm_b32 v52, v130, v128, s45
  v_perm_b32 v53, v134, v132, s45
  v_perm_b32 v54, v138, v136, s45
  v_perm_b32 v55, v142, v140, s45
  v_accvgpr_write_b32 a68, v52
  v_accvgpr_write_b32 a69, v53
  v_accvgpr_write_b32 a70, v54
  v_accvgpr_write_b32 a71, v55
  v_perm_b32 v48, v131, v129, s44
  v_perm_b32 v49, v135, v133, s44
  v_perm_b32 v50, v139, v137, s44
  v_perm_b32 v51, v143, v141, s44
  v_accvgpr_write_b32 a72, v48
  v_accvgpr_write_b32 a73, v49
  v_accvgpr_write_b32 a74, v50
  v_accvgpr_write_b32 a75, v51
  v_perm_b32 v52, v131, v129, s45
  v_perm_b32 v53, v135, v133, s45
  v_perm_b32 v54, v139, v137, s45
  v_perm_b32 v55, v143, v141, s45
  v_accvgpr_write_b32 a76, v52
  v_accvgpr_write_b32 a77, v53
  v_accvgpr_write_b32 a78, v54
  v_accvgpr_write_b32 a79, v55
  s_add_u32 s27, s30, 172032
  buffer_load_dwordx2 v[128:129], v44, s[80:83], s27 offen
  s_add_u32 s27, s30, 173056
  buffer_load_dwordx2 v[130:131], v44, s[80:83], s27 offen
  s_add_u32 s27, s30, 174080
  buffer_load_dwordx2 v[132:133], v44, s[80:83], s27 offen
  s_add_u32 s27, s30, 175104
  buffer_load_dwordx2 v[134:135], v44, s[80:83], s27 offen
  s_add_u32 s27, s30, 188416
  buffer_load_dwordx2 v[136:137], v44, s[80:83], s27 offen
  s_add_u32 s27, s30, 189440
  buffer_load_dwordx2 v[138:139], v44, s[80:83], s27 offen
  s_add_u32 s27, s30, 190464
  buffer_load_dwordx2 v[140:141], v44, s[80:83], s27 offen
  s_add_u32 s27, s30, 191488
  buffer_load_dwordx2 v[142:143], v44, s[80:83], s27 offen
  s_waitcnt vmcnt(48)
  v_perm_b32 v48, v146, v144, s44
  v_perm_b32 v49, v150, v148, s44
  v_perm_b32 v50, v154, v152, s44
  v_perm_b32 v51, v158, v156, s44
  v_accvgpr_write_b32 a80, v48
  v_accvgpr_write_b32 a81, v49
  v_accvgpr_write_b32 a82, v50
  v_accvgpr_write_b32 a83, v51
  v_perm_b32 v52, v146, v144, s45
  v_perm_b32 v53, v150, v148, s45
  v_perm_b32 v54, v154, v152, s45
  v_perm_b32 v55, v158, v156, s45
  v_accvgpr_write_b32 a84, v52
  v_accvgpr_write_b32 a85, v53
  v_accvgpr_write_b32 a86, v54
  v_accvgpr_write_b32 a87, v55
  v_perm_b32 v48, v147, v145, s44
  v_perm_b32 v49, v151, v149, s44
  v_perm_b32 v50, v155, v153, s44
  v_perm_b32 v51, v159, v157, s44
  v_accvgpr_write_b32 a88, v48
  v_accvgpr_write_b32 a89, v49
  v_accvgpr_write_b32 a90, v50
  v_accvgpr_write_b32 a91, v51
  v_perm_b32 v52, v147, v145, s45
  v_perm_b32 v53, v151, v149, s45
  v_perm_b32 v54, v155, v153, s45
  v_perm_b32 v55, v159, v157, s45
  v_accvgpr_write_b32 a92, v52
  v_accvgpr_write_b32 a93, v53
  v_accvgpr_write_b32 a94, v54
  v_accvgpr_write_b32 a95, v55
  s_add_u32 s27, s30, 196608
  buffer_load_dwordx2 v[144:145], v44, s[80:83], s27 offen
  s_add_u32 s27, s30, 197632
  buffer_load_dwordx2 v[146:147], v44, s[80:83], s27 offen
  s_add_u32 s27, s30, 198656
  buffer_load_dwordx2 v[148:149], v44, s[80:83], s27 offen
  s_add_u32 s27, s30, 199680
  buffer_load_dwordx2 v[150:151], v44, s[80:83], s27 offen
  s_add_u32 s27, s30, 212992
  buffer_load_dwordx2 v[152:153], v44, s[80:83], s27 offen
  s_add_u32 s27, s30, 214016
  buffer_load_dwordx2 v[154:155], v44, s[80:83], s27 offen
  s_add_u32 s27, s30, 215040
  buffer_load_dwordx2 v[156:157], v44, s[80:83], s27 offen
  s_add_u32 s27, s30, 216064
  buffer_load_dwordx2 v[158:159], v44, s[80:83], s27 offen
  s_waitcnt vmcnt(48)
  v_perm_b32 v48, v162, v160, s44
  v_perm_b32 v49, v166, v164, s44
  v_perm_b32 v50, v170, v168, s44
  v_perm_b32 v51, v174, v172, s44
  v_accvgpr_write_b32 a96, v48
  v_accvgpr_write_b32 a97, v49
  v_accvgpr_write_b32 a98, v50
  v_accvgpr_write_b32 a99, v51
  v_perm_b32 v52, v162, v160, s45
  v_perm_b32 v53, v166, v164, s45
  v_perm_b32 v54, v170, v168, s45
  v_perm_b32 v55, v174, v172, s45
  v_accvgpr_write_b32 a100, v52
  v_accvgpr_write_b32 a101, v53
  v_accvgpr_write_b32 a102, v54
  v_accvgpr_write_b32 a103, v55
  v_perm_b32 v48, v163, v161, s44
  v_perm_b32 v49, v167, v165, s44
  v_perm_b32 v50, v171, v169, s44
  v_perm_b32 v51, v175, v173, s44
  v_accvgpr_write_b32 a104, v48
  v_accvgpr_write_b32 a105, v49
  v_accvgpr_write_b32 a106, v50
  v_accvgpr_write_b32 a107, v51
  v_perm_b32 v52, v163, v161, s45
  v_perm_b32 v53, v167, v165, s45
  v_perm_b32 v54, v171, v169, s45
  v_perm_b32 v55, v175, v173, s45
  v_accvgpr_write_b32 a108, v52
  v_accvgpr_write_b32 a109, v53
  v_accvgpr_write_b32 a110, v54
  v_accvgpr_write_b32 a111, v55
  s_add_u32 s27, s30, 204800
  buffer_load_dwordx2 v[160:161], v44, s[80:83], s27 offen
  s_add_u32 s27, s30, 205824
  buffer_load_dwordx2 v[162:163], v44, s[80:83], s27 offen
  s_add_u32 s27, s30, 206848
  buffer_load_dwordx2 v[164:165], v44, s[80:83], s27 offen
  s_add_u32 s27, s30, 207872
  buffer_load_dwordx2 v[166:167], v44, s[80:83], s27 offen
  s_add_u32 s27, s30, 221184
  buffer_load_dwordx2 v[168:169], v44, s[80:83], s27 offen
  s_add_u32 s27, s30, 222208
  buffer_load_dwordx2 v[170:171], v44, s[80:83], s27 offen
  s_add_u32 s27, s30, 223232
  buffer_load_dwordx2 v[172:173], v44, s[80:83], s27 offen
  s_add_u32 s27, s30, 224256
  buffer_load_dwordx2 v[174:175], v44, s[80:83], s27 offen
  s_waitcnt vmcnt(48)
  v_perm_b32 v48, v66, v64, s44
  v_perm_b32 v49, v70, v68, s44
  v_perm_b32 v50, v74, v72, s44
  v_perm_b32 v51, v78, v76, s44
  v_accvgpr_write_b32 a112, v48
  v_accvgpr_write_b32 a113, v49
  v_accvgpr_write_b32 a114, v50
  v_accvgpr_write_b32 a115, v51
  v_perm_b32 v52, v66, v64, s45
  v_perm_b32 v53, v70, v68, s45
  v_perm_b32 v54, v74, v72, s45
  v_perm_b32 v55, v78, v76, s45
  v_accvgpr_write_b32 a116, v52
  v_accvgpr_write_b32 a117, v53
  v_accvgpr_write_b32 a118, v54
  v_accvgpr_write_b32 a119, v55
  v_perm_b32 v48, v67, v65, s44
  v_perm_b32 v49, v71, v69, s44
  v_perm_b32 v50, v75, v73, s44
  v_perm_b32 v51, v79, v77, s44
  v_accvgpr_write_b32 a120, v48
  v_accvgpr_write_b32 a121, v49
  v_accvgpr_write_b32 a122, v50
  v_accvgpr_write_b32 a123, v51
  v_perm_b32 v52, v67, v65, s45
  v_perm_b32 v53, v71, v69, s45
  v_perm_b32 v54, v75, v73, s45
  v_perm_b32 v55, v79, v77, s45
  v_accvgpr_write_b32 a124, v52
  v_accvgpr_write_b32 a125, v53
  v_accvgpr_write_b32 a126, v54
  v_accvgpr_write_b32 a127, v55
  s_add_u32 s27, s30, 229376
  buffer_load_dwordx2 v[64:65], v44, s[80:83], s27 offen
  s_add_u32 s27, s30, 230400
  buffer_load_dwordx2 v[66:67], v44, s[80:83], s27 offen
  s_add_u32 s27, s30, 231424
  buffer_load_dwordx2 v[68:69], v44, s[80:83], s27 offen
  s_add_u32 s27, s30, 232448
  buffer_load_dwordx2 v[70:71], v44, s[80:83], s27 offen
  s_add_u32 s27, s30, 245760
  buffer_load_dwordx2 v[72:73], v44, s[80:83], s27 offen
  s_add_u32 s27, s30, 246784
  buffer_load_dwordx2 v[74:75], v44, s[80:83], s27 offen
  s_add_u32 s27, s30, 247808
  buffer_load_dwordx2 v[76:77], v44, s[80:83], s27 offen
  s_add_u32 s27, s30, 248832
  buffer_load_dwordx2 v[78:79], v44, s[80:83], s27 offen
  s_waitcnt vmcnt(48)
  v_perm_b32 v48, v82, v80, s44
  v_perm_b32 v49, v86, v84, s44
  v_perm_b32 v50, v90, v88, s44
  v_perm_b32 v51, v94, v92, s44
  v_accvgpr_write_b32 a128, v48
  v_accvgpr_write_b32 a129, v49
  v_accvgpr_write_b32 a130, v50
  v_accvgpr_write_b32 a131, v51
  v_perm_b32 v52, v82, v80, s45
  v_perm_b32 v53, v86, v84, s45
  v_perm_b32 v54, v90, v88, s45
  v_perm_b32 v55, v94, v92, s45
  v_accvgpr_write_b32 a132, v52
  v_accvgpr_write_b32 a133, v53
  v_accvgpr_write_b32 a134, v54
  v_accvgpr_write_b32 a135, v55
  v_perm_b32 v48, v83, v81, s44
  v_perm_b32 v49, v87, v85, s44
  v_perm_b32 v50, v91, v89, s44
  v_perm_b32 v51, v95, v93, s44
  v_accvgpr_write_b32 a136, v48
  v_accvgpr_write_b32 a137, v49
  v_accvgpr_write_b32 a138, v50
  v_accvgpr_write_b32 a139, v51
  v_perm_b32 v52, v83, v81, s45
  v_perm_b32 v53, v87, v85, s45
  v_perm_b32 v54, v91, v89, s45
  v_perm_b32 v55, v95, v93, s45
  v_accvgpr_write_b32 a140, v52
  v_accvgpr_write_b32 a141, v53
  v_accvgpr_write_b32 a142, v54
  v_accvgpr_write_b32 a143, v55
  s_add_u32 s27, s30, 237568
  buffer_load_dwordx2 v[80:81], v44, s[80:83], s27 offen
  s_add_u32 s27, s30, 238592
  buffer_load_dwordx2 v[82:83], v44, s[80:83], s27 offen
  s_add_u32 s27, s30, 239616
  buffer_load_dwordx2 v[84:85], v44, s[80:83], s27 offen
  s_add_u32 s27, s30, 240640
  buffer_load_dwordx2 v[86:87], v44, s[80:83], s27 offen
  s_add_u32 s27, s30, 253952
  buffer_load_dwordx2 v[88:89], v44, s[80:83], s27 offen
  s_add_u32 s27, s30, 254976
  buffer_load_dwordx2 v[90:91], v44, s[80:83], s27 offen
  s_add_u32 s27, s30, 256000
  buffer_load_dwordx2 v[92:93], v44, s[80:83], s27 offen
  s_add_u32 s27, s30, 257024
  buffer_load_dwordx2 v[94:95], v44, s[80:83], s27 offen
  s_waitcnt vmcnt(48)
  v_perm_b32 v48, v98, v96, s44
  v_perm_b32 v49, v102, v100, s44
  v_perm_b32 v50, v106, v104, s44
  v_perm_b32 v51, v110, v108, s44
  v_accvgpr_write_b32 a144, v48
  v_accvgpr_write_b32 a145, v49
  v_accvgpr_write_b32 a146, v50
  v_accvgpr_write_b32 a147, v51
  v_perm_b32 v52, v98, v96, s45
  v_perm_b32 v53, v102, v100, s45
  v_perm_b32 v54, v106, v104, s45
  v_perm_b32 v55, v110, v108, s45
  v_accvgpr_write_b32 a148, v52
  v_accvgpr_write_b32 a149, v53
  v_accvgpr_write_b32 a150, v54
  v_accvgpr_write_b32 a151, v55
  v_perm_b32 v48, v99, v97, s44
  v_perm_b32 v49, v103, v101, s44
  v_perm_b32 v50, v107, v105, s44
  v_perm_b32 v51, v111, v109, s44
  v_accvgpr_write_b32 a152, v48
  v_accvgpr_write_b32 a153, v49
  v_accvgpr_write_b32 a154, v50
  v_accvgpr_write_b32 a155, v51
  v_perm_b32 v52, v99, v97, s45
  v_perm_b32 v53, v103, v101, s45
  v_perm_b32 v54, v107, v105, s45
  v_perm_b32 v55, v111, v109, s45
  v_accvgpr_write_b32 a156, v52
  v_accvgpr_write_b32 a157, v53
  v_accvgpr_write_b32 a158, v54
  v_accvgpr_write_b32 a159, v55
  buffer_store_dwordx4 v[208:211], v0, s[4:7], s29 offen offset:0 sc1
  buffer_store_dwordx4 v[208:211], v0, s[4:7], s29 offen offset:1024 sc1
  buffer_store_dwordx4 v[208:211], v0, s[4:7], s29 offen offset:2048 sc1
  buffer_store_dwordx4 v[208:211], v0, s[4:7], s29 offen offset:3072 sc1
  s_add_u32 s29, s29, 4096
  s_waitcnt vmcnt(44)
  v_perm_b32 v48, v114, v112, s44
  v_perm_b32 v49, v118, v116, s44
  v_perm_b32 v50, v122, v120, s44
  v_perm_b32 v51, v126, v124, s44
  v_accvgpr_write_b32 a160, v48
  v_accvgpr_write_b32 a161, v49
  v_accvgpr_write_b32 a162, v50
  v_accvgpr_write_b32 a163, v51
  v_perm_b32 v52, v114, v112, s45
  v_perm_b32 v53, v118, v116, s45
  v_perm_b32 v54, v122, v120, s45
  v_perm_b32 v55, v126, v124, s45
  v_accvgpr_write_b32 a164, v52
  v_accvgpr_write_b32 a165, v53
  v_accvgpr_write_b32 a166, v54
  v_accvgpr_write_b32 a167, v55
  v_perm_b32 v48, v115, v113, s44
  v_perm_b32 v49, v119, v117, s44
  v_perm_b32 v50, v123, v121, s44
  v_perm_b32 v51, v127, v125, s44
  v_accvgpr_write_b32 a168, v48
  v_accvgpr_write_b32 a169, v49
  v_accvgpr_write_b32 a170, v50
  v_accvgpr_write_b32 a171, v51
  v_perm_b32 v52, v115, v113, s45
  v_perm_b32 v53, v119, v117, s45
  v_perm_b32 v54, v123, v121, s45
  v_perm_b32 v55, v127, v125, s45
  v_accvgpr_write_b32 a172, v52
  v_accvgpr_write_b32 a173, v53
  v_accvgpr_write_b32 a174, v54
  v_accvgpr_write_b32 a175, v55
  buffer_store_dwordx4 v[208:211], v0, s[4:7], s29 offen offset:0 sc1
  buffer_store_dwordx4 v[208:211], v0, s[4:7], s29 offen offset:1024 sc1
  buffer_store_dwordx4 v[208:211], v0, s[4:7], s29 offen offset:2048 sc1
  buffer_store_dwordx4 v[208:211], v0, s[4:7], s29 offen offset:3072 sc1
  s_add_u32 s29, s29, 520192
  s_waitcnt vmcnt(40)
  v_perm_b32 v48, v130, v128, s44
  v_perm_b32 v49, v134, v132, s44
  v_perm_b32 v50, v138, v136, s44
  v_perm_b32 v51, v142, v140, s44
  v_accvgpr_write_b32 a176, v48
  v_accvgpr_write_b32 a177, v49
  v_accvgpr_write_b32 a178, v50
  v_accvgpr_write_b32 a179, v51
  v_perm_b32 v52, v130, v128, s45
  v_perm_b32 v53, v134, v132, s45
  v_perm_b32 v54, v138, v136, s45
  v_perm_b32 v55, v142, v140, s45
  v_accvgpr_write_b32 a180, v52
  v_accvgpr_write_b32 a181, v53
  v_accvgpr_write_b32 a182, v54
  v_accvgpr_write_b32 a183, v55
  v_perm_b32 v48, v131, v129, s44
  v_perm_b32 v49, v135, v133, s44
  v_perm_b32 v50, v139, v137, s44
  v_perm_b32 v51, v143, v141, s44
  v_accvgpr_write_b32 a184, v48
  v_accvgpr_write_b32 a185, v49
  v_accvgpr_write_b32 a186, v50
  v_accvgpr_write_b32 a187, v51
  v_perm_b32 v52, v131, v129, s45
  v_perm_b32 v53, v135, v133, s45
  v_perm_b32 v54, v139, v137, s45
  v_perm_b32 v55, v143, v141, s45
  v_accvgpr_write_b32 a188, v52
  v_accvgpr_write_b32 a189, v53
  v_accvgpr_write_b32 a190, v54
  v_accvgpr_write_b32 a191, v55
  buffer_store_dwordx4 v[208:211], v0, s[4:7], s29 offen offset:0 sc1
  buffer_store_dwordx4 v[208:211], v0, s[4:7], s29 offen offset:1024 sc1
  buffer_store_dwordx4 v[208:211], v0, s[4:7], s29 offen offset:2048 sc1
  buffer_store_dwordx4 v[208:211], v0, s[4:7], s29 offen offset:3072 sc1
  s_add_u32 s29, s29, 4096
  s_waitcnt vmcnt(36)
  v_perm_b32 v48, v146, v144, s44
  v_perm_b32 v49, v150, v148, s44
  v_perm_b32 v50, v154, v152, s44
  v_perm_b32 v51, v158, v156, s44
  v_accvgpr_write_b32 a192, v48
  v_accvgpr_write_b32 a193, v49
  v_accvgpr_write_b32 a194, v50
  v_accvgpr_write_b32 a195, v51
  v_perm_b32 v52, v146, v144, s45
  v_perm_b32 v53, v150, v148, s45
  v_perm_b32 v54, v154, v152, s45
  v_perm_b32 v55, v158, v156, s45
  v_accvgpr_write_b32 a196, v52
  v_accvgpr_write_b32 a197, v53
  v_accvgpr_write_b32 a198, v54
  v_accvgpr_write_b32 a199, v55
  v_perm_b32 v48, v147, v145, s44
  v_perm_b32 v49, v151, v149, s44
  v_perm_b32 v50, v155, v153, s44
  v_perm_b32 v51, v159, v157, s44
  v_accvgpr_write_b32 a200, v48
  v_accvgpr_write_b32 a201, v49
  v_accvgpr_write_b32 a202, v50
  v_accvgpr_write_b32 a203, v51
  v_perm_b32 v52, v147, v145, s45
  v_perm_b32 v53, v151, v149, s45
  v_perm_b32 v54, v155, v153, s45
  v_perm_b32 v55, v159, v157, s45
  v_accvgpr_write_b32 a204, v52
  v_accvgpr_write_b32 a205, v53
  v_accvgpr_write_b32 a206, v54
  v_accvgpr_write_b32 a207, v55
  buffer_store_dwordx4 v[208:211], v0, s[4:7], s29 offen offset:0 sc1
  buffer_store_dwordx4 v[208:211], v0, s[4:7], s29 offen offset:1024 sc1
  buffer_store_dwordx4 v[208:211], v0, s[4:7], s29 offen offset:2048 sc1
  buffer_store_dwordx4 v[208:211], v0, s[4:7], s29 offen offset:3072 sc1
  s_add_u32 s29, s29, 4096
  s_waitcnt vmcnt(32)
  v_perm_b32 v48, v162, v160, s44
  v_perm_b32 v49, v166, v164, s44
  v_perm_b32 v50, v170, v168, s44
  v_perm_b32 v51, v174, v172, s44
  v_accvgpr_write_b32 a208, v48
  v_accvgpr_write_b32 a209, v49
  v_accvgpr_write_b32 a210, v50
  v_accvgpr_write_b32 a211, v51
  v_perm_b32 v52, v162, v160, s45
  v_perm_b32 v53, v166, v164, s45
  v_perm_b32 v54, v170, v168, s45
  v_perm_b32 v55, v174, v172, s45
  v_accvgpr_write_b32 a212, v52
  v_accvgpr_write_b32 a213, v53
  v_accvgpr_write_b32 a214, v54
  v_accvgpr_write_b32 a215, v55
  v_perm_b32 v48, v163, v161, s44
  v_perm_b32 v49, v167, v165, s44
  v_perm_b32 v50, v171, v169, s44
  v_perm_b32 v51, v175, v173, s44
  v_accvgpr_write_b32 a216, v48
  v_accvgpr_write_b32 a217, v49
  v_accvgpr_write_b32 a218, v50
  v_accvgpr_write_b32 a219, v51
  v_perm_b32 v52, v163, v161, s45
  v_perm_b32 v53, v167, v165, s45
  v_perm_b32 v54, v171, v169, s45
  v_perm_b32 v55, v175, v173, s45
  v_accvgpr_write_b32 a220, v52
  v_accvgpr_write_b32 a221, v53
  v_accvgpr_write_b32 a222, v54
  v_accvgpr_write_b32 a223, v55
  s_waitcnt vmcnt(24)
  v_perm_b32 v48, v66, v64, s44
  v_perm_b32 v49, v70, v68, s44
  v_perm_b32 v50, v74, v72, s44
  v_perm_b32 v51, v78, v76, s44
  v_accvgpr_write_b32 a224, v48
  v_accvgpr_write_b32 a225, v49
  v_accvgpr_write_b32 a226, v50
  v_accvgpr_write_b32 a227, v51
  v_perm_b32 v52, v66, v64, s45
  v_perm_b32 v53, v70, v68, s45
  v_perm_b32 v54, v74, v72, s45
  v_perm_b32 v55, v78, v76, s45
  v_accvgpr_write_b32 a228, v52
  v_accvgpr_write_b32 a229, v53
  v_accvgpr_write_b32 a230, v54
  v_accvgpr_write_b32 a231, v55
  v_perm_b32 v48, v67, v65, s44
  v_perm_b32 v49, v71, v69, s44
  v_perm_b32 v50, v75, v73, s44
  v_perm_b32 v51, v79, v77, s44
  v_accvgpr_write_b32 a232, v48
  v_accvgpr_write_b32 a233, v49
  v_accvgpr_write_b32 a234, v50
  v_accvgpr_write_b32 a235, v51
  v_perm_b32 v52, v67, v65, s45
  v_perm_b32 v53, v71, v69, s45
  v_perm_b32 v54, v75, v73, s45
  v_perm_b32 v55, v79, v77, s45
  v_accvgpr_write_b32 a236, v52
  v_accvgpr_write_b32 a237, v53
  v_accvgpr_write_b32 a238, v54
  v_accvgpr_write_b32 a239, v55
  s_waitcnt vmcnt(16)
  v_perm_b32 v48, v82, v80, s44
  v_perm_b32 v49, v86, v84, s44
  v_perm_b32 v50, v90, v88, s44
  v_perm_b32 v51, v94, v92, s44
  v_accvgpr_write_b32 a240, v48
  v_accvgpr_write_b32 a241, v49
  v_accvgpr_write_b32 a242, v50
  v_accvgpr_write_b32 a243, v51
  v_perm_b32 v52, v82, v80, s45
  v_perm_b32 v53, v86, v84, s45
  v_perm_b32 v54, v90, v88, s45
  v_perm_b32 v55, v94, v92, s45
  v_accvgpr_write_b32 a244, v52
  v_accvgpr_write_b32 a245, v53
  v_accvgpr_write_b32 a246, v54
  v_accvgpr_write_b32 a247, v55
  v_perm_b32 v48, v83, v81, s44
  v_perm_b32 v49, v87, v85, s44
  v_perm_b32 v50, v91, v89, s44
  v_perm_b32 v51, v95, v93, s44
  v_accvgpr_write_b32 a248, v48
  v_accvgpr_write_b32 a249, v49
  v_accvgpr_write_b32 a250, v50
  v_accvgpr_write_b32 a251, v51
  v_perm_b32 v52, v83, v81, s45
  v_perm_b32 v53, v87, v85, s45
  v_perm_b32 v54, v91, v89, s45
  v_perm_b32 v55, v95, v93, s45
  v_accvgpr_write_b32 a252, v52
  v_accvgpr_write_b32 a253, v53
  v_accvgpr_write_b32 a254, v54
  v_accvgpr_write_b32 a255, v55
  s_waitcnt vmcnt(0)
  s_barrier
  s_cmp_ge_u32 s60, 4
  s_cbranch_scc1 L_oh
  s_cmp_lg_u32 s17, 0
  s_cbranch_scc1 g_ar_123
  s_lshl_b32 s36, s89, 3
  s_lshl_b64 s[36:37], 1, s36
  v_lshlrev_b32 v52, 3, s91
  v_mov_b32 v48, s36
  v_mov_b32 v49, s37
  s_mov_b64 exec, 1
  global_atomic_add_x2 v[50:51], v52, v[48:49], s[12:13] sc0
  s_mov_b64 exec, -1
g_ar_123:
  s_waitcnt vmcnt(0)
  s_cmp_lg_u32 s17, 0
  s_cbranch_scc1 g_af_124
  v_readfirstlane_b32 s36, v50
  v_readfirstlane_b32 s37, v51
  s_add_u32 s38, s36, s37
  s_mul_i32 s38, s38, 0x01010101
  s_lshr_b32 s38, s38, 24
  s_cmp_lg_u32 s38, 15
  s_cbranch_scc1 g_af_124
  s_lshl_b32 s38, s89, 3
  s_lshr_b64 s[36:37], s[36:37], s38
  s_and_b32 s36, s36, 0xff
  s_cmp_eq_u32 s36, 15
  s_cselect_b32 s36, 1, 2
  v_mov_b32 v48, s36
  v_lshrrev_b32 v52, 1, v52
  s_mov_b64 exec, 1
  global_store_dword v52, v48, s[12:13] offset:128 sc1
  s_mov_b64 exec, -1
g_af_124:
  s_lshr_b32 s26, s60, 1
  s_cmp_lg_u32 s26, 1
  s_cbranch_scc1 L_ow
  s_and_b32 s28, s85, 28
  s_or_b32 s28, s28, 1
  s_lshl_b32 s27, s28, 6
  s_add_u32 s27, s27, 245104640
  s_mov_b32 s26, 0
g_h_125:
  buffer_load_dwordx2 v[60:61], off, s[4:7], s27 sc1
  s_add_u32 s26, s26, 1
  s_cmp_gt_u32 s26, 1048576
  s_cbranch_scc1 L_end
  s_waitcnt vmcnt(0)
  v_and_or_b32 v60, v61, -1, v60
  v_cmp_eq_u32 vcc, 0, v60
  s_cbranch_vccnz g_h_125
  s_mov_b32 s10, 1835008
  s_load_dwordx2 s[8:9], s[0:1], 72
  s_mul_i32 s26, s77, 14336
  s_sub_u32 s26, s26, 1835008
  s_waitcnt lgkmcnt(0)
  buffer_load_dwordx4 v[64:67], v0, s[8:11], s26 offen offset:0
  buffer_load_dwordx4 v[64:67], v0, s[8:11], s26 offen offset:1024
  buffer_load_dwordx4 v[64:67], v0, s[8:11], s26 offen offset:2048
  buffer_load_dwordx4 v[64:67], v0, s[8:11], s26 offen offset:3072
  s_add_u32 s26, s26, 4096
  buffer_load_dwordx4 v[64:67], v0, s[8:11], s26 offen offset:0
  buffer_load_dwordx4 v[64:67], v0, s[8:11], s26 offen offset:1024
  buffer_load_dwordx4 v[64:67], v0, s[8:11], s26 offen offset:2048
  buffer_load_dwordx4 v[64:67], v0, s[8:11], s26 offen offset:3072
  s_add_u32 s26, s26, 4096
  buffer_load_dwordx4 v[64:67], v0, s[8:11], s26 offen offset:0
  buffer_load_dwordx4 v[64:67], v0, s[8:11], s26 offen offset:1024
  buffer_load_dwordx4 v[64:67], v0, s[8:11], s26 offen offset:2048
  buffer_load_dwordx4 v[64:67], v0, s[8:11], s26 offen offset:3072
  s_add_u32 s26, s26, 4096
  buffer_load_dwordx4 v[64:67], v0, s[8:11], s26 offen offset:0
  buffer_load_dwordx4 v[64:67], v0, s[8:11], s26 offen offset:1024
  s_load_dwordx2 s[8:9], s[0:1], 80
  s_mul_i32 s26, s77, 14336
  s_sub_u32 s26, s26, 1835008
  s_waitcnt lgkmcnt(0)
  buffer_load_dwordx4 v[64:67], v0, s[8:11], s26 offen offset:0
  buffer_load_dwordx4 v[64:67], v0, s[8:11], s26 offen offset:1024
  buffer_load_dwordx4 v[64:67], v0, s[8:11], s26 offen offset:2048
  buffer_load_dwordx4 v[64:67], v0, s[8:11], s26 offen offset:3072
  s_add_u32 s26, s26, 4096
  buffer_load_dwordx4 v[64:67], v0, s[8:11], s26 offen offset:0
  buffer_load_dwordx4 v[64:67], v0, s[8:11], s26 offen offset:1024
  buffer_load_dwordx4 v[64:67], v0, s[8:11], s26 offen offset:2048
  buffer_load_dwordx4 v[64:67], v0, s[8:11], s26 offen offset:3072
  s_add_u32 s26, s26, 4096
  buffer_load_dwordx4 v[64:67], v0, s[8:11], s26 offen offset:0
  buffer_load_dwordx4 v[64:67], v0, s[8:11], s26 offen offset:1024
  buffer_load_dwordx4 v[64:67], v0, s[8:11], s26 offen offset:2048
  buffer_load_dwordx4 v[64:67], v0, s[8:11], s26 offen offset:3072
  s_add_u32 s26, s26, 4096
  buffer_load_dwordx4 v[64:67], v0, s[8:11], s26 offen offset:0
  buffer_load_dwordx4 v[64:67], v0, s[8:11], s26 offen offset:1024
  s_load_dwordx2 s[8:9], s[0:1], 88
  s_mul_i32 s26, s77, 14336
  s_sub_u32 s26, s26, 1835008
  s_waitcnt lgkmcnt(0)
  buffer_load_dwordx4 v[64:67], v0, s[8:11], s26 offen offset:0
  buffer_load_dwordx4 v[64:67], v0, s[8:11], s26 offen offset:1024
  buffer_load_dwordx4 v[64:67], v0, s[8:11], s26 offen offset:2048
  buffer_load_dwordx4 v[64:67], v0, s[8:11], s26 offen offset:3072
  s_add_u32 s26, s26, 4096
  buffer_load_dwordx4 v[64:67], v0, s[8:11], s26 offen offset:0
  buffer_load_dwordx4 v[64:67], v0, s[8:11], s26 offen offset:1024
  buffer_load_dwordx4 v[64:67], v0, s[8:11], s26 offen offset:2048
  buffer_load_dwordx4 v[64:67], v0, s[8:11], s26 offen offset:3072
  s_add_u32 s26, s26, 4096
  buffer_load_dwordx4 v[64:67], v0, s[8:11], s26 offen offset:0
  buffer_load_dwordx4 v[64:67], v0, s[8:11], s26 offen offset:1024
  buffer_load_dwordx4 v[64:67], v0, s[8:11], s26 offen offset:2048
  buffer_load_dwordx4 v[64:67], v0, s[8:11], s26 offen offset:3072
  s_add_u32 s26, s26, 4096
  buffer_load_dwordx4 v[64:67], v0, s[8:11], s26 offen offset:0
  buffer_load_dwordx4 v[64:67], v0, s[8:11], s26 offen offset:1024
L_ow:
  v_mbcnt_lo_u32_b32 v60, -1, 0
  v_and_b32 v60, 0, v60
  v_add_lshl_u32 v60, v60, s91, 2
  s_mov_b32 s26, 0
g_wt_126:
  global_load_dword v61, v60, s[12:13] offset:128 sc1
  s_add_u32 s26, s26, 1
  s_cmp_gt_u32 s26, 1048576
  s_cbranch_scc1 L_end
  s_waitcnt vmcnt(0)
  v_cmp_eq_u32 vcc, 0, v61
  v_readfirstlane_b32 s27, v61
  s_cbranch_vccnz g_wt_126
  s_mov_b32 s89, s27
L_oh:
  s_cmp_lg_u32 s89, 1
  s_cbranch_scc1 L_o_x
  s_mov_b32 s62, 1
  s_mov_b32 s42, 0
  s_mov_b32 s3, 0
  s_mov_b32 s46, 0
  s_mov_b32 s65, 0
  s_mov_b32 s66, 0
  s_mov_b32 s76, 0
  s_mov_b32 s55, 0
  s_mov_b32 s48, 0
  s_mov_b32 s56, 0
  s_mov_b32 s84, 268435456
  s_mov_b32 s86, s41
  s_mov_b32 s49, s60
  s_mul_i32 s63, s49, 257
  s_or_b32 s63, s63, 1179648
  s_lshr_b32 s57, s60, 2
  s_cbranch_scc1 o_help_138
o_round_127:
  s_max_u32 s46, s46, s3
  s_cmp_lg_u32 s3, 0
  s_mov_b32 s3, 0
  s_cbranch_scc1 d_g_143
  s_mov_b32 s67, 0
d_w_142:
  s_min_u32 s26, s49, 71
  s_lshl_b32 s26, s26, 12
  s_add_u32 s27, s26, 243494912
  s_add_u32 s26, s26, 243486720
  buffer_load_dword v248, v246, s[4:7], s26 offen sc1
  buffer_load_dword v249, v246, s[4:7], s27 offen sc1
  s_add_u32 s67, s67, 1
  s_cmp_gt_u32 s67, 1048576
  s_cbranch_scc1 L_end
  s_waitcnt vmcnt(0)
  s_mov_b64 exec, 1
  buffer_store_dword v38, off, s[4:7], s84 sc1
  s_mov_b64 exec, -1
  s_mov_b32 s84, 268435456
  v_min_u32 v162, v248, v249
  v_max_u32 v163, v248, v249
  v_cmp_eq_u32 vcc, 0, v162
  s_cbranch_vccnz d_w_142
  v_max_u32_dpp v163, v163, v163 row_ror:8 row_mask:0xf bank_mask:0xf
  s_nop 1
  v_max_u32_dpp v163, v163, v163 row_ror:4 row_mask:0xf bank_mask:0xf
  s_nop 1
  v_max_u32_dpp v163, v163, v163 row_ror:2 row_mask:0xf bank_mask:0xf
  s_nop 1
  v_max_u32_dpp v163, v163, v163 row_ror:1 row_mask:0xf bank_mask:0xf
  s_nop 0
  v_readlane_b32 s28, v163, 0
  v_readlane_b32 s29, v163, 16
  v_readlane_b32 s30, v163, 32
  v_readlane_b32 s31, v163, 48
  s_max_u32 s28, s28, s29
  s_max_u32 s30, s30, s31
  s_max_u32 s46, s46, s28
  s_max_u32 s46, s46, s30
d_g_143:
  s_lshr_b32 s27, s49, 2
  s_andn2_b32 s52, 0xfff, s46
  s_lshr_b32 s52, s52, 5
  s_min_u32 s52, s52, 64
  s_add_u32 s26, s52, 3
  v_readlane_b32 s89, v247, s27
  s_sub_u32 s26, s26, s60
  s_lshr_b32 s26, s26, 2
  s_bfm_b32 s54, s26, 0
  s_add_u32 s53, s63, 1028
  s_cmp_lt_u32 s49, 60
  s_cselect_b32 s53, s53, 0
  s_cmp_lt_u32 s49, 64
  s_cselect_b32 s26, 2, 1
  s_sub_i32 s26, s27, s26
  s_max_i32 s26, s26, 0
  s_min_u32 s26, s26, 16
  s_bfm_b32 s58, s26, 0
  s_cmp_eq_u32 s27, 16
  s_cselect_b32 s59, 1, 1
  s_cmp_eq_u32 s27, 17
  s_cselect_b32 s59, 0, s59
  s_cmp_eq_u32 s27, 18
  s_cselect_b32 s59, 64, s59
  s_cselect_b32 s50, 0, -1
  s_cselect_b32 s89, 0, s89
  s_cbranch_scc1 o_dl_139
  s_cmp_eq_u32 s27, 16
  s_cbranch_scc1 o_dl_139_a
o_pick_131:
  s_cmp_eq_u32 s59, 0
  s_cbranch_scc1 o_none_135
  s_sub_u32 s59, s59, 1
  s_andn2_b32 s26, s58, s55
  s_and_b32 s26, s26, s54
  s_cbranch_scc1 o_ga_132
  s_and_b32 s26, s55, s50
  s_or_b32 s26, s26, s56
  s_or_b32 s26, s26, s54
  s_andn2_b32 s26, s58, s26
  s_cbranch_scc0 o_none_135
  s_cmp_ge_u32 s46, s89
  s_cbranch_scc1 o_gb_133
o_ga_132:
  s_ff1_i32_b32 s26, s26
  s_bitset1_b32 s55, s26
  s_mov_b32 s64, 1327168
  s_mov_b32 s27, s64
  s_branch o_gd_134
o_none_135:
  s_cmp_lt_u32 s49, 60
  s_cbranch_scc1 o_nn_136
  s_cmp_eq_u32 s50, 0
  s_cbranch_scc1 o_nn_136
  s_and_b32 s26, s63, 1097728
  s_cmp_eq_u32 s26, 1048576
  s_cbranch_scc1 o_nn_136
  s_cmp_lt_u32 s49, 64
  s_cbranch_scc1 o_adv_137
  s_and_b32 s26, s65, 1097728
  s_cmp_lg_u32 s26, 1048576
  s_cbranch_scc1 o_adv_137
o_nn_136:
  s_mov_b32 s64, s53
  s_mov_b32 s51, 0
  s_branch o_task_128
o_gb_133:
  s_ff1_i32_b32 s26, s26
  s_bitset1_b32 s56, s26
  s_andn2_b32 s27, 31, s46
  s_or_b32 s27, s27, 32
  s_lshl_b32 s27, s27, 22
  s_or_b32 s27, s27, 1474688
  s_mov_b32 s64, 1474624
o_gd_134:
  s_lshl4_add_u32 s48, s48, s26
  s_and_b32 s28, s26, s57
  s_lshr_b32 s26, s26, s57
  s_lshl2_add_u32 s26, s26, s60
  s_add_u32 s26, s26, s28
  s_cmp_eq_u32 s26, s52
  s_cselect_b32 s64, s27, s64
  s_mul_i32 s26, s26, 257
  s_or_b32 s64, s64, s26
  s_mov_b32 s51, 1
o_task_128:
  s_cmp_eq_u32 s63, 0
  s_cbranch_scc1 o_nofl_129
  s_cmp_lg_u32 s66, 0
  s_cbranch_scc1 o_have_145
  s_mov_b32 s67, 0
o_w1_144:
  s_and_b32 s32, s63, 0xff
  s_lshl_b32 s32, s32, 12
  s_add_u32 s32, s32, s14
  buffer_load_dword v37, v36, s[4:7], s32 offen sc1
  s_add_u32 s67, s67, 1
  s_cmp_gt_u32 s67, 1048576
  s_cbranch_scc1 L_end
  s_waitcnt vmcnt(0)
  s_mov_b64 exec, 1
  buffer_store_dword v38, off, s[4:7], s84 sc1
  s_mov_b64 exec, -1
  s_mov_b32 s84, 268435456
  v_cmp_eq_u32 vcc, 0, v37
  s_cbranch_vccnz o_w1_144
  s_and_b32 s87, s63, 0xff
  s_lshl_b32 s33, s87, 18
  s_lshl_b32 s32, s87, 19
  s_add_u32 m0, s22, 0
  s_add_u32 s33, s33, s19
  buffer_load_dwordx4 v0, s[4:7], s33 offen offset:0 sc1 lds
  buffer_load_dwordx4 v0, s[4:7], s33 offen offset:1024 sc1 lds
  buffer_load_dwordx4 v0, s[4:7], s33 offen offset:2048 sc1 lds
  buffer_load_dwordx4 v0, s[4:7], s33 offen offset:3072 sc1 lds
  s_add_u32 m0, s23, 0
  s_add_u32 s32, s32, s18
  buffer_load_dwordx4 v0, s[4:7], s32 offen offset:0 sc1 lds
  buffer_load_dwordx4 v0, s[4:7], s32 offen offset:1024 sc1 lds
  buffer_load_dwordx4 v0, s[4:7], s32 offen offset:2048 sc1 lds
  buffer_load_dwordx4 v0, s[4:7], s32 offen offset:3072 sc1 lds
  s_add_u32 m0, m0, 4096
  s_add_u32 s32, s32, 4096
  buffer_load_dwordx4 v0, s[4:7], s32 offen offset:0 sc1 lds
  buffer_load_dwordx4 v0, s[4:7], s32 offen offset:1024 sc1 lds
  buffer_load_dwordx4 v0, s[4:7], s32 offen offset:2048 sc1 lds
  buffer_load_dwordx4 v0, s[4:7], s32 offen offset:3072 sc1 lds
  s_waitcnt vmcnt(0)
  s_barrier
o_have_145:
  ds_read_b128 v[120:123], v33 offset:0
  ds_read_b128 v[40:43], v32 offset:0
  ds_read_b128 v[56:59], v32 offset:1024
  ds_read_b128 v[124:127], v33 offset:2048
  ds_read_b128 v[44:47], v32 offset:4096
  ds_read_b128 v[60:63], v32 offset:5120
  ds_read_b128 v[128:131], v33 offset:4096
  ds_read_b128 v[48:51], v32 offset:8192
  ds_read_b128 v[64:67], v32 offset:9216
  ds_read_b128 v[132:135], v33 offset:6144
  ds_read_b128 v[52:55], v32 offset:12288
  ds_read_b128 v[68:71], v32 offset:13312
  s_cmp_lt_u32 s17, 2
  s_cselect_b32 s65, s65, 0
  s_cmp_lg_u32 s65, 0
  s_cselect_b64 s[44:45], -1, 0
  s_mov_b32 s95, s86
  s_mov_b32 s96, s42
  s_lshl_b32 s97, s43, 14
  s_add_u32 s97, s97, s95
  s_and_b32 s87, s64, 0xff
  s_lshl_b32 s87, s87, 12
  s_add_u32 s87, s87, s14
  s_and_b32 s88, s63, 0xff00
  s_lshl_b32 s88, s88, 3
  s_add_u32 s88, s88, s15
  s_and_b32 s91, s65, 63
  s_lshl_b32 s90, s91, 5
  s_add_u32 s94, s90, s85
  s_add_u32 s90, s90, s43
  s_lshl_b32 s94, s94, 10
  s_lshr_b32 s92, s65, 22
  s_xor_b32 s93, s43, 32
  s_lshl_b32 s91, s90, 10
  s_add_u32 s94, s94, 25165824
  s_cmp_eq_u32 s92, s93
  s_cselect_b32 s92, s94, s91
  s_add_u32 s92, s92, 10485760
  s_and_b32 s93, s65, 49152
  s_cselect_b32 s92, s92, s91
  s_cselect_b64 s[80:81], s[4:5], s[72:73]
  s_cselect_b32 s82, s6, s74
  s_waitcnt lgkmcnt(9)
  v_mfma_f32_16x16x32_bf16 v[104:107], v[40:43], v[120:123], v[24:27]
  v_mfma_f32_16x16x32_bf16 v[108:111], v[56:59], v[120:123], v[28:31]
  s_mov_b64 exec, s[44:45]
  buffer_load_dword v7, v255, s[4:7], s97 offen sc1
  buffer_load_dwordx4 v[184:187], v0, s[80:83], s92 offen sc1
  s_not_b64 exec, exec
  buffer_load_dword v37, v36, s[4:7], s87 offen sc1
  s_mov_b64 exec, -1
  buffer_load_dword v244, v252, s[4:7], s88 offen sc1
  s_waitcnt lgkmcnt(6)
  v_mfma_f32_16x16x32_bf16 v[104:107], v[44:47], v[124:127], v[104:107]
  v_mfma_f32_16x16x32_bf16 v[108:111], v[60:63], v[124:127], v[108:111]
  s_waitcnt lgkmcnt(3)
  v_mfma_f32_16x16x32_bf16 v[104:107], v[48:51], v[128:131], v[104:107]
  v_mfma_f32_16x16x32_bf16 v[108:111], v[64:67], v[128:131], v[108:111]
  s_waitcnt lgkmcnt(0)
  v_mfma_f32_16x16x32_bf16 v[104:107], v[52:55], v[132:135], v[104:107]
  v_mfma_f32_16x16x32_bf16 v[108:111], v[68:71], v[132:135], v[108:111]
  s_cmp_lg_u32 s76, 0
  s_cbranch_scc1 o_klds_148
  v_mov_b32 v196, 0
  v_mov_b32 v199, 0
  v_exp_f32 v56, v104
  v_exp_f32 v57, v105
  v_exp_f32 v58, v106
  v_exp_f32 v59, v107
  v_exp_f32 v60, v108
  v_exp_f32 v61, v109
  v_exp_f32 v62, v110
  v_exp_f32 v63, v111
  v_max3_f32 v116, v104, v105, v106
  v_max3_f32 v116, v107, v108, v116
  v_max3_f32 v116, v109, v110, v116
  v_add_f32 v117, v56, v57
  v_add_f32 v118, v58, v59
  v_add_f32 v117, v117, v60
  v_add_f32 v118, v118, v61
  v_add_f32 v117, v117, v62
  v_add_f32 v118, v118, v63
  s_mov_b32 s67, 0
  s_and_b32 s32, s63, 0xff00
  s_lshl_b32 s32, s32, 10
  s_add_u32 s32, s32, s20
  s_add_u32 s33, s32, 4096
o_w2_146:
  s_waitcnt vmcnt(0)
  v_cmp_eq_u32 vcc, 0, v244
  s_cbranch_vccz o_kgo_156
  s_mov_b64 exec, 1
  buffer_store_dword v38, off, s[4:7], s84 sc1
  s_mov_b64 exec, -1
  s_mov_b32 s84, 268435456
  buffer_load_dword v244, v252, s[4:7], s88 offen sc1
  s_add_u32 s67, s67, 1
  s_cmp_gt_u32 s67, 1048576
  s_cbranch_scc1 L_end
  s_branch o_w2_146
o_kgo_156:
  buffer_load_dwordx4 v[136:139], v0, s[4:7], s32 offen offset:0 sc1
  buffer_load_dwordx4 v[140:143], v0, s[4:7], s32 offen offset:1024 sc1
  buffer_load_dwordx4 v[144:147], v0, s[4:7], s32 offen offset:2048 sc1
  buffer_load_dwordx4 v[148:151], v0, s[4:7], s32 offen offset:3072 sc1
  buffer_load_dwordx2 v[200:201], v1, s[4:7], s33 offen offset:0 sc1
  buffer_load_dwordx2 v[202:203], v1, s[4:7], s33 offen offset:512 sc1
  buffer_load_dwordx2 v[204:205], v1, s[4:7], s33 offen offset:1024 sc1
  buffer_load_dwordx2 v[206:207], v1, s[4:7], s33 offen offset:1536 sc1
  buffer_load_dword v37, v36, s[4:7], s87 offen sc1
  buffer_load_dword v244, v252, s[4:7], s88 offen sc1
  s_barrier
  ds_read_b128 v[152:155], v32 offset:2048
  ds_read_b128 v[156:159], v32 offset:3072
  ds_read_b128 v[160:163], v32 offset:6144
  ds_read_b128 v[164:167], v32 offset:7168
  ds_read_b128 v[168:171], v32 offset:10240
  ds_read_b128 v[172:175], v32 offset:11264
  ds_read_b128 v[176:179], v32 offset:14336
  ds_read_b128 v[180:183], v32 offset:15360
  s_waitcnt vmcnt(9)
  v_mfma_f32_16x16x32_bf16 v[112:115], v[136:139], v[120:123], 0
  s_waitcnt vmcnt(8)
  v_mfma_f32_16x16x32_bf16 v[112:115], v[140:143], v[124:127], v[112:115]
  s_waitcnt vmcnt(7)
  v_mfma_f32_16x16x32_bf16 v[112:115], v[144:147], v[128:131], v[112:115]
  s_waitcnt vmcnt(6)
  v_mfma_f32_16x16x32_bf16 v[112:115], v[148:151], v[132:135], v[112:115]
  s_waitcnt vmcnt(2)
  s_branch o_havek_147
o_klds_148:
  s_waitcnt vmcnt(12)
  s_barrier
  ds_read_b128 v[136:139], v34 offset:0
  ds_read_b128 v[140:143], v34 offset:1024
  ds_read_b128 v[144:147], v34 offset:2048
  ds_read_b128 v[148:151], v34 offset:3072
  ds_read_b64 v[200:201], v35 offset:4096
  ds_read_b64 v[202:203], v35 offset:4608
  ds_read_b64 v[204:205], v35 offset:5120
  ds_read_b64 v[206:207], v35 offset:5632
  v_mov_b32 v196, 0
  v_mov_b32 v199, 0
  v_exp_f32 v56, v104
  v_exp_f32 v57, v105
  v_exp_f32 v58, v106
  v_exp_f32 v59, v107
  v_exp_f32 v60, v108
  v_exp_f32 v61, v109
  v_exp_f32 v62, v110
  v_exp_f32 v63, v111
  v_max3_f32 v116, v104, v105, v106
  v_max3_f32 v116, v107, v108, v116
  v_max3_f32 v116, v109, v110, v116
  s_waitcnt lgkmcnt(4)
  v_mfma_f32_16x16x32_bf16 v[112:115], v[136:139], v[120:123], 0
  ds_read_b128 v[152:155], v32 offset:2048
  ds_read_b128 v[156:159], v32 offset:3072
  v_mfma_f32_16x16x32_bf16 v[112:115], v[140:143], v[124:127], v[112:115]
  ds_read_b128 v[160:163], v32 offset:6144
  ds_read_b128 v[164:167], v32 offset:7168
  v_mfma_f32_16x16x32_bf16 v[112:115], v[144:147], v[128:131], v[112:115]
  ds_read_b128 v[168:171], v32 offset:10240
  ds_read_b128 v[172:175], v32 offset:11264
  v_mfma_f32_16x16x32_bf16 v[112:115], v[148:151], v[132:135], v[112:115]
  ds_read_b128 v[176:179], v32 offset:14336
  ds_read_b128 v[180:183], v32 offset:15360
  v_add_f32 v117, v56, v57
  v_add_f32 v118, v58, v59
  v_add_f32 v117, v117, v60
  v_add_f32 v118, v118, v61
  v_add_f32 v117, v117, v62
  v_add_f32 v118, v118, v63
o_havek_147:
  s_cmp_lg_u32 s65, 0
  s_cbranch_scc1 o_wr1_153
  s_nop 3
  v_mul_f32 v112, s24, v112
  v_mul_f32 v113, s24, v113
  v_exp_f32 v64, v112
  v_exp_f32 v65, v113
  v_max_f32 v116, v111, v116
  v_max3_f32 v116, v112, v113, v116
  v_add_f32 v117, v117, v64
  v_add_f32 v118, v118, v65
  v_add_f32 v117, v117, v118
  s_mov_b32 s28, 0x21800000
  v_mov_b32 v118, v117
  s_nop 1
  v_permlane16_swap_b32 v117, v118
  v_add_f32 v117, v117, v118
  v_mov_b32 v118, v117
  s_nop 0
  s_nop 0
  v_permlane32_swap_b32 v117, v118
  v_add_f32 v117, v117, v118
  v_cmp_lt_f32 vcc, 0x42700000, v116
  v_cmp_gt_f32 s[30:31], s28, v117
  v_rcp_f32 v117, v117
  s_or_b64 vcc, vcc, s[30:31]
  s_cbranch_vccnz o_fb_157
o_fbr_158:
  v_pk_mul_f32 v[56:57], v[56:57], v[116:117] op_sel:[0,1] op_sel_hi:[1,1]
  v_pk_mul_f32 v[58:59], v[58:59], v[116:117] op_sel:[0,1] op_sel_hi:[1,1]
  v_pk_mul_f32 v[60:61], v[60:61], v[116:117] op_sel:[0,1] op_sel_hi:[1,1]
  v_pk_mul_f32 v[62:63], v[62:63], v[116:117] op_sel:[0,1] op_sel_hi:[1,1]
  v_pk_mul_f32 v[64:65], v[64:65], v[116:117] op_sel:[0,1] op_sel_hi:[1,1]
  v_cvt_pk_bf16_f32 v116, v56, v57
  v_cvt_pk_bf16_f32 v117, v58, v59
  v_cvt_pk_bf16_f32 v118, v60, v61
  v_cvt_pk_bf16_f32 v119, v62, v63
  s_waitcnt lgkmcnt(0)
  s_nop 0
  v_mfma_f32_16x16x32_bf16 v[72:75], v[152:155], v[116:119], 0
  s_add_u32 s62, s62, 1
  v_cvt_pk_bf16_f32 v197, v64, v65
  v_cvt_pk_bf16_f32 v198, v64, v65
  v_mfma_f32_16x16x32_bf16 v[76:79], v[156:159], v[116:119], 0
  s_xor_b32 s86, s86, 524288
  v_mfma_f32_16x16x32_bf16 v[80:83], v[160:163], v[116:119], 0
  s_bfe_u32 s42, s62, 0x10001
  v_mfma_f32_16x16x32_bf16 v[84:87], v[164:167], v[116:119], 0
  s_bfe_u32 s26, s64, 65556
  v_mfma_f32_16x16x32_bf16 v[88:91], v[168:171], v[116:119], 0
  s_and_b32 s87, s64, 0xff
  v_mfma_f32_16x16x32_bf16 v[92:95], v[172:175], v[116:119], 0
  s_bfe_u32 s88, s64, 0x80008
  v_mfma_f32_16x16x32_bf16 v[96:99], v[176:179], v[116:119], 0
  s_nop 0
  v_mfma_f32_16x16x32_bf16 v[100:103], v[180:183], v[116:119], 0
  s_nop 0
  v_mfma_f32_16x16x16_bf16 v[72:75], v[200:201], v[198:199], v[72:75]
  s_nop 1
  v_mfma_f32_16x16x16_bf16 v[76:79], v[200:201], v[196:197], v[76:79]
  s_nop 1
  v_mfma_f32_16x16x16_bf16 v[80:83], v[202:203], v[198:199], v[80:83]
  s_nop 1
  v_mfma_f32_16x16x16_bf16 v[84:87], v[202:203], v[196:197], v[84:87]
  s_nop 1
  v_mfma_f32_16x16x16_bf16 v[88:91], v[204:205], v[198:199], v[88:91]
  s_nop 0
  v_cvt_pk_bf16_f32 v40, v72, v73
  v_cvt_pk_bf16_f32 v41, v74, v75
  v_mfma_f32_16x16x16_bf16 v[92:95], v[204:205], v[196:197], v[92:95]
  s_nop 0
  v_cvt_pk_bf16_f32 v42, v76, v77
  v_cvt_pk_bf16_f32 v43, v78, v79
  v_mfma_f32_16x16x16_bf16 v[96:99], v[206:207], v[198:199], v[96:99]
  s_nop 0
  ds_write_b128 v6, v[40:43] offset:0
  v_cvt_pk_bf16_f32 v44, v80, v81
  v_mfma_f32_16x16x16_bf16 v[100:103], v[206:207], v[196:197], v[100:103]
  s_nop 0
  v_cvt_pk_bf16_f32 v45, v82, v83
  v_cvt_pk_bf16_f32 v46, v84, v85
  v_cvt_pk_bf16_f32 v47, v86, v87
  ds_write_b128 v6, v[44:47] offset:1024
  v_cvt_pk_bf16_f32 v48, v88, v89
  v_cvt_pk_bf16_f32 v49, v90, v91
  v_cvt_pk_bf16_f32 v50, v92, v93
  v_cvt_pk_bf16_f32 v51, v94, v95
  ds_write_b128 v6, v[48:51] offset:2048
  v_cvt_pk_bf16_f32 v52, v96, v97
  v_cvt_pk_bf16_f32 v53, v98, v99
  v_cvt_pk_bf16_f32 v54, v100, v101
  v_cvt_pk_bf16_f32 v55, v102, v103
  ds_write_b128 v6, v[52:55] offset:3072
  s_cmp_lt_u32 s17, 2
  s_cbranch_scc1 o_wr0_152
  s_waitcnt lgkmcnt(0)
  s_barrier
  ds_read_b128 v[104:107], v3 offset:0
  ds_read_b128 v[108:111], v3 offset:512
  ds_read_b128 v[112:115], v3 offset:1024
  s_waitcnt lgkmcnt(2)
  v_mfma_f32_32x32x16_bf16 v[40:55], v[104:107], a[0:3], 0
  s_waitcnt vmcnt(0)
  v_cmp_eq_u32 vcc, 0, v37
  s_cmp_eq_u64 vcc, 0
  s_cselect_b32 s66, s26, 0
  s_cmp_eq_u32 s66, 1
  s_cselect_b32 s87, s87, 1024
  s_cselect_b32 s34, 0, 0x28000
  v_mfma_f32_32x32x16_bf16 v[56:71], v[104:107], a[4:7], 0
  ds_read_b128 v[116:119], v3 offset:1536
  s_lshl_b32 s33, s87, 18
  s_lshl_b32 s32, s87, 19
  s_add_u32 m0, s22, s34
  s_add_u32 s33, s33, s19
  s_min_u32 s28, s49, 67
  v_mfma_f32_32x32x16_bf16 v[72:87], v[104:107], a[8:11], 0
  s_lshl1_add_u32 s28, s17, s28
  s_lshl_b32 s28, s28, 12
  s_add_u32 s28, s28, 243486720
  v_mfma_f32_32x32x16_bf16 v[88:103], v[104:107], a[12:15], 0
  buffer_load_dword v249, v246, s[4:7], s28 offen sc1
  s_waitcnt lgkmcnt(2)
  v_mfma_f32_32x32x16_bf16 v[40:55], v[108:111], a[16:19], v[40:55]
  buffer_load_dwordx4 v0, s[4:7], s33 offen offset:0 sc1 lds
  v_mfma_f32_32x32x16_bf16 v[56:71], v[108:111], a[20:23], v[56:71]
  ds_read_b128 v[104:107], v3 offset:2048
  v_mfma_f32_32x32x16_bf16 v[72:87], v[108:111], a[24:27], v[72:87]
  buffer_load_dwordx4 v0, s[4:7], s33 offen offset:1024 sc1 lds
  v_mfma_f32_32x32x16_bf16 v[88:103], v[108:111], a[28:31], v[88:103]
  buffer_load_dwordx4 v0, s[4:7], s33 offen offset:2048 sc1 lds
  s_waitcnt lgkmcnt(2)
  v_mfma_f32_32x32x16_bf16 v[40:55], v[112:115], a[32:35], v[40:55]
  v_mfma_f32_32x32x16_bf16 v[56:71], v[112:115], a[36:39], v[56:71]
  ds_read_b128 v[108:111], v3 offset:2560
  buffer_load_dwordx4 v0, s[4:7], s33 offen offset:3072 sc1 lds
  s_sub_u32 m0, m0, 8192
  s_sub_u32 s33, s33, 8192
  v_mfma_f32_32x32x16_bf16 v[72:87], v[112:115], a[40:43], v[72:87]
  buffer_load_dwordx4 v0, s[4:7], s33 offen offset:0 sc1 lds
  v_mfma_f32_32x32x16_bf16 v[88:103], v[112:115], a[44:47], v[88:103]
  s_waitcnt lgkmcnt(2)
  v_mfma_f32_32x32x16_bf16 v[40:55], v[116:119], a[48:51], v[40:55]
  buffer_load_dwordx4 v0, s[4:7], s33 offen offset:1024 sc1 lds
  v_mfma_f32_32x32x16_bf16 v[56:71], v[116:119], a[52:55], v[56:71]
  ds_read_b128 v[112:115], v3 offset:3072
  buffer_load_dwordx4 v0, s[4:7], s33 offen offset:2048 sc1 lds
  v_mfma_f32_32x32x16_bf16 v[72:87], v[116:119], a[56:59], v[72:87]
  v_mfma_f32_32x32x16_bf16 v[88:103], v[116:119], a[60:63], v[88:103]
  buffer_load_dwordx4 v0, s[4:7], s33 offen offset:3072 sc1 lds
  s_add_u32 m0, s23, s34
  s_add_u32 s32, s32, s18
  s_waitcnt lgkmcnt(2)
  v_mfma_f32_32x32x16_bf16 v[40:55], v[104:107], a[64:67], v[40:55]
  buffer_load_dwordx4 v0, s[4:7], s32 offen offset:0 sc1 lds
  v_mfma_f32_32x32x16_bf16 v[56:71], v[104:107], a[68:71], v[56:71]
  ds_read_b128 v[116:119], v3 offset:3584
  v_mfma_f32_32x32x16_bf16 v[72:87], v[104:107], a[72:75], v[72:87]
  buffer_load_dwordx4 v0, s[4:7], s32 offen offset:1024 sc1 lds
  s_add_i32 m0, m0, 4096
  s_add_i32 s32, s32, 4096
  v_mfma_f32_32x32x16_bf16 v[88:103], v[104:107], a[76:79], v[88:103]
  buffer_load_dwordx4 v0, s[4:7], s32 offen offset:0 sc1 lds
  s_waitcnt lgkmcnt(2)
  v_mfma_f32_32x32x16_bf16 v[40:55], v[108:111], a[80:83], v[40:55]
  v_mfma_f32_32x32x16_bf16 v[56:71], v[108:111], a[84:87], v[56:71]
  ds_read_b128 v[104:107], v3 offset:8192
  buffer_load_dwordx4 v0, s[4:7], s32 offen offset:1024 sc1 lds
  s_add_i32 m0, m0, -16384
  s_add_i32 s32, s32, -16384
  v_mfma_f32_32x32x16_bf16 v[72:87], v[108:111], a[88:91], v[72:87]
  s_and_b32 s29, s64, 0xff00
  s_lshl_b32 s29, s29, 3
  s_add_u32 s29, s29, s15
  buffer_load_dword v245, v252, s[4:7], s29 offen sc1
  v_mfma_f32_32x32x16_bf16 v[88:103], v[108:111], a[92:95], v[88:103]
  s_waitcnt lgkmcnt(2)
  v_mfma_f32_32x32x16_bf16 v[40:55], v[112:115], a[96:99], v[40:55]
  buffer_load_dwordx4 v0, s[4:7], s32 offen offset:0 sc1 lds
  v_mfma_f32_32x32x16_bf16 v[56:71], v[112:115], a[100:103], v[56:71]
  ds_read_b128 v[108:111], v3 offset:8704
  buffer_load_dwordx4 v0, s[4:7], s32 offen offset:1024 sc1 lds
  s_add_i32 m0, m0, -4096
  s_add_i32 s32, s32, -4096
  v_mfma_f32_32x32x16_bf16 v[72:87], v[112:115], a[104:107], v[72:87]
  v_mfma_f32_32x32x16_bf16 v[88:103], v[112:115], a[108:111], v[88:103]
  buffer_load_dwordx4 v0, s[4:7], s32 offen offset:0 sc1 lds
  s_waitcnt lgkmcnt(2)
  v_mfma_f32_32x32x16_bf16 v[40:55], v[116:119], a[112:115], v[40:55]
  buffer_load_dwordx4 v0, s[4:7], s32 offen offset:1024 sc1 lds
  v_mfma_f32_32x32x16_bf16 v[56:71], v[116:119], a[116:119], v[56:71]
  ds_read_b128 v[112:115], v3 offset:9216
  v_mfma_f32_32x32x16_bf16 v[72:87], v[116:119], a[120:123], v[72:87]
  buffer_load_dwordx4 v0, s[4:7], s32 offen offset:2048 sc1 lds
  v_mfma_f32_32x32x16_bf16 v[88:103], v[116:119], a[124:127], v[88:103]
  buffer_load_dwordx4 v0, s[4:7], s32 offen offset:3072 sc1 lds
  s_add_i32 m0, m0, 4096
  s_add_i32 s32, s32, 4096
  s_waitcnt lgkmcnt(2)
  v_mfma_f32_32x32x16_bf16 v[40:55], v[104:107], a[128:131], v[40:55]
  v_mfma_f32_32x32x16_bf16 v[56:71], v[104:107], a[132:135], v[56:71]
  ds_read_b128 v[116:119], v3 offset:9728
  buffer_load_dwordx4 v0, s[4:7], s32 offen offset:2048 sc1 lds
  v_mfma_f32_32x32x16_bf16 v[72:87], v[104:107], a[136:139], v[72:87]
  buffer_load_dwordx4 v0, s[4:7], s32 offen offset:3072 sc1 lds
  s_add_i32 m0, m0, 16384
  s_add_i32 s32, s32, 16384
  v_mfma_f32_32x32x16_bf16 v[88:103], v[104:107], a[140:143], v[88:103]
  s_waitcnt lgkmcnt(2)
  v_mfma_f32_32x32x16_bf16 v[40:55], v[108:111], a[144:147], v[40:55]
  buffer_load_dwordx4 v0, s[4:7], s32 offen offset:2048 sc1 lds
  v_mfma_f32_32x32x16_bf16 v[56:71], v[108:111], a[148:151], v[56:71]
  ds_read_b128 v[104:107], v3 offset:10240
  buffer_load_dwordx4 v0, s[4:7], s32 offen offset:3072 sc1 lds
  s_add_i32 m0, m0, -4096
  s_add_i32 s32, s32, -4096
  v_mfma_f32_32x32x16_bf16 v[72:87], v[108:111], a[152:155], v[72:87]
  v_mfma_f32_32x32x16_bf16 v[88:103], v[108:111], a[156:159], v[88:103]
  buffer_load_dwordx4 v0, s[4:7], s32 offen offset:2048 sc1 lds
  s_waitcnt lgkmcnt(2)
  v_mfma_f32_32x32x16_bf16 v[40:55], v[112:115], a[160:163], v[40:55]
  buffer_load_dwordx4 v0, s[4:7], s32 offen offset:3072 sc1 lds
  v_mfma_f32_32x32x16_bf16 v[56:71], v[112:115], a[164:167], v[56:71]
  ds_read_b128 v[108:111], v3 offset:10752
  v_mfma_f32_32x32x16_bf16 v[72:87], v[112:115], a[168:171], v[72:87]
  v_mfma_f32_32x32x16_bf16 v[88:103], v[112:115], a[172:175], v[88:103]
  s_waitcnt lgkmcnt(2)
  v_mfma_f32_32x32x16_bf16 v[40:55], v[116:119], a[176:179], v[40:55]
  v_mfma_f32_32x32x16_bf16 v[56:71], v[116:119], a[180:183], v[56:71]
  ds_read_b128 v[112:115], v3 offset:11264
  v_mfma_f32_32x32x16_bf16 v[72:87], v[116:119], a[184:187], v[72:87]
  v_mfma_f32_32x32x16_bf16 v[88:103], v[116:119], a[188:191], v[88:103]
  s_waitcnt lgkmcnt(2)
  v_mfma_f32_32x32x16_bf16 v[40:55], v[104:107], a[192:195], v[40:55]
  v_mfma_f32_32x32x16_bf16 v[56:71], v[104:107], a[196:199], v[56:71]
  ds_read_b128 v[116:119], v3 offset:11776
  s_waitcnt vmcnt(12)
  v_cmp_eq_u32 vcc, 0, v245
  s_cmp_eq_u64 vcc, 0
  s_cselect_b32 s76, s26, 0
  s_and_b32 s76, s76, 1
  s_cselect_b32 s88, s88, 1024
  s_waitcnt lgkmcnt(2)
  v_mfma_f32_32x32x16_bf16 v[40:55], v[108:111], a[208:211], v[40:55]
  s_lshl_b32 s32, s88, 18
  s_mov_b32 m0, s40
  s_add_u32 s32, s32, s21
  buffer_load_dwordx4 v0, s[4:7], s32 offen offset:0 sc1 lds
  v_mfma_f32_32x32x16_bf16 v[56:71], v[108:111], a[212:215], v[56:71]
  buffer_load_dwordx4 v0, s[4:7], s32 offen offset:1024 sc1 lds
  s_waitcnt lgkmcnt(1)
  v_mfma_f32_32x32x16_bf16 v[40:55], v[112:115], a[224:227], v[40:55]
  buffer_load_dwordx4 v0, s[4:7], s32 offen offset:2048 sc1 lds
  s_sub_u32 m0, m0, 8192
  s_sub_u32 s32, s32, 8192
  v_mfma_f32_32x32x16_bf16 v[56:71], v[112:115], a[228:231], v[56:71]
  buffer_load_dwordx4 v0, s[4:7], s32 offen offset:0 sc1 lds
  s_waitcnt lgkmcnt(0)
  v_mfma_f32_32x32x16_bf16 v[40:55], v[116:119], a[240:243], v[40:55]
  buffer_load_dwordx4 v0, s[4:7], s32 offen offset:1024 sc1 lds
  v_mfma_f32_32x32x16_bf16 v[56:71], v[116:119], a[244:247], v[56:71]
  buffer_load_dwordx4 v0, s[4:7], s32 offen offset:2048 sc1 lds
  v_cmp_eq_u32 vcc, 0, v249
  v_max_u32_dpp v249, v249, v249 row_ror:8 row_mask:0xf bank_mask:0xf
  s_nop 0
  v_mfma_f32_32x32x16_bf16 v[72:87], v[104:107], a[200:203], v[72:87]
  v_max_u32_dpp v249, v249, v249 row_ror:4 row_mask:0xf bank_mask:0xf
  s_nop 0
  s_nop 0
  v_max_u32_dpp v249, v249, v249 row_ror:2 row_mask:0xf bank_mask:0xf
  s_nop 0
  s_nop 0
  v_max_u32_dpp v249, v249, v249 row_ror:1 row_mask:0xf bank_mask:0xf
  s_nop 0
  v_mfma_f32_32x32x16_bf16 v[88:103], v[104:107], a[204:207], v[88:103]
  v_mov_b32 v248, v249
  s_nop 0
  s_nop 0
  v_permlane16_swap_b32 v249, v248
  v_max_u32 v249, v249, v248
  v_mfma_f32_32x32x16_bf16 v[72:87], v[108:111], a[216:219], v[72:87]
  v_mov_b32 v248, v249
  s_nop 0
  s_nop 0
  v_permlane32_swap_b32 v249, v248
  v_max_u32 v249, v249, v248
  s_cmp_eq_u64 vcc, 0
  s_cselect_b32 s28, 4, 0
  v_mfma_f32_32x32x16_bf16 v[88:103], v[108:111], a[220:223], v[88:103]
  s_lshl_b32 s26, s76, 1
  s_or_b32 s26, s26, s66
  s_or_b32 s26, s26, s28
  v_mov_b32 v248, s26
  ds_write_b64 v39, v[248:249]
  v_mfma_f32_32x32x16_bf16 v[72:87], v[112:115], a[232:235], v[72:87]
  v_cvt_pk_bf16_f32 v212, v40, v56
  v_cvt_pk_bf16_f32 v214, v41, v57
  v_cvt_pk_bf16_f32 v216, v42, v58
  v_cvt_pk_bf16_f32 v218, v43, v59
  v_permlane16_swap_b32 v212, v214
  v_mfma_f32_32x32x16_bf16 v[88:103], v[112:115], a[236:239], v[88:103]
  v_cvt_pk_bf16_f32 v220, v44, v60
  v_cvt_pk_bf16_f32 v222, v45, v61
  v_permlane16_swap_b32 v216, v218
  v_bfi_b32 v212, v254, s42, v212
  v_mfma_f32_32x32x16_bf16 v[72:87], v[116:119], a[248:251], v[72:87]
  v_cvt_pk_bf16_f32 v224, v46, v62
  v_cvt_pk_bf16_f32 v226, v47, v63
  v_permlane16_swap_b32 v220, v222
  v_bfi_b32 v216, v254, s42, v216
  v_cvt_pk_bf16_f32 v228, v48, v64
  v_mfma_f32_32x32x16_bf16 v[88:103], v[116:119], a[252:255], v[88:103]
  v_cvt_pk_bf16_f32 v230, v49, v65
  v_permlane16_swap_b32 v224, v226
  v_bfi_b32 v220, v254, s42, v220
  v_cvt_pk_bf16_f32 v232, v50, v66
  v_cvt_pk_bf16_f32 v234, v51, v67
  v_permlane16_swap_b32 v228, v230
  v_bfi_b32 v224, v254, s42, v224
  v_cvt_pk_bf16_f32 v236, v52, v68
  v_cvt_pk_bf16_f32 v238, v53, v69
  v_permlane16_swap_b32 v232, v234
  v_bfi_b32 v228, v254, s42, v228
  v_cvt_pk_bf16_f32 v240, v54, v70
  v_cvt_pk_bf16_f32 v242, v55, v71
  v_permlane16_swap_b32 v236, v238
  v_bfi_b32 v232, v254, s42, v232
  v_permlane16_swap_b32 v240, v242
  v_bfi_b32 v236, v254, s42, v236
  v_bfi_b32 v240, v254, s42, v240
  v_cvt_pk_bf16_f32 v213, v72, v88
  v_cvt_pk_bf16_f32 v215, v73, v89
  v_cvt_pk_bf16_f32 v217, v74, v90
  v_cvt_pk_bf16_f32 v219, v75, v91
  s_add_u32 s78, s86, 0
  v_permlane16_swap_b32 v213, v215
  buffer_store_dwordx4 v[212:215], v4, s[4:7], s78 offen
  v_cvt_pk_bf16_f32 v221, v76, v92
  v_cvt_pk_bf16_f32 v223, v77, v93
  s_add_u32 s78, s86, 32768
  v_permlane16_swap_b32 v217, v219
  buffer_store_dwordx4 v[216:219], v4, s[4:7], s78 offen
  v_cvt_pk_bf16_f32 v225, v78, v94
  v_cvt_pk_bf16_f32 v227, v79, v95
  s_add_u32 s78, s86, 131072
  v_permlane16_swap_b32 v221, v223
  buffer_store_dwordx4 v[220:223], v4, s[4:7], s78 offen
  v_cvt_pk_bf16_f32 v229, v80, v96
  v_cvt_pk_bf16_f32 v231, v81, v97
  s_add_u32 s78, s86, 163840
  v_permlane16_swap_b32 v225, v227
  buffer_store_dwordx4 v[224:227], v4, s[4:7], s78 offen
  v_cvt_pk_bf16_f32 v233, v82, v98
  v_cvt_pk_bf16_f32 v235, v83, v99
  s_add_u32 s78, s86, 262144
  v_permlane16_swap_b32 v229, v231
  buffer_store_dwordx4 v[228:231], v4, s[4:7], s78 offen
  v_cvt_pk_bf16_f32 v237, v84, v100
  v_cvt_pk_bf16_f32 v239, v85, v101
  s_add_u32 s78, s86, 294912
  v_permlane16_swap_b32 v233, v235
  buffer_store_dwordx4 v[232:235], v4, s[4:7], s78 offen
  v_cvt_pk_bf16_f32 v241, v86, v102
  v_cvt_pk_bf16_f32 v243, v87, v103
  s_add_u32 s78, s86, 393216
  v_permlane16_swap_b32 v237, v239
  buffer_store_dwordx4 v[236:239], v4, s[4:7], s78 offen
  s_add_u32 s78, s86, 425984
  v_permlane16_swap_b32 v241, v243
  buffer_store_dwordx4 v[240:243], v4, s[4:7], s78 offen
  s_waitcnt vmcnt(22)
  s_branch o_we_155
o_wr0_152:
  s_waitcnt lgkmcnt(0)
  s_barrier
  ds_read_b128 v[104:107], v3 offset:0
  ds_read_b128 v[108:111], v3 offset:512
  ds_read_b128 v[112:115], v3 offset:1024
  s_waitcnt lgkmcnt(2)
  v_mfma_f32_32x32x16_bf16 v[40:55], v[104:107], a[0:3], 0
  v_mfma_f32_32x32x16_bf16 v[56:71], v[104:107], a[4:7], 0
  ds_read_b128 v[116:119], v3 offset:1536
  v_mfma_f32_32x32x16_bf16 v[72:87], v[104:107], a[8:11], 0
  v_mfma_f32_32x32x16_bf16 v[88:103], v[104:107], a[12:15], 0
  s_waitcnt lgkmcnt(2)
  v_mfma_f32_32x32x16_bf16 v[40:55], v[108:111], a[16:19], v[40:55]
  v_mfma_f32_32x32x16_bf16 v[56:71], v[108:111], a[20:23], v[56:71]
  ds_read_b128 v[104:107], v3 offset:2048
  v_mfma_f32_32x32x16_bf16 v[72:87], v[108:111], a[24:27], v[72:87]
  v_mfma_f32_32x32x16_bf16 v[88:103], v[108:111], a[28:31], v[88:103]
  s_waitcnt lgkmcnt(2)
  v_mfma_f32_32x32x16_bf16 v[40:55], v[112:115], a[32:35], v[40:55]
  v_mfma_f32_32x32x16_bf16 v[56:71], v[112:115], a[36:39], v[56:71]
  ds_read_b128 v[108:111], v3 offset:2560
  v_mfma_f32_32x32x16_bf16 v[72:87], v[112:115], a[40:43], v[72:87]
  v_mfma_f32_32x32x16_bf16 v[88:103], v[112:115], a[44:47], v[88:103]
  s_waitcnt lgkmcnt(2)
  v_mfma_f32_32x32x16_bf16 v[40:55], v[116:119], a[48:51], v[40:55]
  v_mfma_f32_32x32x16_bf16 v[56:71], v[116:119], a[52:55], v[56:71]
  ds_read_b128 v[112:115], v3 offset:3072
  v_mfma_f32_32x32x16_bf16 v[72:87], v[116:119], a[56:59], v[72:87]
  v_mfma_f32_32x32x16_bf16 v[88:103], v[116:119], a[60:63], v[88:103]
  s_waitcnt lgkmcnt(2)
  v_mfma_f32_32x32x16_bf16 v[40:55], v[104:107], a[64:67], v[40:55]
  v_mfma_f32_32x32x16_bf16 v[56:71], v[104:107], a[68:71], v[56:71]
  ds_read_b128 v[116:119], v3 offset:3584
  v_mfma_f32_32x32x16_bf16 v[72:87], v[104:107], a[72:75], v[72:87]
  v_mfma_f32_32x32x16_bf16 v[88:103], v[104:107], a[76:79], v[88:103]
  s_waitcnt lgkmcnt(2)
  v_mfma_f32_32x32x16_bf16 v[40:55], v[108:111], a[80:83], v[40:55]
  v_mfma_f32_32x32x16_bf16 v[56:71], v[108:111], a[84:87], v[56:71]
  ds_read_b128 v[104:107], v3 offset:8192
  v_mfma_f32_32x32x16_bf16 v[72:87], v[108:111], a[88:91], v[72:87]
  v_mfma_f32_32x32x16_bf16 v[88:103], v[108:111], a[92:95], v[88:103]
  s_waitcnt lgkmcnt(2)
  v_mfma_f32_32x32x16_bf16 v[40:55], v[112:115], a[96:99], v[40:55]
  v_mfma_f32_32x32x16_bf16 v[56:71], v[112:115], a[100:103], v[56:71]
  ds_read_b128 v[108:111], v3 offset:8704
  v_mfma_f32_32x32x16_bf16 v[72:87], v[112:115], a[104:107], v[72:87]
  v_mfma_f32_32x32x16_bf16 v[88:103], v[112:115], a[108:111], v[88:103]
  s_waitcnt lgkmcnt(2)
  v_mfma_f32_32x32x16_bf16 v[40:55], v[116:119], a[112:115], v[40:55]
  v_mfma_f32_32x32x16_bf16 v[56:71], v[116:119], a[116:119], v[56:71]
  ds_read_b128 v[112:115], v3 offset:9216
  v_mfma_f32_32x32x16_bf16 v[72:87], v[116:119], a[120:123], v[72:87]
  v_mfma_f32_32x32x16_bf16 v[88:103], v[116:119], a[124:127], v[88:103]
  s_waitcnt lgkmcnt(2)
  v_mfma_f32_32x32x16_bf16 v[40:55], v[104:107], a[128:131], v[40:55]
  v_mfma_f32_32x32x16_bf16 v[56:71], v[104:107], a[132:135], v[56:71]
  ds_read_b128 v[116:119], v3 offset:9728
  v_mfma_f32_32x32x16_bf16 v[72:87], v[104:107], a[136:139], v[72:87]
  v_mfma_f32_32x32x16_bf16 v[88:103], v[104:107], a[140:143], v[88:103]
  s_waitcnt lgkmcnt(2)
  v_mfma_f32_32x32x16_bf16 v[40:55], v[108:111], a[144:147], v[40:55]
  v_mfma_f32_32x32x16_bf16 v[56:71], v[108:111], a[148:151], v[56:71]
  ds_read_b128 v[104:107], v3 offset:10240
  v_mfma_f32_32x32x16_bf16 v[72:87], v[108:111], a[152:155], v[72:87]
  v_mfma_f32_32x32x16_bf16 v[88:103], v[108:111], a[156:159], v[88:103]
  s_waitcnt lgkmcnt(2)
  v_mfma_f32_32x32x16_bf16 v[40:55], v[112:115], a[160:163], v[40:55]
  v_mfma_f32_32x32x16_bf16 v[56:71], v[112:115], a[164:167], v[56:71]
  ds_read_b128 v[108:111], v3 offset:10752
  v_mfma_f32_32x32x16_bf16 v[72:87], v[112:115], a[168:171], v[72:87]
  v_mfma_f32_32x32x16_bf16 v[88:103], v[112:115], a[172:175], v[88:103]
  s_waitcnt lgkmcnt(2)
  v_mfma_f32_32x32x16_bf16 v[40:55], v[116:119], a[176:179], v[40:55]
  v_mfma_f32_32x32x16_bf16 v[56:71], v[116:119], a[180:183], v[56:71]
  ds_read_b128 v[112:115], v3 offset:11264
  v_mfma_f32_32x32x16_bf16 v[72:87], v[116:119], a[184:187], v[72:87]
  v_mfma_f32_32x32x16_bf16 v[88:103], v[116:119], a[188:191], v[88:103]
  s_waitcnt lgkmcnt(2)
  v_mfma_f32_32x32x16_bf16 v[40:55], v[104:107], a[192:195], v[40:55]
  v_mfma_f32_32x32x16_bf16 v[56:71], v[104:107], a[196:199], v[56:71]
  ds_read_b128 v[116:119], v3 offset:11776
  s_waitcnt lgkmcnt(2)
  v_mfma_f32_32x32x16_bf16 v[40:55], v[108:111], a[208:211], v[40:55]
  v_mfma_f32_32x32x16_bf16 v[56:71], v[108:111], a[212:215], v[56:71]
  s_waitcnt lgkmcnt(1)
  v_mfma_f32_32x32x16_bf16 v[40:55], v[112:115], a[224:227], v[40:55]
  v_mfma_f32_32x32x16_bf16 v[56:71], v[112:115], a[228:231], v[56:71]
  s_waitcnt lgkmcnt(0)
  v_mfma_f32_32x32x16_bf16 v[40:55], v[116:119], a[240:243], v[40:55]
  v_mfma_f32_32x32x16_bf16 v[56:71], v[116:119], a[244:247], v[56:71]
  v_mfma_f32_32x32x16_bf16 v[72:87], v[104:107], a[200:203], v[72:87]
  v_mfma_f32_32x32x16_bf16 v[88:103], v[104:107], a[204:207], v[88:103]
  v_cvt_pk_bf16_f32 v212, v40, v56
  v_cvt_pk_bf16_f32 v214, v41, v57
  v_cvt_pk_bf16_f32 v216, v42, v58
  v_cvt_pk_bf16_f32 v218, v43, v59
  v_permlane16_swap_b32 v212, v214
  v_mfma_f32_32x32x16_bf16 v[72:87], v[108:111], a[216:219], v[72:87]
  v_cvt_pk_bf16_f32 v220, v44, v60
  v_cvt_pk_bf16_f32 v222, v45, v61
  v_permlane16_swap_b32 v216, v218
  v_bfi_b32 v212, v254, s42, v212
  v_cvt_pk_bf16_f32 v224, v46, v62
  v_mfma_f32_32x32x16_bf16 v[88:103], v[108:111], a[220:223], v[88:103]
  v_cvt_pk_bf16_f32 v226, v47, v63
  v_permlane16_swap_b32 v220, v222
  v_bfi_b32 v216, v254, s42, v216
  v_cvt_pk_bf16_f32 v228, v48, v64
  v_mfma_f32_32x32x16_bf16 v[72:87], v[112:115], a[232:235], v[72:87]
  v_cvt_pk_bf16_f32 v230, v49, v65
  v_permlane16_swap_b32 v224, v226
  v_bfi_b32 v220, v254, s42, v220
  v_cvt_pk_bf16_f32 v232, v50, v66
  v_cvt_pk_bf16_f32 v234, v51, v67
  v_mfma_f32_32x32x16_bf16 v[88:103], v[112:115], a[236:239], v[88:103]
  v_permlane16_swap_b32 v228, v230
  v_bfi_b32 v224, v254, s42, v224
  v_cvt_pk_bf16_f32 v236, v52, v68
  v_cvt_pk_bf16_f32 v238, v53, v69
  v_mfma_f32_32x32x16_bf16 v[72:87], v[116:119], a[248:251], v[72:87]
  v_permlane16_swap_b32 v232, v234
  v_bfi_b32 v228, v254, s42, v228
  v_cvt_pk_bf16_f32 v240, v54, v70
  v_cvt_pk_bf16_f32 v242, v55, v71
  v_permlane16_swap_b32 v236, v238
  v_mfma_f32_32x32x16_bf16 v[88:103], v[116:119], a[252:255], v[88:103]
  v_bfi_b32 v232, v254, s42, v232
  v_permlane16_swap_b32 v240, v242
  v_bfi_b32 v236, v254, s42, v236
  v_bfi_b32 v240, v254, s42, v240
  s_nop 7
  v_cvt_pk_bf16_f32 v213, v72, v88
  v_cvt_pk_bf16_f32 v215, v73, v89
  v_cvt_pk_bf16_f32 v217, v74, v90
  v_cvt_pk_bf16_f32 v219, v75, v91
  s_add_u32 s78, s86, 0
  v_permlane16_swap_b32 v213, v215
  buffer_store_dwordx4 v[212:215], v4, s[4:7], s78 offen
  v_cvt_pk_bf16_f32 v221, v76, v92
  v_cvt_pk_bf16_f32 v223, v77, v93
  s_add_u32 s78, s86, 32768
  v_permlane16_swap_b32 v217, v219
  buffer_store_dwordx4 v[216:219], v4, s[4:7], s78 offen
  v_cvt_pk_bf16_f32 v225, v78, v94
  v_cvt_pk_bf16_f32 v227, v79, v95
  s_add_u32 s78, s86, 131072
  v_permlane16_swap_b32 v221, v223
  buffer_store_dwordx4 v[220:223], v4, s[4:7], s78 offen
  v_cvt_pk_bf16_f32 v229, v80, v96
  v_cvt_pk_bf16_f32 v231, v81, v97
  s_add_u32 s78, s86, 163840
  v_permlane16_swap_b32 v225, v227
  buffer_store_dwordx4 v[224:227], v4, s[4:7], s78 offen
  v_cvt_pk_bf16_f32 v233, v82, v98
  v_cvt_pk_bf16_f32 v235, v83, v99
  s_add_u32 s78, s86, 262144
  v_permlane16_swap_b32 v229, v231
  buffer_store_dwordx4 v[228:231], v4, s[4:7], s78 offen
  v_cvt_pk_bf16_f32 v237, v84, v100
  v_cvt_pk_bf16_f32 v239, v85, v101
  s_add_u32 s78, s86, 294912
  v_permlane16_swap_b32 v233, v235
  buffer_store_dwordx4 v[232:235], v4, s[4:7], s78 offen
  v_cvt_pk_bf16_f32 v241, v86, v102
  v_cvt_pk_bf16_f32 v243, v87, v103
  s_add_u32 s78, s86, 393216
  v_permlane16_swap_b32 v237, v239
  buffer_store_dwordx4 v[236:239], v4, s[4:7], s78 offen
  s_add_u32 s78, s86, 425984
  v_permlane16_swap_b32 v241, v243
  buffer_store_dwordx4 v[240:243], v4, s[4:7], s78 offen
  s_branch o_we_155
o_wr1_153:
  s_nop 3
  v_mul_f32 v112, s24, v112
  v_mul_f32 v113, s24, v113
  v_exp_f32 v64, v112
  v_exp_f32 v65, v113
  v_max_f32 v116, v111, v116
  v_max3_f32 v116, v112, v113, v116
  v_add_f32 v117, v117, v64
  v_add_f32 v118, v118, v65
  v_add_f32 v117, v117, v118
  s_mov_b32 s28, 0x21800000
  v_mov_b32 v118, v117
  s_nop 1
  v_permlane16_swap_b32 v117, v118
  v_add_f32 v117, v117, v118
  v_mov_b32 v118, v117
  s_nop 0
  s_nop 0
  v_permlane32_swap_b32 v117, v118
  v_add_f32 v117, v117, v118
  s_mov_b32 s67, 0
  s_mov_b64 vcc, 0
  s_waitcnt vmcnt(3)
o_pl_161:
  v_and_b32 v7, 1, v7
  v_cmp_ne_u32 vcc, s96, v7
  s_cbranch_vccz o_pk_162
  buffer_load_dword v7, v255, s[4:7], s97 offen sc1
  s_add_u32 s67, s67, 1
  s_cmp_gt_u32 s67, 1048576
  s_cbranch_scc1 L_end
  s_waitcnt vmcnt(0)
  s_branch o_pl_161
o_pk_162:
  s_lshl_b32 s94, s43, 14
  s_add_u32 s94, s94, s95
  buffer_load_dwordx4 v[120:123], v5, s[4:7], s94 offen offset:0 sc1
  v_cmp_lt_f32 vcc, 0x42700000, v116
  v_cmp_gt_f32 s[30:31], s28, v117
  v_rcp_f32 v117, v117
  buffer_load_dwordx4 v[124:127], v5, s[4:7], s94 offen offset:512 sc1
  s_or_b64 vcc, vcc, s[30:31]
  s_cbranch_vccnz o_fb_159
o_fbr_160:
  buffer_load_dwordx4 v[128:131], v5, s[4:7], s94 offen offset:256 sc1
  v_pk_mul_f32 v[56:57], v[56:57], v[116:117] op_sel:[0,1] op_sel_hi:[1,1]
  v_pk_mul_f32 v[58:59], v[58:59], v[116:117] op_sel:[0,1] op_sel_hi:[1,1]
  v_pk_mul_f32 v[60:61], v[60:61], v[116:117] op_sel:[0,1] op_sel_hi:[1,1]
  v_pk_mul_f32 v[62:63], v[62:63], v[116:117] op_sel:[0,1] op_sel_hi:[1,1]
  v_pk_mul_f32 v[64:65], v[64:65], v[116:117] op_sel:[0,1] op_sel_hi:[1,1]
  buffer_load_dwordx4 v[132:135], v5, s[4:7], s94 offen offset:768 sc1
  v_cvt_pk_bf16_f32 v116, v56, v57
  v_cvt_pk_bf16_f32 v117, v58, v59
  v_cvt_pk_bf16_f32 v118, v60, v61
  v_cvt_pk_bf16_f32 v119, v62, v63
  s_waitcnt lgkmcnt(0)
  s_nop 0
  v_mfma_f32_16x16x32_bf16 v[72:75], v[152:155], v[116:119], 0
  s_add_u32 s62, s62, 1
  v_cvt_pk_bf16_f32 v197, v64, v65
  v_cvt_pk_bf16_f32 v198, v64, v65
  v_mfma_f32_16x16x32_bf16 v[76:79], v[156:159], v[116:119], 0
  s_add_u32 s94, s94, 4096
  buffer_load_dwordx4 v[136:139], v5, s[4:7], s94 offen offset:0 sc1
  s_xor_b32 s86, s86, 524288
  v_mfma_f32_16x16x32_bf16 v[80:83], v[160:163], v[116:119], 0
  s_bfe_u32 s42, s62, 0x10001
  v_mfma_f32_16x16x32_bf16 v[84:87], v[164:167], v[116:119], 0
  buffer_load_dwordx4 v[140:143], v5, s[4:7], s94 offen offset:512 sc1
  v_mfma_f32_16x16x32_bf16 v[88:91], v[168:171], v[116:119], 0
  v_mfma_f32_16x16x32_bf16 v[92:95], v[172:175], v[116:119], 0
  buffer_load_dwordx4 v[144:147], v5, s[4:7], s94 offen offset:256 sc1
  v_mfma_f32_16x16x32_bf16 v[96:99], v[176:179], v[116:119], 0
  v_mfma_f32_16x16x32_bf16 v[100:103], v[180:183], v[116:119], 0
  buffer_load_dwordx4 v[148:151], v5, s[4:7], s94 offen offset:768 sc1
  v_mfma_f32_16x16x16_bf16 v[72:75], v[200:201], v[198:199], v[72:75]
  s_nop 1
  v_mfma_f32_16x16x16_bf16 v[76:79], v[200:201], v[196:197], v[76:79]
  s_add_u32 s94, s94, 4096
  buffer_load_dwordx4 v[152:155], v5, s[4:7], s94 offen offset:0 sc1
  v_mfma_f32_16x16x16_bf16 v[80:83], v[202:203], v[198:199], v[80:83]
  s_nop 1
  v_mfma_f32_16x16x16_bf16 v[84:87], v[202:203], v[196:197], v[84:87]
  buffer_load_dwordx4 v[156:159], v5, s[4:7], s94 offen offset:512 sc1
  v_mfma_f32_16x16x16_bf16 v[88:91], v[204:205], v[198:199], v[88:91]
  s_nop 0
  v_cvt_pk_bf16_f32 v40, v72, v73
  v_cvt_pk_bf16_f32 v41, v74, v75
  v_mfma_f32_16x16x16_bf16 v[92:95], v[204:205], v[196:197], v[92:95]
  buffer_load_dwordx4 v[160:163], v5, s[4:7], s94 offen offset:256 sc1
  v_cvt_pk_bf16_f32 v42, v76, v77
  v_cvt_pk_bf16_f32 v43, v78, v79
  v_mfma_f32_16x16x16_bf16 v[96:99], v[206:207], v[198:199], v[96:99]
  s_nop 0
  ds_write_b128 v6, v[40:43] offset:0
  v_cvt_pk_bf16_f32 v44, v80, v81
  v_mfma_f32_16x16x16_bf16 v[100:103], v[206:207], v[196:197], v[100:103]
  buffer_load_dwordx4 v[164:167], v5, s[4:7], s94 offen offset:768 sc1
  v_cvt_pk_bf16_f32 v45, v82, v83
  v_cvt_pk_bf16_f32 v46, v84, v85
  v_cvt_pk_bf16_f32 v47, v86, v87
  ds_write_b128 v6, v[44:47] offset:1024
  v_cvt_pk_bf16_f32 v48, v88, v89
  v_cvt_pk_bf16_f32 v49, v90, v91
  v_cvt_pk_bf16_f32 v50, v92, v93
  v_cvt_pk_bf16_f32 v51, v94, v95
  s_add_u32 s94, s94, 4096
  buffer_load_dwordx4 v[168:171], v5, s[4:7], s94 offen offset:0 sc1
  ds_write_b128 v6, v[48:51] offset:2048
  v_cvt_pk_bf16_f32 v52, v96, v97
  v_cvt_pk_bf16_f32 v53, v98, v99
  v_cvt_pk_bf16_f32 v54, v100, v101
  v_cvt_pk_bf16_f32 v55, v102, v103
  ds_write_b128 v6, v[52:55] offset:3072
  buffer_load_dwordx4 v[172:175], v5, s[4:7], s94 offen offset:512 sc1
  s_and_b32 s26, s65, 49152
  s_cbranch_scc1 o_wr2_154
  s_waitcnt lgkmcnt(0)
  s_barrier
  ds_read_b128 v[104:107], v3 offset:0
  ds_read_b128 v[108:111], v3 offset:512
  ds_read_b128 v[112:115], v3 offset:1024
  buffer_load_dwordx4 v[176:179], v5, s[4:7], s94 offen offset:256 sc1
  buffer_load_dwordx4 v[180:183], v5, s[4:7], s94 offen offset:768 sc1
  s_waitcnt lgkmcnt(2)
  v_mfma_f32_32x32x16_bf16 v[40:55], v[104:107], a[0:3], 0
  v_mov_b64 v[188:189], 0
  v_mov_b64 v[190:191], 0
  v_mov_b64 v[192:193], 0
  v_mov_b64 v[194:195], 0
  s_mov_b64 exec, 1
  buffer_store_dword v38, off, s[4:7], s84 sc1
  s_mov_b64 exec, -1
  s_mov_b32 s84, 268435456
  v_mfma_f32_32x32x16_bf16 v[56:71], v[104:107], a[4:7], 0
  ds_read_b128 v[116:119], v3 offset:1536
  v_mfma_f32_32x32x16_bf16 v[72:87], v[104:107], a[8:11], 0
  v_mfma_f32_32x32x16_bf16 v[88:103], v[104:107], a[12:15], 0
  s_waitcnt vmcnt(13)
  v_xor_b32 v7, s96, v120
  v_bitop3_b32 v7, v7, v124, s96 bitop3:0xf6
  v_bitop3_b32 v7, v7, v128, s96 bitop3:0xf6
  v_bitop3_b32 v7, v7, v132, s96 bitop3:0xf6
  s_waitcnt lgkmcnt(2)
  v_mfma_f32_32x32x16_bf16 v[40:55], v[108:111], a[16:19], v[40:55]
  s_waitcnt vmcnt(9)
  v_bitop3_b32 v7, v7, v136, s96 bitop3:0xf6
  v_bitop3_b32 v7, v7, v140, s96 bitop3:0xf6
  v_bitop3_b32 v7, v7, v144, s96 bitop3:0xf6
  v_bitop3_b32 v7, v7, v148, s96 bitop3:0xf6
  s_waitcnt vmcnt(5)
  v_mfma_f32_32x32x16_bf16 v[56:71], v[108:111], a[20:23], v[56:71]
  ds_read_b128 v[104:107], v3 offset:2048
  v_bitop3_b32 v7, v7, v152, s96 bitop3:0xf6
  v_bitop3_b32 v7, v7, v156, s96 bitop3:0xf6
  v_bitop3_b32 v7, v7, v160, s96 bitop3:0xf6
  v_bitop3_b32 v7, v7, v164, s96 bitop3:0xf6
  s_waitcnt vmcnt(1)
  v_mfma_f32_32x32x16_bf16 v[72:87], v[108:111], a[24:27], v[72:87]
  v_bitop3_b32 v7, v7, v168, s96 bitop3:0xf6
  v_bitop3_b32 v7, v7, v172, s96 bitop3:0xf6
  v_bitop3_b32 v7, v7, v176, s96 bitop3:0xf6
  v_bitop3_b32 v7, v7, v180, s96 bitop3:0xf6
  v_and_b32 v7, v254, v7
  v_cmp_ne_u32 vcc, 0, v7
  s_cbranch_vccnz o_rt_163
o_bk_164:
  v_mfma_f32_32x32x16_bf16 v[88:103], v[108:111], a[28:31], v[88:103]
  v_smfmac_f32_16x16x64_bf16 v[188:191], v[16:19], v[120:127], v20
  v_lshlrev_b32 v196, 16, v184
  v_smfmac_f32_16x16x64_bf16 v[192:195], v[16:19], v[128:135], v20
  v_and_b32 v197, 0xffff0000, v184
  v_smfmac_f32_16x16x64_bf16 v[188:191], v[16:19], v[136:143], v20
  v_lshlrev_b32 v198, 16, v185
  s_waitcnt lgkmcnt(2)
  v_mfma_f32_32x32x16_bf16 v[40:55], v[112:115], a[32:35], v[40:55]
  v_smfmac_f32_16x16x64_bf16 v[192:195], v[16:19], v[144:151], v20
  v_and_b32 v199, 0xffff0000, v185
  v_smfmac_f32_16x16x64_bf16 v[188:191], v[16:19], v[152:159], v20
  v_lshlrev_b32 v200, 16, v186
  v_smfmac_f32_16x16x64_bf16 v[192:195], v[16:19], v[160:167], v20
  v_and_b32 v201, 0xffff0000, v186
  v_mfma_f32_32x32x16_bf16 v[56:71], v[112:115], a[36:39], v[56:71]
  ds_read_b128 v[108:111], v3 offset:2560
  v_smfmac_f32_16x16x64_bf16 v[188:191], v[16:19], v[168:175], v20
  v_lshlrev_b32 v202, 16, v187
  v_smfmac_f32_16x16x64_bf16 v[192:195], v[16:19], v[176:183], v20
  v_and_b32 v203, 0xffff0000, v187
  s_bfe_u32 s92, s65, 131086
  v_mfma_f32_32x32x16_bf16 v[72:87], v[112:115], a[40:43], v[72:87]
  s_lshl_b32 s92, s92, 21
  s_add_u32 s92, s92, s91
  s_add_u32 s93, s92, 27262976
  s_add_u32 s92, s92, 20971520
  v_permlane16_swap_b32 v188, v192
  v_mfma_f32_32x32x16_bf16 v[88:103], v[112:115], a[44:47], v[88:103]
  v_permlane16_swap_b32 v189, v193
  v_permlane16_swap_b32 v190, v194
  v_permlane16_swap_b32 v191, v195
  s_waitcnt lgkmcnt(2)
  v_mfma_f32_32x32x16_bf16 v[40:55], v[116:119], a[48:51], v[40:55]
  v_cvt_pk_bf16_f32 v188, 0, v188
  v_cvt_pk_bf16_f32 v189, 0, v189
  v_cvt_pk_bf16_f32 v190, 0, v190
  v_cvt_pk_bf16_f32 v191, 0, v191
  v_cvt_pk_bf16_f32 v192, 0, v192
  v_cvt_pk_bf16_f32 v193, 0, v193
  v_mfma_f32_32x32x16_bf16 v[56:71], v[116:119], a[52:55], v[56:71]
  ds_read_b128 v[112:115], v3 offset:3072
  v_cvt_pk_bf16_f32 v194, 0, v194
  v_cvt_pk_bf16_f32 v195, 0, v195
  v_add_f32 v196, v196, v188
  v_add_f32 v197, v197, v189
  v_add_f32 v198, v198, v190
  v_mfma_f32_32x32x16_bf16 v[72:87], v[116:119], a[56:59], v[72:87]
  v_add_f32 v199, v199, v191
  v_add_f32 v200, v200, v192
  v_add_f32 v201, v201, v193
  v_add_f32 v202, v202, v194
  v_add_f32 v203, v203, v195
  v_cvt_pk_bf16_f32 v120, v196, v197
  v_mfma_f32_32x32x16_bf16 v[88:103], v[116:119], a[60:63], v[88:103]
  v_cvt_pk_bf16_f32 v121, v198, v199
  v_cvt_pk_bf16_f32 v122, v200, v201
  v_cvt_pk_bf16_f32 v123, v202, v203
  v_lshlrev_b32 v196, 16, v120
  v_and_b32 v197, 0xffff0000, v120
  s_waitcnt lgkmcnt(2)
  v_mfma_f32_32x32x16_bf16 v[40:55], v[104:107], a[64:67], v[40:55]
  v_lshlrev_b32 v198, 16, v121
  v_and_b32 v199, 0xffff0000, v121
  v_lshlrev_b32 v200, 16, v122
  v_and_b32 v201, 0xffff0000, v122
  v_lshlrev_b32 v202, 16, v123
  v_and_b32 v203, 0xffff0000, v123
  v_mfma_f32_32x32x16_bf16 v[56:71], v[104:107], a[68:71], v[56:71]
  ds_read_b128 v[116:119], v3 offset:3584
  buffer_store_dwordx4 v[120:123], v0, s[4:7], s92 offen sc1
  v_add_f32 v136, v196, v197
  v_mul_f32 v137, v196, v196
  v_mfma_f32_32x32x16_bf16 v[72:87], v[104:107], a[72:75], v[72:87]
  v_add_f32 v138, v198, v199
  v_mul_f32 v139, v197, v197
  v_fmac_f32 v137, v198, v198
  v_fmac_f32 v139, v199, v199
  v_add_f32 v136, v136, v200
  v_fmac_f32 v137, v200, v200
  v_mfma_f32_32x32x16_bf16 v[88:103], v[104:107], a[76:79], v[88:103]
  v_add_f32 v138, v138, v201
  v_fmac_f32 v139, v201, v201
  v_add_f32 v136, v136, v202
  v_fmac_f32 v137, v202, v202
  v_add_f32 v138, v138, v203
  s_waitcnt lgkmcnt(2)
  v_mfma_f32_32x32x16_bf16 v[40:55], v[108:111], a[80:83], v[40:55]
  v_fmac_f32 v139, v203, v203
  v_add_f32 v136, v136, v138
  v_add_f32 v137, v137, v139
  s_nop 0
  v_add_f32_dpp v136, v136, v136 row_ror:8 row_mask:0xf bank_mask:0xf
  v_add_f32_dpp v137, v137, v137 row_ror:8 row_mask:0xf bank_mask:0xf
  s_nop 0
  v_add_f32_dpp v136, v136, v136 row_ror:4 row_mask:0xf bank_mask:0xf
  v_mfma_f32_32x32x16_bf16 v[56:71], v[108:111], a[84:87], v[56:71]
  ds_read_b128 v[104:107], v3 offset:8192
  v_add_f32_dpp v137, v137, v137 row_ror:4 row_mask:0xf bank_mask:0xf
  v_add_f32_dpp v136, v136, v136 row_ror:2 row_mask:0xf bank_mask:0xf
  s_nop 0
  v_add_f32_dpp v137, v137, v137 row_ror:2 row_mask:0xf bank_mask:0xf
  v_add_f32_dpp v136, v136, v136 row_ror:1 row_mask:0xf bank_mask:0xf
  s_nop 0
  v_add_f32_dpp v137, v137, v137 row_ror:1 row_mask:0xf bank_mask:0xf
  v_mfma_f32_32x32x16_bf16 v[72:87], v[108:111], a[88:91], v[72:87]
  v_mov_b32 v140, v136
  v_mov_b32 v141, v137
  s_nop 0
  v_permlane16_swap_b32 v136, v140
  v_permlane16_swap_b32 v137, v141
  v_mfma_f32_32x32x16_bf16 v[88:103], v[108:111], a[92:95], v[88:103]
  v_add_f32 v136, v136, v140
  v_add_f32 v137, v137, v141
  v_mov_b32 v140, v136
  v_mov_b32 v141, v137
  s_nop 0
  v_permlane32_swap_b32 v136, v140
  s_waitcnt lgkmcnt(2)
  v_mfma_f32_32x32x16_bf16 v[40:55], v[112:115], a[96:99], v[40:55]
  v_permlane32_swap_b32 v137, v141
  v_add_f32 v136, v136, v140
  v_add_f32 v137, v137, v141
  v_mul_f32 v136, 0x3b000000, v136
  v_mul_f32 v137, 0x3b000000, v137
  v_mfma_f32_32x32x16_bf16 v[56:71], v[112:115], a[100:103], v[56:71]
  ds_read_b128 v[108:111], v3 offset:8704
  v_fma_f32 v137, -v136, v136, v137
  v_cvt_pk_bf16_f32 v136, 0, v136
  v_max_f32 v137, 0, v137
  v_sub_f32 v140, v196, v136
  v_sub_f32 v141, v197, v136
  v_mfma_f32_32x32x16_bf16 v[72:87], v[112:115], a[104:107], v[72:87]
  v_cvt_pk_bf16_f32 v137, 0, v137
  v_sub_f32 v142, v198, v136
  v_sub_f32 v143, v199, v136
  v_add_f32 v137, 0x3727c5ac, v137
  v_sub_f32 v144, v200, v136
  v_sub_f32 v145, v201, v136
  v_mfma_f32_32x32x16_bf16 v[88:103], v[112:115], a[108:111], v[88:103]
  v_cvt_pk_bf16_f32 v137, 0, v137
  v_sub_f32 v146, v202, v136
  v_sub_f32 v147, v203, v136
  v_sqrt_f32 v137, v137
  s_waitcnt lgkmcnt(2)
  v_mfma_f32_32x32x16_bf16 v[40:55], v[116:119], a[112:115], v[40:55]
  v_cvt_pk_bf16_f32 v140, 0, v140
  v_cvt_pk_bf16_f32 v141, 0, v141
  v_cvt_pk_bf16_f32 v137, 0, v137
  v_cvt_pk_bf16_f32 v142, 0, v142
  v_cvt_pk_bf16_f32 v143, 0, v143
  v_rcp_f32 v137, v137
  v_mfma_f32_32x32x16_bf16 v[56:71], v[116:119], a[116:119], v[56:71]
  ds_read_b128 v[112:115], v3 offset:9216
  v_cvt_pk_bf16_f32 v144, 0, v144
  v_cvt_pk_bf16_f32 v145, 0, v145
  v_cvt_pk_bf16_f32 v146, 0, v146
  v_cvt_pk_bf16_f32 v147, 0, v147
  v_mul_f32 v140, v140, v137
  v_mfma_f32_32x32x16_bf16 v[72:87], v[116:119], a[120:123], v[72:87]
  v_mul_f32 v141, v141, v137
  v_mul_f32 v142, v142, v137
  v_mul_f32 v143, v143, v137
  v_mul_f32 v144, v144, v137
  v_mul_f32 v145, v145, v137
  v_mul_f32 v146, v146, v137
  v_mfma_f32_32x32x16_bf16 v[88:103], v[116:119], a[124:127], v[88:103]
  v_mul_f32 v147, v147, v137
  v_cvt_pk_bf16_f32 v124, v140, v141
  v_cvt_pk_bf16_f32 v125, v142, v143
  v_cvt_pk_bf16_f32 v126, v144, v145
  v_cvt_pk_bf16_f32 v127, v146, v147
  s_waitcnt lgkmcnt(2)
  v_mfma_f32_32x32x16_bf16 v[40:55], v[104:107], a[128:131], v[40:55]
  v_lshlrev_b32 v204, 16, v124
  v_and_b32 v205, 0xffff0000, v124
  v_lshlrev_b32 v206, 16, v125
  v_and_b32 v207, 0xffff0000, v125
  v_lshlrev_b32 v208, 16, v126
  v_and_b32 v209, 0xffff0000, v126
  v_mfma_f32_32x32x16_bf16 v[56:71], v[104:107], a[132:135], v[56:71]
  ds_read_b128 v[116:119], v3 offset:9728
  v_lshlrev_b32 v210, 16, v127
  v_and_b32 v211, 0xffff0000, v127
  buffer_store_dwordx4 v[124:127], v0, s[4:7], s93 offen sc1
  v_mfma_f32_32x32x16_bf16 v[72:87], v[104:107], a[136:139], v[72:87]
  v_add_f32 v196, v196, v204
  v_add_f32 v197, v197, v205
  v_add_f32 v198, v198, v206
  v_add_f32 v199, v199, v207
  v_add_f32 v200, v200, v208
  v_add_f32 v201, v201, v209
  v_mfma_f32_32x32x16_bf16 v[88:103], v[104:107], a[140:143], v[88:103]
  v_add_f32 v202, v202, v210
  v_add_f32 v203, v203, v211
  v_cvt_pk_bf16_f32 v128, v196, v197
  v_cvt_pk_bf16_f32 v129, v198, v199
  v_cvt_pk_bf16_f32 v130, v200, v201
  s_waitcnt lgkmcnt(2)
  v_mfma_f32_32x32x16_bf16 v[40:55], v[108:111], a[144:147], v[40:55]
  v_cvt_pk_bf16_f32 v131, v202, v203
  v_mul_f32 v188, v204, v8
  v_mul_f32 v189, v205, v9
  v_fmac_f32 v188, v206, v10
  v_fmac_f32 v189, v207, v11
  v_fmac_f32 v188, v208, v12
  v_mfma_f32_32x32x16_bf16 v[56:71], v[108:111], a[148:151], v[56:71]
  ds_read_b128 v[104:107], v3 offset:10240
  v_fmac_f32 v189, v209, v13
  v_fmac_f32 v188, v210, v14
  v_fmac_f32 v189, v211, v15
  v_add_f32 v188, v188, v189
  s_add_u32 s92, s91, 10485760
  v_mfma_f32_32x32x16_bf16 v[72:87], v[108:111], a[152:155], v[72:87]
  s_add_u32 s93, s91, 8388608
  buffer_store_dwordx4 v[128:131], v0, s[4:7], s92 offen sc1
  v_lshlrev_b32 v196, 16, v128
  v_and_b32 v197, 0xffff0000, v128
  v_mfma_f32_32x32x16_bf16 v[88:103], v[108:111], a[156:159], v[88:103]
  v_lshlrev_b32 v198, 16, v129
  v_and_b32 v199, 0xffff0000, v129
  v_lshlrev_b32 v200, 16, v130
  v_and_b32 v201, 0xffff0000, v130
  v_lshlrev_b32 v202, 16, v131
  s_waitcnt lgkmcnt(2)
  v_mfma_f32_32x32x16_bf16 v[40:55], v[112:115], a[160:163], v[40:55]
  v_and_b32 v203, 0xffff0000, v131
  v_add_f32 v136, v196, v197
  v_mul_f32 v137, v196, v196
  v_add_f32 v138, v198, v199
  v_mul_f32 v139, v197, v197
  v_fmac_f32 v137, v198, v198
  v_mfma_f32_32x32x16_bf16 v[56:71], v[112:115], a[164:167], v[56:71]
  ds_read_b128 v[108:111], v3 offset:10752
  v_fmac_f32 v139, v199, v199
  v_add_f32 v136, v136, v200
  v_fmac_f32 v137, v200, v200
  v_add_f32 v138, v138, v201
  v_fmac_f32 v139, v201, v201
  v_mfma_f32_32x32x16_bf16 v[72:87], v[112:115], a[168:171], v[72:87]
  v_add_f32 v136, v136, v202
  v_fmac_f32 v137, v202, v202
  v_add_f32 v138, v138, v203
  v_fmac_f32 v139, v203, v203
  v_add_f32 v136, v136, v138
  v_add_f32 v137, v137, v139
  v_mfma_f32_32x32x16_bf16 v[88:103], v[112:115], a[172:175], v[88:103]
  v_add_f32_dpp v136, v136, v136 row_ror:8 row_mask:0xf bank_mask:0xf
  v_add_f32_dpp v137, v137, v137 row_ror:8 row_mask:0xf bank_mask:0xf
  v_add_f32_dpp v188, v188, v188 row_ror:8 row_mask:0xf bank_mask:0xf
  v_add_f32_dpp v136, v136, v136 row_ror:4 row_mask:0xf bank_mask:0xf
  v_add_f32_dpp v137, v137, v137 row_ror:4 row_mask:0xf bank_mask:0xf
  s_waitcnt lgkmcnt(2)
  v_mfma_f32_32x32x16_bf16 v[40:55], v[116:119], a[176:179], v[40:55]
  v_add_f32_dpp v188, v188, v188 row_ror:4 row_mask:0xf bank_mask:0xf
  v_add_f32_dpp v136, v136, v136 row_ror:2 row_mask:0xf bank_mask:0xf
  v_add_f32_dpp v137, v137, v137 row_ror:2 row_mask:0xf bank_mask:0xf
  v_add_f32_dpp v188, v188, v188 row_ror:2 row_mask:0xf bank_mask:0xf
  v_add_f32_dpp v136, v136, v136 row_ror:1 row_mask:0xf bank_mask:0xf
  v_add_f32_dpp v137, v137, v137 row_ror:1 row_mask:0xf bank_mask:0xf
  v_mfma_f32_32x32x16_bf16 v[56:71], v[116:119], a[180:183], v[56:71]
  ds_read_b128 v[112:115], v3 offset:11264
  v_add_f32_dpp v188, v188, v188 row_ror:1 row_mask:0xf bank_mask:0xf
  v_mov_b32 v140, v136
  v_mov_b32 v141, v137
  v_mov_b32 v142, v188
  v_permlane16_swap_b32 v136, v140
  v_mfma_f32_32x32x16_bf16 v[72:87], v[116:119], a[184:187], v[72:87]
  v_permlane16_swap_b32 v137, v141
  v_permlane16_swap_b32 v188, v142
  v_add_f32 v136, v136, v140
  v_add_f32 v137, v137, v141
  v_mfma_f32_32x32x16_bf16 v[88:103], v[116:119], a[188:191], v[88:103]
  v_add_f32 v188, v188, v142
  v_mov_b32 v140, v136
  v_mov_b32 v141, v137
  v_mov_b32 v142, v188
  v_permlane32_swap_b32 v136, v140
  s_waitcnt lgkmcnt(2)
  v_mfma_f32_32x32x16_bf16 v[40:55], v[104:107], a[192:195], v[40:55]
  v_permlane32_swap_b32 v137, v141
  v_permlane32_swap_b32 v188, v142
  v_add_f32 v136, v136, v140
  v_add_f32 v137, v137, v141
  v_mfma_f32_32x32x16_bf16 v[56:71], v[104:107], a[196:199], v[56:71]
  ds_read_b128 v[116:119], v3 offset:11776
  v_add_f32 v188, v188, v142
  v_mul_f32 v136, 0x3b000000, v136
  v_mul_f32 v137, 0x3b000000, v137
  v_fma_f32 v137, -v136, v136, v137
  v_cvt_pk_bf16_f32 v136, 0, v136
  s_waitcnt lgkmcnt(2)
  v_mfma_f32_32x32x16_bf16 v[40:55], v[108:111], a[208:211], v[40:55]
  v_max_f32 v137, 0, v137
  v_sub_f32 v140, v196, v136
  v_sub_f32 v141, v197, v136
  v_cvt_pk_bf16_f32 v137, 0, v137
  v_sub_f32 v142, v198, v136
  v_sub_f32 v143, v199, v136
  v_mfma_f32_32x32x16_bf16 v[56:71], v[108:111], a[212:215], v[56:71]
  v_add_f32 v137, 0x3727c5ac, v137
  v_sub_f32 v144, v200, v136
  v_sub_f32 v145, v201, v136
  v_cvt_pk_bf16_f32 v137, 0, v137
  v_sub_f32 v146, v202, v136
  v_sub_f32 v147, v203, v136
  s_waitcnt lgkmcnt(1)
  v_mfma_f32_32x32x16_bf16 v[40:55], v[112:115], a[224:227], v[40:55]
  v_sqrt_f32 v137, v137
  v_cvt_pk_bf16_f32 v140, 0, v140
  v_cvt_pk_bf16_f32 v141, 0, v141
  v_cvt_pk_bf16_f32 v137, 0, v137
  v_cvt_pk_bf16_f32 v142, 0, v142
  v_mfma_f32_32x32x16_bf16 v[56:71], v[112:115], a[228:231], v[56:71]
  v_cvt_pk_bf16_f32 v143, 0, v143
  v_rcp_f32 v137, v137
  v_cvt_pk_bf16_f32 v144, 0, v144
  v_cvt_pk_bf16_f32 v145, 0, v145
  v_cvt_pk_bf16_f32 v146, 0, v146
  s_waitcnt lgkmcnt(0)
  v_mfma_f32_32x32x16_bf16 v[40:55], v[116:119], a[240:243], v[40:55]
  v_cvt_pk_bf16_f32 v147, 0, v147
  v_mul_f32 v140, v140, v137
  v_mul_f32 v141, v141, v137
  v_mul_f32 v142, v142, v137
  v_mul_f32 v143, v143, v137
  v_mul_f32 v144, v144, v137
  v_mfma_f32_32x32x16_bf16 v[56:71], v[116:119], a[244:247], v[56:71]
  v_mul_f32 v145, v145, v137
  v_mul_f32 v146, v146, v137
  v_mul_f32 v147, v147, v137
  v_cvt_pk_bf16_f32 v132, v140, v141
  v_cvt_pk_bf16_f32 v133, v142, v143
  v_cvt_pk_bf16_f32 v134, v144, v145
  v_mfma_f32_32x32x16_bf16 v[72:87], v[104:107], a[200:203], v[72:87]
  v_cvt_pk_bf16_f32 v135, v146, v147
  buffer_store_dwordx4 v[132:135], v0, s[4:7], s93 offen sc1
  v_cvt_pk_bf16_f32 v188, 0, v188
  v_ashrrev_i32 v189, 31, v188
  v_mfma_f32_32x32x16_bf16 v[88:103], v[104:107], a[204:207], v[88:103]
  v_or_b32 v189, 0x80000000, v189
  v_xor_b32 v188, v188, v189
  s_sub_u32 s92, 4095, s90
  v_and_b32 v188, 0xffff0000, v188
  v_or_b32 v38, s92, v188
  v_mfma_f32_32x32x16_bf16 v[72:87], v[108:111], a[216:219], v[72:87]
  s_bfe_u32 s92, s65, 196625
  s_lshl_b32 s92, s92, 18
  s_lshl_b32 s93, s90, 7
  s_add_u32 s92, s92, s93
  s_add_u32 s84, s92, 243269632
  v_cvt_pk_bf16_f32 v212, v40, v56
  v_mfma_f32_32x32x16_bf16 v[88:103], v[108:111], a[220:223], v[88:103]
  v_cvt_pk_bf16_f32 v214, v41, v57
  v_cvt_pk_bf16_f32 v216, v42, v58
  v_cvt_pk_bf16_f32 v218, v43, v59
  v_permlane16_swap_b32 v212, v214
  v_mfma_f32_32x32x16_bf16 v[72:87], v[112:115], a[232:235], v[72:87]
  v_cvt_pk_bf16_f32 v220, v44, v60
  v_cvt_pk_bf16_f32 v222, v45, v61
  v_permlane16_swap_b32 v216, v218
  v_bfi_b32 v212, v254, s42, v212
  v_cvt_pk_bf16_f32 v224, v46, v62
  v_mfma_f32_32x32x16_bf16 v[88:103], v[112:115], a[236:239], v[88:103]
  v_cvt_pk_bf16_f32 v226, v47, v63
  v_permlane16_swap_b32 v220, v222
  v_bfi_b32 v216, v254, s42, v216
  v_cvt_pk_bf16_f32 v228, v48, v64
  v_mfma_f32_32x32x16_bf16 v[72:87], v[116:119], a[248:251], v[72:87]
  v_cvt_pk_bf16_f32 v230, v49, v65
  v_permlane16_swap_b32 v224, v226
  v_bfi_b32 v220, v254, s42, v220
  v_cvt_pk_bf16_f32 v232, v50, v66
  v_cvt_pk_bf16_f32 v234, v51, v67
  v_mfma_f32_32x32x16_bf16 v[88:103], v[116:119], a[252:255], v[88:103]
  v_permlane16_swap_b32 v228, v230
  v_bfi_b32 v224, v254, s42, v224
  v_cvt_pk_bf16_f32 v236, v52, v68
  v_cvt_pk_bf16_f32 v238, v53, v69
  v_permlane16_swap_b32 v232, v234
  v_bfi_b32 v228, v254, s42, v228
  v_cvt_pk_bf16_f32 v240, v54, v70
  v_cvt_pk_bf16_f32 v242, v55, v71
  v_permlane16_swap_b32 v236, v238
  v_bfi_b32 v232, v254, s42, v232
  v_permlane16_swap_b32 v240, v242
  v_bfi_b32 v236, v254, s42, v236
  v_bfi_b32 v240, v254, s42, v240
  v_cvt_pk_bf16_f32 v213, v72, v88
  v_cvt_pk_bf16_f32 v215, v73, v89
  v_cvt_pk_bf16_f32 v217, v74, v90
  v_cvt_pk_bf16_f32 v219, v75, v91
  s_add_u32 s78, s86, 0
  v_permlane16_swap_b32 v213, v215
  buffer_store_dwordx4 v[212:215], v4, s[4:7], s78 offen
  v_cvt_pk_bf16_f32 v221, v76, v92
  v_cvt_pk_bf16_f32 v223, v77, v93
  s_add_u32 s78, s86, 32768
  v_permlane16_swap_b32 v217, v219
  buffer_store_dwordx4 v[216:219], v4, s[4:7], s78 offen
  v_cvt_pk_bf16_f32 v225, v78, v94
  v_cvt_pk_bf16_f32 v227, v79, v95
  s_add_u32 s78, s86, 131072
  v_permlane16_swap_b32 v221, v223
  buffer_store_dwordx4 v[220:223], v4, s[4:7], s78 offen
  v_cvt_pk_bf16_f32 v229, v80, v96
  v_cvt_pk_bf16_f32 v231, v81, v97
  s_add_u32 s78, s86, 163840
  v_permlane16_swap_b32 v225, v227
  buffer_store_dwordx4 v[224:227], v4, s[4:7], s78 offen
  v_cvt_pk_bf16_f32 v233, v82, v98
  v_cvt_pk_bf16_f32 v235, v83, v99
  s_add_u32 s78, s86, 262144
  v_permlane16_swap_b32 v229, v231
  buffer_store_dwordx4 v[228:231], v4, s[4:7], s78 offen
  v_cvt_pk_bf16_f32 v237, v84, v100
  v_cvt_pk_bf16_f32 v239, v85, v101
  s_add_u32 s78, s86, 294912
  v_permlane16_swap_b32 v233, v235
  buffer_store_dwordx4 v[232:235], v4, s[4:7], s78 offen
  v_cvt_pk_bf16_f32 v241, v86, v102
  v_cvt_pk_bf16_f32 v243, v87, v103
  s_add_u32 s78, s86, 393216
  v_permlane16_swap_b32 v237, v239
  buffer_store_dwordx4 v[236:239], v4, s[4:7], s78 offen
  s_add_u32 s78, s86, 425984
  v_permlane16_swap_b32 v241, v243
  buffer_store_dwordx4 v[240:243], v4, s[4:7], s78 offen
  s_waitcnt vmcnt(8)
  s_mov_b64 exec, 1
  buffer_store_dword v38, off, s[4:7], s84 sc1
  s_mov_b64 exec, -1
  s_mov_b32 s84, 268435456
  s_branch o_we_155
o_rt_163:
  s_mov_b32 s67, 0
o_rl_167:
  s_lshl_b32 s94, s43, 14
  s_add_u32 s94, s94, s95
  buffer_load_dwordx4 v[120:123], v5, s[4:7], s94 offen offset:0 sc1
  buffer_load_dwordx4 v[124:127], v5, s[4:7], s94 offen offset:512 sc1
  buffer_load_dwordx4 v[128:131], v5, s[4:7], s94 offen offset:256 sc1
  buffer_load_dwordx4 v[132:135], v5, s[4:7], s94 offen offset:768 sc1
  s_add_u32 s94, s94, 4096
  buffer_load_dwordx4 v[136:139], v5, s[4:7], s94 offen offset:0 sc1
  buffer_load_dwordx4 v[140:143], v5, s[4:7], s94 offen offset:512 sc1
  buffer_load_dwordx4 v[144:147], v5, s[4:7], s94 offen offset:256 sc1
  buffer_load_dwordx4 v[148:151], v5, s[4:7], s94 offen offset:768 sc1
  s_add_u32 s94, s94, 4096
  buffer_load_dwordx4 v[152:155], v5, s[4:7], s94 offen offset:0 sc1
  buffer_load_dwordx4 v[156:159], v5, s[4:7], s94 offen offset:512 sc1
  buffer_load_dwordx4 v[160:163], v5, s[4:7], s94 offen offset:256 sc1
  buffer_load_dwordx4 v[164:167], v5, s[4:7], s94 offen offset:768 sc1
  s_add_u32 s94, s94, 4096
  buffer_load_dwordx4 v[168:171], v5, s[4:7], s94 offen offset:0 sc1
  buffer_load_dwordx4 v[172:175], v5, s[4:7], s94 offen offset:512 sc1
  buffer_load_dwordx4 v[176:179], v5, s[4:7], s94 offen offset:256 sc1
  buffer_load_dwordx4 v[180:183], v5, s[4:7], s94 offen offset:768 sc1
  s_add_u32 s67, s67, 1
  s_cmp_gt_u32 s67, 1048576
  s_cbranch_scc1 L_end
  s_waitcnt vmcnt(0)
  v_xor_b32 v7, s96, v120
  v_bitop3_b32 v7, v7, v124, s96 bitop3:0xf6
  v_bitop3_b32 v7, v7, v128, s96 bitop3:0xf6
  v_bitop3_b32 v7, v7, v132, s96 bitop3:0xf6
  v_bitop3_b32 v7, v7, v136, s96 bitop3:0xf6
  v_bitop3_b32 v7, v7, v140, s96 bitop3:0xf6
  v_bitop3_b32 v7, v7, v144, s96 bitop3:0xf6
  v_bitop3_b32 v7, v7, v148, s96 bitop3:0xf6
  v_bitop3_b32 v7, v7, v152, s96 bitop3:0xf6
  v_bitop3_b32 v7, v7, v156, s96 bitop3:0xf6
  v_bitop3_b32 v7, v7, v160, s96 bitop3:0xf6
  v_bitop3_b32 v7, v7, v164, s96 bitop3:0xf6
  v_bitop3_b32 v7, v7, v168, s96 bitop3:0xf6
  v_bitop3_b32 v7, v7, v172, s96 bitop3:0xf6
  v_bitop3_b32 v7, v7, v176, s96 bitop3:0xf6
  v_bitop3_b32 v7, v7, v180, s96 bitop3:0xf6
  v_and_b32 v7, v254, v7
  v_cmp_ne_u32 vcc, 0, v7
  s_cbranch_vccnz o_rl_167
  s_branch o_bk_164
o_rt_165:
  s_mov_b32 s67, 0
o_rl_168:
  s_lshl_b32 s94, s43, 14
  s_add_u32 s94, s94, s95
  buffer_load_dwordx4 v[120:123], v5, s[4:7], s94 offen offset:0 sc1
  buffer_load_dwordx4 v[124:127], v5, s[4:7], s94 offen offset:512 sc1
  buffer_load_dwordx4 v[128:131], v5, s[4:7], s94 offen offset:256 sc1
  buffer_load_dwordx4 v[132:135], v5, s[4:7], s94 offen offset:768 sc1
  s_add_u32 s94, s94, 4096
  buffer_load_dwordx4 v[136:139], v5, s[4:7], s94 offen offset:0 sc1
  buffer_load_dwordx4 v[140:143], v5, s[4:7], s94 offen offset:512 sc1
  buffer_load_dwordx4 v[144:147], v5, s[4:7], s94 offen offset:256 sc1
  buffer_load_dwordx4 v[148:151], v5, s[4:7], s94 offen offset:768 sc1
  s_add_u32 s94, s94, 4096
  buffer_load_dwordx4 v[152:155], v5, s[4:7], s94 offen offset:0 sc1
  buffer_load_dwordx4 v[156:159], v5, s[4:7], s94 offen offset:512 sc1
  buffer_load_dwordx4 v[160:163], v5, s[4:7], s94 offen offset:256 sc1
  buffer_load_dwordx4 v[164:167], v5, s[4:7], s94 offen offset:768 sc1
  s_add_u32 s94, s94, 4096
  buffer_load_dwordx4 v[168:171], v5, s[4:7], s94 offen offset:0 sc1
  buffer_load_dwordx4 v[172:175], v5, s[4:7], s94 offen offset:512 sc1
  buffer_load_dwordx4 v[176:179], v5, s[4:7], s94 offen offset:256 sc1
  buffer_load_dwordx4 v[180:183], v5, s[4:7], s94 offen offset:768 sc1
  s_add_u32 s67, s67, 1
  s_cmp_gt_u32 s67, 1048576
  s_cbranch_scc1 L_end
  s_waitcnt vmcnt(0)
  v_xor_b32 v7, s96, v120
  v_bitop3_b32 v7, v7, v124, s96 bitop3:0xf6
  v_bitop3_b32 v7, v7, v128, s96 bitop3:0xf6
  v_bitop3_b32 v7, v7, v132, s96 bitop3:0xf6
  v_bitop3_b32 v7, v7, v136, s96 bitop3:0xf6
  v_bitop3_b32 v7, v7, v140, s96 bitop3:0xf6
  v_bitop3_b32 v7, v7, v144, s96 bitop3:0xf6
  v_bitop3_b32 v7, v7, v148, s96 bitop3:0xf6
  v_bitop3_b32 v7, v7, v152, s96 bitop3:0xf6
  v_bitop3_b32 v7, v7, v156, s96 bitop3:0xf6
  v_bitop3_b32 v7, v7, v160, s96 bitop3:0xf6
  v_bitop3_b32 v7, v7, v164, s96 bitop3:0xf6
  v_bitop3_b32 v7, v7, v168, s96 bitop3:0xf6
  v_bitop3_b32 v7, v7, v172, s96 bitop3:0xf6
  v_bitop3_b32 v7, v7, v176, s96 bitop3:0xf6
  v_bitop3_b32 v7, v7, v180, s96 bitop3:0xf6
  v_and_b32 v7, v254, v7
  v_cmp_ne_u32 vcc, 0, v7
  s_cbranch_vccnz o_rl_168
  s_branch o_bk_166
o_fb_157:
  v_mov_b32 v118, v116
  s_nop 1
  v_permlane16_swap_b32 v116, v118
  v_max_f32 v116, v116, v118
  v_mov_b32 v118, v116
  s_nop 0
  s_nop 0
  v_permlane32_swap_b32 v116, v118
  v_max_f32 v116, v116, v118
  v_sub_f32 v56, v104, v116
  v_sub_f32 v57, v105, v116
  v_sub_f32 v58, v106, v116
  v_sub_f32 v59, v107, v116
  v_sub_f32 v60, v108, v116
  v_sub_f32 v61, v109, v116
  v_sub_f32 v62, v110, v116
  v_sub_f32 v63, v111, v116
  v_sub_f32 v64, v112, v116
  v_sub_f32 v65, v113, v116
  v_exp_f32 v56, v56
  v_exp_f32 v57, v57
  v_exp_f32 v58, v58
  v_exp_f32 v59, v59
  v_exp_f32 v60, v60
  v_exp_f32 v61, v61
  v_exp_f32 v62, v62
  v_exp_f32 v63, v63
  v_exp_f32 v64, v64
  v_exp_f32 v65, v65
  v_add_f32 v117, v56, v57
  v_add_f32 v117, v117, v58
  v_add_f32 v117, v117, v59
  v_add_f32 v117, v117, v60
  v_add_f32 v117, v117, v61
  v_add_f32 v117, v117, v62
  v_add_f32 v117, v117, v63
  v_add_f32 v117, v117, v64
  v_add_f32 v117, v117, v65
  v_mov_b32 v118, v117
  s_nop 0
  s_nop 0
  v_permlane16_swap_b32 v117, v118
  v_add_f32 v117, v117, v118
  v_mov_b32 v118, v117
  s_nop 0
  s_nop 0
  v_permlane32_swap_b32 v117, v118
  v_add_f32 v117, v117, v118
  v_rcp_f32 v117, v117
  s_branch o_fbr_158
o_fb_159:
  v_mov_b32 v118, v116
  s_nop 1
  v_permlane16_swap_b32 v116, v118
  v_max_f32 v116, v116, v118
  v_mov_b32 v118, v116
  s_nop 0
  s_nop 0
  v_permlane32_swap_b32 v116, v118
  v_max_f32 v116, v116, v118
  v_sub_f32 v56, v104, v116
  v_sub_f32 v57, v105, v116
  v_sub_f32 v58, v106, v116
  v_sub_f32 v59, v107, v116
  v_sub_f32 v60, v108, v116
  v_sub_f32 v61, v109, v116
  v_sub_f32 v62, v110, v116
  v_sub_f32 v63, v111, v116
  v_sub_f32 v64, v112, v116
  v_sub_f32 v65, v113, v116
  v_exp_f32 v56, v56
  v_exp_f32 v57, v57
  v_exp_f32 v58, v58
  v_exp_f32 v59, v59
  v_exp_f32 v60, v60
  v_exp_f32 v61, v61
  v_exp_f32 v62, v62
  v_exp_f32 v63, v63
  v_exp_f32 v64, v64
  v_exp_f32 v65, v65
  v_add_f32 v117, v56, v57
  v_add_f32 v117, v117, v58
  v_add_f32 v117, v117, v59
  v_add_f32 v117, v117, v60
  v_add_f32 v117, v117, v61
  v_add_f32 v117, v117, v62
  v_add_f32 v117, v117, v63
  v_add_f32 v117, v117, v64
  v_add_f32 v117, v117, v65
  v_mov_b32 v118, v117
  s_nop 0
  s_nop 0
  v_permlane16_swap_b32 v117, v118
  v_add_f32 v117, v117, v118
  v_mov_b32 v118, v117
  s_nop 0
  s_nop 0
  v_permlane32_swap_b32 v117, v118
  v_add_f32 v117, v117, v118
  v_rcp_f32 v117, v117
  s_branch o_fbr_160
o_wr2_154:
  s_waitcnt lgkmcnt(0)
  s_barrier
  ds_read_b128 v[104:107], v3 offset:0
  ds_read_b128 v[108:111], v3 offset:512
  ds_read_b128 v[112:115], v3 offset:1024
  buffer_load_dwordx4 v[176:179], v5, s[4:7], s94 offen offset:256 sc1
  buffer_load_dwordx4 v[180:183], v5, s[4:7], s94 offen offset:768 sc1
  s_waitcnt lgkmcnt(2)
  v_mfma_f32_32x32x16_bf16 v[40:55], v[104:107], a[0:3], 0
  v_mov_b64 v[188:189], 0
  v_mov_b64 v[190:191], 0
  v_mov_b64 v[192:193], 0
  v_mov_b64 v[194:195], 0
  s_mov_b64 exec, 1
  buffer_store_dword v38, off, s[4:7], s84 sc1
  s_mov_b64 exec, -1
  s_mov_b32 s84, 268435456
  v_mfma_f32_32x32x16_bf16 v[56:71], v[104:107], a[4:7], 0
  ds_read_b128 v[116:119], v3 offset:1536
  v_mfma_f32_32x32x16_bf16 v[72:87], v[104:107], a[8:11], 0
  v_mfma_f32_32x32x16_bf16 v[88:103], v[104:107], a[12:15], 0
  s_waitcnt vmcnt(13)
  v_xor_b32 v7, s96, v120
  v_bitop3_b32 v7, v7, v124, s96 bitop3:0xf6
  v_bitop3_b32 v7, v7, v128, s96 bitop3:0xf6
  v_bitop3_b32 v7, v7, v132, s96 bitop3:0xf6
  s_waitcnt lgkmcnt(2)
  v_mfma_f32_32x32x16_bf16 v[40:55], v[108:111], a[16:19], v[40:55]
  s_waitcnt vmcnt(9)
  v_bitop3_b32 v7, v7, v136, s96 bitop3:0xf6
  v_bitop3_b32 v7, v7, v140, s96 bitop3:0xf6
  v_bitop3_b32 v7, v7, v144, s96 bitop3:0xf6
  v_bitop3_b32 v7, v7, v148, s96 bitop3:0xf6
  s_waitcnt vmcnt(5)
  v_mfma_f32_32x32x16_bf16 v[56:71], v[108:111], a[20:23], v[56:71]
  ds_read_b128 v[104:107], v3 offset:2048
  v_bitop3_b32 v7, v7, v152, s96 bitop3:0xf6
  v_bitop3_b32 v7, v7, v156, s96 bitop3:0xf6
  v_bitop3_b32 v7, v7, v160, s96 bitop3:0xf6
  v_bitop3_b32 v7, v7, v164, s96 bitop3:0xf6
  s_waitcnt vmcnt(1)
  v_mfma_f32_32x32x16_bf16 v[72:87], v[108:111], a[24:27], v[72:87]
  v_bitop3_b32 v7, v7, v168, s96 bitop3:0xf6
  v_bitop3_b32 v7, v7, v172, s96 bitop3:0xf6
  v_bitop3_b32 v7, v7, v176, s96 bitop3:0xf6
  v_bitop3_b32 v7, v7, v180, s96 bitop3:0xf6
  v_and_b32 v7, v254, v7
  v_cmp_ne_u32 vcc, 0, v7
  s_cbranch_vccnz o_rt_165
o_bk_166:
  v_mfma_f32_32x32x16_bf16 v[88:103], v[108:111], a[28:31], v[88:103]
  v_smfmac_f32_16x16x64_bf16 v[188:191], v[16:19], v[120:127], v20
  v_lshlrev_b32 v196, 16, v184
  v_smfmac_f32_16x16x64_bf16 v[192:195], v[16:19], v[128:135], v20
  v_and_b32 v197, 0xffff0000, v184
  v_smfmac_f32_16x16x64_bf16 v[188:191], v[16:19], v[136:143], v20
  v_lshlrev_b32 v198, 16, v185
  s_waitcnt lgkmcnt(2)
  v_mfma_f32_32x32x16_bf16 v[40:55], v[112:115], a[32:35], v[40:55]
  v_smfmac_f32_16x16x64_bf16 v[192:195], v[16:19], v[144:151], v20
  v_and_b32 v199, 0xffff0000, v185
  v_smfmac_f32_16x16x64_bf16 v[188:191], v[16:19], v[152:159], v20
  v_lshlrev_b32 v200, 16, v186
  v_smfmac_f32_16x16x64_bf16 v[192:195], v[16:19], v[160:167], v20
  v_and_b32 v201, 0xffff0000, v186
  v_mfma_f32_32x32x16_bf16 v[56:71], v[112:115], a[36:39], v[56:71]
  ds_read_b128 v[108:111], v3 offset:2560
  v_smfmac_f32_16x16x64_bf16 v[188:191], v[16:19], v[168:175], v20
  v_lshlrev_b32 v202, 16, v187
  v_smfmac_f32_16x16x64_bf16 v[192:195], v[16:19], v[176:183], v20
  v_and_b32 v203, 0xffff0000, v187
  s_bfe_u32 s92, s65, 131086
  v_mfma_f32_32x32x16_bf16 v[72:87], v[112:115], a[40:43], v[72:87]
  s_lshl_b32 s92, s92, 21
  s_add_u32 s92, s92, s91
  s_add_u32 s93, s92, 27262976
  s_add_u32 s92, s92, 20971520
  v_permlane16_swap_b32 v188, v192
  v_mfma_f32_32x32x16_bf16 v[88:103], v[112:115], a[44:47], v[88:103]
  v_permlane16_swap_b32 v189, v193
  v_permlane16_swap_b32 v190, v194
  v_permlane16_swap_b32 v191, v195
  s_waitcnt lgkmcnt(2)
  v_mfma_f32_32x32x16_bf16 v[40:55], v[116:119], a[48:51], v[40:55]
  v_cvt_pk_bf16_f32 v188, 0, v188
  v_cvt_pk_bf16_f32 v189, 0, v189
  v_cvt_pk_bf16_f32 v190, 0, v190
  v_cvt_pk_bf16_f32 v191, 0, v191
  v_cvt_pk_bf16_f32 v192, 0, v192
  v_cvt_pk_bf16_f32 v193, 0, v193
  v_mfma_f32_32x32x16_bf16 v[56:71], v[116:119], a[52:55], v[56:71]
  ds_read_b128 v[112:115], v3 offset:3072
  v_cvt_pk_bf16_f32 v194, 0, v194
  v_cvt_pk_bf16_f32 v195, 0, v195
  v_add_f32 v196, v196, v188
  v_add_f32 v197, v197, v189
  v_add_f32 v198, v198, v190
  v_mfma_f32_32x32x16_bf16 v[72:87], v[116:119], a[56:59], v[72:87]
  v_add_f32 v199, v199, v191
  v_add_f32 v200, v200, v192
  v_add_f32 v201, v201, v193
  v_add_f32 v202, v202, v194
  v_add_f32 v203, v203, v195
  v_cvt_pk_bf16_f32 v120, v196, v197
  v_mfma_f32_32x32x16_bf16 v[88:103], v[116:119], a[60:63], v[88:103]
  v_cvt_pk_bf16_f32 v121, v198, v199
  v_cvt_pk_bf16_f32 v122, v200, v201
  v_cvt_pk_bf16_f32 v123, v202, v203
  v_lshlrev_b32 v196, 16, v120
  v_and_b32 v197, 0xffff0000, v120
  s_waitcnt lgkmcnt(2)
  v_mfma_f32_32x32x16_bf16 v[40:55], v[104:107], a[64:67], v[40:55]
  v_lshlrev_b32 v198, 16, v121
  v_and_b32 v199, 0xffff0000, v121
  v_lshlrev_b32 v200, 16, v122
  v_and_b32 v201, 0xffff0000, v122
  v_lshlrev_b32 v202, 16, v123
  v_and_b32 v203, 0xffff0000, v123
  v_mfma_f32_32x32x16_bf16 v[56:71], v[104:107], a[68:71], v[56:71]
  ds_read_b128 v[116:119], v3 offset:3584
  buffer_store_dwordx4 v[120:123], v0, s[4:7], s92 offen sc1
  v_add_f32 v136, v196, v197
  v_mul_f32 v137, v196, v196
  v_mfma_f32_32x32x16_bf16 v[72:87], v[104:107], a[72:75], v[72:87]
  v_add_f32 v138, v198, v199
  v_mul_f32 v139, v197, v197
  v_fmac_f32 v137, v198, v198
  v_fmac_f32 v139, v199, v199
  v_add_f32 v136, v136, v200
  v_fmac_f32 v137, v200, v200
  v_mfma_f32_32x32x16_bf16 v[88:103], v[104:107], a[76:79], v[88:103]
  v_add_f32 v138, v138, v201
  v_fmac_f32 v139, v201, v201
  v_add_f32 v136, v136, v202
  v_fmac_f32 v137, v202, v202
  v_add_f32 v138, v138, v203
  s_waitcnt lgkmcnt(2)
  v_mfma_f32_32x32x16_bf16 v[40:55], v[108:111], a[80:83], v[40:55]
  v_fmac_f32 v139, v203, v203
  v_add_f32 v136, v136, v138
  v_add_f32 v137, v137, v139
  s_nop 0
  v_add_f32_dpp v136, v136, v136 row_ror:8 row_mask:0xf bank_mask:0xf
  v_add_f32_dpp v137, v137, v137 row_ror:8 row_mask:0xf bank_mask:0xf
  s_nop 0
  v_add_f32_dpp v136, v136, v136 row_ror:4 row_mask:0xf bank_mask:0xf
  v_mfma_f32_32x32x16_bf16 v[56:71], v[108:111], a[84:87], v[56:71]
  ds_read_b128 v[104:107], v3 offset:8192
  v_add_f32_dpp v137, v137, v137 row_ror:4 row_mask:0xf bank_mask:0xf
  v_add_f32_dpp v136, v136, v136 row_ror:2 row_mask:0xf bank_mask:0xf
  s_nop 0
  v_add_f32_dpp v137, v137, v137 row_ror:2 row_mask:0xf bank_mask:0xf
  v_add_f32_dpp v136, v136, v136 row_ror:1 row_mask:0xf bank_mask:0xf
  s_nop 0
  v_add_f32_dpp v137, v137, v137 row_ror:1 row_mask:0xf bank_mask:0xf
  v_mfma_f32_32x32x16_bf16 v[72:87], v[108:111], a[88:91], v[72:87]
  v_mov_b32 v140, v136
  v_mov_b32 v141, v137
  s_nop 0
  v_permlane16_swap_b32 v136, v140
  v_permlane16_swap_b32 v137, v141
  v_mfma_f32_32x32x16_bf16 v[88:103], v[108:111], a[92:95], v[88:103]
  v_add_f32 v136, v136, v140
  v_add_f32 v137, v137, v141
  v_mov_b32 v140, v136
  v_mov_b32 v141, v137
  s_nop 0
  v_permlane32_swap_b32 v136, v140
  s_waitcnt lgkmcnt(2)
  v_mfma_f32_32x32x16_bf16 v[40:55], v[112:115], a[96:99], v[40:55]
  v_permlane32_swap_b32 v137, v141
  v_add_f32 v136, v136, v140
  v_add_f32 v137, v137, v141
  v_mul_f32 v136, 0x3b000000, v136
  v_mul_f32 v137, 0x3b000000, v137
  v_mfma_f32_32x32x16_bf16 v[56:71], v[112:115], a[100:103], v[56:71]
  ds_read_b128 v[108:111], v3 offset:8704
  v_fma_f32 v137, -v136, v136, v137
  v_cvt_pk_bf16_f32 v136, 0, v136
  v_max_f32 v137, 0, v137
  v_sub_f32 v140, v196, v136
  v_sub_f32 v141, v197, v136
  v_mfma_f32_32x32x16_bf16 v[72:87], v[112:115], a[104:107], v[72:87]
  v_cvt_pk_bf16_f32 v137, 0, v137
  v_sub_f32 v142, v198, v136
  v_sub_f32 v143, v199, v136
  v_add_f32 v137, 0x3727c5ac, v137
  v_sub_f32 v144, v200, v136
  v_sub_f32 v145, v201, v136
  v_mfma_f32_32x32x16_bf16 v[88:103], v[112:115], a[108:111], v[88:103]
  v_cvt_pk_bf16_f32 v137, 0, v137
  v_sub_f32 v146, v202, v136
  v_sub_f32 v147, v203, v136
  v_sqrt_f32 v137, v137
  s_waitcnt lgkmcnt(2)
  v_mfma_f32_32x32x16_bf16 v[40:55], v[116:119], a[112:115], v[40:55]
  v_cvt_pk_bf16_f32 v140, 0, v140
  v_cvt_pk_bf16_f32 v141, 0, v141
  v_cvt_pk_bf16_f32 v137, 0, v137
  v_cvt_pk_bf16_f32 v142, 0, v142
  v_cvt_pk_bf16_f32 v143, 0, v143
  v_rcp_f32 v137, v137
  v_mfma_f32_32x32x16_bf16 v[56:71], v[116:119], a[116:119], v[56:71]
  ds_read_b128 v[112:115], v3 offset:9216
  v_cvt_pk_bf16_f32 v144, 0, v144
  v_cvt_pk_bf16_f32 v145, 0, v145
  v_cvt_pk_bf16_f32 v146, 0, v146
  v_cvt_pk_bf16_f32 v147, 0, v147
  v_mul_f32 v140, v140, v137
  v_mfma_f32_32x32x16_bf16 v[72:87], v[116:119], a[120:123], v[72:87]
  v_mul_f32 v141, v141, v137
  v_mul_f32 v142, v142, v137
  v_mul_f32 v143, v143, v137
  v_mul_f32 v144, v144, v137
  v_mul_f32 v145, v145, v137
  v_mul_f32 v146, v146, v137
  v_mfma_f32_32x32x16_bf16 v[88:103], v[116:119], a[124:127], v[88:103]
  v_mul_f32 v147, v147, v137
  v_cvt_pk_bf16_f32 v124, v140, v141
  v_cvt_pk_bf16_f32 v125, v142, v143
  v_cvt_pk_bf16_f32 v126, v144, v145
  v_cvt_pk_bf16_f32 v127, v146, v147
  s_waitcnt lgkmcnt(2)
  v_mfma_f32_32x32x16_bf16 v[40:55], v[104:107], a[128:131], v[40:55]
  v_lshlrev_b32 v204, 16, v124
  v_and_b32 v205, 0xffff0000, v124
  v_lshlrev_b32 v206, 16, v125
  v_and_b32 v207, 0xffff0000, v125
  v_lshlrev_b32 v208, 16, v126
  v_and_b32 v209, 0xffff0000, v126
  v_mfma_f32_32x32x16_bf16 v[56:71], v[104:107], a[132:135], v[56:71]
  ds_read_b128 v[116:119], v3 offset:9728
  v_lshlrev_b32 v210, 16, v127
  v_and_b32 v211, 0xffff0000, v127
  buffer_store_dwordx4 v[124:127], v0, s[4:7], s93 offen sc1
  v_mfma_f32_32x32x16_bf16 v[72:87], v[104:107], a[136:139], v[72:87]
  v_add_f32 v196, v196, v204
  v_add_f32 v197, v197, v205
  v_add_f32 v198, v198, v206
  v_add_f32 v199, v199, v207
  v_add_f32 v200, v200, v208
  v_add_f32 v201, v201, v209
  v_mfma_f32_32x32x16_bf16 v[88:103], v[104:107], a[140:143], v[88:103]
  v_add_f32 v202, v202, v210
  v_add_f32 v203, v203, v211
  v_cvt_pk_bf16_f32 v128, v196, v197
  v_cvt_pk_bf16_f32 v129, v198, v199
  v_cvt_pk_bf16_f32 v130, v200, v201
  s_waitcnt lgkmcnt(2)
  v_mfma_f32_32x32x16_bf16 v[40:55], v[108:111], a[144:147], v[40:55]
  v_cvt_pk_bf16_f32 v131, v202, v203
  v_mul_f32 v188, v204, v8
  v_mul_f32 v189, v205, v9
  v_fmac_f32 v188, v206, v10
  v_fmac_f32 v189, v207, v11
  v_fmac_f32 v188, v208, v12
  v_mfma_f32_32x32x16_bf16 v[56:71], v[108:111], a[148:151], v[56:71]
  ds_read_b128 v[104:107], v3 offset:10240
  v_fmac_f32 v189, v209, v13
  v_fmac_f32 v188, v210, v14
  v_fmac_f32 v189, v211, v15
  v_add_f32 v188, v188, v189
  buffer_store_dwordx4 v[128:131], v0, s[68:71], s91 offen sc1
  v_mfma_f32_32x32x16_bf16 v[72:87], v[108:111], a[152:155], v[72:87]
  v_add_f32_dpp v188, v188, v188 row_ror:8 row_mask:0xf bank_mask:0xf
  s_nop 1
  v_add_f32_dpp v188, v188, v188 row_ror:4 row_mask:0xf bank_mask:0xf
  s_nop 1
  v_add_f32_dpp v188, v188, v188 row_ror:2 row_mask:0xf bank_mask:0xf
  s_nop 1
  v_add_f32_dpp v188, v188, v188 row_ror:1 row_mask:0xf bank_mask:0xf
  v_mov_b32 v189, v188
  s_nop 0
  s_nop 0
  v_permlane16_swap_b32 v188, v189
  v_mfma_f32_32x32x16_bf16 v[88:103], v[108:111], a[156:159], v[88:103]
  v_add_f32 v188, v188, v189
  v_mov_b32 v189, v188
  s_nop 0
  s_nop 0
  v_permlane32_swap_b32 v188, v189
  v_add_f32 v188, v188, v189
  s_waitcnt lgkmcnt(2)
  v_mfma_f32_32x32x16_bf16 v[40:55], v[112:115], a[160:163], v[40:55]
  v_cvt_pk_bf16_f32 v188, 0, v188
  v_ashrrev_i32 v189, 31, v188
  v_or_b32 v189, 0x80000000, v189
  v_xor_b32 v188, v188, v189
  s_sub_u32 s92, 4095, s90
  v_and_b32 v188, 0xffff0000, v188
  v_mfma_f32_32x32x16_bf16 v[56:71], v[112:115], a[164:167], v[56:71]
  ds_read_b128 v[108:111], v3 offset:10752
  v_or_b32 v38, s92, v188
  s_bfe_u32 s92, s65, 196625
  s_lshl_b32 s92, s92, 18
  s_lshl_b32 s93, s90, 7
  s_add_u32 s92, s92, s93
  v_mfma_f32_32x32x16_bf16 v[72:87], v[112:115], a[168:171], v[72:87]
  s_add_u32 s84, s92, 243269632
  v_mfma_f32_32x32x16_bf16 v[88:103], v[112:115], a[172:175], v[88:103]
  s_waitcnt lgkmcnt(2)
  v_mfma_f32_32x32x16_bf16 v[40:55], v[116:119], a[176:179], v[40:55]
  v_mfma_f32_32x32x16_bf16 v[56:71], v[116:119], a[180:183], v[56:71]
  ds_read_b128 v[112:115], v3 offset:11264
  v_mfma_f32_32x32x16_bf16 v[72:87], v[116:119], a[184:187], v[72:87]
  v_mfma_f32_32x32x16_bf16 v[88:103], v[116:119], a[188:191], v[88:103]
  s_waitcnt lgkmcnt(2)
  v_mfma_f32_32x32x16_bf16 v[40:55], v[104:107], a[192:195], v[40:55]
  v_mfma_f32_32x32x16_bf16 v[56:71], v[104:107], a[196:199], v[56:71]
  ds_read_b128 v[116:119], v3 offset:11776
  s_waitcnt lgkmcnt(2)
  v_mfma_f32_32x32x16_bf16 v[40:55], v[108:111], a[208:211], v[40:55]
  v_mfma_f32_32x32x16_bf16 v[56:71], v[108:111], a[212:215], v[56:71]
  s_waitcnt lgkmcnt(1)
  v_mfma_f32_32x32x16_bf16 v[40:55], v[112:115], a[224:227], v[40:55]
  v_mfma_f32_32x32x16_bf16 v[56:71], v[112:115], a[228:231], v[56:71]
  s_waitcnt lgkmcnt(0)
  v_mfma_f32_32x32x16_bf16 v[40:55], v[116:119], a[240:243], v[40:55]
  v_mfma_f32_32x32x16_bf16 v[56:71], v[116:119], a[244:247], v[56:71]
  v_mfma_f32_32x32x16_bf16 v[72:87], v[104:107], a[200:203], v[72:87]
  v_mfma_f32_32x32x16_bf16 v[88:103], v[104:107], a[204:207], v[88:103]
  v_cvt_pk_bf16_f32 v212, v40, v56
  v_cvt_pk_bf16_f32 v214, v41, v57
  v_cvt_pk_bf16_f32 v216, v42, v58
  v_cvt_pk_bf16_f32 v218, v43, v59
  v_permlane16_swap_b32 v212, v214
  v_mfma_f32_32x32x16_bf16 v[72:87], v[108:111], a[216:219], v[72:87]
  v_cvt_pk_bf16_f32 v220, v44, v60
  v_cvt_pk_bf16_f32 v222, v45, v61
  v_permlane16_swap_b32 v216, v218
  v_bfi_b32 v212, v254, s42, v212
  v_cvt_pk_bf16_f32 v224, v46, v62
  v_mfma_f32_32x32x16_bf16 v[88:103], v[108:111], a[220:223], v[88:103]
  v_cvt_pk_bf16_f32 v226, v47, v63
  v_permlane16_swap_b32 v220, v222
  v_bfi_b32 v216, v254, s42, v216
  v_cvt_pk_bf16_f32 v228, v48, v64
  v_mfma_f32_32x32x16_bf16 v[72:87], v[112:115], a[232:235], v[72:87]
  v_cvt_pk_bf16_f32 v230, v49, v65
  v_permlane16_swap_b32 v224, v226
  v_bfi_b32 v220, v254, s42, v220
  v_cvt_pk_bf16_f32 v232, v50, v66
  v_cvt_pk_bf16_f32 v234, v51, v67
  v_mfma_f32_32x32x16_bf16 v[88:103], v[112:115], a[236:239], v[88:103]
  v_permlane16_swap_b32 v228, v230
  v_bfi_b32 v224, v254, s42, v224
  v_cvt_pk_bf16_f32 v236, v52, v68
  v_cvt_pk_bf16_f32 v238, v53, v69
  v_mfma_f32_32x32x16_bf16 v[72:87], v[116:119], a[248:251], v[72:87]
  v_permlane16_swap_b32 v232, v234
  v_bfi_b32 v228, v254, s42, v228
  v_cvt_pk_bf16_f32 v240, v54, v70
  v_cvt_pk_bf16_f32 v242, v55, v71
  v_permlane16_swap_b32 v236, v238
  v_mfma_f32_32x32x16_bf16 v[88:103], v[116:119], a[252:255], v[88:103]
  v_bfi_b32 v232, v254, s42, v232
  v_permlane16_swap_b32 v240, v242
  v_bfi_b32 v236, v254, s42, v236
  v_bfi_b32 v240, v254, s42, v240
  s_nop 7
  v_cvt_pk_bf16_f32 v213, v72, v88
  v_cvt_pk_bf16_f32 v215, v73, v89
  v_cvt_pk_bf16_f32 v217, v74, v90
  v_cvt_pk_bf16_f32 v219, v75, v91
  s_add_u32 s78, s86, 0
  v_permlane16_swap_b32 v213, v215
  buffer_store_dwordx4 v[212:215], v4, s[4:7], s78 offen
  v_cvt_pk_bf16_f32 v221, v76, v92
  v_cvt_pk_bf16_f32 v223, v77, v93
  s_add_u32 s78, s86, 32768
  v_permlane16_swap_b32 v217, v219
  buffer_store_dwordx4 v[216:219], v4, s[4:7], s78 offen
  v_cvt_pk_bf16_f32 v225, v78, v94
  v_cvt_pk_bf16_f32 v227, v79, v95
  s_add_u32 s78, s86, 131072
  v_permlane16_swap_b32 v221, v223
  buffer_store_dwordx4 v[220:223], v4, s[4:7], s78 offen
  v_cvt_pk_bf16_f32 v229, v80, v96
  v_cvt_pk_bf16_f32 v231, v81, v97
  s_add_u32 s78, s86, 163840
  v_permlane16_swap_b32 v225, v227
  buffer_store_dwordx4 v[224:227], v4, s[4:7], s78 offen
  v_cvt_pk_bf16_f32 v233, v82, v98
  v_cvt_pk_bf16_f32 v235, v83, v99
  s_add_u32 s78, s86, 262144
  v_permlane16_swap_b32 v229, v231
  buffer_store_dwordx4 v[228:231], v4, s[4:7], s78 offen
  v_cvt_pk_bf16_f32 v237, v84, v100
  v_cvt_pk_bf16_f32 v239, v85, v101
  s_add_u32 s78, s86, 294912
  v_permlane16_swap_b32 v233, v235
  buffer_store_dwordx4 v[232:235], v4, s[4:7], s78 offen
  v_cvt_pk_bf16_f32 v241, v86, v102
  v_cvt_pk_bf16_f32 v243, v87, v103
  s_add_u32 s78, s86, 393216
  v_permlane16_swap_b32 v237, v239
  buffer_store_dwordx4 v[236:239], v4, s[4:7], s78 offen
  s_add_u32 s78, s86, 425984
  v_permlane16_swap_b32 v241, v243
  buffer_store_dwordx4 v[240:243], v4, s[4:7], s78 offen
o_we_155:
  v_and_b32 v37, -32, v39
  s_waitcnt lgkmcnt(0)
  s_barrier
  ds_read_b128 v[104:107], v37 offset:16
  s_mov_b32 s65, s63
  s_waitcnt lgkmcnt(0)
  v_and_b32 v104, v104, v106
  v_max_u32 v105, v105, v107
  v_readfirstlane_b32 s26, v104
  v_readfirstlane_b32 s3, v105
  s_and_b32 s66, s26, 1
  s_and_b32 s76, s26, 2
  s_bitcmp1_b32 s26, 2
  s_cselect_b32 s3, s3, 0
  s_cmp_lg_u32 s76, 0
  s_cbranch_scc1 o_nofl_129
  s_and_b32 s26, s63, 49152
  s_cbranch_scc0 o_fl_130
  s_and_b32 s26, s64, s50
  s_cbranch_scc1 o_nofl_129
o_fl_130:
  s_cmp_ge_u32 s17, 2
  s_cbranch_scc1 o_fd_169
  s_cmp_eq_u32 s65, 0
  s_cbranch_scc1 o_fd_169
  s_mov_b32 s96, s42
  s_lshl_b32 s97, s43, 14
  s_add_u32 s97, s97, s86
  buffer_load_dword v7, v255, s[4:7], s97 offen sc1
  s_and_b32 s91, s65, 63
  s_lshl_b32 s90, s91, 5
  s_add_u32 s94, s90, s85
  s_add_u32 s90, s90, s43
  s_lshl_b32 s94, s94, 10
  s_lshr_b32 s92, s65, 22
  s_xor_b32 s93, s43, 32
  s_lshl_b32 s91, s90, 10
  s_add_u32 s94, s94, 25165824
  s_cmp_eq_u32 s92, s93
  s_cselect_b32 s92, s94, s91
  s_add_u32 s92, s92, 10485760
  s_and_b32 s93, s65, 49152
  s_cselect_b32 s92, s92, s91
  s_cselect_b64 s[80:81], s[4:5], s[72:73]
  s_cselect_b32 s82, s6, s74
  buffer_load_dwordx4 v[184:187], v0, s[80:83], s92 offen sc1
  s_mov_b32 s67, 0
  s_mov_b64 vcc, 0
  s_waitcnt vmcnt(1)
o_pl_171:
  v_and_b32 v7, 1, v7
  v_cmp_ne_u32 vcc, s96, v7
  s_cbranch_vccz o_pk_172
  s_mov_b64 exec, 1
  buffer_store_dword v38, off, s[4:7], s84 sc1
  s_mov_b64 exec, -1
  s_mov_b32 s84, 268435456
  buffer_load_dword v7, v255, s[4:7], s97 offen sc1
  s_add_u32 s67, s67, 1
  s_cmp_gt_u32 s67, 1048576
  s_cbranch_scc1 L_end
  s_waitcnt vmcnt(0)
  s_branch o_pl_171
o_pk_172:
  s_and_b32 s26, s65, 49152
  s_cbranch_scc1 o_f2_170
  s_lshl_b32 s94, s43, 14
  s_add_u32 s94, s94, s86
  buffer_load_dwordx4 v[120:123], v5, s[4:7], s94 offen offset:0 sc1
  buffer_load_dwordx4 v[124:127], v5, s[4:7], s94 offen offset:512 sc1
  buffer_load_dwordx4 v[128:131], v5, s[4:7], s94 offen offset:256 sc1
  buffer_load_dwordx4 v[132:135], v5, s[4:7], s94 offen offset:768 sc1
  s_add_u32 s94, s94, 4096
  buffer_load_dwordx4 v[136:139], v5, s[4:7], s94 offen offset:0 sc1
  buffer_load_dwordx4 v[140:143], v5, s[4:7], s94 offen offset:512 sc1
  buffer_load_dwordx4 v[144:147], v5, s[4:7], s94 offen offset:256 sc1
  buffer_load_dwordx4 v[148:151], v5, s[4:7], s94 offen offset:768 sc1
  s_add_u32 s94, s94, 4096
  buffer_load_dwordx4 v[152:155], v5, s[4:7], s94 offen offset:0 sc1
  buffer_load_dwordx4 v[156:159], v5, s[4:7], s94 offen offset:512 sc1
  buffer_load_dwordx4 v[160:163], v5, s[4:7], s94 offen offset:256 sc1
  buffer_load_dwordx4 v[164:167], v5, s[4:7], s94 offen offset:768 sc1
  s_add_u32 s94, s94, 4096
  buffer_load_dwordx4 v[168:171], v5, s[4:7], s94 offen offset:0 sc1
  buffer_load_dwordx4 v[172:175], v5, s[4:7], s94 offen offset:512 sc1
  buffer_load_dwordx4 v[176:179], v5, s[4:7], s94 offen offset:256 sc1
  buffer_load_dwordx4 v[180:183], v5, s[4:7], s94 offen offset:768 sc1
  s_mov_b64 exec, 1
  buffer_store_dword v38, off, s[4:7], s84 sc1
  s_mov_b64 exec, -1
  s_mov_b32 s84, 268435456
  v_mov_b64 v[188:189], 0
  v_mov_b64 v[190:191], 0
  v_mov_b64 v[192:193], 0
  v_mov_b64 v[194:195], 0
  s_waitcnt vmcnt(13)
  v_xor_b32 v7, s96, v120
  v_bitop3_b32 v7, v7, v124, s96 bitop3:0xf6
  v_bitop3_b32 v7, v7, v128, s96 bitop3:0xf6
  v_bitop3_b32 v7, v7, v132, s96 bitop3:0xf6
  s_waitcnt vmcnt(9)
  v_bitop3_b32 v7, v7, v136, s96 bitop3:0xf6
  v_bitop3_b32 v7, v7, v140, s96 bitop3:0xf6
  v_bitop3_b32 v7, v7, v144, s96 bitop3:0xf6
  v_bitop3_b32 v7, v7, v148, s96 bitop3:0xf6
  s_waitcnt vmcnt(5)
  v_bitop3_b32 v7, v7, v152, s96 bitop3:0xf6
  v_bitop3_b32 v7, v7, v156, s96 bitop3:0xf6
  v_bitop3_b32 v7, v7, v160, s96 bitop3:0xf6
  v_bitop3_b32 v7, v7, v164, s96 bitop3:0xf6
  s_waitcnt vmcnt(1)
  v_bitop3_b32 v7, v7, v168, s96 bitop3:0xf6
  v_bitop3_b32 v7, v7, v172, s96 bitop3:0xf6
  v_bitop3_b32 v7, v7, v176, s96 bitop3:0xf6
  v_bitop3_b32 v7, v7, v180, s96 bitop3:0xf6
  v_and_b32 v7, v254, v7
  v_cmp_ne_u32 vcc, 0, v7
  s_cbranch_vccnz o_rt_173
o_bk_174:
  v_smfmac_f32_16x16x64_bf16 v[188:191], v[16:19], v[120:127], v20
  v_lshlrev_b32 v196, 16, v184
  v_smfmac_f32_16x16x64_bf16 v[192:195], v[16:19], v[128:135], v20
  v_and_b32 v197, 0xffff0000, v184
  v_smfmac_f32_16x16x64_bf16 v[188:191], v[16:19], v[136:143], v20
  v_lshlrev_b32 v198, 16, v185
  v_smfmac_f32_16x16x64_bf16 v[192:195], v[16:19], v[144:151], v20
  v_and_b32 v199, 0xffff0000, v185
  v_smfmac_f32_16x16x64_bf16 v[188:191], v[16:19], v[152:159], v20
  v_lshlrev_b32 v200, 16, v186
  v_smfmac_f32_16x16x64_bf16 v[192:195], v[16:19], v[160:167], v20
  v_and_b32 v201, 0xffff0000, v186
  v_smfmac_f32_16x16x64_bf16 v[188:191], v[16:19], v[168:175], v20
  v_lshlrev_b32 v202, 16, v187
  v_smfmac_f32_16x16x64_bf16 v[192:195], v[16:19], v[176:183], v20
  v_and_b32 v203, 0xffff0000, v187
  s_bfe_u32 s92, s65, 131086
  s_lshl_b32 s92, s92, 21
  s_add_u32 s92, s92, s91
  s_add_u32 s93, s92, 27262976
  s_add_u32 s92, s92, 20971520
  s_nop 1
  v_permlane16_swap_b32 v188, v192
  v_permlane16_swap_b32 v189, v193
  v_permlane16_swap_b32 v190, v194
  v_permlane16_swap_b32 v191, v195
  v_cvt_pk_bf16_f32 v188, 0, v188
  v_cvt_pk_bf16_f32 v189, 0, v189
  v_cvt_pk_bf16_f32 v190, 0, v190
  v_cvt_pk_bf16_f32 v191, 0, v191
  v_cvt_pk_bf16_f32 v192, 0, v192
  v_cvt_pk_bf16_f32 v193, 0, v193
  v_cvt_pk_bf16_f32 v194, 0, v194
  v_cvt_pk_bf16_f32 v195, 0, v195
  v_add_f32 v196, v196, v188
  v_add_f32 v197, v197, v189
  v_add_f32 v198, v198, v190
  v_add_f32 v199, v199, v191
  v_add_f32 v200, v200, v192
  v_add_f32 v201, v201, v193
  v_add_f32 v202, v202, v194
  v_add_f32 v203, v203, v195
  v_cvt_pk_bf16_f32 v120, v196, v197
  v_cvt_pk_bf16_f32 v121, v198, v199
  v_cvt_pk_bf16_f32 v122, v200, v201
  v_cvt_pk_bf16_f32 v123, v202, v203
  v_lshlrev_b32 v196, 16, v120
  v_and_b32 v197, 0xffff0000, v120
  v_lshlrev_b32 v198, 16, v121
  v_and_b32 v199, 0xffff0000, v121
  v_lshlrev_b32 v200, 16, v122
  v_and_b32 v201, 0xffff0000, v122
  v_lshlrev_b32 v202, 16, v123
  v_and_b32 v203, 0xffff0000, v123
  buffer_store_dwordx4 v[120:123], v0, s[4:7], s92 offen sc1
  v_add_f32 v136, v196, v197
  v_mul_f32 v137, v196, v196
  v_add_f32 v138, v198, v199
  v_mul_f32 v139, v197, v197
  v_fmac_f32 v137, v198, v198
  v_fmac_f32 v139, v199, v199
  v_add_f32 v136, v136, v200
  v_fmac_f32 v137, v200, v200
  v_add_f32 v138, v138, v201
  v_fmac_f32 v139, v201, v201
  v_add_f32 v136, v136, v202
  v_fmac_f32 v137, v202, v202
  v_add_f32 v138, v138, v203
  v_fmac_f32 v139, v203, v203
  v_add_f32 v136, v136, v138
  v_add_f32 v137, v137, v139
  s_nop 0
  v_add_f32_dpp v136, v136, v136 row_ror:8 row_mask:0xf bank_mask:0xf
  v_add_f32_dpp v137, v137, v137 row_ror:8 row_mask:0xf bank_mask:0xf
  s_nop 0
  v_add_f32_dpp v136, v136, v136 row_ror:4 row_mask:0xf bank_mask:0xf
  v_add_f32_dpp v137, v137, v137 row_ror:4 row_mask:0xf bank_mask:0xf
  s_nop 0
  v_add_f32_dpp v136, v136, v136 row_ror:2 row_mask:0xf bank_mask:0xf
  v_add_f32_dpp v137, v137, v137 row_ror:2 row_mask:0xf bank_mask:0xf
  s_nop 0
  v_add_f32_dpp v136, v136, v136 row_ror:1 row_mask:0xf bank_mask:0xf
  v_add_f32_dpp v137, v137, v137 row_ror:1 row_mask:0xf bank_mask:0xf
  v_mov_b32 v140, v136
  v_mov_b32 v141, v137
  s_nop 0
  v_permlane16_swap_b32 v136, v140
  v_permlane16_swap_b32 v137, v141
  v_add_f32 v136, v136, v140
  v_add_f32 v137, v137, v141
  v_mov_b32 v140, v136
  v_mov_b32 v141, v137
  s_nop 0
  v_permlane32_swap_b32 v136, v140
  v_permlane32_swap_b32 v137, v141
  v_add_f32 v136, v136, v140
  v_add_f32 v137, v137, v141
  v_mul_f32 v136, 0x3b000000, v136
  v_mul_f32 v137, 0x3b000000, v137
  v_fma_f32 v137, -v136, v136, v137
  v_cvt_pk_bf16_f32 v136, 0, v136
  v_max_f32 v137, 0, v137
  v_sub_f32 v140, v196, v136
  v_sub_f32 v141, v197, v136
  v_cvt_pk_bf16_f32 v137, 0, v137
  v_sub_f32 v142, v198, v136
  v_sub_f32 v143, v199, v136
  v_add_f32 v137, 0x3727c5ac, v137
  v_sub_f32 v144, v200, v136
  v_sub_f32 v145, v201, v136
  v_cvt_pk_bf16_f32 v137, 0, v137
  v_sub_f32 v146, v202, v136
  v_sub_f32 v147, v203, v136
  v_sqrt_f32 v137, v137
  v_cvt_pk_bf16_f32 v140, 0, v140
  v_cvt_pk_bf16_f32 v141, 0, v141
  v_cvt_pk_bf16_f32 v137, 0, v137
  v_cvt_pk_bf16_f32 v142, 0, v142
  v_cvt_pk_bf16_f32 v143, 0, v143
  v_rcp_f32 v137, v137
  v_cvt_pk_bf16_f32 v144, 0, v144
  v_cvt_pk_bf16_f32 v145, 0, v145
  v_cvt_pk_bf16_f32 v146, 0, v146
  v_cvt_pk_bf16_f32 v147, 0, v147
  v_mul_f32 v140, v140, v137
  v_mul_f32 v141, v141, v137
  v_mul_f32 v142, v142, v137
  v_mul_f32 v143, v143, v137
  v_mul_f32 v144, v144, v137
  v_mul_f32 v145, v145, v137
  v_mul_f32 v146, v146, v137
  v_mul_f32 v147, v147, v137
  v_cvt_pk_bf16_f32 v124, v140, v141
  v_cvt_pk_bf16_f32 v125, v142, v143
  v_cvt_pk_bf16_f32 v126, v144, v145
  v_cvt_pk_bf16_f32 v127, v146, v147
  v_lshlrev_b32 v204, 16, v124
  v_and_b32 v205, 0xffff0000, v124
  v_lshlrev_b32 v206, 16, v125
  v_and_b32 v207, 0xffff0000, v125
  v_lshlrev_b32 v208, 16, v126
  v_and_b32 v209, 0xffff0000, v126
  v_lshlrev_b32 v210, 16, v127
  v_and_b32 v211, 0xffff0000, v127
  buffer_store_dwordx4 v[124:127], v0, s[4:7], s93 offen sc1
  v_add_f32 v196, v196, v204
  v_add_f32 v197, v197, v205
  v_add_f32 v198, v198, v206
  v_add_f32 v199, v199, v207
  v_add_f32 v200, v200, v208
  v_add_f32 v201, v201, v209
  v_add_f32 v202, v202, v210
  v_add_f32 v203, v203, v211
  v_cvt_pk_bf16_f32 v128, v196, v197
  v_cvt_pk_bf16_f32 v129, v198, v199
  v_cvt_pk_bf16_f32 v130, v200, v201
  v_cvt_pk_bf16_f32 v131, v202, v203
  v_mul_f32 v188, v204, v8
  v_mul_f32 v189, v205, v9
  v_fmac_f32 v188, v206, v10
  v_fmac_f32 v189, v207, v11
  v_fmac_f32 v188, v208, v12
  v_fmac_f32 v189, v209, v13
  v_fmac_f32 v188, v210, v14
  v_fmac_f32 v189, v211, v15
  v_add_f32 v188, v188, v189
  s_add_u32 s92, s91, 10485760
  s_add_u32 s93, s91, 8388608
  buffer_store_dwordx4 v[128:131], v0, s[4:7], s92 offen sc1
  v_lshlrev_b32 v196, 16, v128
  v_and_b32 v197, 0xffff0000, v128
  v_lshlrev_b32 v198, 16, v129
  v_and_b32 v199, 0xffff0000, v129
  v_lshlrev_b32 v200, 16, v130
  v_and_b32 v201, 0xffff0000, v130
  v_lshlrev_b32 v202, 16, v131
  v_and_b32 v203, 0xffff0000, v131
  v_add_f32 v136, v196, v197
  v_mul_f32 v137, v196, v196
  v_add_f32 v138, v198, v199
  v_mul_f32 v139, v197, v197
  v_fmac_f32 v137, v198, v198
  v_fmac_f32 v139, v199, v199
  v_add_f32 v136, v136, v200
  v_fmac_f32 v137, v200, v200
  v_add_f32 v138, v138, v201
  v_fmac_f32 v139, v201, v201
  v_add_f32 v136, v136, v202
  v_fmac_f32 v137, v202, v202
  v_add_f32 v138, v138, v203
  v_fmac_f32 v139, v203, v203
  v_add_f32 v136, v136, v138
  v_add_f32 v137, v137, v139
  s_nop 0
  v_add_f32_dpp v136, v136, v136 row_ror:8 row_mask:0xf bank_mask:0xf
  v_add_f32_dpp v137, v137, v137 row_ror:8 row_mask:0xf bank_mask:0xf
  v_add_f32_dpp v188, v188, v188 row_ror:8 row_mask:0xf bank_mask:0xf
  v_add_f32_dpp v136, v136, v136 row_ror:4 row_mask:0xf bank_mask:0xf
  v_add_f32_dpp v137, v137, v137 row_ror:4 row_mask:0xf bank_mask:0xf
  v_add_f32_dpp v188, v188, v188 row_ror:4 row_mask:0xf bank_mask:0xf
  v_add_f32_dpp v136, v136, v136 row_ror:2 row_mask:0xf bank_mask:0xf
  v_add_f32_dpp v137, v137, v137 row_ror:2 row_mask:0xf bank_mask:0xf
  v_add_f32_dpp v188, v188, v188 row_ror:2 row_mask:0xf bank_mask:0xf
  v_add_f32_dpp v136, v136, v136 row_ror:1 row_mask:0xf bank_mask:0xf
  v_add_f32_dpp v137, v137, v137 row_ror:1 row_mask:0xf bank_mask:0xf
  v_add_f32_dpp v188, v188, v188 row_ror:1 row_mask:0xf bank_mask:0xf
  v_mov_b32 v140, v136
  v_mov_b32 v141, v137
  v_mov_b32 v142, v188
  v_permlane16_swap_b32 v136, v140
  v_permlane16_swap_b32 v137, v141
  v_permlane16_swap_b32 v188, v142
  v_add_f32 v136, v136, v140
  v_add_f32 v137, v137, v141
  v_add_f32 v188, v188, v142
  v_mov_b32 v140, v136
  v_mov_b32 v141, v137
  v_mov_b32 v142, v188
  v_permlane32_swap_b32 v136, v140
  v_permlane32_swap_b32 v137, v141
  v_permlane32_swap_b32 v188, v142
  v_add_f32 v136, v136, v140
  v_add_f32 v137, v137, v141
  v_add_f32 v188, v188, v142
  v_mul_f32 v136, 0x3b000000, v136
  v_mul_f32 v137, 0x3b000000, v137
  v_fma_f32 v137, -v136, v136, v137
  v_cvt_pk_bf16_f32 v136, 0, v136
  v_max_f32 v137, 0, v137
  v_sub_f32 v140, v196, v136
  v_sub_f32 v141, v197, v136
  v_cvt_pk_bf16_f32 v137, 0, v137
  v_sub_f32 v142, v198, v136
  v_sub_f32 v143, v199, v136
  v_add_f32 v137, 0x3727c5ac, v137
  v_sub_f32 v144, v200, v136
  v_sub_f32 v145, v201, v136
  v_cvt_pk_bf16_f32 v137, 0, v137
  v_sub_f32 v146, v202, v136
  v_sub_f32 v147, v203, v136
  v_sqrt_f32 v137, v137
  v_cvt_pk_bf16_f32 v140, 0, v140
  v_cvt_pk_bf16_f32 v141, 0, v141
  v_cvt_pk_bf16_f32 v137, 0, v137
  v_cvt_pk_bf16_f32 v142, 0, v142
  v_cvt_pk_bf16_f32 v143, 0, v143
  v_rcp_f32 v137, v137
  v_cvt_pk_bf16_f32 v144, 0, v144
  v_cvt_pk_bf16_f32 v145, 0, v145
  v_cvt_pk_bf16_f32 v146, 0, v146
  v_cvt_pk_bf16_f32 v147, 0, v147
  v_mul_f32 v140, v140, v137
  v_mul_f32 v141, v141, v137
  v_mul_f32 v142, v142, v137
  v_mul_f32 v143, v143, v137
  v_mul_f32 v144, v144, v137
  v_mul_f32 v145, v145, v137
  v_mul_f32 v146, v146, v137
  v_mul_f32 v147, v147, v137
  v_cvt_pk_bf16_f32 v132, v140, v141
  v_cvt_pk_bf16_f32 v133, v142, v143
  v_cvt_pk_bf16_f32 v134, v144, v145
  v_cvt_pk_bf16_f32 v135, v146, v147
  buffer_store_dwordx4 v[132:135], v0, s[4:7], s93 offen sc1
  v_cvt_pk_bf16_f32 v188, 0, v188
  v_ashrrev_i32 v189, 31, v188
  v_or_b32 v189, 0x80000000, v189
  v_xor_b32 v188, v188, v189
  s_sub_u32 s92, 4095, s90
  v_and_b32 v188, 0xffff0000, v188
  v_or_b32 v38, s92, v188
  s_bfe_u32 s92, s65, 196625
  s_lshl_b32 s92, s92, 18
  s_lshl_b32 s93, s90, 7
  s_add_u32 s92, s92, s93
  s_add_u32 s84, s92, 243269632
  s_waitcnt vmcnt(0)
  s_mov_b64 exec, 1
  buffer_store_dword v38, off, s[4:7], s84 sc1
  s_mov_b64 exec, -1
  s_mov_b32 s84, 268435456
  s_branch o_fd_169
o_rt_173:
  s_mov_b32 s67, 0
o_rl_175:
  s_lshl_b32 s94, s43, 14
  s_add_u32 s94, s94, s86
  buffer_load_dwordx4 v[120:123], v5, s[4:7], s94 offen offset:0 sc1
  buffer_load_dwordx4 v[124:127], v5, s[4:7], s94 offen offset:512 sc1
  buffer_load_dwordx4 v[128:131], v5, s[4:7], s94 offen offset:256 sc1
  buffer_load_dwordx4 v[132:135], v5, s[4:7], s94 offen offset:768 sc1
  s_add_u32 s94, s94, 4096
  buffer_load_dwordx4 v[136:139], v5, s[4:7], s94 offen offset:0 sc1
  buffer_load_dwordx4 v[140:143], v5, s[4:7], s94 offen offset:512 sc1
  buffer_load_dwordx4 v[144:147], v5, s[4:7], s94 offen offset:256 sc1
  buffer_load_dwordx4 v[148:151], v5, s[4:7], s94 offen offset:768 sc1
  s_add_u32 s94, s94, 4096
  buffer_load_dwordx4 v[152:155], v5, s[4:7], s94 offen offset:0 sc1
  buffer_load_dwordx4 v[156:159], v5, s[4:7], s94 offen offset:512 sc1
  buffer_load_dwordx4 v[160:163], v5, s[4:7], s94 offen offset:256 sc1
  buffer_load_dwordx4 v[164:167], v5, s[4:7], s94 offen offset:768 sc1
  s_add_u32 s94, s94, 4096
  buffer_load_dwordx4 v[168:171], v5, s[4:7], s94 offen offset:0 sc1
  buffer_load_dwordx4 v[172:175], v5, s[4:7], s94 offen offset:512 sc1
  buffer_load_dwordx4 v[176:179], v5, s[4:7], s94 offen offset:256 sc1
  buffer_load_dwordx4 v[180:183], v5, s[4:7], s94 offen offset:768 sc1
  s_add_u32 s67, s67, 1
  s_cmp_gt_u32 s67, 1048576
  s_cbranch_scc1 L_end
  s_waitcnt vmcnt(0)
  v_xor_b32 v7, s96, v120
  v_bitop3_b32 v7, v7, v124, s96 bitop3:0xf6
  v_bitop3_b32 v7, v7, v128, s96 bitop3:0xf6
  v_bitop3_b32 v7, v7, v132, s96 bitop3:0xf6
  v_bitop3_b32 v7, v7, v136, s96 bitop3:0xf6
  v_bitop3_b32 v7, v7, v140, s96 bitop3:0xf6
  v_bitop3_b32 v7, v7, v144, s96 bitop3:0xf6
  v_bitop3_b32 v7, v7, v148, s96 bitop3:0xf6
  v_bitop3_b32 v7, v7, v152, s96 bitop3:0xf6
  v_bitop3_b32 v7, v7, v156, s96 bitop3:0xf6
  v_bitop3_b32 v7, v7, v160, s96 bitop3:0xf6
  v_bitop3_b32 v7, v7, v164, s96 bitop3:0xf6
  v_bitop3_b32 v7, v7, v168, s96 bitop3:0xf6
  v_bitop3_b32 v7, v7, v172, s96 bitop3:0xf6
  v_bitop3_b32 v7, v7, v176, s96 bitop3:0xf6
  v_bitop3_b32 v7, v7, v180, s96 bitop3:0xf6
  v_and_b32 v7, v254, v7
  v_cmp_ne_u32 vcc, 0, v7
  s_cbranch_vccnz o_rl_175
  s_branch o_bk_174
o_f2_170:
  s_lshl_b32 s94, s43, 14
  s_add_u32 s94, s94, s86
  buffer_load_dwordx4 v[120:123], v5, s[4:7], s94 offen offset:0 sc1
  buffer_load_dwordx4 v[124:127], v5, s[4:7], s94 offen offset:512 sc1
  buffer_load_dwordx4 v[128:131], v5, s[4:7], s94 offen offset:256 sc1
  buffer_load_dwordx4 v[132:135], v5, s[4:7], s94 offen offset:768 sc1
  s_add_u32 s94, s94, 4096
  buffer_load_dwordx4 v[136:139], v5, s[4:7], s94 offen offset:0 sc1
  buffer_load_dwordx4 v[140:143], v5, s[4:7], s94 offen offset:512 sc1
  buffer_load_dwordx4 v[144:147], v5, s[4:7], s94 offen offset:256 sc1
  buffer_load_dwordx4 v[148:151], v5, s[4:7], s94 offen offset:768 sc1
  s_add_u32 s94, s94, 4096
  buffer_load_dwordx4 v[152:155], v5, s[4:7], s94 offen offset:0 sc1
  buffer_load_dwordx4 v[156:159], v5, s[4:7], s94 offen offset:512 sc1
  buffer_load_dwordx4 v[160:163], v5, s[4:7], s94 offen offset:256 sc1
  buffer_load_dwordx4 v[164:167], v5, s[4:7], s94 offen offset:768 sc1
  s_add_u32 s94, s94, 4096
  buffer_load_dwordx4 v[168:171], v5, s[4:7], s94 offen offset:0 sc1
  buffer_load_dwordx4 v[172:175], v5, s[4:7], s94 offen offset:512 sc1
  buffer_load_dwordx4 v[176:179], v5, s[4:7], s94 offen offset:256 sc1
  buffer_load_dwordx4 v[180:183], v5, s[4:7], s94 offen offset:768 sc1
  s_mov_b64 exec, 1
  buffer_store_dword v38, off, s[4:7], s84 sc1
  s_mov_b64 exec, -1
  s_mov_b32 s84, 268435456
  v_mov_b64 v[188:189], 0
  v_mov_b64 v[190:191], 0
  v_mov_b64 v[192:193], 0
  v_mov_b64 v[194:195], 0
  s_waitcnt vmcnt(13)
  v_xor_b32 v7, s96, v120
  v_bitop3_b32 v7, v7, v124, s96 bitop3:0xf6
  v_bitop3_b32 v7, v7, v128, s96 bitop3:0xf6
  v_bitop3_b32 v7, v7, v132, s96 bitop3:0xf6
  s_waitcnt vmcnt(9)
  v_bitop3_b32 v7, v7, v136, s96 bitop3:0xf6
  v_bitop3_b32 v7, v7, v140, s96 bitop3:0xf6
  v_bitop3_b32 v7, v7, v144, s96 bitop3:0xf6
  v_bitop3_b32 v7, v7, v148, s96 bitop3:0xf6
  s_waitcnt vmcnt(5)
  v_bitop3_b32 v7, v7, v152, s96 bitop3:0xf6
  v_bitop3_b32 v7, v7, v156, s96 bitop3:0xf6
  v_bitop3_b32 v7, v7, v160, s96 bitop3:0xf6
  v_bitop3_b32 v7, v7, v164, s96 bitop3:0xf6
  s_waitcnt vmcnt(1)
  v_bitop3_b32 v7, v7, v168, s96 bitop3:0xf6
  v_bitop3_b32 v7, v7, v172, s96 bitop3:0xf6
  v_bitop3_b32 v7, v7, v176, s96 bitop3:0xf6
  v_bitop3_b32 v7, v7, v180, s96 bitop3:0xf6
  v_and_b32 v7, v254, v7
  v_cmp_ne_u32 vcc, 0, v7
  s_cbranch_vccnz o_rt_176
o_bk_177:
  v_smfmac_f32_16x16x64_bf16 v[188:191], v[16:19], v[120:127], v20
  v_lshlrev_b32 v196, 16, v184
  v_smfmac_f32_16x16x64_bf16 v[192:195], v[16:19], v[128:135], v20
  v_and_b32 v197, 0xffff0000, v184
  v_smfmac_f32_16x16x64_bf16 v[188:191], v[16:19], v[136:143], v20
  v_lshlrev_b32 v198, 16, v185
  v_smfmac_f32_16x16x64_bf16 v[192:195], v[16:19], v[144:151], v20
  v_and_b32 v199, 0xffff0000, v185
  v_smfmac_f32_16x16x64_bf16 v[188:191], v[16:19], v[152:159], v20
  v_lshlrev_b32 v200, 16, v186
  v_smfmac_f32_16x16x64_bf16 v[192:195], v[16:19], v[160:167], v20
  v_and_b32 v201, 0xffff0000, v186
  v_smfmac_f32_16x16x64_bf16 v[188:191], v[16:19], v[168:175], v20
  v_lshlrev_b32 v202, 16, v187
  v_smfmac_f32_16x16x64_bf16 v[192:195], v[16:19], v[176:183], v20
  v_and_b32 v203, 0xffff0000, v187
  s_bfe_u32 s92, s65, 131086
  s_lshl_b32 s92, s92, 21
  s_add_u32 s92, s92, s91
  s_add_u32 s93, s92, 27262976
  s_add_u32 s92, s92, 20971520
  s_nop 1
  v_permlane16_swap_b32 v188, v192
  v_permlane16_swap_b32 v189, v193
  v_permlane16_swap_b32 v190, v194
  v_permlane16_swap_b32 v191, v195
  v_cvt_pk_bf16_f32 v188, 0, v188
  v_cvt_pk_bf16_f32 v189, 0, v189
  v_cvt_pk_bf16_f32 v190, 0, v190
  v_cvt_pk_bf16_f32 v191, 0, v191
  v_cvt_pk_bf16_f32 v192, 0, v192
  v_cvt_pk_bf16_f32 v193, 0, v193
  v_cvt_pk_bf16_f32 v194, 0, v194
  v_cvt_pk_bf16_f32 v195, 0, v195
  v_add_f32 v196, v196, v188
  v_add_f32 v197, v197, v189
  v_add_f32 v198, v198, v190
  v_add_f32 v199, v199, v191
  v_add_f32 v200, v200, v192
  v_add_f32 v201, v201, v193
  v_add_f32 v202, v202, v194
  v_add_f32 v203, v203, v195
  v_cvt_pk_bf16_f32 v120, v196, v197
  v_cvt_pk_bf16_f32 v121, v198, v199
  v_cvt_pk_bf16_f32 v122, v200, v201
  v_cvt_pk_bf16_f32 v123, v202, v203
  v_lshlrev_b32 v196, 16, v120
  v_and_b32 v197, 0xffff0000, v120
  v_lshlrev_b32 v198, 16, v121
  v_and_b32 v199, 0xffff0000, v121
  v_lshlrev_b32 v200, 16, v122
  v_and_b32 v201, 0xffff0000, v122
  v_lshlrev_b32 v202, 16, v123
  v_and_b32 v203, 0xffff0000, v123
  buffer_store_dwordx4 v[120:123], v0, s[4:7], s92 offen sc1
  v_add_f32 v136, v196, v197
  v_mul_f32 v137, v196, v196
  v_add_f32 v138, v198, v199
  v_mul_f32 v139, v197, v197
  v_fmac_f32 v137, v198, v198
  v_fmac_f32 v139, v199, v199
  v_add_f32 v136, v136, v200
  v_fmac_f32 v137, v200, v200
  v_add_f32 v138, v138, v201
  v_fmac_f32 v139, v201, v201
  v_add_f32 v136, v136, v202
  v_fmac_f32 v137, v202, v202
  v_add_f32 v138, v138, v203
  v_fmac_f32 v139, v203, v203
  v_add_f32 v136, v136, v138
  v_add_f32 v137, v137, v139
  s_nop 0
  v_add_f32_dpp v136, v136, v136 row_ror:8 row_mask:0xf bank_mask:0xf
  v_add_f32_dpp v137, v137, v137 row_ror:8 row_mask:0xf bank_mask:0xf
  s_nop 0
  v_add_f32_dpp v136, v136, v136 row_ror:4 row_mask:0xf bank_mask:0xf
  v_add_f32_dpp v137, v137, v137 row_ror:4 row_mask:0xf bank_mask:0xf
  s_nop 0
  v_add_f32_dpp v136, v136, v136 row_ror:2 row_mask:0xf bank_mask:0xf
  v_add_f32_dpp v137, v137, v137 row_ror:2 row_mask:0xf bank_mask:0xf
  s_nop 0
  v_add_f32_dpp v136, v136, v136 row_ror:1 row_mask:0xf bank_mask:0xf
  v_add_f32_dpp v137, v137, v137 row_ror:1 row_mask:0xf bank_mask:0xf
  v_mov_b32 v140, v136
  v_mov_b32 v141, v137
  s_nop 0
  v_permlane16_swap_b32 v136, v140
  v_permlane16_swap_b32 v137, v141
  v_add_f32 v136, v136, v140
  v_add_f32 v137, v137, v141
  v_mov_b32 v140, v136
  v_mov_b32 v141, v137
  s_nop 0
  v_permlane32_swap_b32 v136, v140
  v_permlane32_swap_b32 v137, v141
  v_add_f32 v136, v136, v140
  v_add_f32 v137, v137, v141
  v_mul_f32 v136, 0x3b000000, v136
  v_mul_f32 v137, 0x3b000000, v137
  v_fma_f32 v137, -v136, v136, v137
  v_cvt_pk_bf16_f32 v136, 0, v136
  v_max_f32 v137, 0, v137
  v_sub_f32 v140, v196, v136
  v_sub_f32 v141, v197, v136
  v_cvt_pk_bf16_f32 v137, 0, v137
  v_sub_f32 v142, v198, v136
  v_sub_f32 v143, v199, v136
  v_add_f32 v137, 0x3727c5ac, v137
  v_sub_f32 v144, v200, v136
  v_sub_f32 v145, v201, v136
  v_cvt_pk_bf16_f32 v137, 0, v137
  v_sub_f32 v146, v202, v136
  v_sub_f32 v147, v203, v136
  v_sqrt_f32 v137, v137
  v_cvt_pk_bf16_f32 v140, 0, v140
  v_cvt_pk_bf16_f32 v141, 0, v141
  v_cvt_pk_bf16_f32 v137, 0, v137
  v_cvt_pk_bf16_f32 v142, 0, v142
  v_cvt_pk_bf16_f32 v143, 0, v143
  v_rcp_f32 v137, v137
  v_cvt_pk_bf16_f32 v144, 0, v144
  v_cvt_pk_bf16_f32 v145, 0, v145
  v_cvt_pk_bf16_f32 v146, 0, v146
  v_cvt_pk_bf16_f32 v147, 0, v147
  v_mul_f32 v140, v140, v137
  v_mul_f32 v141, v141, v137
  v_mul_f32 v142, v142, v137
  v_mul_f32 v143, v143, v137
  v_mul_f32 v144, v144, v137
  v_mul_f32 v145, v145, v137
  v_mul_f32 v146, v146, v137
  v_mul_f32 v147, v147, v137
  v_cvt_pk_bf16_f32 v124, v140, v141
  v_cvt_pk_bf16_f32 v125, v142, v143
  v_cvt_pk_bf16_f32 v126, v144, v145
  v_cvt_pk_bf16_f32 v127, v146, v147
  v_lshlrev_b32 v204, 16, v124
  v_and_b32 v205, 0xffff0000, v124
  v_lshlrev_b32 v206, 16, v125
  v_and_b32 v207, 0xffff0000, v125
  v_lshlrev_b32 v208, 16, v126
  v_and_b32 v209, 0xffff0000, v126
  v_lshlrev_b32 v210, 16, v127
  v_and_b32 v211, 0xffff0000, v127
  buffer_store_dwordx4 v[124:127], v0, s[4:7], s93 offen sc1
  v_add_f32 v196, v196, v204
  v_add_f32 v197, v197, v205
  v_add_f32 v198, v198, v206
  v_add_f32 v199, v199, v207
  v_add_f32 v200, v200, v208
  v_add_f32 v201, v201, v209
  v_add_f32 v202, v202, v210
  v_add_f32 v203, v203, v211
  v_cvt_pk_bf16_f32 v128, v196, v197
  v_cvt_pk_bf16_f32 v129, v198, v199
  v_cvt_pk_bf16_f32 v130, v200, v201
  v_cvt_pk_bf16_f32 v131, v202, v203
  v_mul_f32 v188, v204, v8
  v_mul_f32 v189, v205, v9
  v_fmac_f32 v188, v206, v10
  v_fmac_f32 v189, v207, v11
  v_fmac_f32 v188, v208, v12
  v_fmac_f32 v189, v209, v13
  v_fmac_f32 v188, v210, v14
  v_fmac_f32 v189, v211, v15
  v_add_f32 v188, v188, v189
  buffer_store_dwordx4 v[128:131], v0, s[68:71], s91 offen sc1
  s_nop 0
  v_add_f32_dpp v188, v188, v188 row_ror:8 row_mask:0xf bank_mask:0xf
  s_nop 1
  v_add_f32_dpp v188, v188, v188 row_ror:4 row_mask:0xf bank_mask:0xf
  s_nop 1
  v_add_f32_dpp v188, v188, v188 row_ror:2 row_mask:0xf bank_mask:0xf
  s_nop 1
  v_add_f32_dpp v188, v188, v188 row_ror:1 row_mask:0xf bank_mask:0xf
  v_mov_b32 v189, v188
  s_nop 0
  s_nop 0
  v_permlane16_swap_b32 v188, v189
  v_add_f32 v188, v188, v189
  v_mov_b32 v189, v188
  s_nop 0
  s_nop 0
  v_permlane32_swap_b32 v188, v189
  v_add_f32 v188, v188, v189
  v_cvt_pk_bf16_f32 v188, 0, v188
  v_ashrrev_i32 v189, 31, v188
  v_or_b32 v189, 0x80000000, v189
  v_xor_b32 v188, v188, v189
  s_sub_u32 s92, 4095, s90
  v_and_b32 v188, 0xffff0000, v188
  v_or_b32 v38, s92, v188
  s_bfe_u32 s92, s65, 196625
  s_lshl_b32 s92, s92, 18
  s_lshl_b32 s93, s90, 7
  s_add_u32 s92, s92, s93
  s_add_u32 s84, s92, 243269632
  s_waitcnt vmcnt(0)
  s_mov_b64 exec, 1
  buffer_store_dword v38, off, s[4:7], s84 sc1
  s_mov_b64 exec, -1
  s_mov_b32 s84, 268435456
  s_branch o_fd_169
o_rt_176:
  s_mov_b32 s67, 0
o_rl_178:
  s_lshl_b32 s94, s43, 14
  s_add_u32 s94, s94, s86
  buffer_load_dwordx4 v[120:123], v5, s[4:7], s94 offen offset:0 sc1
  buffer_load_dwordx4 v[124:127], v5, s[4:7], s94 offen offset:512 sc1
  buffer_load_dwordx4 v[128:131], v5, s[4:7], s94 offen offset:256 sc1
  buffer_load_dwordx4 v[132:135], v5, s[4:7], s94 offen offset:768 sc1
  s_add_u32 s94, s94, 4096
  buffer_load_dwordx4 v[136:139], v5, s[4:7], s94 offen offset:0 sc1
  buffer_load_dwordx4 v[140:143], v5, s[4:7], s94 offen offset:512 sc1
  buffer_load_dwordx4 v[144:147], v5, s[4:7], s94 offen offset:256 sc1
  buffer_load_dwordx4 v[148:151], v5, s[4:7], s94 offen offset:768 sc1
  s_add_u32 s94, s94, 4096
  buffer_load_dwordx4 v[152:155], v5, s[4:7], s94 offen offset:0 sc1
  buffer_load_dwordx4 v[156:159], v5, s[4:7], s94 offen offset:512 sc1
  buffer_load_dwordx4 v[160:163], v5, s[4:7], s94 offen offset:256 sc1
  buffer_load_dwordx4 v[164:167], v5, s[4:7], s94 offen offset:768 sc1
  s_add_u32 s94, s94, 4096
  buffer_load_dwordx4 v[168:171], v5, s[4:7], s94 offen offset:0 sc1
  buffer_load_dwordx4 v[172:175], v5, s[4:7], s94 offen offset:512 sc1
  buffer_load_dwordx4 v[176:179], v5, s[4:7], s94 offen offset:256 sc1
  buffer_load_dwordx4 v[180:183], v5, s[4:7], s94 offen offset:768 sc1
  s_add_u32 s67, s67, 1
  s_cmp_gt_u32 s67, 1048576
  s_cbranch_scc1 L_end
  s_waitcnt vmcnt(0)
  v_xor_b32 v7, s96, v120
  v_bitop3_b32 v7, v7, v124, s96 bitop3:0xf6
  v_bitop3_b32 v7, v7, v128, s96 bitop3:0xf6
  v_bitop3_b32 v7, v7, v132, s96 bitop3:0xf6
  v_bitop3_b32 v7, v7, v136, s96 bitop3:0xf6
  v_bitop3_b32 v7, v7, v140, s96 bitop3:0xf6
  v_bitop3_b32 v7, v7, v144, s96 bitop3:0xf6
  v_bitop3_b32 v7, v7, v148, s96 bitop3:0xf6
  v_bitop3_b32 v7, v7, v152, s96 bitop3:0xf6
  v_bitop3_b32 v7, v7, v156, s96 bitop3:0xf6
  v_bitop3_b32 v7, v7, v160, s96 bitop3:0xf6
  v_bitop3_b32 v7, v7, v164, s96 bitop3:0xf6
  v_bitop3_b32 v7, v7, v168, s96 bitop3:0xf6
  v_bitop3_b32 v7, v7, v172, s96 bitop3:0xf6
  v_bitop3_b32 v7, v7, v176, s96 bitop3:0xf6
  v_bitop3_b32 v7, v7, v180, s96 bitop3:0xf6
  v_and_b32 v7, v254, v7
  v_cmp_ne_u32 vcc, 0, v7
  s_cbranch_vccnz o_rl_178
  s_branch o_bk_177
o_fd_169:
  s_mov_b32 s65, 0
o_nofl_129:
  s_mov_b32 s63, s64
  s_cmp_lg_u32 s51, 0
  s_cbranch_scc1 o_pick_131
  s_cmp_eq_u32 s50, 0
  s_cbranch_scc1 o_help_138_n
o_adv_137:
  s_add_u32 s49, s49, 4
  s_branch o_round_127
o_dl_139_a:
  s_andn2_b32 s26, s58, s55
  s_and_b32 s29, s26, s54
  s_bcnt1_i32_b32 s27, s29
  s_add_u32 s27, s27, 2
  s_max_u32 s27, s27, 4
  s_andn2_b32 s26, s26, s56
  s_and_b32 s26, s26, 0x3fff
  s_or_b32 s26, s26, s29
  s_cselect_b32 s27, s27, 0
  s_mul_i32 s27, s27, 0
  s_cmp_ge_u32 s46, s89
  s_cselect_b32 s30, s54, -1
  s_mov_b32 s31, 243269696
  s_branch o_dl_139_b
o_dl_139:
  s_and_b32 s26, s55, s54
  s_andn2_b32 s27, s56, s54
  s_or_b32 s26, s26, s27
  s_andn2_b32 s26, s58, s26
  s_bcnt1_i32_b32 s27, s26
  s_bcnt1_i32_b32 s28, s47
  s_mul_i32 s28, s28, -5
  s_lshl1_add_u32 s27, s27, s28
  s_add_i32 s27, s27, 1
  s_max_i32 s27, s27, 0
  s_mul_i32 s27, s27, 37
  s_mov_b32 s30, s54
  s_mov_b32 s31, 243269704
  s_and_b32 s29, s26, s47
  s_andn2_b32 s26, s26, s29
  s_branch o_dl_139_c
o_dl_139_b:
  s_mov_b32 s29, 0
o_dl_139_c:
  s_bfe_u32 s28, s48, 262144
  s_bitset0_b32 s26, s28
  s_bfe_u32 s28, s48, 262148
  s_bitset0_b32 s26, s28
  s_bfe_u32 s28, s48, 262152
  s_bitset0_b32 s26, s28
  s_bfe_u32 s28, s48, 262156
  s_bitset0_b32 s26, s28
  s_lshr_b32 s27, s27, 8
o_dl1_140:
  s_cbranch_scc0 o_dl2_141
  s_ff1_i32_b32 s28, s26
  s_bitset0_b32 s26, s28
  s_bitset1_b32 s29, s28
  s_sub_u32 s27, s27, 1
  s_cmp_lg_u32 s27, 0
  s_branch o_dl1_140
o_dl2_141:
  s_and_b32 s47, s29, 0xffff
  s_and_b32 s30, s30, s47
  s_or_b32 s55, s55, s30
  s_andn2_b32 s26, s47, s30
  s_or_b32 s56, s56, s26
  s_pack_ll_b32_b16 s26, s47, s30
  s_lshl_b32 s27, s60, 7
  s_add_u32 s27, s27, s31
  s_cmp_lg_u32 s43, 0
  s_cbranch_scc1 o_pick_131
  v_mov_b32 v162, s26
  v_mov_b32 v163, s46
  s_mov_b64 exec, 1
  buffer_store_dwordx2 v[162:163], off, s[4:7], s27 sc1
  s_mov_b64 exec, -1
  s_branch o_pick_131
o_help_138:
  s_lshl_b32 s60, s60, 1
  s_and_b32 s60, s60, 2
  s_lshl_b32 s47, s60, 7
  s_add_u32 s47, s47, 243269688
o_help_138_n:
  s_add_u32 s47, s47, 8
  s_lshr_b32 s26, s47, 4
  s_andn2_b32 s26, s57, s26
  s_cbranch_scc0 L_end
  s_mov_b32 s67, 0
o_help_138_w:
  buffer_load_dwordx2 v[162:163], off, s[4:7], s47 sc1
  buffer_load_dwordx2 v[164:165], off, s[4:7], s47 offset:128 sc1
  s_add_u32 s67, s67, 1
  s_cmp_gt_u32 s67, 1048576
  s_cbranch_scc1 L_end
  s_waitcnt vmcnt(0)
  v_readfirstlane_b32 s28, v162
  v_readfirstlane_b32 s30, v164
  v_readfirstlane_b32 s46, v163
  v_readfirstlane_b32 s27, v165
  s_min_u32 s26, s46, s27
  s_cmp_eq_u32 s26, 0
  s_cbranch_scc1 o_help_138_w
  s_max_u32 s46, s46, s27
  s_bitreplicate_b64_b32 s[28:29], s28
  s_bitreplicate_b64_b32 s[30:31], s30
  s_mov_b32 s26, 0x55555555
  s_mov_b32 s27, 0x55555555
  s_and_b64 s[28:29], s[28:29], s[26:27]
  s_andn2_b64 s[30:31], s[30:31], s[26:27]
  s_or_b32 s58, s28, s30
  s_or_b32 s54, s29, s31
  s_andn2_b32 s52, 0xfff, s46
  s_lshr_b32 s52, s52, 5
  s_mov_b32 s53, 0
  s_mov_b32 s63, 0
  s_mov_b32 s49, 72
  s_mov_b32 s59, 64
  s_mov_b32 s50, 0
  s_mov_b32 s89, 0
  s_branch o_pick_131
L_o_x:
  s_mov_b32 s62, 1
  s_mov_b32 s42, 0
  s_mov_b32 s3, 0
  s_mov_b32 s46, 0
  s_mov_b32 s65, 0
  s_mov_b32 s66, 0
  s_mov_b32 s76, 0
  s_mov_b32 s55, 0
  s_mov_b32 s48, 0
  s_mov_b32 s56, 0
  s_mov_b32 s84, 268435456
  s_mov_b32 s86, s41
  s_mov_b32 s49, s60
  s_mul_i32 s63, s49, 257
  s_or_b32 s63, s63, 1179648
  s_lshr_b32 s57, s60, 2
  s_cbranch_scc1 o_help_190
o_round_179:
  s_max_u32 s46, s46, s3
  s_cmp_lg_u32 s3, 0
  s_mov_b32 s3, 0
  s_cbranch_scc1 d_g_195
  s_mov_b32 s67, 0
d_w_194:
  s_min_u32 s26, s49, 71
  s_lshl_b32 s26, s26, 12
  s_add_u32 s27, s26, 243494912
  s_add_u32 s26, s26, 243486720
  buffer_load_dword v248, v246, s[4:7], s26 offen sc1
  buffer_load_dword v249, v246, s[4:7], s27 offen sc1
  s_add_u32 s67, s67, 1
  s_cmp_gt_u32 s67, 1048576
  s_cbranch_scc1 L_end
  s_waitcnt vmcnt(0)
  s_mov_b64 exec, 1
  buffer_store_dword v38, off, s[4:7], s84 sc1
  s_mov_b64 exec, -1
  s_mov_b32 s84, 268435456
  v_min_u32 v162, v248, v249
  v_max_u32 v163, v248, v249
  v_cmp_eq_u32 vcc, 0, v162
  s_cbranch_vccnz d_w_194
  v_max_u32_dpp v163, v163, v163 row_ror:8 row_mask:0xf bank_mask:0xf
  s_nop 1
  v_max_u32_dpp v163, v163, v163 row_ror:4 row_mask:0xf bank_mask:0xf
  s_nop 1
  v_max_u32_dpp v163, v163, v163 row_ror:2 row_mask:0xf bank_mask:0xf
  s_nop 1
  v_max_u32_dpp v163, v163, v163 row_ror:1 row_mask:0xf bank_mask:0xf
  s_nop 0
  v_readlane_b32 s28, v163, 0
  v_readlane_b32 s29, v163, 16
  v_readlane_b32 s30, v163, 32
  v_readlane_b32 s31, v163, 48
  s_max_u32 s28, s28, s29
  s_max_u32 s30, s30, s31
  s_max_u32 s46, s46, s28
  s_max_u32 s46, s46, s30
d_g_195:
  s_lshr_b32 s27, s49, 2
  s_andn2_b32 s52, 0xfff, s46
  s_lshr_b32 s52, s52, 5
  s_min_u32 s52, s52, 64
  s_add_u32 s26, s52, 3
  v_readlane_b32 s89, v247, s27
  s_sub_u32 s26, s26, s60
  s_lshr_b32 s26, s26, 2
  s_bfm_b32 s54, s26, 0
  s_add_u32 s53, s63, 1028
  s_cmp_lt_u32 s49, 60
  s_cselect_b32 s53, s53, 0
  s_cmp_lt_u32 s49, 64
  s_cselect_b32 s26, 2, 1
  s_sub_i32 s26, s27, s26
  s_max_i32 s26, s26, 0
  s_min_u32 s26, s26, 16
  s_bfm_b32 s58, s26, 0
  s_cmp_eq_u32 s27, 16
  s_cselect_b32 s59, 1, 1
  s_cmp_eq_u32 s27, 17
  s_cselect_b32 s59, 0, s59
  s_cmp_eq_u32 s27, 18
  s_cselect_b32 s59, 64, s59
  s_cselect_b32 s50, 0, -1
  s_cselect_b32 s89, 0, s89
  s_cbranch_scc1 o_dl_191
  s_cmp_eq_u32 s27, 16
  s_cbranch_scc1 o_dl_191_a
o_pick_183:
  s_cmp_eq_u32 s59, 0
  s_cbranch_scc1 o_none_187
  s_sub_u32 s59, s59, 1
  s_andn2_b32 s26, s58, s55
  s_and_b32 s26, s26, s54
  s_cbranch_scc1 o_ga_184
  s_and_b32 s26, s55, s50
  s_or_b32 s26, s26, s56
  s_or_b32 s26, s26, s54
  s_andn2_b32 s26, s58, s26
  s_cbranch_scc0 o_none_187
  s_cmp_ge_u32 s46, s89
  s_cbranch_scc1 o_gb_185
o_ga_184:
  s_ff1_i32_b32 s26, s26
  s_bitset1_b32 s55, s26
  s_mov_b32 s64, 1327168
  s_mov_b32 s27, s64
  s_branch o_gd_186
o_none_187:
  s_cmp_lt_u32 s49, 60
  s_cbranch_scc1 o_nn_188
  s_cmp_eq_u32 s50, 0
  s_cbranch_scc1 o_nn_188
  s_and_b32 s26, s63, 1097728
  s_cmp_eq_u32 s26, 1048576
  s_cbranch_scc1 o_nn_188
  s_cmp_lt_u32 s49, 64
  s_cbranch_scc1 o_adv_189
  s_and_b32 s26, s65, 1097728
  s_cmp_lg_u32 s26, 1048576
  s_cbranch_scc1 o_adv_189
o_nn_188:
  s_mov_b32 s64, s53
  s_mov_b32 s51, 0
  s_branch o_task_180
o_gb_185:
  s_ff1_i32_b32 s26, s26
  s_bitset1_b32 s56, s26
  s_andn2_b32 s27, 31, s46
  s_or_b32 s27, s27, 32
  s_lshl_b32 s27, s27, 22
  s_or_b32 s27, s27, 1474688
  s_mov_b32 s64, 1474624
o_gd_186:
  s_lshl4_add_u32 s48, s48, s26
  s_and_b32 s28, s26, s57
  s_lshr_b32 s26, s26, s57
  s_lshl2_add_u32 s26, s26, s60
  s_add_u32 s26, s26, s28
  s_cmp_eq_u32 s26, s52
  s_cselect_b32 s64, s27, s64
  s_mul_i32 s26, s26, 257
  s_or_b32 s64, s64, s26
  s_mov_b32 s51, 1
o_task_180:
  s_cmp_eq_u32 s63, 0
  s_cbranch_scc1 o_nofl_181
  s_cmp_lg_u32 s66, 0
  s_cbranch_scc1 o_have_197
  s_mov_b32 s67, 0
o_w1_196:
  s_and_b32 s32, s63, 0xff
  s_lshl_b32 s32, s32, 12
  s_add_u32 s32, s32, s14
  buffer_load_dword v37, v36, s[4:7], s32 offen sc1
  s_add_u32 s67, s67, 1
  s_cmp_gt_u32 s67, 1048576
  s_cbranch_scc1 L_end
  s_waitcnt vmcnt(0)
  s_mov_b64 exec, 1
  buffer_store_dword v38, off, s[4:7], s84 sc1
  s_mov_b64 exec, -1
  s_mov_b32 s84, 268435456
  v_cmp_eq_u32 vcc, 0, v37
  s_cbranch_vccnz o_w1_196
  s_and_b32 s87, s63, 0xff
  s_lshl_b32 s33, s87, 18
  s_lshl_b32 s32, s87, 19
  s_add_u32 m0, s22, 0
  s_add_u32 s33, s33, s19
  buffer_load_dwordx4 v0, s[4:7], s33 offen offset:0 sc1 lds
  buffer_load_dwordx4 v0, s[4:7], s33 offen offset:1024 sc1 lds
  buffer_load_dwordx4 v0, s[4:7], s33 offen offset:2048 sc1 lds
  buffer_load_dwordx4 v0, s[4:7], s33 offen offset:3072 sc1 lds
  s_add_u32 m0, s23, 0
  s_add_u32 s32, s32, s18
  buffer_load_dwordx4 v0, s[4:7], s32 offen offset:0 sc1 lds
  buffer_load_dwordx4 v0, s[4:7], s32 offen offset:1024 sc1 lds
  buffer_load_dwordx4 v0, s[4:7], s32 offen offset:2048 sc1 lds
  buffer_load_dwordx4 v0, s[4:7], s32 offen offset:3072 sc1 lds
  s_add_u32 m0, m0, 4096
  s_add_u32 s32, s32, 4096
  buffer_load_dwordx4 v0, s[4:7], s32 offen offset:0 sc1 lds
  buffer_load_dwordx4 v0, s[4:7], s32 offen offset:1024 sc1 lds
  buffer_load_dwordx4 v0, s[4:7], s32 offen offset:2048 sc1 lds
  buffer_load_dwordx4 v0, s[4:7], s32 offen offset:3072 sc1 lds
  s_waitcnt vmcnt(0)
  s_barrier
o_have_197:
  ds_read_b128 v[120:123], v33 offset:0
  ds_read_b128 v[40:43], v32 offset:0
  ds_read_b128 v[56:59], v32 offset:1024
  ds_read_b128 v[124:127], v33 offset:2048
  ds_read_b128 v[44:47], v32 offset:4096
  ds_read_b128 v[60:63], v32 offset:5120
  ds_read_b128 v[128:131], v33 offset:4096
  ds_read_b128 v[48:51], v32 offset:8192
  ds_read_b128 v[64:67], v32 offset:9216
  ds_read_b128 v[132:135], v33 offset:6144
  ds_read_b128 v[52:55], v32 offset:12288
  ds_read_b128 v[68:71], v32 offset:13312
  s_cmp_lt_u32 s17, 2
  s_cselect_b32 s65, s65, 0
  s_cmp_lg_u32 s65, 0
  s_cselect_b64 s[44:45], -1, 0
  s_mov_b32 s95, s86
  s_mov_b32 s96, s42
  s_lshl_b32 s97, s43, 14
  s_add_u32 s97, s97, s95
  s_and_b32 s87, s64, 0xff
  s_lshl_b32 s87, s87, 12
  s_add_u32 s87, s87, s14
  s_and_b32 s88, s63, 0xff00
  s_lshl_b32 s88, s88, 3
  s_add_u32 s88, s88, s15
  s_and_b32 s91, s65, 63
  s_lshl_b32 s90, s91, 5
  s_add_u32 s94, s90, s85
  s_add_u32 s90, s90, s43
  s_lshl_b32 s94, s94, 10
  s_lshr_b32 s92, s65, 22
  s_xor_b32 s93, s43, 32
  s_lshl_b32 s91, s90, 10
  s_add_u32 s94, s94, 25165824
  s_cmp_eq_u32 s92, s93
  s_cselect_b32 s92, s94, s91
  s_add_u32 s92, s92, 10485760
  s_and_b32 s93, s65, 49152
  s_cselect_b32 s92, s92, s91
  s_cselect_b64 s[80:81], s[4:5], s[72:73]
  s_cselect_b32 s82, s6, s74
  s_waitcnt lgkmcnt(9)
  v_mfma_f32_16x16x32_bf16 v[104:107], v[40:43], v[120:123], v[24:27]
  v_mfma_f32_16x16x32_bf16 v[108:111], v[56:59], v[120:123], v[28:31]
  s_mov_b64 exec, s[44:45]
  buffer_load_dword v7, v255, s[4:7], s97 offen sc1
  buffer_load_dwordx4 v[184:187], v0, s[80:83], s92 offen sc1
  s_not_b64 exec, exec
  buffer_load_dword v37, v36, s[4:7], s87 offen sc1
  s_mov_b64 exec, -1
  buffer_load_dword v244, v252, s[4:7], s88 offen sc1
  s_waitcnt lgkmcnt(6)
  v_mfma_f32_16x16x32_bf16 v[104:107], v[44:47], v[124:127], v[104:107]
  v_mfma_f32_16x16x32_bf16 v[108:111], v[60:63], v[124:127], v[108:111]
  s_waitcnt lgkmcnt(3)
  v_mfma_f32_16x16x32_bf16 v[104:107], v[48:51], v[128:131], v[104:107]
  v_mfma_f32_16x16x32_bf16 v[108:111], v[64:67], v[128:131], v[108:111]
  s_waitcnt lgkmcnt(0)
  v_mfma_f32_16x16x32_bf16 v[104:107], v[52:55], v[132:135], v[104:107]
  v_mfma_f32_16x16x32_bf16 v[108:111], v[68:71], v[132:135], v[108:111]
  s_cmp_lg_u32 s76, 0
  s_cbranch_scc1 o_klds_200
  v_mov_b32 v196, 0
  v_mov_b32 v199, 0
  v_exp_f32 v56, v104
  v_exp_f32 v57, v105
  v_exp_f32 v58, v106
  v_exp_f32 v59, v107
  v_exp_f32 v60, v108
  v_exp_f32 v61, v109
  v_exp_f32 v62, v110
  v_exp_f32 v63, v111
  v_max3_f32 v116, v104, v105, v106
  v_max3_f32 v116, v107, v108, v116
  v_max3_f32 v116, v109, v110, v116
  v_add_f32 v117, v56, v57
  v_add_f32 v118, v58, v59
  v_add_f32 v117, v117, v60
  v_add_f32 v118, v118, v61
  v_add_f32 v117, v117, v62
  v_add_f32 v118, v118, v63
  s_mov_b32 s67, 0
  s_and_b32 s32, s63, 0xff00
  s_lshl_b32 s32, s32, 10
  s_add_u32 s32, s32, s20
  s_add_u32 s33, s32, 4096
o_w2_198:
  s_waitcnt vmcnt(0)
  v_cmp_eq_u32 vcc, 0, v244
  s_cbranch_vccz o_kgo_208
  s_mov_b64 exec, 1
  buffer_store_dword v38, off, s[4:7], s84 sc1
  s_mov_b64 exec, -1
  s_mov_b32 s84, 268435456
  buffer_load_dword v244, v252, s[4:7], s88 offen sc1
  s_add_u32 s67, s67, 1
  s_cmp_gt_u32 s67, 1048576
  s_cbranch_scc1 L_end
  s_branch o_w2_198
o_kgo_208:
  buffer_load_dwordx4 v[136:139], v0, s[4:7], s32 offen offset:0 sc1
  buffer_load_dwordx4 v[140:143], v0, s[4:7], s32 offen offset:1024 sc1
  buffer_load_dwordx4 v[144:147], v0, s[4:7], s32 offen offset:2048 sc1
  buffer_load_dwordx4 v[148:151], v0, s[4:7], s32 offen offset:3072 sc1
  buffer_load_dwordx2 v[200:201], v1, s[4:7], s33 offen offset:0 sc1
  buffer_load_dwordx2 v[202:203], v1, s[4:7], s33 offen offset:512 sc1
  buffer_load_dwordx2 v[204:205], v1, s[4:7], s33 offen offset:1024 sc1
  buffer_load_dwordx2 v[206:207], v1, s[4:7], s33 offen offset:1536 sc1
  buffer_load_dword v37, v36, s[4:7], s87 offen sc1
  buffer_load_dword v244, v252, s[4:7], s88 offen sc1
  s_barrier
  ds_read_b128 v[152:155], v32 offset:2048
  ds_read_b128 v[156:159], v32 offset:3072
  ds_read_b128 v[160:163], v32 offset:6144
  ds_read_b128 v[164:167], v32 offset:7168
  ds_read_b128 v[168:171], v32 offset:10240
  ds_read_b128 v[172:175], v32 offset:11264
  ds_read_b128 v[176:179], v32 offset:14336
  ds_read_b128 v[180:183], v32 offset:15360
  s_waitcnt vmcnt(9)
  v_mfma_f32_16x16x32_bf16 v[112:115], v[136:139], v[120:123], 0
  s_waitcnt vmcnt(8)
  v_mfma_f32_16x16x32_bf16 v[112:115], v[140:143], v[124:127], v[112:115]
  s_waitcnt vmcnt(7)
  v_mfma_f32_16x16x32_bf16 v[112:115], v[144:147], v[128:131], v[112:115]
  s_waitcnt vmcnt(6)
  v_mfma_f32_16x16x32_bf16 v[112:115], v[148:151], v[132:135], v[112:115]
  s_waitcnt vmcnt(2)
  s_branch o_havek_199
o_klds_200:
  s_waitcnt vmcnt(12)
  s_barrier
  ds_read_b128 v[136:139], v34 offset:0
  ds_read_b128 v[140:143], v34 offset:1024
  ds_read_b128 v[144:147], v34 offset:2048
  ds_read_b128 v[148:151], v34 offset:3072
  ds_read_b64 v[200:201], v35 offset:4096
  ds_read_b64 v[202:203], v35 offset:4608
  ds_read_b64 v[204:205], v35 offset:5120
  ds_read_b64 v[206:207], v35 offset:5632
  v_mov_b32 v196, 0
  v_mov_b32 v199, 0
  v_exp_f32 v56, v104
  v_exp_f32 v57, v105
  v_exp_f32 v58, v106
  v_exp_f32 v59, v107
  v_exp_f32 v60, v108
  v_exp_f32 v61, v109
  v_exp_f32 v62, v110
  v_exp_f32 v63, v111
  v_max3_f32 v116, v104, v105, v106
  v_max3_f32 v116, v107, v108, v116
  v_max3_f32 v116, v109, v110, v116
  s_waitcnt lgkmcnt(4)
  v_mfma_f32_16x16x32_bf16 v[112:115], v[136:139], v[120:123], 0
  ds_read_b128 v[152:155], v32 offset:2048
  ds_read_b128 v[156:159], v32 offset:3072
  v_mfma_f32_16x16x32_bf16 v[112:115], v[140:143], v[124:127], v[112:115]
  ds_read_b128 v[160:163], v32 offset:6144
  ds_read_b128 v[164:167], v32 offset:7168
  v_mfma_f32_16x16x32_bf16 v[112:115], v[144:147], v[128:131], v[112:115]
  ds_read_b128 v[168:171], v32 offset:10240
  ds_read_b128 v[172:175], v32 offset:11264
  v_mfma_f32_16x16x32_bf16 v[112:115], v[148:151], v[132:135], v[112:115]
  ds_read_b128 v[176:179], v32 offset:14336
  ds_read_b128 v[180:183], v32 offset:15360
  v_add_f32 v117, v56, v57
  v_add_f32 v118, v58, v59
  v_add_f32 v117, v117, v60
  v_add_f32 v118, v118, v61
  v_add_f32 v117, v117, v62
  v_add_f32 v118, v118, v63
o_havek_199:
  s_cmp_lg_u32 s65, 0
  s_cbranch_scc1 o_wr1_205
  s_nop 3
  v_mul_f32 v112, s24, v112
  v_mul_f32 v113, s24, v113
  v_exp_f32 v64, v112
  v_exp_f32 v65, v113
  v_max_f32 v116, v111, v116
  v_max3_f32 v116, v112, v113, v116
  v_add_f32 v117, v117, v64
  v_add_f32 v118, v118, v65
  v_add_f32 v117, v117, v118
  s_mov_b32 s28, 0x21800000
  v_mov_b32 v118, v117
  s_nop 1
  v_permlane16_swap_b32 v117, v118
  v_add_f32 v117, v117, v118
  v_mov_b32 v118, v117
  s_nop 0
  s_nop 0
  v_permlane32_swap_b32 v117, v118
  v_add_f32 v117, v117, v118
  v_cmp_lt_f32 vcc, 0x42700000, v116
  v_cmp_gt_f32 s[30:31], s28, v117
  v_rcp_f32 v117, v117
  s_or_b64 vcc, vcc, s[30:31]
  s_cbranch_vccnz o_fb_209
o_fbr_210:
  v_pk_mul_f32 v[56:57], v[56:57], v[116:117] op_sel:[0,1] op_sel_hi:[1,1]
  v_pk_mul_f32 v[58:59], v[58:59], v[116:117] op_sel:[0,1] op_sel_hi:[1,1]
  v_pk_mul_f32 v[60:61], v[60:61], v[116:117] op_sel:[0,1] op_sel_hi:[1,1]
  v_pk_mul_f32 v[62:63], v[62:63], v[116:117] op_sel:[0,1] op_sel_hi:[1,1]
  v_pk_mul_f32 v[64:65], v[64:65], v[116:117] op_sel:[0,1] op_sel_hi:[1,1]
  v_cvt_pk_bf16_f32 v116, v56, v57
  v_cvt_pk_bf16_f32 v117, v58, v59
  v_cvt_pk_bf16_f32 v118, v60, v61
  v_cvt_pk_bf16_f32 v119, v62, v63
  s_waitcnt lgkmcnt(0)
  s_nop 0
  v_mfma_f32_16x16x32_bf16 v[72:75], v[152:155], v[116:119], 0
  s_add_u32 s62, s62, 1
  v_cvt_pk_bf16_f32 v197, v64, v65
  v_cvt_pk_bf16_f32 v198, v64, v65
  v_mfma_f32_16x16x32_bf16 v[76:79], v[156:159], v[116:119], 0
  s_xor_b32 s86, s86, 524288
  v_mfma_f32_16x16x32_bf16 v[80:83], v[160:163], v[116:119], 0
  s_bfe_u32 s42, s62, 0x10001
  v_mfma_f32_16x16x32_bf16 v[84:87], v[164:167], v[116:119], 0
  s_bfe_u32 s26, s64, 65556
  v_mfma_f32_16x16x32_bf16 v[88:91], v[168:171], v[116:119], 0
  s_and_b32 s87, s64, 0xff
  v_mfma_f32_16x16x32_bf16 v[92:95], v[172:175], v[116:119], 0
  s_bfe_u32 s88, s64, 0x80008
  v_mfma_f32_16x16x32_bf16 v[96:99], v[176:179], v[116:119], 0
  s_nop 0
  v_mfma_f32_16x16x32_bf16 v[100:103], v[180:183], v[116:119], 0
  s_nop 0
  v_mfma_f32_16x16x16_bf16 v[72:75], v[200:201], v[198:199], v[72:75]
  s_nop 1
  v_mfma_f32_16x16x16_bf16 v[76:79], v[200:201], v[196:197], v[76:79]
  s_nop 1
  v_mfma_f32_16x16x16_bf16 v[80:83], v[202:203], v[198:199], v[80:83]
  s_nop 1
  v_mfma_f32_16x16x16_bf16 v[84:87], v[202:203], v[196:197], v[84:87]
  s_nop 1
  v_mfma_f32_16x16x16_bf16 v[88:91], v[204:205], v[198:199], v[88:91]
  s_nop 0
  v_cvt_pk_bf16_f32 v40, v72, v73
  v_cvt_pk_bf16_f32 v41, v74, v75
  v_mfma_f32_16x16x16_bf16 v[92:95], v[204:205], v[196:197], v[92:95]
  s_nop 0
  v_cvt_pk_bf16_f32 v42, v76, v77
  v_cvt_pk_bf16_f32 v43, v78, v79
  v_mfma_f32_16x16x16_bf16 v[96:99], v[206:207], v[198:199], v[96:99]
  s_nop 0
  ds_write_b128 v6, v[40:43] offset:0
  v_cvt_pk_bf16_f32 v44, v80, v81
  v_mfma_f32_16x16x16_bf16 v[100:103], v[206:207], v[196:197], v[100:103]
  s_nop 0
  v_cvt_pk_bf16_f32 v45, v82, v83
  v_cvt_pk_bf16_f32 v46, v84, v85
  v_cvt_pk_bf16_f32 v47, v86, v87
  ds_write_b128 v6, v[44:47] offset:1024
  v_cvt_pk_bf16_f32 v48, v88, v89
  v_cvt_pk_bf16_f32 v49, v90, v91
  v_cvt_pk_bf16_f32 v50, v92, v93
  v_cvt_pk_bf16_f32 v51, v94, v95
  ds_write_b128 v6, v[48:51] offset:2048
  v_cvt_pk_bf16_f32 v52, v96, v97
  v_cvt_pk_bf16_f32 v53, v98, v99
  v_cvt_pk_bf16_f32 v54, v100, v101
  v_cvt_pk_bf16_f32 v55, v102, v103
  ds_write_b128 v6, v[52:55] offset:3072
  s_cmp_lt_u32 s17, 2
  s_cbranch_scc1 o_wr0_204
  s_waitcnt lgkmcnt(0)
  s_barrier
  ds_read_b128 v[104:107], v3 offset:0
  ds_read_b128 v[108:111], v3 offset:512
  ds_read_b128 v[112:115], v3 offset:1024
  s_waitcnt lgkmcnt(2)
  v_mfma_f32_32x32x16_bf16 v[40:55], v[104:107], a[0:3], 0
  s_waitcnt vmcnt(0)
  v_cmp_eq_u32 vcc, 0, v37
  s_cmp_eq_u64 vcc, 0
  s_cselect_b32 s66, s26, 0
  s_cmp_eq_u32 s66, 1
  s_cselect_b32 s87, s87, 1024
  s_cselect_b32 s34, 0, 0x28000
  v_mfma_f32_32x32x16_bf16 v[56:71], v[104:107], a[4:7], 0
  ds_read_b128 v[116:119], v3 offset:1536
  s_lshl_b32 s33, s87, 18
  s_lshl_b32 s32, s87, 19
  s_add_u32 m0, s22, s34
  s_add_u32 s33, s33, s19
  s_min_u32 s28, s49, 67
  v_mfma_f32_32x32x16_bf16 v[72:87], v[104:107], a[8:11], 0
  s_lshl1_add_u32 s28, s17, s28
  s_lshl_b32 s28, s28, 12
  s_add_u32 s28, s28, 243486720
  v_mfma_f32_32x32x16_bf16 v[88:103], v[104:107], a[12:15], 0
  buffer_load_dword v249, v246, s[4:7], s28 offen sc1
  s_waitcnt lgkmcnt(2)
  v_mfma_f32_32x32x16_bf16 v[40:55], v[108:111], a[16:19], v[40:55]
  buffer_load_dwordx4 v0, s[4:7], s33 offen offset:0 sc1 lds
  v_mfma_f32_32x32x16_bf16 v[56:71], v[108:111], a[20:23], v[56:71]
  ds_read_b128 v[104:107], v3 offset:2048
  v_mfma_f32_32x32x16_bf16 v[72:87], v[108:111], a[24:27], v[72:87]
  buffer_load_dwordx4 v0, s[4:7], s33 offen offset:1024 sc1 lds
  v_mfma_f32_32x32x16_bf16 v[88:103], v[108:111], a[28:31], v[88:103]
  buffer_load_dwordx4 v0, s[4:7], s33 offen offset:2048 sc1 lds
  s_waitcnt lgkmcnt(2)
  v_mfma_f32_32x32x16_bf16 v[40:55], v[112:115], a[32:35], v[40:55]
  v_mfma_f32_32x32x16_bf16 v[56:71], v[112:115], a[36:39], v[56:71]
  ds_read_b128 v[108:111], v3 offset:2560
  buffer_load_dwordx4 v0, s[4:7], s33 offen offset:3072 sc1 lds
  s_sub_u32 m0, m0, 8192
  s_sub_u32 s33, s33, 8192
  v_mfma_f32_32x32x16_bf16 v[72:87], v[112:115], a[40:43], v[72:87]
  buffer_load_dwordx4 v0, s[4:7], s33 offen offset:0 sc1 lds
  v_mfma_f32_32x32x16_bf16 v[88:103], v[112:115], a[44:47], v[88:103]
  s_waitcnt lgkmcnt(2)
  v_mfma_f32_32x32x16_bf16 v[40:55], v[116:119], a[48:51], v[40:55]
  buffer_load_dwordx4 v0, s[4:7], s33 offen offset:1024 sc1 lds
  v_mfma_f32_32x32x16_bf16 v[56:71], v[116:119], a[52:55], v[56:71]
  ds_read_b128 v[112:115], v3 offset:3072
  buffer_load_dwordx4 v0, s[4:7], s33 offen offset:2048 sc1 lds
  v_mfma_f32_32x32x16_bf16 v[72:87], v[116:119], a[56:59], v[72:87]
  v_mfma_f32_32x32x16_bf16 v[88:103], v[116:119], a[60:63], v[88:103]
  buffer_load_dwordx4 v0, s[4:7], s33 offen offset:3072 sc1 lds
  s_add_u32 m0, s23, s34
  s_add_u32 s32, s32, s18
  s_waitcnt lgkmcnt(2)
  v_mfma_f32_32x32x16_bf16 v[40:55], v[104:107], a[64:67], v[40:55]
  buffer_load_dwordx4 v0, s[4:7], s32 offen offset:0 sc1 lds
  v_mfma_f32_32x32x16_bf16 v[56:71], v[104:107], a[68:71], v[56:71]
  ds_read_b128 v[116:119], v3 offset:3584
  v_mfma_f32_32x32x16_bf16 v[72:87], v[104:107], a[72:75], v[72:87]
  buffer_load_dwordx4 v0, s[4:7], s32 offen offset:1024 sc1 lds
  s_add_i32 m0, m0, 4096
  s_add_i32 s32, s32, 4096
  v_mfma_f32_32x32x16_bf16 v[88:103], v[104:107], a[76:79], v[88:103]
  buffer_load_dwordx4 v0, s[4:7], s32 offen offset:0 sc1 lds
  s_waitcnt lgkmcnt(2)
  v_mfma_f32_32x32x16_bf16 v[40:55], v[108:111], a[80:83], v[40:55]
  v_mfma_f32_32x32x16_bf16 v[56:71], v[108:111], a[84:87], v[56:71]
  ds_read_b128 v[104:107], v3 offset:8192
  buffer_load_dwordx4 v0, s[4:7], s32 offen offset:1024 sc1 lds
  s_add_i32 m0, m0, -16384
  s_add_i32 s32, s32, -16384
  v_mfma_f32_32x32x16_bf16 v[72:87], v[108:111], a[88:91], v[72:87]
  s_and_b32 s29, s64, 0xff00
  s_lshl_b32 s29, s29, 3
  s_add_u32 s29, s29, s15
  buffer_load_dword v245, v252, s[4:7], s29 offen sc1
  v_mfma_f32_32x32x16_bf16 v[88:103], v[108:111], a[92:95], v[88:103]
  s_waitcnt lgkmcnt(2)
  v_mfma_f32_32x32x16_bf16 v[40:55], v[112:115], a[96:99], v[40:55]
  buffer_load_dwordx4 v0, s[4:7], s32 offen offset:0 sc1 lds
  v_mfma_f32_32x32x16_bf16 v[56:71], v[112:115], a[100:103], v[56:71]
  ds_read_b128 v[108:111], v3 offset:8704
  buffer_load_dwordx4 v0, s[4:7], s32 offen offset:1024 sc1 lds
  s_add_i32 m0, m0, -4096
  s_add_i32 s32, s32, -4096
  v_mfma_f32_32x32x16_bf16 v[72:87], v[112:115], a[104:107], v[72:87]
  v_mfma_f32_32x32x16_bf16 v[88:103], v[112:115], a[108:111], v[88:103]
  buffer_load_dwordx4 v0, s[4:7], s32 offen offset:0 sc1 lds
  s_waitcnt lgkmcnt(2)
  v_mfma_f32_32x32x16_bf16 v[40:55], v[116:119], a[112:115], v[40:55]
  buffer_load_dwordx4 v0, s[4:7], s32 offen offset:1024 sc1 lds
  v_mfma_f32_32x32x16_bf16 v[56:71], v[116:119], a[116:119], v[56:71]
  ds_read_b128 v[112:115], v3 offset:9216
  v_mfma_f32_32x32x16_bf16 v[72:87], v[116:119], a[120:123], v[72:87]
  buffer_load_dwordx4 v0, s[4:7], s32 offen offset:2048 sc1 lds
  v_mfma_f32_32x32x16_bf16 v[88:103], v[116:119], a[124:127], v[88:103]
  buffer_load_dwordx4 v0, s[4:7], s32 offen offset:3072 sc1 lds
  s_add_i32 m0, m0, 4096
  s_add_i32 s32, s32, 4096
  s_waitcnt lgkmcnt(2)
  v_mfma_f32_32x32x16_bf16 v[40:55], v[104:107], a[128:131], v[40:55]
  v_mfma_f32_32x32x16_bf16 v[56:71], v[104:107], a[132:135], v[56:71]
  ds_read_b128 v[116:119], v3 offset:9728
  buffer_load_dwordx4 v0, s[4:7], s32 offen offset:2048 sc1 lds
  v_mfma_f32_32x32x16_bf16 v[72:87], v[104:107], a[136:139], v[72:87]
  buffer_load_dwordx4 v0, s[4:7], s32 offen offset:3072 sc1 lds
  s_add_i32 m0, m0, 16384
  s_add_i32 s32, s32, 16384
  v_mfma_f32_32x32x16_bf16 v[88:103], v[104:107], a[140:143], v[88:103]
  s_waitcnt lgkmcnt(2)
  v_mfma_f32_32x32x16_bf16 v[40:55], v[108:111], a[144:147], v[40:55]
  buffer_load_dwordx4 v0, s[4:7], s32 offen offset:2048 sc1 lds
  v_mfma_f32_32x32x16_bf16 v[56:71], v[108:111], a[148:151], v[56:71]
  ds_read_b128 v[104:107], v3 offset:10240
  buffer_load_dwordx4 v0, s[4:7], s32 offen offset:3072 sc1 lds
  s_add_i32 m0, m0, -4096
  s_add_i32 s32, s32, -4096
  v_mfma_f32_32x32x16_bf16 v[72:87], v[108:111], a[152:155], v[72:87]
  v_mfma_f32_32x32x16_bf16 v[88:103], v[108:111], a[156:159], v[88:103]
  buffer_load_dwordx4 v0, s[4:7], s32 offen offset:2048 sc1 lds
  s_waitcnt lgkmcnt(2)
  v_mfma_f32_32x32x16_bf16 v[40:55], v[112:115], a[160:163], v[40:55]
  buffer_load_dwordx4 v0, s[4:7], s32 offen offset:3072 sc1 lds
  v_mfma_f32_32x32x16_bf16 v[56:71], v[112:115], a[164:167], v[56:71]
  ds_read_b128 v[108:111], v3 offset:10752
  v_mfma_f32_32x32x16_bf16 v[72:87], v[112:115], a[168:171], v[72:87]
  v_mfma_f32_32x32x16_bf16 v[88:103], v[112:115], a[172:175], v[88:103]
  s_waitcnt lgkmcnt(2)
  v_mfma_f32_32x32x16_bf16 v[40:55], v[116:119], a[176:179], v[40:55]
  v_mfma_f32_32x32x16_bf16 v[56:71], v[116:119], a[180:183], v[56:71]
  ds_read_b128 v[112:115], v3 offset:11264
  v_mfma_f32_32x32x16_bf16 v[72:87], v[116:119], a[184:187], v[72:87]
  v_mfma_f32_32x32x16_bf16 v[88:103], v[116:119], a[188:191], v[88:103]
  s_waitcnt lgkmcnt(2)
  v_mfma_f32_32x32x16_bf16 v[40:55], v[104:107], a[192:195], v[40:55]
  v_mfma_f32_32x32x16_bf16 v[56:71], v[104:107], a[196:199], v[56:71]
  ds_read_b128 v[116:119], v3 offset:11776
  s_waitcnt vmcnt(12)
  v_cmp_eq_u32 vcc, 0, v245
  s_cmp_eq_u64 vcc, 0
  s_cselect_b32 s76, s26, 0
  s_and_b32 s76, s76, 1
  s_cselect_b32 s88, s88, 1024
  s_waitcnt lgkmcnt(2)
  v_mfma_f32_32x32x16_bf16 v[40:55], v[108:111], a[208:211], v[40:55]
  s_lshl_b32 s32, s88, 18
  s_mov_b32 m0, s40
  s_add_u32 s32, s32, s21
  buffer_load_dwordx4 v0, s[4:7], s32 offen offset:0 sc1 lds
  v_mfma_f32_32x32x16_bf16 v[56:71], v[108:111], a[212:215], v[56:71]
  buffer_load_dwordx4 v0, s[4:7], s32 offen offset:1024 sc1 lds
  s_waitcnt lgkmcnt(1)
  v_mfma_f32_32x32x16_bf16 v[40:55], v[112:115], a[224:227], v[40:55]
  buffer_load_dwordx4 v0, s[4:7], s32 offen offset:2048 sc1 lds
  s_sub_u32 m0, m0, 8192
  s_sub_u32 s32, s32, 8192
  v_mfma_f32_32x32x16_bf16 v[56:71], v[112:115], a[228:231], v[56:71]
  buffer_load_dwordx4 v0, s[4:7], s32 offen offset:0 sc1 lds
  s_waitcnt lgkmcnt(0)
  v_mfma_f32_32x32x16_bf16 v[40:55], v[116:119], a[240:243], v[40:55]
  buffer_load_dwordx4 v0, s[4:7], s32 offen offset:1024 sc1 lds
  v_mfma_f32_32x32x16_bf16 v[56:71], v[116:119], a[244:247], v[56:71]
  buffer_load_dwordx4 v0, s[4:7], s32 offen offset:2048 sc1 lds
  v_cmp_eq_u32 vcc, 0, v249
  v_max_u32_dpp v249, v249, v249 row_ror:8 row_mask:0xf bank_mask:0xf
  s_nop 0
  v_mfma_f32_32x32x16_bf16 v[72:87], v[104:107], a[200:203], v[72:87]
  v_max_u32_dpp v249, v249, v249 row_ror:4 row_mask:0xf bank_mask:0xf
  s_nop 0
  s_nop 0
  v_max_u32_dpp v249, v249, v249 row_ror:2 row_mask:0xf bank_mask:0xf
  s_nop 0
  s_nop 0
  v_max_u32_dpp v249, v249, v249 row_ror:1 row_mask:0xf bank_mask:0xf
  s_nop 0
  v_mfma_f32_32x32x16_bf16 v[88:103], v[104:107], a[204:207], v[88:103]
  v_mov_b32 v248, v249
  s_nop 0
  s_nop 0
  v_permlane16_swap_b32 v249, v248
  v_max_u32 v249, v249, v248
  v_mfma_f32_32x32x16_bf16 v[72:87], v[108:111], a[216:219], v[72:87]
  v_mov_b32 v248, v249
  s_nop 0
  s_nop 0
  v_permlane32_swap_b32 v249, v248
  v_max_u32 v249, v249, v248
  s_cmp_eq_u64 vcc, 0
  s_cselect_b32 s28, 4, 0
  v_mfma_f32_32x32x16_bf16 v[88:103], v[108:111], a[220:223], v[88:103]
  s_lshl_b32 s26, s76, 1
  s_or_b32 s26, s26, s66
  s_or_b32 s26, s26, s28
  v_mov_b32 v248, s26
  ds_write_b64 v39, v[248:249]
  v_mfma_f32_32x32x16_bf16 v[72:87], v[112:115], a[232:235], v[72:87]
  v_cvt_pk_bf16_f32 v212, v40, v56
  v_cvt_pk_bf16_f32 v214, v41, v57
  v_cvt_pk_bf16_f32 v216, v42, v58
  v_cvt_pk_bf16_f32 v218, v43, v59
  v_permlane16_swap_b32 v212, v214
  v_mfma_f32_32x32x16_bf16 v[88:103], v[112:115], a[236:239], v[88:103]
  v_cvt_pk_bf16_f32 v220, v44, v60
  v_cvt_pk_bf16_f32 v222, v45, v61
  v_permlane16_swap_b32 v216, v218
  v_bfi_b32 v212, v254, s42, v212
  v_mfma_f32_32x32x16_bf16 v[72:87], v[116:119], a[248:251], v[72:87]
  v_cvt_pk_bf16_f32 v224, v46, v62
  v_cvt_pk_bf16_f32 v226, v47, v63
  v_permlane16_swap_b32 v220, v222
  v_bfi_b32 v216, v254, s42, v216
  v_cvt_pk_bf16_f32 v228, v48, v64
  v_mfma_f32_32x32x16_bf16 v[88:103], v[116:119], a[252:255], v[88:103]
  v_cvt_pk_bf16_f32 v230, v49, v65
  v_permlane16_swap_b32 v224, v226
  v_bfi_b32 v220, v254, s42, v220
  v_cvt_pk_bf16_f32 v232, v50, v66
  v_cvt_pk_bf16_f32 v234, v51, v67
  v_permlane16_swap_b32 v228, v230
  v_bfi_b32 v224, v254, s42, v224
  v_cvt_pk_bf16_f32 v236, v52, v68
  v_cvt_pk_bf16_f32 v238, v53, v69
  v_permlane16_swap_b32 v232, v234
  v_bfi_b32 v228, v254, s42, v228
  v_cvt_pk_bf16_f32 v240, v54, v70
  v_cvt_pk_bf16_f32 v242, v55, v71
  v_permlane16_swap_b32 v236, v238
  v_bfi_b32 v232, v254, s42, v232
  v_permlane16_swap_b32 v240, v242
  v_bfi_b32 v236, v254, s42, v236
  v_bfi_b32 v240, v254, s42, v240
  v_cvt_pk_bf16_f32 v213, v72, v88
  v_cvt_pk_bf16_f32 v215, v73, v89
  v_cvt_pk_bf16_f32 v217, v74, v90
  v_cvt_pk_bf16_f32 v219, v75, v91
  s_add_u32 s78, s86, 0
  v_permlane16_swap_b32 v213, v215
  buffer_store_dwordx4 v[212:215], v4, s[4:7], s78 offen sc1
  v_cvt_pk_bf16_f32 v221, v76, v92
  v_cvt_pk_bf16_f32 v223, v77, v93
  s_add_u32 s78, s86, 32768
  v_permlane16_swap_b32 v217, v219
  buffer_store_dwordx4 v[216:219], v4, s[4:7], s78 offen sc1
  v_cvt_pk_bf16_f32 v225, v78, v94
  v_cvt_pk_bf16_f32 v227, v79, v95
  s_add_u32 s78, s86, 131072
  v_permlane16_swap_b32 v221, v223
  buffer_store_dwordx4 v[220:223], v4, s[4:7], s78 offen sc1
  v_cvt_pk_bf16_f32 v229, v80, v96
  v_cvt_pk_bf16_f32 v231, v81, v97
  s_add_u32 s78, s86, 163840
  v_permlane16_swap_b32 v225, v227
  buffer_store_dwordx4 v[224:227], v4, s[4:7], s78 offen sc1
  v_cvt_pk_bf16_f32 v233, v82, v98
  v_cvt_pk_bf16_f32 v235, v83, v99
  s_add_u32 s78, s86, 262144
  v_permlane16_swap_b32 v229, v231
  buffer_store_dwordx4 v[228:231], v4, s[4:7], s78 offen sc1
  v_cvt_pk_bf16_f32 v237, v84, v100
  v_cvt_pk_bf16_f32 v239, v85, v101
  s_add_u32 s78, s86, 294912
  v_permlane16_swap_b32 v233, v235
  buffer_store_dwordx4 v[232:235], v4, s[4:7], s78 offen sc1
  v_cvt_pk_bf16_f32 v241, v86, v102
  v_cvt_pk_bf16_f32 v243, v87, v103
  s_add_u32 s78, s86, 393216
  v_permlane16_swap_b32 v237, v239
  buffer_store_dwordx4 v[236:239], v4, s[4:7], s78 offen sc1
  s_add_u32 s78, s86, 425984
  v_permlane16_swap_b32 v241, v243
  buffer_store_dwordx4 v[240:243], v4, s[4:7], s78 offen sc1
  s_waitcnt vmcnt(22)
  s_branch o_we_207
o_wr0_204:
  s_waitcnt lgkmcnt(0)
  s_barrier
  ds_read_b128 v[104:107], v3 offset:0
  ds_read_b128 v[108:111], v3 offset:512
  ds_read_b128 v[112:115], v3 offset:1024
  s_waitcnt lgkmcnt(2)
  v_mfma_f32_32x32x16_bf16 v[40:55], v[104:107], a[0:3], 0
  v_mfma_f32_32x32x16_bf16 v[56:71], v[104:107], a[4:7], 0
  ds_read_b128 v[116:119], v3 offset:1536
  v_mfma_f32_32x32x16_bf16 v[72:87], v[104:107], a[8:11], 0
  v_mfma_f32_32x32x16_bf16 v[88:103], v[104:107], a[12:15], 0
  s_waitcnt lgkmcnt(2)
  v_mfma_f32_32x32x16_bf16 v[40:55], v[108:111], a[16:19], v[40:55]
  v_mfma_f32_32x32x16_bf16 v[56:71], v[108:111], a[20:23], v[56:71]
  ds_read_b128 v[104:107], v3 offset:2048
  v_mfma_f32_32x32x16_bf16 v[72:87], v[108:111], a[24:27], v[72:87]
  v_mfma_f32_32x32x16_bf16 v[88:103], v[108:111], a[28:31], v[88:103]
  s_waitcnt lgkmcnt(2)
  v_mfma_f32_32x32x16_bf16 v[40:55], v[112:115], a[32:35], v[40:55]
  v_mfma_f32_32x32x16_bf16 v[56:71], v[112:115], a[36:39], v[56:71]
  ds_read_b128 v[108:111], v3 offset:2560
  v_mfma_f32_32x32x16_bf16 v[72:87], v[112:115], a[40:43], v[72:87]
  v_mfma_f32_32x32x16_bf16 v[88:103], v[112:115], a[44:47], v[88:103]
  s_waitcnt lgkmcnt(2)
  v_mfma_f32_32x32x16_bf16 v[40:55], v[116:119], a[48:51], v[40:55]
  v_mfma_f32_32x32x16_bf16 v[56:71], v[116:119], a[52:55], v[56:71]
  ds_read_b128 v[112:115], v3 offset:3072
  v_mfma_f32_32x32x16_bf16 v[72:87], v[116:119], a[56:59], v[72:87]
  v_mfma_f32_32x32x16_bf16 v[88:103], v[116:119], a[60:63], v[88:103]
  s_waitcnt lgkmcnt(2)
  v_mfma_f32_32x32x16_bf16 v[40:55], v[104:107], a[64:67], v[40:55]
  v_mfma_f32_32x32x16_bf16 v[56:71], v[104:107], a[68:71], v[56:71]
  ds_read_b128 v[116:119], v3 offset:3584
  v_mfma_f32_32x32x16_bf16 v[72:87], v[104:107], a[72:75], v[72:87]
  v_mfma_f32_32x32x16_bf16 v[88:103], v[104:107], a[76:79], v[88:103]
  s_waitcnt lgkmcnt(2)
  v_mfma_f32_32x32x16_bf16 v[40:55], v[108:111], a[80:83], v[40:55]
  v_mfma_f32_32x32x16_bf16 v[56:71], v[108:111], a[84:87], v[56:71]
  ds_read_b128 v[104:107], v3 offset:8192
  v_mfma_f32_32x32x16_bf16 v[72:87], v[108:111], a[88:91], v[72:87]
  v_mfma_f32_32x32x16_bf16 v[88:103], v[108:111], a[92:95], v[88:103]
  s_waitcnt lgkmcnt(2)
  v_mfma_f32_32x32x16_bf16 v[40:55], v[112:115], a[96:99], v[40:55]
  v_mfma_f32_32x32x16_bf16 v[56:71], v[112:115], a[100:103], v[56:71]
  ds_read_b128 v[108:111], v3 offset:8704
  v_mfma_f32_32x32x16_bf16 v[72:87], v[112:115], a[104:107], v[72:87]
  v_mfma_f32_32x32x16_bf16 v[88:103], v[112:115], a[108:111], v[88:103]
  s_waitcnt lgkmcnt(2)
  v_mfma_f32_32x32x16_bf16 v[40:55], v[116:119], a[112:115], v[40:55]
  v_mfma_f32_32x32x16_bf16 v[56:71], v[116:119], a[116:119], v[56:71]
  ds_read_b128 v[112:115], v3 offset:9216
  v_mfma_f32_32x32x16_bf16 v[72:87], v[116:119], a[120:123], v[72:87]
  v_mfma_f32_32x32x16_bf16 v[88:103], v[116:119], a[124:127], v[88:103]
  s_waitcnt lgkmcnt(2)
  v_mfma_f32_32x32x16_bf16 v[40:55], v[104:107], a[128:131], v[40:55]
  v_mfma_f32_32x32x16_bf16 v[56:71], v[104:107], a[132:135], v[56:71]
  ds_read_b128 v[116:119], v3 offset:9728
  v_mfma_f32_32x32x16_bf16 v[72:87], v[104:107], a[136:139], v[72:87]
  v_mfma_f32_32x32x16_bf16 v[88:103], v[104:107], a[140:143], v[88:103]
  s_waitcnt lgkmcnt(2)
  v_mfma_f32_32x32x16_bf16 v[40:55], v[108:111], a[144:147], v[40:55]
  v_mfma_f32_32x32x16_bf16 v[56:71], v[108:111], a[148:151], v[56:71]
  ds_read_b128 v[104:107], v3 offset:10240
  v_mfma_f32_32x32x16_bf16 v[72:87], v[108:111], a[152:155], v[72:87]
  v_mfma_f32_32x32x16_bf16 v[88:103], v[108:111], a[156:159], v[88:103]
  s_waitcnt lgkmcnt(2)
  v_mfma_f32_32x32x16_bf16 v[40:55], v[112:115], a[160:163], v[40:55]
  v_mfma_f32_32x32x16_bf16 v[56:71], v[112:115], a[164:167], v[56:71]
  ds_read_b128 v[108:111], v3 offset:10752
  v_mfma_f32_32x32x16_bf16 v[72:87], v[112:115], a[168:171], v[72:87]
  v_mfma_f32_32x32x16_bf16 v[88:103], v[112:115], a[172:175], v[88:103]
  s_waitcnt lgkmcnt(2)
  v_mfma_f32_32x32x16_bf16 v[40:55], v[116:119], a[176:179], v[40:55]
  v_mfma_f32_32x32x16_bf16 v[56:71], v[116:119], a[180:183], v[56:71]
  ds_read_b128 v[112:115], v3 offset:11264
  v_mfma_f32_32x32x16_bf16 v[72:87], v[116:119], a[184:187], v[72:87]
  v_mfma_f32_32x32x16_bf16 v[88:103], v[116:119], a[188:191], v[88:103]
  s_waitcnt lgkmcnt(2)
  v_mfma_f32_32x32x16_bf16 v[40:55], v[104:107], a[192:195], v[40:55]
  v_mfma_f32_32x32x16_bf16 v[56:71], v[104:107], a[196:199], v[56:71]
  ds_read_b128 v[116:119], v3 offset:11776
  s_waitcnt lgkmcnt(2)
  v_mfma_f32_32x32x16_bf16 v[40:55], v[108:111], a[208:211], v[40:55]
  v_mfma_f32_32x32x16_bf16 v[56:71], v[108:111], a[212:215], v[56:71]
  s_waitcnt lgkmcnt(1)
  v_mfma_f32_32x32x16_bf16 v[40:55], v[112:115], a[224:227], v[40:55]
  v_mfma_f32_32x32x16_bf16 v[56:71], v[112:115], a[228:231], v[56:71]
  s_waitcnt lgkmcnt(0)
  v_mfma_f32_32x32x16_bf16 v[40:55], v[116:119], a[240:243], v[40:55]
  v_mfma_f32_32x32x16_bf16 v[56:71], v[116:119], a[244:247], v[56:71]
  v_mfma_f32_32x32x16_bf16 v[72:87], v[104:107], a[200:203], v[72:87]
  v_mfma_f32_32x32x16_bf16 v[88:103], v[104:107], a[204:207], v[88:103]
  v_cvt_pk_bf16_f32 v212, v40, v56
  v_cvt_pk_bf16_f32 v214, v41, v57
  v_cvt_pk_bf16_f32 v216, v42, v58
  v_cvt_pk_bf16_f32 v218, v43, v59
  v_permlane16_swap_b32 v212, v214
  v_mfma_f32_32x32x16_bf16 v[72:87], v[108:111], a[216:219], v[72:87]
  v_cvt_pk_bf16_f32 v220, v44, v60
  v_cvt_pk_bf16_f32 v222, v45, v61
  v_permlane16_swap_b32 v216, v218
  v_bfi_b32 v212, v254, s42, v212
  v_cvt_pk_bf16_f32 v224, v46, v62
  v_mfma_f32_32x32x16_bf16 v[88:103], v[108:111], a[220:223], v[88:103]
  v_cvt_pk_bf16_f32 v226, v47, v63
  v_permlane16_swap_b32 v220, v222
  v_bfi_b32 v216, v254, s42, v216
  v_cvt_pk_bf16_f32 v228, v48, v64
  v_mfma_f32_32x32x16_bf16 v[72:87], v[112:115], a[232:235], v[72:87]
  v_cvt_pk_bf16_f32 v230, v49, v65
  v_permlane16_swap_b32 v224, v226
  v_bfi_b32 v220, v254, s42, v220
  v_cvt_pk_bf16_f32 v232, v50, v66
  v_cvt_pk_bf16_f32 v234, v51, v67
  v_mfma_f32_32x32x16_bf16 v[88:103], v[112:115], a[236:239], v[88:103]
  v_permlane16_swap_b32 v228, v230
  v_bfi_b32 v224, v254, s42, v224
  v_cvt_pk_bf16_f32 v236, v52, v68
  v_cvt_pk_bf16_f32 v238, v53, v69
  v_mfma_f32_32x32x16_bf16 v[72:87], v[116:119], a[248:251], v[72:87]
  v_permlane16_swap_b32 v232, v234
  v_bfi_b32 v228, v254, s42, v228
  v_cvt_pk_bf16_f32 v240, v54, v70
  v_cvt_pk_bf16_f32 v242, v55, v71
  v_permlane16_swap_b32 v236, v238
  v_mfma_f32_32x32x16_bf16 v[88:103], v[116:119], a[252:255], v[88:103]
  v_bfi_b32 v232, v254, s42, v232
  v_permlane16_swap_b32 v240, v242
  v_bfi_b32 v236, v254, s42, v236
  v_bfi_b32 v240, v254, s42, v240
  s_nop 7
  v_cvt_pk_bf16_f32 v213, v72, v88
  v_cvt_pk_bf16_f32 v215, v73, v89
  v_cvt_pk_bf16_f32 v217, v74, v90
  v_cvt_pk_bf16_f32 v219, v75, v91
  s_add_u32 s78, s86, 0
  v_permlane16_swap_b32 v213, v215
  buffer_store_dwordx4 v[212:215], v4, s[4:7], s78 offen sc1
  v_cvt_pk_bf16_f32 v221, v76, v92
  v_cvt_pk_bf16_f32 v223, v77, v93
  s_add_u32 s78, s86, 32768
  v_permlane16_swap_b32 v217, v219
  buffer_store_dwordx4 v[216:219], v4, s[4:7], s78 offen sc1
  v_cvt_pk_bf16_f32 v225, v78, v94
  v_cvt_pk_bf16_f32 v227, v79, v95
  s_add_u32 s78, s86, 131072
  v_permlane16_swap_b32 v221, v223
  buffer_store_dwordx4 v[220:223], v4, s[4:7], s78 offen sc1
  v_cvt_pk_bf16_f32 v229, v80, v96
  v_cvt_pk_bf16_f32 v231, v81, v97
  s_add_u32 s78, s86, 163840
  v_permlane16_swap_b32 v225, v227
  buffer_store_dwordx4 v[224:227], v4, s[4:7], s78 offen sc1
  v_cvt_pk_bf16_f32 v233, v82, v98
  v_cvt_pk_bf16_f32 v235, v83, v99
  s_add_u32 s78, s86, 262144
  v_permlane16_swap_b32 v229, v231
  buffer_store_dwordx4 v[228:231], v4, s[4:7], s78 offen sc1
  v_cvt_pk_bf16_f32 v237, v84, v100
  v_cvt_pk_bf16_f32 v239, v85, v101
  s_add_u32 s78, s86, 294912
  v_permlane16_swap_b32 v233, v235
  buffer_store_dwordx4 v[232:235], v4, s[4:7], s78 offen sc1
  v_cvt_pk_bf16_f32 v241, v86, v102
  v_cvt_pk_bf16_f32 v243, v87, v103
  s_add_u32 s78, s86, 393216
  v_permlane16_swap_b32 v237, v239
  buffer_store_dwordx4 v[236:239], v4, s[4:7], s78 offen sc1
  s_add_u32 s78, s86, 425984
  v_permlane16_swap_b32 v241, v243
  buffer_store_dwordx4 v[240:243], v4, s[4:7], s78 offen sc1
  s_branch o_we_207
o_wr1_205:
  s_nop 3
  v_mul_f32 v112, s24, v112
  v_mul_f32 v113, s24, v113
  v_exp_f32 v64, v112
  v_exp_f32 v65, v113
  v_max_f32 v116, v111, v116
  v_max3_f32 v116, v112, v113, v116
  v_add_f32 v117, v117, v64
  v_add_f32 v118, v118, v65
  v_add_f32 v117, v117, v118
  s_mov_b32 s28, 0x21800000
  v_mov_b32 v118, v117
  s_nop 1
  v_permlane16_swap_b32 v117, v118
  v_add_f32 v117, v117, v118
  v_mov_b32 v118, v117
  s_nop 0
  s_nop 0
  v_permlane32_swap_b32 v117, v118
  v_add_f32 v117, v117, v118
  s_mov_b32 s67, 0
  s_mov_b64 vcc, 0
  s_waitcnt vmcnt(3)
o_pl_213:
  v_and_b32 v7, 1, v7
  v_cmp_ne_u32 vcc, s96, v7
  s_cbranch_vccz o_pk_214
  buffer_load_dword v7, v255, s[4:7], s97 offen sc1
  s_add_u32 s67, s67, 1
  s_cmp_gt_u32 s67, 1048576
  s_cbranch_scc1 L_end
  s_waitcnt vmcnt(0)
  s_branch o_pl_213
o_pk_214:
  s_lshl_b32 s94, s43, 14
  s_add_u32 s94, s94, s95
  buffer_load_dwordx4 v[120:123], v5, s[4:7], s94 offen offset:0 sc1
  v_cmp_lt_f32 vcc, 0x42700000, v116
  v_cmp_gt_f32 s[30:31], s28, v117
  v_rcp_f32 v117, v117
  buffer_load_dwordx4 v[124:127], v5, s[4:7], s94 offen offset:512 sc1
  s_or_b64 vcc, vcc, s[30:31]
  s_cbranch_vccnz o_fb_211
o_fbr_212:
  buffer_load_dwordx4 v[128:131], v5, s[4:7], s94 offen offset:256 sc1
  v_pk_mul_f32 v[56:57], v[56:57], v[116:117] op_sel:[0,1] op_sel_hi:[1,1]
  v_pk_mul_f32 v[58:59], v[58:59], v[116:117] op_sel:[0,1] op_sel_hi:[1,1]
  v_pk_mul_f32 v[60:61], v[60:61], v[116:117] op_sel:[0,1] op_sel_hi:[1,1]
  v_pk_mul_f32 v[62:63], v[62:63], v[116:117] op_sel:[0,1] op_sel_hi:[1,1]
  v_pk_mul_f32 v[64:65], v[64:65], v[116:117] op_sel:[0,1] op_sel_hi:[1,1]
  buffer_load_dwordx4 v[132:135], v5, s[4:7], s94 offen offset:768 sc1
  v_cvt_pk_bf16_f32 v116, v56, v57
  v_cvt_pk_bf16_f32 v117, v58, v59
  v_cvt_pk_bf16_f32 v118, v60, v61
  v_cvt_pk_bf16_f32 v119, v62, v63
  s_waitcnt lgkmcnt(0)
  s_nop 0
  v_mfma_f32_16x16x32_bf16 v[72:75], v[152:155], v[116:119], 0
  s_add_u32 s62, s62, 1
  v_cvt_pk_bf16_f32 v197, v64, v65
  v_cvt_pk_bf16_f32 v198, v64, v65
  v_mfma_f32_16x16x32_bf16 v[76:79], v[156:159], v[116:119], 0
  s_add_u32 s94, s94, 4096
  buffer_load_dwordx4 v[136:139], v5, s[4:7], s94 offen offset:0 sc1
  s_xor_b32 s86, s86, 524288
  v_mfma_f32_16x16x32_bf16 v[80:83], v[160:163], v[116:119], 0
  s_bfe_u32 s42, s62, 0x10001
  v_mfma_f32_16x16x32_bf16 v[84:87], v[164:167], v[116:119], 0
  buffer_load_dwordx4 v[140:143], v5, s[4:7], s94 offen offset:512 sc1
  v_mfma_f32_16x16x32_bf16 v[88:91], v[168:171], v[116:119], 0
  v_mfma_f32_16x16x32_bf16 v[92:95], v[172:175], v[116:119], 0
  buffer_load_dwordx4 v[144:147], v5, s[4:7], s94 offen offset:256 sc1
  v_mfma_f32_16x16x32_bf16 v[96:99], v[176:179], v[116:119], 0
  v_mfma_f32_16x16x32_bf16 v[100:103], v[180:183], v[116:119], 0
  buffer_load_dwordx4 v[148:151], v5, s[4:7], s94 offen offset:768 sc1
  v_mfma_f32_16x16x16_bf16 v[72:75], v[200:201], v[198:199], v[72:75]
  s_nop 1
  v_mfma_f32_16x16x16_bf16 v[76:79], v[200:201], v[196:197], v[76:79]
  s_add_u32 s94, s94, 4096
  buffer_load_dwordx4 v[152:155], v5, s[4:7], s94 offen offset:0 sc1
  v_mfma_f32_16x16x16_bf16 v[80:83], v[202:203], v[198:199], v[80:83]
  s_nop 1
  v_mfma_f32_16x16x16_bf16 v[84:87], v[202:203], v[196:197], v[84:87]
  buffer_load_dwordx4 v[156:159], v5, s[4:7], s94 offen offset:512 sc1
  v_mfma_f32_16x16x16_bf16 v[88:91], v[204:205], v[198:199], v[88:91]
  s_nop 0
  v_cvt_pk_bf16_f32 v40, v72, v73
  v_cvt_pk_bf16_f32 v41, v74, v75
  v_mfma_f32_16x16x16_bf16 v[92:95], v[204:205], v[196:197], v[92:95]
  buffer_load_dwordx4 v[160:163], v5, s[4:7], s94 offen offset:256 sc1
  v_cvt_pk_bf16_f32 v42, v76, v77
  v_cvt_pk_bf16_f32 v43, v78, v79
  v_mfma_f32_16x16x16_bf16 v[96:99], v[206:207], v[198:199], v[96:99]
  s_nop 0
  ds_write_b128 v6, v[40:43] offset:0
  v_cvt_pk_bf16_f32 v44, v80, v81
  v_mfma_f32_16x16x16_bf16 v[100:103], v[206:207], v[196:197], v[100:103]
  buffer_load_dwordx4 v[164:167], v5, s[4:7], s94 offen offset:768 sc1
  v_cvt_pk_bf16_f32 v45, v82, v83
  v_cvt_pk_bf16_f32 v46, v84, v85
  v_cvt_pk_bf16_f32 v47, v86, v87
  ds_write_b128 v6, v[44:47] offset:1024
  v_cvt_pk_bf16_f32 v48, v88, v89
  v_cvt_pk_bf16_f32 v49, v90, v91
  v_cvt_pk_bf16_f32 v50, v92, v93
  v_cvt_pk_bf16_f32 v51, v94, v95
  s_add_u32 s94, s94, 4096
  buffer_load_dwordx4 v[168:171], v5, s[4:7], s94 offen offset:0 sc1
  ds_write_b128 v6, v[48:51] offset:2048
  v_cvt_pk_bf16_f32 v52, v96, v97
  v_cvt_pk_bf16_f32 v53, v98, v99
  v_cvt_pk_bf16_f32 v54, v100, v101
  v_cvt_pk_bf16_f32 v55, v102, v103
  ds_write_b128 v6, v[52:55] offset:3072
  buffer_load_dwordx4 v[172:175], v5, s[4:7], s94 offen offset:512 sc1
  s_and_b32 s26, s65, 49152
  s_cbranch_scc1 o_wr2_206
  s_waitcnt lgkmcnt(0)
  s_barrier
  ds_read_b128 v[104:107], v3 offset:0
  ds_read_b128 v[108:111], v3 offset:512
  ds_read_b128 v[112:115], v3 offset:1024
  buffer_load_dwordx4 v[176:179], v5, s[4:7], s94 offen offset:256 sc1
  buffer_load_dwordx4 v[180:183], v5, s[4:7], s94 offen offset:768 sc1
  s_waitcnt lgkmcnt(2)
  v_mfma_f32_32x32x16_bf16 v[40:55], v[104:107], a[0:3], 0
  v_mov_b64 v[188:189], 0
  v_mov_b64 v[190:191], 0
  v_mov_b64 v[192:193], 0
  v_mov_b64 v[194:195], 0
  s_mov_b64 exec, 1
  buffer_store_dword v38, off, s[4:7], s84 sc1
  s_mov_b64 exec, -1
  s_mov_b32 s84, 268435456
  v_mfma_f32_32x32x16_bf16 v[56:71], v[104:107], a[4:7], 0
  ds_read_b128 v[116:119], v3 offset:1536
  v_mfma_f32_32x32x16_bf16 v[72:87], v[104:107], a[8:11], 0
  v_mfma_f32_32x32x16_bf16 v[88:103], v[104:107], a[12:15], 0
  s_waitcnt vmcnt(13)
  v_xor_b32 v7, s96, v120
  v_bitop3_b32 v7, v7, v124, s96 bitop3:0xf6
  v_bitop3_b32 v7, v7, v128, s96 bitop3:0xf6
  v_bitop3_b32 v7, v7, v132, s96 bitop3:0xf6
  s_waitcnt lgkmcnt(2)
  v_mfma_f32_32x32x16_bf16 v[40:55], v[108:111], a[16:19], v[40:55]
  s_waitcnt vmcnt(9)
  v_bitop3_b32 v7, v7, v136, s96 bitop3:0xf6
  v_bitop3_b32 v7, v7, v140, s96 bitop3:0xf6
  v_bitop3_b32 v7, v7, v144, s96 bitop3:0xf6
  v_bitop3_b32 v7, v7, v148, s96 bitop3:0xf6
  s_waitcnt vmcnt(5)
  v_mfma_f32_32x32x16_bf16 v[56:71], v[108:111], a[20:23], v[56:71]
  ds_read_b128 v[104:107], v3 offset:2048
  v_bitop3_b32 v7, v7, v152, s96 bitop3:0xf6
  v_bitop3_b32 v7, v7, v156, s96 bitop3:0xf6
  v_bitop3_b32 v7, v7, v160, s96 bitop3:0xf6
  v_bitop3_b32 v7, v7, v164, s96 bitop3:0xf6
  s_waitcnt vmcnt(1)
  v_mfma_f32_32x32x16_bf16 v[72:87], v[108:111], a[24:27], v[72:87]
  v_bitop3_b32 v7, v7, v168, s96 bitop3:0xf6
  v_bitop3_b32 v7, v7, v172, s96 bitop3:0xf6
  v_bitop3_b32 v7, v7, v176, s96 bitop3:0xf6
  v_bitop3_b32 v7, v7, v180, s96 bitop3:0xf6
  v_and_b32 v7, v254, v7
  v_cmp_ne_u32 vcc, 0, v7
  s_cbranch_vccnz o_rt_215
o_bk_216:
  v_mfma_f32_32x32x16_bf16 v[88:103], v[108:111], a[28:31], v[88:103]
  v_smfmac_f32_16x16x64_bf16 v[188:191], v[16:19], v[120:127], v20
  v_lshlrev_b32 v196, 16, v184
  v_smfmac_f32_16x16x64_bf16 v[192:195], v[16:19], v[128:135], v20
  v_and_b32 v197, 0xffff0000, v184
  v_smfmac_f32_16x16x64_bf16 v[188:191], v[16:19], v[136:143], v20
  v_lshlrev_b32 v198, 16, v185
  s_waitcnt lgkmcnt(2)
  v_mfma_f32_32x32x16_bf16 v[40:55], v[112:115], a[32:35], v[40:55]
  v_smfmac_f32_16x16x64_bf16 v[192:195], v[16:19], v[144:151], v20
  v_and_b32 v199, 0xffff0000, v185
  v_smfmac_f32_16x16x64_bf16 v[188:191], v[16:19], v[152:159], v20
  v_lshlrev_b32 v200, 16, v186
  v_smfmac_f32_16x16x64_bf16 v[192:195], v[16:19], v[160:167], v20
  v_and_b32 v201, 0xffff0000, v186
  v_mfma_f32_32x32x16_bf16 v[56:71], v[112:115], a[36:39], v[56:71]
  ds_read_b128 v[108:111], v3 offset:2560
  v_smfmac_f32_16x16x64_bf16 v[188:191], v[16:19], v[168:175], v20
  v_lshlrev_b32 v202, 16, v187
  v_smfmac_f32_16x16x64_bf16 v[192:195], v[16:19], v[176:183], v20
  v_and_b32 v203, 0xffff0000, v187
  s_bfe_u32 s92, s65, 131086
  v_mfma_f32_32x32x16_bf16 v[72:87], v[112:115], a[40:43], v[72:87]
  s_lshl_b32 s92, s92, 21
  s_add_u32 s92, s92, s91
  s_add_u32 s93, s92, 27262976
  s_add_u32 s92, s92, 20971520
  v_permlane16_swap_b32 v188, v192
  v_mfma_f32_32x32x16_bf16 v[88:103], v[112:115], a[44:47], v[88:103]
  v_permlane16_swap_b32 v189, v193
  v_permlane16_swap_b32 v190, v194
  v_permlane16_swap_b32 v191, v195
  s_waitcnt lgkmcnt(2)
  v_mfma_f32_32x32x16_bf16 v[40:55], v[116:119], a[48:51], v[40:55]
  v_cvt_pk_bf16_f32 v188, 0, v188
  v_cvt_pk_bf16_f32 v189, 0, v189
  v_cvt_pk_bf16_f32 v190, 0, v190
  v_cvt_pk_bf16_f32 v191, 0, v191
  v_cvt_pk_bf16_f32 v192, 0, v192
  v_cvt_pk_bf16_f32 v193, 0, v193
  v_mfma_f32_32x32x16_bf16 v[56:71], v[116:119], a[52:55], v[56:71]
  ds_read_b128 v[112:115], v3 offset:3072
  v_cvt_pk_bf16_f32 v194, 0, v194
  v_cvt_pk_bf16_f32 v195, 0, v195
  v_add_f32 v196, v196, v188
  v_add_f32 v197, v197, v189
  v_add_f32 v198, v198, v190
  v_mfma_f32_32x32x16_bf16 v[72:87], v[116:119], a[56:59], v[72:87]
  v_add_f32 v199, v199, v191
  v_add_f32 v200, v200, v192
  v_add_f32 v201, v201, v193
  v_add_f32 v202, v202, v194
  v_add_f32 v203, v203, v195
  v_cvt_pk_bf16_f32 v120, v196, v197
  v_mfma_f32_32x32x16_bf16 v[88:103], v[116:119], a[60:63], v[88:103]
  v_cvt_pk_bf16_f32 v121, v198, v199
  v_cvt_pk_bf16_f32 v122, v200, v201
  v_cvt_pk_bf16_f32 v123, v202, v203
  v_lshlrev_b32 v196, 16, v120
  v_and_b32 v197, 0xffff0000, v120
  s_waitcnt lgkmcnt(2)
  v_mfma_f32_32x32x16_bf16 v[40:55], v[104:107], a[64:67], v[40:55]
  v_lshlrev_b32 v198, 16, v121
  v_and_b32 v199, 0xffff0000, v121
  v_lshlrev_b32 v200, 16, v122
  v_and_b32 v201, 0xffff0000, v122
  v_lshlrev_b32 v202, 16, v123
  v_and_b32 v203, 0xffff0000, v123
  v_mfma_f32_32x32x16_bf16 v[56:71], v[104:107], a[68:71], v[56:71]
  ds_read_b128 v[116:119], v3 offset:3584
  buffer_store_dwordx4 v[120:123], v0, s[4:7], s92 offen sc1
  v_add_f32 v136, v196, v197
  v_mul_f32 v137, v196, v196
  v_mfma_f32_32x32x16_bf16 v[72:87], v[104:107], a[72:75], v[72:87]
  v_add_f32 v138, v198, v199
  v_mul_f32 v139, v197, v197
  v_fmac_f32 v137, v198, v198
  v_fmac_f32 v139, v199, v199
  v_add_f32 v136, v136, v200
  v_fmac_f32 v137, v200, v200
  v_mfma_f32_32x32x16_bf16 v[88:103], v[104:107], a[76:79], v[88:103]
  v_add_f32 v138, v138, v201
  v_fmac_f32 v139, v201, v201
  v_add_f32 v136, v136, v202
  v_fmac_f32 v137, v202, v202
  v_add_f32 v138, v138, v203
  s_waitcnt lgkmcnt(2)
  v_mfma_f32_32x32x16_bf16 v[40:55], v[108:111], a[80:83], v[40:55]
  v_fmac_f32 v139, v203, v203
  v_add_f32 v136, v136, v138
  v_add_f32 v137, v137, v139
  s_nop 0
  v_add_f32_dpp v136, v136, v136 row_ror:8 row_mask:0xf bank_mask:0xf
  v_add_f32_dpp v137, v137, v137 row_ror:8 row_mask:0xf bank_mask:0xf
  s_nop 0
  v_add_f32_dpp v136, v136, v136 row_ror:4 row_mask:0xf bank_mask:0xf
  v_mfma_f32_32x32x16_bf16 v[56:71], v[108:111], a[84:87], v[56:71]
  ds_read_b128 v[104:107], v3 offset:8192
  v_add_f32_dpp v137, v137, v137 row_ror:4 row_mask:0xf bank_mask:0xf
  v_add_f32_dpp v136, v136, v136 row_ror:2 row_mask:0xf bank_mask:0xf
  s_nop 0
  v_add_f32_dpp v137, v137, v137 row_ror:2 row_mask:0xf bank_mask:0xf
  v_add_f32_dpp v136, v136, v136 row_ror:1 row_mask:0xf bank_mask:0xf
  s_nop 0
  v_add_f32_dpp v137, v137, v137 row_ror:1 row_mask:0xf bank_mask:0xf
  v_mfma_f32_32x32x16_bf16 v[72:87], v[108:111], a[88:91], v[72:87]
  v_mov_b32 v140, v136
  v_mov_b32 v141, v137
  s_nop 0
  v_permlane16_swap_b32 v136, v140
  v_permlane16_swap_b32 v137, v141
  v_mfma_f32_32x32x16_bf16 v[88:103], v[108:111], a[92:95], v[88:103]
  v_add_f32 v136, v136, v140
  v_add_f32 v137, v137, v141
  v_mov_b32 v140, v136
  v_mov_b32 v141, v137
  s_nop 0
  v_permlane32_swap_b32 v136, v140
  s_waitcnt lgkmcnt(2)
  v_mfma_f32_32x32x16_bf16 v[40:55], v[112:115], a[96:99], v[40:55]
  v_permlane32_swap_b32 v137, v141
  v_add_f32 v136, v136, v140
  v_add_f32 v137, v137, v141
  v_mul_f32 v136, 0x3b000000, v136
  v_mul_f32 v137, 0x3b000000, v137
  v_mfma_f32_32x32x16_bf16 v[56:71], v[112:115], a[100:103], v[56:71]
  ds_read_b128 v[108:111], v3 offset:8704
  v_fma_f32 v137, -v136, v136, v137
  v_cvt_pk_bf16_f32 v136, 0, v136
  v_max_f32 v137, 0, v137
  v_sub_f32 v140, v196, v136
  v_sub_f32 v141, v197, v136
  v_mfma_f32_32x32x16_bf16 v[72:87], v[112:115], a[104:107], v[72:87]
  v_cvt_pk_bf16_f32 v137, 0, v137
  v_sub_f32 v142, v198, v136
  v_sub_f32 v143, v199, v136
  v_add_f32 v137, 0x3727c5ac, v137
  v_sub_f32 v144, v200, v136
  v_sub_f32 v145, v201, v136
  v_mfma_f32_32x32x16_bf16 v[88:103], v[112:115], a[108:111], v[88:103]
  v_cvt_pk_bf16_f32 v137, 0, v137
  v_sub_f32 v146, v202, v136
  v_sub_f32 v147, v203, v136
  v_sqrt_f32 v137, v137
  s_waitcnt lgkmcnt(2)
  v_mfma_f32_32x32x16_bf16 v[40:55], v[116:119], a[112:115], v[40:55]
  v_cvt_pk_bf16_f32 v140, 0, v140
  v_cvt_pk_bf16_f32 v141, 0, v141
  v_cvt_pk_bf16_f32 v137, 0, v137
  v_cvt_pk_bf16_f32 v142, 0, v142
  v_cvt_pk_bf16_f32 v143, 0, v143
  v_rcp_f32 v137, v137
  v_mfma_f32_32x32x16_bf16 v[56:71], v[116:119], a[116:119], v[56:71]
  ds_read_b128 v[112:115], v3 offset:9216
  v_cvt_pk_bf16_f32 v144, 0, v144
  v_cvt_pk_bf16_f32 v145, 0, v145
  v_cvt_pk_bf16_f32 v146, 0, v146
  v_cvt_pk_bf16_f32 v147, 0, v147
  v_mul_f32 v140, v140, v137
  v_mfma_f32_32x32x16_bf16 v[72:87], v[116:119], a[120:123], v[72:87]
  v_mul_f32 v141, v141, v137
  v_mul_f32 v142, v142, v137
  v_mul_f32 v143, v143, v137
  v_mul_f32 v144, v144, v137
  v_mul_f32 v145, v145, v137
  v_mul_f32 v146, v146, v137
  v_mfma_f32_32x32x16_bf16 v[88:103], v[116:119], a[124:127], v[88:103]
  v_mul_f32 v147, v147, v137
  v_cvt_pk_bf16_f32 v124, v140, v141
  v_cvt_pk_bf16_f32 v125, v142, v143
  v_cvt_pk_bf16_f32 v126, v144, v145
  v_cvt_pk_bf16_f32 v127, v146, v147
  s_waitcnt lgkmcnt(2)
  v_mfma_f32_32x32x16_bf16 v[40:55], v[104:107], a[128:131], v[40:55]
  v_lshlrev_b32 v204, 16, v124
  v_and_b32 v205, 0xffff0000, v124
  v_lshlrev_b32 v206, 16, v125
  v_and_b32 v207, 0xffff0000, v125
  v_lshlrev_b32 v208, 16, v126
  v_and_b32 v209, 0xffff0000, v126
  v_mfma_f32_32x32x16_bf16 v[56:71], v[104:107], a[132:135], v[56:71]
  ds_read_b128 v[116:119], v3 offset:9728
  v_lshlrev_b32 v210, 16, v127
  v_and_b32 v211, 0xffff0000, v127
  buffer_store_dwordx4 v[124:127], v0, s[4:7], s93 offen sc1
  v_mfma_f32_32x32x16_bf16 v[72:87], v[104:107], a[136:139], v[72:87]
  v_add_f32 v196, v196, v204
  v_add_f32 v197, v197, v205
  v_add_f32 v198, v198, v206
  v_add_f32 v199, v199, v207
  v_add_f32 v200, v200, v208
  v_add_f32 v201, v201, v209
  v_mfma_f32_32x32x16_bf16 v[88:103], v[104:107], a[140:143], v[88:103]
  v_add_f32 v202, v202, v210
  v_add_f32 v203, v203, v211
  v_cvt_pk_bf16_f32 v128, v196, v197
  v_cvt_pk_bf16_f32 v129, v198, v199
  v_cvt_pk_bf16_f32 v130, v200, v201
  s_waitcnt lgkmcnt(2)
  v_mfma_f32_32x32x16_bf16 v[40:55], v[108:111], a[144:147], v[40:55]
  v_cvt_pk_bf16_f32 v131, v202, v203
  v_mul_f32 v188, v204, v8
  v_mul_f32 v189, v205, v9
  v_fmac_f32 v188, v206, v10
  v_fmac_f32 v189, v207, v11
  v_fmac_f32 v188, v208, v12
  v_mfma_f32_32x32x16_bf16 v[56:71], v[108:111], a[148:151], v[56:71]
  ds_read_b128 v[104:107], v3 offset:10240
  v_fmac_f32 v189, v209, v13
  v_fmac_f32 v188, v210, v14
  v_fmac_f32 v189, v211, v15
  v_add_f32 v188, v188, v189
  s_add_u32 s92, s91, 10485760
  v_mfma_f32_32x32x16_bf16 v[72:87], v[108:111], a[152:155], v[72:87]
  s_add_u32 s93, s91, 8388608
  buffer_store_dwordx4 v[128:131], v0, s[4:7], s92 offen sc1
  v_lshlrev_b32 v196, 16, v128
  v_and_b32 v197, 0xffff0000, v128
  v_mfma_f32_32x32x16_bf16 v[88:103], v[108:111], a[156:159], v[88:103]
  v_lshlrev_b32 v198, 16, v129
  v_and_b32 v199, 0xffff0000, v129
  v_lshlrev_b32 v200, 16, v130
  v_and_b32 v201, 0xffff0000, v130
  v_lshlrev_b32 v202, 16, v131
  s_waitcnt lgkmcnt(2)
  v_mfma_f32_32x32x16_bf16 v[40:55], v[112:115], a[160:163], v[40:55]
  v_and_b32 v203, 0xffff0000, v131
  v_add_f32 v136, v196, v197
  v_mul_f32 v137, v196, v196
  v_add_f32 v138, v198, v199
  v_mul_f32 v139, v197, v197
  v_fmac_f32 v137, v198, v198
  v_mfma_f32_32x32x16_bf16 v[56:71], v[112:115], a[164:167], v[56:71]
  ds_read_b128 v[108:111], v3 offset:10752
  v_fmac_f32 v139, v199, v199
  v_add_f32 v136, v136, v200
  v_fmac_f32 v137, v200, v200
  v_add_f32 v138, v138, v201
  v_fmac_f32 v139, v201, v201
  v_mfma_f32_32x32x16_bf16 v[72:87], v[112:115], a[168:171], v[72:87]
  v_add_f32 v136, v136, v202
  v_fmac_f32 v137, v202, v202
  v_add_f32 v138, v138, v203
  v_fmac_f32 v139, v203, v203
  v_add_f32 v136, v136, v138
  v_add_f32 v137, v137, v139
  v_mfma_f32_32x32x16_bf16 v[88:103], v[112:115], a[172:175], v[88:103]
  v_add_f32_dpp v136, v136, v136 row_ror:8 row_mask:0xf bank_mask:0xf
  v_add_f32_dpp v137, v137, v137 row_ror:8 row_mask:0xf bank_mask:0xf
  v_add_f32_dpp v188, v188, v188 row_ror:8 row_mask:0xf bank_mask:0xf
  v_add_f32_dpp v136, v136, v136 row_ror:4 row_mask:0xf bank_mask:0xf
  v_add_f32_dpp v137, v137, v137 row_ror:4 row_mask:0xf bank_mask:0xf
  s_waitcnt lgkmcnt(2)
  v_mfma_f32_32x32x16_bf16 v[40:55], v[116:119], a[176:179], v[40:55]
  v_add_f32_dpp v188, v188, v188 row_ror:4 row_mask:0xf bank_mask:0xf
  v_add_f32_dpp v136, v136, v136 row_ror:2 row_mask:0xf bank_mask:0xf
  v_add_f32_dpp v137, v137, v137 row_ror:2 row_mask:0xf bank_mask:0xf
  v_add_f32_dpp v188, v188, v188 row_ror:2 row_mask:0xf bank_mask:0xf
  v_add_f32_dpp v136, v136, v136 row_ror:1 row_mask:0xf bank_mask:0xf
  v_add_f32_dpp v137, v137, v137 row_ror:1 row_mask:0xf bank_mask:0xf
  v_mfma_f32_32x32x16_bf16 v[56:71], v[116:119], a[180:183], v[56:71]
  ds_read_b128 v[112:115], v3 offset:11264
  v_add_f32_dpp v188, v188, v188 row_ror:1 row_mask:0xf bank_mask:0xf
  v_mov_b32 v140, v136
  v_mov_b32 v141, v137
  v_mov_b32 v142, v188
  v_permlane16_swap_b32 v136, v140
  v_mfma_f32_32x32x16_bf16 v[72:87], v[116:119], a[184:187], v[72:87]
  v_permlane16_swap_b32 v137, v141
  v_permlane16_swap_b32 v188, v142
  v_add_f32 v136, v136, v140
  v_add_f32 v137, v137, v141
  v_mfma_f32_32x32x16_bf16 v[88:103], v[116:119], a[188:191], v[88:103]
  v_add_f32 v188, v188, v142
  v_mov_b32 v140, v136
  v_mov_b32 v141, v137
  v_mov_b32 v142, v188
  v_permlane32_swap_b32 v136, v140
  s_waitcnt lgkmcnt(2)
  v_mfma_f32_32x32x16_bf16 v[40:55], v[104:107], a[192:195], v[40:55]
  v_permlane32_swap_b32 v137, v141
  v_permlane32_swap_b32 v188, v142
  v_add_f32 v136, v136, v140
  v_add_f32 v137, v137, v141
  v_mfma_f32_32x32x16_bf16 v[56:71], v[104:107], a[196:199], v[56:71]
  ds_read_b128 v[116:119], v3 offset:11776
  v_add_f32 v188, v188, v142
  v_mul_f32 v136, 0x3b000000, v136
  v_mul_f32 v137, 0x3b000000, v137
  v_fma_f32 v137, -v136, v136, v137
  v_cvt_pk_bf16_f32 v136, 0, v136
  s_waitcnt lgkmcnt(2)
  v_mfma_f32_32x32x16_bf16 v[40:55], v[108:111], a[208:211], v[40:55]
  v_max_f32 v137, 0, v137
  v_sub_f32 v140, v196, v136
  v_sub_f32 v141, v197, v136
  v_cvt_pk_bf16_f32 v137, 0, v137
  v_sub_f32 v142, v198, v136
  v_sub_f32 v143, v199, v136
  v_mfma_f32_32x32x16_bf16 v[56:71], v[108:111], a[212:215], v[56:71]
  v_add_f32 v137, 0x3727c5ac, v137
  v_sub_f32 v144, v200, v136
  v_sub_f32 v145, v201, v136
  v_cvt_pk_bf16_f32 v137, 0, v137
  v_sub_f32 v146, v202, v136
  v_sub_f32 v147, v203, v136
  s_waitcnt lgkmcnt(1)
  v_mfma_f32_32x32x16_bf16 v[40:55], v[112:115], a[224:227], v[40:55]
  v_sqrt_f32 v137, v137
  v_cvt_pk_bf16_f32 v140, 0, v140
  v_cvt_pk_bf16_f32 v141, 0, v141
  v_cvt_pk_bf16_f32 v137, 0, v137
  v_cvt_pk_bf16_f32 v142, 0, v142
  v_mfma_f32_32x32x16_bf16 v[56:71], v[112:115], a[228:231], v[56:71]
  v_cvt_pk_bf16_f32 v143, 0, v143
  v_rcp_f32 v137, v137
  v_cvt_pk_bf16_f32 v144, 0, v144
  v_cvt_pk_bf16_f32 v145, 0, v145
  v_cvt_pk_bf16_f32 v146, 0, v146
  s_waitcnt lgkmcnt(0)
  v_mfma_f32_32x32x16_bf16 v[40:55], v[116:119], a[240:243], v[40:55]
  v_cvt_pk_bf16_f32 v147, 0, v147
  v_mul_f32 v140, v140, v137
  v_mul_f32 v141, v141, v137
  v_mul_f32 v142, v142, v137
  v_mul_f32 v143, v143, v137
  v_mul_f32 v144, v144, v137
  v_mfma_f32_32x32x16_bf16 v[56:71], v[116:119], a[244:247], v[56:71]
  v_mul_f32 v145, v145, v137
  v_mul_f32 v146, v146, v137
  v_mul_f32 v147, v147, v137
  v_cvt_pk_bf16_f32 v132, v140, v141
  v_cvt_pk_bf16_f32 v133, v142, v143
  v_cvt_pk_bf16_f32 v134, v144, v145
  v_mfma_f32_32x32x16_bf16 v[72:87], v[104:107], a[200:203], v[72:87]
  v_cvt_pk_bf16_f32 v135, v146, v147
  buffer_store_dwordx4 v[132:135], v0, s[4:7], s93 offen sc1
  v_cvt_pk_bf16_f32 v188, 0, v188
  v_ashrrev_i32 v189, 31, v188
  v_mfma_f32_32x32x16_bf16 v[88:103], v[104:107], a[204:207], v[88:103]
  v_or_b32 v189, 0x80000000, v189
  v_xor_b32 v188, v188, v189
  s_sub_u32 s92, 4095, s90
  v_and_b32 v188, 0xffff0000, v188
  v_or_b32 v38, s92, v188
  v_mfma_f32_32x32x16_bf16 v[72:87], v[108:111], a[216:219], v[72:87]
  s_bfe_u32 s92, s65, 196625
  s_lshl_b32 s92, s92, 18
  s_lshl_b32 s93, s90, 7
  s_add_u32 s92, s92, s93
  s_add_u32 s84, s92, 243269632
  v_cvt_pk_bf16_f32 v212, v40, v56
  v_mfma_f32_32x32x16_bf16 v[88:103], v[108:111], a[220:223], v[88:103]
  v_cvt_pk_bf16_f32 v214, v41, v57
  v_cvt_pk_bf16_f32 v216, v42, v58
  v_cvt_pk_bf16_f32 v218, v43, v59
  v_permlane16_swap_b32 v212, v214
  v_mfma_f32_32x32x16_bf16 v[72:87], v[112:115], a[232:235], v[72:87]
  v_cvt_pk_bf16_f32 v220, v44, v60
  v_cvt_pk_bf16_f32 v222, v45, v61
  v_permlane16_swap_b32 v216, v218
  v_bfi_b32 v212, v254, s42, v212
  v_cvt_pk_bf16_f32 v224, v46, v62
  v_mfma_f32_32x32x16_bf16 v[88:103], v[112:115], a[236:239], v[88:103]
  v_cvt_pk_bf16_f32 v226, v47, v63
  v_permlane16_swap_b32 v220, v222
  v_bfi_b32 v216, v254, s42, v216
  v_cvt_pk_bf16_f32 v228, v48, v64
  v_mfma_f32_32x32x16_bf16 v[72:87], v[116:119], a[248:251], v[72:87]
  v_cvt_pk_bf16_f32 v230, v49, v65
  v_permlane16_swap_b32 v224, v226
  v_bfi_b32 v220, v254, s42, v220
  v_cvt_pk_bf16_f32 v232, v50, v66
  v_cvt_pk_bf16_f32 v234, v51, v67
  v_mfma_f32_32x32x16_bf16 v[88:103], v[116:119], a[252:255], v[88:103]
  v_permlane16_swap_b32 v228, v230
  v_bfi_b32 v224, v254, s42, v224
  v_cvt_pk_bf16_f32 v236, v52, v68
  v_cvt_pk_bf16_f32 v238, v53, v69
  v_permlane16_swap_b32 v232, v234
  v_bfi_b32 v228, v254, s42, v228
  v_cvt_pk_bf16_f32 v240, v54, v70
  v_cvt_pk_bf16_f32 v242, v55, v71
  v_permlane16_swap_b32 v236, v238
  v_bfi_b32 v232, v254, s42, v232
  v_permlane16_swap_b32 v240, v242
  v_bfi_b32 v236, v254, s42, v236
  v_bfi_b32 v240, v254, s42, v240
  v_cvt_pk_bf16_f32 v213, v72, v88
  v_cvt_pk_bf16_f32 v215, v73, v89
  v_cvt_pk_bf16_f32 v217, v74, v90
  v_cvt_pk_bf16_f32 v219, v75, v91
  s_add_u32 s78, s86, 0
  v_permlane16_swap_b32 v213, v215
  buffer_store_dwordx4 v[212:215], v4, s[4:7], s78 offen sc1
  v_cvt_pk_bf16_f32 v221, v76, v92
  v_cvt_pk_bf16_f32 v223, v77, v93
  s_add_u32 s78, s86, 32768
  v_permlane16_swap_b32 v217, v219
  buffer_store_dwordx4 v[216:219], v4, s[4:7], s78 offen sc1
  v_cvt_pk_bf16_f32 v225, v78, v94
  v_cvt_pk_bf16_f32 v227, v79, v95
  s_add_u32 s78, s86, 131072
  v_permlane16_swap_b32 v221, v223
  buffer_store_dwordx4 v[220:223], v4, s[4:7], s78 offen sc1
  v_cvt_pk_bf16_f32 v229, v80, v96
  v_cvt_pk_bf16_f32 v231, v81, v97
  s_add_u32 s78, s86, 163840
  v_permlane16_swap_b32 v225, v227
  buffer_store_dwordx4 v[224:227], v4, s[4:7], s78 offen sc1
  v_cvt_pk_bf16_f32 v233, v82, v98
  v_cvt_pk_bf16_f32 v235, v83, v99
  s_add_u32 s78, s86, 262144
  v_permlane16_swap_b32 v229, v231
  buffer_store_dwordx4 v[228:231], v4, s[4:7], s78 offen sc1
  v_cvt_pk_bf16_f32 v237, v84, v100
  v_cvt_pk_bf16_f32 v239, v85, v101
  s_add_u32 s78, s86, 294912
  v_permlane16_swap_b32 v233, v235
  buffer_store_dwordx4 v[232:235], v4, s[4:7], s78 offen sc1
  v_cvt_pk_bf16_f32 v241, v86, v102
  v_cvt_pk_bf16_f32 v243, v87, v103
  s_add_u32 s78, s86, 393216
  v_permlane16_swap_b32 v237, v239
  buffer_store_dwordx4 v[236:239], v4, s[4:7], s78 offen sc1
  s_add_u32 s78, s86, 425984
  v_permlane16_swap_b32 v241, v243
  buffer_store_dwordx4 v[240:243], v4, s[4:7], s78 offen sc1
  s_waitcnt vmcnt(8)
  s_mov_b64 exec, 1
  buffer_store_dword v38, off, s[4:7], s84 sc1
  s_mov_b64 exec, -1
  s_mov_b32 s84, 268435456
  s_branch o_we_207
o_rt_215:
  s_mov_b32 s67, 0
o_rl_219:
  s_lshl_b32 s94, s43, 14
  s_add_u32 s94, s94, s95
  buffer_load_dwordx4 v[120:123], v5, s[4:7], s94 offen offset:0 sc1
  buffer_load_dwordx4 v[124:127], v5, s[4:7], s94 offen offset:512 sc1
  buffer_load_dwordx4 v[128:131], v5, s[4:7], s94 offen offset:256 sc1
  buffer_load_dwordx4 v[132:135], v5, s[4:7], s94 offen offset:768 sc1
  s_add_u32 s94, s94, 4096
  buffer_load_dwordx4 v[136:139], v5, s[4:7], s94 offen offset:0 sc1
  buffer_load_dwordx4 v[140:143], v5, s[4:7], s94 offen offset:512 sc1
  buffer_load_dwordx4 v[144:147], v5, s[4:7], s94 offen offset:256 sc1
  buffer_load_dwordx4 v[148:151], v5, s[4:7], s94 offen offset:768 sc1
  s_add_u32 s94, s94, 4096
  buffer_load_dwordx4 v[152:155], v5, s[4:7], s94 offen offset:0 sc1
  buffer_load_dwordx4 v[156:159], v5, s[4:7], s94 offen offset:512 sc1
  buffer_load_dwordx4 v[160:163], v5, s[4:7], s94 offen offset:256 sc1
  buffer_load_dwordx4 v[164:167], v5, s[4:7], s94 offen offset:768 sc1
  s_add_u32 s94, s94, 4096
  buffer_load_dwordx4 v[168:171], v5, s[4:7], s94 offen offset:0 sc1
  buffer_load_dwordx4 v[172:175], v5, s[4:7], s94 offen offset:512 sc1
  buffer_load_dwordx4 v[176:179], v5, s[4:7], s94 offen offset:256 sc1
  buffer_load_dwordx4 v[180:183], v5, s[4:7], s94 offen offset:768 sc1
  s_add_u32 s67, s67, 1
  s_cmp_gt_u32 s67, 1048576
  s_cbranch_scc1 L_end
  s_waitcnt vmcnt(0)
  v_xor_b32 v7, s96, v120
  v_bitop3_b32 v7, v7, v124, s96 bitop3:0xf6
  v_bitop3_b32 v7, v7, v128, s96 bitop3:0xf6
  v_bitop3_b32 v7, v7, v132, s96 bitop3:0xf6
  v_bitop3_b32 v7, v7, v136, s96 bitop3:0xf6
  v_bitop3_b32 v7, v7, v140, s96 bitop3:0xf6
  v_bitop3_b32 v7, v7, v144, s96 bitop3:0xf6
  v_bitop3_b32 v7, v7, v148, s96 bitop3:0xf6
  v_bitop3_b32 v7, v7, v152, s96 bitop3:0xf6
  v_bitop3_b32 v7, v7, v156, s96 bitop3:0xf6
  v_bitop3_b32 v7, v7, v160, s96 bitop3:0xf6
  v_bitop3_b32 v7, v7, v164, s96 bitop3:0xf6
  v_bitop3_b32 v7, v7, v168, s96 bitop3:0xf6
  v_bitop3_b32 v7, v7, v172, s96 bitop3:0xf6
  v_bitop3_b32 v7, v7, v176, s96 bitop3:0xf6
  v_bitop3_b32 v7, v7, v180, s96 bitop3:0xf6
  v_and_b32 v7, v254, v7
  v_cmp_ne_u32 vcc, 0, v7
  s_cbranch_vccnz o_rl_219
  s_branch o_bk_216
o_rt_217:
  s_mov_b32 s67, 0
o_rl_220:
  s_lshl_b32 s94, s43, 14
  s_add_u32 s94, s94, s95
  buffer_load_dwordx4 v[120:123], v5, s[4:7], s94 offen offset:0 sc1
  buffer_load_dwordx4 v[124:127], v5, s[4:7], s94 offen offset:512 sc1
  buffer_load_dwordx4 v[128:131], v5, s[4:7], s94 offen offset:256 sc1
  buffer_load_dwordx4 v[132:135], v5, s[4:7], s94 offen offset:768 sc1
  s_add_u32 s94, s94, 4096
  buffer_load_dwordx4 v[136:139], v5, s[4:7], s94 offen offset:0 sc1
  buffer_load_dwordx4 v[140:143], v5, s[4:7], s94 offen offset:512 sc1
  buffer_load_dwordx4 v[144:147], v5, s[4:7], s94 offen offset:256 sc1
  buffer_load_dwordx4 v[148:151], v5, s[4:7], s94 offen offset:768 sc1
  s_add_u32 s94, s94, 4096
  buffer_load_dwordx4 v[152:155], v5, s[4:7], s94 offen offset:0 sc1
  buffer_load_dwordx4 v[156:159], v5, s[4:7], s94 offen offset:512 sc1
  buffer_load_dwordx4 v[160:163], v5, s[4:7], s94 offen offset:256 sc1
  buffer_load_dwordx4 v[164:167], v5, s[4:7], s94 offen offset:768 sc1
  s_add_u32 s94, s94, 4096
  buffer_load_dwordx4 v[168:171], v5, s[4:7], s94 offen offset:0 sc1
  buffer_load_dwordx4 v[172:175], v5, s[4:7], s94 offen offset:512 sc1
  buffer_load_dwordx4 v[176:179], v5, s[4:7], s94 offen offset:256 sc1
  buffer_load_dwordx4 v[180:183], v5, s[4:7], s94 offen offset:768 sc1
  s_add_u32 s67, s67, 1
  s_cmp_gt_u32 s67, 1048576
  s_cbranch_scc1 L_end
  s_waitcnt vmcnt(0)
  v_xor_b32 v7, s96, v120
  v_bitop3_b32 v7, v7, v124, s96 bitop3:0xf6
  v_bitop3_b32 v7, v7, v128, s96 bitop3:0xf6
  v_bitop3_b32 v7, v7, v132, s96 bitop3:0xf6
  v_bitop3_b32 v7, v7, v136, s96 bitop3:0xf6
  v_bitop3_b32 v7, v7, v140, s96 bitop3:0xf6
  v_bitop3_b32 v7, v7, v144, s96 bitop3:0xf6
  v_bitop3_b32 v7, v7, v148, s96 bitop3:0xf6
  v_bitop3_b32 v7, v7, v152, s96 bitop3:0xf6
  v_bitop3_b32 v7, v7, v156, s96 bitop3:0xf6
  v_bitop3_b32 v7, v7, v160, s96 bitop3:0xf6
  v_bitop3_b32 v7, v7, v164, s96 bitop3:0xf6
  v_bitop3_b32 v7, v7, v168, s96 bitop3:0xf6
  v_bitop3_b32 v7, v7, v172, s96 bitop3:0xf6
  v_bitop3_b32 v7, v7, v176, s96 bitop3:0xf6
  v_bitop3_b32 v7, v7, v180, s96 bitop3:0xf6
  v_and_b32 v7, v254, v7
  v_cmp_ne_u32 vcc, 0, v7
  s_cbranch_vccnz o_rl_220
  s_branch o_bk_218
o_fb_209:
  v_mov_b32 v118, v116
  s_nop 1
  v_permlane16_swap_b32 v116, v118
  v_max_f32 v116, v116, v118
  v_mov_b32 v118, v116
  s_nop 0
  s_nop 0
  v_permlane32_swap_b32 v116, v118
  v_max_f32 v116, v116, v118
  v_sub_f32 v56, v104, v116
  v_sub_f32 v57, v105, v116
  v_sub_f32 v58, v106, v116
  v_sub_f32 v59, v107, v116
  v_sub_f32 v60, v108, v116
  v_sub_f32 v61, v109, v116
  v_sub_f32 v62, v110, v116
  v_sub_f32 v63, v111, v116
  v_sub_f32 v64, v112, v116
  v_sub_f32 v65, v113, v116
  v_exp_f32 v56, v56
  v_exp_f32 v57, v57
  v_exp_f32 v58, v58
  v_exp_f32 v59, v59
  v_exp_f32 v60, v60
  v_exp_f32 v61, v61
  v_exp_f32 v62, v62
  v_exp_f32 v63, v63
  v_exp_f32 v64, v64
  v_exp_f32 v65, v65
  v_add_f32 v117, v56, v57
  v_add_f32 v117, v117, v58
  v_add_f32 v117, v117, v59
  v_add_f32 v117, v117, v60
  v_add_f32 v117, v117, v61
  v_add_f32 v117, v117, v62
  v_add_f32 v117, v117, v63
  v_add_f32 v117, v117, v64
  v_add_f32 v117, v117, v65
  v_mov_b32 v118, v117
  s_nop 0
  s_nop 0
  v_permlane16_swap_b32 v117, v118
  v_add_f32 v117, v117, v118
  v_mov_b32 v118, v117
  s_nop 0
  s_nop 0
  v_permlane32_swap_b32 v117, v118
  v_add_f32 v117, v117, v118
  v_rcp_f32 v117, v117
  s_branch o_fbr_210
o_fb_211:
  v_mov_b32 v118, v116
  s_nop 1
  v_permlane16_swap_b32 v116, v118
  v_max_f32 v116, v116, v118
  v_mov_b32 v118, v116
  s_nop 0
  s_nop 0
  v_permlane32_swap_b32 v116, v118
  v_max_f32 v116, v116, v118
  v_sub_f32 v56, v104, v116
  v_sub_f32 v57, v105, v116
  v_sub_f32 v58, v106, v116
  v_sub_f32 v59, v107, v116
  v_sub_f32 v60, v108, v116
  v_sub_f32 v61, v109, v116
  v_sub_f32 v62, v110, v116
  v_sub_f32 v63, v111, v116
  v_sub_f32 v64, v112, v116
  v_sub_f32 v65, v113, v116
  v_exp_f32 v56, v56
  v_exp_f32 v57, v57
  v_exp_f32 v58, v58
  v_exp_f32 v59, v59
  v_exp_f32 v60, v60
  v_exp_f32 v61, v61
  v_exp_f32 v62, v62
  v_exp_f32 v63, v63
  v_exp_f32 v64, v64
  v_exp_f32 v65, v65
  v_add_f32 v117, v56, v57
  v_add_f32 v117, v117, v58
  v_add_f32 v117, v117, v59
  v_add_f32 v117, v117, v60
  v_add_f32 v117, v117, v61
  v_add_f32 v117, v117, v62
  v_add_f32 v117, v117, v63
  v_add_f32 v117, v117, v64
  v_add_f32 v117, v117, v65
  v_mov_b32 v118, v117
  s_nop 0
  s_nop 0
  v_permlane16_swap_b32 v117, v118
  v_add_f32 v117, v117, v118
  v_mov_b32 v118, v117
  s_nop 0
  s_nop 0
  v_permlane32_swap_b32 v117, v118
  v_add_f32 v117, v117, v118
  v_rcp_f32 v117, v117
  s_branch o_fbr_212
o_wr2_206:
  s_waitcnt lgkmcnt(0)
  s_barrier
  ds_read_b128 v[104:107], v3 offset:0
  ds_read_b128 v[108:111], v3 offset:512
  ds_read_b128 v[112:115], v3 offset:1024
  buffer_load_dwordx4 v[176:179], v5, s[4:7], s94 offen offset:256 sc1
  buffer_load_dwordx4 v[180:183], v5, s[4:7], s94 offen offset:768 sc1
  s_waitcnt lgkmcnt(2)
  v_mfma_f32_32x32x16_bf16 v[40:55], v[104:107], a[0:3], 0
  v_mov_b64 v[188:189], 0
  v_mov_b64 v[190:191], 0
  v_mov_b64 v[192:193], 0
  v_mov_b64 v[194:195], 0
  s_mov_b64 exec, 1
  buffer_store_dword v38, off, s[4:7], s84 sc1
  s_mov_b64 exec, -1
  s_mov_b32 s84, 268435456
  v_mfma_f32_32x32x16_bf16 v[56:71], v[104:107], a[4:7], 0
  ds_read_b128 v[116:119], v3 offset:1536
  v_mfma_f32_32x32x16_bf16 v[72:87], v[104:107], a[8:11], 0
  v_mfma_f32_32x32x16_bf16 v[88:103], v[104:107], a[12:15], 0
  s_waitcnt vmcnt(13)
  v_xor_b32 v7, s96, v120
  v_bitop3_b32 v7, v7, v124, s96 bitop3:0xf6
  v_bitop3_b32 v7, v7, v128, s96 bitop3:0xf6
  v_bitop3_b32 v7, v7, v132, s96 bitop3:0xf6
  s_waitcnt lgkmcnt(2)
  v_mfma_f32_32x32x16_bf16 v[40:55], v[108:111], a[16:19], v[40:55]
  s_waitcnt vmcnt(9)
  v_bitop3_b32 v7, v7, v136, s96 bitop3:0xf6
  v_bitop3_b32 v7, v7, v140, s96 bitop3:0xf6
  v_bitop3_b32 v7, v7, v144, s96 bitop3:0xf6
  v_bitop3_b32 v7, v7, v148, s96 bitop3:0xf6
  s_waitcnt vmcnt(5)
  v_mfma_f32_32x32x16_bf16 v[56:71], v[108:111], a[20:23], v[56:71]
  ds_read_b128 v[104:107], v3 offset:2048
  v_bitop3_b32 v7, v7, v152, s96 bitop3:0xf6
  v_bitop3_b32 v7, v7, v156, s96 bitop3:0xf6
  v_bitop3_b32 v7, v7, v160, s96 bitop3:0xf6
  v_bitop3_b32 v7, v7, v164, s96 bitop3:0xf6
  s_waitcnt vmcnt(1)
  v_mfma_f32_32x32x16_bf16 v[72:87], v[108:111], a[24:27], v[72:87]
  v_bitop3_b32 v7, v7, v168, s96 bitop3:0xf6
  v_bitop3_b32 v7, v7, v172, s96 bitop3:0xf6
  v_bitop3_b32 v7, v7, v176, s96 bitop3:0xf6
  v_bitop3_b32 v7, v7, v180, s96 bitop3:0xf6
  v_and_b32 v7, v254, v7
  v_cmp_ne_u32 vcc, 0, v7
  s_cbranch_vccnz o_rt_217
o_bk_218:
  v_mfma_f32_32x32x16_bf16 v[88:103], v[108:111], a[28:31], v[88:103]
  v_smfmac_f32_16x16x64_bf16 v[188:191], v[16:19], v[120:127], v20
  v_lshlrev_b32 v196, 16, v184
  v_smfmac_f32_16x16x64_bf16 v[192:195], v[16:19], v[128:135], v20
  v_and_b32 v197, 0xffff0000, v184
  v_smfmac_f32_16x16x64_bf16 v[188:191], v[16:19], v[136:143], v20
  v_lshlrev_b32 v198, 16, v185
  s_waitcnt lgkmcnt(2)
  v_mfma_f32_32x32x16_bf16 v[40:55], v[112:115], a[32:35], v[40:55]
  v_smfmac_f32_16x16x64_bf16 v[192:195], v[16:19], v[144:151], v20
  v_and_b32 v199, 0xffff0000, v185
  v_smfmac_f32_16x16x64_bf16 v[188:191], v[16:19], v[152:159], v20
  v_lshlrev_b32 v200, 16, v186
  v_smfmac_f32_16x16x64_bf16 v[192:195], v[16:19], v[160:167], v20
  v_and_b32 v201, 0xffff0000, v186
  v_mfma_f32_32x32x16_bf16 v[56:71], v[112:115], a[36:39], v[56:71]
  ds_read_b128 v[108:111], v3 offset:2560
  v_smfmac_f32_16x16x64_bf16 v[188:191], v[16:19], v[168:175], v20
  v_lshlrev_b32 v202, 16, v187
  v_smfmac_f32_16x16x64_bf16 v[192:195], v[16:19], v[176:183], v20
  v_and_b32 v203, 0xffff0000, v187
  s_bfe_u32 s92, s65, 131086
  v_mfma_f32_32x32x16_bf16 v[72:87], v[112:115], a[40:43], v[72:87]
  s_lshl_b32 s92, s92, 21
  s_add_u32 s92, s92, s91
  s_add_u32 s93, s92, 27262976
  s_add_u32 s92, s92, 20971520
  v_permlane16_swap_b32 v188, v192
  v_mfma_f32_32x32x16_bf16 v[88:103], v[112:115], a[44:47], v[88:103]
  v_permlane16_swap_b32 v189, v193
  v_permlane16_swap_b32 v190, v194
  v_permlane16_swap_b32 v191, v195
  s_waitcnt lgkmcnt(2)
  v_mfma_f32_32x32x16_bf16 v[40:55], v[116:119], a[48:51], v[40:55]
  v_cvt_pk_bf16_f32 v188, 0, v188
  v_cvt_pk_bf16_f32 v189, 0, v189
  v_cvt_pk_bf16_f32 v190, 0, v190
  v_cvt_pk_bf16_f32 v191, 0, v191
  v_cvt_pk_bf16_f32 v192, 0, v192
  v_cvt_pk_bf16_f32 v193, 0, v193
  v_mfma_f32_32x32x16_bf16 v[56:71], v[116:119], a[52:55], v[56:71]
  ds_read_b128 v[112:115], v3 offset:3072
  v_cvt_pk_bf16_f32 v194, 0, v194
  v_cvt_pk_bf16_f32 v195, 0, v195
  v_add_f32 v196, v196, v188
  v_add_f32 v197, v197, v189
  v_add_f32 v198, v198, v190
  v_mfma_f32_32x32x16_bf16 v[72:87], v[116:119], a[56:59], v[72:87]
  v_add_f32 v199, v199, v191
  v_add_f32 v200, v200, v192
  v_add_f32 v201, v201, v193
  v_add_f32 v202, v202, v194
  v_add_f32 v203, v203, v195
  v_cvt_pk_bf16_f32 v120, v196, v197
  v_mfma_f32_32x32x16_bf16 v[88:103], v[116:119], a[60:63], v[88:103]
  v_cvt_pk_bf16_f32 v121, v198, v199
  v_cvt_pk_bf16_f32 v122, v200, v201
  v_cvt_pk_bf16_f32 v123, v202, v203
  v_lshlrev_b32 v196, 16, v120
  v_and_b32 v197, 0xffff0000, v120
  s_waitcnt lgkmcnt(2)
  v_mfma_f32_32x32x16_bf16 v[40:55], v[104:107], a[64:67], v[40:55]
  v_lshlrev_b32 v198, 16, v121
  v_and_b32 v199, 0xffff0000, v121
  v_lshlrev_b32 v200, 16, v122
  v_and_b32 v201, 0xffff0000, v122
  v_lshlrev_b32 v202, 16, v123
  v_and_b32 v203, 0xffff0000, v123
  v_mfma_f32_32x32x16_bf16 v[56:71], v[104:107], a[68:71], v[56:71]
  ds_read_b128 v[116:119], v3 offset:3584
  buffer_store_dwordx4 v[120:123], v0, s[4:7], s92 offen sc1
  v_add_f32 v136, v196, v197
  v_mul_f32 v137, v196, v196
  v_mfma_f32_32x32x16_bf16 v[72:87], v[104:107], a[72:75], v[72:87]
  v_add_f32 v138, v198, v199
  v_mul_f32 v139, v197, v197
  v_fmac_f32 v137, v198, v198
  v_fmac_f32 v139, v199, v199
  v_add_f32 v136, v136, v200
  v_fmac_f32 v137, v200, v200
  v_mfma_f32_32x32x16_bf16 v[88:103], v[104:107], a[76:79], v[88:103]
  v_add_f32 v138, v138, v201
  v_fmac_f32 v139, v201, v201
  v_add_f32 v136, v136, v202
  v_fmac_f32 v137, v202, v202
  v_add_f32 v138, v138, v203
  s_waitcnt lgkmcnt(2)
  v_mfma_f32_32x32x16_bf16 v[40:55], v[108:111], a[80:83], v[40:55]
  v_fmac_f32 v139, v203, v203
  v_add_f32 v136, v136, v138
  v_add_f32 v137, v137, v139
  s_nop 0
  v_add_f32_dpp v136, v136, v136 row_ror:8 row_mask:0xf bank_mask:0xf
  v_add_f32_dpp v137, v137, v137 row_ror:8 row_mask:0xf bank_mask:0xf
  s_nop 0
  v_add_f32_dpp v136, v136, v136 row_ror:4 row_mask:0xf bank_mask:0xf
  v_mfma_f32_32x32x16_bf16 v[56:71], v[108:111], a[84:87], v[56:71]
  ds_read_b128 v[104:107], v3 offset:8192
  v_add_f32_dpp v137, v137, v137 row_ror:4 row_mask:0xf bank_mask:0xf
  v_add_f32_dpp v136, v136, v136 row_ror:2 row_mask:0xf bank_mask:0xf
  s_nop 0
  v_add_f32_dpp v137, v137, v137 row_ror:2 row_mask:0xf bank_mask:0xf
  v_add_f32_dpp v136, v136, v136 row_ror:1 row_mask:0xf bank_mask:0xf
  s_nop 0
  v_add_f32_dpp v137, v137, v137 row_ror:1 row_mask:0xf bank_mask:0xf
  v_mfma_f32_32x32x16_bf16 v[72:87], v[108:111], a[88:91], v[72:87]
  v_mov_b32 v140, v136
  v_mov_b32 v141, v137
  s_nop 0
  v_permlane16_swap_b32 v136, v140
  v_permlane16_swap_b32 v137, v141
  v_mfma_f32_32x32x16_bf16 v[88:103], v[108:111], a[92:95], v[88:103]
  v_add_f32 v136, v136, v140
  v_add_f32 v137, v137, v141
  v_mov_b32 v140, v136
  v_mov_b32 v141, v137
  s_nop 0
  v_permlane32_swap_b32 v136, v140
  s_waitcnt lgkmcnt(2)
  v_mfma_f32_32x32x16_bf16 v[40:55], v[112:115], a[96:99], v[40:55]
  v_permlane32_swap_b32 v137, v141
  v_add_f32 v136, v136, v140
  v_add_f32 v137, v137, v141
  v_mul_f32 v136, 0x3b000000, v136
  v_mul_f32 v137, 0x3b000000, v137
  v_mfma_f32_32x32x16_bf16 v[56:71], v[112:115], a[100:103], v[56:71]
  ds_read_b128 v[108:111], v3 offset:8704
  v_fma_f32 v137, -v136, v136, v137
  v_cvt_pk_bf16_f32 v136, 0, v136
  v_max_f32 v137, 0, v137
  v_sub_f32 v140, v196, v136
  v_sub_f32 v141, v197, v136
  v_mfma_f32_32x32x16_bf16 v[72:87], v[112:115], a[104:107], v[72:87]
  v_cvt_pk_bf16_f32 v137, 0, v137
  v_sub_f32 v142, v198, v136
  v_sub_f32 v143, v199, v136
  v_add_f32 v137, 0x3727c5ac, v137
  v_sub_f32 v144, v200, v136
  v_sub_f32 v145, v201, v136
  v_mfma_f32_32x32x16_bf16 v[88:103], v[112:115], a[108:111], v[88:103]
  v_cvt_pk_bf16_f32 v137, 0, v137
  v_sub_f32 v146, v202, v136
  v_sub_f32 v147, v203, v136
  v_sqrt_f32 v137, v137
  s_waitcnt lgkmcnt(2)
  v_mfma_f32_32x32x16_bf16 v[40:55], v[116:119], a[112:115], v[40:55]
  v_cvt_pk_bf16_f32 v140, 0, v140
  v_cvt_pk_bf16_f32 v141, 0, v141
  v_cvt_pk_bf16_f32 v137, 0, v137
  v_cvt_pk_bf16_f32 v142, 0, v142
  v_cvt_pk_bf16_f32 v143, 0, v143
  v_rcp_f32 v137, v137
  v_mfma_f32_32x32x16_bf16 v[56:71], v[116:119], a[116:119], v[56:71]
  ds_read_b128 v[112:115], v3 offset:9216
  v_cvt_pk_bf16_f32 v144, 0, v144
  v_cvt_pk_bf16_f32 v145, 0, v145
  v_cvt_pk_bf16_f32 v146, 0, v146
  v_cvt_pk_bf16_f32 v147, 0, v147
  v_mul_f32 v140, v140, v137
  v_mfma_f32_32x32x16_bf16 v[72:87], v[116:119], a[120:123], v[72:87]
  v_mul_f32 v141, v141, v137
  v_mul_f32 v142, v142, v137
  v_mul_f32 v143, v143, v137
  v_mul_f32 v144, v144, v137
  v_mul_f32 v145, v145, v137
  v_mul_f32 v146, v146, v137
  v_mfma_f32_32x32x16_bf16 v[88:103], v[116:119], a[124:127], v[88:103]
  v_mul_f32 v147, v147, v137
  v_cvt_pk_bf16_f32 v124, v140, v141
  v_cvt_pk_bf16_f32 v125, v142, v143
  v_cvt_pk_bf16_f32 v126, v144, v145
  v_cvt_pk_bf16_f32 v127, v146, v147
  s_waitcnt lgkmcnt(2)
  v_mfma_f32_32x32x16_bf16 v[40:55], v[104:107], a[128:131], v[40:55]
  v_lshlrev_b32 v204, 16, v124
  v_and_b32 v205, 0xffff0000, v124
  v_lshlrev_b32 v206, 16, v125
  v_and_b32 v207, 0xffff0000, v125
  v_lshlrev_b32 v208, 16, v126
  v_and_b32 v209, 0xffff0000, v126
  v_mfma_f32_32x32x16_bf16 v[56:71], v[104:107], a[132:135], v[56:71]
  ds_read_b128 v[116:119], v3 offset:9728
  v_lshlrev_b32 v210, 16, v127
  v_and_b32 v211, 0xffff0000, v127
  buffer_store_dwordx4 v[124:127], v0, s[4:7], s93 offen sc1
  v_mfma_f32_32x32x16_bf16 v[72:87], v[104:107], a[136:139], v[72:87]
  v_add_f32 v196, v196, v204
  v_add_f32 v197, v197, v205
  v_add_f32 v198, v198, v206
  v_add_f32 v199, v199, v207
  v_add_f32 v200, v200, v208
  v_add_f32 v201, v201, v209
  v_mfma_f32_32x32x16_bf16 v[88:103], v[104:107], a[140:143], v[88:103]
  v_add_f32 v202, v202, v210
  v_add_f32 v203, v203, v211
  v_cvt_pk_bf16_f32 v128, v196, v197
  v_cvt_pk_bf16_f32 v129, v198, v199
  v_cvt_pk_bf16_f32 v130, v200, v201
  s_waitcnt lgkmcnt(2)
  v_mfma_f32_32x32x16_bf16 v[40:55], v[108:111], a[144:147], v[40:55]
  v_cvt_pk_bf16_f32 v131, v202, v203
  v_mul_f32 v188, v204, v8
  v_mul_f32 v189, v205, v9
  v_fmac_f32 v188, v206, v10
  v_fmac_f32 v189, v207, v11
  v_fmac_f32 v188, v208, v12
  v_mfma_f32_32x32x16_bf16 v[56:71], v[108:111], a[148:151], v[56:71]
  ds_read_b128 v[104:107], v3 offset:10240
  v_fmac_f32 v189, v209, v13
  v_fmac_f32 v188, v210, v14
  v_fmac_f32 v189, v211, v15
  v_add_f32 v188, v188, v189
  buffer_store_dwordx4 v[128:131], v0, s[68:71], s91 offen sc1
  v_mfma_f32_32x32x16_bf16 v[72:87], v[108:111], a[152:155], v[72:87]
  v_add_f32_dpp v188, v188, v188 row_ror:8 row_mask:0xf bank_mask:0xf
  s_nop 1
  v_add_f32_dpp v188, v188, v188 row_ror:4 row_mask:0xf bank_mask:0xf
  s_nop 1
  v_add_f32_dpp v188, v188, v188 row_ror:2 row_mask:0xf bank_mask:0xf
  s_nop 1
  v_add_f32_dpp v188, v188, v188 row_ror:1 row_mask:0xf bank_mask:0xf
  v_mov_b32 v189, v188
  s_nop 0
  s_nop 0
  v_permlane16_swap_b32 v188, v189
  v_mfma_f32_32x32x16_bf16 v[88:103], v[108:111], a[156:159], v[88:103]
  v_add_f32 v188, v188, v189
  v_mov_b32 v189, v188
  s_nop 0
  s_nop 0
  v_permlane32_swap_b32 v188, v189
  v_add_f32 v188, v188, v189
  s_waitcnt lgkmcnt(2)
  v_mfma_f32_32x32x16_bf16 v[40:55], v[112:115], a[160:163], v[40:55]
  v_cvt_pk_bf16_f32 v188, 0, v188
  v_ashrrev_i32 v189, 31, v188
  v_or_b32 v189, 0x80000000, v189
  v_xor_b32 v188, v188, v189
  s_sub_u32 s92, 4095, s90
  v_and_b32 v188, 0xffff0000, v188
  v_mfma_f32_32x32x16_bf16 v[56:71], v[112:115], a[164:167], v[56:71]
  ds_read_b128 v[108:111], v3 offset:10752
  v_or_b32 v38, s92, v188
  s_bfe_u32 s92, s65, 196625
  s_lshl_b32 s92, s92, 18
  s_lshl_b32 s93, s90, 7
  s_add_u32 s92, s92, s93
  v_mfma_f32_32x32x16_bf16 v[72:87], v[112:115], a[168:171], v[72:87]
  s_add_u32 s84, s92, 243269632
  v_mfma_f32_32x32x16_bf16 v[88:103], v[112:115], a[172:175], v[88:103]
  s_waitcnt lgkmcnt(2)
  v_mfma_f32_32x32x16_bf16 v[40:55], v[116:119], a[176:179], v[40:55]
  v_mfma_f32_32x32x16_bf16 v[56:71], v[116:119], a[180:183], v[56:71]
  ds_read_b128 v[112:115], v3 offset:11264
  v_mfma_f32_32x32x16_bf16 v[72:87], v[116:119], a[184:187], v[72:87]
  v_mfma_f32_32x32x16_bf16 v[88:103], v[116:119], a[188:191], v[88:103]
  s_waitcnt lgkmcnt(2)
  v_mfma_f32_32x32x16_bf16 v[40:55], v[104:107], a[192:195], v[40:55]
  v_mfma_f32_32x32x16_bf16 v[56:71], v[104:107], a[196:199], v[56:71]
  ds_read_b128 v[116:119], v3 offset:11776
  s_waitcnt lgkmcnt(2)
  v_mfma_f32_32x32x16_bf16 v[40:55], v[108:111], a[208:211], v[40:55]
  v_mfma_f32_32x32x16_bf16 v[56:71], v[108:111], a[212:215], v[56:71]
  s_waitcnt lgkmcnt(1)
  v_mfma_f32_32x32x16_bf16 v[40:55], v[112:115], a[224:227], v[40:55]
  v_mfma_f32_32x32x16_bf16 v[56:71], v[112:115], a[228:231], v[56:71]
  s_waitcnt lgkmcnt(0)
  v_mfma_f32_32x32x16_bf16 v[40:55], v[116:119], a[240:243], v[40:55]
  v_mfma_f32_32x32x16_bf16 v[56:71], v[116:119], a[244:247], v[56:71]
  v_mfma_f32_32x32x16_bf16 v[72:87], v[104:107], a[200:203], v[72:87]
  v_mfma_f32_32x32x16_bf16 v[88:103], v[104:107], a[204:207], v[88:103]
  v_cvt_pk_bf16_f32 v212, v40, v56
  v_cvt_pk_bf16_f32 v214, v41, v57
  v_cvt_pk_bf16_f32 v216, v42, v58
  v_cvt_pk_bf16_f32 v218, v43, v59
  v_permlane16_swap_b32 v212, v214
  v_mfma_f32_32x32x16_bf16 v[72:87], v[108:111], a[216:219], v[72:87]
  v_cvt_pk_bf16_f32 v220, v44, v60
  v_cvt_pk_bf16_f32 v222, v45, v61
  v_permlane16_swap_b32 v216, v218
  v_bfi_b32 v212, v254, s42, v212
  v_cvt_pk_bf16_f32 v224, v46, v62
  v_mfma_f32_32x32x16_bf16 v[88:103], v[108:111], a[220:223], v[88:103]
  v_cvt_pk_bf16_f32 v226, v47, v63
  v_permlane16_swap_b32 v220, v222
  v_bfi_b32 v216, v254, s42, v216
  v_cvt_pk_bf16_f32 v228, v48, v64
  v_mfma_f32_32x32x16_bf16 v[72:87], v[112:115], a[232:235], v[72:87]
  v_cvt_pk_bf16_f32 v230, v49, v65
  v_permlane16_swap_b32 v224, v226
  v_bfi_b32 v220, v254, s42, v220
  v_cvt_pk_bf16_f32 v232, v50, v66
  v_cvt_pk_bf16_f32 v234, v51, v67
  v_mfma_f32_32x32x16_bf16 v[88:103], v[112:115], a[236:239], v[88:103]
  v_permlane16_swap_b32 v228, v230
  v_bfi_b32 v224, v254, s42, v224
  v_cvt_pk_bf16_f32 v236, v52, v68
  v_cvt_pk_bf16_f32 v238, v53, v69
  v_mfma_f32_32x32x16_bf16 v[72:87], v[116:119], a[248:251], v[72:87]
  v_permlane16_swap_b32 v232, v234
  v_bfi_b32 v228, v254, s42, v228
  v_cvt_pk_bf16_f32 v240, v54, v70
  v_cvt_pk_bf16_f32 v242, v55, v71
  v_permlane16_swap_b32 v236, v238
  v_mfma_f32_32x32x16_bf16 v[88:103], v[116:119], a[252:255], v[88:103]
  v_bfi_b32 v232, v254, s42, v232
  v_permlane16_swap_b32 v240, v242
  v_bfi_b32 v236, v254, s42, v236
  v_bfi_b32 v240, v254, s42, v240
  s_nop 7
  v_cvt_pk_bf16_f32 v213, v72, v88
  v_cvt_pk_bf16_f32 v215, v73, v89
  v_cvt_pk_bf16_f32 v217, v74, v90
  v_cvt_pk_bf16_f32 v219, v75, v91
  s_add_u32 s78, s86, 0
  v_permlane16_swap_b32 v213, v215
  buffer_store_dwordx4 v[212:215], v4, s[4:7], s78 offen sc1
  v_cvt_pk_bf16_f32 v221, v76, v92
  v_cvt_pk_bf16_f32 v223, v77, v93
  s_add_u32 s78, s86, 32768
  v_permlane16_swap_b32 v217, v219
  buffer_store_dwordx4 v[216:219], v4, s[4:7], s78 offen sc1
  v_cvt_pk_bf16_f32 v225, v78, v94
  v_cvt_pk_bf16_f32 v227, v79, v95
  s_add_u32 s78, s86, 131072
  v_permlane16_swap_b32 v221, v223
  buffer_store_dwordx4 v[220:223], v4, s[4:7], s78 offen sc1
  v_cvt_pk_bf16_f32 v229, v80, v96
  v_cvt_pk_bf16_f32 v231, v81, v97
  s_add_u32 s78, s86, 163840
  v_permlane16_swap_b32 v225, v227
  buffer_store_dwordx4 v[224:227], v4, s[4:7], s78 offen sc1
  v_cvt_pk_bf16_f32 v233, v82, v98
  v_cvt_pk_bf16_f32 v235, v83, v99
  s_add_u32 s78, s86, 262144
  v_permlane16_swap_b32 v229, v231
  buffer_store_dwordx4 v[228:231], v4, s[4:7], s78 offen sc1
  v_cvt_pk_bf16_f32 v237, v84, v100
  v_cvt_pk_bf16_f32 v239, v85, v101
  s_add_u32 s78, s86, 294912
  v_permlane16_swap_b32 v233, v235
  buffer_store_dwordx4 v[232:235], v4, s[4:7], s78 offen sc1
  v_cvt_pk_bf16_f32 v241, v86, v102
  v_cvt_pk_bf16_f32 v243, v87, v103
  s_add_u32 s78, s86, 393216
  v_permlane16_swap_b32 v237, v239
  buffer_store_dwordx4 v[236:239], v4, s[4:7], s78 offen sc1
  s_add_u32 s78, s86, 425984
  v_permlane16_swap_b32 v241, v243
  buffer_store_dwordx4 v[240:243], v4, s[4:7], s78 offen sc1
o_we_207:
  v_and_b32 v37, -32, v39
  s_waitcnt lgkmcnt(0)
  s_barrier
  ds_read_b128 v[104:107], v37 offset:16
  s_mov_b32 s65, s63
  s_waitcnt lgkmcnt(0)
  v_and_b32 v104, v104, v106
  v_max_u32 v105, v105, v107
  v_readfirstlane_b32 s26, v104
  v_readfirstlane_b32 s3, v105
  s_and_b32 s66, s26, 1
  s_and_b32 s76, s26, 2
  s_bitcmp1_b32 s26, 2
  s_cselect_b32 s3, s3, 0
  s_cmp_lg_u32 s76, 0
  s_cbranch_scc1 o_nofl_181
  s_and_b32 s26, s63, 49152
  s_cbranch_scc0 o_fl_182
  s_and_b32 s26, s64, s50
  s_cbranch_scc1 o_nofl_181
o_fl_182:
  s_cmp_ge_u32 s17, 2
  s_cbranch_scc1 o_fd_221
  s_cmp_eq_u32 s65, 0
  s_cbranch_scc1 o_fd_221
  s_mov_b32 s96, s42
  s_lshl_b32 s97, s43, 14
  s_add_u32 s97, s97, s86
  buffer_load_dword v7, v255, s[4:7], s97 offen sc1
  s_and_b32 s91, s65, 63
  s_lshl_b32 s90, s91, 5
  s_add_u32 s94, s90, s85
  s_add_u32 s90, s90, s43
  s_lshl_b32 s94, s94, 10
  s_lshr_b32 s92, s65, 22
  s_xor_b32 s93, s43, 32
  s_lshl_b32 s91, s90, 10
  s_add_u32 s94, s94, 25165824
  s_cmp_eq_u32 s92, s93
  s_cselect_b32 s92, s94, s91
  s_add_u32 s92, s92, 10485760
  s_and_b32 s93, s65, 49152
  s_cselect_b32 s92, s92, s91
  s_cselect_b64 s[80:81], s[4:5], s[72:73]
  s_cselect_b32 s82, s6, s74
  buffer_load_dwordx4 v[184:187], v0, s[80:83], s92 offen sc1
  s_mov_b32 s67, 0
  s_mov_b64 vcc, 0
  s_waitcnt vmcnt(1)
o_pl_223:
  v_and_b32 v7, 1, v7
  v_cmp_ne_u32 vcc, s96, v7
  s_cbranch_vccz o_pk_224
  s_mov_b64 exec, 1
  buffer_store_dword v38, off, s[4:7], s84 sc1
  s_mov_b64 exec, -1
  s_mov_b32 s84, 268435456
  buffer_load_dword v7, v255, s[4:7], s97 offen sc1
  s_add_u32 s67, s67, 1
  s_cmp_gt_u32 s67, 1048576
  s_cbranch_scc1 L_end
  s_waitcnt vmcnt(0)
  s_branch o_pl_223
o_pk_224:
  s_and_b32 s26, s65, 49152
  s_cbranch_scc1 o_f2_222
  s_lshl_b32 s94, s43, 14
  s_add_u32 s94, s94, s86
  buffer_load_dwordx4 v[120:123], v5, s[4:7], s94 offen offset:0 sc1
  buffer_load_dwordx4 v[124:127], v5, s[4:7], s94 offen offset:512 sc1
  buffer_load_dwordx4 v[128:131], v5, s[4:7], s94 offen offset:256 sc1
  buffer_load_dwordx4 v[132:135], v5, s[4:7], s94 offen offset:768 sc1
  s_add_u32 s94, s94, 4096
  buffer_load_dwordx4 v[136:139], v5, s[4:7], s94 offen offset:0 sc1
  buffer_load_dwordx4 v[140:143], v5, s[4:7], s94 offen offset:512 sc1
  buffer_load_dwordx4 v[144:147], v5, s[4:7], s94 offen offset:256 sc1
  buffer_load_dwordx4 v[148:151], v5, s[4:7], s94 offen offset:768 sc1
  s_add_u32 s94, s94, 4096
  buffer_load_dwordx4 v[152:155], v5, s[4:7], s94 offen offset:0 sc1
  buffer_load_dwordx4 v[156:159], v5, s[4:7], s94 offen offset:512 sc1
  buffer_load_dwordx4 v[160:163], v5, s[4:7], s94 offen offset:256 sc1
  buffer_load_dwordx4 v[164:167], v5, s[4:7], s94 offen offset:768 sc1
  s_add_u32 s94, s94, 4096
  buffer_load_dwordx4 v[168:171], v5, s[4:7], s94 offen offset:0 sc1
  buffer_load_dwordx4 v[172:175], v5, s[4:7], s94 offen offset:512 sc1
  buffer_load_dwordx4 v[176:179], v5, s[4:7], s94 offen offset:256 sc1
  buffer_load_dwordx4 v[180:183], v5, s[4:7], s94 offen offset:768 sc1
  s_mov_b64 exec, 1
  buffer_store_dword v38, off, s[4:7], s84 sc1
  s_mov_b64 exec, -1
  s_mov_b32 s84, 268435456
  v_mov_b64 v[188:189], 0
  v_mov_b64 v[190:191], 0
  v_mov_b64 v[192:193], 0
  v_mov_b64 v[194:195], 0
  s_waitcnt vmcnt(13)
  v_xor_b32 v7, s96, v120
  v_bitop3_b32 v7, v7, v124, s96 bitop3:0xf6
  v_bitop3_b32 v7, v7, v128, s96 bitop3:0xf6
  v_bitop3_b32 v7, v7, v132, s96 bitop3:0xf6
  s_waitcnt vmcnt(9)
  v_bitop3_b32 v7, v7, v136, s96 bitop3:0xf6
  v_bitop3_b32 v7, v7, v140, s96 bitop3:0xf6
  v_bitop3_b32 v7, v7, v144, s96 bitop3:0xf6
  v_bitop3_b32 v7, v7, v148, s96 bitop3:0xf6
  s_waitcnt vmcnt(5)
  v_bitop3_b32 v7, v7, v152, s96 bitop3:0xf6
  v_bitop3_b32 v7, v7, v156, s96 bitop3:0xf6
  v_bitop3_b32 v7, v7, v160, s96 bitop3:0xf6
  v_bitop3_b32 v7, v7, v164, s96 bitop3:0xf6
  s_waitcnt vmcnt(1)
  v_bitop3_b32 v7, v7, v168, s96 bitop3:0xf6
  v_bitop3_b32 v7, v7, v172, s96 bitop3:0xf6
  v_bitop3_b32 v7, v7, v176, s96 bitop3:0xf6
  v_bitop3_b32 v7, v7, v180, s96 bitop3:0xf6
  v_and_b32 v7, v254, v7
  v_cmp_ne_u32 vcc, 0, v7
  s_cbranch_vccnz o_rt_225
o_bk_226:
  v_smfmac_f32_16x16x64_bf16 v[188:191], v[16:19], v[120:127], v20
  v_lshlrev_b32 v196, 16, v184
  v_smfmac_f32_16x16x64_bf16 v[192:195], v[16:19], v[128:135], v20
  v_and_b32 v197, 0xffff0000, v184
  v_smfmac_f32_16x16x64_bf16 v[188:191], v[16:19], v[136:143], v20
  v_lshlrev_b32 v198, 16, v185
  v_smfmac_f32_16x16x64_bf16 v[192:195], v[16:19], v[144:151], v20
  v_and_b32 v199, 0xffff0000, v185
  v_smfmac_f32_16x16x64_bf16 v[188:191], v[16:19], v[152:159], v20
  v_lshlrev_b32 v200, 16, v186
  v_smfmac_f32_16x16x64_bf16 v[192:195], v[16:19], v[160:167], v20
  v_and_b32 v201, 0xffff0000, v186
  v_smfmac_f32_16x16x64_bf16 v[188:191], v[16:19], v[168:175], v20
  v_lshlrev_b32 v202, 16, v187
  v_smfmac_f32_16x16x64_bf16 v[192:195], v[16:19], v[176:183], v20
  v_and_b32 v203, 0xffff0000, v187
  s_bfe_u32 s92, s65, 131086
  s_lshl_b32 s92, s92, 21
  s_add_u32 s92, s92, s91
  s_add_u32 s93, s92, 27262976
  s_add_u32 s92, s92, 20971520
  s_nop 1
  v_permlane16_swap_b32 v188, v192
  v_permlane16_swap_b32 v189, v193
  v_permlane16_swap_b32 v190, v194
  v_permlane16_swap_b32 v191, v195
  v_cvt_pk_bf16_f32 v188, 0, v188
  v_cvt_pk_bf16_f32 v189, 0, v189
  v_cvt_pk_bf16_f32 v190, 0, v190
  v_cvt_pk_bf16_f32 v191, 0, v191
  v_cvt_pk_bf16_f32 v192, 0, v192
  v_cvt_pk_bf16_f32 v193, 0, v193
  v_cvt_pk_bf16_f32 v194, 0, v194
  v_cvt_pk_bf16_f32 v195, 0, v195
  v_add_f32 v196, v196, v188
  v_add_f32 v197, v197, v189
  v_add_f32 v198, v198, v190
  v_add_f32 v199, v199, v191
  v_add_f32 v200, v200, v192
  v_add_f32 v201, v201, v193
  v_add_f32 v202, v202, v194
  v_add_f32 v203, v203, v195
  v_cvt_pk_bf16_f32 v120, v196, v197
  v_cvt_pk_bf16_f32 v121, v198, v199
  v_cvt_pk_bf16_f32 v122, v200, v201
  v_cvt_pk_bf16_f32 v123, v202, v203
  v_lshlrev_b32 v196, 16, v120
  v_and_b32 v197, 0xffff0000, v120
  v_lshlrev_b32 v198, 16, v121
  v_and_b32 v199, 0xffff0000, v121
  v_lshlrev_b32 v200, 16, v122
  v_and_b32 v201, 0xffff0000, v122
  v_lshlrev_b32 v202, 16, v123
  v_and_b32 v203, 0xffff0000, v123
  buffer_store_dwordx4 v[120:123], v0, s[4:7], s92 offen sc1
  v_add_f32 v136, v196, v197
  v_mul_f32 v137, v196, v196
  v_add_f32 v138, v198, v199
  v_mul_f32 v139, v197, v197
  v_fmac_f32 v137, v198, v198
  v_fmac_f32 v139, v199, v199
  v_add_f32 v136, v136, v200
  v_fmac_f32 v137, v200, v200
  v_add_f32 v138, v138, v201
  v_fmac_f32 v139, v201, v201
  v_add_f32 v136, v136, v202
  v_fmac_f32 v137, v202, v202
  v_add_f32 v138, v138, v203
  v_fmac_f32 v139, v203, v203
  v_add_f32 v136, v136, v138
  v_add_f32 v137, v137, v139
  s_nop 0
  v_add_f32_dpp v136, v136, v136 row_ror:8 row_mask:0xf bank_mask:0xf
  v_add_f32_dpp v137, v137, v137 row_ror:8 row_mask:0xf bank_mask:0xf
  s_nop 0
  v_add_f32_dpp v136, v136, v136 row_ror:4 row_mask:0xf bank_mask:0xf
  v_add_f32_dpp v137, v137, v137 row_ror:4 row_mask:0xf bank_mask:0xf
  s_nop 0
  v_add_f32_dpp v136, v136, v136 row_ror:2 row_mask:0xf bank_mask:0xf
  v_add_f32_dpp v137, v137, v137 row_ror:2 row_mask:0xf bank_mask:0xf
  s_nop 0
  v_add_f32_dpp v136, v136, v136 row_ror:1 row_mask:0xf bank_mask:0xf
  v_add_f32_dpp v137, v137, v137 row_ror:1 row_mask:0xf bank_mask:0xf
  v_mov_b32 v140, v136
  v_mov_b32 v141, v137
  s_nop 0
  v_permlane16_swap_b32 v136, v140
  v_permlane16_swap_b32 v137, v141
  v_add_f32 v136, v136, v140
  v_add_f32 v137, v137, v141
  v_mov_b32 v140, v136
  v_mov_b32 v141, v137
  s_nop 0
  v_permlane32_swap_b32 v136, v140
  v_permlane32_swap_b32 v137, v141
  v_add_f32 v136, v136, v140
  v_add_f32 v137, v137, v141
  v_mul_f32 v136, 0x3b000000, v136
  v_mul_f32 v137, 0x3b000000, v137
  v_fma_f32 v137, -v136, v136, v137
  v_cvt_pk_bf16_f32 v136, 0, v136
  v_max_f32 v137, 0, v137
  v_sub_f32 v140, v196, v136
  v_sub_f32 v141, v197, v136
  v_cvt_pk_bf16_f32 v137, 0, v137
  v_sub_f32 v142, v198, v136
  v_sub_f32 v143, v199, v136
  v_add_f32 v137, 0x3727c5ac, v137
  v_sub_f32 v144, v200, v136
  v_sub_f32 v145, v201, v136
  v_cvt_pk_bf16_f32 v137, 0, v137
  v_sub_f32 v146, v202, v136
  v_sub_f32 v147, v203, v136
  v_sqrt_f32 v137, v137
  v_cvt_pk_bf16_f32 v140, 0, v140
  v_cvt_pk_bf16_f32 v141, 0, v141
  v_cvt_pk_bf16_f32 v137, 0, v137
  v_cvt_pk_bf16_f32 v142, 0, v142
  v_cvt_pk_bf16_f32 v143, 0, v143
  v_rcp_f32 v137, v137
  v_cvt_pk_bf16_f32 v144, 0, v144
  v_cvt_pk_bf16_f32 v145, 0, v145
  v_cvt_pk_bf16_f32 v146, 0, v146
  v_cvt_pk_bf16_f32 v147, 0, v147
  v_mul_f32 v140, v140, v137
  v_mul_f32 v141, v141, v137
  v_mul_f32 v142, v142, v137
  v_mul_f32 v143, v143, v137
  v_mul_f32 v144, v144, v137
  v_mul_f32 v145, v145, v137
  v_mul_f32 v146, v146, v137
  v_mul_f32 v147, v147, v137
  v_cvt_pk_bf16_f32 v124, v140, v141
  v_cvt_pk_bf16_f32 v125, v142, v143
  v_cvt_pk_bf16_f32 v126, v144, v145
  v_cvt_pk_bf16_f32 v127, v146, v147
  v_lshlrev_b32 v204, 16, v124
  v_and_b32 v205, 0xffff0000, v124
  v_lshlrev_b32 v206, 16, v125
  v_and_b32 v207, 0xffff0000, v125
  v_lshlrev_b32 v208, 16, v126
  v_and_b32 v209, 0xffff0000, v126
  v_lshlrev_b32 v210, 16, v127
  v_and_b32 v211, 0xffff0000, v127
  buffer_store_dwordx4 v[124:127], v0, s[4:7], s93 offen sc1
  v_add_f32 v196, v196, v204
  v_add_f32 v197, v197, v205
  v_add_f32 v198, v198, v206
  v_add_f32 v199, v199, v207
  v_add_f32 v200, v200, v208
  v_add_f32 v201, v201, v209
  v_add_f32 v202, v202, v210
  v_add_f32 v203, v203, v211
  v_cvt_pk_bf16_f32 v128, v196, v197
  v_cvt_pk_bf16_f32 v129, v198, v199
  v_cvt_pk_bf16_f32 v130, v200, v201
  v_cvt_pk_bf16_f32 v131, v202, v203
  v_mul_f32 v188, v204, v8
  v_mul_f32 v189, v205, v9
  v_fmac_f32 v188, v206, v10
  v_fmac_f32 v189, v207, v11
  v_fmac_f32 v188, v208, v12
  v_fmac_f32 v189, v209, v13
  v_fmac_f32 v188, v210, v14
  v_fmac_f32 v189, v211, v15
  v_add_f32 v188, v188, v189
  s_add_u32 s92, s91, 10485760
  s_add_u32 s93, s91, 8388608
  buffer_store_dwordx4 v[128:131], v0, s[4:7], s92 offen sc1
  v_lshlrev_b32 v196, 16, v128
  v_and_b32 v197, 0xffff0000, v128
  v_lshlrev_b32 v198, 16, v129
  v_and_b32 v199, 0xffff0000, v129
  v_lshlrev_b32 v200, 16, v130
  v_and_b32 v201, 0xffff0000, v130
  v_lshlrev_b32 v202, 16, v131
  v_and_b32 v203, 0xffff0000, v131
  v_add_f32 v136, v196, v197
  v_mul_f32 v137, v196, v196
  v_add_f32 v138, v198, v199
  v_mul_f32 v139, v197, v197
  v_fmac_f32 v137, v198, v198
  v_fmac_f32 v139, v199, v199
  v_add_f32 v136, v136, v200
  v_fmac_f32 v137, v200, v200
  v_add_f32 v138, v138, v201
  v_fmac_f32 v139, v201, v201
  v_add_f32 v136, v136, v202
  v_fmac_f32 v137, v202, v202
  v_add_f32 v138, v138, v203
  v_fmac_f32 v139, v203, v203
  v_add_f32 v136, v136, v138
  v_add_f32 v137, v137, v139
  s_nop 0
  v_add_f32_dpp v136, v136, v136 row_ror:8 row_mask:0xf bank_mask:0xf
  v_add_f32_dpp v137, v137, v137 row_ror:8 row_mask:0xf bank_mask:0xf
  v_add_f32_dpp v188, v188, v188 row_ror:8 row_mask:0xf bank_mask:0xf
  v_add_f32_dpp v136, v136, v136 row_ror:4 row_mask:0xf bank_mask:0xf
  v_add_f32_dpp v137, v137, v137 row_ror:4 row_mask:0xf bank_mask:0xf
  v_add_f32_dpp v188, v188, v188 row_ror:4 row_mask:0xf bank_mask:0xf
  v_add_f32_dpp v136, v136, v136 row_ror:2 row_mask:0xf bank_mask:0xf
  v_add_f32_dpp v137, v137, v137 row_ror:2 row_mask:0xf bank_mask:0xf
  v_add_f32_dpp v188, v188, v188 row_ror:2 row_mask:0xf bank_mask:0xf
  v_add_f32_dpp v136, v136, v136 row_ror:1 row_mask:0xf bank_mask:0xf
  v_add_f32_dpp v137, v137, v137 row_ror:1 row_mask:0xf bank_mask:0xf
  v_add_f32_dpp v188, v188, v188 row_ror:1 row_mask:0xf bank_mask:0xf
  v_mov_b32 v140, v136
  v_mov_b32 v141, v137
  v_mov_b32 v142, v188
  v_permlane16_swap_b32 v136, v140
  v_permlane16_swap_b32 v137, v141
  v_permlane16_swap_b32 v188, v142
  v_add_f32 v136, v136, v140
  v_add_f32 v137, v137, v141
  v_add_f32 v188, v188, v142
  v_mov_b32 v140, v136
  v_mov_b32 v141, v137
  v_mov_b32 v142, v188
  v_permlane32_swap_b32 v136, v140
  v_permlane32_swap_b32 v137, v141
  v_permlane32_swap_b32 v188, v142
  v_add_f32 v136, v136, v140
  v_add_f32 v137, v137, v141
  v_add_f32 v188, v188, v142
  v_mul_f32 v136, 0x3b000000, v136
  v_mul_f32 v137, 0x3b000000, v137
  v_fma_f32 v137, -v136, v136, v137
  v_cvt_pk_bf16_f32 v136, 0, v136
  v_max_f32 v137, 0, v137
  v_sub_f32 v140, v196, v136
  v_sub_f32 v141, v197, v136
  v_cvt_pk_bf16_f32 v137, 0, v137
  v_sub_f32 v142, v198, v136
  v_sub_f32 v143, v199, v136
  v_add_f32 v137, 0x3727c5ac, v137
  v_sub_f32 v144, v200, v136
  v_sub_f32 v145, v201, v136
  v_cvt_pk_bf16_f32 v137, 0, v137
  v_sub_f32 v146, v202, v136
  v_sub_f32 v147, v203, v136
  v_sqrt_f32 v137, v137
  v_cvt_pk_bf16_f32 v140, 0, v140
  v_cvt_pk_bf16_f32 v141, 0, v141
  v_cvt_pk_bf16_f32 v137, 0, v137
  v_cvt_pk_bf16_f32 v142, 0, v142
  v_cvt_pk_bf16_f32 v143, 0, v143
  v_rcp_f32 v137, v137
  v_cvt_pk_bf16_f32 v144, 0, v144
  v_cvt_pk_bf16_f32 v145, 0, v145
  v_cvt_pk_bf16_f32 v146, 0, v146
  v_cvt_pk_bf16_f32 v147, 0, v147
  v_mul_f32 v140, v140, v137
  v_mul_f32 v141, v141, v137
  v_mul_f32 v142, v142, v137
  v_mul_f32 v143, v143, v137
  v_mul_f32 v144, v144, v137
  v_mul_f32 v145, v145, v137
  v_mul_f32 v146, v146, v137
  v_mul_f32 v147, v147, v137
  v_cvt_pk_bf16_f32 v132, v140, v141
  v_cvt_pk_bf16_f32 v133, v142, v143
  v_cvt_pk_bf16_f32 v134, v144, v145
  v_cvt_pk_bf16_f32 v135, v146, v147
  buffer_store_dwordx4 v[132:135], v0, s[4:7], s93 offen sc1
  v_cvt_pk_bf16_f32 v188, 0, v188
  v_ashrrev_i32 v189, 31, v188
  v_or_b32 v189, 0x80000000, v189
  v_xor_b32 v188, v188, v189
  s_sub_u32 s92, 4095, s90
  v_and_b32 v188, 0xffff0000, v188
  v_or_b32 v38, s92, v188
  s_bfe_u32 s92, s65, 196625
  s_lshl_b32 s92, s92, 18
  s_lshl_b32 s93, s90, 7
  s_add_u32 s92, s92, s93
  s_add_u32 s84, s92, 243269632
  s_waitcnt vmcnt(0)
  s_mov_b64 exec, 1
  buffer_store_dword v38, off, s[4:7], s84 sc1
  s_mov_b64 exec, -1
  s_mov_b32 s84, 268435456
  s_branch o_fd_221
o_rt_225:
  s_mov_b32 s67, 0
o_rl_227:
  s_lshl_b32 s94, s43, 14
  s_add_u32 s94, s94, s86
  buffer_load_dwordx4 v[120:123], v5, s[4:7], s94 offen offset:0 sc1
  buffer_load_dwordx4 v[124:127], v5, s[4:7], s94 offen offset:512 sc1
  buffer_load_dwordx4 v[128:131], v5, s[4:7], s94 offen offset:256 sc1
  buffer_load_dwordx4 v[132:135], v5, s[4:7], s94 offen offset:768 sc1
  s_add_u32 s94, s94, 4096
  buffer_load_dwordx4 v[136:139], v5, s[4:7], s94 offen offset:0 sc1
  buffer_load_dwordx4 v[140:143], v5, s[4:7], s94 offen offset:512 sc1
  buffer_load_dwordx4 v[144:147], v5, s[4:7], s94 offen offset:256 sc1
  buffer_load_dwordx4 v[148:151], v5, s[4:7], s94 offen offset:768 sc1
  s_add_u32 s94, s94, 4096
  buffer_load_dwordx4 v[152:155], v5, s[4:7], s94 offen offset:0 sc1
  buffer_load_dwordx4 v[156:159], v5, s[4:7], s94 offen offset:512 sc1
  buffer_load_dwordx4 v[160:163], v5, s[4:7], s94 offen offset:256 sc1
  buffer_load_dwordx4 v[164:167], v5, s[4:7], s94 offen offset:768 sc1
  s_add_u32 s94, s94, 4096
  buffer_load_dwordx4 v[168:171], v5, s[4:7], s94 offen offset:0 sc1
  buffer_load_dwordx4 v[172:175], v5, s[4:7], s94 offen offset:512 sc1
  buffer_load_dwordx4 v[176:179], v5, s[4:7], s94 offen offset:256 sc1
  buffer_load_dwordx4 v[180:183], v5, s[4:7], s94 offen offset:768 sc1
  s_add_u32 s67, s67, 1
  s_cmp_gt_u32 s67, 1048576
  s_cbranch_scc1 L_end
  s_waitcnt vmcnt(0)
  v_xor_b32 v7, s96, v120
  v_bitop3_b32 v7, v7, v124, s96 bitop3:0xf6
  v_bitop3_b32 v7, v7, v128, s96 bitop3:0xf6
  v_bitop3_b32 v7, v7, v132, s96 bitop3:0xf6
  v_bitop3_b32 v7, v7, v136, s96 bitop3:0xf6
  v_bitop3_b32 v7, v7, v140, s96 bitop3:0xf6
  v_bitop3_b32 v7, v7, v144, s96 bitop3:0xf6
  v_bitop3_b32 v7, v7, v148, s96 bitop3:0xf6
  v_bitop3_b32 v7, v7, v152, s96 bitop3:0xf6
  v_bitop3_b32 v7, v7, v156, s96 bitop3:0xf6
  v_bitop3_b32 v7, v7, v160, s96 bitop3:0xf6
  v_bitop3_b32 v7, v7, v164, s96 bitop3:0xf6
  v_bitop3_b32 v7, v7, v168, s96 bitop3:0xf6
  v_bitop3_b32 v7, v7, v172, s96 bitop3:0xf6
  v_bitop3_b32 v7, v7, v176, s96 bitop3:0xf6
  v_bitop3_b32 v7, v7, v180, s96 bitop3:0xf6
  v_and_b32 v7, v254, v7
  v_cmp_ne_u32 vcc, 0, v7
  s_cbranch_vccnz o_rl_227
  s_branch o_bk_226
o_f2_222:
  s_lshl_b32 s94, s43, 14
  s_add_u32 s94, s94, s86
  buffer_load_dwordx4 v[120:123], v5, s[4:7], s94 offen offset:0 sc1
  buffer_load_dwordx4 v[124:127], v5, s[4:7], s94 offen offset:512 sc1
  buffer_load_dwordx4 v[128:131], v5, s[4:7], s94 offen offset:256 sc1
  buffer_load_dwordx4 v[132:135], v5, s[4:7], s94 offen offset:768 sc1
  s_add_u32 s94, s94, 4096
  buffer_load_dwordx4 v[136:139], v5, s[4:7], s94 offen offset:0 sc1
  buffer_load_dwordx4 v[140:143], v5, s[4:7], s94 offen offset:512 sc1
  buffer_load_dwordx4 v[144:147], v5, s[4:7], s94 offen offset:256 sc1
  buffer_load_dwordx4 v[148:151], v5, s[4:7], s94 offen offset:768 sc1
  s_add_u32 s94, s94, 4096
  buffer_load_dwordx4 v[152:155], v5, s[4:7], s94 offen offset:0 sc1
  buffer_load_dwordx4 v[156:159], v5, s[4:7], s94 offen offset:512 sc1
  buffer_load_dwordx4 v[160:163], v5, s[4:7], s94 offen offset:256 sc1
  buffer_load_dwordx4 v[164:167], v5, s[4:7], s94 offen offset:768 sc1
  s_add_u32 s94, s94, 4096
  buffer_load_dwordx4 v[168:171], v5, s[4:7], s94 offen offset:0 sc1
  buffer_load_dwordx4 v[172:175], v5, s[4:7], s94 offen offset:512 sc1
  buffer_load_dwordx4 v[176:179], v5, s[4:7], s94 offen offset:256 sc1
  buffer_load_dwordx4 v[180:183], v5, s[4:7], s94 offen offset:768 sc1
  s_mov_b64 exec, 1
  buffer_store_dword v38, off, s[4:7], s84 sc1
  s_mov_b64 exec, -1
  s_mov_b32 s84, 268435456
  v_mov_b64 v[188:189], 0
  v_mov_b64 v[190:191], 0
  v_mov_b64 v[192:193], 0
  v_mov_b64 v[194:195], 0
  s_waitcnt vmcnt(13)
  v_xor_b32 v7, s96, v120
  v_bitop3_b32 v7, v7, v124, s96 bitop3:0xf6
  v_bitop3_b32 v7, v7, v128, s96 bitop3:0xf6
  v_bitop3_b32 v7, v7, v132, s96 bitop3:0xf6
  s_waitcnt vmcnt(9)
  v_bitop3_b32 v7, v7, v136, s96 bitop3:0xf6
  v_bitop3_b32 v7, v7, v140, s96 bitop3:0xf6
  v_bitop3_b32 v7, v7, v144, s96 bitop3:0xf6
  v_bitop3_b32 v7, v7, v148, s96 bitop3:0xf6
  s_waitcnt vmcnt(5)
  v_bitop3_b32 v7, v7, v152, s96 bitop3:0xf6
  v_bitop3_b32 v7, v7, v156, s96 bitop3:0xf6
  v_bitop3_b32 v7, v7, v160, s96 bitop3:0xf6
  v_bitop3_b32 v7, v7, v164, s96 bitop3:0xf6
  s_waitcnt vmcnt(1)
  v_bitop3_b32 v7, v7, v168, s96 bitop3:0xf6
  v_bitop3_b32 v7, v7, v172, s96 bitop3:0xf6
  v_bitop3_b32 v7, v7, v176, s96 bitop3:0xf6
  v_bitop3_b32 v7, v7, v180, s96 bitop3:0xf6
  v_and_b32 v7, v254, v7
  v_cmp_ne_u32 vcc, 0, v7
  s_cbranch_vccnz o_rt_228
o_bk_229:
  v_smfmac_f32_16x16x64_bf16 v[188:191], v[16:19], v[120:127], v20
  v_lshlrev_b32 v196, 16, v184
  v_smfmac_f32_16x16x64_bf16 v[192:195], v[16:19], v[128:135], v20
  v_and_b32 v197, 0xffff0000, v184
  v_smfmac_f32_16x16x64_bf16 v[188:191], v[16:19], v[136:143], v20
  v_lshlrev_b32 v198, 16, v185
  v_smfmac_f32_16x16x64_bf16 v[192:195], v[16:19], v[144:151], v20
  v_and_b32 v199, 0xffff0000, v185
  v_smfmac_f32_16x16x64_bf16 v[188:191], v[16:19], v[152:159], v20
  v_lshlrev_b32 v200, 16, v186
  v_smfmac_f32_16x16x64_bf16 v[192:195], v[16:19], v[160:167], v20
  v_and_b32 v201, 0xffff0000, v186
  v_smfmac_f32_16x16x64_bf16 v[188:191], v[16:19], v[168:175], v20
  v_lshlrev_b32 v202, 16, v187
  v_smfmac_f32_16x16x64_bf16 v[192:195], v[16:19], v[176:183], v20
  v_and_b32 v203, 0xffff0000, v187
  s_bfe_u32 s92, s65, 131086
  s_lshl_b32 s92, s92, 21
  s_add_u32 s92, s92, s91
  s_add_u32 s93, s92, 27262976
  s_add_u32 s92, s92, 20971520
  s_nop 1
  v_permlane16_swap_b32 v188, v192
  v_permlane16_swap_b32 v189, v193
  v_permlane16_swap_b32 v190, v194
  v_permlane16_swap_b32 v191, v195
  v_cvt_pk_bf16_f32 v188, 0, v188
  v_cvt_pk_bf16_f32 v189, 0, v189
  v_cvt_pk_bf16_f32 v190, 0, v190
  v_cvt_pk_bf16_f32 v191, 0, v191
  v_cvt_pk_bf16_f32 v192, 0, v192
  v_cvt_pk_bf16_f32 v193, 0, v193
  v_cvt_pk_bf16_f32 v194, 0, v194
  v_cvt_pk_bf16_f32 v195, 0, v195
  v_add_f32 v196, v196, v188
  v_add_f32 v197, v197, v189
  v_add_f32 v198, v198, v190
  v_add_f32 v199, v199, v191
  v_add_f32 v200, v200, v192
  v_add_f32 v201, v201, v193
  v_add_f32 v202, v202, v194
  v_add_f32 v203, v203, v195
  v_cvt_pk_bf16_f32 v120, v196, v197
  v_cvt_pk_bf16_f32 v121, v198, v199
  v_cvt_pk_bf16_f32 v122, v200, v201
  v_cvt_pk_bf16_f32 v123, v202, v203
  v_lshlrev_b32 v196, 16, v120
  v_and_b32 v197, 0xffff0000, v120
  v_lshlrev_b32 v198, 16, v121
  v_and_b32 v199, 0xffff0000, v121
  v_lshlrev_b32 v200, 16, v122
  v_and_b32 v201, 0xffff0000, v122
  v_lshlrev_b32 v202, 16, v123
  v_and_b32 v203, 0xffff0000, v123
  buffer_store_dwordx4 v[120:123], v0, s[4:7], s92 offen sc1
  v_add_f32 v136, v196, v197
  v_mul_f32 v137, v196, v196
  v_add_f32 v138, v198, v199
  v_mul_f32 v139, v197, v197
  v_fmac_f32 v137, v198, v198
  v_fmac_f32 v139, v199, v199
  v_add_f32 v136, v136, v200
  v_fmac_f32 v137, v200, v200
  v_add_f32 v138, v138, v201
  v_fmac_f32 v139, v201, v201
  v_add_f32 v136, v136, v202
  v_fmac_f32 v137, v202, v202
  v_add_f32 v138, v138, v203
  v_fmac_f32 v139, v203, v203
  v_add_f32 v136, v136, v138
  v_add_f32 v137, v137, v139
  s_nop 0
  v_add_f32_dpp v136, v136, v136 row_ror:8 row_mask:0xf bank_mask:0xf
  v_add_f32_dpp v137, v137, v137 row_ror:8 row_mask:0xf bank_mask:0xf
  s_nop 0
  v_add_f32_dpp v136, v136, v136 row_ror:4 row_mask:0xf bank_mask:0xf
  v_add_f32_dpp v137, v137, v137 row_ror:4 row_mask:0xf bank_mask:0xf
  s_nop 0
  v_add_f32_dpp v136, v136, v136 row_ror:2 row_mask:0xf bank_mask:0xf
  v_add_f32_dpp v137, v137, v137 row_ror:2 row_mask:0xf bank_mask:0xf
  s_nop 0
  v_add_f32_dpp v136, v136, v136 row_ror:1 row_mask:0xf bank_mask:0xf
  v_add_f32_dpp v137, v137, v137 row_ror:1 row_mask:0xf bank_mask:0xf
  v_mov_b32 v140, v136
  v_mov_b32 v141, v137
  s_nop 0
  v_permlane16_swap_b32 v136, v140
  v_permlane16_swap_b32 v137, v141
  v_add_f32 v136, v136, v140
  v_add_f32 v137, v137, v141
  v_mov_b32 v140, v136
  v_mov_b32 v141, v137
  s_nop 0
  v_permlane32_swap_b32 v136, v140
  v_permlane32_swap_b32 v137, v141
  v_add_f32 v136, v136, v140
  v_add_f32 v137, v137, v141
  v_mul_f32 v136, 0x3b000000, v136
  v_mul_f32 v137, 0x3b000000, v137
  v_fma_f32 v137, -v136, v136, v137
  v_cvt_pk_bf16_f32 v136, 0, v136
  v_max_f32 v137, 0, v137
  v_sub_f32 v140, v196, v136
  v_sub_f32 v141, v197, v136
  v_cvt_pk_bf16_f32 v137, 0, v137
  v_sub_f32 v142, v198, v136
  v_sub_f32 v143, v199, v136
  v_add_f32 v137, 0x3727c5ac, v137
  v_sub_f32 v144, v200, v136
  v_sub_f32 v145, v201, v136
  v_cvt_pk_bf16_f32 v137, 0, v137
  v_sub_f32 v146, v202, v136
  v_sub_f32 v147, v203, v136
  v_sqrt_f32 v137, v137
  v_cvt_pk_bf16_f32 v140, 0, v140
  v_cvt_pk_bf16_f32 v141, 0, v141
  v_cvt_pk_bf16_f32 v137, 0, v137
  v_cvt_pk_bf16_f32 v142, 0, v142
  v_cvt_pk_bf16_f32 v143, 0, v143
  v_rcp_f32 v137, v137
  v_cvt_pk_bf16_f32 v144, 0, v144
  v_cvt_pk_bf16_f32 v145, 0, v145
  v_cvt_pk_bf16_f32 v146, 0, v146
  v_cvt_pk_bf16_f32 v147, 0, v147
  v_mul_f32 v140, v140, v137
  v_mul_f32 v141, v141, v137
  v_mul_f32 v142, v142, v137
  v_mul_f32 v143, v143, v137
  v_mul_f32 v144, v144, v137
  v_mul_f32 v145, v145, v137
  v_mul_f32 v146, v146, v137
  v_mul_f32 v147, v147, v137
  v_cvt_pk_bf16_f32 v124, v140, v141
  v_cvt_pk_bf16_f32 v125, v142, v143
  v_cvt_pk_bf16_f32 v126, v144, v145
  v_cvt_pk_bf16_f32 v127, v146, v147
  v_lshlrev_b32 v204, 16, v124
  v_and_b32 v205, 0xffff0000, v124
  v_lshlrev_b32 v206, 16, v125
  v_and_b32 v207, 0xffff0000, v125
  v_lshlrev_b32 v208, 16, v126
  v_and_b32 v209, 0xffff0000, v126
  v_lshlrev_b32 v210, 16, v127
  v_and_b32 v211, 0xffff0000, v127
  buffer_store_dwordx4 v[124:127], v0, s[4:7], s93 offen sc1
  v_add_f32 v196, v196, v204
  v_add_f32 v197, v197, v205
  v_add_f32 v198, v198, v206
  v_add_f32 v199, v199, v207
  v_add_f32 v200, v200, v208
  v_add_f32 v201, v201, v209
  v_add_f32 v202, v202, v210
  v_add_f32 v203, v203, v211
  v_cvt_pk_bf16_f32 v128, v196, v197
  v_cvt_pk_bf16_f32 v129, v198, v199
  v_cvt_pk_bf16_f32 v130, v200, v201
  v_cvt_pk_bf16_f32 v131, v202, v203
  v_mul_f32 v188, v204, v8
  v_mul_f32 v189, v205, v9
  v_fmac_f32 v188, v206, v10
  v_fmac_f32 v189, v207, v11
  v_fmac_f32 v188, v208, v12
  v_fmac_f32 v189, v209, v13
  v_fmac_f32 v188, v210, v14
  v_fmac_f32 v189, v211, v15
  v_add_f32 v188, v188, v189
  buffer_store_dwordx4 v[128:131], v0, s[68:71], s91 offen sc1
  s_nop 0
  v_add_f32_dpp v188, v188, v188 row_ror:8 row_mask:0xf bank_mask:0xf
  s_nop 1
  v_add_f32_dpp v188, v188, v188 row_ror:4 row_mask:0xf bank_mask:0xf
  s_nop 1
  v_add_f32_dpp v188, v188, v188 row_ror:2 row_mask:0xf bank_mask:0xf
  s_nop 1
  v_add_f32_dpp v188, v188, v188 row_ror:1 row_mask:0xf bank_mask:0xf
  v_mov_b32 v189, v188
  s_nop 0
  s_nop 0
  v_permlane16_swap_b32 v188, v189
  v_add_f32 v188, v188, v189
  v_mov_b32 v189, v188
  s_nop 0
  s_nop 0
  v_permlane32_swap_b32 v188, v189
  v_add_f32 v188, v188, v189
  v_cvt_pk_bf16_f32 v188, 0, v188
  v_ashrrev_i32 v189, 31, v188
  v_or_b32 v189, 0x80000000, v189
  v_xor_b32 v188, v188, v189
  s_sub_u32 s92, 4095, s90
  v_and_b32 v188, 0xffff0000, v188
  v_or_b32 v38, s92, v188
  s_bfe_u32 s92, s65, 196625
  s_lshl_b32 s92, s92, 18
  s_lshl_b32 s93, s90, 7
  s_add_u32 s92, s92, s93
  s_add_u32 s84, s92, 243269632
  s_waitcnt vmcnt(0)
  s_mov_b64 exec, 1
  buffer_store_dword v38, off, s[4:7], s84 sc1
  s_mov_b64 exec, -1
  s_mov_b32 s84, 268435456
  s_branch o_fd_221
o_rt_228:
  s_mov_b32 s67, 0
o_rl_230:
  s_lshl_b32 s94, s43, 14
  s_add_u32 s94, s94, s86
  buffer_load_dwordx4 v[120:123], v5, s[4:7], s94 offen offset:0 sc1
  buffer_load_dwordx4 v[124:127], v5, s[4:7], s94 offen offset:512 sc1
  buffer_load_dwordx4 v[128:131], v5, s[4:7], s94 offen offset:256 sc1
  buffer_load_dwordx4 v[132:135], v5, s[4:7], s94 offen offset:768 sc1
  s_add_u32 s94, s94, 4096
  buffer_load_dwordx4 v[136:139], v5, s[4:7], s94 offen offset:0 sc1
  buffer_load_dwordx4 v[140:143], v5, s[4:7], s94 offen offset:512 sc1
  buffer_load_dwordx4 v[144:147], v5, s[4:7], s94 offen offset:256 sc1
  buffer_load_dwordx4 v[148:151], v5, s[4:7], s94 offen offset:768 sc1
  s_add_u32 s94, s94, 4096
  buffer_load_dwordx4 v[152:155], v5, s[4:7], s94 offen offset:0 sc1
  buffer_load_dwordx4 v[156:159], v5, s[4:7], s94 offen offset:512 sc1
  buffer_load_dwordx4 v[160:163], v5, s[4:7], s94 offen offset:256 sc1
  buffer_load_dwordx4 v[164:167], v5, s[4:7], s94 offen offset:768 sc1
  s_add_u32 s94, s94, 4096
  buffer_load_dwordx4 v[168:171], v5, s[4:7], s94 offen offset:0 sc1
  buffer_load_dwordx4 v[172:175], v5, s[4:7], s94 offen offset:512 sc1
  buffer_load_dwordx4 v[176:179], v5, s[4:7], s94 offen offset:256 sc1
  buffer_load_dwordx4 v[180:183], v5, s[4:7], s94 offen offset:768 sc1
  s_add_u32 s67, s67, 1
  s_cmp_gt_u32 s67, 1048576
  s_cbranch_scc1 L_end
  s_waitcnt vmcnt(0)
  v_xor_b32 v7, s96, v120
  v_bitop3_b32 v7, v7, v124, s96 bitop3:0xf6
  v_bitop3_b32 v7, v7, v128, s96 bitop3:0xf6
  v_bitop3_b32 v7, v7, v132, s96 bitop3:0xf6
  v_bitop3_b32 v7, v7, v136, s96 bitop3:0xf6
  v_bitop3_b32 v7, v7, v140, s96 bitop3:0xf6
  v_bitop3_b32 v7, v7, v144, s96 bitop3:0xf6
  v_bitop3_b32 v7, v7, v148, s96 bitop3:0xf6
  v_bitop3_b32 v7, v7, v152, s96 bitop3:0xf6
  v_bitop3_b32 v7, v7, v156, s96 bitop3:0xf6
  v_bitop3_b32 v7, v7, v160, s96 bitop3:0xf6
  v_bitop3_b32 v7, v7, v164, s96 bitop3:0xf6
  v_bitop3_b32 v7, v7, v168, s96 bitop3:0xf6
  v_bitop3_b32 v7, v7, v172, s96 bitop3:0xf6
  v_bitop3_b32 v7, v7, v176, s96 bitop3:0xf6
  v_bitop3_b32 v7, v7, v180, s96 bitop3:0xf6
  v_and_b32 v7, v254, v7
  v_cmp_ne_u32 vcc, 0, v7
  s_cbranch_vccnz o_rl_230
  s_branch o_bk_229
o_fd_221:
  s_mov_b32 s65, 0
o_nofl_181:
  s_mov_b32 s63, s64
  s_cmp_lg_u32 s51, 0
  s_cbranch_scc1 o_pick_183
  s_cmp_eq_u32 s50, 0
  s_cbranch_scc1 o_help_190_n
o_adv_189:
  s_add_u32 s49, s49, 4
  s_branch o_round_179
o_dl_191_a:
  s_andn2_b32 s26, s58, s55
  s_and_b32 s29, s26, s54
  s_bcnt1_i32_b32 s27, s29
  s_add_u32 s27, s27, 2
  s_max_u32 s27, s27, 4
  s_andn2_b32 s26, s26, s56
  s_and_b32 s26, s26, 0x3fff
  s_or_b32 s26, s26, s29
  s_cselect_b32 s27, s27, 0
  s_mul_i32 s27, s27, 0
  s_cmp_ge_u32 s46, s89
  s_cselect_b32 s30, s54, -1
  s_mov_b32 s31, 243269696
  s_branch o_dl_191_b
o_dl_191:
  s_and_b32 s26, s55, s54
  s_andn2_b32 s27, s56, s54
  s_or_b32 s26, s26, s27
  s_andn2_b32 s26, s58, s26
  s_bcnt1_i32_b32 s27, s26
  s_bcnt1_i32_b32 s28, s47
  s_mul_i32 s28, s28, -5
  s_lshl1_add_u32 s27, s27, s28
  s_add_i32 s27, s27, 1
  s_max_i32 s27, s27, 0
  s_mul_i32 s27, s27, 37
  s_mov_b32 s30, s54
  s_mov_b32 s31, 243269704
  s_and_b32 s29, s26, s47
  s_andn2_b32 s26, s26, s29
  s_branch o_dl_191_c
o_dl_191_b:
  s_mov_b32 s29, 0
o_dl_191_c:
  s_bfe_u32 s28, s48, 262144
  s_bitset0_b32 s26, s28
  s_bfe_u32 s28, s48, 262148
  s_bitset0_b32 s26, s28
  s_bfe_u32 s28, s48, 262152
  s_bitset0_b32 s26, s28
  s_bfe_u32 s28, s48, 262156
  s_bitset0_b32 s26, s28
  s_lshr_b32 s27, s27, 8
o_dl1_192:
  s_cbranch_scc0 o_dl2_193
  s_ff1_i32_b32 s28, s26
  s_bitset0_b32 s26, s28
  s_bitset1_b32 s29, s28
  s_sub_u32 s27, s27, 1
  s_cmp_lg_u32 s27, 0
  s_branch o_dl1_192
o_dl2_193:
  s_and_b32 s47, s29, 0xffff
  s_and_b32 s30, s30, s47
  s_or_b32 s55, s55, s30
  s_andn2_b32 s26, s47, s30
  s_or_b32 s56, s56, s26
  s_pack_ll_b32_b16 s26, s47, s30
  s_lshl_b32 s27, s60, 7
  s_add_u32 s27, s27, s31
  s_cmp_lg_u32 s43, 0
  s_cbranch_scc1 o_pick_183
  v_mov_b32 v162, s26
  v_mov_b32 v163, s46
  s_mov_b64 exec, 1
  buffer_store_dwordx2 v[162:163], off, s[4:7], s27 sc1
  s_mov_b64 exec, -1
  s_branch o_pick_183
o_help_190:
  s_lshl_b32 s60, s60, 1
  s_and_b32 s60, s60, 2
  s_lshl_b32 s47, s60, 7
  s_add_u32 s47, s47, 243269688
o_help_190_n:
  s_add_u32 s47, s47, 8
  s_lshr_b32 s26, s47, 4
  s_andn2_b32 s26, s57, s26
  s_cbranch_scc0 L_end
  s_mov_b32 s67, 0
o_help_190_w:
  buffer_load_dwordx2 v[162:163], off, s[4:7], s47 sc1
  buffer_load_dwordx2 v[164:165], off, s[4:7], s47 offset:128 sc1
  s_add_u32 s67, s67, 1
  s_cmp_gt_u32 s67, 1048576
  s_cbranch_scc1 L_end
  s_waitcnt vmcnt(0)
  v_readfirstlane_b32 s28, v162
  v_readfirstlane_b32 s30, v164
  v_readfirstlane_b32 s46, v163
  v_readfirstlane_b32 s27, v165
  s_min_u32 s26, s46, s27
  s_cmp_eq_u32 s26, 0
  s_cbranch_scc1 o_help_190_w
  s_max_u32 s46, s46, s27
  s_bitreplicate_b64_b32 s[28:29], s28
  s_bitreplicate_b64_b32 s[30:31], s30
  s_mov_b32 s26, 0x55555555
  s_mov_b32 s27, 0x55555555
  s_and_b64 s[28:29], s[28:29], s[26:27]
  s_andn2_b64 s[30:31], s[30:31], s[26:27]
  s_or_b32 s58, s28, s30
  s_or_b32 s54, s29, s31
  s_andn2_b32 s52, 0xfff, s46
  s_lshr_b32 s52, s52, 5
  s_mov_b32 s53, 0
  s_mov_b32 s63, 0
  s_mov_b32 s49, 72
  s_mov_b32 s59, 64
  s_mov_b32 s50, 0
  s_mov_b32 s89, 0
  s_branch o_pick_183

.section .rodata,"a"
.p2align 6
.amdhsa_kernel interleave_layers__memory_aug_recurrent_mem_tr__moe_arch_mod__prompt_kernel
  .amdhsa_next_free_vgpr 512
  .amdhsa_next_free_sgpr 102
  .amdhsa_accum_offset 256
  .amdhsa_group_segment_fixed_size 0
  .amdhsa_kernarg_size 120
  .amdhsa_user_sgpr_count 2
  .amdhsa_user_sgpr_kernarg_segment_ptr 1
  .amdhsa_system_sgpr_workgroup_id_x 1
  .amdhsa_float_denorm_mode_32 3
.end_amdhsa_kernel
```

```asm
; @launch grid=(256,1,1) block=(256,1,1) lds=163840
.amdgcn_target "amdgcn-amd-amdhsa--gfx950"
.text
.globl interleave_layers__memory_aug_recurrent_mem_tr__moe_arch_mod__prompt_kernel
.p2align 8
.type interleave_layers__memory_aug_recurrent_mem_tr__moe_arch_mod__prompt_kernel,@function
interleave_layers__memory_aug_recurrent_mem_tr__moe_arch_mod__prompt_kernel:
  s_cmp_ge_u32 s2, 256
  s_cbranch_scc1 L_end
  s_mov_b32 s6, 268435456
  s_mov_b32 s7, 0x20000
  s_mov_b32 s11, 0x20000
  s_getreg_b32 s89, hwreg(HW_REG_XCC_ID)
  s_and_b32 s89, s89, 7
  v_lshrrev_b32 v1, 6, v0
  s_and_b32 s91, s2, 7
  s_lshr_b32 s90, s2, 3
  v_readfirstlane_b32 s17, v1
  s_lshl_b32 s100, s91, 5
  s_add_u32 s100, s100, s90
  s_lshl_b32 s100, s100, 2
  s_add_u32 s100, s100, s17
  s_lshl_b32 s100, s100, 12
  s_add_u32 s100, s100, 37748736
  s_cmp_lt_u32 s91, 3
  s_cbranch_scc1 L_chain
  s_cmp_eq_u32 s91, 7
  s_cbranch_scc1 L_qkv
  s_bitcmp1_b32 s90, 4
  s_cbranch_scc1 L_qkv
  s_branch L_o
L_end:
  s_endpgm
L_chain:
  s_load_dwordx2 s[4:5], s[0:1], 112
  s_load_dwordx2 s[12:13], s[0:1], 104
  s_mov_b32 s16, s90
  s_mov_b32 s60, s91
  s_min_u32 s61, s91, 1
  v_lshrrev_b32 v18, 6, v0
  v_and_b32 v19, 63, v0
  v_readfirstlane_b32 s17, v18
  v_and_b32 v7, 15, v19
  v_lshrrev_b32 v17, 4, v19
  v_lshlrev_b32 v0, 4, v19
  s_load_dwordx2 s[56:57], s[0:1], 8
  s_mov_b32 s44, 0x05040100
  s_mov_b32 s45, 0x07060302
  s_mov_b32 s18, 0xcccccccc
  s_mov_b32 s19, 0xcccccccc
  s_mov_b32 s24, 0x3e0293ee
  s_lshl_b32 s26, s17, 10
  v_add_u32 v8, s26, v0
  v_xor_b32 v9, 1024, v8
  v_xor_b32 v10, 2048, v8
  v_xor_b32 v11, 3072, v8
  s_mov_b32 s14, 0x3f803f80
  s_mov_b32 s15, 0x3f803f80
  s_mul_i32 s27, s17, 24576
  s_add_u32 s27, s27, 65536
  v_add_u32 v1, s27, v0
  v_lshrrev_b32 v20, 2, v7
  v_xor_b32 v21, v17, v20
  v_lshlrev_b32 v22, 5, v7
  v_add_u32 v22, s26, v22
  v_lshl_add_u32 v2, v21, 3, v22
  v_and_b32 v21, 3, v7
  v_xor_b32 v21, v21, v17
  v_lshl_add_u32 v22, v17, 2, v20
  v_lshlrev_b32 v22, 5, v22
  v_lshl_add_u32 v3, v21, 3, v22
  v_add_u32 v12, s26, v3
  v_xor_b32 v13, 1024, v12
  v_xor_b32 v14, 2048, v12
  v_xor_b32 v15, 3072, v12
  v_lshlrev_b32 v21, 13, v20
  v_and_b32 v22, 3, v7
  v_lshl_add_u32 v22, v17, 2, v22
  v_lshl_add_u32 v21, v22, 4, v21
  s_lshl_b32 s27, s17, 15
  s_lshl_b32 s28, s16, 8
  s_add_u32 s27, s27, s28
  v_add_u32 v4, s27, v21
  v_and_b32 v21, 1, v7
  v_lshl_add_u32 v21, v17, 2, v21
  v_bfe_u32 v22, v7, 2, 1
  v_lshl_add_u32 v21, v22, 1, v21
  v_lshlrev_b32 v21, 4, v21
  v_bfe_u32 v22, v7, 1, 1
  v_lshl_add_u32 v21, v22, 3, v21
  v_add_u32 v5, s28, v21
  v_cmp_lt_u32 vcc, 7, v7
  v_mov_b32 v22, 0x7ff00000
  s_nop 0
  v_cndmask_b32 v5, v5, v22, vcc
  v_mov_b32 v21, 0x4444
  v_mov_b32 v22, 0xeeee
  v_cndmask_b32 v6, v21, v22, s[18:19]
  s_lshl_b32 s40, s60, 20
  s_add_u32 s40, s40, 0
  s_add_u32 s41, s40, 131072
  s_lshl_b32 s62, s60, 16
  s_add_u32 s62, s62, 4194304
  v_mov_b32 v24, -1
  v_mov_b32 v25, -1
  v_mov_b32 v26, -1
  v_mov_b32 v27, -1
  s_waitcnt lgkmcnt(0)
  buffer_store_dwordx4 v[24:27], v4, s[4:7], s40 offen sc1
  buffer_store_dwordx4 v[24:27], v4, s[4:7], s41 offen sc1
  s_add_u32 s27, s62, 0
  buffer_store_dwordx2 v[24:25], v5, s[4:7], s27 offen sc1
  s_add_u32 s27, s62, 8192
  buffer_store_dwordx2 v[24:25], v5, s[4:7], s27 offen sc1
  s_add_u32 s27, s62, 16384
  buffer_store_dwordx2 v[24:25], v5, s[4:7], s27 offen sc1
  s_add_u32 s27, s62, 24576
  buffer_store_dwordx2 v[24:25], v5, s[4:7], s27 offen sc1
  v_mov_b64 v[28:29], 0
  v_mov_b64 v[30:31], 0
  s_lshl_b32 s26, s16, 12
  s_cmp_eq_u32 s91, 0
  s_cbranch_scc1 L_ch1
  s_cmp_eq_u32 s91, 2
  s_cbranch_scc1 L_ch2
  s_add_u32 s27, s26, 243269632
  buffer_store_dwordx4 v[28:31], v8, s[4:7], s27 offen sc1
  s_add_u32 s27, s26, 243400704
  buffer_store_dwordx4 v[28:31], v8, s[4:7], s27 offen sc1
  s_add_u32 s27, s26, 243531776
  buffer_store_dwordx4 v[28:31], v8, s[4:7], s27 offen sc1
  s_add_u32 s27, s26, 243662848
  buffer_store_dwordx4 v[28:31], v8, s[4:7], s27 offen sc1
  s_add_u32 s27, s26, 243793920
  buffer_store_dwordx4 v[28:31], v8, s[4:7], s27 offen sc1
  s_add_u32 s27, s26, 243924992
  buffer_store_dwordx4 v[28:31], v8, s[4:7], s27 offen sc1
  s_add_u32 s27, s26, 244056064
  buffer_store_dwordx4 v[28:31], v8, s[4:7], s27 offen sc1
  s_add_u32 s27, s26, 244187136
  buffer_store_dwordx4 v[28:31], v8, s[4:7], s27 offen sc1
  s_add_u32 s27, s26, 244318208
  buffer_store_dwordx4 v[28:31], v8, s[4:7], s27 offen sc1
  s_add_u32 s27, s26, 244449280
  buffer_store_dwordx4 v[28:31], v8, s[4:7], s27 offen sc1
  s_add_u32 s27, s26, 244580352
  buffer_store_dwordx4 v[28:31], v8, s[4:7], s27 offen sc1
  s_add_u32 s27, s26, 244711424
  buffer_store_dwordx4 v[28:31], v8, s[4:7], s27 offen sc1
  s_add_u32 s27, s26, 244842496
  buffer_store_dwordx4 v[28:31], v8, s[4:7], s27 offen sc1
  s_add_u32 s27, s26, 244973568
  buffer_store_dwordx4 v[28:31], v8, s[4:7], s27 offen sc1
  s_add_u32 s27, s26, 245104640
  buffer_store_dwordx4 v[28:31], v8, s[4:7], s27 offen sc1
  s_add_u32 s27, s26, 245235712
  buffer_store_dwordx4 v[28:31], v8, s[4:7], s27 offen sc1
  s_add_u32 s27, s26, 245366784
  buffer_store_dwordx4 v[28:31], v8, s[4:7], s27 offen sc1
  s_branch L_ch0
L_ch2:
  s_add_u32 s27, s26, 245891072
  buffer_store_dwordx4 v[24:27], v8, s[4:7], s27 offen sc1
  s_add_u32 s27, s26, 246022144
  buffer_store_dwordx4 v[24:27], v8, s[4:7], s27 offen sc1
  s_add_u32 s27, s26, 246153216
  buffer_store_dwordx4 v[24:27], v8, s[4:7], s27 offen sc1
  s_add_u32 s27, s26, 246284288
  buffer_store_dwordx4 v[24:27], v8, s[4:7], s27 offen sc1
  s_add_u32 s27, s26, 246415360
  buffer_store_dwordx4 v[24:27], v8, s[4:7], s27 offen sc1
  s_add_u32 s27, s26, 246546432
  buffer_store_dwordx4 v[24:27], v8, s[4:7], s27 offen sc1
  s_add_u32 s27, s26, 246677504
  buffer_store_dwordx4 v[24:27], v8, s[4:7], s27 offen sc1
  s_add_u32 s27, s26, 246808576
  buffer_store_dwordx4 v[24:27], v8, s[4:7], s27 offen sc1
  s_add_u32 s27, s26, 246939648
  buffer_store_dwordx4 v[24:27], v8, s[4:7], s27 offen sc1
  s_add_u32 s27, s26, 247070720
  buffer_store_dwordx4 v[24:27], v8, s[4:7], s27 offen sc1
  s_add_u32 s27, s26, 247201792
  buffer_store_dwordx4 v[24:27], v8, s[4:7], s27 offen sc1
  s_add_u32 s27, s26, 247332864
  buffer_store_dwordx4 v[24:27], v8, s[4:7], s27 offen sc1
  s_add_u32 s27, s26, 247463936
  buffer_store_dwordx4 v[24:27], v8, s[4:7], s27 offen sc1
  s_add_u32 s27, s26, 247595008
  buffer_store_dwordx4 v[24:27], v8, s[4:7], s27 offen sc1
  s_add_u32 s27, s26, 247726080
  buffer_store_dwordx4 v[24:27], v8, s[4:7], s27 offen sc1
  s_add_u32 s27, s26, 247857152
  buffer_store_dwordx4 v[24:27], v8, s[4:7], s27 offen sc1
  s_add_u32 s27, s26, 247988224
  buffer_store_dwordx4 v[24:27], v8, s[4:7], s27 offen sc1
  s_add_u32 s27, s26, 248119296
  buffer_store_dwordx4 v[24:27], v8, s[4:7], s27 offen sc1
  s_add_u32 s27, s26, 248250368
  buffer_store_dwordx4 v[24:27], v8, s[4:7], s27 offen sc1
  s_add_u32 s27, s26, 248381440
  buffer_store_dwordx4 v[24:27], v8, s[4:7], s27 offen sc1
  s_add_u32 s27, s26, 248512512
  buffer_store_dwordx4 v[24:27], v8, s[4:7], s27 offen sc1
  s_add_u32 s27, s26, 248643584
  buffer_store_dwordx4 v[24:27], v8, s[4:7], s27 offen sc1
  s_add_u32 s27, s26, 16777216
  buffer_store_dwordx4 v[28:31], v8, s[4:7], s27 offen sc1
  s_add_u32 s27, s26, 16908288
  buffer_store_dwordx4 v[28:31], v8, s[4:7], s27 offen sc1
  s_add_u32 s27, s26, 17039360
  buffer_store_dwordx4 v[28:31], v8, s[4:7], s27 offen sc1
  s_add_u32 s27, s26, 17170432
  buffer_store_dwordx4 v[28:31], v8, s[4:7], s27 offen sc1
  s_add_u32 s27, s26, 17301504
  buffer_store_dwordx4 v[28:31], v8, s[4:7], s27 offen sc1
  s_add_u32 s27, s26, 17432576
  buffer_store_dwordx4 v[28:31], v8, s[4:7], s27 offen sc1
  s_add_u32 s27, s26, 17563648
  buffer_store_dwordx4 v[28:31], v8, s[4:7], s27 offen sc1
  s_add_u32 s27, s26, 17694720
  buffer_store_dwordx4 v[28:31], v8, s[4:7], s27 offen sc1
  s_add_u32 s27, s26, 17825792
  buffer_store_dwordx4 v[28:31], v8, s[4:7], s27 offen sc1
  s_add_u32 s27, s26, 17956864
  buffer_store_dwordx4 v[28:31], v8, s[4:7], s27 offen sc1
  s_add_u32 s27, s26, 18087936
  buffer_store_dwordx4 v[28:31], v8, s[4:7], s27 offen sc1
  s_add_u32 s27, s26, 18219008
  buffer_store_dwordx4 v[28:31], v8, s[4:7], s27 offen sc1
  s_add_u32 s27, s26, 18350080
  buffer_store_dwordx4 v[28:31], v8, s[4:7], s27 offen sc1
  s_add_u32 s27, s26, 18481152
  buffer_store_dwordx4 v[28:31], v8, s[4:7], s27 offen sc1
  s_add_u32 s27, s26, 18612224
  buffer_store_dwordx4 v[28:31], v8, s[4:7], s27 offen sc1
  s_add_u32 s27, s26, 18743296
  buffer_store_dwordx4 v[28:31], v8, s[4:7], s27 offen sc1
L_ch0:
  s_waitcnt vmcnt(0)
  s_barrier
  s_cmp_lg_u32 s17, 0
  s_cbranch_scc1 g_ar_1
  s_lshl_b32 s36, s89, 3
  s_lshl_b64 s[36:37], 1, s36
  v_lshlrev_b32 v124, 3, s91
  v_mov_b32 v120, s36
  v_mov_b32 v121, s37
  s_mov_b64 exec, 1
  global_atomic_add_x2 v[122:123], v124, v[120:121], s[12:13] sc0
  s_mov_b64 exec, -1
g_ar_1:
  s_waitcnt vmcnt(0)
  s_cmp_lg_u32 s17, 0
  s_cbranch_scc1 g_af_2
  v_readfirstlane_b32 s36, v122
  v_readfirstlane_b32 s37, v123
  s_add_u32 s38, s36, s37
  s_mul_i32 s38, s38, 0x01010101
  s_lshr_b32 s38, s38, 24
  s_cmp_lg_u32 s38, 31
  s_cbranch_scc1 g_af_2
  s_lshl_b32 s38, s89, 3
  s_lshr_b64 s[36:37], s[36:37], s38
  s_and_b32 s36, s36, 0xff
  s_cmp_eq_u32 s36, 31
  s_cselect_b32 s36, 1, 2
  v_mov_b32 v120, s36
  v_lshrrev_b32 v124, 1, v124
  s_mov_b64 exec, 1
  global_store_dword v124, v120, s[12:13] offset:128 sc1
  s_mov_b64 exec, -1
g_af_2:
L_ch1:
  s_mov_b32 s58, 8192
  s_mov_b32 s59, 0x20000
  v_and_b32 v21, 1, v7
  v_lshl_add_u32 v21, v17, 1, v21
  v_lshlrev_b32 v21, 10, v21
  v_bfe_u32 v22, v7, 1, 2
  v_lshl_add_u32 v21, v22, 1, v21
  s_and_b32 s27, s16, 15
  s_lshl_b32 s27, s27, 6
  s_lshr_b32 s28, s16, 4
  s_lshl_b32 s28, s28, 3
  s_add_u32 s27, s27, s28
  s_waitcnt lgkmcnt(0)
  buffer_load_ushort v28, v21, s[56:59], s27 offen offset:0
  buffer_load_ushort v29, v21, s[56:59], s27 offen offset:16
  buffer_load_ushort v30, v21, s[56:59], s27 offen offset:32
  buffer_load_ushort v31, v21, s[56:59], s27 offen offset:48
  s_cmp_eq_u32 s91, 0
  s_cbranch_scc1 L_ha
  v_mbcnt_lo_u32_b32 v116, -1, 0
  v_and_b32 v116, 0, v116
  v_add_lshl_u32 v116, v116, 1, 2
  s_mov_b32 s26, 0
g_wt_3:
  global_load_dword v117, v116, s[12:13] offset:128 sc1
  s_add_u32 s26, s26, 1
  s_cmp_gt_u32 s26, 1048576
  s_cbranch_scc1 L_end
  s_waitcnt vmcnt(0)
  v_cmp_eq_u32 vcc, 0, v117
  v_readfirstlane_b32 s27, v117
  s_cbranch_vccnz g_wt_3
  s_and_b32 s28, s16, 28
  s_or_b32 s28, s28, 1
  s_lshl_b32 s27, s28, 6
  s_add_u32 s27, s27, 245104640
  s_mov_b32 s26, 0
g_h_4:
  buffer_load_dwordx2 v[116:117], off, s[4:7], s27 sc1
  s_add_u32 s26, s26, 1
  s_cmp_gt_u32 s26, 1048576
  s_cbranch_scc1 L_end
  s_waitcnt vmcnt(0)
  v_and_or_b32 v116, v117, -1, v116
  v_cmp_eq_u32 vcc, 0, v116
  s_cbranch_vccnz g_h_4
L_ha:
  s_load_dwordx2 s[8:9], s[0:1], 40
  s_load_dwordx2 s[52:53], s[0:1], 16
  s_load_dwordx2 s[32:33], s[0:1], 24
  s_load_dwordx2 s[48:49], s[0:1], 32
  s_mov_b32 s10, 4194304
  s_mov_b32 s11, 0x20000
  s_mov_b32 s54, 4194304
  s_mov_b32 s55, 0x20000
  s_mov_b32 s34, 4194304
  s_mov_b32 s35, 0x20000
  s_mov_b32 s50, 4194304
  s_mov_b32 s51, 0x20000
  v_and_b32 v20, 1, v17
  v_lshlrev_b32 v20, 5, v20
  v_lshrrev_b32 v21, 1, v17
  v_lshl_add_u32 v20, v21, 2, v20
  v_lshlrev_b32 v20, 10, v20
  v_lshl_add_u32 v20, v7, 4, v20
  s_lshl_b32 s26, s16, 17
  s_lshl_b32 s27, s17, 8
  s_add_u32 s26, s26, s27
  s_waitcnt lgkmcnt(0)
  s_add_u32 s27, s26, 0
  buffer_load_dwordx4 v[128:131], v20, s[8:11], s27 offen
  s_add_u32 s27, s26, 1024
  buffer_load_dwordx4 v[132:135], v20, s[8:11], s27 offen
  s_add_u32 s27, s26, 16384
  buffer_load_dwordx4 v[136:139], v20, s[8:11], s27 offen
  s_add_u32 s27, s26, 17408
  buffer_load_dwordx4 v[140:143], v20, s[8:11], s27 offen
  s_add_u32 s27, s26, 2048
  buffer_load_dwordx4 v[144:147], v20, s[8:11], s27 offen
  s_add_u32 s27, s26, 3072
  buffer_load_dwordx4 v[148:151], v20, s[8:11], s27 offen
  s_add_u32 s27, s26, 18432
  buffer_load_dwordx4 v[152:155], v20, s[8:11], s27 offen
  s_add_u32 s27, s26, 19456
  buffer_load_dwordx4 v[156:159], v20, s[8:11], s27 offen
  s_add_u32 s27, s26, 8192
  buffer_load_dwordx4 v[160:163], v20, s[8:11], s27 offen
  s_add_u32 s27, s26, 9216
  buffer_load_dwordx4 v[164:167], v20, s[8:11], s27 offen
  s_add_u32 s27, s26, 24576
  buffer_load_dwordx4 v[168:171], v20, s[8:11], s27 offen
  s_add_u32 s27, s26, 25600
  buffer_load_dwordx4 v[172:175], v20, s[8:11], s27 offen
  s_add_u32 s27, s26, 10240
  buffer_load_dwordx4 v[176:179], v20, s[8:11], s27 offen
  s_add_u32 s27, s26, 11264
  buffer_load_dwordx4 v[180:183], v20, s[8:11], s27 offen
  s_add_u32 s27, s26, 26624
  buffer_load_dwordx4 v[184:187], v20, s[8:11], s27 offen
  s_add_u32 s27, s26, 27648
  buffer_load_dwordx4 v[188:191], v20, s[8:11], s27 offen
  s_add_u32 s27, s26, 65536
  buffer_load_dwordx4 v[192:195], v20, s[8:11], s27 offen
  s_add_u32 s27, s26, 66560
  buffer_load_dwordx4 v[196:199], v20, s[8:11], s27 offen
  s_add_u32 s27, s26, 81920
  buffer_load_dwordx4 v[200:203], v20, s[8:11], s27 offen
  s_add_u32 s27, s26, 82944
  buffer_load_dwordx4 v[204:207], v20, s[8:11], s27 offen
  s_add_u32 s27, s26, 67584
  buffer_load_dwordx4 v[208:211], v20, s[8:11], s27 offen
  s_add_u32 s27, s26, 68608
  buffer_load_dwordx4 v[212:215], v20, s[8:11], s27 offen
  s_add_u32 s27, s26, 83968
  buffer_load_dwordx4 v[216:219], v20, s[8:11], s27 offen
  s_add_u32 s27, s26, 84992
  buffer_load_dwordx4 v[220:223], v20, s[8:11], s27 offen
  s_add_u32 s27, s26, 73728
  buffer_load_dwordx4 v[224:227], v20, s[8:11], s27 offen
  s_add_u32 s27, s26, 74752
  buffer_load_dwordx4 v[228:231], v20, s[8:11], s27 offen
  s_add_u32 s27, s26, 90112
  buffer_load_dwordx4 v[232:235], v20, s[8:11], s27 offen
  s_add_u32 s27, s26, 91136
  buffer_load_dwordx4 v[236:239], v20, s[8:11], s27 offen
  s_add_u32 s27, s26, 75776
  buffer_load_dwordx4 v[240:243], v20, s[8:11], s27 offen
  s_add_u32 s27, s26, 76800
  buffer_load_dwordx4 v[244:247], v20, s[8:11], s27 offen
  s_add_u32 s27, s26, 92160
  buffer_load_dwordx4 v[248:251], v20, s[8:11], s27 offen
  s_add_u32 s27, s26, 93184
  buffer_load_dwordx4 v[252:255], v20, s[8:11], s27 offen
  v_lshrrev_b32 v20, 8, v0
  v_and_b32 v22, 0xf0, v0
  v_lshlrev_b32 v23, 6, v20
  v_xor_b32 v22, v22, v23
  v_lshl_add_u32 v22, v20, 13, v22
  v_xor_b32 v23, 32, v22
  s_lshl_b32 s26, s17, 20
  s_lshl_b32 s27, s16, 8
  s_add_u32 s26, s26, s27
  s_lshl_b32 s28, s17, 13
  s_add_u32 s27, s26, 0
  s_add_u32 m0, s28, 65536
  s_nop 0
  buffer_load_dwordx4 v22, s[32:35], s27 offen lds
  s_add_u32 m0, s28, 66560
  s_add_u32 s27, s27, 32768
  buffer_load_dwordx4 v22, s[32:35], s27 offen lds
  s_add_u32 m0, s28, 67584
  s_add_u32 s27, s27, 32768
  buffer_load_dwordx4 v23, s[32:35], s27 offen lds
  s_add_u32 m0, s28, 68608
  s_add_u32 s27, s27, 32768
  buffer_load_dwordx4 v23, s[32:35], s27 offen lds
  s_add_u32 s27, s26, 262144
  s_add_u32 m0, s28, 69632
  s_nop 0
  buffer_load_dwordx4 v22, s[32:35], s27 offen lds
  s_add_u32 m0, s28, 70656
  s_add_u32 s27, s27, 32768
  buffer_load_dwordx4 v22, s[32:35], s27 offen lds
  s_add_u32 m0, s28, 71680
  s_add_u32 s27, s27, 32768
  buffer_load_dwordx4 v23, s[32:35], s27 offen lds
  s_add_u32 m0, s28, 72704
  s_add_u32 s27, s27, 32768
  buffer_load_dwordx4 v23, s[32:35], s27 offen lds
  s_add_u32 s27, s26, 131072
  s_add_u32 m0, s28, 98304
  s_nop 0
  buffer_load_dwordx4 v22, s[32:35], s27 offen lds
  s_add_u32 m0, s28, 99328
  s_add_u32 s27, s27, 32768
  buffer_load_dwordx4 v22, s[32:35], s27 offen lds
  s_add_u32 m0, s28, 100352
  s_add_u32 s27, s27, 32768
  buffer_load_dwordx4 v23, s[32:35], s27 offen lds
  s_add_u32 m0, s28, 101376
  s_add_u32 s27, s27, 32768
  buffer_load_dwordx4 v23, s[32:35], s27 offen lds
  s_add_u32 s27, s26, 393216
  s_add_u32 m0, s28, 102400
  s_nop 0
  buffer_load_dwordx4 v22, s[32:35], s27 offen lds
  s_add_u32 m0, s28, 103424
  s_add_u32 s27, s27, 32768
  buffer_load_dwordx4 v22, s[32:35], s27 offen lds
  s_add_u32 m0, s28, 104448
  s_add_u32 s27, s27, 32768
  buffer_load_dwordx4 v23, s[32:35], s27 offen lds
  s_add_u32 m0, s28, 105472
  s_add_u32 s27, s27, 32768
  buffer_load_dwordx4 v23, s[32:35], s27 offen lds
  s_waitcnt vmcnt(48)
  v_lshl_or_b32 v28, v29, 16, v28
  v_lshl_or_b32 v29, v31, 16, v30
  v_min_u32 v28, -2, v28
  v_min_u32 v29, -2, v29
  buffer_store_dwordx2 v[28:29], v5, s[4:7], s62 offen sc1
  s_add_u32 s27, s26, 524288
  s_add_u32 m0, s28, 131072
  s_nop 0
  buffer_load_dwordx4 v22, s[32:35], s27 offen lds
  s_add_u32 m0, s28, 132096
  s_add_u32 s27, s27, 32768
  buffer_load_dwordx4 v22, s[32:35], s27 offen lds
  s_add_u32 m0, s28, 133120
  s_add_u32 s27, s27, 32768
  buffer_load_dwordx4 v23, s[32:35], s27 offen lds
  s_add_u32 m0, s28, 134144
  s_add_u32 s27, s27, 32768
  buffer_load_dwordx4 v23, s[32:35], s27 offen lds
  s_add_u32 s27, s26, 786432
  s_add_u32 m0, s28, 135168
  s_nop 0
  buffer_load_dwordx4 v22, s[32:35], s27 offen lds
  s_add_u32 m0, s28, 136192
  s_add_u32 s27, s27, 32768
  buffer_load_dwordx4 v22, s[32:35], s27 offen lds
  s_add_u32 m0, s28, 137216
  s_add_u32 s27, s27, 32768
  buffer_load_dwordx4 v23, s[32:35], s27 offen lds
  s_add_u32 m0, s28, 138240
  s_add_u32 s27, s27, 32768
  buffer_load_dwordx4 v23, s[32:35], s27 offen lds
  v_bfe_u32 v20, v7, 2, 1
  v_lshrrev_b32 v21, 3, v7
  v_and_b32 v104, 1, v17
  v_lshl_add_u32 v21, v21, 1, v104
  v_lshl_add_u32 v104, v20, 3, v21
  v_lshrrev_b32 v105, 1, v17
  v_lshl_add_u32 v104, v105, 4, v104
  v_lshl_add_u32 v20, v21, 1, v20
  s_lshl_b32 s29, s17, 1
  v_xor_b32 v20, s29, v20
  v_lshlrev_b32 v20, 5, v20
  v_lshl_add_u32 v20, v104, 8, v20
  v_and_b32 v21, 3, v7
  v_lshl_add_u32 v20, v21, 3, v20
  s_lshl_b32 s29, s17, 13
  s_add_u32 s29, s29, 65536
  v_add_u32 v20, s29, v20
  v_xor_b32 v104, 0, v20
  v_xor_b32 v105, 32, v20
  v_xor_b32 v106, 8192, v20
  v_xor_b32 v107, 8224, v20
  v_xor_b32 v108, 16384, v20
  v_xor_b32 v109, 16416, v20
  v_xor_b32 v110, 24576, v20
  v_xor_b32 v111, 24608, v20
  s_waitcnt vmcnt(49)
  v_perm_b32 v120, v132, v128, s44
  v_perm_b32 v121, v140, v136, s44
  v_perm_b32 v122, v148, v144, s44
  v_perm_b32 v123, v156, v152, s44
  v_accvgpr_write_b32 a248, v120
  v_accvgpr_write_b32 a249, v121
  v_accvgpr_write_b32 a250, v122
  v_accvgpr_write_b32 a251, v123
  v_perm_b32 v124, v132, v128, s45
  v_perm_b32 v125, v140, v136, s45
  v_perm_b32 v126, v148, v144, s45
  v_perm_b32 v127, v156, v152, s45
  v_accvgpr_write_b32 a232, v124
  v_accvgpr_write_b32 a233, v125
  v_accvgpr_write_b32 a234, v126
  v_accvgpr_write_b32 a235, v127
  v_perm_b32 v120, v133, v129, s44
  v_perm_b32 v121, v141, v137, s44
  v_perm_b32 v122, v149, v145, s44
  v_perm_b32 v123, v157, v153, s44
  v_accvgpr_write_b32 a216, v120
  v_accvgpr_write_b32 a217, v121
  v_accvgpr_write_b32 a218, v122
  v_accvgpr_write_b32 a219, v123
  v_perm_b32 v124, v133, v129, s45
  v_perm_b32 v125, v141, v137, s45
  v_perm_b32 v126, v149, v145, s45
  v_perm_b32 v127, v157, v153, s45
  v_accvgpr_write_b32 a200, v124
  v_accvgpr_write_b32 a201, v125
  v_accvgpr_write_b32 a202, v126
  v_accvgpr_write_b32 a203, v127
  v_perm_b32 v120, v134, v130, s44
  v_perm_b32 v121, v142, v138, s44
  v_perm_b32 v122, v150, v146, s44
  v_perm_b32 v123, v158, v154, s44
  v_accvgpr_write_b32 a184, v120
  v_accvgpr_write_b32 a185, v121
  v_accvgpr_write_b32 a186, v122
  v_accvgpr_write_b32 a187, v123
  v_perm_b32 v24, v134, v130, s45
  v_perm_b32 v25, v142, v138, s45
  v_perm_b32 v26, v150, v146, s45
  v_perm_b32 v27, v158, v154, s45
  v_perm_b32 v40, v135, v131, s44
  v_perm_b32 v41, v143, v139, s44
  v_perm_b32 v42, v151, v147, s44
  v_perm_b32 v43, v159, v155, s44
  v_perm_b32 v56, v135, v131, s45
  v_perm_b32 v57, v143, v139, s45
  v_perm_b32 v58, v151, v147, s45
  v_perm_b32 v59, v159, v155, s45
  s_waitcnt vmcnt(41)
  v_perm_b32 v120, v164, v160, s44
  v_perm_b32 v121, v172, v168, s44
  v_perm_b32 v122, v180, v176, s44
  v_perm_b32 v123, v188, v184, s44
  v_accvgpr_write_b32 a252, v120
  v_accvgpr_write_b32 a253, v121
  v_accvgpr_write_b32 a254, v122
  v_accvgpr_write_b32 a255, v123
  v_perm_b32 v124, v164, v160, s45
  v_perm_b32 v125, v172, v168, s45
  v_perm_b32 v126, v180, v176, s45
  v_perm_b32 v127, v188, v184, s45
  v_accvgpr_write_b32 a236, v124
  v_accvgpr_write_b32 a237, v125
  v_accvgpr_write_b32 a238, v126
  v_accvgpr_write_b32 a239, v127
  v_perm_b32 v120, v165, v161, s44
  v_perm_b32 v121, v173, v169, s44
  v_perm_b32 v122, v181, v177, s44
  v_perm_b32 v123, v189, v185, s44
  v_accvgpr_write_b32 a220, v120
  v_accvgpr_write_b32 a221, v121
  v_accvgpr_write_b32 a222, v122
  v_accvgpr_write_b32 a223, v123
  v_perm_b32 v124, v165, v161, s45
  v_perm_b32 v125, v173, v169, s45
  v_perm_b32 v126, v181, v177, s45
  v_perm_b32 v127, v189, v185, s45
  v_accvgpr_write_b32 a204, v124
  v_accvgpr_write_b32 a205, v125
  v_accvgpr_write_b32 a206, v126
  v_accvgpr_write_b32 a207, v127
  v_perm_b32 v120, v166, v162, s44
  v_perm_b32 v121, v174, v170, s44
  v_perm_b32 v122, v182, v178, s44
  v_perm_b32 v123, v190, v186, s44
  v_accvgpr_write_b32 a188, v120
  v_accvgpr_write_b32 a189, v121
  v_accvgpr_write_b32 a190, v122
  v_accvgpr_write_b32 a191, v123
  v_perm_b32 v28, v166, v162, s45
  v_perm_b32 v29, v174, v170, s45
  v_perm_b32 v30, v182, v178, s45
  v_perm_b32 v31, v190, v186, s45
  v_perm_b32 v44, v167, v163, s44
  v_perm_b32 v45, v175, v171, s44
  v_perm_b32 v46, v183, v179, s44
  v_perm_b32 v47, v191, v187, s44
  v_perm_b32 v60, v167, v163, s45
  v_perm_b32 v61, v175, v171, s45
  v_perm_b32 v62, v183, v179, s45
  v_perm_b32 v63, v191, v187, s45
  s_waitcnt vmcnt(33)
  v_perm_b32 v120, v196, v192, s44
  v_perm_b32 v121, v204, v200, s44
  v_perm_b32 v122, v212, v208, s44
  v_perm_b32 v123, v220, v216, s44
  v_accvgpr_write_b32 a240, v120
  v_accvgpr_write_b32 a241, v121
  v_accvgpr_write_b32 a242, v122
  v_accvgpr_write_b32 a243, v123
  v_perm_b32 v124, v196, v192, s45
  v_perm_b32 v125, v204, v200, s45
  v_perm_b32 v126, v212, v208, s45
  v_perm_b32 v127, v220, v216, s45
  v_accvgpr_write_b32 a224, v124
  v_accvgpr_write_b32 a225, v125
  v_accvgpr_write_b32 a226, v126
  v_accvgpr_write_b32 a227, v127
  v_perm_b32 v120, v197, v193, s44
  v_perm_b32 v121, v205, v201, s44
  v_perm_b32 v122, v213, v209, s44
  v_perm_b32 v123, v221, v217, s44
  v_accvgpr_write_b32 a208, v120
  v_accvgpr_write_b32 a209, v121
  v_accvgpr_write_b32 a210, v122
  v_accvgpr_write_b32 a211, v123
  v_perm_b32 v124, v197, v193, s45
  v_perm_b32 v125, v205, v201, s45
  v_perm_b32 v126, v213, v209, s45
  v_perm_b32 v127, v221, v217, s45
  v_accvgpr_write_b32 a192, v124
  v_accvgpr_write_b32 a193, v125
  v_accvgpr_write_b32 a194, v126
  v_accvgpr_write_b32 a195, v127
  v_perm_b32 v120, v198, v194, s44
  v_perm_b32 v121, v206, v202, s44
  v_perm_b32 v122, v214, v210, s44
  v_perm_b32 v123, v222, v218, s44
  v_accvgpr_write_b32 a176, v120
  v_accvgpr_write_b32 a177, v121
  v_accvgpr_write_b32 a178, v122
  v_accvgpr_write_b32 a179, v123
  v_perm_b32 v32, v198, v194, s45
  v_perm_b32 v33, v206, v202, s45
  v_perm_b32 v34, v214, v210, s45
  v_perm_b32 v35, v222, v218, s45
  v_perm_b32 v48, v199, v195, s44
  v_perm_b32 v49, v207, v203, s44
  v_perm_b32 v50, v215, v211, s44
  v_perm_b32 v51, v223, v219, s44
  v_perm_b32 v64, v199, v195, s45
  v_perm_b32 v65, v207, v203, s45
  v_perm_b32 v66, v215, v211, s45
  v_perm_b32 v67, v223, v219, s45
  s_waitcnt vmcnt(25)
  v_perm_b32 v120, v228, v224, s44
  v_perm_b32 v121, v236, v232, s44
  v_perm_b32 v122, v244, v240, s44
  v_perm_b32 v123, v252, v248, s44
  v_accvgpr_write_b32 a244, v120
  v_accvgpr_write_b32 a245, v121
  v_accvgpr_write_b32 a246, v122
  v_accvgpr_write_b32 a247, v123
  v_perm_b32 v124, v228, v224, s45
  v_perm_b32 v125, v236, v232, s45
  v_perm_b32 v126, v244, v240, s45
  v_perm_b32 v127, v252, v248, s45
  v_accvgpr_write_b32 a228, v124
  v_accvgpr_write_b32 a229, v125
  v_accvgpr_write_b32 a230, v126
  v_accvgpr_write_b32 a231, v127
  v_perm_b32 v120, v229, v225, s44
  v_perm_b32 v121, v237, v233, s44
  v_perm_b32 v122, v245, v241, s44
  v_perm_b32 v123, v253, v249, s44
  v_accvgpr_write_b32 a212, v120
  v_accvgpr_write_b32 a213, v121
  v_accvgpr_write_b32 a214, v122
  v_accvgpr_write_b32 a215, v123
  v_perm_b32 v124, v229, v225, s45
  v_perm_b32 v125, v237, v233, s45
  v_perm_b32 v126, v245, v241, s45
  v_perm_b32 v127, v253, v249, s45
  v_accvgpr_write_b32 a196, v124
  v_accvgpr_write_b32 a197, v125
  v_accvgpr_write_b32 a198, v126
  v_accvgpr_write_b32 a199, v127
  v_perm_b32 v120, v230, v226, s44
  v_perm_b32 v121, v238, v234, s44
  v_perm_b32 v122, v246, v242, s44
  v_perm_b32 v123, v254, v250, s44
  v_accvgpr_write_b32 a180, v120
  v_accvgpr_write_b32 a181, v121
  v_accvgpr_write_b32 a182, v122
  v_accvgpr_write_b32 a183, v123
  v_perm_b32 v36, v230, v226, s45
  v_perm_b32 v37, v238, v234, s45
  v_perm_b32 v38, v246, v242, s45
  v_perm_b32 v39, v254, v250, s45
  v_perm_b32 v52, v231, v227, s44
  v_perm_b32 v53, v239, v235, s44
  v_perm_b32 v54, v247, v243, s44
  v_perm_b32 v55, v255, v251, s44
  v_perm_b32 v68, v231, v227, s45
  v_perm_b32 v69, v239, v235, s45
  v_perm_b32 v70, v247, v243, s45
  v_perm_b32 v71, v255, v251, s45
  v_mov_b64 v[132:133], v[24:25]
  v_mov_b64 v[134:135], v[26:27]
  v_mov_b64 v[140:141], v[28:29]
  v_mov_b64 v[142:143], v[30:31]
  v_mov_b64 v[148:149], v[32:33]
  v_mov_b64 v[150:151], v[34:35]
  v_mov_b64 v[156:157], v[36:37]
  v_mov_b64 v[158:159], v[38:39]
  v_mov_b64 v[164:165], v[40:41]
  v_mov_b64 v[166:167], v[42:43]
  v_mov_b64 v[172:173], v[44:45]
  v_mov_b64 v[174:175], v[46:47]
  v_mov_b64 v[180:181], v[48:49]
  v_mov_b64 v[182:183], v[50:51]
  v_mov_b64 v[188:189], v[52:53]
  v_mov_b64 v[190:191], v[54:55]
  v_mov_b64 v[196:197], v[56:57]
  v_mov_b64 v[198:199], v[58:59]
  v_mov_b64 v[204:205], v[60:61]
  v_mov_b64 v[206:207], v[62:63]
  v_mov_b64 v[212:213], v[64:65]
  v_mov_b64 v[214:215], v[66:67]
  v_mov_b64 v[220:221], v[68:69]
  v_mov_b64 v[222:223], v[70:71]
  s_waitcnt vmcnt(17)
  s_barrier
  s_add_u32 s27, s26, 655360
  s_add_u32 m0, s28, 0
  s_nop 0
  buffer_load_dwordx4 v22, s[32:35], s27 offen lds
  s_add_u32 m0, s28, 1024
  s_add_u32 s27, s27, 32768
  buffer_load_dwordx4 v22, s[32:35], s27 offen lds
  s_add_u32 m0, s28, 2048
  s_add_u32 s27, s27, 32768
  buffer_load_dwordx4 v23, s[32:35], s27 offen lds
  s_add_u32 m0, s28, 3072
  s_add_u32 s27, s27, 32768
  buffer_load_dwordx4 v23, s[32:35], s27 offen lds
  s_add_u32 s27, s26, 917504
  s_add_u32 m0, s28, 4096
  s_nop 0
  buffer_load_dwordx4 v22, s[32:35], s27 offen lds
  s_add_u32 m0, s28, 5120
  s_add_u32 s27, s27, 32768
  buffer_load_dwordx4 v22, s[32:35], s27 offen lds
  s_add_u32 m0, s28, 6144
  s_add_u32 s27, s27, 32768
  buffer_load_dwordx4 v23, s[32:35], s27 offen lds
  s_add_u32 m0, s28, 7168
  s_add_u32 s27, s27, 32768
  buffer_load_dwordx4 v23, s[32:35], s27 offen lds
  s_cmp_lg_u32 s91, 0
  s_cbranch_scc1 g_o0_5
  s_cmp_lg_u32 s17, 0
  s_cbranch_scc1 g_ar_6
  s_lshl_b32 s36, s89, 3
  s_lshl_b64 s[36:37], 1, s36
  v_lshlrev_b32 v124, 3, 0
  v_mov_b32 v120, s36
  v_mov_b32 v121, s37
  s_mov_b64 exec, 1
  global_atomic_add_x2 v[122:123], v124, v[120:121], s[12:13] sc0
  s_mov_b64 exec, -1
g_ar_6:
g_o0_5:
  ds_read_b64_tr_b16 v[40:41], v104 offset:0
  ds_read_b64_tr_b16 v[72:73], v104 offset:1024
  ds_read_b64_tr_b16 v[48:49], v105 offset:0
  ds_read_b64_tr_b16 v[80:81], v105 offset:1024
  ds_read_b64_tr_b16 a[72:73], v106 offset:0
  ds_read_b64_tr_b16 a[48:49], v106 offset:1024
  ds_read_b64_tr_b16 a[24:25], v107 offset:0
  ds_read_b64_tr_b16 a[0:1], v107 offset:1024
  ds_read_b64_tr_b16 a[64:65], v108 offset:0
  ds_read_b64_tr_b16 a[40:41], v108 offset:1024
  ds_read_b64_tr_b16 a[16:17], v109 offset:0
  ds_read_b64_tr_b16 v[248:249], v109 offset:1024
  ds_read_b64_tr_b16 a[56:57], v110 offset:0
  ds_read_b64_tr_b16 a[32:33], v110 offset:1024
  ds_read_b64_tr_b16 a[8:9], v111 offset:0
  ds_read_b64_tr_b16 v[240:241], v111 offset:1024
  s_waitcnt lgkmcnt(0)
  s_waitcnt vmcnt(17)
  s_barrier
  s_add_u32 s27, s26, 0
  s_add_u32 m0, s28, 32768
  s_nop 0
  buffer_load_dwordx4 v22, s[52:55], s27 offen lds
  s_add_u32 m0, s28, 33792
  s_add_u32 s27, s27, 32768
  buffer_load_dwordx4 v22, s[52:55], s27 offen lds
  s_add_u32 m0, s28, 34816
  s_add_u32 s27, s27, 32768
  buffer_load_dwordx4 v23, s[52:55], s27 offen lds
  s_add_u32 m0, s28, 35840
  s_add_u32 s27, s27, 32768
  buffer_load_dwordx4 v23, s[52:55], s27 offen lds
  s_add_u32 s27, s26, 262144
  s_add_u32 m0, s28, 36864
  s_nop 0
  buffer_load_dwordx4 v22, s[52:55], s27 offen lds
  s_add_u32 m0, s28, 37888
  s_add_u32 s27, s27, 32768
  buffer_load_dwordx4 v22, s[52:55], s27 offen lds
  s_add_u32 m0, s28, 38912
  s_add_u32 s27, s27, 32768
  buffer_load_dwordx4 v23, s[52:55], s27 offen lds
  s_add_u32 m0, s28, 39936
  s_add_u32 s27, s27, 32768
  buffer_load_dwordx4 v23, s[52:55], s27 offen lds
  ds_read_b64_tr_b16 v[42:43], v104 offset:32768
  ds_read_b64_tr_b16 v[74:75], v104 offset:33792
  ds_read_b64_tr_b16 v[50:51], v105 offset:32768
  ds_read_b64_tr_b16 v[82:83], v105 offset:33792
  ds_read_b64_tr_b16 a[74:75], v106 offset:32768
  ds_read_b64_tr_b16 a[50:51], v106 offset:33792
  ds_read_b64_tr_b16 a[26:27], v107 offset:32768
  ds_read_b64_tr_b16 a[2:3], v107 offset:33792
  ds_read_b64_tr_b16 a[66:67], v108 offset:32768
  ds_read_b64_tr_b16 a[42:43], v108 offset:33792
  ds_read_b64_tr_b16 a[18:19], v109 offset:32768
  ds_read_b64_tr_b16 v[250:251], v109 offset:33792
  ds_read_b64_tr_b16 a[58:59], v110 offset:32768
  ds_read_b64_tr_b16 a[34:35], v110 offset:33792
  ds_read_b64_tr_b16 a[10:11], v111 offset:32768
  ds_read_b64_tr_b16 v[242:243], v111 offset:33792
  s_waitcnt lgkmcnt(0)
  v_add_u32 v104, 65536, v104
  v_add_u32 v105, 65536, v105
  v_add_u32 v106, 65536, v106
  v_add_u32 v107, 65536, v107
  v_add_u32 v108, 65536, v108
  v_add_u32 v109, 65536, v109
  v_add_u32 v110, 65536, v110
  v_add_u32 v111, 65536, v111
  s_waitcnt vmcnt(16)
  s_barrier
  s_add_u32 s27, s26, 131072
  s_add_u32 m0, s28, 65536
  s_nop 0
  buffer_load_dwordx4 v22, s[52:55], s27 offen lds
  s_add_u32 m0, s28, 66560
  s_add_u32 s27, s27, 32768
  buffer_load_dwordx4 v22, s[52:55], s27 offen lds
  s_add_u32 m0, s28, 67584
  s_add_u32 s27, s27, 32768
  buffer_load_dwordx4 v23, s[52:55], s27 offen lds
  s_add_u32 m0, s28, 68608
  s_add_u32 s27, s27, 32768
  buffer_load_dwordx4 v23, s[52:55], s27 offen lds
  s_add_u32 s27, s26, 393216
  s_add_u32 m0, s28, 69632
  s_nop 0
  buffer_load_dwordx4 v22, s[52:55], s27 offen lds
  s_add_u32 m0, s28, 70656
  s_add_u32 s27, s27, 32768
  buffer_load_dwordx4 v22, s[52:55], s27 offen lds
  s_add_u32 m0, s28, 71680
  s_add_u32 s27, s27, 32768
  buffer_load_dwordx4 v23, s[52:55], s27 offen lds
  s_add_u32 m0, s28, 72704
  s_add_u32 s27, s27, 32768
  buffer_load_dwordx4 v23, s[52:55], s27 offen lds
  ds_read_b64_tr_b16 v[44:45], v104 offset:0
  ds_read_b64_tr_b16 v[76:77], v104 offset:1024
  ds_read_b64_tr_b16 v[52:53], v105 offset:0
  ds_read_b64_tr_b16 v[84:85], v105 offset:1024
  ds_read_b64_tr_b16 a[76:77], v106 offset:0
  ds_read_b64_tr_b16 a[52:53], v106 offset:1024
  ds_read_b64_tr_b16 a[28:29], v107 offset:0
  ds_read_b64_tr_b16 a[4:5], v107 offset:1024
  ds_read_b64_tr_b16 a[68:69], v108 offset:0
  ds_read_b64_tr_b16 a[44:45], v108 offset:1024
  ds_read_b64_tr_b16 a[20:21], v109 offset:0
  ds_read_b64_tr_b16 v[252:253], v109 offset:1024
  ds_read_b64_tr_b16 a[60:61], v110 offset:0
  ds_read_b64_tr_b16 a[36:37], v110 offset:1024
  ds_read_b64_tr_b16 a[12:13], v111 offset:0
  ds_read_b64_tr_b16 v[244:245], v111 offset:1024
  s_waitcnt lgkmcnt(0)
  v_add_u32 v104, -131072, v104
  v_add_u32 v105, -131072, v105
  v_add_u32 v106, -131072, v106
  v_add_u32 v107, -131072, v107
  v_add_u32 v108, -131072, v108
  v_add_u32 v109, -131072, v109
  v_add_u32 v110, -131072, v110
  v_add_u32 v111, -131072, v111
  s_waitcnt vmcnt(16)
  s_barrier
  s_add_u32 s27, s26, 524288
  s_add_u32 m0, s28, 98304
  s_nop 0
  buffer_load_dwordx4 v22, s[52:55], s27 offen lds
  s_add_u32 m0, s28, 99328
  s_add_u32 s27, s27, 32768
  buffer_load_dwordx4 v22, s[52:55], s27 offen lds
  s_add_u32 m0, s28, 100352
  s_add_u32 s27, s27, 32768
  buffer_load_dwordx4 v23, s[52:55], s27 offen lds
  s_add_u32 m0, s28, 101376
  s_add_u32 s27, s27, 32768
  buffer_load_dwordx4 v23, s[52:55], s27 offen lds
  s_add_u32 s27, s26, 786432
  s_add_u32 m0, s28, 102400
  s_nop 0
  buffer_load_dwordx4 v22, s[52:55], s27 offen lds
  s_add_u32 m0, s28, 103424
  s_add_u32 s27, s27, 32768
  buffer_load_dwordx4 v22, s[52:55], s27 offen lds
  s_add_u32 m0, s28, 104448
  s_add_u32 s27, s27, 32768
  buffer_load_dwordx4 v23, s[52:55], s27 offen lds
  s_add_u32 m0, s28, 105472
  s_add_u32 s27, s27, 32768
  buffer_load_dwordx4 v23, s[52:55], s27 offen lds
  ds_read_b64_tr_b16 v[46:47], v104 offset:0
  ds_read_b64_tr_b16 v[78:79], v104 offset:1024
  ds_read_b64_tr_b16 v[54:55], v105 offset:0
  ds_read_b64_tr_b16 v[86:87], v105 offset:1024
  ds_read_b64_tr_b16 a[78:79], v106 offset:0
  ds_read_b64_tr_b16 a[54:55], v106 offset:1024
  ds_read_b64_tr_b16 a[30:31], v107 offset:0
  ds_read_b64_tr_b16 a[6:7], v107 offset:1024
  ds_read_b64_tr_b16 a[70:71], v108 offset:0
  ds_read_b64_tr_b16 a[46:47], v108 offset:1024
  ds_read_b64_tr_b16 a[22:23], v109 offset:0
  ds_read_b64_tr_b16 v[254:255], v109 offset:1024
  ds_read_b64_tr_b16 a[62:63], v110 offset:0
  ds_read_b64_tr_b16 a[38:39], v110 offset:1024
  ds_read_b64_tr_b16 a[14:15], v111 offset:0
  ds_read_b64_tr_b16 v[246:247], v111 offset:1024
  s_waitcnt lgkmcnt(0)
  s_waitcnt vmcnt(16)
  s_barrier
  s_add_u32 s27, s26, 655360
  s_add_u32 m0, s28, 131072
  s_nop 0
  buffer_load_dwordx4 v22, s[52:55], s27 offen lds
  s_add_u32 m0, s28, 132096
  s_add_u32 s27, s27, 32768
  buffer_load_dwordx4 v22, s[52:55], s27 offen lds
  s_add_u32 m0, s28, 133120
  s_add_u32 s27, s27, 32768
  buffer_load_dwordx4 v23, s[52:55], s27 offen lds
  s_add_u32 m0, s28, 134144
  s_add_u32 s27, s27, 32768
  buffer_load_dwordx4 v23, s[52:55], s27 offen lds
  s_add_u32 s27, s26, 917504
  s_add_u32 m0, s28, 135168
  s_nop 0
  buffer_load_dwordx4 v22, s[52:55], s27 offen lds
  s_add_u32 m0, s28, 136192
  s_add_u32 s27, s27, 32768
  buffer_load_dwordx4 v22, s[52:55], s27 offen lds
  s_add_u32 m0, s28, 137216
  s_add_u32 s27, s27, 32768
  buffer_load_dwordx4 v23, s[52:55], s27 offen lds
  s_add_u32 m0, s28, 138240
  s_add_u32 s27, s27, 32768
  buffer_load_dwordx4 v23, s[52:55], s27 offen lds
  s_cmp_lg_u32 s91, 0
  s_cbranch_scc1 g_o0_7
  s_cmp_lg_u32 s17, 0
  s_cbranch_scc1 g_af_8
  v_readfirstlane_b32 s36, v122
  v_readfirstlane_b32 s37, v123
  s_add_u32 s38, s36, s37
  s_mul_i32 s38, s38, 0x01010101
  s_lshr_b32 s38, s38, 24
  s_cmp_lg_u32 s38, 31
  s_cbranch_scc1 g_af_8
  s_lshl_b32 s38, s89, 3
  s_lshr_b64 s[36:37], s[36:37], s38
  s_and_b32 s36, s36, 0xff
  s_cmp_eq_u32 s36, 31
  s_cselect_b32 s36, 1, 2
  v_mov_b32 v120, s36
  v_lshrrev_b32 v124, 1, v124
  s_mov_b64 exec, 1
  global_store_dword v124, v120, s[12:13] offset:128 sc1
  s_mov_b64 exec, -1
g_af_8:
g_o0_7:
  ds_read_b64_tr_b16 v[24:25], v104 offset:32768
  ds_read_b64_tr_b16 v[56:57], v104 offset:33792
  ds_read_b64_tr_b16 v[32:33], v105 offset:32768
  ds_read_b64_tr_b16 v[64:65], v105 offset:33792
  ds_read_b64_tr_b16 a[168:169], v106 offset:32768
  ds_read_b64_tr_b16 a[144:145], v106 offset:33792
  ds_read_b64_tr_b16 a[120:121], v107 offset:32768
  ds_read_b64_tr_b16 a[96:97], v107 offset:33792
  ds_read_b64_tr_b16 a[160:161], v108 offset:32768
  ds_read_b64_tr_b16 a[136:137], v108 offset:33792
  ds_read_b64_tr_b16 a[112:113], v109 offset:32768
  ds_read_b64_tr_b16 a[88:89], v109 offset:33792
  ds_read_b64_tr_b16 a[152:153], v110 offset:32768
  ds_read_b64_tr_b16 a[128:129], v110 offset:33792
  ds_read_b64_tr_b16 a[104:105], v111 offset:32768
  ds_read_b64_tr_b16 a[80:81], v111 offset:33792
  s_waitcnt lgkmcnt(0)
  v_add_u32 v104, 65536, v104
  v_add_u32 v105, 65536, v105
  v_add_u32 v106, 65536, v106
  v_add_u32 v107, 65536, v107
  v_add_u32 v108, 65536, v108
  v_add_u32 v109, 65536, v109
  v_add_u32 v110, 65536, v110
  v_add_u32 v111, 65536, v111
  s_waitcnt vmcnt(16)
  s_barrier
  s_add_u32 s27, s26, 0
  s_add_u32 m0, s28, 0
  s_nop 0
  buffer_load_dwordx4 v22, s[48:51], s27 offen lds
  s_add_u32 m0, s28, 1024
  s_add_u32 s27, s27, 32768
  buffer_load_dwordx4 v22, s[48:51], s27 offen lds
  s_add_u32 m0, s28, 2048
  s_add_u32 s27, s27, 32768
  buffer_load_dwordx4 v23, s[48:51], s27 offen lds
  s_add_u32 m0, s28, 3072
  s_add_u32 s27, s27, 32768
  buffer_load_dwordx4 v23, s[48:51], s27 offen lds
  s_add_u32 s27, s26, 262144
  s_add_u32 m0, s28, 4096
  s_nop 0
  buffer_load_dwordx4 v22, s[48:51], s27 offen lds
  s_add_u32 m0, s28, 5120
  s_add_u32 s27, s27, 32768
  buffer_load_dwordx4 v22, s[48:51], s27 offen lds
  s_add_u32 m0, s28, 6144
  s_add_u32 s27, s27, 32768
  buffer_load_dwordx4 v23, s[48:51], s27 offen lds
  s_add_u32 m0, s28, 7168
  s_add_u32 s27, s27, 32768
  buffer_load_dwordx4 v23, s[48:51], s27 offen lds
  ds_read_b64_tr_b16 v[26:27], v104 offset:0
  ds_read_b64_tr_b16 v[58:59], v104 offset:1024
  ds_read_b64_tr_b16 v[34:35], v105 offset:0
  ds_read_b64_tr_b16 v[66:67], v105 offset:1024
  ds_read_b64_tr_b16 a[170:171], v106 offset:0
  ds_read_b64_tr_b16 a[146:147], v106 offset:1024
  ds_read_b64_tr_b16 a[122:123], v107 offset:0
  ds_read_b64_tr_b16 a[98:99], v107 offset:1024
  ds_read_b64_tr_b16 a[162:163], v108 offset:0
  ds_read_b64_tr_b16 a[138:139], v108 offset:1024
  ds_read_b64_tr_b16 a[114:115], v109 offset:0
  ds_read_b64_tr_b16 a[90:91], v109 offset:1024
  ds_read_b64_tr_b16 a[154:155], v110 offset:0
  ds_read_b64_tr_b16 a[130:131], v110 offset:1024
  ds_read_b64_tr_b16 a[106:107], v111 offset:0
  ds_read_b64_tr_b16 a[82:83], v111 offset:1024
  s_waitcnt lgkmcnt(0)
  s_waitcnt vmcnt(16)
  s_barrier
  s_add_u32 s27, s26, 131072
  s_add_u32 m0, s28, 32768
  s_nop 0
  buffer_load_dwordx4 v22, s[48:51], s27 offen lds
  s_add_u32 m0, s28, 33792
  s_add_u32 s27, s27, 32768
  buffer_load_dwordx4 v22, s[48:51], s27 offen lds
  s_add_u32 m0, s28, 34816
  s_add_u32 s27, s27, 32768
  buffer_load_dwordx4 v23, s[48:51], s27 offen lds
  s_add_u32 m0, s28, 35840
  s_add_u32 s27, s27, 32768
  buffer_load_dwordx4 v23, s[48:51], s27 offen lds
  s_add_u32 s27, s26, 393216
  s_add_u32 m0, s28, 36864
  s_nop 0
  buffer_load_dwordx4 v22, s[48:51], s27 offen lds
  s_add_u32 m0, s28, 37888
  s_add_u32 s27, s27, 32768
  buffer_load_dwordx4 v22, s[48:51], s27 offen lds
  s_add_u32 m0, s28, 38912
  s_add_u32 s27, s27, 32768
  buffer_load_dwordx4 v23, s[48:51], s27 offen lds
  s_add_u32 m0, s28, 39936
  s_add_u32 s27, s27, 32768
  buffer_load_dwordx4 v23, s[48:51], s27 offen lds
  v_mbcnt_lo_u32_b32 v116, -1, 0
  v_and_b32 v116, 1, v116
  v_lshlrev_b32 v118, 2, v116
  global_load_dword v117, v118, s[12:13] offset:128 sc1
  ds_read_b64_tr_b16 v[28:29], v104 offset:32768
  ds_read_b64_tr_b16 v[60:61], v104 offset:33792
  ds_read_b64_tr_b16 v[36:37], v105 offset:32768
  ds_read_b64_tr_b16 v[68:69], v105 offset:33792
  ds_read_b64_tr_b16 a[172:173], v106 offset:32768
  ds_read_b64_tr_b16 a[148:149], v106 offset:33792
  ds_read_b64_tr_b16 a[124:125], v107 offset:32768
  ds_read_b64_tr_b16 a[100:101], v107 offset:33792
  ds_read_b64_tr_b16 a[164:165], v108 offset:32768
  ds_read_b64_tr_b16 a[140:141], v108 offset:33792
  ds_read_b64_tr_b16 a[116:117], v109 offset:32768
  ds_read_b64_tr_b16 a[92:93], v109 offset:33792
  ds_read_b64_tr_b16 a[156:157], v110 offset:32768
  ds_read_b64_tr_b16 a[132:133], v110 offset:33792
  ds_read_b64_tr_b16 a[108:109], v111 offset:32768
  ds_read_b64_tr_b16 a[84:85], v111 offset:33792
  s_waitcnt lgkmcnt(0)
  v_add_u32 v104, 65536, v104
  v_add_u32 v105, 65536, v105
  v_add_u32 v106, 65536, v106
  v_add_u32 v107, 65536, v107
  v_add_u32 v108, 65536, v108
  v_add_u32 v109, 65536, v109
  v_add_u32 v110, 65536, v110
  v_add_u32 v111, 65536, v111
  s_waitcnt vmcnt(16)
  s_barrier
  s_add_u32 s27, s26, 524288
  s_add_u32 m0, s28, 65536
  s_nop 0
  buffer_load_dwordx4 v22, s[48:51], s27 offen lds
  s_add_u32 m0, s28, 66560
  s_add_u32 s27, s27, 32768
  buffer_load_dwordx4 v22, s[48:51], s27 offen lds
  s_add_u32 m0, s28, 67584
  s_add_u32 s27, s27, 32768
  buffer_load_dwordx4 v23, s[48:51], s27 offen lds
  s_add_u32 m0, s28, 68608
  s_add_u32 s27, s27, 32768
  buffer_load_dwordx4 v23, s[48:51], s27 offen lds
  s_add_u32 s27, s26, 786432
  s_add_u32 m0, s28, 69632
  s_nop 0
  buffer_load_dwordx4 v22, s[48:51], s27 offen lds
  s_add_u32 m0, s28, 70656
  s_add_u32 s27, s27, 32768
  buffer_load_dwordx4 v22, s[48:51], s27 offen lds
  s_add_u32 m0, s28, 71680
  s_add_u32 s27, s27, 32768
  buffer_load_dwordx4 v23, s[48:51], s27 offen lds
  s_add_u32 m0, s28, 72704
  s_add_u32 s27, s27, 32768
  buffer_load_dwordx4 v23, s[48:51], s27 offen lds
  ds_read_b64_tr_b16 v[30:31], v104 offset:0
  ds_read_b64_tr_b16 v[62:63], v104 offset:1024
  ds_read_b64_tr_b16 v[38:39], v105 offset:0
  ds_read_b64_tr_b16 v[70:71], v105 offset:1024
  ds_read_b64_tr_b16 a[174:175], v106 offset:0
  ds_read_b64_tr_b16 a[150:151], v106 offset:1024
  ds_read_b64_tr_b16 a[126:127], v107 offset:0
  ds_read_b64_tr_b16 a[102:103], v107 offset:1024
  ds_read_b64_tr_b16 a[166:167], v108 offset:0
  ds_read_b64_tr_b16 a[142:143], v108 offset:1024
  ds_read_b64_tr_b16 a[118:119], v109 offset:0
  ds_read_b64_tr_b16 a[94:95], v109 offset:1024
  ds_read_b64_tr_b16 a[158:159], v110 offset:0
  ds_read_b64_tr_b16 a[134:135], v110 offset:1024
  ds_read_b64_tr_b16 a[110:111], v111 offset:0
  ds_read_b64_tr_b16 a[86:87], v111 offset:1024
  s_waitcnt lgkmcnt(0)
  v_add_u32 v104, -131072, v104
  v_add_u32 v105, -131072, v105
  v_add_u32 v106, -131072, v106
  v_add_u32 v107, -131072, v107
  v_add_u32 v108, -131072, v108
  v_add_u32 v109, -131072, v109
  v_add_u32 v110, -131072, v110
  v_add_u32 v111, -131072, v111
  s_waitcnt vmcnt(16)
  s_barrier
  s_add_u32 s27, s26, 655360
  s_add_u32 m0, s28, 98304
  s_nop 0
  buffer_load_dwordx4 v22, s[48:51], s27 offen lds
  s_add_u32 m0, s28, 99328
  s_add_u32 s27, s27, 32768
  buffer_load_dwordx4 v22, s[48:51], s27 offen lds
  s_add_u32 m0, s28, 100352
  s_add_u32 s27, s27, 32768
  buffer_load_dwordx4 v23, s[48:51], s27 offen lds
  s_add_u32 m0, s28, 101376
  s_add_u32 s27, s27, 32768
  buffer_load_dwordx4 v23, s[48:51], s27 offen lds
  s_add_u32 s27, s26, 917504
  s_add_u32 m0, s28, 102400
  s_nop 0
  buffer_load_dwordx4 v22, s[48:51], s27 offen lds
  s_add_u32 m0, s28, 103424
  s_add_u32 s27, s27, 32768
  buffer_load_dwordx4 v22, s[48:51], s27 offen lds
  s_add_u32 m0, s28, 104448
  s_add_u32 s27, s27, 32768
  buffer_load_dwordx4 v23, s[48:51], s27 offen lds
  s_add_u32 m0, s28, 105472
  s_add_u32 s27, s27, 32768
  buffer_load_dwordx4 v23, s[48:51], s27 offen lds
  s_or_b32 s36, s91, s17
  s_cbranch_scc1 L_sig
  s_lshl_b32 s36, s16, 6
  s_add_u32 s36, s36, 245104644
  v_mov_b32 v120, 1
  s_mov_b64 exec, 1
  buffer_store_dword v120, off, s[4:7], s36 sc1
  s_mov_b64 exec, -1
L_sig:
  ds_read_b64_tr_b16 v[88:89], v104 offset:0
  ds_read_b64_tr_b16 v[208:209], v104 offset:1024
  ds_read_b64_tr_b16 v[96:97], v105 offset:0
  ds_read_b64_tr_b16 v[152:153], v105 offset:1024
  ds_read_b64_tr_b16 v[232:233], v106 offset:0
  ds_read_b64_tr_b16 v[200:201], v106 offset:1024
  ds_read_b64_tr_b16 v[176:177], v107 offset:0
  ds_read_b64_tr_b16 v[144:145], v107 offset:1024
  ds_read_b64_tr_b16 v[224:225], v108 offset:0
  ds_read_b64_tr_b16 v[192:193], v108 offset:1024
  ds_read_b64_tr_b16 v[168:169], v109 offset:0
  ds_read_b64_tr_b16 v[136:137], v109 offset:1024
  ds_read_b64_tr_b16 v[216:217], v110 offset:0
  ds_read_b64_tr_b16 v[184:185], v110 offset:1024
  ds_read_b64_tr_b16 v[160:161], v111 offset:0
  ds_read_b64_tr_b16 v[128:129], v111 offset:1024
  s_waitcnt lgkmcnt(0)
  s_waitcnt vmcnt(16)
  s_barrier
  ds_read_b64_tr_b16 v[90:91], v104 offset:32768
  ds_read_b64_tr_b16 v[210:211], v104 offset:33792
  ds_read_b64_tr_b16 v[98:99], v105 offset:32768
  ds_read_b64_tr_b16 v[154:155], v105 offset:33792
  ds_read_b64_tr_b16 v[234:235], v106 offset:32768
  ds_read_b64_tr_b16 v[202:203], v106 offset:33792
  ds_read_b64_tr_b16 v[178:179], v107 offset:32768
  ds_read_b64_tr_b16 v[146:147], v107 offset:33792
  ds_read_b64_tr_b16 v[226:227], v108 offset:32768
  ds_read_b64_tr_b16 v[194:195], v108 offset:33792
  ds_read_b64_tr_b16 v[170:171], v109 offset:32768
  ds_read_b64_tr_b16 v[138:139], v109 offset:33792
  ds_read_b64_tr_b16 v[218:219], v110 offset:32768
  ds_read_b64_tr_b16 v[186:187], v110 offset:33792
  ds_read_b64_tr_b16 v[162:163], v111 offset:32768
  ds_read_b64_tr_b16 v[130:131], v111 offset:33792
  s_waitcnt lgkmcnt(0)
  s_barrier
  v_add_u32 v104, 65536, v104
  v_add_u32 v105, 65536, v105
  v_add_u32 v106, 65536, v106
  v_add_u32 v107, 65536, v107
  v_add_u32 v108, 65536, v108
  v_add_u32 v109, 65536, v109
  v_add_u32 v110, 65536, v110
  v_add_u32 v111, 65536, v111
  ds_write_b128 v8, v[132:135] offset:16384
  ds_write_b128 v8, v[140:143] offset:20480
  ds_write_b128 v8, v[148:151] offset:24576
  ds_write_b128 v8, v[156:159] offset:28672
  ds_write_b128 v8, v[164:167] offset:32768
  ds_write_b128 v8, v[172:175] offset:36864
  ds_write_b128 v8, v[180:183] offset:40960
  ds_write_b128 v8, v[188:191] offset:45056
  ds_write_b128 v8, v[196:199] offset:49152
  ds_write_b128 v8, v[204:207] offset:53248
  ds_write_b128 v8, v[212:215] offset:57344
  ds_write_b128 v8, v[220:223] offset:61440
  s_waitcnt lgkmcnt(0)
  s_waitcnt vmcnt(8)
  s_barrier
  v_cmp_eq_u32 vcc, 0, v117
  v_lshlrev_b32 v116, 12, v116
  s_or_b32 s66, vcc_lo, s91
  s_cselect_b32 s66, 0, 1
  s_lshl2_add_u32 s36, s16, s17
  s_lshl_b32 s36, s36, 5
  s_add_u32 s36, s36, 244318208
  buffer_load_dword v118, v116, s[4:7], s36 offen sc1
  ds_read_b64_tr_b16 v[92:93], v104 offset:0
  ds_read_b64_tr_b16 v[212:213], v104 offset:1024
  ds_read_b64_tr_b16 v[100:101], v105 offset:0
  ds_read_b64_tr_b16 v[156:157], v105 offset:1024
  ds_read_b64_tr_b16 v[236:237], v106 offset:0
  ds_read_b64_tr_b16 v[204:205], v106 offset:1024
  ds_read_b64_tr_b16 v[180:181], v107 offset:0
  ds_read_b64_tr_b16 v[148:149], v107 offset:1024
  ds_read_b64_tr_b16 v[228:229], v108 offset:0
  ds_read_b64_tr_b16 v[196:197], v108 offset:1024
  ds_read_b64_tr_b16 v[172:173], v109 offset:0
  ds_read_b64_tr_b16 v[140:141], v109 offset:1024
  ds_read_b64_tr_b16 v[220:221], v110 offset:0
  ds_read_b64_tr_b16 v[188:189], v110 offset:1024
  ds_read_b64_tr_b16 v[164:165], v111 offset:0
  ds_read_b64_tr_b16 v[132:133], v111 offset:1024
  s_waitcnt lgkmcnt(0)
  s_waitcnt vmcnt(0)
  s_barrier
  ds_read_b64_tr_b16 v[94:95], v104 offset:32768
  ds_read_b64_tr_b16 v[214:215], v104 offset:33792
  ds_read_b64_tr_b16 v[102:103], v105 offset:32768
  ds_read_b64_tr_b16 v[158:159], v105 offset:33792
  ds_read_b64_tr_b16 v[238:239], v106 offset:32768
  ds_read_b64_tr_b16 v[206:207], v106 offset:33792
  ds_read_b64_tr_b16 v[182:183], v107 offset:32768
  ds_read_b64_tr_b16 v[150:151], v107 offset:33792
  ds_read_b64_tr_b16 v[230:231], v108 offset:32768
  ds_read_b64_tr_b16 v[198:199], v108 offset:33792
  ds_read_b64_tr_b16 v[174:175], v109 offset:32768
  ds_read_b64_tr_b16 v[142:143], v109 offset:33792
  ds_read_b64_tr_b16 v[222:223], v110 offset:32768
  ds_read_b64_tr_b16 v[190:191], v110 offset:33792
  ds_read_b64_tr_b16 v[166:167], v111 offset:32768
  ds_read_b64_tr_b16 v[134:135], v111 offset:33792
  s_waitcnt lgkmcnt(0)
  s_barrier
  s_waitcnt vmcnt(0)
  s_lshl_b32 s26, s16, 13
  s_add_u32 s26, s26, s40
  s_add_u32 s27, s26, 4096
  s_lshl_b32 s28, s17, 13
  s_add_u32 s28, s28, s62
  buffer_load_dwordx4 v[104:107], v8, s[4:7], s26 offen sc1
  buffer_load_dwordx4 v[104:107], v8, s[4:7], s27 offen sc1
  buffer_load_dwordx2 v[104:105], v5, s[4:7], s28 offen sc1
  ds_write_b128 v1, v[24:27] offset:0
  ds_write_b128 v1, v[28:31] offset:1024
  ds_write_b128 v1, v[32:35] offset:2048
  ds_write_b128 v1, v[36:39] offset:3072
  ds_write_b128 v1, v[40:43] offset:4096
  ds_write_b128 v1, v[44:47] offset:5120
  ds_write_b128 v1, v[48:51] offset:6144
  ds_write_b128 v1, v[52:55] offset:7168
  ds_write_b128 v1, v[56:59] offset:8192
  ds_write_b128 v1, v[60:63] offset:9216
  ds_write_b128 v1, v[64:67] offset:10240
  ds_write_b128 v1, v[68:71] offset:11264
  ds_write_b128 v1, v[72:75] offset:12288
  ds_write_b128 v1, v[76:79] offset:13312
  ds_write_b128 v1, v[80:83] offset:14336
  ds_write_b128 v1, v[84:87] offset:15360
  ds_write_b128 v1, v[88:91] offset:16384
  ds_write_b128 v1, v[92:95] offset:17408
  ds_write_b128 v1, v[96:99] offset:18432
  ds_write_b128 v1, v[100:103] offset:19456
  s_mul_i32 s27, s17, 24576
  s_add_u32 m0, s27, 86016
  s_waitcnt lgkmcnt(0)
  v_readlane_b32 s67, v118, 1
  v_readlane_b32 s26, v118, 0
  v_mov_b32 v21, v117
  s_and_b32 s66, s66, s26
  s_cbranch_scc1 L_pk
  v_mbcnt_lo_u32_b32 v20, -1, 0
  v_and_b32 v20, 1, v20
  v_add_lshl_u32 v20, v20, s61, 2
  s_mov_b32 s26, 0
g_wt_9:
  global_load_dword v21, v20, s[12:13] offset:128 sc1
  s_add_u32 s26, s26, 1
  s_cmp_gt_u32 s26, 1048576
  s_cbranch_scc1 L_end
  s_waitcnt vmcnt(0)
  v_cmp_eq_u32 vcc, 0, v21
  v_readfirstlane_b32 s27, v21
  s_cbranch_vccnz g_wt_9
L_pk:
  s_lshr_b32 s26, s91, 1
  s_nop 3
  v_readlane_b32 s27, v21, s26
  s_cmp_lg_u32 s27, 1
  s_cbranch_scc1 L_chain_x
  s_mov_b32 s22, 0
  s_mov_b32 s21, 0
  s_mov_b32 s42, s62
  s_add_u32 s43, s62, 4096
  s_mov_b32 s46, 0
  s_mov_b32 s47, 0
  s_lshl_b32 s26, s16, 2
  s_add_u32 s26, s26, s17
  s_lshl_b32 s27, s60, 13
  s_add_u32 s27, s27, s26
  s_lshr_b32 s25, s27, 2
  s_lshl_b32 s25, s25, 13
  s_add_u32 s25, s25, 192937984
  s_lshr_b32 s64, s27, 2
  s_lshl_b32 s64, s64, 6
  s_add_u32 s64, s64, 513538048
  s_cmp_eq_u32 s17, 3
  s_cselect_b32 s2, 268435456, 0
  s_lshl_b32 s27, s61, 13
  s_add_u32 s27, s27, s26
  s_lshl_b32 s23, s27, 12
  s_add_u32 s23, s23, 41943040
  s_lshl_b32 s63, s27, 5
  s_add_u32 s63, s63, 244318208
  s_mov_b32 s97, 268435456
  s_cmp_eq_u32 s60, 2
  s_cselect_b32 s20, 262144, s97
  s_cselect_b32 s93, 1, 3
  s_lshl_b32 s26, s17, 2
  s_add_u32 s26, s26, s60
  s_cmp_eq_u32 s26, 1
  s_cselect_b32 s97, 245891072, s97
  s_mov_b32 s95, 0
  s_mov_b32 s96, s23
  s_add_u32 s23, s23, 524288
  s_add_u32 s63, s63, 4096
  s_cmp_eq_u32 s66, 0
  s_cbranch_scc1 c_pk_18
  s_sub_u32 s96, s23, 524288
  s_mov_b32 s65, s67
  s_mov_b32 s94, 0
  buffer_load_dwordx4 v0, s[4:7], s96 offen offset:0  lds
  buffer_load_dwordx4 v0, s[4:7], s96 offen offset:1024  lds
  buffer_load_dwordx4 v0, s[4:7], s96 offen offset:2048  lds
  buffer_load_dwordx4 v0, s[4:7], s96 offen offset:3072  lds
  s_branch c_pk2_19
c_pk_18:
  s_mov_b32 s29, 0
  s_sub_u32 s92, s63, 4096
  s_sub_u32 s96, s23, 524288
  s_mov_b32 s95, 0
c_gw_20:
  buffer_load_dword v7, off, s[4:7], s92 sc1
  s_add_u32 s29, s29, 1
  s_cmp_gt_u32 s29, 1048576
  s_cbranch_scc1 c_fail_16
  s_waitcnt vmcnt(0) lgkmcnt(0)
  v_readfirstlane_b32 s65, v7
  s_cmp_eq_u32 s65, 0
  s_cbranch_scc1 c_gw_20
  s_and_b32 s65, s65, s93
  s_cbranch_scc1 c_kvx_22
  s_mov_b32 s95, 1
  s_add_u32 s96, s96, 33554432
  s_add_u32 s92, s92, 262144
c_kvw_21:
  buffer_load_dword v7, off, s[4:7], s92 sc1
  s_add_u32 s29, s29, 1
  s_cmp_gt_u32 s29, 1048576
  s_cbranch_scc1 c_fail_16
  s_waitcnt vmcnt(0) lgkmcnt(0)
  v_readfirstlane_b32 s65, v7
  s_cmp_eq_u32 s65, 0
  s_cbranch_scc1 c_kvw_21
c_kvx_22:
  buffer_load_dword v7, off, s[4:7], s63 sc1
  buffer_load_dwordx4 v0, s[4:7], s96 offen offset:0  lds
  buffer_load_dwordx4 v0, s[4:7], s96 offen offset:1024  lds
  buffer_load_dwordx4 v0, s[4:7], s96 offen offset:2048  lds
  buffer_load_dwordx4 v0, s[4:7], s96 offen offset:3072  lds
  s_waitcnt vmcnt(4)
  v_readfirstlane_b32 s65, v7
  s_mov_b32 s94, 0
c_pk2_19:
  s_waitcnt vmcnt(4)
  ds_read_b128 v[72:75], v1 offset:6144
  ds_read_b128 v[76:79], v1 offset:7168
  ds_read_b128 v[80:83], v1 offset:8192
  ds_read_b128 v[84:87], v1 offset:9216
  ds_read_b128 v[88:91], v1 offset:10240
  ds_read_b128 v[92:95], v1 offset:11264
  ds_read_b128 v[96:99], v1 offset:12288
  ds_read_b128 v[100:103], v1 offset:13312
  ds_read_b128 v[104:107], v1 offset:14336
  ds_read_b128 v[108:111], v1 offset:15360
  ds_read_b128 v[112:115], v1 offset:16384
  ds_read_b128 v[116:119], v1 offset:17408
  ds_read_b128 v[120:123], v1 offset:18432
  ds_read_b128 v[124:127], v1 offset:19456
  v_mov_b64 v[48:49], 0
  v_mov_b64 v[50:51], 0
  v_mov_b64 v[52:53], 0
  v_mov_b64 v[54:55], 0
  v_mov_b64 v[56:57], 0
  v_mov_b64 v[58:59], 0
  v_mov_b64 v[60:61], 0
  v_mov_b64 v[62:63], 0
  v_mov_b64 v[64:65], 0
  v_mov_b64 v[66:67], 0
  v_mov_b64 v[68:69], 0
  v_mov_b64 v[70:71], 0
  s_lshl_b32 s38, s16, 13
  s_add_u32 s38, s38, s40
  s_add_u32 s39, s38, 4096
  ds_read_b128 v[24:27], v1 offset:0
  ds_read_b128 v[28:31], v1 offset:1024
  ds_read_b128 v[32:35], v1 offset:2048
  ds_read_b128 v[36:39], v1 offset:3072
  ds_read_b128 v[40:43], v1 offset:4096
  ds_read_b128 v[44:47], v1 offset:5120
  s_waitcnt lgkmcnt(0)
c_loop_10:
  buffer_load_dwordx4 v[16:19], v8, s[4:7], s42 offen sc1
  buffer_load_dwordx4 v[20:23], v8, s[4:7], s43 offen sc1
  s_mov_b32 s28, 0
  v_mov_b64 v[48:49], 0
  v_mov_b64 v[50:51], 0
  v_mov_b64 v[52:53], 0
  v_mov_b64 v[54:55], 0
  v_mov_b64 v[56:57], 0
  v_mov_b64 v[58:59], 0
  v_mov_b64 v[60:61], 0
  v_mov_b64 v[62:63], 0
  v_mov_b64 v[64:65], 0
  v_mov_b64 v[66:67], 0
  v_mov_b64 v[68:69], 0
  v_mov_b64 v[70:71], 0
  buffer_load_dwordx4 v[16:19], v8, s[4:7], s42 offen sc1
  buffer_load_dwordx4 v[20:23], v8, s[4:7], s43 offen sc1
  s_waitcnt lgkmcnt(0)
  s_and_b32 s29, s65, s93
  s_cbranch_scc0 c_xb_25
c_xr_26:
  s_waitcnt vmcnt(3)
  v_max3_u32 v7, v16, v17, v18
  v_max_u32 v7, v7, v19
  ds_write_b128 v8, v[16:19] offset:4096
  v_smfmac_f32_16x16x64_bf16 v[48:51], v[16:19], v[24:31], v6
  s_waitcnt vmcnt(2)
  v_max3_u32 v7, v20, v21, v7
  v_max3_u32 v7, v22, v23, v7
  ds_write_b128 v8, v[20:23] offset:8192
  v_smfmac_f32_16x16x64_bf16 v[52:55], v[16:19], v[32:39], v6
  v_cmp_eq_u32 vcc, -1, v7
  v_smfmac_f32_16x16x64_bf16 v[56:59], v[16:19], v[40:47], v6
  s_cbranch_vccnz c_retry_11
c_got_12:
  v_smfmac_f32_16x16x64_bf16 v[60:63], v[16:19], v[72:79], v6
  ds_read_b128 v[72:75], v1 offset:20480
  s_and_b32 s65, s65, s93
  s_cselect_b32 s96, s23, 268435456
  v_smfmac_f32_16x16x64_bf16 v[48:51], v[20:23], v[80:87], v6
  ds_read_b128 v[76:79], v1 offset:21504
  v_mov_b32 v7, 1
  v_smfmac_f32_16x16x64_bf16 v[52:55], v[20:23], v[88:95], v6
  ds_read_b128 v[80:83], v1 offset:22528
  v_smfmac_f32_16x16x64_bf16 v[56:59], v[20:23], v[96:103], v6
  ds_read_b128 v[84:87], v1 offset:23552
  s_waitcnt lgkmcnt(4)
  s_barrier
  ds_read_b128 v[24:27], v9 offset:4096
  ds_read_b128 v[28:31], v10 offset:4096
  v_smfmac_f32_16x16x64_bf16 v[60:63], v[20:23], v[104:111], v6
  ds_read_b128 v[32:35], v11 offset:4096
  v_smfmac_f32_16x16x64_bf16 v[64:67], v[16:19], v[112:119], v6
  ds_read_b128 v[36:39], v9 offset:8192
  v_smfmac_f32_16x16x64_bf16 v[68:71], v[16:19], v[120:127], v6
  ds_read_b128 v[40:43], v10 offset:8192
  v_smfmac_f32_16x16x64_bf16 v[64:67], v[20:23], v[208:215], v6
  ds_read_b128 v[44:47], v11 offset:8192
  s_waitcnt lgkmcnt(5)
  v_smfmac_f32_16x16x64_bf16 v[48:51], v[24:27], a[168:175], v6
  buffer_load_dwordx4 v0, s[4:7], s96 offen offset:0  lds
  s_waitcnt lgkmcnt(4)
  v_smfmac_f32_16x16x64_bf16 v[48:51], v[28:31], a[160:167], v6
  ds_read_b128 v[104:107], v8 offset:16384
  s_waitcnt lgkmcnt(4)
  v_smfmac_f32_16x16x64_bf16 v[48:51], v[32:35], a[152:159], v6
  buffer_load_dwordx4 v0, s[4:7], s96 offen offset:1024  lds
  s_waitcnt lgkmcnt(3)
  v_smfmac_f32_16x16x64_bf16 v[48:51], v[36:39], a[144:151], v6
  ds_read_b128 v[108:111], v8 offset:20480
  s_waitcnt lgkmcnt(3)
  v_smfmac_f32_16x16x64_bf16 v[48:51], v[40:43], a[136:143], v6
  buffer_load_dwordx4 v0, s[4:7], s96 offen offset:2048  lds
  s_waitcnt lgkmcnt(2)
  v_smfmac_f32_16x16x64_bf16 v[48:51], v[44:47], a[128:135], v6
  v_smfmac_f32_16x16x64_bf16 v[52:55], v[24:27], a[120:127], v6
  buffer_load_dwordx4 v0, s[4:7], s96 offen offset:3072  lds
  v_smfmac_f32_16x16x64_bf16 v[52:55], v[28:31], a[112:119], v6
  ds_read_b64 v[100:101], v5 offset:4096
  v_add_f32 v48, v48, v50
  v_smfmac_f32_16x16x64_bf16 v[52:55], v[32:35], a[104:111], v6
  ds_read_b128 v[112:115], v8 offset:24576
  v_add_f32 v49, v49, v51
  v_smfmac_f32_16x16x64_bf16 v[52:55], v[36:39], a[96:103], v6
  ds_read_b128 v[116:119], v8 offset:28672
  v_cvt_pk_bf16_f32 v50, v48, v49
  v_smfmac_f32_16x16x64_bf16 v[52:55], v[40:43], a[88:95], v6
  ds_write2_b32 v2, v50, v50 offset0:0 offset1:1
  v_smfmac_f32_16x16x64_bf16 v[52:55], v[44:47], a[80:87], v6
  ds_read_b64_tr_b16 v[88:89], v12 offset:0
  v_smfmac_f32_16x16x64_bf16 v[56:59], v[24:27], a[72:79], v6
  s_mov_b64 exec, 1
  buffer_store_dword v7, off, s[4:7], s64 sc1
  s_mov_b64 exec, -1
  v_smfmac_f32_16x16x64_bf16 v[56:59], v[28:31], a[64:71], v6
  ds_read_b128 v[120:123], v8 offset:32768
  v_add_f32 v52, v52, v54
  v_smfmac_f32_16x16x64_bf16 v[56:59], v[32:35], a[56:63], v6
  ds_read_b128 v[124:127], v8 offset:36864
  v_add_f32 v53, v53, v55
  v_cvt_pk_bf16_f32 v54, v52, v53
  v_smfmac_f32_16x16x64_bf16 v[56:59], v[36:39], a[48:55], v6
  ds_write2_b32 v2, v54, v54 offset0:128 offset1:129
  ds_read_b64_tr_b16 v[90:91], v12 offset:512
  v_smfmac_f32_16x16x64_bf16 v[56:59], v[40:43], a[40:47], v6
  v_smfmac_f32_16x16x64_bf16 v[56:59], v[44:47], a[32:39], v6
  s_waitcnt lgkmcnt(8)
  buffer_store_dwordx2 v[100:101], v5, s[4:7], s97 offen sc1
  v_smfmac_f32_16x16x64_bf16 v[60:63], v[24:27], a[24:31], v6
  v_smfmac_f32_16x16x64_bf16 v[60:63], v[28:31], a[16:23], v6
  s_waitcnt lgkmcnt(0)
  v_add_f32 v56, v56, v58
  v_mfma_f32_16x16x32_bf16 v[92:95], v[72:75], v[88:91], 0
  v_add_f32 v57, v57, v59
  v_cvt_pk_bf16_f32 v58, v56, v57
  v_mfma_f32_16x16x32_bf16 v[96:99], v[76:79], v[88:91], 0
  ds_write_b32 v2, v58
  v_smfmac_f32_16x16x64_bf16 v[60:63], v[32:35], a[8:15], v6
  v_mov_b32 v76, 0
  v_smfmac_f32_16x16x64_bf16 v[60:63], v[36:39], a[0:7], v6
  v_cndmask_b32 v48, v92, v96, s[18:19]
  v_smfmac_f32_16x16x64_bf16 v[60:63], v[40:43], v[248:255], v6
  v_cndmask_b32 v49, v93, v97, s[18:19]
  v_smfmac_f32_16x16x64_bf16 v[60:63], v[44:47], v[240:247], v6
  v_cndmask_b32 v50, v94, v98, s[18:19]
  v_smfmac_f32_16x16x64_bf16 v[68:71], v[20:23], v[152:159], v6
  v_cndmask_b32 v51, v95, v99, s[18:19]
  v_smfmac_f32_16x16x64_bf16 v[64:67], v[24:27], v[232:239], v6
  ds_write_b128 v8, v[48:51] offset:12288
  v_add_f32 v60, v60, v62
  v_add_f32 v61, v61, v63
  v_cvt_pk_bf16_f32 v62, v60, v61
  v_smfmac_f32_16x16x64_bf16 v[64:67], v[28:31], v[224:231], v6
  ds_write_b32 v2, v62 offset:512
  s_waitcnt vmcnt(6)
  v_mov_b32 v79, 0
  v_smfmac_f32_16x16x64_bf16 v[64:67], v[32:35], v[216:223], v6
  v_mov_b64 v[20:21], s[14:15]
  v_smfmac_f32_16x16x64_bf16 v[64:67], v[36:39], v[200:207], v6
  v_mov_b64 v[22:23], s[14:15]
  v_smfmac_f32_16x16x64_bf16 v[64:67], v[40:43], v[192:199], v6
  s_waitcnt lgkmcnt(0)
  s_barrier
  ds_read_b128 v[52:55], v9 offset:12288
  ds_read_b128 v[56:59], v10 offset:12288
  v_smfmac_f32_16x16x64_bf16 v[64:67], v[44:47], v[184:191], v6
  ds_read_b128 v[60:63], v11 offset:12288
  v_smfmac_f32_16x16x64_bf16 v[68:71], v[24:27], v[176:183], v6
  ds_read_b64_tr_b16 v[88:89], v12 offset:0
  ds_read_b64_tr_b16 v[90:91], v12 offset:512
  v_smfmac_f32_16x16x64_bf16 v[68:71], v[28:31], v[168:175], v6
  ds_read_b64_tr_b16 v[92:93], v13 offset:0
  ds_read_b64_tr_b16 v[94:95], v13 offset:512
  v_add_f32 v64, v64, v66
  v_smfmac_f32_16x16x64_bf16 v[68:71], v[32:35], v[160:167], v6
  ds_read_b64_tr_b16 v[96:97], v14 offset:0
  ds_read_b64_tr_b16 v[98:99], v14 offset:512
  v_add_f32 v65, v65, v67
  v_smfmac_f32_16x16x64_bf16 v[68:71], v[36:39], v[144:151], v6
  ds_read_b64_tr_b16 v[100:101], v15 offset:0
  ds_read_b64_tr_b16 v[102:103], v15 offset:512
  s_waitcnt lgkmcnt(8)
  v_cvt_pk_bf16_f32 v66, v64, v65
  v_smfmac_f32_16x16x64_bf16 v[68:71], v[40:43], v[136:143], v6
  v_add_f32 v48, v48, v52
  v_smfmac_f32_16x16x64_bf16 v[68:71], v[44:47], v[128:135], v6
  s_waitcnt lgkmcnt(4)
  v_add_f32 v49, v49, v53
  v_mfma_f32_16x16x32_bf16 v[16:19], v[88:91], v[88:91], 0
  buffer_store_dwordx4 v[88:91], v8, s[4:7], s25 offen sc1
  v_add_f32 v50, v50, v54
  v_add_f32 v51, v51, v55
  v_mfma_f32_16x16x32_bf16 v[16:19], v[92:95], v[92:95], v[16:19]
  s_waitcnt lgkmcnt(0)
  v_add_f32 v56, v56, v60
  v_add_f32 v57, v57, v61
  v_mfma_f32_16x16x32_bf16 v[16:19], v[96:99], v[96:99], v[16:19]
  v_add_f32 v58, v58, v62
  v_add_f32 v59, v59, v63
  v_mfma_f32_16x16x32_bf16 v[16:19], v[100:103], v[100:103], v[16:19]
  v_add_f32 v48, v48, v56
  v_add_f32 v49, v49, v57
  v_add_f32 v50, v50, v58
  v_add_f32 v51, v51, v59
  v_exp_f32 v24, v48
  v_exp_f32 v25, v49
  v_exp_f32 v26, v50
  v_exp_f32 v27, v51
  v_cvt_pk_bf16_f32 v24, v24, v25
  v_mul_f32 v16, s24, v16
  v_cvt_pk_bf16_f32 v25, v26, v27
  v_cndmask_b32 v72, v24, 0, s[18:19]
  v_cndmask_b32 v73, v25, 0, s[18:19]
  v_cndmask_b32 v74, 0, v24, s[18:19]
  v_cndmask_b32 v75, 0, v25, s[18:19]
  v_mul_f32 v17, s24, v17
  v_exp_f32 v28, v16
  v_mfma_f32_16x16x32_bf16 v[60:63], v[72:75], v[20:23], 0
  v_exp_f32 v29, v17
  v_add_f32 v68, v68, v70
  v_mfma_f32_16x16x32_bf16 v[52:55], v[72:75], v[80:83], 0
  s_add_u32 s30, s25, 4096
  v_cvt_pk_bf16_f32 v28, v28, v29
  v_add_f32 v69, v69, v71
  v_mfma_f32_16x16x32_bf16 v[56:59], v[72:75], v[84:87], 0
  v_cndmask_b32 v77, 0, v28, s[18:19]
  v_cndmask_b32 v78, 0, v28, s[18:19]
  v_cvt_pk_bf16_f32 v67, v68, v69
  v_lshrrev_b32 v92, 1, v8
  v_mfma_f32_16x16x16_bf16 v[60:63], v[76:77], v[20:21], v[60:63]
  buffer_store_dwordx2 v[66:67], v92, s[4:7], s30 offen sc1
  v_max3_f32 v7, |v48|, |v49|, |v50|
  v_max_f32 v26, |v16|, |v17|
  v_mfma_f32_16x16x16_bf16 v[52:55], v[78:79], v[66:67], v[52:55]
  v_cndmask_b32 v26, 0, v26, s[18:19]
  v_max3_f32 v7, |v51|, v26, v7
  v_cmp_lt_f32 vcc, 0x42700000, v7
  v_mfma_f32_16x16x16_bf16 v[56:59], v[76:77], v[66:67], v[56:59]
  s_cbranch_vccnz c_fb_14
c_fbr_15:
  s_nop 1
  v_add_f32 v60, v60, v62
  v_add_f32 v61, v61, v63
  v_rcp_f32 v60, v60
  v_rcp_f32 v61, v61
  v_pk_add_f32 v[52:53], v[52:53], v[54:55]
  s_nop 1
  v_pk_add_f32 v[56:57], v[56:57], v[58:59]
  v_pk_mul_f32 v[52:53], v[52:53], v[60:61]
  v_pk_mul_f32 v[56:57], v[56:57], v[60:61]
  v_cvt_pk_bf16_f32 v54, v52, v53
  v_cvt_pk_bf16_f32 v55, v56, v57
  ds_write_b64 v2, v[54:55] offset:4096
  v_mov_b64 v[44:45], 0
  v_mov_b64 v[46:47], 0
  v_mov_b64 v[40:41], 0
  v_mov_b64 v[42:43], 0
  v_mov_b64 v[36:37], 0
  v_mov_b64 v[38:39], 0
  v_mov_b64 v[32:33], 0
  v_mov_b64 v[34:35], 0
  v_mov_b64 v[28:29], 0
  v_mov_b64 v[30:31], 0
  v_mov_b64 v[24:25], 0
  v_mov_b64 v[26:27], 0
  v_mov_b64 v[80:81], 0
  v_mov_b64 v[82:83], 0
  v_mov_b64 v[84:85], 0
  v_mov_b64 v[86:87], 0
  s_waitcnt lgkmcnt(0)
  s_barrier
  ds_read_b64_tr_b16 v[72:73], v3 offset:4096
  ds_read_b64_tr_b16 v[74:75], v3 offset:5120
  ds_read_b64_tr_b16 v[76:77], v3 offset:6144
  ds_read_b64_tr_b16 v[78:79], v3 offset:7168
  s_and_b32 s3, s21, 1
  s_add_u32 s21, s21, 1
  s_add_u32 s22, s22, 1
  s_and_b32 s42, s21, 3
  s_lshl_b32 s42, s42, 13
  s_cmp_eq_u32 s22, 64
  s_cbranch_scc1 c_last_17
  s_waitcnt lgkmcnt(2)
  v_smfmac_f32_16x16x64_bf16 v[44:47], v[72:75], a[248:255], v6
  ds_read_b128 v[16:19], v8 offset:40960
  v_smfmac_f32_16x16x64_bf16 v[40:43], v[72:75], a[232:239], v6
  s_waitcnt lgkmcnt(1)
  ds_read_b128 v[20:23], v8 offset:45056
  v_smfmac_f32_16x16x64_bf16 v[44:47], v[76:79], a[240:247], v6
  ds_read_b128 v[88:91], v8 offset:49152
  v_smfmac_f32_16x16x64_bf16 v[40:43], v[76:79], a[224:231], v6
  ds_read_b128 v[92:95], v8 offset:53248
  v_smfmac_f32_16x16x64_bf16 v[36:39], v[72:75], a[216:223], v6
  ds_read_b128 v[96:99], v8 offset:57344
  v_add_f32 v44, v44, v46
  v_add_f32 v45, v45, v47
  v_smfmac_f32_16x16x64_bf16 v[36:39], v[76:79], a[208:215], v6
  ds_read_b128 v[100:103], v8 offset:61440
  v_cvt_pk_bf16_f32 v48, v44, v45
  v_and_or_b32 v48, v48, -2, s3
  v_smfmac_f32_16x16x64_bf16 v[32:35], v[72:75], a[200:207], v6
  v_add_f32 v40, v40, v42
  v_add_f32 v41, v41, v43
  v_smfmac_f32_16x16x64_bf16 v[32:35], v[76:79], a[192:199], v6
  v_cvt_pk_bf16_f32 v49, v40, v41
  v_add_f32 v36, v36, v38
  v_smfmac_f32_16x16x64_bf16 v[28:31], v[72:75], a[184:191], v6
  v_add_f32 v37, v37, v39
  v_cvt_pk_bf16_f32 v50, v36, v37
  v_smfmac_f32_16x16x64_bf16 v[28:31], v[76:79], a[176:183], v6
  v_add_f32 v32, v32, v34
  v_add_f32 v33, v33, v35
  v_smfmac_f32_16x16x64_bf16 v[24:27], v[72:75], v[104:111], v6
  v_cvt_pk_bf16_f32 v51, v32, v33
  v_smfmac_f32_16x16x64_bf16 v[24:27], v[76:79], v[112:119], v6
  buffer_store_dwordx4 v[48:51], v4, s[4:7], s40 offen
  v_add_f32 v28, v28, v30
  v_add_f32 v29, v29, v31
  v_smfmac_f32_16x16x64_bf16 v[80:83], v[72:75], v[120:127], v6
  s_waitcnt lgkmcnt(0)
  v_cvt_pk_bf16_f32 v52, v28, v29
  v_and_or_b32 v52, v52, -2, s3
  v_smfmac_f32_16x16x64_bf16 v[80:83], v[76:79], v[16:23], v6
  v_add_f32 v24, v24, v26
  v_add_f32 v25, v25, v27
  v_smfmac_f32_16x16x64_bf16 v[84:87], v[72:75], v[88:95], v6
  v_cvt_pk_bf16_f32 v53, v24, v25
  v_smfmac_f32_16x16x64_bf16 v[84:87], v[76:79], v[96:103], v6
  v_add_f32 v80, v80, v82
  v_add_f32 v81, v81, v83
  v_cvt_pk_bf16_f32 v54, v80, v81
  s_nop 0
  s_nop 3
  v_pk_add_f32 v[84:85], v[84:85], v[86:87]
  v_cvt_pk_bf16_f32 v55, v84, v85
  buffer_store_dwordx4 v[52:55], v4, s[4:7], s41 offen
  s_add_u32 s42, s42, s62
  s_add_u32 s43, s42, 4096
  s_add_u32 s23, s23, 524288
  s_add_u32 s25, s25, 262144
  s_add_u32 s63, s63, 4096
  s_add_u32 s64, s64, 2048
  s_andn2_b32 s64, s64, s2
  s_add_u32 s97, s97, 8192
  s_add_u32 s92, s63, s20
  s_cmp_lg_u32 s17, 0
  s_cbranch_scc1 c_oth_31
  s_mov_b32 s28, 0
  s_add_u32 s46, s46, 1
  v_mov_b64 v[64:65], -1
  s_xor_b32 s34, s42, 16384
  buffer_store_dwordx2 v[64:65], v5, s[4:7], s34 offen
  s_mov_b32 vcc_lo, 0xaaaaaaaa
  s_mov_b32 vcc_hi, 0xaaaaaaaa
  v_mov_b32 v7, 0x3f80
  v_cndmask_b32 v7, v7, 1.0, vcc
  s_mov_b32 vcc_lo, 0x30003
  s_mov_b32 vcc_hi, 0x30003
  v_cndmask_b32 v68, 0, v7, vcc
  s_mov_b32 vcc_lo, 0xc000c
  s_mov_b32 vcc_hi, 0xc000c
  v_cndmask_b32 v69, 0, v7, vcc
  s_mov_b32 vcc_lo, 0x300030
  s_mov_b32 vcc_hi, 0x300030
  v_cndmask_b32 v70, 0, v7, vcc
  s_mov_b32 vcc_lo, 0xc000c0
  s_mov_b32 vcc_hi, 0xc000c0
  v_cndmask_b32 v71, 0, v7, vcc
  ds_read_b128 v[104:107], v1 offset:14336
  ds_read_b128 v[108:111], v1 offset:15360
  s_waitcnt lgkmcnt(0)
  ds_read_b128 v[112:115], v1 offset:16384
  ds_read_b128 v[116:119], v1 offset:17408
  ds_read_b128 v[120:123], v1 offset:18432
  ds_read_b128 v[124:127], v1 offset:19456
  s_waitcnt lgkmcnt(0)
c_erl_33:
  buffer_load_dwordx4 v[16:19], v0, s[4:7], s38 offen offset:0 sc1
  buffer_load_dwordx4 v[20:23], v0, s[4:7], s38 offen offset:1024 sc1
  buffer_load_dwordx4 v[24:27], v0, s[4:7], s38 offen offset:2048 sc1
  buffer_load_dwordx4 v[28:31], v0, s[4:7], s38 offen offset:3072 sc1
  buffer_load_dwordx4 v[32:35], v0, s[4:7], s39 offen offset:0 sc1
  buffer_load_dwordx4 v[36:39], v0, s[4:7], s39 offen offset:1024 sc1
  buffer_load_dwordx4 v[40:43], v0, s[4:7], s39 offen offset:2048 sc1
  buffer_load_dwordx4 v[44:47], v0, s[4:7], s39 offen offset:3072 sc1
  buffer_load_dwordx4 v[72:75], v0, s[4:7], s38 offen offset:0 sc1
  buffer_load_dwordx4 v[76:79], v0, s[4:7], s38 offen offset:1024 sc1
  buffer_load_dwordx4 v[80:83], v0, s[4:7], s38 offen offset:2048 sc1
  buffer_load_dwordx4 v[84:87], v0, s[4:7], s38 offen offset:3072 sc1
  buffer_load_dwordx4 v[88:91], v0, s[4:7], s39 offen offset:0 sc1
  buffer_load_dwordx4 v[92:95], v0, s[4:7], s39 offen offset:1024 sc1
  buffer_load_dwordx4 v[96:99], v0, s[4:7], s39 offen offset:2048 sc1
  buffer_load_dwordx4 v[100:103], v0, s[4:7], s39 offen offset:3072 sc1
  s_buffer_load_dword s65, s[4:7], s63
  s_waitcnt vmcnt(15)
  v_mfma_f32_16x16x32_bf16 v[64:67], v[16:19], v[68:71], 0
  v_xor_b32 v7, s3, v16
  s_waitcnt vmcnt(14)
  v_mfma_f32_16x16x32_bf16 v[64:67], v[20:23], v[68:71], v[64:67]
  v_bitop3_b32 v7, v7, v20, s3 bitop3:0xf6
  s_waitcnt vmcnt(13)
  v_mfma_f32_16x16x32_bf16 v[64:67], v[24:27], v[68:71], v[64:67]
  v_bitop3_b32 v7, v7, v24, s3 bitop3:0xf6
  s_waitcnt vmcnt(12)
  v_mfma_f32_16x16x32_bf16 v[64:67], v[28:31], v[68:71], v[64:67]
  v_bitop3_b32 v7, v7, v28, s3 bitop3:0xf6
  s_waitcnt vmcnt(11)
  v_mfma_f32_16x16x32_bf16 v[64:67], v[32:35], v[68:71], v[64:67]
  v_bitop3_b32 v7, v7, v32, s3 bitop3:0xf6
  s_waitcnt vmcnt(10)
  v_mfma_f32_16x16x32_bf16 v[64:67], v[36:39], v[68:71], v[64:67]
  v_bitop3_b32 v7, v7, v36, s3 bitop3:0xf6
  s_waitcnt vmcnt(9)
  v_mfma_f32_16x16x32_bf16 v[64:67], v[40:43], v[68:71], v[64:67]
  v_bitop3_b32 v7, v7, v40, s3 bitop3:0xf6
  s_waitcnt vmcnt(8)
  v_mfma_f32_16x16x32_bf16 v[64:67], v[44:47], v[68:71], v[64:67]
  v_bitop3_b32 v7, v7, v44, s3 bitop3:0xf6
  v_and_b32 v7, 1, v7
  v_cmp_ne_u32 vcc, 0, v7
  v_mov_b32 v7, 0
  v_mov_b32 v7, 0
  s_cbranch_vccnz c_p1r_32
c_publ_35:
  s_nop 1
  s_nop 0
  v_cvt_pk_bf16_f32 v64, v64, v65
  v_cvt_pk_bf16_f32 v65, v66, v67
  v_min_u32 v64, -2, v64
  v_min_u32 v65, -2, v65
  buffer_store_dwordx2 v[64:65], v5, s[4:7], s42 offen
  s_waitcnt vmcnt(1)
  ds_read_b128 v[24:27], v1 offset:0
  ds_read_b128 v[28:31], v1 offset:1024
  ds_read_b128 v[32:35], v1 offset:2048
  ds_read_b128 v[36:39], v1 offset:3072
  ds_read_b128 v[40:43], v1 offset:4096
  ds_read_b128 v[44:47], v1 offset:5120
  ds_read_b128 v[72:75], v1 offset:6144
  ds_read_b128 v[76:79], v1 offset:7168
  ds_read_b128 v[80:83], v1 offset:8192
  ds_read_b128 v[84:87], v1 offset:9216
  ds_read_b128 v[88:91], v1 offset:10240
  ds_read_b128 v[92:95], v1 offset:11264
  ds_read_b128 v[96:99], v1 offset:12288
  ds_read_b128 v[100:103], v1 offset:13312
c_hop2_13:
  s_barrier
  s_cmp_le_u32 s96, s23
  s_cbranch_scc1 c_loop_10
  s_cmp_lg_u32 s96, 268435456
  s_cbranch_scc1 c_fk0_36
  buffer_store_dwordx2 v[64:65], v5, s[4:7], s97 offen sc1
  s_mov_b32 s29, 0
  s_sub_u32 s92, s63, 4096
  s_sub_u32 s96, s23, 524288
  s_mov_b32 s95, 0
c_gw_37:
  buffer_load_dword v7, off, s[4:7], s92 sc1
  s_add_u32 s29, s29, 1
  s_cmp_gt_u32 s29, 1048576
  s_cbranch_scc1 c_fail_16
  s_waitcnt vmcnt(0) lgkmcnt(0)
  v_readfirstlane_b32 s65, v7
  s_cmp_eq_u32 s65, 0
  s_cbranch_scc1 c_gw_37
  s_and_b32 s65, s65, s93
  s_cbranch_scc1 c_kvx_39
  s_mov_b32 s95, 1
  s_add_u32 s96, s96, 33554432
  s_add_u32 s92, s92, 262144
c_kvw_38:
  buffer_load_dword v7, off, s[4:7], s92 sc1
  s_add_u32 s29, s29, 1
  s_cmp_gt_u32 s29, 1048576
  s_cbranch_scc1 c_fail_16
  s_waitcnt vmcnt(0) lgkmcnt(0)
  v_readfirstlane_b32 s65, v7
  s_cmp_eq_u32 s65, 0
  s_cbranch_scc1 c_kvw_38
c_kvx_39:
  buffer_load_dword v7, off, s[4:7], s63 sc1
  buffer_load_dwordx4 v0, s[4:7], s96 offen offset:0  lds
  buffer_load_dwordx4 v0, s[4:7], s96 offen offset:1024  lds
  buffer_load_dwordx4 v0, s[4:7], s96 offen offset:2048  lds
  buffer_load_dwordx4 v0, s[4:7], s96 offen offset:3072  lds
  s_waitcnt vmcnt(4)
  v_readfirstlane_b32 s65, v7
  s_mov_b32 s94, 0
  s_cmp_eq_u32 s95, 0
  s_cbranch_scc1 c_loop_10
c_fk0_36:
  s_mov_b32 s29, 0
c_fk_40:
  buffer_load_dwordx4 v[16:19], v8, s[4:7], s42 offen sc1
  buffer_load_dwordx4 v[20:23], v8, s[4:7], s43 offen sc1
  s_add_u32 s29, s29, 1
  s_cmp_gt_u32 s29, 1048576
  s_cbranch_scc1 c_fail_16
  s_waitcnt vmcnt(0)
  v_max3_u32 v7, v16, v17, v18
  v_max3_u32 v7, v19, v20, v7
  v_max3_u32 v7, v21, v22, v7
  v_max_u32 v7, v7, v23
  v_cmp_eq_u32 vcc, -1, v7
  s_cbranch_vccnz c_fk_40
c_fk1_41:
  s_lshl_b32 s42, s22, 13
  s_add_u32 s42, s42, 245891072
  s_add_u32 s43, s42, 4096
  s_mov_b32 s95, 0
  s_branch c_loop_10
c_xb_25:
  s_cmp_lg_u32 s93, 1
  s_cbranch_scc1 c_xr_26
  s_cmp_ge_u32 s22, 63
  s_cbranch_scc1 c_xr_26
c_xp_42:
  s_cmp_lg_u32 s65, 0
  s_cbranch_scc1 c_xs_43
  buffer_load_dword v7, off, s[4:7], s63 sc1
  s_add_u32 s29, s29, 1
  s_cmp_gt_u32 s29, 1048576
  s_cbranch_scc1 c_fail_16
  s_waitcnt vmcnt(0)
  v_readfirstlane_b32 s65, v7
  s_branch c_xp_42
c_xs_43:
  s_cmp_eq_u32 s65, 1
  s_cbranch_scc1 c_xr_26
  s_mov_b32 s29, 0
c_xw_44:
  buffer_load_dwordx4 v[16:19], v8, s[4:7], s42 offen sc1
  buffer_load_dwordx4 v[20:23], v8, s[4:7], s43 offen sc1
  s_add_u32 s29, s29, 1
  s_cmp_gt_u32 s29, 1048576
  s_cbranch_scc1 c_fail_16
  s_waitcnt vmcnt(0)
  v_max3_u32 v7, v16, v17, v18
  v_max3_u32 v7, v19, v20, v7
  v_max3_u32 v7, v21, v22, v7
  v_max_u32 v7, v7, v23
  v_cmp_eq_u32 vcc, -1, v7
  s_cbranch_vccnz c_xw_44
  v_mov_b32 v7, 1
  s_barrier
  s_mov_b64 exec, 1
  buffer_store_dword v7, off, s[4:7], s64 sc1
  s_mov_b64 exec, -1
  s_add_u32 s22, s22, 1
  s_add_u32 s23, s23, 524288
  s_add_u32 s25, s25, 262144
  s_add_u32 s63, s63, 4096
  s_add_u32 s64, s64, 2048
  s_andn2_b32 s64, s64, s2
  s_mov_b32 s29, 0
  s_sub_u32 s92, s63, 4096
  s_sub_u32 s96, s23, 524288
  s_mov_b32 s95, 0
  s_mov_b32 s95, 1
  s_add_u32 s96, s96, 33554432
  s_add_u32 s92, s92, 262144
c_kvw_46:
  buffer_load_dword v7, off, s[4:7], s92 sc1
  s_add_u32 s29, s29, 1
  s_cmp_gt_u32 s29, 1048576
  s_cbranch_scc1 c_fail_16
  s_waitcnt vmcnt(0) lgkmcnt(0)
  v_readfirstlane_b32 s65, v7
  s_cmp_eq_u32 s65, 0
  s_cbranch_scc1 c_kvw_46
c_kvx_47:
  buffer_load_dword v7, off, s[4:7], s63 sc1
  buffer_load_dwordx4 v0, s[4:7], s96 offen offset:0  lds
  buffer_load_dwordx4 v0, s[4:7], s96 offen offset:1024  lds
  buffer_load_dwordx4 v0, s[4:7], s96 offen offset:2048  lds
  buffer_load_dwordx4 v0, s[4:7], s96 offen offset:3072  lds
  s_waitcnt vmcnt(4)
  v_readfirstlane_b32 s65, v7
  s_mov_b32 s94, 0
  s_branch c_fk1_41
c_last_17:
  s_add_u32 s64, s64, 2048
  v_mov_b32 v7, 1
  s_waitcnt vmcnt(0)
  s_barrier
  s_mov_b64 exec, 1
  buffer_store_dword v7, off, s[4:7], s64 sc1
  s_mov_b64 exec, -1
  s_branch L_chdone
c_oth_31:
  s_buffer_load_dword s65, s[4:7], s63
  ds_read_b128 v[24:27], v1 offset:0
  ds_read_b128 v[28:31], v1 offset:1024
  ds_read_b128 v[32:35], v1 offset:2048
  ds_read_b128 v[36:39], v1 offset:3072
  ds_read_b128 v[40:43], v1 offset:4096
  ds_read_b128 v[44:47], v1 offset:5120
  ds_read_b128 v[72:75], v1 offset:6144
  ds_read_b128 v[76:79], v1 offset:7168
  ds_read_b128 v[80:83], v1 offset:8192
  ds_read_b128 v[84:87], v1 offset:9216
  ds_read_b128 v[88:91], v1 offset:10240
  ds_read_b128 v[92:95], v1 offset:11264
  ds_read_b128 v[96:99], v1 offset:12288
  ds_read_b128 v[100:103], v1 offset:13312
  ds_read_b128 v[104:107], v1 offset:14336
  ds_read_b128 v[108:111], v1 offset:15360
  ds_read_b128 v[112:115], v1 offset:16384
  ds_read_b128 v[116:119], v1 offset:17408
  ds_read_b128 v[120:123], v1 offset:18432
  ds_read_b128 v[124:127], v1 offset:19456
  s_branch c_hop2_13
c_p1r_32:
  s_waitcnt vmcnt(7)
  s_nop 0
  v_mfma_f32_16x16x32_bf16 v[64:67], v[72:75], v[68:71], 0
  v_xor_b32 v7, s3, v72
  s_waitcnt vmcnt(6)
  v_mfma_f32_16x16x32_bf16 v[64:67], v[76:79], v[68:71], v[64:67]
  v_bitop3_b32 v7, v7, v76, s3 bitop3:0xf6
  s_waitcnt vmcnt(5)
  v_mfma_f32_16x16x32_bf16 v[64:67], v[80:83], v[68:71], v[64:67]
  v_bitop3_b32 v7, v7, v80, s3 bitop3:0xf6
  s_waitcnt vmcnt(4)
  v_mfma_f32_16x16x32_bf16 v[64:67], v[84:87], v[68:71], v[64:67]
  v_bitop3_b32 v7, v7, v84, s3 bitop3:0xf6
  s_waitcnt vmcnt(3)
  v_mfma_f32_16x16x32_bf16 v[64:67], v[88:91], v[68:71], v[64:67]
  v_bitop3_b32 v7, v7, v88, s3 bitop3:0xf6
  s_waitcnt vmcnt(2)
  v_mfma_f32_16x16x32_bf16 v[64:67], v[92:95], v[68:71], v[64:67]
  v_bitop3_b32 v7, v7, v92, s3 bitop3:0xf6
  s_waitcnt vmcnt(1)
  v_mfma_f32_16x16x32_bf16 v[64:67], v[96:99], v[68:71], v[64:67]
  v_bitop3_b32 v7, v7, v96, s3 bitop3:0xf6
  s_waitcnt vmcnt(0)
  v_mfma_f32_16x16x32_bf16 v[64:67], v[100:103], v[68:71], v[64:67]
  v_bitop3_b32 v7, v7, v100, s3 bitop3:0xf6
  v_and_b32 v7, 1, v7
  v_cmp_ne_u32 vcc, 0, v7
  s_add_u32 s46, s46, 1
  s_cbranch_vccz c_publ_35
  buffer_load_dwordx4 v[72:75], v0, s[4:7], s38 offen offset:0 sc1
  buffer_load_dwordx4 v[76:79], v0, s[4:7], s38 offen offset:1024 sc1
  buffer_load_dwordx4 v[80:83], v0, s[4:7], s38 offen offset:2048 sc1
  buffer_load_dwordx4 v[84:87], v0, s[4:7], s38 offen offset:3072 sc1
  buffer_load_dwordx4 v[88:91], v0, s[4:7], s39 offen offset:0 sc1
  buffer_load_dwordx4 v[92:95], v0, s[4:7], s39 offen offset:1024 sc1
  buffer_load_dwordx4 v[96:99], v0, s[4:7], s39 offen offset:2048 sc1
  buffer_load_dwordx4 v[100:103], v0, s[4:7], s39 offen offset:3072 sc1
  s_add_u32 s28, s28, 1
  s_cmp_gt_u32 s28, 1048576
  s_cbranch_scc0 c_p1r_32
  s_branch c_fail_16
c_retry_11:
  v_mov_b64 v[48:49], 0
  v_mov_b64 v[50:51], 0
  s_nop 0
  v_mov_b64 v[52:53], 0
  v_mov_b64 v[54:55], 0
  s_nop 1
  v_mov_b64 v[56:57], 0
  v_mov_b64 v[58:59], 0
c_rl_48:
  buffer_load_dwordx4 v[16:19], v8, s[4:7], s42 offen sc1
  buffer_load_dwordx4 v[20:23], v8, s[4:7], s43 offen sc1
  s_add_u32 s28, s28, 1
  s_add_u32 s47, s47, 1
  s_cmp_gt_u32 s28, 1048576
  s_cbranch_scc1 c_fail_16
  s_waitcnt vmcnt(2)
  v_max3_u32 v7, v16, v17, v18
  v_max3_u32 v7, v19, v20, v7
  v_max3_u32 v7, v21, v22, v7
  v_max_u32 v7, v7, v23
  v_cmp_eq_u32 vcc, -1, v7
  s_cbranch_vccnz c_rl_48
  ds_write_b128 v8, v[16:19] offset:4096
  v_smfmac_f32_16x16x64_bf16 v[48:51], v[16:19], v[24:31], v6
  ds_write_b128 v8, v[20:23] offset:8192
  v_smfmac_f32_16x16x64_bf16 v[52:55], v[16:19], v[32:39], v6
  v_smfmac_f32_16x16x64_bf16 v[56:59], v[16:19], v[40:47], v6
  s_branch c_got_12
c_fb_14:
  v_max3_f32 v7, v48, v49, v50
  v_max_f32 v7, v51, v7
  s_mov_b64 exec, s[18:19]
  v_max3_f32 v7, v16, v17, v7
  s_mov_b64 exec, -1
  s_nop 0
  v_max_f32_dpp v7, v7, v7 quad_perm:[2,3,0,1] row_mask:0xf bank_mask:0xf
  v_mov_b32 v24, v7
  s_nop 0
  s_nop 0
  v_permlane16_swap_b32 v7, v24
  v_max_f32 v7, v7, v24
  v_mov_b32 v24, v7
  s_nop 0
  s_nop 0
  v_permlane32_swap_b32 v7, v24
  v_max_f32 v7, v7, v24
  v_sub_f32 v24, v48, v7
  v_sub_f32 v25, v49, v7
  v_sub_f32 v26, v50, v7
  v_sub_f32 v27, v51, v7
  v_sub_f32 v28, v16, v7
  v_sub_f32 v29, v17, v7
  v_exp_f32 v24, v24
  v_exp_f32 v25, v25
  v_exp_f32 v26, v26
  v_exp_f32 v27, v27
  v_exp_f32 v28, v28
  v_exp_f32 v29, v29
  v_cvt_pk_bf16_f32 v24, v24, v25
  v_cvt_pk_bf16_f32 v25, v26, v27
  v_cvt_pk_bf16_f32 v28, v28, v29
  v_cndmask_b32 v72, v24, 0, s[18:19]
  v_cndmask_b32 v73, v25, 0, s[18:19]
  v_cndmask_b32 v74, 0, v24, s[18:19]
  v_cndmask_b32 v75, 0, v25, s[18:19]
  v_cndmask_b32 v77, 0, v28, s[18:19]
  v_cndmask_b32 v78, 0, v28, s[18:19]
  v_mfma_f32_16x16x32_bf16 v[60:63], v[72:75], v[20:23], 0
  v_mfma_f32_16x16x32_bf16 v[52:55], v[72:75], v[80:83], 0
  v_mfma_f32_16x16x32_bf16 v[56:59], v[72:75], v[84:87], 0
  v_mfma_f32_16x16x16_bf16 v[60:63], v[76:77], v[20:21], v[60:63]
  v_mfma_f32_16x16x16_bf16 v[52:55], v[78:79], v[66:67], v[52:55]
  s_nop 2
  v_mfma_f32_16x16x16_bf16 v[56:59], v[76:77], v[66:67], v[56:59]
  s_branch c_fbr_15
c_fail_16:
  s_endpgm
L_chain_x:
  s_mov_b32 s22, 0
  s_mov_b32 s21, 0
  s_mov_b32 s42, s62
  s_add_u32 s43, s62, 4096
  s_mov_b32 s46, 0
  s_mov_b32 s47, 0
  s_lshl_b32 s26, s16, 2
  s_add_u32 s26, s26, s17
  s_lshl_b32 s27, s60, 13
  s_add_u32 s27, s27, s26
  s_lshr_b32 s25, s27, 2
  s_lshl_b32 s25, s25, 13
  s_add_u32 s25, s25, 192937984
  s_lshr_b32 s64, s27, 2
  s_lshl_b32 s64, s64, 6
  s_add_u32 s64, s64, 513538048
  s_cmp_eq_u32 s17, 3
  s_cselect_b32 s2, 268435456, 0
  s_lshl_b32 s27, s61, 13
  s_add_u32 s27, s27, s26
  s_lshl_b32 s23, s27, 12
  s_add_u32 s23, s23, 41943040
  s_lshl_b32 s63, s27, 5
  s_add_u32 s63, s63, 244318208
  s_mov_b32 s97, 268435456
  s_cmp_eq_u32 s60, 2
  s_cselect_b32 s20, 262144, s97
  s_cselect_b32 s93, 1, 3
  s_lshl_b32 s26, s17, 2
  s_add_u32 s26, s26, s60
  s_cmp_eq_u32 s26, 1
  s_cselect_b32 s97, 245891072, s97
  s_mov_b32 s95, 0
  s_mov_b32 s96, s23
  s_add_u32 s23, s23, 524288
  s_add_u32 s63, s63, 4096
  s_cmp_eq_u32 s66, 0
  s_cbranch_scc1 c_pk_57
  s_sub_u32 s96, s23, 524288
  s_mov_b32 s65, s67
  s_mov_b32 s94, 0
  buffer_load_dwordx4 v0, s[4:7], s96 offen offset:0  lds
  buffer_load_dwordx4 v0, s[4:7], s96 offen offset:1024  lds
  buffer_load_dwordx4 v0, s[4:7], s96 offen offset:2048  lds
  buffer_load_dwordx4 v0, s[4:7], s96 offen offset:3072  lds
  s_branch c_pk2_58
c_pk_57:
  s_mov_b32 s29, 0
  s_sub_u32 s92, s63, 4096
  s_sub_u32 s96, s23, 524288
  s_mov_b32 s95, 0
c_gw_59:
  buffer_load_dword v7, off, s[4:7], s92 sc1
  s_add_u32 s29, s29, 1
  s_cmp_gt_u32 s29, 1048576
  s_cbranch_scc1 c_fail_55
  s_waitcnt vmcnt(0) lgkmcnt(0)
  v_readfirstlane_b32 s65, v7
  s_cmp_eq_u32 s65, 0
  s_cbranch_scc1 c_gw_59
  s_and_b32 s65, s65, s93
  s_cbranch_scc1 c_kvx_61
  s_mov_b32 s95, 1
  s_add_u32 s96, s96, 33554432
  s_add_u32 s92, s92, 262144
c_kvw_60:
  buffer_load_dword v7, off, s[4:7], s92 sc1
  s_add_u32 s29, s29, 1
  s_cmp_gt_u32 s29, 1048576
  s_cbranch_scc1 c_fail_55
  s_waitcnt vmcnt(0) lgkmcnt(0)
  v_readfirstlane_b32 s65, v7
  s_cmp_eq_u32 s65, 0
  s_cbranch_scc1 c_kvw_60
c_kvx_61:
  buffer_load_dword v7, off, s[4:7], s63 sc1
  buffer_load_dwordx4 v0, s[4:7], s96 offen offset:0  lds
  buffer_load_dwordx4 v0, s[4:7], s96 offen offset:1024  lds
  buffer_load_dwordx4 v0, s[4:7], s96 offen offset:2048  lds
  buffer_load_dwordx4 v0, s[4:7], s96 offen offset:3072  lds
  s_waitcnt vmcnt(4)
  v_readfirstlane_b32 s65, v7
  s_mov_b32 s94, 0
c_pk2_58:
  s_waitcnt vmcnt(4)
  ds_read_b128 v[72:75], v1 offset:6144
  ds_read_b128 v[76:79], v1 offset:7168
  ds_read_b128 v[80:83], v1 offset:8192
  ds_read_b128 v[84:87], v1 offset:9216
  ds_read_b128 v[88:91], v1 offset:10240
  ds_read_b128 v[92:95], v1 offset:11264
  ds_read_b128 v[96:99], v1 offset:12288
  ds_read_b128 v[100:103], v1 offset:13312
  ds_read_b128 v[104:107], v1 offset:14336
  ds_read_b128 v[108:111], v1 offset:15360
  ds_read_b128 v[112:115], v1 offset:16384
  ds_read_b128 v[116:119], v1 offset:17408
  ds_read_b128 v[120:123], v1 offset:18432
  ds_read_b128 v[124:127], v1 offset:19456
  v_mov_b64 v[48:49], 0
  v_mov_b64 v[50:51], 0
  v_mov_b64 v[52:53], 0
  v_mov_b64 v[54:55], 0
  v_mov_b64 v[56:57], 0
  v_mov_b64 v[58:59], 0
  v_mov_b64 v[60:61], 0
  v_mov_b64 v[62:63], 0
  v_mov_b64 v[64:65], 0
  v_mov_b64 v[66:67], 0
  v_mov_b64 v[68:69], 0
  v_mov_b64 v[70:71], 0
  s_lshl_b32 s38, s16, 13
  s_add_u32 s38, s38, s40
  s_add_u32 s39, s38, 4096
  ds_read_b128 v[24:27], v1 offset:0
  ds_read_b128 v[28:31], v1 offset:1024
  ds_read_b128 v[32:35], v1 offset:2048
  ds_read_b128 v[36:39], v1 offset:3072
  ds_read_b128 v[40:43], v1 offset:4096
  ds_read_b128 v[44:47], v1 offset:5120
  s_waitcnt lgkmcnt(0)
c_loop_49:
  buffer_load_dwordx4 v[16:19], v8, s[4:7], s42 offen sc1
  buffer_load_dwordx4 v[20:23], v8, s[4:7], s43 offen sc1
  s_mov_b32 s28, 0
  v_mov_b64 v[48:49], 0
  v_mov_b64 v[50:51], 0
  v_mov_b64 v[52:53], 0
  v_mov_b64 v[54:55], 0
  v_mov_b64 v[56:57], 0
  v_mov_b64 v[58:59], 0
  v_mov_b64 v[60:61], 0
  v_mov_b64 v[62:63], 0
  v_mov_b64 v[64:65], 0
  v_mov_b64 v[66:67], 0
  v_mov_b64 v[68:69], 0
  v_mov_b64 v[70:71], 0
  buffer_load_dwordx4 v[16:19], v8, s[4:7], s42 offen sc1
  buffer_load_dwordx4 v[20:23], v8, s[4:7], s43 offen sc1
  s_waitcnt lgkmcnt(0)
  s_and_b32 s29, s65, s93
  s_cbranch_scc0 c_xb_64
c_xr_65:
  s_waitcnt vmcnt(3)
  v_max3_u32 v7, v16, v17, v18
  v_max_u32 v7, v7, v19
  ds_write_b128 v8, v[16:19] offset:4096
  v_smfmac_f32_16x16x64_bf16 v[48:51], v[16:19], v[24:31], v6
  s_waitcnt vmcnt(2)
  v_max3_u32 v7, v20, v21, v7
  v_max3_u32 v7, v22, v23, v7
  ds_write_b128 v8, v[20:23] offset:8192
  v_smfmac_f32_16x16x64_bf16 v[52:55], v[16:19], v[32:39], v6
  v_cmp_eq_u32 vcc, -1, v7
  v_smfmac_f32_16x16x64_bf16 v[56:59], v[16:19], v[40:47], v6
  s_cbranch_vccnz c_retry_50
c_got_51:
  v_smfmac_f32_16x16x64_bf16 v[60:63], v[16:19], v[72:79], v6
  ds_read_b128 v[72:75], v1 offset:20480
  s_and_b32 s65, s65, s93
  s_cselect_b32 s96, s23, 268435456
  v_smfmac_f32_16x16x64_bf16 v[48:51], v[20:23], v[80:87], v6
  ds_read_b128 v[76:79], v1 offset:21504
  v_mov_b32 v7, 1
  v_smfmac_f32_16x16x64_bf16 v[52:55], v[20:23], v[88:95], v6
  ds_read_b128 v[80:83], v1 offset:22528
  v_smfmac_f32_16x16x64_bf16 v[56:59], v[20:23], v[96:103], v6
  ds_read_b128 v[84:87], v1 offset:23552
  s_waitcnt lgkmcnt(4)
  s_barrier
  ds_read_b128 v[24:27], v9 offset:4096
  ds_read_b128 v[28:31], v10 offset:4096
  v_smfmac_f32_16x16x64_bf16 v[60:63], v[20:23], v[104:111], v6
  ds_read_b128 v[32:35], v11 offset:4096
  v_smfmac_f32_16x16x64_bf16 v[64:67], v[16:19], v[112:119], v6
  ds_read_b128 v[36:39], v9 offset:8192
  v_smfmac_f32_16x16x64_bf16 v[68:71], v[16:19], v[120:127], v6
  ds_read_b128 v[40:43], v10 offset:8192
  v_smfmac_f32_16x16x64_bf16 v[64:67], v[20:23], v[208:215], v6
  ds_read_b128 v[44:47], v11 offset:8192
  s_waitcnt lgkmcnt(5)
  v_smfmac_f32_16x16x64_bf16 v[48:51], v[24:27], a[168:175], v6
  buffer_load_dwordx4 v0, s[4:7], s96 offen offset:0  lds
  s_waitcnt lgkmcnt(4)
  v_smfmac_f32_16x16x64_bf16 v[48:51], v[28:31], a[160:167], v6
  ds_read_b128 v[104:107], v8 offset:16384
  s_waitcnt lgkmcnt(4)
  v_smfmac_f32_16x16x64_bf16 v[48:51], v[32:35], a[152:159], v6
  buffer_load_dwordx4 v0, s[4:7], s96 offen offset:1024  lds
  s_waitcnt lgkmcnt(3)
  v_smfmac_f32_16x16x64_bf16 v[48:51], v[36:39], a[144:151], v6
  ds_read_b128 v[108:111], v8 offset:20480
  s_waitcnt lgkmcnt(3)
  v_smfmac_f32_16x16x64_bf16 v[48:51], v[40:43], a[136:143], v6
  buffer_load_dwordx4 v0, s[4:7], s96 offen offset:2048  lds
  s_waitcnt lgkmcnt(2)
  v_smfmac_f32_16x16x64_bf16 v[48:51], v[44:47], a[128:135], v6
  v_smfmac_f32_16x16x64_bf16 v[52:55], v[24:27], a[120:127], v6
  buffer_load_dwordx4 v0, s[4:7], s96 offen offset:3072  lds
  v_smfmac_f32_16x16x64_bf16 v[52:55], v[28:31], a[112:119], v6
  ds_read_b64 v[100:101], v5 offset:4096
  v_add_f32 v48, v48, v50
  v_smfmac_f32_16x16x64_bf16 v[52:55], v[32:35], a[104:111], v6
  ds_read_b128 v[112:115], v8 offset:24576
  v_add_f32 v49, v49, v51
  v_smfmac_f32_16x16x64_bf16 v[52:55], v[36:39], a[96:103], v6
  ds_read_b128 v[116:119], v8 offset:28672
  v_cvt_pk_bf16_f32 v50, v48, v49
  v_smfmac_f32_16x16x64_bf16 v[52:55], v[40:43], a[88:95], v6
  ds_write2_b32 v2, v50, v50 offset0:0 offset1:1
  v_smfmac_f32_16x16x64_bf16 v[52:55], v[44:47], a[80:87], v6
  ds_read_b64_tr_b16 v[88:89], v12 offset:0
  v_smfmac_f32_16x16x64_bf16 v[56:59], v[24:27], a[72:79], v6
  s_mov_b64 exec, 1
  buffer_store_dword v7, off, s[4:7], s64 sc1
  s_mov_b64 exec, -1
  v_smfmac_f32_16x16x64_bf16 v[56:59], v[28:31], a[64:71], v6
  ds_read_b128 v[120:123], v8 offset:32768
  v_add_f32 v52, v52, v54
  v_smfmac_f32_16x16x64_bf16 v[56:59], v[32:35], a[56:63], v6
  ds_read_b128 v[124:127], v8 offset:36864
  v_add_f32 v53, v53, v55
  v_cvt_pk_bf16_f32 v54, v52, v53
  v_smfmac_f32_16x16x64_bf16 v[56:59], v[36:39], a[48:55], v6
  ds_write2_b32 v2, v54, v54 offset0:128 offset1:129
  ds_read_b64_tr_b16 v[90:91], v12 offset:512
  v_smfmac_f32_16x16x64_bf16 v[56:59], v[40:43], a[40:47], v6
  v_smfmac_f32_16x16x64_bf16 v[56:59], v[44:47], a[32:39], v6
  s_waitcnt lgkmcnt(8)
  buffer_store_dwordx2 v[100:101], v5, s[4:7], s97 offen sc1
  v_smfmac_f32_16x16x64_bf16 v[60:63], v[24:27], a[24:31], v6
  v_smfmac_f32_16x16x64_bf16 v[60:63], v[28:31], a[16:23], v6
  s_waitcnt lgkmcnt(0)
  v_add_f32 v56, v56, v58
  v_mfma_f32_16x16x32_bf16 v[92:95], v[72:75], v[88:91], 0
  v_add_f32 v57, v57, v59
  v_cvt_pk_bf16_f32 v58, v56, v57
  v_mfma_f32_16x16x32_bf16 v[96:99], v[76:79], v[88:91], 0
  ds_write_b32 v2, v58
  v_smfmac_f32_16x16x64_bf16 v[60:63], v[32:35], a[8:15], v6
  v_mov_b32 v76, 0
  v_smfmac_f32_16x16x64_bf16 v[60:63], v[36:39], a[0:7], v6
  v_cndmask_b32 v48, v92, v96, s[18:19]
  v_smfmac_f32_16x16x64_bf16 v[60:63], v[40:43], v[248:255], v6
  v_cndmask_b32 v49, v93, v97, s[18:19]
  v_smfmac_f32_16x16x64_bf16 v[60:63], v[44:47], v[240:247], v6
  v_cndmask_b32 v50, v94, v98, s[18:19]
  v_smfmac_f32_16x16x64_bf16 v[68:71], v[20:23], v[152:159], v6
  v_cndmask_b32 v51, v95, v99, s[18:19]
  v_smfmac_f32_16x16x64_bf16 v[64:67], v[24:27], v[232:239], v6
  ds_write_b128 v8, v[48:51] offset:12288
  v_add_f32 v60, v60, v62
  v_add_f32 v61, v61, v63
  v_cvt_pk_bf16_f32 v62, v60, v61
  v_smfmac_f32_16x16x64_bf16 v[64:67], v[28:31], v[224:231], v6
  ds_write_b32 v2, v62 offset:512
  s_waitcnt vmcnt(6)
  v_mov_b32 v79, 0
  v_smfmac_f32_16x16x64_bf16 v[64:67], v[32:35], v[216:223], v6
  v_mov_b64 v[20:21], s[14:15]
  v_smfmac_f32_16x16x64_bf16 v[64:67], v[36:39], v[200:207], v6
  v_mov_b64 v[22:23], s[14:15]
  v_smfmac_f32_16x16x64_bf16 v[64:67], v[40:43], v[192:199], v6
  s_waitcnt lgkmcnt(0)
  s_barrier
  ds_read_b128 v[52:55], v9 offset:12288
  ds_read_b128 v[56:59], v10 offset:12288
  v_smfmac_f32_16x16x64_bf16 v[64:67], v[44:47], v[184:191], v6
  ds_read_b128 v[60:63], v11 offset:12288
  v_smfmac_f32_16x16x64_bf16 v[68:71], v[24:27], v[176:183], v6
  ds_read_b64_tr_b16 v[88:89], v12 offset:0
  ds_read_b64_tr_b16 v[90:91], v12 offset:512
  v_smfmac_f32_16x16x64_bf16 v[68:71], v[28:31], v[168:175], v6
  ds_read_b64_tr_b16 v[92:93], v13 offset:0
  ds_read_b64_tr_b16 v[94:95], v13 offset:512
  v_add_f32 v64, v64, v66
  v_smfmac_f32_16x16x64_bf16 v[68:71], v[32:35], v[160:167], v6
  ds_read_b64_tr_b16 v[96:97], v14 offset:0
  ds_read_b64_tr_b16 v[98:99], v14 offset:512
  v_add_f32 v65, v65, v67
  v_smfmac_f32_16x16x64_bf16 v[68:71], v[36:39], v[144:151], v6
  ds_read_b64_tr_b16 v[100:101], v15 offset:0
  ds_read_b64_tr_b16 v[102:103], v15 offset:512
  s_waitcnt lgkmcnt(8)
  v_cvt_pk_bf16_f32 v66, v64, v65
  v_smfmac_f32_16x16x64_bf16 v[68:71], v[40:43], v[136:143], v6
  v_add_f32 v48, v48, v52
  v_smfmac_f32_16x16x64_bf16 v[68:71], v[44:47], v[128:135], v6
  s_waitcnt lgkmcnt(4)
  v_add_f32 v49, v49, v53
  v_mfma_f32_16x16x32_bf16 v[16:19], v[88:91], v[88:91], 0
  buffer_store_dwordx4 v[88:91], v8, s[4:7], s25 offen sc1
  v_add_f32 v50, v50, v54
  v_add_f32 v51, v51, v55
  v_mfma_f32_16x16x32_bf16 v[16:19], v[92:95], v[92:95], v[16:19]
  s_waitcnt lgkmcnt(0)
  v_add_f32 v56, v56, v60
  v_add_f32 v57, v57, v61
  v_mfma_f32_16x16x32_bf16 v[16:19], v[96:99], v[96:99], v[16:19]
  v_add_f32 v58, v58, v62
  v_add_f32 v59, v59, v63
  v_mfma_f32_16x16x32_bf16 v[16:19], v[100:103], v[100:103], v[16:19]
  v_add_f32 v48, v48, v56
  v_add_f32 v49, v49, v57
  v_add_f32 v50, v50, v58
  v_add_f32 v51, v51, v59
  v_exp_f32 v24, v48
  v_exp_f32 v25, v49
  v_exp_f32 v26, v50
  v_exp_f32 v27, v51
  v_cvt_pk_bf16_f32 v24, v24, v25
  v_mul_f32 v16, s24, v16
  v_cvt_pk_bf16_f32 v25, v26, v27
  v_cndmask_b32 v72, v24, 0, s[18:19]
  v_cndmask_b32 v73, v25, 0, s[18:19]
  v_cndmask_b32 v74, 0, v24, s[18:19]
  v_cndmask_b32 v75, 0, v25, s[18:19]
  v_mul_f32 v17, s24, v17
  v_exp_f32 v28, v16
  v_mfma_f32_16x16x32_bf16 v[60:63], v[72:75], v[20:23], 0
  v_exp_f32 v29, v17
  v_add_f32 v68, v68, v70
  v_mfma_f32_16x16x32_bf16 v[52:55], v[72:75], v[80:83], 0
  s_add_u32 s30, s25, 4096
  v_cvt_pk_bf16_f32 v28, v28, v29
  v_add_f32 v69, v69, v71
  v_mfma_f32_16x16x32_bf16 v[56:59], v[72:75], v[84:87], 0
  v_cndmask_b32 v77, 0, v28, s[18:19]
  v_cndmask_b32 v78, 0, v28, s[18:19]
  v_cvt_pk_bf16_f32 v67, v68, v69
  v_lshrrev_b32 v92, 1, v8
  v_mfma_f32_16x16x16_bf16 v[60:63], v[76:77], v[20:21], v[60:63]
  buffer_store_dwordx2 v[66:67], v92, s[4:7], s30 offen sc1
  v_max3_f32 v7, |v48|, |v49|, |v50|
  v_max_f32 v26, |v16|, |v17|
  v_mfma_f32_16x16x16_bf16 v[52:55], v[78:79], v[66:67], v[52:55]
  v_cndmask_b32 v26, 0, v26, s[18:19]
  v_max3_f32 v7, |v51|, v26, v7
  v_cmp_lt_f32 vcc, 0x42700000, v7
  v_mfma_f32_16x16x16_bf16 v[56:59], v[76:77], v[66:67], v[56:59]
  s_cbranch_vccnz c_fb_53
c_fbr_54:
  s_nop 1
  v_add_f32 v60, v60, v62
  v_add_f32 v61, v61, v63
  v_rcp_f32 v60, v60
  v_rcp_f32 v61, v61
  v_pk_add_f32 v[52:53], v[52:53], v[54:55]
  s_nop 1
  v_pk_add_f32 v[56:57], v[56:57], v[58:59]
  v_pk_mul_f32 v[52:53], v[52:53], v[60:61]
  v_pk_mul_f32 v[56:57], v[56:57], v[60:61]
  v_cvt_pk_bf16_f32 v54, v52, v53
  v_cvt_pk_bf16_f32 v55, v56, v57
  ds_write_b64 v2, v[54:55] offset:4096
  v_mov_b64 v[44:45], 0
  v_mov_b64 v[46:47], 0
  v_mov_b64 v[40:41], 0
  v_mov_b64 v[42:43], 0
  v_mov_b64 v[36:37], 0
  v_mov_b64 v[38:39], 0
  v_mov_b64 v[32:33], 0
  v_mov_b64 v[34:35], 0
  v_mov_b64 v[28:29], 0
  v_mov_b64 v[30:31], 0
  v_mov_b64 v[24:25], 0
  v_mov_b64 v[26:27], 0
  v_mov_b64 v[80:81], 0
  v_mov_b64 v[82:83], 0
  v_mov_b64 v[84:85], 0
  v_mov_b64 v[86:87], 0
  s_waitcnt lgkmcnt(0)
  s_barrier
  ds_read_b64_tr_b16 v[72:73], v3 offset:4096
  ds_read_b64_tr_b16 v[74:75], v3 offset:5120
  ds_read_b64_tr_b16 v[76:77], v3 offset:6144
  ds_read_b64_tr_b16 v[78:79], v3 offset:7168
  s_and_b32 s3, s21, 1
  s_add_u32 s21, s21, 1
  s_add_u32 s22, s22, 1
  s_and_b32 s42, s21, 3
  s_lshl_b32 s42, s42, 13
  s_cmp_eq_u32 s22, 64
  s_cbranch_scc1 c_last_56
  s_waitcnt lgkmcnt(2)
  v_smfmac_f32_16x16x64_bf16 v[44:47], v[72:75], a[248:255], v6
  ds_read_b128 v[16:19], v8 offset:40960
  v_smfmac_f32_16x16x64_bf16 v[40:43], v[72:75], a[232:239], v6
  s_waitcnt lgkmcnt(1)
  ds_read_b128 v[20:23], v8 offset:45056
  v_smfmac_f32_16x16x64_bf16 v[44:47], v[76:79], a[240:247], v6
  ds_read_b128 v[88:91], v8 offset:49152
  v_smfmac_f32_16x16x64_bf16 v[40:43], v[76:79], a[224:231], v6
  ds_read_b128 v[92:95], v8 offset:53248
  v_smfmac_f32_16x16x64_bf16 v[36:39], v[72:75], a[216:223], v6
  ds_read_b128 v[96:99], v8 offset:57344
  v_add_f32 v44, v44, v46
  v_add_f32 v45, v45, v47
  v_smfmac_f32_16x16x64_bf16 v[36:39], v[76:79], a[208:215], v6
  ds_read_b128 v[100:103], v8 offset:61440
  v_cvt_pk_bf16_f32 v48, v44, v45
  v_and_or_b32 v48, v48, -2, s3
  v_smfmac_f32_16x16x64_bf16 v[32:35], v[72:75], a[200:207], v6
  v_add_f32 v40, v40, v42
  v_add_f32 v41, v41, v43
  v_smfmac_f32_16x16x64_bf16 v[32:35], v[76:79], a[192:199], v6
  v_cvt_pk_bf16_f32 v49, v40, v41
  v_add_f32 v36, v36, v38
  v_smfmac_f32_16x16x64_bf16 v[28:31], v[72:75], a[184:191], v6
  v_add_f32 v37, v37, v39
  v_cvt_pk_bf16_f32 v50, v36, v37
  v_smfmac_f32_16x16x64_bf16 v[28:31], v[76:79], a[176:183], v6
  v_add_f32 v32, v32, v34
  v_add_f32 v33, v33, v35
  v_smfmac_f32_16x16x64_bf16 v[24:27], v[72:75], v[104:111], v6
  v_cvt_pk_bf16_f32 v51, v32, v33
  v_smfmac_f32_16x16x64_bf16 v[24:27], v[76:79], v[112:119], v6
  buffer_store_dwordx4 v[48:51], v4, s[4:7], s40 offen sc1
  v_add_f32 v28, v28, v30
  v_add_f32 v29, v29, v31
  v_smfmac_f32_16x16x64_bf16 v[80:83], v[72:75], v[120:127], v6
  s_waitcnt lgkmcnt(0)
  v_cvt_pk_bf16_f32 v52, v28, v29
  v_and_or_b32 v52, v52, -2, s3
  v_smfmac_f32_16x16x64_bf16 v[80:83], v[76:79], v[16:23], v6
  v_add_f32 v24, v24, v26
  v_add_f32 v25, v25, v27
  v_smfmac_f32_16x16x64_bf16 v[84:87], v[72:75], v[88:95], v6
  v_cvt_pk_bf16_f32 v53, v24, v25
  v_smfmac_f32_16x16x64_bf16 v[84:87], v[76:79], v[96:103], v6
  v_add_f32 v80, v80, v82
  v_add_f32 v81, v81, v83
  v_cvt_pk_bf16_f32 v54, v80, v81
  s_nop 0
  s_nop 3
  v_pk_add_f32 v[84:85], v[84:85], v[86:87]
  v_cvt_pk_bf16_f32 v55, v84, v85
  buffer_store_dwordx4 v[52:55], v4, s[4:7], s41 offen sc1
  s_add_u32 s42, s42, s62
  s_add_u32 s43, s42, 4096
  s_add_u32 s23, s23, 524288
  s_add_u32 s25, s25, 262144
  s_add_u32 s63, s63, 4096
  s_add_u32 s64, s64, 2048
  s_andn2_b32 s64, s64, s2
  s_add_u32 s97, s97, 8192
  s_add_u32 s92, s63, s20
  s_cmp_lg_u32 s17, 0
  s_cbranch_scc1 c_oth_70
  s_mov_b32 s28, 0
  s_add_u32 s46, s46, 1
  v_mov_b64 v[64:65], -1
  s_xor_b32 s34, s42, 16384
  buffer_store_dwordx2 v[64:65], v5, s[4:7], s34 offen sc1
  s_mov_b32 vcc_lo, 0xaaaaaaaa
  s_mov_b32 vcc_hi, 0xaaaaaaaa
  v_mov_b32 v7, 0x3f80
  v_cndmask_b32 v7, v7, 1.0, vcc
  s_mov_b32 vcc_lo, 0x30003
  s_mov_b32 vcc_hi, 0x30003
  v_cndmask_b32 v68, 0, v7, vcc
  s_mov_b32 vcc_lo, 0xc000c
  s_mov_b32 vcc_hi, 0xc000c
  v_cndmask_b32 v69, 0, v7, vcc
  s_mov_b32 vcc_lo, 0x300030
  s_mov_b32 vcc_hi, 0x300030
  v_cndmask_b32 v70, 0, v7, vcc
  s_mov_b32 vcc_lo, 0xc000c0
  s_mov_b32 vcc_hi, 0xc000c0
  v_cndmask_b32 v71, 0, v7, vcc
  ds_read_b128 v[104:107], v1 offset:14336
  ds_read_b128 v[108:111], v1 offset:15360
  s_waitcnt lgkmcnt(0)
  ds_read_b128 v[112:115], v1 offset:16384
  ds_read_b128 v[116:119], v1 offset:17408
  ds_read_b128 v[120:123], v1 offset:18432
  ds_read_b128 v[124:127], v1 offset:19456
  s_waitcnt lgkmcnt(0)
c_erl_72:
  buffer_load_dwordx4 v[16:19], v0, s[4:7], s38 offen offset:0 sc1
  buffer_load_dwordx4 v[20:23], v0, s[4:7], s38 offen offset:1024 sc1
  buffer_load_dwordx4 v[24:27], v0, s[4:7], s38 offen offset:2048 sc1
  buffer_load_dwordx4 v[28:31], v0, s[4:7], s38 offen offset:3072 sc1
  buffer_load_dwordx4 v[32:35], v0, s[4:7], s39 offen offset:0 sc1
  buffer_load_dwordx4 v[36:39], v0, s[4:7], s39 offen offset:1024 sc1
  buffer_load_dwordx4 v[40:43], v0, s[4:7], s39 offen offset:2048 sc1
  buffer_load_dwordx4 v[44:47], v0, s[4:7], s39 offen offset:3072 sc1
  buffer_load_dwordx4 v[72:75], v0, s[4:7], s38 offen offset:0 sc1
  buffer_load_dwordx4 v[76:79], v0, s[4:7], s38 offen offset:1024 sc1
  buffer_load_dwordx4 v[80:83], v0, s[4:7], s38 offen offset:2048 sc1
  buffer_load_dwordx4 v[84:87], v0, s[4:7], s38 offen offset:3072 sc1
  buffer_load_dwordx4 v[88:91], v0, s[4:7], s39 offen offset:0 sc1
  buffer_load_dwordx4 v[92:95], v0, s[4:7], s39 offen offset:1024 sc1
  buffer_load_dwordx4 v[96:99], v0, s[4:7], s39 offen offset:2048 sc1
  buffer_load_dwordx4 v[100:103], v0, s[4:7], s39 offen offset:3072 sc1
  s_buffer_load_dword s65, s[4:7], s63
  s_waitcnt vmcnt(15)
  v_mfma_f32_16x16x32_bf16 v[64:67], v[16:19], v[68:71], 0
  v_xor_b32 v7, s3, v16
  s_waitcnt vmcnt(14)
  v_mfma_f32_16x16x32_bf16 v[64:67], v[20:23], v[68:71], v[64:67]
  v_bitop3_b32 v7, v7, v20, s3 bitop3:0xf6
  s_waitcnt vmcnt(13)
  v_mfma_f32_16x16x32_bf16 v[64:67], v[24:27], v[68:71], v[64:67]
  v_bitop3_b32 v7, v7, v24, s3 bitop3:0xf6
  s_waitcnt vmcnt(12)
  v_mfma_f32_16x16x32_bf16 v[64:67], v[28:31], v[68:71], v[64:67]
  v_bitop3_b32 v7, v7, v28, s3 bitop3:0xf6
  s_waitcnt vmcnt(11)
  v_mfma_f32_16x16x32_bf16 v[64:67], v[32:35], v[68:71], v[64:67]
  v_bitop3_b32 v7, v7, v32, s3 bitop3:0xf6
  s_waitcnt vmcnt(10)
  v_mfma_f32_16x16x32_bf16 v[64:67], v[36:39], v[68:71], v[64:67]
  v_bitop3_b32 v7, v7, v36, s3 bitop3:0xf6
  s_waitcnt vmcnt(9)
  v_mfma_f32_16x16x32_bf16 v[64:67], v[40:43], v[68:71], v[64:67]
  v_bitop3_b32 v7, v7, v40, s3 bitop3:0xf6
  s_waitcnt vmcnt(8)
  v_mfma_f32_16x16x32_bf16 v[64:67], v[44:47], v[68:71], v[64:67]
  v_bitop3_b32 v7, v7, v44, s3 bitop3:0xf6
  v_and_b32 v7, 1, v7
  v_cmp_ne_u32 vcc, 0, v7
  v_mov_b32 v7, 0
  v_mov_b32 v7, 0
  s_cbranch_vccnz c_p1r_71
c_publ_74:
  s_nop 1
  s_nop 0
  v_cvt_pk_bf16_f32 v64, v64, v65
  v_cvt_pk_bf16_f32 v65, v66, v67
  v_min_u32 v64, -2, v64
  v_min_u32 v65, -2, v65
  buffer_store_dwordx2 v[64:65], v5, s[4:7], s42 offen sc1
  s_waitcnt vmcnt(1)
  ds_read_b128 v[24:27], v1 offset:0
  ds_read_b128 v[28:31], v1 offset:1024
  ds_read_b128 v[32:35], v1 offset:2048
  ds_read_b128 v[36:39], v1 offset:3072
  ds_read_b128 v[40:43], v1 offset:4096
  ds_read_b128 v[44:47], v1 offset:5120
  ds_read_b128 v[72:75], v1 offset:6144
  ds_read_b128 v[76:79], v1 offset:7168
  ds_read_b128 v[80:83], v1 offset:8192
  ds_read_b128 v[84:87], v1 offset:9216
  ds_read_b128 v[88:91], v1 offset:10240
  ds_read_b128 v[92:95], v1 offset:11264
  ds_read_b128 v[96:99], v1 offset:12288
  ds_read_b128 v[100:103], v1 offset:13312
c_hop2_52:
  s_barrier
  s_cmp_le_u32 s96, s23
  s_cbranch_scc1 c_loop_49
  s_cmp_lg_u32 s96, 268435456
  s_cbranch_scc1 c_fk0_75
  buffer_store_dwordx2 v[64:65], v5, s[4:7], s97 offen sc1
  s_mov_b32 s29, 0
  s_sub_u32 s92, s63, 4096
  s_sub_u32 s96, s23, 524288
  s_mov_b32 s95, 0
c_gw_76:
  buffer_load_dword v7, off, s[4:7], s92 sc1
  s_add_u32 s29, s29, 1
  s_cmp_gt_u32 s29, 1048576
  s_cbranch_scc1 c_fail_55
  s_waitcnt vmcnt(0) lgkmcnt(0)
  v_readfirstlane_b32 s65, v7
  s_cmp_eq_u32 s65, 0
  s_cbranch_scc1 c_gw_76
  s_and_b32 s65, s65, s93
  s_cbranch_scc1 c_kvx_78
  s_mov_b32 s95, 1
  s_add_u32 s96, s96, 33554432
  s_add_u32 s92, s92, 262144
c_kvw_77:
  buffer_load_dword v7, off, s[4:7], s92 sc1
  s_add_u32 s29, s29, 1
  s_cmp_gt_u32 s29, 1048576
  s_cbranch_scc1 c_fail_55
  s_waitcnt vmcnt(0) lgkmcnt(0)
  v_readfirstlane_b32 s65, v7
  s_cmp_eq_u32 s65, 0
  s_cbranch_scc1 c_kvw_77
c_kvx_78:
  buffer_load_dword v7, off, s[4:7], s63 sc1
  buffer_load_dwordx4 v0, s[4:7], s96 offen offset:0  lds
  buffer_load_dwordx4 v0, s[4:7], s96 offen offset:1024  lds
  buffer_load_dwordx4 v0, s[4:7], s96 offen offset:2048  lds
  buffer_load_dwordx4 v0, s[4:7], s96 offen offset:3072  lds
  s_waitcnt vmcnt(4)
  v_readfirstlane_b32 s65, v7
  s_mov_b32 s94, 0
  s_cmp_eq_u32 s95, 0
  s_cbranch_scc1 c_loop_49
c_fk0_75:
  s_mov_b32 s29, 0
c_fk_79:
  buffer_load_dwordx4 v[16:19], v8, s[4:7], s42 offen sc1
  buffer_load_dwordx4 v[20:23], v8, s[4:7], s43 offen sc1
  s_add_u32 s29, s29, 1
  s_cmp_gt_u32 s29, 1048576
  s_cbranch_scc1 c_fail_55
  s_waitcnt vmcnt(0)
  v_max3_u32 v7, v16, v17, v18
  v_max3_u32 v7, v19, v20, v7
  v_max3_u32 v7, v21, v22, v7
  v_max_u32 v7, v7, v23
  v_cmp_eq_u32 vcc, -1, v7
  s_cbranch_vccnz c_fk_79
c_fk1_80:
  s_lshl_b32 s42, s22, 13
  s_add_u32 s42, s42, 245891072
  s_add_u32 s43, s42, 4096
  s_mov_b32 s95, 0
  s_branch c_loop_49
c_xb_64:
  s_cmp_lg_u32 s93, 1
  s_cbranch_scc1 c_xr_65
  s_cmp_ge_u32 s22, 63
  s_cbranch_scc1 c_xr_65
c_xp_81:
  s_cmp_lg_u32 s65, 0
  s_cbranch_scc1 c_xs_82
  buffer_load_dword v7, off, s[4:7], s63 sc1
  s_add_u32 s29, s29, 1
  s_cmp_gt_u32 s29, 1048576
  s_cbranch_scc1 c_fail_55
  s_waitcnt vmcnt(0)
  v_readfirstlane_b32 s65, v7
  s_branch c_xp_81
c_xs_82:
  s_cmp_eq_u32 s65, 1
  s_cbranch_scc1 c_xr_65
  s_mov_b32 s29, 0
c_xw_83:
  buffer_load_dwordx4 v[16:19], v8, s[4:7], s42 offen sc1
  buffer_load_dwordx4 v[20:23], v8, s[4:7], s43 offen sc1
  s_add_u32 s29, s29, 1
  s_cmp_gt_u32 s29, 1048576
  s_cbranch_scc1 c_fail_55
  s_waitcnt vmcnt(0)
  v_max3_u32 v7, v16, v17, v18
  v_max3_u32 v7, v19, v20, v7
  v_max3_u32 v7, v21, v22, v7
  v_max_u32 v7, v7, v23
  v_cmp_eq_u32 vcc, -1, v7
  s_cbranch_vccnz c_xw_83
  v_mov_b32 v7, 1
  s_barrier
  s_mov_b64 exec, 1
  buffer_store_dword v7, off, s[4:7], s64 sc1
  s_mov_b64 exec, -1
  s_add_u32 s22, s22, 1
  s_add_u32 s23, s23, 524288
  s_add_u32 s25, s25, 262144
  s_add_u32 s63, s63, 4096
  s_add_u32 s64, s64, 2048
  s_andn2_b32 s64, s64, s2
  s_mov_b32 s29, 0
  s_sub_u32 s92, s63, 4096
  s_sub_u32 s96, s23, 524288
  s_mov_b32 s95, 0
  s_mov_b32 s95, 1
  s_add_u32 s96, s96, 33554432
  s_add_u32 s92, s92, 262144
c_kvw_85:
  buffer_load_dword v7, off, s[4:7], s92 sc1
  s_add_u32 s29, s29, 1
  s_cmp_gt_u32 s29, 1048576
  s_cbranch_scc1 c_fail_55
  s_waitcnt vmcnt(0) lgkmcnt(0)
  v_readfirstlane_b32 s65, v7
  s_cmp_eq_u32 s65, 0
  s_cbranch_scc1 c_kvw_85
c_kvx_86:
  buffer_load_dword v7, off, s[4:7], s63 sc1
  buffer_load_dwordx4 v0, s[4:7], s96 offen offset:0  lds
  buffer_load_dwordx4 v0, s[4:7], s96 offen offset:1024  lds
  buffer_load_dwordx4 v0, s[4:7], s96 offen offset:2048  lds
  buffer_load_dwordx4 v0, s[4:7], s96 offen offset:3072  lds
  s_waitcnt vmcnt(4)
  v_readfirstlane_b32 s65, v7
  s_mov_b32 s94, 0
  s_branch c_fk1_80
c_last_56:
  s_add_u32 s64, s64, 2048
  v_mov_b32 v7, 1
  s_waitcnt vmcnt(0)
  s_barrier
  s_mov_b64 exec, 1
  buffer_store_dword v7, off, s[4:7], s64 sc1
  s_mov_b64 exec, -1
  s_branch L_chdone
c_oth_70:
  s_buffer_load_dword s65, s[4:7], s63
  ds_read_b128 v[24:27], v1 offset:0
  ds_read_b128 v[28:31], v1 offset:1024
  ds_read_b128 v[32:35], v1 offset:2048
  ds_read_b128 v[36:39], v1 offset:3072
  ds_read_b128 v[40:43], v1 offset:4096
  ds_read_b128 v[44:47], v1 offset:5120
  ds_read_b128 v[72:75], v1 offset:6144
  ds_read_b128 v[76:79], v1 offset:7168
  ds_read_b128 v[80:83], v1 offset:8192
  ds_read_b128 v[84:87], v1 offset:9216
  ds_read_b128 v[88:91], v1 offset:10240
  ds_read_b128 v[92:95], v1 offset:11264
  ds_read_b128 v[96:99], v1 offset:12288
  ds_read_b128 v[100:103], v1 offset:13312
  ds_read_b128 v[104:107], v1 offset:14336
  ds_read_b128 v[108:111], v1 offset:15360
  ds_read_b128 v[112:115], v1 offset:16384
  ds_read_b128 v[116:119], v1 offset:17408
  ds_read_b128 v[120:123], v1 offset:18432
  ds_read_b128 v[124:127], v1 offset:19456
  s_branch c_hop2_52
c_p1r_71:
  s_waitcnt vmcnt(7)
  s_nop 0
  v_mfma_f32_16x16x32_bf16 v[64:67], v[72:75], v[68:71], 0
  v_xor_b32 v7, s3, v72
  s_waitcnt vmcnt(6)
  v_mfma_f32_16x16x32_bf16 v[64:67], v[76:79], v[68:71], v[64:67]
  v_bitop3_b32 v7, v7, v76, s3 bitop3:0xf6
  s_waitcnt vmcnt(5)
  v_mfma_f32_16x16x32_bf16 v[64:67], v[80:83], v[68:71], v[64:67]
  v_bitop3_b32 v7, v7, v80, s3 bitop3:0xf6
  s_waitcnt vmcnt(4)
  v_mfma_f32_16x16x32_bf16 v[64:67], v[84:87], v[68:71], v[64:67]
  v_bitop3_b32 v7, v7, v84, s3 bitop3:0xf6
  s_waitcnt vmcnt(3)
  v_mfma_f32_16x16x32_bf16 v[64:67], v[88:91], v[68:71], v[64:67]
  v_bitop3_b32 v7, v7, v88, s3 bitop3:0xf6
  s_waitcnt vmcnt(2)
  v_mfma_f32_16x16x32_bf16 v[64:67], v[92:95], v[68:71], v[64:67]
  v_bitop3_b32 v7, v7, v92, s3 bitop3:0xf6
  s_waitcnt vmcnt(1)
  v_mfma_f32_16x16x32_bf16 v[64:67], v[96:99], v[68:71], v[64:67]
  v_bitop3_b32 v7, v7, v96, s3 bitop3:0xf6
  s_waitcnt vmcnt(0)
  v_mfma_f32_16x16x32_bf16 v[64:67], v[100:103], v[68:71], v[64:67]
  v_bitop3_b32 v7, v7, v100, s3 bitop3:0xf6
  v_and_b32 v7, 1, v7
  v_cmp_ne_u32 vcc, 0, v7
  s_add_u32 s46, s46, 1
  s_cbranch_vccz c_publ_74
  buffer_load_dwordx4 v[72:75], v0, s[4:7], s38 offen offset:0 sc1
  buffer_load_dwordx4 v[76:79], v0, s[4:7], s38 offen offset:1024 sc1
  buffer_load_dwordx4 v[80:83], v0, s[4:7], s38 offen offset:2048 sc1
  buffer_load_dwordx4 v[84:87], v0, s[4:7], s38 offen offset:3072 sc1
  buffer_load_dwordx4 v[88:91], v0, s[4:7], s39 offen offset:0 sc1
  buffer_load_dwordx4 v[92:95], v0, s[4:7], s39 offen offset:1024 sc1
  buffer_load_dwordx4 v[96:99], v0, s[4:7], s39 offen offset:2048 sc1
  buffer_load_dwordx4 v[100:103], v0, s[4:7], s39 offen offset:3072 sc1
  s_add_u32 s28, s28, 1
  s_cmp_gt_u32 s28, 1048576
  s_cbranch_scc0 c_p1r_71
  s_branch c_fail_55
c_retry_50:
  v_mov_b64 v[48:49], 0
  v_mov_b64 v[50:51], 0
  s_nop 0
  v_mov_b64 v[52:53], 0
  v_mov_b64 v[54:55], 0
  s_nop 1
  v_mov_b64 v[56:57], 0
  v_mov_b64 v[58:59], 0
c_rl_87:
  buffer_load_dwordx4 v[16:19], v8, s[4:7], s42 offen sc1
  buffer_load_dwordx4 v[20:23], v8, s[4:7], s43 offen sc1
  s_add_u32 s28, s28, 1
  s_add_u32 s47, s47, 1
  s_cmp_gt_u32 s28, 1048576
  s_cbranch_scc1 c_fail_55
  s_waitcnt vmcnt(2)
  v_max3_u32 v7, v16, v17, v18
  v_max3_u32 v7, v19, v20, v7
  v_max3_u32 v7, v21, v22, v7
  v_max_u32 v7, v7, v23
  v_cmp_eq_u32 vcc, -1, v7
  s_cbranch_vccnz c_rl_87
  ds_write_b128 v8, v[16:19] offset:4096
  v_smfmac_f32_16x16x64_bf16 v[48:51], v[16:19], v[24:31], v6
  ds_write_b128 v8, v[20:23] offset:8192
  v_smfmac_f32_16x16x64_bf16 v[52:55], v[16:19], v[32:39], v6
  v_smfmac_f32_16x16x64_bf16 v[56:59], v[16:19], v[40:47], v6
  s_branch c_got_51
c_fb_53:
  v_max3_f32 v7, v48, v49, v50
  v_max_f32 v7, v51, v7
  s_mov_b64 exec, s[18:19]
  v_max3_f32 v7, v16, v17, v7
  s_mov_b64 exec, -1
  s_nop 0
  v_max_f32_dpp v7, v7, v7 quad_perm:[2,3,0,1] row_mask:0xf bank_mask:0xf
  v_mov_b32 v24, v7
  s_nop 0
  s_nop 0
  v_permlane16_swap_b32 v7, v24
  v_max_f32 v7, v7, v24
  v_mov_b32 v24, v7
  s_nop 0
  s_nop 0
  v_permlane32_swap_b32 v7, v24
  v_max_f32 v7, v7, v24
  v_sub_f32 v24, v48, v7
  v_sub_f32 v25, v49, v7
  v_sub_f32 v26, v50, v7
  v_sub_f32 v27, v51, v7
  v_sub_f32 v28, v16, v7
  v_sub_f32 v29, v17, v7
  v_exp_f32 v24, v24
  v_exp_f32 v25, v25
  v_exp_f32 v26, v26
  v_exp_f32 v27, v27
  v_exp_f32 v28, v28
  v_exp_f32 v29, v29
  v_cvt_pk_bf16_f32 v24, v24, v25
  v_cvt_pk_bf16_f32 v25, v26, v27
  v_cvt_pk_bf16_f32 v28, v28, v29
  v_cndmask_b32 v72, v24, 0, s[18:19]
  v_cndmask_b32 v73, v25, 0, s[18:19]
  v_cndmask_b32 v74, 0, v24, s[18:19]
  v_cndmask_b32 v75, 0, v25, s[18:19]
  v_cndmask_b32 v77, 0, v28, s[18:19]
  v_cndmask_b32 v78, 0, v28, s[18:19]
  v_mfma_f32_16x16x32_bf16 v[60:63], v[72:75], v[20:23], 0
  v_mfma_f32_16x16x32_bf16 v[52:55], v[72:75], v[80:83], 0
  v_mfma_f32_16x16x32_bf16 v[56:59], v[72:75], v[84:87], 0
  v_mfma_f32_16x16x16_bf16 v[60:63], v[76:77], v[20:21], v[60:63]
  v_mfma_f32_16x16x16_bf16 v[52:55], v[78:79], v[66:67], v[52:55]
  s_nop 2
  v_mfma_f32_16x16x16_bf16 v[56:59], v[76:77], v[66:67], v[56:59]
  s_branch c_fbr_54
c_fail_55:
  s_endpgm
L_chdone:
  s_cmp_lg_u32 s91, 0
  s_cbranch_scc1 L_end
  s_lshr_b32 s91, s90, 4
  s_add_u32 s91, s91, 7
  v_lshrrev_b32 v0, 4, v0
  s_waitcnt vmcnt(0) lgkmcnt(0)
  v_mbcnt_lo_u32_b32 v20, -1, 0
  v_and_b32 v20, 3, v20
  v_add_lshl_u32 v20, v20, 0, 2
  s_mov_b32 s26, 0
g_wt_88:
  global_load_dword v21, v20, s[12:13] offset:128 sc1
  s_add_u32 s26, s26, 1
  s_cmp_gt_u32 s26, 1048576
  s_cbranch_scc1 L_end
  s_waitcnt vmcnt(0)
  v_cmp_eq_u32 vcc, 0, v21
  v_readfirstlane_b32 s27, v21
  s_cbranch_vccnz g_wt_88
  s_mov_b32 s89, s27
  s_branch L_o
L_qkv:
  s_mul_i32 s26, s91, 15
  s_add_u32 s26, s26, s90
  s_sub_u32 s26, s26, 61
  s_add_u32 s27, s91, 89
  s_cmp_eq_u32 s90, 31
  s_cselect_b32 s26, s27, s26
  s_add_u32 s27, s90, 60
  s_cmp_eq_u32 s91, 7
  s_cselect_b32 s26, s27, s26
  s_mul_i32 s16, s26, 171
  s_lshr_b32 s16, s16, 9
  s_mul_i32 s27, s16, 3
  s_sub_u32 s60, s26, s27
  s_add_u32 s16, s16, 4
  s_and_b32 s16, s16, 31
  v_and_b32 v19, 63, v0
  v_and_b32 v6, 15, v19
  v_lshrrev_b32 v7, 4, v19
  v_lshlrev_b32 v1, 2, v19
  v_lshlrev_b32 v0, 4, v19
  v_lshlrev_b32 v9, 7, v19
  s_mov_b32 s24, 0x3e0293ee
  s_lshl_b32 s57, s16, 2
  s_add_u32 s57, s57, s17
  v_and_b32 v24, 1, v7
  v_lshlrev_b32 v24, 10, v24
  v_lshl_add_u32 v24, v6, 4, v24
  v_lshrrev_b32 v25, 1, v7
  v_lshl_add_u32 v8, v25, 8, v24
  v_lshrrev_b32 v96, 9, v0
  v_lshlrev_b32 v96, 4, v96
  v_and_b32 v97, 0xf0, v0
  v_xor_b32 v96, v96, v97
  v_and_b32 v97, 0x1f0, v0
  v_lshl_add_u32 v96, v97, 6, v96
  v_xor_b32 v120, 0, v96
  v_xor_b32 v121, 32, v96
  v_xor_b32 v122, 64, v96
  v_xor_b32 v123, 96, v96
  v_xor_b32 v124, 128, v96
  v_xor_b32 v125, 160, v96
  v_xor_b32 v126, 192, v96
  v_xor_b32 v127, 224, v96
  s_and_b32 s26, s17, 1
  s_lshl_b32 s26, s26, 7
  v_xor_b32 v96, s26, v0
  v_xor_b32 v12, 0, v96
  v_xor_b32 v13, 16, v96
  v_xor_b32 v14, 32, v96
  v_xor_b32 v15, 48, v96
  v_xor_b32 v16, 64, v96
  v_xor_b32 v17, 80, v96
  v_xor_b32 v18, 96, v96
  v_xor_b32 v19, 112, v96
  s_lshl_b32 s26, s17, 2
  s_add_u32 s26, s26, 162816
  v_lshrrev_b32 v24, 7, v0
  v_lshl_add_u32 v118, v24, 4, s26
  v_and_b32 v24, 48, v0
  v_add_u32 v119, 162816, v24
  v_lshrrev_b32 v25, 8, v0
  v_and_b32 v20, 0xf0, v0
  v_lshlrev_b32 v21, 6, v25
  v_xor_b32 v20, v20, v21
  v_lshl_add_u32 v20, v25, 13, v20
  v_xor_b32 v21, 32, v20
  s_load_dwordx2 s[64:65], s[0:1], 24
  s_load_dwordx2 s[68:69], s[0:1], 32
  s_load_dwordx2 s[8:9], s[0:1], 16
  s_mov_b32 s10, 4194304
  s_mov_b32 s11, 0x20000
  s_mov_b32 s66, 4194304
  s_mov_b32 s67, 0x20000
  s_mov_b32 s70, 4194304
  s_mov_b32 s71, 0x20000
  v_lshrrev_b32 v25, 2, v6
  v_lshrrev_b32 v26, 1, v7
  v_lshl_add_u32 v27, v26, 3, v25
  v_lshlrev_b32 v27, 8, v27
  v_lshl_add_u32 v26, v25, 1, v26
  v_and_b32 v25, 1, v7
  v_xor_b32 v26, v26, v25
  s_lshl_b32 s26, s17, 1
  v_xor_b32 v26, s26, v26
  v_lshl_add_u32 v27, v26, 5, v27
  v_and_b32 v25, 3, v6
  v_lshl_add_u32 v22, v25, 3, v27
  v_add_u32 v23, 65536, v22
  v_add_u32 v24, 131072, v22
  s_lshl_b32 s28, s17, 13
  s_lshl_b32 s26, s17, 18
  s_lshl_b32 s27, s16, 8
  s_add_u32 s26, s26, s27
  s_waitcnt lgkmcnt(0)
  s_cmp_eq_u32 s60, 1
  s_cbranch_scc1 q_ld_90
  s_cmp_eq_u32 s60, 2
  s_cbranch_scc1 q_ld_91
q_ld_89:
  s_add_u32 s27, s26, 0
  s_add_u32 m0, s28, 0
  s_nop 0
  buffer_load_dwordx4 v20, s[64:67], s27 offen lds
  s_add_u32 m0, s28, 1024
  s_add_u32 s27, s27, 32768
  buffer_load_dwordx4 v20, s[64:67], s27 offen lds
  s_add_u32 m0, s28, 2048
  s_add_u32 s27, s27, 32768
  buffer_load_dwordx4 v21, s[64:67], s27 offen lds
  s_add_u32 m0, s28, 3072
  s_add_u32 s27, s27, 32768
  buffer_load_dwordx4 v21, s[64:67], s27 offen lds
  s_add_u32 m0, s28, 4096
  s_add_u32 s27, s27, 32768
  buffer_load_dwordx4 v20, s[64:67], s27 offen lds
  s_add_u32 m0, s28, 5120
  s_add_u32 s27, s27, 32768
  buffer_load_dwordx4 v20, s[64:67], s27 offen lds
  s_add_u32 m0, s28, 6144
  s_add_u32 s27, s27, 32768
  buffer_load_dwordx4 v21, s[64:67], s27 offen lds
  s_add_u32 m0, s28, 7168
  s_add_u32 s27, s27, 32768
  buffer_load_dwordx4 v21, s[64:67], s27 offen lds
  s_add_u32 s27, s26, 1048576
  s_add_u32 m0, s28, 32768
  s_nop 0
  buffer_load_dwordx4 v20, s[64:67], s27 offen lds
  s_add_u32 m0, s28, 33792
  s_add_u32 s27, s27, 32768
  buffer_load_dwordx4 v20, s[64:67], s27 offen lds
  s_add_u32 m0, s28, 34816
  s_add_u32 s27, s27, 32768
  buffer_load_dwordx4 v21, s[64:67], s27 offen lds
  s_add_u32 m0, s28, 35840
  s_add_u32 s27, s27, 32768
  buffer_load_dwordx4 v21, s[64:67], s27 offen lds
  s_add_u32 m0, s28, 36864
  s_add_u32 s27, s27, 32768
  buffer_load_dwordx4 v20, s[64:67], s27 offen lds
  s_add_u32 m0, s28, 37888
  s_add_u32 s27, s27, 32768
  buffer_load_dwordx4 v20, s[64:67], s27 offen lds
  s_add_u32 m0, s28, 38912
  s_add_u32 s27, s27, 32768
  buffer_load_dwordx4 v21, s[64:67], s27 offen lds
  s_add_u32 m0, s28, 39936
  s_add_u32 s27, s27, 32768
  buffer_load_dwordx4 v21, s[64:67], s27 offen lds
  s_add_u32 s27, s26, 2097152
  s_add_u32 m0, s28, 65536
  s_nop 0
  buffer_load_dwordx4 v20, s[64:67], s27 offen lds
  s_add_u32 m0, s28, 66560
  s_add_u32 s27, s27, 32768
  buffer_load_dwordx4 v20, s[64:67], s27 offen lds
  s_add_u32 m0, s28, 67584
  s_add_u32 s27, s27, 32768
  buffer_load_dwordx4 v21, s[64:67], s27 offen lds
  s_add_u32 m0, s28, 68608
  s_add_u32 s27, s27, 32768
  buffer_load_dwordx4 v21, s[64:67], s27 offen lds
  s_add_u32 m0, s28, 69632
  s_add_u32 s27, s27, 32768
  buffer_load_dwordx4 v20, s[64:67], s27 offen lds
  s_add_u32 m0, s28, 70656
  s_add_u32 s27, s27, 32768
  buffer_load_dwordx4 v20, s[64:67], s27 offen lds
  s_add_u32 m0, s28, 71680
  s_add_u32 s27, s27, 32768
  buffer_load_dwordx4 v21, s[64:67], s27 offen lds
  s_add_u32 m0, s28, 72704
  s_add_u32 s27, s27, 32768
  buffer_load_dwordx4 v21, s[64:67], s27 offen lds
  s_load_dwordx2 s[4:5], s[0:1], 112
  s_load_dwordx2 s[12:13], s[0:1], 104
  s_waitcnt vmcnt(16)
  s_barrier
  s_add_u32 s27, s26, 3145728
  s_add_u32 m0, s28, 98304
  s_nop 0
  buffer_load_dwordx4 v20, s[64:67], s27 offen lds
  s_add_u32 m0, s28, 99328
  s_add_u32 s27, s27, 32768
  buffer_load_dwordx4 v20, s[64:67], s27 offen lds
  s_add_u32 m0, s28, 100352
  s_add_u32 s27, s27, 32768
  buffer_load_dwordx4 v21, s[64:67], s27 offen lds
  s_add_u32 m0, s28, 101376
  s_add_u32 s27, s27, 32768
  buffer_load_dwordx4 v21, s[64:67], s27 offen lds
  s_add_u32 m0, s28, 102400
  s_add_u32 s27, s27, 32768
  buffer_load_dwordx4 v20, s[64:67], s27 offen lds
  s_add_u32 m0, s28, 103424
  s_add_u32 s27, s27, 32768
  buffer_load_dwordx4 v20, s[64:67], s27 offen lds
  s_add_u32 m0, s28, 104448
  s_add_u32 s27, s27, 32768
  buffer_load_dwordx4 v21, s[64:67], s27 offen lds
  s_add_u32 m0, s28, 105472
  s_add_u32 s27, s27, 32768
  buffer_load_dwordx4 v21, s[64:67], s27 offen lds
  ds_read_b64_tr_b16 v[128:129], v22 offset:0
  ds_read_b64_tr_b16 v[130:131], v22 offset:1024
  ds_read_b64_tr_b16 v[132:133], v22 offset:4096
  ds_read_b64_tr_b16 v[134:135], v22 offset:5120
  ds_read_b64_tr_b16 v[136:137], v22 offset:8192
  ds_read_b64_tr_b16 v[138:139], v22 offset:9216
  ds_read_b64_tr_b16 v[140:141], v22 offset:12288
  ds_read_b64_tr_b16 v[142:143], v22 offset:13312
  ds_read_b64_tr_b16 v[144:145], v22 offset:16384
  ds_read_b64_tr_b16 v[146:147], v22 offset:17408
  ds_read_b64_tr_b16 v[148:149], v22 offset:20480
  ds_read_b64_tr_b16 v[150:151], v22 offset:21504
  ds_read_b64_tr_b16 v[152:153], v22 offset:24576
  ds_read_b64_tr_b16 v[154:155], v22 offset:25600
  ds_read_b64_tr_b16 v[156:157], v22 offset:28672
  ds_read_b64_tr_b16 v[158:159], v22 offset:29696
  s_waitcnt lgkmcnt(0)
  s_waitcnt vmcnt(16)
  s_barrier
  s_add_u32 s27, s26, 0
  s_add_u32 m0, s28, 131072
  s_nop 0
  buffer_load_dwordx4 v20, s[68:71], s27 offen lds
  s_add_u32 m0, s28, 132096
  s_add_u32 s27, s27, 32768
  buffer_load_dwordx4 v20, s[68:71], s27 offen lds
  s_add_u32 m0, s28, 133120
  s_add_u32 s27, s27, 32768
  buffer_load_dwordx4 v21, s[68:71], s27 offen lds
  s_add_u32 m0, s28, 134144
  s_add_u32 s27, s27, 32768
  buffer_load_dwordx4 v21, s[68:71], s27 offen lds
  s_add_u32 m0, s28, 135168
  s_add_u32 s27, s27, 32768
  buffer_load_dwordx4 v20, s[68:71], s27 offen lds
  s_add_u32 m0, s28, 136192
  s_add_u32 s27, s27, 32768
  buffer_load_dwordx4 v20, s[68:71], s27 offen lds
  s_add_u32 m0, s28, 137216
  s_add_u32 s27, s27, 32768
  buffer_load_dwordx4 v21, s[68:71], s27 offen lds
  s_add_u32 m0, s28, 138240
  s_add_u32 s27, s27, 32768
  buffer_load_dwordx4 v21, s[68:71], s27 offen lds
  ds_read_b64_tr_b16 v[160:161], v22 offset:32768
  ds_read_b64_tr_b16 v[162:163], v22 offset:33792
  ds_read_b64_tr_b16 v[164:165], v22 offset:36864
  ds_read_b64_tr_b16 v[166:167], v22 offset:37888
  ds_read_b64_tr_b16 v[168:169], v22 offset:40960
  ds_read_b64_tr_b16 v[170:171], v22 offset:41984
  ds_read_b64_tr_b16 v[172:173], v22 offset:45056
  ds_read_b64_tr_b16 v[174:175], v22 offset:46080
  ds_read_b64_tr_b16 v[176:177], v22 offset:49152
  ds_read_b64_tr_b16 v[178:179], v22 offset:50176
  ds_read_b64_tr_b16 v[180:181], v22 offset:53248
  ds_read_b64_tr_b16 v[182:183], v22 offset:54272
  ds_read_b64_tr_b16 v[184:185], v22 offset:57344
  ds_read_b64_tr_b16 v[186:187], v22 offset:58368
  ds_read_b64_tr_b16 v[188:189], v22 offset:61440
  ds_read_b64_tr_b16 v[190:191], v22 offset:62464
  s_waitcnt lgkmcnt(0)
  s_waitcnt vmcnt(16)
  s_barrier
  s_add_u32 s27, s26, 1048576
  s_add_u32 m0, s28, 0
  s_nop 0
  buffer_load_dwordx4 v20, s[68:71], s27 offen lds
  s_add_u32 m0, s28, 1024
  s_add_u32 s27, s27, 32768
  buffer_load_dwordx4 v20, s[68:71], s27 offen lds
  s_add_u32 m0, s28, 2048
  s_add_u32 s27, s27, 32768
  buffer_load_dwordx4 v21, s[68:71], s27 offen lds
  s_add_u32 m0, s28, 3072
  s_add_u32 s27, s27, 32768
  buffer_load_dwordx4 v21, s[68:71], s27 offen lds
  s_add_u32 m0, s28, 4096
  s_add_u32 s27, s27, 32768
  buffer_load_dwordx4 v20, s[68:71], s27 offen lds
  s_add_u32 m0, s28, 5120
  s_add_u32 s27, s27, 32768
  buffer_load_dwordx4 v20, s[68:71], s27 offen lds
  s_add_u32 m0, s28, 6144
  s_add_u32 s27, s27, 32768
  buffer_load_dwordx4 v21, s[68:71], s27 offen lds
  s_add_u32 m0, s28, 7168
  s_add_u32 s27, s27, 32768
  buffer_load_dwordx4 v21, s[68:71], s27 offen lds
  ds_read_b64_tr_b16 v[192:193], v23 offset:0
  ds_read_b64_tr_b16 v[194:195], v23 offset:1024
  ds_read_b64_tr_b16 v[196:197], v23 offset:4096
  ds_read_b64_tr_b16 v[198:199], v23 offset:5120
  ds_read_b64_tr_b16 v[200:201], v23 offset:8192
  ds_read_b64_tr_b16 v[202:203], v23 offset:9216
  ds_read_b64_tr_b16 v[204:205], v23 offset:12288
  ds_read_b64_tr_b16 v[206:207], v23 offset:13312
  ds_read_b64_tr_b16 v[208:209], v23 offset:16384
  ds_read_b64_tr_b16 v[210:211], v23 offset:17408
  ds_read_b64_tr_b16 v[212:213], v23 offset:20480
  ds_read_b64_tr_b16 v[214:215], v23 offset:21504
  ds_read_b64_tr_b16 v[216:217], v23 offset:24576
  ds_read_b64_tr_b16 v[218:219], v23 offset:25600
  ds_read_b64_tr_b16 v[220:221], v23 offset:28672
  ds_read_b64_tr_b16 v[222:223], v23 offset:29696
  s_waitcnt lgkmcnt(0)
  s_waitcnt vmcnt(16)
  s_barrier
  s_add_u32 s27, s26, 2097152
  s_add_u32 m0, s28, 32768
  s_nop 0
  buffer_load_dwordx4 v20, s[68:71], s27 offen lds
  s_add_u32 m0, s28, 33792
  s_add_u32 s27, s27, 32768
  buffer_load_dwordx4 v20, s[68:71], s27 offen lds
  s_add_u32 m0, s28, 34816
  s_add_u32 s27, s27, 32768
  buffer_load_dwordx4 v21, s[68:71], s27 offen lds
  s_add_u32 m0, s28, 35840
  s_add_u32 s27, s27, 32768
  buffer_load_dwordx4 v21, s[68:71], s27 offen lds
  s_add_u32 m0, s28, 36864
  s_add_u32 s27, s27, 32768
  buffer_load_dwordx4 v20, s[68:71], s27 offen lds
  s_add_u32 m0, s28, 37888
  s_add_u32 s27, s27, 32768
  buffer_load_dwordx4 v20, s[68:71], s27 offen lds
  s_add_u32 m0, s28, 38912
  s_add_u32 s27, s27, 32768
  buffer_load_dwordx4 v21, s[68:71], s27 offen lds
  s_add_u32 m0, s28, 39936
  s_add_u32 s27, s27, 32768
  buffer_load_dwordx4 v21, s[68:71], s27 offen lds
  ds_read_b64_tr_b16 v[224:225], v23 offset:32768
  ds_read_b64_tr_b16 v[226:227], v23 offset:33792
  ds_read_b64_tr_b16 v[228:229], v23 offset:36864
  ds_read_b64_tr_b16 v[230:231], v23 offset:37888
  ds_read_b64_tr_b16 v[232:233], v23 offset:40960
  ds_read_b64_tr_b16 v[234:235], v23 offset:41984
  ds_read_b64_tr_b16 v[236:237], v23 offset:45056
  ds_read_b64_tr_b16 v[238:239], v23 offset:46080
  ds_read_b64_tr_b16 v[240:241], v23 offset:49152
  ds_read_b64_tr_b16 v[242:243], v23 offset:50176
  ds_read_b64_tr_b16 v[244:245], v23 offset:53248
  ds_read_b64_tr_b16 v[246:247], v23 offset:54272
  ds_read_b64_tr_b16 v[248:249], v23 offset:57344
  ds_read_b64_tr_b16 v[250:251], v23 offset:58368
  ds_read_b64_tr_b16 v[252:253], v23 offset:61440
  ds_read_b64_tr_b16 v[254:255], v23 offset:62464
  s_waitcnt lgkmcnt(0)
  s_waitcnt vmcnt(16)
  s_barrier
  s_add_u32 s27, s26, 3145728
  s_add_u32 m0, s28, 65536
  s_nop 0
  buffer_load_dwordx4 v20, s[68:71], s27 offen lds
  s_add_u32 m0, s28, 66560
  s_add_u32 s27, s27, 32768
  buffer_load_dwordx4 v20, s[68:71], s27 offen lds
  s_add_u32 m0, s28, 67584
  s_add_u32 s27, s27, 32768
  buffer_load_dwordx4 v21, s[68:71], s27 offen lds
  s_add_u32 m0, s28, 68608
  s_add_u32 s27, s27, 32768
  buffer_load_dwordx4 v21, s[68:71], s27 offen lds
  s_add_u32 m0, s28, 69632
  s_add_u32 s27, s27, 32768
  buffer_load_dwordx4 v20, s[68:71], s27 offen lds
  s_add_u32 m0, s28, 70656
  s_add_u32 s27, s27, 32768
  buffer_load_dwordx4 v20, s[68:71], s27 offen lds
  s_add_u32 m0, s28, 71680
  s_add_u32 s27, s27, 32768
  buffer_load_dwordx4 v21, s[68:71], s27 offen lds
  s_add_u32 m0, s28, 72704
  s_add_u32 s27, s27, 32768
  buffer_load_dwordx4 v21, s[68:71], s27 offen lds
  ds_read_b64_tr_b16 a[0:1], v24 offset:0
  ds_read_b64_tr_b16 a[2:3], v24 offset:1024
  ds_read_b64_tr_b16 a[4:5], v24 offset:4096
  ds_read_b64_tr_b16 a[6:7], v24 offset:5120
  ds_read_b64_tr_b16 a[8:9], v24 offset:8192
  ds_read_b64_tr_b16 a[10:11], v24 offset:9216
  ds_read_b64_tr_b16 a[12:13], v24 offset:12288
  ds_read_b64_tr_b16 a[14:15], v24 offset:13312
  ds_read_b64_tr_b16 a[16:17], v24 offset:16384
  ds_read_b64_tr_b16 a[18:19], v24 offset:17408
  ds_read_b64_tr_b16 a[20:21], v24 offset:20480
  ds_read_b64_tr_b16 a[22:23], v24 offset:21504
  ds_read_b64_tr_b16 a[24:25], v24 offset:24576
  ds_read_b64_tr_b16 a[26:27], v24 offset:25600
  ds_read_b64_tr_b16 a[28:29], v24 offset:28672
  ds_read_b64_tr_b16 a[30:31], v24 offset:29696
  s_waitcnt lgkmcnt(0)
  s_waitcnt vmcnt(16)
  s_barrier
  s_add_u32 s27, s26, 0
  s_add_u32 m0, s28, 98304
  s_nop 0
  buffer_load_dwordx4 v20, s[8:11], s27 offen lds
  s_add_u32 m0, s28, 99328
  s_add_u32 s27, s27, 32768
  buffer_load_dwordx4 v20, s[8:11], s27 offen lds
  s_add_u32 m0, s28, 100352
  s_add_u32 s27, s27, 32768
  buffer_load_dwordx4 v21, s[8:11], s27 offen lds
  s_add_u32 m0, s28, 101376
  s_add_u32 s27, s27, 32768
  buffer_load_dwordx4 v21, s[8:11], s27 offen lds
  s_add_u32 m0, s28, 102400
  s_add_u32 s27, s27, 32768
  buffer_load_dwordx4 v20, s[8:11], s27 offen lds
  s_add_u32 m0, s28, 103424
  s_add_u32 s27, s27, 32768
  buffer_load_dwordx4 v20, s[8:11], s27 offen lds
  s_add_u32 m0, s28, 104448
  s_add_u32 s27, s27, 32768
  buffer_load_dwordx4 v21, s[8:11], s27 offen lds
  s_add_u32 m0, s28, 105472
  s_add_u32 s27, s27, 32768
  buffer_load_dwordx4 v21, s[8:11], s27 offen lds
  ds_read_b64_tr_b16 a[32:33], v22 offset:0
  ds_read_b64_tr_b16 a[34:35], v22 offset:1024
  ds_read_b64_tr_b16 a[36:37], v22 offset:4096
  ds_read_b64_tr_b16 a[38:39], v22 offset:5120
  ds_read_b64_tr_b16 a[40:41], v22 offset:8192
  ds_read_b64_tr_b16 a[42:43], v22 offset:9216
  ds_read_b64_tr_b16 a[44:45], v22 offset:12288
  ds_read_b64_tr_b16 a[46:47], v22 offset:13312
  ds_read_b64_tr_b16 a[48:49], v22 offset:16384
  ds_read_b64_tr_b16 a[50:51], v22 offset:17408
  ds_read_b64_tr_b16 a[52:53], v22 offset:20480
  ds_read_b64_tr_b16 a[54:55], v22 offset:21504
  ds_read_b64_tr_b16 a[56:57], v22 offset:24576
  ds_read_b64_tr_b16 a[58:59], v22 offset:25600
  ds_read_b64_tr_b16 a[60:61], v22 offset:28672
  ds_read_b64_tr_b16 a[62:63], v22 offset:29696
  s_waitcnt lgkmcnt(0)
  s_waitcnt vmcnt(16)
  s_barrier
  s_add_u32 s27, s26, 1048576
  s_add_u32 m0, s28, 131072
  s_nop 0
  buffer_load_dwordx4 v20, s[8:11], s27 offen lds
  s_add_u32 m0, s28, 132096
  s_add_u32 s27, s27, 32768
  buffer_load_dwordx4 v20, s[8:11], s27 offen lds
  s_add_u32 m0, s28, 133120
  s_add_u32 s27, s27, 32768
  buffer_load_dwordx4 v21, s[8:11], s27 offen lds
  s_add_u32 m0, s28, 134144
  s_add_u32 s27, s27, 32768
  buffer_load_dwordx4 v21, s[8:11], s27 offen lds
  s_add_u32 m0, s28, 135168
  s_add_u32 s27, s27, 32768
  buffer_load_dwordx4 v20, s[8:11], s27 offen lds
  s_add_u32 m0, s28, 136192
  s_add_u32 s27, s27, 32768
  buffer_load_dwordx4 v20, s[8:11], s27 offen lds
  s_add_u32 m0, s28, 137216
  s_add_u32 s27, s27, 32768
  buffer_load_dwordx4 v21, s[8:11], s27 offen lds
  s_add_u32 m0, s28, 138240
  s_add_u32 s27, s27, 32768
  buffer_load_dwordx4 v21, s[8:11], s27 offen lds
  ds_read_b64_tr_b16 a[64:65], v22 offset:32768
  ds_read_b64_tr_b16 a[66:67], v22 offset:33792
  ds_read_b64_tr_b16 a[68:69], v22 offset:36864
  ds_read_b64_tr_b16 a[70:71], v22 offset:37888
  ds_read_b64_tr_b16 a[72:73], v22 offset:40960
  ds_read_b64_tr_b16 a[74:75], v22 offset:41984
  ds_read_b64_tr_b16 a[76:77], v22 offset:45056
  ds_read_b64_tr_b16 a[78:79], v22 offset:46080
  ds_read_b64_tr_b16 a[80:81], v22 offset:49152
  ds_read_b64_tr_b16 a[82:83], v22 offset:50176
  ds_read_b64_tr_b16 a[84:85], v22 offset:53248
  ds_read_b64_tr_b16 a[86:87], v22 offset:54272
  ds_read_b64_tr_b16 a[88:89], v22 offset:57344
  ds_read_b64_tr_b16 a[90:91], v22 offset:58368
  ds_read_b64_tr_b16 a[92:93], v22 offset:61440
  ds_read_b64_tr_b16 a[94:95], v22 offset:62464
  s_waitcnt lgkmcnt(0)
  s_waitcnt vmcnt(16)
  s_barrier
  s_add_u32 s27, s26, 2097152
  s_add_u32 m0, s28, 0
  s_nop 0
  buffer_load_dwordx4 v20, s[8:11], s27 offen lds
  s_add_u32 m0, s28, 1024
  s_add_u32 s27, s27, 32768
  buffer_load_dwordx4 v20, s[8:11], s27 offen lds
  s_add_u32 m0, s28, 2048
  s_add_u32 s27, s27, 32768
  buffer_load_dwordx4 v21, s[8:11], s27 offen lds
  s_add_u32 m0, s28, 3072
  s_add_u32 s27, s27, 32768
  buffer_load_dwordx4 v21, s[8:11], s27 offen lds
  s_add_u32 m0, s28, 4096
  s_add_u32 s27, s27, 32768
  buffer_load_dwordx4 v20, s[8:11], s27 offen lds
  s_add_u32 m0, s28, 5120
  s_add_u32 s27, s27, 32768
  buffer_load_dwordx4 v20, s[8:11], s27 offen lds
  s_add_u32 m0, s28, 6144
  s_add_u32 s27, s27, 32768
  buffer_load_dwordx4 v21, s[8:11], s27 offen lds
  s_add_u32 m0, s28, 7168
  s_add_u32 s27, s27, 32768
  buffer_load_dwordx4 v21, s[8:11], s27 offen lds
  ds_read_b64_tr_b16 a[96:97], v23 offset:0
  ds_read_b64_tr_b16 a[98:99], v23 offset:1024
  ds_read_b64_tr_b16 a[100:101], v23 offset:4096
  ds_read_b64_tr_b16 a[102:103], v23 offset:5120
  ds_read_b64_tr_b16 a[104:105], v23 offset:8192
  ds_read_b64_tr_b16 a[106:107], v23 offset:9216
  ds_read_b64_tr_b16 a[108:109], v23 offset:12288
  ds_read_b64_tr_b16 a[110:111], v23 offset:13312
  ds_read_b64_tr_b16 a[112:113], v23 offset:16384
  ds_read_b64_tr_b16 a[114:115], v23 offset:17408
  ds_read_b64_tr_b16 a[116:117], v23 offset:20480
  ds_read_b64_tr_b16 a[118:119], v23 offset:21504
  ds_read_b64_tr_b16 a[120:121], v23 offset:24576
  ds_read_b64_tr_b16 a[122:123], v23 offset:25600
  ds_read_b64_tr_b16 a[124:125], v23 offset:28672
  ds_read_b64_tr_b16 a[126:127], v23 offset:29696
  s_waitcnt lgkmcnt(0)
  s_waitcnt vmcnt(16)
  s_barrier
  s_add_u32 s27, s26, 3145728
  s_add_u32 m0, s28, 32768
  s_nop 0
  buffer_load_dwordx4 v20, s[8:11], s27 offen lds
  s_add_u32 m0, s28, 33792
  s_add_u32 s27, s27, 32768
  buffer_load_dwordx4 v20, s[8:11], s27 offen lds
  s_add_u32 m0, s28, 34816
  s_add_u32 s27, s27, 32768
  buffer_load_dwordx4 v21, s[8:11], s27 offen lds
  s_add_u32 m0, s28, 35840
  s_add_u32 s27, s27, 32768
  buffer_load_dwordx4 v21, s[8:11], s27 offen lds
  s_add_u32 m0, s28, 36864
  s_add_u32 s27, s27, 32768
  buffer_load_dwordx4 v20, s[8:11], s27 offen lds
  s_add_u32 m0, s28, 37888
  s_add_u32 s27, s27, 32768
  buffer_load_dwordx4 v20, s[8:11], s27 offen lds
  s_add_u32 m0, s28, 38912
  s_add_u32 s27, s27, 32768
  buffer_load_dwordx4 v21, s[8:11], s27 offen lds
  s_add_u32 m0, s28, 39936
  s_add_u32 s27, s27, 32768
  buffer_load_dwordx4 v21, s[8:11], s27 offen lds
  ds_read_b64_tr_b16 a[128:129], v23 offset:32768
  ds_read_b64_tr_b16 a[130:131], v23 offset:33792
  ds_read_b64_tr_b16 a[132:133], v23 offset:36864
  ds_read_b64_tr_b16 a[134:135], v23 offset:37888
  ds_read_b64_tr_b16 a[136:137], v23 offset:40960
  ds_read_b64_tr_b16 a[138:139], v23 offset:41984
  ds_read_b64_tr_b16 a[140:141], v23 offset:45056
  ds_read_b64_tr_b16 a[142:143], v23 offset:46080
  ds_read_b64_tr_b16 a[144:145], v23 offset:49152
  ds_read_b64_tr_b16 a[146:147], v23 offset:50176
  ds_read_b64_tr_b16 a[148:149], v23 offset:53248
  ds_read_b64_tr_b16 a[150:151], v23 offset:54272
  ds_read_b64_tr_b16 a[152:153], v23 offset:57344
  ds_read_b64_tr_b16 a[154:155], v23 offset:58368
  ds_read_b64_tr_b16 a[156:157], v23 offset:61440
  ds_read_b64_tr_b16 a[158:159], v23 offset:62464
  s_waitcnt lgkmcnt(0)
  s_waitcnt vmcnt(16)
  s_barrier
  ds_read_b64_tr_b16 a[160:161], v24 offset:0
  ds_read_b64_tr_b16 a[162:163], v24 offset:1024
  ds_read_b64_tr_b16 a[164:165], v24 offset:4096
  ds_read_b64_tr_b16 a[166:167], v24 offset:5120
  ds_read_b64_tr_b16 a[168:169], v24 offset:8192
  ds_read_b64_tr_b16 a[170:171], v24 offset:9216
  ds_read_b64_tr_b16 a[172:173], v24 offset:12288
  ds_read_b64_tr_b16 a[174:175], v24 offset:13312
  ds_read_b64_tr_b16 a[176:177], v24 offset:16384
  ds_read_b64_tr_b16 a[178:179], v24 offset:17408
  ds_read_b64_tr_b16 a[180:181], v24 offset:20480
  ds_read_b64_tr_b16 a[182:183], v24 offset:21504
  ds_read_b64_tr_b16 a[184:185], v24 offset:24576
  ds_read_b64_tr_b16 a[186:187], v24 offset:25600
  ds_read_b64_tr_b16 a[188:189], v24 offset:28672
  ds_read_b64_tr_b16 a[190:191], v24 offset:29696
  s_waitcnt lgkmcnt(0)
  s_waitcnt vmcnt(8)
  s_barrier
  ds_read_b64_tr_b16 a[192:193], v22 offset:0
  ds_read_b64_tr_b16 a[194:195], v22 offset:1024
  ds_read_b64_tr_b16 a[196:197], v22 offset:4096
  ds_read_b64_tr_b16 a[198:199], v22 offset:5120
  ds_read_b64_tr_b16 a[200:201], v22 offset:8192
  ds_read_b64_tr_b16 a[202:203], v22 offset:9216
  ds_read_b64_tr_b16 a[204:205], v22 offset:12288
  ds_read_b64_tr_b16 a[206:207], v22 offset:13312
  ds_read_b64_tr_b16 a[208:209], v22 offset:16384
  ds_read_b64_tr_b16 a[210:211], v22 offset:17408
  ds_read_b64_tr_b16 a[212:213], v22 offset:20480
  ds_read_b64_tr_b16 a[214:215], v22 offset:21504
  ds_read_b64_tr_b16 a[216:217], v22 offset:24576
  ds_read_b64_tr_b16 a[218:219], v22 offset:25600
  ds_read_b64_tr_b16 a[220:221], v22 offset:28672
  ds_read_b64_tr_b16 a[222:223], v22 offset:29696
  s_waitcnt lgkmcnt(0)
  s_waitcnt vmcnt(0)
  s_barrier
  ds_read_b64_tr_b16 a[224:225], v22 offset:32768
  ds_read_b64_tr_b16 a[226:227], v22 offset:33792
  ds_read_b64_tr_b16 a[228:229], v22 offset:36864
  ds_read_b64_tr_b16 a[230:231], v22 offset:37888
  ds_read_b64_tr_b16 a[232:233], v22 offset:40960
  ds_read_b64_tr_b16 a[234:235], v22 offset:41984
  ds_read_b64_tr_b16 a[236:237], v22 offset:45056
  ds_read_b64_tr_b16 a[238:239], v22 offset:46080
  ds_read_b64_tr_b16 a[240:241], v22 offset:49152
  ds_read_b64_tr_b16 a[242:243], v22 offset:50176
  ds_read_b64_tr_b16 a[244:245], v22 offset:53248
  ds_read_b64_tr_b16 a[246:247], v22 offset:54272
  ds_read_b64_tr_b16 a[248:249], v22 offset:57344
  ds_read_b64_tr_b16 a[250:251], v22 offset:58368
  ds_read_b64_tr_b16 a[252:253], v22 offset:61440
  ds_read_b64_tr_b16 a[254:255], v22 offset:62464
  s_waitcnt lgkmcnt(0)
  s_branch q_ld_92
q_ld_90:
  s_add_u32 s27, s26, 0
  s_add_u32 m0, s28, 0
  s_nop 0
  buffer_load_dwordx4 v20, s[68:71], s27 offen lds
  s_add_u32 m0, s28, 1024
  s_add_u32 s27, s27, 32768
  buffer_load_dwordx4 v20, s[68:71], s27 offen lds
  s_add_u32 m0, s28, 2048
  s_add_u32 s27, s27, 32768
  buffer_load_dwordx4 v21, s[68:71], s27 offen lds
  s_add_u32 m0, s28, 3072
  s_add_u32 s27, s27, 32768
  buffer_load_dwordx4 v21, s[68:71], s27 offen lds
  s_add_u32 m0, s28, 4096
  s_add_u32 s27, s27, 32768
  buffer_load_dwordx4 v20, s[68:71], s27 offen lds
  s_add_u32 m0, s28, 5120
  s_add_u32 s27, s27, 32768
  buffer_load_dwordx4 v20, s[68:71], s27 offen lds
  s_add_u32 m0, s28, 6144
  s_add_u32 s27, s27, 32768
  buffer_load_dwordx4 v21, s[68:71], s27 offen lds
  s_add_u32 m0, s28, 7168
  s_add_u32 s27, s27, 32768
  buffer_load_dwordx4 v21, s[68:71], s27 offen lds
  s_add_u32 s27, s26, 1048576
  s_add_u32 m0, s28, 32768
  s_nop 0
  buffer_load_dwordx4 v20, s[68:71], s27 offen lds
  s_add_u32 m0, s28, 33792
  s_add_u32 s27, s27, 32768
  buffer_load_dwordx4 v20, s[68:71], s27 offen lds
  s_add_u32 m0, s28, 34816
  s_add_u32 s27, s27, 32768
  buffer_load_dwordx4 v21, s[68:71], s27 offen lds
  s_add_u32 m0, s28, 35840
  s_add_u32 s27, s27, 32768
  buffer_load_dwordx4 v21, s[68:71], s27 offen lds
  s_add_u32 m0, s28, 36864
  s_add_u32 s27, s27, 32768
  buffer_load_dwordx4 v20, s[68:71], s27 offen lds
  s_add_u32 m0, s28, 37888
  s_add_u32 s27, s27, 32768
  buffer_load_dwordx4 v20, s[68:71], s27 offen lds
  s_add_u32 m0, s28, 38912
  s_add_u32 s27, s27, 32768
  buffer_load_dwordx4 v21, s[68:71], s27 offen lds
  s_add_u32 m0, s28, 39936
  s_add_u32 s27, s27, 32768
  buffer_load_dwordx4 v21, s[68:71], s27 offen lds
  s_add_u32 s27, s26, 2097152
  s_add_u32 m0, s28, 65536
  s_nop 0
  buffer_load_dwordx4 v20, s[68:71], s27 offen lds
  s_add_u32 m0, s28, 66560
  s_add_u32 s27, s27, 32768
  buffer_load_dwordx4 v20, s[68:71], s27 offen lds
  s_add_u32 m0, s28, 67584
  s_add_u32 s27, s27, 32768
  buffer_load_dwordx4 v21, s[68:71], s27 offen lds
  s_add_u32 m0, s28, 68608
  s_add_u32 s27, s27, 32768
  buffer_load_dwordx4 v21, s[68:71], s27 offen lds
  s_add_u32 m0, s28, 69632
  s_add_u32 s27, s27, 32768
  buffer_load_dwordx4 v20, s[68:71], s27 offen lds
  s_add_u32 m0, s28, 70656
  s_add_u32 s27, s27, 32768
  buffer_load_dwordx4 v20, s[68:71], s27 offen lds
  s_add_u32 m0, s28, 71680
  s_add_u32 s27, s27, 32768
  buffer_load_dwordx4 v21, s[68:71], s27 offen lds
  s_add_u32 m0, s28, 72704
  s_add_u32 s27, s27, 32768
  buffer_load_dwordx4 v21, s[68:71], s27 offen lds
  s_load_dwordx2 s[4:5], s[0:1], 112
  s_load_dwordx2 s[12:13], s[0:1], 104
  s_waitcnt vmcnt(16)
  s_barrier
  s_add_u32 s27, s26, 3145728
  s_add_u32 m0, s28, 98304
  s_nop 0
  buffer_load_dwordx4 v20, s[68:71], s27 offen lds
  s_add_u32 m0, s28, 99328
  s_add_u32 s27, s27, 32768
  buffer_load_dwordx4 v20, s[68:71], s27 offen lds
  s_add_u32 m0, s28, 100352
  s_add_u32 s27, s27, 32768
  buffer_load_dwordx4 v21, s[68:71], s27 offen lds
  s_add_u32 m0, s28, 101376
  s_add_u32 s27, s27, 32768
  buffer_load_dwordx4 v21, s[68:71], s27 offen lds
  s_add_u32 m0, s28, 102400
  s_add_u32 s27, s27, 32768
  buffer_load_dwordx4 v20, s[68:71], s27 offen lds
  s_add_u32 m0, s28, 103424
  s_add_u32 s27, s27, 32768
  buffer_load_dwordx4 v20, s[68:71], s27 offen lds
  s_add_u32 m0, s28, 104448
  s_add_u32 s27, s27, 32768
  buffer_load_dwordx4 v21, s[68:71], s27 offen lds
  s_add_u32 m0, s28, 105472
  s_add_u32 s27, s27, 32768
  buffer_load_dwordx4 v21, s[68:71], s27 offen lds
  ds_read_b64_tr_b16 a[0:1], v22 offset:0
  ds_read_b64_tr_b16 a[2:3], v22 offset:1024
  ds_read_b64_tr_b16 a[4:5], v22 offset:4096
  ds_read_b64_tr_b16 a[6:7], v22 offset:5120
  ds_read_b64_tr_b16 a[8:9], v22 offset:8192
  ds_read_b64_tr_b16 a[10:11], v22 offset:9216
  ds_read_b64_tr_b16 a[12:13], v22 offset:12288
  ds_read_b64_tr_b16 a[14:15], v22 offset:13312
  ds_read_b64_tr_b16 a[16:17], v22 offset:16384
  ds_read_b64_tr_b16 a[18:19], v22 offset:17408
  ds_read_b64_tr_b16 a[20:21], v22 offset:20480
  ds_read_b64_tr_b16 a[22:23], v22 offset:21504
  ds_read_b64_tr_b16 a[24:25], v22 offset:24576
  ds_read_b64_tr_b16 a[26:27], v22 offset:25600
  ds_read_b64_tr_b16 a[28:29], v22 offset:28672
  ds_read_b64_tr_b16 a[30:31], v22 offset:29696
  s_waitcnt lgkmcnt(0)
  s_waitcnt vmcnt(16)
  s_barrier
  s_add_u32 s27, s26, 0
  s_add_u32 m0, s28, 131072
  s_nop 0
  buffer_load_dwordx4 v20, s[8:11], s27 offen lds
  s_add_u32 m0, s28, 132096
  s_add_u32 s27, s27, 32768
  buffer_load_dwordx4 v20, s[8:11], s27 offen lds
  s_add_u32 m0, s28, 133120
  s_add_u32 s27, s27, 32768
  buffer_load_dwordx4 v21, s[8:11], s27 offen lds
  s_add_u32 m0, s28, 134144
  s_add_u32 s27, s27, 32768
  buffer_load_dwordx4 v21, s[8:11], s27 offen lds
  s_add_u32 m0, s28, 135168
  s_add_u32 s27, s27, 32768
  buffer_load_dwordx4 v20, s[8:11], s27 offen lds
  s_add_u32 m0, s28, 136192
  s_add_u32 s27, s27, 32768
  buffer_load_dwordx4 v20, s[8:11], s27 offen lds
  s_add_u32 m0, s28, 137216
  s_add_u32 s27, s27, 32768
  buffer_load_dwordx4 v21, s[8:11], s27 offen lds
  s_add_u32 m0, s28, 138240
  s_add_u32 s27, s27, 32768
  buffer_load_dwordx4 v21, s[8:11], s27 offen lds
  ds_read_b64_tr_b16 a[32:33], v22 offset:32768
  ds_read_b64_tr_b16 a[34:35], v22 offset:33792
  ds_read_b64_tr_b16 a[36:37], v22 offset:36864
  ds_read_b64_tr_b16 a[38:39], v22 offset:37888
  ds_read_b64_tr_b16 a[40:41], v22 offset:40960
  ds_read_b64_tr_b16 a[42:43], v22 offset:41984
  ds_read_b64_tr_b16 a[44:45], v22 offset:45056
  ds_read_b64_tr_b16 a[46:47], v22 offset:46080
  ds_read_b64_tr_b16 a[48:49], v22 offset:49152
  ds_read_b64_tr_b16 a[50:51], v22 offset:50176
  ds_read_b64_tr_b16 a[52:53], v22 offset:53248
  ds_read_b64_tr_b16 a[54:55], v22 offset:54272
  ds_read_b64_tr_b16 a[56:57], v22 offset:57344
  ds_read_b64_tr_b16 a[58:59], v22 offset:58368
  ds_read_b64_tr_b16 a[60:61], v22 offset:61440
  ds_read_b64_tr_b16 a[62:63], v22 offset:62464
  s_waitcnt lgkmcnt(0)
  s_waitcnt vmcnt(16)
  s_barrier
  s_add_u32 s27, s26, 1048576
  s_add_u32 m0, s28, 0
  s_nop 0
  buffer_load_dwordx4 v20, s[8:11], s27 offen lds
  s_add_u32 m0, s28, 1024
  s_add_u32 s27, s27, 32768
  buffer_load_dwordx4 v20, s[8:11], s27 offen lds
  s_add_u32 m0, s28, 2048
  s_add_u32 s27, s27, 32768
  buffer_load_dwordx4 v21, s[8:11], s27 offen lds
  s_add_u32 m0, s28, 3072
  s_add_u32 s27, s27, 32768
  buffer_load_dwordx4 v21, s[8:11], s27 offen lds
  s_add_u32 m0, s28, 4096
  s_add_u32 s27, s27, 32768
  buffer_load_dwordx4 v20, s[8:11], s27 offen lds
  s_add_u32 m0, s28, 5120
  s_add_u32 s27, s27, 32768
  buffer_load_dwordx4 v20, s[8:11], s27 offen lds
  s_add_u32 m0, s28, 6144
  s_add_u32 s27, s27, 32768
  buffer_load_dwordx4 v21, s[8:11], s27 offen lds
  s_add_u32 m0, s28, 7168
  s_add_u32 s27, s27, 32768
  buffer_load_dwordx4 v21, s[8:11], s27 offen lds
  ds_read_b64_tr_b16 a[64:65], v23 offset:0
  ds_read_b64_tr_b16 a[66:67], v23 offset:1024
  ds_read_b64_tr_b16 a[68:69], v23 offset:4096
  ds_read_b64_tr_b16 a[70:71], v23 offset:5120
  ds_read_b64_tr_b16 a[72:73], v23 offset:8192
  ds_read_b64_tr_b16 a[74:75], v23 offset:9216
  ds_read_b64_tr_b16 a[76:77], v23 offset:12288
  ds_read_b64_tr_b16 a[78:79], v23 offset:13312
  ds_read_b64_tr_b16 a[80:81], v23 offset:16384
  ds_read_b64_tr_b16 a[82:83], v23 offset:17408
  ds_read_b64_tr_b16 a[84:85], v23 offset:20480
  ds_read_b64_tr_b16 a[86:87], v23 offset:21504
  ds_read_b64_tr_b16 a[88:89], v23 offset:24576
  ds_read_b64_tr_b16 a[90:91], v23 offset:25600
  ds_read_b64_tr_b16 a[92:93], v23 offset:28672
  ds_read_b64_tr_b16 a[94:95], v23 offset:29696
  s_waitcnt lgkmcnt(0)
  s_waitcnt vmcnt(16)
  s_barrier
  s_add_u32 s27, s26, 2097152
  s_add_u32 m0, s28, 32768
  s_nop 0
  buffer_load_dwordx4 v20, s[8:11], s27 offen lds
  s_add_u32 m0, s28, 33792
  s_add_u32 s27, s27, 32768
  buffer_load_dwordx4 v20, s[8:11], s27 offen lds
  s_add_u32 m0, s28, 34816
  s_add_u32 s27, s27, 32768
  buffer_load_dwordx4 v21, s[8:11], s27 offen lds
  s_add_u32 m0, s28, 35840
  s_add_u32 s27, s27, 32768
  buffer_load_dwordx4 v21, s[8:11], s27 offen lds
  s_add_u32 m0, s28, 36864
  s_add_u32 s27, s27, 32768
  buffer_load_dwordx4 v20, s[8:11], s27 offen lds
  s_add_u32 m0, s28, 37888
  s_add_u32 s27, s27, 32768
  buffer_load_dwordx4 v20, s[8:11], s27 offen lds
  s_add_u32 m0, s28, 38912
  s_add_u32 s27, s27, 32768
  buffer_load_dwordx4 v21, s[8:11], s27 offen lds
  s_add_u32 m0, s28, 39936
  s_add_u32 s27, s27, 32768
  buffer_load_dwordx4 v21, s[8:11], s27 offen lds
  ds_read_b64_tr_b16 a[96:97], v23 offset:32768
  ds_read_b64_tr_b16 a[98:99], v23 offset:33792
  ds_read_b64_tr_b16 a[100:101], v23 offset:36864
  ds_read_b64_tr_b16 a[102:103], v23 offset:37888
  ds_read_b64_tr_b16 a[104:105], v23 offset:40960
  ds_read_b64_tr_b16 a[106:107], v23 offset:41984
  ds_read_b64_tr_b16 a[108:109], v23 offset:45056
  ds_read_b64_tr_b16 a[110:111], v23 offset:46080
  ds_read_b64_tr_b16 a[112:113], v23 offset:49152
  ds_read_b64_tr_b16 a[114:115], v23 offset:50176
  ds_read_b64_tr_b16 a[116:117], v23 offset:53248
  ds_read_b64_tr_b16 a[118:119], v23 offset:54272
  ds_read_b64_tr_b16 a[120:121], v23 offset:57344
  ds_read_b64_tr_b16 a[122:123], v23 offset:58368
  ds_read_b64_tr_b16 a[124:125], v23 offset:61440
  ds_read_b64_tr_b16 a[126:127], v23 offset:62464
  s_waitcnt lgkmcnt(0)
  s_waitcnt vmcnt(16)
  s_barrier
  s_add_u32 s27, s26, 3145728
  s_add_u32 m0, s28, 65536
  s_nop 0
  buffer_load_dwordx4 v20, s[8:11], s27 offen lds
  s_add_u32 m0, s28, 66560
  s_add_u32 s27, s27, 32768
  buffer_load_dwordx4 v20, s[8:11], s27 offen lds
  s_add_u32 m0, s28, 67584
  s_add_u32 s27, s27, 32768
  buffer_load_dwordx4 v21, s[8:11], s27 offen lds
  s_add_u32 m0, s28, 68608
  s_add_u32 s27, s27, 32768
  buffer_load_dwordx4 v21, s[8:11], s27 offen lds
  s_add_u32 m0, s28, 69632
  s_add_u32 s27, s27, 32768
  buffer_load_dwordx4 v20, s[8:11], s27 offen lds
  s_add_u32 m0, s28, 70656
  s_add_u32 s27, s27, 32768
  buffer_load_dwordx4 v20, s[8:11], s27 offen lds
  s_add_u32 m0, s28, 71680
  s_add_u32 s27, s27, 32768
  buffer_load_dwordx4 v21, s[8:11], s27 offen lds
  s_add_u32 m0, s28, 72704
  s_add_u32 s27, s27, 32768
  buffer_load_dwordx4 v21, s[8:11], s27 offen lds
  ds_read_b64_tr_b16 a[128:129], v24 offset:0
  ds_read_b64_tr_b16 a[130:131], v24 offset:1024
  ds_read_b64_tr_b16 a[132:133], v24 offset:4096
  ds_read_b64_tr_b16 a[134:135], v24 offset:5120
  ds_read_b64_tr_b16 a[136:137], v24 offset:8192
  ds_read_b64_tr_b16 a[138:139], v24 offset:9216
  ds_read_b64_tr_b16 a[140:141], v24 offset:12288
  ds_read_b64_tr_b16 a[142:143], v24 offset:13312
  ds_read_b64_tr_b16 a[144:145], v24 offset:16384
  ds_read_b64_tr_b16 a[146:147], v24 offset:17408
  ds_read_b64_tr_b16 a[148:149], v24 offset:20480
  ds_read_b64_tr_b16 a[150:151], v24 offset:21504
  ds_read_b64_tr_b16 a[152:153], v24 offset:24576
  ds_read_b64_tr_b16 a[154:155], v24 offset:25600
  ds_read_b64_tr_b16 a[156:157], v24 offset:28672
  ds_read_b64_tr_b16 a[158:159], v24 offset:29696
  s_waitcnt lgkmcnt(0)
  s_waitcnt vmcnt(16)
  s_barrier
  s_add_u32 s27, s26, 0
  s_add_u32 m0, s28, 98304
  s_nop 0
  buffer_load_dwordx4 v20, s[64:67], s27 offen lds
  s_add_u32 m0, s28, 99328
  s_add_u32 s27, s27, 32768
  buffer_load_dwordx4 v20, s[64:67], s27 offen lds
  s_add_u32 m0, s28, 100352
  s_add_u32 s27, s27, 32768
  buffer_load_dwordx4 v21, s[64:67], s27 offen lds
  s_add_u32 m0, s28, 101376
  s_add_u32 s27, s27, 32768
  buffer_load_dwordx4 v21, s[64:67], s27 offen lds
  s_add_u32 m0, s28, 102400
  s_add_u32 s27, s27, 32768
  buffer_load_dwordx4 v20, s[64:67], s27 offen lds
  s_add_u32 m0, s28, 103424
  s_add_u32 s27, s27, 32768
  buffer_load_dwordx4 v20, s[64:67], s27 offen lds
  s_add_u32 m0, s28, 104448
  s_add_u32 s27, s27, 32768
  buffer_load_dwordx4 v21, s[64:67], s27 offen lds
  s_add_u32 m0, s28, 105472
  s_add_u32 s27, s27, 32768
  buffer_load_dwordx4 v21, s[64:67], s27 offen lds
  ds_read_b64_tr_b16 a[160:161], v22 offset:0
  ds_read_b64_tr_b16 a[162:163], v22 offset:1024
  ds_read_b64_tr_b16 a[164:165], v22 offset:4096
  ds_read_b64_tr_b16 a[166:167], v22 offset:5120
  ds_read_b64_tr_b16 a[168:169], v22 offset:8192
  ds_read_b64_tr_b16 a[170:171], v22 offset:9216
  ds_read_b64_tr_b16 a[172:173], v22 offset:12288
  ds_read_b64_tr_b16 a[174:175], v22 offset:13312
  ds_read_b64_tr_b16 a[176:177], v22 offset:16384
  ds_read_b64_tr_b16 a[178:179], v22 offset:17408
  ds_read_b64_tr_b16 a[180:181], v22 offset:20480
  ds_read_b64_tr_b16 a[182:183], v22 offset:21504
  ds_read_b64_tr_b16 a[184:185], v22 offset:24576
  ds_read_b64_tr_b16 a[186:187], v22 offset:25600
  ds_read_b64_tr_b16 a[188:189], v22 offset:28672
  ds_read_b64_tr_b16 a[190:191], v22 offset:29696
  s_waitcnt lgkmcnt(0)
  s_waitcnt vmcnt(16)
  s_barrier
  s_add_u32 s27, s26, 1048576
  s_add_u32 m0, s28, 131072
  s_nop 0
  buffer_load_dwordx4 v20, s[64:67], s27 offen lds
  s_add_u32 m0, s28, 132096
  s_add_u32 s27, s27, 32768
  buffer_load_dwordx4 v20, s[64:67], s27 offen lds
  s_add_u32 m0, s28, 133120
  s_add_u32 s27, s27, 32768
  buffer_load_dwordx4 v21, s[64:67], s27 offen lds
  s_add_u32 m0, s28, 134144
  s_add_u32 s27, s27, 32768
  buffer_load_dwordx4 v21, s[64:67], s27 offen lds
  s_add_u32 m0, s28, 135168
  s_add_u32 s27, s27, 32768
  buffer_load_dwordx4 v20, s[64:67], s27 offen lds
  s_add_u32 m0, s28, 136192
  s_add_u32 s27, s27, 32768
  buffer_load_dwordx4 v20, s[64:67], s27 offen lds
  s_add_u32 m0, s28, 137216
  s_add_u32 s27, s27, 32768
  buffer_load_dwordx4 v21, s[64:67], s27 offen lds
  s_add_u32 m0, s28, 138240
  s_add_u32 s27, s27, 32768
  buffer_load_dwordx4 v21, s[64:67], s27 offen lds
  ds_read_b64_tr_b16 a[192:193], v22 offset:32768
  ds_read_b64_tr_b16 a[194:195], v22 offset:33792
  ds_read_b64_tr_b16 a[196:197], v22 offset:36864
  ds_read_b64_tr_b16 a[198:199], v22 offset:37888
  ds_read_b64_tr_b16 a[200:201], v22 offset:40960
  ds_read_b64_tr_b16 a[202:203], v22 offset:41984
  ds_read_b64_tr_b16 a[204:205], v22 offset:45056
  ds_read_b64_tr_b16 a[206:207], v22 offset:46080
  ds_read_b64_tr_b16 a[208:209], v22 offset:49152
  ds_read_b64_tr_b16 a[210:211], v22 offset:50176
  ds_read_b64_tr_b16 a[212:213], v22 offset:53248
  ds_read_b64_tr_b16 a[214:215], v22 offset:54272
  ds_read_b64_tr_b16 a[216:217], v22 offset:57344
  ds_read_b64_tr_b16 a[218:219], v22 offset:58368
  ds_read_b64_tr_b16 a[220:221], v22 offset:61440
  ds_read_b64_tr_b16 a[222:223], v22 offset:62464
  s_waitcnt lgkmcnt(0)
  s_waitcnt vmcnt(16)
  s_barrier
  s_add_u32 s27, s26, 2097152
  s_add_u32 m0, s28, 0
  s_nop 0
  buffer_load_dwordx4 v20, s[64:67], s27 offen lds
  s_add_u32 m0, s28, 1024
  s_add_u32 s27, s27, 32768
  buffer_load_dwordx4 v20, s[64:67], s27 offen lds
  s_add_u32 m0, s28, 2048
  s_add_u32 s27, s27, 32768
  buffer_load_dwordx4 v21, s[64:67], s27 offen lds
  s_add_u32 m0, s28, 3072
  s_add_u32 s27, s27, 32768
  buffer_load_dwordx4 v21, s[64:67], s27 offen lds
  s_add_u32 m0, s28, 4096
  s_add_u32 s27, s27, 32768
  buffer_load_dwordx4 v20, s[64:67], s27 offen lds
  s_add_u32 m0, s28, 5120
  s_add_u32 s27, s27, 32768
  buffer_load_dwordx4 v20, s[64:67], s27 offen lds
  s_add_u32 m0, s28, 6144
  s_add_u32 s27, s27, 32768
  buffer_load_dwordx4 v21, s[64:67], s27 offen lds
  s_add_u32 m0, s28, 7168
  s_add_u32 s27, s27, 32768
  buffer_load_dwordx4 v21, s[64:67], s27 offen lds
  ds_read_b64_tr_b16 a[224:225], v23 offset:0
  ds_read_b64_tr_b16 a[226:227], v23 offset:1024
  ds_read_b64_tr_b16 a[228:229], v23 offset:4096
  ds_read_b64_tr_b16 a[230:231], v23 offset:5120
  ds_read_b64_tr_b16 a[232:233], v23 offset:8192
  ds_read_b64_tr_b16 a[234:235], v23 offset:9216
  ds_read_b64_tr_b16 a[236:237], v23 offset:12288
  ds_read_b64_tr_b16 a[238:239], v23 offset:13312
  ds_read_b64_tr_b16 a[240:241], v23 offset:16384
  ds_read_b64_tr_b16 a[242:243], v23 offset:17408
  ds_read_b64_tr_b16 a[244:245], v23 offset:20480
  ds_read_b64_tr_b16 a[246:247], v23 offset:21504
  ds_read_b64_tr_b16 a[248:249], v23 offset:24576
  ds_read_b64_tr_b16 a[250:251], v23 offset:25600
  ds_read_b64_tr_b16 a[252:253], v23 offset:28672
  ds_read_b64_tr_b16 a[254:255], v23 offset:29696
  s_waitcnt lgkmcnt(0)
  s_waitcnt vmcnt(16)
  s_barrier
  s_add_u32 s27, s26, 3145728
  s_add_u32 m0, s28, 32768
  s_nop 0
  buffer_load_dwordx4 v20, s[64:67], s27 offen lds
  s_add_u32 m0, s28, 33792
  s_add_u32 s27, s27, 32768
  buffer_load_dwordx4 v20, s[64:67], s27 offen lds
  s_add_u32 m0, s28, 34816
  s_add_u32 s27, s27, 32768
  buffer_load_dwordx4 v21, s[64:67], s27 offen lds
  s_add_u32 m0, s28, 35840
  s_add_u32 s27, s27, 32768
  buffer_load_dwordx4 v21, s[64:67], s27 offen lds
  s_add_u32 m0, s28, 36864
  s_add_u32 s27, s27, 32768
  buffer_load_dwordx4 v20, s[64:67], s27 offen lds
  s_add_u32 m0, s28, 37888
  s_add_u32 s27, s27, 32768
  buffer_load_dwordx4 v20, s[64:67], s27 offen lds
  s_add_u32 m0, s28, 38912
  s_add_u32 s27, s27, 32768
  buffer_load_dwordx4 v21, s[64:67], s27 offen lds
  s_add_u32 m0, s28, 39936
  s_add_u32 s27, s27, 32768
  buffer_load_dwordx4 v21, s[64:67], s27 offen lds
  ds_read_b64_tr_b16 v[128:129], v23 offset:32768
  ds_read_b64_tr_b16 v[130:131], v23 offset:33792
  ds_read_b64_tr_b16 v[132:133], v23 offset:36864
  ds_read_b64_tr_b16 v[134:135], v23 offset:37888
  ds_read_b64_tr_b16 v[136:137], v23 offset:40960
  ds_read_b64_tr_b16 v[138:139], v23 offset:41984
  ds_read_b64_tr_b16 v[140:141], v23 offset:45056
  ds_read_b64_tr_b16 v[142:143], v23 offset:46080
  ds_read_b64_tr_b16 v[144:145], v23 offset:49152
  ds_read_b64_tr_b16 v[146:147], v23 offset:50176
  ds_read_b64_tr_b16 v[148:149], v23 offset:53248
  ds_read_b64_tr_b16 v[150:151], v23 offset:54272
  ds_read_b64_tr_b16 v[152:153], v23 offset:57344
  ds_read_b64_tr_b16 v[154:155], v23 offset:58368
  ds_read_b64_tr_b16 v[156:157], v23 offset:61440
  ds_read_b64_tr_b16 v[158:159], v23 offset:62464
  s_waitcnt lgkmcnt(0)
  s_waitcnt vmcnt(16)
  s_barrier
  ds_read_b64_tr_b16 v[160:161], v24 offset:0
  ds_read_b64_tr_b16 v[162:163], v24 offset:1024
  ds_read_b64_tr_b16 v[164:165], v24 offset:4096
  ds_read_b64_tr_b16 v[166:167], v24 offset:5120
  ds_read_b64_tr_b16 v[168:169], v24 offset:8192
  ds_read_b64_tr_b16 v[170:171], v24 offset:9216
  ds_read_b64_tr_b16 v[172:173], v24 offset:12288
  ds_read_b64_tr_b16 v[174:175], v24 offset:13312
  ds_read_b64_tr_b16 v[176:177], v24 offset:16384
  ds_read_b64_tr_b16 v[178:179], v24 offset:17408
  ds_read_b64_tr_b16 v[180:181], v24 offset:20480
  ds_read_b64_tr_b16 v[182:183], v24 offset:21504
  ds_read_b64_tr_b16 v[184:185], v24 offset:24576
  ds_read_b64_tr_b16 v[186:187], v24 offset:25600
  ds_read_b64_tr_b16 v[188:189], v24 offset:28672
  ds_read_b64_tr_b16 v[190:191], v24 offset:29696
  s_waitcnt lgkmcnt(0)
  s_waitcnt vmcnt(8)
  s_barrier
  ds_read_b64_tr_b16 v[192:193], v22 offset:0
  ds_read_b64_tr_b16 v[194:195], v22 offset:1024
  ds_read_b64_tr_b16 v[196:197], v22 offset:4096
  ds_read_b64_tr_b16 v[198:199], v22 offset:5120
  ds_read_b64_tr_b16 v[200:201], v22 offset:8192
  ds_read_b64_tr_b16 v[202:203], v22 offset:9216
  ds_read_b64_tr_b16 v[204:205], v22 offset:12288
  ds_read_b64_tr_b16 v[206:207], v22 offset:13312
  ds_read_b64_tr_b16 v[208:209], v22 offset:16384
  ds_read_b64_tr_b16 v[210:211], v22 offset:17408
  ds_read_b64_tr_b16 v[212:213], v22 offset:20480
  ds_read_b64_tr_b16 v[214:215], v22 offset:21504
  ds_read_b64_tr_b16 v[216:217], v22 offset:24576
  ds_read_b64_tr_b16 v[218:219], v22 offset:25600
  ds_read_b64_tr_b16 v[220:221], v22 offset:28672
  ds_read_b64_tr_b16 v[222:223], v22 offset:29696
  s_waitcnt lgkmcnt(0)
  s_waitcnt vmcnt(0)
  s_barrier
  ds_read_b64_tr_b16 v[224:225], v22 offset:32768
  ds_read_b64_tr_b16 v[226:227], v22 offset:33792
  ds_read_b64_tr_b16 v[228:229], v22 offset:36864
  ds_read_b64_tr_b16 v[230:231], v22 offset:37888
  ds_read_b64_tr_b16 v[232:233], v22 offset:40960
  ds_read_b64_tr_b16 v[234:235], v22 offset:41984
  ds_read_b64_tr_b16 v[236:237], v22 offset:45056
  ds_read_b64_tr_b16 v[238:239], v22 offset:46080
  ds_read_b64_tr_b16 v[240:241], v22 offset:49152
  ds_read_b64_tr_b16 v[242:243], v22 offset:50176
  ds_read_b64_tr_b16 v[244:245], v22 offset:53248
  ds_read_b64_tr_b16 v[246:247], v22 offset:54272
  ds_read_b64_tr_b16 v[248:249], v22 offset:57344
  ds_read_b64_tr_b16 v[250:251], v22 offset:58368
  ds_read_b64_tr_b16 v[252:253], v22 offset:61440
  ds_read_b64_tr_b16 v[254:255], v22 offset:62464
  s_waitcnt lgkmcnt(0)
  s_branch q_ld_92
q_ld_91:
  s_add_u32 s27, s26, 0
  s_add_u32 m0, s28, 0
  s_nop 0
  buffer_load_dwordx4 v20, s[8:11], s27 offen lds
  s_add_u32 m0, s28, 1024
  s_add_u32 s27, s27, 32768
  buffer_load_dwordx4 v20, s[8:11], s27 offen lds
  s_add_u32 m0, s28, 2048
  s_add_u32 s27, s27, 32768
  buffer_load_dwordx4 v21, s[8:11], s27 offen lds
  s_add_u32 m0, s28, 3072
  s_add_u32 s27, s27, 32768
  buffer_load_dwordx4 v21, s[8:11], s27 offen lds
  s_add_u32 m0, s28, 4096
  s_add_u32 s27, s27, 32768
  buffer_load_dwordx4 v20, s[8:11], s27 offen lds
  s_add_u32 m0, s28, 5120
  s_add_u32 s27, s27, 32768
  buffer_load_dwordx4 v20, s[8:11], s27 offen lds
  s_add_u32 m0, s28, 6144
  s_add_u32 s27, s27, 32768
  buffer_load_dwordx4 v21, s[8:11], s27 offen lds
  s_add_u32 m0, s28, 7168
  s_add_u32 s27, s27, 32768
  buffer_load_dwordx4 v21, s[8:11], s27 offen lds
  s_add_u32 s27, s26, 1048576
  s_add_u32 m0, s28, 32768
  s_nop 0
  buffer_load_dwordx4 v20, s[8:11], s27 offen lds
  s_add_u32 m0, s28, 33792
  s_add_u32 s27, s27, 32768
  buffer_load_dwordx4 v20, s[8:11], s27 offen lds
  s_add_u32 m0, s28, 34816
  s_add_u32 s27, s27, 32768
  buffer_load_dwordx4 v21, s[8:11], s27 offen lds
  s_add_u32 m0, s28, 35840
  s_add_u32 s27, s27, 32768
  buffer_load_dwordx4 v21, s[8:11], s27 offen lds
  s_add_u32 m0, s28, 36864
  s_add_u32 s27, s27, 32768
  buffer_load_dwordx4 v20, s[8:11], s27 offen lds
  s_add_u32 m0, s28, 37888
  s_add_u32 s27, s27, 32768
  buffer_load_dwordx4 v20, s[8:11], s27 offen lds
  s_add_u32 m0, s28, 38912
  s_add_u32 s27, s27, 32768
  buffer_load_dwordx4 v21, s[8:11], s27 offen lds
  s_add_u32 m0, s28, 39936
  s_add_u32 s27, s27, 32768
  buffer_load_dwordx4 v21, s[8:11], s27 offen lds
  s_add_u32 s27, s26, 2097152
  s_add_u32 m0, s28, 65536
  s_nop 0
  buffer_load_dwordx4 v20, s[8:11], s27 offen lds
  s_add_u32 m0, s28, 66560
  s_add_u32 s27, s27, 32768
  buffer_load_dwordx4 v20, s[8:11], s27 offen lds
  s_add_u32 m0, s28, 67584
  s_add_u32 s27, s27, 32768
  buffer_load_dwordx4 v21, s[8:11], s27 offen lds
  s_add_u32 m0, s28, 68608
  s_add_u32 s27, s27, 32768
  buffer_load_dwordx4 v21, s[8:11], s27 offen lds
  s_add_u32 m0, s28, 69632
  s_add_u32 s27, s27, 32768
  buffer_load_dwordx4 v20, s[8:11], s27 offen lds
  s_add_u32 m0, s28, 70656
  s_add_u32 s27, s27, 32768
  buffer_load_dwordx4 v20, s[8:11], s27 offen lds
  s_add_u32 m0, s28, 71680
  s_add_u32 s27, s27, 32768
  buffer_load_dwordx4 v21, s[8:11], s27 offen lds
  s_add_u32 m0, s28, 72704
  s_add_u32 s27, s27, 32768
  buffer_load_dwordx4 v21, s[8:11], s27 offen lds
  s_load_dwordx2 s[4:5], s[0:1], 112
  s_load_dwordx2 s[12:13], s[0:1], 104
  s_waitcnt vmcnt(16)
  s_barrier
  s_add_u32 s27, s26, 3145728
  s_add_u32 m0, s28, 98304
  s_nop 0
  buffer_load_dwordx4 v20, s[8:11], s27 offen lds
  s_add_u32 m0, s28, 99328
  s_add_u32 s27, s27, 32768
  buffer_load_dwordx4 v20, s[8:11], s27 offen lds
  s_add_u32 m0, s28, 100352
  s_add_u32 s27, s27, 32768
  buffer_load_dwordx4 v21, s[8:11], s27 offen lds
  s_add_u32 m0, s28, 101376
  s_add_u32 s27, s27, 32768
  buffer_load_dwordx4 v21, s[8:11], s27 offen lds
  s_add_u32 m0, s28, 102400
  s_add_u32 s27, s27, 32768
  buffer_load_dwordx4 v20, s[8:11], s27 offen lds
  s_add_u32 m0, s28, 103424
  s_add_u32 s27, s27, 32768
  buffer_load_dwordx4 v20, s[8:11], s27 offen lds
  s_add_u32 m0, s28, 104448
  s_add_u32 s27, s27, 32768
  buffer_load_dwordx4 v21, s[8:11], s27 offen lds
  s_add_u32 m0, s28, 105472
  s_add_u32 s27, s27, 32768
  buffer_load_dwordx4 v21, s[8:11], s27 offen lds
  ds_read_b64_tr_b16 a[128:129], v22 offset:0
  ds_read_b64_tr_b16 a[130:131], v22 offset:1024
  ds_read_b64_tr_b16 a[132:133], v22 offset:4096
  ds_read_b64_tr_b16 a[134:135], v22 offset:5120
  ds_read_b64_tr_b16 a[136:137], v22 offset:8192
  ds_read_b64_tr_b16 a[138:139], v22 offset:9216
  ds_read_b64_tr_b16 a[140:141], v22 offset:12288
  ds_read_b64_tr_b16 a[142:143], v22 offset:13312
  ds_read_b64_tr_b16 a[144:145], v22 offset:16384
  ds_read_b64_tr_b16 a[146:147], v22 offset:17408
  ds_read_b64_tr_b16 a[148:149], v22 offset:20480
  ds_read_b64_tr_b16 a[150:151], v22 offset:21504
  ds_read_b64_tr_b16 a[152:153], v22 offset:24576
  ds_read_b64_tr_b16 a[154:155], v22 offset:25600
  ds_read_b64_tr_b16 a[156:157], v22 offset:28672
  ds_read_b64_tr_b16 a[158:159], v22 offset:29696
  s_waitcnt lgkmcnt(0)
  s_waitcnt vmcnt(16)
  s_barrier
  s_add_u32 s27, s26, 0
  s_add_u32 m0, s28, 131072
  s_nop 0
  buffer_load_dwordx4 v20, s[64:67], s27 offen lds
  s_add_u32 m0, s28, 132096
  s_add_u32 s27, s27, 32768
  buffer_load_dwordx4 v20, s[64:67], s27 offen lds
  s_add_u32 m0, s28, 133120
  s_add_u32 s27, s27, 32768
  buffer_load_dwordx4 v21, s[64:67], s27 offen lds
  s_add_u32 m0, s28, 134144
  s_add_u32 s27, s27, 32768
  buffer_load_dwordx4 v21, s[64:67], s27 offen lds
  s_add_u32 m0, s28, 135168
  s_add_u32 s27, s27, 32768
  buffer_load_dwordx4 v20, s[64:67], s27 offen lds
  s_add_u32 m0, s28, 136192
  s_add_u32 s27, s27, 32768
  buffer_load_dwordx4 v20, s[64:67], s27 offen lds
  s_add_u32 m0, s28, 137216
  s_add_u32 s27, s27, 32768
  buffer_load_dwordx4 v21, s[64:67], s27 offen lds
  s_add_u32 m0, s28, 138240
  s_add_u32 s27, s27, 32768
  buffer_load_dwordx4 v21, s[64:67], s27 offen lds
  ds_read_b64_tr_b16 a[160:161], v22 offset:32768
  ds_read_b64_tr_b16 a[162:163], v22 offset:33792
  ds_read_b64_tr_b16 a[164:165], v22 offset:36864
  ds_read_b64_tr_b16 a[166:167], v22 offset:37888
  ds_read_b64_tr_b16 a[168:169], v22 offset:40960
  ds_read_b64_tr_b16 a[170:171], v22 offset:41984
  ds_read_b64_tr_b16 a[172:173], v22 offset:45056
  ds_read_b64_tr_b16 a[174:175], v22 offset:46080
  ds_read_b64_tr_b16 a[176:177], v22 offset:49152
  ds_read_b64_tr_b16 a[178:179], v22 offset:50176
  ds_read_b64_tr_b16 a[180:181], v22 offset:53248
  ds_read_b64_tr_b16 a[182:183], v22 offset:54272
  ds_read_b64_tr_b16 a[184:185], v22 offset:57344
  ds_read_b64_tr_b16 a[186:187], v22 offset:58368
  ds_read_b64_tr_b16 a[188:189], v22 offset:61440
  ds_read_b64_tr_b16 a[190:191], v22 offset:62464
  s_waitcnt lgkmcnt(0)
  s_waitcnt vmcnt(16)
  s_barrier
  s_add_u32 s27, s26, 1048576
  s_add_u32 m0, s28, 0
  s_nop 0
  buffer_load_dwordx4 v20, s[64:67], s27 offen lds
  s_add_u32 m0, s28, 1024
  s_add_u32 s27, s27, 32768
  buffer_load_dwordx4 v20, s[64:67], s27 offen lds
  s_add_u32 m0, s28, 2048
  s_add_u32 s27, s27, 32768
  buffer_load_dwordx4 v21, s[64:67], s27 offen lds
  s_add_u32 m0, s28, 3072
  s_add_u32 s27, s27, 32768
  buffer_load_dwordx4 v21, s[64:67], s27 offen lds
  s_add_u32 m0, s28, 4096
  s_add_u32 s27, s27, 32768
  buffer_load_dwordx4 v20, s[64:67], s27 offen lds
  s_add_u32 m0, s28, 5120
  s_add_u32 s27, s27, 32768
  buffer_load_dwordx4 v20, s[64:67], s27 offen lds
  s_add_u32 m0, s28, 6144
  s_add_u32 s27, s27, 32768
  buffer_load_dwordx4 v21, s[64:67], s27 offen lds
  s_add_u32 m0, s28, 7168
  s_add_u32 s27, s27, 32768
  buffer_load_dwordx4 v21, s[64:67], s27 offen lds
  ds_read_b64_tr_b16 a[192:193], v23 offset:0
  ds_read_b64_tr_b16 a[194:195], v23 offset:1024
  ds_read_b64_tr_b16 a[196:197], v23 offset:4096
  ds_read_b64_tr_b16 a[198:199], v23 offset:5120
  ds_read_b64_tr_b16 a[200:201], v23 offset:8192
  ds_read_b64_tr_b16 a[202:203], v23 offset:9216
  ds_read_b64_tr_b16 a[204:205], v23 offset:12288
  ds_read_b64_tr_b16 a[206:207], v23 offset:13312
  ds_read_b64_tr_b16 a[208:209], v23 offset:16384
  ds_read_b64_tr_b16 a[210:211], v23 offset:17408
  ds_read_b64_tr_b16 a[212:213], v23 offset:20480
  ds_read_b64_tr_b16 a[214:215], v23 offset:21504
  ds_read_b64_tr_b16 a[216:217], v23 offset:24576
  ds_read_b64_tr_b16 a[218:219], v23 offset:25600
  ds_read_b64_tr_b16 a[220:221], v23 offset:28672
  ds_read_b64_tr_b16 a[222:223], v23 offset:29696
  s_waitcnt lgkmcnt(0)
  s_waitcnt vmcnt(16)
  s_barrier
  s_add_u32 s27, s26, 2097152
  s_add_u32 m0, s28, 32768
  s_nop 0
  buffer_load_dwordx4 v20, s[64:67], s27 offen lds
  s_add_u32 m0, s28, 33792
  s_add_u32 s27, s27, 32768
  buffer_load_dwordx4 v20, s[64:67], s27 offen lds
  s_add_u32 m0, s28, 34816
  s_add_u32 s27, s27, 32768
  buffer_load_dwordx4 v21, s[64:67], s27 offen lds
  s_add_u32 m0, s28, 35840
  s_add_u32 s27, s27, 32768
  buffer_load_dwordx4 v21, s[64:67], s27 offen lds
  s_add_u32 m0, s28, 36864
  s_add_u32 s27, s27, 32768
  buffer_load_dwordx4 v20, s[64:67], s27 offen lds
  s_add_u32 m0, s28, 37888
  s_add_u32 s27, s27, 32768
  buffer_load_dwordx4 v20, s[64:67], s27 offen lds
  s_add_u32 m0, s28, 38912
  s_add_u32 s27, s27, 32768
  buffer_load_dwordx4 v21, s[64:67], s27 offen lds
  s_add_u32 m0, s28, 39936
  s_add_u32 s27, s27, 32768
  buffer_load_dwordx4 v21, s[64:67], s27 offen lds
  ds_read_b64_tr_b16 a[224:225], v23 offset:32768
  ds_read_b64_tr_b16 a[226:227], v23 offset:33792
  ds_read_b64_tr_b16 a[228:229], v23 offset:36864
  ds_read_b64_tr_b16 a[230:231], v23 offset:37888
  ds_read_b64_tr_b16 a[232:233], v23 offset:40960
  ds_read_b64_tr_b16 a[234:235], v23 offset:41984
  ds_read_b64_tr_b16 a[236:237], v23 offset:45056
  ds_read_b64_tr_b16 a[238:239], v23 offset:46080
  ds_read_b64_tr_b16 a[240:241], v23 offset:49152
  ds_read_b64_tr_b16 a[242:243], v23 offset:50176
  ds_read_b64_tr_b16 a[244:245], v23 offset:53248
  ds_read_b64_tr_b16 a[246:247], v23 offset:54272
  ds_read_b64_tr_b16 a[248:249], v23 offset:57344
  ds_read_b64_tr_b16 a[250:251], v23 offset:58368
  ds_read_b64_tr_b16 a[252:253], v23 offset:61440
  ds_read_b64_tr_b16 a[254:255], v23 offset:62464
  s_waitcnt lgkmcnt(0)
  s_waitcnt vmcnt(16)
  s_barrier
  s_add_u32 s27, s26, 3145728
  s_add_u32 m0, s28, 65536
  s_nop 0
  buffer_load_dwordx4 v20, s[64:67], s27 offen lds
  s_add_u32 m0, s28, 66560
  s_add_u32 s27, s27, 32768
  buffer_load_dwordx4 v20, s[64:67], s27 offen lds
  s_add_u32 m0, s28, 67584
  s_add_u32 s27, s27, 32768
  buffer_load_dwordx4 v21, s[64:67], s27 offen lds
  s_add_u32 m0, s28, 68608
  s_add_u32 s27, s27, 32768
  buffer_load_dwordx4 v21, s[64:67], s27 offen lds
  s_add_u32 m0, s28, 69632
  s_add_u32 s27, s27, 32768
  buffer_load_dwordx4 v20, s[64:67], s27 offen lds
  s_add_u32 m0, s28, 70656
  s_add_u32 s27, s27, 32768
  buffer_load_dwordx4 v20, s[64:67], s27 offen lds
  s_add_u32 m0, s28, 71680
  s_add_u32 s27, s27, 32768
  buffer_load_dwordx4 v21, s[64:67], s27 offen lds
  s_add_u32 m0, s28, 72704
  s_add_u32 s27, s27, 32768
  buffer_load_dwordx4 v21, s[64:67], s27 offen lds
  ds_read_b64_tr_b16 v[128:129], v24 offset:0
  ds_read_b64_tr_b16 v[130:131], v24 offset:1024
  ds_read_b64_tr_b16 v[132:133], v24 offset:4096
  ds_read_b64_tr_b16 v[134:135], v24 offset:5120
  ds_read_b64_tr_b16 v[136:137], v24 offset:8192
  ds_read_b64_tr_b16 v[138:139], v24 offset:9216
  ds_read_b64_tr_b16 v[140:141], v24 offset:12288
  ds_read_b64_tr_b16 v[142:143], v24 offset:13312
  ds_read_b64_tr_b16 v[144:145], v24 offset:16384
  ds_read_b64_tr_b16 v[146:147], v24 offset:17408
  ds_read_b64_tr_b16 v[148:149], v24 offset:20480
  ds_read_b64_tr_b16 v[150:151], v24 offset:21504
  ds_read_b64_tr_b16 v[152:153], v24 offset:24576
  ds_read_b64_tr_b16 v[154:155], v24 offset:25600
  ds_read_b64_tr_b16 v[156:157], v24 offset:28672
  ds_read_b64_tr_b16 v[158:159], v24 offset:29696
  s_waitcnt lgkmcnt(0)
  s_waitcnt vmcnt(16)
  s_barrier
  s_add_u32 s27, s26, 0
  s_add_u32 m0, s28, 98304
  s_nop 0
  buffer_load_dwordx4 v20, s[68:71], s27 offen lds
  s_add_u32 m0, s28, 99328
  s_add_u32 s27, s27, 32768
  buffer_load_dwordx4 v20, s[68:71], s27 offen lds
  s_add_u32 m0, s28, 100352
  s_add_u32 s27, s27, 32768
  buffer_load_dwordx4 v21, s[68:71], s27 offen lds
  s_add_u32 m0, s28, 101376
  s_add_u32 s27, s27, 32768
  buffer_load_dwordx4 v21, s[68:71], s27 offen lds
  s_add_u32 m0, s28, 102400
  s_add_u32 s27, s27, 32768
  buffer_load_dwordx4 v20, s[68:71], s27 offen lds
  s_add_u32 m0, s28, 103424
  s_add_u32 s27, s27, 32768
  buffer_load_dwordx4 v20, s[68:71], s27 offen lds
  s_add_u32 m0, s28, 104448
  s_add_u32 s27, s27, 32768
  buffer_load_dwordx4 v21, s[68:71], s27 offen lds
  s_add_u32 m0, s28, 105472
  s_add_u32 s27, s27, 32768
  buffer_load_dwordx4 v21, s[68:71], s27 offen lds
  ds_read_b64_tr_b16 v[160:161], v22 offset:0
  ds_read_b64_tr_b16 v[162:163], v22 offset:1024
  ds_read_b64_tr_b16 v[164:165], v22 offset:4096
  ds_read_b64_tr_b16 v[166:167], v22 offset:5120
  ds_read_b64_tr_b16 v[168:169], v22 offset:8192
  ds_read_b64_tr_b16 v[170:171], v22 offset:9216
  ds_read_b64_tr_b16 v[172:173], v22 offset:12288
  ds_read_b64_tr_b16 v[174:175], v22 offset:13312
  ds_read_b64_tr_b16 v[176:177], v22 offset:16384
  ds_read_b64_tr_b16 v[178:179], v22 offset:17408
  ds_read_b64_tr_b16 v[180:181], v22 offset:20480
  ds_read_b64_tr_b16 v[182:183], v22 offset:21504
  ds_read_b64_tr_b16 v[184:185], v22 offset:24576
  ds_read_b64_tr_b16 v[186:187], v22 offset:25600
  ds_read_b64_tr_b16 v[188:189], v22 offset:28672
  ds_read_b64_tr_b16 v[190:191], v22 offset:29696
  s_waitcnt lgkmcnt(0)
  s_waitcnt vmcnt(16)
  s_barrier
  s_add_u32 s27, s26, 1048576
  s_add_u32 m0, s28, 131072
  s_nop 0
  buffer_load_dwordx4 v20, s[68:71], s27 offen lds
  s_add_u32 m0, s28, 132096
  s_add_u32 s27, s27, 32768
  buffer_load_dwordx4 v20, s[68:71], s27 offen lds
  s_add_u32 m0, s28, 133120
  s_add_u32 s27, s27, 32768
  buffer_load_dwordx4 v21, s[68:71], s27 offen lds
  s_add_u32 m0, s28, 134144
  s_add_u32 s27, s27, 32768
  buffer_load_dwordx4 v21, s[68:71], s27 offen lds
  s_add_u32 m0, s28, 135168
  s_add_u32 s27, s27, 32768
  buffer_load_dwordx4 v20, s[68:71], s27 offen lds
  s_add_u32 m0, s28, 136192
  s_add_u32 s27, s27, 32768
  buffer_load_dwordx4 v20, s[68:71], s27 offen lds
  s_add_u32 m0, s28, 137216
  s_add_u32 s27, s27, 32768
  buffer_load_dwordx4 v21, s[68:71], s27 offen lds
  s_add_u32 m0, s28, 138240
  s_add_u32 s27, s27, 32768
  buffer_load_dwordx4 v21, s[68:71], s27 offen lds
  ds_read_b64_tr_b16 v[192:193], v22 offset:32768
  ds_read_b64_tr_b16 v[194:195], v22 offset:33792
  ds_read_b64_tr_b16 v[196:197], v22 offset:36864
  ds_read_b64_tr_b16 v[198:199], v22 offset:37888
  ds_read_b64_tr_b16 v[200:201], v22 offset:40960
  ds_read_b64_tr_b16 v[202:203], v22 offset:41984
  ds_read_b64_tr_b16 v[204:205], v22 offset:45056
  ds_read_b64_tr_b16 v[206:207], v22 offset:46080
  ds_read_b64_tr_b16 v[208:209], v22 offset:49152
  ds_read_b64_tr_b16 v[210:211], v22 offset:50176
  ds_read_b64_tr_b16 v[212:213], v22 offset:53248
  ds_read_b64_tr_b16 v[214:215], v22 offset:54272
  ds_read_b64_tr_b16 v[216:217], v22 offset:57344
  ds_read_b64_tr_b16 v[218:219], v22 offset:58368
  ds_read_b64_tr_b16 v[220:221], v22 offset:61440
  ds_read_b64_tr_b16 v[222:223], v22 offset:62464
  s_waitcnt lgkmcnt(0)
  s_waitcnt vmcnt(16)
  s_barrier
  s_add_u32 s27, s26, 2097152
  s_add_u32 m0, s28, 0
  s_nop 0
  buffer_load_dwordx4 v20, s[68:71], s27 offen lds
  s_add_u32 m0, s28, 1024
  s_add_u32 s27, s27, 32768
  buffer_load_dwordx4 v20, s[68:71], s27 offen lds
  s_add_u32 m0, s28, 2048
  s_add_u32 s27, s27, 32768
  buffer_load_dwordx4 v21, s[68:71], s27 offen lds
  s_add_u32 m0, s28, 3072
  s_add_u32 s27, s27, 32768
  buffer_load_dwordx4 v21, s[68:71], s27 offen lds
  s_add_u32 m0, s28, 4096
  s_add_u32 s27, s27, 32768
  buffer_load_dwordx4 v20, s[68:71], s27 offen lds
  s_add_u32 m0, s28, 5120
  s_add_u32 s27, s27, 32768
  buffer_load_dwordx4 v20, s[68:71], s27 offen lds
  s_add_u32 m0, s28, 6144
  s_add_u32 s27, s27, 32768
  buffer_load_dwordx4 v21, s[68:71], s27 offen lds
  s_add_u32 m0, s28, 7168
  s_add_u32 s27, s27, 32768
  buffer_load_dwordx4 v21, s[68:71], s27 offen lds
  ds_read_b64_tr_b16 v[224:225], v23 offset:0
  ds_read_b64_tr_b16 v[226:227], v23 offset:1024
  ds_read_b64_tr_b16 v[228:229], v23 offset:4096
  ds_read_b64_tr_b16 v[230:231], v23 offset:5120
  ds_read_b64_tr_b16 v[232:233], v23 offset:8192
  ds_read_b64_tr_b16 v[234:235], v23 offset:9216
  ds_read_b64_tr_b16 v[236:237], v23 offset:12288
  ds_read_b64_tr_b16 v[238:239], v23 offset:13312
  ds_read_b64_tr_b16 v[240:241], v23 offset:16384
  ds_read_b64_tr_b16 v[242:243], v23 offset:17408
  ds_read_b64_tr_b16 v[244:245], v23 offset:20480
  ds_read_b64_tr_b16 v[246:247], v23 offset:21504
  ds_read_b64_tr_b16 v[248:249], v23 offset:24576
  ds_read_b64_tr_b16 v[250:251], v23 offset:25600
  ds_read_b64_tr_b16 v[252:253], v23 offset:28672
  ds_read_b64_tr_b16 v[254:255], v23 offset:29696
  s_waitcnt lgkmcnt(0)
  s_waitcnt vmcnt(16)
  s_barrier
  s_add_u32 s27, s26, 3145728
  s_add_u32 m0, s28, 32768
  s_nop 0
  buffer_load_dwordx4 v20, s[68:71], s27 offen lds
  s_add_u32 m0, s28, 33792
  s_add_u32 s27, s27, 32768
  buffer_load_dwordx4 v20, s[68:71], s27 offen lds
  s_add_u32 m0, s28, 34816
  s_add_u32 s27, s27, 32768
  buffer_load_dwordx4 v21, s[68:71], s27 offen lds
  s_add_u32 m0, s28, 35840
  s_add_u32 s27, s27, 32768
  buffer_load_dwordx4 v21, s[68:71], s27 offen lds
  s_add_u32 m0, s28, 36864
  s_add_u32 s27, s27, 32768
  buffer_load_dwordx4 v20, s[68:71], s27 offen lds
  s_add_u32 m0, s28, 37888
  s_add_u32 s27, s27, 32768
  buffer_load_dwordx4 v20, s[68:71], s27 offen lds
  s_add_u32 m0, s28, 38912
  s_add_u32 s27, s27, 32768
  buffer_load_dwordx4 v21, s[68:71], s27 offen lds
  s_add_u32 m0, s28, 39936
  s_add_u32 s27, s27, 32768
  buffer_load_dwordx4 v21, s[68:71], s27 offen lds
  ds_read_b64_tr_b16 a[0:1], v23 offset:32768
  ds_read_b64_tr_b16 a[2:3], v23 offset:33792
  ds_read_b64_tr_b16 a[4:5], v23 offset:36864
  ds_read_b64_tr_b16 a[6:7], v23 offset:37888
  ds_read_b64_tr_b16 a[8:9], v23 offset:40960
  ds_read_b64_tr_b16 a[10:11], v23 offset:41984
  ds_read_b64_tr_b16 a[12:13], v23 offset:45056
  ds_read_b64_tr_b16 a[14:15], v23 offset:46080
  ds_read_b64_tr_b16 a[16:17], v23 offset:49152
  ds_read_b64_tr_b16 a[18:19], v23 offset:50176
  ds_read_b64_tr_b16 a[20:21], v23 offset:53248
  ds_read_b64_tr_b16 a[22:23], v23 offset:54272
  ds_read_b64_tr_b16 a[24:25], v23 offset:57344
  ds_read_b64_tr_b16 a[26:27], v23 offset:58368
  ds_read_b64_tr_b16 a[28:29], v23 offset:61440
  ds_read_b64_tr_b16 a[30:31], v23 offset:62464
  s_waitcnt lgkmcnt(0)
  s_waitcnt vmcnt(16)
  s_barrier
  ds_read_b64_tr_b16 a[32:33], v24 offset:0
  ds_read_b64_tr_b16 a[34:35], v24 offset:1024
  ds_read_b64_tr_b16 a[36:37], v24 offset:4096
  ds_read_b64_tr_b16 a[38:39], v24 offset:5120
  ds_read_b64_tr_b16 a[40:41], v24 offset:8192
  ds_read_b64_tr_b16 a[42:43], v24 offset:9216
  ds_read_b64_tr_b16 a[44:45], v24 offset:12288
  ds_read_b64_tr_b16 a[46:47], v24 offset:13312
  ds_read_b64_tr_b16 a[48:49], v24 offset:16384
  ds_read_b64_tr_b16 a[50:51], v24 offset:17408
  ds_read_b64_tr_b16 a[52:53], v24 offset:20480
  ds_read_b64_tr_b16 a[54:55], v24 offset:21504
  ds_read_b64_tr_b16 a[56:57], v24 offset:24576
  ds_read_b64_tr_b16 a[58:59], v24 offset:25600
  ds_read_b64_tr_b16 a[60:61], v24 offset:28672
  ds_read_b64_tr_b16 a[62:63], v24 offset:29696
  s_waitcnt lgkmcnt(0)
  s_waitcnt vmcnt(8)
  s_barrier
  ds_read_b64_tr_b16 a[64:65], v22 offset:0
  ds_read_b64_tr_b16 a[66:67], v22 offset:1024
  ds_read_b64_tr_b16 a[68:69], v22 offset:4096
  ds_read_b64_tr_b16 a[70:71], v22 offset:5120
  ds_read_b64_tr_b16 a[72:73], v22 offset:8192
  ds_read_b64_tr_b16 a[74:75], v22 offset:9216
  ds_read_b64_tr_b16 a[76:77], v22 offset:12288
  ds_read_b64_tr_b16 a[78:79], v22 offset:13312
  ds_read_b64_tr_b16 a[80:81], v22 offset:16384
  ds_read_b64_tr_b16 a[82:83], v22 offset:17408
  ds_read_b64_tr_b16 a[84:85], v22 offset:20480
  ds_read_b64_tr_b16 a[86:87], v22 offset:21504
  ds_read_b64_tr_b16 a[88:89], v22 offset:24576
  ds_read_b64_tr_b16 a[90:91], v22 offset:25600
  ds_read_b64_tr_b16 a[92:93], v22 offset:28672
  ds_read_b64_tr_b16 a[94:95], v22 offset:29696
  s_waitcnt lgkmcnt(0)
  s_waitcnt vmcnt(0)
  s_barrier
  ds_read_b64_tr_b16 a[96:97], v22 offset:32768
  ds_read_b64_tr_b16 a[98:99], v22 offset:33792
  ds_read_b64_tr_b16 a[100:101], v22 offset:36864
  ds_read_b64_tr_b16 a[102:103], v22 offset:37888
  ds_read_b64_tr_b16 a[104:105], v22 offset:40960
  ds_read_b64_tr_b16 a[106:107], v22 offset:41984
  ds_read_b64_tr_b16 a[108:109], v22 offset:45056
  ds_read_b64_tr_b16 a[110:111], v22 offset:46080
  ds_read_b64_tr_b16 a[112:113], v22 offset:49152
  ds_read_b64_tr_b16 a[114:115], v22 offset:50176
  ds_read_b64_tr_b16 a[116:117], v22 offset:53248
  ds_read_b64_tr_b16 a[118:119], v22 offset:54272
  ds_read_b64_tr_b16 a[120:121], v22 offset:57344
  ds_read_b64_tr_b16 a[122:123], v22 offset:58368
  ds_read_b64_tr_b16 a[124:125], v22 offset:61440
  ds_read_b64_tr_b16 a[126:127], v22 offset:62464
  s_waitcnt lgkmcnt(0)
q_ld_92:
  s_waitcnt lgkmcnt(0)
  s_barrier
  v_mbcnt_lo_u32_b32 v20, -1, 0
  v_and_b32 v20, 0, v20
  v_add_lshl_u32 v20, v20, 1, 2
  s_mov_b32 s26, 0
g_wt_93:
  global_load_dword v21, v20, s[12:13] offset:128 sc1
  s_add_u32 s26, s26, 1
  s_cmp_gt_u32 s26, 1048576
  s_cbranch_scc1 L_end
  s_waitcnt vmcnt(0)
  v_cmp_eq_u32 vcc, 0, v21
  v_readfirstlane_b32 s27, v21
  s_cbranch_vccnz g_wt_93
  v_lshrrev_b32 v7, 7, v0
  v_lshlrev_b32 v7, 12, v7
  v_and_b32 v2, 1023, v9
  s_lshl_b32 s26, s17, 10
  v_add3_u32 v7, v7, v2, s26
  v_mov_b32 v116, 0
  s_mov_b32 s47, s60
  s_add_u32 s76, s60, 3
  s_add_u32 s41, s60, 64
  s_mov_b32 s40, 18
  s_mov_b32 s42, 0
  s_mov_b32 s48, 0
  s_mov_b32 s49, 268435456
  s_mov_b32 s43, 268435456
  s_mov_b32 s50, 32768
  s_mov_b32 s56, 1
  s_mov_b32 s61, 0
  s_mov_b32 s62, 0
  s_lshl_b32 s54, s17, 13
  s_mov_b32 s50, 0
  v_mov_b32 v4, 1
q_slow_94:
  s_nop 1
  s_nop 7
  v_cvt_pk_bf16_f32 v100, v52, v53
  v_cvt_pk_bf16_f32 v101, v54, v55
  v_cvt_pk_bf16_f32 v102, v60, v61
  v_cvt_pk_bf16_f32 v103, v62, v63
  v_cvt_pk_bf16_f32 v104, v56, v57
  v_cvt_pk_bf16_f32 v105, v58, v59
  v_cvt_pk_bf16_f32 v106, v64, v65
  v_cvt_pk_bf16_f32 v107, v66, v67
  s_waitcnt vmcnt(0)
  s_mov_b64 exec, 1
  buffer_store_dword v4, off, s[4:7], s49 sc1
  s_mov_b64 exec, -1
  buffer_store_dwordx4 v[100:103], v8, s[4:7], s43 offen offset:0 sc1
  buffer_store_dwordx4 v[104:107], v8, s[4:7], s43 offen offset:512 sc1
  s_mov_b32 s43, 268435456
  s_xor_b32 s50, s50, 32768
q_nxt_104:
  s_cmp_ge_u32 s47, 128
  s_cbranch_scc1 q_end_95
  s_cmp_lg_u32 s48, 0
  s_cbranch_scc1 q_have_96
  s_mov_b32 s53, 0
q_poll_97:
  s_cmp_lt_u32 s47, 64
  s_cselect_b32 s26, 2, 0
  s_add_u32 s26, s26, s47
  s_lshl_b32 s26, s26, 12
  s_add_u32 s26, s26, 243261440
  s_mov_b64 exec, 0xffffff
  buffer_load_dword v116, v7, s[4:7], s26 offen sc1
  s_mov_b64 exec, -1
  s_add_u32 s53, s53, 1
  s_cmp_gt_u32 s53, 1048576
  s_cbranch_scc1 q_fail_98
  s_waitcnt vmcnt(0)
  s_mov_b64 exec, 3
  buffer_store_dword v4, v0, s[4:7], s49 offen sc1
  s_mov_b64 exec, -1
  s_mov_b32 s49, 268435456
  v_cmp_eq_u32 vcc, 0, v116
  s_nop 0
  s_and_b32 s26, vcc_lo, 0xffffff
  s_cbranch_scc1 q_poll_97
  s_and_b32 s63, s47, 127
  s_lshl_b32 s63, s63, 15
  s_xor_b32 s27, s50, 32768
  s_add_u32 m0, s27, s54
  s_add_u32 s63, s63, s54
  s_add_u32 s63, s63, 6291456
  buffer_load_dwordx4 v12, s[4:7], s63 offen offset:0 sc1 lds
  buffer_load_dwordx4 v13, s[4:7], s63 offen offset:1024 sc1 lds
  buffer_load_dwordx4 v14, s[4:7], s63 offen offset:2048 sc1 lds
  buffer_load_dwordx4 v15, s[4:7], s63 offen offset:3072 sc1 lds
  s_add_u32 m0, m0, 4096
  s_add_u32 s63, s63, 4096
  buffer_load_dwordx4 v16, s[4:7], s63 offen offset:0 sc1 lds
  buffer_load_dwordx4 v17, s[4:7], s63 offen offset:1024 sc1 lds
  buffer_load_dwordx4 v18, s[4:7], s63 offen offset:2048 sc1 lds
  buffer_load_dwordx4 v19, s[4:7], s63 offen offset:3072 sc1 lds
  v_cmp_eq_u32 vcc, 0, v116
  v_max_u32_dpp v117, v116, v116 quad_perm:[1,0,3,2] row_mask:0xf bank_mask:0xf
  s_and_b32 s48, vcc_lo, 0xffffff
  s_cselect_b32 s48, 0, -1
  v_max_u32_dpp v117, v117, v117 quad_perm:[2,3,0,1] row_mask:0xf bank_mask:0xf
  s_nop 1
  v_max_u32_dpp v117, v117, v117 row_half_mirror row_mask:0xf bank_mask:0xf
  v_and_b32 v117, s48, v117
q_have_96:
  ds_write_b32 v118, v117 offset:256
  s_xor_b32 s50, s50, 32768
  s_waitcnt lgkmcnt(0)
  s_barrier
  ds_read_b128 v[108:111], v119 offset:256
  s_cmp_lt_u32 s47, 64
  s_cbranch_scc1 q_nopre_100
  s_waitcnt lgkmcnt(0)
  v_min3_u32 v112, v108, v109, v110
  v_max3_u32 v108, v108, v109, v110
  v_min_u32 v112, v112, v111
  v_max_u32 v108, v108, v111
  v_readfirstlane_b32 s45, v112
  v_readlane_b32 s28, v108, 0
  v_readlane_b32 s29, v108, 1
  v_readlane_b32 s30, v108, 2
  s_cmp_gt_u32 s28, s56
  s_addc_u32 s42, s42, s42
  s_max_u32 s56, s56, s28
  s_and_b32 s26, s42, 1
  s_cselect_b32 s26, s40, 0
  s_cmp_gt_u32 s26, 10
  s_subb_u32 s40, s40, 0
  s_cmp_gt_u32 s29, s56
  s_addc_u32 s42, s42, s42
  s_max_u32 s56, s56, s29
  s_and_b32 s26, s42, 1
  s_cselect_b32 s26, s40, 0
  s_cmp_gt_u32 s26, 10
  s_subb_u32 s40, s40, 0
  s_cmp_gt_u32 s30, s56
  s_addc_u32 s42, s42, s42
  s_max_u32 s56, s56, s30
  s_add_u32 s76, s47, s40
  s_add_u32 s41, s47, 3
  s_sub_u32 s76, s76, 64
  s_and_b32 s26, s42, 1
  s_cselect_b32 s26, s40, 0
  s_cmp_gt_u32 s26, 10
  s_cselect_b32 s76, 64, s76
  s_subb_u32 s40, s40, 0
  s_cmp_lt_u32 s76, 64
  s_cselect_b32 s76, s76, s41
  s_bitcmp1_b32 s42, 0
  s_cbranch_scc1 q_fork_101
q_nopre_100:
  s_waitcnt vmcnt(0)
  s_sub_u32 s26, s47, s60
  s_cmp_lg_u32 s26, 15
  s_cbranch_scc1 q_cold_102
  v_mbcnt_lo_u32_b32 v20, -1, 0
  v_and_b32 v20, 0, v20
  v_add_lshl_u32 v20, v20, 2, 2
  s_mov_b32 s26, 0
g_wt_109:
  global_load_dword v21, v20, s[12:13] offset:128 sc1
  s_add_u32 s26, s26, 1
  s_cmp_gt_u32 s26, 1048576
  s_cbranch_scc1 L_end
  s_waitcnt vmcnt(0)
  v_cmp_eq_u32 vcc, 0, v21
  v_readfirstlane_b32 s27, v21
  s_cbranch_vccnz g_wt_109
  s_load_dwordx2 s[64:65], s[0:1], 72
  s_load_dwordx2 s[68:69], s[0:1], 80
  s_load_dwordx2 s[8:9], s[0:1], 88
  s_mov_b32 s66, 1835008
  s_mov_b32 s70, 1835008
  s_mov_b32 s10, 1835008
  v_lshrrev_b32 v2, 7, v0
  v_and_b32 v3, 0x70, v0
  v_mul_u32_u24 v6, 57344, v2
  v_add_u32 v6, v6, v3
  v_cmp_eq_u32 vcc, 0x70, v3
  v_mov_b32 v3, 0x7ff00000
  s_nop 0
  v_cndmask_b32 v6, v6, v3, vcc
  v_lshrrev_b32 v2, 8, v0
  v_mul_u32_u24 v7, 14336, v2
  v_and_b32 v3, 0xf0, v0
  v_add_u32 v7, v7, v3
  s_mul_i32 s34, s17, 458752
  s_mul_i32 s27, s16, 112
  s_add_u32 s34, s34, s27
  s_mul_i32 s35, s16, 57344
  s_lshl_b32 s27, s17, 8
  s_add_u32 s35, s35, s27
  s_waitcnt lgkmcnt(0)
  s_mul_i32 s26, s17, 23552
  s_add_u32 m0, s26, 65536
  s_add_u32 s36, s34, 0
  buffer_load_dwordx4 v6, s[64:67], s36 offen lds
  s_add_u32 m0, m0, 1024
  s_add_u32 s36, s34, 0
  buffer_load_dwordx4 v6, s[68:71], s36 offen lds
  s_add_u32 m0, m0, 1024
  s_add_u32 s36, s34, 3584
  buffer_load_dwordx4 v6, s[64:67], s36 offen lds
  s_add_u32 m0, m0, 1024
  s_add_u32 s36, s34, 3584
  buffer_load_dwordx4 v6, s[68:71], s36 offen lds
  s_add_u32 m0, m0, 1024
  s_add_u32 s36, s34, 7168
  buffer_load_dwordx4 v6, s[64:67], s36 offen lds
  s_add_u32 m0, m0, 1024
  s_add_u32 s36, s34, 7168
  buffer_load_dwordx4 v6, s[68:71], s36 offen lds
  s_add_u32 m0, m0, 1024
  s_add_u32 s36, s34, 10752
  buffer_load_dwordx4 v6, s[64:67], s36 offen lds
  s_add_u32 m0, m0, 1024
  s_add_u32 s36, s34, 10752
  buffer_load_dwordx4 v6, s[68:71], s36 offen lds
  s_add_u32 m0, m0, 1024
  s_add_u32 s36, s34, 14336
  buffer_load_dwordx4 v6, s[64:67], s36 offen lds
  s_add_u32 m0, m0, 1024
  s_add_u32 s36, s34, 14336
  buffer_load_dwordx4 v6, s[68:71], s36 offen lds
  s_add_u32 m0, m0, 1024
  s_add_u32 s36, s34, 17920
  buffer_load_dwordx4 v6, s[64:67], s36 offen lds
  s_add_u32 m0, m0, 1024
  s_add_u32 s36, s34, 17920
  buffer_load_dwordx4 v6, s[68:71], s36 offen lds
  s_add_u32 m0, m0, 1024
  s_add_u32 s36, s34, 21504
  buffer_load_dwordx4 v6, s[64:67], s36 offen lds
  s_add_u32 m0, m0, 1024
  s_add_u32 s36, s34, 21504
  buffer_load_dwordx4 v6, s[68:71], s36 offen lds
  s_add_u32 m0, m0, 1024
  s_add_u32 s36, s34, 25088
  buffer_load_dwordx4 v6, s[64:67], s36 offen lds
  s_add_u32 m0, m0, 1024
  s_add_u32 s36, s34, 25088
  buffer_load_dwordx4 v6, s[68:71], s36 offen lds
  s_add_u32 m0, m0, 1024
  s_add_u32 s36, s34, 28672
  buffer_load_dwordx4 v6, s[64:67], s36 offen lds
  s_add_u32 m0, m0, 1024
  s_add_u32 s36, s34, 28672
  buffer_load_dwordx4 v6, s[68:71], s36 offen lds
  s_add_u32 m0, m0, 1024
  s_add_u32 s36, s34, 32256
  buffer_load_dwordx4 v6, s[64:67], s36 offen lds
  s_add_u32 m0, m0, 1024
  s_add_u32 s36, s34, 32256
  buffer_load_dwordx4 v6, s[68:71], s36 offen lds
  s_add_u32 m0, m0, 1024
  s_add_u32 s36, s34, 35840
  buffer_load_dwordx4 v6, s[64:67], s36 offen lds
  s_add_u32 m0, m0, 1024
  s_add_u32 s36, s34, 35840
  buffer_load_dwordx4 v6, s[68:71], s36 offen lds
  s_add_u32 m0, m0, 1024
  s_add_u32 s36, s34, 39424
  buffer_load_dwordx4 v6, s[64:67], s36 offen lds
  s_add_u32 m0, m0, 1024
  v_lshrrev_b32 v7, 7, v0
  v_lshlrev_b32 v7, 12, v7
  v_and_b32 v2, 1023, v9
  s_lshl_b32 s26, s17, 10
  v_add3_u32 v7, v7, v2, s26
  v_mov_b32 v116, 0
q_cold_102:
  s_waitcnt lgkmcnt(0)
  s_barrier
  s_cmp_lg_u32 s50, 0
  s_cbranch_scc1 q_c1_106
q_c0_105:
  ds_read_b128 v[68:71], v120 offset:0
  ds_read_b128 v[72:75], v121 offset:0
  ds_read_b128 v[76:79], v122 offset:0
q_w0_107:
  s_waitcnt lgkmcnt(2)
  v_mfma_f32_32x32x16_bf16 v[20:35], v[128:131], v[68:71], 0
  ds_read_b128 v[80:83], v123 offset:0
  s_mov_b32 s46, s47
  s_mov_b32 s47, s76
  s_lshl_b32 s52, s46, 7
  s_add_u32 s52, s52, s57
  v_mfma_f32_32x32x16_bf16 v[36:51], v[68:71], a[0:3], 0
  s_waitcnt vmcnt(0)
  s_mov_b64 exec, 1
  buffer_store_dword v4, off, s[4:7], s49 sc1
  s_mov_b64 exec, -1
  s_lshl_b32 s44, s52, 12
  s_waitcnt lgkmcnt(2)
  v_mfma_f32_32x32x16_bf16 v[20:35], v[132:135], v[72:75], v[20:35]
  ds_read_b128 v[84:87], v124 offset:0
  s_add_u32 s44, s44, 41943040
  s_lshl_b32 s51, s52, 5
  s_add_u32 s51, s51, 244318208
  s_lshr_b32 s55, s47, 7
  v_mfma_f32_32x32x16_bf16 v[36:51], v[72:75], a[4:7], v[36:51]
  s_sub_u32 s27, s47, s60
  s_cmp_eq_u32 s27, 15
  s_cselect_b32 s55, 1, s55
  s_add_u32 s76, s47, 3
  s_cmp_lt_u32 s76, 18
  s_cselect_b32 s76, s76, s41
  s_waitcnt lgkmcnt(2)
  v_mfma_f32_32x32x16_bf16 v[20:35], v[136:139], v[76:79], v[20:35]
  ds_read_b128 v[88:91], v125 offset:0
  v_cvt_pk_bf16_f32 v100, v52, v53
  v_cvt_pk_bf16_f32 v101, v54, v55
  v_cvt_pk_bf16_f32 v102, v60, v61
  v_cvt_pk_bf16_f32 v103, v62, v63
  v_mfma_f32_32x32x16_bf16 v[36:51], v[76:79], a[8:11], v[36:51]
  buffer_store_dwordx4 v[100:103], v8, s[4:7], s43 offen offset:0 sc1
  v_cvt_pk_bf16_f32 v104, v56, v57
  v_cvt_pk_bf16_f32 v105, v58, v59
  s_waitcnt lgkmcnt(2)
  v_mfma_f32_32x32x16_bf16 v[20:35], v[140:143], v[80:83], v[20:35]
  ds_read_b128 v[92:95], v126 offset:0
  v_cvt_pk_bf16_f32 v106, v64, v65
  v_cvt_pk_bf16_f32 v107, v66, v67
  v_mfma_f32_32x32x16_bf16 v[36:51], v[80:83], a[12:15], v[36:51]
  s_waitcnt lgkmcnt(2)
  v_mfma_f32_32x32x16_bf16 v[20:35], v[144:147], v[84:87], v[20:35]
  ds_read_b128 v[96:99], v127 offset:0
  buffer_store_dwordx4 v[104:107], v8, s[4:7], s43 offen offset:512 sc1
  s_lshl_b32 s43, s52, 11
  v_mfma_f32_32x32x16_bf16 v[36:51], v[84:87], a[16:19], v[36:51]
  s_add_u32 s43, s43, 142606336
  s_waitcnt lgkmcnt(2)
  v_mfma_f32_32x32x16_bf16 v[20:35], v[148:151], v[88:91], v[20:35]
  ds_read_b128 v[68:71], v120 offset:256
  v_mfma_f32_32x32x16_bf16 v[36:51], v[88:91], a[20:23], v[36:51]
  s_waitcnt lgkmcnt(2)
  v_mfma_f32_32x32x16_bf16 v[20:35], v[152:155], v[92:95], v[20:35]
  ds_read_b128 v[72:75], v121 offset:256
  s_cmp_lt_u32 s47, 64
  s_cselect_b32 s26, 2, 0
  s_add_u32 s26, s26, s47
  s_lshl_b32 s26, s26, 12
  v_mfma_f32_32x32x16_bf16 v[36:51], v[92:95], a[24:27], v[36:51]
  s_add_u32 s26, s26, 243261440
  s_mov_b64 exec, 0xffffff
  buffer_load_dword v116, v7, s[4:7], s26 offen sc1
  s_mov_b64 exec, -1
  s_waitcnt lgkmcnt(2)
  v_mfma_f32_32x32x16_bf16 v[20:35], v[156:159], v[96:99], v[20:35]
  ds_read_b128 v[76:79], v122 offset:256
  v_mfma_f32_32x32x16_bf16 v[36:51], v[96:99], a[28:31], v[36:51]
  s_waitcnt lgkmcnt(2)
  v_mfma_f32_32x32x16_bf16 v[20:35], v[160:163], v[68:71], v[20:35]
  ds_read_b128 v[80:83], v123 offset:256
  v_mfma_f32_32x32x16_bf16 v[36:51], v[68:71], a[32:35], v[36:51]
  s_waitcnt lgkmcnt(2)
  v_mfma_f32_32x32x16_bf16 v[20:35], v[164:167], v[72:75], v[20:35]
  ds_read_b128 v[84:87], v124 offset:256
  v_mfma_f32_32x32x16_bf16 v[36:51], v[72:75], a[36:39], v[36:51]
  s_waitcnt lgkmcnt(2)
  v_mfma_f32_32x32x16_bf16 v[20:35], v[168:171], v[76:79], v[20:35]
  ds_read_b128 v[88:91], v125 offset:256
  v_mfma_f32_32x32x16_bf16 v[36:51], v[76:79], a[40:43], v[36:51]
  s_waitcnt lgkmcnt(2)
  v_mfma_f32_32x32x16_bf16 v[20:35], v[172:175], v[80:83], v[20:35]
  ds_read_b128 v[92:95], v126 offset:256
  v_mfma_f32_32x32x16_bf16 v[36:51], v[80:83], a[44:47], v[36:51]
  s_waitcnt lgkmcnt(2)
  v_mfma_f32_32x32x16_bf16 v[20:35], v[176:179], v[84:87], v[20:35]
  ds_read_b128 v[96:99], v127 offset:256
  v_mfma_f32_32x32x16_bf16 v[36:51], v[84:87], a[48:51], v[36:51]
  s_waitcnt lgkmcnt(2)
  v_mfma_f32_32x32x16_bf16 v[20:35], v[180:183], v[88:91], v[20:35]
  ds_read_b128 v[68:71], v120 offset:512
  v_mfma_f32_32x32x16_bf16 v[36:51], v[88:91], a[52:55], v[36:51]
  s_waitcnt lgkmcnt(2)
  v_mfma_f32_32x32x16_bf16 v[20:35], v[184:187], v[92:95], v[20:35]
  ds_read_b128 v[72:75], v121 offset:512
  v_mfma_f32_32x32x16_bf16 v[36:51], v[92:95], a[56:59], v[36:51]
  s_waitcnt lgkmcnt(2)
  v_mfma_f32_32x32x16_bf16 v[20:35], v[188:191], v[96:99], v[20:35]
  ds_read_b128 v[76:79], v122 offset:512
  v_mfma_f32_32x32x16_bf16 v[36:51], v[96:99], a[60:63], v[36:51]
  s_waitcnt lgkmcnt(2)
  v_mfma_f32_32x32x16_bf16 v[20:35], v[192:195], v[68:71], v[20:35]
  ds_read_b128 v[80:83], v123 offset:512
  v_mfma_f32_32x32x16_bf16 v[36:51], v[68:71], a[64:67], v[36:51]
  s_waitcnt lgkmcnt(2)
  v_mfma_f32_32x32x16_bf16 v[20:35], v[196:199], v[72:75], v[20:35]
  ds_read_b128 v[84:87], v124 offset:512
  s_waitcnt vmcnt(0)
  s_mov_b64 exec, 3
  buffer_store_dword v4, v0, s[4:7], s49 offen sc1
  s_mov_b64 exec, -1
  v_mfma_f32_32x32x16_bf16 v[36:51], v[72:75], a[68:71], v[36:51]
  v_cmp_eq_u32 vcc, 0, v116
  v_max_u32_dpp v117, v116, v116 quad_perm:[1,0,3,2] row_mask:0xf bank_mask:0xf
  s_and_b32 s48, vcc_lo, 0xffffff
  s_cselect_b32 s48, 0, -1
  v_max_u32_dpp v117, v117, v117 quad_perm:[2,3,0,1] row_mask:0xf bank_mask:0xf
  s_waitcnt lgkmcnt(2)
  v_mfma_f32_32x32x16_bf16 v[20:35], v[200:203], v[76:79], v[20:35]
  ds_read_b128 v[88:91], v125 offset:512
  s_nop 1
  v_max_u32_dpp v117, v117, v117 row_half_mirror row_mask:0xf bank_mask:0xf
  v_and_b32 v117, s48, v117
  s_cmp_lg_u32 s48, 0
  s_cselect_b32 s28, s47, s46
  v_mfma_f32_32x32x16_bf16 v[36:51], v[76:79], a[72:75], v[36:51]
  s_and_b32 s63, s28, 127
  s_lshl_b32 s63, s63, 15
  s_xor_b32 s27, s50, 32768
  s_add_u32 m0, s27, s54
  s_add_u32 s63, s63, s54
  s_waitcnt lgkmcnt(2)
  v_mfma_f32_32x32x16_bf16 v[20:35], v[204:207], v[80:83], v[20:35]
  ds_read_b128 v[92:95], v126 offset:512
  s_add_u32 s63, s63, 6291456
  buffer_load_dwordx4 v12, s[4:7], s63 offen offset:0 sc1 lds
  v_mfma_f32_32x32x16_bf16 v[36:51], v[80:83], a[76:79], v[36:51]
  s_waitcnt lgkmcnt(2)
  v_mfma_f32_32x32x16_bf16 v[20:35], v[208:211], v[84:87], v[20:35]
  ds_read_b128 v[96:99], v127 offset:512
  v_mfma_f32_32x32x16_bf16 v[36:51], v[84:87], a[80:83], v[36:51]
  buffer_load_dwordx4 v13, s[4:7], s63 offen offset:1024 sc1 lds
  s_waitcnt lgkmcnt(2)
  v_mfma_f32_32x32x16_bf16 v[20:35], v[212:215], v[88:91], v[20:35]
  ds_read_b128 v[68:71], v120 offset:768
  v_mfma_f32_32x32x16_bf16 v[36:51], v[88:91], a[84:87], v[36:51]
  s_waitcnt lgkmcnt(2)
  v_mfma_f32_32x32x16_bf16 v[20:35], v[216:219], v[92:95], v[20:35]
  ds_read_b128 v[72:75], v121 offset:768
  buffer_load_dwordx4 v14, s[4:7], s63 offen offset:2048 sc1 lds
  v_mfma_f32_32x32x16_bf16 v[36:51], v[92:95], a[88:91], v[36:51]
  s_waitcnt lgkmcnt(2)
  v_mfma_f32_32x32x16_bf16 v[20:35], v[220:223], v[96:99], v[20:35]
  ds_read_b128 v[76:79], v122 offset:768
  v_mfma_f32_32x32x16_bf16 v[36:51], v[96:99], a[92:95], v[36:51]
  buffer_load_dwordx4 v15, s[4:7], s63 offen offset:3072 sc1 lds
  s_add_u32 m0, m0, 4096
  s_add_u32 s63, s63, 4096
  s_waitcnt lgkmcnt(2)
  v_mfma_f32_32x32x16_bf16 v[20:35], v[224:227], v[68:71], v[20:35]
  ds_read_b128 v[80:83], v123 offset:768
  v_mfma_f32_32x32x16_bf16 v[36:51], v[68:71], a[96:99], v[36:51]
  s_waitcnt lgkmcnt(2)
  v_mfma_f32_32x32x16_bf16 v[20:35], v[228:231], v[72:75], v[20:35]
  ds_read_b128 v[84:87], v124 offset:768
  buffer_load_dwordx4 v16, s[4:7], s63 offen offset:0 sc1 lds
  v_mfma_f32_32x32x16_bf16 v[36:51], v[72:75], a[100:103], v[36:51]
  s_waitcnt lgkmcnt(2)
  v_mfma_f32_32x32x16_bf16 v[20:35], v[232:235], v[76:79], v[20:35]
  ds_read_b128 v[88:91], v125 offset:768
  v_mfma_f32_32x32x16_bf16 v[36:51], v[76:79], a[104:107], v[36:51]
  buffer_load_dwordx4 v17, s[4:7], s63 offen offset:1024 sc1 lds
  s_waitcnt lgkmcnt(2)
  v_mfma_f32_32x32x16_bf16 v[20:35], v[236:239], v[80:83], v[20:35]
  ds_read_b128 v[92:95], v126 offset:768
  v_mfma_f32_32x32x16_bf16 v[36:51], v[80:83], a[108:111], v[36:51]
  s_waitcnt lgkmcnt(2)
  v_mfma_f32_32x32x16_bf16 v[20:35], v[240:243], v[84:87], v[20:35]
  ds_read_b128 v[96:99], v127 offset:768
  buffer_load_dwordx4 v18, s[4:7], s63 offen offset:2048 sc1 lds
  v_mfma_f32_32x32x16_bf16 v[36:51], v[84:87], a[112:115], v[36:51]
  s_waitcnt lgkmcnt(2)
  v_mfma_f32_32x32x16_bf16 v[20:35], v[244:247], v[88:91], v[20:35]
  ds_read_b128 v[68:71], v120 offset:0
  v_mfma_f32_32x32x16_bf16 v[36:51], v[88:91], a[116:119], v[36:51]
  ds_read_b128 v[72:75], v121 offset:0
  buffer_load_dwordx4 v19, s[4:7], s63 offen offset:3072 sc1 lds
  s_mov_b32 s49, s51
  s_waitcnt lgkmcnt(3)
  v_mfma_f32_32x32x16_bf16 v[20:35], v[248:251], v[92:95], v[20:35]
  ds_read_b128 v[76:79], v122 offset:0
  ds_write_b32 v118, v117 offset:0
  v_mfma_f32_32x32x16_bf16 v[36:51], v[92:95], a[120:123], v[36:51]
  ds_read_b128 v[80:83], v123 offset:0
  s_waitcnt lgkmcnt(5)
  v_mfma_f32_32x32x16_bf16 v[20:35], v[252:255], v[96:99], v[20:35]
  ds_read_b128 v[84:87], v124 offset:0
  v_mfma_f32_32x32x16_bf16 v[36:51], v[96:99], a[124:127], v[36:51]
  ds_read_b128 v[88:91], v125 offset:0
  s_waitcnt lgkmcnt(5)
  v_mfma_f32_32x32x16_bf16 v[52:67], a[128:131], v[68:71], 0
  ds_read_b128 v[92:95], v126 offset:0
  v_mfma_f32_32x32x16_bf16 v[52:67], a[132:135], v[72:75], v[52:67]
  ds_read_b128 v[96:99], v127 offset:0
  v_mul_f32 v20, s24, v20
  v_mul_f32 v21, s24, v21
  v_mul_f32 v22, s24, v22
  v_mul_f32 v23, s24, v23
  s_waitcnt lgkmcnt(4)
  v_mfma_f32_32x32x16_bf16 v[52:67], a[136:139], v[76:79], v[52:67]
  ds_read_b128 v[68:71], v120 offset:256
  v_mul_f32 v24, s24, v24
  v_mul_f32 v25, s24, v25
  v_cvt_pk_bf16_f32 v100, v36, v37
  v_cvt_pk_bf16_f32 v101, v38, v39
  v_mfma_f32_32x32x16_bf16 v[52:67], a[140:143], v[80:83], v[52:67]
  ds_read_b128 v[72:75], v121 offset:256
  v_cvt_pk_bf16_f32 v102, v44, v45
  v_cvt_pk_bf16_f32 v103, v46, v47
  buffer_store_dwordx4 v[100:103], v8, s[4:7], s44 offen offset:2048 sc1
  s_waitcnt lgkmcnt(4)
  v_mfma_f32_32x32x16_bf16 v[52:67], a[144:147], v[84:87], v[52:67]
  ds_read_b128 v[76:79], v122 offset:256
  v_cvt_pk_bf16_f32 v104, v40, v41
  v_cvt_pk_bf16_f32 v105, v42, v43
  v_cvt_pk_bf16_f32 v106, v48, v49
  v_cvt_pk_bf16_f32 v107, v50, v51
  v_mfma_f32_32x32x16_bf16 v[52:67], a[148:151], v[88:91], v[52:67]
  ds_read_b128 v[80:83], v123 offset:256
  buffer_store_dwordx4 v[104:107], v8, s[4:7], s44 offen offset:2560 sc1
  v_mul_f32 v26, s24, v26
  s_waitcnt lgkmcnt(4)
  v_mfma_f32_32x32x16_bf16 v[52:67], a[152:155], v[92:95], v[52:67]
  ds_read_b128 v[84:87], v124 offset:256
  v_mul_f32 v27, s24, v27
  v_mul_f32 v28, s24, v28
  v_mul_f32 v29, s24, v29
  v_mul_f32 v30, s24, v30
  v_mfma_f32_32x32x16_bf16 v[52:67], a[156:159], v[96:99], v[52:67]
  ds_read_b128 v[88:91], v125 offset:256
  v_mul_f32 v31, s24, v31
  v_mul_f32 v32, s24, v32
  v_mul_f32 v33, s24, v33
  v_mul_f32 v34, s24, v34
  s_waitcnt lgkmcnt(4)
  v_mfma_f32_32x32x16_bf16 v[52:67], a[160:163], v[68:71], v[52:67]
  ds_read_b128 v[92:95], v126 offset:256
  v_mul_f32 v35, s24, v35
  v_cvt_pk_bf16_f32 v108, v20, v21
  v_cvt_pk_bf16_f32 v109, v22, v23
  v_cvt_pk_bf16_f32 v110, v28, v29
  v_mfma_f32_32x32x16_bf16 v[52:67], a[164:167], v[72:75], v[52:67]
  ds_read_b128 v[96:99], v127 offset:256
  v_cvt_pk_bf16_f32 v111, v30, v31
  buffer_store_dwordx4 v[108:111], v8, s[4:7], s44 offen offset:0 sc1
  s_waitcnt lgkmcnt(4)
  v_mfma_f32_32x32x16_bf16 v[52:67], a[168:171], v[76:79], v[52:67]
  ds_read_b128 v[68:71], v120 offset:512
  v_cvt_pk_bf16_f32 v112, v24, v25
  v_cvt_pk_bf16_f32 v113, v26, v27
  v_cvt_pk_bf16_f32 v114, v32, v33
  v_cvt_pk_bf16_f32 v115, v34, v35
  v_mfma_f32_32x32x16_bf16 v[52:67], a[172:175], v[80:83], v[52:67]
  ds_read_b128 v[72:75], v121 offset:512
  buffer_store_dwordx4 v[112:115], v8, s[4:7], s44 offen offset:512 sc1
  s_waitcnt lgkmcnt(4)
  v_mfma_f32_32x32x16_bf16 v[52:67], a[176:179], v[84:87], v[52:67]
  ds_read_b128 v[76:79], v122 offset:512
  v_mfma_f32_32x32x16_bf16 v[52:67], a[180:183], v[88:91], v[52:67]
  ds_read_b128 v[80:83], v123 offset:512
  s_waitcnt lgkmcnt(4)
  v_mfma_f32_32x32x16_bf16 v[52:67], a[184:187], v[92:95], v[52:67]
  ds_read_b128 v[84:87], v124 offset:512
  v_mfma_f32_32x32x16_bf16 v[52:67], a[188:191], v[96:99], v[52:67]
  ds_read_b128 v[88:91], v125 offset:512
  s_waitcnt lgkmcnt(4)
  v_mfma_f32_32x32x16_bf16 v[52:67], a[192:195], v[68:71], v[52:67]
  ds_read_b128 v[92:95], v126 offset:512
  v_mfma_f32_32x32x16_bf16 v[52:67], a[196:199], v[72:75], v[52:67]
  ds_read_b128 v[96:99], v127 offset:512
  s_waitcnt lgkmcnt(4)
  v_mfma_f32_32x32x16_bf16 v[52:67], a[200:203], v[76:79], v[52:67]
  ds_read_b128 v[68:71], v120 offset:768
  v_mfma_f32_32x32x16_bf16 v[52:67], a[204:207], v[80:83], v[52:67]
  ds_read_b128 v[72:75], v121 offset:768
  s_waitcnt lgkmcnt(4)
  v_mfma_f32_32x32x16_bf16 v[52:67], a[208:211], v[84:87], v[52:67]
  ds_read_b128 v[76:79], v122 offset:768
  ds_read_b128 v[80:83], v123 offset:768
  v_mfma_f32_32x32x16_bf16 v[52:67], a[212:215], v[88:91], v[52:67]
  ds_read_b128 v[84:87], v124 offset:768
  ds_read_b128 v[88:91], v125 offset:768
  s_waitcnt lgkmcnt(6)
  v_mfma_f32_32x32x16_bf16 v[52:67], a[216:219], v[92:95], v[52:67]
  ds_read_b128 v[92:95], v126 offset:768
  v_mfma_f32_32x32x16_bf16 v[52:67], a[220:223], v[96:99], v[52:67]
  ds_read_b128 v[96:99], v127 offset:768
  s_waitcnt lgkmcnt(6)
  v_mfma_f32_32x32x16_bf16 v[52:67], a[224:227], v[68:71], v[52:67]
  v_mfma_f32_32x32x16_bf16 v[52:67], a[228:231], v[72:75], v[52:67]
  s_waitcnt vmcnt(4) lgkmcnt(0)
  s_barrier
  ds_read_b128 v[100:103], v119 offset:0
  v_mfma_f32_32x32x16_bf16 v[52:67], a[232:235], v[76:79], v[52:67]
  ds_read_b128 v[68:71], v120 offset:32768
  v_mfma_f32_32x32x16_bf16 v[52:67], a[236:239], v[80:83], v[52:67]
  ds_read_b128 v[72:75], v121 offset:32768
  s_xor_b32 s50, s50, 32768
  v_mfma_f32_32x32x16_bf16 v[52:67], a[240:243], v[84:87], v[52:67]
  ds_read_b128 v[76:79], v122 offset:32768
  v_mfma_f32_32x32x16_bf16 v[52:67], a[244:247], v[88:91], v[52:67]
  s_waitcnt lgkmcnt(3)
  v_min3_u32 v104, v100, v101, v102
  v_max3_u32 v100, v100, v101, v102
  v_min_u32 v104, v104, v103
  v_max_u32 v100, v100, v103
  v_readfirstlane_b32 s45, v104
  v_mfma_f32_32x32x16_bf16 v[52:67], a[248:251], v[92:95], v[52:67]
  v_readlane_b32 s28, v100, 0
  v_readlane_b32 s29, v100, 1
  v_readlane_b32 s30, v100, 2
  s_cmp_gt_u32 s55, 0
  s_cselect_b32 s45, 0, s45
  v_mfma_f32_32x32x16_bf16 v[52:67], a[252:255], v[96:99], v[52:67]
  s_cmp_eq_u32 s45, 0
  s_cbranch_scc1 q_slow_94
  s_cmp_lt_u32 s47, 64
  s_cbranch_scc1 q_w1_108
  s_cmp_gt_u32 s28, s56
  s_addc_u32 s42, s42, s42
  s_max_u32 s56, s56, s28
  s_and_b32 s26, s42, 1
  s_cselect_b32 s26, s40, 0
  s_cmp_gt_u32 s26, 10
  s_subb_u32 s40, s40, 0
  s_cmp_gt_u32 s29, s56
  s_addc_u32 s42, s42, s42
  s_max_u32 s56, s56, s29
  s_and_b32 s26, s42, 1
  s_cselect_b32 s26, s40, 0
  s_cmp_gt_u32 s26, 10
  s_subb_u32 s40, s40, 0
  s_cmp_gt_u32 s30, s56
  s_addc_u32 s42, s42, s42
  s_max_u32 s56, s56, s30
  s_add_u32 s76, s47, s40
  s_add_u32 s41, s47, 3
  s_sub_u32 s76, s76, 64
  s_and_b32 s26, s42, 1
  s_cselect_b32 s26, s40, 0
  s_cmp_gt_u32 s26, 10
  s_cselect_b32 s76, 64, s76
  s_subb_u32 s40, s40, 0
  s_cmp_lt_u32 s76, 64
  s_cselect_b32 s76, s76, s41
  s_bitcmp1_b32 s42, 0
  s_cbranch_scc0 q_w1_108
  s_branch q_forkw_103
q_c1_106:
  ds_read_b128 v[68:71], v120 offset:32768
  ds_read_b128 v[72:75], v121 offset:32768
  ds_read_b128 v[76:79], v122 offset:32768
q_w1_108:
  s_waitcnt lgkmcnt(2)
  v_mfma_f32_32x32x16_bf16 v[20:35], v[128:131], v[68:71], 0
  ds_read_b128 v[80:83], v123 offset:32768
  s_mov_b32 s46, s47
  s_mov_b32 s47, s76
  s_lshl_b32 s52, s46, 7
  s_add_u32 s52, s52, s57
  v_mfma_f32_32x32x16_bf16 v[36:51], v[68:71], a[0:3], 0
  s_waitcnt vmcnt(0)
  s_mov_b64 exec, 1
  buffer_store_dword v4, off, s[4:7], s49 sc1
  s_mov_b64 exec, -1
  s_lshl_b32 s44, s52, 12
  s_waitcnt lgkmcnt(2)
  v_mfma_f32_32x32x16_bf16 v[20:35], v[132:135], v[72:75], v[20:35]
  ds_read_b128 v[84:87], v124 offset:32768
  s_add_u32 s44, s44, 41943040
  s_lshl_b32 s51, s52, 5
  s_add_u32 s51, s51, 244318208
  s_lshr_b32 s55, s47, 7
  v_mfma_f32_32x32x16_bf16 v[36:51], v[72:75], a[4:7], v[36:51]
  s_sub_u32 s27, s47, s60
  s_cmp_eq_u32 s27, 15
  s_cselect_b32 s55, 1, s55
  s_add_u32 s76, s47, 3
  s_cmp_lt_u32 s76, 18
  s_cselect_b32 s76, s76, s41
  s_waitcnt lgkmcnt(2)
  v_mfma_f32_32x32x16_bf16 v[20:35], v[136:139], v[76:79], v[20:35]
  ds_read_b128 v[88:91], v125 offset:32768
  v_cvt_pk_bf16_f32 v100, v52, v53
  v_cvt_pk_bf16_f32 v101, v54, v55
  v_cvt_pk_bf16_f32 v102, v60, v61
  v_cvt_pk_bf16_f32 v103, v62, v63
  v_mfma_f32_32x32x16_bf16 v[36:51], v[76:79], a[8:11], v[36:51]
  buffer_store_dwordx4 v[100:103], v8, s[4:7], s43 offen offset:0 sc1
  v_cvt_pk_bf16_f32 v104, v56, v57
  v_cvt_pk_bf16_f32 v105, v58, v59
  s_waitcnt lgkmcnt(2)
  v_mfma_f32_32x32x16_bf16 v[20:35], v[140:143], v[80:83], v[20:35]
  ds_read_b128 v[92:95], v126 offset:32768
  v_cvt_pk_bf16_f32 v106, v64, v65
  v_cvt_pk_bf16_f32 v107, v66, v67
  v_mfma_f32_32x32x16_bf16 v[36:51], v[80:83], a[12:15], v[36:51]
  s_waitcnt lgkmcnt(2)
  v_mfma_f32_32x32x16_bf16 v[20:35], v[144:147], v[84:87], v[20:35]
  ds_read_b128 v[96:99], v127 offset:32768
  buffer_store_dwordx4 v[104:107], v8, s[4:7], s43 offen offset:512 sc1
  s_lshl_b32 s43, s52, 11
  v_mfma_f32_32x32x16_bf16 v[36:51], v[84:87], a[16:19], v[36:51]
  s_add_u32 s43, s43, 142606336
  s_waitcnt lgkmcnt(2)
  v_mfma_f32_32x32x16_bf16 v[20:35], v[148:151], v[88:91], v[20:35]
  ds_read_b128 v[68:71], v120 offset:33024
  v_mfma_f32_32x32x16_bf16 v[36:51], v[88:91], a[20:23], v[36:51]
  s_waitcnt lgkmcnt(2)
  v_mfma_f32_32x32x16_bf16 v[20:35], v[152:155], v[92:95], v[20:35]
  ds_read_b128 v[72:75], v121 offset:33024
  s_cmp_lt_u32 s47, 64
  s_cselect_b32 s26, 2, 0
  s_add_u32 s26, s26, s47
  s_lshl_b32 s26, s26, 12
  v_mfma_f32_32x32x16_bf16 v[36:51], v[92:95], a[24:27], v[36:51]
  s_add_u32 s26, s26, 243261440
  s_mov_b64 exec, 0xffffff
  buffer_load_dword v116, v7, s[4:7], s26 offen sc1
  s_mov_b64 exec, -1
  s_waitcnt lgkmcnt(2)
  v_mfma_f32_32x32x16_bf16 v[20:35], v[156:159], v[96:99], v[20:35]
  ds_read_b128 v[76:79], v122 offset:33024
  v_mfma_f32_32x32x16_bf16 v[36:51], v[96:99], a[28:31], v[36:51]
  s_waitcnt lgkmcnt(2)
  v_mfma_f32_32x32x16_bf16 v[20:35], v[160:163], v[68:71], v[20:35]
  ds_read_b128 v[80:83], v123 offset:33024
  v_mfma_f32_32x32x16_bf16 v[36:51], v[68:71], a[32:35], v[36:51]
  s_waitcnt lgkmcnt(2)
  v_mfma_f32_32x32x16_bf16 v[20:35], v[164:167], v[72:75], v[20:35]
  ds_read_b128 v[84:87], v124 offset:33024
  v_mfma_f32_32x32x16_bf16 v[36:51], v[72:75], a[36:39], v[36:51]
  s_waitcnt lgkmcnt(2)
  v_mfma_f32_32x32x16_bf16 v[20:35], v[168:171], v[76:79], v[20:35]
  ds_read_b128 v[88:91], v125 offset:33024
  v_mfma_f32_32x32x16_bf16 v[36:51], v[76:79], a[40:43], v[36:51]
  s_waitcnt lgkmcnt(2)
  v_mfma_f32_32x32x16_bf16 v[20:35], v[172:175], v[80:83], v[20:35]
  ds_read_b128 v[92:95], v126 offset:33024
  v_mfma_f32_32x32x16_bf16 v[36:51], v[80:83], a[44:47], v[36:51]
  s_waitcnt lgkmcnt(2)
  v_mfma_f32_32x32x16_bf16 v[20:35], v[176:179], v[84:87], v[20:35]
  ds_read_b128 v[96:99], v127 offset:33024
  v_mfma_f32_32x32x16_bf16 v[36:51], v[84:87], a[48:51], v[36:51]
  s_waitcnt lgkmcnt(2)
  v_mfma_f32_32x32x16_bf16 v[20:35], v[180:183], v[88:91], v[20:35]
  ds_read_b128 v[68:71], v120 offset:33280
  v_mfma_f32_32x32x16_bf16 v[36:51], v[88:91], a[52:55], v[36:51]
  s_waitcnt lgkmcnt(2)
  v_mfma_f32_32x32x16_bf16 v[20:35], v[184:187], v[92:95], v[20:35]
  ds_read_b128 v[72:75], v121 offset:33280
  v_mfma_f32_32x32x16_bf16 v[36:51], v[92:95], a[56:59], v[36:51]
  s_waitcnt lgkmcnt(2)
  v_mfma_f32_32x32x16_bf16 v[20:35], v[188:191], v[96:99], v[20:35]
  ds_read_b128 v[76:79], v122 offset:33280
  v_mfma_f32_32x32x16_bf16 v[36:51], v[96:99], a[60:63], v[36:51]
  s_waitcnt lgkmcnt(2)
  v_mfma_f32_32x32x16_bf16 v[20:35], v[192:195], v[68:71], v[20:35]
  ds_read_b128 v[80:83], v123 offset:33280
  v_mfma_f32_32x32x16_bf16 v[36:51], v[68:71], a[64:67], v[36:51]
  s_waitcnt lgkmcnt(2)
  v_mfma_f32_32x32x16_bf16 v[20:35], v[196:199], v[72:75], v[20:35]
  ds_read_b128 v[84:87], v124 offset:33280
  s_waitcnt vmcnt(0)
  s_mov_b64 exec, 3
  buffer_store_dword v4, v0, s[4:7], s49 offen sc1
  s_mov_b64 exec, -1
  v_mfma_f32_32x32x16_bf16 v[36:51], v[72:75], a[68:71], v[36:51]
  v_cmp_eq_u32 vcc, 0, v116
  v_max_u32_dpp v117, v116, v116 quad_perm:[1,0,3,2] row_mask:0xf bank_mask:0xf
  s_and_b32 s48, vcc_lo, 0xffffff
  s_cselect_b32 s48, 0, -1
  v_max_u32_dpp v117, v117, v117 quad_perm:[2,3,0,1] row_mask:0xf bank_mask:0xf
  s_waitcnt lgkmcnt(2)
  v_mfma_f32_32x32x16_bf16 v[20:35], v[200:203], v[76:79], v[20:35]
  ds_read_b128 v[88:91], v125 offset:33280
  s_nop 1
  v_max_u32_dpp v117, v117, v117 row_half_mirror row_mask:0xf bank_mask:0xf
  v_and_b32 v117, s48, v117
  s_cmp_lg_u32 s48, 0
  s_cselect_b32 s28, s47, s46
  v_mfma_f32_32x32x16_bf16 v[36:51], v[76:79], a[72:75], v[36:51]
  s_and_b32 s63, s28, 127
  s_lshl_b32 s63, s63, 15
  s_xor_b32 s27, s50, 32768
  s_add_u32 m0, s27, s54
  s_add_u32 s63, s63, s54
  s_waitcnt lgkmcnt(2)
  v_mfma_f32_32x32x16_bf16 v[20:35], v[204:207], v[80:83], v[20:35]
  ds_read_b128 v[92:95], v126 offset:33280
  s_add_u32 s63, s63, 6291456
  buffer_load_dwordx4 v12, s[4:7], s63 offen offset:0 sc1 lds
  v_mfma_f32_32x32x16_bf16 v[36:51], v[80:83], a[76:79], v[36:51]
  s_waitcnt lgkmcnt(2)
  v_mfma_f32_32x32x16_bf16 v[20:35], v[208:211], v[84:87], v[20:35]
  ds_read_b128 v[96:99], v127 offset:33280
  v_mfma_f32_32x32x16_bf16 v[36:51], v[84:87], a[80:83], v[36:51]
  buffer_load_dwordx4 v13, s[4:7], s63 offen offset:1024 sc1 lds
  s_waitcnt lgkmcnt(2)
  v_mfma_f32_32x32x16_bf16 v[20:35], v[212:215], v[88:91], v[20:35]
  ds_read_b128 v[68:71], v120 offset:33536
  v_mfma_f32_32x32x16_bf16 v[36:51], v[88:91], a[84:87], v[36:51]
  s_waitcnt lgkmcnt(2)
  v_mfma_f32_32x32x16_bf16 v[20:35], v[216:219], v[92:95], v[20:35]
  ds_read_b128 v[72:75], v121 offset:33536
  buffer_load_dwordx4 v14, s[4:7], s63 offen offset:2048 sc1 lds
  v_mfma_f32_32x32x16_bf16 v[36:51], v[92:95], a[88:91], v[36:51]
  s_waitcnt lgkmcnt(2)
  v_mfma_f32_32x32x16_bf16 v[20:35], v[220:223], v[96:99], v[20:35]
  ds_read_b128 v[76:79], v122 offset:33536
  v_mfma_f32_32x32x16_bf16 v[36:51], v[96:99], a[92:95], v[36:51]
  buffer_load_dwordx4 v15, s[4:7], s63 offen offset:3072 sc1 lds
  s_add_u32 m0, m0, 4096
  s_add_u32 s63, s63, 4096
  s_waitcnt lgkmcnt(2)
  v_mfma_f32_32x32x16_bf16 v[20:35], v[224:227], v[68:71], v[20:35]
  ds_read_b128 v[80:83], v123 offset:33536
  v_mfma_f32_32x32x16_bf16 v[36:51], v[68:71], a[96:99], v[36:51]
  s_waitcnt lgkmcnt(2)
  v_mfma_f32_32x32x16_bf16 v[20:35], v[228:231], v[72:75], v[20:35]
  ds_read_b128 v[84:87], v124 offset:33536
  buffer_load_dwordx4 v16, s[4:7], s63 offen offset:0 sc1 lds
  v_mfma_f32_32x32x16_bf16 v[36:51], v[72:75], a[100:103], v[36:51]
  s_waitcnt lgkmcnt(2)
  v_mfma_f32_32x32x16_bf16 v[20:35], v[232:235], v[76:79], v[20:35]
  ds_read_b128 v[88:91], v125 offset:33536
  v_mfma_f32_32x32x16_bf16 v[36:51], v[76:79], a[104:107], v[36:51]
  buffer_load_dwordx4 v17, s[4:7], s63 offen offset:1024 sc1 lds
  s_waitcnt lgkmcnt(2)
  v_mfma_f32_32x32x16_bf16 v[20:35], v[236:239], v[80:83], v[20:35]
  ds_read_b128 v[92:95], v126 offset:33536
  v_mfma_f32_32x32x16_bf16 v[36:51], v[80:83], a[108:111], v[36:51]
  s_waitcnt lgkmcnt(2)
  v_mfma_f32_32x32x16_bf16 v[20:35], v[240:243], v[84:87], v[20:35]
  ds_read_b128 v[96:99], v127 offset:33536
  buffer_load_dwordx4 v18, s[4:7], s63 offen offset:2048 sc1 lds
  v_mfma_f32_32x32x16_bf16 v[36:51], v[84:87], a[112:115], v[36:51]
  s_waitcnt lgkmcnt(2)
  v_mfma_f32_32x32x16_bf16 v[20:35], v[244:247], v[88:91], v[20:35]
  ds_read_b128 v[68:71], v120 offset:32768
  v_mfma_f32_32x32x16_bf16 v[36:51], v[88:91], a[116:119], v[36:51]
  ds_read_b128 v[72:75], v121 offset:32768
  buffer_load_dwordx4 v19, s[4:7], s63 offen offset:3072 sc1 lds
  s_mov_b32 s49, s51
  s_waitcnt lgkmcnt(3)
  v_mfma_f32_32x32x16_bf16 v[20:35], v[248:251], v[92:95], v[20:35]
  ds_read_b128 v[76:79], v122 offset:32768
  ds_write_b32 v118, v117 offset:128
  v_mfma_f32_32x32x16_bf16 v[36:51], v[92:95], a[120:123], v[36:51]
  ds_read_b128 v[80:83], v123 offset:32768
  s_waitcnt lgkmcnt(5)
  v_mfma_f32_32x32x16_bf16 v[20:35], v[252:255], v[96:99], v[20:35]
  ds_read_b128 v[84:87], v124 offset:32768
  v_mfma_f32_32x32x16_bf16 v[36:51], v[96:99], a[124:127], v[36:51]
  ds_read_b128 v[88:91], v125 offset:32768
  s_waitcnt lgkmcnt(5)
  v_mfma_f32_32x32x16_bf16 v[52:67], a[128:131], v[68:71], 0
  ds_read_b128 v[92:95], v126 offset:32768
  v_mfma_f32_32x32x16_bf16 v[52:67], a[132:135], v[72:75], v[52:67]
  ds_read_b128 v[96:99], v127 offset:32768
  v_mul_f32 v20, s24, v20
  v_mul_f32 v21, s24, v21
  v_mul_f32 v22, s24, v22
  v_mul_f32 v23, s24, v23
  s_waitcnt lgkmcnt(4)
  v_mfma_f32_32x32x16_bf16 v[52:67], a[136:139], v[76:79], v[52:67]
  ds_read_b128 v[68:71], v120 offset:33024
  v_mul_f32 v24, s24, v24
  v_mul_f32 v25, s24, v25
  v_cvt_pk_bf16_f32 v100, v36, v37
  v_cvt_pk_bf16_f32 v101, v38, v39
  v_mfma_f32_32x32x16_bf16 v[52:67], a[140:143], v[80:83], v[52:67]
  ds_read_b128 v[72:75], v121 offset:33024
  v_cvt_pk_bf16_f32 v102, v44, v45
  v_cvt_pk_bf16_f32 v103, v46, v47
  buffer_store_dwordx4 v[100:103], v8, s[4:7], s44 offen offset:2048 sc1
  s_waitcnt lgkmcnt(4)
  v_mfma_f32_32x32x16_bf16 v[52:67], a[144:147], v[84:87], v[52:67]
  ds_read_b128 v[76:79], v122 offset:33024
  v_cvt_pk_bf16_f32 v104, v40, v41
  v_cvt_pk_bf16_f32 v105, v42, v43
  v_cvt_pk_bf16_f32 v106, v48, v49
  v_cvt_pk_bf16_f32 v107, v50, v51
  v_mfma_f32_32x32x16_bf16 v[52:67], a[148:151], v[88:91], v[52:67]
  ds_read_b128 v[80:83], v123 offset:33024
  buffer_store_dwordx4 v[104:107], v8, s[4:7], s44 offen offset:2560 sc1
  v_mul_f32 v26, s24, v26
  s_waitcnt lgkmcnt(4)
  v_mfma_f32_32x32x16_bf16 v[52:67], a[152:155], v[92:95], v[52:67]
  ds_read_b128 v[84:87], v124 offset:33024
  v_mul_f32 v27, s24, v27
  v_mul_f32 v28, s24, v28
  v_mul_f32 v29, s24, v29
  v_mul_f32 v30, s24, v30
  v_mfma_f32_32x32x16_bf16 v[52:67], a[156:159], v[96:99], v[52:67]
  ds_read_b128 v[88:91], v125 offset:33024
  v_mul_f32 v31, s24, v31
  v_mul_f32 v32, s24, v32
  v_mul_f32 v33, s24, v33
  v_mul_f32 v34, s24, v34
  s_waitcnt lgkmcnt(4)
  v_mfma_f32_32x32x16_bf16 v[52:67], a[160:163], v[68:71], v[52:67]
  ds_read_b128 v[92:95], v126 offset:33024
  v_mul_f32 v35, s24, v35
  v_cvt_pk_bf16_f32 v108, v20, v21
  v_cvt_pk_bf16_f32 v109, v22, v23
  v_cvt_pk_bf16_f32 v110, v28, v29
  v_mfma_f32_32x32x16_bf16 v[52:67], a[164:167], v[72:75], v[52:67]
  ds_read_b128 v[96:99], v127 offset:33024
  v_cvt_pk_bf16_f32 v111, v30, v31
  buffer_store_dwordx4 v[108:111], v8, s[4:7], s44 offen offset:0 sc1
  s_waitcnt lgkmcnt(4)
  v_mfma_f32_32x32x16_bf16 v[52:67], a[168:171], v[76:79], v[52:67]
  ds_read_b128 v[68:71], v120 offset:33280
  v_cvt_pk_bf16_f32 v112, v24, v25
  v_cvt_pk_bf16_f32 v113, v26, v27
  v_cvt_pk_bf16_f32 v114, v32, v33
  v_cvt_pk_bf16_f32 v115, v34, v35
  v_mfma_f32_32x32x16_bf16 v[52:67], a[172:175], v[80:83], v[52:67]
  ds_read_b128 v[72:75], v121 offset:33280
  buffer_store_dwordx4 v[112:115], v8, s[4:7], s44 offen offset:512 sc1
  s_waitcnt lgkmcnt(4)
  v_mfma_f32_32x32x16_bf16 v[52:67], a[176:179], v[84:87], v[52:67]
  ds_read_b128 v[76:79], v122 offset:33280
  v_mfma_f32_32x32x16_bf16 v[52:67], a[180:183], v[88:91], v[52:67]
  ds_read_b128 v[80:83], v123 offset:33280
  s_waitcnt lgkmcnt(4)
  v_mfma_f32_32x32x16_bf16 v[52:67], a[184:187], v[92:95], v[52:67]
  ds_read_b128 v[84:87], v124 offset:33280
  v_mfma_f32_32x32x16_bf16 v[52:67], a[188:191], v[96:99], v[52:67]
  ds_read_b128 v[88:91], v125 offset:33280
  s_waitcnt lgkmcnt(4)
  v_mfma_f32_32x32x16_bf16 v[52:67], a[192:195], v[68:71], v[52:67]
  ds_read_b128 v[92:95], v126 offset:33280
  v_mfma_f32_32x32x16_bf16 v[52:67], a[196:199], v[72:75], v[52:67]
  ds_read_b128 v[96:99], v127 offset:33280
  s_waitcnt lgkmcnt(4)
  v_mfma_f32_32x32x16_bf16 v[52:67], a[200:203], v[76:79], v[52:67]
  ds_read_b128 v[68:71], v120 offset:33536
  v_mfma_f32_32x32x16_bf16 v[52:67], a[204:207], v[80:83], v[52:67]
  ds_read_b128 v[72:75], v121 offset:33536
  s_waitcnt lgkmcnt(4)
  v_mfma_f32_32x32x16_bf16 v[52:67], a[208:211], v[84:87], v[52:67]
  ds_read_b128 v[76:79], v122 offset:33536
  ds_read_b128 v[80:83], v123 offset:33536
  v_mfma_f32_32x32x16_bf16 v[52:67], a[212:215], v[88:91], v[52:67]
  ds_read_b128 v[84:87], v124 offset:33536
  ds_read_b128 v[88:91], v125 offset:33536
  s_waitcnt lgkmcnt(6)
  v_mfma_f32_32x32x16_bf16 v[52:67], a[216:219], v[92:95], v[52:67]
  ds_read_b128 v[92:95], v126 offset:33536
  v_mfma_f32_32x32x16_bf16 v[52:67], a[220:223], v[96:99], v[52:67]
  ds_read_b128 v[96:99], v127 offset:33536
  s_waitcnt lgkmcnt(6)
  v_mfma_f32_32x32x16_bf16 v[52:67], a[224:227], v[68:71], v[52:67]
  v_mfma_f32_32x32x16_bf16 v[52:67], a[228:231], v[72:75], v[52:67]
  s_waitcnt vmcnt(4) lgkmcnt(0)
  s_barrier
  ds_read_b128 v[100:103], v119 offset:128
  v_mfma_f32_32x32x16_bf16 v[52:67], a[232:235], v[76:79], v[52:67]
  ds_read_b128 v[68:71], v120 offset:0
  v_mfma_f32_32x32x16_bf16 v[52:67], a[236:239], v[80:83], v[52:67]
  ds_read_b128 v[72:75], v121 offset:0
  s_xor_b32 s50, s50, 32768
  v_mfma_f32_32x32x16_bf16 v[52:67], a[240:243], v[84:87], v[52:67]
  ds_read_b128 v[76:79], v122 offset:0
  v_mfma_f32_32x32x16_bf16 v[52:67], a[244:247], v[88:91], v[52:67]
  s_waitcnt lgkmcnt(3)
  v_min3_u32 v104, v100, v101, v102
  v_max3_u32 v100, v100, v101, v102
  v_min_u32 v104, v104, v103
  v_max_u32 v100, v100, v103
  v_readfirstlane_b32 s45, v104
  v_mfma_f32_32x32x16_bf16 v[52:67], a[248:251], v[92:95], v[52:67]
  v_readlane_b32 s28, v100, 0
  v_readlane_b32 s29, v100, 1
  v_readlane_b32 s30, v100, 2
  s_cmp_gt_u32 s55, 0
  s_cselect_b32 s45, 0, s45
  v_mfma_f32_32x32x16_bf16 v[52:67], a[252:255], v[96:99], v[52:67]
  s_cmp_eq_u32 s45, 0
  s_cbranch_scc1 q_slow_94
  s_cmp_lt_u32 s47, 64
  s_cbranch_scc1 q_w0_107
  s_cmp_gt_u32 s28, s56
  s_addc_u32 s42, s42, s42
  s_max_u32 s56, s56, s28
  s_and_b32 s26, s42, 1
  s_cselect_b32 s26, s40, 0
  s_cmp_gt_u32 s26, 10
  s_subb_u32 s40, s40, 0
  s_cmp_gt_u32 s29, s56
  s_addc_u32 s42, s42, s42
  s_max_u32 s56, s56, s29
  s_and_b32 s26, s42, 1
  s_cselect_b32 s26, s40, 0
  s_cmp_gt_u32 s26, 10
  s_subb_u32 s40, s40, 0
  s_cmp_gt_u32 s30, s56
  s_addc_u32 s42, s42, s42
  s_max_u32 s56, s56, s30
  s_add_u32 s76, s47, s40
  s_add_u32 s41, s47, 3
  s_sub_u32 s76, s76, 64
  s_and_b32 s26, s42, 1
  s_cselect_b32 s26, s40, 0
  s_cmp_gt_u32 s26, 10
  s_cselect_b32 s76, 64, s76
  s_subb_u32 s40, s40, 0
  s_cmp_lt_u32 s76, 64
  s_cselect_b32 s76, s76, s41
  s_bitcmp1_b32 s42, 0
  s_cbranch_scc0 q_w0_107
  s_branch q_forkw_103
q_forkw_103:
  v_cvt_pk_bf16_f32 v100, v52, v53
  v_cvt_pk_bf16_f32 v101, v54, v55
  v_cvt_pk_bf16_f32 v102, v60, v61
  v_cvt_pk_bf16_f32 v103, v62, v63
  v_cvt_pk_bf16_f32 v104, v56, v57
  v_cvt_pk_bf16_f32 v105, v58, v59
  v_cvt_pk_bf16_f32 v106, v64, v65
  v_cvt_pk_bf16_f32 v107, v66, v67
  s_waitcnt vmcnt(0)
  s_mov_b64 exec, 1
  buffer_store_dword v4, off, s[4:7], s49 sc1
  s_mov_b64 exec, -1
  buffer_store_dwordx4 v[100:103], v8, s[4:7], s43 offen offset:0 sc1
  buffer_store_dwordx4 v[104:107], v8, s[4:7], s43 offen offset:512 sc1
  s_mov_b32 s43, 268435456
  s_waitcnt lgkmcnt(0)
q_fork_101:
  s_mov_b32 s58, s56
  s_mov_b32 s46, s47
  s_mov_b32 s47, s76
  s_add_u32 s76, s47, 3
  s_cmp_lt_u32 s76, 18
  s_cselect_b32 s76, s76, s41
  s_andn2_b32 s59, 0xfff, s58
  s_lshl_b32 s26, s61, 21
  s_lshl_b32 s27, s59, 10
  s_add_u32 s26, s26, s27
  s_lshl_b32 s27, s17, 8
  s_add_u32 s26, s26, s27
  s_add_u32 s26, s26, 27262976
  v_lshrrev_b32 v5, 7, v0
  v_lshlrev_b32 v5, 5, v5
  buffer_load_dwordx4 v[52:55], v5, s[4:7], s26 offen offset:0 sc1
  buffer_load_dwordx4 v[56:59], v5, s[4:7], s26 offen offset:16 sc1
  s_load_dwordx2 s[64:65], s[0:1], 72
  s_load_dwordx2 s[68:69], s[0:1], 80
  s_load_dwordx2 s[8:9], s[0:1], 88
  s_mov_b32 s66, 1835008
  s_mov_b32 s70, 1835008
  s_mov_b32 s10, 1835008
  v_lshrrev_b32 v2, 7, v0
  v_and_b32 v3, 0x70, v0
  v_mul_u32_u24 v6, 57344, v2
  v_add_u32 v6, v6, v3
  v_cmp_eq_u32 vcc, 0x70, v3
  v_mov_b32 v3, 0x7ff00000
  s_nop 0
  v_cndmask_b32 v6, v6, v3, vcc
  v_lshrrev_b32 v2, 8, v0
  v_mul_u32_u24 v7, 14336, v2
  v_and_b32 v3, 0xf0, v0
  v_add_u32 v7, v7, v3
  s_mul_i32 s34, s17, 458752
  s_mul_i32 s27, s16, 112
  s_add_u32 s34, s34, s27
  s_mul_i32 s35, s16, 57344
  s_lshl_b32 s27, s17, 8
  s_add_u32 s35, s35, s27
  s_waitcnt lgkmcnt(0)
  s_xor_b32 s37, s50, 32768
  s_add_u32 s37, s37, s54
  s_mov_b32 m0, s37
  s_add_u32 s36, s34, 39424
  buffer_load_dwordx4 v6, s[68:71], s36 offen lds
  s_add_u32 m0, m0, 1024
  s_add_u32 s36, s34, 43008
  buffer_load_dwordx4 v6, s[64:67], s36 offen lds
  s_add_u32 m0, m0, 1024
  s_add_u32 s36, s34, 43008
  buffer_load_dwordx4 v6, s[68:71], s36 offen lds
  s_add_u32 m0, m0, 1024
  s_add_u32 s36, s34, 46592
  buffer_load_dwordx4 v6, s[64:67], s36 offen lds
  s_add_u32 m0, m0, 1024
  s_add_u32 s36, s34, 46592
  buffer_load_dwordx4 v6, s[68:71], s36 offen lds
  s_add_u32 m0, m0, 1024
  s_add_u32 s36, s34, 50176
  buffer_load_dwordx4 v6, s[64:67], s36 offen lds
  s_add_u32 m0, m0, 1024
  s_add_u32 s36, s34, 50176
  buffer_load_dwordx4 v6, s[68:71], s36 offen lds
  s_add_u32 m0, m0, 1024
  s_add_u32 s36, s34, 53760
  buffer_load_dwordx4 v6, s[64:67], s36 offen lds
  s_add_u32 m0, m0, 1024
  s_add_u32 s36, s34, 53760
  buffer_load_dwordx4 v[60:63], v6, s[68:71], s36 offen
  buffer_load_dwordx4 v[64:67], v7, s[8:11], s35 offen offset:0
  v_add_u32 v120, s50, v120
  v_add_u32 v121, s50, v121
  v_add_u32 v122, s50, v122
  v_add_u32 v123, s50, v123
  v_add_u32 v124, s50, v124
  v_add_u32 v125, s50, v125
  v_add_u32 v126, s50, v126
  v_add_u32 v127, s50, v127
  s_lshl_b32 s52, s46, 7
  s_add_u32 s52, s52, s57
  s_lshl_b32 s77, s52, 12
  s_add_u32 s44, s77, 75497472
  s_add_u32 s77, s77, 41943040
  s_lshl_b32 s51, s52, 5
  s_add_u32 s51, s51, 244318208
  s_waitcnt vmcnt(12)
  s_barrier
  s_mov_b64 exec, 3
  buffer_store_dword v4, v0, s[4:7], s49 offen sc1
  s_mov_b64 exec, -1
  v_mov_b32 v4, 2
  s_mov_b32 s49, s51
  ds_read_b128 v[68:71], v120 offset:0
  ds_read_b128 v[72:75], v121 offset:0
  ds_read_b128 v[76:79], v122 offset:0
  ds_read_b128 v[80:83], v123 offset:0
  s_waitcnt lgkmcnt(3)
  v_mfma_f32_32x32x16_bf16 v[20:35], v[128:131], v[68:71], 0
  v_mfma_f32_32x32x16_bf16 v[36:51], v[68:71], a[0:3], 0
  s_waitcnt lgkmcnt(2)
  v_mfma_f32_32x32x16_bf16 v[20:35], v[132:135], v[72:75], v[20:35]
  ds_read_b128 v[84:87], v124 offset:0
  v_mfma_f32_32x32x16_bf16 v[36:51], v[72:75], a[4:7], v[36:51]
  s_waitcnt lgkmcnt(2)
  v_mfma_f32_32x32x16_bf16 v[20:35], v[136:139], v[76:79], v[20:35]
  ds_read_b128 v[88:91], v125 offset:0
  v_mfma_f32_32x32x16_bf16 v[36:51], v[76:79], a[8:11], v[36:51]
  s_waitcnt lgkmcnt(2)
  v_mfma_f32_32x32x16_bf16 v[20:35], v[140:143], v[80:83], v[20:35]
  ds_read_b128 v[92:95], v126 offset:0
  v_mfma_f32_32x32x16_bf16 v[36:51], v[80:83], a[12:15], v[36:51]
  s_waitcnt lgkmcnt(2)
  v_mfma_f32_32x32x16_bf16 v[20:35], v[144:147], v[84:87], v[20:35]
  ds_read_b128 v[96:99], v127 offset:0
  v_mfma_f32_32x32x16_bf16 v[36:51], v[84:87], a[16:19], v[36:51]
  s_waitcnt lgkmcnt(2)
  v_mfma_f32_32x32x16_bf16 v[20:35], v[148:151], v[88:91], v[20:35]
  ds_read_b128 v[68:71], v120 offset:256
  v_mfma_f32_32x32x16_bf16 v[36:51], v[88:91], a[20:23], v[36:51]
  s_waitcnt lgkmcnt(2)
  v_mfma_f32_32x32x16_bf16 v[20:35], v[152:155], v[92:95], v[20:35]
  ds_read_b128 v[72:75], v121 offset:256
  v_mfma_f32_32x32x16_bf16 v[36:51], v[92:95], a[24:27], v[36:51]
  s_waitcnt lgkmcnt(2)
  v_mfma_f32_32x32x16_bf16 v[20:35], v[156:159], v[96:99], v[20:35]
  ds_read_b128 v[76:79], v122 offset:256
  v_mfma_f32_32x32x16_bf16 v[36:51], v[96:99], a[28:31], v[36:51]
  s_waitcnt lgkmcnt(2)
  v_mfma_f32_32x32x16_bf16 v[20:35], v[160:163], v[68:71], v[20:35]
  ds_read_b128 v[80:83], v123 offset:256
  v_mfma_f32_32x32x16_bf16 v[36:51], v[68:71], a[32:35], v[36:51]
  s_waitcnt lgkmcnt(2)
  v_mfma_f32_32x32x16_bf16 v[20:35], v[164:167], v[72:75], v[20:35]
  ds_read_b128 v[84:87], v124 offset:256
  v_mfma_f32_32x32x16_bf16 v[36:51], v[72:75], a[36:39], v[36:51]
  s_waitcnt lgkmcnt(2)
  v_mfma_f32_32x32x16_bf16 v[20:35], v[168:171], v[76:79], v[20:35]
  ds_read_b128 v[88:91], v125 offset:256
  v_mfma_f32_32x32x16_bf16 v[36:51], v[76:79], a[40:43], v[36:51]
  s_waitcnt lgkmcnt(2)
  v_mfma_f32_32x32x16_bf16 v[20:35], v[172:175], v[80:83], v[20:35]
  ds_read_b128 v[92:95], v126 offset:256
  v_mfma_f32_32x32x16_bf16 v[36:51], v[80:83], a[44:47], v[36:51]
  s_waitcnt lgkmcnt(2)
  v_mfma_f32_32x32x16_bf16 v[20:35], v[176:179], v[84:87], v[20:35]
  ds_read_b128 v[96:99], v127 offset:256
  v_mfma_f32_32x32x16_bf16 v[36:51], v[84:87], a[48:51], v[36:51]
  s_waitcnt lgkmcnt(2)
  v_mfma_f32_32x32x16_bf16 v[20:35], v[180:183], v[88:91], v[20:35]
  ds_read_b128 v[68:71], v120 offset:512
  v_mfma_f32_32x32x16_bf16 v[36:51], v[88:91], a[52:55], v[36:51]
  s_waitcnt lgkmcnt(2)
  v_mfma_f32_32x32x16_bf16 v[20:35], v[184:187], v[92:95], v[20:35]
  ds_read_b128 v[72:75], v121 offset:512
  v_mfma_f32_32x32x16_bf16 v[36:51], v[92:95], a[56:59], v[36:51]
  s_waitcnt lgkmcnt(2)
  v_mfma_f32_32x32x16_bf16 v[20:35], v[188:191], v[96:99], v[20:35]
  ds_read_b128 v[76:79], v122 offset:512
  v_mfma_f32_32x32x16_bf16 v[36:51], v[96:99], a[60:63], v[36:51]
  s_waitcnt lgkmcnt(2)
  v_mfma_f32_32x32x16_bf16 v[20:35], v[192:195], v[68:71], v[20:35]
  ds_read_b128 v[80:83], v123 offset:512
  v_mfma_f32_32x32x16_bf16 v[36:51], v[68:71], a[64:67], v[36:51]
  s_waitcnt lgkmcnt(2)
  v_mfma_f32_32x32x16_bf16 v[20:35], v[196:199], v[72:75], v[20:35]
  ds_read_b128 v[84:87], v124 offset:512
  v_mfma_f32_32x32x16_bf16 v[36:51], v[72:75], a[68:71], v[36:51]
  s_waitcnt lgkmcnt(2)
  v_mfma_f32_32x32x16_bf16 v[20:35], v[200:203], v[76:79], v[20:35]
  ds_read_b128 v[88:91], v125 offset:512
  v_mfma_f32_32x32x16_bf16 v[36:51], v[76:79], a[72:75], v[36:51]
  s_waitcnt lgkmcnt(2)
  v_mfma_f32_32x32x16_bf16 v[20:35], v[204:207], v[80:83], v[20:35]
  ds_read_b128 v[92:95], v126 offset:512
  v_mfma_f32_32x32x16_bf16 v[36:51], v[80:83], a[76:79], v[36:51]
  s_waitcnt lgkmcnt(2)
  v_mfma_f32_32x32x16_bf16 v[20:35], v[208:211], v[84:87], v[20:35]
  ds_read_b128 v[96:99], v127 offset:512
  v_mfma_f32_32x32x16_bf16 v[36:51], v[84:87], a[80:83], v[36:51]
  s_waitcnt lgkmcnt(2)
  v_mfma_f32_32x32x16_bf16 v[20:35], v[212:215], v[88:91], v[20:35]
  ds_read_b128 v[68:71], v120 offset:768
  v_mfma_f32_32x32x16_bf16 v[36:51], v[88:91], a[84:87], v[36:51]
  s_waitcnt lgkmcnt(2)
  v_mfma_f32_32x32x16_bf16 v[20:35], v[216:219], v[92:95], v[20:35]
  ds_read_b128 v[72:75], v121 offset:768
  v_mfma_f32_32x32x16_bf16 v[36:51], v[92:95], a[88:91], v[36:51]
  s_waitcnt lgkmcnt(2)
  v_mfma_f32_32x32x16_bf16 v[20:35], v[220:223], v[96:99], v[20:35]
  ds_read_b128 v[76:79], v122 offset:768
  v_mfma_f32_32x32x16_bf16 v[36:51], v[96:99], a[92:95], v[36:51]
  s_waitcnt lgkmcnt(2)
  v_mfma_f32_32x32x16_bf16 v[20:35], v[224:227], v[68:71], v[20:35]
  ds_read_b128 v[80:83], v123 offset:768
  v_mfma_f32_32x32x16_bf16 v[36:51], v[68:71], a[96:99], v[36:51]
  s_waitcnt lgkmcnt(2)
  v_mfma_f32_32x32x16_bf16 v[20:35], v[228:231], v[72:75], v[20:35]
  ds_read_b128 v[84:87], v124 offset:768
  v_mfma_f32_32x32x16_bf16 v[36:51], v[72:75], a[100:103], v[36:51]
  s_waitcnt lgkmcnt(2)
  v_mfma_f32_32x32x16_bf16 v[20:35], v[232:235], v[76:79], v[20:35]
  ds_read_b128 v[88:91], v125 offset:768
  v_mfma_f32_32x32x16_bf16 v[36:51], v[76:79], a[104:107], v[36:51]
  s_waitcnt lgkmcnt(2)
  v_mfma_f32_32x32x16_bf16 v[20:35], v[236:239], v[80:83], v[20:35]
  ds_read_b128 v[92:95], v126 offset:768
  v_mfma_f32_32x32x16_bf16 v[36:51], v[80:83], a[108:111], v[36:51]
  s_waitcnt lgkmcnt(2)
  v_mfma_f32_32x32x16_bf16 v[20:35], v[240:243], v[84:87], v[20:35]
  ds_read_b128 v[96:99], v127 offset:768
  v_mfma_f32_32x32x16_bf16 v[36:51], v[84:87], a[112:115], v[36:51]
  s_waitcnt lgkmcnt(2)
  v_mfma_f32_32x32x16_bf16 v[20:35], v[244:247], v[88:91], v[20:35]
  v_mfma_f32_32x32x16_bf16 v[36:51], v[88:91], a[116:119], v[36:51]
  s_waitcnt lgkmcnt(1)
  v_mfma_f32_32x32x16_bf16 v[20:35], v[248:251], v[92:95], v[20:35]
  v_mfma_f32_32x32x16_bf16 v[36:51], v[92:95], a[120:123], v[36:51]
  s_waitcnt lgkmcnt(0)
  v_mfma_f32_32x32x16_bf16 v[20:35], v[252:255], v[96:99], v[20:35]
  v_mfma_f32_32x32x16_bf16 v[36:51], v[96:99], a[124:127], v[36:51]
  s_nop 3
  v_mul_f32 v20, s24, v20
  v_mul_f32 v21, s24, v21
  v_mul_f32 v22, s24, v22
  v_mul_f32 v23, s24, v23
  v_mul_f32 v24, s24, v24
  v_mul_f32 v25, s24, v25
  v_mul_f32 v26, s24, v26
  v_mul_f32 v27, s24, v27
  v_mul_f32 v28, s24, v28
  v_mul_f32 v29, s24, v29
  v_mul_f32 v30, s24, v30
  v_mul_f32 v31, s24, v31
  v_mul_f32 v32, s24, v32
  v_mul_f32 v33, s24, v33
  v_mul_f32 v34, s24, v34
  v_mul_f32 v35, s24, v35
  v_cvt_pk_bf16_f32 v108, v20, v21
  v_cvt_pk_bf16_f32 v109, v22, v23
  v_cvt_pk_bf16_f32 v110, v28, v29
  v_cvt_pk_bf16_f32 v111, v30, v31
  buffer_store_dwordx4 v[108:111], v8, s[4:7], s77 offen offset:0 sc1
  v_cvt_pk_bf16_f32 v112, v24, v25
  v_cvt_pk_bf16_f32 v113, v26, v27
  v_cvt_pk_bf16_f32 v114, v32, v33
  v_cvt_pk_bf16_f32 v115, v34, v35
  buffer_store_dwordx4 v[112:115], v8, s[4:7], s77 offen offset:512 sc1
  v_cvt_pk_bf16_f32 v100, v36, v37
  v_cvt_pk_bf16_f32 v101, v38, v39
  v_cvt_pk_bf16_f32 v102, v44, v45
  v_cvt_pk_bf16_f32 v103, v46, v47
  buffer_store_dwordx4 v[100:103], v8, s[4:7], s77 offen offset:2048 sc1
  v_cvt_pk_bf16_f32 v104, v40, v41
  v_cvt_pk_bf16_f32 v105, v42, v43
  v_cvt_pk_bf16_f32 v106, v48, v49
  v_cvt_pk_bf16_f32 v107, v50, v51
  buffer_store_dwordx4 v[104:107], v8, s[4:7], s77 offen offset:2560 sc1
  buffer_store_dwordx4 v[108:111], v8, s[4:7], s44 offen offset:0 sc1
  buffer_store_dwordx4 v[112:115], v8, s[4:7], s44 offen offset:512 sc1
  buffer_store_dwordx4 v[100:103], v8, s[4:7], s44 offen offset:2048 sc1
  buffer_store_dwordx4 v[104:107], v8, s[4:7], s44 offen offset:2560 sc1
  buffer_load_dwordx4 v[68:71], v7, s[8:11], s35 offen offset:1024
  buffer_load_dwordx4 v[72:75], v7, s[8:11], s35 offen offset:2048
  buffer_load_dwordx4 v[76:79], v7, s[8:11], s35 offen offset:3072
  s_add_u32 s35, s35, 4096
  buffer_load_dwordx4 v[80:83], v7, s[8:11], s35 offen offset:0
  buffer_load_dwordx4 v[84:87], v7, s[8:11], s35 offen offset:1024
  buffer_load_dwordx4 v[88:91], v7, s[8:11], s35 offen offset:2048
  buffer_load_dwordx4 v[92:95], v7, s[8:11], s35 offen offset:3072
  s_add_u32 s35, s35, 4096
  buffer_load_dwordx4 v[96:99], v7, s[8:11], s35 offen offset:0
  buffer_load_dwordx4 v[100:103], v7, s[8:11], s35 offen offset:1024
  buffer_load_dwordx4 v[104:107], v7, s[8:11], s35 offen offset:2048
  buffer_load_dwordx4 v[108:111], v7, s[8:11], s35 offen offset:3072
  s_add_u32 s35, s35, 4096
  buffer_load_dwordx4 v[112:115], v7, s[8:11], s35 offen offset:0
  buffer_load_dwordx4 v[48:51], v7, s[8:11], s35 offen offset:1024
  s_mov_b32 vcc_lo, 0xaaaaaaaa
  s_mov_b32 vcc_hi, 0xaaaaaaaa
  v_mov_b32 v3, 0xffff
  v_mov_b32 v24, 0xffff0000
  v_cndmask_b32 v3, v3, v24, vcc
  s_mov_b32 vcc_lo, 0x3030303
  s_mov_b32 vcc_hi, 0x3030303
  v_cndmask_b32 v24, 0, v3, vcc
  s_mov_b32 vcc_lo, 0xc0c0c0c
  s_mov_b32 vcc_hi, 0xc0c0c0c
  v_cndmask_b32 v25, 0, v3, vcc
  s_mov_b32 vcc_lo, 0x30303030
  s_mov_b32 vcc_hi, 0x30303030
  v_cndmask_b32 v26, 0, v3, vcc
  s_mov_b32 vcc_lo, 0xc0c0c0c0
  s_mov_b32 vcc_hi, 0xc0c0c0c0
  v_cndmask_b32 v27, 0, v3, vcc
  s_mov_b32 s30, 0x01000100
  s_mov_b32 s31, 0x03020302
  s_mul_i32 s26, s17, 23552
  s_add_u32 s26, s26, 65536
  v_add_u32 v5, s26, v0
  v_add_u32 v2, s37, v0
  ds_read_b128 v[36:39], v5 offset:0
  ds_read_b128 v[40:43], v5 offset:1024
  ds_read_b128 v[44:47], v5 offset:2048
  ds_read_b128 v[12:15], v5 offset:3072
  ds_read_b128 v[16:19], v5 offset:4096
  ds_read_b128 v[120:123], v5 offset:5120
  ds_read_b128 v[124:127], v5 offset:6144
  s_waitcnt vmcnt(32)
  s_waitcnt vmcnt(17)
  s_mov_b64 exec, 1
  buffer_store_dword v4, off, s[4:7], s51 sc1
  s_mov_b64 exec, -1
  v_perm_b32 v3, v52, v52, s30
  v_and_b32 v20, v24, v3
  v_and_b32 v21, v25, v3
  v_and_b32 v22, v26, v3
  v_and_b32 v23, v27, v3
  s_waitcnt lgkmcnt(5)
  s_nop 0
  v_mfma_f32_16x16x32_bf16 v[28:31], v[20:23], v[36:39], 0
  ds_read_b128 v[36:39], v5 offset:7168
  v_mfma_f32_16x16x32_bf16 v[32:35], v[20:23], v[40:43], 0
  ds_read_b128 v[40:43], v5 offset:8192
  v_perm_b32 v3, v52, v52, s31
  v_and_b32 v20, v24, v3
  v_and_b32 v21, v25, v3
  v_and_b32 v22, v26, v3
  v_and_b32 v23, v27, v3
  s_waitcnt lgkmcnt(5)
  s_nop 0
  v_mfma_f32_16x16x32_bf16 v[28:31], v[20:23], v[44:47], v[28:31]
  ds_read_b128 v[44:47], v5 offset:9216
  v_mfma_f32_16x16x32_bf16 v[32:35], v[20:23], v[12:15], v[32:35]
  ds_read_b128 v[12:15], v5 offset:10240
  v_perm_b32 v3, v53, v53, s30
  v_and_b32 v20, v24, v3
  v_and_b32 v21, v25, v3
  v_and_b32 v22, v26, v3
  v_and_b32 v23, v27, v3
  s_waitcnt lgkmcnt(5)
  s_nop 0
  v_mfma_f32_16x16x32_bf16 v[28:31], v[20:23], v[16:19], v[28:31]
  ds_read_b128 v[16:19], v5 offset:11264
  v_mfma_f32_16x16x32_bf16 v[32:35], v[20:23], v[120:123], v[32:35]
  ds_read_b128 v[120:123], v5 offset:12288
  v_perm_b32 v3, v53, v53, s31
  v_and_b32 v20, v24, v3
  v_and_b32 v21, v25, v3
  v_and_b32 v22, v26, v3
  v_and_b32 v23, v27, v3
  s_waitcnt lgkmcnt(5)
  s_nop 0
  v_mfma_f32_16x16x32_bf16 v[28:31], v[20:23], v[124:127], v[28:31]
  ds_read_b128 v[124:127], v5 offset:13312
  v_mfma_f32_16x16x32_bf16 v[32:35], v[20:23], v[36:39], v[32:35]
  ds_read_b128 v[36:39], v5 offset:14336
  v_perm_b32 v3, v54, v54, s30
  v_and_b32 v20, v24, v3
  v_and_b32 v21, v25, v3
  v_and_b32 v22, v26, v3
  v_and_b32 v23, v27, v3
  s_waitcnt lgkmcnt(5)
  s_nop 0
  v_mfma_f32_16x16x32_bf16 v[28:31], v[20:23], v[40:43], v[28:31]
  ds_read_b128 v[40:43], v5 offset:15360
  v_mfma_f32_16x16x32_bf16 v[32:35], v[20:23], v[44:47], v[32:35]
  ds_read_b128 v[44:47], v5 offset:16384
  v_perm_b32 v3, v54, v54, s31
  v_and_b32 v20, v24, v3
  v_and_b32 v21, v25, v3
  v_and_b32 v22, v26, v3
  v_and_b32 v23, v27, v3
  s_waitcnt lgkmcnt(5)
  s_nop 0
  v_mfma_f32_16x16x32_bf16 v[28:31], v[20:23], v[12:15], v[28:31]
  ds_read_b128 v[12:15], v5 offset:17408
  v_mfma_f32_16x16x32_bf16 v[32:35], v[20:23], v[16:19], v[32:35]
  ds_read_b128 v[16:19], v5 offset:18432
  v_perm_b32 v3, v55, v55, s30
  v_and_b32 v20, v24, v3
  v_and_b32 v21, v25, v3
  v_and_b32 v22, v26, v3
  v_and_b32 v23, v27, v3
  s_waitcnt lgkmcnt(5)
  s_nop 0
  v_mfma_f32_16x16x32_bf16 v[28:31], v[20:23], v[120:123], v[28:31]
  ds_read_b128 v[120:123], v5 offset:19456
  v_mfma_f32_16x16x32_bf16 v[32:35], v[20:23], v[124:127], v[32:35]
  ds_read_b128 v[124:127], v5 offset:20480
  v_perm_b32 v3, v55, v55, s31
  v_and_b32 v20, v24, v3
  v_and_b32 v21, v25, v3
  v_and_b32 v22, v26, v3
  v_and_b32 v23, v27, v3
  s_waitcnt lgkmcnt(5)
  s_nop 0
  v_mfma_f32_16x16x32_bf16 v[28:31], v[20:23], v[36:39], v[28:31]
  ds_read_b128 v[36:39], v5 offset:21504
  v_mfma_f32_16x16x32_bf16 v[32:35], v[20:23], v[40:43], v[32:35]
  ds_read_b128 v[40:43], v5 offset:22528
  v_perm_b32 v3, v56, v56, s30
  v_and_b32 v20, v24, v3
  v_and_b32 v21, v25, v3
  v_and_b32 v22, v26, v3
  v_and_b32 v23, v27, v3
  s_waitcnt lgkmcnt(5)
  s_nop 0
  v_mfma_f32_16x16x32_bf16 v[28:31], v[20:23], v[44:47], v[28:31]
  ds_read_b128 v[44:47], v2 offset:0
  v_mfma_f32_16x16x32_bf16 v[32:35], v[20:23], v[12:15], v[32:35]
  ds_read_b128 v[12:15], v2 offset:1024
  v_perm_b32 v3, v56, v56, s31
  v_and_b32 v20, v24, v3
  v_and_b32 v21, v25, v3
  v_and_b32 v22, v26, v3
  v_and_b32 v23, v27, v3
  s_waitcnt lgkmcnt(5)
  s_nop 0
  v_mfma_f32_16x16x32_bf16 v[28:31], v[20:23], v[16:19], v[28:31]
  ds_read_b128 v[16:19], v2 offset:2048
  v_mfma_f32_16x16x32_bf16 v[32:35], v[20:23], v[120:123], v[32:35]
  ds_read_b128 v[120:123], v2 offset:3072
  v_perm_b32 v3, v57, v57, s30
  v_and_b32 v20, v24, v3
  v_and_b32 v21, v25, v3
  v_and_b32 v22, v26, v3
  v_and_b32 v23, v27, v3
  s_waitcnt lgkmcnt(5)
  s_nop 0
  v_mfma_f32_16x16x32_bf16 v[28:31], v[20:23], v[124:127], v[28:31]
  ds_read_b128 v[124:127], v2 offset:4096
  v_mfma_f32_16x16x32_bf16 v[32:35], v[20:23], v[36:39], v[32:35]
  ds_read_b128 v[36:39], v2 offset:5120
  v_perm_b32 v3, v57, v57, s31
  v_and_b32 v20, v24, v3
  v_and_b32 v21, v25, v3
  v_and_b32 v22, v26, v3
  v_and_b32 v23, v27, v3
  s_waitcnt lgkmcnt(5)
  s_nop 0
  v_mfma_f32_16x16x32_bf16 v[28:31], v[20:23], v[40:43], v[28:31]
  ds_read_b128 v[40:43], v2 offset:6144
  v_mfma_f32_16x16x32_bf16 v[32:35], v[20:23], v[44:47], v[32:35]
  ds_read_b128 v[44:47], v2 offset:7168
  v_perm_b32 v3, v58, v58, s30
  v_and_b32 v20, v24, v3
  v_and_b32 v21, v25, v3
  v_and_b32 v22, v26, v3
  v_and_b32 v23, v27, v3
  s_waitcnt lgkmcnt(5)
  s_nop 0
  v_mfma_f32_16x16x32_bf16 v[28:31], v[20:23], v[12:15], v[28:31]
  v_mfma_f32_16x16x32_bf16 v[32:35], v[20:23], v[16:19], v[32:35]
  v_perm_b32 v3, v58, v58, s31
  v_and_b32 v20, v24, v3
  v_and_b32 v21, v25, v3
  v_and_b32 v22, v26, v3
  v_and_b32 v23, v27, v3
  s_waitcnt lgkmcnt(3)
  s_nop 0
  v_mfma_f32_16x16x32_bf16 v[28:31], v[20:23], v[120:123], v[28:31]
  v_mfma_f32_16x16x32_bf16 v[32:35], v[20:23], v[124:127], v[32:35]
  v_perm_b32 v3, v59, v59, s30
  v_and_b32 v20, v24, v3
  v_and_b32 v21, v25, v3
  v_and_b32 v22, v26, v3
  v_and_b32 v23, v27, v3
  s_waitcnt lgkmcnt(1)
  s_nop 0
  v_mfma_f32_16x16x32_bf16 v[28:31], v[20:23], v[36:39], v[28:31]
  v_mfma_f32_16x16x32_bf16 v[32:35], v[20:23], v[40:43], v[32:35]
  v_perm_b32 v3, v59, v59, s31
  v_and_b32 v20, v24, v3
  v_and_b32 v21, v25, v3
  v_and_b32 v22, v26, v3
  v_and_b32 v23, v27, v3
  s_waitcnt lgkmcnt(0)
  s_nop 0
  v_mfma_f32_16x16x32_bf16 v[28:31], v[20:23], v[44:47], v[28:31]
  v_mfma_f32_16x16x32_bf16 v[32:35], v[20:23], v[60:63], v[32:35]
  v_lshrrev_b32 v2, 8, v0
  v_and_b32 v3, 0xf0, v0
  v_lshlrev_b32 v3, 1, v3
  v_and_b32 v5, 1, v2
  v_lshl_add_u32 v5, v5, 4, v3
  v_add_u32 v5, s37, v5
  s_mov_b32 exec_lo, 0x00ff00ff
  s_mov_b32 exec_hi, 0xff00ff00
  ds_write_b128 v5, v[28:31]
  ds_write_b128 v5, v[32:35] offset:512
  s_mov_b64 exec, -1
  s_xor_b32 s26, s50, 32768
  v_add_u32 v5, s26, v1
  v_lshl_add_u32 v3, v2, 4, v3
  s_waitcnt lgkmcnt(0)
  s_barrier
  ds_read2st64_b32 v[36:37], v5 offset0:0 offset1:1
  ds_read2st64_b32 v[52:53], v5 offset0:2 offset1:3
  ds_read2st64_b32 v[38:39], v5 offset0:32 offset1:33
  ds_read2st64_b32 v[54:55], v5 offset0:34 offset1:35
  ds_read2st64_b32 v[40:41], v5 offset0:64 offset1:65
  ds_read2st64_b32 v[56:57], v5 offset0:66 offset1:67
  ds_read2st64_b32 v[42:43], v5 offset0:96 offset1:97
  ds_read2st64_b32 v[58:59], v5 offset0:98 offset1:99
  s_waitcnt lgkmcnt(0)
  v_add_f32 v36, v36, v40
  v_add_f32 v37, v37, v41
  v_add_f32 v38, v38, v42
  v_add_f32 v39, v39, v43
  v_add_f32 v52, v52, v56
  v_add_f32 v53, v53, v57
  v_add_f32 v54, v54, v58
  v_add_f32 v55, v55, v59
  v_add_f32 v36, v36, v38
  v_add_f32 v37, v37, v39
  v_add_f32 v52, v52, v54
  v_add_f32 v53, v53, v55
  v_add_f32 v36, v36, v37
  v_add_f32 v52, v52, v53
  v_cvt_pk_bf16_f32 v36, 0, v36
  v_cvt_pk_bf16_f32 v52, 0, v52
  v_mul_f32 v40, 0xbfb8aa3b, v36
  v_exp_f32 v40, v40
  s_nop 0
  v_add_f32 v40, 1.0, v40
  v_rcp_f32 v40, v40
  s_nop 0
  v_mul_f32 v36, v36, v40
  v_cvt_pk_bf16_f32 v36, 0, v36
  v_mul_f32 v36, v36, v52
  v_cvt_pk_bf16_f32 v36, v36, v36
  s_lshl_b32 s26, s17, 8
  s_add_u32 s26, s26, 161792
  v_add_u32 v5, s26, v1
  ds_write_b32 v5, v36
  v_mul_u32_u24 v5, 56, v2
  v_add_u32 v5, s26, v5
  ds_read_b64 v[36:37], v5 offset:0
  ds_read_b64 v[38:39], v5 offset:8
  ds_read_b64 v[40:41], v5 offset:16
  ds_read_b64 v[42:43], v5 offset:24
  ds_read_b64 v[44:45], v5 offset:32
  ds_read_b64 v[46:47], v5 offset:40
  ds_read_b64 v[52:53], v5 offset:48
  s_waitcnt lgkmcnt(0)
  v_and_b32 v20, v24, v36
  v_and_b32 v21, v25, v36
  v_and_b32 v22, v26, v36
  v_and_b32 v23, v27, v36
  s_nop 0
  s_nop 0
  v_mfma_f32_16x16x32_bf16 v[28:31], v[20:23], v[64:67], 0
  v_and_b32 v32, v24, v37
  v_and_b32 v33, v25, v37
  v_and_b32 v34, v26, v37
  v_and_b32 v35, v27, v37
  s_waitcnt vmcnt(13)
  s_nop 0
  v_mfma_f32_16x16x32_bf16 v[28:31], v[32:35], v[68:71], v[28:31]
  v_and_b32 v20, v24, v38
  v_and_b32 v21, v25, v38
  v_and_b32 v22, v26, v38
  v_and_b32 v23, v27, v38
  s_waitcnt vmcnt(12)
  s_nop 0
  v_mfma_f32_16x16x32_bf16 v[28:31], v[20:23], v[72:75], v[28:31]
  v_and_b32 v32, v24, v39
  v_and_b32 v33, v25, v39
  v_and_b32 v34, v26, v39
  v_and_b32 v35, v27, v39
  s_waitcnt vmcnt(11)
  s_nop 0
  v_mfma_f32_16x16x32_bf16 v[28:31], v[32:35], v[76:79], v[28:31]
  v_and_b32 v20, v24, v40
  v_and_b32 v21, v25, v40
  v_and_b32 v22, v26, v40
  v_and_b32 v23, v27, v40
  s_waitcnt vmcnt(10)
  s_nop 0
  v_mfma_f32_16x16x32_bf16 v[28:31], v[20:23], v[80:83], v[28:31]
  v_and_b32 v32, v24, v41
  v_and_b32 v33, v25, v41
  v_and_b32 v34, v26, v41
  v_and_b32 v35, v27, v41
  s_waitcnt vmcnt(9)
  s_nop 0
  v_mfma_f32_16x16x32_bf16 v[28:31], v[32:35], v[84:87], v[28:31]
  v_and_b32 v20, v24, v42
  v_and_b32 v21, v25, v42
  v_and_b32 v22, v26, v42
  v_and_b32 v23, v27, v42
  s_waitcnt vmcnt(8)
  s_nop 0
  v_mfma_f32_16x16x32_bf16 v[28:31], v[20:23], v[88:91], v[28:31]
  v_and_b32 v32, v24, v43
  v_and_b32 v33, v25, v43
  v_and_b32 v34, v26, v43
  v_and_b32 v35, v27, v43
  s_waitcnt vmcnt(7)
  s_nop 0
  v_mfma_f32_16x16x32_bf16 v[28:31], v[32:35], v[92:95], v[28:31]
  v_and_b32 v20, v24, v44
  v_and_b32 v21, v25, v44
  v_and_b32 v22, v26, v44
  v_and_b32 v23, v27, v44
  s_waitcnt vmcnt(6)
  s_nop 0
  v_mfma_f32_16x16x32_bf16 v[28:31], v[20:23], v[96:99], v[28:31]
  v_and_b32 v32, v24, v45
  v_and_b32 v33, v25, v45
  v_and_b32 v34, v26, v45
  v_and_b32 v35, v27, v45
  s_waitcnt vmcnt(5)
  s_nop 0
  v_mfma_f32_16x16x32_bf16 v[28:31], v[32:35], v[100:103], v[28:31]
  v_and_b32 v20, v24, v46
  v_and_b32 v21, v25, v46
  v_and_b32 v22, v26, v46
  v_and_b32 v23, v27, v46
  s_waitcnt vmcnt(4)
  s_nop 0
  v_mfma_f32_16x16x32_bf16 v[28:31], v[20:23], v[104:107], v[28:31]
  v_and_b32 v32, v24, v47
  v_and_b32 v33, v25, v47
  v_and_b32 v34, v26, v47
  v_and_b32 v35, v27, v47
  s_waitcnt vmcnt(3)
  s_nop 0
  v_mfma_f32_16x16x32_bf16 v[28:31], v[32:35], v[108:111], v[28:31]
  v_and_b32 v20, v24, v52
  v_and_b32 v21, v25, v52
  v_and_b32 v22, v26, v52
  v_and_b32 v23, v27, v52
  s_waitcnt vmcnt(2)
  s_nop 0
  v_mfma_f32_16x16x32_bf16 v[28:31], v[20:23], v[112:115], v[28:31]
  v_and_b32 v32, v24, v53
  v_and_b32 v33, v25, v53
  v_and_b32 v34, v26, v53
  v_and_b32 v35, v27, v53
  s_waitcnt vmcnt(1)
  s_nop 0
  v_mfma_f32_16x16x32_bf16 v[28:31], v[32:35], v[48:51], v[28:31]
  v_lshrrev_b32 v3, 1, v3
  s_lshl_b32 s26, s46, 7
  s_add_u32 s26, s26, s57
  s_lshl_b32 s26, s26, 8
  s_add_u32 s26, s26, 244318208
  s_nop 2
  v_cvt_pk_bf16_f32 v28, v28, v29
  v_cvt_pk_bf16_f32 v29, v30, v31
  v_min_u32 v28, -2, v28
  v_min_u32 v29, -2, v29
  s_mov_b32 exec_hi, 0
  buffer_store_dwordx2 v[28:29], v3, s[4:7], s26 offen sc1
  s_mov_b32 exec_hi, -1
  v_lshrrev_b32 v7, 7, v0
  v_lshlrev_b32 v7, 12, v7
  v_and_b32 v2, 1023, v9
  s_lshl_b32 s26, s17, 10
  v_add3_u32 v7, v7, v2, s26
  v_mov_b32 v116, 0
  v_lshrrev_b32 v96, 9, v0
  v_lshlrev_b32 v96, 4, v96
  v_and_b32 v97, 0xf0, v0
  v_xor_b32 v96, v96, v97
  v_and_b32 v97, 0x1f0, v0
  v_lshl_add_u32 v96, v97, 6, v96
  v_add_u32 v96, s50, v96
  v_xor_b32 v120, 0, v96
  v_xor_b32 v121, 32, v96
  v_xor_b32 v122, 64, v96
  v_xor_b32 v123, 96, v96
  v_xor_b32 v124, 128, v96
  v_xor_b32 v125, 160, v96
  v_xor_b32 v126, 192, v96
  v_xor_b32 v127, 224, v96
  s_and_b32 s26, s17, 1
  s_lshl_b32 s26, s26, 7
  v_xor_b32 v96, s26, v0
  v_xor_b32 v12, 0, v96
  v_xor_b32 v13, 16, v96
  v_xor_b32 v14, 32, v96
  v_xor_b32 v15, 48, v96
  v_xor_b32 v16, 64, v96
  v_xor_b32 v17, 80, v96
  v_xor_b32 v18, 96, v96
  v_xor_b32 v19, 112, v96
  s_cmp_lt_u32 s47, 64
  s_cselect_b32 s26, 2, 0
  s_add_u32 s26, s26, s47
  s_lshl_b32 s26, s26, 12
  s_add_u32 s26, s26, 243261440
  s_mov_b64 exec, 0xffffff
  buffer_load_dword v116, v7, s[4:7], s26 offen sc1
  s_mov_b64 exec, -1
  s_lshl_b32 s26, s61, 21
  s_lshl_b32 s27, s59, 10
  s_add_u32 s26, s26, s27
  s_add_u32 s27, s26, 20971520
  s_add_u32 s28, s26, 27262976
  s_lshl_b32 s26, s46, 7
  s_add_u32 s26, s26, s17
  s_lshl_b32 s26, s26, 8
  s_add_u32 s26, s26, 244318208
  v_lshrrev_b32 v2, 8, v0
  v_and_b32 v3, 0xf0, v0
  v_lshl_add_u32 v5, v2, 10, v3
  buffer_load_dwordx4 v[108:111], v0, s[4:7], s27 offen sc1
  buffer_load_dwordx4 v[112:115], v0, s[4:7], s28 offen sc1
  s_mov_b32 s53, 0
  ds_read_b128 v[68:71], v120 offset:0
  ds_read_b128 v[72:75], v121 offset:0
  ds_read_b128 v[76:79], v122 offset:0
  ds_read_b128 v[80:83], v123 offset:0
  s_waitcnt lgkmcnt(2)
  v_mfma_f32_32x32x16_bf16 v[52:67], a[128:131], v[68:71], 0
  ds_read_b128 v[84:87], v124 offset:0
  ds_read_b128 v[88:91], v125 offset:0
  ds_read_b128 v[92:95], v126 offset:0
  v_mfma_f32_32x32x16_bf16 v[52:67], a[132:135], v[72:75], v[52:67]
  ds_read_b128 v[96:99], v127 offset:0
  s_waitcnt lgkmcnt(4)
  v_mfma_f32_32x32x16_bf16 v[52:67], a[136:139], v[76:79], v[52:67]
  ds_read_b128 v[68:71], v120 offset:256
  v_mfma_f32_32x32x16_bf16 v[52:67], a[140:143], v[80:83], v[52:67]
  ds_read_b128 v[72:75], v121 offset:256
  s_waitcnt lgkmcnt(4)
  v_mfma_f32_32x32x16_bf16 v[52:67], a[144:147], v[84:87], v[52:67]
  ds_read_b128 v[76:79], v122 offset:256
  v_mfma_f32_32x32x16_bf16 v[52:67], a[148:151], v[88:91], v[52:67]
  ds_read_b128 v[80:83], v123 offset:256
  s_waitcnt lgkmcnt(4)
  v_mfma_f32_32x32x16_bf16 v[52:67], a[152:155], v[92:95], v[52:67]
  ds_read_b128 v[84:87], v124 offset:256
  v_mfma_f32_32x32x16_bf16 v[52:67], a[156:159], v[96:99], v[52:67]
  ds_read_b128 v[88:91], v125 offset:256
  s_waitcnt lgkmcnt(4)
  v_mfma_f32_32x32x16_bf16 v[52:67], a[160:163], v[68:71], v[52:67]
  ds_read_b128 v[92:95], v126 offset:256
  v_mfma_f32_32x32x16_bf16 v[52:67], a[164:167], v[72:75], v[52:67]
  ds_read_b128 v[96:99], v127 offset:256
  s_waitcnt lgkmcnt(4)
  v_mfma_f32_32x32x16_bf16 v[52:67], a[168:171], v[76:79], v[52:67]
  ds_read_b128 v[68:71], v120 offset:512
  v_mfma_f32_32x32x16_bf16 v[52:67], a[172:175], v[80:83], v[52:67]
  ds_read_b128 v[72:75], v121 offset:512
  s_waitcnt lgkmcnt(4)
  v_mfma_f32_32x32x16_bf16 v[52:67], a[176:179], v[84:87], v[52:67]
  ds_read_b128 v[76:79], v122 offset:512
  v_mfma_f32_32x32x16_bf16 v[52:67], a[180:183], v[88:91], v[52:67]
  ds_read_b128 v[80:83], v123 offset:512
  s_waitcnt lgkmcnt(4)
  v_mfma_f32_32x32x16_bf16 v[52:67], a[184:187], v[92:95], v[52:67]
  ds_read_b128 v[84:87], v124 offset:512
  v_mfma_f32_32x32x16_bf16 v[52:67], a[188:191], v[96:99], v[52:67]
  ds_read_b128 v[88:91], v125 offset:512
  s_waitcnt lgkmcnt(4)
  v_mfma_f32_32x32x16_bf16 v[52:67], a[192:195], v[68:71], v[52:67]
  ds_read_b128 v[92:95], v126 offset:512
  v_mfma_f32_32x32x16_bf16 v[52:67], a[196:199], v[72:75], v[52:67]
  ds_read_b128 v[96:99], v127 offset:512
  s_waitcnt lgkmcnt(4)
  v_mfma_f32_32x32x16_bf16 v[52:67], a[200:203], v[76:79], v[52:67]
  ds_read_b128 v[68:71], v120 offset:768
  v_mfma_f32_32x32x16_bf16 v[52:67], a[204:207], v[80:83], v[52:67]
  ds_read_b128 v[72:75], v121 offset:768
  s_waitcnt lgkmcnt(4)
  v_mfma_f32_32x32x16_bf16 v[52:67], a[208:211], v[84:87], v[52:67]
  ds_read_b128 v[76:79], v122 offset:768
  v_mfma_f32_32x32x16_bf16 v[52:67], a[212:215], v[88:91], v[52:67]
  ds_read_b128 v[80:83], v123 offset:768
  s_waitcnt lgkmcnt(4)
  v_mfma_f32_32x32x16_bf16 v[52:67], a[216:219], v[92:95], v[52:67]
  ds_read_b128 v[84:87], v124 offset:768
  v_mfma_f32_32x32x16_bf16 v[52:67], a[220:223], v[96:99], v[52:67]
  ds_read_b128 v[88:91], v125 offset:768
  s_waitcnt lgkmcnt(4)
  v_mfma_f32_32x32x16_bf16 v[52:67], a[224:227], v[68:71], v[52:67]
  ds_read_b128 v[92:95], v126 offset:768
  v_mfma_f32_32x32x16_bf16 v[52:67], a[228:231], v[72:75], v[52:67]
  ds_read_b128 v[96:99], v127 offset:768
  s_waitcnt lgkmcnt(4)
  v_mfma_f32_32x32x16_bf16 v[52:67], a[232:235], v[76:79], v[52:67]
  v_mfma_f32_32x32x16_bf16 v[52:67], a[236:239], v[80:83], v[52:67]
  s_waitcnt lgkmcnt(2)
  v_mfma_f32_32x32x16_bf16 v[52:67], a[240:243], v[84:87], v[52:67]
  v_mfma_f32_32x32x16_bf16 v[52:67], a[244:247], v[88:91], v[52:67]
  s_waitcnt lgkmcnt(0)
  v_mfma_f32_32x32x16_bf16 v[52:67], a[248:251], v[92:95], v[52:67]
  v_mfma_f32_32x32x16_bf16 v[52:67], a[252:255], v[96:99], v[52:67]
  s_lshl_b32 s28, s52, 11
  s_add_u32 s77, s28, 159383552
  s_add_u32 s28, s28, 142606336
  s_add_u32 s51, s51, 262144
  s_nop 7
  v_cvt_pk_bf16_f32 v100, v52, v53
  v_cvt_pk_bf16_f32 v101, v54, v55
  v_cvt_pk_bf16_f32 v102, v60, v61
  v_cvt_pk_bf16_f32 v103, v62, v63
  v_cvt_pk_bf16_f32 v104, v56, v57
  v_cvt_pk_bf16_f32 v105, v58, v59
  v_cvt_pk_bf16_f32 v106, v64, v65
  v_cvt_pk_bf16_f32 v107, v66, v67
m_w_111:
  s_add_u32 s27, s26, 0
  buffer_load_dwordx4 v[20:23], v5, s[4:7], s27 offen sc1
  s_add_u32 s27, s26, 4096
  buffer_load_dwordx4 v[24:27], v5, s[4:7], s27 offen sc1
  s_add_u32 s27, s26, 8192
  buffer_load_dwordx4 v[28:31], v5, s[4:7], s27 offen sc1
  s_add_u32 s27, s26, 12288
  buffer_load_dwordx4 v[32:35], v5, s[4:7], s27 offen sc1
  s_add_u32 s27, s26, 16384
  buffer_load_dwordx4 v[36:39], v5, s[4:7], s27 offen sc1
  s_add_u32 s27, s26, 20480
  buffer_load_dwordx4 v[40:43], v5, s[4:7], s27 offen sc1
  s_add_u32 s27, s26, 24576
  buffer_load_dwordx4 v[44:47], v5, s[4:7], s27 offen sc1
  s_add_u32 s27, s26, 28672
  buffer_load_dwordx4 v[48:51], v5, s[4:7], s27 offen sc1
  s_add_u32 s53, s53, 1
  s_cmp_gt_u32 s53, 1048576
  s_cbranch_scc1 q_fail_98
  s_mov_b32 vcc_lo, 0xaaaaaaaa
  s_mov_b32 vcc_hi, 0xaaaaaaaa
  v_mov_b32 v72, 0x3f80
  v_mov_b32 v68, 1.0
  v_cndmask_b32 v72, v72, v68, vcc
  s_mov_b32 vcc_lo, 0x30003
  s_mov_b32 vcc_hi, 0x30003
  v_cndmask_b32 v68, 0, v72, vcc
  s_mov_b32 vcc_lo, 0xc000c
  s_mov_b32 vcc_hi, 0xc000c
  v_cndmask_b32 v69, 0, v72, vcc
  s_mov_b32 vcc_lo, 0x300030
  s_mov_b32 vcc_hi, 0x300030
  v_cndmask_b32 v70, 0, v72, vcc
  s_mov_b32 vcc_lo, 0xc000c0
  s_mov_b32 vcc_hi, 0xc000c0
  v_cndmask_b32 v71, 0, v72, vcc
  s_waitcnt vmcnt(7)
  s_nop 0
  v_mfma_f32_16x16x32_bf16 v[72:75], v[68:71], v[20:23], 0
  v_max3_u32 v80, v20, v21, 0
  v_max3_u32 v80, v22, v23, v80
  s_waitcnt vmcnt(6)
  v_mfma_f32_16x16x32_bf16 v[72:75], v[68:71], v[24:27], v[72:75]
  v_max3_u32 v80, v24, v25, v80
  v_max3_u32 v80, v26, v27, v80
  s_waitcnt vmcnt(5)
  v_mfma_f32_16x16x32_bf16 v[72:75], v[68:71], v[28:31], v[72:75]
  v_max3_u32 v80, v28, v29, v80
  v_max3_u32 v80, v30, v31, v80
  s_waitcnt vmcnt(4)
  v_mfma_f32_16x16x32_bf16 v[72:75], v[68:71], v[32:35], v[72:75]
  v_max3_u32 v80, v32, v33, v80
  v_max3_u32 v80, v34, v35, v80
  s_waitcnt vmcnt(3)
  v_mfma_f32_16x16x32_bf16 v[72:75], v[68:71], v[36:39], v[72:75]
  v_max3_u32 v80, v36, v37, v80
  v_max3_u32 v80, v38, v39, v80
  s_waitcnt vmcnt(2)
  v_mfma_f32_16x16x32_bf16 v[72:75], v[68:71], v[40:43], v[72:75]
  v_max3_u32 v80, v40, v41, v80
  v_max3_u32 v80, v42, v43, v80
  s_waitcnt vmcnt(1)
  v_mfma_f32_16x16x32_bf16 v[72:75], v[68:71], v[44:47], v[72:75]
  v_max3_u32 v80, v44, v45, v80
  v_max3_u32 v80, v46, v47, v80
  s_waitcnt vmcnt(0)
  v_mfma_f32_16x16x32_bf16 v[72:75], v[68:71], v[48:51], v[72:75]
  v_max3_u32 v80, v48, v49, v80
  v_max3_u32 v80, v50, v51, v80
  v_cmp_eq_u32 vcc, -1, v80
  s_cbranch_vccnz m_w_111
  v_lshlrev_b32 v3, 1, v3
  v_lshl_add_u32 v3, v2, 4, v3
  s_lshl_b32 s26, s17, 9
  s_add_u32 s26, s26, 159744
  v_add_u32 v3, s26, v3
  s_mov_b32 exec_hi, 0
  ds_write_b128 v3, v[72:75]
  s_mov_b32 exec_hi, -1
  v_lshlrev_b32 v3, 1, v0
  v_add_u32 v3, 159744, v3
  buffer_store_dwordx4 v[100:103], v8, s[4:7], s77 offen offset:0 sc1
  buffer_store_dwordx4 v[104:107], v8, s[4:7], s77 offen offset:512 sc1
  buffer_store_dwordx4 v[100:103], v8, s[4:7], s28 offen offset:0 sc1
  buffer_store_dwordx4 v[104:107], v8, s[4:7], s28 offen offset:512 sc1
  v_lshlrev_b32 v80, 16, v108
  v_and_b32 v81, 0xffff0000, v108
  v_lshlrev_b32 v82, 16, v109
  v_and_b32 v83, 0xffff0000, v109
  v_lshlrev_b32 v84, 16, v110
  v_and_b32 v85, 0xffff0000, v110
  v_lshlrev_b32 v86, 16, v111
  v_and_b32 v87, 0xffff0000, v111
  v_lshlrev_b32 v88, 16, v112
  v_and_b32 v89, 0xffff0000, v112
  v_lshlrev_b32 v90, 16, v113
  v_and_b32 v91, 0xffff0000, v113
  v_lshlrev_b32 v92, 16, v114
  v_and_b32 v93, 0xffff0000, v114
  v_lshlrev_b32 v94, 16, v115
  v_and_b32 v95, 0xffff0000, v115
  s_waitcnt lgkmcnt(0)
  s_barrier
  s_cmp_lg_u32 s17, 0
  s_cbranch_scc1 m_done_110
  ds_read_b128 v[72:75], v3
  ds_read_b128 v[76:79], v3 offset:16
  s_and_b32 s29, s58, 0xffff0000
  s_xor_b32 s27, s29, 0x80000000
  s_xor_b32 s28, s29, 0xffff0000
  s_bitcmp1_b32 s29, 31
  s_cselect_b32 s29, s27, s28
  v_mov_b32 v108, s29
  v_mul_f32 v108, 0xbfb8aa3b, v108
  v_exp_f32 v108, v108
  s_nop 0
  v_add_f32 v108, 1.0, v108
  v_rcp_f32 v108, v108
  s_nop 0
  v_cvt_pk_bf16_f32 v108, 0, v108
  s_waitcnt lgkmcnt(0)
  v_cvt_pk_bf16_f32 v72, 0, v72
  v_cvt_pk_bf16_f32 v73, 0, v73
  v_cvt_pk_bf16_f32 v74, 0, v74
  v_cvt_pk_bf16_f32 v75, 0, v75
  v_cvt_pk_bf16_f32 v76, 0, v76
  v_cvt_pk_bf16_f32 v77, 0, v77
  v_cvt_pk_bf16_f32 v78, 0, v78
  v_cvt_pk_bf16_f32 v79, 0, v79
  v_mul_f32 v72, v72, v108
  v_mul_f32 v73, v73, v108
  v_mul_f32 v74, v74, v108
  v_mul_f32 v75, v75, v108
  v_mul_f32 v76, v76, v108
  v_mul_f32 v77, v77, v108
  v_mul_f32 v78, v78, v108
  v_mul_f32 v79, v79, v108
  v_cvt_pk_bf16_f32 v72, 0, v72
  v_cvt_pk_bf16_f32 v73, 0, v73
  v_cvt_pk_bf16_f32 v74, 0, v74
  v_cvt_pk_bf16_f32 v75, 0, v75
  v_cvt_pk_bf16_f32 v76, 0, v76
  v_cvt_pk_bf16_f32 v77, 0, v77
  v_cvt_pk_bf16_f32 v78, 0, v78
  v_cvt_pk_bf16_f32 v79, 0, v79
  v_add_f32 v72, v72, v88
  v_add_f32 v73, v73, v89
  v_add_f32 v74, v74, v90
  v_add_f32 v75, v75, v91
  v_add_f32 v76, v76, v92
  v_add_f32 v77, v77, v93
  v_add_f32 v78, v78, v94
  v_add_f32 v79, v79, v95
  v_cvt_pk_bf16_f32 v72, 0, v72
  v_cvt_pk_bf16_f32 v73, 0, v73
  v_cvt_pk_bf16_f32 v74, 0, v74
  v_cvt_pk_bf16_f32 v75, 0, v75
  v_cvt_pk_bf16_f32 v76, 0, v76
  v_cvt_pk_bf16_f32 v77, 0, v77
  v_cvt_pk_bf16_f32 v78, 0, v78
  v_cvt_pk_bf16_f32 v79, 0, v79
  v_add_f32 v80, v80, v72
  v_add_f32 v81, v81, v73
  v_add_f32 v82, v82, v74
  v_add_f32 v83, v83, v75
  v_add_f32 v84, v84, v76
  v_add_f32 v85, v85, v77
  v_add_f32 v86, v86, v78
  v_add_f32 v87, v87, v79
  v_cvt_pk_bf16_f32 v112, v80, v81
  v_cvt_pk_bf16_f32 v113, v82, v83
  v_cvt_pk_bf16_f32 v114, v84, v85
  v_cvt_pk_bf16_f32 v115, v86, v87
  v_lshlrev_b32 v80, 16, v112
  v_and_b32 v81, 0xffff0000, v112
  v_lshlrev_b32 v82, 16, v113
  v_and_b32 v83, 0xffff0000, v113
  v_lshlrev_b32 v84, 16, v114
  v_and_b32 v85, 0xffff0000, v114
  v_lshlrev_b32 v86, 16, v115
  v_and_b32 v87, 0xffff0000, v115
  s_lshl_b32 s27, s46, 5
  s_add_u32 s27, s27, s16
  s_lshl_b32 s27, s27, 10
  s_add_u32 s27, s27, 33554432
  buffer_store_dwordx4 v[112:115], v0, s[4:7], s27 offen sc1
  v_add_f32 v20, v80, v81
  v_mul_f32 v21, v80, v80
  v_add_f32 v22, v82, v83
  v_mul_f32 v23, v81, v81
  v_fmac_f32 v21, v82, v82
  v_fmac_f32 v23, v83, v83
  v_add_f32 v20, v20, v84
  v_fmac_f32 v21, v84, v84
  v_add_f32 v22, v22, v85
  v_fmac_f32 v23, v85, v85
  v_add_f32 v20, v20, v86
  v_fmac_f32 v21, v86, v86
  v_add_f32 v22, v22, v87
  v_fmac_f32 v23, v87, v87
  v_add_f32 v20, v20, v22
  v_add_f32 v21, v21, v23
  s_nop 0
  v_add_f32_dpp v20, v20, v20 row_ror:8 row_mask:0xf bank_mask:0xf
  v_add_f32_dpp v21, v21, v21 row_ror:8 row_mask:0xf bank_mask:0xf
  s_nop 0
  v_add_f32_dpp v20, v20, v20 row_ror:4 row_mask:0xf bank_mask:0xf
  v_add_f32_dpp v21, v21, v21 row_ror:4 row_mask:0xf bank_mask:0xf
  s_nop 0
  v_add_f32_dpp v20, v20, v20 row_ror:2 row_mask:0xf bank_mask:0xf
  v_add_f32_dpp v21, v21, v21 row_ror:2 row_mask:0xf bank_mask:0xf
  s_nop 0
  v_add_f32_dpp v20, v20, v20 row_ror:1 row_mask:0xf bank_mask:0xf
  v_add_f32_dpp v21, v21, v21 row_ror:1 row_mask:0xf bank_mask:0xf
  v_mov_b32 v24, v20
  v_mov_b32 v25, v21
  s_nop 0
  v_permlane16_swap_b32 v20, v24
  v_permlane16_swap_b32 v21, v25
  v_add_f32 v20, v20, v24
  v_add_f32 v21, v21, v25
  v_mov_b32 v24, v20
  v_mov_b32 v25, v21
  s_nop 0
  v_permlane32_swap_b32 v20, v24
  v_permlane32_swap_b32 v21, v25
  v_add_f32 v20, v20, v24
  v_add_f32 v21, v21, v25
  v_mul_f32 v20, 0x3b000000, v20
  v_mul_f32 v21, 0x3b000000, v21
  v_fma_f32 v21, -v20, v20, v21
  v_cvt_pk_bf16_f32 v20, 0, v20
  v_max_f32 v21, 0, v21
  v_sub_f32 v24, v80, v20
  v_sub_f32 v25, v81, v20
  v_cvt_pk_bf16_f32 v21, 0, v21
  v_sub_f32 v26, v82, v20
  v_sub_f32 v27, v83, v20
  v_add_f32 v21, 0x3727c5ac, v21
  v_sub_f32 v28, v84, v20
  v_sub_f32 v29, v85, v20
  v_cvt_pk_bf16_f32 v21, 0, v21
  v_sub_f32 v30, v86, v20
  v_sub_f32 v31, v87, v20
  v_sqrt_f32 v21, v21
  v_cvt_pk_bf16_f32 v24, 0, v24
  v_cvt_pk_bf16_f32 v25, 0, v25
  v_cvt_pk_bf16_f32 v21, 0, v21
  v_cvt_pk_bf16_f32 v26, 0, v26
  v_cvt_pk_bf16_f32 v27, 0, v27
  v_rcp_f32 v21, v21
  v_cvt_pk_bf16_f32 v28, 0, v28
  v_cvt_pk_bf16_f32 v29, 0, v29
  v_cvt_pk_bf16_f32 v30, 0, v30
  v_cvt_pk_bf16_f32 v31, 0, v31
  v_mul_f32 v24, v24, v21
  v_mul_f32 v25, v25, v21
  v_mul_f32 v26, v26, v21
  v_mul_f32 v27, v27, v21
  v_mul_f32 v28, v28, v21
  v_mul_f32 v29, v29, v21
  v_mul_f32 v30, v30, v21
  v_mul_f32 v31, v31, v21
  v_cvt_pk_bf16_f32 v32, v24, v25
  v_cvt_pk_bf16_f32 v33, v26, v27
  v_cvt_pk_bf16_f32 v34, v28, v29
  v_cvt_pk_bf16_f32 v35, v30, v31
  v_lshl_add_u32 v3, v0, 2, s50
  v_mov_b64 v[20:21], 0
  v_mov_b64 v[24:25], 0
  v_mov_b64 v[28:29], 0
  v_mov_b32 v22, v32
  v_mov_b32 v23, v34
  v_mov_b32 v26, v33
  v_mov_b32 v27, v35
  ds_write_b128 v3, v[22:25] offset:4096
  ds_write_b128 v3, v[20:23] offset:4112
  ds_write_b128 v3, v[26:29] offset:4128
  ds_write_b128 v3, v[24:27] offset:4144
m_done_110:
  v_lshrrev_b32 v96, 9, v0
  v_lshlrev_b32 v96, 4, v96
  v_and_b32 v97, 0xf0, v0
  v_xor_b32 v96, v96, v97
  v_and_b32 v97, 0x1f0, v0
  v_lshl_add_u32 v96, v97, 6, v96
  v_xor_b32 v120, 0, v96
  v_xor_b32 v121, 32, v96
  v_xor_b32 v122, 64, v96
  v_xor_b32 v123, 96, v96
  v_xor_b32 v124, 128, v96
  v_xor_b32 v125, 160, v96
  v_xor_b32 v126, 192, v96
  v_xor_b32 v127, 224, v96
  s_and_b32 s26, s17, 1
  s_lshl_b32 s26, s26, 7
  v_xor_b32 v96, s26, v0
  v_xor_b32 v12, 0, v96
  v_xor_b32 v13, 16, v96
  v_xor_b32 v14, 32, v96
  v_xor_b32 v15, 48, v96
  v_xor_b32 v16, 64, v96
  v_xor_b32 v17, 80, v96
  v_xor_b32 v18, 96, v96
  v_xor_b32 v19, 112, v96
  v_cmp_eq_u32 vcc, 0, v116
  v_max_u32_dpp v117, v116, v116 quad_perm:[1,0,3,2] row_mask:0xf bank_mask:0xf
  s_and_b32 s48, vcc_lo, 0xffffff
  s_cselect_b32 s48, 0, -1
  v_max_u32_dpp v117, v117, v117 quad_perm:[2,3,0,1] row_mask:0xf bank_mask:0xf
  s_nop 1
  v_max_u32_dpp v117, v117, v117 row_half_mirror row_mask:0xf bank_mask:0xf
  v_and_b32 v117, s48, v117
  s_cmp_eq_u32 s48, 0
  s_cbranch_scc1 q_nb_112
  s_and_b32 s63, s47, 127
  s_lshl_b32 s63, s63, 15
  s_xor_b32 s27, s50, 32768
  s_add_u32 m0, s27, s54
  s_add_u32 s63, s63, s54
  s_add_u32 s63, s63, 6291456
  buffer_load_dwordx4 v12, s[4:7], s63 offen offset:0 sc1 lds
  buffer_load_dwordx4 v13, s[4:7], s63 offen offset:1024 sc1 lds
  buffer_load_dwordx4 v14, s[4:7], s63 offen offset:2048 sc1 lds
  buffer_load_dwordx4 v15, s[4:7], s63 offen offset:3072 sc1 lds
  s_add_u32 m0, m0, 4096
  s_add_u32 s63, s63, 4096
  buffer_load_dwordx4 v16, s[4:7], s63 offen offset:0 sc1 lds
  buffer_load_dwordx4 v17, s[4:7], s63 offen offset:1024 sc1 lds
  buffer_load_dwordx4 v18, s[4:7], s63 offen offset:2048 sc1 lds
  buffer_load_dwordx4 v19, s[4:7], s63 offen offset:3072 sc1 lds
q_nb_112:
  v_lshrrev_b32 v2, 8, v0
  v_and_b32 v3, 48, v0
  v_lshl_add_u32 v3, v2, 6, v3
  v_add_u32 v3, s50, v3
  s_mov_b32 vcc_lo, 0xcccccccc
  s_mov_b32 vcc_hi, 0xcccccccc
  v_mov_b32 v32, 0x4444
  v_mov_b32 v33, 0xeeee
  v_cndmask_b32 v32, v32, v33, vcc
  s_waitcnt lgkmcnt(0)
  s_barrier
  ds_read_b128 v[36:39], v3 offset:4096
  ds_read_b128 v[40:43], v3 offset:4352
  ds_read_b128 v[44:47], v3 offset:4608
  ds_read_b128 v[48:51], v3 offset:4864
  ds_read_b128 v[52:55], v3 offset:5120
  ds_read_b128 v[56:59], v3 offset:5376
  ds_read_b128 v[60:63], v3 offset:5632
  ds_read_b128 v[64:67], v3 offset:5888
  v_mov_b64 v[20:21], 0
  v_mov_b64 v[22:23], 0
  v_mov_b64 v[24:25], 0
  v_mov_b64 v[26:27], 0
  v_mov_b64 v[28:29], 0
  v_mov_b64 v[30:31], 0
  s_waitcnt lgkmcnt(7)
  v_smfmac_f32_16x16x64_bf16 v[20:23], v[36:39], v[128:135], v32
  ds_read_b128 v[68:71], v3 offset:6144
  v_smfmac_f32_16x16x64_bf16 v[24:27], v[36:39], a[0:7], v32
  s_and_b32 s26, s59, 16
  v_smfmac_f32_16x16x64_bf16 v[28:31], v[36:39], a[128:135], v32
  s_lshl_b32 s27, s26, 6
  s_waitcnt lgkmcnt(7)
  v_smfmac_f32_16x16x64_bf16 v[20:23], v[40:43], v[136:143], v32
  ds_read_b128 v[72:75], v3 offset:6400
  v_smfmac_f32_16x16x64_bf16 v[24:27], v[40:43], a[8:15], v32
  s_and_b32 s28, s59, 15
  v_smfmac_f32_16x16x64_bf16 v[28:31], v[40:43], a[136:143], v32
  s_lshl4_add_u32 s27, s28, s27
  s_waitcnt lgkmcnt(7)
  v_smfmac_f32_16x16x64_bf16 v[20:23], v[44:47], v[144:151], v32
  ds_read_b128 v[76:79], v3 offset:6656
  v_smfmac_f32_16x16x64_bf16 v[24:27], v[44:47], a[16:23], v32
  s_add_u32 s77, s77, s27
  v_smfmac_f32_16x16x64_bf16 v[28:31], v[44:47], a[144:151], v32
  s_add_u32 s27, s27, s44
  s_waitcnt lgkmcnt(7)
  v_smfmac_f32_16x16x64_bf16 v[20:23], v[48:51], v[152:159], v32
  ds_read_b128 v[80:83], v3 offset:6912
  v_smfmac_f32_16x16x64_bf16 v[24:27], v[48:51], a[24:31], v32
  s_lshr_b32 s26, s26, 1
  v_smfmac_f32_16x16x64_bf16 v[28:31], v[48:51], a[152:159], v32
  s_and_b32 s28, s59, 3
  s_waitcnt lgkmcnt(7)
  v_smfmac_f32_16x16x64_bf16 v[20:23], v[52:55], v[160:167], v32
  ds_read_b128 v[84:87], v3 offset:7168
  v_smfmac_f32_16x16x64_bf16 v[24:27], v[52:55], a[32:39], v32
  s_lshl1_add_u32 s26, s28, s26
  v_smfmac_f32_16x16x64_bf16 v[28:31], v[52:55], a[160:167], v32
  s_and_b32 s28, s59, 12
  s_waitcnt lgkmcnt(7)
  v_smfmac_f32_16x16x64_bf16 v[20:23], v[56:59], v[168:175], v32
  ds_read_b128 v[88:91], v3 offset:7424
  v_smfmac_f32_16x16x64_bf16 v[24:27], v[56:59], a[40:47], v32
  s_lshl_b32 s28, s28, 6
  v_smfmac_f32_16x16x64_bf16 v[28:31], v[56:59], a[168:175], v32
  s_add_u32 s26, s26, s28
  s_waitcnt lgkmcnt(7)
  v_smfmac_f32_16x16x64_bf16 v[20:23], v[60:63], v[176:183], v32
  ds_read_b128 v[92:95], v3 offset:7680
  v_smfmac_f32_16x16x64_bf16 v[24:27], v[60:63], a[48:55], v32
  s_add_u32 s26, s26, s44
  v_smfmac_f32_16x16x64_bf16 v[28:31], v[60:63], a[176:183], v32
  v_and_b32 v2, 0xc0, v0
  s_waitcnt lgkmcnt(7)
  v_smfmac_f32_16x16x64_bf16 v[20:23], v[64:67], v[184:191], v32
  ds_read_b128 v[96:99], v3 offset:7936
  v_smfmac_f32_16x16x64_bf16 v[24:27], v[64:67], a[56:63], v32
  v_and_b32 v5, 12, v1
  v_smfmac_f32_16x16x64_bf16 v[28:31], v[64:67], a[184:191], v32
  v_lshrrev_b32 v5, 1, v5
  s_waitcnt lgkmcnt(7)
  v_smfmac_f32_16x16x64_bf16 v[20:23], v[68:71], v[192:199], v32
  v_lshl_add_u32 v2, v2, 2, v5
  v_smfmac_f32_16x16x64_bf16 v[24:27], v[68:71], a[64:71], v32
  v_smfmac_f32_16x16x64_bf16 v[28:31], v[68:71], a[192:199], v32
  s_waitcnt lgkmcnt(6)
  v_smfmac_f32_16x16x64_bf16 v[20:23], v[72:75], v[200:207], v32
  v_smfmac_f32_16x16x64_bf16 v[24:27], v[72:75], a[72:79], v32
  v_smfmac_f32_16x16x64_bf16 v[28:31], v[72:75], a[200:207], v32
  s_waitcnt lgkmcnt(5)
  v_smfmac_f32_16x16x64_bf16 v[20:23], v[76:79], v[208:215], v32
  v_smfmac_f32_16x16x64_bf16 v[24:27], v[76:79], a[80:87], v32
  v_smfmac_f32_16x16x64_bf16 v[28:31], v[76:79], a[208:215], v32
  s_waitcnt lgkmcnt(4)
  v_smfmac_f32_16x16x64_bf16 v[20:23], v[80:83], v[216:223], v32
  v_smfmac_f32_16x16x64_bf16 v[24:27], v[80:83], a[88:95], v32
  v_smfmac_f32_16x16x64_bf16 v[28:31], v[80:83], a[216:223], v32
  s_waitcnt lgkmcnt(3)
  v_smfmac_f32_16x16x64_bf16 v[20:23], v[84:87], v[224:231], v32
  v_smfmac_f32_16x16x64_bf16 v[24:27], v[84:87], a[96:103], v32
  v_smfmac_f32_16x16x64_bf16 v[28:31], v[84:87], a[224:231], v32
  s_waitcnt lgkmcnt(2)
  v_smfmac_f32_16x16x64_bf16 v[20:23], v[88:91], v[232:239], v32
  v_smfmac_f32_16x16x64_bf16 v[24:27], v[88:91], a[104:111], v32
  v_smfmac_f32_16x16x64_bf16 v[28:31], v[88:91], a[232:239], v32
  s_waitcnt lgkmcnt(1)
  v_smfmac_f32_16x16x64_bf16 v[20:23], v[92:95], v[240:247], v32
  v_smfmac_f32_16x16x64_bf16 v[24:27], v[92:95], a[112:119], v32
  v_smfmac_f32_16x16x64_bf16 v[28:31], v[92:95], a[240:247], v32
  s_waitcnt lgkmcnt(0)
  v_smfmac_f32_16x16x64_bf16 v[20:23], v[96:99], v[248:255], v32
  v_smfmac_f32_16x16x64_bf16 v[24:27], v[96:99], a[120:127], v32
  v_smfmac_f32_16x16x64_bf16 v[28:31], v[96:99], a[248:255], v32
  v_add_f32 v20, v20, v22
  v_add_f32 v21, v21, v23
  s_nop 1
  v_add_f32 v24, v24, v26
  v_add_f32 v25, v25, v27
  s_nop 1
  v_add_f32 v28, v28, v30
  v_add_f32 v29, v29, v31
  v_mul_f32 v20, s24, v20
  v_mul_f32 v21, s24, v21
  v_cvt_pk_bf16_f32 v20, v20, v21
  v_cvt_pk_bf16_f32 v24, v24, v25
  v_cvt_pk_bf16_f32 v28, v28, v29
  s_mov_b64 exec, 0xffff
  s_waitcnt vmcnt(0)
  buffer_store_short v20, v2, s[4:7], s27 offen sc1
  buffer_store_short_d16_hi v20, v2, s[4:7], s27 offen offset:8 sc1
  buffer_store_short v24, v0, s[4:7], s26 offen offset:2048 sc1
  buffer_store_short_d16_hi v24, v0, s[4:7], s26 offen offset:3072 sc1
  buffer_store_short v28, v2, s[4:7], s77 offen sc1
  buffer_store_short_d16_hi v28, v2, s[4:7], s77 offen offset:8 sc1
  s_mov_b64 exec, 3
  s_waitcnt vmcnt(0)
  buffer_store_dword v4, v0, s[4:7], s51 offen sc1
  s_mov_b64 exec, 3
  buffer_store_dword v4, v0, s[4:7], s49 offen sc1
  s_mov_b64 exec, -1
  s_mov_b32 s49, 268435456
  v_mov_b32 v4, 1
  s_branch q_nxt_104
q_end_95:
  s_waitcnt vmcnt(0)
  s_mov_b64 exec, 3
  buffer_store_dword v4, v0, s[4:7], s49 offen sc1
  s_mov_b64 exec, -1
  s_cmp_lg_u32 s60, 0
  s_cbranch_scc1 q_fail_98
  s_load_dwordx2 s[72:73], s[0:1], 96
  s_mov_b32 s74, 2097152
  s_mov_b32 s75, 0x20000
  s_mov_b32 s58, 0
  s_cmp_eq_u32 s17, 3
  s_cselect_b32 s48, 7, 15
k_fin_113:
  s_load_dwordx2 s[64:65], s[0:1], 72
  s_load_dwordx2 s[68:69], s[0:1], 80
  s_load_dwordx2 s[8:9], s[0:1], 88
  s_mov_b32 s66, 1835008
  s_mov_b32 s70, 1835008
  s_mov_b32 s10, 1835008
  v_lshrrev_b32 v2, 7, v0
  v_and_b32 v3, 0x70, v0
  v_mul_u32_u24 v6, 57344, v2
  v_add_u32 v6, v6, v3
  v_cmp_eq_u32 vcc, 0x70, v3
  v_mov_b32 v3, 0x7ff00000
  s_nop 0
  v_cndmask_b32 v6, v6, v3, vcc
  v_lshrrev_b32 v2, 8, v0
  v_mul_u32_u24 v7, 14336, v2
  v_and_b32 v3, 0xf0, v0
  v_add_u32 v7, v7, v3
  s_mul_i32 s34, s17, 458752
  s_mul_i32 s27, s16, 112
  s_add_u32 s34, s34, s27
  s_mul_i32 s35, s16, 57344
  s_lshl_b32 s27, s17, 8
  s_add_u32 s35, s35, s27
  s_waitcnt lgkmcnt(0)
  s_xor_b32 s37, s50, 32768
  s_add_u32 s37, s37, s54
  s_mov_b32 m0, s37
  s_add_u32 s36, s34, 39424
  buffer_load_dwordx4 v6, s[68:71], s36 offen lds
  s_add_u32 m0, m0, 1024
  s_add_u32 s36, s34, 43008
  buffer_load_dwordx4 v6, s[64:67], s36 offen lds
  s_add_u32 m0, m0, 1024
  s_add_u32 s36, s34, 43008
  buffer_load_dwordx4 v6, s[68:71], s36 offen lds
  s_add_u32 m0, m0, 1024
  s_add_u32 s36, s34, 46592
  buffer_load_dwordx4 v6, s[64:67], s36 offen lds
  s_add_u32 m0, m0, 1024
  s_add_u32 s36, s34, 46592
  buffer_load_dwordx4 v6, s[68:71], s36 offen lds
  s_add_u32 m0, m0, 1024
  s_add_u32 s36, s34, 50176
  buffer_load_dwordx4 v6, s[64:67], s36 offen lds
  s_add_u32 m0, m0, 1024
  s_add_u32 s36, s34, 50176
  buffer_load_dwordx4 v6, s[68:71], s36 offen lds
  s_add_u32 m0, m0, 1024
  s_add_u32 s36, s34, 53760
  buffer_load_dwordx4 v6, s[64:67], s36 offen lds
  s_add_u32 m0, m0, 1024
  s_add_u32 s36, s34, 53760
  buffer_load_dwordx4 v[60:63], v6, s[68:71], s36 offen
  buffer_load_dwordx4 v[64:67], v7, s[8:11], s35 offen offset:0
  buffer_load_dwordx4 v[68:71], v7, s[8:11], s35 offen offset:1024
  buffer_load_dwordx4 v[72:75], v7, s[8:11], s35 offen offset:2048
  buffer_load_dwordx4 v[76:79], v7, s[8:11], s35 offen offset:3072
  s_add_u32 s35, s35, 4096
  buffer_load_dwordx4 v[80:83], v7, s[8:11], s35 offen offset:0
  buffer_load_dwordx4 v[84:87], v7, s[8:11], s35 offen offset:1024
  buffer_load_dwordx4 v[88:91], v7, s[8:11], s35 offen offset:2048
  buffer_load_dwordx4 v[92:95], v7, s[8:11], s35 offen offset:3072
  s_add_u32 s35, s35, 4096
  buffer_load_dwordx4 v[96:99], v7, s[8:11], s35 offen offset:0
  buffer_load_dwordx4 v[100:103], v7, s[8:11], s35 offen offset:1024
  buffer_load_dwordx4 v[104:107], v7, s[8:11], s35 offen offset:2048
  buffer_load_dwordx4 v[108:111], v7, s[8:11], s35 offen offset:3072
  s_add_u32 s35, s35, 4096
  buffer_load_dwordx4 v[112:115], v7, s[8:11], s35 offen offset:0
  buffer_load_dwordx4 v[48:51], v7, s[8:11], s35 offen offset:1024
  s_andn2_b32 s28, 0xfe0, s56
  s_lshl_b32 s28, s28, 7
  s_mov_b32 s29, 243793920
  v_mov_b32 v24, 262144
  s_mov_b32 s53, 0
  s_mov_b32 s33, 3
  v_mov_b32 v53, s58
  s_and_b32 s32, s48, 15
  s_cbranch_scc0 k_x_116
k_w_115:
  s_add_u32 s33, s33, 1
  s_and_b32 s33, s33, 3
  s_bitcmp1_b32 s32, s33
  s_cbranch_scc0 k_w_115
  s_lshl2_add_u32 s26, s33, s17
  s_lshl_b32 s26, s26, 14
  s_add_u32 s27, s26, 8192
  v_add_u32 v22, s26, v9
  v_cmp_le_u32 vcc, s28, v22
  s_nop 1
  v_cndmask_b32 v25, 0, v24, vcc
  v_add_u32 v22, v22, v25
  buffer_load_dword v20, v22, s[4:7], s29 offen sc1
  v_add_u32 v23, s27, v9
  v_cmp_le_u32 vcc, s28, v23
  s_nop 1
  v_cndmask_b32 v25, 0, v24, vcc
  v_add_u32 v23, v23, v25
  buffer_load_dword v21, v23, s[4:7], s29 offen sc1
  s_add_u32 s53, s53, 1
  s_cmp_gt_u32 s53, 1048576
  s_cbranch_scc1 q_fail_98
  s_waitcnt vmcnt(0)
  v_min_u32 v52, v20, v21
  v_max3_u32 v53, v20, v21, v53
  v_cmp_eq_u32 vcc, 0, v52
  s_cbranch_vccnz k_w_115
  s_bitset0_b32 s32, s33
  s_cmp_lg_u32 s32, 0
  s_cbranch_scc1 k_w_115
  v_max_u32_dpp v53, v53, v53 row_ror:8 row_mask:0xf bank_mask:0xf
  s_nop 1
  v_max_u32_dpp v53, v53, v53 row_ror:4 row_mask:0xf bank_mask:0xf
  s_nop 1
  v_max_u32_dpp v53, v53, v53 row_ror:2 row_mask:0xf bank_mask:0xf
  s_nop 1
  v_max_u32_dpp v53, v53, v53 row_ror:1 row_mask:0xf bank_mask:0xf
  v_mov_b32 v52, v53
  s_nop 0
  s_nop 0
  v_permlane16_swap_b32 v53, v52
  v_max_u32 v53, v53, v52
  v_mov_b32 v52, v53
  s_nop 0
  s_nop 0
  v_permlane32_swap_b32 v53, v52
  v_max_u32 v53, v53, v52
k_x_116:
  ds_write_b32 v118, v53 offset:256
  s_waitcnt vmcnt(0) lgkmcnt(0)
  s_barrier
  ds_read_b128 v[20:23], v119 offset:256
  s_waitcnt lgkmcnt(0)
  v_max3_u32 v20, v20, v21, v22
  v_max_u32 v20, v20, v23
  s_nop 0
  v_readfirstlane_b32 s26, v20
  s_cmp_eq_u32 s26, s58
  s_cbranch_scc1 q_fail_98
  s_cmp_eq_u32 s58, 0
  s_mov_b32 s58, s26
  s_cbranch_scc1 k_r_117
  s_cmp_lg_u32 s57, 0
  s_cbranch_scc1 k_r_117
  s_lshl_b32 s26, s59, 10
  buffer_store_dwordx4 a[0:3], v0, s[72:75], s26 offen sc1
k_r_117:
  s_andn2_b32 s26, 0xfe0, s56
  s_andn2_b32 s27, 0xfe0, s58
  s_cmp_lt_u32 s27, s26
  s_cselect_b32 s61, 1, 2
  s_andn2_b32 s59, 0xfff, s58
  s_lshl_b32 s26, s61, 21
  s_lshl_b32 s27, s59, 10
  s_add_u32 s26, s26, s27
  s_lshl_b32 s27, s17, 8
  s_add_u32 s26, s26, s27
  s_add_u32 s26, s26, 27262976
  v_lshrrev_b32 v5, 7, v0
  v_lshlrev_b32 v5, 5, v5
  buffer_load_dwordx4 v[52:55], v5, s[4:7], s26 offen offset:0 sc1
  buffer_load_dwordx4 v[56:59], v5, s[4:7], s26 offen offset:16 sc1
  s_mov_b32 vcc_lo, 0xaaaaaaaa
  s_mov_b32 vcc_hi, 0xaaaaaaaa
  v_mov_b32 v3, 0xffff
  v_mov_b32 v24, 0xffff0000
  v_cndmask_b32 v3, v3, v24, vcc
  s_mov_b32 vcc_lo, 0x3030303
  s_mov_b32 vcc_hi, 0x3030303
  v_cndmask_b32 v24, 0, v3, vcc
  s_mov_b32 vcc_lo, 0xc0c0c0c
  s_mov_b32 vcc_hi, 0xc0c0c0c
  v_cndmask_b32 v25, 0, v3, vcc
  s_mov_b32 vcc_lo, 0x30303030
  s_mov_b32 vcc_hi, 0x30303030
  v_cndmask_b32 v26, 0, v3, vcc
  s_mov_b32 vcc_lo, 0xc0c0c0c0
  s_mov_b32 vcc_hi, 0xc0c0c0c0
  v_cndmask_b32 v27, 0, v3, vcc
  s_mov_b32 s30, 0x01000100
  s_mov_b32 s31, 0x03020302
  s_mul_i32 s26, s17, 23552
  s_add_u32 s26, s26, 65536
  v_add_u32 v5, s26, v0
  v_add_u32 v2, s37, v0
  ds_read_b128 v[36:39], v5 offset:0
  ds_read_b128 v[40:43], v5 offset:1024
  ds_read_b128 v[44:47], v5 offset:2048
  ds_read_b128 v[12:15], v5 offset:3072
  ds_read_b128 v[16:19], v5 offset:4096
  ds_read_b128 v[120:123], v5 offset:5120
  ds_read_b128 v[124:127], v5 offset:6144
  s_waitcnt vmcnt(0)
  v_perm_b32 v3, v52, v52, s30
  v_and_b32 v20, v24, v3
  v_and_b32 v21, v25, v3
  v_and_b32 v22, v26, v3
  v_and_b32 v23, v27, v3
  s_waitcnt lgkmcnt(5)
  s_nop 0
  v_mfma_f32_16x16x32_bf16 v[28:31], v[20:23], v[36:39], 0
  ds_read_b128 v[36:39], v5 offset:7168
  v_mfma_f32_16x16x32_bf16 v[32:35], v[20:23], v[40:43], 0
  ds_read_b128 v[40:43], v5 offset:8192
  v_perm_b32 v3, v52, v52, s31
  v_and_b32 v20, v24, v3
  v_and_b32 v21, v25, v3
  v_and_b32 v22, v26, v3
  v_and_b32 v23, v27, v3
  s_waitcnt lgkmcnt(5)
  s_nop 0
  v_mfma_f32_16x16x32_bf16 v[28:31], v[20:23], v[44:47], v[28:31]
  ds_read_b128 v[44:47], v5 offset:9216
  v_mfma_f32_16x16x32_bf16 v[32:35], v[20:23], v[12:15], v[32:35]
  ds_read_b128 v[12:15], v5 offset:10240
  v_perm_b32 v3, v53, v53, s30
  v_and_b32 v20, v24, v3
  v_and_b32 v21, v25, v3
  v_and_b32 v22, v26, v3
  v_and_b32 v23, v27, v3
  s_waitcnt lgkmcnt(5)
  s_nop 0
  v_mfma_f32_16x16x32_bf16 v[28:31], v[20:23], v[16:19], v[28:31]
  ds_read_b128 v[16:19], v5 offset:11264
  v_mfma_f32_16x16x32_bf16 v[32:35], v[20:23], v[120:123], v[32:35]
  ds_read_b128 v[120:123], v5 offset:12288
  v_perm_b32 v3, v53, v53, s31
  v_and_b32 v20, v24, v3
  v_and_b32 v21, v25, v3
  v_and_b32 v22, v26, v3
  v_and_b32 v23, v27, v3
  s_waitcnt lgkmcnt(5)
  s_nop 0
  v_mfma_f32_16x16x32_bf16 v[28:31], v[20:23], v[124:127], v[28:31]
  ds_read_b128 v[124:127], v5 offset:13312
  v_mfma_f32_16x16x32_bf16 v[32:35], v[20:23], v[36:39], v[32:35]
  ds_read_b128 v[36:39], v5 offset:14336
  v_perm_b32 v3, v54, v54, s30
  v_and_b32 v20, v24, v3
  v_and_b32 v21, v25, v3
  v_and_b32 v22, v26, v3
  v_and_b32 v23, v27, v3
  s_waitcnt lgkmcnt(5)
  s_nop 0
  v_mfma_f32_16x16x32_bf16 v[28:31], v[20:23], v[40:43], v[28:31]
  ds_read_b128 v[40:43], v5 offset:15360
  v_mfma_f32_16x16x32_bf16 v[32:35], v[20:23], v[44:47], v[32:35]
  ds_read_b128 v[44:47], v5 offset:16384
  v_perm_b32 v3, v54, v54, s31
  v_and_b32 v20, v24, v3
  v_and_b32 v21, v25, v3
  v_and_b32 v22, v26, v3
  v_and_b32 v23, v27, v3
  s_waitcnt lgkmcnt(5)
  s_nop 0
  v_mfma_f32_16x16x32_bf16 v[28:31], v[20:23], v[12:15], v[28:31]
  ds_read_b128 v[12:15], v5 offset:17408
  v_mfma_f32_16x16x32_bf16 v[32:35], v[20:23], v[16:19], v[32:35]
  ds_read_b128 v[16:19], v5 offset:18432
  v_perm_b32 v3, v55, v55, s30
  v_and_b32 v20, v24, v3
  v_and_b32 v21, v25, v3
  v_and_b32 v22, v26, v3
  v_and_b32 v23, v27, v3
  s_waitcnt lgkmcnt(5)
  s_nop 0
  v_mfma_f32_16x16x32_bf16 v[28:31], v[20:23], v[120:123], v[28:31]
  ds_read_b128 v[120:123], v5 offset:19456
  v_mfma_f32_16x16x32_bf16 v[32:35], v[20:23], v[124:127], v[32:35]
  ds_read_b128 v[124:127], v5 offset:20480
  v_perm_b32 v3, v55, v55, s31
  v_and_b32 v20, v24, v3
  v_and_b32 v21, v25, v3
  v_and_b32 v22, v26, v3
  v_and_b32 v23, v27, v3
  s_waitcnt lgkmcnt(5)
  s_nop 0
  v_mfma_f32_16x16x32_bf16 v[28:31], v[20:23], v[36:39], v[28:31]
  ds_read_b128 v[36:39], v5 offset:21504
  v_mfma_f32_16x16x32_bf16 v[32:35], v[20:23], v[40:43], v[32:35]
  ds_read_b128 v[40:43], v5 offset:22528
  v_perm_b32 v3, v56, v56, s30
  v_and_b32 v20, v24, v3
  v_and_b32 v21, v25, v3
  v_and_b32 v22, v26, v3
  v_and_b32 v23, v27, v3
  s_waitcnt lgkmcnt(5)
  s_nop 0
  v_mfma_f32_16x16x32_bf16 v[28:31], v[20:23], v[44:47], v[28:31]
  ds_read_b128 v[44:47], v2 offset:0
  v_mfma_f32_16x16x32_bf16 v[32:35], v[20:23], v[12:15], v[32:35]
  ds_read_b128 v[12:15], v2 offset:1024
  v_perm_b32 v3, v56, v56, s31
  v_and_b32 v20, v24, v3
  v_and_b32 v21, v25, v3
  v_and_b32 v22, v26, v3
  v_and_b32 v23, v27, v3
  s_waitcnt lgkmcnt(5)
  s_nop 0
  v_mfma_f32_16x16x32_bf16 v[28:31], v[20:23], v[16:19], v[28:31]
  ds_read_b128 v[16:19], v2 offset:2048
  v_mfma_f32_16x16x32_bf16 v[32:35], v[20:23], v[120:123], v[32:35]
  ds_read_b128 v[120:123], v2 offset:3072
  v_perm_b32 v3, v57, v57, s30
  v_and_b32 v20, v24, v3
  v_and_b32 v21, v25, v3
  v_and_b32 v22, v26, v3
  v_and_b32 v23, v27, v3
  s_waitcnt lgkmcnt(5)
  s_nop 0
  v_mfma_f32_16x16x32_bf16 v[28:31], v[20:23], v[124:127], v[28:31]
  ds_read_b128 v[124:127], v2 offset:4096
  v_mfma_f32_16x16x32_bf16 v[32:35], v[20:23], v[36:39], v[32:35]
  ds_read_b128 v[36:39], v2 offset:5120
  v_perm_b32 v3, v57, v57, s31
  v_and_b32 v20, v24, v3
  v_and_b32 v21, v25, v3
  v_and_b32 v22, v26, v3
  v_and_b32 v23, v27, v3
  s_waitcnt lgkmcnt(5)
  s_nop 0
  v_mfma_f32_16x16x32_bf16 v[28:31], v[20:23], v[40:43], v[28:31]
  ds_read_b128 v[40:43], v2 offset:6144
  v_mfma_f32_16x16x32_bf16 v[32:35], v[20:23], v[44:47], v[32:35]
  ds_read_b128 v[44:47], v2 offset:7168
  v_perm_b32 v3, v58, v58, s30
  v_and_b32 v20, v24, v3
  v_and_b32 v21, v25, v3
  v_and_b32 v22, v26, v3
  v_and_b32 v23, v27, v3
  s_waitcnt lgkmcnt(5)
  s_nop 0
  v_mfma_f32_16x16x32_bf16 v[28:31], v[20:23], v[12:15], v[28:31]
  v_mfma_f32_16x16x32_bf16 v[32:35], v[20:23], v[16:19], v[32:35]
  v_perm_b32 v3, v58, v58, s31
  v_and_b32 v20, v24, v3
  v_and_b32 v21, v25, v3
  v_and_b32 v22, v26, v3
  v_and_b32 v23, v27, v3
  s_waitcnt lgkmcnt(3)
  s_nop 0
  v_mfma_f32_16x16x32_bf16 v[28:31], v[20:23], v[120:123], v[28:31]
  v_mfma_f32_16x16x32_bf16 v[32:35], v[20:23], v[124:127], v[32:35]
  v_perm_b32 v3, v59, v59, s30
  v_and_b32 v20, v24, v3
  v_and_b32 v21, v25, v3
  v_and_b32 v22, v26, v3
  v_and_b32 v23, v27, v3
  s_waitcnt lgkmcnt(1)
  s_nop 0
  v_mfma_f32_16x16x32_bf16 v[28:31], v[20:23], v[36:39], v[28:31]
  v_mfma_f32_16x16x32_bf16 v[32:35], v[20:23], v[40:43], v[32:35]
  v_perm_b32 v3, v59, v59, s31
  v_and_b32 v20, v24, v3
  v_and_b32 v21, v25, v3
  v_and_b32 v22, v26, v3
  v_and_b32 v23, v27, v3
  s_waitcnt lgkmcnt(0)
  s_nop 0
  v_mfma_f32_16x16x32_bf16 v[28:31], v[20:23], v[44:47], v[28:31]
  v_mfma_f32_16x16x32_bf16 v[32:35], v[20:23], v[60:63], v[32:35]
  v_lshrrev_b32 v2, 8, v0
  v_and_b32 v3, 0xf0, v0
  v_lshlrev_b32 v3, 1, v3
  v_and_b32 v5, 1, v2
  v_lshl_add_u32 v5, v5, 4, v3
  v_add_u32 v5, s37, v5
  s_mov_b32 exec_lo, 0x00ff00ff
  s_mov_b32 exec_hi, 0xff00ff00
  ds_write_b128 v5, v[28:31]
  ds_write_b128 v5, v[32:35] offset:512
  s_mov_b64 exec, -1
  s_xor_b32 s26, s50, 32768
  v_add_u32 v5, s26, v1
  v_lshl_add_u32 v3, v2, 4, v3
  s_waitcnt lgkmcnt(0)
  s_barrier
  ds_read2st64_b32 v[36:37], v5 offset0:0 offset1:1
  ds_read2st64_b32 v[52:53], v5 offset0:2 offset1:3
  ds_read2st64_b32 v[38:39], v5 offset0:32 offset1:33
  ds_read2st64_b32 v[54:55], v5 offset0:34 offset1:35
  ds_read2st64_b32 v[40:41], v5 offset0:64 offset1:65
  ds_read2st64_b32 v[56:57], v5 offset0:66 offset1:67
  ds_read2st64_b32 v[42:43], v5 offset0:96 offset1:97
  ds_read2st64_b32 v[58:59], v5 offset0:98 offset1:99
  s_waitcnt lgkmcnt(0)
  v_add_f32 v36, v36, v40
  v_add_f32 v37, v37, v41
  v_add_f32 v38, v38, v42
  v_add_f32 v39, v39, v43
  v_add_f32 v52, v52, v56
  v_add_f32 v53, v53, v57
  v_add_f32 v54, v54, v58
  v_add_f32 v55, v55, v59
  v_add_f32 v36, v36, v38
  v_add_f32 v37, v37, v39
  v_add_f32 v52, v52, v54
  v_add_f32 v53, v53, v55
  v_add_f32 v36, v36, v37
  v_add_f32 v52, v52, v53
  v_cvt_pk_bf16_f32 v36, 0, v36
  v_cvt_pk_bf16_f32 v52, 0, v52
  v_mul_f32 v40, 0xbfb8aa3b, v36
  v_exp_f32 v40, v40
  s_nop 0
  v_add_f32 v40, 1.0, v40
  v_rcp_f32 v40, v40
  s_nop 0
  v_mul_f32 v36, v36, v40
  v_cvt_pk_bf16_f32 v36, 0, v36
  v_mul_f32 v36, v36, v52
  v_cvt_pk_bf16_f32 v36, v36, v36
  s_lshl_b32 s26, s17, 8
  s_add_u32 s26, s26, 161792
  v_add_u32 v5, s26, v1
  ds_write_b32 v5, v36
  v_mul_u32_u24 v5, 56, v2
  v_add_u32 v5, s26, v5
  ds_read_b64 v[36:37], v5 offset:0
  ds_read_b64 v[38:39], v5 offset:8
  ds_read_b64 v[40:41], v5 offset:16
  ds_read_b64 v[42:43], v5 offset:24
  ds_read_b64 v[44:45], v5 offset:32
  ds_read_b64 v[46:47], v5 offset:40
  ds_read_b64 v[52:53], v5 offset:48
  s_waitcnt lgkmcnt(0)
  v_and_b32 v20, v24, v36
  v_and_b32 v21, v25, v36
  v_and_b32 v22, v26, v36
  v_and_b32 v23, v27, v36
  s_nop 0
  s_nop 0
  v_mfma_f32_16x16x32_bf16 v[28:31], v[20:23], v[64:67], 0
  v_and_b32 v32, v24, v37
  v_and_b32 v33, v25, v37
  v_and_b32 v34, v26, v37
  v_and_b32 v35, v27, v37
  s_nop 0
  s_nop 0
  v_mfma_f32_16x16x32_bf16 v[28:31], v[32:35], v[68:71], v[28:31]
  v_and_b32 v20, v24, v38
  v_and_b32 v21, v25, v38
  v_and_b32 v22, v26, v38
  v_and_b32 v23, v27, v38
  s_nop 0
  s_nop 0
  v_mfma_f32_16x16x32_bf16 v[28:31], v[20:23], v[72:75], v[28:31]
  v_and_b32 v32, v24, v39
  v_and_b32 v33, v25, v39
  v_and_b32 v34, v26, v39
  v_and_b32 v35, v27, v39
  s_nop 0
  s_nop 0
  v_mfma_f32_16x16x32_bf16 v[28:31], v[32:35], v[76:79], v[28:31]
  v_and_b32 v20, v24, v40
  v_and_b32 v21, v25, v40
  v_and_b32 v22, v26, v40
  v_and_b32 v23, v27, v40
  s_nop 0
  s_nop 0
  v_mfma_f32_16x16x32_bf16 v[28:31], v[20:23], v[80:83], v[28:31]
  v_and_b32 v32, v24, v41
  v_and_b32 v33, v25, v41
  v_and_b32 v34, v26, v41
  v_and_b32 v35, v27, v41
  s_nop 0
  s_nop 0
  v_mfma_f32_16x16x32_bf16 v[28:31], v[32:35], v[84:87], v[28:31]
  v_and_b32 v20, v24, v42
  v_and_b32 v21, v25, v42
  v_and_b32 v22, v26, v42
  v_and_b32 v23, v27, v42
  s_nop 0
  s_nop 0
  v_mfma_f32_16x16x32_bf16 v[28:31], v[20:23], v[88:91], v[28:31]
  v_and_b32 v32, v24, v43
  v_and_b32 v33, v25, v43
  v_and_b32 v34, v26, v43
  v_and_b32 v35, v27, v43
  s_nop 0
  s_nop 0
  v_mfma_f32_16x16x32_bf16 v[28:31], v[32:35], v[92:95], v[28:31]
  v_and_b32 v20, v24, v44
  v_and_b32 v21, v25, v44
  v_and_b32 v22, v26, v44
  v_and_b32 v23, v27, v44
  s_nop 0
  s_nop 0
  v_mfma_f32_16x16x32_bf16 v[28:31], v[20:23], v[96:99], v[28:31]
  v_and_b32 v32, v24, v45
  v_and_b32 v33, v25, v45
  v_and_b32 v34, v26, v45
  v_and_b32 v35, v27, v45
  s_nop 0
  s_nop 0
  v_mfma_f32_16x16x32_bf16 v[28:31], v[32:35], v[100:103], v[28:31]
  v_and_b32 v20, v24, v46
  v_and_b32 v21, v25, v46
  v_and_b32 v22, v26, v46
  v_and_b32 v23, v27, v46
  s_nop 0
  s_nop 0
  v_mfma_f32_16x16x32_bf16 v[28:31], v[20:23], v[104:107], v[28:31]
  v_and_b32 v32, v24, v47
  v_and_b32 v33, v25, v47
  v_and_b32 v34, v26, v47
  v_and_b32 v35, v27, v47
  s_nop 0
  s_nop 0
  v_mfma_f32_16x16x32_bf16 v[28:31], v[32:35], v[108:111], v[28:31]
  v_and_b32 v20, v24, v52
  v_and_b32 v21, v25, v52
  v_and_b32 v22, v26, v52
  v_and_b32 v23, v27, v52
  s_nop 0
  s_nop 0
  v_mfma_f32_16x16x32_bf16 v[28:31], v[20:23], v[112:115], v[28:31]
  v_and_b32 v32, v24, v53
  v_and_b32 v33, v25, v53
  v_and_b32 v34, v26, v53
  v_and_b32 v35, v27, v53
  s_nop 0
  s_nop 0
  v_mfma_f32_16x16x32_bf16 v[28:31], v[32:35], v[48:51], v[28:31]
  v_lshrrev_b32 v3, 1, v3
  s_lshl_b32 s26, s47, 7
  s_add_u32 s26, s26, s57
  s_lshl_b32 s26, s26, 8
  s_add_u32 s26, s26, 244318208
  s_nop 2
  v_cvt_pk_bf16_f32 v28, v28, v29
  v_cvt_pk_bf16_f32 v29, v30, v31
  v_min_u32 v28, -2, v28
  v_min_u32 v29, -2, v29
  s_mov_b32 exec_hi, 0
  buffer_store_dwordx2 v[28:29], v3, s[4:7], s26 offen sc1
  s_mov_b32 exec_hi, -1
  s_cmp_lg_u32 s16, 0
  s_cbranch_scc1 k_nx_114
  s_barrier
  s_lshl_b32 s26, s61, 21
  s_lshl_b32 s27, s59, 10
  s_add_u32 s26, s26, s27
  s_add_u32 s27, s26, 20971520
  s_add_u32 s28, s26, 27262976
  s_lshl_b32 s26, s47, 7
  s_add_u32 s26, s26, s17
  s_lshl_b32 s26, s26, 8
  s_add_u32 s26, s26, 244318208
  v_lshrrev_b32 v2, 8, v0
  v_and_b32 v3, 0xf0, v0
  v_lshl_add_u32 v5, v2, 10, v3
  buffer_load_dwordx4 v[108:111], v0, s[4:7], s27 offen sc1
  buffer_load_dwordx4 v[112:115], v0, s[4:7], s28 offen sc1
  s_mov_b32 s53, 0
m_w_119:
  s_add_u32 s27, s26, 0
  buffer_load_dwordx4 v[20:23], v5, s[4:7], s27 offen sc1
  s_add_u32 s27, s26, 4096
  buffer_load_dwordx4 v[24:27], v5, s[4:7], s27 offen sc1
  s_add_u32 s27, s26, 8192
  buffer_load_dwordx4 v[28:31], v5, s[4:7], s27 offen sc1
  s_add_u32 s27, s26, 12288
  buffer_load_dwordx4 v[32:35], v5, s[4:7], s27 offen sc1
  s_add_u32 s27, s26, 16384
  buffer_load_dwordx4 v[36:39], v5, s[4:7], s27 offen sc1
  s_add_u32 s27, s26, 20480
  buffer_load_dwordx4 v[40:43], v5, s[4:7], s27 offen sc1
  s_add_u32 s27, s26, 24576
  buffer_load_dwordx4 v[44:47], v5, s[4:7], s27 offen sc1
  s_add_u32 s27, s26, 28672
  buffer_load_dwordx4 v[48:51], v5, s[4:7], s27 offen sc1
  s_add_u32 s53, s53, 1
  s_cmp_gt_u32 s53, 1048576
  s_cbranch_scc1 q_fail_98
  s_mov_b32 vcc_lo, 0xaaaaaaaa
  s_mov_b32 vcc_hi, 0xaaaaaaaa
  v_mov_b32 v72, 0x3f80
  v_mov_b32 v68, 1.0
  v_cndmask_b32 v72, v72, v68, vcc
  s_mov_b32 vcc_lo, 0x30003
  s_mov_b32 vcc_hi, 0x30003
  v_cndmask_b32 v68, 0, v72, vcc
  s_mov_b32 vcc_lo, 0xc000c
  s_mov_b32 vcc_hi, 0xc000c
  v_cndmask_b32 v69, 0, v72, vcc
  s_mov_b32 vcc_lo, 0x300030
  s_mov_b32 vcc_hi, 0x300030
  v_cndmask_b32 v70, 0, v72, vcc
  s_mov_b32 vcc_lo, 0xc000c0
  s_mov_b32 vcc_hi, 0xc000c0
  v_cndmask_b32 v71, 0, v72, vcc
  s_waitcnt vmcnt(7)
  s_nop 0
  v_mfma_f32_16x16x32_bf16 v[72:75], v[68:71], v[20:23], 0
  v_max3_u32 v80, v20, v21, 0
  v_max3_u32 v80, v22, v23, v80
  s_waitcnt vmcnt(6)
  v_mfma_f32_16x16x32_bf16 v[72:75], v[68:71], v[24:27], v[72:75]
  v_max3_u32 v80, v24, v25, v80
  v_max3_u32 v80, v26, v27, v80
  s_waitcnt vmcnt(5)
  v_mfma_f32_16x16x32_bf16 v[72:75], v[68:71], v[28:31], v[72:75]
  v_max3_u32 v80, v28, v29, v80
  v_max3_u32 v80, v30, v31, v80
  s_waitcnt vmcnt(4)
  v_mfma_f32_16x16x32_bf16 v[72:75], v[68:71], v[32:35], v[72:75]
  v_max3_u32 v80, v32, v33, v80
  v_max3_u32 v80, v34, v35, v80
  s_waitcnt vmcnt(3)
  v_mfma_f32_16x16x32_bf16 v[72:75], v[68:71], v[36:39], v[72:75]
  v_max3_u32 v80, v36, v37, v80
  v_max3_u32 v80, v38, v39, v80
  s_waitcnt vmcnt(2)
  v_mfma_f32_16x16x32_bf16 v[72:75], v[68:71], v[40:43], v[72:75]
  v_max3_u32 v80, v40, v41, v80
  v_max3_u32 v80, v42, v43, v80
  s_waitcnt vmcnt(1)
  v_mfma_f32_16x16x32_bf16 v[72:75], v[68:71], v[44:47], v[72:75]
  v_max3_u32 v80, v44, v45, v80
  v_max3_u32 v80, v46, v47, v80
  s_waitcnt vmcnt(0)
  v_mfma_f32_16x16x32_bf16 v[72:75], v[68:71], v[48:51], v[72:75]
  v_max3_u32 v80, v48, v49, v80
  v_max3_u32 v80, v50, v51, v80
  v_cmp_eq_u32 vcc, -1, v80
  s_cbranch_vccnz m_w_119
  v_lshlrev_b32 v3, 1, v3
  v_lshl_add_u32 v3, v2, 4, v3
  s_lshl_b32 s26, s17, 9
  s_add_u32 s26, s26, 159744
  v_add_u32 v3, s26, v3
  s_mov_b32 exec_hi, 0
  ds_write_b128 v3, v[72:75]
  s_mov_b32 exec_hi, -1
  v_lshlrev_b32 v3, 1, v0
  v_add_u32 v3, 159744, v3
  v_lshlrev_b32 v80, 16, v108
  v_and_b32 v81, 0xffff0000, v108
  v_lshlrev_b32 v82, 16, v109
  v_and_b32 v83, 0xffff0000, v109
  v_lshlrev_b32 v84, 16, v110
  v_and_b32 v85, 0xffff0000, v110
  v_lshlrev_b32 v86, 16, v111
  v_and_b32 v87, 0xffff0000, v111
  v_lshlrev_b32 v88, 16, v112
  v_and_b32 v89, 0xffff0000, v112
  v_lshlrev_b32 v90, 16, v113
  v_and_b32 v91, 0xffff0000, v113
  v_lshlrev_b32 v92, 16, v114
  v_and_b32 v93, 0xffff0000, v114
  v_lshlrev_b32 v94, 16, v115
  v_and_b32 v95, 0xffff0000, v115
  s_waitcnt lgkmcnt(0)
  s_barrier
  s_cmp_lg_u32 s17, 0
  s_cbranch_scc1 m_done_118
  ds_read_b128 v[72:75], v3
  ds_read_b128 v[76:79], v3 offset:16
  s_and_b32 s29, s58, 0xffff0000
  s_xor_b32 s27, s29, 0x80000000
  s_xor_b32 s28, s29, 0xffff0000
  s_bitcmp1_b32 s29, 31
  s_cselect_b32 s29, s27, s28
  v_mov_b32 v108, s29
  v_mul_f32 v108, 0xbfb8aa3b, v108
  v_exp_f32 v108, v108
  s_nop 0
  v_add_f32 v108, 1.0, v108
  v_rcp_f32 v108, v108
  s_nop 0
  v_cvt_pk_bf16_f32 v108, 0, v108
  v_add_f32 v20, v80, v88
  v_add_f32 v21, v81, v89
  v_add_f32 v22, v82, v90
  v_add_f32 v23, v83, v91
  v_add_f32 v24, v84, v92
  v_add_f32 v25, v85, v93
  v_add_f32 v26, v86, v94
  v_add_f32 v27, v87, v95
  v_cvt_pk_bf16_f32 v28, v20, v21
  v_cvt_pk_bf16_f32 v29, v22, v23
  v_cvt_pk_bf16_f32 v30, v24, v25
  v_cvt_pk_bf16_f32 v31, v26, v27
  v_accvgpr_write_b32 a0, v28
  v_accvgpr_write_b32 a1, v29
  v_accvgpr_write_b32 a2, v30
  v_accvgpr_write_b32 a3, v31
  s_waitcnt lgkmcnt(0)
  v_cvt_pk_bf16_f32 v72, 0, v72
  v_cvt_pk_bf16_f32 v73, 0, v73
  v_cvt_pk_bf16_f32 v74, 0, v74
  v_cvt_pk_bf16_f32 v75, 0, v75
  v_cvt_pk_bf16_f32 v76, 0, v76
  v_cvt_pk_bf16_f32 v77, 0, v77
  v_cvt_pk_bf16_f32 v78, 0, v78
  v_cvt_pk_bf16_f32 v79, 0, v79
  v_mul_f32 v72, v72, v108
  v_mul_f32 v73, v73, v108
  v_mul_f32 v74, v74, v108
  v_mul_f32 v75, v75, v108
  v_mul_f32 v76, v76, v108
  v_mul_f32 v77, v77, v108
  v_mul_f32 v78, v78, v108
  v_mul_f32 v79, v79, v108
  v_cvt_pk_bf16_f32 v72, 0, v72
  v_cvt_pk_bf16_f32 v73, 0, v73
  v_cvt_pk_bf16_f32 v74, 0, v74
  v_cvt_pk_bf16_f32 v75, 0, v75
  v_cvt_pk_bf16_f32 v76, 0, v76
  v_cvt_pk_bf16_f32 v77, 0, v77
  v_cvt_pk_bf16_f32 v78, 0, v78
  v_cvt_pk_bf16_f32 v79, 0, v79
  v_add_f32 v72, v72, v88
  v_add_f32 v73, v73, v89
  v_add_f32 v74, v74, v90
  v_add_f32 v75, v75, v91
  v_add_f32 v76, v76, v92
  v_add_f32 v77, v77, v93
  v_add_f32 v78, v78, v94
  v_add_f32 v79, v79, v95
  v_cvt_pk_bf16_f32 v72, 0, v72
  v_cvt_pk_bf16_f32 v73, 0, v73
  v_cvt_pk_bf16_f32 v74, 0, v74
  v_cvt_pk_bf16_f32 v75, 0, v75
  v_cvt_pk_bf16_f32 v76, 0, v76
  v_cvt_pk_bf16_f32 v77, 0, v77
  v_cvt_pk_bf16_f32 v78, 0, v78
  v_cvt_pk_bf16_f32 v79, 0, v79
  v_add_f32 v80, v80, v72
  v_add_f32 v81, v81, v73
  v_add_f32 v82, v82, v74
  v_add_f32 v83, v83, v75
  v_add_f32 v84, v84, v76
  v_add_f32 v85, v85, v77
  v_add_f32 v86, v86, v78
  v_add_f32 v87, v87, v79
  v_cvt_pk_bf16_f32 v112, v80, v81
  v_cvt_pk_bf16_f32 v113, v82, v83
  v_cvt_pk_bf16_f32 v114, v84, v85
  v_cvt_pk_bf16_f32 v115, v86, v87
  v_lshlrev_b32 v80, 16, v112
  v_and_b32 v81, 0xffff0000, v112
  v_lshlrev_b32 v82, 16, v113
  v_and_b32 v83, 0xffff0000, v113
  v_lshlrev_b32 v84, 16, v114
  v_and_b32 v85, 0xffff0000, v114
  v_lshlrev_b32 v86, 16, v115
  v_and_b32 v87, 0xffff0000, v115
  s_lshl_b32 s26, s59, 10
  buffer_store_dwordx4 v[112:115], v0, s[72:75], s26 offen sc1
m_done_118:
k_nx_114:
  s_add_u32 s47, s47, 3
  s_xor_b32 s48, s48, 31
  s_andn2_b32 s28, 0xfe0, s56
  s_lshl_b32 s28, s28, 7
  s_mov_b32 s29, 243793920
  v_mov_b32 v24, 262144
  s_mov_b32 s53, 0
  s_mov_b32 s33, 3
  v_mov_b32 v53, s58
  s_and_b32 s32, s48, 15
  s_cbranch_scc0 k_x_121
k_w_120:
  s_add_u32 s33, s33, 1
  s_and_b32 s33, s33, 3
  s_bitcmp1_b32 s32, s33
  s_cbranch_scc0 k_w_120
  s_lshl2_add_u32 s26, s33, s17
  s_lshl_b32 s26, s26, 14
  s_add_u32 s27, s26, 8192
  v_add_u32 v22, s26, v9
  v_cmp_le_u32 vcc, s28, v22
  s_nop 1
  v_cndmask_b32 v25, 0, v24, vcc
  v_add_u32 v22, v22, v25
  buffer_load_dword v20, v22, s[4:7], s29 offen sc1
  v_add_u32 v23, s27, v9
  v_cmp_le_u32 vcc, s28, v23
  s_nop 1
  v_cndmask_b32 v25, 0, v24, vcc
  v_add_u32 v23, v23, v25
  buffer_load_dword v21, v23, s[4:7], s29 offen sc1
  s_add_u32 s53, s53, 1
  s_cmp_gt_u32 s53, 1048576
  s_cbranch_scc1 q_fail_98
  s_waitcnt vmcnt(0)
  v_min_u32 v52, v20, v21
  v_max3_u32 v53, v20, v21, v53
  v_cmp_eq_u32 vcc, 0, v52
  s_cbranch_vccnz k_w_120
  s_bitset0_b32 s32, s33
  s_cmp_lg_u32 s32, 0
  s_cbranch_scc1 k_w_120
  v_max_u32_dpp v53, v53, v53 row_ror:8 row_mask:0xf bank_mask:0xf
  s_nop 1
  v_max_u32_dpp v53, v53, v53 row_ror:4 row_mask:0xf bank_mask:0xf
  s_nop 1
  v_max_u32_dpp v53, v53, v53 row_ror:2 row_mask:0xf bank_mask:0xf
  s_nop 1
  v_max_u32_dpp v53, v53, v53 row_ror:1 row_mask:0xf bank_mask:0xf
  v_mov_b32 v52, v53
  s_nop 0
  s_nop 0
  v_permlane16_swap_b32 v53, v52
  v_max_u32 v53, v53, v52
  v_mov_b32 v52, v53
  s_nop 0
  s_nop 0
  v_permlane32_swap_b32 v53, v52
  v_max_u32 v53, v53, v52
k_x_121:
  ds_write_b32 v118, v53 offset:256
  s_waitcnt vmcnt(0) lgkmcnt(0)
  s_barrier
  ds_read_b128 v[20:23], v119 offset:256
  s_waitcnt lgkmcnt(0)
  v_max3_u32 v20, v20, v21, v22
  v_max_u32 v20, v20, v23
  s_nop 0
  v_readfirstlane_b32 s26, v20
  s_cmp_eq_u32 s26, s58
  s_cbranch_scc1 q_fail_98
  s_cmp_eq_u32 s58, 0
  s_mov_b32 s58, s26
  s_cbranch_scc1 k_r_122
  s_cmp_lg_u32 s57, 0
  s_cbranch_scc1 k_r_122
  s_lshl_b32 s26, s59, 10
  buffer_store_dwordx4 a[0:3], v0, s[72:75], s26 offen sc1
k_r_122:
  s_andn2_b32 s26, 0xfe0, s56
  s_andn2_b32 s27, 0xfe0, s58
  s_cmp_lt_u32 s27, s26
  s_cselect_b32 s61, 1, 2
  s_andn2_b32 s59, 0xfff, s58
  s_lshl_b32 s26, s61, 21
  s_lshl_b32 s27, s59, 10
  s_add_u32 s26, s26, s27
  s_lshl_b32 s27, s17, 8
  s_add_u32 s26, s26, s27
  s_add_u32 s26, s26, 27262976
  v_lshrrev_b32 v5, 7, v0
  v_lshlrev_b32 v5, 5, v5
  buffer_load_dwordx4 v[52:55], v5, s[4:7], s26 offen offset:0 sc1
  buffer_load_dwordx4 v[56:59], v5, s[4:7], s26 offen offset:16 sc1
  s_load_dwordx2 s[64:65], s[0:1], 72
  s_load_dwordx2 s[68:69], s[0:1], 80
  s_load_dwordx2 s[8:9], s[0:1], 88
  s_mov_b32 s66, 1835008
  s_mov_b32 s70, 1835008
  s_mov_b32 s10, 1835008
  v_lshrrev_b32 v2, 7, v0
  v_and_b32 v3, 0x70, v0
  v_mul_u32_u24 v6, 57344, v2
  v_add_u32 v6, v6, v3
  v_cmp_eq_u32 vcc, 0x70, v3
  v_mov_b32 v3, 0x7ff00000
  s_nop 0
  v_cndmask_b32 v6, v6, v3, vcc
  v_lshrrev_b32 v2, 8, v0
  v_mul_u32_u24 v7, 14336, v2
  v_and_b32 v3, 0xf0, v0
  v_add_u32 v7, v7, v3
  s_mul_i32 s34, s17, 458752
  s_mul_i32 s27, s16, 112
  s_add_u32 s34, s34, s27
  s_mul_i32 s35, s16, 57344
  s_lshl_b32 s27, s17, 8
  s_add_u32 s35, s35, s27
  s_waitcnt lgkmcnt(0)
  s_xor_b32 s37, s50, 32768
  s_add_u32 s37, s37, s54
  s_mov_b32 m0, s37
  s_add_u32 s36, s34, 39424
  buffer_load_dwordx4 v6, s[68:71], s36 offen lds
  s_add_u32 m0, m0, 1024
  s_add_u32 s36, s34, 43008
  buffer_load_dwordx4 v6, s[64:67], s36 offen lds
  s_add_u32 m0, m0, 1024
  s_add_u32 s36, s34, 43008
  buffer_load_dwordx4 v6, s[68:71], s36 offen lds
  s_add_u32 m0, m0, 1024
  s_add_u32 s36, s34, 46592
  buffer_load_dwordx4 v6, s[64:67], s36 offen lds
  s_add_u32 m0, m0, 1024
  s_add_u32 s36, s34, 46592
  buffer_load_dwordx4 v6, s[68:71], s36 offen lds
  s_add_u32 m0, m0, 1024
  s_add_u32 s36, s34, 50176
  buffer_load_dwordx4 v6, s[64:67], s36 offen lds
  s_add_u32 m0, m0, 1024
  s_add_u32 s36, s34, 50176
  buffer_load_dwordx4 v6, s[68:71], s36 offen lds
  s_add_u32 m0, m0, 1024
  s_add_u32 s36, s34, 53760
  buffer_load_dwordx4 v6, s[64:67], s36 offen lds
  s_add_u32 m0, m0, 1024
  s_add_u32 s36, s34, 53760
  buffer_load_dwordx4 v[60:63], v6, s[68:71], s36 offen
  buffer_load_dwordx4 v[64:67], v7, s[8:11], s35 offen offset:0
  buffer_load_dwordx4 v[68:71], v7, s[8:11], s35 offen offset:1024
  buffer_load_dwordx4 v[72:75], v7, s[8:11], s35 offen offset:2048
  buffer_load_dwordx4 v[76:79], v7, s[8:11], s35 offen offset:3072
  s_add_u32 s35, s35, 4096
  buffer_load_dwordx4 v[80:83], v7, s[8:11], s35 offen offset:0
  buffer_load_dwordx4 v[84:87], v7, s[8:11], s35 offen offset:1024
  buffer_load_dwordx4 v[88:91], v7, s[8:11], s35 offen offset:2048
  buffer_load_dwordx4 v[92:95], v7, s[8:11], s35 offen offset:3072
  s_add_u32 s35, s35, 4096
  buffer_load_dwordx4 v[96:99], v7, s[8:11], s35 offen offset:0
  buffer_load_dwordx4 v[100:103], v7, s[8:11], s35 offen offset:1024
  buffer_load_dwordx4 v[104:107], v7, s[8:11], s35 offen offset:2048
  buffer_load_dwordx4 v[108:111], v7, s[8:11], s35 offen offset:3072
  s_add_u32 s35, s35, 4096
  buffer_load_dwordx4 v[112:115], v7, s[8:11], s35 offen offset:0
  buffer_load_dwordx4 v[48:51], v7, s[8:11], s35 offen offset:1024
  s_mov_b32 vcc_lo, 0xaaaaaaaa
  s_mov_b32 vcc_hi, 0xaaaaaaaa
  v_mov_b32 v3, 0xffff
  v_mov_b32 v24, 0xffff0000
  v_cndmask_b32 v3, v3, v24, vcc
  s_mov_b32 vcc_lo, 0x3030303
  s_mov_b32 vcc_hi, 0x3030303
  v_cndmask_b32 v24, 0, v3, vcc
  s_mov_b32 vcc_lo, 0xc0c0c0c
  s_mov_b32 vcc_hi, 0xc0c0c0c
  v_cndmask_b32 v25, 0, v3, vcc
  s_mov_b32 vcc_lo, 0x30303030
  s_mov_b32 vcc_hi, 0x30303030
  v_cndmask_b32 v26, 0, v3, vcc
  s_mov_b32 vcc_lo, 0xc0c0c0c0
  s_mov_b32 vcc_hi, 0xc0c0c0c0
  v_cndmask_b32 v27, 0, v3, vcc
  s_mov_b32 s30, 0x01000100
  s_mov_b32 s31, 0x03020302
  s_mul_i32 s26, s17, 23552
  s_add_u32 s26, s26, 65536
  v_add_u32 v5, s26, v0
  v_add_u32 v2, s37, v0
  ds_read_b128 v[36:39], v5 offset:0
  ds_read_b128 v[40:43], v5 offset:1024
  ds_read_b128 v[44:47], v5 offset:2048
  ds_read_b128 v[12:15], v5 offset:3072
  ds_read_b128 v[16:19], v5 offset:4096
  ds_read_b128 v[120:123], v5 offset:5120
  ds_read_b128 v[124:127], v5 offset:6144
  s_waitcnt vmcnt(23)
  v_perm_b32 v3, v52, v52, s30
  v_and_b32 v20, v24, v3
  v_and_b32 v21, v25, v3
  v_and_b32 v22, v26, v3
  v_and_b32 v23, v27, v3
  s_waitcnt lgkmcnt(5)
  s_nop 0
  v_mfma_f32_16x16x32_bf16 v[28:31], v[20:23], v[36:39], 0
  ds_read_b128 v[36:39], v5 offset:7168
  v_mfma_f32_16x16x32_bf16 v[32:35], v[20:23], v[40:43], 0
  ds_read_b128 v[40:43], v5 offset:8192
  v_perm_b32 v3, v52, v52, s31
  v_and_b32 v20, v24, v3
  v_and_b32 v21, v25, v3
  v_and_b32 v22, v26, v3
  v_and_b32 v23, v27, v3
  s_waitcnt lgkmcnt(5)
  s_nop 0
  v_mfma_f32_16x16x32_bf16 v[28:31], v[20:23], v[44:47], v[28:31]
  ds_read_b128 v[44:47], v5 offset:9216
  v_mfma_f32_16x16x32_bf16 v[32:35], v[20:23], v[12:15], v[32:35]
  ds_read_b128 v[12:15], v5 offset:10240
  v_perm_b32 v3, v53, v53, s30
  v_and_b32 v20, v24, v3
  v_and_b32 v21, v25, v3
  v_and_b32 v22, v26, v3
  v_and_b32 v23, v27, v3
  s_waitcnt lgkmcnt(5)
  s_nop 0
  v_mfma_f32_16x16x32_bf16 v[28:31], v[20:23], v[16:19], v[28:31]
  ds_read_b128 v[16:19], v5 offset:11264
  v_mfma_f32_16x16x32_bf16 v[32:35], v[20:23], v[120:123], v[32:35]
  ds_read_b128 v[120:123], v5 offset:12288
  v_perm_b32 v3, v53, v53, s31
  v_and_b32 v20, v24, v3
  v_and_b32 v21, v25, v3
  v_and_b32 v22, v26, v3
  v_and_b32 v23, v27, v3
  s_waitcnt lgkmcnt(5)
  s_nop 0
  v_mfma_f32_16x16x32_bf16 v[28:31], v[20:23], v[124:127], v[28:31]
  ds_read_b128 v[124:127], v5 offset:13312
  v_mfma_f32_16x16x32_bf16 v[32:35], v[20:23], v[36:39], v[32:35]
  ds_read_b128 v[36:39], v5 offset:14336
  v_perm_b32 v3, v54, v54, s30
  v_and_b32 v20, v24, v3
  v_and_b32 v21, v25, v3
  v_and_b32 v22, v26, v3
  v_and_b32 v23, v27, v3
  s_waitcnt lgkmcnt(5)
  s_nop 0
  v_mfma_f32_16x16x32_bf16 v[28:31], v[20:23], v[40:43], v[28:31]
  ds_read_b128 v[40:43], v5 offset:15360
  v_mfma_f32_16x16x32_bf16 v[32:35], v[20:23], v[44:47], v[32:35]
  ds_read_b128 v[44:47], v5 offset:16384
  v_perm_b32 v3, v54, v54, s31
  v_and_b32 v20, v24, v3
  v_and_b32 v21, v25, v3
  v_and_b32 v22, v26, v3
  v_and_b32 v23, v27, v3
  s_waitcnt lgkmcnt(5)
  s_nop 0
  v_mfma_f32_16x16x32_bf16 v[28:31], v[20:23], v[12:15], v[28:31]
  ds_read_b128 v[12:15], v5 offset:17408
  v_mfma_f32_16x16x32_bf16 v[32:35], v[20:23], v[16:19], v[32:35]
  ds_read_b128 v[16:19], v5 offset:18432
  v_perm_b32 v3, v55, v55, s30
  v_and_b32 v20, v24, v3
  v_and_b32 v21, v25, v3
  v_and_b32 v22, v26, v3
  v_and_b32 v23, v27, v3
  s_waitcnt lgkmcnt(5)
  s_nop 0
  v_mfma_f32_16x16x32_bf16 v[28:31], v[20:23], v[120:123], v[28:31]
  ds_read_b128 v[120:123], v5 offset:19456
  v_mfma_f32_16x16x32_bf16 v[32:35], v[20:23], v[124:127], v[32:35]
  ds_read_b128 v[124:127], v5 offset:20480
  v_perm_b32 v3, v55, v55, s31
  v_and_b32 v20, v24, v3
  v_and_b32 v21, v25, v3
  v_and_b32 v22, v26, v3
  v_and_b32 v23, v27, v3
  s_waitcnt lgkmcnt(5)
  s_nop 0
  v_mfma_f32_16x16x32_bf16 v[28:31], v[20:23], v[36:39], v[28:31]
  ds_read_b128 v[36:39], v5 offset:21504
  v_mfma_f32_16x16x32_bf16 v[32:35], v[20:23], v[40:43], v[32:35]
  ds_read_b128 v[40:43], v5 offset:22528
  v_perm_b32 v3, v56, v56, s30
  v_and_b32 v20, v24, v3
  v_and_b32 v21, v25, v3
  v_and_b32 v22, v26, v3
  v_and_b32 v23, v27, v3
  s_waitcnt lgkmcnt(5)
  s_nop 0
  v_mfma_f32_16x16x32_bf16 v[28:31], v[20:23], v[44:47], v[28:31]
  s_waitcnt vmcnt(22)
  ds_read_b128 v[44:47], v2 offset:0
  v_mfma_f32_16x16x32_bf16 v[32:35], v[20:23], v[12:15], v[32:35]
  s_waitcnt vmcnt(21)
  ds_read_b128 v[12:15], v2 offset:1024
  v_perm_b32 v3, v56, v56, s31
  v_and_b32 v20, v24, v3
  v_and_b32 v21, v25, v3
  v_and_b32 v22, v26, v3
  v_and_b32 v23, v27, v3
  s_waitcnt lgkmcnt(5)
  s_nop 0
  v_mfma_f32_16x16x32_bf16 v[28:31], v[20:23], v[16:19], v[28:31]
  s_waitcnt vmcnt(20)
  ds_read_b128 v[16:19], v2 offset:2048
  v_mfma_f32_16x16x32_bf16 v[32:35], v[20:23], v[120:123], v[32:35]
  s_waitcnt vmcnt(19)
  ds_read_b128 v[120:123], v2 offset:3072
  v_perm_b32 v3, v57, v57, s30
  v_and_b32 v20, v24, v3
  v_and_b32 v21, v25, v3
  v_and_b32 v22, v26, v3
  v_and_b32 v23, v27, v3
  s_waitcnt lgkmcnt(5)
  s_nop 0
  v_mfma_f32_16x16x32_bf16 v[28:31], v[20:23], v[124:127], v[28:31]
  s_waitcnt vmcnt(18)
  ds_read_b128 v[124:127], v2 offset:4096
  v_mfma_f32_16x16x32_bf16 v[32:35], v[20:23], v[36:39], v[32:35]
  s_waitcnt vmcnt(17)
  ds_read_b128 v[36:39], v2 offset:5120
  v_perm_b32 v3, v57, v57, s31
  v_and_b32 v20, v24, v3
  v_and_b32 v21, v25, v3
  v_and_b32 v22, v26, v3
  v_and_b32 v23, v27, v3
  s_waitcnt lgkmcnt(5)
  s_nop 0
  v_mfma_f32_16x16x32_bf16 v[28:31], v[20:23], v[40:43], v[28:31]
  s_waitcnt vmcnt(16)
  ds_read_b128 v[40:43], v2 offset:6144
  v_mfma_f32_16x16x32_bf16 v[32:35], v[20:23], v[44:47], v[32:35]
  s_waitcnt vmcnt(15)
  ds_read_b128 v[44:47], v2 offset:7168
  v_perm_b32 v3, v58, v58, s30
  v_and_b32 v20, v24, v3
  v_and_b32 v21, v25, v3
  v_and_b32 v22, v26, v3
  v_and_b32 v23, v27, v3
  s_waitcnt lgkmcnt(5)
  s_nop 0
  v_mfma_f32_16x16x32_bf16 v[28:31], v[20:23], v[12:15], v[28:31]
  v_mfma_f32_16x16x32_bf16 v[32:35], v[20:23], v[16:19], v[32:35]
  v_perm_b32 v3, v58, v58, s31
  v_and_b32 v20, v24, v3
  v_and_b32 v21, v25, v3
  v_and_b32 v22, v26, v3
  v_and_b32 v23, v27, v3
  s_waitcnt lgkmcnt(3)
  s_nop 0
  v_mfma_f32_16x16x32_bf16 v[28:31], v[20:23], v[120:123], v[28:31]
  v_mfma_f32_16x16x32_bf16 v[32:35], v[20:23], v[124:127], v[32:35]
  v_perm_b32 v3, v59, v59, s30
  v_and_b32 v20, v24, v3
  v_and_b32 v21, v25, v3
  v_and_b32 v22, v26, v3
  v_and_b32 v23, v27, v3
  s_waitcnt lgkmcnt(1)
  s_nop 0
  v_mfma_f32_16x16x32_bf16 v[28:31], v[20:23], v[36:39], v[28:31]
  v_mfma_f32_16x16x32_bf16 v[32:35], v[20:23], v[40:43], v[32:35]
  v_perm_b32 v3, v59, v59, s31
  v_and_b32 v20, v24, v3
  v_and_b32 v21, v25, v3
  v_and_b32 v22, v26, v3
  v_and_b32 v23, v27, v3
  s_waitcnt lgkmcnt(0)
  s_waitcnt vmcnt(14)
  v_mfma_f32_16x16x32_bf16 v[28:31], v[20:23], v[44:47], v[28:31]
  v_mfma_f32_16x16x32_bf16 v[32:35], v[20:23], v[60:63], v[32:35]
  v_lshrrev_b32 v2, 8, v0
  v_and_b32 v3, 0xf0, v0
  v_lshlrev_b32 v3, 1, v3
  v_and_b32 v5, 1, v2
  v_lshl_add_u32 v5, v5, 4, v3
  v_add_u32 v5, s37, v5
  s_mov_b32 exec_lo, 0x00ff00ff
  s_mov_b32 exec_hi, 0xff00ff00
  ds_write_b128 v5, v[28:31]
  ds_write_b128 v5, v[32:35] offset:512
  s_mov_b64 exec, -1
  s_xor_b32 s26, s50, 32768
  v_add_u32 v5, s26, v1
  v_lshl_add_u32 v3, v2, 4, v3
  s_waitcnt lgkmcnt(0)
  s_barrier
  ds_read2st64_b32 v[36:37], v5 offset0:0 offset1:1
  ds_read2st64_b32 v[52:53], v5 offset0:2 offset1:3
  ds_read2st64_b32 v[38:39], v5 offset0:32 offset1:33
  ds_read2st64_b32 v[54:55], v5 offset0:34 offset1:35
  ds_read2st64_b32 v[40:41], v5 offset0:64 offset1:65
  ds_read2st64_b32 v[56:57], v5 offset0:66 offset1:67
  ds_read2st64_b32 v[42:43], v5 offset0:96 offset1:97
  ds_read2st64_b32 v[58:59], v5 offset0:98 offset1:99
  s_waitcnt lgkmcnt(0)
  v_add_f32 v36, v36, v40
  v_add_f32 v37, v37, v41
  v_add_f32 v38, v38, v42
  v_add_f32 v39, v39, v43
  v_add_f32 v52, v52, v56
  v_add_f32 v53, v53, v57
  v_add_f32 v54, v54, v58
  v_add_f32 v55, v55, v59
  v_add_f32 v36, v36, v38
  v_add_f32 v37, v37, v39
  v_add_f32 v52, v52, v54
  v_add_f32 v53, v53, v55
  v_add_f32 v36, v36, v37
  v_add_f32 v52, v52, v53
  v_cvt_pk_bf16_f32 v36, 0, v36
  v_cvt_pk_bf16_f32 v52, 0, v52
  v_mul_f32 v40, 0xbfb8aa3b, v36
  v_exp_f32 v40, v40
  s_nop 0
  v_add_f32 v40, 1.0, v40
  v_rcp_f32 v40, v40
  s_nop 0
  v_mul_f32 v36, v36, v40
  v_cvt_pk_bf16_f32 v36, 0, v36
  v_mul_f32 v36, v36, v52
  v_cvt_pk_bf16_f32 v36, v36, v36
  s_lshl_b32 s26, s17, 8
  s_add_u32 s26, s26, 161792
  v_add_u32 v5, s26, v1
  ds_write_b32 v5, v36
  v_mul_u32_u24 v5, 56, v2
  v_add_u32 v5, s26, v5
  ds_read_b64 v[36:37], v5 offset:0
  ds_read_b64 v[38:39], v5 offset:8
  ds_read_b64 v[40:41], v5 offset:16
  ds_read_b64 v[42:43], v5 offset:24
  ds_read_b64 v[44:45], v5 offset:32
  ds_read_b64 v[46:47], v5 offset:40
  ds_read_b64 v[52:53], v5 offset:48
  s_waitcnt lgkmcnt(0)
  v_and_b32 v20, v24, v36
  v_and_b32 v21, v25, v36
  v_and_b32 v22, v26, v36
  v_and_b32 v23, v27, v36
  s_waitcnt vmcnt(13)
  s_nop 0
  v_mfma_f32_16x16x32_bf16 v[28:31], v[20:23], v[64:67], 0
  v_and_b32 v32, v24, v37
  v_and_b32 v33, v25, v37
  v_and_b32 v34, v26, v37
  v_and_b32 v35, v27, v37
  s_waitcnt vmcnt(12)
  s_nop 0
  v_mfma_f32_16x16x32_bf16 v[28:31], v[32:35], v[68:71], v[28:31]
  v_and_b32 v20, v24, v38
  v_and_b32 v21, v25, v38
  v_and_b32 v22, v26, v38
  v_and_b32 v23, v27, v38
  s_waitcnt vmcnt(11)
  s_nop 0
  v_mfma_f32_16x16x32_bf16 v[28:31], v[20:23], v[72:75], v[28:31]
  v_and_b32 v32, v24, v39
  v_and_b32 v33, v25, v39
  v_and_b32 v34, v26, v39
  v_and_b32 v35, v27, v39
  s_waitcnt vmcnt(10)
  s_nop 0
  v_mfma_f32_16x16x32_bf16 v[28:31], v[32:35], v[76:79], v[28:31]
  v_and_b32 v20, v24, v40
  v_and_b32 v21, v25, v40
  v_and_b32 v22, v26, v40
  v_and_b32 v23, v27, v40
  s_waitcnt vmcnt(9)
  s_nop 0
  v_mfma_f32_16x16x32_bf16 v[28:31], v[20:23], v[80:83], v[28:31]
  v_and_b32 v32, v24, v41
  v_and_b32 v33, v25, v41
  v_and_b32 v34, v26, v41
  v_and_b32 v35, v27, v41
  s_waitcnt vmcnt(8)
  s_nop 0
  v_mfma_f32_16x16x32_bf16 v[28:31], v[32:35], v[84:87], v[28:31]
  v_and_b32 v20, v24, v42
  v_and_b32 v21, v25, v42
  v_and_b32 v22, v26, v42
  v_and_b32 v23, v27, v42
  s_waitcnt vmcnt(7)
  s_nop 0
  v_mfma_f32_16x16x32_bf16 v[28:31], v[20:23], v[88:91], v[28:31]
  v_and_b32 v32, v24, v43
  v_and_b32 v33, v25, v43
  v_and_b32 v34, v26, v43
  v_and_b32 v35, v27, v43
  s_waitcnt vmcnt(6)
  s_nop 0
  v_mfma_f32_16x16x32_bf16 v[28:31], v[32:35], v[92:95], v[28:31]
  v_and_b32 v20, v24, v44
  v_and_b32 v21, v25, v44
  v_and_b32 v22, v26, v44
  v_and_b32 v23, v27, v44
  s_waitcnt vmcnt(5)
  s_nop 0
  v_mfma_f32_16x16x32_bf16 v[28:31], v[20:23], v[96:99], v[28:31]
  v_and_b32 v32, v24, v45
  v_and_b32 v33, v25, v45
  v_and_b32 v34, v26, v45
  v_and_b32 v35, v27, v45
  s_waitcnt vmcnt(4)
  s_nop 0
  v_mfma_f32_16x16x32_bf16 v[28:31], v[32:35], v[100:103], v[28:31]
  v_and_b32 v20, v24, v46
  v_and_b32 v21, v25, v46
  v_and_b32 v22, v26, v46
  v_and_b32 v23, v27, v46
  s_waitcnt vmcnt(3)
  s_nop 0
  v_mfma_f32_16x16x32_bf16 v[28:31], v[20:23], v[104:107], v[28:31]
  v_and_b32 v32, v24, v47
  v_and_b32 v33, v25, v47
  v_and_b32 v34, v26, v47
  v_and_b32 v35, v27, v47
  s_waitcnt vmcnt(2)
  s_nop 0
  v_mfma_f32_16x16x32_bf16 v[28:31], v[32:35], v[108:111], v[28:31]
  v_and_b32 v20, v24, v52
  v_and_b32 v21, v25, v52
  v_and_b32 v22, v26, v52
  v_and_b32 v23, v27, v52
  s_waitcnt vmcnt(1)
  s_nop 0
  v_mfma_f32_16x16x32_bf16 v[28:31], v[20:23], v[112:115], v[28:31]
  v_and_b32 v32, v24, v53
  v_and_b32 v33, v25, v53
  v_and_b32 v34, v26, v53
  v_and_b32 v35, v27, v53
  s_waitcnt vmcnt(0)
  s_nop 0
  v_mfma_f32_16x16x32_bf16 v[28:31], v[32:35], v[48:51], v[28:31]
  v_lshrrev_b32 v3, 1, v3
  s_lshl_b32 s26, s47, 7
  s_add_u32 s26, s26, s57
  s_lshl_b32 s26, s26, 8
  s_add_u32 s26, s26, 244318208
  s_nop 2
  v_cvt_pk_bf16_f32 v28, v28, v29
  v_cvt_pk_bf16_f32 v29, v30, v31
  v_min_u32 v28, -2, v28
  v_min_u32 v29, -2, v29
  s_mov_b32 exec_hi, 0
  buffer_store_dwordx2 v[28:29], v3, s[4:7], s26 offen sc1
  s_mov_b32 exec_hi, -1
  s_cmp_lg_u32 s16, 0
  s_cbranch_scc1 q_fail_98
  s_barrier
  s_lshl_b32 s26, s61, 21
  s_lshl_b32 s27, s59, 10
  s_add_u32 s26, s26, s27
  s_add_u32 s27, s26, 20971520
  s_add_u32 s28, s26, 27262976
  s_lshl_b32 s26, s47, 7
  s_add_u32 s26, s26, s17
  s_lshl_b32 s26, s26, 8
  s_add_u32 s26, s26, 244318208
  v_lshrrev_b32 v2, 8, v0
  v_and_b32 v3, 0xf0, v0
  v_lshl_add_u32 v5, v2, 10, v3
  buffer_load_dwordx4 v[108:111], v0, s[4:7], s27 offen sc1
  buffer_load_dwordx4 v[112:115], v0, s[4:7], s28 offen sc1
  s_mov_b32 s53, 0
m_w_124:
  s_add_u32 s27, s26, 0
  buffer_load_dwordx4 v[20:23], v5, s[4:7], s27 offen sc1
  s_add_u32 s27, s26, 4096
  buffer_load_dwordx4 v[24:27], v5, s[4:7], s27 offen sc1
  s_add_u32 s27, s26, 8192
  buffer_load_dwordx4 v[28:31], v5, s[4:7], s27 offen sc1
  s_add_u32 s27, s26, 12288
  buffer_load_dwordx4 v[32:35], v5, s[4:7], s27 offen sc1
  s_add_u32 s27, s26, 16384
  buffer_load_dwordx4 v[36:39], v5, s[4:7], s27 offen sc1
  s_add_u32 s27, s26, 20480
  buffer_load_dwordx4 v[40:43], v5, s[4:7], s27 offen sc1
  s_add_u32 s27, s26, 24576
  buffer_load_dwordx4 v[44:47], v5, s[4:7], s27 offen sc1
  s_add_u32 s27, s26, 28672
  buffer_load_dwordx4 v[48:51], v5, s[4:7], s27 offen sc1
  s_add_u32 s53, s53, 1
  s_cmp_gt_u32 s53, 1048576
  s_cbranch_scc1 q_fail_98
  s_mov_b32 vcc_lo, 0xaaaaaaaa
  s_mov_b32 vcc_hi, 0xaaaaaaaa
  v_mov_b32 v72, 0x3f80
  v_mov_b32 v68, 1.0
  v_cndmask_b32 v72, v72, v68, vcc
  s_mov_b32 vcc_lo, 0x30003
  s_mov_b32 vcc_hi, 0x30003
  v_cndmask_b32 v68, 0, v72, vcc
  s_mov_b32 vcc_lo, 0xc000c
  s_mov_b32 vcc_hi, 0xc000c
  v_cndmask_b32 v69, 0, v72, vcc
  s_mov_b32 vcc_lo, 0x300030
  s_mov_b32 vcc_hi, 0x300030
  v_cndmask_b32 v70, 0, v72, vcc
  s_mov_b32 vcc_lo, 0xc000c0
  s_mov_b32 vcc_hi, 0xc000c0
  v_cndmask_b32 v71, 0, v72, vcc
  s_waitcnt vmcnt(7)
  s_nop 0
  v_mfma_f32_16x16x32_bf16 v[72:75], v[68:71], v[20:23], 0
  v_max3_u32 v80, v20, v21, 0
  v_max3_u32 v80, v22, v23, v80
  s_waitcnt vmcnt(6)
  v_mfma_f32_16x16x32_bf16 v[72:75], v[68:71], v[24:27], v[72:75]
  v_max3_u32 v80, v24, v25, v80
  v_max3_u32 v80, v26, v27, v80
  s_waitcnt vmcnt(5)
  v_mfma_f32_16x16x32_bf16 v[72:75], v[68:71], v[28:31], v[72:75]
  v_max3_u32 v80, v28, v29, v80
  v_max3_u32 v80, v30, v31, v80
  s_waitcnt vmcnt(4)
  v_mfma_f32_16x16x32_bf16 v[72:75], v[68:71], v[32:35], v[72:75]
  v_max3_u32 v80, v32, v33, v80
  v_max3_u32 v80, v34, v35, v80
  s_waitcnt vmcnt(3)
  v_mfma_f32_16x16x32_bf16 v[72:75], v[68:71], v[36:39], v[72:75]
  v_max3_u32 v80, v36, v37, v80
  v_max3_u32 v80, v38, v39, v80
  s_waitcnt vmcnt(2)
  v_mfma_f32_16x16x32_bf16 v[72:75], v[68:71], v[40:43], v[72:75]
  v_max3_u32 v80, v40, v41, v80
  v_max3_u32 v80, v42, v43, v80
  s_waitcnt vmcnt(1)
  v_mfma_f32_16x16x32_bf16 v[72:75], v[68:71], v[44:47], v[72:75]
  v_max3_u32 v80, v44, v45, v80
  v_max3_u32 v80, v46, v47, v80
  s_waitcnt vmcnt(0)
  v_mfma_f32_16x16x32_bf16 v[72:75], v[68:71], v[48:51], v[72:75]
  v_max3_u32 v80, v48, v49, v80
  v_max3_u32 v80, v50, v51, v80
  v_cmp_eq_u32 vcc, -1, v80
  s_cbranch_vccnz m_w_124
  v_lshlrev_b32 v3, 1, v3
  v_lshl_add_u32 v3, v2, 4, v3
  s_lshl_b32 s26, s17, 9
  s_add_u32 s26, s26, 159744
  v_add_u32 v3, s26, v3
  s_mov_b32 exec_hi, 0
  ds_write_b128 v3, v[72:75]
  s_mov_b32 exec_hi, -1
  v_lshlrev_b32 v3, 1, v0
  v_add_u32 v3, 159744, v3
  v_lshlrev_b32 v80, 16, v108
  v_and_b32 v81, 0xffff0000, v108
  v_lshlrev_b32 v82, 16, v109
  v_and_b32 v83, 0xffff0000, v109
  v_lshlrev_b32 v84, 16, v110
  v_and_b32 v85, 0xffff0000, v110
  v_lshlrev_b32 v86, 16, v111
  v_and_b32 v87, 0xffff0000, v111
  v_lshlrev_b32 v88, 16, v112
  v_and_b32 v89, 0xffff0000, v112
  v_lshlrev_b32 v90, 16, v113
  v_and_b32 v91, 0xffff0000, v113
  v_lshlrev_b32 v92, 16, v114
  v_and_b32 v93, 0xffff0000, v114
  v_lshlrev_b32 v94, 16, v115
  v_and_b32 v95, 0xffff0000, v115
  s_waitcnt lgkmcnt(0)
  s_barrier
  s_cmp_lg_u32 s17, 0
  s_cbranch_scc1 m_done_123
  ds_read_b128 v[72:75], v3
  ds_read_b128 v[76:79], v3 offset:16
  s_and_b32 s29, s58, 0xffff0000
  s_xor_b32 s27, s29, 0x80000000
  s_xor_b32 s28, s29, 0xffff0000
  s_bitcmp1_b32 s29, 31
  s_cselect_b32 s29, s27, s28
  v_mov_b32 v108, s29
  v_mul_f32 v108, 0xbfb8aa3b, v108
  v_exp_f32 v108, v108
  s_nop 0
  v_add_f32 v108, 1.0, v108
  v_rcp_f32 v108, v108
  s_nop 0
  v_cvt_pk_bf16_f32 v108, 0, v108
  s_waitcnt lgkmcnt(0)
  v_cvt_pk_bf16_f32 v72, 0, v72
  v_cvt_pk_bf16_f32 v73, 0, v73
  v_cvt_pk_bf16_f32 v74, 0, v74
  v_cvt_pk_bf16_f32 v75, 0, v75
  v_cvt_pk_bf16_f32 v76, 0, v76
  v_cvt_pk_bf16_f32 v77, 0, v77
  v_cvt_pk_bf16_f32 v78, 0, v78
  v_cvt_pk_bf16_f32 v79, 0, v79
  v_mul_f32 v72, v72, v108
  v_mul_f32 v73, v73, v108
  v_mul_f32 v74, v74, v108
  v_mul_f32 v75, v75, v108
  v_mul_f32 v76, v76, v108
  v_mul_f32 v77, v77, v108
  v_mul_f32 v78, v78, v108
  v_mul_f32 v79, v79, v108
  v_cvt_pk_bf16_f32 v72, 0, v72
  v_cvt_pk_bf16_f32 v73, 0, v73
  v_cvt_pk_bf16_f32 v74, 0, v74
  v_cvt_pk_bf16_f32 v75, 0, v75
  v_cvt_pk_bf16_f32 v76, 0, v76
  v_cvt_pk_bf16_f32 v77, 0, v77
  v_cvt_pk_bf16_f32 v78, 0, v78
  v_cvt_pk_bf16_f32 v79, 0, v79
  v_add_f32 v72, v72, v88
  v_add_f32 v73, v73, v89
  v_add_f32 v74, v74, v90
  v_add_f32 v75, v75, v91
  v_add_f32 v76, v76, v92
  v_add_f32 v77, v77, v93
  v_add_f32 v78, v78, v94
  v_add_f32 v79, v79, v95
  v_cvt_pk_bf16_f32 v72, 0, v72
  v_cvt_pk_bf16_f32 v73, 0, v73
  v_cvt_pk_bf16_f32 v74, 0, v74
  v_cvt_pk_bf16_f32 v75, 0, v75
  v_cvt_pk_bf16_f32 v76, 0, v76
  v_cvt_pk_bf16_f32 v77, 0, v77
  v_cvt_pk_bf16_f32 v78, 0, v78
  v_cvt_pk_bf16_f32 v79, 0, v79
  v_add_f32 v80, v80, v72
  v_add_f32 v81, v81, v73
  v_add_f32 v82, v82, v74
  v_add_f32 v83, v83, v75
  v_add_f32 v84, v84, v76
  v_add_f32 v85, v85, v77
  v_add_f32 v86, v86, v78
  v_add_f32 v87, v87, v79
  v_cvt_pk_bf16_f32 v112, v80, v81
  v_cvt_pk_bf16_f32 v113, v82, v83
  v_cvt_pk_bf16_f32 v114, v84, v85
  v_cvt_pk_bf16_f32 v115, v86, v87
  v_lshlrev_b32 v80, 16, v112
  v_and_b32 v81, 0xffff0000, v112
  v_lshlrev_b32 v82, 16, v113
  v_and_b32 v83, 0xffff0000, v113
  v_lshlrev_b32 v84, 16, v114
  v_and_b32 v85, 0xffff0000, v114
  v_lshlrev_b32 v86, 16, v115
  v_and_b32 v87, 0xffff0000, v115
  s_lshl_b32 s26, s59, 10
  buffer_store_dwordx4 v[112:115], v0, s[72:75], s26 offen sc1
m_done_123:
q_fail_98:
  s_endpgm
L_o:
  s_sub_u32 s60, s91, 3
  s_and_b32 s61, s90, 15
  s_load_dwordx2 s[80:81], s[0:1], 40
  s_load_dwordx2 s[72:73], s[0:1], 0
  s_mov_b32 s82, 4194304
  v_and_b32 v42, 63, v0
  v_and_b32 v40, 15, v42
  v_lshrrev_b32 v41, 4, v42
  v_lshlrev_b32 v1, 3, v42
  v_lshlrev_b32 v2, 2, v42
  v_lshlrev_b32 v0, 4, v42
  s_mov_b32 s24, 0x3e0293ee
  s_mov_b32 s44, 0x05040100
  s_mov_b32 s45, 0x07060302
  s_and_b32 s26, s17, 1
  s_lshl_b32 s26, s26, 4
  v_lshlrev_b32 v43, 2, v41
  v_sub_u32 v43, v40, v43
  v_add_u32 v43, s26, v43
  v_mov_b32 v7, 0xfe000000
  v_cmp_le_i32 vcc, 0, v43
  s_nop 1
  v_cndmask_b32 v24, v7, 0, vcc
  v_cmp_le_i32 vcc, 1, v43
  s_nop 1
  v_cndmask_b32 v25, v7, 0, vcc
  v_cmp_le_i32 vcc, 2, v43
  s_nop 1
  v_cndmask_b32 v26, v7, 0, vcc
  v_cmp_le_i32 vcc, 3, v43
  s_nop 1
  v_cndmask_b32 v27, v7, 0, vcc
  v_cmp_le_i32 vcc, 16, v43
  s_nop 1
  v_cndmask_b32 v28, v7, 0, vcc
  v_cmp_le_i32 vcc, 17, v43
  s_nop 1
  v_cndmask_b32 v29, v7, 0, vcc
  v_cmp_le_i32 vcc, 18, v43
  s_nop 1
  v_cndmask_b32 v30, v7, 0, vcc
  v_cmp_le_i32 vcc, 19, v43
  s_nop 1
  v_cndmask_b32 v31, v7, 0, vcc
  v_lshrrev_b32 v43, 5, v42
  v_lshlrev_b32 v43, 16, v43
  v_and_b32 v4, 1, v41
  v_lshl_add_u32 v43, v4, 14, v43
  v_lshl_add_u32 v43, v40, 4, v43
  s_lshl_b32 s26, s61, 10
  s_lshl_b32 s27, s17, 8
  s_add_u32 s26, s26, s27
  v_add_u32 v4, s26, v43
  v_lshlrev_b32 v43, 10, v41
  v_lshl_add_u32 v5, v40, 4, v43
  s_lshl_b32 s26, s17, 12
  v_add_u32 v6, s26, v0
  v_and_b32 v43, 1, v41
  v_lshlrev_b32 v43, 12, v43
  v_lshl_add_u32 v43, v40, 4, v43
  v_lshrrev_b32 v3, 1, v41
  v_lshl_add_u32 v3, v3, 8, v43
  s_lshr_b32 s26, s17, 1
  s_lshl_b32 s27, s26, 14
  s_add_u32 s27, s27, 16384
  v_add_u32 v32, s27, v0
  s_lshl_b32 s27, s26, 13
  s_and_b32 s28, s17, 1
  s_lshl_b32 s28, s28, 10
  s_add_u32 s28, s28, s27
  s_add_u32 s28, s28, 49152
  v_add_u32 v33, s28, v0
  s_add_u32 s27, s27, 65536
  v_add_u32 v34, s27, v0
  v_add_u32 v35, s27, v1
  v_and_b32 v36, 0xf0, v0
  v_and_b32 v252, 64, v0
  v_mov_b32 v248, 0
  v_lshlrev_b32 v255, 4, v0
  v_and_b32 v43, 1, v42
  v_xor_b32 v254, 1, v43
  s_lshl_b32 s26, s17, 3
  s_add_u32 s26, s26, 81920
  v_mov_b32 v39, s26
  s_mov_b32 vcc_lo, 0xaaaaaaaa
  s_mov_b32 vcc_hi, 0xaaaaaaaa
  v_mov_b32 v43, 0x3f80
  v_cndmask_b32 v43, v43, 1.0, vcc
  s_mov_b32 vcc_lo, 0xf000f
  s_mov_b32 vcc_hi, 0xf000f00
  v_cndmask_b32 v16, 0, v43, vcc
  v_cndmask_b32 v18, 0, v43, vcc
  s_mov_b32 vcc_lo, 0xf000f0
  s_mov_b32 vcc_hi, 0xf000f000
  v_cndmask_b32 v17, 0, v43, vcc
  v_cndmask_b32 v19, 0, v43, vcc
  s_mov_b32 vcc_lo, 0xcccccccc
  s_mov_b32 vcc_hi, 0xcccccccc
  v_mov_b32 v43, 0x4444
  v_mov_b32 v20, 0xeeee
  v_cndmask_b32 v20, v43, v20, vcc
  s_mov_b32 s70, 2097152
  s_mov_b32 s71, 0x20000
  s_mov_b32 s74, 2097152
  s_mov_b32 s75, 0x20000
  s_mov_b32 s10, 1024
  s_mov_b32 s83, 0x20000
  s_lshr_b32 s85, s17, 1
  s_lshl_b32 s26, s61, 1
  s_add_u32 s85, s85, s26
  s_add_u32 s43, s26, s17
  s_lshl_b32 s14, s61, 8
  s_lshl_b32 s15, s61, 7
  s_add_u32 s15, s15, 245104640
  s_add_u32 s14, s14, 244318208
  s_lshl_b32 s26, s61, 2
  s_add_u32 s26, s26, s17
  s_lshl_b32 s18, s26, 13
  s_add_u32 s18, s18, 41943040
  s_lshl_b32 s19, s26, 12
  s_add_u32 s19, s19, 142606336
  s_lshl_b32 s20, s85, 13
  s_add_u32 s20, s20, 192937984
  s_and_b32 s26, s17, 1
  s_mul_i32 s26, s26, 3072
  s_add_u32 s21, s20, s26
  s_lshr_b32 s40, s17, 1
  s_lshl_b32 s40, s40, 13
  s_add_u32 s40, s40, s26
  s_add_u32 s40, s40, 65536
  s_lshl_b32 s22, s17, 12
  s_add_u32 s22, s22, 49152
  s_lshl_b32 s23, s17, 13
  s_add_u32 s23, s23, 16384
  s_lshl_b32 s41, s60, 20
  s_add_u32 s41, s41, 12582912
  v_lshlrev_b32 v246, 3, v0
  s_mov_b32 s11, 0x20000
  s_waitcnt lgkmcnt(0)
  s_lshl_b32 s77, s60, 4
  s_add_u32 s77, s77, s61
  s_lshl_b32 s77, s77, 2
  s_add_u32 s77, s77, s17
  s_lshl_b32 s26, s77, 10
  buffer_load_dwordx4 v[176:179], v0, s[72:75], s26 offen
  s_add_u32 s26, s26, 262144
  buffer_load_dwordx4 v[180:183], v0, s[72:75], s26 offen
  s_add_u32 s26, s26, 262144
  buffer_load_dwordx4 v[184:187], v0, s[72:75], s26 offen
  s_add_u32 s26, s26, 262144
  buffer_load_dwordx4 v[188:191], v0, s[72:75], s26 offen
  s_add_u32 s26, s26, 262144
  buffer_load_dwordx4 v[192:195], v0, s[72:75], s26 offen
  s_add_u32 s26, s26, 262144
  buffer_load_dwordx4 v[196:199], v0, s[72:75], s26 offen
  s_add_u32 s26, s26, 262144
  buffer_load_dwordx4 v[200:203], v0, s[72:75], s26 offen
  s_add_u32 s26, s26, 262144
  buffer_load_dwordx4 v[204:207], v0, s[72:75], s26 offen
  s_add_u32 s26, s26, 262144
  v_lshrrev_b32 v44, 9, v0
  v_lshlrev_b32 v44, 12, v44
  v_and_b32 v45, 0xf0, v0
  v_add_u32 v44, v44, v45
  v_bfe_u32 v45, v0, 8, 1
  v_lshl_add_u32 v44, v45, 3, v44
  s_lshl_b32 s30, s61, 18
  s_lshl_b32 s27, s17, 8
  s_add_u32 s30, s30, s27
  s_add_u32 s27, s30, 0
  buffer_load_dwordx2 v[64:65], v44, s[80:83], s27 offen
  s_add_u32 s27, s30, 1024
  buffer_load_dwordx2 v[66:67], v44, s[80:83], s27 offen
  s_add_u32 s27, s30, 2048
  buffer_load_dwordx2 v[68:69], v44, s[80:83], s27 offen
  s_add_u32 s27, s30, 3072
  buffer_load_dwordx2 v[70:71], v44, s[80:83], s27 offen
  s_add_u32 s27, s30, 16384
  buffer_load_dwordx2 v[72:73], v44, s[80:83], s27 offen
  s_add_u32 s27, s30, 17408
  buffer_load_dwordx2 v[74:75], v44, s[80:83], s27 offen
  s_add_u32 s27, s30, 18432
  buffer_load_dwordx2 v[76:77], v44, s[80:83], s27 offen
  s_add_u32 s27, s30, 19456
  buffer_load_dwordx2 v[78:79], v44, s[80:83], s27 offen
  s_add_u32 s27, s30, 8192
  buffer_load_dwordx2 v[80:81], v44, s[80:83], s27 offen
  s_add_u32 s27, s30, 9216
  buffer_load_dwordx2 v[82:83], v44, s[80:83], s27 offen
  s_add_u32 s27, s30, 10240
  buffer_load_dwordx2 v[84:85], v44, s[80:83], s27 offen
  s_add_u32 s27, s30, 11264
  buffer_load_dwordx2 v[86:87], v44, s[80:83], s27 offen
  s_add_u32 s27, s30, 24576
  buffer_load_dwordx2 v[88:89], v44, s[80:83], s27 offen
  s_add_u32 s27, s30, 25600
  buffer_load_dwordx2 v[90:91], v44, s[80:83], s27 offen
  s_add_u32 s27, s30, 26624
  buffer_load_dwordx2 v[92:93], v44, s[80:83], s27 offen
  s_add_u32 s27, s30, 27648
  buffer_load_dwordx2 v[94:95], v44, s[80:83], s27 offen
  s_add_u32 s27, s30, 32768
  buffer_load_dwordx2 v[96:97], v44, s[80:83], s27 offen
  s_add_u32 s27, s30, 33792
  buffer_load_dwordx2 v[98:99], v44, s[80:83], s27 offen
  s_add_u32 s27, s30, 34816
  buffer_load_dwordx2 v[100:101], v44, s[80:83], s27 offen
  s_add_u32 s27, s30, 35840
  buffer_load_dwordx2 v[102:103], v44, s[80:83], s27 offen
  s_add_u32 s27, s30, 49152
  buffer_load_dwordx2 v[104:105], v44, s[80:83], s27 offen
  s_add_u32 s27, s30, 50176
  buffer_load_dwordx2 v[106:107], v44, s[80:83], s27 offen
  s_add_u32 s27, s30, 51200
  buffer_load_dwordx2 v[108:109], v44, s[80:83], s27 offen
  s_add_u32 s27, s30, 52224
  buffer_load_dwordx2 v[110:111], v44, s[80:83], s27 offen
  s_add_u32 s27, s30, 40960
  buffer_load_dwordx2 v[112:113], v44, s[80:83], s27 offen
  s_add_u32 s27, s30, 41984
  buffer_load_dwordx2 v[114:115], v44, s[80:83], s27 offen
  s_add_u32 s27, s30, 43008
  buffer_load_dwordx2 v[116:117], v44, s[80:83], s27 offen
  s_add_u32 s27, s30, 44032
  buffer_load_dwordx2 v[118:119], v44, s[80:83], s27 offen
  s_add_u32 s27, s30, 57344
  buffer_load_dwordx2 v[120:121], v44, s[80:83], s27 offen
  s_add_u32 s27, s30, 58368
  buffer_load_dwordx2 v[122:123], v44, s[80:83], s27 offen
  s_add_u32 s27, s30, 59392
  buffer_load_dwordx2 v[124:125], v44, s[80:83], s27 offen
  s_add_u32 s27, s30, 60416
  buffer_load_dwordx2 v[126:127], v44, s[80:83], s27 offen
  s_load_dwordx2 s[4:5], s[0:1], 112
  s_load_dwordx2 s[12:13], s[0:1], 104
  s_load_dwordx2 s[68:69], s[0:1], 96
  s_load_dwordx2 s[8:9], s[0:1], 64
  s_waitcnt lgkmcnt(0)
  buffer_load_dwordx4 v[56:59], v0, s[8:11], 0 offen
  s_lshl_b32 s29, s77, 10
  s_add_u32 s29, s29, 6291456
  s_cmp_lt_u32 s60, 4
  s_cbranch_scc1 o_s1_125
  s_waitcnt vmcnt(0)
  s_branch o_s2_126
o_s1_125:
  s_waitcnt vmcnt(40)
  v_lshlrev_b32 v212, 16, v176
  v_and_b32 v213, 0xffff0000, v176
  v_lshlrev_b32 v214, 16, v177
  v_and_b32 v215, 0xffff0000, v177
  v_lshlrev_b32 v216, 16, v178
  v_and_b32 v217, 0xffff0000, v178
  v_lshlrev_b32 v218, 16, v179
  v_and_b32 v219, 0xffff0000, v179
  v_add_f32 v220, v212, v213
  v_add_f32 v221, v214, v215
  v_add_f32 v222, v216, v217
  v_add_f32 v223, v218, v219
  v_add_f32 v220, v220, v221
  v_add_f32 v222, v222, v223
  v_add_f32 v220, v220, v222
  s_nop 1
  v_add_f32_dpp v220, v220, v220 row_ror:8 row_mask:0xf bank_mask:0xf
  s_nop 1
  v_add_f32_dpp v220, v220, v220 row_ror:4 row_mask:0xf bank_mask:0xf
  s_nop 1
  v_add_f32_dpp v220, v220, v220 row_ror:2 row_mask:0xf bank_mask:0xf
  s_nop 1
  v_add_f32_dpp v220, v220, v220 row_ror:1 row_mask:0xf bank_mask:0xf
  v_mov_b32 v222, v220
  s_nop 0
  s_nop 0
  v_permlane16_swap_b32 v220, v222
  v_add_f32 v220, v220, v222
  v_mov_b32 v222, v220
  s_nop 0
  s_nop 0
  v_permlane32_swap_b32 v220, v222
  v_add_f32 v220, v220, v222
  v_mul_f32 v220, 0x3b000000, v220
  v_sub_f32 v224, v212, v220
  v_sub_f32 v225, v213, v220
  v_sub_f32 v226, v214, v220
  v_sub_f32 v227, v215, v220
  v_sub_f32 v228, v216, v220
  v_sub_f32 v229, v217, v220
  v_sub_f32 v230, v218, v220
  v_sub_f32 v231, v219, v220
  v_mul_f32 v221, v224, v224
  v_mul_f32 v222, v225, v225
  v_fmac_f32 v221, v226, v226
  v_fmac_f32 v222, v227, v227
  v_fmac_f32 v221, v228, v228
  v_fmac_f32 v222, v229, v229
  v_fmac_f32 v221, v230, v230
  v_fmac_f32 v222, v231, v231
  v_add_f32 v221, v221, v222
  v_cvt_pk_bf16_f32 v220, 0, v220
  s_nop 0
  v_add_f32_dpp v221, v221, v221 row_ror:8 row_mask:0xf bank_mask:0xf
  v_sub_f32 v224, v212, v220
  v_sub_f32 v225, v213, v220
  v_add_f32_dpp v221, v221, v221 row_ror:4 row_mask:0xf bank_mask:0xf
  v_sub_f32 v226, v214, v220
  v_sub_f32 v227, v215, v220
  v_add_f32_dpp v221, v221, v221 row_ror:2 row_mask:0xf bank_mask:0xf
  v_sub_f32 v228, v216, v220
  v_sub_f32 v229, v217, v220
  v_add_f32_dpp v221, v221, v221 row_ror:1 row_mask:0xf bank_mask:0xf
  v_sub_f32 v230, v218, v220
  v_sub_f32 v231, v219, v220
  v_mov_b32 v222, v221
  v_cvt_pk_bf16_f32 v224, 0, v224
  v_cvt_pk_bf16_f32 v225, 0, v225
  v_permlane16_swap_b32 v221, v222
  v_cvt_pk_bf16_f32 v226, 0, v226
  v_cvt_pk_bf16_f32 v227, 0, v227
  v_add_f32 v221, v221, v222
  v_cvt_pk_bf16_f32 v228, 0, v228
  v_cvt_pk_bf16_f32 v229, 0, v229
  v_mov_b32 v222, v221
  v_cvt_pk_bf16_f32 v230, 0, v230
  v_cvt_pk_bf16_f32 v231, 0, v231
  v_permlane32_swap_b32 v221, v222
  v_add_f32 v221, v221, v222
  v_mul_f32 v221, 0x3b000000, v221
  v_cvt_pk_bf16_f32 v221, 0, v221
  v_add_f32 v221, 0x3727c5ac, v221
  v_cvt_pk_bf16_f32 v221, 0, v221
  v_sqrt_f32 v221, v221
  s_nop 0
  v_cvt_pk_bf16_f32 v221, 0, v221
  v_rcp_f32 v221, v221
  s_nop 0
  v_mul_f32 v224, v224, v221
  v_mul_f32 v225, v225, v221
  v_mul_f32 v226, v226, v221
  v_mul_f32 v227, v227, v221
  v_mul_f32 v228, v228, v221
  v_mul_f32 v229, v229, v221
  v_mul_f32 v230, v230, v221
  v_mul_f32 v231, v231, v221
  v_cvt_pk_bf16_f32 v176, v224, v225
  v_cvt_pk_bf16_f32 v177, v226, v227
  v_cvt_pk_bf16_f32 v178, v228, v229
  v_cvt_pk_bf16_f32 v179, v230, v231
  buffer_store_dwordx4 v[176:179], v0, s[4:7], s29 offen sc1
  s_add_u32 s29, s29, 262144
  s_waitcnt vmcnt(40)
  v_lshlrev_b32 v212, 16, v180
  v_and_b32 v213, 0xffff0000, v180
  v_lshlrev_b32 v214, 16, v181
  v_and_b32 v215, 0xffff0000, v181
  v_lshlrev_b32 v216, 16, v182
  v_and_b32 v217, 0xffff0000, v182
  v_lshlrev_b32 v218, 16, v183
  v_and_b32 v219, 0xffff0000, v183
  v_add_f32 v220, v212, v213
  v_add_f32 v221, v214, v215
  v_add_f32 v222, v216, v217
  v_add_f32 v223, v218, v219
  v_add_f32 v220, v220, v221
  v_add_f32 v222, v222, v223
  v_add_f32 v220, v220, v222
  s_nop 1
  v_add_f32_dpp v220, v220, v220 row_ror:8 row_mask:0xf bank_mask:0xf
  s_nop 1
  v_add_f32_dpp v220, v220, v220 row_ror:4 row_mask:0xf bank_mask:0xf
  s_nop 1
  v_add_f32_dpp v220, v220, v220 row_ror:2 row_mask:0xf bank_mask:0xf
  s_nop 1
  v_add_f32_dpp v220, v220, v220 row_ror:1 row_mask:0xf bank_mask:0xf
  v_mov_b32 v222, v220
  s_nop 0
  s_nop 0
  v_permlane16_swap_b32 v220, v222
  v_add_f32 v220, v220, v222
  v_mov_b32 v222, v220
  s_nop 0
  s_nop 0
  v_permlane32_swap_b32 v220, v222
  v_add_f32 v220, v220, v222
  v_mul_f32 v220, 0x3b000000, v220
  v_sub_f32 v224, v212, v220
  v_sub_f32 v225, v213, v220
  v_sub_f32 v226, v214, v220
  v_sub_f32 v227, v215, v220
  v_sub_f32 v228, v216, v220
  v_sub_f32 v229, v217, v220
  v_sub_f32 v230, v218, v220
  v_sub_f32 v231, v219, v220
  v_mul_f32 v221, v224, v224
  v_mul_f32 v222, v225, v225
  v_fmac_f32 v221, v226, v226
  v_fmac_f32 v222, v227, v227
  v_fmac_f32 v221, v228, v228
  v_fmac_f32 v222, v229, v229
  v_fmac_f32 v221, v230, v230
  v_fmac_f32 v222, v231, v231
  v_add_f32 v221, v221, v222
  v_cvt_pk_bf16_f32 v220, 0, v220
  s_nop 0
  v_add_f32_dpp v221, v221, v221 row_ror:8 row_mask:0xf bank_mask:0xf
  v_sub_f32 v224, v212, v220
  v_sub_f32 v225, v213, v220
  v_add_f32_dpp v221, v221, v221 row_ror:4 row_mask:0xf bank_mask:0xf
  v_sub_f32 v226, v214, v220
  v_sub_f32 v227, v215, v220
  v_add_f32_dpp v221, v221, v221 row_ror:2 row_mask:0xf bank_mask:0xf
  v_sub_f32 v228, v216, v220
  v_sub_f32 v229, v217, v220
  v_add_f32_dpp v221, v221, v221 row_ror:1 row_mask:0xf bank_mask:0xf
  v_sub_f32 v230, v218, v220
  v_sub_f32 v231, v219, v220
  v_mov_b32 v222, v221
  v_cvt_pk_bf16_f32 v224, 0, v224
  v_cvt_pk_bf16_f32 v225, 0, v225
  v_permlane16_swap_b32 v221, v222
  v_cvt_pk_bf16_f32 v226, 0, v226
  v_cvt_pk_bf16_f32 v227, 0, v227
  v_add_f32 v221, v221, v222
  v_cvt_pk_bf16_f32 v228, 0, v228
  v_cvt_pk_bf16_f32 v229, 0, v229
  v_mov_b32 v222, v221
  v_cvt_pk_bf16_f32 v230, 0, v230
  v_cvt_pk_bf16_f32 v231, 0, v231
  v_permlane32_swap_b32 v221, v222
  v_add_f32 v221, v221, v222
  v_mul_f32 v221, 0x3b000000, v221
  v_cvt_pk_bf16_f32 v221, 0, v221
  v_add_f32 v221, 0x3727c5ac, v221
  v_cvt_pk_bf16_f32 v221, 0, v221
  v_sqrt_f32 v221, v221
  s_nop 0
  v_cvt_pk_bf16_f32 v221, 0, v221
  v_rcp_f32 v221, v221
  s_nop 0
  v_mul_f32 v224, v224, v221
  v_mul_f32 v225, v225, v221
  v_mul_f32 v226, v226, v221
  v_mul_f32 v227, v227, v221
  v_mul_f32 v228, v228, v221
  v_mul_f32 v229, v229, v221
  v_mul_f32 v230, v230, v221
  v_mul_f32 v231, v231, v221
  v_cvt_pk_bf16_f32 v180, v224, v225
  v_cvt_pk_bf16_f32 v181, v226, v227
  v_cvt_pk_bf16_f32 v182, v228, v229
  v_cvt_pk_bf16_f32 v183, v230, v231
  buffer_store_dwordx4 v[180:183], v0, s[4:7], s29 offen sc1
  s_add_u32 s29, s29, 262144
  s_waitcnt vmcnt(40)
  v_lshlrev_b32 v212, 16, v184
  v_and_b32 v213, 0xffff0000, v184
  v_lshlrev_b32 v214, 16, v185
  v_and_b32 v215, 0xffff0000, v185
  v_lshlrev_b32 v216, 16, v186
  v_and_b32 v217, 0xffff0000, v186
  v_lshlrev_b32 v218, 16, v187
  v_and_b32 v219, 0xffff0000, v187
  v_add_f32 v220, v212, v213
  v_add_f32 v221, v214, v215
  v_add_f32 v222, v216, v217
  v_add_f32 v223, v218, v219
  v_add_f32 v220, v220, v221
  v_add_f32 v222, v222, v223
  v_add_f32 v220, v220, v222
  s_nop 1
  v_add_f32_dpp v220, v220, v220 row_ror:8 row_mask:0xf bank_mask:0xf
  s_nop 1
  v_add_f32_dpp v220, v220, v220 row_ror:4 row_mask:0xf bank_mask:0xf
  s_nop 1
  v_add_f32_dpp v220, v220, v220 row_ror:2 row_mask:0xf bank_mask:0xf
  s_nop 1
  v_add_f32_dpp v220, v220, v220 row_ror:1 row_mask:0xf bank_mask:0xf
  v_mov_b32 v222, v220
  s_nop 0
  s_nop 0
  v_permlane16_swap_b32 v220, v222
  v_add_f32 v220, v220, v222
  v_mov_b32 v222, v220
  s_nop 0
  s_nop 0
  v_permlane32_swap_b32 v220, v222
  v_add_f32 v220, v220, v222
  v_mul_f32 v220, 0x3b000000, v220
  v_sub_f32 v224, v212, v220
  v_sub_f32 v225, v213, v220
  v_sub_f32 v226, v214, v220
  v_sub_f32 v227, v215, v220
  v_sub_f32 v228, v216, v220
  v_sub_f32 v229, v217, v220
  v_sub_f32 v230, v218, v220
  v_sub_f32 v231, v219, v220
  v_mul_f32 v221, v224, v224
  v_mul_f32 v222, v225, v225
  v_fmac_f32 v221, v226, v226
  v_fmac_f32 v222, v227, v227
  v_fmac_f32 v221, v228, v228
  v_fmac_f32 v222, v229, v229
  v_fmac_f32 v221, v230, v230
  v_fmac_f32 v222, v231, v231
  v_add_f32 v221, v221, v222
  v_cvt_pk_bf16_f32 v220, 0, v220
  s_nop 0
  v_add_f32_dpp v221, v221, v221 row_ror:8 row_mask:0xf bank_mask:0xf
  v_sub_f32 v224, v212, v220
  v_sub_f32 v225, v213, v220
  v_add_f32_dpp v221, v221, v221 row_ror:4 row_mask:0xf bank_mask:0xf
  v_sub_f32 v226, v214, v220
  v_sub_f32 v227, v215, v220
  v_add_f32_dpp v221, v221, v221 row_ror:2 row_mask:0xf bank_mask:0xf
  v_sub_f32 v228, v216, v220
  v_sub_f32 v229, v217, v220
  v_add_f32_dpp v221, v221, v221 row_ror:1 row_mask:0xf bank_mask:0xf
  v_sub_f32 v230, v218, v220
  v_sub_f32 v231, v219, v220
  v_mov_b32 v222, v221
  v_cvt_pk_bf16_f32 v224, 0, v224
  v_cvt_pk_bf16_f32 v225, 0, v225
  v_permlane16_swap_b32 v221, v222
  v_cvt_pk_bf16_f32 v226, 0, v226
  v_cvt_pk_bf16_f32 v227, 0, v227
  v_add_f32 v221, v221, v222
  v_cvt_pk_bf16_f32 v228, 0, v228
  v_cvt_pk_bf16_f32 v229, 0, v229
  v_mov_b32 v222, v221
  v_cvt_pk_bf16_f32 v230, 0, v230
  v_cvt_pk_bf16_f32 v231, 0, v231
  v_permlane32_swap_b32 v221, v222
  v_add_f32 v221, v221, v222
  v_mul_f32 v221, 0x3b000000, v221
  v_cvt_pk_bf16_f32 v221, 0, v221
  v_add_f32 v221, 0x3727c5ac, v221
  v_cvt_pk_bf16_f32 v221, 0, v221
  v_sqrt_f32 v221, v221
  s_nop 0
  v_cvt_pk_bf16_f32 v221, 0, v221
  v_rcp_f32 v221, v221
  s_nop 0
  v_mul_f32 v224, v224, v221
  v_mul_f32 v225, v225, v221
  v_mul_f32 v226, v226, v221
  v_mul_f32 v227, v227, v221
  v_mul_f32 v228, v228, v221
  v_mul_f32 v229, v229, v221
  v_mul_f32 v230, v230, v221
  v_mul_f32 v231, v231, v221
  v_cvt_pk_bf16_f32 v184, v224, v225
  v_cvt_pk_bf16_f32 v185, v226, v227
  v_cvt_pk_bf16_f32 v186, v228, v229
  v_cvt_pk_bf16_f32 v187, v230, v231
  buffer_store_dwordx4 v[184:187], v0, s[4:7], s29 offen sc1
  s_add_u32 s29, s29, 262144
  s_waitcnt vmcnt(40)
  v_lshlrev_b32 v212, 16, v188
  v_and_b32 v213, 0xffff0000, v188
  v_lshlrev_b32 v214, 16, v189
  v_and_b32 v215, 0xffff0000, v189
  v_lshlrev_b32 v216, 16, v190
  v_and_b32 v217, 0xffff0000, v190
  v_lshlrev_b32 v218, 16, v191
  v_and_b32 v219, 0xffff0000, v191
  v_add_f32 v220, v212, v213
  v_add_f32 v221, v214, v215
  v_add_f32 v222, v216, v217
  v_add_f32 v223, v218, v219
  v_add_f32 v220, v220, v221
  v_add_f32 v222, v222, v223
  v_add_f32 v220, v220, v222
  s_nop 1
  v_add_f32_dpp v220, v220, v220 row_ror:8 row_mask:0xf bank_mask:0xf
  s_nop 1
  v_add_f32_dpp v220, v220, v220 row_ror:4 row_mask:0xf bank_mask:0xf
  s_nop 1
  v_add_f32_dpp v220, v220, v220 row_ror:2 row_mask:0xf bank_mask:0xf
  s_nop 1
  v_add_f32_dpp v220, v220, v220 row_ror:1 row_mask:0xf bank_mask:0xf
  v_mov_b32 v222, v220
  s_nop 0
  s_nop 0
  v_permlane16_swap_b32 v220, v222
  v_add_f32 v220, v220, v222
  v_mov_b32 v222, v220
  s_nop 0
  s_nop 0
  v_permlane32_swap_b32 v220, v222
  v_add_f32 v220, v220, v222
  v_mul_f32 v220, 0x3b000000, v220
  v_sub_f32 v224, v212, v220
  v_sub_f32 v225, v213, v220
  v_sub_f32 v226, v214, v220
  v_sub_f32 v227, v215, v220
  v_sub_f32 v228, v216, v220
  v_sub_f32 v229, v217, v220
  v_sub_f32 v230, v218, v220
  v_sub_f32 v231, v219, v220
  v_mul_f32 v221, v224, v224
  v_mul_f32 v222, v225, v225
  v_fmac_f32 v221, v226, v226
  v_fmac_f32 v222, v227, v227
  v_fmac_f32 v221, v228, v228
  v_fmac_f32 v222, v229, v229
  v_fmac_f32 v221, v230, v230
  v_fmac_f32 v222, v231, v231
  v_add_f32 v221, v221, v222
  v_cvt_pk_bf16_f32 v220, 0, v220
  s_nop 0
  v_add_f32_dpp v221, v221, v221 row_ror:8 row_mask:0xf bank_mask:0xf
  v_sub_f32 v224, v212, v220
  v_sub_f32 v225, v213, v220
  v_add_f32_dpp v221, v221, v221 row_ror:4 row_mask:0xf bank_mask:0xf
  v_sub_f32 v226, v214, v220
  v_sub_f32 v227, v215, v220
  v_add_f32_dpp v221, v221, v221 row_ror:2 row_mask:0xf bank_mask:0xf
  v_sub_f32 v228, v216, v220
  v_sub_f32 v229, v217, v220
  v_add_f32_dpp v221, v221, v221 row_ror:1 row_mask:0xf bank_mask:0xf
  v_sub_f32 v230, v218, v220
  v_sub_f32 v231, v219, v220
  v_mov_b32 v222, v221
  v_cvt_pk_bf16_f32 v224, 0, v224
  v_cvt_pk_bf16_f32 v225, 0, v225
  v_permlane16_swap_b32 v221, v222
  v_cvt_pk_bf16_f32 v226, 0, v226
  v_cvt_pk_bf16_f32 v227, 0, v227
  v_add_f32 v221, v221, v222
  v_cvt_pk_bf16_f32 v228, 0, v228
  v_cvt_pk_bf16_f32 v229, 0, v229
  v_mov_b32 v222, v221
  v_cvt_pk_bf16_f32 v230, 0, v230
  v_cvt_pk_bf16_f32 v231, 0, v231
  v_permlane32_swap_b32 v221, v222
  v_add_f32 v221, v221, v222
  v_mul_f32 v221, 0x3b000000, v221
  v_cvt_pk_bf16_f32 v221, 0, v221
  v_add_f32 v221, 0x3727c5ac, v221
  v_cvt_pk_bf16_f32 v221, 0, v221
  v_sqrt_f32 v221, v221
  s_nop 0
  v_cvt_pk_bf16_f32 v221, 0, v221
  v_rcp_f32 v221, v221
  s_nop 0
  v_mul_f32 v224, v224, v221
  v_mul_f32 v225, v225, v221
  v_mul_f32 v226, v226, v221
  v_mul_f32 v227, v227, v221
  v_mul_f32 v228, v228, v221
  v_mul_f32 v229, v229, v221
  v_mul_f32 v230, v230, v221
  v_mul_f32 v231, v231, v221
  v_cvt_pk_bf16_f32 v188, v224, v225
  v_cvt_pk_bf16_f32 v189, v226, v227
  v_cvt_pk_bf16_f32 v190, v228, v229
  v_cvt_pk_bf16_f32 v191, v230, v231
  buffer_store_dwordx4 v[188:191], v0, s[4:7], s29 offen sc1
  s_add_u32 s29, s29, 262144
  s_waitcnt vmcnt(40)
  v_lshlrev_b32 v212, 16, v192
  v_and_b32 v213, 0xffff0000, v192
  v_lshlrev_b32 v214, 16, v193
  v_and_b32 v215, 0xffff0000, v193
  v_lshlrev_b32 v216, 16, v194
  v_and_b32 v217, 0xffff0000, v194
  v_lshlrev_b32 v218, 16, v195
  v_and_b32 v219, 0xffff0000, v195
  v_add_f32 v220, v212, v213
  v_add_f32 v221, v214, v215
  v_add_f32 v222, v216, v217
  v_add_f32 v223, v218, v219
  v_add_f32 v220, v220, v221
  v_add_f32 v222, v222, v223
  v_add_f32 v220, v220, v222
  s_nop 1
  v_add_f32_dpp v220, v220, v220 row_ror:8 row_mask:0xf bank_mask:0xf
  s_nop 1
  v_add_f32_dpp v220, v220, v220 row_ror:4 row_mask:0xf bank_mask:0xf
  s_nop 1
  v_add_f32_dpp v220, v220, v220 row_ror:2 row_mask:0xf bank_mask:0xf
  s_nop 1
  v_add_f32_dpp v220, v220, v220 row_ror:1 row_mask:0xf bank_mask:0xf
  v_mov_b32 v222, v220
  s_nop 0
  s_nop 0
  v_permlane16_swap_b32 v220, v222
  v_add_f32 v220, v220, v222
  v_mov_b32 v222, v220
  s_nop 0
  s_nop 0
  v_permlane32_swap_b32 v220, v222
  v_add_f32 v220, v220, v222
  v_mul_f32 v220, 0x3b000000, v220
  v_sub_f32 v224, v212, v220
  v_sub_f32 v225, v213, v220
  v_sub_f32 v226, v214, v220
  v_sub_f32 v227, v215, v220
  v_sub_f32 v228, v216, v220
  v_sub_f32 v229, v217, v220
  v_sub_f32 v230, v218, v220
  v_sub_f32 v231, v219, v220
  v_mul_f32 v221, v224, v224
  v_mul_f32 v222, v225, v225
  v_fmac_f32 v221, v226, v226
  v_fmac_f32 v222, v227, v227
  v_fmac_f32 v221, v228, v228
  v_fmac_f32 v222, v229, v229
  v_fmac_f32 v221, v230, v230
  v_fmac_f32 v222, v231, v231
  v_add_f32 v221, v221, v222
  v_cvt_pk_bf16_f32 v220, 0, v220
  s_nop 0
  v_add_f32_dpp v221, v221, v221 row_ror:8 row_mask:0xf bank_mask:0xf
  v_sub_f32 v224, v212, v220
  v_sub_f32 v225, v213, v220
  v_add_f32_dpp v221, v221, v221 row_ror:4 row_mask:0xf bank_mask:0xf
  v_sub_f32 v226, v214, v220
  v_sub_f32 v227, v215, v220
  v_add_f32_dpp v221, v221, v221 row_ror:2 row_mask:0xf bank_mask:0xf
  v_sub_f32 v228, v216, v220
  v_sub_f32 v229, v217, v220
  v_add_f32_dpp v221, v221, v221 row_ror:1 row_mask:0xf bank_mask:0xf
  v_sub_f32 v230, v218, v220
  v_sub_f32 v231, v219, v220
  v_mov_b32 v222, v221
  v_cvt_pk_bf16_f32 v224, 0, v224
  v_cvt_pk_bf16_f32 v225, 0, v225
  v_permlane16_swap_b32 v221, v222
  v_cvt_pk_bf16_f32 v226, 0, v226
  v_cvt_pk_bf16_f32 v227, 0, v227
  v_add_f32 v221, v221, v222
  v_cvt_pk_bf16_f32 v228, 0, v228
  v_cvt_pk_bf16_f32 v229, 0, v229
  v_mov_b32 v222, v221
  v_cvt_pk_bf16_f32 v230, 0, v230
  v_cvt_pk_bf16_f32 v231, 0, v231
  v_permlane32_swap_b32 v221, v222
  v_add_f32 v221, v221, v222
  v_mul_f32 v221, 0x3b000000, v221
  v_cvt_pk_bf16_f32 v221, 0, v221
  v_add_f32 v221, 0x3727c5ac, v221
  v_cvt_pk_bf16_f32 v221, 0, v221
  v_sqrt_f32 v221, v221
  s_nop 0
  v_cvt_pk_bf16_f32 v221, 0, v221
  v_rcp_f32 v221, v221
  s_nop 0
  v_mul_f32 v224, v224, v221
  v_mul_f32 v225, v225, v221
  v_mul_f32 v226, v226, v221
  v_mul_f32 v227, v227, v221
  v_mul_f32 v228, v228, v221
  v_mul_f32 v229, v229, v221
  v_mul_f32 v230, v230, v221
  v_mul_f32 v231, v231, v221
  v_cvt_pk_bf16_f32 v192, v224, v225
  v_cvt_pk_bf16_f32 v193, v226, v227
  v_cvt_pk_bf16_f32 v194, v228, v229
  v_cvt_pk_bf16_f32 v195, v230, v231
  buffer_store_dwordx4 v[192:195], v0, s[4:7], s29 offen sc1
  s_add_u32 s29, s29, 262144
  s_waitcnt vmcnt(40)
  v_lshlrev_b32 v212, 16, v196
  v_and_b32 v213, 0xffff0000, v196
  v_lshlrev_b32 v214, 16, v197
  v_and_b32 v215, 0xffff0000, v197
  v_lshlrev_b32 v216, 16, v198
  v_and_b32 v217, 0xffff0000, v198
  v_lshlrev_b32 v218, 16, v199
  v_and_b32 v219, 0xffff0000, v199
  v_add_f32 v220, v212, v213
  v_add_f32 v221, v214, v215
  v_add_f32 v222, v216, v217
  v_add_f32 v223, v218, v219
  v_add_f32 v220, v220, v221
  v_add_f32 v222, v222, v223
  v_add_f32 v220, v220, v222
  s_nop 1
  v_add_f32_dpp v220, v220, v220 row_ror:8 row_mask:0xf bank_mask:0xf
  s_nop 1
  v_add_f32_dpp v220, v220, v220 row_ror:4 row_mask:0xf bank_mask:0xf
  s_nop 1
  v_add_f32_dpp v220, v220, v220 row_ror:2 row_mask:0xf bank_mask:0xf
  s_nop 1
  v_add_f32_dpp v220, v220, v220 row_ror:1 row_mask:0xf bank_mask:0xf
  v_mov_b32 v222, v220
  s_nop 0
  s_nop 0
  v_permlane16_swap_b32 v220, v222
  v_add_f32 v220, v220, v222
  v_mov_b32 v222, v220
  s_nop 0
  s_nop 0
  v_permlane32_swap_b32 v220, v222
  v_add_f32 v220, v220, v222
  v_mul_f32 v220, 0x3b000000, v220
  v_sub_f32 v224, v212, v220
  v_sub_f32 v225, v213, v220
  v_sub_f32 v226, v214, v220
  v_sub_f32 v227, v215, v220
  v_sub_f32 v228, v216, v220
  v_sub_f32 v229, v217, v220
  v_sub_f32 v230, v218, v220
  v_sub_f32 v231, v219, v220
  v_mul_f32 v221, v224, v224
  v_mul_f32 v222, v225, v225
  v_fmac_f32 v221, v226, v226
  v_fmac_f32 v222, v227, v227
  v_fmac_f32 v221, v228, v228
  v_fmac_f32 v222, v229, v229
  v_fmac_f32 v221, v230, v230
  v_fmac_f32 v222, v231, v231
  v_add_f32 v221, v221, v222
  v_cvt_pk_bf16_f32 v220, 0, v220
  s_nop 0
  v_add_f32_dpp v221, v221, v221 row_ror:8 row_mask:0xf bank_mask:0xf
  v_sub_f32 v224, v212, v220
  v_sub_f32 v225, v213, v220
  v_add_f32_dpp v221, v221, v221 row_ror:4 row_mask:0xf bank_mask:0xf
  v_sub_f32 v226, v214, v220
  v_sub_f32 v227, v215, v220
  v_add_f32_dpp v221, v221, v221 row_ror:2 row_mask:0xf bank_mask:0xf
  v_sub_f32 v228, v216, v220
  v_sub_f32 v229, v217, v220
  v_add_f32_dpp v221, v221, v221 row_ror:1 row_mask:0xf bank_mask:0xf
  v_sub_f32 v230, v218, v220
  v_sub_f32 v231, v219, v220
  v_mov_b32 v222, v221
  v_cvt_pk_bf16_f32 v224, 0, v224
  v_cvt_pk_bf16_f32 v225, 0, v225
  v_permlane16_swap_b32 v221, v222
  v_cvt_pk_bf16_f32 v226, 0, v226
  v_cvt_pk_bf16_f32 v227, 0, v227
  v_add_f32 v221, v221, v222
  v_cvt_pk_bf16_f32 v228, 0, v228
  v_cvt_pk_bf16_f32 v229, 0, v229
  v_mov_b32 v222, v221
  v_cvt_pk_bf16_f32 v230, 0, v230
  v_cvt_pk_bf16_f32 v231, 0, v231
  v_permlane32_swap_b32 v221, v222
  v_add_f32 v221, v221, v222
  v_mul_f32 v221, 0x3b000000, v221
  v_cvt_pk_bf16_f32 v221, 0, v221
  v_add_f32 v221, 0x3727c5ac, v221
  v_cvt_pk_bf16_f32 v221, 0, v221
  v_sqrt_f32 v221, v221
  s_nop 0
  v_cvt_pk_bf16_f32 v221, 0, v221
  v_rcp_f32 v221, v221
  s_nop 0
  v_mul_f32 v224, v224, v221
  v_mul_f32 v225, v225, v221
  v_mul_f32 v226, v226, v221
  v_mul_f32 v227, v227, v221
  v_mul_f32 v228, v228, v221
  v_mul_f32 v229, v229, v221
  v_mul_f32 v230, v230, v221
  v_mul_f32 v231, v231, v221
  v_cvt_pk_bf16_f32 v196, v224, v225
  v_cvt_pk_bf16_f32 v197, v226, v227
  v_cvt_pk_bf16_f32 v198, v228, v229
  v_cvt_pk_bf16_f32 v199, v230, v231
  buffer_store_dwordx4 v[196:199], v0, s[4:7], s29 offen sc1
  s_add_u32 s29, s29, 262144
  s_waitcnt vmcnt(40)
  v_lshlrev_b32 v212, 16, v200
  v_and_b32 v213, 0xffff0000, v200
  v_lshlrev_b32 v214, 16, v201
  v_and_b32 v215, 0xffff0000, v201
  v_lshlrev_b32 v216, 16, v202
  v_and_b32 v217, 0xffff0000, v202
  v_lshlrev_b32 v218, 16, v203
  v_and_b32 v219, 0xffff0000, v203
  v_add_f32 v220, v212, v213
  v_add_f32 v221, v214, v215
  v_add_f32 v222, v216, v217
  v_add_f32 v223, v218, v219
  v_add_f32 v220, v220, v221
  v_add_f32 v222, v222, v223
  v_add_f32 v220, v220, v222
  s_nop 1
  v_add_f32_dpp v220, v220, v220 row_ror:8 row_mask:0xf bank_mask:0xf
  s_nop 1
  v_add_f32_dpp v220, v220, v220 row_ror:4 row_mask:0xf bank_mask:0xf
  s_nop 1
  v_add_f32_dpp v220, v220, v220 row_ror:2 row_mask:0xf bank_mask:0xf
  s_nop 1
  v_add_f32_dpp v220, v220, v220 row_ror:1 row_mask:0xf bank_mask:0xf
  v_mov_b32 v222, v220
  s_nop 0
  s_nop 0
  v_permlane16_swap_b32 v220, v222
  v_add_f32 v220, v220, v222
  v_mov_b32 v222, v220
  s_nop 0
  s_nop 0
  v_permlane32_swap_b32 v220, v222
  v_add_f32 v220, v220, v222
  v_mul_f32 v220, 0x3b000000, v220
  v_sub_f32 v224, v212, v220
  v_sub_f32 v225, v213, v220
  v_sub_f32 v226, v214, v220
  v_sub_f32 v227, v215, v220
  v_sub_f32 v228, v216, v220
  v_sub_f32 v229, v217, v220
  v_sub_f32 v230, v218, v220
  v_sub_f32 v231, v219, v220
  v_mul_f32 v221, v224, v224
  v_mul_f32 v222, v225, v225
  v_fmac_f32 v221, v226, v226
  v_fmac_f32 v222, v227, v227
  v_fmac_f32 v221, v228, v228
  v_fmac_f32 v222, v229, v229
  v_fmac_f32 v221, v230, v230
  v_fmac_f32 v222, v231, v231
  v_add_f32 v221, v221, v222
  v_cvt_pk_bf16_f32 v220, 0, v220
  s_nop 0
  v_add_f32_dpp v221, v221, v221 row_ror:8 row_mask:0xf bank_mask:0xf
  v_sub_f32 v224, v212, v220
  v_sub_f32 v225, v213, v220
  v_add_f32_dpp v221, v221, v221 row_ror:4 row_mask:0xf bank_mask:0xf
  v_sub_f32 v226, v214, v220
  v_sub_f32 v227, v215, v220
  v_add_f32_dpp v221, v221, v221 row_ror:2 row_mask:0xf bank_mask:0xf
  v_sub_f32 v228, v216, v220
  v_sub_f32 v229, v217, v220
  v_add_f32_dpp v221, v221, v221 row_ror:1 row_mask:0xf bank_mask:0xf
  v_sub_f32 v230, v218, v220
  v_sub_f32 v231, v219, v220
  v_mov_b32 v222, v221
  v_cvt_pk_bf16_f32 v224, 0, v224
  v_cvt_pk_bf16_f32 v225, 0, v225
  v_permlane16_swap_b32 v221, v222
  v_cvt_pk_bf16_f32 v226, 0, v226
  v_cvt_pk_bf16_f32 v227, 0, v227
  v_add_f32 v221, v221, v222
  v_cvt_pk_bf16_f32 v228, 0, v228
  v_cvt_pk_bf16_f32 v229, 0, v229
  v_mov_b32 v222, v221
  v_cvt_pk_bf16_f32 v230, 0, v230
  v_cvt_pk_bf16_f32 v231, 0, v231
  v_permlane32_swap_b32 v221, v222
  v_add_f32 v221, v221, v222
  v_mul_f32 v221, 0x3b000000, v221
  v_cvt_pk_bf16_f32 v221, 0, v221
  v_add_f32 v221, 0x3727c5ac, v221
  v_cvt_pk_bf16_f32 v221, 0, v221
  v_sqrt_f32 v221, v221
  s_nop 0
  v_cvt_pk_bf16_f32 v221, 0, v221
  v_rcp_f32 v221, v221
  s_nop 0
  v_mul_f32 v224, v224, v221
  v_mul_f32 v225, v225, v221
  v_mul_f32 v226, v226, v221
  v_mul_f32 v227, v227, v221
  v_mul_f32 v228, v228, v221
  v_mul_f32 v229, v229, v221
  v_mul_f32 v230, v230, v221
  v_mul_f32 v231, v231, v221
  v_cvt_pk_bf16_f32 v200, v224, v225
  v_cvt_pk_bf16_f32 v201, v226, v227
  v_cvt_pk_bf16_f32 v202, v228, v229
  v_cvt_pk_bf16_f32 v203, v230, v231
  buffer_store_dwordx4 v[200:203], v0, s[4:7], s29 offen sc1
  s_add_u32 s29, s29, 262144
  s_waitcnt vmcnt(40)
  v_lshlrev_b32 v212, 16, v204
  v_and_b32 v213, 0xffff0000, v204
  v_lshlrev_b32 v214, 16, v205
  v_and_b32 v215, 0xffff0000, v205
  v_lshlrev_b32 v216, 16, v206
  v_and_b32 v217, 0xffff0000, v206
  v_lshlrev_b32 v218, 16, v207
  v_and_b32 v219, 0xffff0000, v207
  v_add_f32 v220, v212, v213
  v_add_f32 v221, v214, v215
  v_add_f32 v222, v216, v217
  v_add_f32 v223, v218, v219
  v_add_f32 v220, v220, v221
  v_add_f32 v222, v222, v223
  v_add_f32 v220, v220, v222
  s_nop 1
  v_add_f32_dpp v220, v220, v220 row_ror:8 row_mask:0xf bank_mask:0xf
  s_nop 1
  v_add_f32_dpp v220, v220, v220 row_ror:4 row_mask:0xf bank_mask:0xf
  s_nop 1
  v_add_f32_dpp v220, v220, v220 row_ror:2 row_mask:0xf bank_mask:0xf
  s_nop 1
  v_add_f32_dpp v220, v220, v220 row_ror:1 row_mask:0xf bank_mask:0xf
  v_mov_b32 v222, v220
  s_nop 0
  s_nop 0
  v_permlane16_swap_b32 v220, v222
  v_add_f32 v220, v220, v222
  v_mov_b32 v222, v220
  s_nop 0
  s_nop 0
  v_permlane32_swap_b32 v220, v222
  v_add_f32 v220, v220, v222
  v_mul_f32 v220, 0x3b000000, v220
  v_sub_f32 v224, v212, v220
  v_sub_f32 v225, v213, v220
  v_sub_f32 v226, v214, v220
  v_sub_f32 v227, v215, v220
  v_sub_f32 v228, v216, v220
  v_sub_f32 v229, v217, v220
  v_sub_f32 v230, v218, v220
  v_sub_f32 v231, v219, v220
  v_mul_f32 v221, v224, v224
  v_mul_f32 v222, v225, v225
  v_fmac_f32 v221, v226, v226
  v_fmac_f32 v222, v227, v227
  v_fmac_f32 v221, v228, v228
  v_fmac_f32 v222, v229, v229
  v_fmac_f32 v221, v230, v230
  v_fmac_f32 v222, v231, v231
  v_add_f32 v221, v221, v222
  v_cvt_pk_bf16_f32 v220, 0, v220
  s_nop 0
  v_add_f32_dpp v221, v221, v221 row_ror:8 row_mask:0xf bank_mask:0xf
  v_sub_f32 v224, v212, v220
  v_sub_f32 v225, v213, v220
  v_add_f32_dpp v221, v221, v221 row_ror:4 row_mask:0xf bank_mask:0xf
  v_sub_f32 v226, v214, v220
  v_sub_f32 v227, v215, v220
  v_add_f32_dpp v221, v221, v221 row_ror:2 row_mask:0xf bank_mask:0xf
  v_sub_f32 v228, v216, v220
  v_sub_f32 v229, v217, v220
  v_add_f32_dpp v221, v221, v221 row_ror:1 row_mask:0xf bank_mask:0xf
  v_sub_f32 v230, v218, v220
  v_sub_f32 v231, v219, v220
  v_mov_b32 v222, v221
  v_cvt_pk_bf16_f32 v224, 0, v224
  v_cvt_pk_bf16_f32 v225, 0, v225
  v_permlane16_swap_b32 v221, v222
  v_cvt_pk_bf16_f32 v226, 0, v226
  v_cvt_pk_bf16_f32 v227, 0, v227
  v_add_f32 v221, v221, v222
  v_cvt_pk_bf16_f32 v228, 0, v228
  v_cvt_pk_bf16_f32 v229, 0, v229
  v_mov_b32 v222, v221
  v_cvt_pk_bf16_f32 v230, 0, v230
  v_cvt_pk_bf16_f32 v231, 0, v231
  v_permlane32_swap_b32 v221, v222
  v_add_f32 v221, v221, v222
  v_mul_f32 v221, 0x3b000000, v221
  v_cvt_pk_bf16_f32 v221, 0, v221
  v_add_f32 v221, 0x3727c5ac, v221
  v_cvt_pk_bf16_f32 v221, 0, v221
  v_sqrt_f32 v221, v221
  s_nop 0
  v_cvt_pk_bf16_f32 v221, 0, v221
  v_rcp_f32 v221, v221
  s_nop 0
  v_mul_f32 v224, v224, v221
  v_mul_f32 v225, v225, v221
  v_mul_f32 v226, v226, v221
  v_mul_f32 v227, v227, v221
  v_mul_f32 v228, v228, v221
  v_mul_f32 v229, v229, v221
  v_mul_f32 v230, v230, v221
  v_mul_f32 v231, v231, v221
  v_cvt_pk_bf16_f32 v204, v224, v225
  v_cvt_pk_bf16_f32 v205, v226, v227
  v_cvt_pk_bf16_f32 v206, v228, v229
  v_cvt_pk_bf16_f32 v207, v230, v231
  buffer_store_dwordx4 v[204:207], v0, s[4:7], s29 offen sc1
  s_add_u32 s29, s29, 262144
o_s2_126:
  s_waitcnt vmcnt(33)
  v_perm_b32 v48, v66, v64, s44
  v_perm_b32 v49, v70, v68, s44
  v_perm_b32 v50, v74, v72, s44
  v_perm_b32 v51, v78, v76, s44
  v_accvgpr_write_b32 a0, v48
  v_accvgpr_write_b32 a1, v49
  v_accvgpr_write_b32 a2, v50
  v_accvgpr_write_b32 a3, v51
  v_perm_b32 v52, v66, v64, s45
  v_perm_b32 v53, v70, v68, s45
  v_perm_b32 v54, v74, v72, s45
  v_perm_b32 v55, v78, v76, s45
  v_accvgpr_write_b32 a4, v52
  v_accvgpr_write_b32 a5, v53
  v_accvgpr_write_b32 a6, v54
  v_accvgpr_write_b32 a7, v55
  v_perm_b32 v48, v67, v65, s44
  v_perm_b32 v49, v71, v69, s44
  v_perm_b32 v50, v75, v73, s44
  v_perm_b32 v51, v79, v77, s44
  v_accvgpr_write_b32 a8, v48
  v_accvgpr_write_b32 a9, v49
  v_accvgpr_write_b32 a10, v50
  v_accvgpr_write_b32 a11, v51
  v_perm_b32 v52, v67, v65, s45
  v_perm_b32 v53, v71, v69, s45
  v_perm_b32 v54, v75, v73, s45
  v_perm_b32 v55, v79, v77, s45
  v_accvgpr_write_b32 a12, v52
  v_accvgpr_write_b32 a13, v53
  v_accvgpr_write_b32 a14, v54
  v_accvgpr_write_b32 a15, v55
  s_waitcnt vmcnt(25)
  v_perm_b32 v48, v82, v80, s44
  v_perm_b32 v49, v86, v84, s44
  v_perm_b32 v50, v90, v88, s44
  v_perm_b32 v51, v94, v92, s44
  v_accvgpr_write_b32 a16, v48
  v_accvgpr_write_b32 a17, v49
  v_accvgpr_write_b32 a18, v50
  v_accvgpr_write_b32 a19, v51
  v_perm_b32 v52, v82, v80, s45
  v_perm_b32 v53, v86, v84, s45
  v_perm_b32 v54, v90, v88, s45
  v_perm_b32 v55, v94, v92, s45
  v_accvgpr_write_b32 a20, v52
  v_accvgpr_write_b32 a21, v53
  v_accvgpr_write_b32 a22, v54
  v_accvgpr_write_b32 a23, v55
  v_perm_b32 v48, v83, v81, s44
  v_perm_b32 v49, v87, v85, s44
  v_perm_b32 v50, v91, v89, s44
  v_perm_b32 v51, v95, v93, s44
  v_accvgpr_write_b32 a24, v48
  v_accvgpr_write_b32 a25, v49
  v_accvgpr_write_b32 a26, v50
  v_accvgpr_write_b32 a27, v51
  v_perm_b32 v52, v83, v81, s45
  v_perm_b32 v53, v87, v85, s45
  v_perm_b32 v54, v91, v89, s45
  v_perm_b32 v55, v95, v93, s45
  v_accvgpr_write_b32 a28, v52
  v_accvgpr_write_b32 a29, v53
  v_accvgpr_write_b32 a30, v54
  v_accvgpr_write_b32 a31, v55
  s_waitcnt vmcnt(17)
  v_perm_b32 v48, v98, v96, s44
  v_perm_b32 v49, v102, v100, s44
  v_perm_b32 v50, v106, v104, s44
  v_perm_b32 v51, v110, v108, s44
  v_accvgpr_write_b32 a32, v48
  v_accvgpr_write_b32 a33, v49
  v_accvgpr_write_b32 a34, v50
  v_accvgpr_write_b32 a35, v51
  v_perm_b32 v52, v98, v96, s45
  v_perm_b32 v53, v102, v100, s45
  v_perm_b32 v54, v106, v104, s45
  v_perm_b32 v55, v110, v108, s45
  v_accvgpr_write_b32 a36, v52
  v_accvgpr_write_b32 a37, v53
  v_accvgpr_write_b32 a38, v54
  v_accvgpr_write_b32 a39, v55
  v_perm_b32 v48, v99, v97, s44
  v_perm_b32 v49, v103, v101, s44
  v_perm_b32 v50, v107, v105, s44
  v_perm_b32 v51, v111, v109, s44
  v_accvgpr_write_b32 a40, v48
  v_accvgpr_write_b32 a41, v49
  v_accvgpr_write_b32 a42, v50
  v_accvgpr_write_b32 a43, v51
  v_perm_b32 v52, v99, v97, s45
  v_perm_b32 v53, v103, v101, s45
  v_perm_b32 v54, v107, v105, s45
  v_perm_b32 v55, v111, v109, s45
  v_accvgpr_write_b32 a44, v52
  v_accvgpr_write_b32 a45, v53
  v_accvgpr_write_b32 a46, v54
  v_accvgpr_write_b32 a47, v55
  s_waitcnt vmcnt(9)
  v_perm_b32 v48, v114, v112, s44
  v_perm_b32 v49, v118, v116, s44
  v_perm_b32 v50, v122, v120, s44
  v_perm_b32 v51, v126, v124, s44
  v_accvgpr_write_b32 a48, v48
  v_accvgpr_write_b32 a49, v49
  v_accvgpr_write_b32 a50, v50
  v_accvgpr_write_b32 a51, v51
  v_perm_b32 v52, v114, v112, s45
  v_perm_b32 v53, v118, v116, s45
  v_perm_b32 v54, v122, v120, s45
  v_perm_b32 v55, v126, v124, s45
  v_accvgpr_write_b32 a52, v52
  v_accvgpr_write_b32 a53, v53
  v_accvgpr_write_b32 a54, v54
  v_accvgpr_write_b32 a55, v55
  v_perm_b32 v48, v115, v113, s44
  v_perm_b32 v49, v119, v117, s44
  v_perm_b32 v50, v123, v121, s44
  v_perm_b32 v51, v127, v125, s44
  v_accvgpr_write_b32 a56, v48
  v_accvgpr_write_b32 a57, v49
  v_accvgpr_write_b32 a58, v50
  v_accvgpr_write_b32 a59, v51
  v_perm_b32 v52, v115, v113, s45
  v_perm_b32 v53, v119, v117, s45
  v_perm_b32 v54, v123, v121, s45
  v_perm_b32 v55, v127, v125, s45
  v_accvgpr_write_b32 a60, v52
  v_accvgpr_write_b32 a61, v53
  v_accvgpr_write_b32 a62, v54
  v_accvgpr_write_b32 a63, v55
  s_cmp_ge_u32 s60, 4
  s_cbranch_scc1 o_s3_127
  v_mbcnt_lo_u32_b32 v60, -1, 0
  v_and_b32 v60, 0, v60
  v_add_lshl_u32 v60, v60, 1, 2
  s_mov_b32 s26, 0
g_wt_128:
  global_load_dword v61, v60, s[12:13] offset:128 sc1
  s_add_u32 s26, s26, 1
  s_cmp_gt_u32 s26, 1048576
  s_cbranch_scc1 L_end
  s_waitcnt vmcnt(0)
  v_cmp_eq_u32 vcc, 0, v61
  v_readfirstlane_b32 s27, v61
  s_cbranch_vccnz g_wt_128
  s_lshl_b32 s27, s77, 7
  s_add_u32 s27, s27, 243269632
  v_lshlrev_b32 v61, 11, v0
  v_mov_b32 v60, 1
  s_mov_b64 exec, 255
  buffer_store_dword v60, v61, s[4:7], s27 offen sc1
  s_mov_b64 exec, -1
o_s3_127:
  s_add_u32 s27, s30, 65536
  buffer_load_dwordx2 v[128:129], v44, s[80:83], s27 offen
  s_add_u32 s27, s30, 66560
  buffer_load_dwordx2 v[130:131], v44, s[80:83], s27 offen
  s_add_u32 s27, s30, 67584
  buffer_load_dwordx2 v[132:133], v44, s[80:83], s27 offen
  s_add_u32 s27, s30, 68608
  buffer_load_dwordx2 v[134:135], v44, s[80:83], s27 offen
  s_add_u32 s27, s30, 81920
  buffer_load_dwordx2 v[136:137], v44, s[80:83], s27 offen
  s_add_u32 s27, s30, 82944
  buffer_load_dwordx2 v[138:139], v44, s[80:83], s27 offen
  s_add_u32 s27, s30, 83968
  buffer_load_dwordx2 v[140:141], v44, s[80:83], s27 offen
  s_add_u32 s27, s30, 84992
  buffer_load_dwordx2 v[142:143], v44, s[80:83], s27 offen
  s_add_u32 s27, s30, 73728
  buffer_load_dwordx2 v[144:145], v44, s[80:83], s27 offen
  s_add_u32 s27, s30, 74752
  buffer_load_dwordx2 v[146:147], v44, s[80:83], s27 offen
  s_add_u32 s27, s30, 75776
  buffer_load_dwordx2 v[148:149], v44, s[80:83], s27 offen
  s_add_u32 s27, s30, 76800
  buffer_load_dwordx2 v[150:151], v44, s[80:83], s27 offen
  s_add_u32 s27, s30, 90112
  buffer_load_dwordx2 v[152:153], v44, s[80:83], s27 offen
  s_add_u32 s27, s30, 91136
  buffer_load_dwordx2 v[154:155], v44, s[80:83], s27 offen
  s_add_u32 s27, s30, 92160
  buffer_load_dwordx2 v[156:157], v44, s[80:83], s27 offen
  s_add_u32 s27, s30, 93184
  buffer_load_dwordx2 v[158:159], v44, s[80:83], s27 offen
  s_add_u32 s27, s30, 98304
  buffer_load_dwordx2 v[160:161], v44, s[80:83], s27 offen
  s_add_u32 s27, s30, 99328
  buffer_load_dwordx2 v[162:163], v44, s[80:83], s27 offen
  s_add_u32 s27, s30, 100352
  buffer_load_dwordx2 v[164:165], v44, s[80:83], s27 offen
  s_add_u32 s27, s30, 101376
  buffer_load_dwordx2 v[166:167], v44, s[80:83], s27 offen
  s_add_u32 s27, s30, 114688
  buffer_load_dwordx2 v[168:169], v44, s[80:83], s27 offen
  s_add_u32 s27, s30, 115712
  buffer_load_dwordx2 v[170:171], v44, s[80:83], s27 offen
  s_add_u32 s27, s30, 116736
  buffer_load_dwordx2 v[172:173], v44, s[80:83], s27 offen
  s_add_u32 s27, s30, 117760
  buffer_load_dwordx2 v[174:175], v44, s[80:83], s27 offen
  s_add_u32 s27, s30, 106496
  buffer_load_dwordx2 v[64:65], v44, s[80:83], s27 offen
  s_add_u32 s27, s30, 107520
  buffer_load_dwordx2 v[66:67], v44, s[80:83], s27 offen
  s_add_u32 s27, s30, 108544
  buffer_load_dwordx2 v[68:69], v44, s[80:83], s27 offen
  s_add_u32 s27, s30, 109568
  buffer_load_dwordx2 v[70:71], v44, s[80:83], s27 offen
  s_add_u32 s27, s30, 122880
  buffer_load_dwordx2 v[72:73], v44, s[80:83], s27 offen
  s_add_u32 s27, s30, 123904
  buffer_load_dwordx2 v[74:75], v44, s[80:83], s27 offen
  s_add_u32 s27, s30, 124928
  buffer_load_dwordx2 v[76:77], v44, s[80:83], s27 offen
  s_add_u32 s27, s30, 125952
  buffer_load_dwordx2 v[78:79], v44, s[80:83], s27 offen
  s_add_u32 s27, s30, 131072
  buffer_load_dwordx2 v[80:81], v44, s[80:83], s27 offen
  s_add_u32 s27, s30, 132096
  buffer_load_dwordx2 v[82:83], v44, s[80:83], s27 offen
  s_add_u32 s27, s30, 133120
  buffer_load_dwordx2 v[84:85], v44, s[80:83], s27 offen
  s_add_u32 s27, s30, 134144
  buffer_load_dwordx2 v[86:87], v44, s[80:83], s27 offen
  s_add_u32 s27, s30, 147456
  buffer_load_dwordx2 v[88:89], v44, s[80:83], s27 offen
  s_add_u32 s27, s30, 148480
  buffer_load_dwordx2 v[90:91], v44, s[80:83], s27 offen
  s_add_u32 s27, s30, 149504
  buffer_load_dwordx2 v[92:93], v44, s[80:83], s27 offen
  s_add_u32 s27, s30, 150528
  buffer_load_dwordx2 v[94:95], v44, s[80:83], s27 offen
  s_add_u32 s27, s30, 139264
  buffer_load_dwordx2 v[96:97], v44, s[80:83], s27 offen
  s_add_u32 s27, s30, 140288
  buffer_load_dwordx2 v[98:99], v44, s[80:83], s27 offen
  s_add_u32 s27, s30, 141312
  buffer_load_dwordx2 v[100:101], v44, s[80:83], s27 offen
  s_add_u32 s27, s30, 142336
  buffer_load_dwordx2 v[102:103], v44, s[80:83], s27 offen
  s_add_u32 s27, s30, 155648
  buffer_load_dwordx2 v[104:105], v44, s[80:83], s27 offen
  s_add_u32 s27, s30, 156672
  buffer_load_dwordx2 v[106:107], v44, s[80:83], s27 offen
  s_add_u32 s27, s30, 157696
  buffer_load_dwordx2 v[108:109], v44, s[80:83], s27 offen
  s_add_u32 s27, s30, 158720
  buffer_load_dwordx2 v[110:111], v44, s[80:83], s27 offen
  s_add_u32 s27, s30, 163840
  buffer_load_dwordx2 v[112:113], v44, s[80:83], s27 offen
  s_add_u32 s27, s30, 164864
  buffer_load_dwordx2 v[114:115], v44, s[80:83], s27 offen
  s_add_u32 s27, s30, 165888
  buffer_load_dwordx2 v[116:117], v44, s[80:83], s27 offen
  s_add_u32 s27, s30, 166912
  buffer_load_dwordx2 v[118:119], v44, s[80:83], s27 offen
  s_add_u32 s27, s30, 180224
  buffer_load_dwordx2 v[120:121], v44, s[80:83], s27 offen
  s_add_u32 s27, s30, 181248
  buffer_load_dwordx2 v[122:123], v44, s[80:83], s27 offen
  s_add_u32 s27, s30, 182272
  buffer_load_dwordx2 v[124:125], v44, s[80:83], s27 offen
  s_add_u32 s27, s30, 183296
  buffer_load_dwordx2 v[126:127], v44, s[80:83], s27 offen
  v_lshlrev_b32 v8, 16, v56
  v_and_b32 v9, 0xffff0000, v56
  v_lshlrev_b32 v10, 16, v57
  v_and_b32 v11, 0xffff0000, v57
  v_lshlrev_b32 v12, 16, v58
  v_and_b32 v13, 0xffff0000, v58
  v_lshlrev_b32 v14, 16, v59
  v_and_b32 v15, 0xffff0000, v59
  v_mul_f32 v56, v8, v8
  v_fmac_f32 v56, v9, v9
  v_fmac_f32 v56, v10, v10
  v_fmac_f32 v56, v11, v11
  v_fmac_f32 v56, v12, v12
  v_fmac_f32 v56, v13, v13
  v_fmac_f32 v56, v14, v14
  v_fmac_f32 v56, v15, v15
  s_nop 0
  s_nop 0
  v_add_f32_dpp v56, v56, v56 row_ror:8 row_mask:0xf bank_mask:0xf
  s_nop 1
  v_add_f32_dpp v56, v56, v56 row_ror:4 row_mask:0xf bank_mask:0xf
  s_nop 1
  v_add_f32_dpp v56, v56, v56 row_ror:2 row_mask:0xf bank_mask:0xf
  s_nop 1
  v_add_f32_dpp v56, v56, v56 row_ror:1 row_mask:0xf bank_mask:0xf
  v_mov_b32 v57, v56
  s_nop 0
  s_nop 0
  v_permlane16_swap_b32 v56, v57
  v_add_f32 v56, v56, v57
  v_mov_b32 v57, v56
  s_nop 0
  s_nop 0
  v_permlane32_swap_b32 v56, v57
  v_add_f32 v56, v56, v57
  v_sqrt_f32 v56, v56
  s_mov_b32 s28, 0x404d8eb7
  v_writelane_b32 v247, s28, 0
  s_mov_b32 s28, 0x404d8eb7
  v_writelane_b32 v247, s28, 1
  s_mov_b32 s28, 0x404cc30f
  v_writelane_b32 v247, s28, 2
  s_mov_b32 s28, 0x404ba22b
  v_writelane_b32 v247, s28, 3
  s_mov_b32 s28, 0x404a6ab0
  v_writelane_b32 v247, s28, 4
  s_mov_b32 s28, 0x404918ea
  v_writelane_b32 v247, s28, 5
  s_mov_b32 s28, 0x4047a82a
  v_writelane_b32 v247, s28, 6
  s_mov_b32 s28, 0x40461267
  v_writelane_b32 v247, s28, 7
  s_mov_b32 s28, 0x40444faa
  v_writelane_b32 v247, s28, 8
  s_mov_b32 s28, 0x40425526
  v_writelane_b32 v247, s28, 9
  s_mov_b32 s28, 0x404013b2
  v_writelane_b32 v247, s28, 10
  s_mov_b32 s28, 0x403d751c
  v_writelane_b32 v247, s28, 11
  s_mov_b32 s28, 0x403a570a
  v_writelane_b32 v247, s28, 12
  s_mov_b32 s28, 0x4036803f
  v_writelane_b32 v247, s28, 13
  s_mov_b32 s28, 0x403186a2
  v_writelane_b32 v247, s28, 14
  s_mov_b32 s28, 0x402a8231
  v_writelane_b32 v247, s28, 15
  s_mov_b32 s28, 0x401ec2e6
  v_writelane_b32 v247, s28, 16
  s_mov_b32 s28, 0x3ff46943
  v_writelane_b32 v247, s28, 17
  s_mov_b32 s28, 0x3ff46943
  v_writelane_b32 v247, s28, 18
  v_mul_f32 v247, v247, v56
  v_or_b32 v247, 0x80000000, v247
  s_lshl_b32 s29, s61, 2
  s_add_u32 s29, s29, s17
  s_lshl_b32 s29, s29, 13
  s_add_u32 s29, s29, s41
  s_cmp_ge_u32 s60, 4
  s_cselect_b32 s29, 268435456, s29
  v_mov_b64 v[208:209], 0
  v_mov_b64 v[210:211], 0
  s_waitcnt vmcnt(48)
  v_perm_b32 v48, v130, v128, s44
  v_perm_b32 v49, v134, v132, s44
  v_perm_b32 v50, v138, v136, s44
  v_perm_b32 v51, v142, v140, s44
  v_accvgpr_write_b32 a64, v48
  v_accvgpr_write_b32 a65, v49
  v_accvgpr_write_b32 a66, v50
  v_accvgpr_write_b32 a67, v51
  v_perm_b32 v52, v130, v128, s45
  v_perm_b32 v53, v134, v132, s45
  v_perm_b32 v54, v138, v136, s45
  v_perm_b32 v55, v142, v140, s45
  v_accvgpr_write_b32 a68, v52
  v_accvgpr_write_b32 a69, v53
  v_accvgpr_write_b32 a70, v54
  v_accvgpr_write_b32 a71, v55
  v_perm_b32 v48, v131, v129, s44
  v_perm_b32 v49, v135, v133, s44
  v_perm_b32 v50, v139, v137, s44
  v_perm_b32 v51, v143, v141, s44
  v_accvgpr_write_b32 a72, v48
  v_accvgpr_write_b32 a73, v49
  v_accvgpr_write_b32 a74, v50
  v_accvgpr_write_b32 a75, v51
  v_perm_b32 v52, v131, v129, s45
  v_perm_b32 v53, v135, v133, s45
  v_perm_b32 v54, v139, v137, s45
  v_perm_b32 v55, v143, v141, s45
  v_accvgpr_write_b32 a76, v52
  v_accvgpr_write_b32 a77, v53
  v_accvgpr_write_b32 a78, v54
  v_accvgpr_write_b32 a79, v55
  s_add_u32 s27, s30, 172032
  buffer_load_dwordx2 v[128:129], v44, s[80:83], s27 offen
  s_add_u32 s27, s30, 173056
  buffer_load_dwordx2 v[130:131], v44, s[80:83], s27 offen
  s_add_u32 s27, s30, 174080
  buffer_load_dwordx2 v[132:133], v44, s[80:83], s27 offen
  s_add_u32 s27, s30, 175104
  buffer_load_dwordx2 v[134:135], v44, s[80:83], s27 offen
  s_add_u32 s27, s30, 188416
  buffer_load_dwordx2 v[136:137], v44, s[80:83], s27 offen
  s_add_u32 s27, s30, 189440
  buffer_load_dwordx2 v[138:139], v44, s[80:83], s27 offen
  s_add_u32 s27, s30, 190464
  buffer_load_dwordx2 v[140:141], v44, s[80:83], s27 offen
  s_add_u32 s27, s30, 191488
  buffer_load_dwordx2 v[142:143], v44, s[80:83], s27 offen
  s_waitcnt vmcnt(48)
  v_perm_b32 v48, v146, v144, s44
  v_perm_b32 v49, v150, v148, s44
  v_perm_b32 v50, v154, v152, s44
  v_perm_b32 v51, v158, v156, s44
  v_accvgpr_write_b32 a80, v48
  v_accvgpr_write_b32 a81, v49
  v_accvgpr_write_b32 a82, v50
  v_accvgpr_write_b32 a83, v51
  v_perm_b32 v52, v146, v144, s45
  v_perm_b32 v53, v150, v148, s45
  v_perm_b32 v54, v154, v152, s45
  v_perm_b32 v55, v158, v156, s45
  v_accvgpr_write_b32 a84, v52
  v_accvgpr_write_b32 a85, v53
  v_accvgpr_write_b32 a86, v54
  v_accvgpr_write_b32 a87, v55
  v_perm_b32 v48, v147, v145, s44
  v_perm_b32 v49, v151, v149, s44
  v_perm_b32 v50, v155, v153, s44
  v_perm_b32 v51, v159, v157, s44
  v_accvgpr_write_b32 a88, v48
  v_accvgpr_write_b32 a89, v49
  v_accvgpr_write_b32 a90, v50
  v_accvgpr_write_b32 a91, v51
  v_perm_b32 v52, v147, v145, s45
  v_perm_b32 v53, v151, v149, s45
  v_perm_b32 v54, v155, v153, s45
  v_perm_b32 v55, v159, v157, s45
  v_accvgpr_write_b32 a92, v52
  v_accvgpr_write_b32 a93, v53
  v_accvgpr_write_b32 a94, v54
  v_accvgpr_write_b32 a95, v55
  s_add_u32 s27, s30, 196608
  buffer_load_dwordx2 v[144:145], v44, s[80:83], s27 offen
  s_add_u32 s27, s30, 197632
  buffer_load_dwordx2 v[146:147], v44, s[80:83], s27 offen
  s_add_u32 s27, s30, 198656
  buffer_load_dwordx2 v[148:149], v44, s[80:83], s27 offen
  s_add_u32 s27, s30, 199680
  buffer_load_dwordx2 v[150:151], v44, s[80:83], s27 offen
  s_add_u32 s27, s30, 212992
  buffer_load_dwordx2 v[152:153], v44, s[80:83], s27 offen
  s_add_u32 s27, s30, 214016
  buffer_load_dwordx2 v[154:155], v44, s[80:83], s27 offen
  s_add_u32 s27, s30, 215040
  buffer_load_dwordx2 v[156:157], v44, s[80:83], s27 offen
  s_add_u32 s27, s30, 216064
  buffer_load_dwordx2 v[158:159], v44, s[80:83], s27 offen
  s_waitcnt vmcnt(48)
  v_perm_b32 v48, v162, v160, s44
  v_perm_b32 v49, v166, v164, s44
  v_perm_b32 v50, v170, v168, s44
  v_perm_b32 v51, v174, v172, s44
  v_accvgpr_write_b32 a96, v48
  v_accvgpr_write_b32 a97, v49
  v_accvgpr_write_b32 a98, v50
  v_accvgpr_write_b32 a99, v51
  v_perm_b32 v52, v162, v160, s45
  v_perm_b32 v53, v166, v164, s45
  v_perm_b32 v54, v170, v168, s45
  v_perm_b32 v55, v174, v172, s45
  v_accvgpr_write_b32 a100, v52
  v_accvgpr_write_b32 a101, v53
  v_accvgpr_write_b32 a102, v54
  v_accvgpr_write_b32 a103, v55
  v_perm_b32 v48, v163, v161, s44
  v_perm_b32 v49, v167, v165, s44
  v_perm_b32 v50, v171, v169, s44
  v_perm_b32 v51, v175, v173, s44
  v_accvgpr_write_b32 a104, v48
  v_accvgpr_write_b32 a105, v49
  v_accvgpr_write_b32 a106, v50
  v_accvgpr_write_b32 a107, v51
  v_perm_b32 v52, v163, v161, s45
  v_perm_b32 v53, v167, v165, s45
  v_perm_b32 v54, v171, v169, s45
  v_perm_b32 v55, v175, v173, s45
  v_accvgpr_write_b32 a108, v52
  v_accvgpr_write_b32 a109, v53
  v_accvgpr_write_b32 a110, v54
  v_accvgpr_write_b32 a111, v55
  s_add_u32 s27, s30, 204800
  buffer_load_dwordx2 v[160:161], v44, s[80:83], s27 offen
  s_add_u32 s27, s30, 205824
  buffer_load_dwordx2 v[162:163], v44, s[80:83], s27 offen
  s_add_u32 s27, s30, 206848
  buffer_load_dwordx2 v[164:165], v44, s[80:83], s27 offen
  s_add_u32 s27, s30, 207872
  buffer_load_dwordx2 v[166:167], v44, s[80:83], s27 offen
  s_add_u32 s27, s30, 221184
  buffer_load_dwordx2 v[168:169], v44, s[80:83], s27 offen
  s_add_u32 s27, s30, 222208
  buffer_load_dwordx2 v[170:171], v44, s[80:83], s27 offen
  s_add_u32 s27, s30, 223232
  buffer_load_dwordx2 v[172:173], v44, s[80:83], s27 offen
  s_add_u32 s27, s30, 224256
  buffer_load_dwordx2 v[174:175], v44, s[80:83], s27 offen
  s_waitcnt vmcnt(48)
  v_perm_b32 v48, v66, v64, s44
  v_perm_b32 v49, v70, v68, s44
  v_perm_b32 v50, v74, v72, s44
  v_perm_b32 v51, v78, v76, s44
  v_accvgpr_write_b32 a112, v48
  v_accvgpr_write_b32 a113, v49
  v_accvgpr_write_b32 a114, v50
  v_accvgpr_write_b32 a115, v51
  v_perm_b32 v52, v66, v64, s45
  v_perm_b32 v53, v70, v68, s45
  v_perm_b32 v54, v74, v72, s45
  v_perm_b32 v55, v78, v76, s45
  v_accvgpr_write_b32 a116, v52
  v_accvgpr_write_b32 a117, v53
  v_accvgpr_write_b32 a118, v54
  v_accvgpr_write_b32 a119, v55
  v_perm_b32 v48, v67, v65, s44
  v_perm_b32 v49, v71, v69, s44
  v_perm_b32 v50, v75, v73, s44
  v_perm_b32 v51, v79, v77, s44
  v_accvgpr_write_b32 a120, v48
  v_accvgpr_write_b32 a121, v49
  v_accvgpr_write_b32 a122, v50
  v_accvgpr_write_b32 a123, v51
  v_perm_b32 v52, v67, v65, s45
  v_perm_b32 v53, v71, v69, s45
  v_perm_b32 v54, v75, v73, s45
  v_perm_b32 v55, v79, v77, s45
  v_accvgpr_write_b32 a124, v52
  v_accvgpr_write_b32 a125, v53
  v_accvgpr_write_b32 a126, v54
  v_accvgpr_write_b32 a127, v55
  s_add_u32 s27, s30, 229376
  buffer_load_dwordx2 v[64:65], v44, s[80:83], s27 offen
  s_add_u32 s27, s30, 230400
  buffer_load_dwordx2 v[66:67], v44, s[80:83], s27 offen
  s_add_u32 s27, s30, 231424
  buffer_load_dwordx2 v[68:69], v44, s[80:83], s27 offen
  s_add_u32 s27, s30, 232448
  buffer_load_dwordx2 v[70:71], v44, s[80:83], s27 offen
  s_add_u32 s27, s30, 245760
  buffer_load_dwordx2 v[72:73], v44, s[80:83], s27 offen
  s_add_u32 s27, s30, 246784
  buffer_load_dwordx2 v[74:75], v44, s[80:83], s27 offen
  s_add_u32 s27, s30, 247808
  buffer_load_dwordx2 v[76:77], v44, s[80:83], s27 offen
  s_add_u32 s27, s30, 248832
  buffer_load_dwordx2 v[78:79], v44, s[80:83], s27 offen
  s_waitcnt vmcnt(48)
  v_perm_b32 v48, v82, v80, s44
  v_perm_b32 v49, v86, v84, s44
  v_perm_b32 v50, v90, v88, s44
  v_perm_b32 v51, v94, v92, s44
  v_accvgpr_write_b32 a128, v48
  v_accvgpr_write_b32 a129, v49
  v_accvgpr_write_b32 a130, v50
  v_accvgpr_write_b32 a131, v51
  v_perm_b32 v52, v82, v80, s45
  v_perm_b32 v53, v86, v84, s45
  v_perm_b32 v54, v90, v88, s45
  v_perm_b32 v55, v94, v92, s45
  v_accvgpr_write_b32 a132, v52
  v_accvgpr_write_b32 a133, v53
  v_accvgpr_write_b32 a134, v54
  v_accvgpr_write_b32 a135, v55
  v_perm_b32 v48, v83, v81, s44
  v_perm_b32 v49, v87, v85, s44
  v_perm_b32 v50, v91, v89, s44
  v_perm_b32 v51, v95, v93, s44
  v_accvgpr_write_b32 a136, v48
  v_accvgpr_write_b32 a137, v49
  v_accvgpr_write_b32 a138, v50
  v_accvgpr_write_b32 a139, v51
  v_perm_b32 v52, v83, v81, s45
  v_perm_b32 v53, v87, v85, s45
  v_perm_b32 v54, v91, v89, s45
  v_perm_b32 v55, v95, v93, s45
  v_accvgpr_write_b32 a140, v52
  v_accvgpr_write_b32 a141, v53
  v_accvgpr_write_b32 a142, v54
  v_accvgpr_write_b32 a143, v55
  s_add_u32 s27, s30, 237568
  buffer_load_dwordx2 v[80:81], v44, s[80:83], s27 offen
  s_add_u32 s27, s30, 238592
  buffer_load_dwordx2 v[82:83], v44, s[80:83], s27 offen
  s_add_u32 s27, s30, 239616
  buffer_load_dwordx2 v[84:85], v44, s[80:83], s27 offen
  s_add_u32 s27, s30, 240640
  buffer_load_dwordx2 v[86:87], v44, s[80:83], s27 offen
  s_add_u32 s27, s30, 253952
  buffer_load_dwordx2 v[88:89], v44, s[80:83], s27 offen
  s_add_u32 s27, s30, 254976
  buffer_load_dwordx2 v[90:91], v44, s[80:83], s27 offen
  s_add_u32 s27, s30, 256000
  buffer_load_dwordx2 v[92:93], v44, s[80:83], s27 offen
  s_add_u32 s27, s30, 257024
  buffer_load_dwordx2 v[94:95], v44, s[80:83], s27 offen
  s_waitcnt vmcnt(48)
  v_perm_b32 v48, v98, v96, s44
  v_perm_b32 v49, v102, v100, s44
  v_perm_b32 v50, v106, v104, s44
  v_perm_b32 v51, v110, v108, s44
  v_accvgpr_write_b32 a144, v48
  v_accvgpr_write_b32 a145, v49
  v_accvgpr_write_b32 a146, v50
  v_accvgpr_write_b32 a147, v51
  v_perm_b32 v52, v98, v96, s45
  v_perm_b32 v53, v102, v100, s45
  v_perm_b32 v54, v106, v104, s45
  v_perm_b32 v55, v110, v108, s45
  v_accvgpr_write_b32 a148, v52
  v_accvgpr_write_b32 a149, v53
  v_accvgpr_write_b32 a150, v54
  v_accvgpr_write_b32 a151, v55
  v_perm_b32 v48, v99, v97, s44
  v_perm_b32 v49, v103, v101, s44
  v_perm_b32 v50, v107, v105, s44
  v_perm_b32 v51, v111, v109, s44
  v_accvgpr_write_b32 a152, v48
  v_accvgpr_write_b32 a153, v49
  v_accvgpr_write_b32 a154, v50
  v_accvgpr_write_b32 a155, v51
  v_perm_b32 v52, v99, v97, s45
  v_perm_b32 v53, v103, v101, s45
  v_perm_b32 v54, v107, v105, s45
  v_perm_b32 v55, v111, v109, s45
  v_accvgpr_write_b32 a156, v52
  v_accvgpr_write_b32 a157, v53
  v_accvgpr_write_b32 a158, v54
  v_accvgpr_write_b32 a159, v55
  buffer_store_dwordx4 v[208:211], v0, s[4:7], s29 offen offset:0 sc1
  buffer_store_dwordx4 v[208:211], v0, s[4:7], s29 offen offset:1024 sc1
  buffer_store_dwordx4 v[208:211], v0, s[4:7], s29 offen offset:2048 sc1
  buffer_store_dwordx4 v[208:211], v0, s[4:7], s29 offen offset:3072 sc1
  s_add_u32 s29, s29, 4096
  s_waitcnt vmcnt(44)
  v_perm_b32 v48, v114, v112, s44
  v_perm_b32 v49, v118, v116, s44
  v_perm_b32 v50, v122, v120, s44
  v_perm_b32 v51, v126, v124, s44
  v_accvgpr_write_b32 a160, v48
  v_accvgpr_write_b32 a161, v49
  v_accvgpr_write_b32 a162, v50
  v_accvgpr_write_b32 a163, v51
  v_perm_b32 v52, v114, v112, s45
  v_perm_b32 v53, v118, v116, s45
  v_perm_b32 v54, v122, v120, s45
  v_perm_b32 v55, v126, v124, s45
  v_accvgpr_write_b32 a164, v52
  v_accvgpr_write_b32 a165, v53
  v_accvgpr_write_b32 a166, v54
  v_accvgpr_write_b32 a167, v55
  v_perm_b32 v48, v115, v113, s44
  v_perm_b32 v49, v119, v117, s44
  v_perm_b32 v50, v123, v121, s44
  v_perm_b32 v51, v127, v125, s44
  v_accvgpr_write_b32 a168, v48
  v_accvgpr_write_b32 a169, v49
  v_accvgpr_write_b32 a170, v50
  v_accvgpr_write_b32 a171, v51
  v_perm_b32 v52, v115, v113, s45
  v_perm_b32 v53, v119, v117, s45
  v_perm_b32 v54, v123, v121, s45
  v_perm_b32 v55, v127, v125, s45
  v_accvgpr_write_b32 a172, v52
  v_accvgpr_write_b32 a173, v53
  v_accvgpr_write_b32 a174, v54
  v_accvgpr_write_b32 a175, v55
  buffer_store_dwordx4 v[208:211], v0, s[4:7], s29 offen offset:0 sc1
  buffer_store_dwordx4 v[208:211], v0, s[4:7], s29 offen offset:1024 sc1
  buffer_store_dwordx4 v[208:211], v0, s[4:7], s29 offen offset:2048 sc1
  buffer_store_dwordx4 v[208:211], v0, s[4:7], s29 offen offset:3072 sc1
  s_add_u32 s29, s29, 520192
  s_waitcnt vmcnt(40)
  v_perm_b32 v48, v130, v128, s44
  v_perm_b32 v49, v134, v132, s44
  v_perm_b32 v50, v138, v136, s44
  v_perm_b32 v51, v142, v140, s44
  v_accvgpr_write_b32 a176, v48
  v_accvgpr_write_b32 a177, v49
  v_accvgpr_write_b32 a178, v50
  v_accvgpr_write_b32 a179, v51
  v_perm_b32 v52, v130, v128, s45
  v_perm_b32 v53, v134, v132, s45
  v_perm_b32 v54, v138, v136, s45
  v_perm_b32 v55, v142, v140, s45
  v_accvgpr_write_b32 a180, v52
  v_accvgpr_write_b32 a181, v53
  v_accvgpr_write_b32 a182, v54
  v_accvgpr_write_b32 a183, v55
  v_perm_b32 v48, v131, v129, s44
  v_perm_b32 v49, v135, v133, s44
  v_perm_b32 v50, v139, v137, s44
  v_perm_b32 v51, v143, v141, s44
  v_accvgpr_write_b32 a184, v48
  v_accvgpr_write_b32 a185, v49
  v_accvgpr_write_b32 a186, v50
  v_accvgpr_write_b32 a187, v51
  v_perm_b32 v52, v131, v129, s45
  v_perm_b32 v53, v135, v133, s45
  v_perm_b32 v54, v139, v137, s45
  v_perm_b32 v55, v143, v141, s45
  v_accvgpr_write_b32 a188, v52
  v_accvgpr_write_b32 a189, v53
  v_accvgpr_write_b32 a190, v54
  v_accvgpr_write_b32 a191, v55
  buffer_store_dwordx4 v[208:211], v0, s[4:7], s29 offen offset:0 sc1
  buffer_store_dwordx4 v[208:211], v0, s[4:7], s29 offen offset:1024 sc1
  buffer_store_dwordx4 v[208:211], v0, s[4:7], s29 offen offset:2048 sc1
  buffer_store_dwordx4 v[208:211], v0, s[4:7], s29 offen offset:3072 sc1
  s_add_u32 s29, s29, 4096
  s_waitcnt vmcnt(36)
  v_perm_b32 v48, v146, v144, s44
  v_perm_b32 v49, v150, v148, s44
  v_perm_b32 v50, v154, v152, s44
  v_perm_b32 v51, v158, v156, s44
  v_accvgpr_write_b32 a192, v48
  v_accvgpr_write_b32 a193, v49
  v_accvgpr_write_b32 a194, v50
  v_accvgpr_write_b32 a195, v51
  v_perm_b32 v52, v146, v144, s45
  v_perm_b32 v53, v150, v148, s45
  v_perm_b32 v54, v154, v152, s45
  v_perm_b32 v55, v158, v156, s45
  v_accvgpr_write_b32 a196, v52
  v_accvgpr_write_b32 a197, v53
  v_accvgpr_write_b32 a198, v54
  v_accvgpr_write_b32 a199, v55
  v_perm_b32 v48, v147, v145, s44
  v_perm_b32 v49, v151, v149, s44
  v_perm_b32 v50, v155, v153, s44
  v_perm_b32 v51, v159, v157, s44
  v_accvgpr_write_b32 a200, v48
  v_accvgpr_write_b32 a201, v49
  v_accvgpr_write_b32 a202, v50
  v_accvgpr_write_b32 a203, v51
  v_perm_b32 v52, v147, v145, s45
  v_perm_b32 v53, v151, v149, s45
  v_perm_b32 v54, v155, v153, s45
  v_perm_b32 v55, v159, v157, s45
  v_accvgpr_write_b32 a204, v52
  v_accvgpr_write_b32 a205, v53
  v_accvgpr_write_b32 a206, v54
  v_accvgpr_write_b32 a207, v55
  buffer_store_dwordx4 v[208:211], v0, s[4:7], s29 offen offset:0 sc1
  buffer_store_dwordx4 v[208:211], v0, s[4:7], s29 offen offset:1024 sc1
  buffer_store_dwordx4 v[208:211], v0, s[4:7], s29 offen offset:2048 sc1
  buffer_store_dwordx4 v[208:211], v0, s[4:7], s29 offen offset:3072 sc1
  s_add_u32 s29, s29, 4096
  s_waitcnt vmcnt(32)
  v_perm_b32 v48, v162, v160, s44
  v_perm_b32 v49, v166, v164, s44
  v_perm_b32 v50, v170, v168, s44
  v_perm_b32 v51, v174, v172, s44
  v_accvgpr_write_b32 a208, v48
  v_accvgpr_write_b32 a209, v49
  v_accvgpr_write_b32 a210, v50
  v_accvgpr_write_b32 a211, v51
  v_perm_b32 v52, v162, v160, s45
  v_perm_b32 v53, v166, v164, s45
  v_perm_b32 v54, v170, v168, s45
  v_perm_b32 v55, v174, v172, s45
  v_accvgpr_write_b32 a212, v52
  v_accvgpr_write_b32 a213, v53
  v_accvgpr_write_b32 a214, v54
  v_accvgpr_write_b32 a215, v55
  v_perm_b32 v48, v163, v161, s44
  v_perm_b32 v49, v167, v165, s44
  v_perm_b32 v50, v171, v169, s44
  v_perm_b32 v51, v175, v173, s44
  v_accvgpr_write_b32 a216, v48
  v_accvgpr_write_b32 a217, v49
  v_accvgpr_write_b32 a218, v50
  v_accvgpr_write_b32 a219, v51
  v_perm_b32 v52, v163, v161, s45
  v_perm_b32 v53, v167, v165, s45
  v_perm_b32 v54, v171, v169, s45
  v_perm_b32 v55, v175, v173, s45
  v_accvgpr_write_b32 a220, v52
  v_accvgpr_write_b32 a221, v53
  v_accvgpr_write_b32 a222, v54
  v_accvgpr_write_b32 a223, v55
  s_waitcnt vmcnt(24)
  v_perm_b32 v48, v66, v64, s44
  v_perm_b32 v49, v70, v68, s44
  v_perm_b32 v50, v74, v72, s44
  v_perm_b32 v51, v78, v76, s44
  v_accvgpr_write_b32 a224, v48
  v_accvgpr_write_b32 a225, v49
  v_accvgpr_write_b32 a226, v50
  v_accvgpr_write_b32 a227, v51
  v_perm_b32 v52, v66, v64, s45
  v_perm_b32 v53, v70, v68, s45
  v_perm_b32 v54, v74, v72, s45
  v_perm_b32 v55, v78, v76, s45
  v_accvgpr_write_b32 a228, v52
  v_accvgpr_write_b32 a229, v53
  v_accvgpr_write_b32 a230, v54
  v_accvgpr_write_b32 a231, v55
  v_perm_b32 v48, v67, v65, s44
  v_perm_b32 v49, v71, v69, s44
  v_perm_b32 v50, v75, v73, s44
  v_perm_b32 v51, v79, v77, s44
  v_accvgpr_write_b32 a232, v48
  v_accvgpr_write_b32 a233, v49
  v_accvgpr_write_b32 a234, v50
  v_accvgpr_write_b32 a235, v51
  v_perm_b32 v52, v67, v65, s45
  v_perm_b32 v53, v71, v69, s45
  v_perm_b32 v54, v75, v73, s45
  v_perm_b32 v55, v79, v77, s45
  v_accvgpr_write_b32 a236, v52
  v_accvgpr_write_b32 a237, v53
  v_accvgpr_write_b32 a238, v54
  v_accvgpr_write_b32 a239, v55
  s_waitcnt vmcnt(16)
  v_perm_b32 v48, v82, v80, s44
  v_perm_b32 v49, v86, v84, s44
  v_perm_b32 v50, v90, v88, s44
  v_perm_b32 v51, v94, v92, s44
  v_accvgpr_write_b32 a240, v48
  v_accvgpr_write_b32 a241, v49
  v_accvgpr_write_b32 a242, v50
  v_accvgpr_write_b32 a243, v51
  v_perm_b32 v52, v82, v80, s45
  v_perm_b32 v53, v86, v84, s45
  v_perm_b32 v54, v90, v88, s45
  v_perm_b32 v55, v94, v92, s45
  v_accvgpr_write_b32 a244, v52
  v_accvgpr_write_b32 a245, v53
  v_accvgpr_write_b32 a246, v54
  v_accvgpr_write_b32 a247, v55
  v_perm_b32 v48, v83, v81, s44
  v_perm_b32 v49, v87, v85, s44
  v_perm_b32 v50, v91, v89, s44
  v_perm_b32 v51, v95, v93, s44
  v_accvgpr_write_b32 a248, v48
  v_accvgpr_write_b32 a249, v49
  v_accvgpr_write_b32 a250, v50
  v_accvgpr_write_b32 a251, v51
  v_perm_b32 v52, v83, v81, s45
  v_perm_b32 v53, v87, v85, s45
  v_perm_b32 v54, v91, v89, s45
  v_perm_b32 v55, v95, v93, s45
  v_accvgpr_write_b32 a252, v52
  v_accvgpr_write_b32 a253, v53
  v_accvgpr_write_b32 a254, v54
  v_accvgpr_write_b32 a255, v55
  s_waitcnt vmcnt(0)
  s_barrier
  s_cmp_ge_u32 s60, 4
  s_cbranch_scc1 L_oh
  s_cmp_lg_u32 s17, 0
  s_cbranch_scc1 g_ar_129
  s_lshl_b32 s36, s89, 3
  s_lshl_b64 s[36:37], 1, s36
  v_lshlrev_b32 v52, 3, s91
  v_mov_b32 v48, s36
  v_mov_b32 v49, s37
  s_mov_b64 exec, 1
  global_atomic_add_x2 v[50:51], v52, v[48:49], s[12:13] sc0
  s_mov_b64 exec, -1
g_ar_129:
  s_waitcnt vmcnt(0)
  s_cmp_lg_u32 s17, 0
  s_cbranch_scc1 g_af_130
  v_readfirstlane_b32 s36, v50
  v_readfirstlane_b32 s37, v51
  s_add_u32 s38, s36, s37
  s_mul_i32 s38, s38, 0x01010101
  s_lshr_b32 s38, s38, 24
  s_cmp_lg_u32 s38, 15
  s_cbranch_scc1 g_af_130
  s_lshl_b32 s38, s89, 3
  s_lshr_b64 s[36:37], s[36:37], s38
  s_and_b32 s36, s36, 0xff
  s_cmp_eq_u32 s36, 15
  s_cselect_b32 s36, 1, 2
  v_mov_b32 v48, s36
  v_lshrrev_b32 v52, 1, v52
  s_mov_b64 exec, 1
  global_store_dword v52, v48, s[12:13] offset:128 sc1
  s_mov_b64 exec, -1
g_af_130:
  s_lshr_b32 s26, s60, 1
  s_cmp_lg_u32 s26, 1
  s_cbranch_scc1 L_ow
  s_and_b32 s28, s85, 28
  s_or_b32 s28, s28, 1
  s_lshl_b32 s27, s28, 6
  s_add_u32 s27, s27, 245104640
  s_mov_b32 s26, 0
g_h_131:
  buffer_load_dwordx2 v[60:61], off, s[4:7], s27 sc1
  s_add_u32 s26, s26, 1
  s_cmp_gt_u32 s26, 1048576
  s_cbranch_scc1 L_end
  s_waitcnt vmcnt(0)
  v_and_or_b32 v60, v61, -1, v60
  v_cmp_eq_u32 vcc, 0, v60
  s_cbranch_vccnz g_h_131
  s_mov_b32 s10, 1835008
  s_load_dwordx2 s[8:9], s[0:1], 72
  s_mul_i32 s26, s77, 14336
  s_sub_u32 s26, s26, 1835008
  s_waitcnt lgkmcnt(0)
  buffer_load_dwordx4 v[64:67], v0, s[8:11], s26 offen offset:0
  buffer_load_dwordx4 v[64:67], v0, s[8:11], s26 offen offset:1024
  buffer_load_dwordx4 v[64:67], v0, s[8:11], s26 offen offset:2048
  buffer_load_dwordx4 v[64:67], v0, s[8:11], s26 offen offset:3072
  s_add_u32 s26, s26, 4096
  buffer_load_dwordx4 v[64:67], v0, s[8:11], s26 offen offset:0
  buffer_load_dwordx4 v[64:67], v0, s[8:11], s26 offen offset:1024
  buffer_load_dwordx4 v[64:67], v0, s[8:11], s26 offen offset:2048
  buffer_load_dwordx4 v[64:67], v0, s[8:11], s26 offen offset:3072
  s_add_u32 s26, s26, 4096
  buffer_load_dwordx4 v[64:67], v0, s[8:11], s26 offen offset:0
  buffer_load_dwordx4 v[64:67], v0, s[8:11], s26 offen offset:1024
  buffer_load_dwordx4 v[64:67], v0, s[8:11], s26 offen offset:2048
  buffer_load_dwordx4 v[64:67], v0, s[8:11], s26 offen offset:3072
  s_add_u32 s26, s26, 4096
  buffer_load_dwordx4 v[64:67], v0, s[8:11], s26 offen offset:0
  buffer_load_dwordx4 v[64:67], v0, s[8:11], s26 offen offset:1024
  s_load_dwordx2 s[8:9], s[0:1], 80
  s_mul_i32 s26, s77, 14336
  s_sub_u32 s26, s26, 1835008
  s_waitcnt lgkmcnt(0)
  buffer_load_dwordx4 v[64:67], v0, s[8:11], s26 offen offset:0
  buffer_load_dwordx4 v[64:67], v0, s[8:11], s26 offen offset:1024
  buffer_load_dwordx4 v[64:67], v0, s[8:11], s26 offen offset:2048
  buffer_load_dwordx4 v[64:67], v0, s[8:11], s26 offen offset:3072
  s_add_u32 s26, s26, 4096
  buffer_load_dwordx4 v[64:67], v0, s[8:11], s26 offen offset:0
  buffer_load_dwordx4 v[64:67], v0, s[8:11], s26 offen offset:1024
  buffer_load_dwordx4 v[64:67], v0, s[8:11], s26 offen offset:2048
  buffer_load_dwordx4 v[64:67], v0, s[8:11], s26 offen offset:3072
  s_add_u32 s26, s26, 4096
  buffer_load_dwordx4 v[64:67], v0, s[8:11], s26 offen offset:0
  buffer_load_dwordx4 v[64:67], v0, s[8:11], s26 offen offset:1024
  buffer_load_dwordx4 v[64:67], v0, s[8:11], s26 offen offset:2048
  buffer_load_dwordx4 v[64:67], v0, s[8:11], s26 offen offset:3072
  s_add_u32 s26, s26, 4096
  buffer_load_dwordx4 v[64:67], v0, s[8:11], s26 offen offset:0
  buffer_load_dwordx4 v[64:67], v0, s[8:11], s26 offen offset:1024
  s_load_dwordx2 s[8:9], s[0:1], 88
  s_mul_i32 s26, s77, 14336
  s_sub_u32 s26, s26, 1835008
  s_waitcnt lgkmcnt(0)
  buffer_load_dwordx4 v[64:67], v0, s[8:11], s26 offen offset:0
  buffer_load_dwordx4 v[64:67], v0, s[8:11], s26 offen offset:1024
  buffer_load_dwordx4 v[64:67], v0, s[8:11], s26 offen offset:2048
  buffer_load_dwordx4 v[64:67], v0, s[8:11], s26 offen offset:3072
  s_add_u32 s26, s26, 4096
  buffer_load_dwordx4 v[64:67], v0, s[8:11], s26 offen offset:0
  buffer_load_dwordx4 v[64:67], v0, s[8:11], s26 offen offset:1024
  buffer_load_dwordx4 v[64:67], v0, s[8:11], s26 offen offset:2048
  buffer_load_dwordx4 v[64:67], v0, s[8:11], s26 offen offset:3072
  s_add_u32 s26, s26, 4096
  buffer_load_dwordx4 v[64:67], v0, s[8:11], s26 offen offset:0
  buffer_load_dwordx4 v[64:67], v0, s[8:11], s26 offen offset:1024
  buffer_load_dwordx4 v[64:67], v0, s[8:11], s26 offen offset:2048
  buffer_load_dwordx4 v[64:67], v0, s[8:11], s26 offen offset:3072
  s_add_u32 s26, s26, 4096
  buffer_load_dwordx4 v[64:67], v0, s[8:11], s26 offen offset:0
  buffer_load_dwordx4 v[64:67], v0, s[8:11], s26 offen offset:1024
L_ow:
  v_mbcnt_lo_u32_b32 v60, -1, 0
  v_and_b32 v60, 0, v60
  v_add_lshl_u32 v60, v60, s91, 2
  s_mov_b32 s26, 0
g_wt_132:
  global_load_dword v61, v60, s[12:13] offset:128 sc1
  s_add_u32 s26, s26, 1
  s_cmp_gt_u32 s26, 1048576
  s_cbranch_scc1 L_end
  s_waitcnt vmcnt(0)
  v_cmp_eq_u32 vcc, 0, v61
  v_readfirstlane_b32 s27, v61
  s_cbranch_vccnz g_wt_132
  s_mov_b32 s89, s27
L_oh:
  s_cmp_lg_u32 s89, 1
  s_cbranch_scc1 L_o_x
  s_mov_b32 s62, 1
  s_mov_b32 s42, 0
  s_mov_b32 s3, 0
  s_mov_b32 s46, 0
  s_mov_b32 s65, 0
  s_mov_b32 s66, 0
  s_mov_b32 s76, 0
  s_mov_b32 s55, 0
  s_mov_b32 s48, 0
  s_mov_b32 s56, 0
  s_mov_b32 s84, 268435456
  s_mov_b32 s86, s41
  s_mov_b32 s49, s60
  s_mul_i32 s63, s49, 257
  s_or_b32 s63, s63, 1179648
  s_lshr_b32 s57, s60, 2
  s_cbranch_scc1 o_help_144
o_round_133:
  s_max_u32 s46, s46, s3
  s_cmp_lg_u32 s3, 0
  s_mov_b32 s3, 0
  s_cbranch_scc1 d_g_149
  s_mov_b32 s67, 0
d_w_148:
  s_min_u32 s26, s49, 71
  s_lshl_b32 s26, s26, 12
  s_add_u32 s27, s26, 243494912
  s_add_u32 s26, s26, 243486720
  buffer_load_dword v248, v246, s[4:7], s26 offen sc1
  buffer_load_dword v249, v246, s[4:7], s27 offen sc1
  s_add_u32 s67, s67, 1
  s_cmp_gt_u32 s67, 1048576
  s_cbranch_scc1 L_end
  s_waitcnt vmcnt(0)
  s_mov_b64 exec, 1
  buffer_store_dword v38, off, s[4:7], s84 sc1
  s_mov_b64 exec, -1
  s_mov_b32 s84, 268435456
  v_min_u32 v162, v248, v249
  v_max_u32 v163, v248, v249
  v_cmp_eq_u32 vcc, 0, v162
  s_cbranch_vccnz d_w_148
  v_max_u32_dpp v163, v163, v163 row_ror:8 row_mask:0xf bank_mask:0xf
  s_nop 1
  v_max_u32_dpp v163, v163, v163 row_ror:4 row_mask:0xf bank_mask:0xf
  s_nop 1
  v_max_u32_dpp v163, v163, v163 row_ror:2 row_mask:0xf bank_mask:0xf
  s_nop 1
  v_max_u32_dpp v163, v163, v163 row_ror:1 row_mask:0xf bank_mask:0xf
  s_nop 0
  v_readlane_b32 s28, v163, 0
  v_readlane_b32 s29, v163, 16
  v_readlane_b32 s30, v163, 32
  v_readlane_b32 s31, v163, 48
  s_max_u32 s28, s28, s29
  s_max_u32 s30, s30, s31
  s_max_u32 s46, s46, s28
  s_max_u32 s46, s46, s30
d_g_149:
  s_lshr_b32 s27, s49, 2
  s_andn2_b32 s52, 0xfff, s46
  s_lshr_b32 s52, s52, 5
  s_min_u32 s52, s52, 64
  s_add_u32 s26, s52, 3
  v_readlane_b32 s89, v247, s27
  s_sub_u32 s26, s26, s60
  s_lshr_b32 s26, s26, 2
  s_bfm_b32 s54, s26, 0
  s_add_u32 s53, s63, 1028
  s_cmp_lt_u32 s49, 60
  s_cselect_b32 s53, s53, 0
  s_cmp_lt_u32 s49, 64
  s_cselect_b32 s26, 3, 1
  s_sub_i32 s26, s27, s26
  s_max_i32 s26, s26, 0
  s_min_u32 s26, s26, 16
  s_bfm_b32 s58, s26, 0
  s_cmp_eq_u32 s27, 16
  s_cselect_b32 s59, 2, 1
  s_cmp_eq_u32 s27, 17
  s_cselect_b32 s59, 0, s59
  s_cmp_eq_u32 s27, 18
  s_cselect_b32 s59, 64, s59
  s_cselect_b32 s50, 0, -1
  s_cselect_b32 s89, 0, s89
  s_cbranch_scc1 o_dl_145
  s_cmp_eq_u32 s27, 16
  s_cbranch_scc1 o_dl_145_a
o_pick_137:
  s_cmp_eq_u32 s59, 0
  s_cbranch_scc1 o_none_141
  s_sub_u32 s59, s59, 1
  s_andn2_b32 s26, s58, s55
  s_and_b32 s26, s26, s54
  s_cbranch_scc1 o_ga_138
  s_and_b32 s26, s55, s50
  s_or_b32 s26, s26, s56
  s_or_b32 s26, s26, s54
  s_andn2_b32 s26, s58, s26
  s_cbranch_scc0 o_none_141
  s_cmp_ge_u32 s46, s89
  s_cbranch_scc1 o_gb_139
o_ga_138:
  s_ff1_i32_b32 s26, s26
  s_bitset1_b32 s55, s26
  s_mov_b32 s64, 1327168
  s_mov_b32 s27, s64
  s_branch o_gd_140
o_none_141:
  s_cmp_lt_u32 s49, 60
  s_cbranch_scc1 o_nn_142
  s_cmp_eq_u32 s50, 0
  s_cbranch_scc1 o_nn_142
  s_and_b32 s26, s63, 1097728
  s_cmp_eq_u32 s26, 1048576
  s_cbranch_scc1 o_nn_142
  s_cmp_lt_u32 s49, 64
  s_cbranch_scc1 o_adv_143
  s_and_b32 s26, s65, 1097728
  s_cmp_lg_u32 s26, 1048576
  s_cbranch_scc1 o_adv_143
o_nn_142:
  s_mov_b32 s64, s53
  s_mov_b32 s51, 0
  s_branch o_task_134
o_gb_139:
  s_ff1_i32_b32 s26, s26
  s_bitset1_b32 s56, s26
  s_andn2_b32 s27, 31, s46
  s_or_b32 s27, s27, 32
  s_lshl_b32 s27, s27, 22
  s_or_b32 s27, s27, 1474688
  s_mov_b32 s64, 1474624
o_gd_140:
  s_lshl4_add_u32 s48, s48, s26
  s_and_b32 s28, s26, s57
  s_lshr_b32 s26, s26, s57
  s_lshl2_add_u32 s26, s26, s60
  s_add_u32 s26, s26, s28
  s_cmp_eq_u32 s26, s52
  s_cselect_b32 s64, s27, s64
  s_mul_i32 s26, s26, 257
  s_or_b32 s64, s64, s26
  s_mov_b32 s51, 1
o_task_134:
  s_cmp_eq_u32 s63, 0
  s_cbranch_scc1 o_nofl_135
  s_cmp_lg_u32 s66, 0
  s_cbranch_scc1 o_have_151
  s_mov_b32 s67, 0
o_w1_150:
  s_and_b32 s32, s63, 0xff
  s_lshl_b32 s32, s32, 12
  s_add_u32 s32, s32, s14
  buffer_load_dword v37, v36, s[4:7], s32 offen sc1
  s_add_u32 s67, s67, 1
  s_cmp_gt_u32 s67, 1048576
  s_cbranch_scc1 L_end
  s_waitcnt vmcnt(0)
  s_mov_b64 exec, 1
  buffer_store_dword v38, off, s[4:7], s84 sc1
  s_mov_b64 exec, -1
  s_mov_b32 s84, 268435456
  v_cmp_eq_u32 vcc, 0, v37
  s_cbranch_vccnz o_w1_150
  s_and_b32 s87, s63, 0xff
  s_lshl_b32 s33, s87, 18
  s_lshl_b32 s32, s87, 19
  s_add_u32 m0, s22, 0
  s_add_u32 s33, s33, s19
  buffer_load_dwordx4 v0, s[4:7], s33 offen offset:0 sc1 lds
  buffer_load_dwordx4 v0, s[4:7], s33 offen offset:1024 sc1 lds
  buffer_load_dwordx4 v0, s[4:7], s33 offen offset:2048 sc1 lds
  buffer_load_dwordx4 v0, s[4:7], s33 offen offset:3072 sc1 lds
  s_add_u32 m0, s23, 0
  s_add_u32 s32, s32, s18
  buffer_load_dwordx4 v0, s[4:7], s32 offen offset:0 sc1 lds
  buffer_load_dwordx4 v0, s[4:7], s32 offen offset:1024 sc1 lds
  buffer_load_dwordx4 v0, s[4:7], s32 offen offset:2048 sc1 lds
  buffer_load_dwordx4 v0, s[4:7], s32 offen offset:3072 sc1 lds
  s_add_u32 m0, m0, 4096
  s_add_u32 s32, s32, 4096
  buffer_load_dwordx4 v0, s[4:7], s32 offen offset:0 sc1 lds
  buffer_load_dwordx4 v0, s[4:7], s32 offen offset:1024 sc1 lds
  buffer_load_dwordx4 v0, s[4:7], s32 offen offset:2048 sc1 lds
  buffer_load_dwordx4 v0, s[4:7], s32 offen offset:3072 sc1 lds
  s_waitcnt vmcnt(0)
  s_barrier
o_have_151:
  ds_read_b128 v[120:123], v33 offset:0
  ds_read_b128 v[40:43], v32 offset:0
  ds_read_b128 v[56:59], v32 offset:1024
  ds_read_b128 v[124:127], v33 offset:2048
  ds_read_b128 v[44:47], v32 offset:4096
  ds_read_b128 v[60:63], v32 offset:5120
  ds_read_b128 v[128:131], v33 offset:4096
  ds_read_b128 v[48:51], v32 offset:8192
  ds_read_b128 v[64:67], v32 offset:9216
  ds_read_b128 v[132:135], v33 offset:6144
  ds_read_b128 v[52:55], v32 offset:12288
  ds_read_b128 v[68:71], v32 offset:13312
  s_cmp_lt_u32 s17, 2
  s_cselect_b32 s65, s65, 0
  s_cmp_lg_u32 s65, 0
  s_cselect_b64 s[44:45], -1, 0
  s_mov_b32 s95, s86
  s_mov_b32 s96, s42
  s_lshl_b32 s97, s43, 14
  s_add_u32 s97, s97, s95
  s_and_b32 s87, s64, 0xff
  s_lshl_b32 s87, s87, 12
  s_add_u32 s87, s87, s14
  s_and_b32 s88, s63, 0xff00
  s_lshl_b32 s88, s88, 3
  s_add_u32 s88, s88, s15
  s_and_b32 s91, s65, 63
  s_lshl_b32 s90, s91, 5
  s_add_u32 s94, s90, s85
  s_add_u32 s90, s90, s43
  s_lshl_b32 s94, s94, 10
  s_lshr_b32 s92, s65, 22
  s_xor_b32 s93, s43, 32
  s_lshl_b32 s91, s90, 10
  s_add_u32 s94, s94, 25165824
  s_cmp_eq_u32 s92, s93
  s_cselect_b32 s92, s94, s91
  s_add_u32 s92, s92, 10485760
  s_and_b32 s93, s65, 49152
  s_cselect_b32 s92, s92, s91
  s_cselect_b64 s[80:81], s[4:5], s[72:73]
  s_cselect_b32 s82, s6, s74
  s_waitcnt lgkmcnt(9)
  v_mfma_f32_16x16x32_bf16 v[104:107], v[40:43], v[120:123], v[24:27]
  v_mfma_f32_16x16x32_bf16 v[108:111], v[56:59], v[120:123], v[28:31]
  s_mov_b64 exec, s[44:45]
  buffer_load_dword v7, v255, s[4:7], s97 offen sc1
  buffer_load_dwordx4 v[184:187], v0, s[80:83], s92 offen sc1
  s_not_b64 exec, exec
  buffer_load_dword v37, v36, s[4:7], s87 offen sc1
  s_mov_b64 exec, -1
  buffer_load_dword v244, v252, s[4:7], s88 offen sc1
  s_waitcnt lgkmcnt(6)
  v_mfma_f32_16x16x32_bf16 v[104:107], v[44:47], v[124:127], v[104:107]
  v_mfma_f32_16x16x32_bf16 v[108:111], v[60:63], v[124:127], v[108:111]
  s_waitcnt lgkmcnt(3)
  v_mfma_f32_16x16x32_bf16 v[104:107], v[48:51], v[128:131], v[104:107]
  v_mfma_f32_16x16x32_bf16 v[108:111], v[64:67], v[128:131], v[108:111]
  s_waitcnt lgkmcnt(0)
  v_mfma_f32_16x16x32_bf16 v[104:107], v[52:55], v[132:135], v[104:107]
  v_mfma_f32_16x16x32_bf16 v[108:111], v[68:71], v[132:135], v[108:111]
  s_cmp_lg_u32 s76, 0
  s_cbranch_scc1 o_klds_154
  v_mov_b32 v196, 0
  v_mov_b32 v199, 0
  v_exp_f32 v56, v104
  v_exp_f32 v57, v105
  v_exp_f32 v58, v106
  v_exp_f32 v59, v107
  v_exp_f32 v60, v108
  v_exp_f32 v61, v109
  v_exp_f32 v62, v110
  v_exp_f32 v63, v111
  v_max3_f32 v116, v104, v105, v106
  v_max3_f32 v116, v107, v108, v116
  v_max3_f32 v116, v109, v110, v116
  v_add_f32 v117, v56, v57
  v_add_f32 v118, v58, v59
  v_add_f32 v117, v117, v60
  v_add_f32 v118, v118, v61
  v_add_f32 v117, v117, v62
  v_add_f32 v118, v118, v63
  s_mov_b32 s67, 0
  s_and_b32 s32, s63, 0xff00
  s_lshl_b32 s32, s32, 10
  s_add_u32 s32, s32, s20
  s_add_u32 s33, s32, 4096
o_w2_152:
  s_waitcnt vmcnt(0)
  v_cmp_eq_u32 vcc, 0, v244
  s_cbranch_vccz o_kgo_162
  s_mov_b64 exec, 1
  buffer_store_dword v38, off, s[4:7], s84 sc1
  s_mov_b64 exec, -1
  s_mov_b32 s84, 268435456
  buffer_load_dword v244, v252, s[4:7], s88 offen sc1
  s_add_u32 s67, s67, 1
  s_cmp_gt_u32 s67, 1048576
  s_cbranch_scc1 L_end
  s_branch o_w2_152
o_kgo_162:
  buffer_load_dwordx4 v[136:139], v0, s[4:7], s32 offen offset:0 sc1
  buffer_load_dwordx4 v[140:143], v0, s[4:7], s32 offen offset:1024 sc1
  buffer_load_dwordx4 v[144:147], v0, s[4:7], s32 offen offset:2048 sc1
  buffer_load_dwordx4 v[148:151], v0, s[4:7], s32 offen offset:3072 sc1
  buffer_load_dwordx2 v[200:201], v1, s[4:7], s33 offen offset:0 sc1
  buffer_load_dwordx2 v[202:203], v1, s[4:7], s33 offen offset:512 sc1
  buffer_load_dwordx2 v[204:205], v1, s[4:7], s33 offen offset:1024 sc1
  buffer_load_dwordx2 v[206:207], v1, s[4:7], s33 offen offset:1536 sc1
  buffer_load_dword v37, v36, s[4:7], s87 offen sc1
  buffer_load_dword v244, v252, s[4:7], s88 offen sc1
  s_barrier
  ds_read_b128 v[152:155], v32 offset:2048
  ds_read_b128 v[156:159], v32 offset:3072
  ds_read_b128 v[160:163], v32 offset:6144
  ds_read_b128 v[164:167], v32 offset:7168
  ds_read_b128 v[168:171], v32 offset:10240
  ds_read_b128 v[172:175], v32 offset:11264
  ds_read_b128 v[176:179], v32 offset:14336
  ds_read_b128 v[180:183], v32 offset:15360
  s_waitcnt vmcnt(9)
  v_mfma_f32_16x16x32_bf16 v[112:115], v[136:139], v[120:123], 0
  s_waitcnt vmcnt(8)
  v_mfma_f32_16x16x32_bf16 v[112:115], v[140:143], v[124:127], v[112:115]
  s_waitcnt vmcnt(7)
  v_mfma_f32_16x16x32_bf16 v[112:115], v[144:147], v[128:131], v[112:115]
  s_waitcnt vmcnt(6)
  v_mfma_f32_16x16x32_bf16 v[112:115], v[148:151], v[132:135], v[112:115]
  s_waitcnt vmcnt(2)
  s_branch o_havek_153
o_klds_154:
  s_waitcnt vmcnt(12)
  s_barrier
  ds_read_b128 v[136:139], v34 offset:0
  ds_read_b128 v[140:143], v34 offset:1024
  ds_read_b128 v[144:147], v34 offset:2048
  ds_read_b128 v[148:151], v34 offset:3072
  ds_read_b64 v[200:201], v35 offset:4096
  ds_read_b64 v[202:203], v35 offset:4608
  ds_read_b64 v[204:205], v35 offset:5120
  ds_read_b64 v[206:207], v35 offset:5632
  v_mov_b32 v196, 0
  v_mov_b32 v199, 0
  v_exp_f32 v56, v104
  v_exp_f32 v57, v105
  v_exp_f32 v58, v106
  v_exp_f32 v59, v107
  v_exp_f32 v60, v108
  v_exp_f32 v61, v109
  v_exp_f32 v62, v110
  v_exp_f32 v63, v111
  v_max3_f32 v116, v104, v105, v106
  v_max3_f32 v116, v107, v108, v116
  v_max3_f32 v116, v109, v110, v116
  s_waitcnt lgkmcnt(4)
  v_mfma_f32_16x16x32_bf16 v[112:115], v[136:139], v[120:123], 0
  ds_read_b128 v[152:155], v32 offset:2048
  ds_read_b128 v[156:159], v32 offset:3072
  v_mfma_f32_16x16x32_bf16 v[112:115], v[140:143], v[124:127], v[112:115]
  ds_read_b128 v[160:163], v32 offset:6144
  ds_read_b128 v[164:167], v32 offset:7168
  v_mfma_f32_16x16x32_bf16 v[112:115], v[144:147], v[128:131], v[112:115]
  ds_read_b128 v[168:171], v32 offset:10240
  ds_read_b128 v[172:175], v32 offset:11264
  v_mfma_f32_16x16x32_bf16 v[112:115], v[148:151], v[132:135], v[112:115]
  ds_read_b128 v[176:179], v32 offset:14336
  ds_read_b128 v[180:183], v32 offset:15360
  v_add_f32 v117, v56, v57
  v_add_f32 v118, v58, v59
  v_add_f32 v117, v117, v60
  v_add_f32 v118, v118, v61
  v_add_f32 v117, v117, v62
  v_add_f32 v118, v118, v63
o_havek_153:
  s_cmp_lg_u32 s65, 0
  s_cbranch_scc1 o_wr1_159
  s_nop 3
  v_mul_f32 v112, s24, v112
  v_mul_f32 v113, s24, v113
  v_exp_f32 v64, v112
  v_exp_f32 v65, v113
  v_max_f32 v116, v111, v116
  v_max3_f32 v116, v112, v113, v116
  v_add_f32 v117, v117, v64
  v_add_f32 v118, v118, v65
  v_add_f32 v117, v117, v118
  s_mov_b32 s28, 0x21800000
  v_mov_b32 v118, v117
  s_nop 1
  v_permlane16_swap_b32 v117, v118
  v_add_f32 v117, v117, v118
  v_mov_b32 v118, v117
  s_nop 0
  s_nop 0
  v_permlane32_swap_b32 v117, v118
  v_add_f32 v117, v117, v118
  v_cmp_lt_f32 vcc, 0x42700000, v116
  v_cmp_gt_f32 s[30:31], s28, v117
  v_rcp_f32 v117, v117
  s_or_b64 vcc, vcc, s[30:31]
  s_cbranch_vccnz o_fb_163
o_fbr_164:
  v_pk_mul_f32 v[56:57], v[56:57], v[116:117] op_sel:[0,1] op_sel_hi:[1,1]
  v_pk_mul_f32 v[58:59], v[58:59], v[116:117] op_sel:[0,1] op_sel_hi:[1,1]
  v_pk_mul_f32 v[60:61], v[60:61], v[116:117] op_sel:[0,1] op_sel_hi:[1,1]
  v_pk_mul_f32 v[62:63], v[62:63], v[116:117] op_sel:[0,1] op_sel_hi:[1,1]
  v_pk_mul_f32 v[64:65], v[64:65], v[116:117] op_sel:[0,1] op_sel_hi:[1,1]
  v_cvt_pk_bf16_f32 v116, v56, v57
  v_cvt_pk_bf16_f32 v117, v58, v59
  v_cvt_pk_bf16_f32 v118, v60, v61
  v_cvt_pk_bf16_f32 v119, v62, v63
  s_waitcnt lgkmcnt(0)
  s_nop 0
  v_mfma_f32_16x16x32_bf16 v[72:75], v[152:155], v[116:119], 0
  s_add_u32 s62, s62, 1
  v_cvt_pk_bf16_f32 v197, v64, v65
  v_cvt_pk_bf16_f32 v198, v64, v65
  v_mfma_f32_16x16x32_bf16 v[76:79], v[156:159], v[116:119], 0
  s_xor_b32 s86, s86, 524288
  v_mfma_f32_16x16x32_bf16 v[80:83], v[160:163], v[116:119], 0
  s_bfe_u32 s42, s62, 0x10001
  v_mfma_f32_16x16x32_bf16 v[84:87], v[164:167], v[116:119], 0
  s_bfe_u32 s26, s64, 65556
  v_mfma_f32_16x16x32_bf16 v[88:91], v[168:171], v[116:119], 0
  s_and_b32 s87, s64, 0xff
  v_mfma_f32_16x16x32_bf16 v[92:95], v[172:175], v[116:119], 0
  s_bfe_u32 s88, s64, 0x80008
  v_mfma_f32_16x16x32_bf16 v[96:99], v[176:179], v[116:119], 0
  s_nop 0
  v_mfma_f32_16x16x32_bf16 v[100:103], v[180:183], v[116:119], 0
  s_nop 0
  v_mfma_f32_16x16x16_bf16 v[72:75], v[200:201], v[198:199], v[72:75]
  s_nop 1
  v_mfma_f32_16x16x16_bf16 v[76:79], v[200:201], v[196:197], v[76:79]
  s_nop 1
  v_mfma_f32_16x16x16_bf16 v[80:83], v[202:203], v[198:199], v[80:83]
  s_nop 1
  v_mfma_f32_16x16x16_bf16 v[84:87], v[202:203], v[196:197], v[84:87]
  s_nop 1
  v_mfma_f32_16x16x16_bf16 v[88:91], v[204:205], v[198:199], v[88:91]
  s_nop 0
  v_cvt_pk_bf16_f32 v40, v72, v73
  v_cvt_pk_bf16_f32 v41, v74, v75
  v_mfma_f32_16x16x16_bf16 v[92:95], v[204:205], v[196:197], v[92:95]
  s_nop 0
  v_cvt_pk_bf16_f32 v42, v76, v77
  v_cvt_pk_bf16_f32 v43, v78, v79
  v_mfma_f32_16x16x16_bf16 v[96:99], v[206:207], v[198:199], v[96:99]
  s_nop 0
  ds_write_b128 v6, v[40:43] offset:0
  v_cvt_pk_bf16_f32 v44, v80, v81
  v_mfma_f32_16x16x16_bf16 v[100:103], v[206:207], v[196:197], v[100:103]
  s_nop 0
  v_cvt_pk_bf16_f32 v45, v82, v83
  v_cvt_pk_bf16_f32 v46, v84, v85
  v_cvt_pk_bf16_f32 v47, v86, v87
  ds_write_b128 v6, v[44:47] offset:1024
  v_cvt_pk_bf16_f32 v48, v88, v89
  v_cvt_pk_bf16_f32 v49, v90, v91
  v_cvt_pk_bf16_f32 v50, v92, v93
  v_cvt_pk_bf16_f32 v51, v94, v95
  ds_write_b128 v6, v[48:51] offset:2048
  v_cvt_pk_bf16_f32 v52, v96, v97
  v_cvt_pk_bf16_f32 v53, v98, v99
  v_cvt_pk_bf16_f32 v54, v100, v101
  v_cvt_pk_bf16_f32 v55, v102, v103
  ds_write_b128 v6, v[52:55] offset:3072
  s_cmp_lt_u32 s17, 2
  s_cbranch_scc1 o_wr0_158
  s_waitcnt lgkmcnt(0)
  s_barrier
  ds_read_b128 v[104:107], v3 offset:0
  ds_read_b128 v[108:111], v3 offset:512
  ds_read_b128 v[112:115], v3 offset:1024
  s_waitcnt lgkmcnt(2)
  v_mfma_f32_32x32x16_bf16 v[40:55], v[104:107], a[0:3], 0
  s_waitcnt vmcnt(0)
  v_cmp_eq_u32 vcc, 0, v37
  s_cmp_eq_u64 vcc, 0
  s_cselect_b32 s66, s26, 0
  s_cmp_eq_u32 s66, 1
  s_cselect_b32 s87, s87, 1024
  s_cselect_b32 s34, 0, 0x28000
  v_mfma_f32_32x32x16_bf16 v[56:71], v[104:107], a[4:7], 0
  ds_read_b128 v[116:119], v3 offset:1536
  s_lshl_b32 s33, s87, 18
  s_lshl_b32 s32, s87, 19
  s_add_u32 m0, s22, s34
  s_add_u32 s33, s33, s19
  s_min_u32 s28, s49, 67
  v_mfma_f32_32x32x16_bf16 v[72:87], v[104:107], a[8:11], 0
  s_lshl1_add_u32 s28, s17, s28
  s_lshl_b32 s28, s28, 12
  s_add_u32 s28, s28, 243486720
  v_mfma_f32_32x32x16_bf16 v[88:103], v[104:107], a[12:15], 0
  buffer_load_dword v249, v246, s[4:7], s28 offen sc1
  s_waitcnt lgkmcnt(2)
  v_mfma_f32_32x32x16_bf16 v[40:55], v[108:111], a[16:19], v[40:55]
  buffer_load_dwordx4 v0, s[4:7], s33 offen offset:0 sc1 lds
  v_mfma_f32_32x32x16_bf16 v[56:71], v[108:111], a[20:23], v[56:71]
  ds_read_b128 v[104:107], v3 offset:2048
  v_mfma_f32_32x32x16_bf16 v[72:87], v[108:111], a[24:27], v[72:87]
  buffer_load_dwordx4 v0, s[4:7], s33 offen offset:1024 sc1 lds
  v_mfma_f32_32x32x16_bf16 v[88:103], v[108:111], a[28:31], v[88:103]
  buffer_load_dwordx4 v0, s[4:7], s33 offen offset:2048 sc1 lds
  s_waitcnt lgkmcnt(2)
  v_mfma_f32_32x32x16_bf16 v[40:55], v[112:115], a[32:35], v[40:55]
  v_mfma_f32_32x32x16_bf16 v[56:71], v[112:115], a[36:39], v[56:71]
  ds_read_b128 v[108:111], v3 offset:2560
  buffer_load_dwordx4 v0, s[4:7], s33 offen offset:3072 sc1 lds
  s_sub_u32 m0, m0, 8192
  s_sub_u32 s33, s33, 8192
  v_mfma_f32_32x32x16_bf16 v[72:87], v[112:115], a[40:43], v[72:87]
  buffer_load_dwordx4 v0, s[4:7], s33 offen offset:0 sc1 lds
  v_mfma_f32_32x32x16_bf16 v[88:103], v[112:115], a[44:47], v[88:103]
  s_waitcnt lgkmcnt(2)
  v_mfma_f32_32x32x16_bf16 v[40:55], v[116:119], a[48:51], v[40:55]
  buffer_load_dwordx4 v0, s[4:7], s33 offen offset:1024 sc1 lds
  v_mfma_f32_32x32x16_bf16 v[56:71], v[116:119], a[52:55], v[56:71]
  ds_read_b128 v[112:115], v3 offset:3072
  buffer_load_dwordx4 v0, s[4:7], s33 offen offset:2048 sc1 lds
  v_mfma_f32_32x32x16_bf16 v[72:87], v[116:119], a[56:59], v[72:87]
  v_mfma_f32_32x32x16_bf16 v[88:103], v[116:119], a[60:63], v[88:103]
  buffer_load_dwordx4 v0, s[4:7], s33 offen offset:3072 sc1 lds
  s_add_u32 m0, s23, s34
  s_add_u32 s32, s32, s18
  s_waitcnt lgkmcnt(2)
  v_mfma_f32_32x32x16_bf16 v[40:55], v[104:107], a[64:67], v[40:55]
  buffer_load_dwordx4 v0, s[4:7], s32 offen offset:0 sc1 lds
  v_mfma_f32_32x32x16_bf16 v[56:71], v[104:107], a[68:71], v[56:71]
  ds_read_b128 v[116:119], v3 offset:3584
  v_mfma_f32_32x32x16_bf16 v[72:87], v[104:107], a[72:75], v[72:87]
  buffer_load_dwordx4 v0, s[4:7], s32 offen offset:1024 sc1 lds
  s_add_i32 m0, m0, 4096
  s_add_i32 s32, s32, 4096
  v_mfma_f32_32x32x16_bf16 v[88:103], v[104:107], a[76:79], v[88:103]
  buffer_load_dwordx4 v0, s[4:7], s32 offen offset:0 sc1 lds
  s_waitcnt lgkmcnt(2)
  v_mfma_f32_32x32x16_bf16 v[40:55], v[108:111], a[80:83], v[40:55]
  v_mfma_f32_32x32x16_bf16 v[56:71], v[108:111], a[84:87], v[56:71]
  ds_read_b128 v[104:107], v3 offset:8192
  buffer_load_dwordx4 v0, s[4:7], s32 offen offset:1024 sc1 lds
  s_add_i32 m0, m0, -16384
  s_add_i32 s32, s32, -16384
  v_mfma_f32_32x32x16_bf16 v[72:87], v[108:111], a[88:91], v[72:87]
  s_and_b32 s29, s64, 0xff00
  s_lshl_b32 s29, s29, 3
  s_add_u32 s29, s29, s15
  buffer_load_dword v245, v252, s[4:7], s29 offen sc1
  v_mfma_f32_32x32x16_bf16 v[88:103], v[108:111], a[92:95], v[88:103]
  s_waitcnt lgkmcnt(2)
  v_mfma_f32_32x32x16_bf16 v[40:55], v[112:115], a[96:99], v[40:55]
  buffer_load_dwordx4 v0, s[4:7], s32 offen offset:0 sc1 lds
  v_mfma_f32_32x32x16_bf16 v[56:71], v[112:115], a[100:103], v[56:71]
  ds_read_b128 v[108:111], v3 offset:8704
  buffer_load_dwordx4 v0, s[4:7], s32 offen offset:1024 sc1 lds
  s_add_i32 m0, m0, -4096
  s_add_i32 s32, s32, -4096
  v_mfma_f32_32x32x16_bf16 v[72:87], v[112:115], a[104:107], v[72:87]
  v_mfma_f32_32x32x16_bf16 v[88:103], v[112:115], a[108:111], v[88:103]
  buffer_load_dwordx4 v0, s[4:7], s32 offen offset:0 sc1 lds
  s_waitcnt lgkmcnt(2)
  v_mfma_f32_32x32x16_bf16 v[40:55], v[116:119], a[112:115], v[40:55]
  buffer_load_dwordx4 v0, s[4:7], s32 offen offset:1024 sc1 lds
  v_mfma_f32_32x32x16_bf16 v[56:71], v[116:119], a[116:119], v[56:71]
  ds_read_b128 v[112:115], v3 offset:9216
  v_mfma_f32_32x32x16_bf16 v[72:87], v[116:119], a[120:123], v[72:87]
  buffer_load_dwordx4 v0, s[4:7], s32 offen offset:2048 sc1 lds
  v_mfma_f32_32x32x16_bf16 v[88:103], v[116:119], a[124:127], v[88:103]
  buffer_load_dwordx4 v0, s[4:7], s32 offen offset:3072 sc1 lds
  s_add_i32 m0, m0, 4096
  s_add_i32 s32, s32, 4096
  s_waitcnt lgkmcnt(2)
  v_mfma_f32_32x32x16_bf16 v[40:55], v[104:107], a[128:131], v[40:55]
  v_mfma_f32_32x32x16_bf16 v[56:71], v[104:107], a[132:135], v[56:71]
  ds_read_b128 v[116:119], v3 offset:9728
  buffer_load_dwordx4 v0, s[4:7], s32 offen offset:2048 sc1 lds
  v_mfma_f32_32x32x16_bf16 v[72:87], v[104:107], a[136:139], v[72:87]
  buffer_load_dwordx4 v0, s[4:7], s32 offen offset:3072 sc1 lds
  s_add_i32 m0, m0, 16384
  s_add_i32 s32, s32, 16384
  v_mfma_f32_32x32x16_bf16 v[88:103], v[104:107], a[140:143], v[88:103]
  s_waitcnt lgkmcnt(2)
  v_mfma_f32_32x32x16_bf16 v[40:55], v[108:111], a[144:147], v[40:55]
  buffer_load_dwordx4 v0, s[4:7], s32 offen offset:2048 sc1 lds
  v_mfma_f32_32x32x16_bf16 v[56:71], v[108:111], a[148:151], v[56:71]
  ds_read_b128 v[104:107], v3 offset:10240
  buffer_load_dwordx4 v0, s[4:7], s32 offen offset:3072 sc1 lds
  s_add_i32 m0, m0, -4096
  s_add_i32 s32, s32, -4096
  v_mfma_f32_32x32x16_bf16 v[72:87], v[108:111], a[152:155], v[72:87]
  v_mfma_f32_32x32x16_bf16 v[88:103], v[108:111], a[156:159], v[88:103]
  buffer_load_dwordx4 v0, s[4:7], s32 offen offset:2048 sc1 lds
  s_waitcnt lgkmcnt(2)
  v_mfma_f32_32x32x16_bf16 v[40:55], v[112:115], a[160:163], v[40:55]
  buffer_load_dwordx4 v0, s[4:7], s32 offen offset:3072 sc1 lds
  v_mfma_f32_32x32x16_bf16 v[56:71], v[112:115], a[164:167], v[56:71]
  ds_read_b128 v[108:111], v3 offset:10752
  v_mfma_f32_32x32x16_bf16 v[72:87], v[112:115], a[168:171], v[72:87]
  v_mfma_f32_32x32x16_bf16 v[88:103], v[112:115], a[172:175], v[88:103]
  s_waitcnt lgkmcnt(2)
  v_mfma_f32_32x32x16_bf16 v[40:55], v[116:119], a[176:179], v[40:55]
  v_mfma_f32_32x32x16_bf16 v[56:71], v[116:119], a[180:183], v[56:71]
  ds_read_b128 v[112:115], v3 offset:11264
  v_mfma_f32_32x32x16_bf16 v[72:87], v[116:119], a[184:187], v[72:87]
  v_mfma_f32_32x32x16_bf16 v[88:103], v[116:119], a[188:191], v[88:103]
  s_waitcnt lgkmcnt(2)
  v_mfma_f32_32x32x16_bf16 v[40:55], v[104:107], a[192:195], v[40:55]
  v_mfma_f32_32x32x16_bf16 v[56:71], v[104:107], a[196:199], v[56:71]
  ds_read_b128 v[116:119], v3 offset:11776
  s_waitcnt vmcnt(12)
  v_cmp_eq_u32 vcc, 0, v245
  s_cmp_eq_u64 vcc, 0
  s_cselect_b32 s76, s26, 0
  s_and_b32 s76, s76, 1
  s_cselect_b32 s88, s88, 1024
  s_waitcnt lgkmcnt(2)
  v_mfma_f32_32x32x16_bf16 v[40:55], v[108:111], a[208:211], v[40:55]
  s_lshl_b32 s32, s88, 18
  s_mov_b32 m0, s40
  s_add_u32 s32, s32, s21
  buffer_load_dwordx4 v0, s[4:7], s32 offen offset:0 sc1 lds
  v_mfma_f32_32x32x16_bf16 v[56:71], v[108:111], a[212:215], v[56:71]
  buffer_load_dwordx4 v0, s[4:7], s32 offen offset:1024 sc1 lds
  s_waitcnt lgkmcnt(1)
  v_mfma_f32_32x32x16_bf16 v[40:55], v[112:115], a[224:227], v[40:55]
  buffer_load_dwordx4 v0, s[4:7], s32 offen offset:2048 sc1 lds
  s_sub_u32 m0, m0, 8192
  s_sub_u32 s32, s32, 8192
  v_mfma_f32_32x32x16_bf16 v[56:71], v[112:115], a[228:231], v[56:71]
  buffer_load_dwordx4 v0, s[4:7], s32 offen offset:0 sc1 lds
  s_waitcnt lgkmcnt(0)
  v_mfma_f32_32x32x16_bf16 v[40:55], v[116:119], a[240:243], v[40:55]
  buffer_load_dwordx4 v0, s[4:7], s32 offen offset:1024 sc1 lds
  v_mfma_f32_32x32x16_bf16 v[56:71], v[116:119], a[244:247], v[56:71]
  buffer_load_dwordx4 v0, s[4:7], s32 offen offset:2048 sc1 lds
  v_cmp_eq_u32 vcc, 0, v249
  v_max_u32_dpp v249, v249, v249 row_ror:8 row_mask:0xf bank_mask:0xf
  s_nop 0
  v_mfma_f32_32x32x16_bf16 v[72:87], v[104:107], a[200:203], v[72:87]
  v_max_u32_dpp v249, v249, v249 row_ror:4 row_mask:0xf bank_mask:0xf
  s_nop 0
  s_nop 0
  v_max_u32_dpp v249, v249, v249 row_ror:2 row_mask:0xf bank_mask:0xf
  s_nop 0
  s_nop 0
  v_max_u32_dpp v249, v249, v249 row_ror:1 row_mask:0xf bank_mask:0xf
  s_nop 0
  v_mfma_f32_32x32x16_bf16 v[88:103], v[104:107], a[204:207], v[88:103]
  v_mov_b32 v248, v249
  s_nop 0
  s_nop 0
  v_permlane16_swap_b32 v249, v248
  v_max_u32 v249, v249, v248
  v_mfma_f32_32x32x16_bf16 v[72:87], v[108:111], a[216:219], v[72:87]
  v_mov_b32 v248, v249
  s_nop 0
  s_nop 0
  v_permlane32_swap_b32 v249, v248
  v_max_u32 v249, v249, v248
  s_cmp_eq_u64 vcc, 0
  s_cselect_b32 s28, 4, 0
  v_mfma_f32_32x32x16_bf16 v[88:103], v[108:111], a[220:223], v[88:103]
  s_lshl_b32 s26, s76, 1
  s_or_b32 s26, s26, s66
  s_or_b32 s26, s26, s28
  v_mov_b32 v248, s26
  ds_write_b64 v39, v[248:249]
  v_mfma_f32_32x32x16_bf16 v[72:87], v[112:115], a[232:235], v[72:87]
  v_cvt_pk_bf16_f32 v212, v40, v56
  v_cvt_pk_bf16_f32 v214, v41, v57
  v_cvt_pk_bf16_f32 v216, v42, v58
  v_cvt_pk_bf16_f32 v218, v43, v59
  v_permlane16_swap_b32 v212, v214
  v_mfma_f32_32x32x16_bf16 v[88:103], v[112:115], a[236:239], v[88:103]
  v_cvt_pk_bf16_f32 v220, v44, v60
  v_cvt_pk_bf16_f32 v222, v45, v61
  v_permlane16_swap_b32 v216, v218
  v_bfi_b32 v212, v254, s42, v212
  v_mfma_f32_32x32x16_bf16 v[72:87], v[116:119], a[248:251], v[72:87]
  v_cvt_pk_bf16_f32 v224, v46, v62
  v_cvt_pk_bf16_f32 v226, v47, v63
  v_permlane16_swap_b32 v220, v222
  v_bfi_b32 v216, v254, s42, v216
  v_cvt_pk_bf16_f32 v228, v48, v64
  v_mfma_f32_32x32x16_bf16 v[88:103], v[116:119], a[252:255], v[88:103]
  v_cvt_pk_bf16_f32 v230, v49, v65
  v_permlane16_swap_b32 v224, v226
  v_bfi_b32 v220, v254, s42, v220
  v_cvt_pk_bf16_f32 v232, v50, v66
  v_cvt_pk_bf16_f32 v234, v51, v67
  v_permlane16_swap_b32 v228, v230
  v_bfi_b32 v224, v254, s42, v224
  v_cvt_pk_bf16_f32 v236, v52, v68
  v_cvt_pk_bf16_f32 v238, v53, v69
  v_permlane16_swap_b32 v232, v234
  v_bfi_b32 v228, v254, s42, v228
  v_cvt_pk_bf16_f32 v240, v54, v70
  v_cvt_pk_bf16_f32 v242, v55, v71
  v_permlane16_swap_b32 v236, v238
  v_bfi_b32 v232, v254, s42, v232
  v_permlane16_swap_b32 v240, v242
  v_bfi_b32 v236, v254, s42, v236
  v_bfi_b32 v240, v254, s42, v240
  v_cvt_pk_bf16_f32 v213, v72, v88
  v_cvt_pk_bf16_f32 v215, v73, v89
  v_cvt_pk_bf16_f32 v217, v74, v90
  v_cvt_pk_bf16_f32 v219, v75, v91
  s_add_u32 s78, s86, 0
  v_permlane16_swap_b32 v213, v215
  buffer_store_dwordx4 v[212:215], v4, s[4:7], s78 offen
  v_cvt_pk_bf16_f32 v221, v76, v92
  v_cvt_pk_bf16_f32 v223, v77, v93
  s_add_u32 s78, s86, 32768
  v_permlane16_swap_b32 v217, v219
  buffer_store_dwordx4 v[216:219], v4, s[4:7], s78 offen
  v_cvt_pk_bf16_f32 v225, v78, v94
  v_cvt_pk_bf16_f32 v227, v79, v95
  s_add_u32 s78, s86, 131072
  v_permlane16_swap_b32 v221, v223
  buffer_store_dwordx4 v[220:223], v4, s[4:7], s78 offen
  v_cvt_pk_bf16_f32 v229, v80, v96
  v_cvt_pk_bf16_f32 v231, v81, v97
  s_add_u32 s78, s86, 163840
  v_permlane16_swap_b32 v225, v227
  buffer_store_dwordx4 v[224:227], v4, s[4:7], s78 offen
  v_cvt_pk_bf16_f32 v233, v82, v98
  v_cvt_pk_bf16_f32 v235, v83, v99
  s_add_u32 s78, s86, 262144
  v_permlane16_swap_b32 v229, v231
  buffer_store_dwordx4 v[228:231], v4, s[4:7], s78 offen
  v_cvt_pk_bf16_f32 v237, v84, v100
  v_cvt_pk_bf16_f32 v239, v85, v101
  s_add_u32 s78, s86, 294912
  v_permlane16_swap_b32 v233, v235
  buffer_store_dwordx4 v[232:235], v4, s[4:7], s78 offen
  v_cvt_pk_bf16_f32 v241, v86, v102
  v_cvt_pk_bf16_f32 v243, v87, v103
  s_add_u32 s78, s86, 393216
  v_permlane16_swap_b32 v237, v239
  buffer_store_dwordx4 v[236:239], v4, s[4:7], s78 offen
  s_add_u32 s78, s86, 425984
  v_permlane16_swap_b32 v241, v243
  buffer_store_dwordx4 v[240:243], v4, s[4:7], s78 offen
  s_waitcnt vmcnt(22)
  s_branch o_we_161
o_wr0_158:
  s_waitcnt lgkmcnt(0)
  s_barrier
  ds_read_b128 v[104:107], v3 offset:0
  ds_read_b128 v[108:111], v3 offset:512
  ds_read_b128 v[112:115], v3 offset:1024
  s_waitcnt lgkmcnt(2)
  v_mfma_f32_32x32x16_bf16 v[40:55], v[104:107], a[0:3], 0
  v_mfma_f32_32x32x16_bf16 v[56:71], v[104:107], a[4:7], 0
  ds_read_b128 v[116:119], v3 offset:1536
  v_mfma_f32_32x32x16_bf16 v[72:87], v[104:107], a[8:11], 0
  v_mfma_f32_32x32x16_bf16 v[88:103], v[104:107], a[12:15], 0
  s_waitcnt lgkmcnt(2)
  v_mfma_f32_32x32x16_bf16 v[40:55], v[108:111], a[16:19], v[40:55]
  v_mfma_f32_32x32x16_bf16 v[56:71], v[108:111], a[20:23], v[56:71]
  ds_read_b128 v[104:107], v3 offset:2048
  v_mfma_f32_32x32x16_bf16 v[72:87], v[108:111], a[24:27], v[72:87]
  v_mfma_f32_32x32x16_bf16 v[88:103], v[108:111], a[28:31], v[88:103]
  s_waitcnt lgkmcnt(2)
  v_mfma_f32_32x32x16_bf16 v[40:55], v[112:115], a[32:35], v[40:55]
  v_mfma_f32_32x32x16_bf16 v[56:71], v[112:115], a[36:39], v[56:71]
  ds_read_b128 v[108:111], v3 offset:2560
  v_mfma_f32_32x32x16_bf16 v[72:87], v[112:115], a[40:43], v[72:87]
  v_mfma_f32_32x32x16_bf16 v[88:103], v[112:115], a[44:47], v[88:103]
  s_waitcnt lgkmcnt(2)
  v_mfma_f32_32x32x16_bf16 v[40:55], v[116:119], a[48:51], v[40:55]
  v_mfma_f32_32x32x16_bf16 v[56:71], v[116:119], a[52:55], v[56:71]
  ds_read_b128 v[112:115], v3 offset:3072
  v_mfma_f32_32x32x16_bf16 v[72:87], v[116:119], a[56:59], v[72:87]
  v_mfma_f32_32x32x16_bf16 v[88:103], v[116:119], a[60:63], v[88:103]
  s_waitcnt lgkmcnt(2)
  v_mfma_f32_32x32x16_bf16 v[40:55], v[104:107], a[64:67], v[40:55]
  v_mfma_f32_32x32x16_bf16 v[56:71], v[104:107], a[68:71], v[56:71]
  ds_read_b128 v[116:119], v3 offset:3584
  v_mfma_f32_32x32x16_bf16 v[72:87], v[104:107], a[72:75], v[72:87]
  v_mfma_f32_32x32x16_bf16 v[88:103], v[104:107], a[76:79], v[88:103]
  s_waitcnt lgkmcnt(2)
  v_mfma_f32_32x32x16_bf16 v[40:55], v[108:111], a[80:83], v[40:55]
  v_mfma_f32_32x32x16_bf16 v[56:71], v[108:111], a[84:87], v[56:71]
  ds_read_b128 v[104:107], v3 offset:8192
  v_mfma_f32_32x32x16_bf16 v[72:87], v[108:111], a[88:91], v[72:87]
  v_mfma_f32_32x32x16_bf16 v[88:103], v[108:111], a[92:95], v[88:103]
  s_waitcnt lgkmcnt(2)
  v_mfma_f32_32x32x16_bf16 v[40:55], v[112:115], a[96:99], v[40:55]
  v_mfma_f32_32x32x16_bf16 v[56:71], v[112:115], a[100:103], v[56:71]
  ds_read_b128 v[108:111], v3 offset:8704
  v_mfma_f32_32x32x16_bf16 v[72:87], v[112:115], a[104:107], v[72:87]
  v_mfma_f32_32x32x16_bf16 v[88:103], v[112:115], a[108:111], v[88:103]
  s_waitcnt lgkmcnt(2)
  v_mfma_f32_32x32x16_bf16 v[40:55], v[116:119], a[112:115], v[40:55]
  v_mfma_f32_32x32x16_bf16 v[56:71], v[116:119], a[116:119], v[56:71]
  ds_read_b128 v[112:115], v3 offset:9216
  v_mfma_f32_32x32x16_bf16 v[72:87], v[116:119], a[120:123], v[72:87]
  v_mfma_f32_32x32x16_bf16 v[88:103], v[116:119], a[124:127], v[88:103]
  s_waitcnt lgkmcnt(2)
  v_mfma_f32_32x32x16_bf16 v[40:55], v[104:107], a[128:131], v[40:55]
  v_mfma_f32_32x32x16_bf16 v[56:71], v[104:107], a[132:135], v[56:71]
  ds_read_b128 v[116:119], v3 offset:9728
  v_mfma_f32_32x32x16_bf16 v[72:87], v[104:107], a[136:139], v[72:87]
  v_mfma_f32_32x32x16_bf16 v[88:103], v[104:107], a[140:143], v[88:103]
  s_waitcnt lgkmcnt(2)
  v_mfma_f32_32x32x16_bf16 v[40:55], v[108:111], a[144:147], v[40:55]
  v_mfma_f32_32x32x16_bf16 v[56:71], v[108:111], a[148:151], v[56:71]
  ds_read_b128 v[104:107], v3 offset:10240
  v_mfma_f32_32x32x16_bf16 v[72:87], v[108:111], a[152:155], v[72:87]
  v_mfma_f32_32x32x16_bf16 v[88:103], v[108:111], a[156:159], v[88:103]
  s_waitcnt lgkmcnt(2)
  v_mfma_f32_32x32x16_bf16 v[40:55], v[112:115], a[160:163], v[40:55]
  v_mfma_f32_32x32x16_bf16 v[56:71], v[112:115], a[164:167], v[56:71]
  ds_read_b128 v[108:111], v3 offset:10752
  v_mfma_f32_32x32x16_bf16 v[72:87], v[112:115], a[168:171], v[72:87]
  v_mfma_f32_32x32x16_bf16 v[88:103], v[112:115], a[172:175], v[88:103]
  s_waitcnt lgkmcnt(2)
  v_mfma_f32_32x32x16_bf16 v[40:55], v[116:119], a[176:179], v[40:55]
  v_mfma_f32_32x32x16_bf16 v[56:71], v[116:119], a[180:183], v[56:71]
  ds_read_b128 v[112:115], v3 offset:11264
  v_mfma_f32_32x32x16_bf16 v[72:87], v[116:119], a[184:187], v[72:87]
  v_mfma_f32_32x32x16_bf16 v[88:103], v[116:119], a[188:191], v[88:103]
  s_waitcnt lgkmcnt(2)
  v_mfma_f32_32x32x16_bf16 v[40:55], v[104:107], a[192:195], v[40:55]
  v_mfma_f32_32x32x16_bf16 v[56:71], v[104:107], a[196:199], v[56:71]
  ds_read_b128 v[116:119], v3 offset:11776
  s_waitcnt lgkmcnt(2)
  v_mfma_f32_32x32x16_bf16 v[40:55], v[108:111], a[208:211], v[40:55]
  v_mfma_f32_32x32x16_bf16 v[56:71], v[108:111], a[212:215], v[56:71]
  s_waitcnt lgkmcnt(1)
  v_mfma_f32_32x32x16_bf16 v[40:55], v[112:115], a[224:227], v[40:55]
  v_mfma_f32_32x32x16_bf16 v[56:71], v[112:115], a[228:231], v[56:71]
  s_waitcnt lgkmcnt(0)
  v_mfma_f32_32x32x16_bf16 v[40:55], v[116:119], a[240:243], v[40:55]
  v_mfma_f32_32x32x16_bf16 v[56:71], v[116:119], a[244:247], v[56:71]
  v_mfma_f32_32x32x16_bf16 v[72:87], v[104:107], a[200:203], v[72:87]
  v_mfma_f32_32x32x16_bf16 v[88:103], v[104:107], a[204:207], v[88:103]
  v_cvt_pk_bf16_f32 v212, v40, v56
  v_cvt_pk_bf16_f32 v214, v41, v57
  v_cvt_pk_bf16_f32 v216, v42, v58
  v_cvt_pk_bf16_f32 v218, v43, v59
  v_permlane16_swap_b32 v212, v214
  v_mfma_f32_32x32x16_bf16 v[72:87], v[108:111], a[216:219], v[72:87]
  v_cvt_pk_bf16_f32 v220, v44, v60
  v_cvt_pk_bf16_f32 v222, v45, v61
  v_permlane16_swap_b32 v216, v218
  v_bfi_b32 v212, v254, s42, v212
  v_cvt_pk_bf16_f32 v224, v46, v62
  v_mfma_f32_32x32x16_bf16 v[88:103], v[108:111], a[220:223], v[88:103]
  v_cvt_pk_bf16_f32 v226, v47, v63
  v_permlane16_swap_b32 v220, v222
  v_bfi_b32 v216, v254, s42, v216
  v_cvt_pk_bf16_f32 v228, v48, v64
  v_mfma_f32_32x32x16_bf16 v[72:87], v[112:115], a[232:235], v[72:87]
  v_cvt_pk_bf16_f32 v230, v49, v65
  v_permlane16_swap_b32 v224, v226
  v_bfi_b32 v220, v254, s42, v220
  v_cvt_pk_bf16_f32 v232, v50, v66
  v_cvt_pk_bf16_f32 v234, v51, v67
  v_mfma_f32_32x32x16_bf16 v[88:103], v[112:115], a[236:239], v[88:103]
  v_permlane16_swap_b32 v228, v230
  v_bfi_b32 v224, v254, s42, v224
  v_cvt_pk_bf16_f32 v236, v52, v68
  v_cvt_pk_bf16_f32 v238, v53, v69
  v_mfma_f32_32x32x16_bf16 v[72:87], v[116:119], a[248:251], v[72:87]
  v_permlane16_swap_b32 v232, v234
  v_bfi_b32 v228, v254, s42, v228
  v_cvt_pk_bf16_f32 v240, v54, v70
  v_cvt_pk_bf16_f32 v242, v55, v71
  v_permlane16_swap_b32 v236, v238
  v_mfma_f32_32x32x16_bf16 v[88:103], v[116:119], a[252:255], v[88:103]
  v_bfi_b32 v232, v254, s42, v232
  v_permlane16_swap_b32 v240, v242
  v_bfi_b32 v236, v254, s42, v236
  v_bfi_b32 v240, v254, s42, v240
  s_nop 7
  v_cvt_pk_bf16_f32 v213, v72, v88
  v_cvt_pk_bf16_f32 v215, v73, v89
  v_cvt_pk_bf16_f32 v217, v74, v90
  v_cvt_pk_bf16_f32 v219, v75, v91
  s_add_u32 s78, s86, 0
  v_permlane16_swap_b32 v213, v215
  buffer_store_dwordx4 v[212:215], v4, s[4:7], s78 offen
  v_cvt_pk_bf16_f32 v221, v76, v92
  v_cvt_pk_bf16_f32 v223, v77, v93
  s_add_u32 s78, s86, 32768
  v_permlane16_swap_b32 v217, v219
  buffer_store_dwordx4 v[216:219], v4, s[4:7], s78 offen
  v_cvt_pk_bf16_f32 v225, v78, v94
  v_cvt_pk_bf16_f32 v227, v79, v95
  s_add_u32 s78, s86, 131072
  v_permlane16_swap_b32 v221, v223
  buffer_store_dwordx4 v[220:223], v4, s[4:7], s78 offen
  v_cvt_pk_bf16_f32 v229, v80, v96
  v_cvt_pk_bf16_f32 v231, v81, v97
  s_add_u32 s78, s86, 163840
  v_permlane16_swap_b32 v225, v227
  buffer_store_dwordx4 v[224:227], v4, s[4:7], s78 offen
  v_cvt_pk_bf16_f32 v233, v82, v98
  v_cvt_pk_bf16_f32 v235, v83, v99
  s_add_u32 s78, s86, 262144
  v_permlane16_swap_b32 v229, v231
  buffer_store_dwordx4 v[228:231], v4, s[4:7], s78 offen
  v_cvt_pk_bf16_f32 v237, v84, v100
  v_cvt_pk_bf16_f32 v239, v85, v101
  s_add_u32 s78, s86, 294912
  v_permlane16_swap_b32 v233, v235
  buffer_store_dwordx4 v[232:235], v4, s[4:7], s78 offen
  v_cvt_pk_bf16_f32 v241, v86, v102
  v_cvt_pk_bf16_f32 v243, v87, v103
  s_add_u32 s78, s86, 393216
  v_permlane16_swap_b32 v237, v239
  buffer_store_dwordx4 v[236:239], v4, s[4:7], s78 offen
  s_add_u32 s78, s86, 425984
  v_permlane16_swap_b32 v241, v243
  buffer_store_dwordx4 v[240:243], v4, s[4:7], s78 offen
  s_branch o_we_161
o_wr1_159:
  s_nop 3
  v_mul_f32 v112, s24, v112
  v_mul_f32 v113, s24, v113
  v_exp_f32 v64, v112
  v_exp_f32 v65, v113
  v_max_f32 v116, v111, v116
  v_max3_f32 v116, v112, v113, v116
  v_add_f32 v117, v117, v64
  v_add_f32 v118, v118, v65
  v_add_f32 v117, v117, v118
  s_mov_b32 s28, 0x21800000
  v_mov_b32 v118, v117
  s_nop 1
  v_permlane16_swap_b32 v117, v118
  v_add_f32 v117, v117, v118
  v_mov_b32 v118, v117
  s_nop 0
  s_nop 0
  v_permlane32_swap_b32 v117, v118
  v_add_f32 v117, v117, v118
  s_mov_b32 s67, 0
  s_mov_b64 vcc, 0
  s_waitcnt vmcnt(3)
o_pl_167:
  v_and_b32 v7, 1, v7
  v_cmp_ne_u32 vcc, s96, v7
  s_cbranch_vccz o_pk_168
  buffer_load_dword v7, v255, s[4:7], s97 offen sc1
  s_add_u32 s67, s67, 1
  s_cmp_gt_u32 s67, 1048576
  s_cbranch_scc1 L_end
  s_waitcnt vmcnt(0)
  s_branch o_pl_167
o_pk_168:
  s_lshl_b32 s94, s43, 14
  s_add_u32 s94, s94, s95
  buffer_load_dwordx4 v[120:123], v5, s[4:7], s94 offen offset:0 sc1
  v_cmp_lt_f32 vcc, 0x42700000, v116
  v_cmp_gt_f32 s[30:31], s28, v117
  v_rcp_f32 v117, v117
  buffer_load_dwordx4 v[124:127], v5, s[4:7], s94 offen offset:512 sc1
  s_or_b64 vcc, vcc, s[30:31]
  s_cbranch_vccnz o_fb_165
o_fbr_166:
  buffer_load_dwordx4 v[128:131], v5, s[4:7], s94 offen offset:256 sc1
  v_pk_mul_f32 v[56:57], v[56:57], v[116:117] op_sel:[0,1] op_sel_hi:[1,1]
  v_pk_mul_f32 v[58:59], v[58:59], v[116:117] op_sel:[0,1] op_sel_hi:[1,1]
  v_pk_mul_f32 v[60:61], v[60:61], v[116:117] op_sel:[0,1] op_sel_hi:[1,1]
  v_pk_mul_f32 v[62:63], v[62:63], v[116:117] op_sel:[0,1] op_sel_hi:[1,1]
  v_pk_mul_f32 v[64:65], v[64:65], v[116:117] op_sel:[0,1] op_sel_hi:[1,1]
  buffer_load_dwordx4 v[132:135], v5, s[4:7], s94 offen offset:768 sc1
  v_cvt_pk_bf16_f32 v116, v56, v57
  v_cvt_pk_bf16_f32 v117, v58, v59
  v_cvt_pk_bf16_f32 v118, v60, v61
  v_cvt_pk_bf16_f32 v119, v62, v63
  s_waitcnt lgkmcnt(0)
  s_nop 0
  v_mfma_f32_16x16x32_bf16 v[72:75], v[152:155], v[116:119], 0
  s_add_u32 s62, s62, 1
  v_cvt_pk_bf16_f32 v197, v64, v65
  v_cvt_pk_bf16_f32 v198, v64, v65
  v_mfma_f32_16x16x32_bf16 v[76:79], v[156:159], v[116:119], 0
  s_add_u32 s94, s94, 4096
  buffer_load_dwordx4 v[136:139], v5, s[4:7], s94 offen offset:0 sc1
  s_xor_b32 s86, s86, 524288
  v_mfma_f32_16x16x32_bf16 v[80:83], v[160:163], v[116:119], 0
  s_bfe_u32 s42, s62, 0x10001
  v_mfma_f32_16x16x32_bf16 v[84:87], v[164:167], v[116:119], 0
  buffer_load_dwordx4 v[140:143], v5, s[4:7], s94 offen offset:512 sc1
  v_mfma_f32_16x16x32_bf16 v[88:91], v[168:171], v[116:119], 0
  v_mfma_f32_16x16x32_bf16 v[92:95], v[172:175], v[116:119], 0
  buffer_load_dwordx4 v[144:147], v5, s[4:7], s94 offen offset:256 sc1
  v_mfma_f32_16x16x32_bf16 v[96:99], v[176:179], v[116:119], 0
  v_mfma_f32_16x16x32_bf16 v[100:103], v[180:183], v[116:119], 0
  buffer_load_dwordx4 v[148:151], v5, s[4:7], s94 offen offset:768 sc1
  v_mfma_f32_16x16x16_bf16 v[72:75], v[200:201], v[198:199], v[72:75]
  s_nop 1
  v_mfma_f32_16x16x16_bf16 v[76:79], v[200:201], v[196:197], v[76:79]
  s_add_u32 s94, s94, 4096
  buffer_load_dwordx4 v[152:155], v5, s[4:7], s94 offen offset:0 sc1
  v_mfma_f32_16x16x16_bf16 v[80:83], v[202:203], v[198:199], v[80:83]
  s_nop 1
  v_mfma_f32_16x16x16_bf16 v[84:87], v[202:203], v[196:197], v[84:87]
  buffer_load_dwordx4 v[156:159], v5, s[4:7], s94 offen offset:512 sc1
  v_mfma_f32_16x16x16_bf16 v[88:91], v[204:205], v[198:199], v[88:91]
  s_nop 0
  v_cvt_pk_bf16_f32 v40, v72, v73
  v_cvt_pk_bf16_f32 v41, v74, v75
  v_mfma_f32_16x16x16_bf16 v[92:95], v[204:205], v[196:197], v[92:95]
  buffer_load_dwordx4 v[160:163], v5, s[4:7], s94 offen offset:256 sc1
  v_cvt_pk_bf16_f32 v42, v76, v77
  v_cvt_pk_bf16_f32 v43, v78, v79
  v_mfma_f32_16x16x16_bf16 v[96:99], v[206:207], v[198:199], v[96:99]
  s_nop 0
  ds_write_b128 v6, v[40:43] offset:0
  v_cvt_pk_bf16_f32 v44, v80, v81
  v_mfma_f32_16x16x16_bf16 v[100:103], v[206:207], v[196:197], v[100:103]
  buffer_load_dwordx4 v[164:167], v5, s[4:7], s94 offen offset:768 sc1
  v_cvt_pk_bf16_f32 v45, v82, v83
  v_cvt_pk_bf16_f32 v46, v84, v85
  v_cvt_pk_bf16_f32 v47, v86, v87
  ds_write_b128 v6, v[44:47] offset:1024
  v_cvt_pk_bf16_f32 v48, v88, v89
  v_cvt_pk_bf16_f32 v49, v90, v91
  v_cvt_pk_bf16_f32 v50, v92, v93
  v_cvt_pk_bf16_f32 v51, v94, v95
  s_add_u32 s94, s94, 4096
  buffer_load_dwordx4 v[168:171], v5, s[4:7], s94 offen offset:0 sc1
  ds_write_b128 v6, v[48:51] offset:2048
  v_cvt_pk_bf16_f32 v52, v96, v97
  v_cvt_pk_bf16_f32 v53, v98, v99
  v_cvt_pk_bf16_f32 v54, v100, v101
  v_cvt_pk_bf16_f32 v55, v102, v103
  ds_write_b128 v6, v[52:55] offset:3072
  buffer_load_dwordx4 v[172:175], v5, s[4:7], s94 offen offset:512 sc1
  s_and_b32 s26, s65, 49152
  s_cbranch_scc1 o_wr2_160
  s_waitcnt lgkmcnt(0)
  s_barrier
  ds_read_b128 v[104:107], v3 offset:0
  ds_read_b128 v[108:111], v3 offset:512
  ds_read_b128 v[112:115], v3 offset:1024
  buffer_load_dwordx4 v[176:179], v5, s[4:7], s94 offen offset:256 sc1
  buffer_load_dwordx4 v[180:183], v5, s[4:7], s94 offen offset:768 sc1
  s_waitcnt lgkmcnt(2)
  v_mfma_f32_32x32x16_bf16 v[40:55], v[104:107], a[0:3], 0
  v_mov_b64 v[188:189], 0
  v_mov_b64 v[190:191], 0
  v_mov_b64 v[192:193], 0
  v_mov_b64 v[194:195], 0
  s_mov_b64 exec, 1
  buffer_store_dword v38, off, s[4:7], s84 sc1
  s_mov_b64 exec, -1
  s_mov_b32 s84, 268435456
  v_mfma_f32_32x32x16_bf16 v[56:71], v[104:107], a[4:7], 0
  ds_read_b128 v[116:119], v3 offset:1536
  v_mfma_f32_32x32x16_bf16 v[72:87], v[104:107], a[8:11], 0
  v_mfma_f32_32x32x16_bf16 v[88:103], v[104:107], a[12:15], 0
  s_waitcnt vmcnt(13)
  v_xor_b32 v7, s96, v120
  v_bitop3_b32 v7, v7, v124, s96 bitop3:0xf6
  v_bitop3_b32 v7, v7, v128, s96 bitop3:0xf6
  v_bitop3_b32 v7, v7, v132, s96 bitop3:0xf6
  s_waitcnt lgkmcnt(2)
  v_mfma_f32_32x32x16_bf16 v[40:55], v[108:111], a[16:19], v[40:55]
  s_waitcnt vmcnt(9)
  v_bitop3_b32 v7, v7, v136, s96 bitop3:0xf6
  v_bitop3_b32 v7, v7, v140, s96 bitop3:0xf6
  v_bitop3_b32 v7, v7, v144, s96 bitop3:0xf6
  v_bitop3_b32 v7, v7, v148, s96 bitop3:0xf6
  s_waitcnt vmcnt(5)
  v_mfma_f32_32x32x16_bf16 v[56:71], v[108:111], a[20:23], v[56:71]
  ds_read_b128 v[104:107], v3 offset:2048
  v_bitop3_b32 v7, v7, v152, s96 bitop3:0xf6
  v_bitop3_b32 v7, v7, v156, s96 bitop3:0xf6
  v_bitop3_b32 v7, v7, v160, s96 bitop3:0xf6
  v_bitop3_b32 v7, v7, v164, s96 bitop3:0xf6
  s_waitcnt vmcnt(1)
  v_mfma_f32_32x32x16_bf16 v[72:87], v[108:111], a[24:27], v[72:87]
  v_bitop3_b32 v7, v7, v168, s96 bitop3:0xf6
  v_bitop3_b32 v7, v7, v172, s96 bitop3:0xf6
  v_bitop3_b32 v7, v7, v176, s96 bitop3:0xf6
  v_bitop3_b32 v7, v7, v180, s96 bitop3:0xf6
  v_and_b32 v7, v254, v7
  v_cmp_ne_u32 vcc, 0, v7
  s_cbranch_vccnz o_rt_169
o_bk_170:
  v_mfma_f32_32x32x16_bf16 v[88:103], v[108:111], a[28:31], v[88:103]
  v_smfmac_f32_16x16x64_bf16 v[188:191], v[16:19], v[120:127], v20
  v_lshlrev_b32 v196, 16, v184
  v_smfmac_f32_16x16x64_bf16 v[192:195], v[16:19], v[128:135], v20
  v_and_b32 v197, 0xffff0000, v184
  v_smfmac_f32_16x16x64_bf16 v[188:191], v[16:19], v[136:143], v20
  v_lshlrev_b32 v198, 16, v185
  s_waitcnt lgkmcnt(2)
  v_mfma_f32_32x32x16_bf16 v[40:55], v[112:115], a[32:35], v[40:55]
  v_smfmac_f32_16x16x64_bf16 v[192:195], v[16:19], v[144:151], v20
  v_and_b32 v199, 0xffff0000, v185
  v_smfmac_f32_16x16x64_bf16 v[188:191], v[16:19], v[152:159], v20
  v_lshlrev_b32 v200, 16, v186
  v_smfmac_f32_16x16x64_bf16 v[192:195], v[16:19], v[160:167], v20
  v_and_b32 v201, 0xffff0000, v186
  v_mfma_f32_32x32x16_bf16 v[56:71], v[112:115], a[36:39], v[56:71]
  ds_read_b128 v[108:111], v3 offset:2560
  v_smfmac_f32_16x16x64_bf16 v[188:191], v[16:19], v[168:175], v20
  v_lshlrev_b32 v202, 16, v187
  v_smfmac_f32_16x16x64_bf16 v[192:195], v[16:19], v[176:183], v20
  v_and_b32 v203, 0xffff0000, v187
  s_bfe_u32 s92, s65, 131086
  v_mfma_f32_32x32x16_bf16 v[72:87], v[112:115], a[40:43], v[72:87]
  s_lshl_b32 s92, s92, 21
  s_add_u32 s92, s92, s91
  s_add_u32 s93, s92, 27262976
  s_add_u32 s92, s92, 20971520
  v_permlane16_swap_b32 v188, v192
  v_mfma_f32_32x32x16_bf16 v[88:103], v[112:115], a[44:47], v[88:103]
  v_permlane16_swap_b32 v189, v193
  v_permlane16_swap_b32 v190, v194
  v_permlane16_swap_b32 v191, v195
  s_waitcnt lgkmcnt(2)
  v_mfma_f32_32x32x16_bf16 v[40:55], v[116:119], a[48:51], v[40:55]
  v_cvt_pk_bf16_f32 v188, 0, v188
  v_cvt_pk_bf16_f32 v189, 0, v189
  v_cvt_pk_bf16_f32 v190, 0, v190
  v_cvt_pk_bf16_f32 v191, 0, v191
  v_cvt_pk_bf16_f32 v192, 0, v192
  v_cvt_pk_bf16_f32 v193, 0, v193
  v_mfma_f32_32x32x16_bf16 v[56:71], v[116:119], a[52:55], v[56:71]
  ds_read_b128 v[112:115], v3 offset:3072
  v_cvt_pk_bf16_f32 v194, 0, v194
  v_cvt_pk_bf16_f32 v195, 0, v195
  v_add_f32 v196, v196, v188
  v_add_f32 v197, v197, v189
  v_add_f32 v198, v198, v190
  v_mfma_f32_32x32x16_bf16 v[72:87], v[116:119], a[56:59], v[72:87]
  v_add_f32 v199, v199, v191
  v_add_f32 v200, v200, v192
  v_add_f32 v201, v201, v193
  v_add_f32 v202, v202, v194
  v_add_f32 v203, v203, v195
  v_cvt_pk_bf16_f32 v120, v196, v197
  v_mfma_f32_32x32x16_bf16 v[88:103], v[116:119], a[60:63], v[88:103]
  v_cvt_pk_bf16_f32 v121, v198, v199
  v_cvt_pk_bf16_f32 v122, v200, v201
  v_cvt_pk_bf16_f32 v123, v202, v203
  v_lshlrev_b32 v196, 16, v120
  v_and_b32 v197, 0xffff0000, v120
  s_waitcnt lgkmcnt(2)
  v_mfma_f32_32x32x16_bf16 v[40:55], v[104:107], a[64:67], v[40:55]
  v_lshlrev_b32 v198, 16, v121
  v_and_b32 v199, 0xffff0000, v121
  v_lshlrev_b32 v200, 16, v122
  v_and_b32 v201, 0xffff0000, v122
  v_lshlrev_b32 v202, 16, v123
  v_and_b32 v203, 0xffff0000, v123
  v_mfma_f32_32x32x16_bf16 v[56:71], v[104:107], a[68:71], v[56:71]
  ds_read_b128 v[116:119], v3 offset:3584
  buffer_store_dwordx4 v[120:123], v0, s[4:7], s92 offen sc1
  v_add_f32 v136, v196, v197
  v_mul_f32 v137, v196, v196
  v_mfma_f32_32x32x16_bf16 v[72:87], v[104:107], a[72:75], v[72:87]
  v_add_f32 v138, v198, v199
  v_mul_f32 v139, v197, v197
  v_fmac_f32 v137, v198, v198
  v_fmac_f32 v139, v199, v199
  v_add_f32 v136, v136, v200
  v_fmac_f32 v137, v200, v200
  v_mfma_f32_32x32x16_bf16 v[88:103], v[104:107], a[76:79], v[88:103]
  v_add_f32 v138, v138, v201
  v_fmac_f32 v139, v201, v201
  v_add_f32 v136, v136, v202
  v_fmac_f32 v137, v202, v202
  v_add_f32 v138, v138, v203
  s_waitcnt lgkmcnt(2)
  v_mfma_f32_32x32x16_bf16 v[40:55], v[108:111], a[80:83], v[40:55]
  v_fmac_f32 v139, v203, v203
  v_add_f32 v136, v136, v138
  v_add_f32 v137, v137, v139
  s_nop 0
  v_add_f32_dpp v136, v136, v136 row_ror:8 row_mask:0xf bank_mask:0xf
  v_add_f32_dpp v137, v137, v137 row_ror:8 row_mask:0xf bank_mask:0xf
  s_nop 0
  v_add_f32_dpp v136, v136, v136 row_ror:4 row_mask:0xf bank_mask:0xf
  v_mfma_f32_32x32x16_bf16 v[56:71], v[108:111], a[84:87], v[56:71]
  ds_read_b128 v[104:107], v3 offset:8192
  v_add_f32_dpp v137, v137, v137 row_ror:4 row_mask:0xf bank_mask:0xf
  v_add_f32_dpp v136, v136, v136 row_ror:2 row_mask:0xf bank_mask:0xf
  s_nop 0
  v_add_f32_dpp v137, v137, v137 row_ror:2 row_mask:0xf bank_mask:0xf
  v_add_f32_dpp v136, v136, v136 row_ror:1 row_mask:0xf bank_mask:0xf
  s_nop 0
  v_add_f32_dpp v137, v137, v137 row_ror:1 row_mask:0xf bank_mask:0xf
  v_mfma_f32_32x32x16_bf16 v[72:87], v[108:111], a[88:91], v[72:87]
  v_mov_b32 v140, v136
  v_mov_b32 v141, v137
  s_nop 0
  v_permlane16_swap_b32 v136, v140
  v_permlane16_swap_b32 v137, v141
  v_mfma_f32_32x32x16_bf16 v[88:103], v[108:111], a[92:95], v[88:103]
  v_add_f32 v136, v136, v140
  v_add_f32 v137, v137, v141
  v_mov_b32 v140, v136
  v_mov_b32 v141, v137
  s_nop 0
  v_permlane32_swap_b32 v136, v140
  s_waitcnt lgkmcnt(2)
  v_mfma_f32_32x32x16_bf16 v[40:55], v[112:115], a[96:99], v[40:55]
  v_permlane32_swap_b32 v137, v141
  v_add_f32 v136, v136, v140
  v_add_f32 v137, v137, v141
  v_mul_f32 v136, 0x3b000000, v136
  v_mul_f32 v137, 0x3b000000, v137
  v_mfma_f32_32x32x16_bf16 v[56:71], v[112:115], a[100:103], v[56:71]
  ds_read_b128 v[108:111], v3 offset:8704
  v_fma_f32 v137, -v136, v136, v137
  v_cvt_pk_bf16_f32 v136, 0, v136
  v_max_f32 v137, 0, v137
  v_sub_f32 v140, v196, v136
  v_sub_f32 v141, v197, v136
  v_mfma_f32_32x32x16_bf16 v[72:87], v[112:115], a[104:107], v[72:87]
  v_cvt_pk_bf16_f32 v137, 0, v137
  v_sub_f32 v142, v198, v136
  v_sub_f32 v143, v199, v136
  v_add_f32 v137, 0x3727c5ac, v137
  v_sub_f32 v144, v200, v136
  v_sub_f32 v145, v201, v136
  v_mfma_f32_32x32x16_bf16 v[88:103], v[112:115], a[108:111], v[88:103]
  v_cvt_pk_bf16_f32 v137, 0, v137
  v_sub_f32 v146, v202, v136
  v_sub_f32 v147, v203, v136
  v_sqrt_f32 v137, v137
  s_waitcnt lgkmcnt(2)
  v_mfma_f32_32x32x16_bf16 v[40:55], v[116:119], a[112:115], v[40:55]
  v_cvt_pk_bf16_f32 v140, 0, v140
  v_cvt_pk_bf16_f32 v141, 0, v141
  v_cvt_pk_bf16_f32 v137, 0, v137
  v_cvt_pk_bf16_f32 v142, 0, v142
  v_cvt_pk_bf16_f32 v143, 0, v143
  v_rcp_f32 v137, v137
  v_mfma_f32_32x32x16_bf16 v[56:71], v[116:119], a[116:119], v[56:71]
  ds_read_b128 v[112:115], v3 offset:9216
  v_cvt_pk_bf16_f32 v144, 0, v144
  v_cvt_pk_bf16_f32 v145, 0, v145
  v_cvt_pk_bf16_f32 v146, 0, v146
  v_cvt_pk_bf16_f32 v147, 0, v147
  v_mul_f32 v140, v140, v137
  v_mfma_f32_32x32x16_bf16 v[72:87], v[116:119], a[120:123], v[72:87]
  v_mul_f32 v141, v141, v137
  v_mul_f32 v142, v142, v137
  v_mul_f32 v143, v143, v137
  v_mul_f32 v144, v144, v137
  v_mul_f32 v145, v145, v137
  v_mul_f32 v146, v146, v137
  v_mfma_f32_32x32x16_bf16 v[88:103], v[116:119], a[124:127], v[88:103]
  v_mul_f32 v147, v147, v137
  v_cvt_pk_bf16_f32 v124, v140, v141
  v_cvt_pk_bf16_f32 v125, v142, v143
  v_cvt_pk_bf16_f32 v126, v144, v145
  v_cvt_pk_bf16_f32 v127, v146, v147
  s_waitcnt lgkmcnt(2)
  v_mfma_f32_32x32x16_bf16 v[40:55], v[104:107], a[128:131], v[40:55]
  v_lshlrev_b32 v204, 16, v124
  v_and_b32 v205, 0xffff0000, v124
  v_lshlrev_b32 v206, 16, v125
  v_and_b32 v207, 0xffff0000, v125
  v_lshlrev_b32 v208, 16, v126
  v_and_b32 v209, 0xffff0000, v126
  v_mfma_f32_32x32x16_bf16 v[56:71], v[104:107], a[132:135], v[56:71]
  ds_read_b128 v[116:119], v3 offset:9728
  v_lshlrev_b32 v210, 16, v127
  v_and_b32 v211, 0xffff0000, v127
  buffer_store_dwordx4 v[124:127], v0, s[4:7], s93 offen sc1
  v_mfma_f32_32x32x16_bf16 v[72:87], v[104:107], a[136:139], v[72:87]
  v_add_f32 v196, v196, v204
  v_add_f32 v197, v197, v205
  v_add_f32 v198, v198, v206
  v_add_f32 v199, v199, v207
  v_add_f32 v200, v200, v208
  v_add_f32 v201, v201, v209
  v_mfma_f32_32x32x16_bf16 v[88:103], v[104:107], a[140:143], v[88:103]
  v_add_f32 v202, v202, v210
  v_add_f32 v203, v203, v211
  v_cvt_pk_bf16_f32 v128, v196, v197
  v_cvt_pk_bf16_f32 v129, v198, v199
  v_cvt_pk_bf16_f32 v130, v200, v201
  s_waitcnt lgkmcnt(2)
  v_mfma_f32_32x32x16_bf16 v[40:55], v[108:111], a[144:147], v[40:55]
  v_cvt_pk_bf16_f32 v131, v202, v203
  v_mul_f32 v188, v204, v8
  v_mul_f32 v189, v205, v9
  v_fmac_f32 v188, v206, v10
  v_fmac_f32 v189, v207, v11
  v_fmac_f32 v188, v208, v12
  v_mfma_f32_32x32x16_bf16 v[56:71], v[108:111], a[148:151], v[56:71]
  ds_read_b128 v[104:107], v3 offset:10240
  v_fmac_f32 v189, v209, v13
  v_fmac_f32 v188, v210, v14
  v_fmac_f32 v189, v211, v15
  v_add_f32 v188, v188, v189
  s_add_u32 s92, s91, 10485760
  v_mfma_f32_32x32x16_bf16 v[72:87], v[108:111], a[152:155], v[72:87]
  s_add_u32 s93, s91, 8388608
  buffer_store_dwordx4 v[128:131], v0, s[4:7], s92 offen sc1
  v_lshlrev_b32 v196, 16, v128
  v_and_b32 v197, 0xffff0000, v128
  v_mfma_f32_32x32x16_bf16 v[88:103], v[108:111], a[156:159], v[88:103]
  v_lshlrev_b32 v198, 16, v129
  v_and_b32 v199, 0xffff0000, v129
  v_lshlrev_b32 v200, 16, v130
  v_and_b32 v201, 0xffff0000, v130
  v_lshlrev_b32 v202, 16, v131
  s_waitcnt lgkmcnt(2)
  v_mfma_f32_32x32x16_bf16 v[40:55], v[112:115], a[160:163], v[40:55]
  v_and_b32 v203, 0xffff0000, v131
  v_add_f32 v136, v196, v197
  v_mul_f32 v137, v196, v196
  v_add_f32 v138, v198, v199
  v_mul_f32 v139, v197, v197
  v_fmac_f32 v137, v198, v198
  v_mfma_f32_32x32x16_bf16 v[56:71], v[112:115], a[164:167], v[56:71]
  ds_read_b128 v[108:111], v3 offset:10752
  v_fmac_f32 v139, v199, v199
  v_add_f32 v136, v136, v200
  v_fmac_f32 v137, v200, v200
  v_add_f32 v138, v138, v201
  v_fmac_f32 v139, v201, v201
  v_mfma_f32_32x32x16_bf16 v[72:87], v[112:115], a[168:171], v[72:87]
  v_add_f32 v136, v136, v202
  v_fmac_f32 v137, v202, v202
  v_add_f32 v138, v138, v203
  v_fmac_f32 v139, v203, v203
  v_add_f32 v136, v136, v138
  v_add_f32 v137, v137, v139
  v_mfma_f32_32x32x16_bf16 v[88:103], v[112:115], a[172:175], v[88:103]
  v_add_f32_dpp v136, v136, v136 row_ror:8 row_mask:0xf bank_mask:0xf
  v_add_f32_dpp v137, v137, v137 row_ror:8 row_mask:0xf bank_mask:0xf
  v_add_f32_dpp v188, v188, v188 row_ror:8 row_mask:0xf bank_mask:0xf
  v_add_f32_dpp v136, v136, v136 row_ror:4 row_mask:0xf bank_mask:0xf
  v_add_f32_dpp v137, v137, v137 row_ror:4 row_mask:0xf bank_mask:0xf
  s_waitcnt lgkmcnt(2)
  v_mfma_f32_32x32x16_bf16 v[40:55], v[116:119], a[176:179], v[40:55]
  v_add_f32_dpp v188, v188, v188 row_ror:4 row_mask:0xf bank_mask:0xf
  v_add_f32_dpp v136, v136, v136 row_ror:2 row_mask:0xf bank_mask:0xf
  v_add_f32_dpp v137, v137, v137 row_ror:2 row_mask:0xf bank_mask:0xf
  v_add_f32_dpp v188, v188, v188 row_ror:2 row_mask:0xf bank_mask:0xf
  v_add_f32_dpp v136, v136, v136 row_ror:1 row_mask:0xf bank_mask:0xf
  v_add_f32_dpp v137, v137, v137 row_ror:1 row_mask:0xf bank_mask:0xf
  v_mfma_f32_32x32x16_bf16 v[56:71], v[116:119], a[180:183], v[56:71]
  ds_read_b128 v[112:115], v3 offset:11264
  v_add_f32_dpp v188, v188, v188 row_ror:1 row_mask:0xf bank_mask:0xf
  v_mov_b32 v140, v136
  v_mov_b32 v141, v137
  v_mov_b32 v142, v188
  v_permlane16_swap_b32 v136, v140
  v_mfma_f32_32x32x16_bf16 v[72:87], v[116:119], a[184:187], v[72:87]
  v_permlane16_swap_b32 v137, v141
  v_permlane16_swap_b32 v188, v142
  v_add_f32 v136, v136, v140
  v_add_f32 v137, v137, v141
  v_mfma_f32_32x32x16_bf16 v[88:103], v[116:119], a[188:191], v[88:103]
  v_add_f32 v188, v188, v142
  v_mov_b32 v140, v136
  v_mov_b32 v141, v137
  v_mov_b32 v142, v188
  v_permlane32_swap_b32 v136, v140
  s_waitcnt lgkmcnt(2)
  v_mfma_f32_32x32x16_bf16 v[40:55], v[104:107], a[192:195], v[40:55]
  v_permlane32_swap_b32 v137, v141
  v_permlane32_swap_b32 v188, v142
  v_add_f32 v136, v136, v140
  v_add_f32 v137, v137, v141
  v_mfma_f32_32x32x16_bf16 v[56:71], v[104:107], a[196:199], v[56:71]
  ds_read_b128 v[116:119], v3 offset:11776
  v_add_f32 v188, v188, v142
  v_mul_f32 v136, 0x3b000000, v136
  v_mul_f32 v137, 0x3b000000, v137
  v_fma_f32 v137, -v136, v136, v137
  v_cvt_pk_bf16_f32 v136, 0, v136
  s_waitcnt lgkmcnt(2)
  v_mfma_f32_32x32x16_bf16 v[40:55], v[108:111], a[208:211], v[40:55]
  v_max_f32 v137, 0, v137
  v_sub_f32 v140, v196, v136
  v_sub_f32 v141, v197, v136
  v_cvt_pk_bf16_f32 v137, 0, v137
  v_sub_f32 v142, v198, v136
  v_sub_f32 v143, v199, v136
  v_mfma_f32_32x32x16_bf16 v[56:71], v[108:111], a[212:215], v[56:71]
  v_add_f32 v137, 0x3727c5ac, v137
  v_sub_f32 v144, v200, v136
  v_sub_f32 v145, v201, v136
  v_cvt_pk_bf16_f32 v137, 0, v137
  v_sub_f32 v146, v202, v136
  v_sub_f32 v147, v203, v136
  s_waitcnt lgkmcnt(1)
  v_mfma_f32_32x32x16_bf16 v[40:55], v[112:115], a[224:227], v[40:55]
  v_sqrt_f32 v137, v137
  v_cvt_pk_bf16_f32 v140, 0, v140
  v_cvt_pk_bf16_f32 v141, 0, v141
  v_cvt_pk_bf16_f32 v137, 0, v137
  v_cvt_pk_bf16_f32 v142, 0, v142
  v_mfma_f32_32x32x16_bf16 v[56:71], v[112:115], a[228:231], v[56:71]
  v_cvt_pk_bf16_f32 v143, 0, v143
  v_rcp_f32 v137, v137
  v_cvt_pk_bf16_f32 v144, 0, v144
  v_cvt_pk_bf16_f32 v145, 0, v145
  v_cvt_pk_bf16_f32 v146, 0, v146
  s_waitcnt lgkmcnt(0)
  v_mfma_f32_32x32x16_bf16 v[40:55], v[116:119], a[240:243], v[40:55]
  v_cvt_pk_bf16_f32 v147, 0, v147
  v_mul_f32 v140, v140, v137
  v_mul_f32 v141, v141, v137
  v_mul_f32 v142, v142, v137
  v_mul_f32 v143, v143, v137
  v_mul_f32 v144, v144, v137
  v_mfma_f32_32x32x16_bf16 v[56:71], v[116:119], a[244:247], v[56:71]
  v_mul_f32 v145, v145, v137
  v_mul_f32 v146, v146, v137
  v_mul_f32 v147, v147, v137
  v_cvt_pk_bf16_f32 v132, v140, v141
  v_cvt_pk_bf16_f32 v133, v142, v143
  v_cvt_pk_bf16_f32 v134, v144, v145
  v_mfma_f32_32x32x16_bf16 v[72:87], v[104:107], a[200:203], v[72:87]
  v_cvt_pk_bf16_f32 v135, v146, v147
  buffer_store_dwordx4 v[132:135], v0, s[4:7], s93 offen sc1
  v_cvt_pk_bf16_f32 v188, 0, v188
  v_ashrrev_i32 v189, 31, v188
  v_mfma_f32_32x32x16_bf16 v[88:103], v[104:107], a[204:207], v[88:103]
  v_or_b32 v189, 0x80000000, v189
  v_xor_b32 v188, v188, v189
  s_sub_u32 s92, 4095, s90
  v_and_b32 v188, 0xffff0000, v188
  v_or_b32 v38, s92, v188
  v_mfma_f32_32x32x16_bf16 v[72:87], v[108:111], a[216:219], v[72:87]
  s_bfe_u32 s92, s65, 196625
  s_lshl_b32 s92, s92, 18
  s_lshl_b32 s93, s90, 7
  s_add_u32 s92, s92, s93
  s_add_u32 s84, s92, 243269632
  v_cvt_pk_bf16_f32 v212, v40, v56
  v_mfma_f32_32x32x16_bf16 v[88:103], v[108:111], a[220:223], v[88:103]
  v_cvt_pk_bf16_f32 v214, v41, v57
  v_cvt_pk_bf16_f32 v216, v42, v58
  v_cvt_pk_bf16_f32 v218, v43, v59
  v_permlane16_swap_b32 v212, v214
  v_mfma_f32_32x32x16_bf16 v[72:87], v[112:115], a[232:235], v[72:87]
  v_cvt_pk_bf16_f32 v220, v44, v60
  v_cvt_pk_bf16_f32 v222, v45, v61
  v_permlane16_swap_b32 v216, v218
  v_bfi_b32 v212, v254, s42, v212
  v_cvt_pk_bf16_f32 v224, v46, v62
  v_mfma_f32_32x32x16_bf16 v[88:103], v[112:115], a[236:239], v[88:103]
  v_cvt_pk_bf16_f32 v226, v47, v63
  v_permlane16_swap_b32 v220, v222
  v_bfi_b32 v216, v254, s42, v216
  v_cvt_pk_bf16_f32 v228, v48, v64
  v_mfma_f32_32x32x16_bf16 v[72:87], v[116:119], a[248:251], v[72:87]
  v_cvt_pk_bf16_f32 v230, v49, v65
  v_permlane16_swap_b32 v224, v226
  v_bfi_b32 v220, v254, s42, v220
  v_cvt_pk_bf16_f32 v232, v50, v66
  v_cvt_pk_bf16_f32 v234, v51, v67
  v_mfma_f32_32x32x16_bf16 v[88:103], v[116:119], a[252:255], v[88:103]
  v_permlane16_swap_b32 v228, v230
  v_bfi_b32 v224, v254, s42, v224
  v_cvt_pk_bf16_f32 v236, v52, v68
  v_cvt_pk_bf16_f32 v238, v53, v69
  v_permlane16_swap_b32 v232, v234
  v_bfi_b32 v228, v254, s42, v228
  v_cvt_pk_bf16_f32 v240, v54, v70
  v_cvt_pk_bf16_f32 v242, v55, v71
  v_permlane16_swap_b32 v236, v238
  v_bfi_b32 v232, v254, s42, v232
  v_permlane16_swap_b32 v240, v242
  v_bfi_b32 v236, v254, s42, v236
  v_bfi_b32 v240, v254, s42, v240
  v_cvt_pk_bf16_f32 v213, v72, v88
  v_cvt_pk_bf16_f32 v215, v73, v89
  v_cvt_pk_bf16_f32 v217, v74, v90
  v_cvt_pk_bf16_f32 v219, v75, v91
  s_add_u32 s78, s86, 0
  v_permlane16_swap_b32 v213, v215
  buffer_store_dwordx4 v[212:215], v4, s[4:7], s78 offen
  v_cvt_pk_bf16_f32 v221, v76, v92
  v_cvt_pk_bf16_f32 v223, v77, v93
  s_add_u32 s78, s86, 32768
  v_permlane16_swap_b32 v217, v219
  buffer_store_dwordx4 v[216:219], v4, s[4:7], s78 offen
  v_cvt_pk_bf16_f32 v225, v78, v94
  v_cvt_pk_bf16_f32 v227, v79, v95
  s_add_u32 s78, s86, 131072
  v_permlane16_swap_b32 v221, v223
  buffer_store_dwordx4 v[220:223], v4, s[4:7], s78 offen
  v_cvt_pk_bf16_f32 v229, v80, v96
  v_cvt_pk_bf16_f32 v231, v81, v97
  s_add_u32 s78, s86, 163840
  v_permlane16_swap_b32 v225, v227
  buffer_store_dwordx4 v[224:227], v4, s[4:7], s78 offen
  v_cvt_pk_bf16_f32 v233, v82, v98
  v_cvt_pk_bf16_f32 v235, v83, v99
  s_add_u32 s78, s86, 262144
  v_permlane16_swap_b32 v229, v231
  buffer_store_dwordx4 v[228:231], v4, s[4:7], s78 offen
  v_cvt_pk_bf16_f32 v237, v84, v100
  v_cvt_pk_bf16_f32 v239, v85, v101
  s_add_u32 s78, s86, 294912
  v_permlane16_swap_b32 v233, v235
  buffer_store_dwordx4 v[232:235], v4, s[4:7], s78 offen
  v_cvt_pk_bf16_f32 v241, v86, v102
  v_cvt_pk_bf16_f32 v243, v87, v103
  s_add_u32 s78, s86, 393216
  v_permlane16_swap_b32 v237, v239
  buffer_store_dwordx4 v[236:239], v4, s[4:7], s78 offen
  s_add_u32 s78, s86, 425984
  v_permlane16_swap_b32 v241, v243
  buffer_store_dwordx4 v[240:243], v4, s[4:7], s78 offen
  s_waitcnt vmcnt(8)
  s_mov_b64 exec, 1
  buffer_store_dword v38, off, s[4:7], s84 sc1
  s_mov_b64 exec, -1
  s_mov_b32 s84, 268435456
  s_branch o_we_161
o_rt_169:
  s_mov_b32 s67, 0
o_rl_173:
  s_lshl_b32 s94, s43, 14
  s_add_u32 s94, s94, s95
  buffer_load_dwordx4 v[120:123], v5, s[4:7], s94 offen offset:0 sc1
  buffer_load_dwordx4 v[124:127], v5, s[4:7], s94 offen offset:512 sc1
  buffer_load_dwordx4 v[128:131], v5, s[4:7], s94 offen offset:256 sc1
  buffer_load_dwordx4 v[132:135], v5, s[4:7], s94 offen offset:768 sc1
  s_add_u32 s94, s94, 4096
  buffer_load_dwordx4 v[136:139], v5, s[4:7], s94 offen offset:0 sc1
  buffer_load_dwordx4 v[140:143], v5, s[4:7], s94 offen offset:512 sc1
  buffer_load_dwordx4 v[144:147], v5, s[4:7], s94 offen offset:256 sc1
  buffer_load_dwordx4 v[148:151], v5, s[4:7], s94 offen offset:768 sc1
  s_add_u32 s94, s94, 4096
  buffer_load_dwordx4 v[152:155], v5, s[4:7], s94 offen offset:0 sc1
  buffer_load_dwordx4 v[156:159], v5, s[4:7], s94 offen offset:512 sc1
  buffer_load_dwordx4 v[160:163], v5, s[4:7], s94 offen offset:256 sc1
  buffer_load_dwordx4 v[164:167], v5, s[4:7], s94 offen offset:768 sc1
  s_add_u32 s94, s94, 4096
  buffer_load_dwordx4 v[168:171], v5, s[4:7], s94 offen offset:0 sc1
  buffer_load_dwordx4 v[172:175], v5, s[4:7], s94 offen offset:512 sc1
  buffer_load_dwordx4 v[176:179], v5, s[4:7], s94 offen offset:256 sc1
  buffer_load_dwordx4 v[180:183], v5, s[4:7], s94 offen offset:768 sc1
  s_add_u32 s67, s67, 1
  s_cmp_gt_u32 s67, 1048576
  s_cbranch_scc1 L_end
  s_waitcnt vmcnt(0)
  v_xor_b32 v7, s96, v120
  v_bitop3_b32 v7, v7, v124, s96 bitop3:0xf6
  v_bitop3_b32 v7, v7, v128, s96 bitop3:0xf6
  v_bitop3_b32 v7, v7, v132, s96 bitop3:0xf6
  v_bitop3_b32 v7, v7, v136, s96 bitop3:0xf6
  v_bitop3_b32 v7, v7, v140, s96 bitop3:0xf6
  v_bitop3_b32 v7, v7, v144, s96 bitop3:0xf6
  v_bitop3_b32 v7, v7, v148, s96 bitop3:0xf6
  v_bitop3_b32 v7, v7, v152, s96 bitop3:0xf6
  v_bitop3_b32 v7, v7, v156, s96 bitop3:0xf6
  v_bitop3_b32 v7, v7, v160, s96 bitop3:0xf6
  v_bitop3_b32 v7, v7, v164, s96 bitop3:0xf6
  v_bitop3_b32 v7, v7, v168, s96 bitop3:0xf6
  v_bitop3_b32 v7, v7, v172, s96 bitop3:0xf6
  v_bitop3_b32 v7, v7, v176, s96 bitop3:0xf6
  v_bitop3_b32 v7, v7, v180, s96 bitop3:0xf6
  v_and_b32 v7, v254, v7
  v_cmp_ne_u32 vcc, 0, v7
  s_cbranch_vccnz o_rl_173
  s_branch o_bk_170
o_rt_171:
  s_mov_b32 s67, 0
o_rl_174:
  s_lshl_b32 s94, s43, 14
  s_add_u32 s94, s94, s95
  buffer_load_dwordx4 v[120:123], v5, s[4:7], s94 offen offset:0 sc1
  buffer_load_dwordx4 v[124:127], v5, s[4:7], s94 offen offset:512 sc1
  buffer_load_dwordx4 v[128:131], v5, s[4:7], s94 offen offset:256 sc1
  buffer_load_dwordx4 v[132:135], v5, s[4:7], s94 offen offset:768 sc1
  s_add_u32 s94, s94, 4096
  buffer_load_dwordx4 v[136:139], v5, s[4:7], s94 offen offset:0 sc1
  buffer_load_dwordx4 v[140:143], v5, s[4:7], s94 offen offset:512 sc1
  buffer_load_dwordx4 v[144:147], v5, s[4:7], s94 offen offset:256 sc1
  buffer_load_dwordx4 v[148:151], v5, s[4:7], s94 offen offset:768 sc1
  s_add_u32 s94, s94, 4096
  buffer_load_dwordx4 v[152:155], v5, s[4:7], s94 offen offset:0 sc1
  buffer_load_dwordx4 v[156:159], v5, s[4:7], s94 offen offset:512 sc1
  buffer_load_dwordx4 v[160:163], v5, s[4:7], s94 offen offset:256 sc1
  buffer_load_dwordx4 v[164:167], v5, s[4:7], s94 offen offset:768 sc1
  s_add_u32 s94, s94, 4096
  buffer_load_dwordx4 v[168:171], v5, s[4:7], s94 offen offset:0 sc1
  buffer_load_dwordx4 v[172:175], v5, s[4:7], s94 offen offset:512 sc1
  buffer_load_dwordx4 v[176:179], v5, s[4:7], s94 offen offset:256 sc1
  buffer_load_dwordx4 v[180:183], v5, s[4:7], s94 offen offset:768 sc1
  s_add_u32 s67, s67, 1
  s_cmp_gt_u32 s67, 1048576
  s_cbranch_scc1 L_end
  s_waitcnt vmcnt(0)
  v_xor_b32 v7, s96, v120
  v_bitop3_b32 v7, v7, v124, s96 bitop3:0xf6
  v_bitop3_b32 v7, v7, v128, s96 bitop3:0xf6
  v_bitop3_b32 v7, v7, v132, s96 bitop3:0xf6
  v_bitop3_b32 v7, v7, v136, s96 bitop3:0xf6
  v_bitop3_b32 v7, v7, v140, s96 bitop3:0xf6
  v_bitop3_b32 v7, v7, v144, s96 bitop3:0xf6
  v_bitop3_b32 v7, v7, v148, s96 bitop3:0xf6
  v_bitop3_b32 v7, v7, v152, s96 bitop3:0xf6
  v_bitop3_b32 v7, v7, v156, s96 bitop3:0xf6
  v_bitop3_b32 v7, v7, v160, s96 bitop3:0xf6
  v_bitop3_b32 v7, v7, v164, s96 bitop3:0xf6
  v_bitop3_b32 v7, v7, v168, s96 bitop3:0xf6
  v_bitop3_b32 v7, v7, v172, s96 bitop3:0xf6
  v_bitop3_b32 v7, v7, v176, s96 bitop3:0xf6
  v_bitop3_b32 v7, v7, v180, s96 bitop3:0xf6
  v_and_b32 v7, v254, v7
  v_cmp_ne_u32 vcc, 0, v7
  s_cbranch_vccnz o_rl_174
  s_branch o_bk_172
o_fb_163:
  v_mov_b32 v118, v116
  s_nop 1
  v_permlane16_swap_b32 v116, v118
  v_max_f32 v116, v116, v118
  v_mov_b32 v118, v116
  s_nop 0
  s_nop 0
  v_permlane32_swap_b32 v116, v118
  v_max_f32 v116, v116, v118
  v_sub_f32 v56, v104, v116
  v_sub_f32 v57, v105, v116
  v_sub_f32 v58, v106, v116
  v_sub_f32 v59, v107, v116
  v_sub_f32 v60, v108, v116
  v_sub_f32 v61, v109, v116
  v_sub_f32 v62, v110, v116
  v_sub_f32 v63, v111, v116
  v_sub_f32 v64, v112, v116
  v_sub_f32 v65, v113, v116
  v_exp_f32 v56, v56
  v_exp_f32 v57, v57
  v_exp_f32 v58, v58
  v_exp_f32 v59, v59
  v_exp_f32 v60, v60
  v_exp_f32 v61, v61
  v_exp_f32 v62, v62
  v_exp_f32 v63, v63
  v_exp_f32 v64, v64
  v_exp_f32 v65, v65
  v_add_f32 v117, v56, v57
  v_add_f32 v117, v117, v58
  v_add_f32 v117, v117, v59
  v_add_f32 v117, v117, v60
  v_add_f32 v117, v117, v61
  v_add_f32 v117, v117, v62
  v_add_f32 v117, v117, v63
  v_add_f32 v117, v117, v64
  v_add_f32 v117, v117, v65
  v_mov_b32 v118, v117
  s_nop 0
  s_nop 0
  v_permlane16_swap_b32 v117, v118
  v_add_f32 v117, v117, v118
  v_mov_b32 v118, v117
  s_nop 0
  s_nop 0
  v_permlane32_swap_b32 v117, v118
  v_add_f32 v117, v117, v118
  v_rcp_f32 v117, v117
  s_branch o_fbr_164
o_fb_165:
  v_mov_b32 v118, v116
  s_nop 1
  v_permlane16_swap_b32 v116, v118
  v_max_f32 v116, v116, v118
  v_mov_b32 v118, v116
  s_nop 0
  s_nop 0
  v_permlane32_swap_b32 v116, v118
  v_max_f32 v116, v116, v118
  v_sub_f32 v56, v104, v116
  v_sub_f32 v57, v105, v116
  v_sub_f32 v58, v106, v116
  v_sub_f32 v59, v107, v116
  v_sub_f32 v60, v108, v116
  v_sub_f32 v61, v109, v116
  v_sub_f32 v62, v110, v116
  v_sub_f32 v63, v111, v116
  v_sub_f32 v64, v112, v116
  v_sub_f32 v65, v113, v116
  v_exp_f32 v56, v56
  v_exp_f32 v57, v57
  v_exp_f32 v58, v58
  v_exp_f32 v59, v59
  v_exp_f32 v60, v60
  v_exp_f32 v61, v61
  v_exp_f32 v62, v62
  v_exp_f32 v63, v63
  v_exp_f32 v64, v64
  v_exp_f32 v65, v65
  v_add_f32 v117, v56, v57
  v_add_f32 v117, v117, v58
  v_add_f32 v117, v117, v59
  v_add_f32 v117, v117, v60
  v_add_f32 v117, v117, v61
  v_add_f32 v117, v117, v62
  v_add_f32 v117, v117, v63
  v_add_f32 v117, v117, v64
  v_add_f32 v117, v117, v65
  v_mov_b32 v118, v117
  s_nop 0
  s_nop 0
  v_permlane16_swap_b32 v117, v118
  v_add_f32 v117, v117, v118
  v_mov_b32 v118, v117
  s_nop 0
  s_nop 0
  v_permlane32_swap_b32 v117, v118
  v_add_f32 v117, v117, v118
  v_rcp_f32 v117, v117
  s_branch o_fbr_166
o_wr2_160:
  s_waitcnt lgkmcnt(0)
  s_barrier
  ds_read_b128 v[104:107], v3 offset:0
  ds_read_b128 v[108:111], v3 offset:512
  ds_read_b128 v[112:115], v3 offset:1024
  buffer_load_dwordx4 v[176:179], v5, s[4:7], s94 offen offset:256 sc1
  buffer_load_dwordx4 v[180:183], v5, s[4:7], s94 offen offset:768 sc1
  s_waitcnt lgkmcnt(2)
  v_mfma_f32_32x32x16_bf16 v[40:55], v[104:107], a[0:3], 0
  v_mov_b64 v[188:189], 0
  v_mov_b64 v[190:191], 0
  v_mov_b64 v[192:193], 0
  v_mov_b64 v[194:195], 0
  s_mov_b64 exec, 1
  buffer_store_dword v38, off, s[4:7], s84 sc1
  s_mov_b64 exec, -1
  s_mov_b32 s84, 268435456
  v_mfma_f32_32x32x16_bf16 v[56:71], v[104:107], a[4:7], 0
  ds_read_b128 v[116:119], v3 offset:1536
  v_mfma_f32_32x32x16_bf16 v[72:87], v[104:107], a[8:11], 0
  v_mfma_f32_32x32x16_bf16 v[88:103], v[104:107], a[12:15], 0
  s_waitcnt vmcnt(13)
  v_xor_b32 v7, s96, v120
  v_bitop3_b32 v7, v7, v124, s96 bitop3:0xf6
  v_bitop3_b32 v7, v7, v128, s96 bitop3:0xf6
  v_bitop3_b32 v7, v7, v132, s96 bitop3:0xf6
  s_waitcnt lgkmcnt(2)
  v_mfma_f32_32x32x16_bf16 v[40:55], v[108:111], a[16:19], v[40:55]
  s_waitcnt vmcnt(9)
  v_bitop3_b32 v7, v7, v136, s96 bitop3:0xf6
  v_bitop3_b32 v7, v7, v140, s96 bitop3:0xf6
  v_bitop3_b32 v7, v7, v144, s96 bitop3:0xf6
  v_bitop3_b32 v7, v7, v148, s96 bitop3:0xf6
  s_waitcnt vmcnt(5)
  v_mfma_f32_32x32x16_bf16 v[56:71], v[108:111], a[20:23], v[56:71]
  ds_read_b128 v[104:107], v3 offset:2048
  v_bitop3_b32 v7, v7, v152, s96 bitop3:0xf6
  v_bitop3_b32 v7, v7, v156, s96 bitop3:0xf6
  v_bitop3_b32 v7, v7, v160, s96 bitop3:0xf6
  v_bitop3_b32 v7, v7, v164, s96 bitop3:0xf6
  s_waitcnt vmcnt(1)
  v_mfma_f32_32x32x16_bf16 v[72:87], v[108:111], a[24:27], v[72:87]
  v_bitop3_b32 v7, v7, v168, s96 bitop3:0xf6
  v_bitop3_b32 v7, v7, v172, s96 bitop3:0xf6
  v_bitop3_b32 v7, v7, v176, s96 bitop3:0xf6
  v_bitop3_b32 v7, v7, v180, s96 bitop3:0xf6
  v_and_b32 v7, v254, v7
  v_cmp_ne_u32 vcc, 0, v7
  s_cbranch_vccnz o_rt_171
o_bk_172:
  v_mfma_f32_32x32x16_bf16 v[88:103], v[108:111], a[28:31], v[88:103]
  v_smfmac_f32_16x16x64_bf16 v[188:191], v[16:19], v[120:127], v20
  v_lshlrev_b32 v196, 16, v184
  v_smfmac_f32_16x16x64_bf16 v[192:195], v[16:19], v[128:135], v20
  v_and_b32 v197, 0xffff0000, v184
  v_smfmac_f32_16x16x64_bf16 v[188:191], v[16:19], v[136:143], v20
  v_lshlrev_b32 v198, 16, v185
  s_waitcnt lgkmcnt(2)
  v_mfma_f32_32x32x16_bf16 v[40:55], v[112:115], a[32:35], v[40:55]
  v_smfmac_f32_16x16x64_bf16 v[192:195], v[16:19], v[144:151], v20
  v_and_b32 v199, 0xffff0000, v185
  v_smfmac_f32_16x16x64_bf16 v[188:191], v[16:19], v[152:159], v20
  v_lshlrev_b32 v200, 16, v186
  v_smfmac_f32_16x16x64_bf16 v[192:195], v[16:19], v[160:167], v20
  v_and_b32 v201, 0xffff0000, v186
  v_mfma_f32_32x32x16_bf16 v[56:71], v[112:115], a[36:39], v[56:71]
  ds_read_b128 v[108:111], v3 offset:2560
  v_smfmac_f32_16x16x64_bf16 v[188:191], v[16:19], v[168:175], v20
  v_lshlrev_b32 v202, 16, v187
  v_smfmac_f32_16x16x64_bf16 v[192:195], v[16:19], v[176:183], v20
  v_and_b32 v203, 0xffff0000, v187
  s_bfe_u32 s92, s65, 131086
  v_mfma_f32_32x32x16_bf16 v[72:87], v[112:115], a[40:43], v[72:87]
  s_lshl_b32 s92, s92, 21
  s_add_u32 s92, s92, s91
  s_add_u32 s93, s92, 27262976
  s_add_u32 s92, s92, 20971520
  v_permlane16_swap_b32 v188, v192
  v_mfma_f32_32x32x16_bf16 v[88:103], v[112:115], a[44:47], v[88:103]
  v_permlane16_swap_b32 v189, v193
  v_permlane16_swap_b32 v190, v194
  v_permlane16_swap_b32 v191, v195
  s_waitcnt lgkmcnt(2)
  v_mfma_f32_32x32x16_bf16 v[40:55], v[116:119], a[48:51], v[40:55]
  v_cvt_pk_bf16_f32 v188, 0, v188
  v_cvt_pk_bf16_f32 v189, 0, v189
  v_cvt_pk_bf16_f32 v190, 0, v190
  v_cvt_pk_bf16_f32 v191, 0, v191
  v_cvt_pk_bf16_f32 v192, 0, v192
  v_cvt_pk_bf16_f32 v193, 0, v193
  v_mfma_f32_32x32x16_bf16 v[56:71], v[116:119], a[52:55], v[56:71]
  ds_read_b128 v[112:115], v3 offset:3072
  v_cvt_pk_bf16_f32 v194, 0, v194
  v_cvt_pk_bf16_f32 v195, 0, v195
  v_add_f32 v196, v196, v188
  v_add_f32 v197, v197, v189
  v_add_f32 v198, v198, v190
  v_mfma_f32_32x32x16_bf16 v[72:87], v[116:119], a[56:59], v[72:87]
  v_add_f32 v199, v199, v191
  v_add_f32 v200, v200, v192
  v_add_f32 v201, v201, v193
  v_add_f32 v202, v202, v194
  v_add_f32 v203, v203, v195
  v_cvt_pk_bf16_f32 v120, v196, v197
  v_mfma_f32_32x32x16_bf16 v[88:103], v[116:119], a[60:63], v[88:103]
  v_cvt_pk_bf16_f32 v121, v198, v199
  v_cvt_pk_bf16_f32 v122, v200, v201
  v_cvt_pk_bf16_f32 v123, v202, v203
  v_lshlrev_b32 v196, 16, v120
  v_and_b32 v197, 0xffff0000, v120
  s_waitcnt lgkmcnt(2)
  v_mfma_f32_32x32x16_bf16 v[40:55], v[104:107], a[64:67], v[40:55]
  v_lshlrev_b32 v198, 16, v121
  v_and_b32 v199, 0xffff0000, v121
  v_lshlrev_b32 v200, 16, v122
  v_and_b32 v201, 0xffff0000, v122
  v_lshlrev_b32 v202, 16, v123
  v_and_b32 v203, 0xffff0000, v123
  v_mfma_f32_32x32x16_bf16 v[56:71], v[104:107], a[68:71], v[56:71]
  ds_read_b128 v[116:119], v3 offset:3584
  buffer_store_dwordx4 v[120:123], v0, s[4:7], s92 offen sc1
  v_add_f32 v136, v196, v197
  v_mul_f32 v137, v196, v196
  v_mfma_f32_32x32x16_bf16 v[72:87], v[104:107], a[72:75], v[72:87]
  v_add_f32 v138, v198, v199
  v_mul_f32 v139, v197, v197
  v_fmac_f32 v137, v198, v198
  v_fmac_f32 v139, v199, v199
  v_add_f32 v136, v136, v200
  v_fmac_f32 v137, v200, v200
  v_mfma_f32_32x32x16_bf16 v[88:103], v[104:107], a[76:79], v[88:103]
  v_add_f32 v138, v138, v201
  v_fmac_f32 v139, v201, v201
  v_add_f32 v136, v136, v202
  v_fmac_f32 v137, v202, v202
  v_add_f32 v138, v138, v203
  s_waitcnt lgkmcnt(2)
  v_mfma_f32_32x32x16_bf16 v[40:55], v[108:111], a[80:83], v[40:55]
  v_fmac_f32 v139, v203, v203
  v_add_f32 v136, v136, v138
  v_add_f32 v137, v137, v139
  s_nop 0
  v_add_f32_dpp v136, v136, v136 row_ror:8 row_mask:0xf bank_mask:0xf
  v_add_f32_dpp v137, v137, v137 row_ror:8 row_mask:0xf bank_mask:0xf
  s_nop 0
  v_add_f32_dpp v136, v136, v136 row_ror:4 row_mask:0xf bank_mask:0xf
  v_mfma_f32_32x32x16_bf16 v[56:71], v[108:111], a[84:87], v[56:71]
  ds_read_b128 v[104:107], v3 offset:8192
  v_add_f32_dpp v137, v137, v137 row_ror:4 row_mask:0xf bank_mask:0xf
  v_add_f32_dpp v136, v136, v136 row_ror:2 row_mask:0xf bank_mask:0xf
  s_nop 0
  v_add_f32_dpp v137, v137, v137 row_ror:2 row_mask:0xf bank_mask:0xf
  v_add_f32_dpp v136, v136, v136 row_ror:1 row_mask:0xf bank_mask:0xf
  s_nop 0
  v_add_f32_dpp v137, v137, v137 row_ror:1 row_mask:0xf bank_mask:0xf
  v_mfma_f32_32x32x16_bf16 v[72:87], v[108:111], a[88:91], v[72:87]
  v_mov_b32 v140, v136
  v_mov_b32 v141, v137
  s_nop 0
  v_permlane16_swap_b32 v136, v140
  v_permlane16_swap_b32 v137, v141
  v_mfma_f32_32x32x16_bf16 v[88:103], v[108:111], a[92:95], v[88:103]
  v_add_f32 v136, v136, v140
  v_add_f32 v137, v137, v141
  v_mov_b32 v140, v136
  v_mov_b32 v141, v137
  s_nop 0
  v_permlane32_swap_b32 v136, v140
  s_waitcnt lgkmcnt(2)
  v_mfma_f32_32x32x16_bf16 v[40:55], v[112:115], a[96:99], v[40:55]
  v_permlane32_swap_b32 v137, v141
  v_add_f32 v136, v136, v140
  v_add_f32 v137, v137, v141
  v_mul_f32 v136, 0x3b000000, v136
  v_mul_f32 v137, 0x3b000000, v137
  v_mfma_f32_32x32x16_bf16 v[56:71], v[112:115], a[100:103], v[56:71]
  ds_read_b128 v[108:111], v3 offset:8704
  v_fma_f32 v137, -v136, v136, v137
  v_cvt_pk_bf16_f32 v136, 0, v136
  v_max_f32 v137, 0, v137
  v_sub_f32 v140, v196, v136
  v_sub_f32 v141, v197, v136
  v_mfma_f32_32x32x16_bf16 v[72:87], v[112:115], a[104:107], v[72:87]
  v_cvt_pk_bf16_f32 v137, 0, v137
  v_sub_f32 v142, v198, v136
  v_sub_f32 v143, v199, v136
  v_add_f32 v137, 0x3727c5ac, v137
  v_sub_f32 v144, v200, v136
  v_sub_f32 v145, v201, v136
  v_mfma_f32_32x32x16_bf16 v[88:103], v[112:115], a[108:111], v[88:103]
  v_cvt_pk_bf16_f32 v137, 0, v137
  v_sub_f32 v146, v202, v136
  v_sub_f32 v147, v203, v136
  v_sqrt_f32 v137, v137
  s_waitcnt lgkmcnt(2)
  v_mfma_f32_32x32x16_bf16 v[40:55], v[116:119], a[112:115], v[40:55]
  v_cvt_pk_bf16_f32 v140, 0, v140
  v_cvt_pk_bf16_f32 v141, 0, v141
  v_cvt_pk_bf16_f32 v137, 0, v137
  v_cvt_pk_bf16_f32 v142, 0, v142
  v_cvt_pk_bf16_f32 v143, 0, v143
  v_rcp_f32 v137, v137
  v_mfma_f32_32x32x16_bf16 v[56:71], v[116:119], a[116:119], v[56:71]
  ds_read_b128 v[112:115], v3 offset:9216
  v_cvt_pk_bf16_f32 v144, 0, v144
  v_cvt_pk_bf16_f32 v145, 0, v145
  v_cvt_pk_bf16_f32 v146, 0, v146
  v_cvt_pk_bf16_f32 v147, 0, v147
  v_mul_f32 v140, v140, v137
  v_mfma_f32_32x32x16_bf16 v[72:87], v[116:119], a[120:123], v[72:87]
  v_mul_f32 v141, v141, v137
  v_mul_f32 v142, v142, v137
  v_mul_f32 v143, v143, v137
  v_mul_f32 v144, v144, v137
  v_mul_f32 v145, v145, v137
  v_mul_f32 v146, v146, v137
  v_mfma_f32_32x32x16_bf16 v[88:103], v[116:119], a[124:127], v[88:103]
  v_mul_f32 v147, v147, v137
  v_cvt_pk_bf16_f32 v124, v140, v141
  v_cvt_pk_bf16_f32 v125, v142, v143
  v_cvt_pk_bf16_f32 v126, v144, v145
  v_cvt_pk_bf16_f32 v127, v146, v147
  s_waitcnt lgkmcnt(2)
  v_mfma_f32_32x32x16_bf16 v[40:55], v[104:107], a[128:131], v[40:55]
  v_lshlrev_b32 v204, 16, v124
  v_and_b32 v205, 0xffff0000, v124
  v_lshlrev_b32 v206, 16, v125
  v_and_b32 v207, 0xffff0000, v125
  v_lshlrev_b32 v208, 16, v126
  v_and_b32 v209, 0xffff0000, v126
  v_mfma_f32_32x32x16_bf16 v[56:71], v[104:107], a[132:135], v[56:71]
  ds_read_b128 v[116:119], v3 offset:9728
  v_lshlrev_b32 v210, 16, v127
  v_and_b32 v211, 0xffff0000, v127
  buffer_store_dwordx4 v[124:127], v0, s[4:7], s93 offen sc1
  v_mfma_f32_32x32x16_bf16 v[72:87], v[104:107], a[136:139], v[72:87]
  v_add_f32 v196, v196, v204
  v_add_f32 v197, v197, v205
  v_add_f32 v198, v198, v206
  v_add_f32 v199, v199, v207
  v_add_f32 v200, v200, v208
  v_add_f32 v201, v201, v209
  v_mfma_f32_32x32x16_bf16 v[88:103], v[104:107], a[140:143], v[88:103]
  v_add_f32 v202, v202, v210
  v_add_f32 v203, v203, v211
  v_cvt_pk_bf16_f32 v128, v196, v197
  v_cvt_pk_bf16_f32 v129, v198, v199
  v_cvt_pk_bf16_f32 v130, v200, v201
  s_waitcnt lgkmcnt(2)
  v_mfma_f32_32x32x16_bf16 v[40:55], v[108:111], a[144:147], v[40:55]
  v_cvt_pk_bf16_f32 v131, v202, v203
  v_mul_f32 v188, v204, v8
  v_mul_f32 v189, v205, v9
  v_fmac_f32 v188, v206, v10
  v_fmac_f32 v189, v207, v11
  v_fmac_f32 v188, v208, v12
  v_mfma_f32_32x32x16_bf16 v[56:71], v[108:111], a[148:151], v[56:71]
  ds_read_b128 v[104:107], v3 offset:10240
  v_fmac_f32 v189, v209, v13
  v_fmac_f32 v188, v210, v14
  v_fmac_f32 v189, v211, v15
  v_add_f32 v188, v188, v189
  buffer_store_dwordx4 v[128:131], v0, s[68:71], s91 offen sc1
  v_mfma_f32_32x32x16_bf16 v[72:87], v[108:111], a[152:155], v[72:87]
  v_add_f32_dpp v188, v188, v188 row_ror:8 row_mask:0xf bank_mask:0xf
  s_nop 1
  v_add_f32_dpp v188, v188, v188 row_ror:4 row_mask:0xf bank_mask:0xf
  s_nop 1
  v_add_f32_dpp v188, v188, v188 row_ror:2 row_mask:0xf bank_mask:0xf
  s_nop 1
  v_add_f32_dpp v188, v188, v188 row_ror:1 row_mask:0xf bank_mask:0xf
  v_mov_b32 v189, v188
  s_nop 0
  s_nop 0
  v_permlane16_swap_b32 v188, v189
  v_mfma_f32_32x32x16_bf16 v[88:103], v[108:111], a[156:159], v[88:103]
  v_add_f32 v188, v188, v189
  v_mov_b32 v189, v188
  s_nop 0
  s_nop 0
  v_permlane32_swap_b32 v188, v189
  v_add_f32 v188, v188, v189
  s_waitcnt lgkmcnt(2)
  v_mfma_f32_32x32x16_bf16 v[40:55], v[112:115], a[160:163], v[40:55]
  v_cvt_pk_bf16_f32 v188, 0, v188
  v_ashrrev_i32 v189, 31, v188
  v_or_b32 v189, 0x80000000, v189
  v_xor_b32 v188, v188, v189
  s_sub_u32 s92, 4095, s90
  v_and_b32 v188, 0xffff0000, v188
  v_mfma_f32_32x32x16_bf16 v[56:71], v[112:115], a[164:167], v[56:71]
  ds_read_b128 v[108:111], v3 offset:10752
  v_or_b32 v38, s92, v188
  s_bfe_u32 s92, s65, 196625
  s_lshl_b32 s92, s92, 18
  s_lshl_b32 s93, s90, 7
  s_add_u32 s92, s92, s93
  v_mfma_f32_32x32x16_bf16 v[72:87], v[112:115], a[168:171], v[72:87]
  s_add_u32 s84, s92, 243269632
  v_mfma_f32_32x32x16_bf16 v[88:103], v[112:115], a[172:175], v[88:103]
  s_waitcnt lgkmcnt(2)
  v_mfma_f32_32x32x16_bf16 v[40:55], v[116:119], a[176:179], v[40:55]
  v_mfma_f32_32x32x16_bf16 v[56:71], v[116:119], a[180:183], v[56:71]
  ds_read_b128 v[112:115], v3 offset:11264
  v_mfma_f32_32x32x16_bf16 v[72:87], v[116:119], a[184:187], v[72:87]
  v_mfma_f32_32x32x16_bf16 v[88:103], v[116:119], a[188:191], v[88:103]
  s_waitcnt lgkmcnt(2)
  v_mfma_f32_32x32x16_bf16 v[40:55], v[104:107], a[192:195], v[40:55]
  v_mfma_f32_32x32x16_bf16 v[56:71], v[104:107], a[196:199], v[56:71]
  ds_read_b128 v[116:119], v3 offset:11776
  s_waitcnt lgkmcnt(2)
  v_mfma_f32_32x32x16_bf16 v[40:55], v[108:111], a[208:211], v[40:55]
  v_mfma_f32_32x32x16_bf16 v[56:71], v[108:111], a[212:215], v[56:71]
  s_waitcnt lgkmcnt(1)
  v_mfma_f32_32x32x16_bf16 v[40:55], v[112:115], a[224:227], v[40:55]
  v_mfma_f32_32x32x16_bf16 v[56:71], v[112:115], a[228:231], v[56:71]
  s_waitcnt lgkmcnt(0)
  v_mfma_f32_32x32x16_bf16 v[40:55], v[116:119], a[240:243], v[40:55]
  v_mfma_f32_32x32x16_bf16 v[56:71], v[116:119], a[244:247], v[56:71]
  v_mfma_f32_32x32x16_bf16 v[72:87], v[104:107], a[200:203], v[72:87]
  v_mfma_f32_32x32x16_bf16 v[88:103], v[104:107], a[204:207], v[88:103]
  v_cvt_pk_bf16_f32 v212, v40, v56
  v_cvt_pk_bf16_f32 v214, v41, v57
  v_cvt_pk_bf16_f32 v216, v42, v58
  v_cvt_pk_bf16_f32 v218, v43, v59
  v_permlane16_swap_b32 v212, v214
  v_mfma_f32_32x32x16_bf16 v[72:87], v[108:111], a[216:219], v[72:87]
  v_cvt_pk_bf16_f32 v220, v44, v60
  v_cvt_pk_bf16_f32 v222, v45, v61
  v_permlane16_swap_b32 v216, v218
  v_bfi_b32 v212, v254, s42, v212
  v_cvt_pk_bf16_f32 v224, v46, v62
  v_mfma_f32_32x32x16_bf16 v[88:103], v[108:111], a[220:223], v[88:103]
  v_cvt_pk_bf16_f32 v226, v47, v63
  v_permlane16_swap_b32 v220, v222
  v_bfi_b32 v216, v254, s42, v216
  v_cvt_pk_bf16_f32 v228, v48, v64
  v_mfma_f32_32x32x16_bf16 v[72:87], v[112:115], a[232:235], v[72:87]
  v_cvt_pk_bf16_f32 v230, v49, v65
  v_permlane16_swap_b32 v224, v226
  v_bfi_b32 v220, v254, s42, v220
  v_cvt_pk_bf16_f32 v232, v50, v66
  v_cvt_pk_bf16_f32 v234, v51, v67
  v_mfma_f32_32x32x16_bf16 v[88:103], v[112:115], a[236:239], v[88:103]
  v_permlane16_swap_b32 v228, v230
  v_bfi_b32 v224, v254, s42, v224
  v_cvt_pk_bf16_f32 v236, v52, v68
  v_cvt_pk_bf16_f32 v238, v53, v69
  v_mfma_f32_32x32x16_bf16 v[72:87], v[116:119], a[248:251], v[72:87]
  v_permlane16_swap_b32 v232, v234
  v_bfi_b32 v228, v254, s42, v228
  v_cvt_pk_bf16_f32 v240, v54, v70
  v_cvt_pk_bf16_f32 v242, v55, v71
  v_permlane16_swap_b32 v236, v238
  v_mfma_f32_32x32x16_bf16 v[88:103], v[116:119], a[252:255], v[88:103]
  v_bfi_b32 v232, v254, s42, v232
  v_permlane16_swap_b32 v240, v242
  v_bfi_b32 v236, v254, s42, v236
  v_bfi_b32 v240, v254, s42, v240
  s_nop 7
  v_cvt_pk_bf16_f32 v213, v72, v88
  v_cvt_pk_bf16_f32 v215, v73, v89
  v_cvt_pk_bf16_f32 v217, v74, v90
  v_cvt_pk_bf16_f32 v219, v75, v91
  s_add_u32 s78, s86, 0
  v_permlane16_swap_b32 v213, v215
  buffer_store_dwordx4 v[212:215], v4, s[4:7], s78 offen
  v_cvt_pk_bf16_f32 v221, v76, v92
  v_cvt_pk_bf16_f32 v223, v77, v93
  s_add_u32 s78, s86, 32768
  v_permlane16_swap_b32 v217, v219
  buffer_store_dwordx4 v[216:219], v4, s[4:7], s78 offen
  v_cvt_pk_bf16_f32 v225, v78, v94
  v_cvt_pk_bf16_f32 v227, v79, v95
  s_add_u32 s78, s86, 131072
  v_permlane16_swap_b32 v221, v223
  buffer_store_dwordx4 v[220:223], v4, s[4:7], s78 offen
  v_cvt_pk_bf16_f32 v229, v80, v96
  v_cvt_pk_bf16_f32 v231, v81, v97
  s_add_u32 s78, s86, 163840
  v_permlane16_swap_b32 v225, v227
  buffer_store_dwordx4 v[224:227], v4, s[4:7], s78 offen
  v_cvt_pk_bf16_f32 v233, v82, v98
  v_cvt_pk_bf16_f32 v235, v83, v99
  s_add_u32 s78, s86, 262144
  v_permlane16_swap_b32 v229, v231
  buffer_store_dwordx4 v[228:231], v4, s[4:7], s78 offen
  v_cvt_pk_bf16_f32 v237, v84, v100
  v_cvt_pk_bf16_f32 v239, v85, v101
  s_add_u32 s78, s86, 294912
  v_permlane16_swap_b32 v233, v235
  buffer_store_dwordx4 v[232:235], v4, s[4:7], s78 offen
  v_cvt_pk_bf16_f32 v241, v86, v102
  v_cvt_pk_bf16_f32 v243, v87, v103
  s_add_u32 s78, s86, 393216
  v_permlane16_swap_b32 v237, v239
  buffer_store_dwordx4 v[236:239], v4, s[4:7], s78 offen
  s_add_u32 s78, s86, 425984
  v_permlane16_swap_b32 v241, v243
  buffer_store_dwordx4 v[240:243], v4, s[4:7], s78 offen
o_we_161:
  v_and_b32 v37, -32, v39
  s_waitcnt lgkmcnt(0)
  s_barrier
  ds_read_b128 v[104:107], v37 offset:16
  s_mov_b32 s65, s63
  s_waitcnt lgkmcnt(0)
  v_and_b32 v104, v104, v106
  v_max_u32 v105, v105, v107
  v_readfirstlane_b32 s26, v104
  v_readfirstlane_b32 s3, v105
  s_and_b32 s66, s26, 1
  s_and_b32 s76, s26, 2
  s_bitcmp1_b32 s26, 2
  s_cselect_b32 s3, s3, 0
  s_cmp_lg_u32 s76, 0
  s_cbranch_scc1 o_nofl_135
  s_and_b32 s26, s63, 49152
  s_cbranch_scc0 o_fl_136
  s_and_b32 s26, s64, s50
  s_cbranch_scc1 o_nofl_135
o_fl_136:
  s_cmp_ge_u32 s17, 2
  s_cbranch_scc1 o_fd_175
  s_cmp_eq_u32 s65, 0
  s_cbranch_scc1 o_fd_175
  s_mov_b32 s96, s42
  s_lshl_b32 s97, s43, 14
  s_add_u32 s97, s97, s86
  buffer_load_dword v7, v255, s[4:7], s97 offen sc1
  s_and_b32 s91, s65, 63
  s_lshl_b32 s90, s91, 5
  s_add_u32 s94, s90, s85
  s_add_u32 s90, s90, s43
  s_lshl_b32 s94, s94, 10
  s_lshr_b32 s92, s65, 22
  s_xor_b32 s93, s43, 32
  s_lshl_b32 s91, s90, 10
  s_add_u32 s94, s94, 25165824
  s_cmp_eq_u32 s92, s93
  s_cselect_b32 s92, s94, s91
  s_add_u32 s92, s92, 10485760
  s_and_b32 s93, s65, 49152
  s_cselect_b32 s92, s92, s91
  s_cselect_b64 s[80:81], s[4:5], s[72:73]
  s_cselect_b32 s82, s6, s74
  buffer_load_dwordx4 v[184:187], v0, s[80:83], s92 offen sc1
  s_mov_b32 s67, 0
  s_mov_b64 vcc, 0
  s_waitcnt vmcnt(1)
o_pl_177:
  v_and_b32 v7, 1, v7
  v_cmp_ne_u32 vcc, s96, v7
  s_cbranch_vccz o_pk_178
  s_mov_b64 exec, 1
  buffer_store_dword v38, off, s[4:7], s84 sc1
  s_mov_b64 exec, -1
  s_mov_b32 s84, 268435456
  buffer_load_dword v7, v255, s[4:7], s97 offen sc1
  s_add_u32 s67, s67, 1
  s_cmp_gt_u32 s67, 1048576
  s_cbranch_scc1 L_end
  s_waitcnt vmcnt(0)
  s_branch o_pl_177
o_pk_178:
  s_and_b32 s26, s65, 49152
  s_cbranch_scc1 o_f2_176
  s_lshl_b32 s94, s43, 14
  s_add_u32 s94, s94, s86
  buffer_load_dwordx4 v[120:123], v5, s[4:7], s94 offen offset:0 sc1
  buffer_load_dwordx4 v[124:127], v5, s[4:7], s94 offen offset:512 sc1
  buffer_load_dwordx4 v[128:131], v5, s[4:7], s94 offen offset:256 sc1
  buffer_load_dwordx4 v[132:135], v5, s[4:7], s94 offen offset:768 sc1
  s_add_u32 s94, s94, 4096
  buffer_load_dwordx4 v[136:139], v5, s[4:7], s94 offen offset:0 sc1
  buffer_load_dwordx4 v[140:143], v5, s[4:7], s94 offen offset:512 sc1
  buffer_load_dwordx4 v[144:147], v5, s[4:7], s94 offen offset:256 sc1
  buffer_load_dwordx4 v[148:151], v5, s[4:7], s94 offen offset:768 sc1
  s_add_u32 s94, s94, 4096
  buffer_load_dwordx4 v[152:155], v5, s[4:7], s94 offen offset:0 sc1
  buffer_load_dwordx4 v[156:159], v5, s[4:7], s94 offen offset:512 sc1
  buffer_load_dwordx4 v[160:163], v5, s[4:7], s94 offen offset:256 sc1
  buffer_load_dwordx4 v[164:167], v5, s[4:7], s94 offen offset:768 sc1
  s_add_u32 s94, s94, 4096
  buffer_load_dwordx4 v[168:171], v5, s[4:7], s94 offen offset:0 sc1
  buffer_load_dwordx4 v[172:175], v5, s[4:7], s94 offen offset:512 sc1
  buffer_load_dwordx4 v[176:179], v5, s[4:7], s94 offen offset:256 sc1
  buffer_load_dwordx4 v[180:183], v5, s[4:7], s94 offen offset:768 sc1
  s_mov_b64 exec, 1
  buffer_store_dword v38, off, s[4:7], s84 sc1
  s_mov_b64 exec, -1
  s_mov_b32 s84, 268435456
  v_mov_b64 v[188:189], 0
  v_mov_b64 v[190:191], 0
  v_mov_b64 v[192:193], 0
  v_mov_b64 v[194:195], 0
  s_waitcnt vmcnt(13)
  v_xor_b32 v7, s96, v120
  v_bitop3_b32 v7, v7, v124, s96 bitop3:0xf6
  v_bitop3_b32 v7, v7, v128, s96 bitop3:0xf6
  v_bitop3_b32 v7, v7, v132, s96 bitop3:0xf6
  s_waitcnt vmcnt(9)
  v_bitop3_b32 v7, v7, v136, s96 bitop3:0xf6
  v_bitop3_b32 v7, v7, v140, s96 bitop3:0xf6
  v_bitop3_b32 v7, v7, v144, s96 bitop3:0xf6
  v_bitop3_b32 v7, v7, v148, s96 bitop3:0xf6
  s_waitcnt vmcnt(5)
  v_bitop3_b32 v7, v7, v152, s96 bitop3:0xf6
  v_bitop3_b32 v7, v7, v156, s96 bitop3:0xf6
  v_bitop3_b32 v7, v7, v160, s96 bitop3:0xf6
  v_bitop3_b32 v7, v7, v164, s96 bitop3:0xf6
  s_waitcnt vmcnt(1)
  v_bitop3_b32 v7, v7, v168, s96 bitop3:0xf6
  v_bitop3_b32 v7, v7, v172, s96 bitop3:0xf6
  v_bitop3_b32 v7, v7, v176, s96 bitop3:0xf6
  v_bitop3_b32 v7, v7, v180, s96 bitop3:0xf6
  v_and_b32 v7, v254, v7
  v_cmp_ne_u32 vcc, 0, v7
  s_cbranch_vccnz o_rt_179
o_bk_180:
  v_smfmac_f32_16x16x64_bf16 v[188:191], v[16:19], v[120:127], v20
  v_lshlrev_b32 v196, 16, v184
  v_smfmac_f32_16x16x64_bf16 v[192:195], v[16:19], v[128:135], v20
  v_and_b32 v197, 0xffff0000, v184
  v_smfmac_f32_16x16x64_bf16 v[188:191], v[16:19], v[136:143], v20
  v_lshlrev_b32 v198, 16, v185
  v_smfmac_f32_16x16x64_bf16 v[192:195], v[16:19], v[144:151], v20
  v_and_b32 v199, 0xffff0000, v185
  v_smfmac_f32_16x16x64_bf16 v[188:191], v[16:19], v[152:159], v20
  v_lshlrev_b32 v200, 16, v186
  v_smfmac_f32_16x16x64_bf16 v[192:195], v[16:19], v[160:167], v20
  v_and_b32 v201, 0xffff0000, v186
  v_smfmac_f32_16x16x64_bf16 v[188:191], v[16:19], v[168:175], v20
  v_lshlrev_b32 v202, 16, v187
  v_smfmac_f32_16x16x64_bf16 v[192:195], v[16:19], v[176:183], v20
  v_and_b32 v203, 0xffff0000, v187
  s_bfe_u32 s92, s65, 131086
  s_lshl_b32 s92, s92, 21
  s_add_u32 s92, s92, s91
  s_add_u32 s93, s92, 27262976
  s_add_u32 s92, s92, 20971520
  s_nop 1
  v_permlane16_swap_b32 v188, v192
  v_permlane16_swap_b32 v189, v193
  v_permlane16_swap_b32 v190, v194
  v_permlane16_swap_b32 v191, v195
  v_cvt_pk_bf16_f32 v188, 0, v188
  v_cvt_pk_bf16_f32 v189, 0, v189
  v_cvt_pk_bf16_f32 v190, 0, v190
  v_cvt_pk_bf16_f32 v191, 0, v191
  v_cvt_pk_bf16_f32 v192, 0, v192
  v_cvt_pk_bf16_f32 v193, 0, v193
  v_cvt_pk_bf16_f32 v194, 0, v194
  v_cvt_pk_bf16_f32 v195, 0, v195
  v_add_f32 v196, v196, v188
  v_add_f32 v197, v197, v189
  v_add_f32 v198, v198, v190
  v_add_f32 v199, v199, v191
  v_add_f32 v200, v200, v192
  v_add_f32 v201, v201, v193
  v_add_f32 v202, v202, v194
  v_add_f32 v203, v203, v195
  v_cvt_pk_bf16_f32 v120, v196, v197
  v_cvt_pk_bf16_f32 v121, v198, v199
  v_cvt_pk_bf16_f32 v122, v200, v201
  v_cvt_pk_bf16_f32 v123, v202, v203
  v_lshlrev_b32 v196, 16, v120
  v_and_b32 v197, 0xffff0000, v120
  v_lshlrev_b32 v198, 16, v121
  v_and_b32 v199, 0xffff0000, v121
  v_lshlrev_b32 v200, 16, v122
  v_and_b32 v201, 0xffff0000, v122
  v_lshlrev_b32 v202, 16, v123
  v_and_b32 v203, 0xffff0000, v123
  buffer_store_dwordx4 v[120:123], v0, s[4:7], s92 offen sc1
  v_add_f32 v136, v196, v197
  v_mul_f32 v137, v196, v196
  v_add_f32 v138, v198, v199
  v_mul_f32 v139, v197, v197
  v_fmac_f32 v137, v198, v198
  v_fmac_f32 v139, v199, v199
  v_add_f32 v136, v136, v200
  v_fmac_f32 v137, v200, v200
  v_add_f32 v138, v138, v201
  v_fmac_f32 v139, v201, v201
  v_add_f32 v136, v136, v202
  v_fmac_f32 v137, v202, v202
  v_add_f32 v138, v138, v203
  v_fmac_f32 v139, v203, v203
  v_add_f32 v136, v136, v138
  v_add_f32 v137, v137, v139
  s_nop 0
  v_add_f32_dpp v136, v136, v136 row_ror:8 row_mask:0xf bank_mask:0xf
  v_add_f32_dpp v137, v137, v137 row_ror:8 row_mask:0xf bank_mask:0xf
  s_nop 0
  v_add_f32_dpp v136, v136, v136 row_ror:4 row_mask:0xf bank_mask:0xf
  v_add_f32_dpp v137, v137, v137 row_ror:4 row_mask:0xf bank_mask:0xf
  s_nop 0
  v_add_f32_dpp v136, v136, v136 row_ror:2 row_mask:0xf bank_mask:0xf
  v_add_f32_dpp v137, v137, v137 row_ror:2 row_mask:0xf bank_mask:0xf
  s_nop 0
  v_add_f32_dpp v136, v136, v136 row_ror:1 row_mask:0xf bank_mask:0xf
  v_add_f32_dpp v137, v137, v137 row_ror:1 row_mask:0xf bank_mask:0xf
  v_mov_b32 v140, v136
  v_mov_b32 v141, v137
  s_nop 0
  v_permlane16_swap_b32 v136, v140
  v_permlane16_swap_b32 v137, v141
  v_add_f32 v136, v136, v140
  v_add_f32 v137, v137, v141
  v_mov_b32 v140, v136
  v_mov_b32 v141, v137
  s_nop 0
  v_permlane32_swap_b32 v136, v140
  v_permlane32_swap_b32 v137, v141
  v_add_f32 v136, v136, v140
  v_add_f32 v137, v137, v141
  v_mul_f32 v136, 0x3b000000, v136
  v_mul_f32 v137, 0x3b000000, v137
  v_fma_f32 v137, -v136, v136, v137
  v_cvt_pk_bf16_f32 v136, 0, v136
  v_max_f32 v137, 0, v137
  v_sub_f32 v140, v196, v136
  v_sub_f32 v141, v197, v136
  v_cvt_pk_bf16_f32 v137, 0, v137
  v_sub_f32 v142, v198, v136
  v_sub_f32 v143, v199, v136
  v_add_f32 v137, 0x3727c5ac, v137
  v_sub_f32 v144, v200, v136
  v_sub_f32 v145, v201, v136
  v_cvt_pk_bf16_f32 v137, 0, v137
  v_sub_f32 v146, v202, v136
  v_sub_f32 v147, v203, v136
  v_sqrt_f32 v137, v137
  v_cvt_pk_bf16_f32 v140, 0, v140
  v_cvt_pk_bf16_f32 v141, 0, v141
  v_cvt_pk_bf16_f32 v137, 0, v137
  v_cvt_pk_bf16_f32 v142, 0, v142
  v_cvt_pk_bf16_f32 v143, 0, v143
  v_rcp_f32 v137, v137
  v_cvt_pk_bf16_f32 v144, 0, v144
  v_cvt_pk_bf16_f32 v145, 0, v145
  v_cvt_pk_bf16_f32 v146, 0, v146
  v_cvt_pk_bf16_f32 v147, 0, v147
  v_mul_f32 v140, v140, v137
  v_mul_f32 v141, v141, v137
  v_mul_f32 v142, v142, v137
  v_mul_f32 v143, v143, v137
  v_mul_f32 v144, v144, v137
  v_mul_f32 v145, v145, v137
  v_mul_f32 v146, v146, v137
  v_mul_f32 v147, v147, v137
  v_cvt_pk_bf16_f32 v124, v140, v141
  v_cvt_pk_bf16_f32 v125, v142, v143
  v_cvt_pk_bf16_f32 v126, v144, v145
  v_cvt_pk_bf16_f32 v127, v146, v147
  v_lshlrev_b32 v204, 16, v124
  v_and_b32 v205, 0xffff0000, v124
  v_lshlrev_b32 v206, 16, v125
  v_and_b32 v207, 0xffff0000, v125
  v_lshlrev_b32 v208, 16, v126
  v_and_b32 v209, 0xffff0000, v126
  v_lshlrev_b32 v210, 16, v127
  v_and_b32 v211, 0xffff0000, v127
  buffer_store_dwordx4 v[124:127], v0, s[4:7], s93 offen sc1
  v_add_f32 v196, v196, v204
  v_add_f32 v197, v197, v205
  v_add_f32 v198, v198, v206
  v_add_f32 v199, v199, v207
  v_add_f32 v200, v200, v208
  v_add_f32 v201, v201, v209
  v_add_f32 v202, v202, v210
  v_add_f32 v203, v203, v211
  v_cvt_pk_bf16_f32 v128, v196, v197
  v_cvt_pk_bf16_f32 v129, v198, v199
  v_cvt_pk_bf16_f32 v130, v200, v201
  v_cvt_pk_bf16_f32 v131, v202, v203
  v_mul_f32 v188, v204, v8
  v_mul_f32 v189, v205, v9
  v_fmac_f32 v188, v206, v10
  v_fmac_f32 v189, v207, v11
  v_fmac_f32 v188, v208, v12
  v_fmac_f32 v189, v209, v13
  v_fmac_f32 v188, v210, v14
  v_fmac_f32 v189, v211, v15
  v_add_f32 v188, v188, v189
  s_add_u32 s92, s91, 10485760
  s_add_u32 s93, s91, 8388608
  buffer_store_dwordx4 v[128:131], v0, s[4:7], s92 offen sc1
  v_lshlrev_b32 v196, 16, v128
  v_and_b32 v197, 0xffff0000, v128
  v_lshlrev_b32 v198, 16, v129
  v_and_b32 v199, 0xffff0000, v129
  v_lshlrev_b32 v200, 16, v130
  v_and_b32 v201, 0xffff0000, v130
  v_lshlrev_b32 v202, 16, v131
  v_and_b32 v203, 0xffff0000, v131
  v_add_f32 v136, v196, v197
  v_mul_f32 v137, v196, v196
  v_add_f32 v138, v198, v199
  v_mul_f32 v139, v197, v197
  v_fmac_f32 v137, v198, v198
  v_fmac_f32 v139, v199, v199
  v_add_f32 v136, v136, v200
  v_fmac_f32 v137, v200, v200
  v_add_f32 v138, v138, v201
  v_fmac_f32 v139, v201, v201
  v_add_f32 v136, v136, v202
  v_fmac_f32 v137, v202, v202
  v_add_f32 v138, v138, v203
  v_fmac_f32 v139, v203, v203
  v_add_f32 v136, v136, v138
  v_add_f32 v137, v137, v139
  s_nop 0
  v_add_f32_dpp v136, v136, v136 row_ror:8 row_mask:0xf bank_mask:0xf
  v_add_f32_dpp v137, v137, v137 row_ror:8 row_mask:0xf bank_mask:0xf
  v_add_f32_dpp v188, v188, v188 row_ror:8 row_mask:0xf bank_mask:0xf
  v_add_f32_dpp v136, v136, v136 row_ror:4 row_mask:0xf bank_mask:0xf
  v_add_f32_dpp v137, v137, v137 row_ror:4 row_mask:0xf bank_mask:0xf
  v_add_f32_dpp v188, v188, v188 row_ror:4 row_mask:0xf bank_mask:0xf
  v_add_f32_dpp v136, v136, v136 row_ror:2 row_mask:0xf bank_mask:0xf
  v_add_f32_dpp v137, v137, v137 row_ror:2 row_mask:0xf bank_mask:0xf
  v_add_f32_dpp v188, v188, v188 row_ror:2 row_mask:0xf bank_mask:0xf
  v_add_f32_dpp v136, v136, v136 row_ror:1 row_mask:0xf bank_mask:0xf
  v_add_f32_dpp v137, v137, v137 row_ror:1 row_mask:0xf bank_mask:0xf
  v_add_f32_dpp v188, v188, v188 row_ror:1 row_mask:0xf bank_mask:0xf
  v_mov_b32 v140, v136
  v_mov_b32 v141, v137
  v_mov_b32 v142, v188
  v_permlane16_swap_b32 v136, v140
  v_permlane16_swap_b32 v137, v141
  v_permlane16_swap_b32 v188, v142
  v_add_f32 v136, v136, v140
  v_add_f32 v137, v137, v141
  v_add_f32 v188, v188, v142
  v_mov_b32 v140, v136
  v_mov_b32 v141, v137
  v_mov_b32 v142, v188
  v_permlane32_swap_b32 v136, v140
  v_permlane32_swap_b32 v137, v141
  v_permlane32_swap_b32 v188, v142
  v_add_f32 v136, v136, v140
  v_add_f32 v137, v137, v141
  v_add_f32 v188, v188, v142
  v_mul_f32 v136, 0x3b000000, v136
  v_mul_f32 v137, 0x3b000000, v137
  v_fma_f32 v137, -v136, v136, v137
  v_cvt_pk_bf16_f32 v136, 0, v136
  v_max_f32 v137, 0, v137
  v_sub_f32 v140, v196, v136
  v_sub_f32 v141, v197, v136
  v_cvt_pk_bf16_f32 v137, 0, v137
  v_sub_f32 v142, v198, v136
  v_sub_f32 v143, v199, v136
  v_add_f32 v137, 0x3727c5ac, v137
  v_sub_f32 v144, v200, v136
  v_sub_f32 v145, v201, v136
  v_cvt_pk_bf16_f32 v137, 0, v137
  v_sub_f32 v146, v202, v136
  v_sub_f32 v147, v203, v136
  v_sqrt_f32 v137, v137
  v_cvt_pk_bf16_f32 v140, 0, v140
  v_cvt_pk_bf16_f32 v141, 0, v141
  v_cvt_pk_bf16_f32 v137, 0, v137
  v_cvt_pk_bf16_f32 v142, 0, v142
  v_cvt_pk_bf16_f32 v143, 0, v143
  v_rcp_f32 v137, v137
  v_cvt_pk_bf16_f32 v144, 0, v144
  v_cvt_pk_bf16_f32 v145, 0, v145
  v_cvt_pk_bf16_f32 v146, 0, v146
  v_cvt_pk_bf16_f32 v147, 0, v147
  v_mul_f32 v140, v140, v137
  v_mul_f32 v141, v141, v137
  v_mul_f32 v142, v142, v137
  v_mul_f32 v143, v143, v137
  v_mul_f32 v144, v144, v137
  v_mul_f32 v145, v145, v137
  v_mul_f32 v146, v146, v137
  v_mul_f32 v147, v147, v137
  v_cvt_pk_bf16_f32 v132, v140, v141
  v_cvt_pk_bf16_f32 v133, v142, v143
  v_cvt_pk_bf16_f32 v134, v144, v145
  v_cvt_pk_bf16_f32 v135, v146, v147
  buffer_store_dwordx4 v[132:135], v0, s[4:7], s93 offen sc1
  v_cvt_pk_bf16_f32 v188, 0, v188
  v_ashrrev_i32 v189, 31, v188
  v_or_b32 v189, 0x80000000, v189
  v_xor_b32 v188, v188, v189
  s_sub_u32 s92, 4095, s90
  v_and_b32 v188, 0xffff0000, v188
  v_or_b32 v38, s92, v188
  s_bfe_u32 s92, s65, 196625
  s_lshl_b32 s92, s92, 18
  s_lshl_b32 s93, s90, 7
  s_add_u32 s92, s92, s93
  s_add_u32 s84, s92, 243269632
  s_waitcnt vmcnt(0)
  s_mov_b64 exec, 1
  buffer_store_dword v38, off, s[4:7], s84 sc1
  s_mov_b64 exec, -1
  s_mov_b32 s84, 268435456
  s_branch o_fd_175
o_rt_179:
  s_mov_b32 s67, 0
o_rl_181:
  s_lshl_b32 s94, s43, 14
  s_add_u32 s94, s94, s86
  buffer_load_dwordx4 v[120:123], v5, s[4:7], s94 offen offset:0 sc1
  buffer_load_dwordx4 v[124:127], v5, s[4:7], s94 offen offset:512 sc1
  buffer_load_dwordx4 v[128:131], v5, s[4:7], s94 offen offset:256 sc1
  buffer_load_dwordx4 v[132:135], v5, s[4:7], s94 offen offset:768 sc1
  s_add_u32 s94, s94, 4096
  buffer_load_dwordx4 v[136:139], v5, s[4:7], s94 offen offset:0 sc1
  buffer_load_dwordx4 v[140:143], v5, s[4:7], s94 offen offset:512 sc1
  buffer_load_dwordx4 v[144:147], v5, s[4:7], s94 offen offset:256 sc1
  buffer_load_dwordx4 v[148:151], v5, s[4:7], s94 offen offset:768 sc1
  s_add_u32 s94, s94, 4096
  buffer_load_dwordx4 v[152:155], v5, s[4:7], s94 offen offset:0 sc1
  buffer_load_dwordx4 v[156:159], v5, s[4:7], s94 offen offset:512 sc1
  buffer_load_dwordx4 v[160:163], v5, s[4:7], s94 offen offset:256 sc1
  buffer_load_dwordx4 v[164:167], v5, s[4:7], s94 offen offset:768 sc1
  s_add_u32 s94, s94, 4096
  buffer_load_dwordx4 v[168:171], v5, s[4:7], s94 offen offset:0 sc1
  buffer_load_dwordx4 v[172:175], v5, s[4:7], s94 offen offset:512 sc1
  buffer_load_dwordx4 v[176:179], v5, s[4:7], s94 offen offset:256 sc1
  buffer_load_dwordx4 v[180:183], v5, s[4:7], s94 offen offset:768 sc1
  s_add_u32 s67, s67, 1
  s_cmp_gt_u32 s67, 1048576
  s_cbranch_scc1 L_end
  s_waitcnt vmcnt(0)
  v_xor_b32 v7, s96, v120
  v_bitop3_b32 v7, v7, v124, s96 bitop3:0xf6
  v_bitop3_b32 v7, v7, v128, s96 bitop3:0xf6
  v_bitop3_b32 v7, v7, v132, s96 bitop3:0xf6
  v_bitop3_b32 v7, v7, v136, s96 bitop3:0xf6
  v_bitop3_b32 v7, v7, v140, s96 bitop3:0xf6
  v_bitop3_b32 v7, v7, v144, s96 bitop3:0xf6
  v_bitop3_b32 v7, v7, v148, s96 bitop3:0xf6
  v_bitop3_b32 v7, v7, v152, s96 bitop3:0xf6
  v_bitop3_b32 v7, v7, v156, s96 bitop3:0xf6
  v_bitop3_b32 v7, v7, v160, s96 bitop3:0xf6
  v_bitop3_b32 v7, v7, v164, s96 bitop3:0xf6
  v_bitop3_b32 v7, v7, v168, s96 bitop3:0xf6
  v_bitop3_b32 v7, v7, v172, s96 bitop3:0xf6
  v_bitop3_b32 v7, v7, v176, s96 bitop3:0xf6
  v_bitop3_b32 v7, v7, v180, s96 bitop3:0xf6
  v_and_b32 v7, v254, v7
  v_cmp_ne_u32 vcc, 0, v7
  s_cbranch_vccnz o_rl_181
  s_branch o_bk_180
o_f2_176:
  s_lshl_b32 s94, s43, 14
  s_add_u32 s94, s94, s86
  buffer_load_dwordx4 v[120:123], v5, s[4:7], s94 offen offset:0 sc1
  buffer_load_dwordx4 v[124:127], v5, s[4:7], s94 offen offset:512 sc1
  buffer_load_dwordx4 v[128:131], v5, s[4:7], s94 offen offset:256 sc1
  buffer_load_dwordx4 v[132:135], v5, s[4:7], s94 offen offset:768 sc1
  s_add_u32 s94, s94, 4096
  buffer_load_dwordx4 v[136:139], v5, s[4:7], s94 offen offset:0 sc1
  buffer_load_dwordx4 v[140:143], v5, s[4:7], s94 offen offset:512 sc1
  buffer_load_dwordx4 v[144:147], v5, s[4:7], s94 offen offset:256 sc1
  buffer_load_dwordx4 v[148:151], v5, s[4:7], s94 offen offset:768 sc1
  s_add_u32 s94, s94, 4096
  buffer_load_dwordx4 v[152:155], v5, s[4:7], s94 offen offset:0 sc1
  buffer_load_dwordx4 v[156:159], v5, s[4:7], s94 offen offset:512 sc1
  buffer_load_dwordx4 v[160:163], v5, s[4:7], s94 offen offset:256 sc1
  buffer_load_dwordx4 v[164:167], v5, s[4:7], s94 offen offset:768 sc1
  s_add_u32 s94, s94, 4096
  buffer_load_dwordx4 v[168:171], v5, s[4:7], s94 offen offset:0 sc1
  buffer_load_dwordx4 v[172:175], v5, s[4:7], s94 offen offset:512 sc1
  buffer_load_dwordx4 v[176:179], v5, s[4:7], s94 offen offset:256 sc1
  buffer_load_dwordx4 v[180:183], v5, s[4:7], s94 offen offset:768 sc1
  s_mov_b64 exec, 1
  buffer_store_dword v38, off, s[4:7], s84 sc1
  s_mov_b64 exec, -1
  s_mov_b32 s84, 268435456
  v_mov_b64 v[188:189], 0
  v_mov_b64 v[190:191], 0
  v_mov_b64 v[192:193], 0
  v_mov_b64 v[194:195], 0
  s_waitcnt vmcnt(13)
  v_xor_b32 v7, s96, v120
  v_bitop3_b32 v7, v7, v124, s96 bitop3:0xf6
  v_bitop3_b32 v7, v7, v128, s96 bitop3:0xf6
  v_bitop3_b32 v7, v7, v132, s96 bitop3:0xf6
  s_waitcnt vmcnt(9)
  v_bitop3_b32 v7, v7, v136, s96 bitop3:0xf6
  v_bitop3_b32 v7, v7, v140, s96 bitop3:0xf6
  v_bitop3_b32 v7, v7, v144, s96 bitop3:0xf6
  v_bitop3_b32 v7, v7, v148, s96 bitop3:0xf6
  s_waitcnt vmcnt(5)
  v_bitop3_b32 v7, v7, v152, s96 bitop3:0xf6
  v_bitop3_b32 v7, v7, v156, s96 bitop3:0xf6
  v_bitop3_b32 v7, v7, v160, s96 bitop3:0xf6
  v_bitop3_b32 v7, v7, v164, s96 bitop3:0xf6
  s_waitcnt vmcnt(1)
  v_bitop3_b32 v7, v7, v168, s96 bitop3:0xf6
  v_bitop3_b32 v7, v7, v172, s96 bitop3:0xf6
  v_bitop3_b32 v7, v7, v176, s96 bitop3:0xf6
  v_bitop3_b32 v7, v7, v180, s96 bitop3:0xf6
  v_and_b32 v7, v254, v7
  v_cmp_ne_u32 vcc, 0, v7
  s_cbranch_vccnz o_rt_182
o_bk_183:
  v_smfmac_f32_16x16x64_bf16 v[188:191], v[16:19], v[120:127], v20
  v_lshlrev_b32 v196, 16, v184
  v_smfmac_f32_16x16x64_bf16 v[192:195], v[16:19], v[128:135], v20
  v_and_b32 v197, 0xffff0000, v184
  v_smfmac_f32_16x16x64_bf16 v[188:191], v[16:19], v[136:143], v20
  v_lshlrev_b32 v198, 16, v185
  v_smfmac_f32_16x16x64_bf16 v[192:195], v[16:19], v[144:151], v20
  v_and_b32 v199, 0xffff0000, v185
  v_smfmac_f32_16x16x64_bf16 v[188:191], v[16:19], v[152:159], v20
  v_lshlrev_b32 v200, 16, v186
  v_smfmac_f32_16x16x64_bf16 v[192:195], v[16:19], v[160:167], v20
  v_and_b32 v201, 0xffff0000, v186
  v_smfmac_f32_16x16x64_bf16 v[188:191], v[16:19], v[168:175], v20
  v_lshlrev_b32 v202, 16, v187
  v_smfmac_f32_16x16x64_bf16 v[192:195], v[16:19], v[176:183], v20
  v_and_b32 v203, 0xffff0000, v187
  s_bfe_u32 s92, s65, 131086
  s_lshl_b32 s92, s92, 21
  s_add_u32 s92, s92, s91
  s_add_u32 s93, s92, 27262976
  s_add_u32 s92, s92, 20971520
  s_nop 1
  v_permlane16_swap_b32 v188, v192
  v_permlane16_swap_b32 v189, v193
  v_permlane16_swap_b32 v190, v194
  v_permlane16_swap_b32 v191, v195
  v_cvt_pk_bf16_f32 v188, 0, v188
  v_cvt_pk_bf16_f32 v189, 0, v189
  v_cvt_pk_bf16_f32 v190, 0, v190
  v_cvt_pk_bf16_f32 v191, 0, v191
  v_cvt_pk_bf16_f32 v192, 0, v192
  v_cvt_pk_bf16_f32 v193, 0, v193
  v_cvt_pk_bf16_f32 v194, 0, v194
  v_cvt_pk_bf16_f32 v195, 0, v195
  v_add_f32 v196, v196, v188
  v_add_f32 v197, v197, v189
  v_add_f32 v198, v198, v190
  v_add_f32 v199, v199, v191
  v_add_f32 v200, v200, v192
  v_add_f32 v201, v201, v193
  v_add_f32 v202, v202, v194
  v_add_f32 v203, v203, v195
  v_cvt_pk_bf16_f32 v120, v196, v197
  v_cvt_pk_bf16_f32 v121, v198, v199
  v_cvt_pk_bf16_f32 v122, v200, v201
  v_cvt_pk_bf16_f32 v123, v202, v203
  v_lshlrev_b32 v196, 16, v120
  v_and_b32 v197, 0xffff0000, v120
  v_lshlrev_b32 v198, 16, v121
  v_and_b32 v199, 0xffff0000, v121
  v_lshlrev_b32 v200, 16, v122
  v_and_b32 v201, 0xffff0000, v122
  v_lshlrev_b32 v202, 16, v123
  v_and_b32 v203, 0xffff0000, v123
  buffer_store_dwordx4 v[120:123], v0, s[4:7], s92 offen sc1
  v_add_f32 v136, v196, v197
  v_mul_f32 v137, v196, v196
  v_add_f32 v138, v198, v199
  v_mul_f32 v139, v197, v197
  v_fmac_f32 v137, v198, v198
  v_fmac_f32 v139, v199, v199
  v_add_f32 v136, v136, v200
  v_fmac_f32 v137, v200, v200
  v_add_f32 v138, v138, v201
  v_fmac_f32 v139, v201, v201
  v_add_f32 v136, v136, v202
  v_fmac_f32 v137, v202, v202
  v_add_f32 v138, v138, v203
  v_fmac_f32 v139, v203, v203
  v_add_f32 v136, v136, v138
  v_add_f32 v137, v137, v139
  s_nop 0
  v_add_f32_dpp v136, v136, v136 row_ror:8 row_mask:0xf bank_mask:0xf
  v_add_f32_dpp v137, v137, v137 row_ror:8 row_mask:0xf bank_mask:0xf
  s_nop 0
  v_add_f32_dpp v136, v136, v136 row_ror:4 row_mask:0xf bank_mask:0xf
  v_add_f32_dpp v137, v137, v137 row_ror:4 row_mask:0xf bank_mask:0xf
  s_nop 0
  v_add_f32_dpp v136, v136, v136 row_ror:2 row_mask:0xf bank_mask:0xf
  v_add_f32_dpp v137, v137, v137 row_ror:2 row_mask:0xf bank_mask:0xf
  s_nop 0
  v_add_f32_dpp v136, v136, v136 row_ror:1 row_mask:0xf bank_mask:0xf
  v_add_f32_dpp v137, v137, v137 row_ror:1 row_mask:0xf bank_mask:0xf
  v_mov_b32 v140, v136
  v_mov_b32 v141, v137
  s_nop 0
  v_permlane16_swap_b32 v136, v140
  v_permlane16_swap_b32 v137, v141
  v_add_f32 v136, v136, v140
  v_add_f32 v137, v137, v141
  v_mov_b32 v140, v136
  v_mov_b32 v141, v137
  s_nop 0
  v_permlane32_swap_b32 v136, v140
  v_permlane32_swap_b32 v137, v141
  v_add_f32 v136, v136, v140
  v_add_f32 v137, v137, v141
  v_mul_f32 v136, 0x3b000000, v136
  v_mul_f32 v137, 0x3b000000, v137
  v_fma_f32 v137, -v136, v136, v137
  v_cvt_pk_bf16_f32 v136, 0, v136
  v_max_f32 v137, 0, v137
  v_sub_f32 v140, v196, v136
  v_sub_f32 v141, v197, v136
  v_cvt_pk_bf16_f32 v137, 0, v137
  v_sub_f32 v142, v198, v136
  v_sub_f32 v143, v199, v136
  v_add_f32 v137, 0x3727c5ac, v137
  v_sub_f32 v144, v200, v136
  v_sub_f32 v145, v201, v136
  v_cvt_pk_bf16_f32 v137, 0, v137
  v_sub_f32 v146, v202, v136
  v_sub_f32 v147, v203, v136
  v_sqrt_f32 v137, v137
  v_cvt_pk_bf16_f32 v140, 0, v140
  v_cvt_pk_bf16_f32 v141, 0, v141
  v_cvt_pk_bf16_f32 v137, 0, v137
  v_cvt_pk_bf16_f32 v142, 0, v142
  v_cvt_pk_bf16_f32 v143, 0, v143
  v_rcp_f32 v137, v137
  v_cvt_pk_bf16_f32 v144, 0, v144
  v_cvt_pk_bf16_f32 v145, 0, v145
  v_cvt_pk_bf16_f32 v146, 0, v146
  v_cvt_pk_bf16_f32 v147, 0, v147
  v_mul_f32 v140, v140, v137
  v_mul_f32 v141, v141, v137
  v_mul_f32 v142, v142, v137
  v_mul_f32 v143, v143, v137
  v_mul_f32 v144, v144, v137
  v_mul_f32 v145, v145, v137
  v_mul_f32 v146, v146, v137
  v_mul_f32 v147, v147, v137
  v_cvt_pk_bf16_f32 v124, v140, v141
  v_cvt_pk_bf16_f32 v125, v142, v143
  v_cvt_pk_bf16_f32 v126, v144, v145
  v_cvt_pk_bf16_f32 v127, v146, v147
  v_lshlrev_b32 v204, 16, v124
  v_and_b32 v205, 0xffff0000, v124
  v_lshlrev_b32 v206, 16, v125
  v_and_b32 v207, 0xffff0000, v125
  v_lshlrev_b32 v208, 16, v126
  v_and_b32 v209, 0xffff0000, v126
  v_lshlrev_b32 v210, 16, v127
  v_and_b32 v211, 0xffff0000, v127
  buffer_store_dwordx4 v[124:127], v0, s[4:7], s93 offen sc1
  v_add_f32 v196, v196, v204
  v_add_f32 v197, v197, v205
  v_add_f32 v198, v198, v206
  v_add_f32 v199, v199, v207
  v_add_f32 v200, v200, v208
  v_add_f32 v201, v201, v209
  v_add_f32 v202, v202, v210
  v_add_f32 v203, v203, v211
  v_cvt_pk_bf16_f32 v128, v196, v197
  v_cvt_pk_bf16_f32 v129, v198, v199
  v_cvt_pk_bf16_f32 v130, v200, v201
  v_cvt_pk_bf16_f32 v131, v202, v203
  v_mul_f32 v188, v204, v8
  v_mul_f32 v189, v205, v9
  v_fmac_f32 v188, v206, v10
  v_fmac_f32 v189, v207, v11
  v_fmac_f32 v188, v208, v12
  v_fmac_f32 v189, v209, v13
  v_fmac_f32 v188, v210, v14
  v_fmac_f32 v189, v211, v15
  v_add_f32 v188, v188, v189
  buffer_store_dwordx4 v[128:131], v0, s[68:71], s91 offen sc1
  s_nop 0
  v_add_f32_dpp v188, v188, v188 row_ror:8 row_mask:0xf bank_mask:0xf
  s_nop 1
  v_add_f32_dpp v188, v188, v188 row_ror:4 row_mask:0xf bank_mask:0xf
  s_nop 1
  v_add_f32_dpp v188, v188, v188 row_ror:2 row_mask:0xf bank_mask:0xf
  s_nop 1
  v_add_f32_dpp v188, v188, v188 row_ror:1 row_mask:0xf bank_mask:0xf
  v_mov_b32 v189, v188
  s_nop 0
  s_nop 0
  v_permlane16_swap_b32 v188, v189
  v_add_f32 v188, v188, v189
  v_mov_b32 v189, v188
  s_nop 0
  s_nop 0
  v_permlane32_swap_b32 v188, v189
  v_add_f32 v188, v188, v189
  v_cvt_pk_bf16_f32 v188, 0, v188
  v_ashrrev_i32 v189, 31, v188
  v_or_b32 v189, 0x80000000, v189
  v_xor_b32 v188, v188, v189
  s_sub_u32 s92, 4095, s90
  v_and_b32 v188, 0xffff0000, v188
  v_or_b32 v38, s92, v188
  s_bfe_u32 s92, s65, 196625
  s_lshl_b32 s92, s92, 18
  s_lshl_b32 s93, s90, 7
  s_add_u32 s92, s92, s93
  s_add_u32 s84, s92, 243269632
  s_waitcnt vmcnt(0)
  s_mov_b64 exec, 1
  buffer_store_dword v38, off, s[4:7], s84 sc1
  s_mov_b64 exec, -1
  s_mov_b32 s84, 268435456
  s_branch o_fd_175
o_rt_182:
  s_mov_b32 s67, 0
o_rl_184:
  s_lshl_b32 s94, s43, 14
  s_add_u32 s94, s94, s86
  buffer_load_dwordx4 v[120:123], v5, s[4:7], s94 offen offset:0 sc1
  buffer_load_dwordx4 v[124:127], v5, s[4:7], s94 offen offset:512 sc1
  buffer_load_dwordx4 v[128:131], v5, s[4:7], s94 offen offset:256 sc1
  buffer_load_dwordx4 v[132:135], v5, s[4:7], s94 offen offset:768 sc1
  s_add_u32 s94, s94, 4096
  buffer_load_dwordx4 v[136:139], v5, s[4:7], s94 offen offset:0 sc1
  buffer_load_dwordx4 v[140:143], v5, s[4:7], s94 offen offset:512 sc1
  buffer_load_dwordx4 v[144:147], v5, s[4:7], s94 offen offset:256 sc1
  buffer_load_dwordx4 v[148:151], v5, s[4:7], s94 offen offset:768 sc1
  s_add_u32 s94, s94, 4096
  buffer_load_dwordx4 v[152:155], v5, s[4:7], s94 offen offset:0 sc1
  buffer_load_dwordx4 v[156:159], v5, s[4:7], s94 offen offset:512 sc1
  buffer_load_dwordx4 v[160:163], v5, s[4:7], s94 offen offset:256 sc1
  buffer_load_dwordx4 v[164:167], v5, s[4:7], s94 offen offset:768 sc1
  s_add_u32 s94, s94, 4096
  buffer_load_dwordx4 v[168:171], v5, s[4:7], s94 offen offset:0 sc1
  buffer_load_dwordx4 v[172:175], v5, s[4:7], s94 offen offset:512 sc1
  buffer_load_dwordx4 v[176:179], v5, s[4:7], s94 offen offset:256 sc1
  buffer_load_dwordx4 v[180:183], v5, s[4:7], s94 offen offset:768 sc1
  s_add_u32 s67, s67, 1
  s_cmp_gt_u32 s67, 1048576
  s_cbranch_scc1 L_end
  s_waitcnt vmcnt(0)
  v_xor_b32 v7, s96, v120
  v_bitop3_b32 v7, v7, v124, s96 bitop3:0xf6
  v_bitop3_b32 v7, v7, v128, s96 bitop3:0xf6
  v_bitop3_b32 v7, v7, v132, s96 bitop3:0xf6
  v_bitop3_b32 v7, v7, v136, s96 bitop3:0xf6
  v_bitop3_b32 v7, v7, v140, s96 bitop3:0xf6
  v_bitop3_b32 v7, v7, v144, s96 bitop3:0xf6
  v_bitop3_b32 v7, v7, v148, s96 bitop3:0xf6
  v_bitop3_b32 v7, v7, v152, s96 bitop3:0xf6
  v_bitop3_b32 v7, v7, v156, s96 bitop3:0xf6
  v_bitop3_b32 v7, v7, v160, s96 bitop3:0xf6
  v_bitop3_b32 v7, v7, v164, s96 bitop3:0xf6
  v_bitop3_b32 v7, v7, v168, s96 bitop3:0xf6
  v_bitop3_b32 v7, v7, v172, s96 bitop3:0xf6
  v_bitop3_b32 v7, v7, v176, s96 bitop3:0xf6
  v_bitop3_b32 v7, v7, v180, s96 bitop3:0xf6
  v_and_b32 v7, v254, v7
  v_cmp_ne_u32 vcc, 0, v7
  s_cbranch_vccnz o_rl_184
  s_branch o_bk_183
o_fd_175:
  s_mov_b32 s65, 0
o_nofl_135:
  s_mov_b32 s63, s64
  s_cmp_lg_u32 s51, 0
  s_cbranch_scc1 o_pick_137
  s_cmp_eq_u32 s50, 0
  s_cbranch_scc1 o_help_144_n
o_adv_143:
  s_add_u32 s49, s49, 4
  s_branch o_round_133
o_dl_145_a:
  s_andn2_b32 s26, s58, s55
  s_and_b32 s29, s26, s54
  s_bcnt1_i32_b32 s27, s29
  s_add_u32 s27, s27, 2
  s_max_u32 s27, s27, 4
  s_andn2_b32 s26, s26, s56
  s_and_b32 s26, s26, 0x3fff
  s_or_b32 s26, s26, s29
  s_cselect_b32 s27, s27, 0
  s_mul_i32 s27, s27, 0
  s_cmp_ge_u32 s46, s89
  s_cselect_b32 s30, s54, -1
  s_mov_b32 s31, 243269696
  s_branch o_dl_145_b
o_dl_145:
  s_and_b32 s26, s55, s54
  s_andn2_b32 s27, s56, s54
  s_or_b32 s26, s26, s27
  s_andn2_b32 s26, s58, s26
  s_bcnt1_i32_b32 s27, s26
  s_bcnt1_i32_b32 s28, s47
  s_mul_i32 s28, s28, -5
  s_lshl1_add_u32 s27, s27, s28
  s_add_i32 s27, s27, 1
  s_max_i32 s27, s27, 0
  s_mul_i32 s27, s27, 37
  s_mov_b32 s30, s54
  s_mov_b32 s31, 243269704
  s_and_b32 s29, s26, s47
  s_andn2_b32 s26, s26, s29
  s_branch o_dl_145_c
o_dl_145_b:
  s_mov_b32 s29, 0
o_dl_145_c:
  s_bfe_u32 s28, s48, 262144
  s_bitset0_b32 s26, s28
  s_bfe_u32 s28, s48, 262148
  s_bitset0_b32 s26, s28
  s_bfe_u32 s28, s48, 262152
  s_bitset0_b32 s26, s28
  s_bfe_u32 s28, s48, 262156
  s_bitset0_b32 s26, s28
  s_lshr_b32 s27, s27, 8
o_dl1_146:
  s_cbranch_scc0 o_dl2_147
  s_ff1_i32_b32 s28, s26
  s_bitset0_b32 s26, s28
  s_bitset1_b32 s29, s28
  s_sub_u32 s27, s27, 1
  s_cmp_lg_u32 s27, 0
  s_branch o_dl1_146
o_dl2_147:
  s_and_b32 s47, s29, 0xffff
  s_and_b32 s30, s30, s47
  s_or_b32 s55, s55, s30
  s_andn2_b32 s26, s47, s30
  s_or_b32 s56, s56, s26
  s_pack_ll_b32_b16 s26, s47, s30
  s_lshl_b32 s27, s60, 7
  s_add_u32 s27, s27, s31
  s_cmp_lg_u32 s43, 0
  s_cbranch_scc1 o_pick_137
  v_mov_b32 v162, s26
  v_mov_b32 v163, s46
  s_mov_b64 exec, 1
  buffer_store_dwordx2 v[162:163], off, s[4:7], s27 sc1
  s_mov_b64 exec, -1
  s_branch o_pick_137
o_help_144:
  s_lshl_b32 s60, s60, 1
  s_and_b32 s60, s60, 2
  s_lshl_b32 s47, s60, 7
  s_add_u32 s47, s47, 243269688
o_help_144_n:
  s_add_u32 s47, s47, 8
  s_lshr_b32 s26, s47, 4
  s_andn2_b32 s26, s57, s26
  s_cbranch_scc0 L_end
  s_mov_b32 s67, 0
o_help_144_w:
  buffer_load_dwordx2 v[162:163], off, s[4:7], s47 sc1
  buffer_load_dwordx2 v[164:165], off, s[4:7], s47 offset:128 sc1
  s_add_u32 s67, s67, 1
  s_cmp_gt_u32 s67, 1048576
  s_cbranch_scc1 L_end
  s_waitcnt vmcnt(0)
  v_readfirstlane_b32 s28, v162
  v_readfirstlane_b32 s30, v164
  v_readfirstlane_b32 s46, v163
  v_readfirstlane_b32 s27, v165
  s_min_u32 s26, s46, s27
  s_cmp_eq_u32 s26, 0
  s_cbranch_scc1 o_help_144_w
  s_max_u32 s46, s46, s27
  s_bitreplicate_b64_b32 s[28:29], s28
  s_bitreplicate_b64_b32 s[30:31], s30
  s_mov_b32 s26, 0x55555555
  s_mov_b32 s27, 0x55555555
  s_and_b64 s[28:29], s[28:29], s[26:27]
  s_andn2_b64 s[30:31], s[30:31], s[26:27]
  s_or_b32 s58, s28, s30
  s_or_b32 s54, s29, s31
  s_andn2_b32 s52, 0xfff, s46
  s_lshr_b32 s52, s52, 5
  s_mov_b32 s53, 0
  s_mov_b32 s63, 0
  s_mov_b32 s49, 72
  s_mov_b32 s59, 64
  s_mov_b32 s50, 0
  s_mov_b32 s89, 0
  s_branch o_pick_137
L_o_x:
  s_mov_b32 s62, 1
  s_mov_b32 s42, 0
  s_mov_b32 s3, 0
  s_mov_b32 s46, 0
  s_mov_b32 s65, 0
  s_mov_b32 s66, 0
  s_mov_b32 s76, 0
  s_mov_b32 s55, 0
  s_mov_b32 s48, 0
  s_mov_b32 s56, 0
  s_mov_b32 s84, 268435456
  s_mov_b32 s86, s41
  s_mov_b32 s49, s60
  s_mul_i32 s63, s49, 257
  s_or_b32 s63, s63, 1179648
  s_lshr_b32 s57, s60, 2
  s_cbranch_scc1 o_help_196
o_round_185:
  s_max_u32 s46, s46, s3
  s_cmp_lg_u32 s3, 0
  s_mov_b32 s3, 0
  s_cbranch_scc1 d_g_201
  s_mov_b32 s67, 0
d_w_200:
  s_min_u32 s26, s49, 71
  s_lshl_b32 s26, s26, 12
  s_add_u32 s27, s26, 243494912
  s_add_u32 s26, s26, 243486720
  buffer_load_dword v248, v246, s[4:7], s26 offen sc1
  buffer_load_dword v249, v246, s[4:7], s27 offen sc1
  s_add_u32 s67, s67, 1
  s_cmp_gt_u32 s67, 1048576
  s_cbranch_scc1 L_end
  s_waitcnt vmcnt(0)
  s_mov_b64 exec, 1
  buffer_store_dword v38, off, s[4:7], s84 sc1
  s_mov_b64 exec, -1
  s_mov_b32 s84, 268435456
  v_min_u32 v162, v248, v249
  v_max_u32 v163, v248, v249
  v_cmp_eq_u32 vcc, 0, v162
  s_cbranch_vccnz d_w_200
  v_max_u32_dpp v163, v163, v163 row_ror:8 row_mask:0xf bank_mask:0xf
  s_nop 1
  v_max_u32_dpp v163, v163, v163 row_ror:4 row_mask:0xf bank_mask:0xf
  s_nop 1
  v_max_u32_dpp v163, v163, v163 row_ror:2 row_mask:0xf bank_mask:0xf
  s_nop 1
  v_max_u32_dpp v163, v163, v163 row_ror:1 row_mask:0xf bank_mask:0xf
  s_nop 0
  v_readlane_b32 s28, v163, 0
  v_readlane_b32 s29, v163, 16
  v_readlane_b32 s30, v163, 32
  v_readlane_b32 s31, v163, 48
  s_max_u32 s28, s28, s29
  s_max_u32 s30, s30, s31
  s_max_u32 s46, s46, s28
  s_max_u32 s46, s46, s30
d_g_201:
  s_lshr_b32 s27, s49, 2
  s_andn2_b32 s52, 0xfff, s46
  s_lshr_b32 s52, s52, 5
  s_min_u32 s52, s52, 64
  s_add_u32 s26, s52, 3
  v_readlane_b32 s89, v247, s27
  s_sub_u32 s26, s26, s60
  s_lshr_b32 s26, s26, 2
  s_bfm_b32 s54, s26, 0
  s_add_u32 s53, s63, 1028
  s_cmp_lt_u32 s49, 60
  s_cselect_b32 s53, s53, 0
  s_cmp_lt_u32 s49, 64
  s_cselect_b32 s26, 3, 1
  s_sub_i32 s26, s27, s26
  s_max_i32 s26, s26, 0
  s_min_u32 s26, s26, 16
  s_bfm_b32 s58, s26, 0
  s_cmp_eq_u32 s27, 16
  s_cselect_b32 s59, 2, 1
  s_cmp_eq_u32 s27, 17
  s_cselect_b32 s59, 0, s59
  s_cmp_eq_u32 s27, 18
  s_cselect_b32 s59, 64, s59
  s_cselect_b32 s50, 0, -1
  s_cselect_b32 s89, 0, s89
  s_cbranch_scc1 o_dl_197
  s_cmp_eq_u32 s27, 16
  s_cbranch_scc1 o_dl_197_a
o_pick_189:
  s_cmp_eq_u32 s59, 0
  s_cbranch_scc1 o_none_193
  s_sub_u32 s59, s59, 1
  s_andn2_b32 s26, s58, s55
  s_and_b32 s26, s26, s54
  s_cbranch_scc1 o_ga_190
  s_and_b32 s26, s55, s50
  s_or_b32 s26, s26, s56
  s_or_b32 s26, s26, s54
  s_andn2_b32 s26, s58, s26
  s_cbranch_scc0 o_none_193
  s_cmp_ge_u32 s46, s89
  s_cbranch_scc1 o_gb_191
o_ga_190:
  s_ff1_i32_b32 s26, s26
  s_bitset1_b32 s55, s26
  s_mov_b32 s64, 1327168
  s_mov_b32 s27, s64
  s_branch o_gd_192
o_none_193:
  s_cmp_lt_u32 s49, 60
  s_cbranch_scc1 o_nn_194
  s_cmp_eq_u32 s50, 0
  s_cbranch_scc1 o_nn_194
  s_and_b32 s26, s63, 1097728
  s_cmp_eq_u32 s26, 1048576
  s_cbranch_scc1 o_nn_194
  s_cmp_lt_u32 s49, 64
  s_cbranch_scc1 o_adv_195
  s_and_b32 s26, s65, 1097728
  s_cmp_lg_u32 s26, 1048576
  s_cbranch_scc1 o_adv_195
o_nn_194:
  s_mov_b32 s64, s53
  s_mov_b32 s51, 0
  s_branch o_task_186
o_gb_191:
  s_ff1_i32_b32 s26, s26
  s_bitset1_b32 s56, s26
  s_andn2_b32 s27, 31, s46
  s_or_b32 s27, s27, 32
  s_lshl_b32 s27, s27, 22
  s_or_b32 s27, s27, 1474688
  s_mov_b32 s64, 1474624
o_gd_192:
  s_lshl4_add_u32 s48, s48, s26
  s_and_b32 s28, s26, s57
  s_lshr_b32 s26, s26, s57
  s_lshl2_add_u32 s26, s26, s60
  s_add_u32 s26, s26, s28
  s_cmp_eq_u32 s26, s52
  s_cselect_b32 s64, s27, s64
  s_mul_i32 s26, s26, 257
  s_or_b32 s64, s64, s26
  s_mov_b32 s51, 1
o_task_186:
  s_cmp_eq_u32 s63, 0
  s_cbranch_scc1 o_nofl_187
  s_cmp_lg_u32 s66, 0
  s_cbranch_scc1 o_have_203
  s_mov_b32 s67, 0
o_w1_202:
  s_and_b32 s32, s63, 0xff
  s_lshl_b32 s32, s32, 12
  s_add_u32 s32, s32, s14
  buffer_load_dword v37, v36, s[4:7], s32 offen sc1
  s_add_u32 s67, s67, 1
  s_cmp_gt_u32 s67, 1048576
  s_cbranch_scc1 L_end
  s_waitcnt vmcnt(0)
  s_mov_b64 exec, 1
  buffer_store_dword v38, off, s[4:7], s84 sc1
  s_mov_b64 exec, -1
  s_mov_b32 s84, 268435456
  v_cmp_eq_u32 vcc, 0, v37
  s_cbranch_vccnz o_w1_202
  s_and_b32 s87, s63, 0xff
  s_lshl_b32 s33, s87, 18
  s_lshl_b32 s32, s87, 19
  s_add_u32 m0, s22, 0
  s_add_u32 s33, s33, s19
  buffer_load_dwordx4 v0, s[4:7], s33 offen offset:0 sc1 lds
  buffer_load_dwordx4 v0, s[4:7], s33 offen offset:1024 sc1 lds
  buffer_load_dwordx4 v0, s[4:7], s33 offen offset:2048 sc1 lds
  buffer_load_dwordx4 v0, s[4:7], s33 offen offset:3072 sc1 lds
  s_add_u32 m0, s23, 0
  s_add_u32 s32, s32, s18
  buffer_load_dwordx4 v0, s[4:7], s32 offen offset:0 sc1 lds
  buffer_load_dwordx4 v0, s[4:7], s32 offen offset:1024 sc1 lds
  buffer_load_dwordx4 v0, s[4:7], s32 offen offset:2048 sc1 lds
  buffer_load_dwordx4 v0, s[4:7], s32 offen offset:3072 sc1 lds
  s_add_u32 m0, m0, 4096
  s_add_u32 s32, s32, 4096
  buffer_load_dwordx4 v0, s[4:7], s32 offen offset:0 sc1 lds
  buffer_load_dwordx4 v0, s[4:7], s32 offen offset:1024 sc1 lds
  buffer_load_dwordx4 v0, s[4:7], s32 offen offset:2048 sc1 lds
  buffer_load_dwordx4 v0, s[4:7], s32 offen offset:3072 sc1 lds
  s_waitcnt vmcnt(0)
  s_barrier
o_have_203:
  ds_read_b128 v[120:123], v33 offset:0
  ds_read_b128 v[40:43], v32 offset:0
  ds_read_b128 v[56:59], v32 offset:1024
  ds_read_b128 v[124:127], v33 offset:2048
  ds_read_b128 v[44:47], v32 offset:4096
  ds_read_b128 v[60:63], v32 offset:5120
  ds_read_b128 v[128:131], v33 offset:4096
  ds_read_b128 v[48:51], v32 offset:8192
  ds_read_b128 v[64:67], v32 offset:9216
  ds_read_b128 v[132:135], v33 offset:6144
  ds_read_b128 v[52:55], v32 offset:12288
  ds_read_b128 v[68:71], v32 offset:13312
  s_cmp_lt_u32 s17, 2
  s_cselect_b32 s65, s65, 0
  s_cmp_lg_u32 s65, 0
  s_cselect_b64 s[44:45], -1, 0
  s_mov_b32 s95, s86
  s_mov_b32 s96, s42
  s_lshl_b32 s97, s43, 14
  s_add_u32 s97, s97, s95
  s_and_b32 s87, s64, 0xff
  s_lshl_b32 s87, s87, 12
  s_add_u32 s87, s87, s14
  s_and_b32 s88, s63, 0xff00
  s_lshl_b32 s88, s88, 3
  s_add_u32 s88, s88, s15
  s_and_b32 s91, s65, 63
  s_lshl_b32 s90, s91, 5
  s_add_u32 s94, s90, s85
  s_add_u32 s90, s90, s43
  s_lshl_b32 s94, s94, 10
  s_lshr_b32 s92, s65, 22
  s_xor_b32 s93, s43, 32
  s_lshl_b32 s91, s90, 10
  s_add_u32 s94, s94, 25165824
  s_cmp_eq_u32 s92, s93
  s_cselect_b32 s92, s94, s91
  s_add_u32 s92, s92, 10485760
  s_and_b32 s93, s65, 49152
  s_cselect_b32 s92, s92, s91
  s_cselect_b64 s[80:81], s[4:5], s[72:73]
  s_cselect_b32 s82, s6, s74
  s_waitcnt lgkmcnt(9)
  v_mfma_f32_16x16x32_bf16 v[104:107], v[40:43], v[120:123], v[24:27]
  v_mfma_f32_16x16x32_bf16 v[108:111], v[56:59], v[120:123], v[28:31]
  s_mov_b64 exec, s[44:45]
  buffer_load_dword v7, v255, s[4:7], s97 offen sc1
  buffer_load_dwordx4 v[184:187], v0, s[80:83], s92 offen sc1
  s_not_b64 exec, exec
  buffer_load_dword v37, v36, s[4:7], s87 offen sc1
  s_mov_b64 exec, -1
  buffer_load_dword v244, v252, s[4:7], s88 offen sc1
  s_waitcnt lgkmcnt(6)
  v_mfma_f32_16x16x32_bf16 v[104:107], v[44:47], v[124:127], v[104:107]
  v_mfma_f32_16x16x32_bf16 v[108:111], v[60:63], v[124:127], v[108:111]
  s_waitcnt lgkmcnt(3)
  v_mfma_f32_16x16x32_bf16 v[104:107], v[48:51], v[128:131], v[104:107]
  v_mfma_f32_16x16x32_bf16 v[108:111], v[64:67], v[128:131], v[108:111]
  s_waitcnt lgkmcnt(0)
  v_mfma_f32_16x16x32_bf16 v[104:107], v[52:55], v[132:135], v[104:107]
  v_mfma_f32_16x16x32_bf16 v[108:111], v[68:71], v[132:135], v[108:111]
  s_cmp_lg_u32 s76, 0
  s_cbranch_scc1 o_klds_206
  v_mov_b32 v196, 0
  v_mov_b32 v199, 0
  v_exp_f32 v56, v104
  v_exp_f32 v57, v105
  v_exp_f32 v58, v106
  v_exp_f32 v59, v107
  v_exp_f32 v60, v108
  v_exp_f32 v61, v109
  v_exp_f32 v62, v110
  v_exp_f32 v63, v111
  v_max3_f32 v116, v104, v105, v106
  v_max3_f32 v116, v107, v108, v116
  v_max3_f32 v116, v109, v110, v116
  v_add_f32 v117, v56, v57
  v_add_f32 v118, v58, v59
  v_add_f32 v117, v117, v60
  v_add_f32 v118, v118, v61
  v_add_f32 v117, v117, v62
  v_add_f32 v118, v118, v63
  s_mov_b32 s67, 0
  s_and_b32 s32, s63, 0xff00
  s_lshl_b32 s32, s32, 10
  s_add_u32 s32, s32, s20
  s_add_u32 s33, s32, 4096
o_w2_204:
  s_waitcnt vmcnt(0)
  v_cmp_eq_u32 vcc, 0, v244
  s_cbranch_vccz o_kgo_214
  s_mov_b64 exec, 1
  buffer_store_dword v38, off, s[4:7], s84 sc1
  s_mov_b64 exec, -1
  s_mov_b32 s84, 268435456
  buffer_load_dword v244, v252, s[4:7], s88 offen sc1
  s_add_u32 s67, s67, 1
  s_cmp_gt_u32 s67, 1048576
  s_cbranch_scc1 L_end
  s_branch o_w2_204
o_kgo_214:
  buffer_load_dwordx4 v[136:139], v0, s[4:7], s32 offen offset:0 sc1
  buffer_load_dwordx4 v[140:143], v0, s[4:7], s32 offen offset:1024 sc1
  buffer_load_dwordx4 v[144:147], v0, s[4:7], s32 offen offset:2048 sc1
  buffer_load_dwordx4 v[148:151], v0, s[4:7], s32 offen offset:3072 sc1
  buffer_load_dwordx2 v[200:201], v1, s[4:7], s33 offen offset:0 sc1
  buffer_load_dwordx2 v[202:203], v1, s[4:7], s33 offen offset:512 sc1
  buffer_load_dwordx2 v[204:205], v1, s[4:7], s33 offen offset:1024 sc1
  buffer_load_dwordx2 v[206:207], v1, s[4:7], s33 offen offset:1536 sc1
  buffer_load_dword v37, v36, s[4:7], s87 offen sc1
  buffer_load_dword v244, v252, s[4:7], s88 offen sc1
  s_barrier
  ds_read_b128 v[152:155], v32 offset:2048
  ds_read_b128 v[156:159], v32 offset:3072
  ds_read_b128 v[160:163], v32 offset:6144
  ds_read_b128 v[164:167], v32 offset:7168
  ds_read_b128 v[168:171], v32 offset:10240
  ds_read_b128 v[172:175], v32 offset:11264
  ds_read_b128 v[176:179], v32 offset:14336
  ds_read_b128 v[180:183], v32 offset:15360
  s_waitcnt vmcnt(9)
  v_mfma_f32_16x16x32_bf16 v[112:115], v[136:139], v[120:123], 0
  s_waitcnt vmcnt(8)
  v_mfma_f32_16x16x32_bf16 v[112:115], v[140:143], v[124:127], v[112:115]
  s_waitcnt vmcnt(7)
  v_mfma_f32_16x16x32_bf16 v[112:115], v[144:147], v[128:131], v[112:115]
  s_waitcnt vmcnt(6)
  v_mfma_f32_16x16x32_bf16 v[112:115], v[148:151], v[132:135], v[112:115]
  s_waitcnt vmcnt(2)
  s_branch o_havek_205
o_klds_206:
  s_waitcnt vmcnt(12)
  s_barrier
  ds_read_b128 v[136:139], v34 offset:0
  ds_read_b128 v[140:143], v34 offset:1024
  ds_read_b128 v[144:147], v34 offset:2048
  ds_read_b128 v[148:151], v34 offset:3072
  ds_read_b64 v[200:201], v35 offset:4096
  ds_read_b64 v[202:203], v35 offset:4608
  ds_read_b64 v[204:205], v35 offset:5120
  ds_read_b64 v[206:207], v35 offset:5632
  v_mov_b32 v196, 0
  v_mov_b32 v199, 0
  v_exp_f32 v56, v104
  v_exp_f32 v57, v105
  v_exp_f32 v58, v106
  v_exp_f32 v59, v107
  v_exp_f32 v60, v108
  v_exp_f32 v61, v109
  v_exp_f32 v62, v110
  v_exp_f32 v63, v111
  v_max3_f32 v116, v104, v105, v106
  v_max3_f32 v116, v107, v108, v116
  v_max3_f32 v116, v109, v110, v116
  s_waitcnt lgkmcnt(4)
  v_mfma_f32_16x16x32_bf16 v[112:115], v[136:139], v[120:123], 0
  ds_read_b128 v[152:155], v32 offset:2048
  ds_read_b128 v[156:159], v32 offset:3072
  v_mfma_f32_16x16x32_bf16 v[112:115], v[140:143], v[124:127], v[112:115]
  ds_read_b128 v[160:163], v32 offset:6144
  ds_read_b128 v[164:167], v32 offset:7168
  v_mfma_f32_16x16x32_bf16 v[112:115], v[144:147], v[128:131], v[112:115]
  ds_read_b128 v[168:171], v32 offset:10240
  ds_read_b128 v[172:175], v32 offset:11264
  v_mfma_f32_16x16x32_bf16 v[112:115], v[148:151], v[132:135], v[112:115]
  ds_read_b128 v[176:179], v32 offset:14336
  ds_read_b128 v[180:183], v32 offset:15360
  v_add_f32 v117, v56, v57
  v_add_f32 v118, v58, v59
  v_add_f32 v117, v117, v60
  v_add_f32 v118, v118, v61
  v_add_f32 v117, v117, v62
  v_add_f32 v118, v118, v63
o_havek_205:
  s_cmp_lg_u32 s65, 0
  s_cbranch_scc1 o_wr1_211
  s_nop 3
  v_mul_f32 v112, s24, v112
  v_mul_f32 v113, s24, v113
  v_exp_f32 v64, v112
  v_exp_f32 v65, v113
  v_max_f32 v116, v111, v116
  v_max3_f32 v116, v112, v113, v116
  v_add_f32 v117, v117, v64
  v_add_f32 v118, v118, v65
  v_add_f32 v117, v117, v118
  s_mov_b32 s28, 0x21800000
  v_mov_b32 v118, v117
  s_nop 1
  v_permlane16_swap_b32 v117, v118
  v_add_f32 v117, v117, v118
  v_mov_b32 v118, v117
  s_nop 0
  s_nop 0
  v_permlane32_swap_b32 v117, v118
  v_add_f32 v117, v117, v118
  v_cmp_lt_f32 vcc, 0x42700000, v116
  v_cmp_gt_f32 s[30:31], s28, v117
  v_rcp_f32 v117, v117
  s_or_b64 vcc, vcc, s[30:31]
  s_cbranch_vccnz o_fb_215
o_fbr_216:
  v_pk_mul_f32 v[56:57], v[56:57], v[116:117] op_sel:[0,1] op_sel_hi:[1,1]
  v_pk_mul_f32 v[58:59], v[58:59], v[116:117] op_sel:[0,1] op_sel_hi:[1,1]
  v_pk_mul_f32 v[60:61], v[60:61], v[116:117] op_sel:[0,1] op_sel_hi:[1,1]
  v_pk_mul_f32 v[62:63], v[62:63], v[116:117] op_sel:[0,1] op_sel_hi:[1,1]
  v_pk_mul_f32 v[64:65], v[64:65], v[116:117] op_sel:[0,1] op_sel_hi:[1,1]
  v_cvt_pk_bf16_f32 v116, v56, v57
  v_cvt_pk_bf16_f32 v117, v58, v59
  v_cvt_pk_bf16_f32 v118, v60, v61
  v_cvt_pk_bf16_f32 v119, v62, v63
  s_waitcnt lgkmcnt(0)
  s_nop 0
  v_mfma_f32_16x16x32_bf16 v[72:75], v[152:155], v[116:119], 0
  s_add_u32 s62, s62, 1
  v_cvt_pk_bf16_f32 v197, v64, v65
  v_cvt_pk_bf16_f32 v198, v64, v65
  v_mfma_f32_16x16x32_bf16 v[76:79], v[156:159], v[116:119], 0
  s_xor_b32 s86, s86, 524288
  v_mfma_f32_16x16x32_bf16 v[80:83], v[160:163], v[116:119], 0
  s_bfe_u32 s42, s62, 0x10001
  v_mfma_f32_16x16x32_bf16 v[84:87], v[164:167], v[116:119], 0
  s_bfe_u32 s26, s64, 65556
  v_mfma_f32_16x16x32_bf16 v[88:91], v[168:171], v[116:119], 0
  s_and_b32 s87, s64, 0xff
  v_mfma_f32_16x16x32_bf16 v[92:95], v[172:175], v[116:119], 0
  s_bfe_u32 s88, s64, 0x80008
  v_mfma_f32_16x16x32_bf16 v[96:99], v[176:179], v[116:119], 0
  s_nop 0
  v_mfma_f32_16x16x32_bf16 v[100:103], v[180:183], v[116:119], 0
  s_nop 0
  v_mfma_f32_16x16x16_bf16 v[72:75], v[200:201], v[198:199], v[72:75]
  s_nop 1
  v_mfma_f32_16x16x16_bf16 v[76:79], v[200:201], v[196:197], v[76:79]
  s_nop 1
  v_mfma_f32_16x16x16_bf16 v[80:83], v[202:203], v[198:199], v[80:83]
  s_nop 1
  v_mfma_f32_16x16x16_bf16 v[84:87], v[202:203], v[196:197], v[84:87]
  s_nop 1
  v_mfma_f32_16x16x16_bf16 v[88:91], v[204:205], v[198:199], v[88:91]
  s_nop 0
  v_cvt_pk_bf16_f32 v40, v72, v73
  v_cvt_pk_bf16_f32 v41, v74, v75
  v_mfma_f32_16x16x16_bf16 v[92:95], v[204:205], v[196:197], v[92:95]
  s_nop 0
  v_cvt_pk_bf16_f32 v42, v76, v77
  v_cvt_pk_bf16_f32 v43, v78, v79
  v_mfma_f32_16x16x16_bf16 v[96:99], v[206:207], v[198:199], v[96:99]
  s_nop 0
  ds_write_b128 v6, v[40:43] offset:0
  v_cvt_pk_bf16_f32 v44, v80, v81
  v_mfma_f32_16x16x16_bf16 v[100:103], v[206:207], v[196:197], v[100:103]
  s_nop 0
  v_cvt_pk_bf16_f32 v45, v82, v83
  v_cvt_pk_bf16_f32 v46, v84, v85
  v_cvt_pk_bf16_f32 v47, v86, v87
  ds_write_b128 v6, v[44:47] offset:1024
  v_cvt_pk_bf16_f32 v48, v88, v89
  v_cvt_pk_bf16_f32 v49, v90, v91
  v_cvt_pk_bf16_f32 v50, v92, v93
  v_cvt_pk_bf16_f32 v51, v94, v95
  ds_write_b128 v6, v[48:51] offset:2048
  v_cvt_pk_bf16_f32 v52, v96, v97
  v_cvt_pk_bf16_f32 v53, v98, v99
  v_cvt_pk_bf16_f32 v54, v100, v101
  v_cvt_pk_bf16_f32 v55, v102, v103
  ds_write_b128 v6, v[52:55] offset:3072
  s_cmp_lt_u32 s17, 2
  s_cbranch_scc1 o_wr0_210
  s_waitcnt lgkmcnt(0)
  s_barrier
  ds_read_b128 v[104:107], v3 offset:0
  ds_read_b128 v[108:111], v3 offset:512
  ds_read_b128 v[112:115], v3 offset:1024
  s_waitcnt lgkmcnt(2)
  v_mfma_f32_32x32x16_bf16 v[40:55], v[104:107], a[0:3], 0
  s_waitcnt vmcnt(0)
  v_cmp_eq_u32 vcc, 0, v37
  s_cmp_eq_u64 vcc, 0
  s_cselect_b32 s66, s26, 0
  s_cmp_eq_u32 s66, 1
  s_cselect_b32 s87, s87, 1024
  s_cselect_b32 s34, 0, 0x28000
  v_mfma_f32_32x32x16_bf16 v[56:71], v[104:107], a[4:7], 0
  ds_read_b128 v[116:119], v3 offset:1536
  s_lshl_b32 s33, s87, 18
  s_lshl_b32 s32, s87, 19
  s_add_u32 m0, s22, s34
  s_add_u32 s33, s33, s19
  s_min_u32 s28, s49, 67
  v_mfma_f32_32x32x16_bf16 v[72:87], v[104:107], a[8:11], 0
  s_lshl1_add_u32 s28, s17, s28
  s_lshl_b32 s28, s28, 12
  s_add_u32 s28, s28, 243486720
  v_mfma_f32_32x32x16_bf16 v[88:103], v[104:107], a[12:15], 0
  buffer_load_dword v249, v246, s[4:7], s28 offen sc1
  s_waitcnt lgkmcnt(2)
  v_mfma_f32_32x32x16_bf16 v[40:55], v[108:111], a[16:19], v[40:55]
  buffer_load_dwordx4 v0, s[4:7], s33 offen offset:0 sc1 lds
  v_mfma_f32_32x32x16_bf16 v[56:71], v[108:111], a[20:23], v[56:71]
  ds_read_b128 v[104:107], v3 offset:2048
  v_mfma_f32_32x32x16_bf16 v[72:87], v[108:111], a[24:27], v[72:87]
  buffer_load_dwordx4 v0, s[4:7], s33 offen offset:1024 sc1 lds
  v_mfma_f32_32x32x16_bf16 v[88:103], v[108:111], a[28:31], v[88:103]
  buffer_load_dwordx4 v0, s[4:7], s33 offen offset:2048 sc1 lds
  s_waitcnt lgkmcnt(2)
  v_mfma_f32_32x32x16_bf16 v[40:55], v[112:115], a[32:35], v[40:55]
  v_mfma_f32_32x32x16_bf16 v[56:71], v[112:115], a[36:39], v[56:71]
  ds_read_b128 v[108:111], v3 offset:2560
  buffer_load_dwordx4 v0, s[4:7], s33 offen offset:3072 sc1 lds
  s_sub_u32 m0, m0, 8192
  s_sub_u32 s33, s33, 8192
  v_mfma_f32_32x32x16_bf16 v[72:87], v[112:115], a[40:43], v[72:87]
  buffer_load_dwordx4 v0, s[4:7], s33 offen offset:0 sc1 lds
  v_mfma_f32_32x32x16_bf16 v[88:103], v[112:115], a[44:47], v[88:103]
  s_waitcnt lgkmcnt(2)
  v_mfma_f32_32x32x16_bf16 v[40:55], v[116:119], a[48:51], v[40:55]
  buffer_load_dwordx4 v0, s[4:7], s33 offen offset:1024 sc1 lds
  v_mfma_f32_32x32x16_bf16 v[56:71], v[116:119], a[52:55], v[56:71]
  ds_read_b128 v[112:115], v3 offset:3072
  buffer_load_dwordx4 v0, s[4:7], s33 offen offset:2048 sc1 lds
  v_mfma_f32_32x32x16_bf16 v[72:87], v[116:119], a[56:59], v[72:87]
  v_mfma_f32_32x32x16_bf16 v[88:103], v[116:119], a[60:63], v[88:103]
  buffer_load_dwordx4 v0, s[4:7], s33 offen offset:3072 sc1 lds
  s_add_u32 m0, s23, s34
  s_add_u32 s32, s32, s18
  s_waitcnt lgkmcnt(2)
  v_mfma_f32_32x32x16_bf16 v[40:55], v[104:107], a[64:67], v[40:55]
  buffer_load_dwordx4 v0, s[4:7], s32 offen offset:0 sc1 lds
  v_mfma_f32_32x32x16_bf16 v[56:71], v[104:107], a[68:71], v[56:71]
  ds_read_b128 v[116:119], v3 offset:3584
  v_mfma_f32_32x32x16_bf16 v[72:87], v[104:107], a[72:75], v[72:87]
  buffer_load_dwordx4 v0, s[4:7], s32 offen offset:1024 sc1 lds
  s_add_i32 m0, m0, 4096
  s_add_i32 s32, s32, 4096
  v_mfma_f32_32x32x16_bf16 v[88:103], v[104:107], a[76:79], v[88:103]
  buffer_load_dwordx4 v0, s[4:7], s32 offen offset:0 sc1 lds
  s_waitcnt lgkmcnt(2)
  v_mfma_f32_32x32x16_bf16 v[40:55], v[108:111], a[80:83], v[40:55]
  v_mfma_f32_32x32x16_bf16 v[56:71], v[108:111], a[84:87], v[56:71]
  ds_read_b128 v[104:107], v3 offset:8192
  buffer_load_dwordx4 v0, s[4:7], s32 offen offset:1024 sc1 lds
  s_add_i32 m0, m0, -16384
  s_add_i32 s32, s32, -16384
  v_mfma_f32_32x32x16_bf16 v[72:87], v[108:111], a[88:91], v[72:87]
  s_and_b32 s29, s64, 0xff00
  s_lshl_b32 s29, s29, 3
  s_add_u32 s29, s29, s15
  buffer_load_dword v245, v252, s[4:7], s29 offen sc1
  v_mfma_f32_32x32x16_bf16 v[88:103], v[108:111], a[92:95], v[88:103]
  s_waitcnt lgkmcnt(2)
  v_mfma_f32_32x32x16_bf16 v[40:55], v[112:115], a[96:99], v[40:55]
  buffer_load_dwordx4 v0, s[4:7], s32 offen offset:0 sc1 lds
  v_mfma_f32_32x32x16_bf16 v[56:71], v[112:115], a[100:103], v[56:71]
  ds_read_b128 v[108:111], v3 offset:8704
  buffer_load_dwordx4 v0, s[4:7], s32 offen offset:1024 sc1 lds
  s_add_i32 m0, m0, -4096
  s_add_i32 s32, s32, -4096
  v_mfma_f32_32x32x16_bf16 v[72:87], v[112:115], a[104:107], v[72:87]
  v_mfma_f32_32x32x16_bf16 v[88:103], v[112:115], a[108:111], v[88:103]
  buffer_load_dwordx4 v0, s[4:7], s32 offen offset:0 sc1 lds
  s_waitcnt lgkmcnt(2)
  v_mfma_f32_32x32x16_bf16 v[40:55], v[116:119], a[112:115], v[40:55]
  buffer_load_dwordx4 v0, s[4:7], s32 offen offset:1024 sc1 lds
  v_mfma_f32_32x32x16_bf16 v[56:71], v[116:119], a[116:119], v[56:71]
  ds_read_b128 v[112:115], v3 offset:9216
  v_mfma_f32_32x32x16_bf16 v[72:87], v[116:119], a[120:123], v[72:87]
  buffer_load_dwordx4 v0, s[4:7], s32 offen offset:2048 sc1 lds
  v_mfma_f32_32x32x16_bf16 v[88:103], v[116:119], a[124:127], v[88:103]
  buffer_load_dwordx4 v0, s[4:7], s32 offen offset:3072 sc1 lds
  s_add_i32 m0, m0, 4096
  s_add_i32 s32, s32, 4096
  s_waitcnt lgkmcnt(2)
  v_mfma_f32_32x32x16_bf16 v[40:55], v[104:107], a[128:131], v[40:55]
  v_mfma_f32_32x32x16_bf16 v[56:71], v[104:107], a[132:135], v[56:71]
  ds_read_b128 v[116:119], v3 offset:9728
  buffer_load_dwordx4 v0, s[4:7], s32 offen offset:2048 sc1 lds
  v_mfma_f32_32x32x16_bf16 v[72:87], v[104:107], a[136:139], v[72:87]
  buffer_load_dwordx4 v0, s[4:7], s32 offen offset:3072 sc1 lds
  s_add_i32 m0, m0, 16384
  s_add_i32 s32, s32, 16384
  v_mfma_f32_32x32x16_bf16 v[88:103], v[104:107], a[140:143], v[88:103]
  s_waitcnt lgkmcnt(2)
  v_mfma_f32_32x32x16_bf16 v[40:55], v[108:111], a[144:147], v[40:55]
  buffer_load_dwordx4 v0, s[4:7], s32 offen offset:2048 sc1 lds
  v_mfma_f32_32x32x16_bf16 v[56:71], v[108:111], a[148:151], v[56:71]
  ds_read_b128 v[104:107], v3 offset:10240
  buffer_load_dwordx4 v0, s[4:7], s32 offen offset:3072 sc1 lds
  s_add_i32 m0, m0, -4096
  s_add_i32 s32, s32, -4096
  v_mfma_f32_32x32x16_bf16 v[72:87], v[108:111], a[152:155], v[72:87]
  v_mfma_f32_32x32x16_bf16 v[88:103], v[108:111], a[156:159], v[88:103]
  buffer_load_dwordx4 v0, s[4:7], s32 offen offset:2048 sc1 lds
  s_waitcnt lgkmcnt(2)
  v_mfma_f32_32x32x16_bf16 v[40:55], v[112:115], a[160:163], v[40:55]
  buffer_load_dwordx4 v0, s[4:7], s32 offen offset:3072 sc1 lds
  v_mfma_f32_32x32x16_bf16 v[56:71], v[112:115], a[164:167], v[56:71]
  ds_read_b128 v[108:111], v3 offset:10752
  v_mfma_f32_32x32x16_bf16 v[72:87], v[112:115], a[168:171], v[72:87]
  v_mfma_f32_32x32x16_bf16 v[88:103], v[112:115], a[172:175], v[88:103]
  s_waitcnt lgkmcnt(2)
  v_mfma_f32_32x32x16_bf16 v[40:55], v[116:119], a[176:179], v[40:55]
  v_mfma_f32_32x32x16_bf16 v[56:71], v[116:119], a[180:183], v[56:71]
  ds_read_b128 v[112:115], v3 offset:11264
  v_mfma_f32_32x32x16_bf16 v[72:87], v[116:119], a[184:187], v[72:87]
  v_mfma_f32_32x32x16_bf16 v[88:103], v[116:119], a[188:191], v[88:103]
  s_waitcnt lgkmcnt(2)
  v_mfma_f32_32x32x16_bf16 v[40:55], v[104:107], a[192:195], v[40:55]
  v_mfma_f32_32x32x16_bf16 v[56:71], v[104:107], a[196:199], v[56:71]
  ds_read_b128 v[116:119], v3 offset:11776
  s_waitcnt vmcnt(12)
  v_cmp_eq_u32 vcc, 0, v245
  s_cmp_eq_u64 vcc, 0
  s_cselect_b32 s76, s26, 0
  s_and_b32 s76, s76, 1
  s_cselect_b32 s88, s88, 1024
  s_waitcnt lgkmcnt(2)
  v_mfma_f32_32x32x16_bf16 v[40:55], v[108:111], a[208:211], v[40:55]
  s_lshl_b32 s32, s88, 18
  s_mov_b32 m0, s40
  s_add_u32 s32, s32, s21
  buffer_load_dwordx4 v0, s[4:7], s32 offen offset:0 sc1 lds
  v_mfma_f32_32x32x16_bf16 v[56:71], v[108:111], a[212:215], v[56:71]
  buffer_load_dwordx4 v0, s[4:7], s32 offen offset:1024 sc1 lds
  s_waitcnt lgkmcnt(1)
  v_mfma_f32_32x32x16_bf16 v[40:55], v[112:115], a[224:227], v[40:55]
  buffer_load_dwordx4 v0, s[4:7], s32 offen offset:2048 sc1 lds
  s_sub_u32 m0, m0, 8192
  s_sub_u32 s32, s32, 8192
  v_mfma_f32_32x32x16_bf16 v[56:71], v[112:115], a[228:231], v[56:71]
  buffer_load_dwordx4 v0, s[4:7], s32 offen offset:0 sc1 lds
  s_waitcnt lgkmcnt(0)
  v_mfma_f32_32x32x16_bf16 v[40:55], v[116:119], a[240:243], v[40:55]
  buffer_load_dwordx4 v0, s[4:7], s32 offen offset:1024 sc1 lds
  v_mfma_f32_32x32x16_bf16 v[56:71], v[116:119], a[244:247], v[56:71]
  buffer_load_dwordx4 v0, s[4:7], s32 offen offset:2048 sc1 lds
  v_cmp_eq_u32 vcc, 0, v249
  v_max_u32_dpp v249, v249, v249 row_ror:8 row_mask:0xf bank_mask:0xf
  s_nop 0
  v_mfma_f32_32x32x16_bf16 v[72:87], v[104:107], a[200:203], v[72:87]
  v_max_u32_dpp v249, v249, v249 row_ror:4 row_mask:0xf bank_mask:0xf
  s_nop 0
  s_nop 0
  v_max_u32_dpp v249, v249, v249 row_ror:2 row_mask:0xf bank_mask:0xf
  s_nop 0
  s_nop 0
  v_max_u32_dpp v249, v249, v249 row_ror:1 row_mask:0xf bank_mask:0xf
  s_nop 0
  v_mfma_f32_32x32x16_bf16 v[88:103], v[104:107], a[204:207], v[88:103]
  v_mov_b32 v248, v249
  s_nop 0
  s_nop 0
  v_permlane16_swap_b32 v249, v248
  v_max_u32 v249, v249, v248
  v_mfma_f32_32x32x16_bf16 v[72:87], v[108:111], a[216:219], v[72:87]
  v_mov_b32 v248, v249
  s_nop 0
  s_nop 0
  v_permlane32_swap_b32 v249, v248
  v_max_u32 v249, v249, v248
  s_cmp_eq_u64 vcc, 0
  s_cselect_b32 s28, 4, 0
  v_mfma_f32_32x32x16_bf16 v[88:103], v[108:111], a[220:223], v[88:103]
  s_lshl_b32 s26, s76, 1
  s_or_b32 s26, s26, s66
  s_or_b32 s26, s26, s28
  v_mov_b32 v248, s26
  ds_write_b64 v39, v[248:249]
  v_mfma_f32_32x32x16_bf16 v[72:87], v[112:115], a[232:235], v[72:87]
  v_cvt_pk_bf16_f32 v212, v40, v56
  v_cvt_pk_bf16_f32 v214, v41, v57
  v_cvt_pk_bf16_f32 v216, v42, v58
  v_cvt_pk_bf16_f32 v218, v43, v59
  v_permlane16_swap_b32 v212, v214
  v_mfma_f32_32x32x16_bf16 v[88:103], v[112:115], a[236:239], v[88:103]
  v_cvt_pk_bf16_f32 v220, v44, v60
  v_cvt_pk_bf16_f32 v222, v45, v61
  v_permlane16_swap_b32 v216, v218
  v_bfi_b32 v212, v254, s42, v212
  v_mfma_f32_32x32x16_bf16 v[72:87], v[116:119], a[248:251], v[72:87]
  v_cvt_pk_bf16_f32 v224, v46, v62
  v_cvt_pk_bf16_f32 v226, v47, v63
  v_permlane16_swap_b32 v220, v222
  v_bfi_b32 v216, v254, s42, v216
  v_cvt_pk_bf16_f32 v228, v48, v64
  v_mfma_f32_32x32x16_bf16 v[88:103], v[116:119], a[252:255], v[88:103]
  v_cvt_pk_bf16_f32 v230, v49, v65
  v_permlane16_swap_b32 v224, v226
  v_bfi_b32 v220, v254, s42, v220
  v_cvt_pk_bf16_f32 v232, v50, v66
  v_cvt_pk_bf16_f32 v234, v51, v67
  v_permlane16_swap_b32 v228, v230
  v_bfi_b32 v224, v254, s42, v224
  v_cvt_pk_bf16_f32 v236, v52, v68
  v_cvt_pk_bf16_f32 v238, v53, v69
  v_permlane16_swap_b32 v232, v234
  v_bfi_b32 v228, v254, s42, v228
  v_cvt_pk_bf16_f32 v240, v54, v70
  v_cvt_pk_bf16_f32 v242, v55, v71
  v_permlane16_swap_b32 v236, v238
  v_bfi_b32 v232, v254, s42, v232
  v_permlane16_swap_b32 v240, v242
  v_bfi_b32 v236, v254, s42, v236
  v_bfi_b32 v240, v254, s42, v240
  v_cvt_pk_bf16_f32 v213, v72, v88
  v_cvt_pk_bf16_f32 v215, v73, v89
  v_cvt_pk_bf16_f32 v217, v74, v90
  v_cvt_pk_bf16_f32 v219, v75, v91
  s_add_u32 s78, s86, 0
  v_permlane16_swap_b32 v213, v215
  buffer_store_dwordx4 v[212:215], v4, s[4:7], s78 offen sc1
  v_cvt_pk_bf16_f32 v221, v76, v92
  v_cvt_pk_bf16_f32 v223, v77, v93
  s_add_u32 s78, s86, 32768
  v_permlane16_swap_b32 v217, v219
  buffer_store_dwordx4 v[216:219], v4, s[4:7], s78 offen sc1
  v_cvt_pk_bf16_f32 v225, v78, v94
  v_cvt_pk_bf16_f32 v227, v79, v95
  s_add_u32 s78, s86, 131072
  v_permlane16_swap_b32 v221, v223
  buffer_store_dwordx4 v[220:223], v4, s[4:7], s78 offen sc1
  v_cvt_pk_bf16_f32 v229, v80, v96
  v_cvt_pk_bf16_f32 v231, v81, v97
  s_add_u32 s78, s86, 163840
  v_permlane16_swap_b32 v225, v227
  buffer_store_dwordx4 v[224:227], v4, s[4:7], s78 offen sc1
  v_cvt_pk_bf16_f32 v233, v82, v98
  v_cvt_pk_bf16_f32 v235, v83, v99
  s_add_u32 s78, s86, 262144
  v_permlane16_swap_b32 v229, v231
  buffer_store_dwordx4 v[228:231], v4, s[4:7], s78 offen sc1
  v_cvt_pk_bf16_f32 v237, v84, v100
  v_cvt_pk_bf16_f32 v239, v85, v101
  s_add_u32 s78, s86, 294912
  v_permlane16_swap_b32 v233, v235
  buffer_store_dwordx4 v[232:235], v4, s[4:7], s78 offen sc1
  v_cvt_pk_bf16_f32 v241, v86, v102
  v_cvt_pk_bf16_f32 v243, v87, v103
  s_add_u32 s78, s86, 393216
  v_permlane16_swap_b32 v237, v239
  buffer_store_dwordx4 v[236:239], v4, s[4:7], s78 offen sc1
  s_add_u32 s78, s86, 425984
  v_permlane16_swap_b32 v241, v243
  buffer_store_dwordx4 v[240:243], v4, s[4:7], s78 offen sc1
  s_waitcnt vmcnt(22)
  s_branch o_we_213
o_wr0_210:
  s_waitcnt lgkmcnt(0)
  s_barrier
  ds_read_b128 v[104:107], v3 offset:0
  ds_read_b128 v[108:111], v3 offset:512
  ds_read_b128 v[112:115], v3 offset:1024
  s_waitcnt lgkmcnt(2)
  v_mfma_f32_32x32x16_bf16 v[40:55], v[104:107], a[0:3], 0
  v_mfma_f32_32x32x16_bf16 v[56:71], v[104:107], a[4:7], 0
  ds_read_b128 v[116:119], v3 offset:1536
  v_mfma_f32_32x32x16_bf16 v[72:87], v[104:107], a[8:11], 0
  v_mfma_f32_32x32x16_bf16 v[88:103], v[104:107], a[12:15], 0
  s_waitcnt lgkmcnt(2)
  v_mfma_f32_32x32x16_bf16 v[40:55], v[108:111], a[16:19], v[40:55]
  v_mfma_f32_32x32x16_bf16 v[56:71], v[108:111], a[20:23], v[56:71]
  ds_read_b128 v[104:107], v3 offset:2048
  v_mfma_f32_32x32x16_bf16 v[72:87], v[108:111], a[24:27], v[72:87]
  v_mfma_f32_32x32x16_bf16 v[88:103], v[108:111], a[28:31], v[88:103]
  s_waitcnt lgkmcnt(2)
  v_mfma_f32_32x32x16_bf16 v[40:55], v[112:115], a[32:35], v[40:55]
  v_mfma_f32_32x32x16_bf16 v[56:71], v[112:115], a[36:39], v[56:71]
  ds_read_b128 v[108:111], v3 offset:2560
  v_mfma_f32_32x32x16_bf16 v[72:87], v[112:115], a[40:43], v[72:87]
  v_mfma_f32_32x32x16_bf16 v[88:103], v[112:115], a[44:47], v[88:103]
  s_waitcnt lgkmcnt(2)
  v_mfma_f32_32x32x16_bf16 v[40:55], v[116:119], a[48:51], v[40:55]
  v_mfma_f32_32x32x16_bf16 v[56:71], v[116:119], a[52:55], v[56:71]
  ds_read_b128 v[112:115], v3 offset:3072
  v_mfma_f32_32x32x16_bf16 v[72:87], v[116:119], a[56:59], v[72:87]
  v_mfma_f32_32x32x16_bf16 v[88:103], v[116:119], a[60:63], v[88:103]
  s_waitcnt lgkmcnt(2)
  v_mfma_f32_32x32x16_bf16 v[40:55], v[104:107], a[64:67], v[40:55]
  v_mfma_f32_32x32x16_bf16 v[56:71], v[104:107], a[68:71], v[56:71]
  ds_read_b128 v[116:119], v3 offset:3584
  v_mfma_f32_32x32x16_bf16 v[72:87], v[104:107], a[72:75], v[72:87]
  v_mfma_f32_32x32x16_bf16 v[88:103], v[104:107], a[76:79], v[88:103]
  s_waitcnt lgkmcnt(2)
  v_mfma_f32_32x32x16_bf16 v[40:55], v[108:111], a[80:83], v[40:55]
  v_mfma_f32_32x32x16_bf16 v[56:71], v[108:111], a[84:87], v[56:71]
  ds_read_b128 v[104:107], v3 offset:8192
  v_mfma_f32_32x32x16_bf16 v[72:87], v[108:111], a[88:91], v[72:87]
  v_mfma_f32_32x32x16_bf16 v[88:103], v[108:111], a[92:95], v[88:103]
  s_waitcnt lgkmcnt(2)
  v_mfma_f32_32x32x16_bf16 v[40:55], v[112:115], a[96:99], v[40:55]
  v_mfma_f32_32x32x16_bf16 v[56:71], v[112:115], a[100:103], v[56:71]
  ds_read_b128 v[108:111], v3 offset:8704
  v_mfma_f32_32x32x16_bf16 v[72:87], v[112:115], a[104:107], v[72:87]
  v_mfma_f32_32x32x16_bf16 v[88:103], v[112:115], a[108:111], v[88:103]
  s_waitcnt lgkmcnt(2)
  v_mfma_f32_32x32x16_bf16 v[40:55], v[116:119], a[112:115], v[40:55]
  v_mfma_f32_32x32x16_bf16 v[56:71], v[116:119], a[116:119], v[56:71]
  ds_read_b128 v[112:115], v3 offset:9216
  v_mfma_f32_32x32x16_bf16 v[72:87], v[116:119], a[120:123], v[72:87]
  v_mfma_f32_32x32x16_bf16 v[88:103], v[116:119], a[124:127], v[88:103]
  s_waitcnt lgkmcnt(2)
  v_mfma_f32_32x32x16_bf16 v[40:55], v[104:107], a[128:131], v[40:55]
  v_mfma_f32_32x32x16_bf16 v[56:71], v[104:107], a[132:135], v[56:71]
  ds_read_b128 v[116:119], v3 offset:9728
  v_mfma_f32_32x32x16_bf16 v[72:87], v[104:107], a[136:139], v[72:87]
  v_mfma_f32_32x32x16_bf16 v[88:103], v[104:107], a[140:143], v[88:103]
  s_waitcnt lgkmcnt(2)
  v_mfma_f32_32x32x16_bf16 v[40:55], v[108:111], a[144:147], v[40:55]
  v_mfma_f32_32x32x16_bf16 v[56:71], v[108:111], a[148:151], v[56:71]
  ds_read_b128 v[104:107], v3 offset:10240
  v_mfma_f32_32x32x16_bf16 v[72:87], v[108:111], a[152:155], v[72:87]
  v_mfma_f32_32x32x16_bf16 v[88:103], v[108:111], a[156:159], v[88:103]
  s_waitcnt lgkmcnt(2)
  v_mfma_f32_32x32x16_bf16 v[40:55], v[112:115], a[160:163], v[40:55]
  v_mfma_f32_32x32x16_bf16 v[56:71], v[112:115], a[164:167], v[56:71]
  ds_read_b128 v[108:111], v3 offset:10752
  v_mfma_f32_32x32x16_bf16 v[72:87], v[112:115], a[168:171], v[72:87]
  v_mfma_f32_32x32x16_bf16 v[88:103], v[112:115], a[172:175], v[88:103]
  s_waitcnt lgkmcnt(2)
  v_mfma_f32_32x32x16_bf16 v[40:55], v[116:119], a[176:179], v[40:55]
  v_mfma_f32_32x32x16_bf16 v[56:71], v[116:119], a[180:183], v[56:71]
  ds_read_b128 v[112:115], v3 offset:11264
  v_mfma_f32_32x32x16_bf16 v[72:87], v[116:119], a[184:187], v[72:87]
  v_mfma_f32_32x32x16_bf16 v[88:103], v[116:119], a[188:191], v[88:103]
  s_waitcnt lgkmcnt(2)
  v_mfma_f32_32x32x16_bf16 v[40:55], v[104:107], a[192:195], v[40:55]
  v_mfma_f32_32x32x16_bf16 v[56:71], v[104:107], a[196:199], v[56:71]
  ds_read_b128 v[116:119], v3 offset:11776
  s_waitcnt lgkmcnt(2)
  v_mfma_f32_32x32x16_bf16 v[40:55], v[108:111], a[208:211], v[40:55]
  v_mfma_f32_32x32x16_bf16 v[56:71], v[108:111], a[212:215], v[56:71]
  s_waitcnt lgkmcnt(1)
  v_mfma_f32_32x32x16_bf16 v[40:55], v[112:115], a[224:227], v[40:55]
  v_mfma_f32_32x32x16_bf16 v[56:71], v[112:115], a[228:231], v[56:71]
  s_waitcnt lgkmcnt(0)
  v_mfma_f32_32x32x16_bf16 v[40:55], v[116:119], a[240:243], v[40:55]
  v_mfma_f32_32x32x16_bf16 v[56:71], v[116:119], a[244:247], v[56:71]
  v_mfma_f32_32x32x16_bf16 v[72:87], v[104:107], a[200:203], v[72:87]
  v_mfma_f32_32x32x16_bf16 v[88:103], v[104:107], a[204:207], v[88:103]
  v_cvt_pk_bf16_f32 v212, v40, v56
  v_cvt_pk_bf16_f32 v214, v41, v57
  v_cvt_pk_bf16_f32 v216, v42, v58
  v_cvt_pk_bf16_f32 v218, v43, v59
  v_permlane16_swap_b32 v212, v214
  v_mfma_f32_32x32x16_bf16 v[72:87], v[108:111], a[216:219], v[72:87]
  v_cvt_pk_bf16_f32 v220, v44, v60
  v_cvt_pk_bf16_f32 v222, v45, v61
  v_permlane16_swap_b32 v216, v218
  v_bfi_b32 v212, v254, s42, v212
  v_cvt_pk_bf16_f32 v224, v46, v62
  v_mfma_f32_32x32x16_bf16 v[88:103], v[108:111], a[220:223], v[88:103]
  v_cvt_pk_bf16_f32 v226, v47, v63
  v_permlane16_swap_b32 v220, v222
  v_bfi_b32 v216, v254, s42, v216
  v_cvt_pk_bf16_f32 v228, v48, v64
  v_mfma_f32_32x32x16_bf16 v[72:87], v[112:115], a[232:235], v[72:87]
  v_cvt_pk_bf16_f32 v230, v49, v65
  v_permlane16_swap_b32 v224, v226
  v_bfi_b32 v220, v254, s42, v220
  v_cvt_pk_bf16_f32 v232, v50, v66
  v_cvt_pk_bf16_f32 v234, v51, v67
  v_mfma_f32_32x32x16_bf16 v[88:103], v[112:115], a[236:239], v[88:103]
  v_permlane16_swap_b32 v228, v230
  v_bfi_b32 v224, v254, s42, v224
  v_cvt_pk_bf16_f32 v236, v52, v68
  v_cvt_pk_bf16_f32 v238, v53, v69
  v_mfma_f32_32x32x16_bf16 v[72:87], v[116:119], a[248:251], v[72:87]
  v_permlane16_swap_b32 v232, v234
  v_bfi_b32 v228, v254, s42, v228
  v_cvt_pk_bf16_f32 v240, v54, v70
  v_cvt_pk_bf16_f32 v242, v55, v71
  v_permlane16_swap_b32 v236, v238
  v_mfma_f32_32x32x16_bf16 v[88:103], v[116:119], a[252:255], v[88:103]
  v_bfi_b32 v232, v254, s42, v232
  v_permlane16_swap_b32 v240, v242
  v_bfi_b32 v236, v254, s42, v236
  v_bfi_b32 v240, v254, s42, v240
  s_nop 7
  v_cvt_pk_bf16_f32 v213, v72, v88
  v_cvt_pk_bf16_f32 v215, v73, v89
  v_cvt_pk_bf16_f32 v217, v74, v90
  v_cvt_pk_bf16_f32 v219, v75, v91
  s_add_u32 s78, s86, 0
  v_permlane16_swap_b32 v213, v215
  buffer_store_dwordx4 v[212:215], v4, s[4:7], s78 offen sc1
  v_cvt_pk_bf16_f32 v221, v76, v92
  v_cvt_pk_bf16_f32 v223, v77, v93
  s_add_u32 s78, s86, 32768
  v_permlane16_swap_b32 v217, v219
  buffer_store_dwordx4 v[216:219], v4, s[4:7], s78 offen sc1
  v_cvt_pk_bf16_f32 v225, v78, v94
  v_cvt_pk_bf16_f32 v227, v79, v95
  s_add_u32 s78, s86, 131072
  v_permlane16_swap_b32 v221, v223
  buffer_store_dwordx4 v[220:223], v4, s[4:7], s78 offen sc1
  v_cvt_pk_bf16_f32 v229, v80, v96
  v_cvt_pk_bf16_f32 v231, v81, v97
  s_add_u32 s78, s86, 163840
  v_permlane16_swap_b32 v225, v227
  buffer_store_dwordx4 v[224:227], v4, s[4:7], s78 offen sc1
  v_cvt_pk_bf16_f32 v233, v82, v98
  v_cvt_pk_bf16_f32 v235, v83, v99
  s_add_u32 s78, s86, 262144
  v_permlane16_swap_b32 v229, v231
  buffer_store_dwordx4 v[228:231], v4, s[4:7], s78 offen sc1
  v_cvt_pk_bf16_f32 v237, v84, v100
  v_cvt_pk_bf16_f32 v239, v85, v101
  s_add_u32 s78, s86, 294912
  v_permlane16_swap_b32 v233, v235
  buffer_store_dwordx4 v[232:235], v4, s[4:7], s78 offen sc1
  v_cvt_pk_bf16_f32 v241, v86, v102
  v_cvt_pk_bf16_f32 v243, v87, v103
  s_add_u32 s78, s86, 393216
  v_permlane16_swap_b32 v237, v239
  buffer_store_dwordx4 v[236:239], v4, s[4:7], s78 offen sc1
  s_add_u32 s78, s86, 425984
  v_permlane16_swap_b32 v241, v243
  buffer_store_dwordx4 v[240:243], v4, s[4:7], s78 offen sc1
  s_branch o_we_213
o_wr1_211:
  s_nop 3
  v_mul_f32 v112, s24, v112
  v_mul_f32 v113, s24, v113
  v_exp_f32 v64, v112
  v_exp_f32 v65, v113
  v_max_f32 v116, v111, v116
  v_max3_f32 v116, v112, v113, v116
  v_add_f32 v117, v117, v64
  v_add_f32 v118, v118, v65
  v_add_f32 v117, v117, v118
  s_mov_b32 s28, 0x21800000
  v_mov_b32 v118, v117
  s_nop 1
  v_permlane16_swap_b32 v117, v118
  v_add_f32 v117, v117, v118
  v_mov_b32 v118, v117
  s_nop 0
  s_nop 0
  v_permlane32_swap_b32 v117, v118
  v_add_f32 v117, v117, v118
  s_mov_b32 s67, 0
  s_mov_b64 vcc, 0
  s_waitcnt vmcnt(3)
o_pl_219:
  v_and_b32 v7, 1, v7
  v_cmp_ne_u32 vcc, s96, v7
  s_cbranch_vccz o_pk_220
  buffer_load_dword v7, v255, s[4:7], s97 offen sc1
  s_add_u32 s67, s67, 1
  s_cmp_gt_u32 s67, 1048576
  s_cbranch_scc1 L_end
  s_waitcnt vmcnt(0)
  s_branch o_pl_219
o_pk_220:
  s_lshl_b32 s94, s43, 14
  s_add_u32 s94, s94, s95
  buffer_load_dwordx4 v[120:123], v5, s[4:7], s94 offen offset:0 sc1
  v_cmp_lt_f32 vcc, 0x42700000, v116
  v_cmp_gt_f32 s[30:31], s28, v117
  v_rcp_f32 v117, v117
  buffer_load_dwordx4 v[124:127], v5, s[4:7], s94 offen offset:512 sc1
  s_or_b64 vcc, vcc, s[30:31]
  s_cbranch_vccnz o_fb_217
o_fbr_218:
  buffer_load_dwordx4 v[128:131], v5, s[4:7], s94 offen offset:256 sc1
  v_pk_mul_f32 v[56:57], v[56:57], v[116:117] op_sel:[0,1] op_sel_hi:[1,1]
  v_pk_mul_f32 v[58:59], v[58:59], v[116:117] op_sel:[0,1] op_sel_hi:[1,1]
  v_pk_mul_f32 v[60:61], v[60:61], v[116:117] op_sel:[0,1] op_sel_hi:[1,1]
  v_pk_mul_f32 v[62:63], v[62:63], v[116:117] op_sel:[0,1] op_sel_hi:[1,1]
  v_pk_mul_f32 v[64:65], v[64:65], v[116:117] op_sel:[0,1] op_sel_hi:[1,1]
  buffer_load_dwordx4 v[132:135], v5, s[4:7], s94 offen offset:768 sc1
  v_cvt_pk_bf16_f32 v116, v56, v57
  v_cvt_pk_bf16_f32 v117, v58, v59
  v_cvt_pk_bf16_f32 v118, v60, v61
  v_cvt_pk_bf16_f32 v119, v62, v63
  s_waitcnt lgkmcnt(0)
  s_nop 0
  v_mfma_f32_16x16x32_bf16 v[72:75], v[152:155], v[116:119], 0
  s_add_u32 s62, s62, 1
  v_cvt_pk_bf16_f32 v197, v64, v65
  v_cvt_pk_bf16_f32 v198, v64, v65
  v_mfma_f32_16x16x32_bf16 v[76:79], v[156:159], v[116:119], 0
  s_add_u32 s94, s94, 4096
  buffer_load_dwordx4 v[136:139], v5, s[4:7], s94 offen offset:0 sc1
  s_xor_b32 s86, s86, 524288
  v_mfma_f32_16x16x32_bf16 v[80:83], v[160:163], v[116:119], 0
  s_bfe_u32 s42, s62, 0x10001
  v_mfma_f32_16x16x32_bf16 v[84:87], v[164:167], v[116:119], 0
  buffer_load_dwordx4 v[140:143], v5, s[4:7], s94 offen offset:512 sc1
  v_mfma_f32_16x16x32_bf16 v[88:91], v[168:171], v[116:119], 0
  v_mfma_f32_16x16x32_bf16 v[92:95], v[172:175], v[116:119], 0
  buffer_load_dwordx4 v[144:147], v5, s[4:7], s94 offen offset:256 sc1
  v_mfma_f32_16x16x32_bf16 v[96:99], v[176:179], v[116:119], 0
  v_mfma_f32_16x16x32_bf16 v[100:103], v[180:183], v[116:119], 0
  buffer_load_dwordx4 v[148:151], v5, s[4:7], s94 offen offset:768 sc1
  v_mfma_f32_16x16x16_bf16 v[72:75], v[200:201], v[198:199], v[72:75]
  s_nop 1
  v_mfma_f32_16x16x16_bf16 v[76:79], v[200:201], v[196:197], v[76:79]
  s_add_u32 s94, s94, 4096
  buffer_load_dwordx4 v[152:155], v5, s[4:7], s94 offen offset:0 sc1
  v_mfma_f32_16x16x16_bf16 v[80:83], v[202:203], v[198:199], v[80:83]
  s_nop 1
  v_mfma_f32_16x16x16_bf16 v[84:87], v[202:203], v[196:197], v[84:87]
  buffer_load_dwordx4 v[156:159], v5, s[4:7], s94 offen offset:512 sc1
  v_mfma_f32_16x16x16_bf16 v[88:91], v[204:205], v[198:199], v[88:91]
  s_nop 0
  v_cvt_pk_bf16_f32 v40, v72, v73
  v_cvt_pk_bf16_f32 v41, v74, v75
  v_mfma_f32_16x16x16_bf16 v[92:95], v[204:205], v[196:197], v[92:95]
  buffer_load_dwordx4 v[160:163], v5, s[4:7], s94 offen offset:256 sc1
  v_cvt_pk_bf16_f32 v42, v76, v77
  v_cvt_pk_bf16_f32 v43, v78, v79
  v_mfma_f32_16x16x16_bf16 v[96:99], v[206:207], v[198:199], v[96:99]
  s_nop 0
  ds_write_b128 v6, v[40:43] offset:0
  v_cvt_pk_bf16_f32 v44, v80, v81
  v_mfma_f32_16x16x16_bf16 v[100:103], v[206:207], v[196:197], v[100:103]
  buffer_load_dwordx4 v[164:167], v5, s[4:7], s94 offen offset:768 sc1
  v_cvt_pk_bf16_f32 v45, v82, v83
  v_cvt_pk_bf16_f32 v46, v84, v85
  v_cvt_pk_bf16_f32 v47, v86, v87
  ds_write_b128 v6, v[44:47] offset:1024
  v_cvt_pk_bf16_f32 v48, v88, v89
  v_cvt_pk_bf16_f32 v49, v90, v91
  v_cvt_pk_bf16_f32 v50, v92, v93
  v_cvt_pk_bf16_f32 v51, v94, v95
  s_add_u32 s94, s94, 4096
  buffer_load_dwordx4 v[168:171], v5, s[4:7], s94 offen offset:0 sc1
  ds_write_b128 v6, v[48:51] offset:2048
  v_cvt_pk_bf16_f32 v52, v96, v97
  v_cvt_pk_bf16_f32 v53, v98, v99
  v_cvt_pk_bf16_f32 v54, v100, v101
  v_cvt_pk_bf16_f32 v55, v102, v103
  ds_write_b128 v6, v[52:55] offset:3072
  buffer_load_dwordx4 v[172:175], v5, s[4:7], s94 offen offset:512 sc1
  s_and_b32 s26, s65, 49152
  s_cbranch_scc1 o_wr2_212
  s_waitcnt lgkmcnt(0)
  s_barrier
  ds_read_b128 v[104:107], v3 offset:0
  ds_read_b128 v[108:111], v3 offset:512
  ds_read_b128 v[112:115], v3 offset:1024
  buffer_load_dwordx4 v[176:179], v5, s[4:7], s94 offen offset:256 sc1
  buffer_load_dwordx4 v[180:183], v5, s[4:7], s94 offen offset:768 sc1
  s_waitcnt lgkmcnt(2)
  v_mfma_f32_32x32x16_bf16 v[40:55], v[104:107], a[0:3], 0
  v_mov_b64 v[188:189], 0
  v_mov_b64 v[190:191], 0
  v_mov_b64 v[192:193], 0
  v_mov_b64 v[194:195], 0
  s_mov_b64 exec, 1
  buffer_store_dword v38, off, s[4:7], s84 sc1
  s_mov_b64 exec, -1
  s_mov_b32 s84, 268435456
  v_mfma_f32_32x32x16_bf16 v[56:71], v[104:107], a[4:7], 0
  ds_read_b128 v[116:119], v3 offset:1536
  v_mfma_f32_32x32x16_bf16 v[72:87], v[104:107], a[8:11], 0
  v_mfma_f32_32x32x16_bf16 v[88:103], v[104:107], a[12:15], 0
  s_waitcnt vmcnt(13)
  v_xor_b32 v7, s96, v120
  v_bitop3_b32 v7, v7, v124, s96 bitop3:0xf6
  v_bitop3_b32 v7, v7, v128, s96 bitop3:0xf6
  v_bitop3_b32 v7, v7, v132, s96 bitop3:0xf6
  s_waitcnt lgkmcnt(2)
  v_mfma_f32_32x32x16_bf16 v[40:55], v[108:111], a[16:19], v[40:55]
  s_waitcnt vmcnt(9)
  v_bitop3_b32 v7, v7, v136, s96 bitop3:0xf6
  v_bitop3_b32 v7, v7, v140, s96 bitop3:0xf6
  v_bitop3_b32 v7, v7, v144, s96 bitop3:0xf6
  v_bitop3_b32 v7, v7, v148, s96 bitop3:0xf6
  s_waitcnt vmcnt(5)
  v_mfma_f32_32x32x16_bf16 v[56:71], v[108:111], a[20:23], v[56:71]
  ds_read_b128 v[104:107], v3 offset:2048
  v_bitop3_b32 v7, v7, v152, s96 bitop3:0xf6
  v_bitop3_b32 v7, v7, v156, s96 bitop3:0xf6
  v_bitop3_b32 v7, v7, v160, s96 bitop3:0xf6
  v_bitop3_b32 v7, v7, v164, s96 bitop3:0xf6
  s_waitcnt vmcnt(1)
  v_mfma_f32_32x32x16_bf16 v[72:87], v[108:111], a[24:27], v[72:87]
  v_bitop3_b32 v7, v7, v168, s96 bitop3:0xf6
  v_bitop3_b32 v7, v7, v172, s96 bitop3:0xf6
  v_bitop3_b32 v7, v7, v176, s96 bitop3:0xf6
  v_bitop3_b32 v7, v7, v180, s96 bitop3:0xf6
  v_and_b32 v7, v254, v7
  v_cmp_ne_u32 vcc, 0, v7
  s_cbranch_vccnz o_rt_221
o_bk_222:
  v_mfma_f32_32x32x16_bf16 v[88:103], v[108:111], a[28:31], v[88:103]
  v_smfmac_f32_16x16x64_bf16 v[188:191], v[16:19], v[120:127], v20
  v_lshlrev_b32 v196, 16, v184
  v_smfmac_f32_16x16x64_bf16 v[192:195], v[16:19], v[128:135], v20
  v_and_b32 v197, 0xffff0000, v184
  v_smfmac_f32_16x16x64_bf16 v[188:191], v[16:19], v[136:143], v20
  v_lshlrev_b32 v198, 16, v185
  s_waitcnt lgkmcnt(2)
  v_mfma_f32_32x32x16_bf16 v[40:55], v[112:115], a[32:35], v[40:55]
  v_smfmac_f32_16x16x64_bf16 v[192:195], v[16:19], v[144:151], v20
  v_and_b32 v199, 0xffff0000, v185
  v_smfmac_f32_16x16x64_bf16 v[188:191], v[16:19], v[152:159], v20
  v_lshlrev_b32 v200, 16, v186
  v_smfmac_f32_16x16x64_bf16 v[192:195], v[16:19], v[160:167], v20
  v_and_b32 v201, 0xffff0000, v186
  v_mfma_f32_32x32x16_bf16 v[56:71], v[112:115], a[36:39], v[56:71]
  ds_read_b128 v[108:111], v3 offset:2560
  v_smfmac_f32_16x16x64_bf16 v[188:191], v[16:19], v[168:175], v20
  v_lshlrev_b32 v202, 16, v187
  v_smfmac_f32_16x16x64_bf16 v[192:195], v[16:19], v[176:183], v20
  v_and_b32 v203, 0xffff0000, v187
  s_bfe_u32 s92, s65, 131086
  v_mfma_f32_32x32x16_bf16 v[72:87], v[112:115], a[40:43], v[72:87]
  s_lshl_b32 s92, s92, 21
  s_add_u32 s92, s92, s91
  s_add_u32 s93, s92, 27262976
  s_add_u32 s92, s92, 20971520
  v_permlane16_swap_b32 v188, v192
  v_mfma_f32_32x32x16_bf16 v[88:103], v[112:115], a[44:47], v[88:103]
  v_permlane16_swap_b32 v189, v193
  v_permlane16_swap_b32 v190, v194
  v_permlane16_swap_b32 v191, v195
  s_waitcnt lgkmcnt(2)
  v_mfma_f32_32x32x16_bf16 v[40:55], v[116:119], a[48:51], v[40:55]
  v_cvt_pk_bf16_f32 v188, 0, v188
  v_cvt_pk_bf16_f32 v189, 0, v189
  v_cvt_pk_bf16_f32 v190, 0, v190
  v_cvt_pk_bf16_f32 v191, 0, v191
  v_cvt_pk_bf16_f32 v192, 0, v192
  v_cvt_pk_bf16_f32 v193, 0, v193
  v_mfma_f32_32x32x16_bf16 v[56:71], v[116:119], a[52:55], v[56:71]
  ds_read_b128 v[112:115], v3 offset:3072
  v_cvt_pk_bf16_f32 v194, 0, v194
  v_cvt_pk_bf16_f32 v195, 0, v195
  v_add_f32 v196, v196, v188
  v_add_f32 v197, v197, v189
  v_add_f32 v198, v198, v190
  v_mfma_f32_32x32x16_bf16 v[72:87], v[116:119], a[56:59], v[72:87]
  v_add_f32 v199, v199, v191
  v_add_f32 v200, v200, v192
  v_add_f32 v201, v201, v193
  v_add_f32 v202, v202, v194
  v_add_f32 v203, v203, v195
  v_cvt_pk_bf16_f32 v120, v196, v197
  v_mfma_f32_32x32x16_bf16 v[88:103], v[116:119], a[60:63], v[88:103]
  v_cvt_pk_bf16_f32 v121, v198, v199
  v_cvt_pk_bf16_f32 v122, v200, v201
  v_cvt_pk_bf16_f32 v123, v202, v203
  v_lshlrev_b32 v196, 16, v120
  v_and_b32 v197, 0xffff0000, v120
  s_waitcnt lgkmcnt(2)
  v_mfma_f32_32x32x16_bf16 v[40:55], v[104:107], a[64:67], v[40:55]
  v_lshlrev_b32 v198, 16, v121
  v_and_b32 v199, 0xffff0000, v121
  v_lshlrev_b32 v200, 16, v122
  v_and_b32 v201, 0xffff0000, v122
  v_lshlrev_b32 v202, 16, v123
  v_and_b32 v203, 0xffff0000, v123
  v_mfma_f32_32x32x16_bf16 v[56:71], v[104:107], a[68:71], v[56:71]
  ds_read_b128 v[116:119], v3 offset:3584
  buffer_store_dwordx4 v[120:123], v0, s[4:7], s92 offen sc1
  v_add_f32 v136, v196, v197
  v_mul_f32 v137, v196, v196
  v_mfma_f32_32x32x16_bf16 v[72:87], v[104:107], a[72:75], v[72:87]
  v_add_f32 v138, v198, v199
  v_mul_f32 v139, v197, v197
  v_fmac_f32 v137, v198, v198
  v_fmac_f32 v139, v199, v199
  v_add_f32 v136, v136, v200
  v_fmac_f32 v137, v200, v200
  v_mfma_f32_32x32x16_bf16 v[88:103], v[104:107], a[76:79], v[88:103]
  v_add_f32 v138, v138, v201
  v_fmac_f32 v139, v201, v201
  v_add_f32 v136, v136, v202
  v_fmac_f32 v137, v202, v202
  v_add_f32 v138, v138, v203
  s_waitcnt lgkmcnt(2)
  v_mfma_f32_32x32x16_bf16 v[40:55], v[108:111], a[80:83], v[40:55]
  v_fmac_f32 v139, v203, v203
  v_add_f32 v136, v136, v138
  v_add_f32 v137, v137, v139
  s_nop 0
  v_add_f32_dpp v136, v136, v136 row_ror:8 row_mask:0xf bank_mask:0xf
  v_add_f32_dpp v137, v137, v137 row_ror:8 row_mask:0xf bank_mask:0xf
  s_nop 0
  v_add_f32_dpp v136, v136, v136 row_ror:4 row_mask:0xf bank_mask:0xf
  v_mfma_f32_32x32x16_bf16 v[56:71], v[108:111], a[84:87], v[56:71]
  ds_read_b128 v[104:107], v3 offset:8192
  v_add_f32_dpp v137, v137, v137 row_ror:4 row_mask:0xf bank_mask:0xf
  v_add_f32_dpp v136, v136, v136 row_ror:2 row_mask:0xf bank_mask:0xf
  s_nop 0
  v_add_f32_dpp v137, v137, v137 row_ror:2 row_mask:0xf bank_mask:0xf
  v_add_f32_dpp v136, v136, v136 row_ror:1 row_mask:0xf bank_mask:0xf
  s_nop 0
  v_add_f32_dpp v137, v137, v137 row_ror:1 row_mask:0xf bank_mask:0xf
  v_mfma_f32_32x32x16_bf16 v[72:87], v[108:111], a[88:91], v[72:87]
  v_mov_b32 v140, v136
  v_mov_b32 v141, v137
  s_nop 0
  v_permlane16_swap_b32 v136, v140
  v_permlane16_swap_b32 v137, v141
  v_mfma_f32_32x32x16_bf16 v[88:103], v[108:111], a[92:95], v[88:103]
  v_add_f32 v136, v136, v140
  v_add_f32 v137, v137, v141
  v_mov_b32 v140, v136
  v_mov_b32 v141, v137
  s_nop 0
  v_permlane32_swap_b32 v136, v140
  s_waitcnt lgkmcnt(2)
  v_mfma_f32_32x32x16_bf16 v[40:55], v[112:115], a[96:99], v[40:55]
  v_permlane32_swap_b32 v137, v141
  v_add_f32 v136, v136, v140
  v_add_f32 v137, v137, v141
  v_mul_f32 v136, 0x3b000000, v136
  v_mul_f32 v137, 0x3b000000, v137
  v_mfma_f32_32x32x16_bf16 v[56:71], v[112:115], a[100:103], v[56:71]
  ds_read_b128 v[108:111], v3 offset:8704
  v_fma_f32 v137, -v136, v136, v137
  v_cvt_pk_bf16_f32 v136, 0, v136
  v_max_f32 v137, 0, v137
  v_sub_f32 v140, v196, v136
  v_sub_f32 v141, v197, v136
  v_mfma_f32_32x32x16_bf16 v[72:87], v[112:115], a[104:107], v[72:87]
  v_cvt_pk_bf16_f32 v137, 0, v137
  v_sub_f32 v142, v198, v136
  v_sub_f32 v143, v199, v136
  v_add_f32 v137, 0x3727c5ac, v137
  v_sub_f32 v144, v200, v136
  v_sub_f32 v145, v201, v136
  v_mfma_f32_32x32x16_bf16 v[88:103], v[112:115], a[108:111], v[88:103]
  v_cvt_pk_bf16_f32 v137, 0, v137
  v_sub_f32 v146, v202, v136
  v_sub_f32 v147, v203, v136
  v_sqrt_f32 v137, v137
  s_waitcnt lgkmcnt(2)
  v_mfma_f32_32x32x16_bf16 v[40:55], v[116:119], a[112:115], v[40:55]
  v_cvt_pk_bf16_f32 v140, 0, v140
  v_cvt_pk_bf16_f32 v141, 0, v141
  v_cvt_pk_bf16_f32 v137, 0, v137
  v_cvt_pk_bf16_f32 v142, 0, v142
  v_cvt_pk_bf16_f32 v143, 0, v143
  v_rcp_f32 v137, v137
  v_mfma_f32_32x32x16_bf16 v[56:71], v[116:119], a[116:119], v[56:71]
  ds_read_b128 v[112:115], v3 offset:9216
  v_cvt_pk_bf16_f32 v144, 0, v144
  v_cvt_pk_bf16_f32 v145, 0, v145
  v_cvt_pk_bf16_f32 v146, 0, v146
  v_cvt_pk_bf16_f32 v147, 0, v147
  v_mul_f32 v140, v140, v137
  v_mfma_f32_32x32x16_bf16 v[72:87], v[116:119], a[120:123], v[72:87]
  v_mul_f32 v141, v141, v137
  v_mul_f32 v142, v142, v137
  v_mul_f32 v143, v143, v137
  v_mul_f32 v144, v144, v137
  v_mul_f32 v145, v145, v137
  v_mul_f32 v146, v146, v137
  v_mfma_f32_32x32x16_bf16 v[88:103], v[116:119], a[124:127], v[88:103]
  v_mul_f32 v147, v147, v137
  v_cvt_pk_bf16_f32 v124, v140, v141
  v_cvt_pk_bf16_f32 v125, v142, v143
  v_cvt_pk_bf16_f32 v126, v144, v145
  v_cvt_pk_bf16_f32 v127, v146, v147
  s_waitcnt lgkmcnt(2)
  v_mfma_f32_32x32x16_bf16 v[40:55], v[104:107], a[128:131], v[40:55]
  v_lshlrev_b32 v204, 16, v124
  v_and_b32 v205, 0xffff0000, v124
  v_lshlrev_b32 v206, 16, v125
  v_and_b32 v207, 0xffff0000, v125
  v_lshlrev_b32 v208, 16, v126
  v_and_b32 v209, 0xffff0000, v126
  v_mfma_f32_32x32x16_bf16 v[56:71], v[104:107], a[132:135], v[56:71]
  ds_read_b128 v[116:119], v3 offset:9728
  v_lshlrev_b32 v210, 16, v127
  v_and_b32 v211, 0xffff0000, v127
  buffer_store_dwordx4 v[124:127], v0, s[4:7], s93 offen sc1
  v_mfma_f32_32x32x16_bf16 v[72:87], v[104:107], a[136:139], v[72:87]
  v_add_f32 v196, v196, v204
  v_add_f32 v197, v197, v205
  v_add_f32 v198, v198, v206
  v_add_f32 v199, v199, v207
  v_add_f32 v200, v200, v208
  v_add_f32 v201, v201, v209
  v_mfma_f32_32x32x16_bf16 v[88:103], v[104:107], a[140:143], v[88:103]
  v_add_f32 v202, v202, v210
  v_add_f32 v203, v203, v211
  v_cvt_pk_bf16_f32 v128, v196, v197
  v_cvt_pk_bf16_f32 v129, v198, v199
  v_cvt_pk_bf16_f32 v130, v200, v201
  s_waitcnt lgkmcnt(2)
  v_mfma_f32_32x32x16_bf16 v[40:55], v[108:111], a[144:147], v[40:55]
  v_cvt_pk_bf16_f32 v131, v202, v203
  v_mul_f32 v188, v204, v8
  v_mul_f32 v189, v205, v9
  v_fmac_f32 v188, v206, v10
  v_fmac_f32 v189, v207, v11
  v_fmac_f32 v188, v208, v12
  v_mfma_f32_32x32x16_bf16 v[56:71], v[108:111], a[148:151], v[56:71]
  ds_read_b128 v[104:107], v3 offset:10240
  v_fmac_f32 v189, v209, v13
  v_fmac_f32 v188, v210, v14
  v_fmac_f32 v189, v211, v15
  v_add_f32 v188, v188, v189
  s_add_u32 s92, s91, 10485760
  v_mfma_f32_32x32x16_bf16 v[72:87], v[108:111], a[152:155], v[72:87]
  s_add_u32 s93, s91, 8388608
  buffer_store_dwordx4 v[128:131], v0, s[4:7], s92 offen sc1
  v_lshlrev_b32 v196, 16, v128
  v_and_b32 v197, 0xffff0000, v128
  v_mfma_f32_32x32x16_bf16 v[88:103], v[108:111], a[156:159], v[88:103]
  v_lshlrev_b32 v198, 16, v129
  v_and_b32 v199, 0xffff0000, v129
  v_lshlrev_b32 v200, 16, v130
  v_and_b32 v201, 0xffff0000, v130
  v_lshlrev_b32 v202, 16, v131
  s_waitcnt lgkmcnt(2)
  v_mfma_f32_32x32x16_bf16 v[40:55], v[112:115], a[160:163], v[40:55]
  v_and_b32 v203, 0xffff0000, v131
  v_add_f32 v136, v196, v197
  v_mul_f32 v137, v196, v196
  v_add_f32 v138, v198, v199
  v_mul_f32 v139, v197, v197
  v_fmac_f32 v137, v198, v198
  v_mfma_f32_32x32x16_bf16 v[56:71], v[112:115], a[164:167], v[56:71]
  ds_read_b128 v[108:111], v3 offset:10752
  v_fmac_f32 v139, v199, v199
  v_add_f32 v136, v136, v200
  v_fmac_f32 v137, v200, v200
  v_add_f32 v138, v138, v201
  v_fmac_f32 v139, v201, v201
  v_mfma_f32_32x32x16_bf16 v[72:87], v[112:115], a[168:171], v[72:87]
  v_add_f32 v136, v136, v202
  v_fmac_f32 v137, v202, v202
  v_add_f32 v138, v138, v203
  v_fmac_f32 v139, v203, v203
  v_add_f32 v136, v136, v138
  v_add_f32 v137, v137, v139
  v_mfma_f32_32x32x16_bf16 v[88:103], v[112:115], a[172:175], v[88:103]
  v_add_f32_dpp v136, v136, v136 row_ror:8 row_mask:0xf bank_mask:0xf
  v_add_f32_dpp v137, v137, v137 row_ror:8 row_mask:0xf bank_mask:0xf
  v_add_f32_dpp v188, v188, v188 row_ror:8 row_mask:0xf bank_mask:0xf
  v_add_f32_dpp v136, v136, v136 row_ror:4 row_mask:0xf bank_mask:0xf
  v_add_f32_dpp v137, v137, v137 row_ror:4 row_mask:0xf bank_mask:0xf
  s_waitcnt lgkmcnt(2)
  v_mfma_f32_32x32x16_bf16 v[40:55], v[116:119], a[176:179], v[40:55]
  v_add_f32_dpp v188, v188, v188 row_ror:4 row_mask:0xf bank_mask:0xf
  v_add_f32_dpp v136, v136, v136 row_ror:2 row_mask:0xf bank_mask:0xf
  v_add_f32_dpp v137, v137, v137 row_ror:2 row_mask:0xf bank_mask:0xf
  v_add_f32_dpp v188, v188, v188 row_ror:2 row_mask:0xf bank_mask:0xf
  v_add_f32_dpp v136, v136, v136 row_ror:1 row_mask:0xf bank_mask:0xf
  v_add_f32_dpp v137, v137, v137 row_ror:1 row_mask:0xf bank_mask:0xf
  v_mfma_f32_32x32x16_bf16 v[56:71], v[116:119], a[180:183], v[56:71]
  ds_read_b128 v[112:115], v3 offset:11264
  v_add_f32_dpp v188, v188, v188 row_ror:1 row_mask:0xf bank_mask:0xf
  v_mov_b32 v140, v136
  v_mov_b32 v141, v137
  v_mov_b32 v142, v188
  v_permlane16_swap_b32 v136, v140
  v_mfma_f32_32x32x16_bf16 v[72:87], v[116:119], a[184:187], v[72:87]
  v_permlane16_swap_b32 v137, v141
  v_permlane16_swap_b32 v188, v142
  v_add_f32 v136, v136, v140
  v_add_f32 v137, v137, v141
  v_mfma_f32_32x32x16_bf16 v[88:103], v[116:119], a[188:191], v[88:103]
  v_add_f32 v188, v188, v142
  v_mov_b32 v140, v136
  v_mov_b32 v141, v137
  v_mov_b32 v142, v188
  v_permlane32_swap_b32 v136, v140
  s_waitcnt lgkmcnt(2)
  v_mfma_f32_32x32x16_bf16 v[40:55], v[104:107], a[192:195], v[40:55]
  v_permlane32_swap_b32 v137, v141
  v_permlane32_swap_b32 v188, v142
  v_add_f32 v136, v136, v140
  v_add_f32 v137, v137, v141
  v_mfma_f32_32x32x16_bf16 v[56:71], v[104:107], a[196:199], v[56:71]
  ds_read_b128 v[116:119], v3 offset:11776
  v_add_f32 v188, v188, v142
  v_mul_f32 v136, 0x3b000000, v136
  v_mul_f32 v137, 0x3b000000, v137
  v_fma_f32 v137, -v136, v136, v137
  v_cvt_pk_bf16_f32 v136, 0, v136
  s_waitcnt lgkmcnt(2)
  v_mfma_f32_32x32x16_bf16 v[40:55], v[108:111], a[208:211], v[40:55]
  v_max_f32 v137, 0, v137
  v_sub_f32 v140, v196, v136
  v_sub_f32 v141, v197, v136
  v_cvt_pk_bf16_f32 v137, 0, v137
  v_sub_f32 v142, v198, v136
  v_sub_f32 v143, v199, v136
  v_mfma_f32_32x32x16_bf16 v[56:71], v[108:111], a[212:215], v[56:71]
  v_add_f32 v137, 0x3727c5ac, v137
  v_sub_f32 v144, v200, v136
  v_sub_f32 v145, v201, v136
  v_cvt_pk_bf16_f32 v137, 0, v137
  v_sub_f32 v146, v202, v136
  v_sub_f32 v147, v203, v136
  s_waitcnt lgkmcnt(1)
  v_mfma_f32_32x32x16_bf16 v[40:55], v[112:115], a[224:227], v[40:55]
  v_sqrt_f32 v137, v137
  v_cvt_pk_bf16_f32 v140, 0, v140
  v_cvt_pk_bf16_f32 v141, 0, v141
  v_cvt_pk_bf16_f32 v137, 0, v137
  v_cvt_pk_bf16_f32 v142, 0, v142
  v_mfma_f32_32x32x16_bf16 v[56:71], v[112:115], a[228:231], v[56:71]
  v_cvt_pk_bf16_f32 v143, 0, v143
  v_rcp_f32 v137, v137
  v_cvt_pk_bf16_f32 v144, 0, v144
  v_cvt_pk_bf16_f32 v145, 0, v145
  v_cvt_pk_bf16_f32 v146, 0, v146
  s_waitcnt lgkmcnt(0)
  v_mfma_f32_32x32x16_bf16 v[40:55], v[116:119], a[240:243], v[40:55]
  v_cvt_pk_bf16_f32 v147, 0, v147
  v_mul_f32 v140, v140, v137
  v_mul_f32 v141, v141, v137
  v_mul_f32 v142, v142, v137
  v_mul_f32 v143, v143, v137
  v_mul_f32 v144, v144, v137
  v_mfma_f32_32x32x16_bf16 v[56:71], v[116:119], a[244:247], v[56:71]
  v_mul_f32 v145, v145, v137
  v_mul_f32 v146, v146, v137
  v_mul_f32 v147, v147, v137
  v_cvt_pk_bf16_f32 v132, v140, v141
  v_cvt_pk_bf16_f32 v133, v142, v143
  v_cvt_pk_bf16_f32 v134, v144, v145
  v_mfma_f32_32x32x16_bf16 v[72:87], v[104:107], a[200:203], v[72:87]
  v_cvt_pk_bf16_f32 v135, v146, v147
  buffer_store_dwordx4 v[132:135], v0, s[4:7], s93 offen sc1
  v_cvt_pk_bf16_f32 v188, 0, v188
  v_ashrrev_i32 v189, 31, v188
  v_mfma_f32_32x32x16_bf16 v[88:103], v[104:107], a[204:207], v[88:103]
  v_or_b32 v189, 0x80000000, v189
  v_xor_b32 v188, v188, v189
  s_sub_u32 s92, 4095, s90
  v_and_b32 v188, 0xffff0000, v188
  v_or_b32 v38, s92, v188
  v_mfma_f32_32x32x16_bf16 v[72:87], v[108:111], a[216:219], v[72:87]
  s_bfe_u32 s92, s65, 196625
  s_lshl_b32 s92, s92, 18
  s_lshl_b32 s93, s90, 7
  s_add_u32 s92, s92, s93
  s_add_u32 s84, s92, 243269632
  v_cvt_pk_bf16_f32 v212, v40, v56
  v_mfma_f32_32x32x16_bf16 v[88:103], v[108:111], a[220:223], v[88:103]
  v_cvt_pk_bf16_f32 v214, v41, v57
  v_cvt_pk_bf16_f32 v216, v42, v58
  v_cvt_pk_bf16_f32 v218, v43, v59
  v_permlane16_swap_b32 v212, v214
  v_mfma_f32_32x32x16_bf16 v[72:87], v[112:115], a[232:235], v[72:87]
  v_cvt_pk_bf16_f32 v220, v44, v60
  v_cvt_pk_bf16_f32 v222, v45, v61
  v_permlane16_swap_b32 v216, v218
  v_bfi_b32 v212, v254, s42, v212
  v_cvt_pk_bf16_f32 v224, v46, v62
  v_mfma_f32_32x32x16_bf16 v[88:103], v[112:115], a[236:239], v[88:103]
  v_cvt_pk_bf16_f32 v226, v47, v63
  v_permlane16_swap_b32 v220, v222
  v_bfi_b32 v216, v254, s42, v216
  v_cvt_pk_bf16_f32 v228, v48, v64
  v_mfma_f32_32x32x16_bf16 v[72:87], v[116:119], a[248:251], v[72:87]
  v_cvt_pk_bf16_f32 v230, v49, v65
  v_permlane16_swap_b32 v224, v226
  v_bfi_b32 v220, v254, s42, v220
  v_cvt_pk_bf16_f32 v232, v50, v66
  v_cvt_pk_bf16_f32 v234, v51, v67
  v_mfma_f32_32x32x16_bf16 v[88:103], v[116:119], a[252:255], v[88:103]
  v_permlane16_swap_b32 v228, v230
  v_bfi_b32 v224, v254, s42, v224
  v_cvt_pk_bf16_f32 v236, v52, v68
  v_cvt_pk_bf16_f32 v238, v53, v69
  v_permlane16_swap_b32 v232, v234
  v_bfi_b32 v228, v254, s42, v228
  v_cvt_pk_bf16_f32 v240, v54, v70
  v_cvt_pk_bf16_f32 v242, v55, v71
  v_permlane16_swap_b32 v236, v238
  v_bfi_b32 v232, v254, s42, v232
  v_permlane16_swap_b32 v240, v242
  v_bfi_b32 v236, v254, s42, v236
  v_bfi_b32 v240, v254, s42, v240
  v_cvt_pk_bf16_f32 v213, v72, v88
  v_cvt_pk_bf16_f32 v215, v73, v89
  v_cvt_pk_bf16_f32 v217, v74, v90
  v_cvt_pk_bf16_f32 v219, v75, v91
  s_add_u32 s78, s86, 0
  v_permlane16_swap_b32 v213, v215
  buffer_store_dwordx4 v[212:215], v4, s[4:7], s78 offen sc1
  v_cvt_pk_bf16_f32 v221, v76, v92
  v_cvt_pk_bf16_f32 v223, v77, v93
  s_add_u32 s78, s86, 32768
  v_permlane16_swap_b32 v217, v219
  buffer_store_dwordx4 v[216:219], v4, s[4:7], s78 offen sc1
  v_cvt_pk_bf16_f32 v225, v78, v94
  v_cvt_pk_bf16_f32 v227, v79, v95
  s_add_u32 s78, s86, 131072
  v_permlane16_swap_b32 v221, v223
  buffer_store_dwordx4 v[220:223], v4, s[4:7], s78 offen sc1
  v_cvt_pk_bf16_f32 v229, v80, v96
  v_cvt_pk_bf16_f32 v231, v81, v97
  s_add_u32 s78, s86, 163840
  v_permlane16_swap_b32 v225, v227
  buffer_store_dwordx4 v[224:227], v4, s[4:7], s78 offen sc1
  v_cvt_pk_bf16_f32 v233, v82, v98
  v_cvt_pk_bf16_f32 v235, v83, v99
  s_add_u32 s78, s86, 262144
  v_permlane16_swap_b32 v229, v231
  buffer_store_dwordx4 v[228:231], v4, s[4:7], s78 offen sc1
  v_cvt_pk_bf16_f32 v237, v84, v100
  v_cvt_pk_bf16_f32 v239, v85, v101
  s_add_u32 s78, s86, 294912
  v_permlane16_swap_b32 v233, v235
  buffer_store_dwordx4 v[232:235], v4, s[4:7], s78 offen sc1
  v_cvt_pk_bf16_f32 v241, v86, v102
  v_cvt_pk_bf16_f32 v243, v87, v103
  s_add_u32 s78, s86, 393216
  v_permlane16_swap_b32 v237, v239
  buffer_store_dwordx4 v[236:239], v4, s[4:7], s78 offen sc1
  s_add_u32 s78, s86, 425984
  v_permlane16_swap_b32 v241, v243
  buffer_store_dwordx4 v[240:243], v4, s[4:7], s78 offen sc1
  s_waitcnt vmcnt(8)
  s_mov_b64 exec, 1
  buffer_store_dword v38, off, s[4:7], s84 sc1
  s_mov_b64 exec, -1
  s_mov_b32 s84, 268435456
  s_branch o_we_213
o_rt_221:
  s_mov_b32 s67, 0
o_rl_225:
  s_lshl_b32 s94, s43, 14
  s_add_u32 s94, s94, s95
  buffer_load_dwordx4 v[120:123], v5, s[4:7], s94 offen offset:0 sc1
  buffer_load_dwordx4 v[124:127], v5, s[4:7], s94 offen offset:512 sc1
  buffer_load_dwordx4 v[128:131], v5, s[4:7], s94 offen offset:256 sc1
  buffer_load_dwordx4 v[132:135], v5, s[4:7], s94 offen offset:768 sc1
  s_add_u32 s94, s94, 4096
  buffer_load_dwordx4 v[136:139], v5, s[4:7], s94 offen offset:0 sc1
  buffer_load_dwordx4 v[140:143], v5, s[4:7], s94 offen offset:512 sc1
  buffer_load_dwordx4 v[144:147], v5, s[4:7], s94 offen offset:256 sc1
  buffer_load_dwordx4 v[148:151], v5, s[4:7], s94 offen offset:768 sc1
  s_add_u32 s94, s94, 4096
  buffer_load_dwordx4 v[152:155], v5, s[4:7], s94 offen offset:0 sc1
  buffer_load_dwordx4 v[156:159], v5, s[4:7], s94 offen offset:512 sc1
  buffer_load_dwordx4 v[160:163], v5, s[4:7], s94 offen offset:256 sc1
  buffer_load_dwordx4 v[164:167], v5, s[4:7], s94 offen offset:768 sc1
  s_add_u32 s94, s94, 4096
  buffer_load_dwordx4 v[168:171], v5, s[4:7], s94 offen offset:0 sc1
  buffer_load_dwordx4 v[172:175], v5, s[4:7], s94 offen offset:512 sc1
  buffer_load_dwordx4 v[176:179], v5, s[4:7], s94 offen offset:256 sc1
  buffer_load_dwordx4 v[180:183], v5, s[4:7], s94 offen offset:768 sc1
  s_add_u32 s67, s67, 1
  s_cmp_gt_u32 s67, 1048576
  s_cbranch_scc1 L_end
  s_waitcnt vmcnt(0)
  v_xor_b32 v7, s96, v120
  v_bitop3_b32 v7, v7, v124, s96 bitop3:0xf6
  v_bitop3_b32 v7, v7, v128, s96 bitop3:0xf6
  v_bitop3_b32 v7, v7, v132, s96 bitop3:0xf6
  v_bitop3_b32 v7, v7, v136, s96 bitop3:0xf6
  v_bitop3_b32 v7, v7, v140, s96 bitop3:0xf6
  v_bitop3_b32 v7, v7, v144, s96 bitop3:0xf6
  v_bitop3_b32 v7, v7, v148, s96 bitop3:0xf6
  v_bitop3_b32 v7, v7, v152, s96 bitop3:0xf6
  v_bitop3_b32 v7, v7, v156, s96 bitop3:0xf6
  v_bitop3_b32 v7, v7, v160, s96 bitop3:0xf6
  v_bitop3_b32 v7, v7, v164, s96 bitop3:0xf6
  v_bitop3_b32 v7, v7, v168, s96 bitop3:0xf6
  v_bitop3_b32 v7, v7, v172, s96 bitop3:0xf6
  v_bitop3_b32 v7, v7, v176, s96 bitop3:0xf6
  v_bitop3_b32 v7, v7, v180, s96 bitop3:0xf6
  v_and_b32 v7, v254, v7
  v_cmp_ne_u32 vcc, 0, v7
  s_cbranch_vccnz o_rl_225
  s_branch o_bk_222
o_rt_223:
  s_mov_b32 s67, 0
o_rl_226:
  s_lshl_b32 s94, s43, 14
  s_add_u32 s94, s94, s95
  buffer_load_dwordx4 v[120:123], v5, s[4:7], s94 offen offset:0 sc1
  buffer_load_dwordx4 v[124:127], v5, s[4:7], s94 offen offset:512 sc1
  buffer_load_dwordx4 v[128:131], v5, s[4:7], s94 offen offset:256 sc1
  buffer_load_dwordx4 v[132:135], v5, s[4:7], s94 offen offset:768 sc1
  s_add_u32 s94, s94, 4096
  buffer_load_dwordx4 v[136:139], v5, s[4:7], s94 offen offset:0 sc1
  buffer_load_dwordx4 v[140:143], v5, s[4:7], s94 offen offset:512 sc1
  buffer_load_dwordx4 v[144:147], v5, s[4:7], s94 offen offset:256 sc1
  buffer_load_dwordx4 v[148:151], v5, s[4:7], s94 offen offset:768 sc1
  s_add_u32 s94, s94, 4096
  buffer_load_dwordx4 v[152:155], v5, s[4:7], s94 offen offset:0 sc1
  buffer_load_dwordx4 v[156:159], v5, s[4:7], s94 offen offset:512 sc1
  buffer_load_dwordx4 v[160:163], v5, s[4:7], s94 offen offset:256 sc1
  buffer_load_dwordx4 v[164:167], v5, s[4:7], s94 offen offset:768 sc1
  s_add_u32 s94, s94, 4096
  buffer_load_dwordx4 v[168:171], v5, s[4:7], s94 offen offset:0 sc1
  buffer_load_dwordx4 v[172:175], v5, s[4:7], s94 offen offset:512 sc1
  buffer_load_dwordx4 v[176:179], v5, s[4:7], s94 offen offset:256 sc1
  buffer_load_dwordx4 v[180:183], v5, s[4:7], s94 offen offset:768 sc1
  s_add_u32 s67, s67, 1
  s_cmp_gt_u32 s67, 1048576
  s_cbranch_scc1 L_end
  s_waitcnt vmcnt(0)
  v_xor_b32 v7, s96, v120
  v_bitop3_b32 v7, v7, v124, s96 bitop3:0xf6
  v_bitop3_b32 v7, v7, v128, s96 bitop3:0xf6
  v_bitop3_b32 v7, v7, v132, s96 bitop3:0xf6
  v_bitop3_b32 v7, v7, v136, s96 bitop3:0xf6
  v_bitop3_b32 v7, v7, v140, s96 bitop3:0xf6
  v_bitop3_b32 v7, v7, v144, s96 bitop3:0xf6
  v_bitop3_b32 v7, v7, v148, s96 bitop3:0xf6
  v_bitop3_b32 v7, v7, v152, s96 bitop3:0xf6
  v_bitop3_b32 v7, v7, v156, s96 bitop3:0xf6
  v_bitop3_b32 v7, v7, v160, s96 bitop3:0xf6
  v_bitop3_b32 v7, v7, v164, s96 bitop3:0xf6
  v_bitop3_b32 v7, v7, v168, s96 bitop3:0xf6
  v_bitop3_b32 v7, v7, v172, s96 bitop3:0xf6
  v_bitop3_b32 v7, v7, v176, s96 bitop3:0xf6
  v_bitop3_b32 v7, v7, v180, s96 bitop3:0xf6
  v_and_b32 v7, v254, v7
  v_cmp_ne_u32 vcc, 0, v7
  s_cbranch_vccnz o_rl_226
  s_branch o_bk_224
o_fb_215:
  v_mov_b32 v118, v116
  s_nop 1
  v_permlane16_swap_b32 v116, v118
  v_max_f32 v116, v116, v118
  v_mov_b32 v118, v116
  s_nop 0
  s_nop 0
  v_permlane32_swap_b32 v116, v118
  v_max_f32 v116, v116, v118
  v_sub_f32 v56, v104, v116
  v_sub_f32 v57, v105, v116
  v_sub_f32 v58, v106, v116
  v_sub_f32 v59, v107, v116
  v_sub_f32 v60, v108, v116
  v_sub_f32 v61, v109, v116
  v_sub_f32 v62, v110, v116
  v_sub_f32 v63, v111, v116
  v_sub_f32 v64, v112, v116
  v_sub_f32 v65, v113, v116
  v_exp_f32 v56, v56
  v_exp_f32 v57, v57
  v_exp_f32 v58, v58
  v_exp_f32 v59, v59
  v_exp_f32 v60, v60
  v_exp_f32 v61, v61
  v_exp_f32 v62, v62
  v_exp_f32 v63, v63
  v_exp_f32 v64, v64
  v_exp_f32 v65, v65
  v_add_f32 v117, v56, v57
  v_add_f32 v117, v117, v58
  v_add_f32 v117, v117, v59
  v_add_f32 v117, v117, v60
  v_add_f32 v117, v117, v61
  v_add_f32 v117, v117, v62
  v_add_f32 v117, v117, v63
  v_add_f32 v117, v117, v64
  v_add_f32 v117, v117, v65
  v_mov_b32 v118, v117
  s_nop 0
  s_nop 0
  v_permlane16_swap_b32 v117, v118
  v_add_f32 v117, v117, v118
  v_mov_b32 v118, v117
  s_nop 0
  s_nop 0
  v_permlane32_swap_b32 v117, v118
  v_add_f32 v117, v117, v118
  v_rcp_f32 v117, v117
  s_branch o_fbr_216
o_fb_217:
  v_mov_b32 v118, v116
  s_nop 1
  v_permlane16_swap_b32 v116, v118
  v_max_f32 v116, v116, v118
  v_mov_b32 v118, v116
  s_nop 0
  s_nop 0
  v_permlane32_swap_b32 v116, v118
  v_max_f32 v116, v116, v118
  v_sub_f32 v56, v104, v116
  v_sub_f32 v57, v105, v116
  v_sub_f32 v58, v106, v116
  v_sub_f32 v59, v107, v116
  v_sub_f32 v60, v108, v116
  v_sub_f32 v61, v109, v116
  v_sub_f32 v62, v110, v116
  v_sub_f32 v63, v111, v116
  v_sub_f32 v64, v112, v116
  v_sub_f32 v65, v113, v116
  v_exp_f32 v56, v56
  v_exp_f32 v57, v57
  v_exp_f32 v58, v58
  v_exp_f32 v59, v59
  v_exp_f32 v60, v60
  v_exp_f32 v61, v61
  v_exp_f32 v62, v62
  v_exp_f32 v63, v63
  v_exp_f32 v64, v64
  v_exp_f32 v65, v65
  v_add_f32 v117, v56, v57
  v_add_f32 v117, v117, v58
  v_add_f32 v117, v117, v59
  v_add_f32 v117, v117, v60
  v_add_f32 v117, v117, v61
  v_add_f32 v117, v117, v62
  v_add_f32 v117, v117, v63
  v_add_f32 v117, v117, v64
  v_add_f32 v117, v117, v65
  v_mov_b32 v118, v117
  s_nop 0
  s_nop 0
  v_permlane16_swap_b32 v117, v118
  v_add_f32 v117, v117, v118
  v_mov_b32 v118, v117
  s_nop 0
  s_nop 0
  v_permlane32_swap_b32 v117, v118
  v_add_f32 v117, v117, v118
  v_rcp_f32 v117, v117
  s_branch o_fbr_218
o_wr2_212:
  s_waitcnt lgkmcnt(0)
  s_barrier
  ds_read_b128 v[104:107], v3 offset:0
  ds_read_b128 v[108:111], v3 offset:512
  ds_read_b128 v[112:115], v3 offset:1024
  buffer_load_dwordx4 v[176:179], v5, s[4:7], s94 offen offset:256 sc1
  buffer_load_dwordx4 v[180:183], v5, s[4:7], s94 offen offset:768 sc1
  s_waitcnt lgkmcnt(2)
  v_mfma_f32_32x32x16_bf16 v[40:55], v[104:107], a[0:3], 0
  v_mov_b64 v[188:189], 0
  v_mov_b64 v[190:191], 0
  v_mov_b64 v[192:193], 0
  v_mov_b64 v[194:195], 0
  s_mov_b64 exec, 1
  buffer_store_dword v38, off, s[4:7], s84 sc1
  s_mov_b64 exec, -1
  s_mov_b32 s84, 268435456
  v_mfma_f32_32x32x16_bf16 v[56:71], v[104:107], a[4:7], 0
  ds_read_b128 v[116:119], v3 offset:1536
  v_mfma_f32_32x32x16_bf16 v[72:87], v[104:107], a[8:11], 0
  v_mfma_f32_32x32x16_bf16 v[88:103], v[104:107], a[12:15], 0
  s_waitcnt vmcnt(13)
  v_xor_b32 v7, s96, v120
  v_bitop3_b32 v7, v7, v124, s96 bitop3:0xf6
  v_bitop3_b32 v7, v7, v128, s96 bitop3:0xf6
  v_bitop3_b32 v7, v7, v132, s96 bitop3:0xf6
  s_waitcnt lgkmcnt(2)
  v_mfma_f32_32x32x16_bf16 v[40:55], v[108:111], a[16:19], v[40:55]
  s_waitcnt vmcnt(9)
  v_bitop3_b32 v7, v7, v136, s96 bitop3:0xf6
  v_bitop3_b32 v7, v7, v140, s96 bitop3:0xf6
  v_bitop3_b32 v7, v7, v144, s96 bitop3:0xf6
  v_bitop3_b32 v7, v7, v148, s96 bitop3:0xf6
  s_waitcnt vmcnt(5)
  v_mfma_f32_32x32x16_bf16 v[56:71], v[108:111], a[20:23], v[56:71]
  ds_read_b128 v[104:107], v3 offset:2048
  v_bitop3_b32 v7, v7, v152, s96 bitop3:0xf6
  v_bitop3_b32 v7, v7, v156, s96 bitop3:0xf6
  v_bitop3_b32 v7, v7, v160, s96 bitop3:0xf6
  v_bitop3_b32 v7, v7, v164, s96 bitop3:0xf6
  s_waitcnt vmcnt(1)
  v_mfma_f32_32x32x16_bf16 v[72:87], v[108:111], a[24:27], v[72:87]
  v_bitop3_b32 v7, v7, v168, s96 bitop3:0xf6
  v_bitop3_b32 v7, v7, v172, s96 bitop3:0xf6
  v_bitop3_b32 v7, v7, v176, s96 bitop3:0xf6
  v_bitop3_b32 v7, v7, v180, s96 bitop3:0xf6
  v_and_b32 v7, v254, v7
  v_cmp_ne_u32 vcc, 0, v7
  s_cbranch_vccnz o_rt_223
o_bk_224:
  v_mfma_f32_32x32x16_bf16 v[88:103], v[108:111], a[28:31], v[88:103]
  v_smfmac_f32_16x16x64_bf16 v[188:191], v[16:19], v[120:127], v20
  v_lshlrev_b32 v196, 16, v184
  v_smfmac_f32_16x16x64_bf16 v[192:195], v[16:19], v[128:135], v20
  v_and_b32 v197, 0xffff0000, v184
  v_smfmac_f32_16x16x64_bf16 v[188:191], v[16:19], v[136:143], v20
  v_lshlrev_b32 v198, 16, v185
  s_waitcnt lgkmcnt(2)
  v_mfma_f32_32x32x16_bf16 v[40:55], v[112:115], a[32:35], v[40:55]
  v_smfmac_f32_16x16x64_bf16 v[192:195], v[16:19], v[144:151], v20
  v_and_b32 v199, 0xffff0000, v185
  v_smfmac_f32_16x16x64_bf16 v[188:191], v[16:19], v[152:159], v20
  v_lshlrev_b32 v200, 16, v186
  v_smfmac_f32_16x16x64_bf16 v[192:195], v[16:19], v[160:167], v20
  v_and_b32 v201, 0xffff0000, v186
  v_mfma_f32_32x32x16_bf16 v[56:71], v[112:115], a[36:39], v[56:71]
  ds_read_b128 v[108:111], v3 offset:2560
  v_smfmac_f32_16x16x64_bf16 v[188:191], v[16:19], v[168:175], v20
  v_lshlrev_b32 v202, 16, v187
  v_smfmac_f32_16x16x64_bf16 v[192:195], v[16:19], v[176:183], v20
  v_and_b32 v203, 0xffff0000, v187
  s_bfe_u32 s92, s65, 131086
  v_mfma_f32_32x32x16_bf16 v[72:87], v[112:115], a[40:43], v[72:87]
  s_lshl_b32 s92, s92, 21
  s_add_u32 s92, s92, s91
  s_add_u32 s93, s92, 27262976
  s_add_u32 s92, s92, 20971520
  v_permlane16_swap_b32 v188, v192
  v_mfma_f32_32x32x16_bf16 v[88:103], v[112:115], a[44:47], v[88:103]
  v_permlane16_swap_b32 v189, v193
  v_permlane16_swap_b32 v190, v194
  v_permlane16_swap_b32 v191, v195
  s_waitcnt lgkmcnt(2)
  v_mfma_f32_32x32x16_bf16 v[40:55], v[116:119], a[48:51], v[40:55]
  v_cvt_pk_bf16_f32 v188, 0, v188
  v_cvt_pk_bf16_f32 v189, 0, v189
  v_cvt_pk_bf16_f32 v190, 0, v190
  v_cvt_pk_bf16_f32 v191, 0, v191
  v_cvt_pk_bf16_f32 v192, 0, v192
  v_cvt_pk_bf16_f32 v193, 0, v193
  v_mfma_f32_32x32x16_bf16 v[56:71], v[116:119], a[52:55], v[56:71]
  ds_read_b128 v[112:115], v3 offset:3072
  v_cvt_pk_bf16_f32 v194, 0, v194
  v_cvt_pk_bf16_f32 v195, 0, v195
  v_add_f32 v196, v196, v188
  v_add_f32 v197, v197, v189
  v_add_f32 v198, v198, v190
  v_mfma_f32_32x32x16_bf16 v[72:87], v[116:119], a[56:59], v[72:87]
  v_add_f32 v199, v199, v191
  v_add_f32 v200, v200, v192
  v_add_f32 v201, v201, v193
  v_add_f32 v202, v202, v194
  v_add_f32 v203, v203, v195
  v_cvt_pk_bf16_f32 v120, v196, v197
  v_mfma_f32_32x32x16_bf16 v[88:103], v[116:119], a[60:63], v[88:103]
  v_cvt_pk_bf16_f32 v121, v198, v199
  v_cvt_pk_bf16_f32 v122, v200, v201
  v_cvt_pk_bf16_f32 v123, v202, v203
  v_lshlrev_b32 v196, 16, v120
  v_and_b32 v197, 0xffff0000, v120
  s_waitcnt lgkmcnt(2)
  v_mfma_f32_32x32x16_bf16 v[40:55], v[104:107], a[64:67], v[40:55]
  v_lshlrev_b32 v198, 16, v121
  v_and_b32 v199, 0xffff0000, v121
  v_lshlrev_b32 v200, 16, v122
  v_and_b32 v201, 0xffff0000, v122
  v_lshlrev_b32 v202, 16, v123
  v_and_b32 v203, 0xffff0000, v123
  v_mfma_f32_32x32x16_bf16 v[56:71], v[104:107], a[68:71], v[56:71]
  ds_read_b128 v[116:119], v3 offset:3584
  buffer_store_dwordx4 v[120:123], v0, s[4:7], s92 offen sc1
  v_add_f32 v136, v196, v197
  v_mul_f32 v137, v196, v196
  v_mfma_f32_32x32x16_bf16 v[72:87], v[104:107], a[72:75], v[72:87]
  v_add_f32 v138, v198, v199
  v_mul_f32 v139, v197, v197
  v_fmac_f32 v137, v198, v198
  v_fmac_f32 v139, v199, v199
  v_add_f32 v136, v136, v200
  v_fmac_f32 v137, v200, v200
  v_mfma_f32_32x32x16_bf16 v[88:103], v[104:107], a[76:79], v[88:103]
  v_add_f32 v138, v138, v201
  v_fmac_f32 v139, v201, v201
  v_add_f32 v136, v136, v202
  v_fmac_f32 v137, v202, v202
  v_add_f32 v138, v138, v203
  s_waitcnt lgkmcnt(2)
  v_mfma_f32_32x32x16_bf16 v[40:55], v[108:111], a[80:83], v[40:55]
  v_fmac_f32 v139, v203, v203
  v_add_f32 v136, v136, v138
  v_add_f32 v137, v137, v139
  s_nop 0
  v_add_f32_dpp v136, v136, v136 row_ror:8 row_mask:0xf bank_mask:0xf
  v_add_f32_dpp v137, v137, v137 row_ror:8 row_mask:0xf bank_mask:0xf
  s_nop 0
  v_add_f32_dpp v136, v136, v136 row_ror:4 row_mask:0xf bank_mask:0xf
  v_mfma_f32_32x32x16_bf16 v[56:71], v[108:111], a[84:87], v[56:71]
  ds_read_b128 v[104:107], v3 offset:8192
  v_add_f32_dpp v137, v137, v137 row_ror:4 row_mask:0xf bank_mask:0xf
  v_add_f32_dpp v136, v136, v136 row_ror:2 row_mask:0xf bank_mask:0xf
  s_nop 0
  v_add_f32_dpp v137, v137, v137 row_ror:2 row_mask:0xf bank_mask:0xf
  v_add_f32_dpp v136, v136, v136 row_ror:1 row_mask:0xf bank_mask:0xf
  s_nop 0
  v_add_f32_dpp v137, v137, v137 row_ror:1 row_mask:0xf bank_mask:0xf
  v_mfma_f32_32x32x16_bf16 v[72:87], v[108:111], a[88:91], v[72:87]
  v_mov_b32 v140, v136
  v_mov_b32 v141, v137
  s_nop 0
  v_permlane16_swap_b32 v136, v140
  v_permlane16_swap_b32 v137, v141
  v_mfma_f32_32x32x16_bf16 v[88:103], v[108:111], a[92:95], v[88:103]
  v_add_f32 v136, v136, v140
  v_add_f32 v137, v137, v141
  v_mov_b32 v140, v136
  v_mov_b32 v141, v137
  s_nop 0
  v_permlane32_swap_b32 v136, v140
  s_waitcnt lgkmcnt(2)
  v_mfma_f32_32x32x16_bf16 v[40:55], v[112:115], a[96:99], v[40:55]
  v_permlane32_swap_b32 v137, v141
  v_add_f32 v136, v136, v140
  v_add_f32 v137, v137, v141
  v_mul_f32 v136, 0x3b000000, v136
  v_mul_f32 v137, 0x3b000000, v137
  v_mfma_f32_32x32x16_bf16 v[56:71], v[112:115], a[100:103], v[56:71]
  ds_read_b128 v[108:111], v3 offset:8704
  v_fma_f32 v137, -v136, v136, v137
  v_cvt_pk_bf16_f32 v136, 0, v136
  v_max_f32 v137, 0, v137
  v_sub_f32 v140, v196, v136
  v_sub_f32 v141, v197, v136
  v_mfma_f32_32x32x16_bf16 v[72:87], v[112:115], a[104:107], v[72:87]
  v_cvt_pk_bf16_f32 v137, 0, v137
  v_sub_f32 v142, v198, v136
  v_sub_f32 v143, v199, v136
  v_add_f32 v137, 0x3727c5ac, v137
  v_sub_f32 v144, v200, v136
  v_sub_f32 v145, v201, v136
  v_mfma_f32_32x32x16_bf16 v[88:103], v[112:115], a[108:111], v[88:103]
  v_cvt_pk_bf16_f32 v137, 0, v137
  v_sub_f32 v146, v202, v136
  v_sub_f32 v147, v203, v136
  v_sqrt_f32 v137, v137
  s_waitcnt lgkmcnt(2)
  v_mfma_f32_32x32x16_bf16 v[40:55], v[116:119], a[112:115], v[40:55]
  v_cvt_pk_bf16_f32 v140, 0, v140
  v_cvt_pk_bf16_f32 v141, 0, v141
  v_cvt_pk_bf16_f32 v137, 0, v137
  v_cvt_pk_bf16_f32 v142, 0, v142
  v_cvt_pk_bf16_f32 v143, 0, v143
  v_rcp_f32 v137, v137
  v_mfma_f32_32x32x16_bf16 v[56:71], v[116:119], a[116:119], v[56:71]
  ds_read_b128 v[112:115], v3 offset:9216
  v_cvt_pk_bf16_f32 v144, 0, v144
  v_cvt_pk_bf16_f32 v145, 0, v145
  v_cvt_pk_bf16_f32 v146, 0, v146
  v_cvt_pk_bf16_f32 v147, 0, v147
  v_mul_f32 v140, v140, v137
  v_mfma_f32_32x32x16_bf16 v[72:87], v[116:119], a[120:123], v[72:87]
  v_mul_f32 v141, v141, v137
  v_mul_f32 v142, v142, v137
  v_mul_f32 v143, v143, v137
  v_mul_f32 v144, v144, v137
  v_mul_f32 v145, v145, v137
  v_mul_f32 v146, v146, v137
  v_mfma_f32_32x32x16_bf16 v[88:103], v[116:119], a[124:127], v[88:103]
  v_mul_f32 v147, v147, v137
  v_cvt_pk_bf16_f32 v124, v140, v141
  v_cvt_pk_bf16_f32 v125, v142, v143
  v_cvt_pk_bf16_f32 v126, v144, v145
  v_cvt_pk_bf16_f32 v127, v146, v147
  s_waitcnt lgkmcnt(2)
  v_mfma_f32_32x32x16_bf16 v[40:55], v[104:107], a[128:131], v[40:55]
  v_lshlrev_b32 v204, 16, v124
  v_and_b32 v205, 0xffff0000, v124
  v_lshlrev_b32 v206, 16, v125
  v_and_b32 v207, 0xffff0000, v125
  v_lshlrev_b32 v208, 16, v126
  v_and_b32 v209, 0xffff0000, v126
  v_mfma_f32_32x32x16_bf16 v[56:71], v[104:107], a[132:135], v[56:71]
  ds_read_b128 v[116:119], v3 offset:9728
  v_lshlrev_b32 v210, 16, v127
  v_and_b32 v211, 0xffff0000, v127
  buffer_store_dwordx4 v[124:127], v0, s[4:7], s93 offen sc1
  v_mfma_f32_32x32x16_bf16 v[72:87], v[104:107], a[136:139], v[72:87]
  v_add_f32 v196, v196, v204
  v_add_f32 v197, v197, v205
  v_add_f32 v198, v198, v206
  v_add_f32 v199, v199, v207
  v_add_f32 v200, v200, v208
  v_add_f32 v201, v201, v209
  v_mfma_f32_32x32x16_bf16 v[88:103], v[104:107], a[140:143], v[88:103]
  v_add_f32 v202, v202, v210
  v_add_f32 v203, v203, v211
  v_cvt_pk_bf16_f32 v128, v196, v197
  v_cvt_pk_bf16_f32 v129, v198, v199
  v_cvt_pk_bf16_f32 v130, v200, v201
  s_waitcnt lgkmcnt(2)
  v_mfma_f32_32x32x16_bf16 v[40:55], v[108:111], a[144:147], v[40:55]
  v_cvt_pk_bf16_f32 v131, v202, v203
  v_mul_f32 v188, v204, v8
  v_mul_f32 v189, v205, v9
  v_fmac_f32 v188, v206, v10
  v_fmac_f32 v189, v207, v11
  v_fmac_f32 v188, v208, v12
  v_mfma_f32_32x32x16_bf16 v[56:71], v[108:111], a[148:151], v[56:71]
  ds_read_b128 v[104:107], v3 offset:10240
  v_fmac_f32 v189, v209, v13
  v_fmac_f32 v188, v210, v14
  v_fmac_f32 v189, v211, v15
  v_add_f32 v188, v188, v189
  buffer_store_dwordx4 v[128:131], v0, s[68:71], s91 offen sc1
  v_mfma_f32_32x32x16_bf16 v[72:87], v[108:111], a[152:155], v[72:87]
  v_add_f32_dpp v188, v188, v188 row_ror:8 row_mask:0xf bank_mask:0xf
  s_nop 1
  v_add_f32_dpp v188, v188, v188 row_ror:4 row_mask:0xf bank_mask:0xf
  s_nop 1
  v_add_f32_dpp v188, v188, v188 row_ror:2 row_mask:0xf bank_mask:0xf
  s_nop 1
  v_add_f32_dpp v188, v188, v188 row_ror:1 row_mask:0xf bank_mask:0xf
  v_mov_b32 v189, v188
  s_nop 0
  s_nop 0
  v_permlane16_swap_b32 v188, v189
  v_mfma_f32_32x32x16_bf16 v[88:103], v[108:111], a[156:159], v[88:103]
  v_add_f32 v188, v188, v189
  v_mov_b32 v189, v188
  s_nop 0
  s_nop 0
  v_permlane32_swap_b32 v188, v189
  v_add_f32 v188, v188, v189
  s_waitcnt lgkmcnt(2)
  v_mfma_f32_32x32x16_bf16 v[40:55], v[112:115], a[160:163], v[40:55]
  v_cvt_pk_bf16_f32 v188, 0, v188
  v_ashrrev_i32 v189, 31, v188
  v_or_b32 v189, 0x80000000, v189
  v_xor_b32 v188, v188, v189
  s_sub_u32 s92, 4095, s90
  v_and_b32 v188, 0xffff0000, v188
  v_mfma_f32_32x32x16_bf16 v[56:71], v[112:115], a[164:167], v[56:71]
  ds_read_b128 v[108:111], v3 offset:10752
  v_or_b32 v38, s92, v188
  s_bfe_u32 s92, s65, 196625
  s_lshl_b32 s92, s92, 18
  s_lshl_b32 s93, s90, 7
  s_add_u32 s92, s92, s93
  v_mfma_f32_32x32x16_bf16 v[72:87], v[112:115], a[168:171], v[72:87]
  s_add_u32 s84, s92, 243269632
  v_mfma_f32_32x32x16_bf16 v[88:103], v[112:115], a[172:175], v[88:103]
  s_waitcnt lgkmcnt(2)
  v_mfma_f32_32x32x16_bf16 v[40:55], v[116:119], a[176:179], v[40:55]
  v_mfma_f32_32x32x16_bf16 v[56:71], v[116:119], a[180:183], v[56:71]
  ds_read_b128 v[112:115], v3 offset:11264
  v_mfma_f32_32x32x16_bf16 v[72:87], v[116:119], a[184:187], v[72:87]
  v_mfma_f32_32x32x16_bf16 v[88:103], v[116:119], a[188:191], v[88:103]
  s_waitcnt lgkmcnt(2)
  v_mfma_f32_32x32x16_bf16 v[40:55], v[104:107], a[192:195], v[40:55]
  v_mfma_f32_32x32x16_bf16 v[56:71], v[104:107], a[196:199], v[56:71]
  ds_read_b128 v[116:119], v3 offset:11776
  s_waitcnt lgkmcnt(2)
  v_mfma_f32_32x32x16_bf16 v[40:55], v[108:111], a[208:211], v[40:55]
  v_mfma_f32_32x32x16_bf16 v[56:71], v[108:111], a[212:215], v[56:71]
  s_waitcnt lgkmcnt(1)
  v_mfma_f32_32x32x16_bf16 v[40:55], v[112:115], a[224:227], v[40:55]
  v_mfma_f32_32x32x16_bf16 v[56:71], v[112:115], a[228:231], v[56:71]
  s_waitcnt lgkmcnt(0)
  v_mfma_f32_32x32x16_bf16 v[40:55], v[116:119], a[240:243], v[40:55]
  v_mfma_f32_32x32x16_bf16 v[56:71], v[116:119], a[244:247], v[56:71]
  v_mfma_f32_32x32x16_bf16 v[72:87], v[104:107], a[200:203], v[72:87]
  v_mfma_f32_32x32x16_bf16 v[88:103], v[104:107], a[204:207], v[88:103]
  v_cvt_pk_bf16_f32 v212, v40, v56
  v_cvt_pk_bf16_f32 v214, v41, v57
  v_cvt_pk_bf16_f32 v216, v42, v58
  v_cvt_pk_bf16_f32 v218, v43, v59
  v_permlane16_swap_b32 v212, v214
  v_mfma_f32_32x32x16_bf16 v[72:87], v[108:111], a[216:219], v[72:87]
  v_cvt_pk_bf16_f32 v220, v44, v60
  v_cvt_pk_bf16_f32 v222, v45, v61
  v_permlane16_swap_b32 v216, v218
  v_bfi_b32 v212, v254, s42, v212
  v_cvt_pk_bf16_f32 v224, v46, v62
  v_mfma_f32_32x32x16_bf16 v[88:103], v[108:111], a[220:223], v[88:103]
  v_cvt_pk_bf16_f32 v226, v47, v63
  v_permlane16_swap_b32 v220, v222
  v_bfi_b32 v216, v254, s42, v216
  v_cvt_pk_bf16_f32 v228, v48, v64
  v_mfma_f32_32x32x16_bf16 v[72:87], v[112:115], a[232:235], v[72:87]
  v_cvt_pk_bf16_f32 v230, v49, v65
  v_permlane16_swap_b32 v224, v226
  v_bfi_b32 v220, v254, s42, v220
  v_cvt_pk_bf16_f32 v232, v50, v66
  v_cvt_pk_bf16_f32 v234, v51, v67
  v_mfma_f32_32x32x16_bf16 v[88:103], v[112:115], a[236:239], v[88:103]
  v_permlane16_swap_b32 v228, v230
  v_bfi_b32 v224, v254, s42, v224
  v_cvt_pk_bf16_f32 v236, v52, v68
  v_cvt_pk_bf16_f32 v238, v53, v69
  v_mfma_f32_32x32x16_bf16 v[72:87], v[116:119], a[248:251], v[72:87]
  v_permlane16_swap_b32 v232, v234
  v_bfi_b32 v228, v254, s42, v228
  v_cvt_pk_bf16_f32 v240, v54, v70
  v_cvt_pk_bf16_f32 v242, v55, v71
  v_permlane16_swap_b32 v236, v238
  v_mfma_f32_32x32x16_bf16 v[88:103], v[116:119], a[252:255], v[88:103]
  v_bfi_b32 v232, v254, s42, v232
  v_permlane16_swap_b32 v240, v242
  v_bfi_b32 v236, v254, s42, v236
  v_bfi_b32 v240, v254, s42, v240
  s_nop 7
  v_cvt_pk_bf16_f32 v213, v72, v88
  v_cvt_pk_bf16_f32 v215, v73, v89
  v_cvt_pk_bf16_f32 v217, v74, v90
  v_cvt_pk_bf16_f32 v219, v75, v91
  s_add_u32 s78, s86, 0
  v_permlane16_swap_b32 v213, v215
  buffer_store_dwordx4 v[212:215], v4, s[4:7], s78 offen sc1
  v_cvt_pk_bf16_f32 v221, v76, v92
  v_cvt_pk_bf16_f32 v223, v77, v93
  s_add_u32 s78, s86, 32768
  v_permlane16_swap_b32 v217, v219
  buffer_store_dwordx4 v[216:219], v4, s[4:7], s78 offen sc1
  v_cvt_pk_bf16_f32 v225, v78, v94
  v_cvt_pk_bf16_f32 v227, v79, v95
  s_add_u32 s78, s86, 131072
  v_permlane16_swap_b32 v221, v223
  buffer_store_dwordx4 v[220:223], v4, s[4:7], s78 offen sc1
  v_cvt_pk_bf16_f32 v229, v80, v96
  v_cvt_pk_bf16_f32 v231, v81, v97
  s_add_u32 s78, s86, 163840
  v_permlane16_swap_b32 v225, v227
  buffer_store_dwordx4 v[224:227], v4, s[4:7], s78 offen sc1
  v_cvt_pk_bf16_f32 v233, v82, v98
  v_cvt_pk_bf16_f32 v235, v83, v99
  s_add_u32 s78, s86, 262144
  v_permlane16_swap_b32 v229, v231
  buffer_store_dwordx4 v[228:231], v4, s[4:7], s78 offen sc1
  v_cvt_pk_bf16_f32 v237, v84, v100
  v_cvt_pk_bf16_f32 v239, v85, v101
  s_add_u32 s78, s86, 294912
  v_permlane16_swap_b32 v233, v235
  buffer_store_dwordx4 v[232:235], v4, s[4:7], s78 offen sc1
  v_cvt_pk_bf16_f32 v241, v86, v102
  v_cvt_pk_bf16_f32 v243, v87, v103
  s_add_u32 s78, s86, 393216
  v_permlane16_swap_b32 v237, v239
  buffer_store_dwordx4 v[236:239], v4, s[4:7], s78 offen sc1
  s_add_u32 s78, s86, 425984
  v_permlane16_swap_b32 v241, v243
  buffer_store_dwordx4 v[240:243], v4, s[4:7], s78 offen sc1
o_we_213:
  v_and_b32 v37, -32, v39
  s_waitcnt lgkmcnt(0)
  s_barrier
  ds_read_b128 v[104:107], v37 offset:16
  s_mov_b32 s65, s63
  s_waitcnt lgkmcnt(0)
  v_and_b32 v104, v104, v106
  v_max_u32 v105, v105, v107
  v_readfirstlane_b32 s26, v104
  v_readfirstlane_b32 s3, v105
  s_and_b32 s66, s26, 1
  s_and_b32 s76, s26, 2
  s_bitcmp1_b32 s26, 2
  s_cselect_b32 s3, s3, 0
  s_cmp_lg_u32 s76, 0
  s_cbranch_scc1 o_nofl_187
  s_and_b32 s26, s63, 49152
  s_cbranch_scc0 o_fl_188
  s_and_b32 s26, s64, s50
  s_cbranch_scc1 o_nofl_187
o_fl_188:
  s_cmp_ge_u32 s17, 2
  s_cbranch_scc1 o_fd_227
  s_cmp_eq_u32 s65, 0
  s_cbranch_scc1 o_fd_227
  s_mov_b32 s96, s42
  s_lshl_b32 s97, s43, 14
  s_add_u32 s97, s97, s86
  buffer_load_dword v7, v255, s[4:7], s97 offen sc1
  s_and_b32 s91, s65, 63
  s_lshl_b32 s90, s91, 5
  s_add_u32 s94, s90, s85
  s_add_u32 s90, s90, s43
  s_lshl_b32 s94, s94, 10
  s_lshr_b32 s92, s65, 22
  s_xor_b32 s93, s43, 32
  s_lshl_b32 s91, s90, 10
  s_add_u32 s94, s94, 25165824
  s_cmp_eq_u32 s92, s93
  s_cselect_b32 s92, s94, s91
  s_add_u32 s92, s92, 10485760
  s_and_b32 s93, s65, 49152
  s_cselect_b32 s92, s92, s91
  s_cselect_b64 s[80:81], s[4:5], s[72:73]
  s_cselect_b32 s82, s6, s74
  buffer_load_dwordx4 v[184:187], v0, s[80:83], s92 offen sc1
  s_mov_b32 s67, 0
  s_mov_b64 vcc, 0
  s_waitcnt vmcnt(1)
o_pl_229:
  v_and_b32 v7, 1, v7
  v_cmp_ne_u32 vcc, s96, v7
  s_cbranch_vccz o_pk_230
  s_mov_b64 exec, 1
  buffer_store_dword v38, off, s[4:7], s84 sc1
  s_mov_b64 exec, -1
  s_mov_b32 s84, 268435456
  buffer_load_dword v7, v255, s[4:7], s97 offen sc1
  s_add_u32 s67, s67, 1
  s_cmp_gt_u32 s67, 1048576
  s_cbranch_scc1 L_end
  s_waitcnt vmcnt(0)
  s_branch o_pl_229
o_pk_230:
  s_and_b32 s26, s65, 49152
  s_cbranch_scc1 o_f2_228
  s_lshl_b32 s94, s43, 14
  s_add_u32 s94, s94, s86
  buffer_load_dwordx4 v[120:123], v5, s[4:7], s94 offen offset:0 sc1
  buffer_load_dwordx4 v[124:127], v5, s[4:7], s94 offen offset:512 sc1
  buffer_load_dwordx4 v[128:131], v5, s[4:7], s94 offen offset:256 sc1
  buffer_load_dwordx4 v[132:135], v5, s[4:7], s94 offen offset:768 sc1
  s_add_u32 s94, s94, 4096
  buffer_load_dwordx4 v[136:139], v5, s[4:7], s94 offen offset:0 sc1
  buffer_load_dwordx4 v[140:143], v5, s[4:7], s94 offen offset:512 sc1
  buffer_load_dwordx4 v[144:147], v5, s[4:7], s94 offen offset:256 sc1
  buffer_load_dwordx4 v[148:151], v5, s[4:7], s94 offen offset:768 sc1
  s_add_u32 s94, s94, 4096
  buffer_load_dwordx4 v[152:155], v5, s[4:7], s94 offen offset:0 sc1
  buffer_load_dwordx4 v[156:159], v5, s[4:7], s94 offen offset:512 sc1
  buffer_load_dwordx4 v[160:163], v5, s[4:7], s94 offen offset:256 sc1
  buffer_load_dwordx4 v[164:167], v5, s[4:7], s94 offen offset:768 sc1
  s_add_u32 s94, s94, 4096
  buffer_load_dwordx4 v[168:171], v5, s[4:7], s94 offen offset:0 sc1
  buffer_load_dwordx4 v[172:175], v5, s[4:7], s94 offen offset:512 sc1
  buffer_load_dwordx4 v[176:179], v5, s[4:7], s94 offen offset:256 sc1
  buffer_load_dwordx4 v[180:183], v5, s[4:7], s94 offen offset:768 sc1
  s_mov_b64 exec, 1
  buffer_store_dword v38, off, s[4:7], s84 sc1
  s_mov_b64 exec, -1
  s_mov_b32 s84, 268435456
  v_mov_b64 v[188:189], 0
  v_mov_b64 v[190:191], 0
  v_mov_b64 v[192:193], 0
  v_mov_b64 v[194:195], 0
  s_waitcnt vmcnt(13)
  v_xor_b32 v7, s96, v120
  v_bitop3_b32 v7, v7, v124, s96 bitop3:0xf6
  v_bitop3_b32 v7, v7, v128, s96 bitop3:0xf6
  v_bitop3_b32 v7, v7, v132, s96 bitop3:0xf6
  s_waitcnt vmcnt(9)
  v_bitop3_b32 v7, v7, v136, s96 bitop3:0xf6
  v_bitop3_b32 v7, v7, v140, s96 bitop3:0xf6
  v_bitop3_b32 v7, v7, v144, s96 bitop3:0xf6
  v_bitop3_b32 v7, v7, v148, s96 bitop3:0xf6
  s_waitcnt vmcnt(5)
  v_bitop3_b32 v7, v7, v152, s96 bitop3:0xf6
  v_bitop3_b32 v7, v7, v156, s96 bitop3:0xf6
  v_bitop3_b32 v7, v7, v160, s96 bitop3:0xf6
  v_bitop3_b32 v7, v7, v164, s96 bitop3:0xf6
  s_waitcnt vmcnt(1)
  v_bitop3_b32 v7, v7, v168, s96 bitop3:0xf6
  v_bitop3_b32 v7, v7, v172, s96 bitop3:0xf6
  v_bitop3_b32 v7, v7, v176, s96 bitop3:0xf6
  v_bitop3_b32 v7, v7, v180, s96 bitop3:0xf6
  v_and_b32 v7, v254, v7
  v_cmp_ne_u32 vcc, 0, v7
  s_cbranch_vccnz o_rt_231
o_bk_232:
  v_smfmac_f32_16x16x64_bf16 v[188:191], v[16:19], v[120:127], v20
  v_lshlrev_b32 v196, 16, v184
  v_smfmac_f32_16x16x64_bf16 v[192:195], v[16:19], v[128:135], v20
  v_and_b32 v197, 0xffff0000, v184
  v_smfmac_f32_16x16x64_bf16 v[188:191], v[16:19], v[136:143], v20
  v_lshlrev_b32 v198, 16, v185
  v_smfmac_f32_16x16x64_bf16 v[192:195], v[16:19], v[144:151], v20
  v_and_b32 v199, 0xffff0000, v185
  v_smfmac_f32_16x16x64_bf16 v[188:191], v[16:19], v[152:159], v20
  v_lshlrev_b32 v200, 16, v186
  v_smfmac_f32_16x16x64_bf16 v[192:195], v[16:19], v[160:167], v20
  v_and_b32 v201, 0xffff0000, v186
  v_smfmac_f32_16x16x64_bf16 v[188:191], v[16:19], v[168:175], v20
  v_lshlrev_b32 v202, 16, v187
  v_smfmac_f32_16x16x64_bf16 v[192:195], v[16:19], v[176:183], v20
  v_and_b32 v203, 0xffff0000, v187
  s_bfe_u32 s92, s65, 131086
  s_lshl_b32 s92, s92, 21
  s_add_u32 s92, s92, s91
  s_add_u32 s93, s92, 27262976
  s_add_u32 s92, s92, 20971520
  s_nop 1
  v_permlane16_swap_b32 v188, v192
  v_permlane16_swap_b32 v189, v193
  v_permlane16_swap_b32 v190, v194
  v_permlane16_swap_b32 v191, v195
  v_cvt_pk_bf16_f32 v188, 0, v188
  v_cvt_pk_bf16_f32 v189, 0, v189
  v_cvt_pk_bf16_f32 v190, 0, v190
  v_cvt_pk_bf16_f32 v191, 0, v191
  v_cvt_pk_bf16_f32 v192, 0, v192
  v_cvt_pk_bf16_f32 v193, 0, v193
  v_cvt_pk_bf16_f32 v194, 0, v194
  v_cvt_pk_bf16_f32 v195, 0, v195
  v_add_f32 v196, v196, v188
  v_add_f32 v197, v197, v189
  v_add_f32 v198, v198, v190
  v_add_f32 v199, v199, v191
  v_add_f32 v200, v200, v192
  v_add_f32 v201, v201, v193
  v_add_f32 v202, v202, v194
  v_add_f32 v203, v203, v195
  v_cvt_pk_bf16_f32 v120, v196, v197
  v_cvt_pk_bf16_f32 v121, v198, v199
  v_cvt_pk_bf16_f32 v122, v200, v201
  v_cvt_pk_bf16_f32 v123, v202, v203
  v_lshlrev_b32 v196, 16, v120
  v_and_b32 v197, 0xffff0000, v120
  v_lshlrev_b32 v198, 16, v121
  v_and_b32 v199, 0xffff0000, v121
  v_lshlrev_b32 v200, 16, v122
  v_and_b32 v201, 0xffff0000, v122
  v_lshlrev_b32 v202, 16, v123
  v_and_b32 v203, 0xffff0000, v123
  buffer_store_dwordx4 v[120:123], v0, s[4:7], s92 offen sc1
  v_add_f32 v136, v196, v197
  v_mul_f32 v137, v196, v196
  v_add_f32 v138, v198, v199
  v_mul_f32 v139, v197, v197
  v_fmac_f32 v137, v198, v198
  v_fmac_f32 v139, v199, v199
  v_add_f32 v136, v136, v200
  v_fmac_f32 v137, v200, v200
  v_add_f32 v138, v138, v201
  v_fmac_f32 v139, v201, v201
  v_add_f32 v136, v136, v202
  v_fmac_f32 v137, v202, v202
  v_add_f32 v138, v138, v203
  v_fmac_f32 v139, v203, v203
  v_add_f32 v136, v136, v138
  v_add_f32 v137, v137, v139
  s_nop 0
  v_add_f32_dpp v136, v136, v136 row_ror:8 row_mask:0xf bank_mask:0xf
  v_add_f32_dpp v137, v137, v137 row_ror:8 row_mask:0xf bank_mask:0xf
  s_nop 0
  v_add_f32_dpp v136, v136, v136 row_ror:4 row_mask:0xf bank_mask:0xf
  v_add_f32_dpp v137, v137, v137 row_ror:4 row_mask:0xf bank_mask:0xf
  s_nop 0
  v_add_f32_dpp v136, v136, v136 row_ror:2 row_mask:0xf bank_mask:0xf
  v_add_f32_dpp v137, v137, v137 row_ror:2 row_mask:0xf bank_mask:0xf
  s_nop 0
  v_add_f32_dpp v136, v136, v136 row_ror:1 row_mask:0xf bank_mask:0xf
  v_add_f32_dpp v137, v137, v137 row_ror:1 row_mask:0xf bank_mask:0xf
  v_mov_b32 v140, v136
  v_mov_b32 v141, v137
  s_nop 0
  v_permlane16_swap_b32 v136, v140
  v_permlane16_swap_b32 v137, v141
  v_add_f32 v136, v136, v140
  v_add_f32 v137, v137, v141
  v_mov_b32 v140, v136
  v_mov_b32 v141, v137
  s_nop 0
  v_permlane32_swap_b32 v136, v140
  v_permlane32_swap_b32 v137, v141
  v_add_f32 v136, v136, v140
  v_add_f32 v137, v137, v141
  v_mul_f32 v136, 0x3b000000, v136
  v_mul_f32 v137, 0x3b000000, v137
  v_fma_f32 v137, -v136, v136, v137
  v_cvt_pk_bf16_f32 v136, 0, v136
  v_max_f32 v137, 0, v137
  v_sub_f32 v140, v196, v136
  v_sub_f32 v141, v197, v136
  v_cvt_pk_bf16_f32 v137, 0, v137
  v_sub_f32 v142, v198, v136
  v_sub_f32 v143, v199, v136
  v_add_f32 v137, 0x3727c5ac, v137
  v_sub_f32 v144, v200, v136
  v_sub_f32 v145, v201, v136
  v_cvt_pk_bf16_f32 v137, 0, v137
  v_sub_f32 v146, v202, v136
  v_sub_f32 v147, v203, v136
  v_sqrt_f32 v137, v137
  v_cvt_pk_bf16_f32 v140, 0, v140
  v_cvt_pk_bf16_f32 v141, 0, v141
  v_cvt_pk_bf16_f32 v137, 0, v137
  v_cvt_pk_bf16_f32 v142, 0, v142
  v_cvt_pk_bf16_f32 v143, 0, v143
  v_rcp_f32 v137, v137
  v_cvt_pk_bf16_f32 v144, 0, v144
  v_cvt_pk_bf16_f32 v145, 0, v145
  v_cvt_pk_bf16_f32 v146, 0, v146
  v_cvt_pk_bf16_f32 v147, 0, v147
  v_mul_f32 v140, v140, v137
  v_mul_f32 v141, v141, v137
  v_mul_f32 v142, v142, v137
  v_mul_f32 v143, v143, v137
  v_mul_f32 v144, v144, v137
  v_mul_f32 v145, v145, v137
  v_mul_f32 v146, v146, v137
  v_mul_f32 v147, v147, v137
  v_cvt_pk_bf16_f32 v124, v140, v141
  v_cvt_pk_bf16_f32 v125, v142, v143
  v_cvt_pk_bf16_f32 v126, v144, v145
  v_cvt_pk_bf16_f32 v127, v146, v147
  v_lshlrev_b32 v204, 16, v124
  v_and_b32 v205, 0xffff0000, v124
  v_lshlrev_b32 v206, 16, v125
  v_and_b32 v207, 0xffff0000, v125
  v_lshlrev_b32 v208, 16, v126
  v_and_b32 v209, 0xffff0000, v126
  v_lshlrev_b32 v210, 16, v127
  v_and_b32 v211, 0xffff0000, v127
  buffer_store_dwordx4 v[124:127], v0, s[4:7], s93 offen sc1
  v_add_f32 v196, v196, v204
  v_add_f32 v197, v197, v205
  v_add_f32 v198, v198, v206
  v_add_f32 v199, v199, v207
  v_add_f32 v200, v200, v208
  v_add_f32 v201, v201, v209
  v_add_f32 v202, v202, v210
  v_add_f32 v203, v203, v211
  v_cvt_pk_bf16_f32 v128, v196, v197
  v_cvt_pk_bf16_f32 v129, v198, v199
  v_cvt_pk_bf16_f32 v130, v200, v201
  v_cvt_pk_bf16_f32 v131, v202, v203
  v_mul_f32 v188, v204, v8
  v_mul_f32 v189, v205, v9
  v_fmac_f32 v188, v206, v10
  v_fmac_f32 v189, v207, v11
  v_fmac_f32 v188, v208, v12
  v_fmac_f32 v189, v209, v13
  v_fmac_f32 v188, v210, v14
  v_fmac_f32 v189, v211, v15
  v_add_f32 v188, v188, v189
  s_add_u32 s92, s91, 10485760
  s_add_u32 s93, s91, 8388608
  buffer_store_dwordx4 v[128:131], v0, s[4:7], s92 offen sc1
  v_lshlrev_b32 v196, 16, v128
  v_and_b32 v197, 0xffff0000, v128
  v_lshlrev_b32 v198, 16, v129
  v_and_b32 v199, 0xffff0000, v129
  v_lshlrev_b32 v200, 16, v130
  v_and_b32 v201, 0xffff0000, v130
  v_lshlrev_b32 v202, 16, v131
  v_and_b32 v203, 0xffff0000, v131
  v_add_f32 v136, v196, v197
  v_mul_f32 v137, v196, v196
  v_add_f32 v138, v198, v199
  v_mul_f32 v139, v197, v197
  v_fmac_f32 v137, v198, v198
  v_fmac_f32 v139, v199, v199
  v_add_f32 v136, v136, v200
  v_fmac_f32 v137, v200, v200
  v_add_f32 v138, v138, v201
  v_fmac_f32 v139, v201, v201
  v_add_f32 v136, v136, v202
  v_fmac_f32 v137, v202, v202
  v_add_f32 v138, v138, v203
  v_fmac_f32 v139, v203, v203
  v_add_f32 v136, v136, v138
  v_add_f32 v137, v137, v139
  s_nop 0
  v_add_f32_dpp v136, v136, v136 row_ror:8 row_mask:0xf bank_mask:0xf
  v_add_f32_dpp v137, v137, v137 row_ror:8 row_mask:0xf bank_mask:0xf
  v_add_f32_dpp v188, v188, v188 row_ror:8 row_mask:0xf bank_mask:0xf
  v_add_f32_dpp v136, v136, v136 row_ror:4 row_mask:0xf bank_mask:0xf
  v_add_f32_dpp v137, v137, v137 row_ror:4 row_mask:0xf bank_mask:0xf
  v_add_f32_dpp v188, v188, v188 row_ror:4 row_mask:0xf bank_mask:0xf
  v_add_f32_dpp v136, v136, v136 row_ror:2 row_mask:0xf bank_mask:0xf
  v_add_f32_dpp v137, v137, v137 row_ror:2 row_mask:0xf bank_mask:0xf
  v_add_f32_dpp v188, v188, v188 row_ror:2 row_mask:0xf bank_mask:0xf
  v_add_f32_dpp v136, v136, v136 row_ror:1 row_mask:0xf bank_mask:0xf
  v_add_f32_dpp v137, v137, v137 row_ror:1 row_mask:0xf bank_mask:0xf
  v_add_f32_dpp v188, v188, v188 row_ror:1 row_mask:0xf bank_mask:0xf
  v_mov_b32 v140, v136
  v_mov_b32 v141, v137
  v_mov_b32 v142, v188
  v_permlane16_swap_b32 v136, v140
  v_permlane16_swap_b32 v137, v141
  v_permlane16_swap_b32 v188, v142
  v_add_f32 v136, v136, v140
  v_add_f32 v137, v137, v141
  v_add_f32 v188, v188, v142
  v_mov_b32 v140, v136
  v_mov_b32 v141, v137
  v_mov_b32 v142, v188
  v_permlane32_swap_b32 v136, v140
  v_permlane32_swap_b32 v137, v141
  v_permlane32_swap_b32 v188, v142
  v_add_f32 v136, v136, v140
  v_add_f32 v137, v137, v141
  v_add_f32 v188, v188, v142
  v_mul_f32 v136, 0x3b000000, v136
  v_mul_f32 v137, 0x3b000000, v137
  v_fma_f32 v137, -v136, v136, v137
  v_cvt_pk_bf16_f32 v136, 0, v136
  v_max_f32 v137, 0, v137
  v_sub_f32 v140, v196, v136
  v_sub_f32 v141, v197, v136
  v_cvt_pk_bf16_f32 v137, 0, v137
  v_sub_f32 v142, v198, v136
  v_sub_f32 v143, v199, v136
  v_add_f32 v137, 0x3727c5ac, v137
  v_sub_f32 v144, v200, v136
  v_sub_f32 v145, v201, v136
  v_cvt_pk_bf16_f32 v137, 0, v137
  v_sub_f32 v146, v202, v136
  v_sub_f32 v147, v203, v136
  v_sqrt_f32 v137, v137
  v_cvt_pk_bf16_f32 v140, 0, v140
  v_cvt_pk_bf16_f32 v141, 0, v141
  v_cvt_pk_bf16_f32 v137, 0, v137
  v_cvt_pk_bf16_f32 v142, 0, v142
  v_cvt_pk_bf16_f32 v143, 0, v143
  v_rcp_f32 v137, v137
  v_cvt_pk_bf16_f32 v144, 0, v144
  v_cvt_pk_bf16_f32 v145, 0, v145
  v_cvt_pk_bf16_f32 v146, 0, v146
  v_cvt_pk_bf16_f32 v147, 0, v147
  v_mul_f32 v140, v140, v137
  v_mul_f32 v141, v141, v137
  v_mul_f32 v142, v142, v137
  v_mul_f32 v143, v143, v137
  v_mul_f32 v144, v144, v137
  v_mul_f32 v145, v145, v137
  v_mul_f32 v146, v146, v137
  v_mul_f32 v147, v147, v137
  v_cvt_pk_bf16_f32 v132, v140, v141
  v_cvt_pk_bf16_f32 v133, v142, v143
  v_cvt_pk_bf16_f32 v134, v144, v145
  v_cvt_pk_bf16_f32 v135, v146, v147
  buffer_store_dwordx4 v[132:135], v0, s[4:7], s93 offen sc1
  v_cvt_pk_bf16_f32 v188, 0, v188
  v_ashrrev_i32 v189, 31, v188
  v_or_b32 v189, 0x80000000, v189
  v_xor_b32 v188, v188, v189
  s_sub_u32 s92, 4095, s90
  v_and_b32 v188, 0xffff0000, v188
  v_or_b32 v38, s92, v188
  s_bfe_u32 s92, s65, 196625
  s_lshl_b32 s92, s92, 18
  s_lshl_b32 s93, s90, 7
  s_add_u32 s92, s92, s93
  s_add_u32 s84, s92, 243269632
  s_waitcnt vmcnt(0)
  s_mov_b64 exec, 1
  buffer_store_dword v38, off, s[4:7], s84 sc1
  s_mov_b64 exec, -1
  s_mov_b32 s84, 268435456
  s_branch o_fd_227
o_rt_231:
  s_mov_b32 s67, 0
o_rl_233:
  s_lshl_b32 s94, s43, 14
  s_add_u32 s94, s94, s86
  buffer_load_dwordx4 v[120:123], v5, s[4:7], s94 offen offset:0 sc1
  buffer_load_dwordx4 v[124:127], v5, s[4:7], s94 offen offset:512 sc1
  buffer_load_dwordx4 v[128:131], v5, s[4:7], s94 offen offset:256 sc1
  buffer_load_dwordx4 v[132:135], v5, s[4:7], s94 offen offset:768 sc1
  s_add_u32 s94, s94, 4096
  buffer_load_dwordx4 v[136:139], v5, s[4:7], s94 offen offset:0 sc1
  buffer_load_dwordx4 v[140:143], v5, s[4:7], s94 offen offset:512 sc1
  buffer_load_dwordx4 v[144:147], v5, s[4:7], s94 offen offset:256 sc1
  buffer_load_dwordx4 v[148:151], v5, s[4:7], s94 offen offset:768 sc1
  s_add_u32 s94, s94, 4096
  buffer_load_dwordx4 v[152:155], v5, s[4:7], s94 offen offset:0 sc1
  buffer_load_dwordx4 v[156:159], v5, s[4:7], s94 offen offset:512 sc1
  buffer_load_dwordx4 v[160:163], v5, s[4:7], s94 offen offset:256 sc1
  buffer_load_dwordx4 v[164:167], v5, s[4:7], s94 offen offset:768 sc1
  s_add_u32 s94, s94, 4096
  buffer_load_dwordx4 v[168:171], v5, s[4:7], s94 offen offset:0 sc1
  buffer_load_dwordx4 v[172:175], v5, s[4:7], s94 offen offset:512 sc1
  buffer_load_dwordx4 v[176:179], v5, s[4:7], s94 offen offset:256 sc1
  buffer_load_dwordx4 v[180:183], v5, s[4:7], s94 offen offset:768 sc1
  s_add_u32 s67, s67, 1
  s_cmp_gt_u32 s67, 1048576
  s_cbranch_scc1 L_end
  s_waitcnt vmcnt(0)
  v_xor_b32 v7, s96, v120
  v_bitop3_b32 v7, v7, v124, s96 bitop3:0xf6
  v_bitop3_b32 v7, v7, v128, s96 bitop3:0xf6
  v_bitop3_b32 v7, v7, v132, s96 bitop3:0xf6
  v_bitop3_b32 v7, v7, v136, s96 bitop3:0xf6
  v_bitop3_b32 v7, v7, v140, s96 bitop3:0xf6
  v_bitop3_b32 v7, v7, v144, s96 bitop3:0xf6
  v_bitop3_b32 v7, v7, v148, s96 bitop3:0xf6
  v_bitop3_b32 v7, v7, v152, s96 bitop3:0xf6
  v_bitop3_b32 v7, v7, v156, s96 bitop3:0xf6
  v_bitop3_b32 v7, v7, v160, s96 bitop3:0xf6
  v_bitop3_b32 v7, v7, v164, s96 bitop3:0xf6
  v_bitop3_b32 v7, v7, v168, s96 bitop3:0xf6
  v_bitop3_b32 v7, v7, v172, s96 bitop3:0xf6
  v_bitop3_b32 v7, v7, v176, s96 bitop3:0xf6
  v_bitop3_b32 v7, v7, v180, s96 bitop3:0xf6
  v_and_b32 v7, v254, v7
  v_cmp_ne_u32 vcc, 0, v7
  s_cbranch_vccnz o_rl_233
  s_branch o_bk_232
o_f2_228:
  s_lshl_b32 s94, s43, 14
  s_add_u32 s94, s94, s86
  buffer_load_dwordx4 v[120:123], v5, s[4:7], s94 offen offset:0 sc1
  buffer_load_dwordx4 v[124:127], v5, s[4:7], s94 offen offset:512 sc1
  buffer_load_dwordx4 v[128:131], v5, s[4:7], s94 offen offset:256 sc1
  buffer_load_dwordx4 v[132:135], v5, s[4:7], s94 offen offset:768 sc1
  s_add_u32 s94, s94, 4096
  buffer_load_dwordx4 v[136:139], v5, s[4:7], s94 offen offset:0 sc1
  buffer_load_dwordx4 v[140:143], v5, s[4:7], s94 offen offset:512 sc1
  buffer_load_dwordx4 v[144:147], v5, s[4:7], s94 offen offset:256 sc1
  buffer_load_dwordx4 v[148:151], v5, s[4:7], s94 offen offset:768 sc1
  s_add_u32 s94, s94, 4096
  buffer_load_dwordx4 v[152:155], v5, s[4:7], s94 offen offset:0 sc1
  buffer_load_dwordx4 v[156:159], v5, s[4:7], s94 offen offset:512 sc1
  buffer_load_dwordx4 v[160:163], v5, s[4:7], s94 offen offset:256 sc1
  buffer_load_dwordx4 v[164:167], v5, s[4:7], s94 offen offset:768 sc1
  s_add_u32 s94, s94, 4096
  buffer_load_dwordx4 v[168:171], v5, s[4:7], s94 offen offset:0 sc1
  buffer_load_dwordx4 v[172:175], v5, s[4:7], s94 offen offset:512 sc1
  buffer_load_dwordx4 v[176:179], v5, s[4:7], s94 offen offset:256 sc1
  buffer_load_dwordx4 v[180:183], v5, s[4:7], s94 offen offset:768 sc1
  s_mov_b64 exec, 1
  buffer_store_dword v38, off, s[4:7], s84 sc1
  s_mov_b64 exec, -1
  s_mov_b32 s84, 268435456
  v_mov_b64 v[188:189], 0
  v_mov_b64 v[190:191], 0
  v_mov_b64 v[192:193], 0
  v_mov_b64 v[194:195], 0
  s_waitcnt vmcnt(13)
  v_xor_b32 v7, s96, v120
  v_bitop3_b32 v7, v7, v124, s96 bitop3:0xf6
  v_bitop3_b32 v7, v7, v128, s96 bitop3:0xf6
  v_bitop3_b32 v7, v7, v132, s96 bitop3:0xf6
  s_waitcnt vmcnt(9)
  v_bitop3_b32 v7, v7, v136, s96 bitop3:0xf6
  v_bitop3_b32 v7, v7, v140, s96 bitop3:0xf6
  v_bitop3_b32 v7, v7, v144, s96 bitop3:0xf6
  v_bitop3_b32 v7, v7, v148, s96 bitop3:0xf6
  s_waitcnt vmcnt(5)
  v_bitop3_b32 v7, v7, v152, s96 bitop3:0xf6
  v_bitop3_b32 v7, v7, v156, s96 bitop3:0xf6
  v_bitop3_b32 v7, v7, v160, s96 bitop3:0xf6
  v_bitop3_b32 v7, v7, v164, s96 bitop3:0xf6
  s_waitcnt vmcnt(1)
  v_bitop3_b32 v7, v7, v168, s96 bitop3:0xf6
  v_bitop3_b32 v7, v7, v172, s96 bitop3:0xf6
  v_bitop3_b32 v7, v7, v176, s96 bitop3:0xf6
  v_bitop3_b32 v7, v7, v180, s96 bitop3:0xf6
  v_and_b32 v7, v254, v7
  v_cmp_ne_u32 vcc, 0, v7
  s_cbranch_vccnz o_rt_234
o_bk_235:
  v_smfmac_f32_16x16x64_bf16 v[188:191], v[16:19], v[120:127], v20
  v_lshlrev_b32 v196, 16, v184
  v_smfmac_f32_16x16x64_bf16 v[192:195], v[16:19], v[128:135], v20
  v_and_b32 v197, 0xffff0000, v184
  v_smfmac_f32_16x16x64_bf16 v[188:191], v[16:19], v[136:143], v20
  v_lshlrev_b32 v198, 16, v185
  v_smfmac_f32_16x16x64_bf16 v[192:195], v[16:19], v[144:151], v20
  v_and_b32 v199, 0xffff0000, v185
  v_smfmac_f32_16x16x64_bf16 v[188:191], v[16:19], v[152:159], v20
  v_lshlrev_b32 v200, 16, v186
  v_smfmac_f32_16x16x64_bf16 v[192:195], v[16:19], v[160:167], v20
  v_and_b32 v201, 0xffff0000, v186
  v_smfmac_f32_16x16x64_bf16 v[188:191], v[16:19], v[168:175], v20
  v_lshlrev_b32 v202, 16, v187
  v_smfmac_f32_16x16x64_bf16 v[192:195], v[16:19], v[176:183], v20
  v_and_b32 v203, 0xffff0000, v187
  s_bfe_u32 s92, s65, 131086
  s_lshl_b32 s92, s92, 21
  s_add_u32 s92, s92, s91
  s_add_u32 s93, s92, 27262976
  s_add_u32 s92, s92, 20971520
  s_nop 1
  v_permlane16_swap_b32 v188, v192
  v_permlane16_swap_b32 v189, v193
  v_permlane16_swap_b32 v190, v194
  v_permlane16_swap_b32 v191, v195
  v_cvt_pk_bf16_f32 v188, 0, v188
  v_cvt_pk_bf16_f32 v189, 0, v189
  v_cvt_pk_bf16_f32 v190, 0, v190
  v_cvt_pk_bf16_f32 v191, 0, v191
  v_cvt_pk_bf16_f32 v192, 0, v192
  v_cvt_pk_bf16_f32 v193, 0, v193
  v_cvt_pk_bf16_f32 v194, 0, v194
  v_cvt_pk_bf16_f32 v195, 0, v195
  v_add_f32 v196, v196, v188
  v_add_f32 v197, v197, v189
  v_add_f32 v198, v198, v190
  v_add_f32 v199, v199, v191
  v_add_f32 v200, v200, v192
  v_add_f32 v201, v201, v193
  v_add_f32 v202, v202, v194
  v_add_f32 v203, v203, v195
  v_cvt_pk_bf16_f32 v120, v196, v197
  v_cvt_pk_bf16_f32 v121, v198, v199
  v_cvt_pk_bf16_f32 v122, v200, v201
  v_cvt_pk_bf16_f32 v123, v202, v203
  v_lshlrev_b32 v196, 16, v120
  v_and_b32 v197, 0xffff0000, v120
  v_lshlrev_b32 v198, 16, v121
  v_and_b32 v199, 0xffff0000, v121
  v_lshlrev_b32 v200, 16, v122
  v_and_b32 v201, 0xffff0000, v122
  v_lshlrev_b32 v202, 16, v123
  v_and_b32 v203, 0xffff0000, v123
  buffer_store_dwordx4 v[120:123], v0, s[4:7], s92 offen sc1
  v_add_f32 v136, v196, v197
  v_mul_f32 v137, v196, v196
  v_add_f32 v138, v198, v199
  v_mul_f32 v139, v197, v197
  v_fmac_f32 v137, v198, v198
  v_fmac_f32 v139, v199, v199
  v_add_f32 v136, v136, v200
  v_fmac_f32 v137, v200, v200
  v_add_f32 v138, v138, v201
  v_fmac_f32 v139, v201, v201
  v_add_f32 v136, v136, v202
  v_fmac_f32 v137, v202, v202
  v_add_f32 v138, v138, v203
  v_fmac_f32 v139, v203, v203
  v_add_f32 v136, v136, v138
  v_add_f32 v137, v137, v139
  s_nop 0
  v_add_f32_dpp v136, v136, v136 row_ror:8 row_mask:0xf bank_mask:0xf
  v_add_f32_dpp v137, v137, v137 row_ror:8 row_mask:0xf bank_mask:0xf
  s_nop 0
  v_add_f32_dpp v136, v136, v136 row_ror:4 row_mask:0xf bank_mask:0xf
  v_add_f32_dpp v137, v137, v137 row_ror:4 row_mask:0xf bank_mask:0xf
  s_nop 0
  v_add_f32_dpp v136, v136, v136 row_ror:2 row_mask:0xf bank_mask:0xf
  v_add_f32_dpp v137, v137, v137 row_ror:2 row_mask:0xf bank_mask:0xf
  s_nop 0
  v_add_f32_dpp v136, v136, v136 row_ror:1 row_mask:0xf bank_mask:0xf
  v_add_f32_dpp v137, v137, v137 row_ror:1 row_mask:0xf bank_mask:0xf
  v_mov_b32 v140, v136
  v_mov_b32 v141, v137
  s_nop 0
  v_permlane16_swap_b32 v136, v140
  v_permlane16_swap_b32 v137, v141
  v_add_f32 v136, v136, v140
  v_add_f32 v137, v137, v141
  v_mov_b32 v140, v136
  v_mov_b32 v141, v137
  s_nop 0
  v_permlane32_swap_b32 v136, v140
  v_permlane32_swap_b32 v137, v141
  v_add_f32 v136, v136, v140
  v_add_f32 v137, v137, v141
  v_mul_f32 v136, 0x3b000000, v136
  v_mul_f32 v137, 0x3b000000, v137
  v_fma_f32 v137, -v136, v136, v137
  v_cvt_pk_bf16_f32 v136, 0, v136
  v_max_f32 v137, 0, v137
  v_sub_f32 v140, v196, v136
  v_sub_f32 v141, v197, v136
  v_cvt_pk_bf16_f32 v137, 0, v137
  v_sub_f32 v142, v198, v136
  v_sub_f32 v143, v199, v136
  v_add_f32 v137, 0x3727c5ac, v137
  v_sub_f32 v144, v200, v136
  v_sub_f32 v145, v201, v136
  v_cvt_pk_bf16_f32 v137, 0, v137
  v_sub_f32 v146, v202, v136
  v_sub_f32 v147, v203, v136
  v_sqrt_f32 v137, v137
  v_cvt_pk_bf16_f32 v140, 0, v140
  v_cvt_pk_bf16_f32 v141, 0, v141
  v_cvt_pk_bf16_f32 v137, 0, v137
  v_cvt_pk_bf16_f32 v142, 0, v142
  v_cvt_pk_bf16_f32 v143, 0, v143
  v_rcp_f32 v137, v137
  v_cvt_pk_bf16_f32 v144, 0, v144
  v_cvt_pk_bf16_f32 v145, 0, v145
  v_cvt_pk_bf16_f32 v146, 0, v146
  v_cvt_pk_bf16_f32 v147, 0, v147
  v_mul_f32 v140, v140, v137
  v_mul_f32 v141, v141, v137
  v_mul_f32 v142, v142, v137
  v_mul_f32 v143, v143, v137
  v_mul_f32 v144, v144, v137
  v_mul_f32 v145, v145, v137
  v_mul_f32 v146, v146, v137
  v_mul_f32 v147, v147, v137
  v_cvt_pk_bf16_f32 v124, v140, v141
  v_cvt_pk_bf16_f32 v125, v142, v143
  v_cvt_pk_bf16_f32 v126, v144, v145
  v_cvt_pk_bf16_f32 v127, v146, v147
  v_lshlrev_b32 v204, 16, v124
  v_and_b32 v205, 0xffff0000, v124
  v_lshlrev_b32 v206, 16, v125
  v_and_b32 v207, 0xffff0000, v125
  v_lshlrev_b32 v208, 16, v126
  v_and_b32 v209, 0xffff0000, v126
  v_lshlrev_b32 v210, 16, v127
  v_and_b32 v211, 0xffff0000, v127
  buffer_store_dwordx4 v[124:127], v0, s[4:7], s93 offen sc1
  v_add_f32 v196, v196, v204
  v_add_f32 v197, v197, v205
  v_add_f32 v198, v198, v206
  v_add_f32 v199, v199, v207
  v_add_f32 v200, v200, v208
  v_add_f32 v201, v201, v209
  v_add_f32 v202, v202, v210
  v_add_f32 v203, v203, v211
  v_cvt_pk_bf16_f32 v128, v196, v197
  v_cvt_pk_bf16_f32 v129, v198, v199
  v_cvt_pk_bf16_f32 v130, v200, v201
  v_cvt_pk_bf16_f32 v131, v202, v203
  v_mul_f32 v188, v204, v8
  v_mul_f32 v189, v205, v9
  v_fmac_f32 v188, v206, v10
  v_fmac_f32 v189, v207, v11
  v_fmac_f32 v188, v208, v12
  v_fmac_f32 v189, v209, v13
  v_fmac_f32 v188, v210, v14
  v_fmac_f32 v189, v211, v15
  v_add_f32 v188, v188, v189
  buffer_store_dwordx4 v[128:131], v0, s[68:71], s91 offen sc1
  s_nop 0
  v_add_f32_dpp v188, v188, v188 row_ror:8 row_mask:0xf bank_mask:0xf
  s_nop 1
  v_add_f32_dpp v188, v188, v188 row_ror:4 row_mask:0xf bank_mask:0xf
  s_nop 1
  v_add_f32_dpp v188, v188, v188 row_ror:2 row_mask:0xf bank_mask:0xf
  s_nop 1
  v_add_f32_dpp v188, v188, v188 row_ror:1 row_mask:0xf bank_mask:0xf
  v_mov_b32 v189, v188
  s_nop 0
  s_nop 0
  v_permlane16_swap_b32 v188, v189
  v_add_f32 v188, v188, v189
  v_mov_b32 v189, v188
  s_nop 0
  s_nop 0
  v_permlane32_swap_b32 v188, v189
  v_add_f32 v188, v188, v189
  v_cvt_pk_bf16_f32 v188, 0, v188
  v_ashrrev_i32 v189, 31, v188
  v_or_b32 v189, 0x80000000, v189
  v_xor_b32 v188, v188, v189
  s_sub_u32 s92, 4095, s90
  v_and_b32 v188, 0xffff0000, v188
  v_or_b32 v38, s92, v188
  s_bfe_u32 s92, s65, 196625
  s_lshl_b32 s92, s92, 18
  s_lshl_b32 s93, s90, 7
  s_add_u32 s92, s92, s93
  s_add_u32 s84, s92, 243269632
  s_waitcnt vmcnt(0)
  s_mov_b64 exec, 1
  buffer_store_dword v38, off, s[4:7], s84 sc1
  s_mov_b64 exec, -1
  s_mov_b32 s84, 268435456
  s_branch o_fd_227
o_rt_234:
  s_mov_b32 s67, 0
o_rl_236:
  s_lshl_b32 s94, s43, 14
  s_add_u32 s94, s94, s86
  buffer_load_dwordx4 v[120:123], v5, s[4:7], s94 offen offset:0 sc1
  buffer_load_dwordx4 v[124:127], v5, s[4:7], s94 offen offset:512 sc1
  buffer_load_dwordx4 v[128:131], v5, s[4:7], s94 offen offset:256 sc1
  buffer_load_dwordx4 v[132:135], v5, s[4:7], s94 offen offset:768 sc1
  s_add_u32 s94, s94, 4096
  buffer_load_dwordx4 v[136:139], v5, s[4:7], s94 offen offset:0 sc1
  buffer_load_dwordx4 v[140:143], v5, s[4:7], s94 offen offset:512 sc1
  buffer_load_dwordx4 v[144:147], v5, s[4:7], s94 offen offset:256 sc1
  buffer_load_dwordx4 v[148:151], v5, s[4:7], s94 offen offset:768 sc1
  s_add_u32 s94, s94, 4096
  buffer_load_dwordx4 v[152:155], v5, s[4:7], s94 offen offset:0 sc1
  buffer_load_dwordx4 v[156:159], v5, s[4:7], s94 offen offset:512 sc1
  buffer_load_dwordx4 v[160:163], v5, s[4:7], s94 offen offset:256 sc1
  buffer_load_dwordx4 v[164:167], v5, s[4:7], s94 offen offset:768 sc1
  s_add_u32 s94, s94, 4096
  buffer_load_dwordx4 v[168:171], v5, s[4:7], s94 offen offset:0 sc1
  buffer_load_dwordx4 v[172:175], v5, s[4:7], s94 offen offset:512 sc1
  buffer_load_dwordx4 v[176:179], v5, s[4:7], s94 offen offset:256 sc1
  buffer_load_dwordx4 v[180:183], v5, s[4:7], s94 offen offset:768 sc1
  s_add_u32 s67, s67, 1
  s_cmp_gt_u32 s67, 1048576
  s_cbranch_scc1 L_end
  s_waitcnt vmcnt(0)
  v_xor_b32 v7, s96, v120
  v_bitop3_b32 v7, v7, v124, s96 bitop3:0xf6
  v_bitop3_b32 v7, v7, v128, s96 bitop3:0xf6
  v_bitop3_b32 v7, v7, v132, s96 bitop3:0xf6
  v_bitop3_b32 v7, v7, v136, s96 bitop3:0xf6
  v_bitop3_b32 v7, v7, v140, s96 bitop3:0xf6
  v_bitop3_b32 v7, v7, v144, s96 bitop3:0xf6
  v_bitop3_b32 v7, v7, v148, s96 bitop3:0xf6
  v_bitop3_b32 v7, v7, v152, s96 bitop3:0xf6
  v_bitop3_b32 v7, v7, v156, s96 bitop3:0xf6
  v_bitop3_b32 v7, v7, v160, s96 bitop3:0xf6
  v_bitop3_b32 v7, v7, v164, s96 bitop3:0xf6
  v_bitop3_b32 v7, v7, v168, s96 bitop3:0xf6
  v_bitop3_b32 v7, v7, v172, s96 bitop3:0xf6
  v_bitop3_b32 v7, v7, v176, s96 bitop3:0xf6
  v_bitop3_b32 v7, v7, v180, s96 bitop3:0xf6
  v_and_b32 v7, v254, v7
  v_cmp_ne_u32 vcc, 0, v7
  s_cbranch_vccnz o_rl_236
  s_branch o_bk_235
o_fd_227:
  s_mov_b32 s65, 0
o_nofl_187:
  s_mov_b32 s63, s64
  s_cmp_lg_u32 s51, 0
  s_cbranch_scc1 o_pick_189
  s_cmp_eq_u32 s50, 0
  s_cbranch_scc1 o_help_196_n
o_adv_195:
  s_add_u32 s49, s49, 4
  s_branch o_round_185
o_dl_197_a:
  s_andn2_b32 s26, s58, s55
  s_and_b32 s29, s26, s54
  s_bcnt1_i32_b32 s27, s29
  s_add_u32 s27, s27, 2
  s_max_u32 s27, s27, 4
  s_andn2_b32 s26, s26, s56
  s_and_b32 s26, s26, 0x3fff
  s_or_b32 s26, s26, s29
  s_cselect_b32 s27, s27, 0
  s_mul_i32 s27, s27, 0
  s_cmp_ge_u32 s46, s89
  s_cselect_b32 s30, s54, -1
  s_mov_b32 s31, 243269696
  s_branch o_dl_197_b
o_dl_197:
  s_and_b32 s26, s55, s54
  s_andn2_b32 s27, s56, s54
  s_or_b32 s26, s26, s27
  s_andn2_b32 s26, s58, s26
  s_bcnt1_i32_b32 s27, s26
  s_bcnt1_i32_b32 s28, s47
  s_mul_i32 s28, s28, -5
  s_lshl1_add_u32 s27, s27, s28
  s_add_i32 s27, s27, 1
  s_max_i32 s27, s27, 0
  s_mul_i32 s27, s27, 37
  s_mov_b32 s30, s54
  s_mov_b32 s31, 243269704
  s_and_b32 s29, s26, s47
  s_andn2_b32 s26, s26, s29
  s_branch o_dl_197_c
o_dl_197_b:
  s_mov_b32 s29, 0
o_dl_197_c:
  s_bfe_u32 s28, s48, 262144
  s_bitset0_b32 s26, s28
  s_bfe_u32 s28, s48, 262148
  s_bitset0_b32 s26, s28
  s_bfe_u32 s28, s48, 262152
  s_bitset0_b32 s26, s28
  s_bfe_u32 s28, s48, 262156
  s_bitset0_b32 s26, s28
  s_lshr_b32 s27, s27, 8
o_dl1_198:
  s_cbranch_scc0 o_dl2_199
  s_ff1_i32_b32 s28, s26
  s_bitset0_b32 s26, s28
  s_bitset1_b32 s29, s28
  s_sub_u32 s27, s27, 1
  s_cmp_lg_u32 s27, 0
  s_branch o_dl1_198
o_dl2_199:
  s_and_b32 s47, s29, 0xffff
  s_and_b32 s30, s30, s47
  s_or_b32 s55, s55, s30
  s_andn2_b32 s26, s47, s30
  s_or_b32 s56, s56, s26
  s_pack_ll_b32_b16 s26, s47, s30
  s_lshl_b32 s27, s60, 7
  s_add_u32 s27, s27, s31
  s_cmp_lg_u32 s43, 0
  s_cbranch_scc1 o_pick_189
  v_mov_b32 v162, s26
  v_mov_b32 v163, s46
  s_mov_b64 exec, 1
  buffer_store_dwordx2 v[162:163], off, s[4:7], s27 sc1
  s_mov_b64 exec, -1
  s_branch o_pick_189
o_help_196:
  s_lshl_b32 s60, s60, 1
  s_and_b32 s60, s60, 2
  s_lshl_b32 s47, s60, 7
  s_add_u32 s47, s47, 243269688
o_help_196_n:
  s_add_u32 s47, s47, 8
  s_lshr_b32 s26, s47, 4
  s_andn2_b32 s26, s57, s26
  s_cbranch_scc0 L_end
  s_mov_b32 s67, 0
o_help_196_w:
  buffer_load_dwordx2 v[162:163], off, s[4:7], s47 sc1
  buffer_load_dwordx2 v[164:165], off, s[4:7], s47 offset:128 sc1
  s_add_u32 s67, s67, 1
  s_cmp_gt_u32 s67, 1048576
  s_cbranch_scc1 L_end
  s_waitcnt vmcnt(0)
  v_readfirstlane_b32 s28, v162
  v_readfirstlane_b32 s30, v164
  v_readfirstlane_b32 s46, v163
  v_readfirstlane_b32 s27, v165
  s_min_u32 s26, s46, s27
  s_cmp_eq_u32 s26, 0
  s_cbranch_scc1 o_help_196_w
  s_max_u32 s46, s46, s27
  s_bitreplicate_b64_b32 s[28:29], s28
  s_bitreplicate_b64_b32 s[30:31], s30
  s_mov_b32 s26, 0x55555555
  s_mov_b32 s27, 0x55555555
  s_and_b64 s[28:29], s[28:29], s[26:27]
  s_andn2_b64 s[30:31], s[30:31], s[26:27]
  s_or_b32 s58, s28, s30
  s_or_b32 s54, s29, s31
  s_andn2_b32 s52, 0xfff, s46
  s_lshr_b32 s52, s52, 5
  s_mov_b32 s53, 0
  s_mov_b32 s63, 0
  s_mov_b32 s49, 72
  s_mov_b32 s59, 64
  s_mov_b32 s50, 0
  s_mov_b32 s89, 0
  s_branch o_pick_189

.section .rodata,"a"
.p2align 6
.amdhsa_kernel interleave_layers__memory_aug_recurrent_mem_tr__moe_arch_mod__prompt_kernel
  .amdhsa_next_free_vgpr 512
  .amdhsa_next_free_sgpr 102
  .amdhsa_accum_offset 256
  .amdhsa_group_segment_fixed_size 0
  .amdhsa_kernarg_size 120
  .amdhsa_user_sgpr_count 2
  .amdhsa_user_sgpr_kernarg_segment_ptr 1
  .amdhsa_system_sgpr_workgroup_id_x 1
  .amdhsa_float_denorm_mode_32 3
.end_amdhsa_kernel
```

```asm
; @launch grid=(256,1,1) block=(256,1,1) lds=163840
.amdgcn_target "amdgcn-amd-amdhsa--gfx950"
.text
.globl interleave_layers__memory_aug_recurrent_mem_tr__moe_arch_mod__prompt_kernel
.p2align 8
.type interleave_layers__memory_aug_recurrent_mem_tr__moe_arch_mod__prompt_kernel,@function
interleave_layers__memory_aug_recurrent_mem_tr__moe_arch_mod__prompt_kernel:
  s_cmp_ge_u32 s2, 256
  s_cbranch_scc1 L_end
  s_mov_b32 s6, 268435456
  s_mov_b32 s7, 0x20000
  s_mov_b32 s11, 0x20000
  s_getreg_b32 s89, hwreg(HW_REG_XCC_ID)
  s_and_b32 s89, s89, 7
  v_lshrrev_b32 v1, 6, v0
  s_and_b32 s91, s2, 7
  s_lshr_b32 s90, s2, 3
  v_readfirstlane_b32 s17, v1
  s_lshl_b32 s100, s91, 5
  s_add_u32 s100, s100, s90
  s_lshl_b32 s100, s100, 2
  s_add_u32 s100, s100, s17
  s_lshl_b32 s100, s100, 12
  s_add_u32 s100, s100, 37748736
  s_cmp_lt_u32 s91, 3
  s_cbranch_scc1 L_chain
  s_cmp_eq_u32 s91, 7
  s_cbranch_scc1 L_qkv
  s_bitcmp1_b32 s90, 4
  s_cbranch_scc1 L_qkv
  s_branch L_o
L_end:
  s_endpgm
L_chain:
  s_load_dwordx2 s[4:5], s[0:1], 112
  s_load_dwordx2 s[12:13], s[0:1], 104
  s_mov_b32 s16, s90
  s_mov_b32 s60, s91
  s_min_u32 s61, s91, 1
  v_lshrrev_b32 v18, 6, v0
  v_and_b32 v19, 63, v0
  v_readfirstlane_b32 s17, v18
  v_and_b32 v7, 15, v19
  v_lshrrev_b32 v17, 4, v19
  v_lshlrev_b32 v0, 4, v19
  s_load_dwordx2 s[56:57], s[0:1], 8
  s_mov_b32 s44, 0x05040100
  s_mov_b32 s45, 0x07060302
  s_mov_b32 s18, 0xcccccccc
  s_mov_b32 s19, 0xcccccccc
  s_mov_b32 s24, 0x3e0293ee
  s_lshl_b32 s26, s17, 10
  v_add_u32 v8, s26, v0
  v_xor_b32 v9, 1024, v8
  v_xor_b32 v10, 2048, v8
  v_xor_b32 v11, 3072, v8
  s_mov_b32 s14, 0x3f803f80
  s_mov_b32 s15, 0x3f803f80
  s_mul_i32 s27, s17, 24576
  s_add_u32 s27, s27, 65536
  v_add_u32 v1, s27, v0
  v_lshrrev_b32 v20, 2, v7
  v_xor_b32 v21, v17, v20
  v_lshlrev_b32 v22, 5, v7
  v_add_u32 v22, s26, v22
  v_lshl_add_u32 v2, v21, 3, v22
  v_and_b32 v21, 3, v7
  v_xor_b32 v21, v21, v17
  v_lshl_add_u32 v22, v17, 2, v20
  v_lshlrev_b32 v22, 5, v22
  v_lshl_add_u32 v3, v21, 3, v22
  v_add_u32 v12, s26, v3
  v_xor_b32 v13, 1024, v12
  v_xor_b32 v14, 2048, v12
  v_xor_b32 v15, 3072, v12
  v_lshlrev_b32 v21, 13, v20
  v_and_b32 v22, 3, v7
  v_lshl_add_u32 v22, v17, 2, v22
  v_lshl_add_u32 v21, v22, 4, v21
  s_lshl_b32 s27, s17, 16
  s_lshl_b32 s28, s16, 8
  s_add_u32 s27, s27, s28
  v_add_u32 v4, s27, v21
  v_and_b32 v21, 1, v7
  v_lshl_add_u32 v21, v17, 2, v21
  v_bfe_u32 v22, v7, 2, 1
  v_lshl_add_u32 v21, v22, 1, v21
  v_lshlrev_b32 v21, 4, v21
  v_bfe_u32 v22, v7, 1, 1
  v_lshl_add_u32 v21, v22, 3, v21
  v_add_u32 v5, s28, v21
  v_cmp_lt_u32 vcc, 7, v7
  v_mov_b32 v22, 0x7ff00000
  s_nop 0
  v_cndmask_b32 v5, v5, v22, vcc
  v_mov_b32 v21, 0x4444
  v_mov_b32 v22, 0xeeee
  v_cndmask_b32 v6, v21, v22, s[18:19]
  s_lshl_b32 s40, s60, 20
  s_add_u32 s40, s40, 0
  s_add_u32 s41, s40, 32768
  s_lshl_b32 s62, s60, 16
  s_add_u32 s62, s62, 4194304
  v_mov_b32 v24, -1
  v_mov_b32 v25, -1
  v_mov_b32 v26, -1
  v_mov_b32 v27, -1
  s_waitcnt lgkmcnt(0)
  buffer_store_dwordx4 v[24:27], v4, s[4:7], s40 offen sc1
  buffer_store_dwordx4 v[24:27], v4, s[4:7], s41 offen sc1
  s_add_u32 s27, s62, 0
  buffer_store_dwordx2 v[24:25], v5, s[4:7], s27 offen sc1
  s_add_u32 s27, s62, 8192
  buffer_store_dwordx2 v[24:25], v5, s[4:7], s27 offen sc1
  s_add_u32 s27, s62, 16384
  buffer_store_dwordx2 v[24:25], v5, s[4:7], s27 offen sc1
  s_add_u32 s27, s62, 24576
  buffer_store_dwordx2 v[24:25], v5, s[4:7], s27 offen sc1
  v_mov_b64 v[28:29], 0
  v_mov_b64 v[30:31], 0
  s_lshl_b32 s26, s16, 12
  s_cmp_eq_u32 s91, 0
  s_cbranch_scc1 L_ch1
  s_cmp_eq_u32 s91, 2
  s_cbranch_scc1 L_ch2
  s_add_u32 s27, s26, 243269632
  buffer_store_dwordx4 v[28:31], v8, s[4:7], s27 offen sc1
  s_add_u32 s27, s26, 243400704
  buffer_store_dwordx4 v[28:31], v8, s[4:7], s27 offen sc1
  s_add_u32 s27, s26, 243531776
  buffer_store_dwordx4 v[28:31], v8, s[4:7], s27 offen sc1
  s_add_u32 s27, s26, 243662848
  buffer_store_dwordx4 v[28:31], v8, s[4:7], s27 offen sc1
  s_add_u32 s27, s26, 243793920
  buffer_store_dwordx4 v[28:31], v8, s[4:7], s27 offen sc1
  s_add_u32 s27, s26, 243924992
  buffer_store_dwordx4 v[28:31], v8, s[4:7], s27 offen sc1
  s_add_u32 s27, s26, 244056064
  buffer_store_dwordx4 v[28:31], v8, s[4:7], s27 offen sc1
  s_add_u32 s27, s26, 244187136
  buffer_store_dwordx4 v[28:31], v8, s[4:7], s27 offen sc1
  s_add_u32 s27, s26, 244318208
  buffer_store_dwordx4 v[28:31], v8, s[4:7], s27 offen sc1
  s_add_u32 s27, s26, 244449280
  buffer_store_dwordx4 v[28:31], v8, s[4:7], s27 offen sc1
  s_add_u32 s27, s26, 244580352
  buffer_store_dwordx4 v[28:31], v8, s[4:7], s27 offen sc1
  s_add_u32 s27, s26, 244711424
  buffer_store_dwordx4 v[28:31], v8, s[4:7], s27 offen sc1
  s_add_u32 s27, s26, 244842496
  buffer_store_dwordx4 v[28:31], v8, s[4:7], s27 offen sc1
  s_add_u32 s27, s26, 244973568
  buffer_store_dwordx4 v[28:31], v8, s[4:7], s27 offen sc1
  s_add_u32 s27, s26, 245104640
  buffer_store_dwordx4 v[28:31], v8, s[4:7], s27 offen sc1
  s_add_u32 s27, s26, 245235712
  buffer_store_dwordx4 v[28:31], v8, s[4:7], s27 offen sc1
  s_add_u32 s27, s26, 245366784
  buffer_store_dwordx4 v[28:31], v8, s[4:7], s27 offen sc1
  s_branch L_ch0
L_ch2:
  s_add_u32 s27, s26, 245891072
  buffer_store_dwordx4 v[24:27], v8, s[4:7], s27 offen sc1
  s_add_u32 s27, s26, 246022144
  buffer_store_dwordx4 v[24:27], v8, s[4:7], s27 offen sc1
  s_add_u32 s27, s26, 246153216
  buffer_store_dwordx4 v[24:27], v8, s[4:7], s27 offen sc1
  s_add_u32 s27, s26, 246284288
  buffer_store_dwordx4 v[24:27], v8, s[4:7], s27 offen sc1
  s_add_u32 s27, s26, 246415360
  buffer_store_dwordx4 v[24:27], v8, s[4:7], s27 offen sc1
  s_add_u32 s27, s26, 246546432
  buffer_store_dwordx4 v[24:27], v8, s[4:7], s27 offen sc1
  s_add_u32 s27, s26, 246677504
  buffer_store_dwordx4 v[24:27], v8, s[4:7], s27 offen sc1
  s_add_u32 s27, s26, 246808576
  buffer_store_dwordx4 v[24:27], v8, s[4:7], s27 offen sc1
  s_add_u32 s27, s26, 246939648
  buffer_store_dwordx4 v[24:27], v8, s[4:7], s27 offen sc1
  s_add_u32 s27, s26, 247070720
  buffer_store_dwordx4 v[24:27], v8, s[4:7], s27 offen sc1
  s_add_u32 s27, s26, 247201792
  buffer_store_dwordx4 v[24:27], v8, s[4:7], s27 offen sc1
  s_add_u32 s27, s26, 247332864
  buffer_store_dwordx4 v[24:27], v8, s[4:7], s27 offen sc1
  s_add_u32 s27, s26, 247463936
  buffer_store_dwordx4 v[24:27], v8, s[4:7], s27 offen sc1
  s_add_u32 s27, s26, 247595008
  buffer_store_dwordx4 v[24:27], v8, s[4:7], s27 offen sc1
  s_add_u32 s27, s26, 247726080
  buffer_store_dwordx4 v[24:27], v8, s[4:7], s27 offen sc1
  s_add_u32 s27, s26, 247857152
  buffer_store_dwordx4 v[24:27], v8, s[4:7], s27 offen sc1
  s_add_u32 s27, s26, 247988224
  buffer_store_dwordx4 v[24:27], v8, s[4:7], s27 offen sc1
  s_add_u32 s27, s26, 248119296
  buffer_store_dwordx4 v[24:27], v8, s[4:7], s27 offen sc1
  s_add_u32 s27, s26, 248250368
  buffer_store_dwordx4 v[24:27], v8, s[4:7], s27 offen sc1
  s_add_u32 s27, s26, 248381440
  buffer_store_dwordx4 v[24:27], v8, s[4:7], s27 offen sc1
  s_add_u32 s27, s26, 248512512
  buffer_store_dwordx4 v[24:27], v8, s[4:7], s27 offen sc1
  s_add_u32 s27, s26, 248643584
  buffer_store_dwordx4 v[24:27], v8, s[4:7], s27 offen sc1
  s_add_u32 s27, s26, 16777216
  buffer_store_dwordx4 v[28:31], v8, s[4:7], s27 offen sc1
  s_add_u32 s27, s26, 16908288
  buffer_store_dwordx4 v[28:31], v8, s[4:7], s27 offen sc1
  s_add_u32 s27, s26, 17039360
  buffer_store_dwordx4 v[28:31], v8, s[4:7], s27 offen sc1
  s_add_u32 s27, s26, 17170432
  buffer_store_dwordx4 v[28:31], v8, s[4:7], s27 offen sc1
  s_add_u32 s27, s26, 17301504
  buffer_store_dwordx4 v[28:31], v8, s[4:7], s27 offen sc1
  s_add_u32 s27, s26, 17432576
  buffer_store_dwordx4 v[28:31], v8, s[4:7], s27 offen sc1
  s_add_u32 s27, s26, 17563648
  buffer_store_dwordx4 v[28:31], v8, s[4:7], s27 offen sc1
  s_add_u32 s27, s26, 17694720
  buffer_store_dwordx4 v[28:31], v8, s[4:7], s27 offen sc1
  s_add_u32 s27, s26, 17825792
  buffer_store_dwordx4 v[28:31], v8, s[4:7], s27 offen sc1
  s_add_u32 s27, s26, 17956864
  buffer_store_dwordx4 v[28:31], v8, s[4:7], s27 offen sc1
  s_add_u32 s27, s26, 18087936
  buffer_store_dwordx4 v[28:31], v8, s[4:7], s27 offen sc1
  s_add_u32 s27, s26, 18219008
  buffer_store_dwordx4 v[28:31], v8, s[4:7], s27 offen sc1
  s_add_u32 s27, s26, 18350080
  buffer_store_dwordx4 v[28:31], v8, s[4:7], s27 offen sc1
  s_add_u32 s27, s26, 18481152
  buffer_store_dwordx4 v[28:31], v8, s[4:7], s27 offen sc1
  s_add_u32 s27, s26, 18612224
  buffer_store_dwordx4 v[28:31], v8, s[4:7], s27 offen sc1
  s_add_u32 s27, s26, 18743296
  buffer_store_dwordx4 v[28:31], v8, s[4:7], s27 offen sc1
L_ch0:
  s_waitcnt vmcnt(0)
  s_barrier
  s_cmp_lg_u32 s17, 0
  s_cbranch_scc1 g_ar_1
  s_lshl_b32 s36, s89, 3
  s_lshl_b64 s[36:37], 1, s36
  v_lshlrev_b32 v124, 3, s91
  v_mov_b32 v120, s36
  v_mov_b32 v121, s37
  s_mov_b64 exec, 1
  global_atomic_add_x2 v[122:123], v124, v[120:121], s[12:13] sc0
  s_mov_b64 exec, -1
g_ar_1:
  s_waitcnt vmcnt(0)
  s_cmp_lg_u32 s17, 0
  s_cbranch_scc1 g_af_2
  v_readfirstlane_b32 s36, v122
  v_readfirstlane_b32 s37, v123
  s_add_u32 s38, s36, s37
  s_mul_i32 s38, s38, 0x01010101
  s_lshr_b32 s38, s38, 24
  s_cmp_lg_u32 s38, 31
  s_cbranch_scc1 g_af_2
  s_lshl_b32 s38, s89, 3
  s_lshr_b64 s[36:37], s[36:37], s38
  s_and_b32 s36, s36, 0xff
  s_cmp_eq_u32 s36, 31
  s_cselect_b32 s36, 1, 2
  v_mov_b32 v120, s36
  v_lshrrev_b32 v124, 1, v124
  s_mov_b64 exec, 1
  global_store_dword v124, v120, s[12:13] offset:128 sc1
  s_mov_b64 exec, -1
g_af_2:
L_ch1:
  s_mov_b32 s58, 8192
  s_mov_b32 s59, 0x20000
  v_and_b32 v21, 1, v7
  v_lshl_add_u32 v21, v17, 1, v21
  v_lshlrev_b32 v21, 10, v21
  v_bfe_u32 v22, v7, 1, 2
  v_lshl_add_u32 v21, v22, 1, v21
  s_lshr_b32 s27, s16, 3
  s_lshl_b32 s27, s27, 8
  s_and_b32 s28, s16, 3
  s_lshl_b32 s28, s28, 6
  s_add_u32 s27, s27, s28
  s_and_b32 s28, s16, 4
  s_lshl_b32 s28, s28, 1
  s_add_u32 s27, s27, s28
  s_waitcnt lgkmcnt(0)
  buffer_load_ushort v28, v21, s[56:59], s27 offen offset:0
  buffer_load_ushort v29, v21, s[56:59], s27 offen offset:16
  buffer_load_ushort v30, v21, s[56:59], s27 offen offset:32
  buffer_load_ushort v31, v21, s[56:59], s27 offen offset:48
  s_cmp_eq_u32 s91, 0
  s_cbranch_scc1 L_ha
  v_mbcnt_lo_u32_b32 v116, -1, 0
  v_and_b32 v116, 0, v116
  v_add_lshl_u32 v116, v116, 1, 2
  s_mov_b32 s26, 0
g_wt_3:
  global_load_dword v117, v116, s[12:13] offset:128 sc1
  s_add_u32 s26, s26, 1
  s_cmp_gt_u32 s26, 1048576
  s_cbranch_scc1 L_end
  s_waitcnt vmcnt(0)
  v_cmp_eq_u32 vcc, 0, v117
  v_readfirstlane_b32 s27, v117
  s_cbranch_vccnz g_wt_3
  s_and_b32 s28, s16, 28
  s_or_b32 s28, s28, 1
  s_lshl_b32 s27, s28, 6
  s_add_u32 s27, s27, 245104640
  s_mov_b32 s26, 0
g_h_4:
  buffer_load_dwordx2 v[116:117], off, s[4:7], s27 sc1
  s_add_u32 s26, s26, 1
  s_cmp_gt_u32 s26, 1048576
  s_cbranch_scc1 L_end
  s_waitcnt vmcnt(0)
  v_and_or_b32 v116, v117, -1, v116
  v_cmp_eq_u32 vcc, 0, v116
  s_cbranch_vccnz g_h_4
L_ha:
  s_load_dwordx2 s[8:9], s[0:1], 40
  s_load_dwordx2 s[52:53], s[0:1], 16
  s_load_dwordx2 s[32:33], s[0:1], 24
  s_load_dwordx2 s[48:49], s[0:1], 32
  s_mov_b32 s10, 4194304
  s_mov_b32 s11, 0x20000
  s_mov_b32 s54, 4194304
  s_mov_b32 s55, 0x20000
  s_mov_b32 s34, 4194304
  s_mov_b32 s35, 0x20000
  s_mov_b32 s50, 4194304
  s_mov_b32 s51, 0x20000
  v_and_b32 v20, 1, v17
  v_lshlrev_b32 v20, 5, v20
  v_lshrrev_b32 v21, 1, v17
  v_lshl_add_u32 v20, v21, 2, v20
  v_lshlrev_b32 v20, 10, v20
  v_lshl_add_u32 v20, v7, 4, v20
  s_lshl_b32 s26, s16, 17
  s_lshl_b32 s27, s17, 8
  s_add_u32 s26, s26, s27
  s_waitcnt lgkmcnt(0)
  s_add_u32 s27, s26, 0
  buffer_load_dwordx4 v[128:131], v20, s[8:11], s27 offen
  s_add_u32 s27, s26, 1024
  buffer_load_dwordx4 v[132:135], v20, s[8:11], s27 offen
  s_add_u32 s27, s26, 16384
  buffer_load_dwordx4 v[136:139], v20, s[8:11], s27 offen
  s_add_u32 s27, s26, 17408
  buffer_load_dwordx4 v[140:143], v20, s[8:11], s27 offen
  s_add_u32 s27, s26, 2048
  buffer_load_dwordx4 v[144:147], v20, s[8:11], s27 offen
  s_add_u32 s27, s26, 3072
  buffer_load_dwordx4 v[148:151], v20, s[8:11], s27 offen
  s_add_u32 s27, s26, 18432
  buffer_load_dwordx4 v[152:155], v20, s[8:11], s27 offen
  s_add_u32 s27, s26, 19456
  buffer_load_dwordx4 v[156:159], v20, s[8:11], s27 offen
  s_add_u32 s27, s26, 8192
  buffer_load_dwordx4 v[160:163], v20, s[8:11], s27 offen
  s_add_u32 s27, s26, 9216
  buffer_load_dwordx4 v[164:167], v20, s[8:11], s27 offen
  s_add_u32 s27, s26, 24576
  buffer_load_dwordx4 v[168:171], v20, s[8:11], s27 offen
  s_add_u32 s27, s26, 25600
  buffer_load_dwordx4 v[172:175], v20, s[8:11], s27 offen
  s_add_u32 s27, s26, 10240
  buffer_load_dwordx4 v[176:179], v20, s[8:11], s27 offen
  s_add_u32 s27, s26, 11264
  buffer_load_dwordx4 v[180:183], v20, s[8:11], s27 offen
  s_add_u32 s27, s26, 26624
  buffer_load_dwordx4 v[184:187], v20, s[8:11], s27 offen
  s_add_u32 s27, s26, 27648
  buffer_load_dwordx4 v[188:191], v20, s[8:11], s27 offen
  s_add_u32 s27, s26, 65536
  buffer_load_dwordx4 v[192:195], v20, s[8:11], s27 offen
  s_add_u32 s27, s26, 66560
  buffer_load_dwordx4 v[196:199], v20, s[8:11], s27 offen
  s_add_u32 s27, s26, 81920
  buffer_load_dwordx4 v[200:203], v20, s[8:11], s27 offen
  s_add_u32 s27, s26, 82944
  buffer_load_dwordx4 v[204:207], v20, s[8:11], s27 offen
  s_add_u32 s27, s26, 67584
  buffer_load_dwordx4 v[208:211], v20, s[8:11], s27 offen
  s_add_u32 s27, s26, 68608
  buffer_load_dwordx4 v[212:215], v20, s[8:11], s27 offen
  s_add_u32 s27, s26, 83968
  buffer_load_dwordx4 v[216:219], v20, s[8:11], s27 offen
  s_add_u32 s27, s26, 84992
  buffer_load_dwordx4 v[220:223], v20, s[8:11], s27 offen
  s_add_u32 s27, s26, 73728
  buffer_load_dwordx4 v[224:227], v20, s[8:11], s27 offen
  s_add_u32 s27, s26, 74752
  buffer_load_dwordx4 v[228:231], v20, s[8:11], s27 offen
  s_add_u32 s27, s26, 90112
  buffer_load_dwordx4 v[232:235], v20, s[8:11], s27 offen
  s_add_u32 s27, s26, 91136
  buffer_load_dwordx4 v[236:239], v20, s[8:11], s27 offen
  s_add_u32 s27, s26, 75776
  buffer_load_dwordx4 v[240:243], v20, s[8:11], s27 offen
  s_add_u32 s27, s26, 76800
  buffer_load_dwordx4 v[244:247], v20, s[8:11], s27 offen
  s_add_u32 s27, s26, 92160
  buffer_load_dwordx4 v[248:251], v20, s[8:11], s27 offen
  s_add_u32 s27, s26, 93184
  buffer_load_dwordx4 v[252:255], v20, s[8:11], s27 offen
  v_lshrrev_b32 v20, 8, v0
  v_and_b32 v22, 0xf0, v0
  v_lshlrev_b32 v23, 6, v20
  v_xor_b32 v22, v22, v23
  v_lshl_add_u32 v22, v20, 13, v22
  v_xor_b32 v23, 32, v22
  s_lshr_b32 s26, s17, 1
  s_lshl_b32 s26, s26, 20
  s_and_b32 s27, s17, 1
  s_lshl_b32 s27, s27, 18
  s_add_u32 s26, s26, s27
  s_lshl_b32 s27, s16, 8
  s_add_u32 s26, s26, s27
  s_lshl_b32 s28, s17, 13
  s_add_u32 s27, s26, 0
  s_add_u32 m0, s28, 65536
  s_nop 0
  buffer_load_dwordx4 v22, s[32:35], s27 offen lds
  s_add_u32 m0, s28, 66560
  s_add_u32 s27, s27, 32768
  buffer_load_dwordx4 v22, s[32:35], s27 offen lds
  s_add_u32 m0, s28, 67584
  s_add_u32 s27, s27, 32768
  buffer_load_dwordx4 v23, s[32:35], s27 offen lds
  s_add_u32 m0, s28, 68608
  s_add_u32 s27, s27, 32768
  buffer_load_dwordx4 v23, s[32:35], s27 offen lds
  s_add_u32 m0, s28, 69632
  s_add_u32 s27, s27, 32768
  buffer_load_dwordx4 v22, s[32:35], s27 offen lds
  s_add_u32 m0, s28, 70656
  s_add_u32 s27, s27, 32768
  buffer_load_dwordx4 v22, s[32:35], s27 offen lds
  s_add_u32 m0, s28, 71680
  s_add_u32 s27, s27, 32768
  buffer_load_dwordx4 v23, s[32:35], s27 offen lds
  s_add_u32 m0, s28, 72704
  s_add_u32 s27, s27, 32768
  buffer_load_dwordx4 v23, s[32:35], s27 offen lds
  s_add_u32 s27, s26, 524288
  s_add_u32 m0, s28, 98304
  s_nop 0
  buffer_load_dwordx4 v22, s[32:35], s27 offen lds
  s_add_u32 m0, s28, 99328
  s_add_u32 s27, s27, 32768
  buffer_load_dwordx4 v22, s[32:35], s27 offen lds
  s_add_u32 m0, s28, 100352
  s_add_u32 s27, s27, 32768
  buffer_load_dwordx4 v23, s[32:35], s27 offen lds
  s_add_u32 m0, s28, 101376
  s_add_u32 s27, s27, 32768
  buffer_load_dwordx4 v23, s[32:35], s27 offen lds
  s_add_u32 m0, s28, 102400
  s_add_u32 s27, s27, 32768
  buffer_load_dwordx4 v22, s[32:35], s27 offen lds
  s_add_u32 m0, s28, 103424
  s_add_u32 s27, s27, 32768
  buffer_load_dwordx4 v22, s[32:35], s27 offen lds
  s_add_u32 m0, s28, 104448
  s_add_u32 s27, s27, 32768
  buffer_load_dwordx4 v23, s[32:35], s27 offen lds
  s_add_u32 m0, s28, 105472
  s_add_u32 s27, s27, 32768
  buffer_load_dwordx4 v23, s[32:35], s27 offen lds
  s_waitcnt vmcnt(48)
  v_lshl_or_b32 v28, v29, 16, v28
  v_lshl_or_b32 v29, v31, 16, v30
  v_min_u32 v28, -2, v28
  v_min_u32 v29, -2, v29
  buffer_store_dwordx2 v[28:29], v5, s[4:7], s62 offen sc1
  s_add_u32 s27, s26, 2097152
  s_add_u32 m0, s28, 131072
  s_nop 0
  buffer_load_dwordx4 v22, s[32:35], s27 offen lds
  s_add_u32 m0, s28, 132096
  s_add_u32 s27, s27, 32768
  buffer_load_dwordx4 v22, s[32:35], s27 offen lds
  s_add_u32 m0, s28, 133120
  s_add_u32 s27, s27, 32768
  buffer_load_dwordx4 v23, s[32:35], s27 offen lds
  s_add_u32 m0, s28, 134144
  s_add_u32 s27, s27, 32768
  buffer_load_dwordx4 v23, s[32:35], s27 offen lds
  s_add_u32 m0, s28, 135168
  s_add_u32 s27, s27, 32768
  buffer_load_dwordx4 v22, s[32:35], s27 offen lds
  s_add_u32 m0, s28, 136192
  s_add_u32 s27, s27, 32768
  buffer_load_dwordx4 v22, s[32:35], s27 offen lds
  s_add_u32 m0, s28, 137216
  s_add_u32 s27, s27, 32768
  buffer_load_dwordx4 v23, s[32:35], s27 offen lds
  s_add_u32 m0, s28, 138240
  s_add_u32 s27, s27, 32768
  buffer_load_dwordx4 v23, s[32:35], s27 offen lds
  v_bfe_u32 v20, v7, 2, 1
  v_lshrrev_b32 v21, 3, v7
  v_and_b32 v104, 1, v17
  v_lshl_add_u32 v21, v21, 1, v104
  v_lshl_add_u32 v104, v20, 3, v21
  v_lshrrev_b32 v105, 1, v17
  v_lshl_add_u32 v104, v105, 5, v104
  v_lshl_add_u32 v20, v21, 1, v20
  s_lshl_b32 s29, s17, 1
  v_xor_b32 v20, s29, v20
  v_lshlrev_b32 v20, 5, v20
  v_lshl_add_u32 v20, v104, 8, v20
  v_and_b32 v21, 3, v7
  v_lshl_add_u32 v20, v21, 3, v20
  s_lshr_b32 s29, s17, 1
  s_lshl_b32 s29, s29, 14
  s_and_b32 s30, s17, 1
  s_lshl_b32 s30, s30, 10
  s_add_u32 s29, s29, s30
  s_add_u32 s29, s29, 65536
  v_add_u32 v20, s29, v20
  v_xor_b32 v104, 0, v20
  v_xor_b32 v105, 32, v20
  v_xor_b32 v106, 1024, v20
  v_xor_b32 v107, 1056, v20
  v_xor_b32 v108, 16384, v20
  v_xor_b32 v109, 16416, v20
  v_xor_b32 v110, 17408, v20
  v_xor_b32 v111, 17440, v20
  s_waitcnt vmcnt(49)
  v_perm_b32 v120, v132, v128, s44
  v_perm_b32 v121, v140, v136, s44
  v_perm_b32 v122, v148, v144, s44
  v_perm_b32 v123, v156, v152, s44
  v_accvgpr_write_b32 a248, v120
  v_accvgpr_write_b32 a249, v121
  v_accvgpr_write_b32 a250, v122
  v_accvgpr_write_b32 a251, v123
  v_perm_b32 v124, v132, v128, s45
  v_perm_b32 v125, v140, v136, s45
  v_perm_b32 v126, v148, v144, s45
  v_perm_b32 v127, v156, v152, s45
  v_accvgpr_write_b32 a232, v124
  v_accvgpr_write_b32 a233, v125
  v_accvgpr_write_b32 a234, v126
  v_accvgpr_write_b32 a235, v127
  v_perm_b32 v120, v133, v129, s44
  v_perm_b32 v121, v141, v137, s44
  v_perm_b32 v122, v149, v145, s44
  v_perm_b32 v123, v157, v153, s44
  v_accvgpr_write_b32 a216, v120
  v_accvgpr_write_b32 a217, v121
  v_accvgpr_write_b32 a218, v122
  v_accvgpr_write_b32 a219, v123
  v_perm_b32 v124, v133, v129, s45
  v_perm_b32 v125, v141, v137, s45
  v_perm_b32 v126, v149, v145, s45
  v_perm_b32 v127, v157, v153, s45
  v_accvgpr_write_b32 a200, v124
  v_accvgpr_write_b32 a201, v125
  v_accvgpr_write_b32 a202, v126
  v_accvgpr_write_b32 a203, v127
  v_perm_b32 v120, v134, v130, s44
  v_perm_b32 v121, v142, v138, s44
  v_perm_b32 v122, v150, v146, s44
  v_perm_b32 v123, v158, v154, s44
  v_accvgpr_write_b32 a184, v120
  v_accvgpr_write_b32 a185, v121
  v_accvgpr_write_b32 a186, v122
  v_accvgpr_write_b32 a187, v123
  v_perm_b32 v24, v134, v130, s45
  v_perm_b32 v25, v142, v138, s45
  v_perm_b32 v26, v150, v146, s45
  v_perm_b32 v27, v158, v154, s45
  v_perm_b32 v40, v135, v131, s44
  v_perm_b32 v41, v143, v139, s44
  v_perm_b32 v42, v151, v147, s44
  v_perm_b32 v43, v159, v155, s44
  v_perm_b32 v56, v135, v131, s45
  v_perm_b32 v57, v143, v139, s45
  v_perm_b32 v58, v151, v147, s45
  v_perm_b32 v59, v159, v155, s45
  s_waitcnt vmcnt(41)
  v_perm_b32 v120, v164, v160, s44
  v_perm_b32 v121, v172, v168, s44
  v_perm_b32 v122, v180, v176, s44
  v_perm_b32 v123, v188, v184, s44
  v_accvgpr_write_b32 a252, v120
  v_accvgpr_write_b32 a253, v121
  v_accvgpr_write_b32 a254, v122
  v_accvgpr_write_b32 a255, v123
  v_perm_b32 v124, v164, v160, s45
  v_perm_b32 v125, v172, v168, s45
  v_perm_b32 v126, v180, v176, s45
  v_perm_b32 v127, v188, v184, s45
  v_accvgpr_write_b32 a236, v124
  v_accvgpr_write_b32 a237, v125
  v_accvgpr_write_b32 a238, v126
  v_accvgpr_write_b32 a239, v127
  v_perm_b32 v120, v165, v161, s44
  v_perm_b32 v121, v173, v169, s44
  v_perm_b32 v122, v181, v177, s44
  v_perm_b32 v123, v189, v185, s44
  v_accvgpr_write_b32 a220, v120
  v_accvgpr_write_b32 a221, v121
  v_accvgpr_write_b32 a222, v122
  v_accvgpr_write_b32 a223, v123
  v_perm_b32 v124, v165, v161, s45
  v_perm_b32 v125, v173, v169, s45
  v_perm_b32 v126, v181, v177, s45
  v_perm_b32 v127, v189, v185, s45
  v_accvgpr_write_b32 a204, v124
  v_accvgpr_write_b32 a205, v125
  v_accvgpr_write_b32 a206, v126
  v_accvgpr_write_b32 a207, v127
  v_perm_b32 v120, v166, v162, s44
  v_perm_b32 v121, v174, v170, s44
  v_perm_b32 v122, v182, v178, s44
  v_perm_b32 v123, v190, v186, s44
  v_accvgpr_write_b32 a188, v120
  v_accvgpr_write_b32 a189, v121
  v_accvgpr_write_b32 a190, v122
  v_accvgpr_write_b32 a191, v123
  v_perm_b32 v28, v166, v162, s45
  v_perm_b32 v29, v174, v170, s45
  v_perm_b32 v30, v182, v178, s45
  v_perm_b32 v31, v190, v186, s45
  v_perm_b32 v44, v167, v163, s44
  v_perm_b32 v45, v175, v171, s44
  v_perm_b32 v46, v183, v179, s44
  v_perm_b32 v47, v191, v187, s44
  v_perm_b32 v60, v167, v163, s45
  v_perm_b32 v61, v175, v171, s45
  v_perm_b32 v62, v183, v179, s45
  v_perm_b32 v63, v191, v187, s45
  s_waitcnt vmcnt(33)
  v_perm_b32 v120, v196, v192, s44
  v_perm_b32 v121, v204, v200, s44
  v_perm_b32 v122, v212, v208, s44
  v_perm_b32 v123, v220, v216, s44
  v_accvgpr_write_b32 a240, v120
  v_accvgpr_write_b32 a241, v121
  v_accvgpr_write_b32 a242, v122
  v_accvgpr_write_b32 a243, v123
  v_perm_b32 v124, v196, v192, s45
  v_perm_b32 v125, v204, v200, s45
  v_perm_b32 v126, v212, v208, s45
  v_perm_b32 v127, v220, v216, s45
  v_accvgpr_write_b32 a224, v124
  v_accvgpr_write_b32 a225, v125
  v_accvgpr_write_b32 a226, v126
  v_accvgpr_write_b32 a227, v127
  v_perm_b32 v120, v197, v193, s44
  v_perm_b32 v121, v205, v201, s44
  v_perm_b32 v122, v213, v209, s44
  v_perm_b32 v123, v221, v217, s44
  v_accvgpr_write_b32 a208, v120
  v_accvgpr_write_b32 a209, v121
  v_accvgpr_write_b32 a210, v122
  v_accvgpr_write_b32 a211, v123
  v_perm_b32 v124, v197, v193, s45
  v_perm_b32 v125, v205, v201, s45
  v_perm_b32 v126, v213, v209, s45
  v_perm_b32 v127, v221, v217, s45
  v_accvgpr_write_b32 a192, v124
  v_accvgpr_write_b32 a193, v125
  v_accvgpr_write_b32 a194, v126
  v_accvgpr_write_b32 a195, v127
  v_perm_b32 v120, v198, v194, s44
  v_perm_b32 v121, v206, v202, s44
  v_perm_b32 v122, v214, v210, s44
  v_perm_b32 v123, v222, v218, s44
  v_accvgpr_write_b32 a176, v120
  v_accvgpr_write_b32 a177, v121
  v_accvgpr_write_b32 a178, v122
  v_accvgpr_write_b32 a179, v123
  v_perm_b32 v32, v198, v194, s45
  v_perm_b32 v33, v206, v202, s45
  v_perm_b32 v34, v214, v210, s45
  v_perm_b32 v35, v222, v218, s45
  v_perm_b32 v48, v199, v195, s44
  v_perm_b32 v49, v207, v203, s44
  v_perm_b32 v50, v215, v211, s44
  v_perm_b32 v51, v223, v219, s44
  v_perm_b32 v64, v199, v195, s45
  v_perm_b32 v65, v207, v203, s45
  v_perm_b32 v66, v215, v211, s45
  v_perm_b32 v67, v223, v219, s45
  s_waitcnt vmcnt(25)
  v_perm_b32 v120, v228, v224, s44
  v_perm_b32 v121, v236, v232, s44
  v_perm_b32 v122, v244, v240, s44
  v_perm_b32 v123, v252, v248, s44
  v_accvgpr_write_b32 a244, v120
  v_accvgpr_write_b32 a245, v121
  v_accvgpr_write_b32 a246, v122
  v_accvgpr_write_b32 a247, v123
  v_perm_b32 v124, v228, v224, s45
  v_perm_b32 v125, v236, v232, s45
  v_perm_b32 v126, v244, v240, s45
  v_perm_b32 v127, v252, v248, s45
  v_accvgpr_write_b32 a228, v124
  v_accvgpr_write_b32 a229, v125
  v_accvgpr_write_b32 a230, v126
  v_accvgpr_write_b32 a231, v127
  v_perm_b32 v120, v229, v225, s44
  v_perm_b32 v121, v237, v233, s44
  v_perm_b32 v122, v245, v241, s44
  v_perm_b32 v123, v253, v249, s44
  v_accvgpr_write_b32 a212, v120
  v_accvgpr_write_b32 a213, v121
  v_accvgpr_write_b32 a214, v122
  v_accvgpr_write_b32 a215, v123
  v_perm_b32 v124, v229, v225, s45
  v_perm_b32 v125, v237, v233, s45
  v_perm_b32 v126, v245, v241, s45
  v_perm_b32 v127, v253, v249, s45
  v_accvgpr_write_b32 a196, v124
  v_accvgpr_write_b32 a197, v125
  v_accvgpr_write_b32 a198, v126
  v_accvgpr_write_b32 a199, v127
  v_perm_b32 v120, v230, v226, s44
  v_perm_b32 v121, v238, v234, s44
  v_perm_b32 v122, v246, v242, s44
  v_perm_b32 v123, v254, v250, s44
  v_accvgpr_write_b32 a180, v120
  v_accvgpr_write_b32 a181, v121
  v_accvgpr_write_b32 a182, v122
  v_accvgpr_write_b32 a183, v123
  v_perm_b32 v36, v230, v226, s45
  v_perm_b32 v37, v238, v234, s45
  v_perm_b32 v38, v246, v242, s45
  v_perm_b32 v39, v254, v250, s45
  v_perm_b32 v52, v231, v227, s44
  v_perm_b32 v53, v239, v235, s44
  v_perm_b32 v54, v247, v243, s44
  v_perm_b32 v55, v255, v251, s44
  v_perm_b32 v68, v231, v227, s45
  v_perm_b32 v69, v239, v235, s45
  v_perm_b32 v70, v247, v243, s45
  v_perm_b32 v71, v255, v251, s45
  v_mov_b64 v[128:129], v[24:25]
  v_mov_b64 v[130:131], v[26:27]
  v_mov_b64 v[132:133], v[28:29]
  v_mov_b64 v[134:135], v[30:31]
  v_mov_b64 v[136:137], v[32:33]
  v_mov_b64 v[138:139], v[34:35]
  v_mov_b64 v[140:141], v[36:37]
  v_mov_b64 v[142:143], v[38:39]
  v_mov_b64 v[144:145], v[40:41]
  v_mov_b64 v[146:147], v[42:43]
  v_mov_b64 v[148:149], v[44:45]
  v_mov_b64 v[150:151], v[46:47]
  v_mov_b64 v[152:153], v[48:49]
  v_mov_b64 v[154:155], v[50:51]
  v_mov_b64 v[156:157], v[52:53]
  v_mov_b64 v[158:159], v[54:55]
  v_mov_b64 v[184:185], v[56:57]
  v_mov_b64 v[186:187], v[58:59]
  v_mov_b64 v[188:189], v[60:61]
  v_mov_b64 v[190:191], v[62:63]
  v_mov_b64 v[192:193], v[64:65]
  v_mov_b64 v[194:195], v[66:67]
  v_mov_b64 v[196:197], v[68:69]
  v_mov_b64 v[198:199], v[70:71]
  s_waitcnt vmcnt(17)
  s_barrier
  s_add_u32 s27, s26, 2621440
  s_add_u32 m0, s28, 0
  s_nop 0
  buffer_load_dwordx4 v22, s[32:35], s27 offen lds
  s_add_u32 m0, s28, 1024
  s_add_u32 s27, s27, 32768
  buffer_load_dwordx4 v22, s[32:35], s27 offen lds
  s_add_u32 m0, s28, 2048
  s_add_u32 s27, s27, 32768
  buffer_load_dwordx4 v23, s[32:35], s27 offen lds
  s_add_u32 m0, s28, 3072
  s_add_u32 s27, s27, 32768
  buffer_load_dwordx4 v23, s[32:35], s27 offen lds
  s_add_u32 m0, s28, 4096
  s_add_u32 s27, s27, 32768
  buffer_load_dwordx4 v22, s[32:35], s27 offen lds
  s_add_u32 m0, s28, 5120
  s_add_u32 s27, s27, 32768
  buffer_load_dwordx4 v22, s[32:35], s27 offen lds
  s_add_u32 m0, s28, 6144
  s_add_u32 s27, s27, 32768
  buffer_load_dwordx4 v23, s[32:35], s27 offen lds
  s_add_u32 m0, s28, 7168
  s_add_u32 s27, s27, 32768
  buffer_load_dwordx4 v23, s[32:35], s27 offen lds
  s_cmp_lg_u32 s91, 0
  s_cbranch_scc1 g_o0_5
  s_cmp_lg_u32 s17, 0
  s_cbranch_scc1 g_ar_6
  s_lshl_b32 s36, s89, 3
  s_lshl_b64 s[36:37], 1, s36
  v_lshlrev_b32 v124, 3, 0
  v_mov_b32 v120, s36
  v_mov_b32 v121, s37
  s_mov_b64 exec, 1
  global_atomic_add_x2 v[122:123], v124, v[120:121], s[12:13] sc0
  s_mov_b64 exec, -1
g_ar_6:
g_o0_5:
  ds_read_b64_tr_b16 v[40:41], v104 offset:0
  ds_read_b64_tr_b16 v[42:43], v104 offset:4096
  ds_read_b64_tr_b16 v[48:49], v105 offset:0
  ds_read_b64_tr_b16 v[50:51], v105 offset:4096
  ds_read_b64_tr_b16 a[72:73], v106 offset:0
  ds_read_b64_tr_b16 a[74:75], v106 offset:4096
  ds_read_b64_tr_b16 a[24:25], v107 offset:0
  ds_read_b64_tr_b16 a[26:27], v107 offset:4096
  ds_read_b64_tr_b16 a[64:65], v108 offset:0
  ds_read_b64_tr_b16 a[66:67], v108 offset:4096
  ds_read_b64_tr_b16 a[16:17], v109 offset:0
  ds_read_b64_tr_b16 a[18:19], v109 offset:4096
  ds_read_b64_tr_b16 a[56:57], v110 offset:0
  ds_read_b64_tr_b16 a[58:59], v110 offset:4096
  ds_read_b64_tr_b16 a[8:9], v111 offset:0
  ds_read_b64_tr_b16 a[10:11], v111 offset:4096
  s_waitcnt lgkmcnt(0)
  s_waitcnt vmcnt(17)
  s_barrier
  s_add_u32 s27, s26, 0
  s_add_u32 m0, s28, 32768
  s_nop 0
  buffer_load_dwordx4 v22, s[52:55], s27 offen lds
  s_add_u32 m0, s28, 33792
  s_add_u32 s27, s27, 32768
  buffer_load_dwordx4 v22, s[52:55], s27 offen lds
  s_add_u32 m0, s28, 34816
  s_add_u32 s27, s27, 32768
  buffer_load_dwordx4 v23, s[52:55], s27 offen lds
  s_add_u32 m0, s28, 35840
  s_add_u32 s27, s27, 32768
  buffer_load_dwordx4 v23, s[52:55], s27 offen lds
  s_add_u32 m0, s28, 36864
  s_add_u32 s27, s27, 32768
  buffer_load_dwordx4 v22, s[52:55], s27 offen lds
  s_add_u32 m0, s28, 37888
  s_add_u32 s27, s27, 32768
  buffer_load_dwordx4 v22, s[52:55], s27 offen lds
  s_add_u32 m0, s28, 38912
  s_add_u32 s27, s27, 32768
  buffer_load_dwordx4 v23, s[52:55], s27 offen lds
  s_add_u32 m0, s28, 39936
  s_add_u32 s27, s27, 32768
  buffer_load_dwordx4 v23, s[52:55], s27 offen lds
  ds_read_b64_tr_b16 v[44:45], v104 offset:32768
  ds_read_b64_tr_b16 v[46:47], v104 offset:36864
  ds_read_b64_tr_b16 v[52:53], v105 offset:32768
  ds_read_b64_tr_b16 v[54:55], v105 offset:36864
  ds_read_b64_tr_b16 a[76:77], v106 offset:32768
  ds_read_b64_tr_b16 a[78:79], v106 offset:36864
  ds_read_b64_tr_b16 a[28:29], v107 offset:32768
  ds_read_b64_tr_b16 a[30:31], v107 offset:36864
  ds_read_b64_tr_b16 a[68:69], v108 offset:32768
  ds_read_b64_tr_b16 a[70:71], v108 offset:36864
  ds_read_b64_tr_b16 a[20:21], v109 offset:32768
  ds_read_b64_tr_b16 a[22:23], v109 offset:36864
  ds_read_b64_tr_b16 a[60:61], v110 offset:32768
  ds_read_b64_tr_b16 a[62:63], v110 offset:36864
  ds_read_b64_tr_b16 a[12:13], v111 offset:32768
  ds_read_b64_tr_b16 a[14:15], v111 offset:36864
  s_waitcnt lgkmcnt(0)
  v_add_u32 v104, 65536, v104
  v_add_u32 v105, 65536, v105
  v_add_u32 v106, 65536, v106
  v_add_u32 v107, 65536, v107
  v_add_u32 v108, 65536, v108
  v_add_u32 v109, 65536, v109
  v_add_u32 v110, 65536, v110
  v_add_u32 v111, 65536, v111
  s_waitcnt vmcnt(16)
  s_barrier
  s_add_u32 s27, s26, 524288
  s_add_u32 m0, s28, 65536
  s_nop 0
  buffer_load_dwordx4 v22, s[52:55], s27 offen lds
  s_add_u32 m0, s28, 66560
  s_add_u32 s27, s27, 32768
  buffer_load_dwordx4 v22, s[52:55], s27 offen lds
  s_add_u32 m0, s28, 67584
  s_add_u32 s27, s27, 32768
  buffer_load_dwordx4 v23, s[52:55], s27 offen lds
  s_add_u32 m0, s28, 68608
  s_add_u32 s27, s27, 32768
  buffer_load_dwordx4 v23, s[52:55], s27 offen lds
  s_add_u32 m0, s28, 69632
  s_add_u32 s27, s27, 32768
  buffer_load_dwordx4 v22, s[52:55], s27 offen lds
  s_add_u32 m0, s28, 70656
  s_add_u32 s27, s27, 32768
  buffer_load_dwordx4 v22, s[52:55], s27 offen lds
  s_add_u32 m0, s28, 71680
  s_add_u32 s27, s27, 32768
  buffer_load_dwordx4 v23, s[52:55], s27 offen lds
  s_add_u32 m0, s28, 72704
  s_add_u32 s27, s27, 32768
  buffer_load_dwordx4 v23, s[52:55], s27 offen lds
  ds_read_b64_tr_b16 v[72:73], v104 offset:0
  ds_read_b64_tr_b16 v[74:75], v104 offset:4096
  ds_read_b64_tr_b16 v[80:81], v105 offset:0
  ds_read_b64_tr_b16 v[82:83], v105 offset:4096
  ds_read_b64_tr_b16 a[48:49], v106 offset:0
  ds_read_b64_tr_b16 a[50:51], v106 offset:4096
  ds_read_b64_tr_b16 a[0:1], v107 offset:0
  ds_read_b64_tr_b16 a[2:3], v107 offset:4096
  ds_read_b64_tr_b16 a[40:41], v108 offset:0
  ds_read_b64_tr_b16 a[42:43], v108 offset:4096
  ds_read_b64_tr_b16 v[248:249], v109 offset:0
  ds_read_b64_tr_b16 v[250:251], v109 offset:4096
  ds_read_b64_tr_b16 a[32:33], v110 offset:0
  ds_read_b64_tr_b16 a[34:35], v110 offset:4096
  ds_read_b64_tr_b16 v[240:241], v111 offset:0
  ds_read_b64_tr_b16 v[242:243], v111 offset:4096
  s_waitcnt lgkmcnt(0)
  v_add_u32 v104, -131072, v104
  v_add_u32 v105, -131072, v105
  v_add_u32 v106, -131072, v106
  v_add_u32 v107, -131072, v107
  v_add_u32 v108, -131072, v108
  v_add_u32 v109, -131072, v109
  v_add_u32 v110, -131072, v110
  v_add_u32 v111, -131072, v111
  s_waitcnt vmcnt(16)
  s_barrier
  s_add_u32 s27, s26, 2097152
  s_add_u32 m0, s28, 98304
  s_nop 0
  buffer_load_dwordx4 v22, s[52:55], s27 offen lds
  s_add_u32 m0, s28, 99328
  s_add_u32 s27, s27, 32768
  buffer_load_dwordx4 v22, s[52:55], s27 offen lds
  s_add_u32 m0, s28, 100352
  s_add_u32 s27, s27, 32768
  buffer_load_dwordx4 v23, s[52:55], s27 offen lds
  s_add_u32 m0, s28, 101376
  s_add_u32 s27, s27, 32768
  buffer_load_dwordx4 v23, s[52:55], s27 offen lds
  s_add_u32 m0, s28, 102400
  s_add_u32 s27, s27, 32768
  buffer_load_dwordx4 v22, s[52:55], s27 offen lds
  s_add_u32 m0, s28, 103424
  s_add_u32 s27, s27, 32768
  buffer_load_dwordx4 v22, s[52:55], s27 offen lds
  s_add_u32 m0, s28, 104448
  s_add_u32 s27, s27, 32768
  buffer_load_dwordx4 v23, s[52:55], s27 offen lds
  s_add_u32 m0, s28, 105472
  s_add_u32 s27, s27, 32768
  buffer_load_dwordx4 v23, s[52:55], s27 offen lds
  ds_read_b64_tr_b16 v[76:77], v104 offset:0
  ds_read_b64_tr_b16 v[78:79], v104 offset:4096
  ds_read_b64_tr_b16 v[84:85], v105 offset:0
  ds_read_b64_tr_b16 v[86:87], v105 offset:4096
  ds_read_b64_tr_b16 a[52:53], v106 offset:0
  ds_read_b64_tr_b16 a[54:55], v106 offset:4096
  ds_read_b64_tr_b16 a[4:5], v107 offset:0
  ds_read_b64_tr_b16 a[6:7], v107 offset:4096
  ds_read_b64_tr_b16 a[44:45], v108 offset:0
  ds_read_b64_tr_b16 a[46:47], v108 offset:4096
  ds_read_b64_tr_b16 v[252:253], v109 offset:0
  ds_read_b64_tr_b16 v[254:255], v109 offset:4096
  ds_read_b64_tr_b16 a[36:37], v110 offset:0
  ds_read_b64_tr_b16 a[38:39], v110 offset:4096
  ds_read_b64_tr_b16 v[244:245], v111 offset:0
  ds_read_b64_tr_b16 v[246:247], v111 offset:4096
  s_waitcnt lgkmcnt(0)
  s_waitcnt vmcnt(16)
  s_barrier
  s_add_u32 s27, s26, 2621440
  s_add_u32 m0, s28, 131072
  s_nop 0
  buffer_load_dwordx4 v22, s[52:55], s27 offen lds
  s_add_u32 m0, s28, 132096
  s_add_u32 s27, s27, 32768
  buffer_load_dwordx4 v22, s[52:55], s27 offen lds
  s_add_u32 m0, s28, 133120
  s_add_u32 s27, s27, 32768
  buffer_load_dwordx4 v23, s[52:55], s27 offen lds
  s_add_u32 m0, s28, 134144
  s_add_u32 s27, s27, 32768
  buffer_load_dwordx4 v23, s[52:55], s27 offen lds
  s_add_u32 m0, s28, 135168
  s_add_u32 s27, s27, 32768
  buffer_load_dwordx4 v22, s[52:55], s27 offen lds
  s_add_u32 m0, s28, 136192
  s_add_u32 s27, s27, 32768
  buffer_load_dwordx4 v22, s[52:55], s27 offen lds
  s_add_u32 m0, s28, 137216
  s_add_u32 s27, s27, 32768
  buffer_load_dwordx4 v23, s[52:55], s27 offen lds
  s_add_u32 m0, s28, 138240
  s_add_u32 s27, s27, 32768
  buffer_load_dwordx4 v23, s[52:55], s27 offen lds
  s_cmp_lg_u32 s91, 0
  s_cbranch_scc1 g_o0_7
  s_cmp_lg_u32 s17, 0
  s_cbranch_scc1 g_af_8
  v_readfirstlane_b32 s36, v122
  v_readfirstlane_b32 s37, v123
  s_add_u32 s38, s36, s37
  s_mul_i32 s38, s38, 0x01010101
  s_lshr_b32 s38, s38, 24
  s_cmp_lg_u32 s38, 31
  s_cbranch_scc1 g_af_8
  s_lshl_b32 s38, s89, 3
  s_lshr_b64 s[36:37], s[36:37], s38
  s_and_b32 s36, s36, 0xff
  s_cmp_eq_u32 s36, 31
  s_cselect_b32 s36, 1, 2
  v_mov_b32 v120, s36
  v_lshrrev_b32 v124, 1, v124
  s_mov_b64 exec, 1
  global_store_dword v124, v120, s[12:13] offset:128 sc1
  s_mov_b64 exec, -1
g_af_8:
g_o0_7:
  ds_read_b64_tr_b16 v[24:25], v104 offset:32768
  ds_read_b64_tr_b16 v[26:27], v104 offset:36864
  ds_read_b64_tr_b16 v[32:33], v105 offset:32768
  ds_read_b64_tr_b16 v[34:35], v105 offset:36864
  ds_read_b64_tr_b16 a[168:169], v106 offset:32768
  ds_read_b64_tr_b16 a[170:171], v106 offset:36864
  ds_read_b64_tr_b16 a[120:121], v107 offset:32768
  ds_read_b64_tr_b16 a[122:123], v107 offset:36864
  ds_read_b64_tr_b16 a[160:161], v108 offset:32768
  ds_read_b64_tr_b16 a[162:163], v108 offset:36864
  ds_read_b64_tr_b16 a[112:113], v109 offset:32768
  ds_read_b64_tr_b16 a[114:115], v109 offset:36864
  ds_read_b64_tr_b16 a[152:153], v110 offset:32768
  ds_read_b64_tr_b16 a[154:155], v110 offset:36864
  ds_read_b64_tr_b16 a[104:105], v111 offset:32768
  ds_read_b64_tr_b16 a[106:107], v111 offset:36864
  s_waitcnt lgkmcnt(0)
  v_add_u32 v104, 65536, v104
  v_add_u32 v105, 65536, v105
  v_add_u32 v106, 65536, v106
  v_add_u32 v107, 65536, v107
  v_add_u32 v108, 65536, v108
  v_add_u32 v109, 65536, v109
  v_add_u32 v110, 65536, v110
  v_add_u32 v111, 65536, v111
  s_waitcnt vmcnt(16)
  s_barrier
  s_add_u32 s27, s26, 0
  s_add_u32 m0, s28, 0
  s_nop 0
  buffer_load_dwordx4 v22, s[48:51], s27 offen lds
  s_add_u32 m0, s28, 1024
  s_add_u32 s27, s27, 32768
  buffer_load_dwordx4 v22, s[48:51], s27 offen lds
  s_add_u32 m0, s28, 2048
  s_add_u32 s27, s27, 32768
  buffer_load_dwordx4 v23, s[48:51], s27 offen lds
  s_add_u32 m0, s28, 3072
  s_add_u32 s27, s27, 32768
  buffer_load_dwordx4 v23, s[48:51], s27 offen lds
  s_add_u32 m0, s28, 4096
  s_add_u32 s27, s27, 32768
  buffer_load_dwordx4 v22, s[48:51], s27 offen lds
  s_add_u32 m0, s28, 5120
  s_add_u32 s27, s27, 32768
  buffer_load_dwordx4 v22, s[48:51], s27 offen lds
  s_add_u32 m0, s28, 6144
  s_add_u32 s27, s27, 32768
  buffer_load_dwordx4 v23, s[48:51], s27 offen lds
  s_add_u32 m0, s28, 7168
  s_add_u32 s27, s27, 32768
  buffer_load_dwordx4 v23, s[48:51], s27 offen lds
  ds_read_b64_tr_b16 v[28:29], v104 offset:0
  ds_read_b64_tr_b16 v[30:31], v104 offset:4096
  ds_read_b64_tr_b16 v[36:37], v105 offset:0
  ds_read_b64_tr_b16 v[38:39], v105 offset:4096
  ds_read_b64_tr_b16 a[172:173], v106 offset:0
  ds_read_b64_tr_b16 a[174:175], v106 offset:4096
  ds_read_b64_tr_b16 a[124:125], v107 offset:0
  ds_read_b64_tr_b16 a[126:127], v107 offset:4096
  ds_read_b64_tr_b16 a[164:165], v108 offset:0
  ds_read_b64_tr_b16 a[166:167], v108 offset:4096
  ds_read_b64_tr_b16 a[116:117], v109 offset:0
  ds_read_b64_tr_b16 a[118:119], v109 offset:4096
  ds_read_b64_tr_b16 a[156:157], v110 offset:0
  ds_read_b64_tr_b16 a[158:159], v110 offset:4096
  ds_read_b64_tr_b16 a[108:109], v111 offset:0
  ds_read_b64_tr_b16 a[110:111], v111 offset:4096
  s_waitcnt lgkmcnt(0)
  s_waitcnt vmcnt(16)
  s_barrier
  s_add_u32 s27, s26, 524288
  s_add_u32 m0, s28, 32768
  s_nop 0
  buffer_load_dwordx4 v22, s[48:51], s27 offen lds
  s_add_u32 m0, s28, 33792
  s_add_u32 s27, s27, 32768
  buffer_load_dwordx4 v22, s[48:51], s27 offen lds
  s_add_u32 m0, s28, 34816
  s_add_u32 s27, s27, 32768
  buffer_load_dwordx4 v23, s[48:51], s27 offen lds
  s_add_u32 m0, s28, 35840
  s_add_u32 s27, s27, 32768
  buffer_load_dwordx4 v23, s[48:51], s27 offen lds
  s_add_u32 m0, s28, 36864
  s_add_u32 s27, s27, 32768
  buffer_load_dwordx4 v22, s[48:51], s27 offen lds
  s_add_u32 m0, s28, 37888
  s_add_u32 s27, s27, 32768
  buffer_load_dwordx4 v22, s[48:51], s27 offen lds
  s_add_u32 m0, s28, 38912
  s_add_u32 s27, s27, 32768
  buffer_load_dwordx4 v23, s[48:51], s27 offen lds
  s_add_u32 m0, s28, 39936
  s_add_u32 s27, s27, 32768
  buffer_load_dwordx4 v23, s[48:51], s27 offen lds
  v_mbcnt_lo_u32_b32 v116, -1, 0
  v_and_b32 v116, 1, v116
  v_lshlrev_b32 v118, 2, v116
  global_load_dword v117, v118, s[12:13] offset:128 sc1
  ds_read_b64_tr_b16 v[56:57], v104 offset:32768
  ds_read_b64_tr_b16 v[58:59], v104 offset:36864
  ds_read_b64_tr_b16 v[64:65], v105 offset:32768
  ds_read_b64_tr_b16 v[66:67], v105 offset:36864
  ds_read_b64_tr_b16 a[144:145], v106 offset:32768
  ds_read_b64_tr_b16 a[146:147], v106 offset:36864
  ds_read_b64_tr_b16 a[96:97], v107 offset:32768
  ds_read_b64_tr_b16 a[98:99], v107 offset:36864
  ds_read_b64_tr_b16 a[136:137], v108 offset:32768
  ds_read_b64_tr_b16 a[138:139], v108 offset:36864
  ds_read_b64_tr_b16 a[88:89], v109 offset:32768
  ds_read_b64_tr_b16 a[90:91], v109 offset:36864
  ds_read_b64_tr_b16 a[128:129], v110 offset:32768
  ds_read_b64_tr_b16 a[130:131], v110 offset:36864
  ds_read_b64_tr_b16 a[80:81], v111 offset:32768
  ds_read_b64_tr_b16 a[82:83], v111 offset:36864
  s_waitcnt lgkmcnt(0)
  v_add_u32 v104, 65536, v104
  v_add_u32 v105, 65536, v105
  v_add_u32 v106, 65536, v106
  v_add_u32 v107, 65536, v107
  v_add_u32 v108, 65536, v108
  v_add_u32 v109, 65536, v109
  v_add_u32 v110, 65536, v110
  v_add_u32 v111, 65536, v111
  s_waitcnt vmcnt(16)
  s_barrier
  s_add_u32 s27, s26, 2097152
  s_add_u32 m0, s28, 65536
  s_nop 0
  buffer_load_dwordx4 v22, s[48:51], s27 offen lds
  s_add_u32 m0, s28, 66560
  s_add_u32 s27, s27, 32768
  buffer_load_dwordx4 v22, s[48:51], s27 offen lds
  s_add_u32 m0, s28, 67584
  s_add_u32 s27, s27, 32768
  buffer_load_dwordx4 v23, s[48:51], s27 offen lds
  s_add_u32 m0, s28, 68608
  s_add_u32 s27, s27, 32768
  buffer_load_dwordx4 v23, s[48:51], s27 offen lds
  s_add_u32 m0, s28, 69632
  s_add_u32 s27, s27, 32768
  buffer_load_dwordx4 v22, s[48:51], s27 offen lds
  s_add_u32 m0, s28, 70656
  s_add_u32 s27, s27, 32768
  buffer_load_dwordx4 v22, s[48:51], s27 offen lds
  s_add_u32 m0, s28, 71680
  s_add_u32 s27, s27, 32768
  buffer_load_dwordx4 v23, s[48:51], s27 offen lds
  s_add_u32 m0, s28, 72704
  s_add_u32 s27, s27, 32768
  buffer_load_dwordx4 v23, s[48:51], s27 offen lds
  ds_read_b64_tr_b16 v[60:61], v104 offset:0
  ds_read_b64_tr_b16 v[62:63], v104 offset:4096
  ds_read_b64_tr_b16 v[68:69], v105 offset:0
  ds_read_b64_tr_b16 v[70:71], v105 offset:4096
  ds_read_b64_tr_b16 a[148:149], v106 offset:0
  ds_read_b64_tr_b16 a[150:151], v106 offset:4096
  ds_read_b64_tr_b16 a[100:101], v107 offset:0
  ds_read_b64_tr_b16 a[102:103], v107 offset:4096
  ds_read_b64_tr_b16 a[140:141], v108 offset:0
  ds_read_b64_tr_b16 a[142:143], v108 offset:4096
  ds_read_b64_tr_b16 a[92:93], v109 offset:0
  ds_read_b64_tr_b16 a[94:95], v109 offset:4096
  ds_read_b64_tr_b16 a[132:133], v110 offset:0
  ds_read_b64_tr_b16 a[134:135], v110 offset:4096
  ds_read_b64_tr_b16 a[84:85], v111 offset:0
  ds_read_b64_tr_b16 a[86:87], v111 offset:4096
  s_waitcnt lgkmcnt(0)
  v_add_u32 v104, -131072, v104
  v_add_u32 v105, -131072, v105
  v_add_u32 v106, -131072, v106
  v_add_u32 v107, -131072, v107
  v_add_u32 v108, -131072, v108
  v_add_u32 v109, -131072, v109
  v_add_u32 v110, -131072, v110
  v_add_u32 v111, -131072, v111
  s_waitcnt vmcnt(16)
  s_barrier
  s_add_u32 s27, s26, 2621440
  s_add_u32 m0, s28, 98304
  s_nop 0
  buffer_load_dwordx4 v22, s[48:51], s27 offen lds
  s_add_u32 m0, s28, 99328
  s_add_u32 s27, s27, 32768
  buffer_load_dwordx4 v22, s[48:51], s27 offen lds
  s_add_u32 m0, s28, 100352
  s_add_u32 s27, s27, 32768
  buffer_load_dwordx4 v23, s[48:51], s27 offen lds
  s_add_u32 m0, s28, 101376
  s_add_u32 s27, s27, 32768
  buffer_load_dwordx4 v23, s[48:51], s27 offen lds
  s_add_u32 m0, s28, 102400
  s_add_u32 s27, s27, 32768
  buffer_load_dwordx4 v22, s[48:51], s27 offen lds
  s_add_u32 m0, s28, 103424
  s_add_u32 s27, s27, 32768
  buffer_load_dwordx4 v22, s[48:51], s27 offen lds
  s_add_u32 m0, s28, 104448
  s_add_u32 s27, s27, 32768
  buffer_load_dwordx4 v23, s[48:51], s27 offen lds
  s_add_u32 m0, s28, 105472
  s_add_u32 s27, s27, 32768
  buffer_load_dwordx4 v23, s[48:51], s27 offen lds
  s_or_b32 s36, s91, s17
  s_cbranch_scc1 L_sig
  s_lshl_b32 s36, s16, 6
  s_add_u32 s36, s36, 245104644
  v_mov_b32 v120, 1
  s_mov_b64 exec, 1
  buffer_store_dword v120, off, s[4:7], s36 sc1
  s_mov_b64 exec, -1
L_sig:
  ds_read_b64_tr_b16 v[88:89], v104 offset:0
  ds_read_b64_tr_b16 v[90:91], v104 offset:4096
  ds_read_b64_tr_b16 v[96:97], v105 offset:0
  ds_read_b64_tr_b16 v[98:99], v105 offset:4096
  ds_read_b64_tr_b16 v[232:233], v106 offset:0
  ds_read_b64_tr_b16 v[234:235], v106 offset:4096
  ds_read_b64_tr_b16 v[176:177], v107 offset:0
  ds_read_b64_tr_b16 v[178:179], v107 offset:4096
  ds_read_b64_tr_b16 v[224:225], v108 offset:0
  ds_read_b64_tr_b16 v[226:227], v108 offset:4096
  ds_read_b64_tr_b16 v[168:169], v109 offset:0
  ds_read_b64_tr_b16 v[170:171], v109 offset:4096
  ds_read_b64_tr_b16 v[216:217], v110 offset:0
  ds_read_b64_tr_b16 v[218:219], v110 offset:4096
  ds_read_b64_tr_b16 v[160:161], v111 offset:0
  ds_read_b64_tr_b16 v[162:163], v111 offset:4096
  s_waitcnt lgkmcnt(0)
  s_waitcnt vmcnt(16)
  s_barrier
  ds_read_b64_tr_b16 v[92:93], v104 offset:32768
  ds_read_b64_tr_b16 v[94:95], v104 offset:36864
  ds_read_b64_tr_b16 v[100:101], v105 offset:32768
  ds_read_b64_tr_b16 v[102:103], v105 offset:36864
  ds_read_b64_tr_b16 v[236:237], v106 offset:32768
  ds_read_b64_tr_b16 v[238:239], v106 offset:36864
  ds_read_b64_tr_b16 v[180:181], v107 offset:32768
  ds_read_b64_tr_b16 v[182:183], v107 offset:36864
  ds_read_b64_tr_b16 v[228:229], v108 offset:32768
  ds_read_b64_tr_b16 v[230:231], v108 offset:36864
  ds_read_b64_tr_b16 v[172:173], v109 offset:32768
  ds_read_b64_tr_b16 v[174:175], v109 offset:36864
  ds_read_b64_tr_b16 v[220:221], v110 offset:32768
  ds_read_b64_tr_b16 v[222:223], v110 offset:36864
  ds_read_b64_tr_b16 v[164:165], v111 offset:32768
  ds_read_b64_tr_b16 v[166:167], v111 offset:36864
  s_waitcnt lgkmcnt(0)
  s_barrier
  v_add_u32 v104, 65536, v104
  v_add_u32 v105, 65536, v105
  v_add_u32 v106, 65536, v106
  v_add_u32 v107, 65536, v107
  v_add_u32 v108, 65536, v108
  v_add_u32 v109, 65536, v109
  v_add_u32 v110, 65536, v110
  v_add_u32 v111, 65536, v111
  ds_write_b128 v8, v[128:131] offset:16384
  ds_write_b128 v8, v[132:135] offset:20480
  ds_write_b128 v8, v[136:139] offset:24576
  ds_write_b128 v8, v[140:143] offset:28672
  ds_write_b128 v8, v[144:147] offset:32768
  ds_write_b128 v8, v[148:151] offset:36864
  ds_write_b128 v8, v[152:155] offset:40960
  ds_write_b128 v8, v[156:159] offset:45056
  ds_write_b128 v8, v[184:187] offset:49152
  ds_write_b128 v8, v[188:191] offset:53248
  ds_write_b128 v8, v[192:195] offset:57344
  ds_write_b128 v8, v[196:199] offset:61440
  s_waitcnt lgkmcnt(0)
  s_waitcnt vmcnt(8)
  s_barrier
  v_cmp_eq_u32 vcc, 0, v117
  v_lshlrev_b32 v116, 12, v116
  s_or_b32 s66, vcc_lo, s91
  s_cselect_b32 s66, 0, 1
  s_lshl2_add_u32 s36, s16, s17
  s_lshl_b32 s36, s36, 5
  s_add_u32 s36, s36, 244318208
  buffer_load_dword v118, v116, s[4:7], s36 offen sc1
  ds_read_b64_tr_b16 v[208:209], v104 offset:0
  ds_read_b64_tr_b16 v[210:211], v104 offset:4096
  ds_read_b64_tr_b16 v[152:153], v105 offset:0
  ds_read_b64_tr_b16 v[154:155], v105 offset:4096
  ds_read_b64_tr_b16 v[200:201], v106 offset:0
  ds_read_b64_tr_b16 v[202:203], v106 offset:4096
  ds_read_b64_tr_b16 v[144:145], v107 offset:0
  ds_read_b64_tr_b16 v[146:147], v107 offset:4096
  ds_read_b64_tr_b16 v[192:193], v108 offset:0
  ds_read_b64_tr_b16 v[194:195], v108 offset:4096
  ds_read_b64_tr_b16 v[136:137], v109 offset:0
  ds_read_b64_tr_b16 v[138:139], v109 offset:4096
  ds_read_b64_tr_b16 v[184:185], v110 offset:0
  ds_read_b64_tr_b16 v[186:187], v110 offset:4096
  ds_read_b64_tr_b16 v[128:129], v111 offset:0
  ds_read_b64_tr_b16 v[130:131], v111 offset:4096
  s_waitcnt lgkmcnt(0)
  s_waitcnt vmcnt(0)
  s_barrier
  ds_read_b64_tr_b16 v[212:213], v104 offset:32768
  ds_read_b64_tr_b16 v[214:215], v104 offset:36864
  ds_read_b64_tr_b16 v[156:157], v105 offset:32768
  ds_read_b64_tr_b16 v[158:159], v105 offset:36864
  ds_read_b64_tr_b16 v[204:205], v106 offset:32768
  ds_read_b64_tr_b16 v[206:207], v106 offset:36864
  ds_read_b64_tr_b16 v[148:149], v107 offset:32768
  ds_read_b64_tr_b16 v[150:151], v107 offset:36864
  ds_read_b64_tr_b16 v[196:197], v108 offset:32768
  ds_read_b64_tr_b16 v[198:199], v108 offset:36864
  ds_read_b64_tr_b16 v[140:141], v109 offset:32768
  ds_read_b64_tr_b16 v[142:143], v109 offset:36864
  ds_read_b64_tr_b16 v[188:189], v110 offset:32768
  ds_read_b64_tr_b16 v[190:191], v110 offset:36864
  ds_read_b64_tr_b16 v[132:133], v111 offset:32768
  ds_read_b64_tr_b16 v[134:135], v111 offset:36864
  s_waitcnt lgkmcnt(0)
  s_barrier
  s_waitcnt vmcnt(0)
  s_lshl_b32 s26, s16, 13
  s_add_u32 s26, s26, s40
  s_add_u32 s27, s26, 4096
  s_lshl_b32 s28, s17, 13
  s_add_u32 s28, s28, s62
  buffer_load_dwordx4 v[104:107], v8, s[4:7], s26 offen sc1
  buffer_load_dwordx4 v[104:107], v8, s[4:7], s27 offen sc1
  buffer_load_dwordx2 v[104:105], v5, s[4:7], s28 offen sc1
  ds_write_b128 v1, v[24:27] offset:0
  ds_write_b128 v1, v[28:31] offset:1024
  ds_write_b128 v1, v[32:35] offset:2048
  ds_write_b128 v1, v[36:39] offset:3072
  ds_write_b128 v1, v[40:43] offset:4096
  ds_write_b128 v1, v[44:47] offset:5120
  ds_write_b128 v1, v[48:51] offset:6144
  ds_write_b128 v1, v[52:55] offset:7168
  ds_write_b128 v1, v[56:59] offset:8192
  ds_write_b128 v1, v[60:63] offset:9216
  ds_write_b128 v1, v[64:67] offset:10240
  ds_write_b128 v1, v[68:71] offset:11264
  ds_write_b128 v1, v[72:75] offset:12288
  ds_write_b128 v1, v[76:79] offset:13312
  ds_write_b128 v1, v[80:83] offset:14336
  ds_write_b128 v1, v[84:87] offset:15360
  ds_write_b128 v1, v[88:91] offset:16384
  ds_write_b128 v1, v[92:95] offset:17408
  ds_write_b128 v1, v[96:99] offset:18432
  ds_write_b128 v1, v[100:103] offset:19456
  s_mul_i32 s27, s17, 24576
  s_add_u32 m0, s27, 86016
  s_waitcnt lgkmcnt(0)
  v_readlane_b32 s67, v118, 1
  v_readlane_b32 s26, v118, 0
  v_mov_b32 v21, v117
  s_and_b32 s66, s66, s26
  s_cbranch_scc1 L_pk
  v_mbcnt_lo_u32_b32 v20, -1, 0
  v_and_b32 v20, 1, v20
  v_add_lshl_u32 v20, v20, s61, 2
  s_mov_b32 s26, 0
g_wt_9:
  global_load_dword v21, v20, s[12:13] offset:128 sc1
  s_add_u32 s26, s26, 1
  s_cmp_gt_u32 s26, 1048576
  s_cbranch_scc1 L_end
  s_waitcnt vmcnt(0)
  v_cmp_eq_u32 vcc, 0, v21
  v_readfirstlane_b32 s27, v21
  s_cbranch_vccnz g_wt_9
L_pk:
  s_lshr_b32 s26, s91, 1
  s_nop 3
  v_readlane_b32 s27, v21, s26
  s_cmp_lg_u32 s27, 1
  s_cbranch_scc1 L_chain_x
  s_mov_b32 s22, 0
  s_mov_b32 s21, 0
  s_mov_b32 s42, s62
  s_add_u32 s43, s62, 4096
  s_mov_b32 s46, 0
  s_mov_b32 s47, 0
  s_lshl_b32 s26, s16, 2
  s_add_u32 s26, s26, s17
  s_lshl_b32 s27, s60, 13
  s_add_u32 s27, s27, s26
  s_lshr_b32 s25, s27, 2
  s_lshl_b32 s25, s25, 13
  s_add_u32 s25, s25, 192937984
  s_lshr_b32 s64, s27, 2
  s_lshl_b32 s64, s64, 6
  s_add_u32 s64, s64, 513538048
  s_cmp_eq_u32 s17, 3
  s_cselect_b32 s2, 268435456, 0
  s_lshl_b32 s27, s61, 13
  s_add_u32 s27, s27, s26
  s_lshl_b32 s23, s27, 12
  s_add_u32 s23, s23, 41943040
  s_lshl_b32 s63, s27, 5
  s_add_u32 s63, s63, 244318208
  s_mov_b32 s97, 268435456
  s_cmp_eq_u32 s60, 2
  s_cselect_b32 s20, 262144, s97
  s_cselect_b32 s93, 1, 3
  s_lshl_b32 s26, s17, 2
  s_add_u32 s26, s26, s60
  s_cmp_eq_u32 s26, 1
  s_cselect_b32 s97, 245891072, s97
  s_mov_b32 s95, 0
  s_mov_b32 s96, s23
  s_add_u32 s23, s23, 524288
  s_add_u32 s63, s63, 4096
  s_cmp_eq_u32 s66, 0
  s_cbranch_scc1 c_pk_18
  s_sub_u32 s96, s23, 524288
  s_mov_b32 s65, s67
  s_mov_b32 s94, 0
  buffer_load_dwordx4 v0, s[4:7], s96 offen offset:0  lds
  buffer_load_dwordx4 v0, s[4:7], s96 offen offset:1024  lds
  buffer_load_dwordx4 v0, s[4:7], s96 offen offset:2048  lds
  buffer_load_dwordx4 v0, s[4:7], s96 offen offset:3072  lds
  s_branch c_pk2_19
c_pk_18:
  s_mov_b32 s29, 0
  s_sub_u32 s92, s63, 4096
  s_sub_u32 s96, s23, 524288
  s_mov_b32 s95, 0
c_gw_20:
  buffer_load_dword v7, off, s[4:7], s92 sc1
  s_add_u32 s29, s29, 1
  s_cmp_gt_u32 s29, 1048576
  s_cbranch_scc1 c_fail_16
  s_waitcnt vmcnt(0) lgkmcnt(0)
  v_readfirstlane_b32 s65, v7
  s_cmp_eq_u32 s65, 0
  s_cbranch_scc1 c_gw_20
  s_and_b32 s65, s65, s93
  s_cbranch_scc1 c_kvx_22
  s_mov_b32 s95, 1
  s_add_u32 s96, s96, 33554432
  s_add_u32 s92, s92, 262144
c_kvw_21:
  buffer_load_dword v7, off, s[4:7], s92 sc1
  s_add_u32 s29, s29, 1
  s_cmp_gt_u32 s29, 1048576
  s_cbranch_scc1 c_fail_16
  s_waitcnt vmcnt(0) lgkmcnt(0)
  v_readfirstlane_b32 s65, v7
  s_cmp_eq_u32 s65, 0
  s_cbranch_scc1 c_kvw_21
c_kvx_22:
  buffer_load_dword v7, off, s[4:7], s63 sc1
  buffer_load_dwordx4 v0, s[4:7], s96 offen offset:0  lds
  buffer_load_dwordx4 v0, s[4:7], s96 offen offset:1024  lds
  buffer_load_dwordx4 v0, s[4:7], s96 offen offset:2048  lds
  buffer_load_dwordx4 v0, s[4:7], s96 offen offset:3072  lds
  s_waitcnt vmcnt(4)
  v_readfirstlane_b32 s65, v7
  s_mov_b32 s94, 0
c_pk2_19:
  s_waitcnt vmcnt(4)
  ds_read_b128 v[72:75], v1 offset:6144
  ds_read_b128 v[76:79], v1 offset:7168
  ds_read_b128 v[80:83], v1 offset:8192
  ds_read_b128 v[84:87], v1 offset:9216
  ds_read_b128 v[88:91], v1 offset:10240
  ds_read_b128 v[92:95], v1 offset:11264
  ds_read_b128 v[96:99], v1 offset:12288
  ds_read_b128 v[100:103], v1 offset:13312
  ds_read_b128 v[104:107], v1 offset:14336
  ds_read_b128 v[108:111], v1 offset:15360
  ds_read_b128 v[112:115], v1 offset:16384
  ds_read_b128 v[116:119], v1 offset:17408
  ds_read_b128 v[120:123], v1 offset:18432
  ds_read_b128 v[124:127], v1 offset:19456
  v_mov_b64 v[48:49], 0
  v_mov_b64 v[50:51], 0
  v_mov_b64 v[52:53], 0
  v_mov_b64 v[54:55], 0
  v_mov_b64 v[56:57], 0
  v_mov_b64 v[58:59], 0
  v_mov_b64 v[60:61], 0
  v_mov_b64 v[62:63], 0
  v_mov_b64 v[64:65], 0
  v_mov_b64 v[66:67], 0
  v_mov_b64 v[68:69], 0
  v_mov_b64 v[70:71], 0
  s_lshl_b32 s38, s16, 13
  s_add_u32 s38, s38, s40
  s_add_u32 s39, s38, 4096
  ds_read_b128 v[24:27], v1 offset:0
  ds_read_b128 v[28:31], v1 offset:1024
  ds_read_b128 v[32:35], v1 offset:2048
  ds_read_b128 v[36:39], v1 offset:3072
  ds_read_b128 v[40:43], v1 offset:4096
  ds_read_b128 v[44:47], v1 offset:5120
  s_waitcnt lgkmcnt(0)
c_loop_10:
  buffer_load_dwordx4 v[16:19], v8, s[4:7], s42 offen sc1
  buffer_load_dwordx4 v[20:23], v8, s[4:7], s43 offen sc1
  s_mov_b32 s28, 0
  v_mov_b64 v[48:49], 0
  v_mov_b64 v[50:51], 0
  v_mov_b64 v[52:53], 0
  v_mov_b64 v[54:55], 0
  v_mov_b64 v[56:57], 0
  v_mov_b64 v[58:59], 0
  v_mov_b64 v[60:61], 0
  v_mov_b64 v[62:63], 0
  v_mov_b64 v[64:65], 0
  v_mov_b64 v[66:67], 0
  v_mov_b64 v[68:69], 0
  v_mov_b64 v[70:71], 0
  buffer_load_dwordx4 v[16:19], v8, s[4:7], s42 offen sc1
  buffer_load_dwordx4 v[20:23], v8, s[4:7], s43 offen sc1
  s_waitcnt lgkmcnt(0)
  s_and_b32 s29, s65, s93
  s_cbranch_scc0 c_xb_25
c_xr_26:
  s_waitcnt vmcnt(3)
  v_max3_u32 v7, v16, v17, v18
  v_max_u32 v7, v7, v19
  ds_write_b128 v8, v[16:19] offset:4096
  v_smfmac_f32_16x16x64_bf16 v[48:51], v[16:19], v[24:31], v6
  s_waitcnt vmcnt(2)
  v_max3_u32 v7, v20, v21, v7
  v_max3_u32 v7, v22, v23, v7
  ds_write_b128 v8, v[20:23] offset:8192
  v_smfmac_f32_16x16x64_bf16 v[52:55], v[16:19], v[32:39], v6
  v_cmp_eq_u32 vcc, -1, v7
  v_smfmac_f32_16x16x64_bf16 v[56:59], v[16:19], v[40:47], v6
  s_cbranch_vccnz c_retry_11
c_got_12:
  v_smfmac_f32_16x16x64_bf16 v[60:63], v[16:19], v[72:79], v6
  ds_read_b128 v[72:75], v1 offset:20480
  s_and_b32 s65, s65, s93
  s_cselect_b32 s96, s23, 268435456
  v_smfmac_f32_16x16x64_bf16 v[48:51], v[20:23], v[80:87], v6
  ds_read_b128 v[76:79], v1 offset:21504
  v_mov_b32 v7, 1
  v_smfmac_f32_16x16x64_bf16 v[52:55], v[20:23], v[88:95], v6
  ds_read_b128 v[80:83], v1 offset:22528
  v_smfmac_f32_16x16x64_bf16 v[56:59], v[20:23], v[96:103], v6
  ds_read_b128 v[84:87], v1 offset:23552
  s_waitcnt lgkmcnt(4)
  s_barrier
  ds_read_b128 v[24:27], v9 offset:4096
  ds_read_b128 v[28:31], v10 offset:4096
  v_smfmac_f32_16x16x64_bf16 v[60:63], v[20:23], v[104:111], v6
  ds_read_b128 v[32:35], v11 offset:4096
  v_smfmac_f32_16x16x64_bf16 v[64:67], v[16:19], v[112:119], v6
  ds_read_b128 v[36:39], v9 offset:8192
  v_smfmac_f32_16x16x64_bf16 v[68:71], v[16:19], v[120:127], v6
  ds_read_b128 v[40:43], v10 offset:8192
  v_smfmac_f32_16x16x64_bf16 v[64:67], v[20:23], v[208:215], v6
  ds_read_b128 v[44:47], v11 offset:8192
  s_waitcnt lgkmcnt(5)
  v_smfmac_f32_16x16x64_bf16 v[48:51], v[24:27], a[168:175], v6
  buffer_load_dwordx4 v0, s[4:7], s96 offen offset:0  lds
  s_waitcnt lgkmcnt(4)
  v_smfmac_f32_16x16x64_bf16 v[48:51], v[28:31], a[160:167], v6
  ds_read_b128 v[104:107], v8 offset:16384
  s_waitcnt lgkmcnt(4)
  v_smfmac_f32_16x16x64_bf16 v[48:51], v[32:35], a[152:159], v6
  buffer_load_dwordx4 v0, s[4:7], s96 offen offset:1024  lds
  s_waitcnt lgkmcnt(3)
  v_smfmac_f32_16x16x64_bf16 v[48:51], v[36:39], a[144:151], v6
  ds_read_b128 v[108:111], v8 offset:20480
  s_waitcnt lgkmcnt(3)
  v_smfmac_f32_16x16x64_bf16 v[48:51], v[40:43], a[136:143], v6
  buffer_load_dwordx4 v0, s[4:7], s96 offen offset:2048  lds
  s_waitcnt lgkmcnt(2)
  v_smfmac_f32_16x16x64_bf16 v[48:51], v[44:47], a[128:135], v6
  v_smfmac_f32_16x16x64_bf16 v[52:55], v[24:27], a[120:127], v6
  buffer_load_dwordx4 v0, s[4:7], s96 offen offset:3072  lds
  v_smfmac_f32_16x16x64_bf16 v[52:55], v[28:31], a[112:119], v6
  ds_read_b64 v[100:101], v5 offset:4096
  v_add_f32 v48, v48, v50
  v_smfmac_f32_16x16x64_bf16 v[52:55], v[32:35], a[104:111], v6
  ds_read_b128 v[112:115], v8 offset:24576
  v_add_f32 v49, v49, v51
  v_smfmac_f32_16x16x64_bf16 v[52:55], v[36:39], a[96:103], v6
  ds_read_b128 v[116:119], v8 offset:28672
  v_cvt_pk_bf16_f32 v50, v48, v49
  v_smfmac_f32_16x16x64_bf16 v[52:55], v[40:43], a[88:95], v6
  ds_write2_b32 v2, v50, v50 offset0:0 offset1:1
  v_smfmac_f32_16x16x64_bf16 v[52:55], v[44:47], a[80:87], v6
  ds_read_b64_tr_b16 v[88:89], v12 offset:0
  v_smfmac_f32_16x16x64_bf16 v[56:59], v[24:27], a[72:79], v6
  s_mov_b64 exec, 1
  buffer_store_dword v7, off, s[4:7], s64 sc1
  s_mov_b64 exec, -1
  v_smfmac_f32_16x16x64_bf16 v[56:59], v[28:31], a[64:71], v6
  ds_read_b128 v[120:123], v8 offset:32768
  v_add_f32 v52, v52, v54
  v_smfmac_f32_16x16x64_bf16 v[56:59], v[32:35], a[56:63], v6
  ds_read_b128 v[124:127], v8 offset:36864
  v_add_f32 v53, v53, v55
  v_cvt_pk_bf16_f32 v54, v52, v53
  v_smfmac_f32_16x16x64_bf16 v[56:59], v[36:39], a[48:55], v6
  ds_write2_b32 v2, v54, v54 offset0:128 offset1:129
  ds_read_b64_tr_b16 v[90:91], v12 offset:512
  v_smfmac_f32_16x16x64_bf16 v[56:59], v[40:43], a[40:47], v6
  v_smfmac_f32_16x16x64_bf16 v[56:59], v[44:47], a[32:39], v6
  v_smfmac_f32_16x16x64_bf16 v[60:63], v[24:27], a[24:31], v6
  v_smfmac_f32_16x16x64_bf16 v[60:63], v[28:31], a[16:23], v6
  s_waitcnt lgkmcnt(0)
  v_add_f32 v56, v56, v58
  v_mfma_f32_16x16x32_bf16 v[92:95], v[72:75], v[88:91], 0
  buffer_store_dwordx2 v[100:101], v5, s[4:7], s97 offen sc1
  v_add_f32 v57, v57, v59
  v_cvt_pk_bf16_f32 v58, v56, v57
  v_mfma_f32_16x16x32_bf16 v[96:99], v[76:79], v[88:91], 0
  ds_write_b32 v2, v58
  v_smfmac_f32_16x16x64_bf16 v[60:63], v[32:35], a[8:15], v6
  v_mov_b32 v76, 0
  v_smfmac_f32_16x16x64_bf16 v[60:63], v[36:39], a[0:7], v6
  v_cndmask_b32 v48, v92, v96, s[18:19]
  v_smfmac_f32_16x16x64_bf16 v[60:63], v[40:43], v[248:255], v6
  v_cndmask_b32 v49, v93, v97, s[18:19]
  v_smfmac_f32_16x16x64_bf16 v[60:63], v[44:47], v[240:247], v6
  v_cndmask_b32 v50, v94, v98, s[18:19]
  v_smfmac_f32_16x16x64_bf16 v[68:71], v[20:23], v[152:159], v6
  v_cndmask_b32 v51, v95, v99, s[18:19]
  v_smfmac_f32_16x16x64_bf16 v[64:67], v[24:27], v[232:239], v6
  ds_write_b128 v8, v[48:51] offset:12288
  v_add_f32 v60, v60, v62
  v_add_f32 v61, v61, v63
  v_cvt_pk_bf16_f32 v62, v60, v61
  v_smfmac_f32_16x16x64_bf16 v[64:67], v[28:31], v[224:231], v6
  ds_write_b32 v2, v62 offset:512
  s_waitcnt vmcnt(6)
  v_mov_b32 v79, 0
  v_smfmac_f32_16x16x64_bf16 v[64:67], v[32:35], v[216:223], v6
  v_mov_b64 v[20:21], s[14:15]
  v_smfmac_f32_16x16x64_bf16 v[64:67], v[36:39], v[200:207], v6
  v_mov_b64 v[22:23], s[14:15]
  v_smfmac_f32_16x16x64_bf16 v[64:67], v[40:43], v[192:199], v6
  s_waitcnt lgkmcnt(0)
  s_barrier
  ds_read_b128 v[52:55], v9 offset:12288
  ds_read_b128 v[56:59], v10 offset:12288
  v_smfmac_f32_16x16x64_bf16 v[64:67], v[44:47], v[184:191], v6
  ds_read_b128 v[60:63], v11 offset:12288
  v_smfmac_f32_16x16x64_bf16 v[68:71], v[24:27], v[176:183], v6
  ds_read_b64_tr_b16 v[88:89], v12 offset:0
  ds_read_b64_tr_b16 v[90:91], v12 offset:512
  v_smfmac_f32_16x16x64_bf16 v[68:71], v[28:31], v[168:175], v6
  ds_read_b64_tr_b16 v[92:93], v13 offset:0
  ds_read_b64_tr_b16 v[94:95], v13 offset:512
  v_add_f32 v64, v64, v66
  v_smfmac_f32_16x16x64_bf16 v[68:71], v[32:35], v[160:167], v6
  ds_read_b64_tr_b16 v[96:97], v14 offset:0
  ds_read_b64_tr_b16 v[98:99], v14 offset:512
  v_add_f32 v65, v65, v67
  v_smfmac_f32_16x16x64_bf16 v[68:71], v[36:39], v[144:151], v6
  ds_read_b64_tr_b16 v[100:101], v15 offset:0
  ds_read_b64_tr_b16 v[102:103], v15 offset:512
  s_waitcnt lgkmcnt(8)
  v_cvt_pk_bf16_f32 v66, v64, v65
  v_smfmac_f32_16x16x64_bf16 v[68:71], v[40:43], v[136:143], v6
  v_add_f32 v48, v48, v52
  v_smfmac_f32_16x16x64_bf16 v[68:71], v[44:47], v[128:135], v6
  s_waitcnt lgkmcnt(4)
  v_add_f32 v49, v49, v53
  v_mfma_f32_16x16x32_bf16 v[16:19], v[88:91], v[88:91], 0
  buffer_store_dwordx4 v[88:91], v8, s[4:7], s25 offen sc1
  v_add_f32 v50, v50, v54
  v_add_f32 v51, v51, v55
  v_mfma_f32_16x16x32_bf16 v[16:19], v[92:95], v[92:95], v[16:19]
  s_waitcnt lgkmcnt(0)
  v_add_f32 v56, v56, v60
  v_add_f32 v57, v57, v61
  v_mfma_f32_16x16x32_bf16 v[16:19], v[96:99], v[96:99], v[16:19]
  v_add_f32 v58, v58, v62
  v_add_f32 v59, v59, v63
  v_mfma_f32_16x16x32_bf16 v[16:19], v[100:103], v[100:103], v[16:19]
  v_add_f32 v48, v48, v56
  v_add_f32 v49, v49, v57
  v_add_f32 v50, v50, v58
  v_add_f32 v51, v51, v59
  v_exp_f32 v24, v48
  v_exp_f32 v25, v49
  v_exp_f32 v26, v50
  v_exp_f32 v27, v51
  v_cvt_pk_bf16_f32 v24, v24, v25
  v_mul_f32 v16, s24, v16
  v_cvt_pk_bf16_f32 v25, v26, v27
  v_cndmask_b32 v72, v24, 0, s[18:19]
  v_cndmask_b32 v73, v25, 0, s[18:19]
  v_cndmask_b32 v74, 0, v24, s[18:19]
  v_cndmask_b32 v75, 0, v25, s[18:19]
  v_mul_f32 v17, s24, v17
  v_exp_f32 v28, v16
  v_mfma_f32_16x16x32_bf16 v[60:63], v[72:75], v[20:23], 0
  v_exp_f32 v29, v17
  v_add_f32 v68, v68, v70
  v_mfma_f32_16x16x32_bf16 v[52:55], v[72:75], v[80:83], 0
  s_add_u32 s30, s25, 4096
  v_cvt_pk_bf16_f32 v28, v28, v29
  v_add_f32 v69, v69, v71
  v_mfma_f32_16x16x32_bf16 v[56:59], v[72:75], v[84:87], 0
  v_cndmask_b32 v77, 0, v28, s[18:19]
  v_cndmask_b32 v78, 0, v28, s[18:19]
  v_cvt_pk_bf16_f32 v67, v68, v69
  v_lshrrev_b32 v92, 1, v8
  v_mfma_f32_16x16x16_bf16 v[60:63], v[76:77], v[20:21], v[60:63]
  buffer_store_dwordx2 v[66:67], v92, s[4:7], s30 offen sc1
  v_max3_f32 v7, |v48|, |v49|, |v50|
  v_max_f32 v26, |v16|, |v17|
  v_mfma_f32_16x16x16_bf16 v[52:55], v[78:79], v[66:67], v[52:55]
  v_cndmask_b32 v26, 0, v26, s[18:19]
  v_max3_f32 v7, |v51|, v26, v7
  v_mfma_f32_16x16x16_bf16 v[56:59], v[76:77], v[66:67], v[56:59]
  v_cmp_lt_f32 vcc, 0x42700000, v7
  v_mov_b64 v[44:45], 0
  v_add_f32 v60, v60, v62
  v_add_f32 v61, v61, v63
  s_cbranch_vccnz c_fb_14
c_fbr_15:
  v_rcp_f32 v60, v60
  v_rcp_f32 v61, v61
  v_pk_add_f32 v[52:53], v[52:53], v[54:55]
  v_pk_add_f32 v[56:57], v[56:57], v[58:59]
  v_pk_mul_f32 v[52:53], v[52:53], v[60:61]
  v_pk_mul_f32 v[56:57], v[56:57], v[60:61]
  v_cvt_pk_bf16_f32 v54, v52, v53
  v_cvt_pk_bf16_f32 v55, v56, v57
  ds_write_b64 v2, v[54:55] offset:4096
  v_mov_b64 v[46:47], 0
  v_mov_b64 v[40:41], 0
  v_mov_b64 v[42:43], 0
  v_mov_b64 v[36:37], 0
  v_mov_b64 v[38:39], 0
  v_mov_b64 v[32:33], 0
  v_mov_b64 v[34:35], 0
  v_mov_b64 v[28:29], 0
  v_mov_b64 v[30:31], 0
  v_mov_b64 v[24:25], 0
  v_mov_b64 v[26:27], 0
  v_mov_b64 v[80:81], 0
  v_mov_b64 v[82:83], 0
  v_mov_b64 v[84:85], 0
  v_mov_b64 v[86:87], 0
  s_waitcnt lgkmcnt(0)
  s_barrier
  ds_read_b64_tr_b16 v[72:73], v3 offset:4096
  ds_read_b64_tr_b16 v[74:75], v3 offset:5120
  ds_read_b64_tr_b16 v[76:77], v3 offset:6144
  ds_read_b64_tr_b16 v[78:79], v3 offset:7168
  s_and_b32 s3, s21, 1
  s_add_u32 s21, s21, 1
  s_add_u32 s22, s22, 1
  s_and_b32 s42, s21, 3
  s_lshl_b32 s42, s42, 13
  s_cmp_eq_u32 s22, 64
  s_cbranch_scc1 c_last_17
  s_waitcnt lgkmcnt(2)
  v_smfmac_f32_16x16x64_bf16 v[44:47], v[72:75], a[248:255], v6
  s_waitcnt lgkmcnt(0)
  ds_read_b128 v[16:19], v8 offset:40960
  v_smfmac_f32_16x16x64_bf16 v[44:47], v[76:79], a[240:247], v6
  ds_read_b128 v[20:23], v8 offset:45056
  v_smfmac_f32_16x16x64_bf16 v[40:43], v[72:75], a[232:239], v6
  ds_read_b128 v[88:91], v8 offset:49152
  v_smfmac_f32_16x16x64_bf16 v[40:43], v[76:79], a[224:231], v6
  ds_read_b128 v[92:95], v8 offset:53248
  v_add_f32 v44, v44, v46
  v_add_f32 v45, v45, v47
  v_smfmac_f32_16x16x64_bf16 v[36:39], v[72:75], a[216:223], v6
  ds_read_b128 v[96:99], v8 offset:57344
  v_cvt_pk_bf16_f32 v48, v44, v45
  v_and_or_b32 v48, v48, -2, s3
  v_smfmac_f32_16x16x64_bf16 v[36:39], v[76:79], a[208:215], v6
  ds_read_b128 v[100:103], v8 offset:61440
  v_add_f32 v40, v40, v42
  v_add_f32 v41, v41, v43
  v_smfmac_f32_16x16x64_bf16 v[32:35], v[72:75], a[200:207], v6
  v_cvt_pk_bf16_f32 v49, v40, v41
  v_smfmac_f32_16x16x64_bf16 v[32:35], v[76:79], a[192:199], v6
  v_add_f32 v36, v36, v38
  v_add_f32 v37, v37, v39
  v_smfmac_f32_16x16x64_bf16 v[28:31], v[72:75], a[184:191], v6
  v_cvt_pk_bf16_f32 v50, v36, v37
  v_smfmac_f32_16x16x64_bf16 v[28:31], v[76:79], a[176:183], v6
  v_add_f32 v32, v32, v34
  v_add_f32 v33, v33, v35
  v_smfmac_f32_16x16x64_bf16 v[24:27], v[72:75], v[104:111], v6
  v_cvt_pk_bf16_f32 v51, v32, v33
  v_smfmac_f32_16x16x64_bf16 v[24:27], v[76:79], v[112:119], v6
  buffer_store_dwordx4 v[48:51], v4, s[4:7], s40 offen
  v_add_f32 v28, v28, v30
  v_add_f32 v29, v29, v31
  v_smfmac_f32_16x16x64_bf16 v[80:83], v[72:75], v[120:127], v6
  s_waitcnt lgkmcnt(0)
  v_cvt_pk_bf16_f32 v52, v28, v29
  v_and_or_b32 v52, v52, -2, s3
  v_smfmac_f32_16x16x64_bf16 v[80:83], v[76:79], v[16:23], v6
  v_add_f32 v24, v24, v26
  v_add_f32 v25, v25, v27
  v_smfmac_f32_16x16x64_bf16 v[84:87], v[72:75], v[88:95], v6
  v_cvt_pk_bf16_f32 v53, v24, v25
  v_smfmac_f32_16x16x64_bf16 v[84:87], v[76:79], v[96:103], v6
  v_add_f32 v80, v80, v82
  v_add_f32 v81, v81, v83
  v_cvt_pk_bf16_f32 v54, v80, v81
  s_nop 0
  s_nop 3
  v_pk_add_f32 v[84:85], v[84:85], v[86:87]
  v_cvt_pk_bf16_f32 v55, v84, v85
  buffer_store_dwordx4 v[52:55], v4, s[4:7], s41 offen
  s_add_u32 s42, s42, s62
  s_add_u32 s43, s42, 4096
  s_add_u32 s23, s23, 524288
  s_add_u32 s25, s25, 262144
  s_add_u32 s63, s63, 4096
  s_add_u32 s64, s64, 2048
  s_andn2_b32 s64, s64, s2
  s_add_u32 s97, s97, 8192
  s_add_u32 s92, s63, s20
  s_cmp_lg_u32 s17, 0
  s_cbranch_scc1 c_oth_29
  s_mov_b32 s28, 0
  s_add_u32 s46, s46, 1
  v_mov_b64 v[64:65], -1
  s_xor_b32 s34, s42, 16384
  buffer_store_dwordx2 v[64:65], v5, s[4:7], s34 offen
  s_mov_b32 vcc_lo, 0xaaaaaaaa
  s_mov_b32 vcc_hi, 0xaaaaaaaa
  v_mov_b32 v7, 0x3f80
  v_cndmask_b32 v7, v7, 1.0, vcc
  s_mov_b32 vcc_lo, 0x30003
  s_mov_b32 vcc_hi, 0x30003
  v_cndmask_b32 v68, 0, v7, vcc
  s_mov_b32 vcc_lo, 0xc000c
  s_mov_b32 vcc_hi, 0xc000c
  v_cndmask_b32 v69, 0, v7, vcc
  s_mov_b32 vcc_lo, 0x300030
  s_mov_b32 vcc_hi, 0x300030
  v_cndmask_b32 v70, 0, v7, vcc
  s_mov_b32 vcc_lo, 0xc000c0
  s_mov_b32 vcc_hi, 0xc000c0
  v_cndmask_b32 v71, 0, v7, vcc
  ds_read_b128 v[104:107], v1 offset:14336
  ds_read_b128 v[108:111], v1 offset:15360
  s_waitcnt lgkmcnt(0)
  ds_read_b128 v[112:115], v1 offset:16384
  ds_read_b128 v[116:119], v1 offset:17408
  ds_read_b128 v[120:123], v1 offset:18432
  ds_read_b128 v[124:127], v1 offset:19456
  s_waitcnt lgkmcnt(0)
  buffer_load_dwordx4 v[16:19], v0, s[4:7], s38 offen offset:0 sc1
  buffer_load_dwordx4 v[20:23], v0, s[4:7], s38 offen offset:1024 sc1
  buffer_load_dwordx4 v[24:27], v0, s[4:7], s38 offen offset:2048 sc1
  buffer_load_dwordx4 v[28:31], v0, s[4:7], s38 offen offset:3072 sc1
  buffer_load_dwordx4 v[32:35], v0, s[4:7], s39 offen offset:0 sc1
  buffer_load_dwordx4 v[36:39], v0, s[4:7], s39 offen offset:1024 sc1
  buffer_load_dwordx4 v[40:43], v0, s[4:7], s39 offen offset:2048 sc1
  buffer_load_dwordx4 v[44:47], v0, s[4:7], s39 offen offset:3072 sc1
  buffer_load_dwordx4 v[72:75], v0, s[4:7], s38 offen offset:0 sc1
  buffer_load_dwordx4 v[76:79], v0, s[4:7], s38 offen offset:1024 sc1
  buffer_load_dwordx4 v[80:83], v0, s[4:7], s38 offen offset:2048 sc1
  buffer_load_dwordx4 v[84:87], v0, s[4:7], s38 offen offset:3072 sc1
  buffer_load_dwordx4 v[88:91], v0, s[4:7], s39 offen offset:0 sc1
  buffer_load_dwordx4 v[92:95], v0, s[4:7], s39 offen offset:1024 sc1
  buffer_load_dwordx4 v[96:99], v0, s[4:7], s39 offen offset:2048 sc1
  buffer_load_dwordx4 v[100:103], v0, s[4:7], s39 offen offset:3072 sc1
  s_buffer_load_dword s65, s[4:7], s63
  s_waitcnt vmcnt(15)
  v_mfma_f32_16x16x32_bf16 v[64:67], v[16:19], v[68:71], 0
  v_xor_b32 v7, s3, v16
  s_waitcnt vmcnt(14)
  v_mfma_f32_16x16x32_bf16 v[64:67], v[20:23], v[68:71], v[64:67]
  v_bitop3_b32 v7, v7, v20, s3 bitop3:0xf6
  s_waitcnt vmcnt(13)
  v_mfma_f32_16x16x32_bf16 v[64:67], v[24:27], v[68:71], v[64:67]
  v_bitop3_b32 v7, v7, v24, s3 bitop3:0xf6
  s_waitcnt vmcnt(12)
  v_mfma_f32_16x16x32_bf16 v[64:67], v[28:31], v[68:71], v[64:67]
  v_bitop3_b32 v7, v7, v28, s3 bitop3:0xf6
  s_waitcnt vmcnt(11)
  v_mfma_f32_16x16x32_bf16 v[64:67], v[32:35], v[68:71], v[64:67]
  v_bitop3_b32 v7, v7, v32, s3 bitop3:0xf6
  s_waitcnt vmcnt(10)
  v_mfma_f32_16x16x32_bf16 v[64:67], v[36:39], v[68:71], v[64:67]
  v_bitop3_b32 v7, v7, v36, s3 bitop3:0xf6
  s_waitcnt vmcnt(9)
  v_mfma_f32_16x16x32_bf16 v[64:67], v[40:43], v[68:71], v[64:67]
  v_bitop3_b32 v7, v7, v40, s3 bitop3:0xf6
  s_waitcnt vmcnt(8)
  v_mfma_f32_16x16x32_bf16 v[64:67], v[44:47], v[68:71], v[64:67]
  v_bitop3_b32 v7, v7, v44, s3 bitop3:0xf6
  v_and_b32 v7, 1, v7
  v_cmp_ne_u32 vcc, 0, v7
  v_mov_b32 v7, 0
  v_mov_b32 v7, 0
  s_cbranch_vccnz c_p1r_30
c_publ_31:
  s_nop 1
  s_nop 0
  v_cvt_pk_bf16_f32 v64, v64, v65
  v_cvt_pk_bf16_f32 v65, v66, v67
  v_min_u32 v64, -2, v64
  v_min_u32 v65, -2, v65
  buffer_store_dwordx2 v[64:65], v5, s[4:7], s42 offen
  s_waitcnt vmcnt(1)
  ds_read_b128 v[24:27], v1 offset:0
  ds_read_b128 v[28:31], v1 offset:1024
  ds_read_b128 v[32:35], v1 offset:2048
  ds_read_b128 v[36:39], v1 offset:3072
  ds_read_b128 v[40:43], v1 offset:4096
  ds_read_b128 v[44:47], v1 offset:5120
  ds_read_b128 v[72:75], v1 offset:6144
  ds_read_b128 v[76:79], v1 offset:7168
  ds_read_b128 v[80:83], v1 offset:8192
  ds_read_b128 v[84:87], v1 offset:9216
  ds_read_b128 v[88:91], v1 offset:10240
  ds_read_b128 v[92:95], v1 offset:11264
  ds_read_b128 v[96:99], v1 offset:12288
  ds_read_b128 v[100:103], v1 offset:13312
c_hop2_13:
  s_barrier
  s_cmp_le_u32 s96, s23
  s_cbranch_scc1 c_loop_10
  s_cmp_lg_u32 s96, 268435456
  s_cbranch_scc1 c_fk0_32
  buffer_store_dwordx2 v[64:65], v5, s[4:7], s97 offen sc1
  s_mov_b32 s29, 0
  s_sub_u32 s92, s63, 4096
  s_sub_u32 s96, s23, 524288
  s_mov_b32 s95, 0
c_gw_33:
  buffer_load_dword v7, off, s[4:7], s92 sc1
  s_add_u32 s29, s29, 1
  s_cmp_gt_u32 s29, 1048576
  s_cbranch_scc1 c_fail_16
  s_waitcnt vmcnt(0) lgkmcnt(0)
  v_readfirstlane_b32 s65, v7
  s_cmp_eq_u32 s65, 0
  s_cbranch_scc1 c_gw_33
  s_and_b32 s65, s65, s93
  s_cbranch_scc1 c_kvx_35
  s_mov_b32 s95, 1
  s_add_u32 s96, s96, 33554432
  s_add_u32 s92, s92, 262144
c_kvw_34:
  buffer_load_dword v7, off, s[4:7], s92 sc1
  s_add_u32 s29, s29, 1
  s_cmp_gt_u32 s29, 1048576
  s_cbranch_scc1 c_fail_16
  s_waitcnt vmcnt(0) lgkmcnt(0)
  v_readfirstlane_b32 s65, v7
  s_cmp_eq_u32 s65, 0
  s_cbranch_scc1 c_kvw_34
c_kvx_35:
  buffer_load_dword v7, off, s[4:7], s63 sc1
  buffer_load_dwordx4 v0, s[4:7], s96 offen offset:0  lds
  buffer_load_dwordx4 v0, s[4:7], s96 offen offset:1024  lds
  buffer_load_dwordx4 v0, s[4:7], s96 offen offset:2048  lds
  buffer_load_dwordx4 v0, s[4:7], s96 offen offset:3072  lds
  s_waitcnt vmcnt(4)
  v_readfirstlane_b32 s65, v7
  s_mov_b32 s94, 0
  s_cmp_eq_u32 s95, 0
  s_cbranch_scc1 c_loop_10
c_fk0_32:
  s_mov_b32 s29, 0
c_fk_36:
  buffer_load_dwordx4 v[16:19], v8, s[4:7], s42 offen sc1
  buffer_load_dwordx4 v[20:23], v8, s[4:7], s43 offen sc1
  s_add_u32 s29, s29, 1
  s_cmp_gt_u32 s29, 1048576
  s_cbranch_scc1 c_fail_16
  s_waitcnt vmcnt(0)
  v_max3_u32 v7, v16, v17, v18
  v_max3_u32 v7, v19, v20, v7
  v_max3_u32 v7, v21, v22, v7
  v_max_u32 v7, v7, v23
  v_cmp_eq_u32 vcc, -1, v7
  s_cbranch_vccnz c_fk_36
c_fk1_37:
  s_lshl_b32 s42, s22, 13
  s_add_u32 s42, s42, 245891072
  s_add_u32 s43, s42, 4096
  s_mov_b32 s95, 0
  s_branch c_loop_10
c_xb_25:
  s_cmp_lg_u32 s93, 1
  s_cbranch_scc1 c_xr_26
  s_cmp_ge_u32 s22, 63
  s_cbranch_scc1 c_xr_26
c_xp_38:
  s_cmp_lg_u32 s65, 0
  s_cbranch_scc1 c_xs_39
  buffer_load_dword v7, off, s[4:7], s63 sc1
  s_add_u32 s29, s29, 1
  s_cmp_gt_u32 s29, 1048576
  s_cbranch_scc1 c_fail_16
  s_waitcnt vmcnt(0)
  v_readfirstlane_b32 s65, v7
  s_branch c_xp_38
c_xs_39:
  s_cmp_eq_u32 s65, 1
  s_cbranch_scc1 c_xr_26
  s_mov_b32 s29, 0
c_xw_40:
  buffer_load_dwordx4 v[16:19], v8, s[4:7], s42 offen sc1
  buffer_load_dwordx4 v[20:23], v8, s[4:7], s43 offen sc1
  s_add_u32 s29, s29, 1
  s_cmp_gt_u32 s29, 1048576
  s_cbranch_scc1 c_fail_16
  s_waitcnt vmcnt(0)
  v_max3_u32 v7, v16, v17, v18
  v_max3_u32 v7, v19, v20, v7
  v_max3_u32 v7, v21, v22, v7
  v_max_u32 v7, v7, v23
  v_cmp_eq_u32 vcc, -1, v7
  s_cbranch_vccnz c_xw_40
  v_mov_b32 v7, 1
  s_barrier
  s_mov_b64 exec, 1
  buffer_store_dword v7, off, s[4:7], s64 sc1
  s_mov_b64 exec, -1
  s_add_u32 s22, s22, 1
  s_add_u32 s23, s23, 524288
  s_add_u32 s25, s25, 262144
  s_add_u32 s63, s63, 4096
  s_add_u32 s64, s64, 2048
  s_andn2_b32 s64, s64, s2
  s_mov_b32 s29, 0
  s_sub_u32 s92, s63, 4096
  s_sub_u32 s96, s23, 524288
  s_mov_b32 s95, 0
  s_mov_b32 s95, 1
  s_add_u32 s96, s96, 33554432
  s_add_u32 s92, s92, 262144
c_kvw_42:
  buffer_load_dword v7, off, s[4:7], s92 sc1
  s_add_u32 s29, s29, 1
  s_cmp_gt_u32 s29, 1048576
  s_cbranch_scc1 c_fail_16
  s_waitcnt vmcnt(0) lgkmcnt(0)
  v_readfirstlane_b32 s65, v7
  s_cmp_eq_u32 s65, 0
  s_cbranch_scc1 c_kvw_42
c_kvx_43:
  buffer_load_dword v7, off, s[4:7], s63 sc1
  buffer_load_dwordx4 v0, s[4:7], s96 offen offset:0  lds
  buffer_load_dwordx4 v0, s[4:7], s96 offen offset:1024  lds
  buffer_load_dwordx4 v0, s[4:7], s96 offen offset:2048  lds
  buffer_load_dwordx4 v0, s[4:7], s96 offen offset:3072  lds
  s_waitcnt vmcnt(4)
  v_readfirstlane_b32 s65, v7
  s_mov_b32 s94, 0
  s_branch c_fk1_37
c_last_17:
  s_add_u32 s64, s64, 2048
  v_mov_b32 v7, 1
  s_waitcnt vmcnt(0)
  s_barrier
  s_mov_b64 exec, 1
  buffer_store_dword v7, off, s[4:7], s64 sc1
  s_mov_b64 exec, -1
  s_branch L_chdone
c_oth_29:
  s_buffer_load_dword s65, s[4:7], s63
  ds_read_b128 v[24:27], v1 offset:0
  ds_read_b128 v[28:31], v1 offset:1024
  ds_read_b128 v[32:35], v1 offset:2048
  ds_read_b128 v[36:39], v1 offset:3072
  ds_read_b128 v[40:43], v1 offset:4096
  ds_read_b128 v[44:47], v1 offset:5120
  ds_read_b128 v[72:75], v1 offset:6144
  ds_read_b128 v[76:79], v1 offset:7168
  ds_read_b128 v[80:83], v1 offset:8192
  ds_read_b128 v[84:87], v1 offset:9216
  ds_read_b128 v[88:91], v1 offset:10240
  ds_read_b128 v[92:95], v1 offset:11264
  ds_read_b128 v[96:99], v1 offset:12288
  ds_read_b128 v[100:103], v1 offset:13312
  ds_read_b128 v[104:107], v1 offset:14336
  ds_read_b128 v[108:111], v1 offset:15360
  ds_read_b128 v[112:115], v1 offset:16384
  ds_read_b128 v[116:119], v1 offset:17408
  ds_read_b128 v[120:123], v1 offset:18432
  ds_read_b128 v[124:127], v1 offset:19456
  s_branch c_hop2_13
c_p1r_30:
  s_waitcnt vmcnt(7)
  s_nop 0
  v_mfma_f32_16x16x32_bf16 v[64:67], v[72:75], v[68:71], 0
  v_xor_b32 v7, s3, v72
  s_waitcnt vmcnt(6)
  v_mfma_f32_16x16x32_bf16 v[64:67], v[76:79], v[68:71], v[64:67]
  v_bitop3_b32 v7, v7, v76, s3 bitop3:0xf6
  s_waitcnt vmcnt(5)
  v_mfma_f32_16x16x32_bf16 v[64:67], v[80:83], v[68:71], v[64:67]
  v_bitop3_b32 v7, v7, v80, s3 bitop3:0xf6
  s_waitcnt vmcnt(4)
  v_mfma_f32_16x16x32_bf16 v[64:67], v[84:87], v[68:71], v[64:67]
  v_bitop3_b32 v7, v7, v84, s3 bitop3:0xf6
  s_waitcnt vmcnt(3)
  v_mfma_f32_16x16x32_bf16 v[64:67], v[88:91], v[68:71], v[64:67]
  v_bitop3_b32 v7, v7, v88, s3 bitop3:0xf6
  s_waitcnt vmcnt(2)
  v_mfma_f32_16x16x32_bf16 v[64:67], v[92:95], v[68:71], v[64:67]
  v_bitop3_b32 v7, v7, v92, s3 bitop3:0xf6
  s_waitcnt vmcnt(1)
  v_mfma_f32_16x16x32_bf16 v[64:67], v[96:99], v[68:71], v[64:67]
  v_bitop3_b32 v7, v7, v96, s3 bitop3:0xf6
  s_waitcnt vmcnt(0)
  v_mfma_f32_16x16x32_bf16 v[64:67], v[100:103], v[68:71], v[64:67]
  v_bitop3_b32 v7, v7, v100, s3 bitop3:0xf6
  v_and_b32 v7, 1, v7
  v_cmp_ne_u32 vcc, 0, v7
  s_add_u32 s46, s46, 1
  s_cbranch_vccz c_publ_31
  buffer_load_dwordx4 v[72:75], v0, s[4:7], s38 offen offset:0 sc1
  buffer_load_dwordx4 v[76:79], v0, s[4:7], s38 offen offset:1024 sc1
  buffer_load_dwordx4 v[80:83], v0, s[4:7], s38 offen offset:2048 sc1
  buffer_load_dwordx4 v[84:87], v0, s[4:7], s38 offen offset:3072 sc1
  buffer_load_dwordx4 v[88:91], v0, s[4:7], s39 offen offset:0 sc1
  buffer_load_dwordx4 v[92:95], v0, s[4:7], s39 offen offset:1024 sc1
  buffer_load_dwordx4 v[96:99], v0, s[4:7], s39 offen offset:2048 sc1
  buffer_load_dwordx4 v[100:103], v0, s[4:7], s39 offen offset:3072 sc1
  s_add_u32 s28, s28, 1
  s_cmp_gt_u32 s28, 1048576
  s_cbranch_scc0 c_p1r_30
  s_branch c_fail_16
c_retry_11:
  v_mov_b64 v[48:49], 0
  v_mov_b64 v[50:51], 0
  s_nop 0
  v_mov_b64 v[52:53], 0
  v_mov_b64 v[54:55], 0
  s_nop 1
  v_mov_b64 v[56:57], 0
  v_mov_b64 v[58:59], 0
c_rl_44:
  buffer_load_dwordx4 v[16:19], v8, s[4:7], s42 offen sc1
  buffer_load_dwordx4 v[20:23], v8, s[4:7], s43 offen sc1
  s_add_u32 s28, s28, 1
  s_add_u32 s47, s47, 1
  s_cmp_gt_u32 s28, 1048576
  s_cbranch_scc1 c_fail_16
  s_waitcnt vmcnt(2)
  v_max3_u32 v7, v16, v17, v18
  v_max3_u32 v7, v19, v20, v7
  v_max3_u32 v7, v21, v22, v7
  v_max_u32 v7, v7, v23
  v_cmp_eq_u32 vcc, -1, v7
  s_cbranch_vccnz c_rl_44
  ds_write_b128 v8, v[16:19] offset:4096
  v_smfmac_f32_16x16x64_bf16 v[48:51], v[16:19], v[24:31], v6
  ds_write_b128 v8, v[20:23] offset:8192
  v_smfmac_f32_16x16x64_bf16 v[52:55], v[16:19], v[32:39], v6
  v_smfmac_f32_16x16x64_bf16 v[56:59], v[16:19], v[40:47], v6
  s_branch c_got_12
c_fb_14:
  v_max3_f32 v7, v48, v49, v50
  v_max_f32 v7, v51, v7
  s_mov_b64 exec, s[18:19]
  v_max3_f32 v7, v16, v17, v7
  s_mov_b64 exec, -1
  s_nop 0
  v_max_f32_dpp v7, v7, v7 quad_perm:[2,3,0,1] row_mask:0xf bank_mask:0xf
  v_mov_b32 v24, v7
  s_nop 0
  s_nop 0
  v_permlane16_swap_b32 v7, v24
  v_max_f32 v7, v7, v24
  v_mov_b32 v24, v7
  s_nop 0
  s_nop 0
  v_permlane32_swap_b32 v7, v24
  v_max_f32 v7, v7, v24
  v_sub_f32 v24, v48, v7
  v_sub_f32 v25, v49, v7
  v_sub_f32 v26, v50, v7
  v_sub_f32 v27, v51, v7
  v_sub_f32 v28, v16, v7
  v_sub_f32 v29, v17, v7
  v_exp_f32 v24, v24
  v_exp_f32 v25, v25
  v_exp_f32 v26, v26
  v_exp_f32 v27, v27
  v_exp_f32 v28, v28
  v_exp_f32 v29, v29
  v_cvt_pk_bf16_f32 v24, v24, v25
  v_cvt_pk_bf16_f32 v25, v26, v27
  v_cvt_pk_bf16_f32 v28, v28, v29
  v_cndmask_b32 v72, v24, 0, s[18:19]
  v_cndmask_b32 v73, v25, 0, s[18:19]
  v_cndmask_b32 v74, 0, v24, s[18:19]
  v_cndmask_b32 v75, 0, v25, s[18:19]
  v_cndmask_b32 v77, 0, v28, s[18:19]
  v_cndmask_b32 v78, 0, v28, s[18:19]
  v_mfma_f32_16x16x32_bf16 v[60:63], v[72:75], v[20:23], 0
  v_mfma_f32_16x16x32_bf16 v[52:55], v[72:75], v[80:83], 0
  v_mfma_f32_16x16x32_bf16 v[56:59], v[72:75], v[84:87], 0
  v_mfma_f32_16x16x16_bf16 v[60:63], v[76:77], v[20:21], v[60:63]
  v_mfma_f32_16x16x16_bf16 v[52:55], v[78:79], v[66:67], v[52:55]
  s_nop 2
  v_mfma_f32_16x16x16_bf16 v[56:59], v[76:77], v[66:67], v[56:59]
  s_nop 7
  v_add_f32 v60, v60, v62
  v_add_f32 v61, v61, v63
  s_branch c_fbr_15
c_fail_16:
  s_endpgm
L_chain_x:
  s_mov_b32 s22, 0
  s_mov_b32 s21, 0
  s_mov_b32 s42, s62
  s_add_u32 s43, s62, 4096
  s_mov_b32 s46, 0
  s_mov_b32 s47, 0
  s_lshl_b32 s26, s16, 2
  s_add_u32 s26, s26, s17
  s_lshl_b32 s27, s60, 13
  s_add_u32 s27, s27, s26
  s_lshr_b32 s25, s27, 2
  s_lshl_b32 s25, s25, 13
  s_add_u32 s25, s25, 192937984
  s_lshr_b32 s64, s27, 2
  s_lshl_b32 s64, s64, 6
  s_add_u32 s64, s64, 513538048
  s_cmp_eq_u32 s17, 3
  s_cselect_b32 s2, 268435456, 0
  s_lshl_b32 s27, s61, 13
  s_add_u32 s27, s27, s26
  s_lshl_b32 s23, s27, 12
  s_add_u32 s23, s23, 41943040
  s_lshl_b32 s63, s27, 5
  s_add_u32 s63, s63, 244318208
  s_mov_b32 s97, 268435456
  s_cmp_eq_u32 s60, 2
  s_cselect_b32 s20, 262144, s97
  s_cselect_b32 s93, 1, 3
  s_lshl_b32 s26, s17, 2
  s_add_u32 s26, s26, s60
  s_cmp_eq_u32 s26, 1
  s_cselect_b32 s97, 245891072, s97
  s_mov_b32 s95, 0
  s_mov_b32 s96, s23
  s_add_u32 s23, s23, 524288
  s_add_u32 s63, s63, 4096
  s_cmp_eq_u32 s66, 0
  s_cbranch_scc1 c_pk_53
  s_sub_u32 s96, s23, 524288
  s_mov_b32 s65, s67
  s_mov_b32 s94, 0
  buffer_load_dwordx4 v0, s[4:7], s96 offen offset:0  lds
  buffer_load_dwordx4 v0, s[4:7], s96 offen offset:1024  lds
  buffer_load_dwordx4 v0, s[4:7], s96 offen offset:2048  lds
  buffer_load_dwordx4 v0, s[4:7], s96 offen offset:3072  lds
  s_branch c_pk2_54
c_pk_53:
  s_mov_b32 s29, 0
  s_sub_u32 s92, s63, 4096
  s_sub_u32 s96, s23, 524288
  s_mov_b32 s95, 0
c_gw_55:
  buffer_load_dword v7, off, s[4:7], s92 sc1
  s_add_u32 s29, s29, 1
  s_cmp_gt_u32 s29, 1048576
  s_cbranch_scc1 c_fail_51
  s_waitcnt vmcnt(0) lgkmcnt(0)
  v_readfirstlane_b32 s65, v7
  s_cmp_eq_u32 s65, 0
  s_cbranch_scc1 c_gw_55
  s_and_b32 s65, s65, s93
  s_cbranch_scc1 c_kvx_57
  s_mov_b32 s95, 1
  s_add_u32 s96, s96, 33554432
  s_add_u32 s92, s92, 262144
c_kvw_56:
  buffer_load_dword v7, off, s[4:7], s92 sc1
  s_add_u32 s29, s29, 1
  s_cmp_gt_u32 s29, 1048576
  s_cbranch_scc1 c_fail_51
  s_waitcnt vmcnt(0) lgkmcnt(0)
  v_readfirstlane_b32 s65, v7
  s_cmp_eq_u32 s65, 0
  s_cbranch_scc1 c_kvw_56
c_kvx_57:
  buffer_load_dword v7, off, s[4:7], s63 sc1
  buffer_load_dwordx4 v0, s[4:7], s96 offen offset:0  lds
  buffer_load_dwordx4 v0, s[4:7], s96 offen offset:1024  lds
  buffer_load_dwordx4 v0, s[4:7], s96 offen offset:2048  lds
  buffer_load_dwordx4 v0, s[4:7], s96 offen offset:3072  lds
  s_waitcnt vmcnt(4)
  v_readfirstlane_b32 s65, v7
  s_mov_b32 s94, 0
c_pk2_54:
  s_waitcnt vmcnt(4)
  ds_read_b128 v[72:75], v1 offset:6144
  ds_read_b128 v[76:79], v1 offset:7168
  ds_read_b128 v[80:83], v1 offset:8192
  ds_read_b128 v[84:87], v1 offset:9216
  ds_read_b128 v[88:91], v1 offset:10240
  ds_read_b128 v[92:95], v1 offset:11264
  ds_read_b128 v[96:99], v1 offset:12288
  ds_read_b128 v[100:103], v1 offset:13312
  ds_read_b128 v[104:107], v1 offset:14336
  ds_read_b128 v[108:111], v1 offset:15360
  ds_read_b128 v[112:115], v1 offset:16384
  ds_read_b128 v[116:119], v1 offset:17408
  ds_read_b128 v[120:123], v1 offset:18432
  ds_read_b128 v[124:127], v1 offset:19456
  v_mov_b64 v[48:49], 0
  v_mov_b64 v[50:51], 0
  v_mov_b64 v[52:53], 0
  v_mov_b64 v[54:55], 0
  v_mov_b64 v[56:57], 0
  v_mov_b64 v[58:59], 0
  v_mov_b64 v[60:61], 0
  v_mov_b64 v[62:63], 0
  v_mov_b64 v[64:65], 0
  v_mov_b64 v[66:67], 0
  v_mov_b64 v[68:69], 0
  v_mov_b64 v[70:71], 0
  s_lshl_b32 s38, s16, 13
  s_add_u32 s38, s38, s40
  s_add_u32 s39, s38, 4096
  ds_read_b128 v[24:27], v1 offset:0
  ds_read_b128 v[28:31], v1 offset:1024
  ds_read_b128 v[32:35], v1 offset:2048
  ds_read_b128 v[36:39], v1 offset:3072
  ds_read_b128 v[40:43], v1 offset:4096
  ds_read_b128 v[44:47], v1 offset:5120
  s_waitcnt lgkmcnt(0)
c_loop_45:
  buffer_load_dwordx4 v[16:19], v8, s[4:7], s42 offen sc1
  buffer_load_dwordx4 v[20:23], v8, s[4:7], s43 offen sc1
  s_mov_b32 s28, 0
  v_mov_b64 v[48:49], 0
  v_mov_b64 v[50:51], 0
  v_mov_b64 v[52:53], 0
  v_mov_b64 v[54:55], 0
  v_mov_b64 v[56:57], 0
  v_mov_b64 v[58:59], 0
  v_mov_b64 v[60:61], 0
  v_mov_b64 v[62:63], 0
  v_mov_b64 v[64:65], 0
  v_mov_b64 v[66:67], 0
  v_mov_b64 v[68:69], 0
  v_mov_b64 v[70:71], 0
  buffer_load_dwordx4 v[16:19], v8, s[4:7], s42 offen sc1
  buffer_load_dwordx4 v[20:23], v8, s[4:7], s43 offen sc1
  s_waitcnt lgkmcnt(0)
  s_and_b32 s29, s65, s93
  s_cbranch_scc0 c_xb_60
c_xr_61:
  s_waitcnt vmcnt(3)
  v_max3_u32 v7, v16, v17, v18
  v_max_u32 v7, v7, v19
  ds_write_b128 v8, v[16:19] offset:4096
  v_smfmac_f32_16x16x64_bf16 v[48:51], v[16:19], v[24:31], v6
  s_waitcnt vmcnt(2)
  v_max3_u32 v7, v20, v21, v7
  v_max3_u32 v7, v22, v23, v7
  ds_write_b128 v8, v[20:23] offset:8192
  v_smfmac_f32_16x16x64_bf16 v[52:55], v[16:19], v[32:39], v6
  v_cmp_eq_u32 vcc, -1, v7
  v_smfmac_f32_16x16x64_bf16 v[56:59], v[16:19], v[40:47], v6
  s_cbranch_vccnz c_retry_46
c_got_47:
  v_smfmac_f32_16x16x64_bf16 v[60:63], v[16:19], v[72:79], v6
  ds_read_b128 v[72:75], v1 offset:20480
  s_and_b32 s65, s65, s93
  s_cselect_b32 s96, s23, 268435456
  v_smfmac_f32_16x16x64_bf16 v[48:51], v[20:23], v[80:87], v6
  ds_read_b128 v[76:79], v1 offset:21504
  v_mov_b32 v7, 1
  v_smfmac_f32_16x16x64_bf16 v[52:55], v[20:23], v[88:95], v6
  ds_read_b128 v[80:83], v1 offset:22528
  v_smfmac_f32_16x16x64_bf16 v[56:59], v[20:23], v[96:103], v6
  ds_read_b128 v[84:87], v1 offset:23552
  s_waitcnt lgkmcnt(4)
  s_barrier
  ds_read_b128 v[24:27], v9 offset:4096
  ds_read_b128 v[28:31], v10 offset:4096
  v_smfmac_f32_16x16x64_bf16 v[60:63], v[20:23], v[104:111], v6
  ds_read_b128 v[32:35], v11 offset:4096
  v_smfmac_f32_16x16x64_bf16 v[64:67], v[16:19], v[112:119], v6
  ds_read_b128 v[36:39], v9 offset:8192
  v_smfmac_f32_16x16x64_bf16 v[68:71], v[16:19], v[120:127], v6
  ds_read_b128 v[40:43], v10 offset:8192
  v_smfmac_f32_16x16x64_bf16 v[64:67], v[20:23], v[208:215], v6
  ds_read_b128 v[44:47], v11 offset:8192
  s_waitcnt lgkmcnt(5)
  v_smfmac_f32_16x16x64_bf16 v[48:51], v[24:27], a[168:175], v6
  buffer_load_dwordx4 v0, s[4:7], s96 offen offset:0  lds
  s_waitcnt lgkmcnt(4)
  v_smfmac_f32_16x16x64_bf16 v[48:51], v[28:31], a[160:167], v6
  ds_read_b128 v[104:107], v8 offset:16384
  s_waitcnt lgkmcnt(4)
  v_smfmac_f32_16x16x64_bf16 v[48:51], v[32:35], a[152:159], v6
  buffer_load_dwordx4 v0, s[4:7], s96 offen offset:1024  lds
  s_waitcnt lgkmcnt(3)
  v_smfmac_f32_16x16x64_bf16 v[48:51], v[36:39], a[144:151], v6
  ds_read_b128 v[108:111], v8 offset:20480
  s_waitcnt lgkmcnt(3)
  v_smfmac_f32_16x16x64_bf16 v[48:51], v[40:43], a[136:143], v6
  buffer_load_dwordx4 v0, s[4:7], s96 offen offset:2048  lds
  s_waitcnt lgkmcnt(2)
  v_smfmac_f32_16x16x64_bf16 v[48:51], v[44:47], a[128:135], v6
  v_smfmac_f32_16x16x64_bf16 v[52:55], v[24:27], a[120:127], v6
  buffer_load_dwordx4 v0, s[4:7], s96 offen offset:3072  lds
  v_smfmac_f32_16x16x64_bf16 v[52:55], v[28:31], a[112:119], v6
  ds_read_b64 v[100:101], v5 offset:4096
  v_add_f32 v48, v48, v50
  v_smfmac_f32_16x16x64_bf16 v[52:55], v[32:35], a[104:111], v6
  ds_read_b128 v[112:115], v8 offset:24576
  v_add_f32 v49, v49, v51
  v_smfmac_f32_16x16x64_bf16 v[52:55], v[36:39], a[96:103], v6
  ds_read_b128 v[116:119], v8 offset:28672
  v_cvt_pk_bf16_f32 v50, v48, v49
  v_smfmac_f32_16x16x64_bf16 v[52:55], v[40:43], a[88:95], v6
  ds_write2_b32 v2, v50, v50 offset0:0 offset1:1
  v_smfmac_f32_16x16x64_bf16 v[52:55], v[44:47], a[80:87], v6
  ds_read_b64_tr_b16 v[88:89], v12 offset:0
  v_smfmac_f32_16x16x64_bf16 v[56:59], v[24:27], a[72:79], v6
  s_mov_b64 exec, 1
  buffer_store_dword v7, off, s[4:7], s64 sc1
  s_mov_b64 exec, -1
  v_smfmac_f32_16x16x64_bf16 v[56:59], v[28:31], a[64:71], v6
  ds_read_b128 v[120:123], v8 offset:32768
  v_add_f32 v52, v52, v54
  v_smfmac_f32_16x16x64_bf16 v[56:59], v[32:35], a[56:63], v6
  ds_read_b128 v[124:127], v8 offset:36864
  v_add_f32 v53, v53, v55
  v_cvt_pk_bf16_f32 v54, v52, v53
  v_smfmac_f32_16x16x64_bf16 v[56:59], v[36:39], a[48:55], v6
  ds_write2_b32 v2, v54, v54 offset0:128 offset1:129
  ds_read_b64_tr_b16 v[90:91], v12 offset:512
  v_smfmac_f32_16x16x64_bf16 v[56:59], v[40:43], a[40:47], v6
  v_smfmac_f32_16x16x64_bf16 v[56:59], v[44:47], a[32:39], v6
  v_smfmac_f32_16x16x64_bf16 v[60:63], v[24:27], a[24:31], v6
  v_smfmac_f32_16x16x64_bf16 v[60:63], v[28:31], a[16:23], v6
  s_waitcnt lgkmcnt(0)
  v_add_f32 v56, v56, v58
  v_mfma_f32_16x16x32_bf16 v[92:95], v[72:75], v[88:91], 0
  buffer_store_dwordx2 v[100:101], v5, s[4:7], s97 offen sc1
  v_add_f32 v57, v57, v59
  v_cvt_pk_bf16_f32 v58, v56, v57
  v_mfma_f32_16x16x32_bf16 v[96:99], v[76:79], v[88:91], 0
  ds_write_b32 v2, v58
  v_smfmac_f32_16x16x64_bf16 v[60:63], v[32:35], a[8:15], v6
  v_mov_b32 v76, 0
  v_smfmac_f32_16x16x64_bf16 v[60:63], v[36:39], a[0:7], v6
  v_cndmask_b32 v48, v92, v96, s[18:19]
  v_smfmac_f32_16x16x64_bf16 v[60:63], v[40:43], v[248:255], v6
  v_cndmask_b32 v49, v93, v97, s[18:19]
  v_smfmac_f32_16x16x64_bf16 v[60:63], v[44:47], v[240:247], v6
  v_cndmask_b32 v50, v94, v98, s[18:19]
  v_smfmac_f32_16x16x64_bf16 v[68:71], v[20:23], v[152:159], v6
  v_cndmask_b32 v51, v95, v99, s[18:19]
  v_smfmac_f32_16x16x64_bf16 v[64:67], v[24:27], v[232:239], v6
  ds_write_b128 v8, v[48:51] offset:12288
  v_add_f32 v60, v60, v62
  v_add_f32 v61, v61, v63
  v_cvt_pk_bf16_f32 v62, v60, v61
  v_smfmac_f32_16x16x64_bf16 v[64:67], v[28:31], v[224:231], v6
  ds_write_b32 v2, v62 offset:512
  s_waitcnt vmcnt(6)
  v_mov_b32 v79, 0
  v_smfmac_f32_16x16x64_bf16 v[64:67], v[32:35], v[216:223], v6
  v_mov_b64 v[20:21], s[14:15]
  v_smfmac_f32_16x16x64_bf16 v[64:67], v[36:39], v[200:207], v6
  v_mov_b64 v[22:23], s[14:15]
  v_smfmac_f32_16x16x64_bf16 v[64:67], v[40:43], v[192:199], v6
  s_waitcnt lgkmcnt(0)
  s_barrier
  ds_read_b128 v[52:55], v9 offset:12288
  ds_read_b128 v[56:59], v10 offset:12288
  v_smfmac_f32_16x16x64_bf16 v[64:67], v[44:47], v[184:191], v6
  ds_read_b128 v[60:63], v11 offset:12288
  v_smfmac_f32_16x16x64_bf16 v[68:71], v[24:27], v[176:183], v6
  ds_read_b64_tr_b16 v[88:89], v12 offset:0
  ds_read_b64_tr_b16 v[90:91], v12 offset:512
  v_smfmac_f32_16x16x64_bf16 v[68:71], v[28:31], v[168:175], v6
  ds_read_b64_tr_b16 v[92:93], v13 offset:0
  ds_read_b64_tr_b16 v[94:95], v13 offset:512
  v_add_f32 v64, v64, v66
  v_smfmac_f32_16x16x64_bf16 v[68:71], v[32:35], v[160:167], v6
  ds_read_b64_tr_b16 v[96:97], v14 offset:0
  ds_read_b64_tr_b16 v[98:99], v14 offset:512
  v_add_f32 v65, v65, v67
  v_smfmac_f32_16x16x64_bf16 v[68:71], v[36:39], v[144:151], v6
  ds_read_b64_tr_b16 v[100:101], v15 offset:0
  ds_read_b64_tr_b16 v[102:103], v15 offset:512
  s_waitcnt lgkmcnt(8)
  v_cvt_pk_bf16_f32 v66, v64, v65
  v_smfmac_f32_16x16x64_bf16 v[68:71], v[40:43], v[136:143], v6
  v_add_f32 v48, v48, v52
  v_smfmac_f32_16x16x64_bf16 v[68:71], v[44:47], v[128:135], v6
  s_waitcnt lgkmcnt(4)
  v_add_f32 v49, v49, v53
  v_mfma_f32_16x16x32_bf16 v[16:19], v[88:91], v[88:91], 0
  buffer_store_dwordx4 v[88:91], v8, s[4:7], s25 offen sc1
  v_add_f32 v50, v50, v54
  v_add_f32 v51, v51, v55
  v_mfma_f32_16x16x32_bf16 v[16:19], v[92:95], v[92:95], v[16:19]
  s_waitcnt lgkmcnt(0)
  v_add_f32 v56, v56, v60
  v_add_f32 v57, v57, v61
  v_mfma_f32_16x16x32_bf16 v[16:19], v[96:99], v[96:99], v[16:19]
  v_add_f32 v58, v58, v62
  v_add_f32 v59, v59, v63
  v_mfma_f32_16x16x32_bf16 v[16:19], v[100:103], v[100:103], v[16:19]
  v_add_f32 v48, v48, v56
  v_add_f32 v49, v49, v57
  v_add_f32 v50, v50, v58
  v_add_f32 v51, v51, v59
  v_exp_f32 v24, v48
  v_exp_f32 v25, v49
  v_exp_f32 v26, v50
  v_exp_f32 v27, v51
  v_cvt_pk_bf16_f32 v24, v24, v25
  v_mul_f32 v16, s24, v16
  v_cvt_pk_bf16_f32 v25, v26, v27
  v_cndmask_b32 v72, v24, 0, s[18:19]
  v_cndmask_b32 v73, v25, 0, s[18:19]
  v_cndmask_b32 v74, 0, v24, s[18:19]
  v_cndmask_b32 v75, 0, v25, s[18:19]
  v_mul_f32 v17, s24, v17
  v_exp_f32 v28, v16
  v_mfma_f32_16x16x32_bf16 v[60:63], v[72:75], v[20:23], 0
  v_exp_f32 v29, v17
  v_add_f32 v68, v68, v70
  v_mfma_f32_16x16x32_bf16 v[52:55], v[72:75], v[80:83], 0
  s_add_u32 s30, s25, 4096
  v_cvt_pk_bf16_f32 v28, v28, v29
  v_add_f32 v69, v69, v71
  v_mfma_f32_16x16x32_bf16 v[56:59], v[72:75], v[84:87], 0
  v_cndmask_b32 v77, 0, v28, s[18:19]
  v_cndmask_b32 v78, 0, v28, s[18:19]
  v_cvt_pk_bf16_f32 v67, v68, v69
  v_lshrrev_b32 v92, 1, v8
  v_mfma_f32_16x16x16_bf16 v[60:63], v[76:77], v[20:21], v[60:63]
  buffer_store_dwordx2 v[66:67], v92, s[4:7], s30 offen sc1
  v_max3_f32 v7, |v48|, |v49|, |v50|
  v_max_f32 v26, |v16|, |v17|
  v_mfma_f32_16x16x16_bf16 v[52:55], v[78:79], v[66:67], v[52:55]
  v_cndmask_b32 v26, 0, v26, s[18:19]
  v_max3_f32 v7, |v51|, v26, v7
  v_mfma_f32_16x16x16_bf16 v[56:59], v[76:77], v[66:67], v[56:59]
  v_cmp_lt_f32 vcc, 0x42700000, v7
  v_mov_b64 v[44:45], 0
  v_add_f32 v60, v60, v62
  v_add_f32 v61, v61, v63
  s_cbranch_vccnz c_fb_49
c_fbr_50:
  v_rcp_f32 v60, v60
  v_rcp_f32 v61, v61
  v_pk_add_f32 v[52:53], v[52:53], v[54:55]
  v_pk_add_f32 v[56:57], v[56:57], v[58:59]
  v_pk_mul_f32 v[52:53], v[52:53], v[60:61]
  v_pk_mul_f32 v[56:57], v[56:57], v[60:61]
  v_cvt_pk_bf16_f32 v54, v52, v53
  v_cvt_pk_bf16_f32 v55, v56, v57
  ds_write_b64 v2, v[54:55] offset:4096
  v_mov_b64 v[46:47], 0
  v_mov_b64 v[40:41], 0
  v_mov_b64 v[42:43], 0
  v_mov_b64 v[36:37], 0
  v_mov_b64 v[38:39], 0
  v_mov_b64 v[32:33], 0
  v_mov_b64 v[34:35], 0
  v_mov_b64 v[28:29], 0
  v_mov_b64 v[30:31], 0
  v_mov_b64 v[24:25], 0
  v_mov_b64 v[26:27], 0
  v_mov_b64 v[80:81], 0
  v_mov_b64 v[82:83], 0
  v_mov_b64 v[84:85], 0
  v_mov_b64 v[86:87], 0
  s_waitcnt lgkmcnt(0)
  s_barrier
  ds_read_b64_tr_b16 v[72:73], v3 offset:4096
  ds_read_b64_tr_b16 v[74:75], v3 offset:5120
  ds_read_b64_tr_b16 v[76:77], v3 offset:6144
  ds_read_b64_tr_b16 v[78:79], v3 offset:7168
  s_and_b32 s3, s21, 1
  s_add_u32 s21, s21, 1
  s_add_u32 s22, s22, 1
  s_and_b32 s42, s21, 3
  s_lshl_b32 s42, s42, 13
  s_cmp_eq_u32 s22, 64
  s_cbranch_scc1 c_last_52
  s_waitcnt lgkmcnt(2)
  v_smfmac_f32_16x16x64_bf16 v[44:47], v[72:75], a[248:255], v6
  s_waitcnt lgkmcnt(0)
  ds_read_b128 v[16:19], v8 offset:40960
  v_smfmac_f32_16x16x64_bf16 v[44:47], v[76:79], a[240:247], v6
  ds_read_b128 v[20:23], v8 offset:45056
  v_smfmac_f32_16x16x64_bf16 v[40:43], v[72:75], a[232:239], v6
  ds_read_b128 v[88:91], v8 offset:49152
  v_smfmac_f32_16x16x64_bf16 v[40:43], v[76:79], a[224:231], v6
  ds_read_b128 v[92:95], v8 offset:53248
  v_add_f32 v44, v44, v46
  v_add_f32 v45, v45, v47
  v_smfmac_f32_16x16x64_bf16 v[36:39], v[72:75], a[216:223], v6
  ds_read_b128 v[96:99], v8 offset:57344
  v_cvt_pk_bf16_f32 v48, v44, v45
  v_and_or_b32 v48, v48, -2, s3
  v_smfmac_f32_16x16x64_bf16 v[36:39], v[76:79], a[208:215], v6
  ds_read_b128 v[100:103], v8 offset:61440
  v_add_f32 v40, v40, v42
  v_add_f32 v41, v41, v43
  v_smfmac_f32_16x16x64_bf16 v[32:35], v[72:75], a[200:207], v6
  v_cvt_pk_bf16_f32 v49, v40, v41
  v_smfmac_f32_16x16x64_bf16 v[32:35], v[76:79], a[192:199], v6
  v_add_f32 v36, v36, v38
  v_add_f32 v37, v37, v39
  v_smfmac_f32_16x16x64_bf16 v[28:31], v[72:75], a[184:191], v6
  v_cvt_pk_bf16_f32 v50, v36, v37
  v_smfmac_f32_16x16x64_bf16 v[28:31], v[76:79], a[176:183], v6
  v_add_f32 v32, v32, v34
  v_add_f32 v33, v33, v35
  v_smfmac_f32_16x16x64_bf16 v[24:27], v[72:75], v[104:111], v6
  v_cvt_pk_bf16_f32 v51, v32, v33
  v_smfmac_f32_16x16x64_bf16 v[24:27], v[76:79], v[112:119], v6
  buffer_store_dwordx4 v[48:51], v4, s[4:7], s40 offen sc1
  v_add_f32 v28, v28, v30
  v_add_f32 v29, v29, v31
  v_smfmac_f32_16x16x64_bf16 v[80:83], v[72:75], v[120:127], v6
  s_waitcnt lgkmcnt(0)
  v_cvt_pk_bf16_f32 v52, v28, v29
  v_and_or_b32 v52, v52, -2, s3
  v_smfmac_f32_16x16x64_bf16 v[80:83], v[76:79], v[16:23], v6
  v_add_f32 v24, v24, v26
  v_add_f32 v25, v25, v27
  v_smfmac_f32_16x16x64_bf16 v[84:87], v[72:75], v[88:95], v6
  v_cvt_pk_bf16_f32 v53, v24, v25
  v_smfmac_f32_16x16x64_bf16 v[84:87], v[76:79], v[96:103], v6
  v_add_f32 v80, v80, v82
  v_add_f32 v81, v81, v83
  v_cvt_pk_bf16_f32 v54, v80, v81
  s_nop 0
  s_nop 3
  v_pk_add_f32 v[84:85], v[84:85], v[86:87]
  v_cvt_pk_bf16_f32 v55, v84, v85
  buffer_store_dwordx4 v[52:55], v4, s[4:7], s41 offen sc1
  s_add_u32 s42, s42, s62
  s_add_u32 s43, s42, 4096
  s_add_u32 s23, s23, 524288
  s_add_u32 s25, s25, 262144
  s_add_u32 s63, s63, 4096
  s_add_u32 s64, s64, 2048
  s_andn2_b32 s64, s64, s2
  s_add_u32 s97, s97, 8192
  s_add_u32 s92, s63, s20
  s_cmp_lg_u32 s17, 0
  s_cbranch_scc1 c_oth_64
  s_mov_b32 s28, 0
  s_add_u32 s46, s46, 1
  v_mov_b64 v[64:65], -1
  s_xor_b32 s34, s42, 16384
  buffer_store_dwordx2 v[64:65], v5, s[4:7], s34 offen sc1
  s_mov_b32 vcc_lo, 0xaaaaaaaa
  s_mov_b32 vcc_hi, 0xaaaaaaaa
  v_mov_b32 v7, 0x3f80
  v_cndmask_b32 v7, v7, 1.0, vcc
  s_mov_b32 vcc_lo, 0x30003
  s_mov_b32 vcc_hi, 0x30003
  v_cndmask_b32 v68, 0, v7, vcc
  s_mov_b32 vcc_lo, 0xc000c
  s_mov_b32 vcc_hi, 0xc000c
  v_cndmask_b32 v69, 0, v7, vcc
  s_mov_b32 vcc_lo, 0x300030
  s_mov_b32 vcc_hi, 0x300030
  v_cndmask_b32 v70, 0, v7, vcc
  s_mov_b32 vcc_lo, 0xc000c0
  s_mov_b32 vcc_hi, 0xc000c0
  v_cndmask_b32 v71, 0, v7, vcc
  ds_read_b128 v[104:107], v1 offset:14336
  ds_read_b128 v[108:111], v1 offset:15360
  s_waitcnt lgkmcnt(0)
  ds_read_b128 v[112:115], v1 offset:16384
  ds_read_b128 v[116:119], v1 offset:17408
  ds_read_b128 v[120:123], v1 offset:18432
  ds_read_b128 v[124:127], v1 offset:19456
  s_waitcnt lgkmcnt(0)
  buffer_load_dwordx4 v[16:19], v0, s[4:7], s38 offen offset:0 sc1
  buffer_load_dwordx4 v[20:23], v0, s[4:7], s38 offen offset:1024 sc1
  buffer_load_dwordx4 v[24:27], v0, s[4:7], s38 offen offset:2048 sc1
  buffer_load_dwordx4 v[28:31], v0, s[4:7], s38 offen offset:3072 sc1
  buffer_load_dwordx4 v[32:35], v0, s[4:7], s39 offen offset:0 sc1
  buffer_load_dwordx4 v[36:39], v0, s[4:7], s39 offen offset:1024 sc1
  buffer_load_dwordx4 v[40:43], v0, s[4:7], s39 offen offset:2048 sc1
  buffer_load_dwordx4 v[44:47], v0, s[4:7], s39 offen offset:3072 sc1
  buffer_load_dwordx4 v[72:75], v0, s[4:7], s38 offen offset:0 sc1
  buffer_load_dwordx4 v[76:79], v0, s[4:7], s38 offen offset:1024 sc1
  buffer_load_dwordx4 v[80:83], v0, s[4:7], s38 offen offset:2048 sc1
  buffer_load_dwordx4 v[84:87], v0, s[4:7], s38 offen offset:3072 sc1
  buffer_load_dwordx4 v[88:91], v0, s[4:7], s39 offen offset:0 sc1
  buffer_load_dwordx4 v[92:95], v0, s[4:7], s39 offen offset:1024 sc1
  buffer_load_dwordx4 v[96:99], v0, s[4:7], s39 offen offset:2048 sc1
  buffer_load_dwordx4 v[100:103], v0, s[4:7], s39 offen offset:3072 sc1
  s_buffer_load_dword s65, s[4:7], s63
  s_waitcnt vmcnt(15)
  v_mfma_f32_16x16x32_bf16 v[64:67], v[16:19], v[68:71], 0
  v_xor_b32 v7, s3, v16
  s_waitcnt vmcnt(14)
  v_mfma_f32_16x16x32_bf16 v[64:67], v[20:23], v[68:71], v[64:67]
  v_bitop3_b32 v7, v7, v20, s3 bitop3:0xf6
  s_waitcnt vmcnt(13)
  v_mfma_f32_16x16x32_bf16 v[64:67], v[24:27], v[68:71], v[64:67]
  v_bitop3_b32 v7, v7, v24, s3 bitop3:0xf6
  s_waitcnt vmcnt(12)
  v_mfma_f32_16x16x32_bf16 v[64:67], v[28:31], v[68:71], v[64:67]
  v_bitop3_b32 v7, v7, v28, s3 bitop3:0xf6
  s_waitcnt vmcnt(11)
  v_mfma_f32_16x16x32_bf16 v[64:67], v[32:35], v[68:71], v[64:67]
  v_bitop3_b32 v7, v7, v32, s3 bitop3:0xf6
  s_waitcnt vmcnt(10)
  v_mfma_f32_16x16x32_bf16 v[64:67], v[36:39], v[68:71], v[64:67]
  v_bitop3_b32 v7, v7, v36, s3 bitop3:0xf6
  s_waitcnt vmcnt(9)
  v_mfma_f32_16x16x32_bf16 v[64:67], v[40:43], v[68:71], v[64:67]
  v_bitop3_b32 v7, v7, v40, s3 bitop3:0xf6
  s_waitcnt vmcnt(8)
  v_mfma_f32_16x16x32_bf16 v[64:67], v[44:47], v[68:71], v[64:67]
  v_bitop3_b32 v7, v7, v44, s3 bitop3:0xf6
  v_and_b32 v7, 1, v7
  v_cmp_ne_u32 vcc, 0, v7
  v_mov_b32 v7, 0
  v_mov_b32 v7, 0
  s_cbranch_vccnz c_p1r_65
c_publ_66:
  s_nop 1
  s_nop 0
  v_cvt_pk_bf16_f32 v64, v64, v65
  v_cvt_pk_bf16_f32 v65, v66, v67
  v_min_u32 v64, -2, v64
  v_min_u32 v65, -2, v65
  buffer_store_dwordx2 v[64:65], v5, s[4:7], s42 offen sc1
  s_waitcnt vmcnt(1)
  ds_read_b128 v[24:27], v1 offset:0
  ds_read_b128 v[28:31], v1 offset:1024
  ds_read_b128 v[32:35], v1 offset:2048
  ds_read_b128 v[36:39], v1 offset:3072
  ds_read_b128 v[40:43], v1 offset:4096
  ds_read_b128 v[44:47], v1 offset:5120
  ds_read_b128 v[72:75], v1 offset:6144
  ds_read_b128 v[76:79], v1 offset:7168
  ds_read_b128 v[80:83], v1 offset:8192
  ds_read_b128 v[84:87], v1 offset:9216
  ds_read_b128 v[88:91], v1 offset:10240
  ds_read_b128 v[92:95], v1 offset:11264
  ds_read_b128 v[96:99], v1 offset:12288
  ds_read_b128 v[100:103], v1 offset:13312
c_hop2_48:
  s_barrier
  s_cmp_le_u32 s96, s23
  s_cbranch_scc1 c_loop_45
  s_cmp_lg_u32 s96, 268435456
  s_cbranch_scc1 c_fk0_67
  buffer_store_dwordx2 v[64:65], v5, s[4:7], s97 offen sc1
  s_mov_b32 s29, 0
  s_sub_u32 s92, s63, 4096
  s_sub_u32 s96, s23, 524288
  s_mov_b32 s95, 0
c_gw_68:
  buffer_load_dword v7, off, s[4:7], s92 sc1
  s_add_u32 s29, s29, 1
  s_cmp_gt_u32 s29, 1048576
  s_cbranch_scc1 c_fail_51
  s_waitcnt vmcnt(0) lgkmcnt(0)
  v_readfirstlane_b32 s65, v7
  s_cmp_eq_u32 s65, 0
  s_cbranch_scc1 c_gw_68
  s_and_b32 s65, s65, s93
  s_cbranch_scc1 c_kvx_70
  s_mov_b32 s95, 1
  s_add_u32 s96, s96, 33554432
  s_add_u32 s92, s92, 262144
c_kvw_69:
  buffer_load_dword v7, off, s[4:7], s92 sc1
  s_add_u32 s29, s29, 1
  s_cmp_gt_u32 s29, 1048576
  s_cbranch_scc1 c_fail_51
  s_waitcnt vmcnt(0) lgkmcnt(0)
  v_readfirstlane_b32 s65, v7
  s_cmp_eq_u32 s65, 0
  s_cbranch_scc1 c_kvw_69
c_kvx_70:
  buffer_load_dword v7, off, s[4:7], s63 sc1
  buffer_load_dwordx4 v0, s[4:7], s96 offen offset:0  lds
  buffer_load_dwordx4 v0, s[4:7], s96 offen offset:1024  lds
  buffer_load_dwordx4 v0, s[4:7], s96 offen offset:2048  lds
  buffer_load_dwordx4 v0, s[4:7], s96 offen offset:3072  lds
  s_waitcnt vmcnt(4)
  v_readfirstlane_b32 s65, v7
  s_mov_b32 s94, 0
  s_cmp_eq_u32 s95, 0
  s_cbranch_scc1 c_loop_45
c_fk0_67:
  s_mov_b32 s29, 0
c_fk_71:
  buffer_load_dwordx4 v[16:19], v8, s[4:7], s42 offen sc1
  buffer_load_dwordx4 v[20:23], v8, s[4:7], s43 offen sc1
  s_add_u32 s29, s29, 1
  s_cmp_gt_u32 s29, 1048576
  s_cbranch_scc1 c_fail_51
  s_waitcnt vmcnt(0)
  v_max3_u32 v7, v16, v17, v18
  v_max3_u32 v7, v19, v20, v7
  v_max3_u32 v7, v21, v22, v7
  v_max_u32 v7, v7, v23
  v_cmp_eq_u32 vcc, -1, v7
  s_cbranch_vccnz c_fk_71
c_fk1_72:
  s_lshl_b32 s42, s22, 13
  s_add_u32 s42, s42, 245891072
  s_add_u32 s43, s42, 4096
  s_mov_b32 s95, 0
  s_branch c_loop_45
c_xb_60:
  s_cmp_lg_u32 s93, 1
  s_cbranch_scc1 c_xr_61
  s_cmp_ge_u32 s22, 63
  s_cbranch_scc1 c_xr_61
c_xp_73:
  s_cmp_lg_u32 s65, 0
  s_cbranch_scc1 c_xs_74
  buffer_load_dword v7, off, s[4:7], s63 sc1
  s_add_u32 s29, s29, 1
  s_cmp_gt_u32 s29, 1048576
  s_cbranch_scc1 c_fail_51
  s_waitcnt vmcnt(0)
  v_readfirstlane_b32 s65, v7
  s_branch c_xp_73
c_xs_74:
  s_cmp_eq_u32 s65, 1
  s_cbranch_scc1 c_xr_61
  s_mov_b32 s29, 0
c_xw_75:
  buffer_load_dwordx4 v[16:19], v8, s[4:7], s42 offen sc1
  buffer_load_dwordx4 v[20:23], v8, s[4:7], s43 offen sc1
  s_add_u32 s29, s29, 1
  s_cmp_gt_u32 s29, 1048576
  s_cbranch_scc1 c_fail_51
  s_waitcnt vmcnt(0)
  v_max3_u32 v7, v16, v17, v18
  v_max3_u32 v7, v19, v20, v7
  v_max3_u32 v7, v21, v22, v7
  v_max_u32 v7, v7, v23
  v_cmp_eq_u32 vcc, -1, v7
  s_cbranch_vccnz c_xw_75
  v_mov_b32 v7, 1
  s_barrier
  s_mov_b64 exec, 1
  buffer_store_dword v7, off, s[4:7], s64 sc1
  s_mov_b64 exec, -1
  s_add_u32 s22, s22, 1
  s_add_u32 s23, s23, 524288
  s_add_u32 s25, s25, 262144
  s_add_u32 s63, s63, 4096
  s_add_u32 s64, s64, 2048
  s_andn2_b32 s64, s64, s2
  s_mov_b32 s29, 0
  s_sub_u32 s92, s63, 4096
  s_sub_u32 s96, s23, 524288
  s_mov_b32 s95, 0
  s_mov_b32 s95, 1
  s_add_u32 s96, s96, 33554432
  s_add_u32 s92, s92, 262144
c_kvw_77:
  buffer_load_dword v7, off, s[4:7], s92 sc1
  s_add_u32 s29, s29, 1
  s_cmp_gt_u32 s29, 1048576
  s_cbranch_scc1 c_fail_51
  s_waitcnt vmcnt(0) lgkmcnt(0)
  v_readfirstlane_b32 s65, v7
  s_cmp_eq_u32 s65, 0
  s_cbranch_scc1 c_kvw_77
c_kvx_78:
  buffer_load_dword v7, off, s[4:7], s63 sc1
  buffer_load_dwordx4 v0, s[4:7], s96 offen offset:0  lds
  buffer_load_dwordx4 v0, s[4:7], s96 offen offset:1024  lds
  buffer_load_dwordx4 v0, s[4:7], s96 offen offset:2048  lds
  buffer_load_dwordx4 v0, s[4:7], s96 offen offset:3072  lds
  s_waitcnt vmcnt(4)
  v_readfirstlane_b32 s65, v7
  s_mov_b32 s94, 0
  s_branch c_fk1_72
c_last_52:
  s_add_u32 s64, s64, 2048
  v_mov_b32 v7, 1
  s_waitcnt vmcnt(0)
  s_barrier
  s_mov_b64 exec, 1
  buffer_store_dword v7, off, s[4:7], s64 sc1
  s_mov_b64 exec, -1
  s_branch L_chdone
c_oth_64:
  s_buffer_load_dword s65, s[4:7], s63
  ds_read_b128 v[24:27], v1 offset:0
  ds_read_b128 v[28:31], v1 offset:1024
  ds_read_b128 v[32:35], v1 offset:2048
  ds_read_b128 v[36:39], v1 offset:3072
  ds_read_b128 v[40:43], v1 offset:4096
  ds_read_b128 v[44:47], v1 offset:5120
  ds_read_b128 v[72:75], v1 offset:6144
  ds_read_b128 v[76:79], v1 offset:7168
  ds_read_b128 v[80:83], v1 offset:8192
  ds_read_b128 v[84:87], v1 offset:9216
  ds_read_b128 v[88:91], v1 offset:10240
  ds_read_b128 v[92:95], v1 offset:11264
  ds_read_b128 v[96:99], v1 offset:12288
  ds_read_b128 v[100:103], v1 offset:13312
  ds_read_b128 v[104:107], v1 offset:14336
  ds_read_b128 v[108:111], v1 offset:15360
  ds_read_b128 v[112:115], v1 offset:16384
  ds_read_b128 v[116:119], v1 offset:17408
  ds_read_b128 v[120:123], v1 offset:18432
  ds_read_b128 v[124:127], v1 offset:19456
  s_branch c_hop2_48
c_p1r_65:
  s_waitcnt vmcnt(7)
  s_nop 0
  v_mfma_f32_16x16x32_bf16 v[64:67], v[72:75], v[68:71], 0
  v_xor_b32 v7, s3, v72
  s_waitcnt vmcnt(6)
  v_mfma_f32_16x16x32_bf16 v[64:67], v[76:79], v[68:71], v[64:67]
  v_bitop3_b32 v7, v7, v76, s3 bitop3:0xf6
  s_waitcnt vmcnt(5)
  v_mfma_f32_16x16x32_bf16 v[64:67], v[80:83], v[68:71], v[64:67]
  v_bitop3_b32 v7, v7, v80, s3 bitop3:0xf6
  s_waitcnt vmcnt(4)
  v_mfma_f32_16x16x32_bf16 v[64:67], v[84:87], v[68:71], v[64:67]
  v_bitop3_b32 v7, v7, v84, s3 bitop3:0xf6
  s_waitcnt vmcnt(3)
  v_mfma_f32_16x16x32_bf16 v[64:67], v[88:91], v[68:71], v[64:67]
  v_bitop3_b32 v7, v7, v88, s3 bitop3:0xf6
  s_waitcnt vmcnt(2)
  v_mfma_f32_16x16x32_bf16 v[64:67], v[92:95], v[68:71], v[64:67]
  v_bitop3_b32 v7, v7, v92, s3 bitop3:0xf6
  s_waitcnt vmcnt(1)
  v_mfma_f32_16x16x32_bf16 v[64:67], v[96:99], v[68:71], v[64:67]
  v_bitop3_b32 v7, v7, v96, s3 bitop3:0xf6
  s_waitcnt vmcnt(0)
  v_mfma_f32_16x16x32_bf16 v[64:67], v[100:103], v[68:71], v[64:67]
  v_bitop3_b32 v7, v7, v100, s3 bitop3:0xf6
  v_and_b32 v7, 1, v7
  v_cmp_ne_u32 vcc, 0, v7
  s_add_u32 s46, s46, 1
  s_cbranch_vccz c_publ_66
  buffer_load_dwordx4 v[72:75], v0, s[4:7], s38 offen offset:0 sc1
  buffer_load_dwordx4 v[76:79], v0, s[4:7], s38 offen offset:1024 sc1
  buffer_load_dwordx4 v[80:83], v0, s[4:7], s38 offen offset:2048 sc1
  buffer_load_dwordx4 v[84:87], v0, s[4:7], s38 offen offset:3072 sc1
  buffer_load_dwordx4 v[88:91], v0, s[4:7], s39 offen offset:0 sc1
  buffer_load_dwordx4 v[92:95], v0, s[4:7], s39 offen offset:1024 sc1
  buffer_load_dwordx4 v[96:99], v0, s[4:7], s39 offen offset:2048 sc1
  buffer_load_dwordx4 v[100:103], v0, s[4:7], s39 offen offset:3072 sc1
  s_add_u32 s28, s28, 1
  s_cmp_gt_u32 s28, 1048576
  s_cbranch_scc0 c_p1r_65
  s_branch c_fail_51
c_retry_46:
  v_mov_b64 v[48:49], 0
  v_mov_b64 v[50:51], 0
  s_nop 0
  v_mov_b64 v[52:53], 0
  v_mov_b64 v[54:55], 0
  s_nop 1
  v_mov_b64 v[56:57], 0
  v_mov_b64 v[58:59], 0
c_rl_79:
  buffer_load_dwordx4 v[16:19], v8, s[4:7], s42 offen sc1
  buffer_load_dwordx4 v[20:23], v8, s[4:7], s43 offen sc1
  s_add_u32 s28, s28, 1
  s_add_u32 s47, s47, 1
  s_cmp_gt_u32 s28, 1048576
  s_cbranch_scc1 c_fail_51
  s_waitcnt vmcnt(2)
  v_max3_u32 v7, v16, v17, v18
  v_max3_u32 v7, v19, v20, v7
  v_max3_u32 v7, v21, v22, v7
  v_max_u32 v7, v7, v23
  v_cmp_eq_u32 vcc, -1, v7
  s_cbranch_vccnz c_rl_79
  ds_write_b128 v8, v[16:19] offset:4096
  v_smfmac_f32_16x16x64_bf16 v[48:51], v[16:19], v[24:31], v6
  ds_write_b128 v8, v[20:23] offset:8192
  v_smfmac_f32_16x16x64_bf16 v[52:55], v[16:19], v[32:39], v6
  v_smfmac_f32_16x16x64_bf16 v[56:59], v[16:19], v[40:47], v6
  s_branch c_got_47
c_fb_49:
  v_max3_f32 v7, v48, v49, v50
  v_max_f32 v7, v51, v7
  s_mov_b64 exec, s[18:19]
  v_max3_f32 v7, v16, v17, v7
  s_mov_b64 exec, -1
  s_nop 0
  v_max_f32_dpp v7, v7, v7 quad_perm:[2,3,0,1] row_mask:0xf bank_mask:0xf
  v_mov_b32 v24, v7
  s_nop 0
  s_nop 0
  v_permlane16_swap_b32 v7, v24
  v_max_f32 v7, v7, v24
  v_mov_b32 v24, v7
  s_nop 0
  s_nop 0
  v_permlane32_swap_b32 v7, v24
  v_max_f32 v7, v7, v24
  v_sub_f32 v24, v48, v7
  v_sub_f32 v25, v49, v7
  v_sub_f32 v26, v50, v7
  v_sub_f32 v27, v51, v7
  v_sub_f32 v28, v16, v7
  v_sub_f32 v29, v17, v7
  v_exp_f32 v24, v24
  v_exp_f32 v25, v25
  v_exp_f32 v26, v26
  v_exp_f32 v27, v27
  v_exp_f32 v28, v28
  v_exp_f32 v29, v29
  v_cvt_pk_bf16_f32 v24, v24, v25
  v_cvt_pk_bf16_f32 v25, v26, v27
  v_cvt_pk_bf16_f32 v28, v28, v29
  v_cndmask_b32 v72, v24, 0, s[18:19]
  v_cndmask_b32 v73, v25, 0, s[18:19]
  v_cndmask_b32 v74, 0, v24, s[18:19]
  v_cndmask_b32 v75, 0, v25, s[18:19]
  v_cndmask_b32 v77, 0, v28, s[18:19]
  v_cndmask_b32 v78, 0, v28, s[18:19]
  v_mfma_f32_16x16x32_bf16 v[60:63], v[72:75], v[20:23], 0
  v_mfma_f32_16x16x32_bf16 v[52:55], v[72:75], v[80:83], 0
  v_mfma_f32_16x16x32_bf16 v[56:59], v[72:75], v[84:87], 0
  v_mfma_f32_16x16x16_bf16 v[60:63], v[76:77], v[20:21], v[60:63]
  v_mfma_f32_16x16x16_bf16 v[52:55], v[78:79], v[66:67], v[52:55]
  s_nop 2
  v_mfma_f32_16x16x16_bf16 v[56:59], v[76:77], v[66:67], v[56:59]
  s_nop 7
  v_add_f32 v60, v60, v62
  v_add_f32 v61, v61, v63
  s_branch c_fbr_50
c_fail_51:
  s_endpgm
L_chdone:
  s_cmp_lg_u32 s91, 0
  s_cbranch_scc1 L_end
  s_lshr_b32 s91, s90, 4
  s_add_u32 s91, s91, 7
  v_lshrrev_b32 v0, 4, v0
  s_waitcnt vmcnt(0) lgkmcnt(0)
  v_mbcnt_lo_u32_b32 v20, -1, 0
  v_and_b32 v20, 3, v20
  v_add_lshl_u32 v20, v20, 0, 2
  s_mov_b32 s26, 0
g_wt_80:
  global_load_dword v21, v20, s[12:13] offset:128 sc1
  s_add_u32 s26, s26, 1
  s_cmp_gt_u32 s26, 1048576
  s_cbranch_scc1 L_end
  s_waitcnt vmcnt(0)
  v_cmp_eq_u32 vcc, 0, v21
  v_readfirstlane_b32 s27, v21
  s_cbranch_vccnz g_wt_80
  s_mov_b32 s89, s27
  s_branch L_o
L_qkv:
  s_mul_i32 s26, s91, 15
  s_add_u32 s26, s26, s90
  s_sub_u32 s26, s26, 61
  s_add_u32 s27, s91, 89
  s_cmp_eq_u32 s90, 31
  s_cselect_b32 s26, s27, s26
  s_add_u32 s27, s90, 60
  s_cmp_eq_u32 s91, 7
  s_cselect_b32 s26, s27, s26
  s_mul_i32 s16, s26, 171
  s_lshr_b32 s16, s16, 9
  s_mul_i32 s27, s16, 3
  s_sub_u32 s60, s26, s27
  s_add_u32 s16, s16, 4
  s_and_b32 s16, s16, 31
  v_and_b32 v19, 63, v0
  v_and_b32 v6, 15, v19
  v_lshrrev_b32 v7, 4, v19
  v_lshlrev_b32 v1, 2, v19
  v_lshlrev_b32 v0, 4, v19
  v_lshlrev_b32 v9, 7, v19
  s_mov_b32 s24, 0x3e0293ee
  s_lshl_b32 s57, s16, 2
  s_add_u32 s57, s57, s17
  v_and_b32 v24, 1, v7
  v_lshlrev_b32 v24, 10, v24
  v_lshl_add_u32 v24, v6, 4, v24
  v_lshrrev_b32 v25, 1, v7
  v_lshl_add_u32 v8, v25, 8, v24
  v_lshrrev_b32 v96, 9, v0
  v_lshlrev_b32 v96, 4, v96
  v_and_b32 v97, 0xf0, v0
  v_xor_b32 v96, v96, v97
  v_and_b32 v97, 0x1f0, v0
  v_lshl_add_u32 v96, v97, 6, v96
  v_xor_b32 v120, 0, v96
  v_xor_b32 v121, 32, v96
  v_xor_b32 v122, 64, v96
  v_xor_b32 v123, 96, v96
  v_xor_b32 v124, 128, v96
  v_xor_b32 v125, 160, v96
  v_xor_b32 v126, 192, v96
  v_xor_b32 v127, 224, v96
  s_and_b32 s26, s17, 1
  s_lshl_b32 s26, s26, 7
  v_xor_b32 v96, s26, v0
  v_xor_b32 v12, 0, v96
  v_xor_b32 v13, 16, v96
  v_xor_b32 v14, 32, v96
  v_xor_b32 v15, 48, v96
  v_xor_b32 v16, 64, v96
  v_xor_b32 v17, 80, v96
  v_xor_b32 v18, 96, v96
  v_xor_b32 v19, 112, v96
  s_lshl_b32 s26, s17, 2
  s_add_u32 s26, s26, 162816
  v_lshrrev_b32 v24, 7, v0
  v_lshl_add_u32 v118, v24, 4, s26
  v_and_b32 v24, 48, v0
  v_add_u32 v119, 162816, v24
  v_lshrrev_b32 v25, 8, v0
  v_and_b32 v20, 0xf0, v0
  v_lshlrev_b32 v21, 6, v25
  v_xor_b32 v20, v20, v21
  v_lshl_add_u32 v20, v25, 13, v20
  v_xor_b32 v21, 32, v20
  s_load_dwordx2 s[64:65], s[0:1], 24
  s_load_dwordx2 s[68:69], s[0:1], 32
  s_load_dwordx2 s[8:9], s[0:1], 16
  s_mov_b32 s10, 4194304
  s_mov_b32 s11, 0x20000
  s_mov_b32 s66, 4194304
  s_mov_b32 s67, 0x20000
  s_mov_b32 s70, 4194304
  s_mov_b32 s71, 0x20000
  v_lshrrev_b32 v25, 2, v6
  v_lshrrev_b32 v26, 1, v7
  v_lshl_add_u32 v27, v26, 3, v25
  v_lshlrev_b32 v27, 8, v27
  v_lshl_add_u32 v26, v25, 1, v26
  v_and_b32 v25, 1, v7
  v_xor_b32 v26, v26, v25
  s_lshl_b32 s26, s17, 1
  v_xor_b32 v26, s26, v26
  v_lshl_add_u32 v27, v26, 5, v27
  v_and_b32 v25, 3, v6
  v_lshl_add_u32 v22, v25, 3, v27
  v_add_u32 v23, 65536, v22
  v_add_u32 v24, 131072, v22
  s_lshl_b32 s28, s17, 13
  s_lshl_b32 s26, s17, 18
  s_lshl_b32 s27, s16, 8
  s_add_u32 s26, s26, s27
  s_waitcnt lgkmcnt(0)
  s_cmp_eq_u32 s60, 1
  s_cbranch_scc1 q_ld_82
  s_cmp_eq_u32 s60, 2
  s_cbranch_scc1 q_ld_83
q_ld_81:
  s_add_u32 s27, s26, 0
  s_add_u32 m0, s28, 0
  s_nop 0
  buffer_load_dwordx4 v20, s[64:67], s27 offen lds
  s_add_u32 m0, s28, 1024
  s_add_u32 s27, s27, 32768
  buffer_load_dwordx4 v20, s[64:67], s27 offen lds
  s_add_u32 m0, s28, 2048
  s_add_u32 s27, s27, 32768
  buffer_load_dwordx4 v21, s[64:67], s27 offen lds
  s_add_u32 m0, s28, 3072
  s_add_u32 s27, s27, 32768
  buffer_load_dwordx4 v21, s[64:67], s27 offen lds
  s_add_u32 m0, s28, 4096
  s_add_u32 s27, s27, 32768
  buffer_load_dwordx4 v20, s[64:67], s27 offen lds
  s_add_u32 m0, s28, 5120
  s_add_u32 s27, s27, 32768
  buffer_load_dwordx4 v20, s[64:67], s27 offen lds
  s_add_u32 m0, s28, 6144
  s_add_u32 s27, s27, 32768
  buffer_load_dwordx4 v21, s[64:67], s27 offen lds
  s_add_u32 m0, s28, 7168
  s_add_u32 s27, s27, 32768
  buffer_load_dwordx4 v21, s[64:67], s27 offen lds
  s_add_u32 s27, s26, 1048576
  s_add_u32 m0, s28, 32768
  s_nop 0
  buffer_load_dwordx4 v20, s[64:67], s27 offen lds
  s_add_u32 m0, s28, 33792
  s_add_u32 s27, s27, 32768
  buffer_load_dwordx4 v20, s[64:67], s27 offen lds
  s_add_u32 m0, s28, 34816
  s_add_u32 s27, s27, 32768
  buffer_load_dwordx4 v21, s[64:67], s27 offen lds
  s_add_u32 m0, s28, 35840
  s_add_u32 s27, s27, 32768
  buffer_load_dwordx4 v21, s[64:67], s27 offen lds
  s_add_u32 m0, s28, 36864
  s_add_u32 s27, s27, 32768
  buffer_load_dwordx4 v20, s[64:67], s27 offen lds
  s_add_u32 m0, s28, 37888
  s_add_u32 s27, s27, 32768
  buffer_load_dwordx4 v20, s[64:67], s27 offen lds
  s_add_u32 m0, s28, 38912
  s_add_u32 s27, s27, 32768
  buffer_load_dwordx4 v21, s[64:67], s27 offen lds
  s_add_u32 m0, s28, 39936
  s_add_u32 s27, s27, 32768
  buffer_load_dwordx4 v21, s[64:67], s27 offen lds
  s_add_u32 s27, s26, 2097152
  s_add_u32 m0, s28, 65536
  s_nop 0
  buffer_load_dwordx4 v20, s[64:67], s27 offen lds
  s_add_u32 m0, s28, 66560
  s_add_u32 s27, s27, 32768
  buffer_load_dwordx4 v20, s[64:67], s27 offen lds
  s_add_u32 m0, s28, 67584
  s_add_u32 s27, s27, 32768
  buffer_load_dwordx4 v21, s[64:67], s27 offen lds
  s_add_u32 m0, s28, 68608
  s_add_u32 s27, s27, 32768
  buffer_load_dwordx4 v21, s[64:67], s27 offen lds
  s_add_u32 m0, s28, 69632
  s_add_u32 s27, s27, 32768
  buffer_load_dwordx4 v20, s[64:67], s27 offen lds
  s_add_u32 m0, s28, 70656
  s_add_u32 s27, s27, 32768
  buffer_load_dwordx4 v20, s[64:67], s27 offen lds
  s_add_u32 m0, s28, 71680
  s_add_u32 s27, s27, 32768
  buffer_load_dwordx4 v21, s[64:67], s27 offen lds
  s_add_u32 m0, s28, 72704
  s_add_u32 s27, s27, 32768
  buffer_load_dwordx4 v21, s[64:67], s27 offen lds
  s_load_dwordx2 s[4:5], s[0:1], 112
  s_load_dwordx2 s[12:13], s[0:1], 104
  s_waitcnt vmcnt(16)
  s_barrier
  s_add_u32 s27, s26, 3145728
  s_add_u32 m0, s28, 98304
  s_nop 0
  buffer_load_dwordx4 v20, s[64:67], s27 offen lds
  s_add_u32 m0, s28, 99328
  s_add_u32 s27, s27, 32768
  buffer_load_dwordx4 v20, s[64:67], s27 offen lds
  s_add_u32 m0, s28, 100352
  s_add_u32 s27, s27, 32768
  buffer_load_dwordx4 v21, s[64:67], s27 offen lds
  s_add_u32 m0, s28, 101376
  s_add_u32 s27, s27, 32768
  buffer_load_dwordx4 v21, s[64:67], s27 offen lds
  s_add_u32 m0, s28, 102400
  s_add_u32 s27, s27, 32768
  buffer_load_dwordx4 v20, s[64:67], s27 offen lds
  s_add_u32 m0, s28, 103424
  s_add_u32 s27, s27, 32768
  buffer_load_dwordx4 v20, s[64:67], s27 offen lds
  s_add_u32 m0, s28, 104448
  s_add_u32 s27, s27, 32768
  buffer_load_dwordx4 v21, s[64:67], s27 offen lds
  s_add_u32 m0, s28, 105472
  s_add_u32 s27, s27, 32768
  buffer_load_dwordx4 v21, s[64:67], s27 offen lds
  ds_read_b64_tr_b16 v[128:129], v22 offset:0
  ds_read_b64_tr_b16 v[130:131], v22 offset:1024
  ds_read_b64_tr_b16 v[132:133], v22 offset:4096
  ds_read_b64_tr_b16 v[134:135], v22 offset:5120
  ds_read_b64_tr_b16 v[136:137], v22 offset:8192
  ds_read_b64_tr_b16 v[138:139], v22 offset:9216
  ds_read_b64_tr_b16 v[140:141], v22 offset:12288
  ds_read_b64_tr_b16 v[142:143], v22 offset:13312
  ds_read_b64_tr_b16 v[144:145], v22 offset:16384
  ds_read_b64_tr_b16 v[146:147], v22 offset:17408
  ds_read_b64_tr_b16 v[148:149], v22 offset:20480
  ds_read_b64_tr_b16 v[150:151], v22 offset:21504
  ds_read_b64_tr_b16 v[152:153], v22 offset:24576
  ds_read_b64_tr_b16 v[154:155], v22 offset:25600
  ds_read_b64_tr_b16 v[156:157], v22 offset:28672
  ds_read_b64_tr_b16 v[158:159], v22 offset:29696
  s_waitcnt lgkmcnt(0)
  s_waitcnt vmcnt(16)
  s_barrier
  s_add_u32 s27, s26, 0
  s_add_u32 m0, s28, 131072
  s_nop 0
  buffer_load_dwordx4 v20, s[68:71], s27 offen lds
  s_add_u32 m0, s28, 132096
  s_add_u32 s27, s27, 32768
  buffer_load_dwordx4 v20, s[68:71], s27 offen lds
  s_add_u32 m0, s28, 133120
  s_add_u32 s27, s27, 32768
  buffer_load_dwordx4 v21, s[68:71], s27 offen lds
  s_add_u32 m0, s28, 134144
  s_add_u32 s27, s27, 32768
  buffer_load_dwordx4 v21, s[68:71], s27 offen lds
  s_add_u32 m0, s28, 135168
  s_add_u32 s27, s27, 32768
  buffer_load_dwordx4 v20, s[68:71], s27 offen lds
  s_add_u32 m0, s28, 136192
  s_add_u32 s27, s27, 32768
  buffer_load_dwordx4 v20, s[68:71], s27 offen lds
  s_add_u32 m0, s28, 137216
  s_add_u32 s27, s27, 32768
  buffer_load_dwordx4 v21, s[68:71], s27 offen lds
  s_add_u32 m0, s28, 138240
  s_add_u32 s27, s27, 32768
  buffer_load_dwordx4 v21, s[68:71], s27 offen lds
  ds_read_b64_tr_b16 v[160:161], v22 offset:32768
  ds_read_b64_tr_b16 v[162:163], v22 offset:33792
  ds_read_b64_tr_b16 v[164:165], v22 offset:36864
  ds_read_b64_tr_b16 v[166:167], v22 offset:37888
  ds_read_b64_tr_b16 v[168:169], v22 offset:40960
  ds_read_b64_tr_b16 v[170:171], v22 offset:41984
  ds_read_b64_tr_b16 v[172:173], v22 offset:45056
  ds_read_b64_tr_b16 v[174:175], v22 offset:46080
  ds_read_b64_tr_b16 v[176:177], v22 offset:49152
  ds_read_b64_tr_b16 v[178:179], v22 offset:50176
  ds_read_b64_tr_b16 v[180:181], v22 offset:53248
  ds_read_b64_tr_b16 v[182:183], v22 offset:54272
  ds_read_b64_tr_b16 v[184:185], v22 offset:57344
  ds_read_b64_tr_b16 v[186:187], v22 offset:58368
  ds_read_b64_tr_b16 v[188:189], v22 offset:61440
  ds_read_b64_tr_b16 v[190:191], v22 offset:62464
  s_waitcnt lgkmcnt(0)
  s_waitcnt vmcnt(16)
  s_barrier
  s_add_u32 s27, s26, 1048576
  s_add_u32 m0, s28, 0
  s_nop 0
  buffer_load_dwordx4 v20, s[68:71], s27 offen lds
  s_add_u32 m0, s28, 1024
  s_add_u32 s27, s27, 32768
  buffer_load_dwordx4 v20, s[68:71], s27 offen lds
  s_add_u32 m0, s28, 2048
  s_add_u32 s27, s27, 32768
  buffer_load_dwordx4 v21, s[68:71], s27 offen lds
  s_add_u32 m0, s28, 3072
  s_add_u32 s27, s27, 32768
  buffer_load_dwordx4 v21, s[68:71], s27 offen lds
  s_add_u32 m0, s28, 4096
  s_add_u32 s27, s27, 32768
  buffer_load_dwordx4 v20, s[68:71], s27 offen lds
  s_add_u32 m0, s28, 5120
  s_add_u32 s27, s27, 32768
  buffer_load_dwordx4 v20, s[68:71], s27 offen lds
  s_add_u32 m0, s28, 6144
  s_add_u32 s27, s27, 32768
  buffer_load_dwordx4 v21, s[68:71], s27 offen lds
  s_add_u32 m0, s28, 7168
  s_add_u32 s27, s27, 32768
  buffer_load_dwordx4 v21, s[68:71], s27 offen lds
  ds_read_b64_tr_b16 v[192:193], v23 offset:0
  ds_read_b64_tr_b16 v[194:195], v23 offset:1024
  ds_read_b64_tr_b16 v[196:197], v23 offset:4096
  ds_read_b64_tr_b16 v[198:199], v23 offset:5120
  ds_read_b64_tr_b16 v[200:201], v23 offset:8192
  ds_read_b64_tr_b16 v[202:203], v23 offset:9216
  ds_read_b64_tr_b16 v[204:205], v23 offset:12288
  ds_read_b64_tr_b16 v[206:207], v23 offset:13312
  ds_read_b64_tr_b16 v[208:209], v23 offset:16384
  ds_read_b64_tr_b16 v[210:211], v23 offset:17408
  ds_read_b64_tr_b16 v[212:213], v23 offset:20480
  ds_read_b64_tr_b16 v[214:215], v23 offset:21504
  ds_read_b64_tr_b16 v[216:217], v23 offset:24576
  ds_read_b64_tr_b16 v[218:219], v23 offset:25600
  ds_read_b64_tr_b16 v[220:221], v23 offset:28672
  ds_read_b64_tr_b16 v[222:223], v23 offset:29696
  s_waitcnt lgkmcnt(0)
  s_waitcnt vmcnt(16)
  s_barrier
  s_add_u32 s27, s26, 2097152
  s_add_u32 m0, s28, 32768
  s_nop 0
  buffer_load_dwordx4 v20, s[68:71], s27 offen lds
  s_add_u32 m0, s28, 33792
  s_add_u32 s27, s27, 32768
  buffer_load_dwordx4 v20, s[68:71], s27 offen lds
  s_add_u32 m0, s28, 34816
  s_add_u32 s27, s27, 32768
  buffer_load_dwordx4 v21, s[68:71], s27 offen lds
  s_add_u32 m0, s28, 35840
  s_add_u32 s27, s27, 32768
  buffer_load_dwordx4 v21, s[68:71], s27 offen lds
  s_add_u32 m0, s28, 36864
  s_add_u32 s27, s27, 32768
  buffer_load_dwordx4 v20, s[68:71], s27 offen lds
  s_add_u32 m0, s28, 37888
  s_add_u32 s27, s27, 32768
  buffer_load_dwordx4 v20, s[68:71], s27 offen lds
  s_add_u32 m0, s28, 38912
  s_add_u32 s27, s27, 32768
  buffer_load_dwordx4 v21, s[68:71], s27 offen lds
  s_add_u32 m0, s28, 39936
  s_add_u32 s27, s27, 32768
  buffer_load_dwordx4 v21, s[68:71], s27 offen lds
  ds_read_b64_tr_b16 v[224:225], v23 offset:32768
  ds_read_b64_tr_b16 v[226:227], v23 offset:33792
  ds_read_b64_tr_b16 v[228:229], v23 offset:36864
  ds_read_b64_tr_b16 v[230:231], v23 offset:37888
  ds_read_b64_tr_b16 v[232:233], v23 offset:40960
  ds_read_b64_tr_b16 v[234:235], v23 offset:41984
  ds_read_b64_tr_b16 v[236:237], v23 offset:45056
  ds_read_b64_tr_b16 v[238:239], v23 offset:46080
  ds_read_b64_tr_b16 v[240:241], v23 offset:49152
  ds_read_b64_tr_b16 v[242:243], v23 offset:50176
  ds_read_b64_tr_b16 v[244:245], v23 offset:53248
  ds_read_b64_tr_b16 v[246:247], v23 offset:54272
  ds_read_b64_tr_b16 v[248:249], v23 offset:57344
  ds_read_b64_tr_b16 v[250:251], v23 offset:58368
  ds_read_b64_tr_b16 v[252:253], v23 offset:61440
  ds_read_b64_tr_b16 v[254:255], v23 offset:62464
  s_waitcnt lgkmcnt(0)
  s_waitcnt vmcnt(16)
  s_barrier
  s_add_u32 s27, s26, 3145728
  s_add_u32 m0, s28, 65536
  s_nop 0
  buffer_load_dwordx4 v20, s[68:71], s27 offen lds
  s_add_u32 m0, s28, 66560
  s_add_u32 s27, s27, 32768
  buffer_load_dwordx4 v20, s[68:71], s27 offen lds
  s_add_u32 m0, s28, 67584
  s_add_u32 s27, s27, 32768
  buffer_load_dwordx4 v21, s[68:71], s27 offen lds
  s_add_u32 m0, s28, 68608
  s_add_u32 s27, s27, 32768
  buffer_load_dwordx4 v21, s[68:71], s27 offen lds
  s_add_u32 m0, s28, 69632
  s_add_u32 s27, s27, 32768
  buffer_load_dwordx4 v20, s[68:71], s27 offen lds
  s_add_u32 m0, s28, 70656
  s_add_u32 s27, s27, 32768
  buffer_load_dwordx4 v20, s[68:71], s27 offen lds
  s_add_u32 m0, s28, 71680
  s_add_u32 s27, s27, 32768
  buffer_load_dwordx4 v21, s[68:71], s27 offen lds
  s_add_u32 m0, s28, 72704
  s_add_u32 s27, s27, 32768
  buffer_load_dwordx4 v21, s[68:71], s27 offen lds
  ds_read_b64_tr_b16 a[0:1], v24 offset:0
  ds_read_b64_tr_b16 a[2:3], v24 offset:1024
  ds_read_b64_tr_b16 a[4:5], v24 offset:4096
  ds_read_b64_tr_b16 a[6:7], v24 offset:5120
  ds_read_b64_tr_b16 a[8:9], v24 offset:8192
  ds_read_b64_tr_b16 a[10:11], v24 offset:9216
  ds_read_b64_tr_b16 a[12:13], v24 offset:12288
  ds_read_b64_tr_b16 a[14:15], v24 offset:13312
  ds_read_b64_tr_b16 a[16:17], v24 offset:16384
  ds_read_b64_tr_b16 a[18:19], v24 offset:17408
  ds_read_b64_tr_b16 a[20:21], v24 offset:20480
  ds_read_b64_tr_b16 a[22:23], v24 offset:21504
  ds_read_b64_tr_b16 a[24:25], v24 offset:24576
  ds_read_b64_tr_b16 a[26:27], v24 offset:25600
  ds_read_b64_tr_b16 a[28:29], v24 offset:28672
  ds_read_b64_tr_b16 a[30:31], v24 offset:29696
  s_waitcnt lgkmcnt(0)
  s_waitcnt vmcnt(16)
  s_barrier
  s_add_u32 s27, s26, 0
  s_add_u32 m0, s28, 98304
  s_nop 0
  buffer_load_dwordx4 v20, s[8:11], s27 offen lds
  s_add_u32 m0, s28, 99328
  s_add_u32 s27, s27, 32768
  buffer_load_dwordx4 v20, s[8:11], s27 offen lds
  s_add_u32 m0, s28, 100352
  s_add_u32 s27, s27, 32768
  buffer_load_dwordx4 v21, s[8:11], s27 offen lds
  s_add_u32 m0, s28, 101376
  s_add_u32 s27, s27, 32768
  buffer_load_dwordx4 v21, s[8:11], s27 offen lds
  s_add_u32 m0, s28, 102400
  s_add_u32 s27, s27, 32768
  buffer_load_dwordx4 v20, s[8:11], s27 offen lds
  s_add_u32 m0, s28, 103424
  s_add_u32 s27, s27, 32768
  buffer_load_dwordx4 v20, s[8:11], s27 offen lds
  s_add_u32 m0, s28, 104448
  s_add_u32 s27, s27, 32768
  buffer_load_dwordx4 v21, s[8:11], s27 offen lds
  s_add_u32 m0, s28, 105472
  s_add_u32 s27, s27, 32768
  buffer_load_dwordx4 v21, s[8:11], s27 offen lds
  ds_read_b64_tr_b16 a[32:33], v22 offset:0
  ds_read_b64_tr_b16 a[34:35], v22 offset:1024
  ds_read_b64_tr_b16 a[36:37], v22 offset:4096
  ds_read_b64_tr_b16 a[38:39], v22 offset:5120
  ds_read_b64_tr_b16 a[40:41], v22 offset:8192
  ds_read_b64_tr_b16 a[42:43], v22 offset:9216
  ds_read_b64_tr_b16 a[44:45], v22 offset:12288
  ds_read_b64_tr_b16 a[46:47], v22 offset:13312
  ds_read_b64_tr_b16 a[48:49], v22 offset:16384
  ds_read_b64_tr_b16 a[50:51], v22 offset:17408
  ds_read_b64_tr_b16 a[52:53], v22 offset:20480
  ds_read_b64_tr_b16 a[54:55], v22 offset:21504
  ds_read_b64_tr_b16 a[56:57], v22 offset:24576
  ds_read_b64_tr_b16 a[58:59], v22 offset:25600
  ds_read_b64_tr_b16 a[60:61], v22 offset:28672
  ds_read_b64_tr_b16 a[62:63], v22 offset:29696
  s_waitcnt lgkmcnt(0)
  s_waitcnt vmcnt(16)
  s_barrier
  s_add_u32 s27, s26, 1048576
  s_add_u32 m0, s28, 131072
  s_nop 0
  buffer_load_dwordx4 v20, s[8:11], s27 offen lds
  s_add_u32 m0, s28, 132096
  s_add_u32 s27, s27, 32768
  buffer_load_dwordx4 v20, s[8:11], s27 offen lds
  s_add_u32 m0, s28, 133120
  s_add_u32 s27, s27, 32768
  buffer_load_dwordx4 v21, s[8:11], s27 offen lds
  s_add_u32 m0, s28, 134144
  s_add_u32 s27, s27, 32768
  buffer_load_dwordx4 v21, s[8:11], s27 offen lds
  s_add_u32 m0, s28, 135168
  s_add_u32 s27, s27, 32768
  buffer_load_dwordx4 v20, s[8:11], s27 offen lds
  s_add_u32 m0, s28, 136192
  s_add_u32 s27, s27, 32768
  buffer_load_dwordx4 v20, s[8:11], s27 offen lds
  s_add_u32 m0, s28, 137216
  s_add_u32 s27, s27, 32768
  buffer_load_dwordx4 v21, s[8:11], s27 offen lds
  s_add_u32 m0, s28, 138240
  s_add_u32 s27, s27, 32768
  buffer_load_dwordx4 v21, s[8:11], s27 offen lds
  ds_read_b64_tr_b16 a[64:65], v22 offset:32768
  ds_read_b64_tr_b16 a[66:67], v22 offset:33792
  ds_read_b64_tr_b16 a[68:69], v22 offset:36864
  ds_read_b64_tr_b16 a[70:71], v22 offset:37888
  ds_read_b64_tr_b16 a[72:73], v22 offset:40960
  ds_read_b64_tr_b16 a[74:75], v22 offset:41984
  ds_read_b64_tr_b16 a[76:77], v22 offset:45056
  ds_read_b64_tr_b16 a[78:79], v22 offset:46080
  ds_read_b64_tr_b16 a[80:81], v22 offset:49152
  ds_read_b64_tr_b16 a[82:83], v22 offset:50176
  ds_read_b64_tr_b16 a[84:85], v22 offset:53248
  ds_read_b64_tr_b16 a[86:87], v22 offset:54272
  ds_read_b64_tr_b16 a[88:89], v22 offset:57344
  ds_read_b64_tr_b16 a[90:91], v22 offset:58368
  ds_read_b64_tr_b16 a[92:93], v22 offset:61440
  ds_read_b64_tr_b16 a[94:95], v22 offset:62464
  s_waitcnt lgkmcnt(0)
  s_waitcnt vmcnt(16)
  s_barrier
  s_add_u32 s27, s26, 2097152
  s_add_u32 m0, s28, 0
  s_nop 0
  buffer_load_dwordx4 v20, s[8:11], s27 offen lds
  s_add_u32 m0, s28, 1024
  s_add_u32 s27, s27, 32768
  buffer_load_dwordx4 v20, s[8:11], s27 offen lds
  s_add_u32 m0, s28, 2048
  s_add_u32 s27, s27, 32768
  buffer_load_dwordx4 v21, s[8:11], s27 offen lds
  s_add_u32 m0, s28, 3072
  s_add_u32 s27, s27, 32768
  buffer_load_dwordx4 v21, s[8:11], s27 offen lds
  s_add_u32 m0, s28, 4096
  s_add_u32 s27, s27, 32768
  buffer_load_dwordx4 v20, s[8:11], s27 offen lds
  s_add_u32 m0, s28, 5120
  s_add_u32 s27, s27, 32768
  buffer_load_dwordx4 v20, s[8:11], s27 offen lds
  s_add_u32 m0, s28, 6144
  s_add_u32 s27, s27, 32768
  buffer_load_dwordx4 v21, s[8:11], s27 offen lds
  s_add_u32 m0, s28, 7168
  s_add_u32 s27, s27, 32768
  buffer_load_dwordx4 v21, s[8:11], s27 offen lds
  ds_read_b64_tr_b16 a[96:97], v23 offset:0
  ds_read_b64_tr_b16 a[98:99], v23 offset:1024
  ds_read_b64_tr_b16 a[100:101], v23 offset:4096
  ds_read_b64_tr_b16 a[102:103], v23 offset:5120
  ds_read_b64_tr_b16 a[104:105], v23 offset:8192
  ds_read_b64_tr_b16 a[106:107], v23 offset:9216
  ds_read_b64_tr_b16 a[108:109], v23 offset:12288
  ds_read_b64_tr_b16 a[110:111], v23 offset:13312
  ds_read_b64_tr_b16 a[112:113], v23 offset:16384
  ds_read_b64_tr_b16 a[114:115], v23 offset:17408
  ds_read_b64_tr_b16 a[116:117], v23 offset:20480
  ds_read_b64_tr_b16 a[118:119], v23 offset:21504
  ds_read_b64_tr_b16 a[120:121], v23 offset:24576
  ds_read_b64_tr_b16 a[122:123], v23 offset:25600
  ds_read_b64_tr_b16 a[124:125], v23 offset:28672
  ds_read_b64_tr_b16 a[126:127], v23 offset:29696
  s_waitcnt lgkmcnt(0)
  s_waitcnt vmcnt(16)
  s_barrier
  s_add_u32 s27, s26, 3145728
  s_add_u32 m0, s28, 32768
  s_nop 0
  buffer_load_dwordx4 v20, s[8:11], s27 offen lds
  s_add_u32 m0, s28, 33792
  s_add_u32 s27, s27, 32768
  buffer_load_dwordx4 v20, s[8:11], s27 offen lds
  s_add_u32 m0, s28, 34816
  s_add_u32 s27, s27, 32768
  buffer_load_dwordx4 v21, s[8:11], s27 offen lds
  s_add_u32 m0, s28, 35840
  s_add_u32 s27, s27, 32768
  buffer_load_dwordx4 v21, s[8:11], s27 offen lds
  s_add_u32 m0, s28, 36864
  s_add_u32 s27, s27, 32768
  buffer_load_dwordx4 v20, s[8:11], s27 offen lds
  s_add_u32 m0, s28, 37888
  s_add_u32 s27, s27, 32768
  buffer_load_dwordx4 v20, s[8:11], s27 offen lds
  s_add_u32 m0, s28, 38912
  s_add_u32 s27, s27, 32768
  buffer_load_dwordx4 v21, s[8:11], s27 offen lds
  s_add_u32 m0, s28, 39936
  s_add_u32 s27, s27, 32768
  buffer_load_dwordx4 v21, s[8:11], s27 offen lds
  ds_read_b64_tr_b16 a[128:129], v23 offset:32768
  ds_read_b64_tr_b16 a[130:131], v23 offset:33792
  ds_read_b64_tr_b16 a[132:133], v23 offset:36864
  ds_read_b64_tr_b16 a[134:135], v23 offset:37888
  ds_read_b64_tr_b16 a[136:137], v23 offset:40960
  ds_read_b64_tr_b16 a[138:139], v23 offset:41984
  ds_read_b64_tr_b16 a[140:141], v23 offset:45056
  ds_read_b64_tr_b16 a[142:143], v23 offset:46080
  ds_read_b64_tr_b16 a[144:145], v23 offset:49152
  ds_read_b64_tr_b16 a[146:147], v23 offset:50176
  ds_read_b64_tr_b16 a[148:149], v23 offset:53248
  ds_read_b64_tr_b16 a[150:151], v23 offset:54272
  ds_read_b64_tr_b16 a[152:153], v23 offset:57344
  ds_read_b64_tr_b16 a[154:155], v23 offset:58368
  ds_read_b64_tr_b16 a[156:157], v23 offset:61440
  ds_read_b64_tr_b16 a[158:159], v23 offset:62464
  s_waitcnt lgkmcnt(0)
  s_waitcnt vmcnt(16)
  s_barrier
  ds_read_b64_tr_b16 a[160:161], v24 offset:0
  ds_read_b64_tr_b16 a[162:163], v24 offset:1024
  ds_read_b64_tr_b16 a[164:165], v24 offset:4096
  ds_read_b64_tr_b16 a[166:167], v24 offset:5120
  ds_read_b64_tr_b16 a[168:169], v24 offset:8192
  ds_read_b64_tr_b16 a[170:171], v24 offset:9216
  ds_read_b64_tr_b16 a[172:173], v24 offset:12288
  ds_read_b64_tr_b16 a[174:175], v24 offset:13312
  ds_read_b64_tr_b16 a[176:177], v24 offset:16384
  ds_read_b64_tr_b16 a[178:179], v24 offset:17408
  ds_read_b64_tr_b16 a[180:181], v24 offset:20480
  ds_read_b64_tr_b16 a[182:183], v24 offset:21504
  ds_read_b64_tr_b16 a[184:185], v24 offset:24576
  ds_read_b64_tr_b16 a[186:187], v24 offset:25600
  ds_read_b64_tr_b16 a[188:189], v24 offset:28672
  ds_read_b64_tr_b16 a[190:191], v24 offset:29696
  s_waitcnt lgkmcnt(0)
  s_waitcnt vmcnt(8)
  s_barrier
  ds_read_b64_tr_b16 a[192:193], v22 offset:0
  ds_read_b64_tr_b16 a[194:195], v22 offset:1024
  ds_read_b64_tr_b16 a[196:197], v22 offset:4096
  ds_read_b64_tr_b16 a[198:199], v22 offset:5120
  ds_read_b64_tr_b16 a[200:201], v22 offset:8192
  ds_read_b64_tr_b16 a[202:203], v22 offset:9216
  ds_read_b64_tr_b16 a[204:205], v22 offset:12288
  ds_read_b64_tr_b16 a[206:207], v22 offset:13312
  ds_read_b64_tr_b16 a[208:209], v22 offset:16384
  ds_read_b64_tr_b16 a[210:211], v22 offset:17408
  ds_read_b64_tr_b16 a[212:213], v22 offset:20480
  ds_read_b64_tr_b16 a[214:215], v22 offset:21504
  ds_read_b64_tr_b16 a[216:217], v22 offset:24576
  ds_read_b64_tr_b16 a[218:219], v22 offset:25600
  ds_read_b64_tr_b16 a[220:221], v22 offset:28672
  ds_read_b64_tr_b16 a[222:223], v22 offset:29696
  s_waitcnt lgkmcnt(0)
  s_waitcnt vmcnt(0)
  s_barrier
  ds_read_b64_tr_b16 a[224:225], v22 offset:32768
  ds_read_b64_tr_b16 a[226:227], v22 offset:33792
  ds_read_b64_tr_b16 a[228:229], v22 offset:36864
  ds_read_b64_tr_b16 a[230:231], v22 offset:37888
  ds_read_b64_tr_b16 a[232:233], v22 offset:40960
  ds_read_b64_tr_b16 a[234:235], v22 offset:41984
  ds_read_b64_tr_b16 a[236:237], v22 offset:45056
  ds_read_b64_tr_b16 a[238:239], v22 offset:46080
  ds_read_b64_tr_b16 a[240:241], v22 offset:49152
  ds_read_b64_tr_b16 a[242:243], v22 offset:50176
  ds_read_b64_tr_b16 a[244:245], v22 offset:53248
  ds_read_b64_tr_b16 a[246:247], v22 offset:54272
  ds_read_b64_tr_b16 a[248:249], v22 offset:57344
  ds_read_b64_tr_b16 a[250:251], v22 offset:58368
  ds_read_b64_tr_b16 a[252:253], v22 offset:61440
  ds_read_b64_tr_b16 a[254:255], v22 offset:62464
  s_waitcnt lgkmcnt(0)
  s_branch q_ld_84
q_ld_82:
  s_add_u32 s27, s26, 0
  s_add_u32 m0, s28, 0
  s_nop 0
  buffer_load_dwordx4 v20, s[68:71], s27 offen lds
  s_add_u32 m0, s28, 1024
  s_add_u32 s27, s27, 32768
  buffer_load_dwordx4 v20, s[68:71], s27 offen lds
  s_add_u32 m0, s28, 2048
  s_add_u32 s27, s27, 32768
  buffer_load_dwordx4 v21, s[68:71], s27 offen lds
  s_add_u32 m0, s28, 3072
  s_add_u32 s27, s27, 32768
  buffer_load_dwordx4 v21, s[68:71], s27 offen lds
  s_add_u32 m0, s28, 4096
  s_add_u32 s27, s27, 32768
  buffer_load_dwordx4 v20, s[68:71], s27 offen lds
  s_add_u32 m0, s28, 5120
  s_add_u32 s27, s27, 32768
  buffer_load_dwordx4 v20, s[68:71], s27 offen lds
  s_add_u32 m0, s28, 6144
  s_add_u32 s27, s27, 32768
  buffer_load_dwordx4 v21, s[68:71], s27 offen lds
  s_add_u32 m0, s28, 7168
  s_add_u32 s27, s27, 32768
  buffer_load_dwordx4 v21, s[68:71], s27 offen lds
  s_add_u32 s27, s26, 1048576
  s_add_u32 m0, s28, 32768
  s_nop 0
  buffer_load_dwordx4 v20, s[68:71], s27 offen lds
  s_add_u32 m0, s28, 33792
  s_add_u32 s27, s27, 32768
  buffer_load_dwordx4 v20, s[68:71], s27 offen lds
  s_add_u32 m0, s28, 34816
  s_add_u32 s27, s27, 32768
  buffer_load_dwordx4 v21, s[68:71], s27 offen lds
  s_add_u32 m0, s28, 35840
  s_add_u32 s27, s27, 32768
  buffer_load_dwordx4 v21, s[68:71], s27 offen lds
  s_add_u32 m0, s28, 36864
  s_add_u32 s27, s27, 32768
  buffer_load_dwordx4 v20, s[68:71], s27 offen lds
  s_add_u32 m0, s28, 37888
  s_add_u32 s27, s27, 32768
  buffer_load_dwordx4 v20, s[68:71], s27 offen lds
  s_add_u32 m0, s28, 38912
  s_add_u32 s27, s27, 32768
  buffer_load_dwordx4 v21, s[68:71], s27 offen lds
  s_add_u32 m0, s28, 39936
  s_add_u32 s27, s27, 32768
  buffer_load_dwordx4 v21, s[68:71], s27 offen lds
  s_add_u32 s27, s26, 2097152
  s_add_u32 m0, s28, 65536
  s_nop 0
  buffer_load_dwordx4 v20, s[68:71], s27 offen lds
  s_add_u32 m0, s28, 66560
  s_add_u32 s27, s27, 32768
  buffer_load_dwordx4 v20, s[68:71], s27 offen lds
  s_add_u32 m0, s28, 67584
  s_add_u32 s27, s27, 32768
  buffer_load_dwordx4 v21, s[68:71], s27 offen lds
  s_add_u32 m0, s28, 68608
  s_add_u32 s27, s27, 32768
  buffer_load_dwordx4 v21, s[68:71], s27 offen lds
  s_add_u32 m0, s28, 69632
  s_add_u32 s27, s27, 32768
  buffer_load_dwordx4 v20, s[68:71], s27 offen lds
  s_add_u32 m0, s28, 70656
  s_add_u32 s27, s27, 32768
  buffer_load_dwordx4 v20, s[68:71], s27 offen lds
  s_add_u32 m0, s28, 71680
  s_add_u32 s27, s27, 32768
  buffer_load_dwordx4 v21, s[68:71], s27 offen lds
  s_add_u32 m0, s28, 72704
  s_add_u32 s27, s27, 32768
  buffer_load_dwordx4 v21, s[68:71], s27 offen lds
  s_load_dwordx2 s[4:5], s[0:1], 112
  s_load_dwordx2 s[12:13], s[0:1], 104
  s_waitcnt vmcnt(16)
  s_barrier
  s_add_u32 s27, s26, 3145728
  s_add_u32 m0, s28, 98304
  s_nop 0
  buffer_load_dwordx4 v20, s[68:71], s27 offen lds
  s_add_u32 m0, s28, 99328
  s_add_u32 s27, s27, 32768
  buffer_load_dwordx4 v20, s[68:71], s27 offen lds
  s_add_u32 m0, s28, 100352
  s_add_u32 s27, s27, 32768
  buffer_load_dwordx4 v21, s[68:71], s27 offen lds
  s_add_u32 m0, s28, 101376
  s_add_u32 s27, s27, 32768
  buffer_load_dwordx4 v21, s[68:71], s27 offen lds
  s_add_u32 m0, s28, 102400
  s_add_u32 s27, s27, 32768
  buffer_load_dwordx4 v20, s[68:71], s27 offen lds
  s_add_u32 m0, s28, 103424
  s_add_u32 s27, s27, 32768
  buffer_load_dwordx4 v20, s[68:71], s27 offen lds
  s_add_u32 m0, s28, 104448
  s_add_u32 s27, s27, 32768
  buffer_load_dwordx4 v21, s[68:71], s27 offen lds
  s_add_u32 m0, s28, 105472
  s_add_u32 s27, s27, 32768
  buffer_load_dwordx4 v21, s[68:71], s27 offen lds
  ds_read_b64_tr_b16 a[0:1], v22 offset:0
  ds_read_b64_tr_b16 a[2:3], v22 offset:1024
  ds_read_b64_tr_b16 a[4:5], v22 offset:4096
  ds_read_b64_tr_b16 a[6:7], v22 offset:5120
  ds_read_b64_tr_b16 a[8:9], v22 offset:8192
  ds_read_b64_tr_b16 a[10:11], v22 offset:9216
  ds_read_b64_tr_b16 a[12:13], v22 offset:12288
  ds_read_b64_tr_b16 a[14:15], v22 offset:13312
  ds_read_b64_tr_b16 a[16:17], v22 offset:16384
  ds_read_b64_tr_b16 a[18:19], v22 offset:17408
  ds_read_b64_tr_b16 a[20:21], v22 offset:20480
  ds_read_b64_tr_b16 a[22:23], v22 offset:21504
  ds_read_b64_tr_b16 a[24:25], v22 offset:24576
  ds_read_b64_tr_b16 a[26:27], v22 offset:25600
  ds_read_b64_tr_b16 a[28:29], v22 offset:28672
  ds_read_b64_tr_b16 a[30:31], v22 offset:29696
  s_waitcnt lgkmcnt(0)
  s_waitcnt vmcnt(16)
  s_barrier
  s_add_u32 s27, s26, 0
  s_add_u32 m0, s28, 131072
  s_nop 0
  buffer_load_dwordx4 v20, s[8:11], s27 offen lds
  s_add_u32 m0, s28, 132096
  s_add_u32 s27, s27, 32768
  buffer_load_dwordx4 v20, s[8:11], s27 offen lds
  s_add_u32 m0, s28, 133120
  s_add_u32 s27, s27, 32768
  buffer_load_dwordx4 v21, s[8:11], s27 offen lds
  s_add_u32 m0, s28, 134144
  s_add_u32 s27, s27, 32768
  buffer_load_dwordx4 v21, s[8:11], s27 offen lds
  s_add_u32 m0, s28, 135168
  s_add_u32 s27, s27, 32768
  buffer_load_dwordx4 v20, s[8:11], s27 offen lds
  s_add_u32 m0, s28, 136192
  s_add_u32 s27, s27, 32768
  buffer_load_dwordx4 v20, s[8:11], s27 offen lds
  s_add_u32 m0, s28, 137216
  s_add_u32 s27, s27, 32768
  buffer_load_dwordx4 v21, s[8:11], s27 offen lds
  s_add_u32 m0, s28, 138240
  s_add_u32 s27, s27, 32768
  buffer_load_dwordx4 v21, s[8:11], s27 offen lds
  ds_read_b64_tr_b16 a[32:33], v22 offset:32768
  ds_read_b64_tr_b16 a[34:35], v22 offset:33792
  ds_read_b64_tr_b16 a[36:37], v22 offset:36864
  ds_read_b64_tr_b16 a[38:39], v22 offset:37888
  ds_read_b64_tr_b16 a[40:41], v22 offset:40960
  ds_read_b64_tr_b16 a[42:43], v22 offset:41984
  ds_read_b64_tr_b16 a[44:45], v22 offset:45056
  ds_read_b64_tr_b16 a[46:47], v22 offset:46080
  ds_read_b64_tr_b16 a[48:49], v22 offset:49152
  ds_read_b64_tr_b16 a[50:51], v22 offset:50176
  ds_read_b64_tr_b16 a[52:53], v22 offset:53248
  ds_read_b64_tr_b16 a[54:55], v22 offset:54272
  ds_read_b64_tr_b16 a[56:57], v22 offset:57344
  ds_read_b64_tr_b16 a[58:59], v22 offset:58368
  ds_read_b64_tr_b16 a[60:61], v22 offset:61440
  ds_read_b64_tr_b16 a[62:63], v22 offset:62464
  s_waitcnt lgkmcnt(0)
  s_waitcnt vmcnt(16)
  s_barrier
  s_add_u32 s27, s26, 1048576
  s_add_u32 m0, s28, 0
  s_nop 0
  buffer_load_dwordx4 v20, s[8:11], s27 offen lds
  s_add_u32 m0, s28, 1024
  s_add_u32 s27, s27, 32768
  buffer_load_dwordx4 v20, s[8:11], s27 offen lds
  s_add_u32 m0, s28, 2048
  s_add_u32 s27, s27, 32768
  buffer_load_dwordx4 v21, s[8:11], s27 offen lds
  s_add_u32 m0, s28, 3072
  s_add_u32 s27, s27, 32768
  buffer_load_dwordx4 v21, s[8:11], s27 offen lds
  s_add_u32 m0, s28, 4096
  s_add_u32 s27, s27, 32768
  buffer_load_dwordx4 v20, s[8:11], s27 offen lds
  s_add_u32 m0, s28, 5120
  s_add_u32 s27, s27, 32768
  buffer_load_dwordx4 v20, s[8:11], s27 offen lds
  s_add_u32 m0, s28, 6144
  s_add_u32 s27, s27, 32768
  buffer_load_dwordx4 v21, s[8:11], s27 offen lds
  s_add_u32 m0, s28, 7168
  s_add_u32 s27, s27, 32768
  buffer_load_dwordx4 v21, s[8:11], s27 offen lds
  ds_read_b64_tr_b16 a[64:65], v23 offset:0
  ds_read_b64_tr_b16 a[66:67], v23 offset:1024
  ds_read_b64_tr_b16 a[68:69], v23 offset:4096
  ds_read_b64_tr_b16 a[70:71], v23 offset:5120
  ds_read_b64_tr_b16 a[72:73], v23 offset:8192
  ds_read_b64_tr_b16 a[74:75], v23 offset:9216
  ds_read_b64_tr_b16 a[76:77], v23 offset:12288
  ds_read_b64_tr_b16 a[78:79], v23 offset:13312
  ds_read_b64_tr_b16 a[80:81], v23 offset:16384
  ds_read_b64_tr_b16 a[82:83], v23 offset:17408
  ds_read_b64_tr_b16 a[84:85], v23 offset:20480
  ds_read_b64_tr_b16 a[86:87], v23 offset:21504
  ds_read_b64_tr_b16 a[88:89], v23 offset:24576
  ds_read_b64_tr_b16 a[90:91], v23 offset:25600
  ds_read_b64_tr_b16 a[92:93], v23 offset:28672
  ds_read_b64_tr_b16 a[94:95], v23 offset:29696
  s_waitcnt lgkmcnt(0)
  s_waitcnt vmcnt(16)
  s_barrier
  s_add_u32 s27, s26, 2097152
  s_add_u32 m0, s28, 32768
  s_nop 0
  buffer_load_dwordx4 v20, s[8:11], s27 offen lds
  s_add_u32 m0, s28, 33792
  s_add_u32 s27, s27, 32768
  buffer_load_dwordx4 v20, s[8:11], s27 offen lds
  s_add_u32 m0, s28, 34816
  s_add_u32 s27, s27, 32768
  buffer_load_dwordx4 v21, s[8:11], s27 offen lds
  s_add_u32 m0, s28, 35840
  s_add_u32 s27, s27, 32768
  buffer_load_dwordx4 v21, s[8:11], s27 offen lds
  s_add_u32 m0, s28, 36864
  s_add_u32 s27, s27, 32768
  buffer_load_dwordx4 v20, s[8:11], s27 offen lds
  s_add_u32 m0, s28, 37888
  s_add_u32 s27, s27, 32768
  buffer_load_dwordx4 v20, s[8:11], s27 offen lds
  s_add_u32 m0, s28, 38912
  s_add_u32 s27, s27, 32768
  buffer_load_dwordx4 v21, s[8:11], s27 offen lds
  s_add_u32 m0, s28, 39936
  s_add_u32 s27, s27, 32768
  buffer_load_dwordx4 v21, s[8:11], s27 offen lds
  ds_read_b64_tr_b16 a[96:97], v23 offset:32768
  ds_read_b64_tr_b16 a[98:99], v23 offset:33792
  ds_read_b64_tr_b16 a[100:101], v23 offset:36864
  ds_read_b64_tr_b16 a[102:103], v23 offset:37888
  ds_read_b64_tr_b16 a[104:105], v23 offset:40960
  ds_read_b64_tr_b16 a[106:107], v23 offset:41984
  ds_read_b64_tr_b16 a[108:109], v23 offset:45056
  ds_read_b64_tr_b16 a[110:111], v23 offset:46080
  ds_read_b64_tr_b16 a[112:113], v23 offset:49152
  ds_read_b64_tr_b16 a[114:115], v23 offset:50176
  ds_read_b64_tr_b16 a[116:117], v23 offset:53248
  ds_read_b64_tr_b16 a[118:119], v23 offset:54272
  ds_read_b64_tr_b16 a[120:121], v23 offset:57344
  ds_read_b64_tr_b16 a[122:123], v23 offset:58368
  ds_read_b64_tr_b16 a[124:125], v23 offset:61440
  ds_read_b64_tr_b16 a[126:127], v23 offset:62464
  s_waitcnt lgkmcnt(0)
  s_waitcnt vmcnt(16)
  s_barrier
  s_add_u32 s27, s26, 3145728
  s_add_u32 m0, s28, 65536
  s_nop 0
  buffer_load_dwordx4 v20, s[8:11], s27 offen lds
  s_add_u32 m0, s28, 66560
  s_add_u32 s27, s27, 32768
  buffer_load_dwordx4 v20, s[8:11], s27 offen lds
  s_add_u32 m0, s28, 67584
  s_add_u32 s27, s27, 32768
  buffer_load_dwordx4 v21, s[8:11], s27 offen lds
  s_add_u32 m0, s28, 68608
  s_add_u32 s27, s27, 32768
  buffer_load_dwordx4 v21, s[8:11], s27 offen lds
  s_add_u32 m0, s28, 69632
  s_add_u32 s27, s27, 32768
  buffer_load_dwordx4 v20, s[8:11], s27 offen lds
  s_add_u32 m0, s28, 70656
  s_add_u32 s27, s27, 32768
  buffer_load_dwordx4 v20, s[8:11], s27 offen lds
  s_add_u32 m0, s28, 71680
  s_add_u32 s27, s27, 32768
  buffer_load_dwordx4 v21, s[8:11], s27 offen lds
  s_add_u32 m0, s28, 72704
  s_add_u32 s27, s27, 32768
  buffer_load_dwordx4 v21, s[8:11], s27 offen lds
  ds_read_b64_tr_b16 a[128:129], v24 offset:0
  ds_read_b64_tr_b16 a[130:131], v24 offset:1024
  ds_read_b64_tr_b16 a[132:133], v24 offset:4096
  ds_read_b64_tr_b16 a[134:135], v24 offset:5120
  ds_read_b64_tr_b16 a[136:137], v24 offset:8192
  ds_read_b64_tr_b16 a[138:139], v24 offset:9216
  ds_read_b64_tr_b16 a[140:141], v24 offset:12288
  ds_read_b64_tr_b16 a[142:143], v24 offset:13312
  ds_read_b64_tr_b16 a[144:145], v24 offset:16384
  ds_read_b64_tr_b16 a[146:147], v24 offset:17408
  ds_read_b64_tr_b16 a[148:149], v24 offset:20480
  ds_read_b64_tr_b16 a[150:151], v24 offset:21504
  ds_read_b64_tr_b16 a[152:153], v24 offset:24576
  ds_read_b64_tr_b16 a[154:155], v24 offset:25600
  ds_read_b64_tr_b16 a[156:157], v24 offset:28672
  ds_read_b64_tr_b16 a[158:159], v24 offset:29696
  s_waitcnt lgkmcnt(0)
  s_waitcnt vmcnt(16)
  s_barrier
  s_add_u32 s27, s26, 0
  s_add_u32 m0, s28, 98304
  s_nop 0
  buffer_load_dwordx4 v20, s[64:67], s27 offen lds
  s_add_u32 m0, s28, 99328
  s_add_u32 s27, s27, 32768
  buffer_load_dwordx4 v20, s[64:67], s27 offen lds
  s_add_u32 m0, s28, 100352
  s_add_u32 s27, s27, 32768
  buffer_load_dwordx4 v21, s[64:67], s27 offen lds
  s_add_u32 m0, s28, 101376
  s_add_u32 s27, s27, 32768
  buffer_load_dwordx4 v21, s[64:67], s27 offen lds
  s_add_u32 m0, s28, 102400
  s_add_u32 s27, s27, 32768
  buffer_load_dwordx4 v20, s[64:67], s27 offen lds
  s_add_u32 m0, s28, 103424
  s_add_u32 s27, s27, 32768
  buffer_load_dwordx4 v20, s[64:67], s27 offen lds
  s_add_u32 m0, s28, 104448
  s_add_u32 s27, s27, 32768
  buffer_load_dwordx4 v21, s[64:67], s27 offen lds
  s_add_u32 m0, s28, 105472
  s_add_u32 s27, s27, 32768
  buffer_load_dwordx4 v21, s[64:67], s27 offen lds
  ds_read_b64_tr_b16 a[160:161], v22 offset:0
  ds_read_b64_tr_b16 a[162:163], v22 offset:1024
  ds_read_b64_tr_b16 a[164:165], v22 offset:4096
  ds_read_b64_tr_b16 a[166:167], v22 offset:5120
  ds_read_b64_tr_b16 a[168:169], v22 offset:8192
  ds_read_b64_tr_b16 a[170:171], v22 offset:9216
  ds_read_b64_tr_b16 a[172:173], v22 offset:12288
  ds_read_b64_tr_b16 a[174:175], v22 offset:13312
  ds_read_b64_tr_b16 a[176:177], v22 offset:16384
  ds_read_b64_tr_b16 a[178:179], v22 offset:17408
  ds_read_b64_tr_b16 a[180:181], v22 offset:20480
  ds_read_b64_tr_b16 a[182:183], v22 offset:21504
  ds_read_b64_tr_b16 a[184:185], v22 offset:24576
  ds_read_b64_tr_b16 a[186:187], v22 offset:25600
  ds_read_b64_tr_b16 a[188:189], v22 offset:28672
  ds_read_b64_tr_b16 a[190:191], v22 offset:29696
  s_waitcnt lgkmcnt(0)
  s_waitcnt vmcnt(16)
  s_barrier
  s_add_u32 s27, s26, 1048576
  s_add_u32 m0, s28, 131072
  s_nop 0
  buffer_load_dwordx4 v20, s[64:67], s27 offen lds
  s_add_u32 m0, s28, 132096
  s_add_u32 s27, s27, 32768
  buffer_load_dwordx4 v20, s[64:67], s27 offen lds
  s_add_u32 m0, s28, 133120
  s_add_u32 s27, s27, 32768
  buffer_load_dwordx4 v21, s[64:67], s27 offen lds
  s_add_u32 m0, s28, 134144
  s_add_u32 s27, s27, 32768
  buffer_load_dwordx4 v21, s[64:67], s27 offen lds
  s_add_u32 m0, s28, 135168
  s_add_u32 s27, s27, 32768
  buffer_load_dwordx4 v20, s[64:67], s27 offen lds
  s_add_u32 m0, s28, 136192
  s_add_u32 s27, s27, 32768
  buffer_load_dwordx4 v20, s[64:67], s27 offen lds
  s_add_u32 m0, s28, 137216
  s_add_u32 s27, s27, 32768
  buffer_load_dwordx4 v21, s[64:67], s27 offen lds
  s_add_u32 m0, s28, 138240
  s_add_u32 s27, s27, 32768
  buffer_load_dwordx4 v21, s[64:67], s27 offen lds
  ds_read_b64_tr_b16 a[192:193], v22 offset:32768
  ds_read_b64_tr_b16 a[194:195], v22 offset:33792
  ds_read_b64_tr_b16 a[196:197], v22 offset:36864
  ds_read_b64_tr_b16 a[198:199], v22 offset:37888
  ds_read_b64_tr_b16 a[200:201], v22 offset:40960
  ds_read_b64_tr_b16 a[202:203], v22 offset:41984
  ds_read_b64_tr_b16 a[204:205], v22 offset:45056
  ds_read_b64_tr_b16 a[206:207], v22 offset:46080
  ds_read_b64_tr_b16 a[208:209], v22 offset:49152
  ds_read_b64_tr_b16 a[210:211], v22 offset:50176
  ds_read_b64_tr_b16 a[212:213], v22 offset:53248
  ds_read_b64_tr_b16 a[214:215], v22 offset:54272
  ds_read_b64_tr_b16 a[216:217], v22 offset:57344
  ds_read_b64_tr_b16 a[218:219], v22 offset:58368
  ds_read_b64_tr_b16 a[220:221], v22 offset:61440
  ds_read_b64_tr_b16 a[222:223], v22 offset:62464
  s_waitcnt lgkmcnt(0)
  s_waitcnt vmcnt(16)
  s_barrier
  s_add_u32 s27, s26, 2097152
  s_add_u32 m0, s28, 0
  s_nop 0
  buffer_load_dwordx4 v20, s[64:67], s27 offen lds
  s_add_u32 m0, s28, 1024
  s_add_u32 s27, s27, 32768
  buffer_load_dwordx4 v20, s[64:67], s27 offen lds
  s_add_u32 m0, s28, 2048
  s_add_u32 s27, s27, 32768
  buffer_load_dwordx4 v21, s[64:67], s27 offen lds
  s_add_u32 m0, s28, 3072
  s_add_u32 s27, s27, 32768
  buffer_load_dwordx4 v21, s[64:67], s27 offen lds
  s_add_u32 m0, s28, 4096
  s_add_u32 s27, s27, 32768
  buffer_load_dwordx4 v20, s[64:67], s27 offen lds
  s_add_u32 m0, s28, 5120
  s_add_u32 s27, s27, 32768
  buffer_load_dwordx4 v20, s[64:67], s27 offen lds
  s_add_u32 m0, s28, 6144
  s_add_u32 s27, s27, 32768
  buffer_load_dwordx4 v21, s[64:67], s27 offen lds
  s_add_u32 m0, s28, 7168
  s_add_u32 s27, s27, 32768
  buffer_load_dwordx4 v21, s[64:67], s27 offen lds
  ds_read_b64_tr_b16 a[224:225], v23 offset:0
  ds_read_b64_tr_b16 a[226:227], v23 offset:1024
  ds_read_b64_tr_b16 a[228:229], v23 offset:4096
  ds_read_b64_tr_b16 a[230:231], v23 offset:5120
  ds_read_b64_tr_b16 a[232:233], v23 offset:8192
  ds_read_b64_tr_b16 a[234:235], v23 offset:9216
  ds_read_b64_tr_b16 a[236:237], v23 offset:12288
  ds_read_b64_tr_b16 a[238:239], v23 offset:13312
  ds_read_b64_tr_b16 a[240:241], v23 offset:16384
  ds_read_b64_tr_b16 a[242:243], v23 offset:17408
  ds_read_b64_tr_b16 a[244:245], v23 offset:20480
  ds_read_b64_tr_b16 a[246:247], v23 offset:21504
  ds_read_b64_tr_b16 a[248:249], v23 offset:24576
  ds_read_b64_tr_b16 a[250:251], v23 offset:25600
  ds_read_b64_tr_b16 a[252:253], v23 offset:28672
  ds_read_b64_tr_b16 a[254:255], v23 offset:29696
  s_waitcnt lgkmcnt(0)
  s_waitcnt vmcnt(16)
  s_barrier
  s_add_u32 s27, s26, 3145728
  s_add_u32 m0, s28, 32768
  s_nop 0
  buffer_load_dwordx4 v20, s[64:67], s27 offen lds
  s_add_u32 m0, s28, 33792
  s_add_u32 s27, s27, 32768
  buffer_load_dwordx4 v20, s[64:67], s27 offen lds
  s_add_u32 m0, s28, 34816
  s_add_u32 s27, s27, 32768
  buffer_load_dwordx4 v21, s[64:67], s27 offen lds
  s_add_u32 m0, s28, 35840
  s_add_u32 s27, s27, 32768
  buffer_load_dwordx4 v21, s[64:67], s27 offen lds
  s_add_u32 m0, s28, 36864
  s_add_u32 s27, s27, 32768
  buffer_load_dwordx4 v20, s[64:67], s27 offen lds
  s_add_u32 m0, s28, 37888
  s_add_u32 s27, s27, 32768
  buffer_load_dwordx4 v20, s[64:67], s27 offen lds
  s_add_u32 m0, s28, 38912
  s_add_u32 s27, s27, 32768
  buffer_load_dwordx4 v21, s[64:67], s27 offen lds
  s_add_u32 m0, s28, 39936
  s_add_u32 s27, s27, 32768
  buffer_load_dwordx4 v21, s[64:67], s27 offen lds
  ds_read_b64_tr_b16 v[128:129], v23 offset:32768
  ds_read_b64_tr_b16 v[130:131], v23 offset:33792
  ds_read_b64_tr_b16 v[132:133], v23 offset:36864
  ds_read_b64_tr_b16 v[134:135], v23 offset:37888
  ds_read_b64_tr_b16 v[136:137], v23 offset:40960
  ds_read_b64_tr_b16 v[138:139], v23 offset:41984
  ds_read_b64_tr_b16 v[140:141], v23 offset:45056
  ds_read_b64_tr_b16 v[142:143], v23 offset:46080
  ds_read_b64_tr_b16 v[144:145], v23 offset:49152
  ds_read_b64_tr_b16 v[146:147], v23 offset:50176
  ds_read_b64_tr_b16 v[148:149], v23 offset:53248
  ds_read_b64_tr_b16 v[150:151], v23 offset:54272
  ds_read_b64_tr_b16 v[152:153], v23 offset:57344
  ds_read_b64_tr_b16 v[154:155], v23 offset:58368
  ds_read_b64_tr_b16 v[156:157], v23 offset:61440
  ds_read_b64_tr_b16 v[158:159], v23 offset:62464
  s_waitcnt lgkmcnt(0)
  s_waitcnt vmcnt(16)
  s_barrier
  ds_read_b64_tr_b16 v[160:161], v24 offset:0
  ds_read_b64_tr_b16 v[162:163], v24 offset:1024
  ds_read_b64_tr_b16 v[164:165], v24 offset:4096
  ds_read_b64_tr_b16 v[166:167], v24 offset:5120
  ds_read_b64_tr_b16 v[168:169], v24 offset:8192
  ds_read_b64_tr_b16 v[170:171], v24 offset:9216
  ds_read_b64_tr_b16 v[172:173], v24 offset:12288
  ds_read_b64_tr_b16 v[174:175], v24 offset:13312
  ds_read_b64_tr_b16 v[176:177], v24 offset:16384
  ds_read_b64_tr_b16 v[178:179], v24 offset:17408
  ds_read_b64_tr_b16 v[180:181], v24 offset:20480
  ds_read_b64_tr_b16 v[182:183], v24 offset:21504
  ds_read_b64_tr_b16 v[184:185], v24 offset:24576
  ds_read_b64_tr_b16 v[186:187], v24 offset:25600
  ds_read_b64_tr_b16 v[188:189], v24 offset:28672
  ds_read_b64_tr_b16 v[190:191], v24 offset:29696
  s_waitcnt lgkmcnt(0)
  s_waitcnt vmcnt(8)
  s_barrier
  ds_read_b64_tr_b16 v[192:193], v22 offset:0
  ds_read_b64_tr_b16 v[194:195], v22 offset:1024
  ds_read_b64_tr_b16 v[196:197], v22 offset:4096
  ds_read_b64_tr_b16 v[198:199], v22 offset:5120
  ds_read_b64_tr_b16 v[200:201], v22 offset:8192
  ds_read_b64_tr_b16 v[202:203], v22 offset:9216
  ds_read_b64_tr_b16 v[204:205], v22 offset:12288
  ds_read_b64_tr_b16 v[206:207], v22 offset:13312
  ds_read_b64_tr_b16 v[208:209], v22 offset:16384
  ds_read_b64_tr_b16 v[210:211], v22 offset:17408
  ds_read_b64_tr_b16 v[212:213], v22 offset:20480
  ds_read_b64_tr_b16 v[214:215], v22 offset:21504
  ds_read_b64_tr_b16 v[216:217], v22 offset:24576
  ds_read_b64_tr_b16 v[218:219], v22 offset:25600
  ds_read_b64_tr_b16 v[220:221], v22 offset:28672
  ds_read_b64_tr_b16 v[222:223], v22 offset:29696
  s_waitcnt lgkmcnt(0)
  s_waitcnt vmcnt(0)
  s_barrier
  ds_read_b64_tr_b16 v[224:225], v22 offset:32768
  ds_read_b64_tr_b16 v[226:227], v22 offset:33792
  ds_read_b64_tr_b16 v[228:229], v22 offset:36864
  ds_read_b64_tr_b16 v[230:231], v22 offset:37888
  ds_read_b64_tr_b16 v[232:233], v22 offset:40960
  ds_read_b64_tr_b16 v[234:235], v22 offset:41984
  ds_read_b64_tr_b16 v[236:237], v22 offset:45056
  ds_read_b64_tr_b16 v[238:239], v22 offset:46080
  ds_read_b64_tr_b16 v[240:241], v22 offset:49152
  ds_read_b64_tr_b16 v[242:243], v22 offset:50176
  ds_read_b64_tr_b16 v[244:245], v22 offset:53248
  ds_read_b64_tr_b16 v[246:247], v22 offset:54272
  ds_read_b64_tr_b16 v[248:249], v22 offset:57344
  ds_read_b64_tr_b16 v[250:251], v22 offset:58368
  ds_read_b64_tr_b16 v[252:253], v22 offset:61440
  ds_read_b64_tr_b16 v[254:255], v22 offset:62464
  s_waitcnt lgkmcnt(0)
  s_branch q_ld_84
q_ld_83:
  s_add_u32 s27, s26, 0
  s_add_u32 m0, s28, 0
  s_nop 0
  buffer_load_dwordx4 v20, s[8:11], s27 offen lds
  s_add_u32 m0, s28, 1024
  s_add_u32 s27, s27, 32768
  buffer_load_dwordx4 v20, s[8:11], s27 offen lds
  s_add_u32 m0, s28, 2048
  s_add_u32 s27, s27, 32768
  buffer_load_dwordx4 v21, s[8:11], s27 offen lds
  s_add_u32 m0, s28, 3072
  s_add_u32 s27, s27, 32768
  buffer_load_dwordx4 v21, s[8:11], s27 offen lds
  s_add_u32 m0, s28, 4096
  s_add_u32 s27, s27, 32768
  buffer_load_dwordx4 v20, s[8:11], s27 offen lds
  s_add_u32 m0, s28, 5120
  s_add_u32 s27, s27, 32768
  buffer_load_dwordx4 v20, s[8:11], s27 offen lds
  s_add_u32 m0, s28, 6144
  s_add_u32 s27, s27, 32768
  buffer_load_dwordx4 v21, s[8:11], s27 offen lds
  s_add_u32 m0, s28, 7168
  s_add_u32 s27, s27, 32768
  buffer_load_dwordx4 v21, s[8:11], s27 offen lds
  s_add_u32 s27, s26, 1048576
  s_add_u32 m0, s28, 32768
  s_nop 0
  buffer_load_dwordx4 v20, s[8:11], s27 offen lds
  s_add_u32 m0, s28, 33792
  s_add_u32 s27, s27, 32768
  buffer_load_dwordx4 v20, s[8:11], s27 offen lds
  s_add_u32 m0, s28, 34816
  s_add_u32 s27, s27, 32768
  buffer_load_dwordx4 v21, s[8:11], s27 offen lds
  s_add_u32 m0, s28, 35840
  s_add_u32 s27, s27, 32768
  buffer_load_dwordx4 v21, s[8:11], s27 offen lds
  s_add_u32 m0, s28, 36864
  s_add_u32 s27, s27, 32768
  buffer_load_dwordx4 v20, s[8:11], s27 offen lds
  s_add_u32 m0, s28, 37888
  s_add_u32 s27, s27, 32768
  buffer_load_dwordx4 v20, s[8:11], s27 offen lds
  s_add_u32 m0, s28, 38912
  s_add_u32 s27, s27, 32768
  buffer_load_dwordx4 v21, s[8:11], s27 offen lds
  s_add_u32 m0, s28, 39936
  s_add_u32 s27, s27, 32768
  buffer_load_dwordx4 v21, s[8:11], s27 offen lds
  s_add_u32 s27, s26, 2097152
  s_add_u32 m0, s28, 65536
  s_nop 0
  buffer_load_dwordx4 v20, s[8:11], s27 offen lds
  s_add_u32 m0, s28, 66560
  s_add_u32 s27, s27, 32768
  buffer_load_dwordx4 v20, s[8:11], s27 offen lds
  s_add_u32 m0, s28, 67584
  s_add_u32 s27, s27, 32768
  buffer_load_dwordx4 v21, s[8:11], s27 offen lds
  s_add_u32 m0, s28, 68608
  s_add_u32 s27, s27, 32768
  buffer_load_dwordx4 v21, s[8:11], s27 offen lds
  s_add_u32 m0, s28, 69632
  s_add_u32 s27, s27, 32768
  buffer_load_dwordx4 v20, s[8:11], s27 offen lds
  s_add_u32 m0, s28, 70656
  s_add_u32 s27, s27, 32768
  buffer_load_dwordx4 v20, s[8:11], s27 offen lds
  s_add_u32 m0, s28, 71680
  s_add_u32 s27, s27, 32768
  buffer_load_dwordx4 v21, s[8:11], s27 offen lds
  s_add_u32 m0, s28, 72704
  s_add_u32 s27, s27, 32768
  buffer_load_dwordx4 v21, s[8:11], s27 offen lds
  s_load_dwordx2 s[4:5], s[0:1], 112
  s_load_dwordx2 s[12:13], s[0:1], 104
  s_waitcnt vmcnt(16)
  s_barrier
  s_add_u32 s27, s26, 3145728
  s_add_u32 m0, s28, 98304
  s_nop 0
  buffer_load_dwordx4 v20, s[8:11], s27 offen lds
  s_add_u32 m0, s28, 99328
  s_add_u32 s27, s27, 32768
  buffer_load_dwordx4 v20, s[8:11], s27 offen lds
  s_add_u32 m0, s28, 100352
  s_add_u32 s27, s27, 32768
  buffer_load_dwordx4 v21, s[8:11], s27 offen lds
  s_add_u32 m0, s28, 101376
  s_add_u32 s27, s27, 32768
  buffer_load_dwordx4 v21, s[8:11], s27 offen lds
  s_add_u32 m0, s28, 102400
  s_add_u32 s27, s27, 32768
  buffer_load_dwordx4 v20, s[8:11], s27 offen lds
  s_add_u32 m0, s28, 103424
  s_add_u32 s27, s27, 32768
  buffer_load_dwordx4 v20, s[8:11], s27 offen lds
  s_add_u32 m0, s28, 104448
  s_add_u32 s27, s27, 32768
  buffer_load_dwordx4 v21, s[8:11], s27 offen lds
  s_add_u32 m0, s28, 105472
  s_add_u32 s27, s27, 32768
  buffer_load_dwordx4 v21, s[8:11], s27 offen lds
  ds_read_b64_tr_b16 a[128:129], v22 offset:0
  ds_read_b64_tr_b16 a[130:131], v22 offset:1024
  ds_read_b64_tr_b16 a[132:133], v22 offset:4096
  ds_read_b64_tr_b16 a[134:135], v22 offset:5120
  ds_read_b64_tr_b16 a[136:137], v22 offset:8192
  ds_read_b64_tr_b16 a[138:139], v22 offset:9216
  ds_read_b64_tr_b16 a[140:141], v22 offset:12288
  ds_read_b64_tr_b16 a[142:143], v22 offset:13312
  ds_read_b64_tr_b16 a[144:145], v22 offset:16384
  ds_read_b64_tr_b16 a[146:147], v22 offset:17408
  ds_read_b64_tr_b16 a[148:149], v22 offset:20480
  ds_read_b64_tr_b16 a[150:151], v22 offset:21504
  ds_read_b64_tr_b16 a[152:153], v22 offset:24576
  ds_read_b64_tr_b16 a[154:155], v22 offset:25600
  ds_read_b64_tr_b16 a[156:157], v22 offset:28672
  ds_read_b64_tr_b16 a[158:159], v22 offset:29696
  s_waitcnt lgkmcnt(0)
  s_waitcnt vmcnt(16)
  s_barrier
  s_add_u32 s27, s26, 0
  s_add_u32 m0, s28, 131072
  s_nop 0
  buffer_load_dwordx4 v20, s[64:67], s27 offen lds
  s_add_u32 m0, s28, 132096
  s_add_u32 s27, s27, 32768
  buffer_load_dwordx4 v20, s[64:67], s27 offen lds
  s_add_u32 m0, s28, 133120
  s_add_u32 s27, s27, 32768
  buffer_load_dwordx4 v21, s[64:67], s27 offen lds
  s_add_u32 m0, s28, 134144
  s_add_u32 s27, s27, 32768
  buffer_load_dwordx4 v21, s[64:67], s27 offen lds
  s_add_u32 m0, s28, 135168
  s_add_u32 s27, s27, 32768
  buffer_load_dwordx4 v20, s[64:67], s27 offen lds
  s_add_u32 m0, s28, 136192
  s_add_u32 s27, s27, 32768
  buffer_load_dwordx4 v20, s[64:67], s27 offen lds
  s_add_u32 m0, s28, 137216
  s_add_u32 s27, s27, 32768
  buffer_load_dwordx4 v21, s[64:67], s27 offen lds
  s_add_u32 m0, s28, 138240
  s_add_u32 s27, s27, 32768
  buffer_load_dwordx4 v21, s[64:67], s27 offen lds
  ds_read_b64_tr_b16 a[160:161], v22 offset:32768
  ds_read_b64_tr_b16 a[162:163], v22 offset:33792
  ds_read_b64_tr_b16 a[164:165], v22 offset:36864
  ds_read_b64_tr_b16 a[166:167], v22 offset:37888
  ds_read_b64_tr_b16 a[168:169], v22 offset:40960
  ds_read_b64_tr_b16 a[170:171], v22 offset:41984
  ds_read_b64_tr_b16 a[172:173], v22 offset:45056
  ds_read_b64_tr_b16 a[174:175], v22 offset:46080
  ds_read_b64_tr_b16 a[176:177], v22 offset:49152
  ds_read_b64_tr_b16 a[178:179], v22 offset:50176
  ds_read_b64_tr_b16 a[180:181], v22 offset:53248
  ds_read_b64_tr_b16 a[182:183], v22 offset:54272
  ds_read_b64_tr_b16 a[184:185], v22 offset:57344
  ds_read_b64_tr_b16 a[186:187], v22 offset:58368
  ds_read_b64_tr_b16 a[188:189], v22 offset:61440
  ds_read_b64_tr_b16 a[190:191], v22 offset:62464
  s_waitcnt lgkmcnt(0)
  s_waitcnt vmcnt(16)
  s_barrier
  s_add_u32 s27, s26, 1048576
  s_add_u32 m0, s28, 0
  s_nop 0
  buffer_load_dwordx4 v20, s[64:67], s27 offen lds
  s_add_u32 m0, s28, 1024
  s_add_u32 s27, s27, 32768
  buffer_load_dwordx4 v20, s[64:67], s27 offen lds
  s_add_u32 m0, s28, 2048
  s_add_u32 s27, s27, 32768
  buffer_load_dwordx4 v21, s[64:67], s27 offen lds
  s_add_u32 m0, s28, 3072
  s_add_u32 s27, s27, 32768
  buffer_load_dwordx4 v21, s[64:67], s27 offen lds
  s_add_u32 m0, s28, 4096
  s_add_u32 s27, s27, 32768
  buffer_load_dwordx4 v20, s[64:67], s27 offen lds
  s_add_u32 m0, s28, 5120
  s_add_u32 s27, s27, 32768
  buffer_load_dwordx4 v20, s[64:67], s27 offen lds
  s_add_u32 m0, s28, 6144
  s_add_u32 s27, s27, 32768
  buffer_load_dwordx4 v21, s[64:67], s27 offen lds
  s_add_u32 m0, s28, 7168
  s_add_u32 s27, s27, 32768
  buffer_load_dwordx4 v21, s[64:67], s27 offen lds
  ds_read_b64_tr_b16 a[192:193], v23 offset:0
  ds_read_b64_tr_b16 a[194:195], v23 offset:1024
  ds_read_b64_tr_b16 a[196:197], v23 offset:4096
  ds_read_b64_tr_b16 a[198:199], v23 offset:5120
  ds_read_b64_tr_b16 a[200:201], v23 offset:8192
  ds_read_b64_tr_b16 a[202:203], v23 offset:9216
  ds_read_b64_tr_b16 a[204:205], v23 offset:12288
  ds_read_b64_tr_b16 a[206:207], v23 offset:13312
  ds_read_b64_tr_b16 a[208:209], v23 offset:16384
  ds_read_b64_tr_b16 a[210:211], v23 offset:17408
  ds_read_b64_tr_b16 a[212:213], v23 offset:20480
  ds_read_b64_tr_b16 a[214:215], v23 offset:21504
  ds_read_b64_tr_b16 a[216:217], v23 offset:24576
  ds_read_b64_tr_b16 a[218:219], v23 offset:25600
  ds_read_b64_tr_b16 a[220:221], v23 offset:28672
  ds_read_b64_tr_b16 a[222:223], v23 offset:29696
  s_waitcnt lgkmcnt(0)
  s_waitcnt vmcnt(16)
  s_barrier
  s_add_u32 s27, s26, 2097152
  s_add_u32 m0, s28, 32768
  s_nop 0
  buffer_load_dwordx4 v20, s[64:67], s27 offen lds
  s_add_u32 m0, s28, 33792
  s_add_u32 s27, s27, 32768
  buffer_load_dwordx4 v20, s[64:67], s27 offen lds
  s_add_u32 m0, s28, 34816
  s_add_u32 s27, s27, 32768
  buffer_load_dwordx4 v21, s[64:67], s27 offen lds
  s_add_u32 m0, s28, 35840
  s_add_u32 s27, s27, 32768
  buffer_load_dwordx4 v21, s[64:67], s27 offen lds
  s_add_u32 m0, s28, 36864
  s_add_u32 s27, s27, 32768
  buffer_load_dwordx4 v20, s[64:67], s27 offen lds
  s_add_u32 m0, s28, 37888
  s_add_u32 s27, s27, 32768
  buffer_load_dwordx4 v20, s[64:67], s27 offen lds
  s_add_u32 m0, s28, 38912
  s_add_u32 s27, s27, 32768
  buffer_load_dwordx4 v21, s[64:67], s27 offen lds
  s_add_u32 m0, s28, 39936
  s_add_u32 s27, s27, 32768
  buffer_load_dwordx4 v21, s[64:67], s27 offen lds
  ds_read_b64_tr_b16 a[224:225], v23 offset:32768
  ds_read_b64_tr_b16 a[226:227], v23 offset:33792
  ds_read_b64_tr_b16 a[228:229], v23 offset:36864
  ds_read_b64_tr_b16 a[230:231], v23 offset:37888
  ds_read_b64_tr_b16 a[232:233], v23 offset:40960
  ds_read_b64_tr_b16 a[234:235], v23 offset:41984
  ds_read_b64_tr_b16 a[236:237], v23 offset:45056
  ds_read_b64_tr_b16 a[238:239], v23 offset:46080
  ds_read_b64_tr_b16 a[240:241], v23 offset:49152
  ds_read_b64_tr_b16 a[242:243], v23 offset:50176
  ds_read_b64_tr_b16 a[244:245], v23 offset:53248
  ds_read_b64_tr_b16 a[246:247], v23 offset:54272
  ds_read_b64_tr_b16 a[248:249], v23 offset:57344
  ds_read_b64_tr_b16 a[250:251], v23 offset:58368
  ds_read_b64_tr_b16 a[252:253], v23 offset:61440
  ds_read_b64_tr_b16 a[254:255], v23 offset:62464
  s_waitcnt lgkmcnt(0)
  s_waitcnt vmcnt(16)
  s_barrier
  s_add_u32 s27, s26, 3145728
  s_add_u32 m0, s28, 65536
  s_nop 0
  buffer_load_dwordx4 v20, s[64:67], s27 offen lds
  s_add_u32 m0, s28, 66560
  s_add_u32 s27, s27, 32768
  buffer_load_dwordx4 v20, s[64:67], s27 offen lds
  s_add_u32 m0, s28, 67584
  s_add_u32 s27, s27, 32768
  buffer_load_dwordx4 v21, s[64:67], s27 offen lds
  s_add_u32 m0, s28, 68608
  s_add_u32 s27, s27, 32768
  buffer_load_dwordx4 v21, s[64:67], s27 offen lds
  s_add_u32 m0, s28, 69632
  s_add_u32 s27, s27, 32768
  buffer_load_dwordx4 v20, s[64:67], s27 offen lds
  s_add_u32 m0, s28, 70656
  s_add_u32 s27, s27, 32768
  buffer_load_dwordx4 v20, s[64:67], s27 offen lds
  s_add_u32 m0, s28, 71680
  s_add_u32 s27, s27, 32768
  buffer_load_dwordx4 v21, s[64:67], s27 offen lds
  s_add_u32 m0, s28, 72704
  s_add_u32 s27, s27, 32768
  buffer_load_dwordx4 v21, s[64:67], s27 offen lds
  ds_read_b64_tr_b16 v[128:129], v24 offset:0
  ds_read_b64_tr_b16 v[130:131], v24 offset:1024
  ds_read_b64_tr_b16 v[132:133], v24 offset:4096
  ds_read_b64_tr_b16 v[134:135], v24 offset:5120
  ds_read_b64_tr_b16 v[136:137], v24 offset:8192
  ds_read_b64_tr_b16 v[138:139], v24 offset:9216
  ds_read_b64_tr_b16 v[140:141], v24 offset:12288
  ds_read_b64_tr_b16 v[142:143], v24 offset:13312
  ds_read_b64_tr_b16 v[144:145], v24 offset:16384
  ds_read_b64_tr_b16 v[146:147], v24 offset:17408
  ds_read_b64_tr_b16 v[148:149], v24 offset:20480
  ds_read_b64_tr_b16 v[150:151], v24 offset:21504
  ds_read_b64_tr_b16 v[152:153], v24 offset:24576
  ds_read_b64_tr_b16 v[154:155], v24 offset:25600
  ds_read_b64_tr_b16 v[156:157], v24 offset:28672
  ds_read_b64_tr_b16 v[158:159], v24 offset:29696
  s_waitcnt lgkmcnt(0)
  s_waitcnt vmcnt(16)
  s_barrier
  s_add_u32 s27, s26, 0
  s_add_u32 m0, s28, 98304
  s_nop 0
  buffer_load_dwordx4 v20, s[68:71], s27 offen lds
  s_add_u32 m0, s28, 99328
  s_add_u32 s27, s27, 32768
  buffer_load_dwordx4 v20, s[68:71], s27 offen lds
  s_add_u32 m0, s28, 100352
  s_add_u32 s27, s27, 32768
  buffer_load_dwordx4 v21, s[68:71], s27 offen lds
  s_add_u32 m0, s28, 101376
  s_add_u32 s27, s27, 32768
  buffer_load_dwordx4 v21, s[68:71], s27 offen lds
  s_add_u32 m0, s28, 102400
  s_add_u32 s27, s27, 32768
  buffer_load_dwordx4 v20, s[68:71], s27 offen lds
  s_add_u32 m0, s28, 103424
  s_add_u32 s27, s27, 32768
  buffer_load_dwordx4 v20, s[68:71], s27 offen lds
  s_add_u32 m0, s28, 104448
  s_add_u32 s27, s27, 32768
  buffer_load_dwordx4 v21, s[68:71], s27 offen lds
  s_add_u32 m0, s28, 105472
  s_add_u32 s27, s27, 32768
  buffer_load_dwordx4 v21, s[68:71], s27 offen lds
  ds_read_b64_tr_b16 v[160:161], v22 offset:0
  ds_read_b64_tr_b16 v[162:163], v22 offset:1024
  ds_read_b64_tr_b16 v[164:165], v22 offset:4096
  ds_read_b64_tr_b16 v[166:167], v22 offset:5120
  ds_read_b64_tr_b16 v[168:169], v22 offset:8192
  ds_read_b64_tr_b16 v[170:171], v22 offset:9216
  ds_read_b64_tr_b16 v[172:173], v22 offset:12288
  ds_read_b64_tr_b16 v[174:175], v22 offset:13312
  ds_read_b64_tr_b16 v[176:177], v22 offset:16384
  ds_read_b64_tr_b16 v[178:179], v22 offset:17408
  ds_read_b64_tr_b16 v[180:181], v22 offset:20480
  ds_read_b64_tr_b16 v[182:183], v22 offset:21504
  ds_read_b64_tr_b16 v[184:185], v22 offset:24576
  ds_read_b64_tr_b16 v[186:187], v22 offset:25600
  ds_read_b64_tr_b16 v[188:189], v22 offset:28672
  ds_read_b64_tr_b16 v[190:191], v22 offset:29696
  s_waitcnt lgkmcnt(0)
  s_waitcnt vmcnt(16)
  s_barrier
  s_add_u32 s27, s26, 1048576
  s_add_u32 m0, s28, 131072
  s_nop 0
  buffer_load_dwordx4 v20, s[68:71], s27 offen lds
  s_add_u32 m0, s28, 132096
  s_add_u32 s27, s27, 32768
  buffer_load_dwordx4 v20, s[68:71], s27 offen lds
  s_add_u32 m0, s28, 133120
  s_add_u32 s27, s27, 32768
  buffer_load_dwordx4 v21, s[68:71], s27 offen lds
  s_add_u32 m0, s28, 134144
  s_add_u32 s27, s27, 32768
  buffer_load_dwordx4 v21, s[68:71], s27 offen lds
  s_add_u32 m0, s28, 135168
  s_add_u32 s27, s27, 32768
  buffer_load_dwordx4 v20, s[68:71], s27 offen lds
  s_add_u32 m0, s28, 136192
  s_add_u32 s27, s27, 32768
  buffer_load_dwordx4 v20, s[68:71], s27 offen lds
  s_add_u32 m0, s28, 137216
  s_add_u32 s27, s27, 32768
  buffer_load_dwordx4 v21, s[68:71], s27 offen lds
  s_add_u32 m0, s28, 138240
  s_add_u32 s27, s27, 32768
  buffer_load_dwordx4 v21, s[68:71], s27 offen lds
  ds_read_b64_tr_b16 v[192:193], v22 offset:32768
  ds_read_b64_tr_b16 v[194:195], v22 offset:33792
  ds_read_b64_tr_b16 v[196:197], v22 offset:36864
  ds_read_b64_tr_b16 v[198:199], v22 offset:37888
  ds_read_b64_tr_b16 v[200:201], v22 offset:40960
  ds_read_b64_tr_b16 v[202:203], v22 offset:41984
  ds_read_b64_tr_b16 v[204:205], v22 offset:45056
  ds_read_b64_tr_b16 v[206:207], v22 offset:46080
  ds_read_b64_tr_b16 v[208:209], v22 offset:49152
  ds_read_b64_tr_b16 v[210:211], v22 offset:50176
  ds_read_b64_tr_b16 v[212:213], v22 offset:53248
  ds_read_b64_tr_b16 v[214:215], v22 offset:54272
  ds_read_b64_tr_b16 v[216:217], v22 offset:57344
  ds_read_b64_tr_b16 v[218:219], v22 offset:58368
  ds_read_b64_tr_b16 v[220:221], v22 offset:61440
  ds_read_b64_tr_b16 v[222:223], v22 offset:62464
  s_waitcnt lgkmcnt(0)
  s_waitcnt vmcnt(16)
  s_barrier
  s_add_u32 s27, s26, 2097152
  s_add_u32 m0, s28, 0
  s_nop 0
  buffer_load_dwordx4 v20, s[68:71], s27 offen lds
  s_add_u32 m0, s28, 1024
  s_add_u32 s27, s27, 32768
  buffer_load_dwordx4 v20, s[68:71], s27 offen lds
  s_add_u32 m0, s28, 2048
  s_add_u32 s27, s27, 32768
  buffer_load_dwordx4 v21, s[68:71], s27 offen lds
  s_add_u32 m0, s28, 3072
  s_add_u32 s27, s27, 32768
  buffer_load_dwordx4 v21, s[68:71], s27 offen lds
  s_add_u32 m0, s28, 4096
  s_add_u32 s27, s27, 32768
  buffer_load_dwordx4 v20, s[68:71], s27 offen lds
  s_add_u32 m0, s28, 5120
  s_add_u32 s27, s27, 32768
  buffer_load_dwordx4 v20, s[68:71], s27 offen lds
  s_add_u32 m0, s28, 6144
  s_add_u32 s27, s27, 32768
  buffer_load_dwordx4 v21, s[68:71], s27 offen lds
  s_add_u32 m0, s28, 7168
  s_add_u32 s27, s27, 32768
  buffer_load_dwordx4 v21, s[68:71], s27 offen lds
  ds_read_b64_tr_b16 v[224:225], v23 offset:0
  ds_read_b64_tr_b16 v[226:227], v23 offset:1024
  ds_read_b64_tr_b16 v[228:229], v23 offset:4096
  ds_read_b64_tr_b16 v[230:231], v23 offset:5120
  ds_read_b64_tr_b16 v[232:233], v23 offset:8192
  ds_read_b64_tr_b16 v[234:235], v23 offset:9216
  ds_read_b64_tr_b16 v[236:237], v23 offset:12288
  ds_read_b64_tr_b16 v[238:239], v23 offset:13312
  ds_read_b64_tr_b16 v[240:241], v23 offset:16384
  ds_read_b64_tr_b16 v[242:243], v23 offset:17408
  ds_read_b64_tr_b16 v[244:245], v23 offset:20480
  ds_read_b64_tr_b16 v[246:247], v23 offset:21504
  ds_read_b64_tr_b16 v[248:249], v23 offset:24576
  ds_read_b64_tr_b16 v[250:251], v23 offset:25600
  ds_read_b64_tr_b16 v[252:253], v23 offset:28672
  ds_read_b64_tr_b16 v[254:255], v23 offset:29696
  s_waitcnt lgkmcnt(0)
  s_waitcnt vmcnt(16)
  s_barrier
  s_add_u32 s27, s26, 3145728
  s_add_u32 m0, s28, 32768
  s_nop 0
  buffer_load_dwordx4 v20, s[68:71], s27 offen lds
  s_add_u32 m0, s28, 33792
  s_add_u32 s27, s27, 32768
  buffer_load_dwordx4 v20, s[68:71], s27 offen lds
  s_add_u32 m0, s28, 34816
  s_add_u32 s27, s27, 32768
  buffer_load_dwordx4 v21, s[68:71], s27 offen lds
  s_add_u32 m0, s28, 35840
  s_add_u32 s27, s27, 32768
  buffer_load_dwordx4 v21, s[68:71], s27 offen lds
  s_add_u32 m0, s28, 36864
  s_add_u32 s27, s27, 32768
  buffer_load_dwordx4 v20, s[68:71], s27 offen lds
  s_add_u32 m0, s28, 37888
  s_add_u32 s27, s27, 32768
  buffer_load_dwordx4 v20, s[68:71], s27 offen lds
  s_add_u32 m0, s28, 38912
  s_add_u32 s27, s27, 32768
  buffer_load_dwordx4 v21, s[68:71], s27 offen lds
  s_add_u32 m0, s28, 39936
  s_add_u32 s27, s27, 32768
  buffer_load_dwordx4 v21, s[68:71], s27 offen lds
  ds_read_b64_tr_b16 a[0:1], v23 offset:32768
  ds_read_b64_tr_b16 a[2:3], v23 offset:33792
  ds_read_b64_tr_b16 a[4:5], v23 offset:36864
  ds_read_b64_tr_b16 a[6:7], v23 offset:37888
  ds_read_b64_tr_b16 a[8:9], v23 offset:40960
  ds_read_b64_tr_b16 a[10:11], v23 offset:41984
  ds_read_b64_tr_b16 a[12:13], v23 offset:45056
  ds_read_b64_tr_b16 a[14:15], v23 offset:46080
  ds_read_b64_tr_b16 a[16:17], v23 offset:49152
  ds_read_b64_tr_b16 a[18:19], v23 offset:50176
  ds_read_b64_tr_b16 a[20:21], v23 offset:53248
  ds_read_b64_tr_b16 a[22:23], v23 offset:54272
  ds_read_b64_tr_b16 a[24:25], v23 offset:57344
  ds_read_b64_tr_b16 a[26:27], v23 offset:58368
  ds_read_b64_tr_b16 a[28:29], v23 offset:61440
  ds_read_b64_tr_b16 a[30:31], v23 offset:62464
  s_waitcnt lgkmcnt(0)
  s_waitcnt vmcnt(16)
  s_barrier
  ds_read_b64_tr_b16 a[32:33], v24 offset:0
  ds_read_b64_tr_b16 a[34:35], v24 offset:1024
  ds_read_b64_tr_b16 a[36:37], v24 offset:4096
  ds_read_b64_tr_b16 a[38:39], v24 offset:5120
  ds_read_b64_tr_b16 a[40:41], v24 offset:8192
  ds_read_b64_tr_b16 a[42:43], v24 offset:9216
  ds_read_b64_tr_b16 a[44:45], v24 offset:12288
  ds_read_b64_tr_b16 a[46:47], v24 offset:13312
  ds_read_b64_tr_b16 a[48:49], v24 offset:16384
  ds_read_b64_tr_b16 a[50:51], v24 offset:17408
  ds_read_b64_tr_b16 a[52:53], v24 offset:20480
  ds_read_b64_tr_b16 a[54:55], v24 offset:21504
  ds_read_b64_tr_b16 a[56:57], v24 offset:24576
  ds_read_b64_tr_b16 a[58:59], v24 offset:25600
  ds_read_b64_tr_b16 a[60:61], v24 offset:28672
  ds_read_b64_tr_b16 a[62:63], v24 offset:29696
  s_waitcnt lgkmcnt(0)
  s_waitcnt vmcnt(8)
  s_barrier
  ds_read_b64_tr_b16 a[64:65], v22 offset:0
  ds_read_b64_tr_b16 a[66:67], v22 offset:1024
  ds_read_b64_tr_b16 a[68:69], v22 offset:4096
  ds_read_b64_tr_b16 a[70:71], v22 offset:5120
  ds_read_b64_tr_b16 a[72:73], v22 offset:8192
  ds_read_b64_tr_b16 a[74:75], v22 offset:9216
  ds_read_b64_tr_b16 a[76:77], v22 offset:12288
  ds_read_b64_tr_b16 a[78:79], v22 offset:13312
  ds_read_b64_tr_b16 a[80:81], v22 offset:16384
  ds_read_b64_tr_b16 a[82:83], v22 offset:17408
  ds_read_b64_tr_b16 a[84:85], v22 offset:20480
  ds_read_b64_tr_b16 a[86:87], v22 offset:21504
  ds_read_b64_tr_b16 a[88:89], v22 offset:24576
  ds_read_b64_tr_b16 a[90:91], v22 offset:25600
  ds_read_b64_tr_b16 a[92:93], v22 offset:28672
  ds_read_b64_tr_b16 a[94:95], v22 offset:29696
  s_waitcnt lgkmcnt(0)
  s_waitcnt vmcnt(0)
  s_barrier
  ds_read_b64_tr_b16 a[96:97], v22 offset:32768
  ds_read_b64_tr_b16 a[98:99], v22 offset:33792
  ds_read_b64_tr_b16 a[100:101], v22 offset:36864
  ds_read_b64_tr_b16 a[102:103], v22 offset:37888
  ds_read_b64_tr_b16 a[104:105], v22 offset:40960
  ds_read_b64_tr_b16 a[106:107], v22 offset:41984
  ds_read_b64_tr_b16 a[108:109], v22 offset:45056
  ds_read_b64_tr_b16 a[110:111], v22 offset:46080
  ds_read_b64_tr_b16 a[112:113], v22 offset:49152
  ds_read_b64_tr_b16 a[114:115], v22 offset:50176
  ds_read_b64_tr_b16 a[116:117], v22 offset:53248
  ds_read_b64_tr_b16 a[118:119], v22 offset:54272
  ds_read_b64_tr_b16 a[120:121], v22 offset:57344
  ds_read_b64_tr_b16 a[122:123], v22 offset:58368
  ds_read_b64_tr_b16 a[124:125], v22 offset:61440
  ds_read_b64_tr_b16 a[126:127], v22 offset:62464
  s_waitcnt lgkmcnt(0)
q_ld_84:
  s_waitcnt lgkmcnt(0)
  s_barrier
  v_mbcnt_lo_u32_b32 v20, -1, 0
  v_and_b32 v20, 0, v20
  v_add_lshl_u32 v20, v20, 1, 2
  s_mov_b32 s26, 0
g_wt_85:
  global_load_dword v21, v20, s[12:13] offset:128 sc1
  s_add_u32 s26, s26, 1
  s_cmp_gt_u32 s26, 1048576
  s_cbranch_scc1 L_end
  s_waitcnt vmcnt(0)
  v_cmp_eq_u32 vcc, 0, v21
  v_readfirstlane_b32 s27, v21
  s_cbranch_vccnz g_wt_85
  v_lshrrev_b32 v7, 7, v0
  v_lshlrev_b32 v7, 12, v7
  v_and_b32 v2, 1023, v9
  s_lshl_b32 s26, s17, 10
  v_add3_u32 v7, v7, v2, s26
  v_mov_b32 v116, 0
  s_mov_b32 s47, s60
  s_add_u32 s76, s60, 3
  s_add_u32 s41, s60, 64
  s_mov_b32 s40, 18
  s_mov_b32 s42, 0
  s_mov_b32 s48, 0
  s_mov_b32 s49, 268435456
  s_mov_b32 s43, 268435456
  s_mov_b32 s50, 32768
  s_mov_b32 s56, 1
  s_mov_b32 s61, 0
  s_mov_b32 s62, 0
  s_lshl_b32 s54, s17, 13
  s_mov_b32 s50, 0
  v_mov_b32 v4, 1
q_slow_86:
  s_nop 1
  s_nop 7
  v_cvt_pk_bf16_f32 v100, v52, v53
  v_cvt_pk_bf16_f32 v101, v54, v55
  v_cvt_pk_bf16_f32 v102, v60, v61
  v_cvt_pk_bf16_f32 v103, v62, v63
  v_cvt_pk_bf16_f32 v104, v56, v57
  v_cvt_pk_bf16_f32 v105, v58, v59
  v_cvt_pk_bf16_f32 v106, v64, v65
  v_cvt_pk_bf16_f32 v107, v66, v67
  s_waitcnt vmcnt(0)
  s_mov_b64 exec, 1
  buffer_store_dword v4, off, s[4:7], s49 sc1
  s_mov_b64 exec, -1
  buffer_store_dwordx4 v[100:103], v8, s[4:7], s43 offen offset:0 sc1
  buffer_store_dwordx4 v[104:107], v8, s[4:7], s43 offen offset:512 sc1
  s_mov_b32 s43, 268435456
  s_xor_b32 s50, s50, 32768
q_nxt_96:
  s_cmp_ge_u32 s47, 128
  s_cbranch_scc1 q_end_87
  s_cmp_lg_u32 s48, 0
  s_cbranch_scc1 q_have_88
  s_mov_b32 s53, 0
q_poll_89:
  s_cmp_lt_u32 s47, 64
  s_cselect_b32 s26, 2, 0
  s_add_u32 s26, s26, s47
  s_lshl_b32 s26, s26, 12
  s_add_u32 s26, s26, 243261440
  s_mov_b64 exec, 0xffffff
  buffer_load_dword v116, v7, s[4:7], s26 offen sc1
  s_mov_b64 exec, -1
  s_add_u32 s53, s53, 1
  s_cmp_gt_u32 s53, 1048576
  s_cbranch_scc1 q_fail_90
  s_waitcnt vmcnt(0)
  s_mov_b64 exec, 3
  buffer_store_dword v4, v0, s[4:7], s49 offen sc1
  s_mov_b64 exec, -1
  s_mov_b32 s49, 268435456
  v_cmp_eq_u32 vcc, 0, v116
  s_nop 0
  s_and_b32 s26, vcc_lo, 0xffffff
  s_cbranch_scc1 q_poll_89
  s_and_b32 s63, s47, 127
  s_lshl_b32 s63, s63, 15
  s_xor_b32 s27, s50, 32768
  s_add_u32 m0, s27, s54
  s_add_u32 s63, s63, s54
  s_add_u32 s63, s63, 6291456
  buffer_load_dwordx4 v12, s[4:7], s63 offen offset:0 sc1 lds
  buffer_load_dwordx4 v13, s[4:7], s63 offen offset:1024 sc1 lds
  buffer_load_dwordx4 v14, s[4:7], s63 offen offset:2048 sc1 lds
  buffer_load_dwordx4 v15, s[4:7], s63 offen offset:3072 sc1 lds
  s_add_u32 m0, m0, 4096
  s_add_u32 s63, s63, 4096
  buffer_load_dwordx4 v16, s[4:7], s63 offen offset:0 sc1 lds
  buffer_load_dwordx4 v17, s[4:7], s63 offen offset:1024 sc1 lds
  buffer_load_dwordx4 v18, s[4:7], s63 offen offset:2048 sc1 lds
  buffer_load_dwordx4 v19, s[4:7], s63 offen offset:3072 sc1 lds
  v_cmp_eq_u32 vcc, 0, v116
  v_max_u32_dpp v117, v116, v116 quad_perm:[1,0,3,2] row_mask:0xf bank_mask:0xf
  s_and_b32 s48, vcc_lo, 0xffffff
  s_cselect_b32 s48, 0, -1
  v_max_u32_dpp v117, v117, v117 quad_perm:[2,3,0,1] row_mask:0xf bank_mask:0xf
  s_nop 1
  v_max_u32_dpp v117, v117, v117 row_half_mirror row_mask:0xf bank_mask:0xf
  v_and_b32 v117, s48, v117
q_have_88:
  ds_write_b32 v118, v117 offset:256
  s_xor_b32 s50, s50, 32768
  s_waitcnt lgkmcnt(0)
  s_barrier
  ds_read_b128 v[108:111], v119 offset:256
  s_cmp_lt_u32 s47, 64
  s_cbranch_scc1 q_nopre_92
  s_waitcnt lgkmcnt(0)
  v_min3_u32 v112, v108, v109, v110
  v_max3_u32 v108, v108, v109, v110
  v_min_u32 v112, v112, v111
  v_max_u32 v108, v108, v111
  v_readfirstlane_b32 s45, v112
  v_readlane_b32 s28, v108, 0
  v_readlane_b32 s29, v108, 1
  v_readlane_b32 s30, v108, 2
  s_cmp_gt_u32 s28, s56
  s_addc_u32 s42, s42, s42
  s_max_u32 s56, s56, s28
  s_and_b32 s26, s42, 1
  s_cselect_b32 s26, s40, 0
  s_cmp_gt_u32 s26, 10
  s_subb_u32 s40, s40, 0
  s_cmp_gt_u32 s29, s56
  s_addc_u32 s42, s42, s42
  s_max_u32 s56, s56, s29
  s_and_b32 s26, s42, 1
  s_cselect_b32 s26, s40, 0
  s_cmp_gt_u32 s26, 10
  s_subb_u32 s40, s40, 0
  s_cmp_gt_u32 s30, s56
  s_addc_u32 s42, s42, s42
  s_max_u32 s56, s56, s30
  s_add_u32 s76, s47, s40
  s_add_u32 s41, s47, 3
  s_sub_u32 s76, s76, 64
  s_and_b32 s26, s42, 1
  s_cselect_b32 s26, s40, 0
  s_cmp_gt_u32 s26, 10
  s_cselect_b32 s76, 64, s76
  s_subb_u32 s40, s40, 0
  s_cmp_lt_u32 s76, 64
  s_cselect_b32 s76, s76, s41
  s_bitcmp1_b32 s42, 0
  s_cbranch_scc1 q_fork_93
q_nopre_92:
  s_waitcnt vmcnt(0)
  s_sub_u32 s26, s47, s60
  s_cmp_lg_u32 s26, 15
  s_cbranch_scc1 q_cold_94
  v_mbcnt_lo_u32_b32 v20, -1, 0
  v_and_b32 v20, 0, v20
  v_add_lshl_u32 v20, v20, 2, 2
  s_mov_b32 s26, 0
g_wt_101:
  global_load_dword v21, v20, s[12:13] offset:128 sc1
  s_add_u32 s26, s26, 1
  s_cmp_gt_u32 s26, 1048576
  s_cbranch_scc1 L_end
  s_waitcnt vmcnt(0)
  v_cmp_eq_u32 vcc, 0, v21
  v_readfirstlane_b32 s27, v21
  s_cbranch_vccnz g_wt_101
  s_load_dwordx2 s[64:65], s[0:1], 72
  s_load_dwordx2 s[68:69], s[0:1], 80
  s_load_dwordx2 s[8:9], s[0:1], 88
  s_mov_b32 s66, 1835008
  s_mov_b32 s70, 1835008
  s_mov_b32 s10, 1835008
  v_lshrrev_b32 v2, 7, v0
  v_and_b32 v3, 0x70, v0
  v_mul_u32_u24 v6, 57344, v2
  v_add_u32 v6, v6, v3
  v_cmp_eq_u32 vcc, 0x70, v3
  v_mov_b32 v3, 0x7ff00000
  s_nop 0
  v_cndmask_b32 v6, v6, v3, vcc
  v_lshrrev_b32 v2, 8, v0
  v_mul_u32_u24 v7, 14336, v2
  v_and_b32 v3, 0xf0, v0
  v_add_u32 v7, v7, v3
  s_mul_i32 s34, s17, 458752
  s_mul_i32 s27, s16, 112
  s_add_u32 s34, s34, s27
  s_mul_i32 s35, s16, 57344
  s_lshl_b32 s27, s17, 8
  s_add_u32 s35, s35, s27
  s_waitcnt lgkmcnt(0)
  s_mul_i32 s26, s17, 23552
  s_add_u32 m0, s26, 65536
  s_add_u32 s36, s34, 0
  buffer_load_dwordx4 v6, s[64:67], s36 offen lds
  s_add_u32 m0, m0, 1024
  s_add_u32 s36, s34, 0
  buffer_load_dwordx4 v6, s[68:71], s36 offen lds
  s_add_u32 m0, m0, 1024
  s_add_u32 s36, s34, 3584
  buffer_load_dwordx4 v6, s[64:67], s36 offen lds
  s_add_u32 m0, m0, 1024
  s_add_u32 s36, s34, 3584
  buffer_load_dwordx4 v6, s[68:71], s36 offen lds
  s_add_u32 m0, m0, 1024
  s_add_u32 s36, s34, 7168
  buffer_load_dwordx4 v6, s[64:67], s36 offen lds
  s_add_u32 m0, m0, 1024
  s_add_u32 s36, s34, 7168
  buffer_load_dwordx4 v6, s[68:71], s36 offen lds
  s_add_u32 m0, m0, 1024
  s_add_u32 s36, s34, 10752
  buffer_load_dwordx4 v6, s[64:67], s36 offen lds
  s_add_u32 m0, m0, 1024
  s_add_u32 s36, s34, 10752
  buffer_load_dwordx4 v6, s[68:71], s36 offen lds
  s_add_u32 m0, m0, 1024
  s_add_u32 s36, s34, 14336
  buffer_load_dwordx4 v6, s[64:67], s36 offen lds
  s_add_u32 m0, m0, 1024
  s_add_u32 s36, s34, 14336
  buffer_load_dwordx4 v6, s[68:71], s36 offen lds
  s_add_u32 m0, m0, 1024
  s_add_u32 s36, s34, 17920
  buffer_load_dwordx4 v6, s[64:67], s36 offen lds
  s_add_u32 m0, m0, 1024
  s_add_u32 s36, s34, 17920
  buffer_load_dwordx4 v6, s[68:71], s36 offen lds
  s_add_u32 m0, m0, 1024
  s_add_u32 s36, s34, 21504
  buffer_load_dwordx4 v6, s[64:67], s36 offen lds
  s_add_u32 m0, m0, 1024
  s_add_u32 s36, s34, 21504
  buffer_load_dwordx4 v6, s[68:71], s36 offen lds
  s_add_u32 m0, m0, 1024
  s_add_u32 s36, s34, 25088
  buffer_load_dwordx4 v6, s[64:67], s36 offen lds
  s_add_u32 m0, m0, 1024
  s_add_u32 s36, s34, 25088
  buffer_load_dwordx4 v6, s[68:71], s36 offen lds
  s_add_u32 m0, m0, 1024
  s_add_u32 s36, s34, 28672
  buffer_load_dwordx4 v6, s[64:67], s36 offen lds
  s_add_u32 m0, m0, 1024
  s_add_u32 s36, s34, 28672
  buffer_load_dwordx4 v6, s[68:71], s36 offen lds
  s_add_u32 m0, m0, 1024
  s_add_u32 s36, s34, 32256
  buffer_load_dwordx4 v6, s[64:67], s36 offen lds
  s_add_u32 m0, m0, 1024
  s_add_u32 s36, s34, 32256
  buffer_load_dwordx4 v6, s[68:71], s36 offen lds
  s_add_u32 m0, m0, 1024
  s_add_u32 s36, s34, 35840
  buffer_load_dwordx4 v6, s[64:67], s36 offen lds
  s_add_u32 m0, m0, 1024
  s_add_u32 s36, s34, 35840
  buffer_load_dwordx4 v6, s[68:71], s36 offen lds
  s_add_u32 m0, m0, 1024
  s_add_u32 s36, s34, 39424
  buffer_load_dwordx4 v6, s[64:67], s36 offen lds
  s_add_u32 m0, m0, 1024
  v_lshrrev_b32 v7, 7, v0
  v_lshlrev_b32 v7, 12, v7
  v_and_b32 v2, 1023, v9
  s_lshl_b32 s26, s17, 10
  v_add3_u32 v7, v7, v2, s26
  v_mov_b32 v116, 0
q_cold_94:
  s_waitcnt lgkmcnt(0)
  s_barrier
  s_cmp_lg_u32 s50, 0
  s_cbranch_scc1 q_c1_98
q_c0_97:
  ds_read_b128 v[68:71], v120 offset:0
  ds_read_b128 v[72:75], v121 offset:0
  ds_read_b128 v[76:79], v122 offset:0
q_w0_99:
  s_waitcnt lgkmcnt(2)
  v_mfma_f32_32x32x16_bf16 v[20:35], v[128:131], v[68:71], 0
  ds_read_b128 v[80:83], v123 offset:0
  s_mov_b32 s46, s47
  s_mov_b32 s47, s76
  s_lshl_b32 s52, s46, 7
  s_add_u32 s52, s52, s57
  v_mfma_f32_32x32x16_bf16 v[36:51], v[68:71], a[0:3], 0
  s_waitcnt vmcnt(0)
  s_mov_b64 exec, 1
  buffer_store_dword v4, off, s[4:7], s49 sc1
  s_mov_b64 exec, -1
  s_lshl_b32 s44, s52, 12
  s_waitcnt lgkmcnt(2)
  v_mfma_f32_32x32x16_bf16 v[20:35], v[132:135], v[72:75], v[20:35]
  ds_read_b128 v[84:87], v124 offset:0
  s_add_u32 s44, s44, 41943040
  s_lshl_b32 s51, s52, 5
  s_add_u32 s51, s51, 244318208
  s_lshr_b32 s55, s47, 7
  v_mfma_f32_32x32x16_bf16 v[36:51], v[72:75], a[4:7], v[36:51]
  s_sub_u32 s27, s47, s60
  s_cmp_eq_u32 s27, 15
  s_cselect_b32 s55, 1, s55
  s_add_u32 s76, s47, 3
  s_cmp_lt_u32 s76, 18
  s_cselect_b32 s76, s76, s41
  s_waitcnt lgkmcnt(2)
  v_mfma_f32_32x32x16_bf16 v[20:35], v[136:139], v[76:79], v[20:35]
  ds_read_b128 v[88:91], v125 offset:0
  v_cvt_pk_bf16_f32 v100, v52, v53
  v_cvt_pk_bf16_f32 v101, v54, v55
  v_cvt_pk_bf16_f32 v102, v60, v61
  v_cvt_pk_bf16_f32 v103, v62, v63
  v_mfma_f32_32x32x16_bf16 v[36:51], v[76:79], a[8:11], v[36:51]
  buffer_store_dwordx4 v[100:103], v8, s[4:7], s43 offen offset:0 sc1
  v_cvt_pk_bf16_f32 v104, v56, v57
  v_cvt_pk_bf16_f32 v105, v58, v59
  s_waitcnt lgkmcnt(2)
  v_mfma_f32_32x32x16_bf16 v[20:35], v[140:143], v[80:83], v[20:35]
  ds_read_b128 v[92:95], v126 offset:0
  v_cvt_pk_bf16_f32 v106, v64, v65
  v_cvt_pk_bf16_f32 v107, v66, v67
  v_mfma_f32_32x32x16_bf16 v[36:51], v[80:83], a[12:15], v[36:51]
  s_waitcnt lgkmcnt(2)
  v_mfma_f32_32x32x16_bf16 v[20:35], v[144:147], v[84:87], v[20:35]
  ds_read_b128 v[96:99], v127 offset:0
  buffer_store_dwordx4 v[104:107], v8, s[4:7], s43 offen offset:512 sc1
  s_lshl_b32 s43, s52, 11
  v_mfma_f32_32x32x16_bf16 v[36:51], v[84:87], a[16:19], v[36:51]
  s_add_u32 s43, s43, 142606336
  s_waitcnt lgkmcnt(2)
  v_mfma_f32_32x32x16_bf16 v[20:35], v[148:151], v[88:91], v[20:35]
  ds_read_b128 v[68:71], v120 offset:256
  v_mfma_f32_32x32x16_bf16 v[36:51], v[88:91], a[20:23], v[36:51]
  s_waitcnt lgkmcnt(2)
  v_mfma_f32_32x32x16_bf16 v[20:35], v[152:155], v[92:95], v[20:35]
  ds_read_b128 v[72:75], v121 offset:256
  s_cmp_lt_u32 s47, 64
  s_cselect_b32 s26, 2, 0
  s_add_u32 s26, s26, s47
  s_lshl_b32 s26, s26, 12
  v_mfma_f32_32x32x16_bf16 v[36:51], v[92:95], a[24:27], v[36:51]
  s_add_u32 s26, s26, 243261440
  s_mov_b64 exec, 0xffffff
  buffer_load_dword v116, v7, s[4:7], s26 offen sc1
  s_mov_b64 exec, -1
  s_waitcnt lgkmcnt(2)
  v_mfma_f32_32x32x16_bf16 v[20:35], v[156:159], v[96:99], v[20:35]
  ds_read_b128 v[76:79], v122 offset:256
  v_mfma_f32_32x32x16_bf16 v[36:51], v[96:99], a[28:31], v[36:51]
  s_waitcnt lgkmcnt(2)
  v_mfma_f32_32x32x16_bf16 v[20:35], v[160:163], v[68:71], v[20:35]
  ds_read_b128 v[80:83], v123 offset:256
  v_mfma_f32_32x32x16_bf16 v[36:51], v[68:71], a[32:35], v[36:51]
  s_waitcnt lgkmcnt(2)
  v_mfma_f32_32x32x16_bf16 v[20:35], v[164:167], v[72:75], v[20:35]
  ds_read_b128 v[84:87], v124 offset:256
  v_mfma_f32_32x32x16_bf16 v[36:51], v[72:75], a[36:39], v[36:51]
  s_waitcnt lgkmcnt(2)
  v_mfma_f32_32x32x16_bf16 v[20:35], v[168:171], v[76:79], v[20:35]
  ds_read_b128 v[88:91], v125 offset:256
  v_mfma_f32_32x32x16_bf16 v[36:51], v[76:79], a[40:43], v[36:51]
  s_waitcnt lgkmcnt(2)
  v_mfma_f32_32x32x16_bf16 v[20:35], v[172:175], v[80:83], v[20:35]
  ds_read_b128 v[92:95], v126 offset:256
  v_mfma_f32_32x32x16_bf16 v[36:51], v[80:83], a[44:47], v[36:51]
  s_waitcnt lgkmcnt(2)
  v_mfma_f32_32x32x16_bf16 v[20:35], v[176:179], v[84:87], v[20:35]
  ds_read_b128 v[96:99], v127 offset:256
  v_mfma_f32_32x32x16_bf16 v[36:51], v[84:87], a[48:51], v[36:51]
  s_waitcnt lgkmcnt(2)
  v_mfma_f32_32x32x16_bf16 v[20:35], v[180:183], v[88:91], v[20:35]
  ds_read_b128 v[68:71], v120 offset:512
  v_mfma_f32_32x32x16_bf16 v[36:51], v[88:91], a[52:55], v[36:51]
  s_waitcnt lgkmcnt(2)
  v_mfma_f32_32x32x16_bf16 v[20:35], v[184:187], v[92:95], v[20:35]
  ds_read_b128 v[72:75], v121 offset:512
  v_mfma_f32_32x32x16_bf16 v[36:51], v[92:95], a[56:59], v[36:51]
  s_waitcnt lgkmcnt(2)
  v_mfma_f32_32x32x16_bf16 v[20:35], v[188:191], v[96:99], v[20:35]
  ds_read_b128 v[76:79], v122 offset:512
  v_mfma_f32_32x32x16_bf16 v[36:51], v[96:99], a[60:63], v[36:51]
  s_waitcnt lgkmcnt(2)
  v_mfma_f32_32x32x16_bf16 v[20:35], v[192:195], v[68:71], v[20:35]
  ds_read_b128 v[80:83], v123 offset:512
  v_mfma_f32_32x32x16_bf16 v[36:51], v[68:71], a[64:67], v[36:51]
  s_waitcnt lgkmcnt(2)
  v_mfma_f32_32x32x16_bf16 v[20:35], v[196:199], v[72:75], v[20:35]
  ds_read_b128 v[84:87], v124 offset:512
  s_waitcnt vmcnt(0)
  s_mov_b64 exec, 3
  buffer_store_dword v4, v0, s[4:7], s49 offen sc1
  s_mov_b64 exec, -1
  v_mfma_f32_32x32x16_bf16 v[36:51], v[72:75], a[68:71], v[36:51]
  v_cmp_eq_u32 vcc, 0, v116
  v_max_u32_dpp v117, v116, v116 quad_perm:[1,0,3,2] row_mask:0xf bank_mask:0xf
  s_and_b32 s48, vcc_lo, 0xffffff
  s_cselect_b32 s48, 0, -1
  v_max_u32_dpp v117, v117, v117 quad_perm:[2,3,0,1] row_mask:0xf bank_mask:0xf
  s_waitcnt lgkmcnt(2)
  v_mfma_f32_32x32x16_bf16 v[20:35], v[200:203], v[76:79], v[20:35]
  ds_read_b128 v[88:91], v125 offset:512
  s_nop 1
  v_max_u32_dpp v117, v117, v117 row_half_mirror row_mask:0xf bank_mask:0xf
  v_and_b32 v117, s48, v117
  s_cmp_lg_u32 s48, 0
  s_cselect_b32 s28, s47, s46
  v_mfma_f32_32x32x16_bf16 v[36:51], v[76:79], a[72:75], v[36:51]
  s_and_b32 s63, s28, 127
  s_lshl_b32 s63, s63, 15
  s_xor_b32 s27, s50, 32768
  s_add_u32 m0, s27, s54
  s_add_u32 s63, s63, s54
  s_waitcnt lgkmcnt(2)
  v_mfma_f32_32x32x16_bf16 v[20:35], v[204:207], v[80:83], v[20:35]
  ds_read_b128 v[92:95], v126 offset:512
  s_add_u32 s63, s63, 6291456
  buffer_load_dwordx4 v12, s[4:7], s63 offen offset:0 sc1 lds
  v_mfma_f32_32x32x16_bf16 v[36:51], v[80:83], a[76:79], v[36:51]
  s_waitcnt lgkmcnt(2)
  v_mfma_f32_32x32x16_bf16 v[20:35], v[208:211], v[84:87], v[20:35]
  ds_read_b128 v[96:99], v127 offset:512
  v_mfma_f32_32x32x16_bf16 v[36:51], v[84:87], a[80:83], v[36:51]
  buffer_load_dwordx4 v13, s[4:7], s63 offen offset:1024 sc1 lds
  s_waitcnt lgkmcnt(2)
  v_mfma_f32_32x32x16_bf16 v[20:35], v[212:215], v[88:91], v[20:35]
  ds_read_b128 v[68:71], v120 offset:768
  v_mfma_f32_32x32x16_bf16 v[36:51], v[88:91], a[84:87], v[36:51]
  s_waitcnt lgkmcnt(2)
  v_mfma_f32_32x32x16_bf16 v[20:35], v[216:219], v[92:95], v[20:35]
  ds_read_b128 v[72:75], v121 offset:768
  buffer_load_dwordx4 v14, s[4:7], s63 offen offset:2048 sc1 lds
  v_mfma_f32_32x32x16_bf16 v[36:51], v[92:95], a[88:91], v[36:51]
  s_waitcnt lgkmcnt(2)
  v_mfma_f32_32x32x16_bf16 v[20:35], v[220:223], v[96:99], v[20:35]
  ds_read_b128 v[76:79], v122 offset:768
  v_mfma_f32_32x32x16_bf16 v[36:51], v[96:99], a[92:95], v[36:51]
  buffer_load_dwordx4 v15, s[4:7], s63 offen offset:3072 sc1 lds
  s_add_u32 m0, m0, 4096
  s_add_u32 s63, s63, 4096
  s_waitcnt lgkmcnt(2)
  v_mfma_f32_32x32x16_bf16 v[20:35], v[224:227], v[68:71], v[20:35]
  ds_read_b128 v[80:83], v123 offset:768
  v_mfma_f32_32x32x16_bf16 v[36:51], v[68:71], a[96:99], v[36:51]
  s_waitcnt lgkmcnt(2)
  v_mfma_f32_32x32x16_bf16 v[20:35], v[228:231], v[72:75], v[20:35]
  ds_read_b128 v[84:87], v124 offset:768
  buffer_load_dwordx4 v16, s[4:7], s63 offen offset:0 sc1 lds
  v_mfma_f32_32x32x16_bf16 v[36:51], v[72:75], a[100:103], v[36:51]
  s_waitcnt lgkmcnt(2)
  v_mfma_f32_32x32x16_bf16 v[20:35], v[232:235], v[76:79], v[20:35]
  ds_read_b128 v[88:91], v125 offset:768
  v_mfma_f32_32x32x16_bf16 v[36:51], v[76:79], a[104:107], v[36:51]
  buffer_load_dwordx4 v17, s[4:7], s63 offen offset:1024 sc1 lds
  s_waitcnt lgkmcnt(2)
  v_mfma_f32_32x32x16_bf16 v[20:35], v[236:239], v[80:83], v[20:35]
  ds_read_b128 v[92:95], v126 offset:768
  v_mfma_f32_32x32x16_bf16 v[36:51], v[80:83], a[108:111], v[36:51]
  s_waitcnt lgkmcnt(2)
  v_mfma_f32_32x32x16_bf16 v[20:35], v[240:243], v[84:87], v[20:35]
  ds_read_b128 v[96:99], v127 offset:768
  buffer_load_dwordx4 v18, s[4:7], s63 offen offset:2048 sc1 lds
  v_mfma_f32_32x32x16_bf16 v[36:51], v[84:87], a[112:115], v[36:51]
  s_waitcnt lgkmcnt(2)
  v_mfma_f32_32x32x16_bf16 v[20:35], v[244:247], v[88:91], v[20:35]
  ds_read_b128 v[68:71], v120 offset:0
  v_mfma_f32_32x32x16_bf16 v[36:51], v[88:91], a[116:119], v[36:51]
  ds_read_b128 v[72:75], v121 offset:0
  buffer_load_dwordx4 v19, s[4:7], s63 offen offset:3072 sc1 lds
  s_mov_b32 s49, s51
  s_waitcnt lgkmcnt(3)
  v_mfma_f32_32x32x16_bf16 v[20:35], v[248:251], v[92:95], v[20:35]
  ds_read_b128 v[76:79], v122 offset:0
  ds_write_b32 v118, v117 offset:0
  v_mfma_f32_32x32x16_bf16 v[36:51], v[92:95], a[120:123], v[36:51]
  ds_read_b128 v[80:83], v123 offset:0
  s_waitcnt lgkmcnt(5)
  v_mfma_f32_32x32x16_bf16 v[20:35], v[252:255], v[96:99], v[20:35]
  ds_read_b128 v[84:87], v124 offset:0
  v_mfma_f32_32x32x16_bf16 v[36:51], v[96:99], a[124:127], v[36:51]
  ds_read_b128 v[88:91], v125 offset:0
  s_waitcnt lgkmcnt(5)
  v_mfma_f32_32x32x16_bf16 v[52:67], a[128:131], v[68:71], 0
  ds_read_b128 v[92:95], v126 offset:0
  v_mfma_f32_32x32x16_bf16 v[52:67], a[132:135], v[72:75], v[52:67]
  ds_read_b128 v[96:99], v127 offset:0
  v_mul_f32 v20, s24, v20
  v_mul_f32 v21, s24, v21
  v_mul_f32 v22, s24, v22
  v_mul_f32 v23, s24, v23
  s_waitcnt lgkmcnt(4)
  v_mfma_f32_32x32x16_bf16 v[52:67], a[136:139], v[76:79], v[52:67]
  ds_read_b128 v[68:71], v120 offset:256
  v_mul_f32 v24, s24, v24
  v_mul_f32 v25, s24, v25
  v_cvt_pk_bf16_f32 v100, v36, v37
  v_cvt_pk_bf16_f32 v101, v38, v39
  v_mfma_f32_32x32x16_bf16 v[52:67], a[140:143], v[80:83], v[52:67]
  ds_read_b128 v[72:75], v121 offset:256
  v_cvt_pk_bf16_f32 v102, v44, v45
  v_cvt_pk_bf16_f32 v103, v46, v47
  buffer_store_dwordx4 v[100:103], v8, s[4:7], s44 offen offset:2048 sc1
  s_waitcnt lgkmcnt(4)
  v_mfma_f32_32x32x16_bf16 v[52:67], a[144:147], v[84:87], v[52:67]
  ds_read_b128 v[76:79], v122 offset:256
  v_cvt_pk_bf16_f32 v104, v40, v41
  v_cvt_pk_bf16_f32 v105, v42, v43
  v_cvt_pk_bf16_f32 v106, v48, v49
  v_cvt_pk_bf16_f32 v107, v50, v51
  v_mfma_f32_32x32x16_bf16 v[52:67], a[148:151], v[88:91], v[52:67]
  ds_read_b128 v[80:83], v123 offset:256
  buffer_store_dwordx4 v[104:107], v8, s[4:7], s44 offen offset:2560 sc1
  v_mul_f32 v26, s24, v26
  s_waitcnt lgkmcnt(4)
  v_mfma_f32_32x32x16_bf16 v[52:67], a[152:155], v[92:95], v[52:67]
  ds_read_b128 v[84:87], v124 offset:256
  v_mul_f32 v27, s24, v27
  v_mul_f32 v28, s24, v28
  v_mul_f32 v29, s24, v29
  v_mul_f32 v30, s24, v30
  v_mfma_f32_32x32x16_bf16 v[52:67], a[156:159], v[96:99], v[52:67]
  ds_read_b128 v[88:91], v125 offset:256
  v_mul_f32 v31, s24, v31
  v_mul_f32 v32, s24, v32
  v_mul_f32 v33, s24, v33
  v_mul_f32 v34, s24, v34
  s_waitcnt lgkmcnt(4)
  v_mfma_f32_32x32x16_bf16 v[52:67], a[160:163], v[68:71], v[52:67]
  ds_read_b128 v[92:95], v126 offset:256
  v_mul_f32 v35, s24, v35
  v_cvt_pk_bf16_f32 v108, v20, v21
  v_cvt_pk_bf16_f32 v109, v22, v23
  v_cvt_pk_bf16_f32 v110, v28, v29
  v_mfma_f32_32x32x16_bf16 v[52:67], a[164:167], v[72:75], v[52:67]
  ds_read_b128 v[96:99], v127 offset:256
  v_cvt_pk_bf16_f32 v111, v30, v31
  buffer_store_dwordx4 v[108:111], v8, s[4:7], s44 offen offset:0 sc1
  s_waitcnt lgkmcnt(4)
  v_mfma_f32_32x32x16_bf16 v[52:67], a[168:171], v[76:79], v[52:67]
  ds_read_b128 v[68:71], v120 offset:512
  v_cvt_pk_bf16_f32 v112, v24, v25
  v_cvt_pk_bf16_f32 v113, v26, v27
  v_cvt_pk_bf16_f32 v114, v32, v33
  v_cvt_pk_bf16_f32 v115, v34, v35
  v_mfma_f32_32x32x16_bf16 v[52:67], a[172:175], v[80:83], v[52:67]
  ds_read_b128 v[72:75], v121 offset:512
  buffer_store_dwordx4 v[112:115], v8, s[4:7], s44 offen offset:512 sc1
  s_waitcnt lgkmcnt(4)
  v_mfma_f32_32x32x16_bf16 v[52:67], a[176:179], v[84:87], v[52:67]
  ds_read_b128 v[76:79], v122 offset:512
  v_mfma_f32_32x32x16_bf16 v[52:67], a[180:183], v[88:91], v[52:67]
  ds_read_b128 v[80:83], v123 offset:512
  s_waitcnt lgkmcnt(4)
  v_mfma_f32_32x32x16_bf16 v[52:67], a[184:187], v[92:95], v[52:67]
  ds_read_b128 v[84:87], v124 offset:512
  v_mfma_f32_32x32x16_bf16 v[52:67], a[188:191], v[96:99], v[52:67]
  ds_read_b128 v[88:91], v125 offset:512
  s_waitcnt lgkmcnt(4)
  v_mfma_f32_32x32x16_bf16 v[52:67], a[192:195], v[68:71], v[52:67]
  ds_read_b128 v[92:95], v126 offset:512
  v_mfma_f32_32x32x16_bf16 v[52:67], a[196:199], v[72:75], v[52:67]
  ds_read_b128 v[96:99], v127 offset:512
  s_waitcnt lgkmcnt(4)
  v_mfma_f32_32x32x16_bf16 v[52:67], a[200:203], v[76:79], v[52:67]
  ds_read_b128 v[68:71], v120 offset:768
  v_mfma_f32_32x32x16_bf16 v[52:67], a[204:207], v[80:83], v[52:67]
  ds_read_b128 v[72:75], v121 offset:768
  s_waitcnt lgkmcnt(4)
  v_mfma_f32_32x32x16_bf16 v[52:67], a[208:211], v[84:87], v[52:67]
  ds_read_b128 v[76:79], v122 offset:768
  ds_read_b128 v[80:83], v123 offset:768
  v_mfma_f32_32x32x16_bf16 v[52:67], a[212:215], v[88:91], v[52:67]
  ds_read_b128 v[84:87], v124 offset:768
  ds_read_b128 v[88:91], v125 offset:768
  s_waitcnt lgkmcnt(6)
  v_mfma_f32_32x32x16_bf16 v[52:67], a[216:219], v[92:95], v[52:67]
  ds_read_b128 v[92:95], v126 offset:768
  v_mfma_f32_32x32x16_bf16 v[52:67], a[220:223], v[96:99], v[52:67]
  ds_read_b128 v[96:99], v127 offset:768
  s_waitcnt lgkmcnt(6)
  v_mfma_f32_32x32x16_bf16 v[52:67], a[224:227], v[68:71], v[52:67]
  v_mfma_f32_32x32x16_bf16 v[52:67], a[228:231], v[72:75], v[52:67]
  s_waitcnt vmcnt(4) lgkmcnt(0)
  s_barrier
  ds_read_b128 v[100:103], v119 offset:0
  v_mfma_f32_32x32x16_bf16 v[52:67], a[232:235], v[76:79], v[52:67]
  ds_read_b128 v[68:71], v120 offset:32768
  v_mfma_f32_32x32x16_bf16 v[52:67], a[236:239], v[80:83], v[52:67]
  ds_read_b128 v[72:75], v121 offset:32768
  s_xor_b32 s50, s50, 32768
  v_mfma_f32_32x32x16_bf16 v[52:67], a[240:243], v[84:87], v[52:67]
  ds_read_b128 v[76:79], v122 offset:32768
  v_mfma_f32_32x32x16_bf16 v[52:67], a[244:247], v[88:91], v[52:67]
  s_waitcnt lgkmcnt(3)
  v_min3_u32 v104, v100, v101, v102
  v_max3_u32 v100, v100, v101, v102
  v_min_u32 v104, v104, v103
  v_max_u32 v100, v100, v103
  v_readfirstlane_b32 s45, v104
  v_mfma_f32_32x32x16_bf16 v[52:67], a[248:251], v[92:95], v[52:67]
  v_readlane_b32 s28, v100, 0
  v_readlane_b32 s29, v100, 1
  v_readlane_b32 s30, v100, 2
  s_cmp_gt_u32 s55, 0
  s_cselect_b32 s45, 0, s45
  v_mfma_f32_32x32x16_bf16 v[52:67], a[252:255], v[96:99], v[52:67]
  s_cmp_eq_u32 s45, 0
  s_cbranch_scc1 q_slow_86
  s_cmp_lt_u32 s47, 64
  s_cbranch_scc1 q_w1_100
  s_cmp_gt_u32 s28, s56
  s_addc_u32 s42, s42, s42
  s_max_u32 s56, s56, s28
  s_and_b32 s26, s42, 1
  s_cselect_b32 s26, s40, 0
  s_cmp_gt_u32 s26, 10
  s_subb_u32 s40, s40, 0
  s_cmp_gt_u32 s29, s56
  s_addc_u32 s42, s42, s42
  s_max_u32 s56, s56, s29
  s_and_b32 s26, s42, 1
  s_cselect_b32 s26, s40, 0
  s_cmp_gt_u32 s26, 10
  s_subb_u32 s40, s40, 0
  s_cmp_gt_u32 s30, s56
  s_addc_u32 s42, s42, s42
  s_max_u32 s56, s56, s30
  s_add_u32 s76, s47, s40
  s_add_u32 s41, s47, 3
  s_sub_u32 s76, s76, 64
  s_and_b32 s26, s42, 1
  s_cselect_b32 s26, s40, 0
  s_cmp_gt_u32 s26, 10
  s_cselect_b32 s76, 64, s76
  s_subb_u32 s40, s40, 0
  s_cmp_lt_u32 s76, 64
  s_cselect_b32 s76, s76, s41
  s_bitcmp1_b32 s42, 0
  s_cbranch_scc0 q_w1_100
  s_branch q_forkw_95
q_c1_98:
  ds_read_b128 v[68:71], v120 offset:32768
  ds_read_b128 v[72:75], v121 offset:32768
  ds_read_b128 v[76:79], v122 offset:32768
q_w1_100:
  s_waitcnt lgkmcnt(2)
  v_mfma_f32_32x32x16_bf16 v[20:35], v[128:131], v[68:71], 0
  ds_read_b128 v[80:83], v123 offset:32768
  s_mov_b32 s46, s47
  s_mov_b32 s47, s76
  s_lshl_b32 s52, s46, 7
  s_add_u32 s52, s52, s57
  v_mfma_f32_32x32x16_bf16 v[36:51], v[68:71], a[0:3], 0
  s_waitcnt vmcnt(0)
  s_mov_b64 exec, 1
  buffer_store_dword v4, off, s[4:7], s49 sc1
  s_mov_b64 exec, -1
  s_lshl_b32 s44, s52, 12
  s_waitcnt lgkmcnt(2)
  v_mfma_f32_32x32x16_bf16 v[20:35], v[132:135], v[72:75], v[20:35]
  ds_read_b128 v[84:87], v124 offset:32768
  s_add_u32 s44, s44, 41943040
  s_lshl_b32 s51, s52, 5
  s_add_u32 s51, s51, 244318208
  s_lshr_b32 s55, s47, 7
  v_mfma_f32_32x32x16_bf16 v[36:51], v[72:75], a[4:7], v[36:51]
  s_sub_u32 s27, s47, s60
  s_cmp_eq_u32 s27, 15
  s_cselect_b32 s55, 1, s55
  s_add_u32 s76, s47, 3
  s_cmp_lt_u32 s76, 18
  s_cselect_b32 s76, s76, s41
  s_waitcnt lgkmcnt(2)
  v_mfma_f32_32x32x16_bf16 v[20:35], v[136:139], v[76:79], v[20:35]
  ds_read_b128 v[88:91], v125 offset:32768
  v_cvt_pk_bf16_f32 v100, v52, v53
  v_cvt_pk_bf16_f32 v101, v54, v55
  v_cvt_pk_bf16_f32 v102, v60, v61
  v_cvt_pk_bf16_f32 v103, v62, v63
  v_mfma_f32_32x32x16_bf16 v[36:51], v[76:79], a[8:11], v[36:51]
  buffer_store_dwordx4 v[100:103], v8, s[4:7], s43 offen offset:0 sc1
  v_cvt_pk_bf16_f32 v104, v56, v57
  v_cvt_pk_bf16_f32 v105, v58, v59
  s_waitcnt lgkmcnt(2)
  v_mfma_f32_32x32x16_bf16 v[20:35], v[140:143], v[80:83], v[20:35]
  ds_read_b128 v[92:95], v126 offset:32768
  v_cvt_pk_bf16_f32 v106, v64, v65
  v_cvt_pk_bf16_f32 v107, v66, v67
  v_mfma_f32_32x32x16_bf16 v[36:51], v[80:83], a[12:15], v[36:51]
  s_waitcnt lgkmcnt(2)
  v_mfma_f32_32x32x16_bf16 v[20:35], v[144:147], v[84:87], v[20:35]
  ds_read_b128 v[96:99], v127 offset:32768
  buffer_store_dwordx4 v[104:107], v8, s[4:7], s43 offen offset:512 sc1
  s_lshl_b32 s43, s52, 11
  v_mfma_f32_32x32x16_bf16 v[36:51], v[84:87], a[16:19], v[36:51]
  s_add_u32 s43, s43, 142606336
  s_waitcnt lgkmcnt(2)
  v_mfma_f32_32x32x16_bf16 v[20:35], v[148:151], v[88:91], v[20:35]
  ds_read_b128 v[68:71], v120 offset:33024
  v_mfma_f32_32x32x16_bf16 v[36:51], v[88:91], a[20:23], v[36:51]
  s_waitcnt lgkmcnt(2)
  v_mfma_f32_32x32x16_bf16 v[20:35], v[152:155], v[92:95], v[20:35]
  ds_read_b128 v[72:75], v121 offset:33024
  s_cmp_lt_u32 s47, 64
  s_cselect_b32 s26, 2, 0
  s_add_u32 s26, s26, s47
  s_lshl_b32 s26, s26, 12
  v_mfma_f32_32x32x16_bf16 v[36:51], v[92:95], a[24:27], v[36:51]
  s_add_u32 s26, s26, 243261440
  s_mov_b64 exec, 0xffffff
  buffer_load_dword v116, v7, s[4:7], s26 offen sc1
  s_mov_b64 exec, -1
  s_waitcnt lgkmcnt(2)
  v_mfma_f32_32x32x16_bf16 v[20:35], v[156:159], v[96:99], v[20:35]
  ds_read_b128 v[76:79], v122 offset:33024
  v_mfma_f32_32x32x16_bf16 v[36:51], v[96:99], a[28:31], v[36:51]
  s_waitcnt lgkmcnt(2)
  v_mfma_f32_32x32x16_bf16 v[20:35], v[160:163], v[68:71], v[20:35]
  ds_read_b128 v[80:83], v123 offset:33024
  v_mfma_f32_32x32x16_bf16 v[36:51], v[68:71], a[32:35], v[36:51]
  s_waitcnt lgkmcnt(2)
  v_mfma_f32_32x32x16_bf16 v[20:35], v[164:167], v[72:75], v[20:35]
  ds_read_b128 v[84:87], v124 offset:33024
  v_mfma_f32_32x32x16_bf16 v[36:51], v[72:75], a[36:39], v[36:51]
  s_waitcnt lgkmcnt(2)
  v_mfma_f32_32x32x16_bf16 v[20:35], v[168:171], v[76:79], v[20:35]
  ds_read_b128 v[88:91], v125 offset:33024
  v_mfma_f32_32x32x16_bf16 v[36:51], v[76:79], a[40:43], v[36:51]
  s_waitcnt lgkmcnt(2)
  v_mfma_f32_32x32x16_bf16 v[20:35], v[172:175], v[80:83], v[20:35]
  ds_read_b128 v[92:95], v126 offset:33024
  v_mfma_f32_32x32x16_bf16 v[36:51], v[80:83], a[44:47], v[36:51]
  s_waitcnt lgkmcnt(2)
  v_mfma_f32_32x32x16_bf16 v[20:35], v[176:179], v[84:87], v[20:35]
  ds_read_b128 v[96:99], v127 offset:33024
  v_mfma_f32_32x32x16_bf16 v[36:51], v[84:87], a[48:51], v[36:51]
  s_waitcnt lgkmcnt(2)
  v_mfma_f32_32x32x16_bf16 v[20:35], v[180:183], v[88:91], v[20:35]
  ds_read_b128 v[68:71], v120 offset:33280
  v_mfma_f32_32x32x16_bf16 v[36:51], v[88:91], a[52:55], v[36:51]
  s_waitcnt lgkmcnt(2)
  v_mfma_f32_32x32x16_bf16 v[20:35], v[184:187], v[92:95], v[20:35]
  ds_read_b128 v[72:75], v121 offset:33280
  v_mfma_f32_32x32x16_bf16 v[36:51], v[92:95], a[56:59], v[36:51]
  s_waitcnt lgkmcnt(2)
  v_mfma_f32_32x32x16_bf16 v[20:35], v[188:191], v[96:99], v[20:35]
  ds_read_b128 v[76:79], v122 offset:33280
  v_mfma_f32_32x32x16_bf16 v[36:51], v[96:99], a[60:63], v[36:51]
  s_waitcnt lgkmcnt(2)
  v_mfma_f32_32x32x16_bf16 v[20:35], v[192:195], v[68:71], v[20:35]
  ds_read_b128 v[80:83], v123 offset:33280
  v_mfma_f32_32x32x16_bf16 v[36:51], v[68:71], a[64:67], v[36:51]
  s_waitcnt lgkmcnt(2)
  v_mfma_f32_32x32x16_bf16 v[20:35], v[196:199], v[72:75], v[20:35]
  ds_read_b128 v[84:87], v124 offset:33280
  s_waitcnt vmcnt(0)
  s_mov_b64 exec, 3
  buffer_store_dword v4, v0, s[4:7], s49 offen sc1
  s_mov_b64 exec, -1
  v_mfma_f32_32x32x16_bf16 v[36:51], v[72:75], a[68:71], v[36:51]
  v_cmp_eq_u32 vcc, 0, v116
  v_max_u32_dpp v117, v116, v116 quad_perm:[1,0,3,2] row_mask:0xf bank_mask:0xf
  s_and_b32 s48, vcc_lo, 0xffffff
  s_cselect_b32 s48, 0, -1
  v_max_u32_dpp v117, v117, v117 quad_perm:[2,3,0,1] row_mask:0xf bank_mask:0xf
  s_waitcnt lgkmcnt(2)
  v_mfma_f32_32x32x16_bf16 v[20:35], v[200:203], v[76:79], v[20:35]
  ds_read_b128 v[88:91], v125 offset:33280
  s_nop 1
  v_max_u32_dpp v117, v117, v117 row_half_mirror row_mask:0xf bank_mask:0xf
  v_and_b32 v117, s48, v117
  s_cmp_lg_u32 s48, 0
  s_cselect_b32 s28, s47, s46
  v_mfma_f32_32x32x16_bf16 v[36:51], v[76:79], a[72:75], v[36:51]
  s_and_b32 s63, s28, 127
  s_lshl_b32 s63, s63, 15
  s_xor_b32 s27, s50, 32768
  s_add_u32 m0, s27, s54
  s_add_u32 s63, s63, s54
  s_waitcnt lgkmcnt(2)
  v_mfma_f32_32x32x16_bf16 v[20:35], v[204:207], v[80:83], v[20:35]
  ds_read_b128 v[92:95], v126 offset:33280
  s_add_u32 s63, s63, 6291456
  buffer_load_dwordx4 v12, s[4:7], s63 offen offset:0 sc1 lds
  v_mfma_f32_32x32x16_bf16 v[36:51], v[80:83], a[76:79], v[36:51]
  s_waitcnt lgkmcnt(2)
  v_mfma_f32_32x32x16_bf16 v[20:35], v[208:211], v[84:87], v[20:35]
  ds_read_b128 v[96:99], v127 offset:33280
  v_mfma_f32_32x32x16_bf16 v[36:51], v[84:87], a[80:83], v[36:51]
  buffer_load_dwordx4 v13, s[4:7], s63 offen offset:1024 sc1 lds
  s_waitcnt lgkmcnt(2)
  v_mfma_f32_32x32x16_bf16 v[20:35], v[212:215], v[88:91], v[20:35]
  ds_read_b128 v[68:71], v120 offset:33536
  v_mfma_f32_32x32x16_bf16 v[36:51], v[88:91], a[84:87], v[36:51]
  s_waitcnt lgkmcnt(2)
  v_mfma_f32_32x32x16_bf16 v[20:35], v[216:219], v[92:95], v[20:35]
  ds_read_b128 v[72:75], v121 offset:33536
  buffer_load_dwordx4 v14, s[4:7], s63 offen offset:2048 sc1 lds
  v_mfma_f32_32x32x16_bf16 v[36:51], v[92:95], a[88:91], v[36:51]
  s_waitcnt lgkmcnt(2)
  v_mfma_f32_32x32x16_bf16 v[20:35], v[220:223], v[96:99], v[20:35]
  ds_read_b128 v[76:79], v122 offset:33536
  v_mfma_f32_32x32x16_bf16 v[36:51], v[96:99], a[92:95], v[36:51]
  buffer_load_dwordx4 v15, s[4:7], s63 offen offset:3072 sc1 lds
  s_add_u32 m0, m0, 4096
  s_add_u32 s63, s63, 4096
  s_waitcnt lgkmcnt(2)
  v_mfma_f32_32x32x16_bf16 v[20:35], v[224:227], v[68:71], v[20:35]
  ds_read_b128 v[80:83], v123 offset:33536
  v_mfma_f32_32x32x16_bf16 v[36:51], v[68:71], a[96:99], v[36:51]
  s_waitcnt lgkmcnt(2)
  v_mfma_f32_32x32x16_bf16 v[20:35], v[228:231], v[72:75], v[20:35]
  ds_read_b128 v[84:87], v124 offset:33536
  buffer_load_dwordx4 v16, s[4:7], s63 offen offset:0 sc1 lds
  v_mfma_f32_32x32x16_bf16 v[36:51], v[72:75], a[100:103], v[36:51]
  s_waitcnt lgkmcnt(2)
  v_mfma_f32_32x32x16_bf16 v[20:35], v[232:235], v[76:79], v[20:35]
  ds_read_b128 v[88:91], v125 offset:33536
  v_mfma_f32_32x32x16_bf16 v[36:51], v[76:79], a[104:107], v[36:51]
  buffer_load_dwordx4 v17, s[4:7], s63 offen offset:1024 sc1 lds
  s_waitcnt lgkmcnt(2)
  v_mfma_f32_32x32x16_bf16 v[20:35], v[236:239], v[80:83], v[20:35]
  ds_read_b128 v[92:95], v126 offset:33536
  v_mfma_f32_32x32x16_bf16 v[36:51], v[80:83], a[108:111], v[36:51]
  s_waitcnt lgkmcnt(2)
  v_mfma_f32_32x32x16_bf16 v[20:35], v[240:243], v[84:87], v[20:35]
  ds_read_b128 v[96:99], v127 offset:33536
  buffer_load_dwordx4 v18, s[4:7], s63 offen offset:2048 sc1 lds
  v_mfma_f32_32x32x16_bf16 v[36:51], v[84:87], a[112:115], v[36:51]
  s_waitcnt lgkmcnt(2)
  v_mfma_f32_32x32x16_bf16 v[20:35], v[244:247], v[88:91], v[20:35]
  ds_read_b128 v[68:71], v120 offset:32768
  v_mfma_f32_32x32x16_bf16 v[36:51], v[88:91], a[116:119], v[36:51]
  ds_read_b128 v[72:75], v121 offset:32768
  buffer_load_dwordx4 v19, s[4:7], s63 offen offset:3072 sc1 lds
  s_mov_b32 s49, s51
  s_waitcnt lgkmcnt(3)
  v_mfma_f32_32x32x16_bf16 v[20:35], v[248:251], v[92:95], v[20:35]
  ds_read_b128 v[76:79], v122 offset:32768
  ds_write_b32 v118, v117 offset:128
  v_mfma_f32_32x32x16_bf16 v[36:51], v[92:95], a[120:123], v[36:51]
  ds_read_b128 v[80:83], v123 offset:32768
  s_waitcnt lgkmcnt(5)
  v_mfma_f32_32x32x16_bf16 v[20:35], v[252:255], v[96:99], v[20:35]
  ds_read_b128 v[84:87], v124 offset:32768
  v_mfma_f32_32x32x16_bf16 v[36:51], v[96:99], a[124:127], v[36:51]
  ds_read_b128 v[88:91], v125 offset:32768
  s_waitcnt lgkmcnt(5)
  v_mfma_f32_32x32x16_bf16 v[52:67], a[128:131], v[68:71], 0
  ds_read_b128 v[92:95], v126 offset:32768
  v_mfma_f32_32x32x16_bf16 v[52:67], a[132:135], v[72:75], v[52:67]
  ds_read_b128 v[96:99], v127 offset:32768
  v_mul_f32 v20, s24, v20
  v_mul_f32 v21, s24, v21
  v_mul_f32 v22, s24, v22
  v_mul_f32 v23, s24, v23
  s_waitcnt lgkmcnt(4)
  v_mfma_f32_32x32x16_bf16 v[52:67], a[136:139], v[76:79], v[52:67]
  ds_read_b128 v[68:71], v120 offset:33024
  v_mul_f32 v24, s24, v24
  v_mul_f32 v25, s24, v25
  v_cvt_pk_bf16_f32 v100, v36, v37
  v_cvt_pk_bf16_f32 v101, v38, v39
  v_mfma_f32_32x32x16_bf16 v[52:67], a[140:143], v[80:83], v[52:67]
  ds_read_b128 v[72:75], v121 offset:33024
  v_cvt_pk_bf16_f32 v102, v44, v45
  v_cvt_pk_bf16_f32 v103, v46, v47
  buffer_store_dwordx4 v[100:103], v8, s[4:7], s44 offen offset:2048 sc1
  s_waitcnt lgkmcnt(4)
  v_mfma_f32_32x32x16_bf16 v[52:67], a[144:147], v[84:87], v[52:67]
  ds_read_b128 v[76:79], v122 offset:33024
  v_cvt_pk_bf16_f32 v104, v40, v41
  v_cvt_pk_bf16_f32 v105, v42, v43
  v_cvt_pk_bf16_f32 v106, v48, v49
  v_cvt_pk_bf16_f32 v107, v50, v51
  v_mfma_f32_32x32x16_bf16 v[52:67], a[148:151], v[88:91], v[52:67]
  ds_read_b128 v[80:83], v123 offset:33024
  buffer_store_dwordx4 v[104:107], v8, s[4:7], s44 offen offset:2560 sc1
  v_mul_f32 v26, s24, v26
  s_waitcnt lgkmcnt(4)
  v_mfma_f32_32x32x16_bf16 v[52:67], a[152:155], v[92:95], v[52:67]
  ds_read_b128 v[84:87], v124 offset:33024
  v_mul_f32 v27, s24, v27
  v_mul_f32 v28, s24, v28
  v_mul_f32 v29, s24, v29
  v_mul_f32 v30, s24, v30
  v_mfma_f32_32x32x16_bf16 v[52:67], a[156:159], v[96:99], v[52:67]
  ds_read_b128 v[88:91], v125 offset:33024
  v_mul_f32 v31, s24, v31
  v_mul_f32 v32, s24, v32
  v_mul_f32 v33, s24, v33
  v_mul_f32 v34, s24, v34
  s_waitcnt lgkmcnt(4)
  v_mfma_f32_32x32x16_bf16 v[52:67], a[160:163], v[68:71], v[52:67]
  ds_read_b128 v[92:95], v126 offset:33024
  v_mul_f32 v35, s24, v35
  v_cvt_pk_bf16_f32 v108, v20, v21
  v_cvt_pk_bf16_f32 v109, v22, v23
  v_cvt_pk_bf16_f32 v110, v28, v29
  v_mfma_f32_32x32x16_bf16 v[52:67], a[164:167], v[72:75], v[52:67]
  ds_read_b128 v[96:99], v127 offset:33024
  v_cvt_pk_bf16_f32 v111, v30, v31
  buffer_store_dwordx4 v[108:111], v8, s[4:7], s44 offen offset:0 sc1
  s_waitcnt lgkmcnt(4)
  v_mfma_f32_32x32x16_bf16 v[52:67], a[168:171], v[76:79], v[52:67]
  ds_read_b128 v[68:71], v120 offset:33280
  v_cvt_pk_bf16_f32 v112, v24, v25
  v_cvt_pk_bf16_f32 v113, v26, v27
  v_cvt_pk_bf16_f32 v114, v32, v33
  v_cvt_pk_bf16_f32 v115, v34, v35
  v_mfma_f32_32x32x16_bf16 v[52:67], a[172:175], v[80:83], v[52:67]
  ds_read_b128 v[72:75], v121 offset:33280
  buffer_store_dwordx4 v[112:115], v8, s[4:7], s44 offen offset:512 sc1
  s_waitcnt lgkmcnt(4)
  v_mfma_f32_32x32x16_bf16 v[52:67], a[176:179], v[84:87], v[52:67]
  ds_read_b128 v[76:79], v122 offset:33280
  v_mfma_f32_32x32x16_bf16 v[52:67], a[180:183], v[88:91], v[52:67]
  ds_read_b128 v[80:83], v123 offset:33280
  s_waitcnt lgkmcnt(4)
  v_mfma_f32_32x32x16_bf16 v[52:67], a[184:187], v[92:95], v[52:67]
  ds_read_b128 v[84:87], v124 offset:33280
  v_mfma_f32_32x32x16_bf16 v[52:67], a[188:191], v[96:99], v[52:67]
  ds_read_b128 v[88:91], v125 offset:33280
  s_waitcnt lgkmcnt(4)
  v_mfma_f32_32x32x16_bf16 v[52:67], a[192:195], v[68:71], v[52:67]
  ds_read_b128 v[92:95], v126 offset:33280
  v_mfma_f32_32x32x16_bf16 v[52:67], a[196:199], v[72:75], v[52:67]
  ds_read_b128 v[96:99], v127 offset:33280
  s_waitcnt lgkmcnt(4)
  v_mfma_f32_32x32x16_bf16 v[52:67], a[200:203], v[76:79], v[52:67]
  ds_read_b128 v[68:71], v120 offset:33536
  v_mfma_f32_32x32x16_bf16 v[52:67], a[204:207], v[80:83], v[52:67]
  ds_read_b128 v[72:75], v121 offset:33536
  s_waitcnt lgkmcnt(4)
  v_mfma_f32_32x32x16_bf16 v[52:67], a[208:211], v[84:87], v[52:67]
  ds_read_b128 v[76:79], v122 offset:33536
  ds_read_b128 v[80:83], v123 offset:33536
  v_mfma_f32_32x32x16_bf16 v[52:67], a[212:215], v[88:91], v[52:67]
  ds_read_b128 v[84:87], v124 offset:33536
  ds_read_b128 v[88:91], v125 offset:33536
  s_waitcnt lgkmcnt(6)
  v_mfma_f32_32x32x16_bf16 v[52:67], a[216:219], v[92:95], v[52:67]
  ds_read_b128 v[92:95], v126 offset:33536
  v_mfma_f32_32x32x16_bf16 v[52:67], a[220:223], v[96:99], v[52:67]
  ds_read_b128 v[96:99], v127 offset:33536
  s_waitcnt lgkmcnt(6)
  v_mfma_f32_32x32x16_bf16 v[52:67], a[224:227], v[68:71], v[52:67]
  v_mfma_f32_32x32x16_bf16 v[52:67], a[228:231], v[72:75], v[52:67]
  s_waitcnt vmcnt(4) lgkmcnt(0)
  s_barrier
  ds_read_b128 v[100:103], v119 offset:128
  v_mfma_f32_32x32x16_bf16 v[52:67], a[232:235], v[76:79], v[52:67]
  ds_read_b128 v[68:71], v120 offset:0
  v_mfma_f32_32x32x16_bf16 v[52:67], a[236:239], v[80:83], v[52:67]
  ds_read_b128 v[72:75], v121 offset:0
  s_xor_b32 s50, s50, 32768
  v_mfma_f32_32x32x16_bf16 v[52:67], a[240:243], v[84:87], v[52:67]
  ds_read_b128 v[76:79], v122 offset:0
  v_mfma_f32_32x32x16_bf16 v[52:67], a[244:247], v[88:91], v[52:67]
  s_waitcnt lgkmcnt(3)
  v_min3_u32 v104, v100, v101, v102
  v_max3_u32 v100, v100, v101, v102
  v_min_u32 v104, v104, v103
  v_max_u32 v100, v100, v103
  v_readfirstlane_b32 s45, v104
  v_mfma_f32_32x32x16_bf16 v[52:67], a[248:251], v[92:95], v[52:67]
  v_readlane_b32 s28, v100, 0
  v_readlane_b32 s29, v100, 1
  v_readlane_b32 s30, v100, 2
  s_cmp_gt_u32 s55, 0
  s_cselect_b32 s45, 0, s45
  v_mfma_f32_32x32x16_bf16 v[52:67], a[252:255], v[96:99], v[52:67]
  s_cmp_eq_u32 s45, 0
  s_cbranch_scc1 q_slow_86
  s_cmp_lt_u32 s47, 64
  s_cbranch_scc1 q_w0_99
  s_cmp_gt_u32 s28, s56
  s_addc_u32 s42, s42, s42
  s_max_u32 s56, s56, s28
  s_and_b32 s26, s42, 1
  s_cselect_b32 s26, s40, 0
  s_cmp_gt_u32 s26, 10
  s_subb_u32 s40, s40, 0
  s_cmp_gt_u32 s29, s56
  s_addc_u32 s42, s42, s42
  s_max_u32 s56, s56, s29
  s_and_b32 s26, s42, 1
  s_cselect_b32 s26, s40, 0
  s_cmp_gt_u32 s26, 10
  s_subb_u32 s40, s40, 0
  s_cmp_gt_u32 s30, s56
  s_addc_u32 s42, s42, s42
  s_max_u32 s56, s56, s30
  s_add_u32 s76, s47, s40
  s_add_u32 s41, s47, 3
  s_sub_u32 s76, s76, 64
  s_and_b32 s26, s42, 1
  s_cselect_b32 s26, s40, 0
  s_cmp_gt_u32 s26, 10
  s_cselect_b32 s76, 64, s76
  s_subb_u32 s40, s40, 0
  s_cmp_lt_u32 s76, 64
  s_cselect_b32 s76, s76, s41
  s_bitcmp1_b32 s42, 0
  s_cbranch_scc0 q_w0_99
  s_branch q_forkw_95
q_forkw_95:
  v_cvt_pk_bf16_f32 v100, v52, v53
  v_cvt_pk_bf16_f32 v101, v54, v55
  v_cvt_pk_bf16_f32 v102, v60, v61
  v_cvt_pk_bf16_f32 v103, v62, v63
  v_cvt_pk_bf16_f32 v104, v56, v57
  v_cvt_pk_bf16_f32 v105, v58, v59
  v_cvt_pk_bf16_f32 v106, v64, v65
  v_cvt_pk_bf16_f32 v107, v66, v67
  s_waitcnt vmcnt(0)
  s_mov_b64 exec, 1
  buffer_store_dword v4, off, s[4:7], s49 sc1
  s_mov_b64 exec, -1
  buffer_store_dwordx4 v[100:103], v8, s[4:7], s43 offen offset:0 sc1
  buffer_store_dwordx4 v[104:107], v8, s[4:7], s43 offen offset:512 sc1
  s_mov_b32 s43, 268435456
  s_waitcnt lgkmcnt(0)
q_fork_93:
  s_mov_b32 s58, s56
  s_mov_b32 s46, s47
  s_mov_b32 s47, s76
  s_add_u32 s76, s47, 3
  s_cmp_lt_u32 s76, 18
  s_cselect_b32 s76, s76, s41
  s_andn2_b32 s59, 0xfff, s58
  s_lshl_b32 s26, s61, 21
  s_lshl_b32 s27, s59, 10
  s_add_u32 s26, s26, s27
  s_lshl_b32 s27, s17, 8
  s_add_u32 s26, s26, s27
  s_add_u32 s26, s26, 27262976
  v_lshrrev_b32 v5, 7, v0
  v_lshlrev_b32 v5, 5, v5
  buffer_load_dwordx4 v[52:55], v5, s[4:7], s26 offen offset:0 sc1
  buffer_load_dwordx4 v[56:59], v5, s[4:7], s26 offen offset:16 sc1
  s_load_dwordx2 s[64:65], s[0:1], 72
  s_load_dwordx2 s[68:69], s[0:1], 80
  s_load_dwordx2 s[8:9], s[0:1], 88
  s_mov_b32 s66, 1835008
  s_mov_b32 s70, 1835008
  s_mov_b32 s10, 1835008
  v_lshrrev_b32 v2, 7, v0
  v_and_b32 v3, 0x70, v0
  v_mul_u32_u24 v6, 57344, v2
  v_add_u32 v6, v6, v3
  v_cmp_eq_u32 vcc, 0x70, v3
  v_mov_b32 v3, 0x7ff00000
  s_nop 0
  v_cndmask_b32 v6, v6, v3, vcc
  v_lshrrev_b32 v2, 8, v0
  v_mul_u32_u24 v7, 14336, v2
  v_and_b32 v3, 0xf0, v0
  v_add_u32 v7, v7, v3
  s_mul_i32 s34, s17, 458752
  s_mul_i32 s27, s16, 112
  s_add_u32 s34, s34, s27
  s_mul_i32 s35, s16, 57344
  s_lshl_b32 s27, s17, 8
  s_add_u32 s35, s35, s27
  s_waitcnt lgkmcnt(0)
  s_xor_b32 s37, s50, 32768
  s_add_u32 s37, s37, s54
  s_mov_b32 m0, s37
  s_add_u32 s36, s34, 39424
  buffer_load_dwordx4 v6, s[68:71], s36 offen lds
  s_add_u32 m0, m0, 1024
  s_add_u32 s36, s34, 43008
  buffer_load_dwordx4 v6, s[64:67], s36 offen lds
  s_add_u32 m0, m0, 1024
  s_add_u32 s36, s34, 43008
  buffer_load_dwordx4 v6, s[68:71], s36 offen lds
  s_add_u32 m0, m0, 1024
  s_add_u32 s36, s34, 46592
  buffer_load_dwordx4 v6, s[64:67], s36 offen lds
  s_add_u32 m0, m0, 1024
  s_add_u32 s36, s34, 46592
  buffer_load_dwordx4 v6, s[68:71], s36 offen lds
  s_add_u32 m0, m0, 1024
  s_add_u32 s36, s34, 50176
  buffer_load_dwordx4 v6, s[64:67], s36 offen lds
  s_add_u32 m0, m0, 1024
  s_add_u32 s36, s34, 50176
  buffer_load_dwordx4 v6, s[68:71], s36 offen lds
  s_add_u32 m0, m0, 1024
  s_add_u32 s36, s34, 53760
  buffer_load_dwordx4 v6, s[64:67], s36 offen lds
  s_add_u32 m0, m0, 1024
  s_add_u32 s36, s34, 53760
  buffer_load_dwordx4 v[60:63], v6, s[68:71], s36 offen
  buffer_load_dwordx4 v[64:67], v7, s[8:11], s35 offen offset:0
  v_add_u32 v120, s50, v120
  v_add_u32 v121, s50, v121
  v_add_u32 v122, s50, v122
  v_add_u32 v123, s50, v123
  v_add_u32 v124, s50, v124
  v_add_u32 v125, s50, v125
  v_add_u32 v126, s50, v126
  v_add_u32 v127, s50, v127
  s_lshl_b32 s52, s46, 7
  s_add_u32 s52, s52, s57
  s_lshl_b32 s77, s52, 12
  s_add_u32 s44, s77, 75497472
  s_add_u32 s77, s77, 41943040
  s_lshl_b32 s51, s52, 5
  s_add_u32 s51, s51, 244318208
  s_waitcnt vmcnt(12)
  s_barrier
  s_mov_b64 exec, 3
  buffer_store_dword v4, v0, s[4:7], s49 offen sc1
  s_mov_b64 exec, -1
  v_mov_b32 v4, 2
  s_mov_b32 s49, s51
  ds_read_b128 v[68:71], v120 offset:0
  ds_read_b128 v[72:75], v121 offset:0
  ds_read_b128 v[76:79], v122 offset:0
  ds_read_b128 v[80:83], v123 offset:0
  s_waitcnt lgkmcnt(3)
  v_mfma_f32_32x32x16_bf16 v[20:35], v[128:131], v[68:71], 0
  v_mfma_f32_32x32x16_bf16 v[36:51], v[68:71], a[0:3], 0
  s_waitcnt lgkmcnt(2)
  v_mfma_f32_32x32x16_bf16 v[20:35], v[132:135], v[72:75], v[20:35]
  ds_read_b128 v[84:87], v124 offset:0
  v_mfma_f32_32x32x16_bf16 v[36:51], v[72:75], a[4:7], v[36:51]
  s_waitcnt lgkmcnt(2)
  v_mfma_f32_32x32x16_bf16 v[20:35], v[136:139], v[76:79], v[20:35]
  ds_read_b128 v[88:91], v125 offset:0
  v_mfma_f32_32x32x16_bf16 v[36:51], v[76:79], a[8:11], v[36:51]
  s_waitcnt lgkmcnt(2)
  v_mfma_f32_32x32x16_bf16 v[20:35], v[140:143], v[80:83], v[20:35]
  ds_read_b128 v[92:95], v126 offset:0
  v_mfma_f32_32x32x16_bf16 v[36:51], v[80:83], a[12:15], v[36:51]
  s_waitcnt lgkmcnt(2)
  v_mfma_f32_32x32x16_bf16 v[20:35], v[144:147], v[84:87], v[20:35]
  ds_read_b128 v[96:99], v127 offset:0
  v_mfma_f32_32x32x16_bf16 v[36:51], v[84:87], a[16:19], v[36:51]
  s_waitcnt lgkmcnt(2)
  v_mfma_f32_32x32x16_bf16 v[20:35], v[148:151], v[88:91], v[20:35]
  ds_read_b128 v[68:71], v120 offset:256
  v_mfma_f32_32x32x16_bf16 v[36:51], v[88:91], a[20:23], v[36:51]
  s_waitcnt lgkmcnt(2)
  v_mfma_f32_32x32x16_bf16 v[20:35], v[152:155], v[92:95], v[20:35]
  ds_read_b128 v[72:75], v121 offset:256
  v_mfma_f32_32x32x16_bf16 v[36:51], v[92:95], a[24:27], v[36:51]
  s_waitcnt lgkmcnt(2)
  v_mfma_f32_32x32x16_bf16 v[20:35], v[156:159], v[96:99], v[20:35]
  ds_read_b128 v[76:79], v122 offset:256
  v_mfma_f32_32x32x16_bf16 v[36:51], v[96:99], a[28:31], v[36:51]
  s_waitcnt lgkmcnt(2)
  v_mfma_f32_32x32x16_bf16 v[20:35], v[160:163], v[68:71], v[20:35]
  ds_read_b128 v[80:83], v123 offset:256
  v_mfma_f32_32x32x16_bf16 v[36:51], v[68:71], a[32:35], v[36:51]
  s_waitcnt lgkmcnt(2)
  v_mfma_f32_32x32x16_bf16 v[20:35], v[164:167], v[72:75], v[20:35]
  ds_read_b128 v[84:87], v124 offset:256
  v_mfma_f32_32x32x16_bf16 v[36:51], v[72:75], a[36:39], v[36:51]
  s_waitcnt lgkmcnt(2)
  v_mfma_f32_32x32x16_bf16 v[20:35], v[168:171], v[76:79], v[20:35]
  ds_read_b128 v[88:91], v125 offset:256
  v_mfma_f32_32x32x16_bf16 v[36:51], v[76:79], a[40:43], v[36:51]
  s_waitcnt lgkmcnt(2)
  v_mfma_f32_32x32x16_bf16 v[20:35], v[172:175], v[80:83], v[20:35]
  ds_read_b128 v[92:95], v126 offset:256
  v_mfma_f32_32x32x16_bf16 v[36:51], v[80:83], a[44:47], v[36:51]
  s_waitcnt lgkmcnt(2)
  v_mfma_f32_32x32x16_bf16 v[20:35], v[176:179], v[84:87], v[20:35]
  ds_read_b128 v[96:99], v127 offset:256
  v_mfma_f32_32x32x16_bf16 v[36:51], v[84:87], a[48:51], v[36:51]
  s_waitcnt lgkmcnt(2)
  v_mfma_f32_32x32x16_bf16 v[20:35], v[180:183], v[88:91], v[20:35]
  ds_read_b128 v[68:71], v120 offset:512
  v_mfma_f32_32x32x16_bf16 v[36:51], v[88:91], a[52:55], v[36:51]
  s_waitcnt lgkmcnt(2)
  v_mfma_f32_32x32x16_bf16 v[20:35], v[184:187], v[92:95], v[20:35]
  ds_read_b128 v[72:75], v121 offset:512
  v_mfma_f32_32x32x16_bf16 v[36:51], v[92:95], a[56:59], v[36:51]
  s_waitcnt lgkmcnt(2)
  v_mfma_f32_32x32x16_bf16 v[20:35], v[188:191], v[96:99], v[20:35]
  ds_read_b128 v[76:79], v122 offset:512
  v_mfma_f32_32x32x16_bf16 v[36:51], v[96:99], a[60:63], v[36:51]
  s_waitcnt lgkmcnt(2)
  v_mfma_f32_32x32x16_bf16 v[20:35], v[192:195], v[68:71], v[20:35]
  ds_read_b128 v[80:83], v123 offset:512
  v_mfma_f32_32x32x16_bf16 v[36:51], v[68:71], a[64:67], v[36:51]
  s_waitcnt lgkmcnt(2)
  v_mfma_f32_32x32x16_bf16 v[20:35], v[196:199], v[72:75], v[20:35]
  ds_read_b128 v[84:87], v124 offset:512
  v_mfma_f32_32x32x16_bf16 v[36:51], v[72:75], a[68:71], v[36:51]
  s_waitcnt lgkmcnt(2)
  v_mfma_f32_32x32x16_bf16 v[20:35], v[200:203], v[76:79], v[20:35]
  ds_read_b128 v[88:91], v125 offset:512
  v_mfma_f32_32x32x16_bf16 v[36:51], v[76:79], a[72:75], v[36:51]
  s_waitcnt lgkmcnt(2)
  v_mfma_f32_32x32x16_bf16 v[20:35], v[204:207], v[80:83], v[20:35]
  ds_read_b128 v[92:95], v126 offset:512
  v_mfma_f32_32x32x16_bf16 v[36:51], v[80:83], a[76:79], v[36:51]
  s_waitcnt lgkmcnt(2)
  v_mfma_f32_32x32x16_bf16 v[20:35], v[208:211], v[84:87], v[20:35]
  ds_read_b128 v[96:99], v127 offset:512
  v_mfma_f32_32x32x16_bf16 v[36:51], v[84:87], a[80:83], v[36:51]
  s_waitcnt lgkmcnt(2)
  v_mfma_f32_32x32x16_bf16 v[20:35], v[212:215], v[88:91], v[20:35]
  ds_read_b128 v[68:71], v120 offset:768
  v_mfma_f32_32x32x16_bf16 v[36:51], v[88:91], a[84:87], v[36:51]
  s_waitcnt lgkmcnt(2)
  v_mfma_f32_32x32x16_bf16 v[20:35], v[216:219], v[92:95], v[20:35]
  ds_read_b128 v[72:75], v121 offset:768
  v_mfma_f32_32x32x16_bf16 v[36:51], v[92:95], a[88:91], v[36:51]
  s_waitcnt lgkmcnt(2)
  v_mfma_f32_32x32x16_bf16 v[20:35], v[220:223], v[96:99], v[20:35]
  ds_read_b128 v[76:79], v122 offset:768
  v_mfma_f32_32x32x16_bf16 v[36:51], v[96:99], a[92:95], v[36:51]
  s_waitcnt lgkmcnt(2)
  v_mfma_f32_32x32x16_bf16 v[20:35], v[224:227], v[68:71], v[20:35]
  ds_read_b128 v[80:83], v123 offset:768
  v_mfma_f32_32x32x16_bf16 v[36:51], v[68:71], a[96:99], v[36:51]
  s_waitcnt lgkmcnt(2)
  v_mfma_f32_32x32x16_bf16 v[20:35], v[228:231], v[72:75], v[20:35]
  ds_read_b128 v[84:87], v124 offset:768
  v_mfma_f32_32x32x16_bf16 v[36:51], v[72:75], a[100:103], v[36:51]
  s_waitcnt lgkmcnt(2)
  v_mfma_f32_32x32x16_bf16 v[20:35], v[232:235], v[76:79], v[20:35]
  ds_read_b128 v[88:91], v125 offset:768
  v_mfma_f32_32x32x16_bf16 v[36:51], v[76:79], a[104:107], v[36:51]
  s_waitcnt lgkmcnt(2)
  v_mfma_f32_32x32x16_bf16 v[20:35], v[236:239], v[80:83], v[20:35]
  ds_read_b128 v[92:95], v126 offset:768
  v_mfma_f32_32x32x16_bf16 v[36:51], v[80:83], a[108:111], v[36:51]
  s_waitcnt lgkmcnt(2)
  v_mfma_f32_32x32x16_bf16 v[20:35], v[240:243], v[84:87], v[20:35]
  ds_read_b128 v[96:99], v127 offset:768
  v_mfma_f32_32x32x16_bf16 v[36:51], v[84:87], a[112:115], v[36:51]
  s_waitcnt lgkmcnt(2)
  v_mfma_f32_32x32x16_bf16 v[20:35], v[244:247], v[88:91], v[20:35]
  v_mfma_f32_32x32x16_bf16 v[36:51], v[88:91], a[116:119], v[36:51]
  s_waitcnt lgkmcnt(1)
  v_mfma_f32_32x32x16_bf16 v[20:35], v[248:251], v[92:95], v[20:35]
  v_mfma_f32_32x32x16_bf16 v[36:51], v[92:95], a[120:123], v[36:51]
  s_waitcnt lgkmcnt(0)
  v_mfma_f32_32x32x16_bf16 v[20:35], v[252:255], v[96:99], v[20:35]
  v_mfma_f32_32x32x16_bf16 v[36:51], v[96:99], a[124:127], v[36:51]
  s_nop 3
  v_mul_f32 v20, s24, v20
  v_mul_f32 v21, s24, v21
  v_mul_f32 v22, s24, v22
  v_mul_f32 v23, s24, v23
  v_mul_f32 v24, s24, v24
  v_mul_f32 v25, s24, v25
  v_mul_f32 v26, s24, v26
  v_mul_f32 v27, s24, v27
  v_mul_f32 v28, s24, v28
  v_mul_f32 v29, s24, v29
  v_mul_f32 v30, s24, v30
  v_mul_f32 v31, s24, v31
  v_mul_f32 v32, s24, v32
  v_mul_f32 v33, s24, v33
  v_mul_f32 v34, s24, v34
  v_mul_f32 v35, s24, v35
  v_cvt_pk_bf16_f32 v108, v20, v21
  v_cvt_pk_bf16_f32 v109, v22, v23
  v_cvt_pk_bf16_f32 v110, v28, v29
  v_cvt_pk_bf16_f32 v111, v30, v31
  buffer_store_dwordx4 v[108:111], v8, s[4:7], s77 offen offset:0 sc1
  v_cvt_pk_bf16_f32 v112, v24, v25
  v_cvt_pk_bf16_f32 v113, v26, v27
  v_cvt_pk_bf16_f32 v114, v32, v33
  v_cvt_pk_bf16_f32 v115, v34, v35
  buffer_store_dwordx4 v[112:115], v8, s[4:7], s77 offen offset:512 sc1
  v_cvt_pk_bf16_f32 v100, v36, v37
  v_cvt_pk_bf16_f32 v101, v38, v39
  v_cvt_pk_bf16_f32 v102, v44, v45
  v_cvt_pk_bf16_f32 v103, v46, v47
  buffer_store_dwordx4 v[100:103], v8, s[4:7], s77 offen offset:2048 sc1
  v_cvt_pk_bf16_f32 v104, v40, v41
  v_cvt_pk_bf16_f32 v105, v42, v43
  v_cvt_pk_bf16_f32 v106, v48, v49
  v_cvt_pk_bf16_f32 v107, v50, v51
  buffer_store_dwordx4 v[104:107], v8, s[4:7], s77 offen offset:2560 sc1
  buffer_store_dwordx4 v[108:111], v8, s[4:7], s44 offen offset:0 sc1
  buffer_store_dwordx4 v[112:115], v8, s[4:7], s44 offen offset:512 sc1
  buffer_store_dwordx4 v[100:103], v8, s[4:7], s44 offen offset:2048 sc1
  buffer_store_dwordx4 v[104:107], v8, s[4:7], s44 offen offset:2560 sc1
  buffer_load_dwordx4 v[68:71], v7, s[8:11], s35 offen offset:1024
  buffer_load_dwordx4 v[72:75], v7, s[8:11], s35 offen offset:2048
  buffer_load_dwordx4 v[76:79], v7, s[8:11], s35 offen offset:3072
  s_add_u32 s35, s35, 4096
  buffer_load_dwordx4 v[80:83], v7, s[8:11], s35 offen offset:0
  buffer_load_dwordx4 v[84:87], v7, s[8:11], s35 offen offset:1024
  buffer_load_dwordx4 v[88:91], v7, s[8:11], s35 offen offset:2048
  buffer_load_dwordx4 v[92:95], v7, s[8:11], s35 offen offset:3072
  s_add_u32 s35, s35, 4096
  buffer_load_dwordx4 v[96:99], v7, s[8:11], s35 offen offset:0
  buffer_load_dwordx4 v[100:103], v7, s[8:11], s35 offen offset:1024
  buffer_load_dwordx4 v[104:107], v7, s[8:11], s35 offen offset:2048
  buffer_load_dwordx4 v[108:111], v7, s[8:11], s35 offen offset:3072
  s_add_u32 s35, s35, 4096
  buffer_load_dwordx4 v[112:115], v7, s[8:11], s35 offen offset:0
  buffer_load_dwordx4 v[48:51], v7, s[8:11], s35 offen offset:1024
  s_mov_b32 vcc_lo, 0xaaaaaaaa
  s_mov_b32 vcc_hi, 0xaaaaaaaa
  v_mov_b32 v3, 0xffff
  v_mov_b32 v24, 0xffff0000
  v_cndmask_b32 v3, v3, v24, vcc
  s_mov_b32 vcc_lo, 0x3030303
  s_mov_b32 vcc_hi, 0x3030303
  v_cndmask_b32 v24, 0, v3, vcc
  s_mov_b32 vcc_lo, 0xc0c0c0c
  s_mov_b32 vcc_hi, 0xc0c0c0c
  v_cndmask_b32 v25, 0, v3, vcc
  s_mov_b32 vcc_lo, 0x30303030
  s_mov_b32 vcc_hi, 0x30303030
  v_cndmask_b32 v26, 0, v3, vcc
  s_mov_b32 vcc_lo, 0xc0c0c0c0
  s_mov_b32 vcc_hi, 0xc0c0c0c0
  v_cndmask_b32 v27, 0, v3, vcc
  s_mov_b32 s30, 0x01000100
  s_mov_b32 s31, 0x03020302
  s_mul_i32 s26, s17, 23552
  s_add_u32 s26, s26, 65536
  v_add_u32 v5, s26, v0
  v_add_u32 v2, s37, v0
  ds_read_b128 v[36:39], v5 offset:0
  ds_read_b128 v[40:43], v5 offset:1024
  ds_read_b128 v[44:47], v5 offset:2048
  ds_read_b128 v[12:15], v5 offset:3072
  ds_read_b128 v[16:19], v5 offset:4096
  ds_read_b128 v[120:123], v5 offset:5120
  ds_read_b128 v[124:127], v5 offset:6144
  s_waitcnt vmcnt(32)
  s_waitcnt vmcnt(17)
  s_mov_b64 exec, 1
  buffer_store_dword v4, off, s[4:7], s51 sc1
  s_mov_b64 exec, -1
  v_perm_b32 v3, v52, v52, s30
  v_and_b32 v20, v24, v3
  v_and_b32 v21, v25, v3
  v_and_b32 v22, v26, v3
  v_and_b32 v23, v27, v3
  s_waitcnt lgkmcnt(5)
  s_nop 0
  v_mfma_f32_16x16x32_bf16 v[28:31], v[20:23], v[36:39], 0
  ds_read_b128 v[36:39], v5 offset:7168
  v_mfma_f32_16x16x32_bf16 v[32:35], v[20:23], v[40:43], 0
  ds_read_b128 v[40:43], v5 offset:8192
  v_perm_b32 v3, v52, v52, s31
  v_and_b32 v20, v24, v3
  v_and_b32 v21, v25, v3
  v_and_b32 v22, v26, v3
  v_and_b32 v23, v27, v3
  s_waitcnt lgkmcnt(5)
  s_nop 0
  v_mfma_f32_16x16x32_bf16 v[28:31], v[20:23], v[44:47], v[28:31]
  ds_read_b128 v[44:47], v5 offset:9216
  v_mfma_f32_16x16x32_bf16 v[32:35], v[20:23], v[12:15], v[32:35]
  ds_read_b128 v[12:15], v5 offset:10240
  v_perm_b32 v3, v53, v53, s30
  v_and_b32 v20, v24, v3
  v_and_b32 v21, v25, v3
  v_and_b32 v22, v26, v3
  v_and_b32 v23, v27, v3
  s_waitcnt lgkmcnt(5)
  s_nop 0
  v_mfma_f32_16x16x32_bf16 v[28:31], v[20:23], v[16:19], v[28:31]
  ds_read_b128 v[16:19], v5 offset:11264
  v_mfma_f32_16x16x32_bf16 v[32:35], v[20:23], v[120:123], v[32:35]
  ds_read_b128 v[120:123], v5 offset:12288
  v_perm_b32 v3, v53, v53, s31
  v_and_b32 v20, v24, v3
  v_and_b32 v21, v25, v3
  v_and_b32 v22, v26, v3
  v_and_b32 v23, v27, v3
  s_waitcnt lgkmcnt(5)
  s_nop 0
  v_mfma_f32_16x16x32_bf16 v[28:31], v[20:23], v[124:127], v[28:31]
  ds_read_b128 v[124:127], v5 offset:13312
  v_mfma_f32_16x16x32_bf16 v[32:35], v[20:23], v[36:39], v[32:35]
  ds_read_b128 v[36:39], v5 offset:14336
  v_perm_b32 v3, v54, v54, s30
  v_and_b32 v20, v24, v3
  v_and_b32 v21, v25, v3
  v_and_b32 v22, v26, v3
  v_and_b32 v23, v27, v3
  s_waitcnt lgkmcnt(5)
  s_nop 0
  v_mfma_f32_16x16x32_bf16 v[28:31], v[20:23], v[40:43], v[28:31]
  ds_read_b128 v[40:43], v5 offset:15360
  v_mfma_f32_16x16x32_bf16 v[32:35], v[20:23], v[44:47], v[32:35]
  ds_read_b128 v[44:47], v5 offset:16384
  v_perm_b32 v3, v54, v54, s31
  v_and_b32 v20, v24, v3
  v_and_b32 v21, v25, v3
  v_and_b32 v22, v26, v3
  v_and_b32 v23, v27, v3
  s_waitcnt lgkmcnt(5)
  s_nop 0
  v_mfma_f32_16x16x32_bf16 v[28:31], v[20:23], v[12:15], v[28:31]
  ds_read_b128 v[12:15], v5 offset:17408
  v_mfma_f32_16x16x32_bf16 v[32:35], v[20:23], v[16:19], v[32:35]
  ds_read_b128 v[16:19], v5 offset:18432
  v_perm_b32 v3, v55, v55, s30
  v_and_b32 v20, v24, v3
  v_and_b32 v21, v25, v3
  v_and_b32 v22, v26, v3
  v_and_b32 v23, v27, v3
  s_waitcnt lgkmcnt(5)
  s_nop 0
  v_mfma_f32_16x16x32_bf16 v[28:31], v[20:23], v[120:123], v[28:31]
  ds_read_b128 v[120:123], v5 offset:19456
  v_mfma_f32_16x16x32_bf16 v[32:35], v[20:23], v[124:127], v[32:35]
  ds_read_b128 v[124:127], v5 offset:20480
  v_perm_b32 v3, v55, v55, s31
  v_and_b32 v20, v24, v3
  v_and_b32 v21, v25, v3
  v_and_b32 v22, v26, v3
  v_and_b32 v23, v27, v3
  s_waitcnt lgkmcnt(5)
  s_nop 0
  v_mfma_f32_16x16x32_bf16 v[28:31], v[20:23], v[36:39], v[28:31]
  ds_read_b128 v[36:39], v5 offset:21504
  v_mfma_f32_16x16x32_bf16 v[32:35], v[20:23], v[40:43], v[32:35]
  ds_read_b128 v[40:43], v5 offset:22528
  v_perm_b32 v3, v56, v56, s30
  v_and_b32 v20, v24, v3
  v_and_b32 v21, v25, v3
  v_and_b32 v22, v26, v3
  v_and_b32 v23, v27, v3
  s_waitcnt lgkmcnt(5)
  s_nop 0
  v_mfma_f32_16x16x32_bf16 v[28:31], v[20:23], v[44:47], v[28:31]
  ds_read_b128 v[44:47], v2 offset:0
  v_mfma_f32_16x16x32_bf16 v[32:35], v[20:23], v[12:15], v[32:35]
  ds_read_b128 v[12:15], v2 offset:1024
  v_perm_b32 v3, v56, v56, s31
  v_and_b32 v20, v24, v3
  v_and_b32 v21, v25, v3
  v_and_b32 v22, v26, v3
  v_and_b32 v23, v27, v3
  s_waitcnt lgkmcnt(5)
  s_nop 0
  v_mfma_f32_16x16x32_bf16 v[28:31], v[20:23], v[16:19], v[28:31]
  ds_read_b128 v[16:19], v2 offset:2048
  v_mfma_f32_16x16x32_bf16 v[32:35], v[20:23], v[120:123], v[32:35]
  ds_read_b128 v[120:123], v2 offset:3072
  v_perm_b32 v3, v57, v57, s30
  v_and_b32 v20, v24, v3
  v_and_b32 v21, v25, v3
  v_and_b32 v22, v26, v3
  v_and_b32 v23, v27, v3
  s_waitcnt lgkmcnt(5)
  s_nop 0
  v_mfma_f32_16x16x32_bf16 v[28:31], v[20:23], v[124:127], v[28:31]
  ds_read_b128 v[124:127], v2 offset:4096
  v_mfma_f32_16x16x32_bf16 v[32:35], v[20:23], v[36:39], v[32:35]
  ds_read_b128 v[36:39], v2 offset:5120
  v_perm_b32 v3, v57, v57, s31
  v_and_b32 v20, v24, v3
  v_and_b32 v21, v25, v3
  v_and_b32 v22, v26, v3
  v_and_b32 v23, v27, v3
  s_waitcnt lgkmcnt(5)
  s_nop 0
  v_mfma_f32_16x16x32_bf16 v[28:31], v[20:23], v[40:43], v[28:31]
  ds_read_b128 v[40:43], v2 offset:6144
  v_mfma_f32_16x16x32_bf16 v[32:35], v[20:23], v[44:47], v[32:35]
  ds_read_b128 v[44:47], v2 offset:7168
  v_perm_b32 v3, v58, v58, s30
  v_and_b32 v20, v24, v3
  v_and_b32 v21, v25, v3
  v_and_b32 v22, v26, v3
  v_and_b32 v23, v27, v3
  s_waitcnt lgkmcnt(5)
  s_nop 0
  v_mfma_f32_16x16x32_bf16 v[28:31], v[20:23], v[12:15], v[28:31]
  v_mfma_f32_16x16x32_bf16 v[32:35], v[20:23], v[16:19], v[32:35]
  v_perm_b32 v3, v58, v58, s31
  v_and_b32 v20, v24, v3
  v_and_b32 v21, v25, v3
  v_and_b32 v22, v26, v3
  v_and_b32 v23, v27, v3
  s_waitcnt lgkmcnt(3)
  s_nop 0
  v_mfma_f32_16x16x32_bf16 v[28:31], v[20:23], v[120:123], v[28:31]
  v_mfma_f32_16x16x32_bf16 v[32:35], v[20:23], v[124:127], v[32:35]
  v_perm_b32 v3, v59, v59, s30
  v_and_b32 v20, v24, v3
  v_and_b32 v21, v25, v3
  v_and_b32 v22, v26, v3
  v_and_b32 v23, v27, v3
  s_waitcnt lgkmcnt(1)
  s_nop 0
  v_mfma_f32_16x16x32_bf16 v[28:31], v[20:23], v[36:39], v[28:31]
  v_mfma_f32_16x16x32_bf16 v[32:35], v[20:23], v[40:43], v[32:35]
  v_perm_b32 v3, v59, v59, s31
  v_and_b32 v20, v24, v3
  v_and_b32 v21, v25, v3
  v_and_b32 v22, v26, v3
  v_and_b32 v23, v27, v3
  s_waitcnt lgkmcnt(0)
  s_nop 0
  v_mfma_f32_16x16x32_bf16 v[28:31], v[20:23], v[44:47], v[28:31]
  v_mfma_f32_16x16x32_bf16 v[32:35], v[20:23], v[60:63], v[32:35]
  v_lshrrev_b32 v2, 8, v0
  v_and_b32 v3, 0xf0, v0
  v_lshlrev_b32 v3, 1, v3
  v_and_b32 v5, 1, v2
  v_lshl_add_u32 v5, v5, 4, v3
  v_add_u32 v5, s37, v5
  s_mov_b32 exec_lo, 0x00ff00ff
  s_mov_b32 exec_hi, 0xff00ff00
  ds_write_b128 v5, v[28:31]
  ds_write_b128 v5, v[32:35] offset:512
  s_mov_b64 exec, -1
  s_xor_b32 s26, s50, 32768
  v_add_u32 v5, s26, v1
  v_lshl_add_u32 v3, v2, 4, v3
  s_waitcnt lgkmcnt(0)
  s_barrier
  ds_read2st64_b32 v[36:37], v5 offset0:0 offset1:1
  ds_read2st64_b32 v[52:53], v5 offset0:2 offset1:3
  ds_read2st64_b32 v[38:39], v5 offset0:32 offset1:33
  ds_read2st64_b32 v[54:55], v5 offset0:34 offset1:35
  ds_read2st64_b32 v[40:41], v5 offset0:64 offset1:65
  ds_read2st64_b32 v[56:57], v5 offset0:66 offset1:67
  ds_read2st64_b32 v[42:43], v5 offset0:96 offset1:97
  ds_read2st64_b32 v[58:59], v5 offset0:98 offset1:99
  s_waitcnt lgkmcnt(0)
  v_add_f32 v36, v36, v40
  v_add_f32 v37, v37, v41
  v_add_f32 v38, v38, v42
  v_add_f32 v39, v39, v43
  v_add_f32 v52, v52, v56
  v_add_f32 v53, v53, v57
  v_add_f32 v54, v54, v58
  v_add_f32 v55, v55, v59
  v_add_f32 v36, v36, v38
  v_add_f32 v37, v37, v39
  v_add_f32 v52, v52, v54
  v_add_f32 v53, v53, v55
  v_add_f32 v36, v36, v37
  v_add_f32 v52, v52, v53
  v_cvt_pk_bf16_f32 v36, 0, v36
  v_cvt_pk_bf16_f32 v52, 0, v52
  v_mul_f32 v40, 0xbfb8aa3b, v36
  v_exp_f32 v40, v40
  s_nop 0
  v_add_f32 v40, 1.0, v40
  v_rcp_f32 v40, v40
  s_nop 0
  v_mul_f32 v36, v36, v40
  v_cvt_pk_bf16_f32 v36, 0, v36
  v_mul_f32 v36, v36, v52
  v_cvt_pk_bf16_f32 v36, v36, v36
  s_lshl_b32 s26, s17, 8
  s_add_u32 s26, s26, 161792
  v_add_u32 v5, s26, v1
  ds_write_b32 v5, v36
  v_mul_u32_u24 v5, 56, v2
  v_add_u32 v5, s26, v5
  ds_read_b64 v[36:37], v5 offset:0
  ds_read_b64 v[38:39], v5 offset:8
  ds_read_b64 v[40:41], v5 offset:16
  ds_read_b64 v[42:43], v5 offset:24
  ds_read_b64 v[44:45], v5 offset:32
  ds_read_b64 v[46:47], v5 offset:40
  ds_read_b64 v[52:53], v5 offset:48
  s_waitcnt lgkmcnt(0)
  v_and_b32 v20, v24, v36
  v_and_b32 v21, v25, v36
  v_and_b32 v22, v26, v36
  v_and_b32 v23, v27, v36
  s_nop 0
  s_nop 0
  v_mfma_f32_16x16x32_bf16 v[28:31], v[20:23], v[64:67], 0
  v_and_b32 v32, v24, v37
  v_and_b32 v33, v25, v37
  v_and_b32 v34, v26, v37
  v_and_b32 v35, v27, v37
  s_waitcnt vmcnt(13)
  s_nop 0
  v_mfma_f32_16x16x32_bf16 v[28:31], v[32:35], v[68:71], v[28:31]
  v_and_b32 v20, v24, v38
  v_and_b32 v21, v25, v38
  v_and_b32 v22, v26, v38
  v_and_b32 v23, v27, v38
  s_waitcnt vmcnt(12)
  s_nop 0
  v_mfma_f32_16x16x32_bf16 v[28:31], v[20:23], v[72:75], v[28:31]
  v_and_b32 v32, v24, v39
  v_and_b32 v33, v25, v39
  v_and_b32 v34, v26, v39
  v_and_b32 v35, v27, v39
  s_waitcnt vmcnt(11)
  s_nop 0
  v_mfma_f32_16x16x32_bf16 v[28:31], v[32:35], v[76:79], v[28:31]
  v_and_b32 v20, v24, v40
  v_and_b32 v21, v25, v40
  v_and_b32 v22, v26, v40
  v_and_b32 v23, v27, v40
  s_waitcnt vmcnt(10)
  s_nop 0
  v_mfma_f32_16x16x32_bf16 v[28:31], v[20:23], v[80:83], v[28:31]
  v_and_b32 v32, v24, v41
  v_and_b32 v33, v25, v41
  v_and_b32 v34, v26, v41
  v_and_b32 v35, v27, v41
  s_waitcnt vmcnt(9)
  s_nop 0
  v_mfma_f32_16x16x32_bf16 v[28:31], v[32:35], v[84:87], v[28:31]
  v_and_b32 v20, v24, v42
  v_and_b32 v21, v25, v42
  v_and_b32 v22, v26, v42
  v_and_b32 v23, v27, v42
  s_waitcnt vmcnt(8)
  s_nop 0
  v_mfma_f32_16x16x32_bf16 v[28:31], v[20:23], v[88:91], v[28:31]
  v_and_b32 v32, v24, v43
  v_and_b32 v33, v25, v43
  v_and_b32 v34, v26, v43
  v_and_b32 v35, v27, v43
  s_waitcnt vmcnt(7)
  s_nop 0
  v_mfma_f32_16x16x32_bf16 v[28:31], v[32:35], v[92:95], v[28:31]
  v_and_b32 v20, v24, v44
  v_and_b32 v21, v25, v44
  v_and_b32 v22, v26, v44
  v_and_b32 v23, v27, v44
  s_waitcnt vmcnt(6)
  s_nop 0
  v_mfma_f32_16x16x32_bf16 v[28:31], v[20:23], v[96:99], v[28:31]
  v_and_b32 v32, v24, v45
  v_and_b32 v33, v25, v45
  v_and_b32 v34, v26, v45
  v_and_b32 v35, v27, v45
  s_waitcnt vmcnt(5)
  s_nop 0
  v_mfma_f32_16x16x32_bf16 v[28:31], v[32:35], v[100:103], v[28:31]
  v_and_b32 v20, v24, v46
  v_and_b32 v21, v25, v46
  v_and_b32 v22, v26, v46
  v_and_b32 v23, v27, v46
  s_waitcnt vmcnt(4)
  s_nop 0
  v_mfma_f32_16x16x32_bf16 v[28:31], v[20:23], v[104:107], v[28:31]
  v_and_b32 v32, v24, v47
  v_and_b32 v33, v25, v47
  v_and_b32 v34, v26, v47
  v_and_b32 v35, v27, v47
  s_waitcnt vmcnt(3)
  s_nop 0
  v_mfma_f32_16x16x32_bf16 v[28:31], v[32:35], v[108:111], v[28:31]
  v_and_b32 v20, v24, v52
  v_and_b32 v21, v25, v52
  v_and_b32 v22, v26, v52
  v_and_b32 v23, v27, v52
  s_waitcnt vmcnt(2)
  s_nop 0
  v_mfma_f32_16x16x32_bf16 v[28:31], v[20:23], v[112:115], v[28:31]
  v_and_b32 v32, v24, v53
  v_and_b32 v33, v25, v53
  v_and_b32 v34, v26, v53
  v_and_b32 v35, v27, v53
  s_waitcnt vmcnt(1)
  s_nop 0
  v_mfma_f32_16x16x32_bf16 v[28:31], v[32:35], v[48:51], v[28:31]
  v_lshrrev_b32 v3, 1, v3
  s_lshl_b32 s26, s46, 7
  s_add_u32 s26, s26, s57
  s_lshl_b32 s26, s26, 8
  s_add_u32 s26, s26, 244318208
  s_nop 2
  v_cvt_pk_bf16_f32 v28, v28, v29
  v_cvt_pk_bf16_f32 v29, v30, v31
  v_min_u32 v28, -2, v28
  v_min_u32 v29, -2, v29
  s_mov_b32 exec_hi, 0
  buffer_store_dwordx2 v[28:29], v3, s[4:7], s26 offen sc1
  s_mov_b32 exec_hi, -1
  v_lshrrev_b32 v7, 7, v0
  v_lshlrev_b32 v7, 12, v7
  v_and_b32 v2, 1023, v9
  s_lshl_b32 s26, s17, 10
  v_add3_u32 v7, v7, v2, s26
  v_mov_b32 v116, 0
  v_lshrrev_b32 v96, 9, v0
  v_lshlrev_b32 v96, 4, v96
  v_and_b32 v97, 0xf0, v0
  v_xor_b32 v96, v96, v97
  v_and_b32 v97, 0x1f0, v0
  v_lshl_add_u32 v96, v97, 6, v96
  v_add_u32 v96, s50, v96
  v_xor_b32 v120, 0, v96
  v_xor_b32 v121, 32, v96
  v_xor_b32 v122, 64, v96
  v_xor_b32 v123, 96, v96
  v_xor_b32 v124, 128, v96
  v_xor_b32 v125, 160, v96
  v_xor_b32 v126, 192, v96
  v_xor_b32 v127, 224, v96
  s_and_b32 s26, s17, 1
  s_lshl_b32 s26, s26, 7
  v_xor_b32 v96, s26, v0
  v_xor_b32 v12, 0, v96
  v_xor_b32 v13, 16, v96
  v_xor_b32 v14, 32, v96
  v_xor_b32 v15, 48, v96
  v_xor_b32 v16, 64, v96
  v_xor_b32 v17, 80, v96
  v_xor_b32 v18, 96, v96
  v_xor_b32 v19, 112, v96
  s_cmp_lt_u32 s47, 64
  s_cselect_b32 s26, 2, 0
  s_add_u32 s26, s26, s47
  s_lshl_b32 s26, s26, 12
  s_add_u32 s26, s26, 243261440
  s_mov_b64 exec, 0xffffff
  buffer_load_dword v116, v7, s[4:7], s26 offen sc1
  s_mov_b64 exec, -1
  s_lshl_b32 s26, s61, 21
  s_lshl_b32 s27, s59, 10
  s_add_u32 s26, s26, s27
  s_add_u32 s27, s26, 20971520
  s_add_u32 s28, s26, 27262976
  s_lshl_b32 s26, s46, 7
  s_add_u32 s26, s26, s17
  s_lshl_b32 s26, s26, 8
  s_add_u32 s26, s26, 244318208
  v_lshrrev_b32 v2, 8, v0
  v_and_b32 v3, 0xf0, v0
  v_lshl_add_u32 v5, v2, 10, v3
  buffer_load_dwordx4 v[108:111], v0, s[4:7], s27 offen sc1
  buffer_load_dwordx4 v[112:115], v0, s[4:7], s28 offen sc1
  s_mov_b32 s53, 0
  ds_read_b128 v[68:71], v120 offset:0
  ds_read_b128 v[72:75], v121 offset:0
  ds_read_b128 v[76:79], v122 offset:0
  ds_read_b128 v[80:83], v123 offset:0
  s_waitcnt lgkmcnt(2)
  v_mfma_f32_32x32x16_bf16 v[52:67], a[128:131], v[68:71], 0
  ds_read_b128 v[84:87], v124 offset:0
  ds_read_b128 v[88:91], v125 offset:0
  ds_read_b128 v[92:95], v126 offset:0
  v_mfma_f32_32x32x16_bf16 v[52:67], a[132:135], v[72:75], v[52:67]
  ds_read_b128 v[96:99], v127 offset:0
  s_waitcnt lgkmcnt(4)
  v_mfma_f32_32x32x16_bf16 v[52:67], a[136:139], v[76:79], v[52:67]
  ds_read_b128 v[68:71], v120 offset:256
  v_mfma_f32_32x32x16_bf16 v[52:67], a[140:143], v[80:83], v[52:67]
  ds_read_b128 v[72:75], v121 offset:256
  s_waitcnt lgkmcnt(4)
  v_mfma_f32_32x32x16_bf16 v[52:67], a[144:147], v[84:87], v[52:67]
  ds_read_b128 v[76:79], v122 offset:256
  v_mfma_f32_32x32x16_bf16 v[52:67], a[148:151], v[88:91], v[52:67]
  ds_read_b128 v[80:83], v123 offset:256
  s_waitcnt lgkmcnt(4)
  v_mfma_f32_32x32x16_bf16 v[52:67], a[152:155], v[92:95], v[52:67]
  ds_read_b128 v[84:87], v124 offset:256
  v_mfma_f32_32x32x16_bf16 v[52:67], a[156:159], v[96:99], v[52:67]
  ds_read_b128 v[88:91], v125 offset:256
  s_waitcnt lgkmcnt(4)
  v_mfma_f32_32x32x16_bf16 v[52:67], a[160:163], v[68:71], v[52:67]
  ds_read_b128 v[92:95], v126 offset:256
  v_mfma_f32_32x32x16_bf16 v[52:67], a[164:167], v[72:75], v[52:67]
  ds_read_b128 v[96:99], v127 offset:256
  s_waitcnt lgkmcnt(4)
  v_mfma_f32_32x32x16_bf16 v[52:67], a[168:171], v[76:79], v[52:67]
  ds_read_b128 v[68:71], v120 offset:512
  v_mfma_f32_32x32x16_bf16 v[52:67], a[172:175], v[80:83], v[52:67]
  ds_read_b128 v[72:75], v121 offset:512
  s_waitcnt lgkmcnt(4)
  v_mfma_f32_32x32x16_bf16 v[52:67], a[176:179], v[84:87], v[52:67]
  ds_read_b128 v[76:79], v122 offset:512
  v_mfma_f32_32x32x16_bf16 v[52:67], a[180:183], v[88:91], v[52:67]
  ds_read_b128 v[80:83], v123 offset:512
  s_waitcnt lgkmcnt(4)
  v_mfma_f32_32x32x16_bf16 v[52:67], a[184:187], v[92:95], v[52:67]
  ds_read_b128 v[84:87], v124 offset:512
  v_mfma_f32_32x32x16_bf16 v[52:67], a[188:191], v[96:99], v[52:67]
  ds_read_b128 v[88:91], v125 offset:512
  s_waitcnt lgkmcnt(4)
  v_mfma_f32_32x32x16_bf16 v[52:67], a[192:195], v[68:71], v[52:67]
  ds_read_b128 v[92:95], v126 offset:512
  v_mfma_f32_32x32x16_bf16 v[52:67], a[196:199], v[72:75], v[52:67]
  ds_read_b128 v[96:99], v127 offset:512
  s_waitcnt lgkmcnt(4)
  v_mfma_f32_32x32x16_bf16 v[52:67], a[200:203], v[76:79], v[52:67]
  ds_read_b128 v[68:71], v120 offset:768
  v_mfma_f32_32x32x16_bf16 v[52:67], a[204:207], v[80:83], v[52:67]
  ds_read_b128 v[72:75], v121 offset:768
  s_waitcnt lgkmcnt(4)
  v_mfma_f32_32x32x16_bf16 v[52:67], a[208:211], v[84:87], v[52:67]
  ds_read_b128 v[76:79], v122 offset:768
  v_mfma_f32_32x32x16_bf16 v[52:67], a[212:215], v[88:91], v[52:67]
  ds_read_b128 v[80:83], v123 offset:768
  s_waitcnt lgkmcnt(4)
  v_mfma_f32_32x32x16_bf16 v[52:67], a[216:219], v[92:95], v[52:67]
  ds_read_b128 v[84:87], v124 offset:768
  v_mfma_f32_32x32x16_bf16 v[52:67], a[220:223], v[96:99], v[52:67]
  ds_read_b128 v[88:91], v125 offset:768
  s_waitcnt lgkmcnt(4)
  v_mfma_f32_32x32x16_bf16 v[52:67], a[224:227], v[68:71], v[52:67]
  ds_read_b128 v[92:95], v126 offset:768
  v_mfma_f32_32x32x16_bf16 v[52:67], a[228:231], v[72:75], v[52:67]
  ds_read_b128 v[96:99], v127 offset:768
  s_waitcnt lgkmcnt(4)
  v_mfma_f32_32x32x16_bf16 v[52:67], a[232:235], v[76:79], v[52:67]
  v_mfma_f32_32x32x16_bf16 v[52:67], a[236:239], v[80:83], v[52:67]
  s_waitcnt lgkmcnt(2)
  v_mfma_f32_32x32x16_bf16 v[52:67], a[240:243], v[84:87], v[52:67]
  v_mfma_f32_32x32x16_bf16 v[52:67], a[244:247], v[88:91], v[52:67]
  s_waitcnt lgkmcnt(0)
  v_mfma_f32_32x32x16_bf16 v[52:67], a[248:251], v[92:95], v[52:67]
  v_mfma_f32_32x32x16_bf16 v[52:67], a[252:255], v[96:99], v[52:67]
  s_lshl_b32 s28, s52, 11
  s_add_u32 s77, s28, 159383552
  s_add_u32 s28, s28, 142606336
  s_add_u32 s51, s51, 262144
  s_nop 7
  v_cvt_pk_bf16_f32 v100, v52, v53
  v_cvt_pk_bf16_f32 v101, v54, v55
  v_cvt_pk_bf16_f32 v102, v60, v61
  v_cvt_pk_bf16_f32 v103, v62, v63
  v_cvt_pk_bf16_f32 v104, v56, v57
  v_cvt_pk_bf16_f32 v105, v58, v59
  v_cvt_pk_bf16_f32 v106, v64, v65
  v_cvt_pk_bf16_f32 v107, v66, v67
m_w_103:
  s_add_u32 s27, s26, 0
  buffer_load_dwordx4 v[20:23], v5, s[4:7], s27 offen sc1
  s_add_u32 s27, s26, 4096
  buffer_load_dwordx4 v[24:27], v5, s[4:7], s27 offen sc1
  s_add_u32 s27, s26, 8192
  buffer_load_dwordx4 v[28:31], v5, s[4:7], s27 offen sc1
  s_add_u32 s27, s26, 12288
  buffer_load_dwordx4 v[32:35], v5, s[4:7], s27 offen sc1
  s_add_u32 s27, s26, 16384
  buffer_load_dwordx4 v[36:39], v5, s[4:7], s27 offen sc1
  s_add_u32 s27, s26, 20480
  buffer_load_dwordx4 v[40:43], v5, s[4:7], s27 offen sc1
  s_add_u32 s27, s26, 24576
  buffer_load_dwordx4 v[44:47], v5, s[4:7], s27 offen sc1
  s_add_u32 s27, s26, 28672
  buffer_load_dwordx4 v[48:51], v5, s[4:7], s27 offen sc1
  s_add_u32 s53, s53, 1
  s_cmp_gt_u32 s53, 1048576
  s_cbranch_scc1 q_fail_90
  s_mov_b32 vcc_lo, 0xaaaaaaaa
  s_mov_b32 vcc_hi, 0xaaaaaaaa
  v_mov_b32 v72, 0x3f80
  v_mov_b32 v68, 1.0
  v_cndmask_b32 v72, v72, v68, vcc
  s_mov_b32 vcc_lo, 0x30003
  s_mov_b32 vcc_hi, 0x30003
  v_cndmask_b32 v68, 0, v72, vcc
  s_mov_b32 vcc_lo, 0xc000c
  s_mov_b32 vcc_hi, 0xc000c
  v_cndmask_b32 v69, 0, v72, vcc
  s_mov_b32 vcc_lo, 0x300030
  s_mov_b32 vcc_hi, 0x300030
  v_cndmask_b32 v70, 0, v72, vcc
  s_mov_b32 vcc_lo, 0xc000c0
  s_mov_b32 vcc_hi, 0xc000c0
  v_cndmask_b32 v71, 0, v72, vcc
  s_waitcnt vmcnt(7)
  s_nop 0
  v_mfma_f32_16x16x32_bf16 v[72:75], v[68:71], v[20:23], 0
  v_max3_u32 v80, v20, v21, 0
  v_max3_u32 v80, v22, v23, v80
  s_waitcnt vmcnt(6)
  v_mfma_f32_16x16x32_bf16 v[72:75], v[68:71], v[24:27], v[72:75]
  v_max3_u32 v80, v24, v25, v80
  v_max3_u32 v80, v26, v27, v80
  s_waitcnt vmcnt(5)
  v_mfma_f32_16x16x32_bf16 v[72:75], v[68:71], v[28:31], v[72:75]
  v_max3_u32 v80, v28, v29, v80
  v_max3_u32 v80, v30, v31, v80
  s_waitcnt vmcnt(4)
  v_mfma_f32_16x16x32_bf16 v[72:75], v[68:71], v[32:35], v[72:75]
  v_max3_u32 v80, v32, v33, v80
  v_max3_u32 v80, v34, v35, v80
  s_waitcnt vmcnt(3)
  v_mfma_f32_16x16x32_bf16 v[72:75], v[68:71], v[36:39], v[72:75]
  v_max3_u32 v80, v36, v37, v80
  v_max3_u32 v80, v38, v39, v80
  s_waitcnt vmcnt(2)
  v_mfma_f32_16x16x32_bf16 v[72:75], v[68:71], v[40:43], v[72:75]
  v_max3_u32 v80, v40, v41, v80
  v_max3_u32 v80, v42, v43, v80
  s_waitcnt vmcnt(1)
  v_mfma_f32_16x16x32_bf16 v[72:75], v[68:71], v[44:47], v[72:75]
  v_max3_u32 v80, v44, v45, v80
  v_max3_u32 v80, v46, v47, v80
  s_waitcnt vmcnt(0)
  v_mfma_f32_16x16x32_bf16 v[72:75], v[68:71], v[48:51], v[72:75]
  v_max3_u32 v80, v48, v49, v80
  v_max3_u32 v80, v50, v51, v80
  v_cmp_eq_u32 vcc, -1, v80
  s_cbranch_vccnz m_w_103
  v_lshlrev_b32 v3, 1, v3
  v_lshl_add_u32 v3, v2, 4, v3
  s_lshl_b32 s26, s17, 9
  s_add_u32 s26, s26, 159744
  v_add_u32 v3, s26, v3
  s_mov_b32 exec_hi, 0
  ds_write_b128 v3, v[72:75]
  s_mov_b32 exec_hi, -1
  v_lshlrev_b32 v3, 1, v0
  v_add_u32 v3, 159744, v3
  buffer_store_dwordx4 v[100:103], v8, s[4:7], s77 offen offset:0 sc1
  buffer_store_dwordx4 v[104:107], v8, s[4:7], s77 offen offset:512 sc1
  buffer_store_dwordx4 v[100:103], v8, s[4:7], s28 offen offset:0 sc1
  buffer_store_dwordx4 v[104:107], v8, s[4:7], s28 offen offset:512 sc1
  v_lshlrev_b32 v80, 16, v108
  v_and_b32 v81, 0xffff0000, v108
  v_lshlrev_b32 v82, 16, v109
  v_and_b32 v83, 0xffff0000, v109
  v_lshlrev_b32 v84, 16, v110
  v_and_b32 v85, 0xffff0000, v110
  v_lshlrev_b32 v86, 16, v111
  v_and_b32 v87, 0xffff0000, v111
  v_lshlrev_b32 v88, 16, v112
  v_and_b32 v89, 0xffff0000, v112
  v_lshlrev_b32 v90, 16, v113
  v_and_b32 v91, 0xffff0000, v113
  v_lshlrev_b32 v92, 16, v114
  v_and_b32 v93, 0xffff0000, v114
  v_lshlrev_b32 v94, 16, v115
  v_and_b32 v95, 0xffff0000, v115
  s_waitcnt lgkmcnt(0)
  s_barrier
  s_cmp_lg_u32 s17, 0
  s_cbranch_scc1 m_done_102
  ds_read_b128 v[72:75], v3
  ds_read_b128 v[76:79], v3 offset:16
  s_and_b32 s29, s58, 0xffff0000
  s_xor_b32 s27, s29, 0x80000000
  s_xor_b32 s28, s29, 0xffff0000
  s_bitcmp1_b32 s29, 31
  s_cselect_b32 s29, s27, s28
  v_mov_b32 v108, s29
  v_mul_f32 v108, 0xbfb8aa3b, v108
  v_exp_f32 v108, v108
  s_nop 0
  v_add_f32 v108, 1.0, v108
  v_rcp_f32 v108, v108
  s_nop 0
  v_cvt_pk_bf16_f32 v108, 0, v108
  s_waitcnt lgkmcnt(0)
  v_cvt_pk_bf16_f32 v72, 0, v72
  v_cvt_pk_bf16_f32 v73, 0, v73
  v_cvt_pk_bf16_f32 v74, 0, v74
  v_cvt_pk_bf16_f32 v75, 0, v75
  v_cvt_pk_bf16_f32 v76, 0, v76
  v_cvt_pk_bf16_f32 v77, 0, v77
  v_cvt_pk_bf16_f32 v78, 0, v78
  v_cvt_pk_bf16_f32 v79, 0, v79
  v_mul_f32 v72, v72, v108
  v_mul_f32 v73, v73, v108
  v_mul_f32 v74, v74, v108
  v_mul_f32 v75, v75, v108
  v_mul_f32 v76, v76, v108
  v_mul_f32 v77, v77, v108
  v_mul_f32 v78, v78, v108
  v_mul_f32 v79, v79, v108
  v_cvt_pk_bf16_f32 v72, 0, v72
  v_cvt_pk_bf16_f32 v73, 0, v73
  v_cvt_pk_bf16_f32 v74, 0, v74
  v_cvt_pk_bf16_f32 v75, 0, v75
  v_cvt_pk_bf16_f32 v76, 0, v76
  v_cvt_pk_bf16_f32 v77, 0, v77
  v_cvt_pk_bf16_f32 v78, 0, v78
  v_cvt_pk_bf16_f32 v79, 0, v79
  v_add_f32 v72, v72, v88
  v_add_f32 v73, v73, v89
  v_add_f32 v74, v74, v90
  v_add_f32 v75, v75, v91
  v_add_f32 v76, v76, v92
  v_add_f32 v77, v77, v93
  v_add_f32 v78, v78, v94
  v_add_f32 v79, v79, v95
  v_cvt_pk_bf16_f32 v72, 0, v72
  v_cvt_pk_bf16_f32 v73, 0, v73
  v_cvt_pk_bf16_f32 v74, 0, v74
  v_cvt_pk_bf16_f32 v75, 0, v75
  v_cvt_pk_bf16_f32 v76, 0, v76
  v_cvt_pk_bf16_f32 v77, 0, v77
  v_cvt_pk_bf16_f32 v78, 0, v78
  v_cvt_pk_bf16_f32 v79, 0, v79
  v_add_f32 v80, v80, v72
  v_add_f32 v81, v81, v73
  v_add_f32 v82, v82, v74
  v_add_f32 v83, v83, v75
  v_add_f32 v84, v84, v76
  v_add_f32 v85, v85, v77
  v_add_f32 v86, v86, v78
  v_add_f32 v87, v87, v79
  v_cvt_pk_bf16_f32 v112, v80, v81
  v_cvt_pk_bf16_f32 v113, v82, v83
  v_cvt_pk_bf16_f32 v114, v84, v85
  v_cvt_pk_bf16_f32 v115, v86, v87
  v_lshlrev_b32 v80, 16, v112
  v_and_b32 v81, 0xffff0000, v112
  v_lshlrev_b32 v82, 16, v113
  v_and_b32 v83, 0xffff0000, v113
  v_lshlrev_b32 v84, 16, v114
  v_and_b32 v85, 0xffff0000, v114
  v_lshlrev_b32 v86, 16, v115
  v_and_b32 v87, 0xffff0000, v115
  s_lshl_b32 s27, s46, 5
  s_add_u32 s27, s27, s16
  s_lshl_b32 s27, s27, 10
  s_add_u32 s27, s27, 33554432
  buffer_store_dwordx4 v[112:115], v0, s[4:7], s27 offen sc1
  v_add_f32 v20, v80, v81
  v_mul_f32 v21, v80, v80
  v_add_f32 v22, v82, v83
  v_mul_f32 v23, v81, v81
  v_fmac_f32 v21, v82, v82
  v_fmac_f32 v23, v83, v83
  v_add_f32 v20, v20, v84
  v_fmac_f32 v21, v84, v84
  v_add_f32 v22, v22, v85
  v_fmac_f32 v23, v85, v85
  v_add_f32 v20, v20, v86
  v_fmac_f32 v21, v86, v86
  v_add_f32 v22, v22, v87
  v_fmac_f32 v23, v87, v87
  v_add_f32 v20, v20, v22
  v_add_f32 v21, v21, v23
  s_nop 0
  v_add_f32_dpp v20, v20, v20 row_ror:8 row_mask:0xf bank_mask:0xf
  v_add_f32_dpp v21, v21, v21 row_ror:8 row_mask:0xf bank_mask:0xf
  s_nop 0
  v_add_f32_dpp v20, v20, v20 row_ror:4 row_mask:0xf bank_mask:0xf
  v_add_f32_dpp v21, v21, v21 row_ror:4 row_mask:0xf bank_mask:0xf
  s_nop 0
  v_add_f32_dpp v20, v20, v20 row_ror:2 row_mask:0xf bank_mask:0xf
  v_add_f32_dpp v21, v21, v21 row_ror:2 row_mask:0xf bank_mask:0xf
  s_nop 0
  v_add_f32_dpp v20, v20, v20 row_ror:1 row_mask:0xf bank_mask:0xf
  v_add_f32_dpp v21, v21, v21 row_ror:1 row_mask:0xf bank_mask:0xf
  v_mov_b32 v24, v20
  v_mov_b32 v25, v21
  s_nop 0
  v_permlane16_swap_b32 v20, v24
  v_permlane16_swap_b32 v21, v25
  v_add_f32 v20, v20, v24
  v_add_f32 v21, v21, v25
  v_mov_b32 v24, v20
  v_mov_b32 v25, v21
  s_nop 0
  v_permlane32_swap_b32 v20, v24
  v_permlane32_swap_b32 v21, v25
  v_add_f32 v20, v20, v24
  v_add_f32 v21, v21, v25
  v_mul_f32 v20, 0x3b000000, v20
  v_mul_f32 v21, 0x3b000000, v21
  v_fma_f32 v21, -v20, v20, v21
  v_cvt_pk_bf16_f32 v20, 0, v20
  v_max_f32 v21, 0, v21
  v_sub_f32 v24, v80, v20
  v_sub_f32 v25, v81, v20
  v_cvt_pk_bf16_f32 v21, 0, v21
  v_sub_f32 v26, v82, v20
  v_sub_f32 v27, v83, v20
  v_add_f32 v21, 0x3727c5ac, v21
  v_sub_f32 v28, v84, v20
  v_sub_f32 v29, v85, v20
  v_cvt_pk_bf16_f32 v21, 0, v21
  v_sub_f32 v30, v86, v20
  v_sub_f32 v31, v87, v20
  v_sqrt_f32 v21, v21
  v_cvt_pk_bf16_f32 v24, 0, v24
  v_cvt_pk_bf16_f32 v25, 0, v25
  v_cvt_pk_bf16_f32 v21, 0, v21
  v_cvt_pk_bf16_f32 v26, 0, v26
  v_cvt_pk_bf16_f32 v27, 0, v27
  v_rcp_f32 v21, v21
  v_cvt_pk_bf16_f32 v28, 0, v28
  v_cvt_pk_bf16_f32 v29, 0, v29
  v_cvt_pk_bf16_f32 v30, 0, v30
  v_cvt_pk_bf16_f32 v31, 0, v31
  v_mul_f32 v24, v24, v21
  v_mul_f32 v25, v25, v21
  v_mul_f32 v26, v26, v21
  v_mul_f32 v27, v27, v21
  v_mul_f32 v28, v28, v21
  v_mul_f32 v29, v29, v21
  v_mul_f32 v30, v30, v21
  v_mul_f32 v31, v31, v21
  v_cvt_pk_bf16_f32 v32, v24, v25
  v_cvt_pk_bf16_f32 v33, v26, v27
  v_cvt_pk_bf16_f32 v34, v28, v29
  v_cvt_pk_bf16_f32 v35, v30, v31
  v_lshl_add_u32 v3, v0, 2, s50
  v_mov_b64 v[20:21], 0
  v_mov_b64 v[24:25], 0
  v_mov_b64 v[28:29], 0
  v_mov_b32 v22, v32
  v_mov_b32 v23, v34
  v_mov_b32 v26, v33
  v_mov_b32 v27, v35
  ds_write_b128 v3, v[22:25] offset:4096
  ds_write_b128 v3, v[20:23] offset:4112
  ds_write_b128 v3, v[26:29] offset:4128
  ds_write_b128 v3, v[24:27] offset:4144
m_done_102:
  v_lshrrev_b32 v96, 9, v0
  v_lshlrev_b32 v96, 4, v96
  v_and_b32 v97, 0xf0, v0
  v_xor_b32 v96, v96, v97
  v_and_b32 v97, 0x1f0, v0
  v_lshl_add_u32 v96, v97, 6, v96
  v_xor_b32 v120, 0, v96
  v_xor_b32 v121, 32, v96
  v_xor_b32 v122, 64, v96
  v_xor_b32 v123, 96, v96
  v_xor_b32 v124, 128, v96
  v_xor_b32 v125, 160, v96
  v_xor_b32 v126, 192, v96
  v_xor_b32 v127, 224, v96
  s_and_b32 s26, s17, 1
  s_lshl_b32 s26, s26, 7
  v_xor_b32 v96, s26, v0
  v_xor_b32 v12, 0, v96
  v_xor_b32 v13, 16, v96
  v_xor_b32 v14, 32, v96
  v_xor_b32 v15, 48, v96
  v_xor_b32 v16, 64, v96
  v_xor_b32 v17, 80, v96
  v_xor_b32 v18, 96, v96
  v_xor_b32 v19, 112, v96
  v_cmp_eq_u32 vcc, 0, v116
  v_max_u32_dpp v117, v116, v116 quad_perm:[1,0,3,2] row_mask:0xf bank_mask:0xf
  s_and_b32 s48, vcc_lo, 0xffffff
  s_cselect_b32 s48, 0, -1
  v_max_u32_dpp v117, v117, v117 quad_perm:[2,3,0,1] row_mask:0xf bank_mask:0xf
  s_nop 1
  v_max_u32_dpp v117, v117, v117 row_half_mirror row_mask:0xf bank_mask:0xf
  v_and_b32 v117, s48, v117
  s_cmp_eq_u32 s48, 0
  s_cbranch_scc1 q_nb_104
  s_and_b32 s63, s47, 127
  s_lshl_b32 s63, s63, 15
  s_xor_b32 s27, s50, 32768
  s_add_u32 m0, s27, s54
  s_add_u32 s63, s63, s54
  s_add_u32 s63, s63, 6291456
  buffer_load_dwordx4 v12, s[4:7], s63 offen offset:0 sc1 lds
  buffer_load_dwordx4 v13, s[4:7], s63 offen offset:1024 sc1 lds
  buffer_load_dwordx4 v14, s[4:7], s63 offen offset:2048 sc1 lds
  buffer_load_dwordx4 v15, s[4:7], s63 offen offset:3072 sc1 lds
  s_add_u32 m0, m0, 4096
  s_add_u32 s63, s63, 4096
  buffer_load_dwordx4 v16, s[4:7], s63 offen offset:0 sc1 lds
  buffer_load_dwordx4 v17, s[4:7], s63 offen offset:1024 sc1 lds
  buffer_load_dwordx4 v18, s[4:7], s63 offen offset:2048 sc1 lds
  buffer_load_dwordx4 v19, s[4:7], s63 offen offset:3072 sc1 lds
q_nb_104:
  v_lshrrev_b32 v2, 8, v0
  v_and_b32 v3, 48, v0
  v_lshl_add_u32 v3, v2, 6, v3
  v_add_u32 v3, s50, v3
  s_mov_b32 vcc_lo, 0xcccccccc
  s_mov_b32 vcc_hi, 0xcccccccc
  v_mov_b32 v32, 0x4444
  v_mov_b32 v33, 0xeeee
  v_cndmask_b32 v32, v32, v33, vcc
  s_waitcnt lgkmcnt(0)
  s_barrier
  ds_read_b128 v[36:39], v3 offset:4096
  ds_read_b128 v[40:43], v3 offset:4352
  ds_read_b128 v[44:47], v3 offset:4608
  ds_read_b128 v[48:51], v3 offset:4864
  ds_read_b128 v[52:55], v3 offset:5120
  ds_read_b128 v[56:59], v3 offset:5376
  ds_read_b128 v[60:63], v3 offset:5632
  ds_read_b128 v[64:67], v3 offset:5888
  v_mov_b64 v[20:21], 0
  v_mov_b64 v[22:23], 0
  v_mov_b64 v[24:25], 0
  v_mov_b64 v[26:27], 0
  v_mov_b64 v[28:29], 0
  v_mov_b64 v[30:31], 0
  s_waitcnt lgkmcnt(7)
  v_smfmac_f32_16x16x64_bf16 v[20:23], v[36:39], v[128:135], v32
  ds_read_b128 v[68:71], v3 offset:6144
  v_smfmac_f32_16x16x64_bf16 v[24:27], v[36:39], a[0:7], v32
  s_and_b32 s26, s59, 16
  v_smfmac_f32_16x16x64_bf16 v[28:31], v[36:39], a[128:135], v32
  s_lshl_b32 s27, s26, 6
  s_waitcnt lgkmcnt(7)
  v_smfmac_f32_16x16x64_bf16 v[20:23], v[40:43], v[136:143], v32
  ds_read_b128 v[72:75], v3 offset:6400
  v_smfmac_f32_16x16x64_bf16 v[24:27], v[40:43], a[8:15], v32
  s_and_b32 s28, s59, 15
  v_smfmac_f32_16x16x64_bf16 v[28:31], v[40:43], a[136:143], v32
  s_lshl4_add_u32 s27, s28, s27
  s_waitcnt lgkmcnt(7)
  v_smfmac_f32_16x16x64_bf16 v[20:23], v[44:47], v[144:151], v32
  ds_read_b128 v[76:79], v3 offset:6656
  v_smfmac_f32_16x16x64_bf16 v[24:27], v[44:47], a[16:23], v32
  s_add_u32 s77, s77, s27
  v_smfmac_f32_16x16x64_bf16 v[28:31], v[44:47], a[144:151], v32
  s_add_u32 s27, s27, s44
  s_waitcnt lgkmcnt(7)
  v_smfmac_f32_16x16x64_bf16 v[20:23], v[48:51], v[152:159], v32
  ds_read_b128 v[80:83], v3 offset:6912
  v_smfmac_f32_16x16x64_bf16 v[24:27], v[48:51], a[24:31], v32
  s_lshr_b32 s26, s26, 1
  v_smfmac_f32_16x16x64_bf16 v[28:31], v[48:51], a[152:159], v32
  s_and_b32 s28, s59, 3
  s_waitcnt lgkmcnt(7)
  v_smfmac_f32_16x16x64_bf16 v[20:23], v[52:55], v[160:167], v32
  ds_read_b128 v[84:87], v3 offset:7168
  v_smfmac_f32_16x16x64_bf16 v[24:27], v[52:55], a[32:39], v32
  s_lshl1_add_u32 s26, s28, s26
  v_smfmac_f32_16x16x64_bf16 v[28:31], v[52:55], a[160:167], v32
  s_and_b32 s28, s59, 12
  s_waitcnt lgkmcnt(7)
  v_smfmac_f32_16x16x64_bf16 v[20:23], v[56:59], v[168:175], v32
  ds_read_b128 v[88:91], v3 offset:7424
  v_smfmac_f32_16x16x64_bf16 v[24:27], v[56:59], a[40:47], v32
  s_lshl_b32 s28, s28, 6
  v_smfmac_f32_16x16x64_bf16 v[28:31], v[56:59], a[168:175], v32
  s_add_u32 s26, s26, s28
  s_waitcnt lgkmcnt(7)
  v_smfmac_f32_16x16x64_bf16 v[20:23], v[60:63], v[176:183], v32
  ds_read_b128 v[92:95], v3 offset:7680
  v_smfmac_f32_16x16x64_bf16 v[24:27], v[60:63], a[48:55], v32
  s_add_u32 s26, s26, s44
  v_smfmac_f32_16x16x64_bf16 v[28:31], v[60:63], a[176:183], v32
  v_and_b32 v2, 0xc0, v0
  s_waitcnt lgkmcnt(7)
  v_smfmac_f32_16x16x64_bf16 v[20:23], v[64:67], v[184:191], v32
  ds_read_b128 v[96:99], v3 offset:7936
  v_smfmac_f32_16x16x64_bf16 v[24:27], v[64:67], a[56:63], v32
  v_and_b32 v5, 12, v1
  v_smfmac_f32_16x16x64_bf16 v[28:31], v[64:67], a[184:191], v32
  v_lshrrev_b32 v5, 1, v5
  s_waitcnt lgkmcnt(7)
  v_smfmac_f32_16x16x64_bf16 v[20:23], v[68:71], v[192:199], v32
  v_lshl_add_u32 v2, v2, 2, v5
  v_smfmac_f32_16x16x64_bf16 v[24:27], v[68:71], a[64:71], v32
  v_smfmac_f32_16x16x64_bf16 v[28:31], v[68:71], a[192:199], v32
  s_waitcnt lgkmcnt(6)
  v_smfmac_f32_16x16x64_bf16 v[20:23], v[72:75], v[200:207], v32
  v_smfmac_f32_16x16x64_bf16 v[24:27], v[72:75], a[72:79], v32
  v_smfmac_f32_16x16x64_bf16 v[28:31], v[72:75], a[200:207], v32
  s_waitcnt lgkmcnt(5)
  v_smfmac_f32_16x16x64_bf16 v[20:23], v[76:79], v[208:215], v32
  v_smfmac_f32_16x16x64_bf16 v[24:27], v[76:79], a[80:87], v32
  v_smfmac_f32_16x16x64_bf16 v[28:31], v[76:79], a[208:215], v32
  s_waitcnt lgkmcnt(4)
  v_smfmac_f32_16x16x64_bf16 v[20:23], v[80:83], v[216:223], v32
  v_smfmac_f32_16x16x64_bf16 v[24:27], v[80:83], a[88:95], v32
  v_smfmac_f32_16x16x64_bf16 v[28:31], v[80:83], a[216:223], v32
  s_waitcnt lgkmcnt(3)
  v_smfmac_f32_16x16x64_bf16 v[20:23], v[84:87], v[224:231], v32
  v_smfmac_f32_16x16x64_bf16 v[24:27], v[84:87], a[96:103], v32
  v_smfmac_f32_16x16x64_bf16 v[28:31], v[84:87], a[224:231], v32
  s_waitcnt lgkmcnt(2)
  v_smfmac_f32_16x16x64_bf16 v[20:23], v[88:91], v[232:239], v32
  v_smfmac_f32_16x16x64_bf16 v[24:27], v[88:91], a[104:111], v32
  v_smfmac_f32_16x16x64_bf16 v[28:31], v[88:91], a[232:239], v32
  s_waitcnt lgkmcnt(1)
  v_smfmac_f32_16x16x64_bf16 v[20:23], v[92:95], v[240:247], v32
  v_smfmac_f32_16x16x64_bf16 v[24:27], v[92:95], a[112:119], v32
  v_smfmac_f32_16x16x64_bf16 v[28:31], v[92:95], a[240:247], v32
  s_waitcnt lgkmcnt(0)
  v_smfmac_f32_16x16x64_bf16 v[20:23], v[96:99], v[248:255], v32
  v_smfmac_f32_16x16x64_bf16 v[24:27], v[96:99], a[120:127], v32
  v_smfmac_f32_16x16x64_bf16 v[28:31], v[96:99], a[248:255], v32
  v_add_f32 v20, v20, v22
  v_add_f32 v21, v21, v23
  s_nop 1
  v_add_f32 v24, v24, v26
  v_add_f32 v25, v25, v27
  s_nop 1
  v_add_f32 v28, v28, v30
  v_add_f32 v29, v29, v31
  v_mul_f32 v20, s24, v20
  v_mul_f32 v21, s24, v21
  v_cvt_pk_bf16_f32 v20, v20, v21
  v_cvt_pk_bf16_f32 v24, v24, v25
  v_cvt_pk_bf16_f32 v28, v28, v29
  s_mov_b64 exec, 0xffff
  s_waitcnt vmcnt(0)
  buffer_store_short v20, v2, s[4:7], s27 offen sc1
  buffer_store_short_d16_hi v20, v2, s[4:7], s27 offen offset:8 sc1
  buffer_store_short v24, v0, s[4:7], s26 offen offset:2048 sc1
  buffer_store_short_d16_hi v24, v0, s[4:7], s26 offen offset:3072 sc1
  buffer_store_short v28, v2, s[4:7], s77 offen sc1
  buffer_store_short_d16_hi v28, v2, s[4:7], s77 offen offset:8 sc1
  s_mov_b64 exec, 3
  s_waitcnt vmcnt(0)
  buffer_store_dword v4, v0, s[4:7], s51 offen sc1
  s_mov_b64 exec, 3
  buffer_store_dword v4, v0, s[4:7], s49 offen sc1
  s_mov_b64 exec, -1
  s_mov_b32 s49, 268435456
  v_mov_b32 v4, 1
  s_branch q_nxt_96
q_end_87:
  s_waitcnt vmcnt(0)
  s_mov_b64 exec, 3
  buffer_store_dword v4, v0, s[4:7], s49 offen sc1
  s_mov_b64 exec, -1
  s_cmp_lg_u32 s60, 0
  s_cbranch_scc1 q_fail_90
  s_load_dwordx2 s[72:73], s[0:1], 96
  s_mov_b32 s74, 2097152
  s_mov_b32 s75, 0x20000
  s_mov_b32 s58, 0
  s_cmp_eq_u32 s17, 3
  s_cselect_b32 s48, 7, 15
k_fin_105:
  s_load_dwordx2 s[64:65], s[0:1], 72
  s_load_dwordx2 s[68:69], s[0:1], 80
  s_load_dwordx2 s[8:9], s[0:1], 88
  s_mov_b32 s66, 1835008
  s_mov_b32 s70, 1835008
  s_mov_b32 s10, 1835008
  v_lshrrev_b32 v2, 7, v0
  v_and_b32 v3, 0x70, v0
  v_mul_u32_u24 v6, 57344, v2
  v_add_u32 v6, v6, v3
  v_cmp_eq_u32 vcc, 0x70, v3
  v_mov_b32 v3, 0x7ff00000
  s_nop 0
  v_cndmask_b32 v6, v6, v3, vcc
  v_lshrrev_b32 v2, 8, v0
  v_mul_u32_u24 v7, 14336, v2
  v_and_b32 v3, 0xf0, v0
  v_add_u32 v7, v7, v3
  s_mul_i32 s34, s17, 458752
  s_mul_i32 s27, s16, 112
  s_add_u32 s34, s34, s27
  s_mul_i32 s35, s16, 57344
  s_lshl_b32 s27, s17, 8
  s_add_u32 s35, s35, s27
  s_waitcnt lgkmcnt(0)
  s_xor_b32 s37, s50, 32768
  s_add_u32 s37, s37, s54
  s_mov_b32 m0, s37
  s_add_u32 s36, s34, 39424
  buffer_load_dwordx4 v6, s[68:71], s36 offen lds
  s_add_u32 m0, m0, 1024
  s_add_u32 s36, s34, 43008
  buffer_load_dwordx4 v6, s[64:67], s36 offen lds
  s_add_u32 m0, m0, 1024
  s_add_u32 s36, s34, 43008
  buffer_load_dwordx4 v6, s[68:71], s36 offen lds
  s_add_u32 m0, m0, 1024
  s_add_u32 s36, s34, 46592
  buffer_load_dwordx4 v6, s[64:67], s36 offen lds
  s_add_u32 m0, m0, 1024
  s_add_u32 s36, s34, 46592
  buffer_load_dwordx4 v6, s[68:71], s36 offen lds
  s_add_u32 m0, m0, 1024
  s_add_u32 s36, s34, 50176
  buffer_load_dwordx4 v6, s[64:67], s36 offen lds
  s_add_u32 m0, m0, 1024
  s_add_u32 s36, s34, 50176
  buffer_load_dwordx4 v6, s[68:71], s36 offen lds
  s_add_u32 m0, m0, 1024
  s_add_u32 s36, s34, 53760
  buffer_load_dwordx4 v6, s[64:67], s36 offen lds
  s_add_u32 m0, m0, 1024
  s_add_u32 s36, s34, 53760
  buffer_load_dwordx4 v[60:63], v6, s[68:71], s36 offen
  buffer_load_dwordx4 v[64:67], v7, s[8:11], s35 offen offset:0
  buffer_load_dwordx4 v[68:71], v7, s[8:11], s35 offen offset:1024
  buffer_load_dwordx4 v[72:75], v7, s[8:11], s35 offen offset:2048
  buffer_load_dwordx4 v[76:79], v7, s[8:11], s35 offen offset:3072
  s_add_u32 s35, s35, 4096
  buffer_load_dwordx4 v[80:83], v7, s[8:11], s35 offen offset:0
  buffer_load_dwordx4 v[84:87], v7, s[8:11], s35 offen offset:1024
  buffer_load_dwordx4 v[88:91], v7, s[8:11], s35 offen offset:2048
  buffer_load_dwordx4 v[92:95], v7, s[8:11], s35 offen offset:3072
  s_add_u32 s35, s35, 4096
  buffer_load_dwordx4 v[96:99], v7, s[8:11], s35 offen offset:0
  buffer_load_dwordx4 v[100:103], v7, s[8:11], s35 offen offset:1024
  buffer_load_dwordx4 v[104:107], v7, s[8:11], s35 offen offset:2048
  buffer_load_dwordx4 v[108:111], v7, s[8:11], s35 offen offset:3072
  s_add_u32 s35, s35, 4096
  buffer_load_dwordx4 v[112:115], v7, s[8:11], s35 offen offset:0
  buffer_load_dwordx4 v[48:51], v7, s[8:11], s35 offen offset:1024
  s_andn2_b32 s28, 0xfe0, s56
  s_lshl_b32 s28, s28, 7
  s_mov_b32 s29, 243793920
  v_mov_b32 v24, 262144
  s_mov_b32 s53, 0
  s_mov_b32 s33, 3
  v_mov_b32 v53, s58
  s_and_b32 s32, s48, 15
  s_cbranch_scc0 k_x_108
k_w_107:
  s_add_u32 s33, s33, 1
  s_and_b32 s33, s33, 3
  s_bitcmp1_b32 s32, s33
  s_cbranch_scc0 k_w_107
  s_lshl2_add_u32 s26, s33, s17
  s_lshl_b32 s26, s26, 14
  s_add_u32 s27, s26, 8192
  v_add_u32 v22, s26, v9
  v_cmp_le_u32 vcc, s28, v22
  s_nop 1
  v_cndmask_b32 v25, 0, v24, vcc
  v_add_u32 v22, v22, v25
  buffer_load_dword v20, v22, s[4:7], s29 offen sc1
  v_add_u32 v23, s27, v9
  v_cmp_le_u32 vcc, s28, v23
  s_nop 1
  v_cndmask_b32 v25, 0, v24, vcc
  v_add_u32 v23, v23, v25
  buffer_load_dword v21, v23, s[4:7], s29 offen sc1
  s_add_u32 s53, s53, 1
  s_cmp_gt_u32 s53, 1048576
  s_cbranch_scc1 q_fail_90
  s_waitcnt vmcnt(0)
  v_min_u32 v52, v20, v21
  v_max3_u32 v53, v20, v21, v53
  v_cmp_eq_u32 vcc, 0, v52
  s_cbranch_vccnz k_w_107
  s_bitset0_b32 s32, s33
  s_cmp_lg_u32 s32, 0
  s_cbranch_scc1 k_w_107
  v_max_u32_dpp v53, v53, v53 row_ror:8 row_mask:0xf bank_mask:0xf
  s_nop 1
  v_max_u32_dpp v53, v53, v53 row_ror:4 row_mask:0xf bank_mask:0xf
  s_nop 1
  v_max_u32_dpp v53, v53, v53 row_ror:2 row_mask:0xf bank_mask:0xf
  s_nop 1
  v_max_u32_dpp v53, v53, v53 row_ror:1 row_mask:0xf bank_mask:0xf
  v_mov_b32 v52, v53
  s_nop 0
  s_nop 0
  v_permlane16_swap_b32 v53, v52
  v_max_u32 v53, v53, v52
  v_mov_b32 v52, v53
  s_nop 0
  s_nop 0
  v_permlane32_swap_b32 v53, v52
  v_max_u32 v53, v53, v52
k_x_108:
  ds_write_b32 v118, v53 offset:256
  s_waitcnt vmcnt(0) lgkmcnt(0)
  s_barrier
  ds_read_b128 v[20:23], v119 offset:256
  s_waitcnt lgkmcnt(0)
  v_max3_u32 v20, v20, v21, v22
  v_max_u32 v20, v20, v23
  s_nop 0
  v_readfirstlane_b32 s26, v20
  s_cmp_eq_u32 s26, s58
  s_cbranch_scc1 q_fail_90
  s_cmp_eq_u32 s58, 0
  s_mov_b32 s58, s26
  s_cbranch_scc1 k_r_109
  s_cmp_lg_u32 s57, 0
  s_cbranch_scc1 k_r_109
  s_lshl_b32 s26, s59, 10
  buffer_store_dwordx4 a[0:3], v0, s[72:75], s26 offen sc1
k_r_109:
  s_andn2_b32 s26, 0xfe0, s56
  s_andn2_b32 s27, 0xfe0, s58
  s_cmp_lt_u32 s27, s26
  s_cselect_b32 s61, 1, 2
  s_andn2_b32 s59, 0xfff, s58
  s_lshl_b32 s26, s61, 21
  s_lshl_b32 s27, s59, 10
  s_add_u32 s26, s26, s27
  s_lshl_b32 s27, s17, 8
  s_add_u32 s26, s26, s27
  s_add_u32 s26, s26, 27262976
  v_lshrrev_b32 v5, 7, v0
  v_lshlrev_b32 v5, 5, v5
  buffer_load_dwordx4 v[52:55], v5, s[4:7], s26 offen offset:0 sc1
  buffer_load_dwordx4 v[56:59], v5, s[4:7], s26 offen offset:16 sc1
  s_mov_b32 vcc_lo, 0xaaaaaaaa
  s_mov_b32 vcc_hi, 0xaaaaaaaa
  v_mov_b32 v3, 0xffff
  v_mov_b32 v24, 0xffff0000
  v_cndmask_b32 v3, v3, v24, vcc
  s_mov_b32 vcc_lo, 0x3030303
  s_mov_b32 vcc_hi, 0x3030303
  v_cndmask_b32 v24, 0, v3, vcc
  s_mov_b32 vcc_lo, 0xc0c0c0c
  s_mov_b32 vcc_hi, 0xc0c0c0c
  v_cndmask_b32 v25, 0, v3, vcc
  s_mov_b32 vcc_lo, 0x30303030
  s_mov_b32 vcc_hi, 0x30303030
  v_cndmask_b32 v26, 0, v3, vcc
  s_mov_b32 vcc_lo, 0xc0c0c0c0
  s_mov_b32 vcc_hi, 0xc0c0c0c0
  v_cndmask_b32 v27, 0, v3, vcc
  s_mov_b32 s30, 0x01000100
  s_mov_b32 s31, 0x03020302
  s_mul_i32 s26, s17, 23552
  s_add_u32 s26, s26, 65536
  v_add_u32 v5, s26, v0
  v_add_u32 v2, s37, v0
  ds_read_b128 v[36:39], v5 offset:0
  ds_read_b128 v[40:43], v5 offset:1024
  ds_read_b128 v[44:47], v5 offset:2048
  ds_read_b128 v[12:15], v5 offset:3072
  ds_read_b128 v[16:19], v5 offset:4096
  ds_read_b128 v[120:123], v5 offset:5120
  ds_read_b128 v[124:127], v5 offset:6144
  s_waitcnt vmcnt(0)
  v_perm_b32 v3, v52, v52, s30
  v_and_b32 v20, v24, v3
  v_and_b32 v21, v25, v3
  v_and_b32 v22, v26, v3
  v_and_b32 v23, v27, v3
  s_waitcnt lgkmcnt(5)
  s_nop 0
  v_mfma_f32_16x16x32_bf16 v[28:31], v[20:23], v[36:39], 0
  ds_read_b128 v[36:39], v5 offset:7168
  v_mfma_f32_16x16x32_bf16 v[32:35], v[20:23], v[40:43], 0
  ds_read_b128 v[40:43], v5 offset:8192
  v_perm_b32 v3, v52, v52, s31
  v_and_b32 v20, v24, v3
  v_and_b32 v21, v25, v3
  v_and_b32 v22, v26, v3
  v_and_b32 v23, v27, v3
  s_waitcnt lgkmcnt(5)
  s_nop 0
  v_mfma_f32_16x16x32_bf16 v[28:31], v[20:23], v[44:47], v[28:31]
  ds_read_b128 v[44:47], v5 offset:9216
  v_mfma_f32_16x16x32_bf16 v[32:35], v[20:23], v[12:15], v[32:35]
  ds_read_b128 v[12:15], v5 offset:10240
  v_perm_b32 v3, v53, v53, s30
  v_and_b32 v20, v24, v3
  v_and_b32 v21, v25, v3
  v_and_b32 v22, v26, v3
  v_and_b32 v23, v27, v3
  s_waitcnt lgkmcnt(5)
  s_nop 0
  v_mfma_f32_16x16x32_bf16 v[28:31], v[20:23], v[16:19], v[28:31]
  ds_read_b128 v[16:19], v5 offset:11264
  v_mfma_f32_16x16x32_bf16 v[32:35], v[20:23], v[120:123], v[32:35]
  ds_read_b128 v[120:123], v5 offset:12288
  v_perm_b32 v3, v53, v53, s31
  v_and_b32 v20, v24, v3
  v_and_b32 v21, v25, v3
  v_and_b32 v22, v26, v3
  v_and_b32 v23, v27, v3
  s_waitcnt lgkmcnt(5)
  s_nop 0
  v_mfma_f32_16x16x32_bf16 v[28:31], v[20:23], v[124:127], v[28:31]
  ds_read_b128 v[124:127], v5 offset:13312
  v_mfma_f32_16x16x32_bf16 v[32:35], v[20:23], v[36:39], v[32:35]
  ds_read_b128 v[36:39], v5 offset:14336
  v_perm_b32 v3, v54, v54, s30
  v_and_b32 v20, v24, v3
  v_and_b32 v21, v25, v3
  v_and_b32 v22, v26, v3
  v_and_b32 v23, v27, v3
  s_waitcnt lgkmcnt(5)
  s_nop 0
  v_mfma_f32_16x16x32_bf16 v[28:31], v[20:23], v[40:43], v[28:31]
  ds_read_b128 v[40:43], v5 offset:15360
  v_mfma_f32_16x16x32_bf16 v[32:35], v[20:23], v[44:47], v[32:35]
  ds_read_b128 v[44:47], v5 offset:16384
  v_perm_b32 v3, v54, v54, s31
  v_and_b32 v20, v24, v3
  v_and_b32 v21, v25, v3
  v_and_b32 v22, v26, v3
  v_and_b32 v23, v27, v3
  s_waitcnt lgkmcnt(5)
  s_nop 0
  v_mfma_f32_16x16x32_bf16 v[28:31], v[20:23], v[12:15], v[28:31]
  ds_read_b128 v[12:15], v5 offset:17408
  v_mfma_f32_16x16x32_bf16 v[32:35], v[20:23], v[16:19], v[32:35]
  ds_read_b128 v[16:19], v5 offset:18432
  v_perm_b32 v3, v55, v55, s30
  v_and_b32 v20, v24, v3
  v_and_b32 v21, v25, v3
  v_and_b32 v22, v26, v3
  v_and_b32 v23, v27, v3
  s_waitcnt lgkmcnt(5)
  s_nop 0
  v_mfma_f32_16x16x32_bf16 v[28:31], v[20:23], v[120:123], v[28:31]
  ds_read_b128 v[120:123], v5 offset:19456
  v_mfma_f32_16x16x32_bf16 v[32:35], v[20:23], v[124:127], v[32:35]
  ds_read_b128 v[124:127], v5 offset:20480
  v_perm_b32 v3, v55, v55, s31
  v_and_b32 v20, v24, v3
  v_and_b32 v21, v25, v3
  v_and_b32 v22, v26, v3
  v_and_b32 v23, v27, v3
  s_waitcnt lgkmcnt(5)
  s_nop 0
  v_mfma_f32_16x16x32_bf16 v[28:31], v[20:23], v[36:39], v[28:31]
  ds_read_b128 v[36:39], v5 offset:21504
  v_mfma_f32_16x16x32_bf16 v[32:35], v[20:23], v[40:43], v[32:35]
  ds_read_b128 v[40:43], v5 offset:22528
  v_perm_b32 v3, v56, v56, s30
  v_and_b32 v20, v24, v3
  v_and_b32 v21, v25, v3
  v_and_b32 v22, v26, v3
  v_and_b32 v23, v27, v3
  s_waitcnt lgkmcnt(5)
  s_nop 0
  v_mfma_f32_16x16x32_bf16 v[28:31], v[20:23], v[44:47], v[28:31]
  ds_read_b128 v[44:47], v2 offset:0
  v_mfma_f32_16x16x32_bf16 v[32:35], v[20:23], v[12:15], v[32:35]
  ds_read_b128 v[12:15], v2 offset:1024
  v_perm_b32 v3, v56, v56, s31
  v_and_b32 v20, v24, v3
  v_and_b32 v21, v25, v3
  v_and_b32 v22, v26, v3
  v_and_b32 v23, v27, v3
  s_waitcnt lgkmcnt(5)
  s_nop 0
  v_mfma_f32_16x16x32_bf16 v[28:31], v[20:23], v[16:19], v[28:31]
  ds_read_b128 v[16:19], v2 offset:2048
  v_mfma_f32_16x16x32_bf16 v[32:35], v[20:23], v[120:123], v[32:35]
  ds_read_b128 v[120:123], v2 offset:3072
  v_perm_b32 v3, v57, v57, s30
  v_and_b32 v20, v24, v3
  v_and_b32 v21, v25, v3
  v_and_b32 v22, v26, v3
  v_and_b32 v23, v27, v3
  s_waitcnt lgkmcnt(5)
  s_nop 0
  v_mfma_f32_16x16x32_bf16 v[28:31], v[20:23], v[124:127], v[28:31]
  ds_read_b128 v[124:127], v2 offset:4096
  v_mfma_f32_16x16x32_bf16 v[32:35], v[20:23], v[36:39], v[32:35]
  ds_read_b128 v[36:39], v2 offset:5120
  v_perm_b32 v3, v57, v57, s31
  v_and_b32 v20, v24, v3
  v_and_b32 v21, v25, v3
  v_and_b32 v22, v26, v3
  v_and_b32 v23, v27, v3
  s_waitcnt lgkmcnt(5)
  s_nop 0
  v_mfma_f32_16x16x32_bf16 v[28:31], v[20:23], v[40:43], v[28:31]
  ds_read_b128 v[40:43], v2 offset:6144
  v_mfma_f32_16x16x32_bf16 v[32:35], v[20:23], v[44:47], v[32:35]
  ds_read_b128 v[44:47], v2 offset:7168
  v_perm_b32 v3, v58, v58, s30
  v_and_b32 v20, v24, v3
  v_and_b32 v21, v25, v3
  v_and_b32 v22, v26, v3
  v_and_b32 v23, v27, v3
  s_waitcnt lgkmcnt(5)
  s_nop 0
  v_mfma_f32_16x16x32_bf16 v[28:31], v[20:23], v[12:15], v[28:31]
  v_mfma_f32_16x16x32_bf16 v[32:35], v[20:23], v[16:19], v[32:35]
  v_perm_b32 v3, v58, v58, s31
  v_and_b32 v20, v24, v3
  v_and_b32 v21, v25, v3
  v_and_b32 v22, v26, v3
  v_and_b32 v23, v27, v3
  s_waitcnt lgkmcnt(3)
  s_nop 0
  v_mfma_f32_16x16x32_bf16 v[28:31], v[20:23], v[120:123], v[28:31]
  v_mfma_f32_16x16x32_bf16 v[32:35], v[20:23], v[124:127], v[32:35]
  v_perm_b32 v3, v59, v59, s30
  v_and_b32 v20, v24, v3
  v_and_b32 v21, v25, v3
  v_and_b32 v22, v26, v3
  v_and_b32 v23, v27, v3
  s_waitcnt lgkmcnt(1)
  s_nop 0
  v_mfma_f32_16x16x32_bf16 v[28:31], v[20:23], v[36:39], v[28:31]
  v_mfma_f32_16x16x32_bf16 v[32:35], v[20:23], v[40:43], v[32:35]
  v_perm_b32 v3, v59, v59, s31
  v_and_b32 v20, v24, v3
  v_and_b32 v21, v25, v3
  v_and_b32 v22, v26, v3
  v_and_b32 v23, v27, v3
  s_waitcnt lgkmcnt(0)
  s_nop 0
  v_mfma_f32_16x16x32_bf16 v[28:31], v[20:23], v[44:47], v[28:31]
  v_mfma_f32_16x16x32_bf16 v[32:35], v[20:23], v[60:63], v[32:35]
  v_lshrrev_b32 v2, 8, v0
  v_and_b32 v3, 0xf0, v0
  v_lshlrev_b32 v3, 1, v3
  v_and_b32 v5, 1, v2
  v_lshl_add_u32 v5, v5, 4, v3
  v_add_u32 v5, s37, v5
  s_mov_b32 exec_lo, 0x00ff00ff
  s_mov_b32 exec_hi, 0xff00ff00
  ds_write_b128 v5, v[28:31]
  ds_write_b128 v5, v[32:35] offset:512
  s_mov_b64 exec, -1
  s_xor_b32 s26, s50, 32768
  v_add_u32 v5, s26, v1
  v_lshl_add_u32 v3, v2, 4, v3
  s_waitcnt lgkmcnt(0)
  s_barrier
  ds_read2st64_b32 v[36:37], v5 offset0:0 offset1:1
  ds_read2st64_b32 v[52:53], v5 offset0:2 offset1:3
  ds_read2st64_b32 v[38:39], v5 offset0:32 offset1:33
  ds_read2st64_b32 v[54:55], v5 offset0:34 offset1:35
  ds_read2st64_b32 v[40:41], v5 offset0:64 offset1:65
  ds_read2st64_b32 v[56:57], v5 offset0:66 offset1:67
  ds_read2st64_b32 v[42:43], v5 offset0:96 offset1:97
  ds_read2st64_b32 v[58:59], v5 offset0:98 offset1:99
  s_waitcnt lgkmcnt(0)
  v_add_f32 v36, v36, v40
  v_add_f32 v37, v37, v41
  v_add_f32 v38, v38, v42
  v_add_f32 v39, v39, v43
  v_add_f32 v52, v52, v56
  v_add_f32 v53, v53, v57
  v_add_f32 v54, v54, v58
  v_add_f32 v55, v55, v59
  v_add_f32 v36, v36, v38
  v_add_f32 v37, v37, v39
  v_add_f32 v52, v52, v54
  v_add_f32 v53, v53, v55
  v_add_f32 v36, v36, v37
  v_add_f32 v52, v52, v53
  v_cvt_pk_bf16_f32 v36, 0, v36
  v_cvt_pk_bf16_f32 v52, 0, v52
  v_mul_f32 v40, 0xbfb8aa3b, v36
  v_exp_f32 v40, v40
  s_nop 0
  v_add_f32 v40, 1.0, v40
  v_rcp_f32 v40, v40
  s_nop 0
  v_mul_f32 v36, v36, v40
  v_cvt_pk_bf16_f32 v36, 0, v36
  v_mul_f32 v36, v36, v52
  v_cvt_pk_bf16_f32 v36, v36, v36
  s_lshl_b32 s26, s17, 8
  s_add_u32 s26, s26, 161792
  v_add_u32 v5, s26, v1
  ds_write_b32 v5, v36
  v_mul_u32_u24 v5, 56, v2
  v_add_u32 v5, s26, v5
  ds_read_b64 v[36:37], v5 offset:0
  ds_read_b64 v[38:39], v5 offset:8
  ds_read_b64 v[40:41], v5 offset:16
  ds_read_b64 v[42:43], v5 offset:24
  ds_read_b64 v[44:45], v5 offset:32
  ds_read_b64 v[46:47], v5 offset:40
  ds_read_b64 v[52:53], v5 offset:48
  s_waitcnt lgkmcnt(0)
  v_and_b32 v20, v24, v36
  v_and_b32 v21, v25, v36
  v_and_b32 v22, v26, v36
  v_and_b32 v23, v27, v36
  s_nop 0
  s_nop 0
  v_mfma_f32_16x16x32_bf16 v[28:31], v[20:23], v[64:67], 0
  v_and_b32 v32, v24, v37
  v_and_b32 v33, v25, v37
  v_and_b32 v34, v26, v37
  v_and_b32 v35, v27, v37
  s_nop 0
  s_nop 0
  v_mfma_f32_16x16x32_bf16 v[28:31], v[32:35], v[68:71], v[28:31]
  v_and_b32 v20, v24, v38
  v_and_b32 v21, v25, v38
  v_and_b32 v22, v26, v38
  v_and_b32 v23, v27, v38
  s_nop 0
  s_nop 0
  v_mfma_f32_16x16x32_bf16 v[28:31], v[20:23], v[72:75], v[28:31]
  v_and_b32 v32, v24, v39
  v_and_b32 v33, v25, v39
  v_and_b32 v34, v26, v39
  v_and_b32 v35, v27, v39
  s_nop 0
  s_nop 0
  v_mfma_f32_16x16x32_bf16 v[28:31], v[32:35], v[76:79], v[28:31]
  v_and_b32 v20, v24, v40
  v_and_b32 v21, v25, v40
  v_and_b32 v22, v26, v40
  v_and_b32 v23, v27, v40
  s_nop 0
  s_nop 0
  v_mfma_f32_16x16x32_bf16 v[28:31], v[20:23], v[80:83], v[28:31]
  v_and_b32 v32, v24, v41
  v_and_b32 v33, v25, v41
  v_and_b32 v34, v26, v41
  v_and_b32 v35, v27, v41
  s_nop 0
  s_nop 0
  v_mfma_f32_16x16x32_bf16 v[28:31], v[32:35], v[84:87], v[28:31]
  v_and_b32 v20, v24, v42
  v_and_b32 v21, v25, v42
  v_and_b32 v22, v26, v42
  v_and_b32 v23, v27, v42
  s_nop 0
  s_nop 0
  v_mfma_f32_16x16x32_bf16 v[28:31], v[20:23], v[88:91], v[28:31]
  v_and_b32 v32, v24, v43
  v_and_b32 v33, v25, v43
  v_and_b32 v34, v26, v43
  v_and_b32 v35, v27, v43
  s_nop 0
  s_nop 0
  v_mfma_f32_16x16x32_bf16 v[28:31], v[32:35], v[92:95], v[28:31]
  v_and_b32 v20, v24, v44
  v_and_b32 v21, v25, v44
  v_and_b32 v22, v26, v44
  v_and_b32 v23, v27, v44
  s_nop 0
  s_nop 0
  v_mfma_f32_16x16x32_bf16 v[28:31], v[20:23], v[96:99], v[28:31]
  v_and_b32 v32, v24, v45
  v_and_b32 v33, v25, v45
  v_and_b32 v34, v26, v45
  v_and_b32 v35, v27, v45
  s_nop 0
  s_nop 0
  v_mfma_f32_16x16x32_bf16 v[28:31], v[32:35], v[100:103], v[28:31]
  v_and_b32 v20, v24, v46
  v_and_b32 v21, v25, v46
  v_and_b32 v22, v26, v46
  v_and_b32 v23, v27, v46
  s_nop 0
  s_nop 0
  v_mfma_f32_16x16x32_bf16 v[28:31], v[20:23], v[104:107], v[28:31]
  v_and_b32 v32, v24, v47
  v_and_b32 v33, v25, v47
  v_and_b32 v34, v26, v47
  v_and_b32 v35, v27, v47
  s_nop 0
  s_nop 0
  v_mfma_f32_16x16x32_bf16 v[28:31], v[32:35], v[108:111], v[28:31]
  v_and_b32 v20, v24, v52
  v_and_b32 v21, v25, v52
  v_and_b32 v22, v26, v52
  v_and_b32 v23, v27, v52
  s_nop 0
  s_nop 0
  v_mfma_f32_16x16x32_bf16 v[28:31], v[20:23], v[112:115], v[28:31]
  v_and_b32 v32, v24, v53
  v_and_b32 v33, v25, v53
  v_and_b32 v34, v26, v53
  v_and_b32 v35, v27, v53
  s_nop 0
  s_nop 0
  v_mfma_f32_16x16x32_bf16 v[28:31], v[32:35], v[48:51], v[28:31]
  v_lshrrev_b32 v3, 1, v3
  s_lshl_b32 s26, s47, 7
  s_add_u32 s26, s26, s57
  s_lshl_b32 s26, s26, 8
  s_add_u32 s26, s26, 244318208
  s_nop 2
  v_cvt_pk_bf16_f32 v28, v28, v29
  v_cvt_pk_bf16_f32 v29, v30, v31
  v_min_u32 v28, -2, v28
  v_min_u32 v29, -2, v29
  s_mov_b32 exec_hi, 0
  buffer_store_dwordx2 v[28:29], v3, s[4:7], s26 offen sc1
  s_mov_b32 exec_hi, -1
  s_cmp_lg_u32 s16, 0
  s_cbranch_scc1 k_nx_106
  s_barrier
  s_lshl_b32 s26, s61, 21
  s_lshl_b32 s27, s59, 10
  s_add_u32 s26, s26, s27
  s_add_u32 s27, s26, 20971520
  s_add_u32 s28, s26, 27262976
  s_lshl_b32 s26, s47, 7
  s_add_u32 s26, s26, s17
  s_lshl_b32 s26, s26, 8
  s_add_u32 s26, s26, 244318208
  v_lshrrev_b32 v2, 8, v0
  v_and_b32 v3, 0xf0, v0
  v_lshl_add_u32 v5, v2, 10, v3
  buffer_load_dwordx4 v[108:111], v0, s[4:7], s27 offen sc1
  buffer_load_dwordx4 v[112:115], v0, s[4:7], s28 offen sc1
  s_mov_b32 s53, 0
m_w_111:
  s_add_u32 s27, s26, 0
  buffer_load_dwordx4 v[20:23], v5, s[4:7], s27 offen sc1
  s_add_u32 s27, s26, 4096
  buffer_load_dwordx4 v[24:27], v5, s[4:7], s27 offen sc1
  s_add_u32 s27, s26, 8192
  buffer_load_dwordx4 v[28:31], v5, s[4:7], s27 offen sc1
  s_add_u32 s27, s26, 12288
  buffer_load_dwordx4 v[32:35], v5, s[4:7], s27 offen sc1
  s_add_u32 s27, s26, 16384
  buffer_load_dwordx4 v[36:39], v5, s[4:7], s27 offen sc1
  s_add_u32 s27, s26, 20480
  buffer_load_dwordx4 v[40:43], v5, s[4:7], s27 offen sc1
  s_add_u32 s27, s26, 24576
  buffer_load_dwordx4 v[44:47], v5, s[4:7], s27 offen sc1
  s_add_u32 s27, s26, 28672
  buffer_load_dwordx4 v[48:51], v5, s[4:7], s27 offen sc1
  s_add_u32 s53, s53, 1
  s_cmp_gt_u32 s53, 1048576
  s_cbranch_scc1 q_fail_90
  s_mov_b32 vcc_lo, 0xaaaaaaaa
  s_mov_b32 vcc_hi, 0xaaaaaaaa
  v_mov_b32 v72, 0x3f80
  v_mov_b32 v68, 1.0
  v_cndmask_b32 v72, v72, v68, vcc
  s_mov_b32 vcc_lo, 0x30003
  s_mov_b32 vcc_hi, 0x30003
  v_cndmask_b32 v68, 0, v72, vcc
  s_mov_b32 vcc_lo, 0xc000c
  s_mov_b32 vcc_hi, 0xc000c
  v_cndmask_b32 v69, 0, v72, vcc
  s_mov_b32 vcc_lo, 0x300030
  s_mov_b32 vcc_hi, 0x300030
  v_cndmask_b32 v70, 0, v72, vcc
  s_mov_b32 vcc_lo, 0xc000c0
  s_mov_b32 vcc_hi, 0xc000c0
  v_cndmask_b32 v71, 0, v72, vcc
  s_waitcnt vmcnt(7)
  s_nop 0
  v_mfma_f32_16x16x32_bf16 v[72:75], v[68:71], v[20:23], 0
  v_max3_u32 v80, v20, v21, 0
  v_max3_u32 v80, v22, v23, v80
  s_waitcnt vmcnt(6)
  v_mfma_f32_16x16x32_bf16 v[72:75], v[68:71], v[24:27], v[72:75]
  v_max3_u32 v80, v24, v25, v80
  v_max3_u32 v80, v26, v27, v80
  s_waitcnt vmcnt(5)
  v_mfma_f32_16x16x32_bf16 v[72:75], v[68:71], v[28:31], v[72:75]
  v_max3_u32 v80, v28, v29, v80
  v_max3_u32 v80, v30, v31, v80
  s_waitcnt vmcnt(4)
  v_mfma_f32_16x16x32_bf16 v[72:75], v[68:71], v[32:35], v[72:75]
  v_max3_u32 v80, v32, v33, v80
  v_max3_u32 v80, v34, v35, v80
  s_waitcnt vmcnt(3)
  v_mfma_f32_16x16x32_bf16 v[72:75], v[68:71], v[36:39], v[72:75]
  v_max3_u32 v80, v36, v37, v80
  v_max3_u32 v80, v38, v39, v80
  s_waitcnt vmcnt(2)
  v_mfma_f32_16x16x32_bf16 v[72:75], v[68:71], v[40:43], v[72:75]
  v_max3_u32 v80, v40, v41, v80
  v_max3_u32 v80, v42, v43, v80
  s_waitcnt vmcnt(1)
  v_mfma_f32_16x16x32_bf16 v[72:75], v[68:71], v[44:47], v[72:75]
  v_max3_u32 v80, v44, v45, v80
  v_max3_u32 v80, v46, v47, v80
  s_waitcnt vmcnt(0)
  v_mfma_f32_16x16x32_bf16 v[72:75], v[68:71], v[48:51], v[72:75]
  v_max3_u32 v80, v48, v49, v80
  v_max3_u32 v80, v50, v51, v80
  v_cmp_eq_u32 vcc, -1, v80
  s_cbranch_vccnz m_w_111
  v_lshlrev_b32 v3, 1, v3
  v_lshl_add_u32 v3, v2, 4, v3
  s_lshl_b32 s26, s17, 9
  s_add_u32 s26, s26, 159744
  v_add_u32 v3, s26, v3
  s_mov_b32 exec_hi, 0
  ds_write_b128 v3, v[72:75]
  s_mov_b32 exec_hi, -1
  v_lshlrev_b32 v3, 1, v0
  v_add_u32 v3, 159744, v3
  v_lshlrev_b32 v80, 16, v108
  v_and_b32 v81, 0xffff0000, v108
  v_lshlrev_b32 v82, 16, v109
  v_and_b32 v83, 0xffff0000, v109
  v_lshlrev_b32 v84, 16, v110
  v_and_b32 v85, 0xffff0000, v110
  v_lshlrev_b32 v86, 16, v111
  v_and_b32 v87, 0xffff0000, v111
  v_lshlrev_b32 v88, 16, v112
  v_and_b32 v89, 0xffff0000, v112
  v_lshlrev_b32 v90, 16, v113
  v_and_b32 v91, 0xffff0000, v113
  v_lshlrev_b32 v92, 16, v114
  v_and_b32 v93, 0xffff0000, v114
  v_lshlrev_b32 v94, 16, v115
  v_and_b32 v95, 0xffff0000, v115
  s_waitcnt lgkmcnt(0)
  s_barrier
  s_cmp_lg_u32 s17, 0
  s_cbranch_scc1 m_done_110
  ds_read_b128 v[72:75], v3
  ds_read_b128 v[76:79], v3 offset:16
  s_and_b32 s29, s58, 0xffff0000
  s_xor_b32 s27, s29, 0x80000000
  s_xor_b32 s28, s29, 0xffff0000
  s_bitcmp1_b32 s29, 31
  s_cselect_b32 s29, s27, s28
  v_mov_b32 v108, s29
  v_mul_f32 v108, 0xbfb8aa3b, v108
  v_exp_f32 v108, v108
  s_nop 0
  v_add_f32 v108, 1.0, v108
  v_rcp_f32 v108, v108
  s_nop 0
  v_cvt_pk_bf16_f32 v108, 0, v108
  v_add_f32 v20, v80, v88
  v_add_f32 v21, v81, v89
  v_add_f32 v22, v82, v90
  v_add_f32 v23, v83, v91
  v_add_f32 v24, v84, v92
  v_add_f32 v25, v85, v93
  v_add_f32 v26, v86, v94
  v_add_f32 v27, v87, v95
  v_cvt_pk_bf16_f32 v28, v20, v21
  v_cvt_pk_bf16_f32 v29, v22, v23
  v_cvt_pk_bf16_f32 v30, v24, v25
  v_cvt_pk_bf16_f32 v31, v26, v27
  v_accvgpr_write_b32 a0, v28
  v_accvgpr_write_b32 a1, v29
  v_accvgpr_write_b32 a2, v30
  v_accvgpr_write_b32 a3, v31
  s_waitcnt lgkmcnt(0)
  v_cvt_pk_bf16_f32 v72, 0, v72
  v_cvt_pk_bf16_f32 v73, 0, v73
  v_cvt_pk_bf16_f32 v74, 0, v74
  v_cvt_pk_bf16_f32 v75, 0, v75
  v_cvt_pk_bf16_f32 v76, 0, v76
  v_cvt_pk_bf16_f32 v77, 0, v77
  v_cvt_pk_bf16_f32 v78, 0, v78
  v_cvt_pk_bf16_f32 v79, 0, v79
  v_mul_f32 v72, v72, v108
  v_mul_f32 v73, v73, v108
  v_mul_f32 v74, v74, v108
  v_mul_f32 v75, v75, v108
  v_mul_f32 v76, v76, v108
  v_mul_f32 v77, v77, v108
  v_mul_f32 v78, v78, v108
  v_mul_f32 v79, v79, v108
  v_cvt_pk_bf16_f32 v72, 0, v72
  v_cvt_pk_bf16_f32 v73, 0, v73
  v_cvt_pk_bf16_f32 v74, 0, v74
  v_cvt_pk_bf16_f32 v75, 0, v75
  v_cvt_pk_bf16_f32 v76, 0, v76
  v_cvt_pk_bf16_f32 v77, 0, v77
  v_cvt_pk_bf16_f32 v78, 0, v78
  v_cvt_pk_bf16_f32 v79, 0, v79
  v_add_f32 v72, v72, v88
  v_add_f32 v73, v73, v89
  v_add_f32 v74, v74, v90
  v_add_f32 v75, v75, v91
  v_add_f32 v76, v76, v92
  v_add_f32 v77, v77, v93
  v_add_f32 v78, v78, v94
  v_add_f32 v79, v79, v95
  v_cvt_pk_bf16_f32 v72, 0, v72
  v_cvt_pk_bf16_f32 v73, 0, v73
  v_cvt_pk_bf16_f32 v74, 0, v74
  v_cvt_pk_bf16_f32 v75, 0, v75
  v_cvt_pk_bf16_f32 v76, 0, v76
  v_cvt_pk_bf16_f32 v77, 0, v77
  v_cvt_pk_bf16_f32 v78, 0, v78
  v_cvt_pk_bf16_f32 v79, 0, v79
  v_add_f32 v80, v80, v72
  v_add_f32 v81, v81, v73
  v_add_f32 v82, v82, v74
  v_add_f32 v83, v83, v75
  v_add_f32 v84, v84, v76
  v_add_f32 v85, v85, v77
  v_add_f32 v86, v86, v78
  v_add_f32 v87, v87, v79
  v_cvt_pk_bf16_f32 v112, v80, v81
  v_cvt_pk_bf16_f32 v113, v82, v83
  v_cvt_pk_bf16_f32 v114, v84, v85
  v_cvt_pk_bf16_f32 v115, v86, v87
  v_lshlrev_b32 v80, 16, v112
  v_and_b32 v81, 0xffff0000, v112
  v_lshlrev_b32 v82, 16, v113
  v_and_b32 v83, 0xffff0000, v113
  v_lshlrev_b32 v84, 16, v114
  v_and_b32 v85, 0xffff0000, v114
  v_lshlrev_b32 v86, 16, v115
  v_and_b32 v87, 0xffff0000, v115
  s_lshl_b32 s26, s59, 10
  buffer_store_dwordx4 v[112:115], v0, s[72:75], s26 offen sc1
m_done_110:
k_nx_106:
  s_add_u32 s47, s47, 3
  s_xor_b32 s48, s48, 31
  s_andn2_b32 s28, 0xfe0, s56
  s_lshl_b32 s28, s28, 7
  s_mov_b32 s29, 243793920
  v_mov_b32 v24, 262144
  s_mov_b32 s53, 0
  s_mov_b32 s33, 3
  v_mov_b32 v53, s58
  s_and_b32 s32, s48, 15
  s_cbranch_scc0 k_x_113
k_w_112:
  s_add_u32 s33, s33, 1
  s_and_b32 s33, s33, 3
  s_bitcmp1_b32 s32, s33
  s_cbranch_scc0 k_w_112
  s_lshl2_add_u32 s26, s33, s17
  s_lshl_b32 s26, s26, 14
  s_add_u32 s27, s26, 8192
  v_add_u32 v22, s26, v9
  v_cmp_le_u32 vcc, s28, v22
  s_nop 1
  v_cndmask_b32 v25, 0, v24, vcc
  v_add_u32 v22, v22, v25
  buffer_load_dword v20, v22, s[4:7], s29 offen sc1
  v_add_u32 v23, s27, v9
  v_cmp_le_u32 vcc, s28, v23
  s_nop 1
  v_cndmask_b32 v25, 0, v24, vcc
  v_add_u32 v23, v23, v25
  buffer_load_dword v21, v23, s[4:7], s29 offen sc1
  s_add_u32 s53, s53, 1
  s_cmp_gt_u32 s53, 1048576
  s_cbranch_scc1 q_fail_90
  s_waitcnt vmcnt(0)
  v_min_u32 v52, v20, v21
  v_max3_u32 v53, v20, v21, v53
  v_cmp_eq_u32 vcc, 0, v52
  s_cbranch_vccnz k_w_112
  s_bitset0_b32 s32, s33
  s_cmp_lg_u32 s32, 0
  s_cbranch_scc1 k_w_112
  v_max_u32_dpp v53, v53, v53 row_ror:8 row_mask:0xf bank_mask:0xf
  s_nop 1
  v_max_u32_dpp v53, v53, v53 row_ror:4 row_mask:0xf bank_mask:0xf
  s_nop 1
  v_max_u32_dpp v53, v53, v53 row_ror:2 row_mask:0xf bank_mask:0xf
  s_nop 1
  v_max_u32_dpp v53, v53, v53 row_ror:1 row_mask:0xf bank_mask:0xf
  v_mov_b32 v52, v53
  s_nop 0
  s_nop 0
  v_permlane16_swap_b32 v53, v52
  v_max_u32 v53, v53, v52
  v_mov_b32 v52, v53
  s_nop 0
  s_nop 0
  v_permlane32_swap_b32 v53, v52
  v_max_u32 v53, v53, v52
k_x_113:
  ds_write_b32 v118, v53 offset:256
  s_waitcnt vmcnt(0) lgkmcnt(0)
  s_barrier
  ds_read_b128 v[20:23], v119 offset:256
  s_waitcnt lgkmcnt(0)
  v_max3_u32 v20, v20, v21, v22
  v_max_u32 v20, v20, v23
  s_nop 0
  v_readfirstlane_b32 s26, v20
  s_cmp_eq_u32 s26, s58
  s_cbranch_scc1 q_fail_90
  s_cmp_eq_u32 s58, 0
  s_mov_b32 s58, s26
  s_cbranch_scc1 k_r_114
  s_cmp_lg_u32 s57, 0
  s_cbranch_scc1 k_r_114
  s_lshl_b32 s26, s59, 10
  buffer_store_dwordx4 a[0:3], v0, s[72:75], s26 offen sc1
k_r_114:
  s_andn2_b32 s26, 0xfe0, s56
  s_andn2_b32 s27, 0xfe0, s58
  s_cmp_lt_u32 s27, s26
  s_cselect_b32 s61, 1, 2
  s_andn2_b32 s59, 0xfff, s58
  s_lshl_b32 s26, s61, 21
  s_lshl_b32 s27, s59, 10
  s_add_u32 s26, s26, s27
  s_lshl_b32 s27, s17, 8
  s_add_u32 s26, s26, s27
  s_add_u32 s26, s26, 27262976
  v_lshrrev_b32 v5, 7, v0
  v_lshlrev_b32 v5, 5, v5
  buffer_load_dwordx4 v[52:55], v5, s[4:7], s26 offen offset:0 sc1
  buffer_load_dwordx4 v[56:59], v5, s[4:7], s26 offen offset:16 sc1
  s_load_dwordx2 s[64:65], s[0:1], 72
  s_load_dwordx2 s[68:69], s[0:1], 80
  s_load_dwordx2 s[8:9], s[0:1], 88
  s_mov_b32 s66, 1835008
  s_mov_b32 s70, 1835008
  s_mov_b32 s10, 1835008
  v_lshrrev_b32 v2, 7, v0
  v_and_b32 v3, 0x70, v0
  v_mul_u32_u24 v6, 57344, v2
  v_add_u32 v6, v6, v3
  v_cmp_eq_u32 vcc, 0x70, v3
  v_mov_b32 v3, 0x7ff00000
  s_nop 0
  v_cndmask_b32 v6, v6, v3, vcc
  v_lshrrev_b32 v2, 8, v0
  v_mul_u32_u24 v7, 14336, v2
  v_and_b32 v3, 0xf0, v0
  v_add_u32 v7, v7, v3
  s_mul_i32 s34, s17, 458752
  s_mul_i32 s27, s16, 112
  s_add_u32 s34, s34, s27
  s_mul_i32 s35, s16, 57344
  s_lshl_b32 s27, s17, 8
  s_add_u32 s35, s35, s27
  s_waitcnt lgkmcnt(0)
  s_xor_b32 s37, s50, 32768
  s_add_u32 s37, s37, s54
  s_mov_b32 m0, s37
  s_add_u32 s36, s34, 39424
  buffer_load_dwordx4 v6, s[68:71], s36 offen lds
  s_add_u32 m0, m0, 1024
  s_add_u32 s36, s34, 43008
  buffer_load_dwordx4 v6, s[64:67], s36 offen lds
  s_add_u32 m0, m0, 1024
  s_add_u32 s36, s34, 43008
  buffer_load_dwordx4 v6, s[68:71], s36 offen lds
  s_add_u32 m0, m0, 1024
  s_add_u32 s36, s34, 46592
  buffer_load_dwordx4 v6, s[64:67], s36 offen lds
  s_add_u32 m0, m0, 1024
  s_add_u32 s36, s34, 46592
  buffer_load_dwordx4 v6, s[68:71], s36 offen lds
  s_add_u32 m0, m0, 1024
  s_add_u32 s36, s34, 50176
  buffer_load_dwordx4 v6, s[64:67], s36 offen lds
  s_add_u32 m0, m0, 1024
  s_add_u32 s36, s34, 50176
  buffer_load_dwordx4 v6, s[68:71], s36 offen lds
  s_add_u32 m0, m0, 1024
  s_add_u32 s36, s34, 53760
  buffer_load_dwordx4 v6, s[64:67], s36 offen lds
  s_add_u32 m0, m0, 1024
  s_add_u32 s36, s34, 53760
  buffer_load_dwordx4 v[60:63], v6, s[68:71], s36 offen
  buffer_load_dwordx4 v[64:67], v7, s[8:11], s35 offen offset:0
  buffer_load_dwordx4 v[68:71], v7, s[8:11], s35 offen offset:1024
  buffer_load_dwordx4 v[72:75], v7, s[8:11], s35 offen offset:2048
  buffer_load_dwordx4 v[76:79], v7, s[8:11], s35 offen offset:3072
  s_add_u32 s35, s35, 4096
  buffer_load_dwordx4 v[80:83], v7, s[8:11], s35 offen offset:0
  buffer_load_dwordx4 v[84:87], v7, s[8:11], s35 offen offset:1024
  buffer_load_dwordx4 v[88:91], v7, s[8:11], s35 offen offset:2048
  buffer_load_dwordx4 v[92:95], v7, s[8:11], s35 offen offset:3072
  s_add_u32 s35, s35, 4096
  buffer_load_dwordx4 v[96:99], v7, s[8:11], s35 offen offset:0
  buffer_load_dwordx4 v[100:103], v7, s[8:11], s35 offen offset:1024
  buffer_load_dwordx4 v[104:107], v7, s[8:11], s35 offen offset:2048
  buffer_load_dwordx4 v[108:111], v7, s[8:11], s35 offen offset:3072
  s_add_u32 s35, s35, 4096
  buffer_load_dwordx4 v[112:115], v7, s[8:11], s35 offen offset:0
  buffer_load_dwordx4 v[48:51], v7, s[8:11], s35 offen offset:1024
  s_mov_b32 vcc_lo, 0xaaaaaaaa
  s_mov_b32 vcc_hi, 0xaaaaaaaa
  v_mov_b32 v3, 0xffff
  v_mov_b32 v24, 0xffff0000
  v_cndmask_b32 v3, v3, v24, vcc
  s_mov_b32 vcc_lo, 0x3030303
  s_mov_b32 vcc_hi, 0x3030303
  v_cndmask_b32 v24, 0, v3, vcc
  s_mov_b32 vcc_lo, 0xc0c0c0c
  s_mov_b32 vcc_hi, 0xc0c0c0c
  v_cndmask_b32 v25, 0, v3, vcc
  s_mov_b32 vcc_lo, 0x30303030
  s_mov_b32 vcc_hi, 0x30303030
  v_cndmask_b32 v26, 0, v3, vcc
  s_mov_b32 vcc_lo, 0xc0c0c0c0
  s_mov_b32 vcc_hi, 0xc0c0c0c0
  v_cndmask_b32 v27, 0, v3, vcc
  s_mov_b32 s30, 0x01000100
  s_mov_b32 s31, 0x03020302
  s_mul_i32 s26, s17, 23552
  s_add_u32 s26, s26, 65536
  v_add_u32 v5, s26, v0
  v_add_u32 v2, s37, v0
  ds_read_b128 v[36:39], v5 offset:0
  ds_read_b128 v[40:43], v5 offset:1024
  ds_read_b128 v[44:47], v5 offset:2048
  ds_read_b128 v[12:15], v5 offset:3072
  ds_read_b128 v[16:19], v5 offset:4096
  ds_read_b128 v[120:123], v5 offset:5120
  ds_read_b128 v[124:127], v5 offset:6144
  s_waitcnt vmcnt(23)
  v_perm_b32 v3, v52, v52, s30
  v_and_b32 v20, v24, v3
  v_and_b32 v21, v25, v3
  v_and_b32 v22, v26, v3
  v_and_b32 v23, v27, v3
  s_waitcnt lgkmcnt(5)
  s_nop 0
  v_mfma_f32_16x16x32_bf16 v[28:31], v[20:23], v[36:39], 0
  ds_read_b128 v[36:39], v5 offset:7168
  v_mfma_f32_16x16x32_bf16 v[32:35], v[20:23], v[40:43], 0
  ds_read_b128 v[40:43], v5 offset:8192
  v_perm_b32 v3, v52, v52, s31
  v_and_b32 v20, v24, v3
  v_and_b32 v21, v25, v3
  v_and_b32 v22, v26, v3
  v_and_b32 v23, v27, v3
  s_waitcnt lgkmcnt(5)
  s_nop 0
  v_mfma_f32_16x16x32_bf16 v[28:31], v[20:23], v[44:47], v[28:31]
  ds_read_b128 v[44:47], v5 offset:9216
  v_mfma_f32_16x16x32_bf16 v[32:35], v[20:23], v[12:15], v[32:35]
  ds_read_b128 v[12:15], v5 offset:10240
  v_perm_b32 v3, v53, v53, s30
  v_and_b32 v20, v24, v3
  v_and_b32 v21, v25, v3
  v_and_b32 v22, v26, v3
  v_and_b32 v23, v27, v3
  s_waitcnt lgkmcnt(5)
  s_nop 0
  v_mfma_f32_16x16x32_bf16 v[28:31], v[20:23], v[16:19], v[28:31]
  ds_read_b128 v[16:19], v5 offset:11264
  v_mfma_f32_16x16x32_bf16 v[32:35], v[20:23], v[120:123], v[32:35]
  ds_read_b128 v[120:123], v5 offset:12288
  v_perm_b32 v3, v53, v53, s31
  v_and_b32 v20, v24, v3
  v_and_b32 v21, v25, v3
  v_and_b32 v22, v26, v3
  v_and_b32 v23, v27, v3
  s_waitcnt lgkmcnt(5)
  s_nop 0
  v_mfma_f32_16x16x32_bf16 v[28:31], v[20:23], v[124:127], v[28:31]
  ds_read_b128 v[124:127], v5 offset:13312
  v_mfma_f32_16x16x32_bf16 v[32:35], v[20:23], v[36:39], v[32:35]
  ds_read_b128 v[36:39], v5 offset:14336
  v_perm_b32 v3, v54, v54, s30
  v_and_b32 v20, v24, v3
  v_and_b32 v21, v25, v3
  v_and_b32 v22, v26, v3
  v_and_b32 v23, v27, v3
  s_waitcnt lgkmcnt(5)
  s_nop 0
  v_mfma_f32_16x16x32_bf16 v[28:31], v[20:23], v[40:43], v[28:31]
  ds_read_b128 v[40:43], v5 offset:15360
  v_mfma_f32_16x16x32_bf16 v[32:35], v[20:23], v[44:47], v[32:35]
  ds_read_b128 v[44:47], v5 offset:16384
  v_perm_b32 v3, v54, v54, s31
  v_and_b32 v20, v24, v3
  v_and_b32 v21, v25, v3
  v_and_b32 v22, v26, v3
  v_and_b32 v23, v27, v3
  s_waitcnt lgkmcnt(5)
  s_nop 0
  v_mfma_f32_16x16x32_bf16 v[28:31], v[20:23], v[12:15], v[28:31]
  ds_read_b128 v[12:15], v5 offset:17408
  v_mfma_f32_16x16x32_bf16 v[32:35], v[20:23], v[16:19], v[32:35]
  ds_read_b128 v[16:19], v5 offset:18432
  v_perm_b32 v3, v55, v55, s30
  v_and_b32 v20, v24, v3
  v_and_b32 v21, v25, v3
  v_and_b32 v22, v26, v3
  v_and_b32 v23, v27, v3
  s_waitcnt lgkmcnt(5)
  s_nop 0
  v_mfma_f32_16x16x32_bf16 v[28:31], v[20:23], v[120:123], v[28:31]
  ds_read_b128 v[120:123], v5 offset:19456
  v_mfma_f32_16x16x32_bf16 v[32:35], v[20:23], v[124:127], v[32:35]
  ds_read_b128 v[124:127], v5 offset:20480
  v_perm_b32 v3, v55, v55, s31
  v_and_b32 v20, v24, v3
  v_and_b32 v21, v25, v3
  v_and_b32 v22, v26, v3
  v_and_b32 v23, v27, v3
  s_waitcnt lgkmcnt(5)
  s_nop 0
  v_mfma_f32_16x16x32_bf16 v[28:31], v[20:23], v[36:39], v[28:31]
  ds_read_b128 v[36:39], v5 offset:21504
  v_mfma_f32_16x16x32_bf16 v[32:35], v[20:23], v[40:43], v[32:35]
  ds_read_b128 v[40:43], v5 offset:22528
  v_perm_b32 v3, v56, v56, s30
  v_and_b32 v20, v24, v3
  v_and_b32 v21, v25, v3
  v_and_b32 v22, v26, v3
  v_and_b32 v23, v27, v3
  s_waitcnt lgkmcnt(5)
  s_nop 0
  v_mfma_f32_16x16x32_bf16 v[28:31], v[20:23], v[44:47], v[28:31]
  s_waitcnt vmcnt(22)
  ds_read_b128 v[44:47], v2 offset:0
  v_mfma_f32_16x16x32_bf16 v[32:35], v[20:23], v[12:15], v[32:35]
  s_waitcnt vmcnt(21)
  ds_read_b128 v[12:15], v2 offset:1024
  v_perm_b32 v3, v56, v56, s31
  v_and_b32 v20, v24, v3
  v_and_b32 v21, v25, v3
  v_and_b32 v22, v26, v3
  v_and_b32 v23, v27, v3
  s_waitcnt lgkmcnt(5)
  s_nop 0
  v_mfma_f32_16x16x32_bf16 v[28:31], v[20:23], v[16:19], v[28:31]
  s_waitcnt vmcnt(20)
  ds_read_b128 v[16:19], v2 offset:2048
  v_mfma_f32_16x16x32_bf16 v[32:35], v[20:23], v[120:123], v[32:35]
  s_waitcnt vmcnt(19)
  ds_read_b128 v[120:123], v2 offset:3072
  v_perm_b32 v3, v57, v57, s30
  v_and_b32 v20, v24, v3
  v_and_b32 v21, v25, v3
  v_and_b32 v22, v26, v3
  v_and_b32 v23, v27, v3
  s_waitcnt lgkmcnt(5)
  s_nop 0
  v_mfma_f32_16x16x32_bf16 v[28:31], v[20:23], v[124:127], v[28:31]
  s_waitcnt vmcnt(18)
  ds_read_b128 v[124:127], v2 offset:4096
  v_mfma_f32_16x16x32_bf16 v[32:35], v[20:23], v[36:39], v[32:35]
  s_waitcnt vmcnt(17)
  ds_read_b128 v[36:39], v2 offset:5120
  v_perm_b32 v3, v57, v57, s31
  v_and_b32 v20, v24, v3
  v_and_b32 v21, v25, v3
  v_and_b32 v22, v26, v3
  v_and_b32 v23, v27, v3
  s_waitcnt lgkmcnt(5)
  s_nop 0
  v_mfma_f32_16x16x32_bf16 v[28:31], v[20:23], v[40:43], v[28:31]
  s_waitcnt vmcnt(16)
  ds_read_b128 v[40:43], v2 offset:6144
  v_mfma_f32_16x16x32_bf16 v[32:35], v[20:23], v[44:47], v[32:35]
  s_waitcnt vmcnt(15)
  ds_read_b128 v[44:47], v2 offset:7168
  v_perm_b32 v3, v58, v58, s30
  v_and_b32 v20, v24, v3
  v_and_b32 v21, v25, v3
  v_and_b32 v22, v26, v3
  v_and_b32 v23, v27, v3
  s_waitcnt lgkmcnt(5)
  s_nop 0
  v_mfma_f32_16x16x32_bf16 v[28:31], v[20:23], v[12:15], v[28:31]
  v_mfma_f32_16x16x32_bf16 v[32:35], v[20:23], v[16:19], v[32:35]
  v_perm_b32 v3, v58, v58, s31
  v_and_b32 v20, v24, v3
  v_and_b32 v21, v25, v3
  v_and_b32 v22, v26, v3
  v_and_b32 v23, v27, v3
  s_waitcnt lgkmcnt(3)
  s_nop 0
  v_mfma_f32_16x16x32_bf16 v[28:31], v[20:23], v[120:123], v[28:31]
  v_mfma_f32_16x16x32_bf16 v[32:35], v[20:23], v[124:127], v[32:35]
  v_perm_b32 v3, v59, v59, s30
  v_and_b32 v20, v24, v3
  v_and_b32 v21, v25, v3
  v_and_b32 v22, v26, v3
  v_and_b32 v23, v27, v3
  s_waitcnt lgkmcnt(1)
  s_nop 0
  v_mfma_f32_16x16x32_bf16 v[28:31], v[20:23], v[36:39], v[28:31]
  v_mfma_f32_16x16x32_bf16 v[32:35], v[20:23], v[40:43], v[32:35]
  v_perm_b32 v3, v59, v59, s31
  v_and_b32 v20, v24, v3
  v_and_b32 v21, v25, v3
  v_and_b32 v22, v26, v3
  v_and_b32 v23, v27, v3
  s_waitcnt lgkmcnt(0)
  s_waitcnt vmcnt(14)
  v_mfma_f32_16x16x32_bf16 v[28:31], v[20:23], v[44:47], v[28:31]
  v_mfma_f32_16x16x32_bf16 v[32:35], v[20:23], v[60:63], v[32:35]
  v_lshrrev_b32 v2, 8, v0
  v_and_b32 v3, 0xf0, v0
  v_lshlrev_b32 v3, 1, v3
  v_and_b32 v5, 1, v2
  v_lshl_add_u32 v5, v5, 4, v3
  v_add_u32 v5, s37, v5
  s_mov_b32 exec_lo, 0x00ff00ff
  s_mov_b32 exec_hi, 0xff00ff00
  ds_write_b128 v5, v[28:31]
  ds_write_b128 v5, v[32:35] offset:512
  s_mov_b64 exec, -1
  s_xor_b32 s26, s50, 32768
  v_add_u32 v5, s26, v1
  v_lshl_add_u32 v3, v2, 4, v3
  s_waitcnt lgkmcnt(0)
  s_barrier
  ds_read2st64_b32 v[36:37], v5 offset0:0 offset1:1
  ds_read2st64_b32 v[52:53], v5 offset0:2 offset1:3
  ds_read2st64_b32 v[38:39], v5 offset0:32 offset1:33
  ds_read2st64_b32 v[54:55], v5 offset0:34 offset1:35
  ds_read2st64_b32 v[40:41], v5 offset0:64 offset1:65
  ds_read2st64_b32 v[56:57], v5 offset0:66 offset1:67
  ds_read2st64_b32 v[42:43], v5 offset0:96 offset1:97
  ds_read2st64_b32 v[58:59], v5 offset0:98 offset1:99
  s_waitcnt lgkmcnt(0)
  v_add_f32 v36, v36, v40
  v_add_f32 v37, v37, v41
  v_add_f32 v38, v38, v42
  v_add_f32 v39, v39, v43
  v_add_f32 v52, v52, v56
  v_add_f32 v53, v53, v57
  v_add_f32 v54, v54, v58
  v_add_f32 v55, v55, v59
  v_add_f32 v36, v36, v38
  v_add_f32 v37, v37, v39
  v_add_f32 v52, v52, v54
  v_add_f32 v53, v53, v55
  v_add_f32 v36, v36, v37
  v_add_f32 v52, v52, v53
  v_cvt_pk_bf16_f32 v36, 0, v36
  v_cvt_pk_bf16_f32 v52, 0, v52
  v_mul_f32 v40, 0xbfb8aa3b, v36
  v_exp_f32 v40, v40
  s_nop 0
  v_add_f32 v40, 1.0, v40
  v_rcp_f32 v40, v40
  s_nop 0
  v_mul_f32 v36, v36, v40
  v_cvt_pk_bf16_f32 v36, 0, v36
  v_mul_f32 v36, v36, v52
  v_cvt_pk_bf16_f32 v36, v36, v36
  s_lshl_b32 s26, s17, 8
  s_add_u32 s26, s26, 161792
  v_add_u32 v5, s26, v1
  ds_write_b32 v5, v36
  v_mul_u32_u24 v5, 56, v2
  v_add_u32 v5, s26, v5
  ds_read_b64 v[36:37], v5 offset:0
  ds_read_b64 v[38:39], v5 offset:8
  ds_read_b64 v[40:41], v5 offset:16
  ds_read_b64 v[42:43], v5 offset:24
  ds_read_b64 v[44:45], v5 offset:32
  ds_read_b64 v[46:47], v5 offset:40
  ds_read_b64 v[52:53], v5 offset:48
  s_waitcnt lgkmcnt(0)
  v_and_b32 v20, v24, v36
  v_and_b32 v21, v25, v36
  v_and_b32 v22, v26, v36
  v_and_b32 v23, v27, v36
  s_waitcnt vmcnt(13)
  s_nop 0
  v_mfma_f32_16x16x32_bf16 v[28:31], v[20:23], v[64:67], 0
  v_and_b32 v32, v24, v37
  v_and_b32 v33, v25, v37
  v_and_b32 v34, v26, v37
  v_and_b32 v35, v27, v37
  s_waitcnt vmcnt(12)
  s_nop 0
  v_mfma_f32_16x16x32_bf16 v[28:31], v[32:35], v[68:71], v[28:31]
  v_and_b32 v20, v24, v38
  v_and_b32 v21, v25, v38
  v_and_b32 v22, v26, v38
  v_and_b32 v23, v27, v38
  s_waitcnt vmcnt(11)
  s_nop 0
  v_mfma_f32_16x16x32_bf16 v[28:31], v[20:23], v[72:75], v[28:31]
  v_and_b32 v32, v24, v39
  v_and_b32 v33, v25, v39
  v_and_b32 v34, v26, v39
  v_and_b32 v35, v27, v39
  s_waitcnt vmcnt(10)
  s_nop 0
  v_mfma_f32_16x16x32_bf16 v[28:31], v[32:35], v[76:79], v[28:31]
  v_and_b32 v20, v24, v40
  v_and_b32 v21, v25, v40
  v_and_b32 v22, v26, v40
  v_and_b32 v23, v27, v40
  s_waitcnt vmcnt(9)
  s_nop 0
  v_mfma_f32_16x16x32_bf16 v[28:31], v[20:23], v[80:83], v[28:31]
  v_and_b32 v32, v24, v41
  v_and_b32 v33, v25, v41
  v_and_b32 v34, v26, v41
  v_and_b32 v35, v27, v41
  s_waitcnt vmcnt(8)
  s_nop 0
  v_mfma_f32_16x16x32_bf16 v[28:31], v[32:35], v[84:87], v[28:31]
  v_and_b32 v20, v24, v42
  v_and_b32 v21, v25, v42
  v_and_b32 v22, v26, v42
  v_and_b32 v23, v27, v42
  s_waitcnt vmcnt(7)
  s_nop 0
  v_mfma_f32_16x16x32_bf16 v[28:31], v[20:23], v[88:91], v[28:31]
  v_and_b32 v32, v24, v43
  v_and_b32 v33, v25, v43
  v_and_b32 v34, v26, v43
  v_and_b32 v35, v27, v43
  s_waitcnt vmcnt(6)
  s_nop 0
  v_mfma_f32_16x16x32_bf16 v[28:31], v[32:35], v[92:95], v[28:31]
  v_and_b32 v20, v24, v44
  v_and_b32 v21, v25, v44
  v_and_b32 v22, v26, v44
  v_and_b32 v23, v27, v44
  s_waitcnt vmcnt(5)
  s_nop 0
  v_mfma_f32_16x16x32_bf16 v[28:31], v[20:23], v[96:99], v[28:31]
  v_and_b32 v32, v24, v45
  v_and_b32 v33, v25, v45
  v_and_b32 v34, v26, v45
  v_and_b32 v35, v27, v45
  s_waitcnt vmcnt(4)
  s_nop 0
  v_mfma_f32_16x16x32_bf16 v[28:31], v[32:35], v[100:103], v[28:31]
  v_and_b32 v20, v24, v46
  v_and_b32 v21, v25, v46
  v_and_b32 v22, v26, v46
  v_and_b32 v23, v27, v46
  s_waitcnt vmcnt(3)
  s_nop 0
  v_mfma_f32_16x16x32_bf16 v[28:31], v[20:23], v[104:107], v[28:31]
  v_and_b32 v32, v24, v47
  v_and_b32 v33, v25, v47
  v_and_b32 v34, v26, v47
  v_and_b32 v35, v27, v47
  s_waitcnt vmcnt(2)
  s_nop 0
  v_mfma_f32_16x16x32_bf16 v[28:31], v[32:35], v[108:111], v[28:31]
  v_and_b32 v20, v24, v52
  v_and_b32 v21, v25, v52
  v_and_b32 v22, v26, v52
  v_and_b32 v23, v27, v52
  s_waitcnt vmcnt(1)
  s_nop 0
  v_mfma_f32_16x16x32_bf16 v[28:31], v[20:23], v[112:115], v[28:31]
  v_and_b32 v32, v24, v53
  v_and_b32 v33, v25, v53
  v_and_b32 v34, v26, v53
  v_and_b32 v35, v27, v53
  s_waitcnt vmcnt(0)
  s_nop 0
  v_mfma_f32_16x16x32_bf16 v[28:31], v[32:35], v[48:51], v[28:31]
  v_lshrrev_b32 v3, 1, v3
  s_lshl_b32 s26, s47, 7
  s_add_u32 s26, s26, s57
  s_lshl_b32 s26, s26, 8
  s_add_u32 s26, s26, 244318208
  s_nop 2
  v_cvt_pk_bf16_f32 v28, v28, v29
  v_cvt_pk_bf16_f32 v29, v30, v31
  v_min_u32 v28, -2, v28
  v_min_u32 v29, -2, v29
  s_mov_b32 exec_hi, 0
  buffer_store_dwordx2 v[28:29], v3, s[4:7], s26 offen sc1
  s_mov_b32 exec_hi, -1
  s_cmp_lg_u32 s16, 0
  s_cbranch_scc1 q_fail_90
  s_barrier
  s_lshl_b32 s26, s61, 21
  s_lshl_b32 s27, s59, 10
  s_add_u32 s26, s26, s27
  s_add_u32 s27, s26, 20971520
  s_add_u32 s28, s26, 27262976
  s_lshl_b32 s26, s47, 7
  s_add_u32 s26, s26, s17
  s_lshl_b32 s26, s26, 8
  s_add_u32 s26, s26, 244318208
  v_lshrrev_b32 v2, 8, v0
  v_and_b32 v3, 0xf0, v0
  v_lshl_add_u32 v5, v2, 10, v3
  buffer_load_dwordx4 v[108:111], v0, s[4:7], s27 offen sc1
  buffer_load_dwordx4 v[112:115], v0, s[4:7], s28 offen sc1
  s_mov_b32 s53, 0
m_w_116:
  s_add_u32 s27, s26, 0
  buffer_load_dwordx4 v[20:23], v5, s[4:7], s27 offen sc1
  s_add_u32 s27, s26, 4096
  buffer_load_dwordx4 v[24:27], v5, s[4:7], s27 offen sc1
  s_add_u32 s27, s26, 8192
  buffer_load_dwordx4 v[28:31], v5, s[4:7], s27 offen sc1
  s_add_u32 s27, s26, 12288
  buffer_load_dwordx4 v[32:35], v5, s[4:7], s27 offen sc1
  s_add_u32 s27, s26, 16384
  buffer_load_dwordx4 v[36:39], v5, s[4:7], s27 offen sc1
  s_add_u32 s27, s26, 20480
  buffer_load_dwordx4 v[40:43], v5, s[4:7], s27 offen sc1
  s_add_u32 s27, s26, 24576
  buffer_load_dwordx4 v[44:47], v5, s[4:7], s27 offen sc1
  s_add_u32 s27, s26, 28672
  buffer_load_dwordx4 v[48:51], v5, s[4:7], s27 offen sc1
  s_add_u32 s53, s53, 1
  s_cmp_gt_u32 s53, 1048576
  s_cbranch_scc1 q_fail_90
  s_mov_b32 vcc_lo, 0xaaaaaaaa
  s_mov_b32 vcc_hi, 0xaaaaaaaa
  v_mov_b32 v72, 0x3f80
  v_mov_b32 v68, 1.0
  v_cndmask_b32 v72, v72, v68, vcc
  s_mov_b32 vcc_lo, 0x30003
  s_mov_b32 vcc_hi, 0x30003
  v_cndmask_b32 v68, 0, v72, vcc
  s_mov_b32 vcc_lo, 0xc000c
  s_mov_b32 vcc_hi, 0xc000c
  v_cndmask_b32 v69, 0, v72, vcc
  s_mov_b32 vcc_lo, 0x300030
  s_mov_b32 vcc_hi, 0x300030
  v_cndmask_b32 v70, 0, v72, vcc
  s_mov_b32 vcc_lo, 0xc000c0
  s_mov_b32 vcc_hi, 0xc000c0
  v_cndmask_b32 v71, 0, v72, vcc
  s_waitcnt vmcnt(7)
  s_nop 0
  v_mfma_f32_16x16x32_bf16 v[72:75], v[68:71], v[20:23], 0
  v_max3_u32 v80, v20, v21, 0
  v_max3_u32 v80, v22, v23, v80
  s_waitcnt vmcnt(6)
  v_mfma_f32_16x16x32_bf16 v[72:75], v[68:71], v[24:27], v[72:75]
  v_max3_u32 v80, v24, v25, v80
  v_max3_u32 v80, v26, v27, v80
  s_waitcnt vmcnt(5)
  v_mfma_f32_16x16x32_bf16 v[72:75], v[68:71], v[28:31], v[72:75]
  v_max3_u32 v80, v28, v29, v80
  v_max3_u32 v80, v30, v31, v80
  s_waitcnt vmcnt(4)
  v_mfma_f32_16x16x32_bf16 v[72:75], v[68:71], v[32:35], v[72:75]
  v_max3_u32 v80, v32, v33, v80
  v_max3_u32 v80, v34, v35, v80
  s_waitcnt vmcnt(3)
  v_mfma_f32_16x16x32_bf16 v[72:75], v[68:71], v[36:39], v[72:75]
  v_max3_u32 v80, v36, v37, v80
  v_max3_u32 v80, v38, v39, v80
  s_waitcnt vmcnt(2)
  v_mfma_f32_16x16x32_bf16 v[72:75], v[68:71], v[40:43], v[72:75]
  v_max3_u32 v80, v40, v41, v80
  v_max3_u32 v80, v42, v43, v80
  s_waitcnt vmcnt(1)
  v_mfma_f32_16x16x32_bf16 v[72:75], v[68:71], v[44:47], v[72:75]
  v_max3_u32 v80, v44, v45, v80
  v_max3_u32 v80, v46, v47, v80
  s_waitcnt vmcnt(0)
  v_mfma_f32_16x16x32_bf16 v[72:75], v[68:71], v[48:51], v[72:75]
  v_max3_u32 v80, v48, v49, v80
  v_max3_u32 v80, v50, v51, v80
  v_cmp_eq_u32 vcc, -1, v80
  s_cbranch_vccnz m_w_116
  v_lshlrev_b32 v3, 1, v3
  v_lshl_add_u32 v3, v2, 4, v3
  s_lshl_b32 s26, s17, 9
  s_add_u32 s26, s26, 159744
  v_add_u32 v3, s26, v3
  s_mov_b32 exec_hi, 0
  ds_write_b128 v3, v[72:75]
  s_mov_b32 exec_hi, -1
  v_lshlrev_b32 v3, 1, v0
  v_add_u32 v3, 159744, v3
  v_lshlrev_b32 v80, 16, v108
  v_and_b32 v81, 0xffff0000, v108
  v_lshlrev_b32 v82, 16, v109
  v_and_b32 v83, 0xffff0000, v109
  v_lshlrev_b32 v84, 16, v110
  v_and_b32 v85, 0xffff0000, v110
  v_lshlrev_b32 v86, 16, v111
  v_and_b32 v87, 0xffff0000, v111
  v_lshlrev_b32 v88, 16, v112
  v_and_b32 v89, 0xffff0000, v112
  v_lshlrev_b32 v90, 16, v113
  v_and_b32 v91, 0xffff0000, v113
  v_lshlrev_b32 v92, 16, v114
  v_and_b32 v93, 0xffff0000, v114
  v_lshlrev_b32 v94, 16, v115
  v_and_b32 v95, 0xffff0000, v115
  s_waitcnt lgkmcnt(0)
  s_barrier
  s_cmp_lg_u32 s17, 0
  s_cbranch_scc1 m_done_115
  ds_read_b128 v[72:75], v3
  ds_read_b128 v[76:79], v3 offset:16
  s_and_b32 s29, s58, 0xffff0000
  s_xor_b32 s27, s29, 0x80000000
  s_xor_b32 s28, s29, 0xffff0000
  s_bitcmp1_b32 s29, 31
  s_cselect_b32 s29, s27, s28
  v_mov_b32 v108, s29
  v_mul_f32 v108, 0xbfb8aa3b, v108
  v_exp_f32 v108, v108
  s_nop 0
  v_add_f32 v108, 1.0, v108
  v_rcp_f32 v108, v108
  s_nop 0
  v_cvt_pk_bf16_f32 v108, 0, v108
  s_waitcnt lgkmcnt(0)
  v_cvt_pk_bf16_f32 v72, 0, v72
  v_cvt_pk_bf16_f32 v73, 0, v73
  v_cvt_pk_bf16_f32 v74, 0, v74
  v_cvt_pk_bf16_f32 v75, 0, v75
  v_cvt_pk_bf16_f32 v76, 0, v76
  v_cvt_pk_bf16_f32 v77, 0, v77
  v_cvt_pk_bf16_f32 v78, 0, v78
  v_cvt_pk_bf16_f32 v79, 0, v79
  v_mul_f32 v72, v72, v108
  v_mul_f32 v73, v73, v108
  v_mul_f32 v74, v74, v108
  v_mul_f32 v75, v75, v108
  v_mul_f32 v76, v76, v108
  v_mul_f32 v77, v77, v108
  v_mul_f32 v78, v78, v108
  v_mul_f32 v79, v79, v108
  v_cvt_pk_bf16_f32 v72, 0, v72
  v_cvt_pk_bf16_f32 v73, 0, v73
  v_cvt_pk_bf16_f32 v74, 0, v74
  v_cvt_pk_bf16_f32 v75, 0, v75
  v_cvt_pk_bf16_f32 v76, 0, v76
  v_cvt_pk_bf16_f32 v77, 0, v77
  v_cvt_pk_bf16_f32 v78, 0, v78
  v_cvt_pk_bf16_f32 v79, 0, v79
  v_add_f32 v72, v72, v88
  v_add_f32 v73, v73, v89
  v_add_f32 v74, v74, v90
  v_add_f32 v75, v75, v91
  v_add_f32 v76, v76, v92
  v_add_f32 v77, v77, v93
  v_add_f32 v78, v78, v94
  v_add_f32 v79, v79, v95
  v_cvt_pk_bf16_f32 v72, 0, v72
  v_cvt_pk_bf16_f32 v73, 0, v73
  v_cvt_pk_bf16_f32 v74, 0, v74
  v_cvt_pk_bf16_f32 v75, 0, v75
  v_cvt_pk_bf16_f32 v76, 0, v76
  v_cvt_pk_bf16_f32 v77, 0, v77
  v_cvt_pk_bf16_f32 v78, 0, v78
  v_cvt_pk_bf16_f32 v79, 0, v79
  v_add_f32 v80, v80, v72
  v_add_f32 v81, v81, v73
  v_add_f32 v82, v82, v74
  v_add_f32 v83, v83, v75
  v_add_f32 v84, v84, v76
  v_add_f32 v85, v85, v77
  v_add_f32 v86, v86, v78
  v_add_f32 v87, v87, v79
  v_cvt_pk_bf16_f32 v112, v80, v81
  v_cvt_pk_bf16_f32 v113, v82, v83
  v_cvt_pk_bf16_f32 v114, v84, v85
  v_cvt_pk_bf16_f32 v115, v86, v87
  v_lshlrev_b32 v80, 16, v112
  v_and_b32 v81, 0xffff0000, v112
  v_lshlrev_b32 v82, 16, v113
  v_and_b32 v83, 0xffff0000, v113
  v_lshlrev_b32 v84, 16, v114
  v_and_b32 v85, 0xffff0000, v114
  v_lshlrev_b32 v86, 16, v115
  v_and_b32 v87, 0xffff0000, v115
  s_lshl_b32 s26, s59, 10
  buffer_store_dwordx4 v[112:115], v0, s[72:75], s26 offen sc1
m_done_115:
q_fail_90:
  s_endpgm
L_o:
  s_sub_u32 s60, s91, 3
  s_and_b32 s61, s90, 15
  s_load_dwordx2 s[80:81], s[0:1], 40
  s_load_dwordx2 s[72:73], s[0:1], 0
  s_mov_b32 s82, 4194304
  v_and_b32 v42, 63, v0
  v_and_b32 v40, 15, v42
  v_lshrrev_b32 v41, 4, v42
  v_lshlrev_b32 v1, 3, v42
  v_lshlrev_b32 v2, 2, v42
  v_lshlrev_b32 v0, 4, v42
  s_mov_b32 s24, 0x3e0293ee
  s_mov_b32 s44, 0x05040100
  s_mov_b32 s45, 0x07060302
  s_and_b32 s26, s17, 1
  s_lshl_b32 s26, s26, 4
  v_lshlrev_b32 v43, 2, v41
  v_sub_u32 v43, v40, v43
  v_add_u32 v43, s26, v43
  v_mov_b32 v7, 0xfe000000
  v_cmp_le_i32 vcc, 0, v43
  s_nop 1
  v_cndmask_b32 v24, v7, 0, vcc
  v_cmp_le_i32 vcc, 1, v43
  s_nop 1
  v_cndmask_b32 v25, v7, 0, vcc
  v_cmp_le_i32 vcc, 2, v43
  s_nop 1
  v_cndmask_b32 v26, v7, 0, vcc
  v_cmp_le_i32 vcc, 3, v43
  s_nop 1
  v_cndmask_b32 v27, v7, 0, vcc
  v_cmp_le_i32 vcc, 16, v43
  s_nop 1
  v_cndmask_b32 v28, v7, 0, vcc
  v_cmp_le_i32 vcc, 17, v43
  s_nop 1
  v_cndmask_b32 v29, v7, 0, vcc
  v_cmp_le_i32 vcc, 18, v43
  s_nop 1
  v_cndmask_b32 v30, v7, 0, vcc
  v_cmp_le_i32 vcc, 19, v43
  s_nop 1
  v_cndmask_b32 v31, v7, 0, vcc
  v_lshrrev_b32 v43, 5, v42
  v_lshlrev_b32 v43, 16, v43
  v_and_b32 v4, 1, v41
  v_lshl_add_u32 v43, v4, 14, v43
  v_lshl_add_u32 v43, v40, 4, v43
  s_lshl_b32 s26, s61, 10
  s_lshl_b32 s27, s17, 8
  s_add_u32 s26, s26, s27
  v_add_u32 v4, s26, v43
  v_lshlrev_b32 v43, 10, v41
  v_lshl_add_u32 v5, v40, 4, v43
  s_lshl_b32 s26, s17, 12
  v_add_u32 v6, s26, v0
  v_and_b32 v43, 1, v41
  v_lshlrev_b32 v43, 12, v43
  v_lshl_add_u32 v43, v40, 4, v43
  v_lshrrev_b32 v3, 1, v41
  v_lshl_add_u32 v3, v3, 8, v43
  s_lshr_b32 s26, s17, 1
  s_lshl_b32 s27, s26, 14
  s_add_u32 s27, s27, 16384
  v_add_u32 v32, s27, v0
  s_lshl_b32 s27, s26, 13
  s_and_b32 s28, s17, 1
  s_lshl_b32 s28, s28, 10
  s_add_u32 s28, s28, s27
  s_add_u32 s28, s28, 49152
  v_add_u32 v33, s28, v0
  s_add_u32 s27, s27, 65536
  v_add_u32 v34, s27, v0
  v_add_u32 v35, s27, v1
  v_and_b32 v36, 0xf0, v0
  v_and_b32 v252, 64, v0
  v_mov_b32 v248, 0
  v_lshlrev_b32 v255, 4, v0
  v_and_b32 v43, 1, v42
  v_xor_b32 v254, 1, v43
  s_lshl_b32 s26, s17, 3
  s_add_u32 s26, s26, 81920
  v_mov_b32 v39, s26
  s_mov_b32 vcc_lo, 0xaaaaaaaa
  s_mov_b32 vcc_hi, 0xaaaaaaaa
  v_mov_b32 v43, 0x3f80
  v_cndmask_b32 v43, v43, 1.0, vcc
  s_mov_b32 vcc_lo, 0xf000f
  s_mov_b32 vcc_hi, 0xf000f00
  v_cndmask_b32 v16, 0, v43, vcc
  v_cndmask_b32 v18, 0, v43, vcc
  s_mov_b32 vcc_lo, 0xf000f0
  s_mov_b32 vcc_hi, 0xf000f000
  v_cndmask_b32 v17, 0, v43, vcc
  v_cndmask_b32 v19, 0, v43, vcc
  s_mov_b32 vcc_lo, 0xcccccccc
  s_mov_b32 vcc_hi, 0xcccccccc
  v_mov_b32 v43, 0x4444
  v_mov_b32 v20, 0xeeee
  v_cndmask_b32 v20, v43, v20, vcc
  s_mov_b32 s70, 2097152
  s_mov_b32 s71, 0x20000
  s_mov_b32 s74, 2097152
  s_mov_b32 s75, 0x20000
  s_mov_b32 s10, 1024
  s_mov_b32 s83, 0x20000
  s_lshr_b32 s85, s17, 1
  s_lshl_b32 s26, s61, 1
  s_add_u32 s85, s85, s26
  s_add_u32 s43, s26, s17
  s_lshl_b32 s14, s61, 8
  s_lshl_b32 s15, s61, 7
  s_add_u32 s15, s15, 245104640
  s_add_u32 s14, s14, 244318208
  s_lshl_b32 s26, s61, 2
  s_add_u32 s26, s26, s17
  s_lshl_b32 s18, s26, 13
  s_add_u32 s18, s18, 41943040
  s_lshl_b32 s19, s26, 12
  s_add_u32 s19, s19, 142606336
  s_lshl_b32 s20, s85, 13
  s_add_u32 s20, s20, 192937984
  s_and_b32 s26, s17, 1
  s_mul_i32 s26, s26, 3072
  s_add_u32 s21, s20, s26
  s_lshr_b32 s40, s17, 1
  s_lshl_b32 s40, s40, 13
  s_add_u32 s40, s40, s26
  s_add_u32 s40, s40, 65536
  s_lshl_b32 s22, s17, 12
  s_add_u32 s22, s22, 49152
  s_lshl_b32 s23, s17, 13
  s_add_u32 s23, s23, 16384
  s_lshl_b32 s41, s60, 20
  s_add_u32 s41, s41, 12582912
  v_lshlrev_b32 v246, 3, v0
  s_mov_b32 s11, 0x20000
  s_waitcnt lgkmcnt(0)
  s_lshl_b32 s77, s60, 4
  s_add_u32 s77, s77, s61
  s_lshl_b32 s77, s77, 2
  s_add_u32 s77, s77, s17
  s_lshl_b32 s26, s77, 10
  buffer_load_dwordx4 v[176:179], v0, s[72:75], s26 offen
  s_add_u32 s26, s26, 262144
  buffer_load_dwordx4 v[180:183], v0, s[72:75], s26 offen
  s_add_u32 s26, s26, 262144
  buffer_load_dwordx4 v[184:187], v0, s[72:75], s26 offen
  s_add_u32 s26, s26, 262144
  buffer_load_dwordx4 v[188:191], v0, s[72:75], s26 offen
  s_add_u32 s26, s26, 262144
  buffer_load_dwordx4 v[192:195], v0, s[72:75], s26 offen
  s_add_u32 s26, s26, 262144
  buffer_load_dwordx4 v[196:199], v0, s[72:75], s26 offen
  s_add_u32 s26, s26, 262144
  buffer_load_dwordx4 v[200:203], v0, s[72:75], s26 offen
  s_add_u32 s26, s26, 262144
  buffer_load_dwordx4 v[204:207], v0, s[72:75], s26 offen
  s_add_u32 s26, s26, 262144
  v_lshrrev_b32 v44, 9, v0
  v_lshlrev_b32 v44, 12, v44
  v_and_b32 v45, 0xf0, v0
  v_add_u32 v44, v44, v45
  v_bfe_u32 v45, v0, 8, 1
  v_lshl_add_u32 v44, v45, 3, v44
  s_lshl_b32 s30, s61, 18
  s_lshl_b32 s27, s17, 8
  s_add_u32 s30, s30, s27
  s_add_u32 s27, s30, 0
  buffer_load_dwordx2 v[64:65], v44, s[80:83], s27 offen
  s_add_u32 s27, s30, 1024
  buffer_load_dwordx2 v[66:67], v44, s[80:83], s27 offen
  s_add_u32 s27, s30, 2048
  buffer_load_dwordx2 v[68:69], v44, s[80:83], s27 offen
  s_add_u32 s27, s30, 3072
  buffer_load_dwordx2 v[70:71], v44, s[80:83], s27 offen
  s_add_u32 s27, s30, 16384
  buffer_load_dwordx2 v[72:73], v44, s[80:83], s27 offen
  s_add_u32 s27, s30, 17408
  buffer_load_dwordx2 v[74:75], v44, s[80:83], s27 offen
  s_add_u32 s27, s30, 18432
  buffer_load_dwordx2 v[76:77], v44, s[80:83], s27 offen
  s_add_u32 s27, s30, 19456
  buffer_load_dwordx2 v[78:79], v44, s[80:83], s27 offen
  s_add_u32 s27, s30, 8192
  buffer_load_dwordx2 v[80:81], v44, s[80:83], s27 offen
  s_add_u32 s27, s30, 9216
  buffer_load_dwordx2 v[82:83], v44, s[80:83], s27 offen
  s_add_u32 s27, s30, 10240
  buffer_load_dwordx2 v[84:85], v44, s[80:83], s27 offen
  s_add_u32 s27, s30, 11264
  buffer_load_dwordx2 v[86:87], v44, s[80:83], s27 offen
  s_add_u32 s27, s30, 24576
  buffer_load_dwordx2 v[88:89], v44, s[80:83], s27 offen
  s_add_u32 s27, s30, 25600
  buffer_load_dwordx2 v[90:91], v44, s[80:83], s27 offen
  s_add_u32 s27, s30, 26624
  buffer_load_dwordx2 v[92:93], v44, s[80:83], s27 offen
  s_add_u32 s27, s30, 27648
  buffer_load_dwordx2 v[94:95], v44, s[80:83], s27 offen
  s_add_u32 s27, s30, 32768
  buffer_load_dwordx2 v[96:97], v44, s[80:83], s27 offen
  s_add_u32 s27, s30, 33792
  buffer_load_dwordx2 v[98:99], v44, s[80:83], s27 offen
  s_add_u32 s27, s30, 34816
  buffer_load_dwordx2 v[100:101], v44, s[80:83], s27 offen
  s_add_u32 s27, s30, 35840
  buffer_load_dwordx2 v[102:103], v44, s[80:83], s27 offen
  s_add_u32 s27, s30, 49152
  buffer_load_dwordx2 v[104:105], v44, s[80:83], s27 offen
  s_add_u32 s27, s30, 50176
  buffer_load_dwordx2 v[106:107], v44, s[80:83], s27 offen
  s_add_u32 s27, s30, 51200
  buffer_load_dwordx2 v[108:109], v44, s[80:83], s27 offen
  s_add_u32 s27, s30, 52224
  buffer_load_dwordx2 v[110:111], v44, s[80:83], s27 offen
  s_add_u32 s27, s30, 40960
  buffer_load_dwordx2 v[112:113], v44, s[80:83], s27 offen
  s_add_u32 s27, s30, 41984
  buffer_load_dwordx2 v[114:115], v44, s[80:83], s27 offen
  s_add_u32 s27, s30, 43008
  buffer_load_dwordx2 v[116:117], v44, s[80:83], s27 offen
  s_add_u32 s27, s30, 44032
  buffer_load_dwordx2 v[118:119], v44, s[80:83], s27 offen
  s_add_u32 s27, s30, 57344
  buffer_load_dwordx2 v[120:121], v44, s[80:83], s27 offen
  s_add_u32 s27, s30, 58368
  buffer_load_dwordx2 v[122:123], v44, s[80:83], s27 offen
  s_add_u32 s27, s30, 59392
  buffer_load_dwordx2 v[124:125], v44, s[80:83], s27 offen
  s_add_u32 s27, s30, 60416
  buffer_load_dwordx2 v[126:127], v44, s[80:83], s27 offen
  s_load_dwordx2 s[4:5], s[0:1], 112
  s_load_dwordx2 s[12:13], s[0:1], 104
  s_load_dwordx2 s[68:69], s[0:1], 96
  s_load_dwordx2 s[8:9], s[0:1], 64
  s_waitcnt lgkmcnt(0)
  buffer_load_dwordx4 v[56:59], v0, s[8:11], 0 offen
  s_lshl_b32 s29, s77, 10
  s_add_u32 s29, s29, 6291456
  s_cmp_lt_u32 s60, 4
  s_cbranch_scc1 o_s1_117
  s_waitcnt vmcnt(0)
  s_branch o_s2_118
o_s1_117:
  s_waitcnt vmcnt(40)
  v_lshlrev_b32 v212, 16, v176
  v_and_b32 v213, 0xffff0000, v176
  v_lshlrev_b32 v214, 16, v177
  v_and_b32 v215, 0xffff0000, v177
  v_lshlrev_b32 v216, 16, v178
  v_and_b32 v217, 0xffff0000, v178
  v_lshlrev_b32 v218, 16, v179
  v_and_b32 v219, 0xffff0000, v179
  v_add_f32 v220, v212, v213
  v_add_f32 v221, v214, v215
  v_add_f32 v222, v216, v217
  v_add_f32 v223, v218, v219
  v_add_f32 v220, v220, v221
  v_add_f32 v222, v222, v223
  v_add_f32 v220, v220, v222
  s_nop 1
  v_add_f32_dpp v220, v220, v220 row_ror:8 row_mask:0xf bank_mask:0xf
  s_nop 1
  v_add_f32_dpp v220, v220, v220 row_ror:4 row_mask:0xf bank_mask:0xf
  s_nop 1
  v_add_f32_dpp v220, v220, v220 row_ror:2 row_mask:0xf bank_mask:0xf
  s_nop 1
  v_add_f32_dpp v220, v220, v220 row_ror:1 row_mask:0xf bank_mask:0xf
  v_mov_b32 v222, v220
  s_nop 0
  s_nop 0
  v_permlane16_swap_b32 v220, v222
  v_add_f32 v220, v220, v222
  v_mov_b32 v222, v220
  s_nop 0
  s_nop 0
  v_permlane32_swap_b32 v220, v222
  v_add_f32 v220, v220, v222
  v_mul_f32 v220, 0x3b000000, v220
  v_sub_f32 v224, v212, v220
  v_sub_f32 v225, v213, v220
  v_sub_f32 v226, v214, v220
  v_sub_f32 v227, v215, v220
  v_sub_f32 v228, v216, v220
  v_sub_f32 v229, v217, v220
  v_sub_f32 v230, v218, v220
  v_sub_f32 v231, v219, v220
  v_mul_f32 v221, v224, v224
  v_mul_f32 v222, v225, v225
  v_fmac_f32 v221, v226, v226
  v_fmac_f32 v222, v227, v227
  v_fmac_f32 v221, v228, v228
  v_fmac_f32 v222, v229, v229
  v_fmac_f32 v221, v230, v230
  v_fmac_f32 v222, v231, v231
  v_add_f32 v221, v221, v222
  v_cvt_pk_bf16_f32 v220, 0, v220
  s_nop 0
  v_add_f32_dpp v221, v221, v221 row_ror:8 row_mask:0xf bank_mask:0xf
  v_sub_f32 v224, v212, v220
  v_sub_f32 v225, v213, v220
  v_add_f32_dpp v221, v221, v221 row_ror:4 row_mask:0xf bank_mask:0xf
  v_sub_f32 v226, v214, v220
  v_sub_f32 v227, v215, v220
  v_add_f32_dpp v221, v221, v221 row_ror:2 row_mask:0xf bank_mask:0xf
  v_sub_f32 v228, v216, v220
  v_sub_f32 v229, v217, v220
  v_add_f32_dpp v221, v221, v221 row_ror:1 row_mask:0xf bank_mask:0xf
  v_sub_f32 v230, v218, v220
  v_sub_f32 v231, v219, v220
  v_mov_b32 v222, v221
  v_cvt_pk_bf16_f32 v224, 0, v224
  v_cvt_pk_bf16_f32 v225, 0, v225
  v_permlane16_swap_b32 v221, v222
  v_cvt_pk_bf16_f32 v226, 0, v226
  v_cvt_pk_bf16_f32 v227, 0, v227
  v_add_f32 v221, v221, v222
  v_cvt_pk_bf16_f32 v228, 0, v228
  v_cvt_pk_bf16_f32 v229, 0, v229
  v_mov_b32 v222, v221
  v_cvt_pk_bf16_f32 v230, 0, v230
  v_cvt_pk_bf16_f32 v231, 0, v231
  v_permlane32_swap_b32 v221, v222
  v_add_f32 v221, v221, v222
  v_mul_f32 v221, 0x3b000000, v221
  v_cvt_pk_bf16_f32 v221, 0, v221
  v_add_f32 v221, 0x3727c5ac, v221
  v_cvt_pk_bf16_f32 v221, 0, v221
  v_sqrt_f32 v221, v221
  s_nop 0
  v_cvt_pk_bf16_f32 v221, 0, v221
  v_rcp_f32 v221, v221
  s_nop 0
  v_mul_f32 v224, v224, v221
  v_mul_f32 v225, v225, v221
  v_mul_f32 v226, v226, v221
  v_mul_f32 v227, v227, v221
  v_mul_f32 v228, v228, v221
  v_mul_f32 v229, v229, v221
  v_mul_f32 v230, v230, v221
  v_mul_f32 v231, v231, v221
  v_cvt_pk_bf16_f32 v176, v224, v225
  v_cvt_pk_bf16_f32 v177, v226, v227
  v_cvt_pk_bf16_f32 v178, v228, v229
  v_cvt_pk_bf16_f32 v179, v230, v231
  buffer_store_dwordx4 v[176:179], v0, s[4:7], s29 offen sc1
  s_add_u32 s29, s29, 262144
  s_waitcnt vmcnt(40)
  v_lshlrev_b32 v212, 16, v180
  v_and_b32 v213, 0xffff0000, v180
  v_lshlrev_b32 v214, 16, v181
  v_and_b32 v215, 0xffff0000, v181
  v_lshlrev_b32 v216, 16, v182
  v_and_b32 v217, 0xffff0000, v182
  v_lshlrev_b32 v218, 16, v183
  v_and_b32 v219, 0xffff0000, v183
  v_add_f32 v220, v212, v213
  v_add_f32 v221, v214, v215
  v_add_f32 v222, v216, v217
  v_add_f32 v223, v218, v219
  v_add_f32 v220, v220, v221
  v_add_f32 v222, v222, v223
  v_add_f32 v220, v220, v222
  s_nop 1
  v_add_f32_dpp v220, v220, v220 row_ror:8 row_mask:0xf bank_mask:0xf
  s_nop 1
  v_add_f32_dpp v220, v220, v220 row_ror:4 row_mask:0xf bank_mask:0xf
  s_nop 1
  v_add_f32_dpp v220, v220, v220 row_ror:2 row_mask:0xf bank_mask:0xf
  s_nop 1
  v_add_f32_dpp v220, v220, v220 row_ror:1 row_mask:0xf bank_mask:0xf
  v_mov_b32 v222, v220
  s_nop 0
  s_nop 0
  v_permlane16_swap_b32 v220, v222
  v_add_f32 v220, v220, v222
  v_mov_b32 v222, v220
  s_nop 0
  s_nop 0
  v_permlane32_swap_b32 v220, v222
  v_add_f32 v220, v220, v222
  v_mul_f32 v220, 0x3b000000, v220
  v_sub_f32 v224, v212, v220
  v_sub_f32 v225, v213, v220
  v_sub_f32 v226, v214, v220
  v_sub_f32 v227, v215, v220
  v_sub_f32 v228, v216, v220
  v_sub_f32 v229, v217, v220
  v_sub_f32 v230, v218, v220
  v_sub_f32 v231, v219, v220
  v_mul_f32 v221, v224, v224
  v_mul_f32 v222, v225, v225
  v_fmac_f32 v221, v226, v226
  v_fmac_f32 v222, v227, v227
  v_fmac_f32 v221, v228, v228
  v_fmac_f32 v222, v229, v229
  v_fmac_f32 v221, v230, v230
  v_fmac_f32 v222, v231, v231
  v_add_f32 v221, v221, v222
  v_cvt_pk_bf16_f32 v220, 0, v220
  s_nop 0
  v_add_f32_dpp v221, v221, v221 row_ror:8 row_mask:0xf bank_mask:0xf
  v_sub_f32 v224, v212, v220
  v_sub_f32 v225, v213, v220
  v_add_f32_dpp v221, v221, v221 row_ror:4 row_mask:0xf bank_mask:0xf
  v_sub_f32 v226, v214, v220
  v_sub_f32 v227, v215, v220
  v_add_f32_dpp v221, v221, v221 row_ror:2 row_mask:0xf bank_mask:0xf
  v_sub_f32 v228, v216, v220
  v_sub_f32 v229, v217, v220
  v_add_f32_dpp v221, v221, v221 row_ror:1 row_mask:0xf bank_mask:0xf
  v_sub_f32 v230, v218, v220
  v_sub_f32 v231, v219, v220
  v_mov_b32 v222, v221
  v_cvt_pk_bf16_f32 v224, 0, v224
  v_cvt_pk_bf16_f32 v225, 0, v225
  v_permlane16_swap_b32 v221, v222
  v_cvt_pk_bf16_f32 v226, 0, v226
  v_cvt_pk_bf16_f32 v227, 0, v227
  v_add_f32 v221, v221, v222
  v_cvt_pk_bf16_f32 v228, 0, v228
  v_cvt_pk_bf16_f32 v229, 0, v229
  v_mov_b32 v222, v221
  v_cvt_pk_bf16_f32 v230, 0, v230
  v_cvt_pk_bf16_f32 v231, 0, v231
  v_permlane32_swap_b32 v221, v222
  v_add_f32 v221, v221, v222
  v_mul_f32 v221, 0x3b000000, v221
  v_cvt_pk_bf16_f32 v221, 0, v221
  v_add_f32 v221, 0x3727c5ac, v221
  v_cvt_pk_bf16_f32 v221, 0, v221
  v_sqrt_f32 v221, v221
  s_nop 0
  v_cvt_pk_bf16_f32 v221, 0, v221
  v_rcp_f32 v221, v221
  s_nop 0
  v_mul_f32 v224, v224, v221
  v_mul_f32 v225, v225, v221
  v_mul_f32 v226, v226, v221
  v_mul_f32 v227, v227, v221
  v_mul_f32 v228, v228, v221
  v_mul_f32 v229, v229, v221
  v_mul_f32 v230, v230, v221
  v_mul_f32 v231, v231, v221
  v_cvt_pk_bf16_f32 v180, v224, v225
  v_cvt_pk_bf16_f32 v181, v226, v227
  v_cvt_pk_bf16_f32 v182, v228, v229
  v_cvt_pk_bf16_f32 v183, v230, v231
  buffer_store_dwordx4 v[180:183], v0, s[4:7], s29 offen sc1
  s_add_u32 s29, s29, 262144
  s_waitcnt vmcnt(40)
  v_lshlrev_b32 v212, 16, v184
  v_and_b32 v213, 0xffff0000, v184
  v_lshlrev_b32 v214, 16, v185
  v_and_b32 v215, 0xffff0000, v185
  v_lshlrev_b32 v216, 16, v186
  v_and_b32 v217, 0xffff0000, v186
  v_lshlrev_b32 v218, 16, v187
  v_and_b32 v219, 0xffff0000, v187
  v_add_f32 v220, v212, v213
  v_add_f32 v221, v214, v215
  v_add_f32 v222, v216, v217
  v_add_f32 v223, v218, v219
  v_add_f32 v220, v220, v221
  v_add_f32 v222, v222, v223
  v_add_f32 v220, v220, v222
  s_nop 1
  v_add_f32_dpp v220, v220, v220 row_ror:8 row_mask:0xf bank_mask:0xf
  s_nop 1
  v_add_f32_dpp v220, v220, v220 row_ror:4 row_mask:0xf bank_mask:0xf
  s_nop 1
  v_add_f32_dpp v220, v220, v220 row_ror:2 row_mask:0xf bank_mask:0xf
  s_nop 1
  v_add_f32_dpp v220, v220, v220 row_ror:1 row_mask:0xf bank_mask:0xf
  v_mov_b32 v222, v220
  s_nop 0
  s_nop 0
  v_permlane16_swap_b32 v220, v222
  v_add_f32 v220, v220, v222
  v_mov_b32 v222, v220
  s_nop 0
  s_nop 0
  v_permlane32_swap_b32 v220, v222
  v_add_f32 v220, v220, v222
  v_mul_f32 v220, 0x3b000000, v220
  v_sub_f32 v224, v212, v220
  v_sub_f32 v225, v213, v220
  v_sub_f32 v226, v214, v220
  v_sub_f32 v227, v215, v220
  v_sub_f32 v228, v216, v220
  v_sub_f32 v229, v217, v220
  v_sub_f32 v230, v218, v220
  v_sub_f32 v231, v219, v220
  v_mul_f32 v221, v224, v224
  v_mul_f32 v222, v225, v225
  v_fmac_f32 v221, v226, v226
  v_fmac_f32 v222, v227, v227
  v_fmac_f32 v221, v228, v228
  v_fmac_f32 v222, v229, v229
  v_fmac_f32 v221, v230, v230
  v_fmac_f32 v222, v231, v231
  v_add_f32 v221, v221, v222
  v_cvt_pk_bf16_f32 v220, 0, v220
  s_nop 0
  v_add_f32_dpp v221, v221, v221 row_ror:8 row_mask:0xf bank_mask:0xf
  v_sub_f32 v224, v212, v220
  v_sub_f32 v225, v213, v220
  v_add_f32_dpp v221, v221, v221 row_ror:4 row_mask:0xf bank_mask:0xf
  v_sub_f32 v226, v214, v220
  v_sub_f32 v227, v215, v220
  v_add_f32_dpp v221, v221, v221 row_ror:2 row_mask:0xf bank_mask:0xf
  v_sub_f32 v228, v216, v220
  v_sub_f32 v229, v217, v220
  v_add_f32_dpp v221, v221, v221 row_ror:1 row_mask:0xf bank_mask:0xf
  v_sub_f32 v230, v218, v220
  v_sub_f32 v231, v219, v220
  v_mov_b32 v222, v221
  v_cvt_pk_bf16_f32 v224, 0, v224
  v_cvt_pk_bf16_f32 v225, 0, v225
  v_permlane16_swap_b32 v221, v222
  v_cvt_pk_bf16_f32 v226, 0, v226
  v_cvt_pk_bf16_f32 v227, 0, v227
  v_add_f32 v221, v221, v222
  v_cvt_pk_bf16_f32 v228, 0, v228
  v_cvt_pk_bf16_f32 v229, 0, v229
  v_mov_b32 v222, v221
  v_cvt_pk_bf16_f32 v230, 0, v230
  v_cvt_pk_bf16_f32 v231, 0, v231
  v_permlane32_swap_b32 v221, v222
  v_add_f32 v221, v221, v222
  v_mul_f32 v221, 0x3b000000, v221
  v_cvt_pk_bf16_f32 v221, 0, v221
  v_add_f32 v221, 0x3727c5ac, v221
  v_cvt_pk_bf16_f32 v221, 0, v221
  v_sqrt_f32 v221, v221
  s_nop 0
  v_cvt_pk_bf16_f32 v221, 0, v221
  v_rcp_f32 v221, v221
  s_nop 0
  v_mul_f32 v224, v224, v221
  v_mul_f32 v225, v225, v221
  v_mul_f32 v226, v226, v221
  v_mul_f32 v227, v227, v221
  v_mul_f32 v228, v228, v221
  v_mul_f32 v229, v229, v221
  v_mul_f32 v230, v230, v221
  v_mul_f32 v231, v231, v221
  v_cvt_pk_bf16_f32 v184, v224, v225
  v_cvt_pk_bf16_f32 v185, v226, v227
  v_cvt_pk_bf16_f32 v186, v228, v229
  v_cvt_pk_bf16_f32 v187, v230, v231
  buffer_store_dwordx4 v[184:187], v0, s[4:7], s29 offen sc1
  s_add_u32 s29, s29, 262144
  s_waitcnt vmcnt(40)
  v_lshlrev_b32 v212, 16, v188
  v_and_b32 v213, 0xffff0000, v188
  v_lshlrev_b32 v214, 16, v189
  v_and_b32 v215, 0xffff0000, v189
  v_lshlrev_b32 v216, 16, v190
  v_and_b32 v217, 0xffff0000, v190
  v_lshlrev_b32 v218, 16, v191
  v_and_b32 v219, 0xffff0000, v191
  v_add_f32 v220, v212, v213
  v_add_f32 v221, v214, v215
  v_add_f32 v222, v216, v217
  v_add_f32 v223, v218, v219
  v_add_f32 v220, v220, v221
  v_add_f32 v222, v222, v223
  v_add_f32 v220, v220, v222
  s_nop 1
  v_add_f32_dpp v220, v220, v220 row_ror:8 row_mask:0xf bank_mask:0xf
  s_nop 1
  v_add_f32_dpp v220, v220, v220 row_ror:4 row_mask:0xf bank_mask:0xf
  s_nop 1
  v_add_f32_dpp v220, v220, v220 row_ror:2 row_mask:0xf bank_mask:0xf
  s_nop 1
  v_add_f32_dpp v220, v220, v220 row_ror:1 row_mask:0xf bank_mask:0xf
  v_mov_b32 v222, v220
  s_nop 0
  s_nop 0
  v_permlane16_swap_b32 v220, v222
  v_add_f32 v220, v220, v222
  v_mov_b32 v222, v220
  s_nop 0
  s_nop 0
  v_permlane32_swap_b32 v220, v222
  v_add_f32 v220, v220, v222
  v_mul_f32 v220, 0x3b000000, v220
  v_sub_f32 v224, v212, v220
  v_sub_f32 v225, v213, v220
  v_sub_f32 v226, v214, v220
  v_sub_f32 v227, v215, v220
  v_sub_f32 v228, v216, v220
  v_sub_f32 v229, v217, v220
  v_sub_f32 v230, v218, v220
  v_sub_f32 v231, v219, v220
  v_mul_f32 v221, v224, v224
  v_mul_f32 v222, v225, v225
  v_fmac_f32 v221, v226, v226
  v_fmac_f32 v222, v227, v227
  v_fmac_f32 v221, v228, v228
  v_fmac_f32 v222, v229, v229
  v_fmac_f32 v221, v230, v230
  v_fmac_f32 v222, v231, v231
  v_add_f32 v221, v221, v222
  v_cvt_pk_bf16_f32 v220, 0, v220
  s_nop 0
  v_add_f32_dpp v221, v221, v221 row_ror:8 row_mask:0xf bank_mask:0xf
  v_sub_f32 v224, v212, v220
  v_sub_f32 v225, v213, v220
  v_add_f32_dpp v221, v221, v221 row_ror:4 row_mask:0xf bank_mask:0xf
  v_sub_f32 v226, v214, v220
  v_sub_f32 v227, v215, v220
  v_add_f32_dpp v221, v221, v221 row_ror:2 row_mask:0xf bank_mask:0xf
  v_sub_f32 v228, v216, v220
  v_sub_f32 v229, v217, v220
  v_add_f32_dpp v221, v221, v221 row_ror:1 row_mask:0xf bank_mask:0xf
  v_sub_f32 v230, v218, v220
  v_sub_f32 v231, v219, v220
  v_mov_b32 v222, v221
  v_cvt_pk_bf16_f32 v224, 0, v224
  v_cvt_pk_bf16_f32 v225, 0, v225
  v_permlane16_swap_b32 v221, v222
  v_cvt_pk_bf16_f32 v226, 0, v226
  v_cvt_pk_bf16_f32 v227, 0, v227
  v_add_f32 v221, v221, v222
  v_cvt_pk_bf16_f32 v228, 0, v228
  v_cvt_pk_bf16_f32 v229, 0, v229
  v_mov_b32 v222, v221
  v_cvt_pk_bf16_f32 v230, 0, v230
  v_cvt_pk_bf16_f32 v231, 0, v231
  v_permlane32_swap_b32 v221, v222
  v_add_f32 v221, v221, v222
  v_mul_f32 v221, 0x3b000000, v221
  v_cvt_pk_bf16_f32 v221, 0, v221
  v_add_f32 v221, 0x3727c5ac, v221
  v_cvt_pk_bf16_f32 v221, 0, v221
  v_sqrt_f32 v221, v221
  s_nop 0
  v_cvt_pk_bf16_f32 v221, 0, v221
  v_rcp_f32 v221, v221
  s_nop 0
  v_mul_f32 v224, v224, v221
  v_mul_f32 v225, v225, v221
  v_mul_f32 v226, v226, v221
  v_mul_f32 v227, v227, v221
  v_mul_f32 v228, v228, v221
  v_mul_f32 v229, v229, v221
  v_mul_f32 v230, v230, v221
  v_mul_f32 v231, v231, v221
  v_cvt_pk_bf16_f32 v188, v224, v225
  v_cvt_pk_bf16_f32 v189, v226, v227
  v_cvt_pk_bf16_f32 v190, v228, v229
  v_cvt_pk_bf16_f32 v191, v230, v231
  buffer_store_dwordx4 v[188:191], v0, s[4:7], s29 offen sc1
  s_add_u32 s29, s29, 262144
  s_waitcnt vmcnt(40)
  v_lshlrev_b32 v212, 16, v192
  v_and_b32 v213, 0xffff0000, v192
  v_lshlrev_b32 v214, 16, v193
  v_and_b32 v215, 0xffff0000, v193
  v_lshlrev_b32 v216, 16, v194
  v_and_b32 v217, 0xffff0000, v194
  v_lshlrev_b32 v218, 16, v195
  v_and_b32 v219, 0xffff0000, v195
  v_add_f32 v220, v212, v213
  v_add_f32 v221, v214, v215
  v_add_f32 v222, v216, v217
  v_add_f32 v223, v218, v219
  v_add_f32 v220, v220, v221
  v_add_f32 v222, v222, v223
  v_add_f32 v220, v220, v222
  s_nop 1
  v_add_f32_dpp v220, v220, v220 row_ror:8 row_mask:0xf bank_mask:0xf
  s_nop 1
  v_add_f32_dpp v220, v220, v220 row_ror:4 row_mask:0xf bank_mask:0xf
  s_nop 1
  v_add_f32_dpp v220, v220, v220 row_ror:2 row_mask:0xf bank_mask:0xf
  s_nop 1
  v_add_f32_dpp v220, v220, v220 row_ror:1 row_mask:0xf bank_mask:0xf
  v_mov_b32 v222, v220
  s_nop 0
  s_nop 0
  v_permlane16_swap_b32 v220, v222
  v_add_f32 v220, v220, v222
  v_mov_b32 v222, v220
  s_nop 0
  s_nop 0
  v_permlane32_swap_b32 v220, v222
  v_add_f32 v220, v220, v222
  v_mul_f32 v220, 0x3b000000, v220
  v_sub_f32 v224, v212, v220
  v_sub_f32 v225, v213, v220
  v_sub_f32 v226, v214, v220
  v_sub_f32 v227, v215, v220
  v_sub_f32 v228, v216, v220
  v_sub_f32 v229, v217, v220
  v_sub_f32 v230, v218, v220
  v_sub_f32 v231, v219, v220
  v_mul_f32 v221, v224, v224
  v_mul_f32 v222, v225, v225
  v_fmac_f32 v221, v226, v226
  v_fmac_f32 v222, v227, v227
  v_fmac_f32 v221, v228, v228
  v_fmac_f32 v222, v229, v229
  v_fmac_f32 v221, v230, v230
  v_fmac_f32 v222, v231, v231
  v_add_f32 v221, v221, v222
  v_cvt_pk_bf16_f32 v220, 0, v220
  s_nop 0
  v_add_f32_dpp v221, v221, v221 row_ror:8 row_mask:0xf bank_mask:0xf
  v_sub_f32 v224, v212, v220
  v_sub_f32 v225, v213, v220
  v_add_f32_dpp v221, v221, v221 row_ror:4 row_mask:0xf bank_mask:0xf
  v_sub_f32 v226, v214, v220
  v_sub_f32 v227, v215, v220
  v_add_f32_dpp v221, v221, v221 row_ror:2 row_mask:0xf bank_mask:0xf
  v_sub_f32 v228, v216, v220
  v_sub_f32 v229, v217, v220
  v_add_f32_dpp v221, v221, v221 row_ror:1 row_mask:0xf bank_mask:0xf
  v_sub_f32 v230, v218, v220
  v_sub_f32 v231, v219, v220
  v_mov_b32 v222, v221
  v_cvt_pk_bf16_f32 v224, 0, v224
  v_cvt_pk_bf16_f32 v225, 0, v225
  v_permlane16_swap_b32 v221, v222
  v_cvt_pk_bf16_f32 v226, 0, v226
  v_cvt_pk_bf16_f32 v227, 0, v227
  v_add_f32 v221, v221, v222
  v_cvt_pk_bf16_f32 v228, 0, v228
  v_cvt_pk_bf16_f32 v229, 0, v229
  v_mov_b32 v222, v221
  v_cvt_pk_bf16_f32 v230, 0, v230
  v_cvt_pk_bf16_f32 v231, 0, v231
  v_permlane32_swap_b32 v221, v222
  v_add_f32 v221, v221, v222
  v_mul_f32 v221, 0x3b000000, v221
  v_cvt_pk_bf16_f32 v221, 0, v221
  v_add_f32 v221, 0x3727c5ac, v221
  v_cvt_pk_bf16_f32 v221, 0, v221
  v_sqrt_f32 v221, v221
  s_nop 0
  v_cvt_pk_bf16_f32 v221, 0, v221
  v_rcp_f32 v221, v221
  s_nop 0
  v_mul_f32 v224, v224, v221
  v_mul_f32 v225, v225, v221
  v_mul_f32 v226, v226, v221
  v_mul_f32 v227, v227, v221
  v_mul_f32 v228, v228, v221
  v_mul_f32 v229, v229, v221
  v_mul_f32 v230, v230, v221
  v_mul_f32 v231, v231, v221
  v_cvt_pk_bf16_f32 v192, v224, v225
  v_cvt_pk_bf16_f32 v193, v226, v227
  v_cvt_pk_bf16_f32 v194, v228, v229
  v_cvt_pk_bf16_f32 v195, v230, v231
  buffer_store_dwordx4 v[192:195], v0, s[4:7], s29 offen sc1
  s_add_u32 s29, s29, 262144
  s_waitcnt vmcnt(40)
  v_lshlrev_b32 v212, 16, v196
  v_and_b32 v213, 0xffff0000, v196
  v_lshlrev_b32 v214, 16, v197
  v_and_b32 v215, 0xffff0000, v197
  v_lshlrev_b32 v216, 16, v198
  v_and_b32 v217, 0xffff0000, v198
  v_lshlrev_b32 v218, 16, v199
  v_and_b32 v219, 0xffff0000, v199
  v_add_f32 v220, v212, v213
  v_add_f32 v221, v214, v215
  v_add_f32 v222, v216, v217
  v_add_f32 v223, v218, v219
  v_add_f32 v220, v220, v221
  v_add_f32 v222, v222, v223
  v_add_f32 v220, v220, v222
  s_nop 1
  v_add_f32_dpp v220, v220, v220 row_ror:8 row_mask:0xf bank_mask:0xf
  s_nop 1
  v_add_f32_dpp v220, v220, v220 row_ror:4 row_mask:0xf bank_mask:0xf
  s_nop 1
  v_add_f32_dpp v220, v220, v220 row_ror:2 row_mask:0xf bank_mask:0xf
  s_nop 1
  v_add_f32_dpp v220, v220, v220 row_ror:1 row_mask:0xf bank_mask:0xf
  v_mov_b32 v222, v220
  s_nop 0
  s_nop 0
  v_permlane16_swap_b32 v220, v222
  v_add_f32 v220, v220, v222
  v_mov_b32 v222, v220
  s_nop 0
  s_nop 0
  v_permlane32_swap_b32 v220, v222
  v_add_f32 v220, v220, v222
  v_mul_f32 v220, 0x3b000000, v220
  v_sub_f32 v224, v212, v220
  v_sub_f32 v225, v213, v220
  v_sub_f32 v226, v214, v220
  v_sub_f32 v227, v215, v220
  v_sub_f32 v228, v216, v220
  v_sub_f32 v229, v217, v220
  v_sub_f32 v230, v218, v220
  v_sub_f32 v231, v219, v220
  v_mul_f32 v221, v224, v224
  v_mul_f32 v222, v225, v225
  v_fmac_f32 v221, v226, v226
  v_fmac_f32 v222, v227, v227
  v_fmac_f32 v221, v228, v228
  v_fmac_f32 v222, v229, v229
  v_fmac_f32 v221, v230, v230
  v_fmac_f32 v222, v231, v231
  v_add_f32 v221, v221, v222
  v_cvt_pk_bf16_f32 v220, 0, v220
  s_nop 0
  v_add_f32_dpp v221, v221, v221 row_ror:8 row_mask:0xf bank_mask:0xf
  v_sub_f32 v224, v212, v220
  v_sub_f32 v225, v213, v220
  v_add_f32_dpp v221, v221, v221 row_ror:4 row_mask:0xf bank_mask:0xf
  v_sub_f32 v226, v214, v220
  v_sub_f32 v227, v215, v220
  v_add_f32_dpp v221, v221, v221 row_ror:2 row_mask:0xf bank_mask:0xf
  v_sub_f32 v228, v216, v220
  v_sub_f32 v229, v217, v220
  v_add_f32_dpp v221, v221, v221 row_ror:1 row_mask:0xf bank_mask:0xf
  v_sub_f32 v230, v218, v220
  v_sub_f32 v231, v219, v220
  v_mov_b32 v222, v221
  v_cvt_pk_bf16_f32 v224, 0, v224
  v_cvt_pk_bf16_f32 v225, 0, v225
  v_permlane16_swap_b32 v221, v222
  v_cvt_pk_bf16_f32 v226, 0, v226
  v_cvt_pk_bf16_f32 v227, 0, v227
  v_add_f32 v221, v221, v222
  v_cvt_pk_bf16_f32 v228, 0, v228
  v_cvt_pk_bf16_f32 v229, 0, v229
  v_mov_b32 v222, v221
  v_cvt_pk_bf16_f32 v230, 0, v230
  v_cvt_pk_bf16_f32 v231, 0, v231
  v_permlane32_swap_b32 v221, v222
  v_add_f32 v221, v221, v222
  v_mul_f32 v221, 0x3b000000, v221
  v_cvt_pk_bf16_f32 v221, 0, v221
  v_add_f32 v221, 0x3727c5ac, v221
  v_cvt_pk_bf16_f32 v221, 0, v221
  v_sqrt_f32 v221, v221
  s_nop 0
  v_cvt_pk_bf16_f32 v221, 0, v221
  v_rcp_f32 v221, v221
  s_nop 0
  v_mul_f32 v224, v224, v221
  v_mul_f32 v225, v225, v221
  v_mul_f32 v226, v226, v221
  v_mul_f32 v227, v227, v221
  v_mul_f32 v228, v228, v221
  v_mul_f32 v229, v229, v221
  v_mul_f32 v230, v230, v221
  v_mul_f32 v231, v231, v221
  v_cvt_pk_bf16_f32 v196, v224, v225
  v_cvt_pk_bf16_f32 v197, v226, v227
  v_cvt_pk_bf16_f32 v198, v228, v229
  v_cvt_pk_bf16_f32 v199, v230, v231
  buffer_store_dwordx4 v[196:199], v0, s[4:7], s29 offen sc1
  s_add_u32 s29, s29, 262144
  s_waitcnt vmcnt(40)
  v_lshlrev_b32 v212, 16, v200
  v_and_b32 v213, 0xffff0000, v200
  v_lshlrev_b32 v214, 16, v201
  v_and_b32 v215, 0xffff0000, v201
  v_lshlrev_b32 v216, 16, v202
  v_and_b32 v217, 0xffff0000, v202
  v_lshlrev_b32 v218, 16, v203
  v_and_b32 v219, 0xffff0000, v203
  v_add_f32 v220, v212, v213
  v_add_f32 v221, v214, v215
  v_add_f32 v222, v216, v217
  v_add_f32 v223, v218, v219
  v_add_f32 v220, v220, v221
  v_add_f32 v222, v222, v223
  v_add_f32 v220, v220, v222
  s_nop 1
  v_add_f32_dpp v220, v220, v220 row_ror:8 row_mask:0xf bank_mask:0xf
  s_nop 1
  v_add_f32_dpp v220, v220, v220 row_ror:4 row_mask:0xf bank_mask:0xf
  s_nop 1
  v_add_f32_dpp v220, v220, v220 row_ror:2 row_mask:0xf bank_mask:0xf
  s_nop 1
  v_add_f32_dpp v220, v220, v220 row_ror:1 row_mask:0xf bank_mask:0xf
  v_mov_b32 v222, v220
  s_nop 0
  s_nop 0
  v_permlane16_swap_b32 v220, v222
  v_add_f32 v220, v220, v222
  v_mov_b32 v222, v220
  s_nop 0
  s_nop 0
  v_permlane32_swap_b32 v220, v222
  v_add_f32 v220, v220, v222
  v_mul_f32 v220, 0x3b000000, v220
  v_sub_f32 v224, v212, v220
  v_sub_f32 v225, v213, v220
  v_sub_f32 v226, v214, v220
  v_sub_f32 v227, v215, v220
  v_sub_f32 v228, v216, v220
  v_sub_f32 v229, v217, v220
  v_sub_f32 v230, v218, v220
  v_sub_f32 v231, v219, v220
  v_mul_f32 v221, v224, v224
  v_mul_f32 v222, v225, v225
  v_fmac_f32 v221, v226, v226
  v_fmac_f32 v222, v227, v227
  v_fmac_f32 v221, v228, v228
  v_fmac_f32 v222, v229, v229
  v_fmac_f32 v221, v230, v230
  v_fmac_f32 v222, v231, v231
  v_add_f32 v221, v221, v222
  v_cvt_pk_bf16_f32 v220, 0, v220
  s_nop 0
  v_add_f32_dpp v221, v221, v221 row_ror:8 row_mask:0xf bank_mask:0xf
  v_sub_f32 v224, v212, v220
  v_sub_f32 v225, v213, v220
  v_add_f32_dpp v221, v221, v221 row_ror:4 row_mask:0xf bank_mask:0xf
  v_sub_f32 v226, v214, v220
  v_sub_f32 v227, v215, v220
  v_add_f32_dpp v221, v221, v221 row_ror:2 row_mask:0xf bank_mask:0xf
  v_sub_f32 v228, v216, v220
  v_sub_f32 v229, v217, v220
  v_add_f32_dpp v221, v221, v221 row_ror:1 row_mask:0xf bank_mask:0xf
  v_sub_f32 v230, v218, v220
  v_sub_f32 v231, v219, v220
  v_mov_b32 v222, v221
  v_cvt_pk_bf16_f32 v224, 0, v224
  v_cvt_pk_bf16_f32 v225, 0, v225
  v_permlane16_swap_b32 v221, v222
  v_cvt_pk_bf16_f32 v226, 0, v226
  v_cvt_pk_bf16_f32 v227, 0, v227
  v_add_f32 v221, v221, v222
  v_cvt_pk_bf16_f32 v228, 0, v228
  v_cvt_pk_bf16_f32 v229, 0, v229
  v_mov_b32 v222, v221
  v_cvt_pk_bf16_f32 v230, 0, v230
  v_cvt_pk_bf16_f32 v231, 0, v231
  v_permlane32_swap_b32 v221, v222
  v_add_f32 v221, v221, v222
  v_mul_f32 v221, 0x3b000000, v221
  v_cvt_pk_bf16_f32 v221, 0, v221
  v_add_f32 v221, 0x3727c5ac, v221
  v_cvt_pk_bf16_f32 v221, 0, v221
  v_sqrt_f32 v221, v221
  s_nop 0
  v_cvt_pk_bf16_f32 v221, 0, v221
  v_rcp_f32 v221, v221
  s_nop 0
  v_mul_f32 v224, v224, v221
  v_mul_f32 v225, v225, v221
  v_mul_f32 v226, v226, v221
  v_mul_f32 v227, v227, v221
  v_mul_f32 v228, v228, v221
  v_mul_f32 v229, v229, v221
  v_mul_f32 v230, v230, v221
  v_mul_f32 v231, v231, v221
  v_cvt_pk_bf16_f32 v200, v224, v225
  v_cvt_pk_bf16_f32 v201, v226, v227
  v_cvt_pk_bf16_f32 v202, v228, v229
  v_cvt_pk_bf16_f32 v203, v230, v231
  buffer_store_dwordx4 v[200:203], v0, s[4:7], s29 offen sc1
  s_add_u32 s29, s29, 262144
  s_waitcnt vmcnt(40)
  v_lshlrev_b32 v212, 16, v204
  v_and_b32 v213, 0xffff0000, v204
  v_lshlrev_b32 v214, 16, v205
  v_and_b32 v215, 0xffff0000, v205
  v_lshlrev_b32 v216, 16, v206
  v_and_b32 v217, 0xffff0000, v206
  v_lshlrev_b32 v218, 16, v207
  v_and_b32 v219, 0xffff0000, v207
  v_add_f32 v220, v212, v213
  v_add_f32 v221, v214, v215
  v_add_f32 v222, v216, v217
  v_add_f32 v223, v218, v219
  v_add_f32 v220, v220, v221
  v_add_f32 v222, v222, v223
  v_add_f32 v220, v220, v222
  s_nop 1
  v_add_f32_dpp v220, v220, v220 row_ror:8 row_mask:0xf bank_mask:0xf
  s_nop 1
  v_add_f32_dpp v220, v220, v220 row_ror:4 row_mask:0xf bank_mask:0xf
  s_nop 1
  v_add_f32_dpp v220, v220, v220 row_ror:2 row_mask:0xf bank_mask:0xf
  s_nop 1
  v_add_f32_dpp v220, v220, v220 row_ror:1 row_mask:0xf bank_mask:0xf
  v_mov_b32 v222, v220
  s_nop 0
  s_nop 0
  v_permlane16_swap_b32 v220, v222
  v_add_f32 v220, v220, v222
  v_mov_b32 v222, v220
  s_nop 0
  s_nop 0
  v_permlane32_swap_b32 v220, v222
  v_add_f32 v220, v220, v222
  v_mul_f32 v220, 0x3b000000, v220
  v_sub_f32 v224, v212, v220
  v_sub_f32 v225, v213, v220
  v_sub_f32 v226, v214, v220
  v_sub_f32 v227, v215, v220
  v_sub_f32 v228, v216, v220
  v_sub_f32 v229, v217, v220
  v_sub_f32 v230, v218, v220
  v_sub_f32 v231, v219, v220
  v_mul_f32 v221, v224, v224
  v_mul_f32 v222, v225, v225
  v_fmac_f32 v221, v226, v226
  v_fmac_f32 v222, v227, v227
  v_fmac_f32 v221, v228, v228
  v_fmac_f32 v222, v229, v229
  v_fmac_f32 v221, v230, v230
  v_fmac_f32 v222, v231, v231
  v_add_f32 v221, v221, v222
  v_cvt_pk_bf16_f32 v220, 0, v220
  s_nop 0
  v_add_f32_dpp v221, v221, v221 row_ror:8 row_mask:0xf bank_mask:0xf
  v_sub_f32 v224, v212, v220
  v_sub_f32 v225, v213, v220
  v_add_f32_dpp v221, v221, v221 row_ror:4 row_mask:0xf bank_mask:0xf
  v_sub_f32 v226, v214, v220
  v_sub_f32 v227, v215, v220
  v_add_f32_dpp v221, v221, v221 row_ror:2 row_mask:0xf bank_mask:0xf
  v_sub_f32 v228, v216, v220
  v_sub_f32 v229, v217, v220
  v_add_f32_dpp v221, v221, v221 row_ror:1 row_mask:0xf bank_mask:0xf
  v_sub_f32 v230, v218, v220
  v_sub_f32 v231, v219, v220
  v_mov_b32 v222, v221
  v_cvt_pk_bf16_f32 v224, 0, v224
  v_cvt_pk_bf16_f32 v225, 0, v225
  v_permlane16_swap_b32 v221, v222
  v_cvt_pk_bf16_f32 v226, 0, v226
  v_cvt_pk_bf16_f32 v227, 0, v227
  v_add_f32 v221, v221, v222
  v_cvt_pk_bf16_f32 v228, 0, v228
  v_cvt_pk_bf16_f32 v229, 0, v229
  v_mov_b32 v222, v221
  v_cvt_pk_bf16_f32 v230, 0, v230
  v_cvt_pk_bf16_f32 v231, 0, v231
  v_permlane32_swap_b32 v221, v222
  v_add_f32 v221, v221, v222
  v_mul_f32 v221, 0x3b000000, v221
  v_cvt_pk_bf16_f32 v221, 0, v221
  v_add_f32 v221, 0x3727c5ac, v221
  v_cvt_pk_bf16_f32 v221, 0, v221
  v_sqrt_f32 v221, v221
  s_nop 0
  v_cvt_pk_bf16_f32 v221, 0, v221
  v_rcp_f32 v221, v221
  s_nop 0
  v_mul_f32 v224, v224, v221
  v_mul_f32 v225, v225, v221
  v_mul_f32 v226, v226, v221
  v_mul_f32 v227, v227, v221
  v_mul_f32 v228, v228, v221
  v_mul_f32 v229, v229, v221
  v_mul_f32 v230, v230, v221
  v_mul_f32 v231, v231, v221
  v_cvt_pk_bf16_f32 v204, v224, v225
  v_cvt_pk_bf16_f32 v205, v226, v227
  v_cvt_pk_bf16_f32 v206, v228, v229
  v_cvt_pk_bf16_f32 v207, v230, v231
  buffer_store_dwordx4 v[204:207], v0, s[4:7], s29 offen sc1
  s_add_u32 s29, s29, 262144
o_s2_118:
  s_waitcnt vmcnt(33)
  v_perm_b32 v48, v66, v64, s44
  v_perm_b32 v49, v70, v68, s44
  v_perm_b32 v50, v74, v72, s44
  v_perm_b32 v51, v78, v76, s44
  v_accvgpr_write_b32 a0, v48
  v_accvgpr_write_b32 a1, v49
  v_accvgpr_write_b32 a2, v50
  v_accvgpr_write_b32 a3, v51
  v_perm_b32 v52, v66, v64, s45
  v_perm_b32 v53, v70, v68, s45
  v_perm_b32 v54, v74, v72, s45
  v_perm_b32 v55, v78, v76, s45
  v_accvgpr_write_b32 a4, v52
  v_accvgpr_write_b32 a5, v53
  v_accvgpr_write_b32 a6, v54
  v_accvgpr_write_b32 a7, v55
  v_perm_b32 v48, v67, v65, s44
  v_perm_b32 v49, v71, v69, s44
  v_perm_b32 v50, v75, v73, s44
  v_perm_b32 v51, v79, v77, s44
  v_accvgpr_write_b32 a8, v48
  v_accvgpr_write_b32 a9, v49
  v_accvgpr_write_b32 a10, v50
  v_accvgpr_write_b32 a11, v51
  v_perm_b32 v52, v67, v65, s45
  v_perm_b32 v53, v71, v69, s45
  v_perm_b32 v54, v75, v73, s45
  v_perm_b32 v55, v79, v77, s45
  v_accvgpr_write_b32 a12, v52
  v_accvgpr_write_b32 a13, v53
  v_accvgpr_write_b32 a14, v54
  v_accvgpr_write_b32 a15, v55
  s_waitcnt vmcnt(25)
  v_perm_b32 v48, v82, v80, s44
  v_perm_b32 v49, v86, v84, s44
  v_perm_b32 v50, v90, v88, s44
  v_perm_b32 v51, v94, v92, s44
  v_accvgpr_write_b32 a16, v48
  v_accvgpr_write_b32 a17, v49
  v_accvgpr_write_b32 a18, v50
  v_accvgpr_write_b32 a19, v51
  v_perm_b32 v52, v82, v80, s45
  v_perm_b32 v53, v86, v84, s45
  v_perm_b32 v54, v90, v88, s45
  v_perm_b32 v55, v94, v92, s45
  v_accvgpr_write_b32 a20, v52
  v_accvgpr_write_b32 a21, v53
  v_accvgpr_write_b32 a22, v54
  v_accvgpr_write_b32 a23, v55
  v_perm_b32 v48, v83, v81, s44
  v_perm_b32 v49, v87, v85, s44
  v_perm_b32 v50, v91, v89, s44
  v_perm_b32 v51, v95, v93, s44
  v_accvgpr_write_b32 a24, v48
  v_accvgpr_write_b32 a25, v49
  v_accvgpr_write_b32 a26, v50
  v_accvgpr_write_b32 a27, v51
  v_perm_b32 v52, v83, v81, s45
  v_perm_b32 v53, v87, v85, s45
  v_perm_b32 v54, v91, v89, s45
  v_perm_b32 v55, v95, v93, s45
  v_accvgpr_write_b32 a28, v52
  v_accvgpr_write_b32 a29, v53
  v_accvgpr_write_b32 a30, v54
  v_accvgpr_write_b32 a31, v55
  s_waitcnt vmcnt(17)
  v_perm_b32 v48, v98, v96, s44
  v_perm_b32 v49, v102, v100, s44
  v_perm_b32 v50, v106, v104, s44
  v_perm_b32 v51, v110, v108, s44
  v_accvgpr_write_b32 a32, v48
  v_accvgpr_write_b32 a33, v49
  v_accvgpr_write_b32 a34, v50
  v_accvgpr_write_b32 a35, v51
  v_perm_b32 v52, v98, v96, s45
  v_perm_b32 v53, v102, v100, s45
  v_perm_b32 v54, v106, v104, s45
  v_perm_b32 v55, v110, v108, s45
  v_accvgpr_write_b32 a36, v52
  v_accvgpr_write_b32 a37, v53
  v_accvgpr_write_b32 a38, v54
  v_accvgpr_write_b32 a39, v55
  v_perm_b32 v48, v99, v97, s44
  v_perm_b32 v49, v103, v101, s44
  v_perm_b32 v50, v107, v105, s44
  v_perm_b32 v51, v111, v109, s44
  v_accvgpr_write_b32 a40, v48
  v_accvgpr_write_b32 a41, v49
  v_accvgpr_write_b32 a42, v50
  v_accvgpr_write_b32 a43, v51
  v_perm_b32 v52, v99, v97, s45
  v_perm_b32 v53, v103, v101, s45
  v_perm_b32 v54, v107, v105, s45
  v_perm_b32 v55, v111, v109, s45
  v_accvgpr_write_b32 a44, v52
  v_accvgpr_write_b32 a45, v53
  v_accvgpr_write_b32 a46, v54
  v_accvgpr_write_b32 a47, v55
  s_waitcnt vmcnt(9)
  v_perm_b32 v48, v114, v112, s44
  v_perm_b32 v49, v118, v116, s44
  v_perm_b32 v50, v122, v120, s44
  v_perm_b32 v51, v126, v124, s44
  v_accvgpr_write_b32 a48, v48
  v_accvgpr_write_b32 a49, v49
  v_accvgpr_write_b32 a50, v50
  v_accvgpr_write_b32 a51, v51
  v_perm_b32 v52, v114, v112, s45
  v_perm_b32 v53, v118, v116, s45
  v_perm_b32 v54, v122, v120, s45
  v_perm_b32 v55, v126, v124, s45
  v_accvgpr_write_b32 a52, v52
  v_accvgpr_write_b32 a53, v53
  v_accvgpr_write_b32 a54, v54
  v_accvgpr_write_b32 a55, v55
  v_perm_b32 v48, v115, v113, s44
  v_perm_b32 v49, v119, v117, s44
  v_perm_b32 v50, v123, v121, s44
  v_perm_b32 v51, v127, v125, s44
  v_accvgpr_write_b32 a56, v48
  v_accvgpr_write_b32 a57, v49
  v_accvgpr_write_b32 a58, v50
  v_accvgpr_write_b32 a59, v51
  v_perm_b32 v52, v115, v113, s45
  v_perm_b32 v53, v119, v117, s45
  v_perm_b32 v54, v123, v121, s45
  v_perm_b32 v55, v127, v125, s45
  v_accvgpr_write_b32 a60, v52
  v_accvgpr_write_b32 a61, v53
  v_accvgpr_write_b32 a62, v54
  v_accvgpr_write_b32 a63, v55
  s_cmp_ge_u32 s60, 4
  s_cbranch_scc1 o_s3_119
  v_mbcnt_lo_u32_b32 v60, -1, 0
  v_and_b32 v60, 0, v60
  v_add_lshl_u32 v60, v60, 1, 2
  s_mov_b32 s26, 0
g_wt_120:
  global_load_dword v61, v60, s[12:13] offset:128 sc1
  s_add_u32 s26, s26, 1
  s_cmp_gt_u32 s26, 1048576
  s_cbranch_scc1 L_end
  s_waitcnt vmcnt(0)
  v_cmp_eq_u32 vcc, 0, v61
  v_readfirstlane_b32 s27, v61
  s_cbranch_vccnz g_wt_120
  s_lshl_b32 s27, s77, 7
  s_add_u32 s27, s27, 243269632
  v_lshlrev_b32 v61, 11, v0
  v_mov_b32 v60, 1
  s_mov_b64 exec, 255
  buffer_store_dword v60, v61, s[4:7], s27 offen sc1
  s_mov_b64 exec, -1
o_s3_119:
  s_add_u32 s27, s30, 65536
  buffer_load_dwordx2 v[128:129], v44, s[80:83], s27 offen
  s_add_u32 s27, s30, 66560
  buffer_load_dwordx2 v[130:131], v44, s[80:83], s27 offen
  s_add_u32 s27, s30, 67584
  buffer_load_dwordx2 v[132:133], v44, s[80:83], s27 offen
  s_add_u32 s27, s30, 68608
  buffer_load_dwordx2 v[134:135], v44, s[80:83], s27 offen
  s_add_u32 s27, s30, 81920
  buffer_load_dwordx2 v[136:137], v44, s[80:83], s27 offen
  s_add_u32 s27, s30, 82944
  buffer_load_dwordx2 v[138:139], v44, s[80:83], s27 offen
  s_add_u32 s27, s30, 83968
  buffer_load_dwordx2 v[140:141], v44, s[80:83], s27 offen
  s_add_u32 s27, s30, 84992
  buffer_load_dwordx2 v[142:143], v44, s[80:83], s27 offen
  s_add_u32 s27, s30, 73728
  buffer_load_dwordx2 v[144:145], v44, s[80:83], s27 offen
  s_add_u32 s27, s30, 74752
  buffer_load_dwordx2 v[146:147], v44, s[80:83], s27 offen
  s_add_u32 s27, s30, 75776
  buffer_load_dwordx2 v[148:149], v44, s[80:83], s27 offen
  s_add_u32 s27, s30, 76800
  buffer_load_dwordx2 v[150:151], v44, s[80:83], s27 offen
  s_add_u32 s27, s30, 90112
  buffer_load_dwordx2 v[152:153], v44, s[80:83], s27 offen
  s_add_u32 s27, s30, 91136
  buffer_load_dwordx2 v[154:155], v44, s[80:83], s27 offen
  s_add_u32 s27, s30, 92160
  buffer_load_dwordx2 v[156:157], v44, s[80:83], s27 offen
  s_add_u32 s27, s30, 93184
  buffer_load_dwordx2 v[158:159], v44, s[80:83], s27 offen
  s_add_u32 s27, s30, 98304
  buffer_load_dwordx2 v[160:161], v44, s[80:83], s27 offen
  s_add_u32 s27, s30, 99328
  buffer_load_dwordx2 v[162:163], v44, s[80:83], s27 offen
  s_add_u32 s27, s30, 100352
  buffer_load_dwordx2 v[164:165], v44, s[80:83], s27 offen
  s_add_u32 s27, s30, 101376
  buffer_load_dwordx2 v[166:167], v44, s[80:83], s27 offen
  s_add_u32 s27, s30, 114688
  buffer_load_dwordx2 v[168:169], v44, s[80:83], s27 offen
  s_add_u32 s27, s30, 115712
  buffer_load_dwordx2 v[170:171], v44, s[80:83], s27 offen
  s_add_u32 s27, s30, 116736
  buffer_load_dwordx2 v[172:173], v44, s[80:83], s27 offen
  s_add_u32 s27, s30, 117760
  buffer_load_dwordx2 v[174:175], v44, s[80:83], s27 offen
  s_add_u32 s27, s30, 106496
  buffer_load_dwordx2 v[64:65], v44, s[80:83], s27 offen
  s_add_u32 s27, s30, 107520
  buffer_load_dwordx2 v[66:67], v44, s[80:83], s27 offen
  s_add_u32 s27, s30, 108544
  buffer_load_dwordx2 v[68:69], v44, s[80:83], s27 offen
  s_add_u32 s27, s30, 109568
  buffer_load_dwordx2 v[70:71], v44, s[80:83], s27 offen
  s_add_u32 s27, s30, 122880
  buffer_load_dwordx2 v[72:73], v44, s[80:83], s27 offen
  s_add_u32 s27, s30, 123904
  buffer_load_dwordx2 v[74:75], v44, s[80:83], s27 offen
  s_add_u32 s27, s30, 124928
  buffer_load_dwordx2 v[76:77], v44, s[80:83], s27 offen
  s_add_u32 s27, s30, 125952
  buffer_load_dwordx2 v[78:79], v44, s[80:83], s27 offen
  s_add_u32 s27, s30, 131072
  buffer_load_dwordx2 v[80:81], v44, s[80:83], s27 offen
  s_add_u32 s27, s30, 132096
  buffer_load_dwordx2 v[82:83], v44, s[80:83], s27 offen
  s_add_u32 s27, s30, 133120
  buffer_load_dwordx2 v[84:85], v44, s[80:83], s27 offen
  s_add_u32 s27, s30, 134144
  buffer_load_dwordx2 v[86:87], v44, s[80:83], s27 offen
  s_add_u32 s27, s30, 147456
  buffer_load_dwordx2 v[88:89], v44, s[80:83], s27 offen
  s_add_u32 s27, s30, 148480
  buffer_load_dwordx2 v[90:91], v44, s[80:83], s27 offen
  s_add_u32 s27, s30, 149504
  buffer_load_dwordx2 v[92:93], v44, s[80:83], s27 offen
  s_add_u32 s27, s30, 150528
  buffer_load_dwordx2 v[94:95], v44, s[80:83], s27 offen
  s_add_u32 s27, s30, 139264
  buffer_load_dwordx2 v[96:97], v44, s[80:83], s27 offen
  s_add_u32 s27, s30, 140288
  buffer_load_dwordx2 v[98:99], v44, s[80:83], s27 offen
  s_add_u32 s27, s30, 141312
  buffer_load_dwordx2 v[100:101], v44, s[80:83], s27 offen
  s_add_u32 s27, s30, 142336
  buffer_load_dwordx2 v[102:103], v44, s[80:83], s27 offen
  s_add_u32 s27, s30, 155648
  buffer_load_dwordx2 v[104:105], v44, s[80:83], s27 offen
  s_add_u32 s27, s30, 156672
  buffer_load_dwordx2 v[106:107], v44, s[80:83], s27 offen
  s_add_u32 s27, s30, 157696
  buffer_load_dwordx2 v[108:109], v44, s[80:83], s27 offen
  s_add_u32 s27, s30, 158720
  buffer_load_dwordx2 v[110:111], v44, s[80:83], s27 offen
  s_add_u32 s27, s30, 163840
  buffer_load_dwordx2 v[112:113], v44, s[80:83], s27 offen
  s_add_u32 s27, s30, 164864
  buffer_load_dwordx2 v[114:115], v44, s[80:83], s27 offen
  s_add_u32 s27, s30, 165888
  buffer_load_dwordx2 v[116:117], v44, s[80:83], s27 offen
  s_add_u32 s27, s30, 166912
  buffer_load_dwordx2 v[118:119], v44, s[80:83], s27 offen
  s_add_u32 s27, s30, 180224
  buffer_load_dwordx2 v[120:121], v44, s[80:83], s27 offen
  s_add_u32 s27, s30, 181248
  buffer_load_dwordx2 v[122:123], v44, s[80:83], s27 offen
  s_add_u32 s27, s30, 182272
  buffer_load_dwordx2 v[124:125], v44, s[80:83], s27 offen
  s_add_u32 s27, s30, 183296
  buffer_load_dwordx2 v[126:127], v44, s[80:83], s27 offen
  v_lshlrev_b32 v8, 16, v56
  v_and_b32 v9, 0xffff0000, v56
  v_lshlrev_b32 v10, 16, v57
  v_and_b32 v11, 0xffff0000, v57
  v_lshlrev_b32 v12, 16, v58
  v_and_b32 v13, 0xffff0000, v58
  v_lshlrev_b32 v14, 16, v59
  v_and_b32 v15, 0xffff0000, v59
  v_mul_f32 v56, v8, v8
  v_fmac_f32 v56, v9, v9
  v_fmac_f32 v56, v10, v10
  v_fmac_f32 v56, v11, v11
  v_fmac_f32 v56, v12, v12
  v_fmac_f32 v56, v13, v13
  v_fmac_f32 v56, v14, v14
  v_fmac_f32 v56, v15, v15
  s_nop 0
  s_nop 0
  v_add_f32_dpp v56, v56, v56 row_ror:8 row_mask:0xf bank_mask:0xf
  s_nop 1
  v_add_f32_dpp v56, v56, v56 row_ror:4 row_mask:0xf bank_mask:0xf
  s_nop 1
  v_add_f32_dpp v56, v56, v56 row_ror:2 row_mask:0xf bank_mask:0xf
  s_nop 1
  v_add_f32_dpp v56, v56, v56 row_ror:1 row_mask:0xf bank_mask:0xf
  v_mov_b32 v57, v56
  s_nop 0
  s_nop 0
  v_permlane16_swap_b32 v56, v57
  v_add_f32 v56, v56, v57
  v_mov_b32 v57, v56
  s_nop 0
  s_nop 0
  v_permlane32_swap_b32 v56, v57
  v_add_f32 v56, v56, v57
  v_sqrt_f32 v56, v56
  s_mov_b32 s28, 0x404d8eb7
  v_writelane_b32 v247, s28, 0
  s_mov_b32 s28, 0x404d8eb7
  v_writelane_b32 v247, s28, 1
  s_mov_b32 s28, 0x404cc30f
  v_writelane_b32 v247, s28, 2
  s_mov_b32 s28, 0x404ba22b
  v_writelane_b32 v247, s28, 3
  s_mov_b32 s28, 0x404a6ab0
  v_writelane_b32 v247, s28, 4
  s_mov_b32 s28, 0x404918ea
  v_writelane_b32 v247, s28, 5
  s_mov_b32 s28, 0x4047a82a
  v_writelane_b32 v247, s28, 6
  s_mov_b32 s28, 0x40461267
  v_writelane_b32 v247, s28, 7
  s_mov_b32 s28, 0x40444faa
  v_writelane_b32 v247, s28, 8
  s_mov_b32 s28, 0x40425526
  v_writelane_b32 v247, s28, 9
  s_mov_b32 s28, 0x404013b2
  v_writelane_b32 v247, s28, 10
  s_mov_b32 s28, 0x403d751c
  v_writelane_b32 v247, s28, 11
  s_mov_b32 s28, 0x403a570a
  v_writelane_b32 v247, s28, 12
  s_mov_b32 s28, 0x4036803f
  v_writelane_b32 v247, s28, 13
  s_mov_b32 s28, 0x403186a2
  v_writelane_b32 v247, s28, 14
  s_mov_b32 s28, 0x402a8231
  v_writelane_b32 v247, s28, 15
  s_mov_b32 s28, 0x401ec2e6
  v_writelane_b32 v247, s28, 16
  s_mov_b32 s28, 0x3ff46943
  v_writelane_b32 v247, s28, 17
  s_mov_b32 s28, 0x3ff46943
  v_writelane_b32 v247, s28, 18
  v_mul_f32 v247, v247, v56
  v_or_b32 v247, 0x80000000, v247
  s_lshl_b32 s29, s61, 2
  s_add_u32 s29, s29, s17
  s_lshl_b32 s29, s29, 13
  s_add_u32 s29, s29, s41
  s_cmp_ge_u32 s60, 4
  s_cselect_b32 s29, 268435456, s29
  v_mov_b64 v[208:209], 0
  v_mov_b64 v[210:211], 0
  s_waitcnt vmcnt(48)
  v_perm_b32 v48, v130, v128, s44
  v_perm_b32 v49, v134, v132, s44
  v_perm_b32 v50, v138, v136, s44
  v_perm_b32 v51, v142, v140, s44
  v_accvgpr_write_b32 a64, v48
  v_accvgpr_write_b32 a65, v49
  v_accvgpr_write_b32 a66, v50
  v_accvgpr_write_b32 a67, v51
  v_perm_b32 v52, v130, v128, s45
  v_perm_b32 v53, v134, v132, s45
  v_perm_b32 v54, v138, v136, s45
  v_perm_b32 v55, v142, v140, s45
  v_accvgpr_write_b32 a68, v52
  v_accvgpr_write_b32 a69, v53
  v_accvgpr_write_b32 a70, v54
  v_accvgpr_write_b32 a71, v55
  v_perm_b32 v48, v131, v129, s44
  v_perm_b32 v49, v135, v133, s44
  v_perm_b32 v50, v139, v137, s44
  v_perm_b32 v51, v143, v141, s44
  v_accvgpr_write_b32 a72, v48
  v_accvgpr_write_b32 a73, v49
  v_accvgpr_write_b32 a74, v50
  v_accvgpr_write_b32 a75, v51
  v_perm_b32 v52, v131, v129, s45
  v_perm_b32 v53, v135, v133, s45
  v_perm_b32 v54, v139, v137, s45
  v_perm_b32 v55, v143, v141, s45
  v_accvgpr_write_b32 a76, v52
  v_accvgpr_write_b32 a77, v53
  v_accvgpr_write_b32 a78, v54
  v_accvgpr_write_b32 a79, v55
  s_add_u32 s27, s30, 172032
  buffer_load_dwordx2 v[128:129], v44, s[80:83], s27 offen
  s_add_u32 s27, s30, 173056
  buffer_load_dwordx2 v[130:131], v44, s[80:83], s27 offen
  s_add_u32 s27, s30, 174080
  buffer_load_dwordx2 v[132:133], v44, s[80:83], s27 offen
  s_add_u32 s27, s30, 175104
  buffer_load_dwordx2 v[134:135], v44, s[80:83], s27 offen
  s_add_u32 s27, s30, 188416
  buffer_load_dwordx2 v[136:137], v44, s[80:83], s27 offen
  s_add_u32 s27, s30, 189440
  buffer_load_dwordx2 v[138:139], v44, s[80:83], s27 offen
  s_add_u32 s27, s30, 190464
  buffer_load_dwordx2 v[140:141], v44, s[80:83], s27 offen
  s_add_u32 s27, s30, 191488
  buffer_load_dwordx2 v[142:143], v44, s[80:83], s27 offen
  s_waitcnt vmcnt(48)
  v_perm_b32 v48, v146, v144, s44
  v_perm_b32 v49, v150, v148, s44
  v_perm_b32 v50, v154, v152, s44
  v_perm_b32 v51, v158, v156, s44
  v_accvgpr_write_b32 a80, v48
  v_accvgpr_write_b32 a81, v49
  v_accvgpr_write_b32 a82, v50
  v_accvgpr_write_b32 a83, v51
  v_perm_b32 v52, v146, v144, s45
  v_perm_b32 v53, v150, v148, s45
  v_perm_b32 v54, v154, v152, s45
  v_perm_b32 v55, v158, v156, s45
  v_accvgpr_write_b32 a84, v52
  v_accvgpr_write_b32 a85, v53
  v_accvgpr_write_b32 a86, v54
  v_accvgpr_write_b32 a87, v55
  v_perm_b32 v48, v147, v145, s44
  v_perm_b32 v49, v151, v149, s44
  v_perm_b32 v50, v155, v153, s44
  v_perm_b32 v51, v159, v157, s44
  v_accvgpr_write_b32 a88, v48
  v_accvgpr_write_b32 a89, v49
  v_accvgpr_write_b32 a90, v50
  v_accvgpr_write_b32 a91, v51
  v_perm_b32 v52, v147, v145, s45
  v_perm_b32 v53, v151, v149, s45
  v_perm_b32 v54, v155, v153, s45
  v_perm_b32 v55, v159, v157, s45
  v_accvgpr_write_b32 a92, v52
  v_accvgpr_write_b32 a93, v53
  v_accvgpr_write_b32 a94, v54
  v_accvgpr_write_b32 a95, v55
  s_add_u32 s27, s30, 196608
  buffer_load_dwordx2 v[144:145], v44, s[80:83], s27 offen
  s_add_u32 s27, s30, 197632
  buffer_load_dwordx2 v[146:147], v44, s[80:83], s27 offen
  s_add_u32 s27, s30, 198656
  buffer_load_dwordx2 v[148:149], v44, s[80:83], s27 offen
  s_add_u32 s27, s30, 199680
  buffer_load_dwordx2 v[150:151], v44, s[80:83], s27 offen
  s_add_u32 s27, s30, 212992
  buffer_load_dwordx2 v[152:153], v44, s[80:83], s27 offen
  s_add_u32 s27, s30, 214016
  buffer_load_dwordx2 v[154:155], v44, s[80:83], s27 offen
  s_add_u32 s27, s30, 215040
  buffer_load_dwordx2 v[156:157], v44, s[80:83], s27 offen
  s_add_u32 s27, s30, 216064
  buffer_load_dwordx2 v[158:159], v44, s[80:83], s27 offen
  s_waitcnt vmcnt(48)
  v_perm_b32 v48, v162, v160, s44
  v_perm_b32 v49, v166, v164, s44
  v_perm_b32 v50, v170, v168, s44
  v_perm_b32 v51, v174, v172, s44
  v_accvgpr_write_b32 a96, v48
  v_accvgpr_write_b32 a97, v49
  v_accvgpr_write_b32 a98, v50
  v_accvgpr_write_b32 a99, v51
  v_perm_b32 v52, v162, v160, s45
  v_perm_b32 v53, v166, v164, s45
  v_perm_b32 v54, v170, v168, s45
  v_perm_b32 v55, v174, v172, s45
  v_accvgpr_write_b32 a100, v52
  v_accvgpr_write_b32 a101, v53
  v_accvgpr_write_b32 a102, v54
  v_accvgpr_write_b32 a103, v55
  v_perm_b32 v48, v163, v161, s44
  v_perm_b32 v49, v167, v165, s44
  v_perm_b32 v50, v171, v169, s44
  v_perm_b32 v51, v175, v173, s44
  v_accvgpr_write_b32 a104, v48
  v_accvgpr_write_b32 a105, v49
  v_accvgpr_write_b32 a106, v50
  v_accvgpr_write_b32 a107, v51
  v_perm_b32 v52, v163, v161, s45
  v_perm_b32 v53, v167, v165, s45
  v_perm_b32 v54, v171, v169, s45
  v_perm_b32 v55, v175, v173, s45
  v_accvgpr_write_b32 a108, v52
  v_accvgpr_write_b32 a109, v53
  v_accvgpr_write_b32 a110, v54
  v_accvgpr_write_b32 a111, v55
  s_add_u32 s27, s30, 204800
  buffer_load_dwordx2 v[160:161], v44, s[80:83], s27 offen
  s_add_u32 s27, s30, 205824
  buffer_load_dwordx2 v[162:163], v44, s[80:83], s27 offen
  s_add_u32 s27, s30, 206848
  buffer_load_dwordx2 v[164:165], v44, s[80:83], s27 offen
  s_add_u32 s27, s30, 207872
  buffer_load_dwordx2 v[166:167], v44, s[80:83], s27 offen
  s_add_u32 s27, s30, 221184
  buffer_load_dwordx2 v[168:169], v44, s[80:83], s27 offen
  s_add_u32 s27, s30, 222208
  buffer_load_dwordx2 v[170:171], v44, s[80:83], s27 offen
  s_add_u32 s27, s30, 223232
  buffer_load_dwordx2 v[172:173], v44, s[80:83], s27 offen
  s_add_u32 s27, s30, 224256
  buffer_load_dwordx2 v[174:175], v44, s[80:83], s27 offen
  s_waitcnt vmcnt(48)
  v_perm_b32 v48, v66, v64, s44
  v_perm_b32 v49, v70, v68, s44
  v_perm_b32 v50, v74, v72, s44
  v_perm_b32 v51, v78, v76, s44
  v_accvgpr_write_b32 a112, v48
  v_accvgpr_write_b32 a113, v49
  v_accvgpr_write_b32 a114, v50
  v_accvgpr_write_b32 a115, v51
  v_perm_b32 v52, v66, v64, s45
  v_perm_b32 v53, v70, v68, s45
  v_perm_b32 v54, v74, v72, s45
  v_perm_b32 v55, v78, v76, s45
  v_accvgpr_write_b32 a116, v52
  v_accvgpr_write_b32 a117, v53
  v_accvgpr_write_b32 a118, v54
  v_accvgpr_write_b32 a119, v55
  v_perm_b32 v48, v67, v65, s44
  v_perm_b32 v49, v71, v69, s44
  v_perm_b32 v50, v75, v73, s44
  v_perm_b32 v51, v79, v77, s44
  v_accvgpr_write_b32 a120, v48
  v_accvgpr_write_b32 a121, v49
  v_accvgpr_write_b32 a122, v50
  v_accvgpr_write_b32 a123, v51
  v_perm_b32 v52, v67, v65, s45
  v_perm_b32 v53, v71, v69, s45
  v_perm_b32 v54, v75, v73, s45
  v_perm_b32 v55, v79, v77, s45
  v_accvgpr_write_b32 a124, v52
  v_accvgpr_write_b32 a125, v53
  v_accvgpr_write_b32 a126, v54
  v_accvgpr_write_b32 a127, v55
  s_add_u32 s27, s30, 229376
  buffer_load_dwordx2 v[64:65], v44, s[80:83], s27 offen
  s_add_u32 s27, s30, 230400
  buffer_load_dwordx2 v[66:67], v44, s[80:83], s27 offen
  s_add_u32 s27, s30, 231424
  buffer_load_dwordx2 v[68:69], v44, s[80:83], s27 offen
  s_add_u32 s27, s30, 232448
  buffer_load_dwordx2 v[70:71], v44, s[80:83], s27 offen
  s_add_u32 s27, s30, 245760
  buffer_load_dwordx2 v[72:73], v44, s[80:83], s27 offen
  s_add_u32 s27, s30, 246784
  buffer_load_dwordx2 v[74:75], v44, s[80:83], s27 offen
  s_add_u32 s27, s30, 247808
  buffer_load_dwordx2 v[76:77], v44, s[80:83], s27 offen
  s_add_u32 s27, s30, 248832
  buffer_load_dwordx2 v[78:79], v44, s[80:83], s27 offen
  s_waitcnt vmcnt(48)
  v_perm_b32 v48, v82, v80, s44
  v_perm_b32 v49, v86, v84, s44
  v_perm_b32 v50, v90, v88, s44
  v_perm_b32 v51, v94, v92, s44
  v_accvgpr_write_b32 a128, v48
  v_accvgpr_write_b32 a129, v49
  v_accvgpr_write_b32 a130, v50
  v_accvgpr_write_b32 a131, v51
  v_perm_b32 v52, v82, v80, s45
  v_perm_b32 v53, v86, v84, s45
  v_perm_b32 v54, v90, v88, s45
  v_perm_b32 v55, v94, v92, s45
  v_accvgpr_write_b32 a132, v52
  v_accvgpr_write_b32 a133, v53
  v_accvgpr_write_b32 a134, v54
  v_accvgpr_write_b32 a135, v55
  v_perm_b32 v48, v83, v81, s44
  v_perm_b32 v49, v87, v85, s44
  v_perm_b32 v50, v91, v89, s44
  v_perm_b32 v51, v95, v93, s44
  v_accvgpr_write_b32 a136, v48
  v_accvgpr_write_b32 a137, v49
  v_accvgpr_write_b32 a138, v50
  v_accvgpr_write_b32 a139, v51
  v_perm_b32 v52, v83, v81, s45
  v_perm_b32 v53, v87, v85, s45
  v_perm_b32 v54, v91, v89, s45
  v_perm_b32 v55, v95, v93, s45
  v_accvgpr_write_b32 a140, v52
  v_accvgpr_write_b32 a141, v53
  v_accvgpr_write_b32 a142, v54
  v_accvgpr_write_b32 a143, v55
  s_add_u32 s27, s30, 237568
  buffer_load_dwordx2 v[80:81], v44, s[80:83], s27 offen
  s_add_u32 s27, s30, 238592
  buffer_load_dwordx2 v[82:83], v44, s[80:83], s27 offen
  s_add_u32 s27, s30, 239616
  buffer_load_dwordx2 v[84:85], v44, s[80:83], s27 offen
  s_add_u32 s27, s30, 240640
  buffer_load_dwordx2 v[86:87], v44, s[80:83], s27 offen
  s_add_u32 s27, s30, 253952
  buffer_load_dwordx2 v[88:89], v44, s[80:83], s27 offen
  s_add_u32 s27, s30, 254976
  buffer_load_dwordx2 v[90:91], v44, s[80:83], s27 offen
  s_add_u32 s27, s30, 256000
  buffer_load_dwordx2 v[92:93], v44, s[80:83], s27 offen
  s_add_u32 s27, s30, 257024
  buffer_load_dwordx2 v[94:95], v44, s[80:83], s27 offen
  s_waitcnt vmcnt(48)
  v_perm_b32 v48, v98, v96, s44
  v_perm_b32 v49, v102, v100, s44
  v_perm_b32 v50, v106, v104, s44
  v_perm_b32 v51, v110, v108, s44
  v_accvgpr_write_b32 a144, v48
  v_accvgpr_write_b32 a145, v49
  v_accvgpr_write_b32 a146, v50
  v_accvgpr_write_b32 a147, v51
  v_perm_b32 v52, v98, v96, s45
  v_perm_b32 v53, v102, v100, s45
  v_perm_b32 v54, v106, v104, s45
  v_perm_b32 v55, v110, v108, s45
  v_accvgpr_write_b32 a148, v52
  v_accvgpr_write_b32 a149, v53
  v_accvgpr_write_b32 a150, v54
  v_accvgpr_write_b32 a151, v55
  v_perm_b32 v48, v99, v97, s44
  v_perm_b32 v49, v103, v101, s44
  v_perm_b32 v50, v107, v105, s44
  v_perm_b32 v51, v111, v109, s44
  v_accvgpr_write_b32 a152, v48
  v_accvgpr_write_b32 a153, v49
  v_accvgpr_write_b32 a154, v50
  v_accvgpr_write_b32 a155, v51
  v_perm_b32 v52, v99, v97, s45
  v_perm_b32 v53, v103, v101, s45
  v_perm_b32 v54, v107, v105, s45
  v_perm_b32 v55, v111, v109, s45
  v_accvgpr_write_b32 a156, v52
  v_accvgpr_write_b32 a157, v53
  v_accvgpr_write_b32 a158, v54
  v_accvgpr_write_b32 a159, v55
  buffer_store_dwordx4 v[208:211], v0, s[4:7], s29 offen offset:0 sc1
  buffer_store_dwordx4 v[208:211], v0, s[4:7], s29 offen offset:1024 sc1
  buffer_store_dwordx4 v[208:211], v0, s[4:7], s29 offen offset:2048 sc1
  buffer_store_dwordx4 v[208:211], v0, s[4:7], s29 offen offset:3072 sc1
  s_add_u32 s29, s29, 4096
  s_waitcnt vmcnt(44)
  v_perm_b32 v48, v114, v112, s44
  v_perm_b32 v49, v118, v116, s44
  v_perm_b32 v50, v122, v120, s44
  v_perm_b32 v51, v126, v124, s44
  v_accvgpr_write_b32 a160, v48
  v_accvgpr_write_b32 a161, v49
  v_accvgpr_write_b32 a162, v50
  v_accvgpr_write_b32 a163, v51
  v_perm_b32 v52, v114, v112, s45
  v_perm_b32 v53, v118, v116, s45
  v_perm_b32 v54, v122, v120, s45
  v_perm_b32 v55, v126, v124, s45
  v_accvgpr_write_b32 a164, v52
  v_accvgpr_write_b32 a165, v53
  v_accvgpr_write_b32 a166, v54
  v_accvgpr_write_b32 a167, v55
  v_perm_b32 v48, v115, v113, s44
  v_perm_b32 v49, v119, v117, s44
  v_perm_b32 v50, v123, v121, s44
  v_perm_b32 v51, v127, v125, s44
  v_accvgpr_write_b32 a168, v48
  v_accvgpr_write_b32 a169, v49
  v_accvgpr_write_b32 a170, v50
  v_accvgpr_write_b32 a171, v51
  v_perm_b32 v52, v115, v113, s45
  v_perm_b32 v53, v119, v117, s45
  v_perm_b32 v54, v123, v121, s45
  v_perm_b32 v55, v127, v125, s45
  v_accvgpr_write_b32 a172, v52
  v_accvgpr_write_b32 a173, v53
  v_accvgpr_write_b32 a174, v54
  v_accvgpr_write_b32 a175, v55
  buffer_store_dwordx4 v[208:211], v0, s[4:7], s29 offen offset:0 sc1
  buffer_store_dwordx4 v[208:211], v0, s[4:7], s29 offen offset:1024 sc1
  buffer_store_dwordx4 v[208:211], v0, s[4:7], s29 offen offset:2048 sc1
  buffer_store_dwordx4 v[208:211], v0, s[4:7], s29 offen offset:3072 sc1
  s_add_u32 s29, s29, 520192
  s_waitcnt vmcnt(40)
  v_perm_b32 v48, v130, v128, s44
  v_perm_b32 v49, v134, v132, s44
  v_perm_b32 v50, v138, v136, s44
  v_perm_b32 v51, v142, v140, s44
  v_accvgpr_write_b32 a176, v48
  v_accvgpr_write_b32 a177, v49
  v_accvgpr_write_b32 a178, v50
  v_accvgpr_write_b32 a179, v51
  v_perm_b32 v52, v130, v128, s45
  v_perm_b32 v53, v134, v132, s45
  v_perm_b32 v54, v138, v136, s45
  v_perm_b32 v55, v142, v140, s45
  v_accvgpr_write_b32 a180, v52
  v_accvgpr_write_b32 a181, v53
  v_accvgpr_write_b32 a182, v54
  v_accvgpr_write_b32 a183, v55
  v_perm_b32 v48, v131, v129, s44
  v_perm_b32 v49, v135, v133, s44
  v_perm_b32 v50, v139, v137, s44
  v_perm_b32 v51, v143, v141, s44
  v_accvgpr_write_b32 a184, v48
  v_accvgpr_write_b32 a185, v49
  v_accvgpr_write_b32 a186, v50
  v_accvgpr_write_b32 a187, v51
  v_perm_b32 v52, v131, v129, s45
  v_perm_b32 v53, v135, v133, s45
  v_perm_b32 v54, v139, v137, s45
  v_perm_b32 v55, v143, v141, s45
  v_accvgpr_write_b32 a188, v52
  v_accvgpr_write_b32 a189, v53
  v_accvgpr_write_b32 a190, v54
  v_accvgpr_write_b32 a191, v55
  buffer_store_dwordx4 v[208:211], v0, s[4:7], s29 offen offset:0 sc1
  buffer_store_dwordx4 v[208:211], v0, s[4:7], s29 offen offset:1024 sc1
  buffer_store_dwordx4 v[208:211], v0, s[4:7], s29 offen offset:2048 sc1
  buffer_store_dwordx4 v[208:211], v0, s[4:7], s29 offen offset:3072 sc1
  s_add_u32 s29, s29, 4096
  s_waitcnt vmcnt(36)
  v_perm_b32 v48, v146, v144, s44
  v_perm_b32 v49, v150, v148, s44
  v_perm_b32 v50, v154, v152, s44
  v_perm_b32 v51, v158, v156, s44
  v_accvgpr_write_b32 a192, v48
  v_accvgpr_write_b32 a193, v49
  v_accvgpr_write_b32 a194, v50
  v_accvgpr_write_b32 a195, v51
  v_perm_b32 v52, v146, v144, s45
  v_perm_b32 v53, v150, v148, s45
  v_perm_b32 v54, v154, v152, s45
  v_perm_b32 v55, v158, v156, s45
  v_accvgpr_write_b32 a196, v52
  v_accvgpr_write_b32 a197, v53
  v_accvgpr_write_b32 a198, v54
  v_accvgpr_write_b32 a199, v55
  v_perm_b32 v48, v147, v145, s44
  v_perm_b32 v49, v151, v149, s44
  v_perm_b32 v50, v155, v153, s44
  v_perm_b32 v51, v159, v157, s44
  v_accvgpr_write_b32 a200, v48
  v_accvgpr_write_b32 a201, v49
  v_accvgpr_write_b32 a202, v50
  v_accvgpr_write_b32 a203, v51
  v_perm_b32 v52, v147, v145, s45
  v_perm_b32 v53, v151, v149, s45
  v_perm_b32 v54, v155, v153, s45
  v_perm_b32 v55, v159, v157, s45
  v_accvgpr_write_b32 a204, v52
  v_accvgpr_write_b32 a205, v53
  v_accvgpr_write_b32 a206, v54
  v_accvgpr_write_b32 a207, v55
  buffer_store_dwordx4 v[208:211], v0, s[4:7], s29 offen offset:0 sc1
  buffer_store_dwordx4 v[208:211], v0, s[4:7], s29 offen offset:1024 sc1
  buffer_store_dwordx4 v[208:211], v0, s[4:7], s29 offen offset:2048 sc1
  buffer_store_dwordx4 v[208:211], v0, s[4:7], s29 offen offset:3072 sc1
  s_add_u32 s29, s29, 4096
  s_waitcnt vmcnt(32)
  v_perm_b32 v48, v162, v160, s44
  v_perm_b32 v49, v166, v164, s44
  v_perm_b32 v50, v170, v168, s44
  v_perm_b32 v51, v174, v172, s44
  v_accvgpr_write_b32 a208, v48
  v_accvgpr_write_b32 a209, v49
  v_accvgpr_write_b32 a210, v50
  v_accvgpr_write_b32 a211, v51
  v_perm_b32 v52, v162, v160, s45
  v_perm_b32 v53, v166, v164, s45
  v_perm_b32 v54, v170, v168, s45
  v_perm_b32 v55, v174, v172, s45
  v_accvgpr_write_b32 a212, v52
  v_accvgpr_write_b32 a213, v53
  v_accvgpr_write_b32 a214, v54
  v_accvgpr_write_b32 a215, v55
  v_perm_b32 v48, v163, v161, s44
  v_perm_b32 v49, v167, v165, s44
  v_perm_b32 v50, v171, v169, s44
  v_perm_b32 v51, v175, v173, s44
  v_accvgpr_write_b32 a216, v48
  v_accvgpr_write_b32 a217, v49
  v_accvgpr_write_b32 a218, v50
  v_accvgpr_write_b32 a219, v51
  v_perm_b32 v52, v163, v161, s45
  v_perm_b32 v53, v167, v165, s45
  v_perm_b32 v54, v171, v169, s45
  v_perm_b32 v55, v175, v173, s45
  v_accvgpr_write_b32 a220, v52
  v_accvgpr_write_b32 a221, v53
  v_accvgpr_write_b32 a222, v54
  v_accvgpr_write_b32 a223, v55
  s_waitcnt vmcnt(24)
  v_perm_b32 v48, v66, v64, s44
  v_perm_b32 v49, v70, v68, s44
  v_perm_b32 v50, v74, v72, s44
  v_perm_b32 v51, v78, v76, s44
  v_accvgpr_write_b32 a224, v48
  v_accvgpr_write_b32 a225, v49
  v_accvgpr_write_b32 a226, v50
  v_accvgpr_write_b32 a227, v51
  v_perm_b32 v52, v66, v64, s45
  v_perm_b32 v53, v70, v68, s45
  v_perm_b32 v54, v74, v72, s45
  v_perm_b32 v55, v78, v76, s45
  v_accvgpr_write_b32 a228, v52
  v_accvgpr_write_b32 a229, v53
  v_accvgpr_write_b32 a230, v54
  v_accvgpr_write_b32 a231, v55
  v_perm_b32 v48, v67, v65, s44
  v_perm_b32 v49, v71, v69, s44
  v_perm_b32 v50, v75, v73, s44
  v_perm_b32 v51, v79, v77, s44
  v_accvgpr_write_b32 a232, v48
  v_accvgpr_write_b32 a233, v49
  v_accvgpr_write_b32 a234, v50
  v_accvgpr_write_b32 a235, v51
  v_perm_b32 v52, v67, v65, s45
  v_perm_b32 v53, v71, v69, s45
  v_perm_b32 v54, v75, v73, s45
  v_perm_b32 v55, v79, v77, s45
  v_accvgpr_write_b32 a236, v52
  v_accvgpr_write_b32 a237, v53
  v_accvgpr_write_b32 a238, v54
  v_accvgpr_write_b32 a239, v55
  s_waitcnt vmcnt(16)
  v_perm_b32 v48, v82, v80, s44
  v_perm_b32 v49, v86, v84, s44
  v_perm_b32 v50, v90, v88, s44
  v_perm_b32 v51, v94, v92, s44
  v_accvgpr_write_b32 a240, v48
  v_accvgpr_write_b32 a241, v49
  v_accvgpr_write_b32 a242, v50
  v_accvgpr_write_b32 a243, v51
  v_perm_b32 v52, v82, v80, s45
  v_perm_b32 v53, v86, v84, s45
  v_perm_b32 v54, v90, v88, s45
  v_perm_b32 v55, v94, v92, s45
  v_accvgpr_write_b32 a244, v52
  v_accvgpr_write_b32 a245, v53
  v_accvgpr_write_b32 a246, v54
  v_accvgpr_write_b32 a247, v55
  v_perm_b32 v48, v83, v81, s44
  v_perm_b32 v49, v87, v85, s44
  v_perm_b32 v50, v91, v89, s44
  v_perm_b32 v51, v95, v93, s44
  v_accvgpr_write_b32 a248, v48
  v_accvgpr_write_b32 a249, v49
  v_accvgpr_write_b32 a250, v50
  v_accvgpr_write_b32 a251, v51
  v_perm_b32 v52, v83, v81, s45
  v_perm_b32 v53, v87, v85, s45
  v_perm_b32 v54, v91, v89, s45
  v_perm_b32 v55, v95, v93, s45
  v_accvgpr_write_b32 a252, v52
  v_accvgpr_write_b32 a253, v53
  v_accvgpr_write_b32 a254, v54
  v_accvgpr_write_b32 a255, v55
  s_waitcnt vmcnt(0)
  s_barrier
  s_cmp_ge_u32 s60, 4
  s_cbranch_scc1 L_oh
  s_cmp_lg_u32 s17, 0
  s_cbranch_scc1 g_ar_121
  s_lshl_b32 s36, s89, 3
  s_lshl_b64 s[36:37], 1, s36
  v_lshlrev_b32 v52, 3, s91
  v_mov_b32 v48, s36
  v_mov_b32 v49, s37
  s_mov_b64 exec, 1
  global_atomic_add_x2 v[50:51], v52, v[48:49], s[12:13] sc0
  s_mov_b64 exec, -1
g_ar_121:
  s_waitcnt vmcnt(0)
  s_cmp_lg_u32 s17, 0
  s_cbranch_scc1 g_af_122
  v_readfirstlane_b32 s36, v50
  v_readfirstlane_b32 s37, v51
  s_add_u32 s38, s36, s37
  s_mul_i32 s38, s38, 0x01010101
  s_lshr_b32 s38, s38, 24
  s_cmp_lg_u32 s38, 15
  s_cbranch_scc1 g_af_122
  s_lshl_b32 s38, s89, 3
  s_lshr_b64 s[36:37], s[36:37], s38
  s_and_b32 s36, s36, 0xff
  s_cmp_eq_u32 s36, 15
  s_cselect_b32 s36, 1, 2
  v_mov_b32 v48, s36
  v_lshrrev_b32 v52, 1, v52
  s_mov_b64 exec, 1
  global_store_dword v52, v48, s[12:13] offset:128 sc1
  s_mov_b64 exec, -1
g_af_122:
  s_lshr_b32 s26, s60, 1
  s_cmp_lg_u32 s26, 1
  s_cbranch_scc1 L_ow
  s_and_b32 s28, s85, 28
  s_or_b32 s28, s28, 1
  s_lshl_b32 s27, s28, 6
  s_add_u32 s27, s27, 245104640
  s_mov_b32 s26, 0
g_h_123:
  buffer_load_dwordx2 v[60:61], off, s[4:7], s27 sc1
  s_add_u32 s26, s26, 1
  s_cmp_gt_u32 s26, 1048576
  s_cbranch_scc1 L_end
  s_waitcnt vmcnt(0)
  v_and_or_b32 v60, v61, -1, v60
  v_cmp_eq_u32 vcc, 0, v60
  s_cbranch_vccnz g_h_123
  s_mov_b32 s10, 1835008
  s_load_dwordx2 s[8:9], s[0:1], 72
  s_mul_i32 s26, s77, 14336
  s_sub_u32 s26, s26, 1835008
  s_waitcnt lgkmcnt(0)
  buffer_load_dwordx4 v[64:67], v0, s[8:11], s26 offen offset:0
  buffer_load_dwordx4 v[64:67], v0, s[8:11], s26 offen offset:1024
  buffer_load_dwordx4 v[64:67], v0, s[8:11], s26 offen offset:2048
  buffer_load_dwordx4 v[64:67], v0, s[8:11], s26 offen offset:3072
  s_add_u32 s26, s26, 4096
  buffer_load_dwordx4 v[64:67], v0, s[8:11], s26 offen offset:0
  buffer_load_dwordx4 v[64:67], v0, s[8:11], s26 offen offset:1024
  buffer_load_dwordx4 v[64:67], v0, s[8:11], s26 offen offset:2048
  buffer_load_dwordx4 v[64:67], v0, s[8:11], s26 offen offset:3072
  s_add_u32 s26, s26, 4096
  buffer_load_dwordx4 v[64:67], v0, s[8:11], s26 offen offset:0
  buffer_load_dwordx4 v[64:67], v0, s[8:11], s26 offen offset:1024
  buffer_load_dwordx4 v[64:67], v0, s[8:11], s26 offen offset:2048
  buffer_load_dwordx4 v[64:67], v0, s[8:11], s26 offen offset:3072
  s_add_u32 s26, s26, 4096
  buffer_load_dwordx4 v[64:67], v0, s[8:11], s26 offen offset:0
  buffer_load_dwordx4 v[64:67], v0, s[8:11], s26 offen offset:1024
  s_load_dwordx2 s[8:9], s[0:1], 80
  s_mul_i32 s26, s77, 14336
  s_sub_u32 s26, s26, 1835008
  s_waitcnt lgkmcnt(0)
  buffer_load_dwordx4 v[64:67], v0, s[8:11], s26 offen offset:0
  buffer_load_dwordx4 v[64:67], v0, s[8:11], s26 offen offset:1024
  buffer_load_dwordx4 v[64:67], v0, s[8:11], s26 offen offset:2048
  buffer_load_dwordx4 v[64:67], v0, s[8:11], s26 offen offset:3072
  s_add_u32 s26, s26, 4096
  buffer_load_dwordx4 v[64:67], v0, s[8:11], s26 offen offset:0
  buffer_load_dwordx4 v[64:67], v0, s[8:11], s26 offen offset:1024
  buffer_load_dwordx4 v[64:67], v0, s[8:11], s26 offen offset:2048
  buffer_load_dwordx4 v[64:67], v0, s[8:11], s26 offen offset:3072
  s_add_u32 s26, s26, 4096
  buffer_load_dwordx4 v[64:67], v0, s[8:11], s26 offen offset:0
  buffer_load_dwordx4 v[64:67], v0, s[8:11], s26 offen offset:1024
  buffer_load_dwordx4 v[64:67], v0, s[8:11], s26 offen offset:2048
  buffer_load_dwordx4 v[64:67], v0, s[8:11], s26 offen offset:3072
  s_add_u32 s26, s26, 4096
  buffer_load_dwordx4 v[64:67], v0, s[8:11], s26 offen offset:0
  buffer_load_dwordx4 v[64:67], v0, s[8:11], s26 offen offset:1024
  s_load_dwordx2 s[8:9], s[0:1], 88
  s_mul_i32 s26, s77, 14336
  s_sub_u32 s26, s26, 1835008
  s_waitcnt lgkmcnt(0)
  buffer_load_dwordx4 v[64:67], v0, s[8:11], s26 offen offset:0
  buffer_load_dwordx4 v[64:67], v0, s[8:11], s26 offen offset:1024
  buffer_load_dwordx4 v[64:67], v0, s[8:11], s26 offen offset:2048
  buffer_load_dwordx4 v[64:67], v0, s[8:11], s26 offen offset:3072
  s_add_u32 s26, s26, 4096
  buffer_load_dwordx4 v[64:67], v0, s[8:11], s26 offen offset:0
  buffer_load_dwordx4 v[64:67], v0, s[8:11], s26 offen offset:1024
  buffer_load_dwordx4 v[64:67], v0, s[8:11], s26 offen offset:2048
  buffer_load_dwordx4 v[64:67], v0, s[8:11], s26 offen offset:3072
  s_add_u32 s26, s26, 4096
  buffer_load_dwordx4 v[64:67], v0, s[8:11], s26 offen offset:0
  buffer_load_dwordx4 v[64:67], v0, s[8:11], s26 offen offset:1024
  buffer_load_dwordx4 v[64:67], v0, s[8:11], s26 offen offset:2048
  buffer_load_dwordx4 v[64:67], v0, s[8:11], s26 offen offset:3072
  s_add_u32 s26, s26, 4096
  buffer_load_dwordx4 v[64:67], v0, s[8:11], s26 offen offset:0
  buffer_load_dwordx4 v[64:67], v0, s[8:11], s26 offen offset:1024
L_ow:
  v_mbcnt_lo_u32_b32 v60, -1, 0
  v_and_b32 v60, 0, v60
  v_add_lshl_u32 v60, v60, s91, 2
  s_mov_b32 s26, 0
g_wt_124:
  global_load_dword v61, v60, s[12:13] offset:128 sc1
  s_add_u32 s26, s26, 1
  s_cmp_gt_u32 s26, 1048576
  s_cbranch_scc1 L_end
  s_waitcnt vmcnt(0)
  v_cmp_eq_u32 vcc, 0, v61
  v_readfirstlane_b32 s27, v61
  s_cbranch_vccnz g_wt_124
  s_mov_b32 s89, s27
L_oh:
  s_cmp_lg_u32 s89, 1
  s_cbranch_scc1 L_o_x
  s_mov_b32 s62, 1
  s_mov_b32 s42, 0
  s_mov_b32 s3, 0
  s_mov_b32 s46, 0
  s_mov_b32 s65, 0
  s_mov_b32 s66, 0
  s_mov_b32 s76, 0
  s_mov_b32 s55, 0
  s_mov_b32 s48, 0
  s_mov_b32 s56, 0
  s_mov_b32 s84, 268435456
  s_mov_b32 s86, s41
  s_mov_b32 s49, s60
  s_mul_i32 s63, s49, 257
  s_or_b32 s63, s63, 1179648
  s_lshr_b32 s57, s60, 2
  s_cbranch_scc1 o_help_136
o_round_125:
  s_max_u32 s46, s46, s3
  s_cmp_lg_u32 s3, 0
  s_mov_b32 s3, 0
  s_cbranch_scc1 d_g_141
  s_mov_b32 s67, 0
d_w_140:
  s_min_u32 s26, s49, 71
  s_lshl_b32 s26, s26, 12
  s_add_u32 s27, s26, 243494912
  s_add_u32 s26, s26, 243486720
  buffer_load_dword v248, v246, s[4:7], s26 offen sc1
  buffer_load_dword v249, v246, s[4:7], s27 offen sc1
  s_add_u32 s67, s67, 1
  s_cmp_gt_u32 s67, 1048576
  s_cbranch_scc1 L_end
  s_waitcnt vmcnt(0)
  s_mov_b64 exec, 1
  buffer_store_dword v38, off, s[4:7], s84 sc1
  s_mov_b64 exec, -1
  s_mov_b32 s84, 268435456
  v_min_u32 v162, v248, v249
  v_max_u32 v163, v248, v249
  v_cmp_eq_u32 vcc, 0, v162
  s_cbranch_vccnz d_w_140
  v_max_u32_dpp v163, v163, v163 row_ror:8 row_mask:0xf bank_mask:0xf
  s_nop 1
  v_max_u32_dpp v163, v163, v163 row_ror:4 row_mask:0xf bank_mask:0xf
  s_nop 1
  v_max_u32_dpp v163, v163, v163 row_ror:2 row_mask:0xf bank_mask:0xf
  s_nop 1
  v_max_u32_dpp v163, v163, v163 row_ror:1 row_mask:0xf bank_mask:0xf
  s_nop 0
  v_readlane_b32 s28, v163, 0
  v_readlane_b32 s29, v163, 16
  v_readlane_b32 s30, v163, 32
  v_readlane_b32 s31, v163, 48
  s_max_u32 s28, s28, s29
  s_max_u32 s30, s30, s31
  s_max_u32 s46, s46, s28
  s_max_u32 s46, s46, s30
d_g_141:
  s_lshr_b32 s27, s49, 2
  s_andn2_b32 s52, 0xfff, s46
  s_lshr_b32 s52, s52, 5
  s_min_u32 s52, s52, 64
  s_add_u32 s26, s52, 3
  v_readlane_b32 s89, v247, s27
  s_sub_u32 s26, s26, s60
  s_lshr_b32 s26, s26, 2
  s_bfm_b32 s54, s26, 0
  s_add_u32 s53, s63, 1028
  s_cmp_lt_u32 s49, 60
  s_cselect_b32 s53, s53, 0
  s_cmp_lt_u32 s49, 64
  s_cselect_b32 s26, 2, 1
  s_sub_i32 s26, s27, s26
  s_max_i32 s26, s26, 0
  s_min_u32 s26, s26, 16
  s_bfm_b32 s58, s26, 0
  s_cmp_eq_u32 s27, 16
  s_cselect_b32 s59, 1, 1
  s_cmp_eq_u32 s27, 17
  s_cselect_b32 s59, 0, s59
  s_cmp_eq_u32 s27, 18
  s_cselect_b32 s59, 64, s59
  s_cselect_b32 s50, 0, -1
  s_cselect_b32 s89, 0, s89
  s_cbranch_scc1 o_dl_137
  s_cmp_eq_u32 s27, 16
  s_cbranch_scc1 o_dl_137_a
o_pick_129:
  s_cmp_eq_u32 s59, 0
  s_cbranch_scc1 o_none_133
  s_sub_u32 s59, s59, 1
  s_andn2_b32 s26, s58, s55
  s_and_b32 s26, s26, s54
  s_cbranch_scc1 o_ga_130
  s_and_b32 s26, s55, s50
  s_or_b32 s26, s26, s56
  s_or_b32 s26, s26, s54
  s_andn2_b32 s26, s58, s26
  s_cbranch_scc0 o_none_133
  s_cmp_ge_u32 s46, s89
  s_cbranch_scc1 o_gb_131
o_ga_130:
  s_ff1_i32_b32 s26, s26
  s_bitset1_b32 s55, s26
  s_mov_b32 s64, 1327168
  s_mov_b32 s27, s64
  s_branch o_gd_132
o_none_133:
  s_cmp_lt_u32 s49, 60
  s_cbranch_scc1 o_nn_134
  s_cmp_eq_u32 s50, 0
  s_cbranch_scc1 o_nn_134
  s_and_b32 s26, s63, 1097728
  s_cmp_eq_u32 s26, 1048576
  s_cbranch_scc1 o_nn_134
  s_cmp_lt_u32 s49, 64
  s_cbranch_scc1 o_adv_135
  s_and_b32 s26, s65, 1097728
  s_cmp_lg_u32 s26, 1048576
  s_cbranch_scc1 o_adv_135
o_nn_134:
  s_mov_b32 s64, s53
  s_mov_b32 s51, 0
  s_branch o_task_126
o_gb_131:
  s_ff1_i32_b32 s26, s26
  s_bitset1_b32 s56, s26
  s_andn2_b32 s27, 31, s46
  s_or_b32 s27, s27, 32
  s_lshl_b32 s27, s27, 22
  s_or_b32 s27, s27, 1474688
  s_mov_b32 s64, 1474624
o_gd_132:
  s_lshl4_add_u32 s48, s48, s26
  s_and_b32 s28, s26, s57
  s_lshr_b32 s26, s26, s57
  s_lshl2_add_u32 s26, s26, s60
  s_add_u32 s26, s26, s28
  s_cmp_eq_u32 s26, s52
  s_cselect_b32 s64, s27, s64
  s_mul_i32 s26, s26, 257
  s_or_b32 s64, s64, s26
  s_mov_b32 s51, 1
o_task_126:
  s_cmp_eq_u32 s63, 0
  s_cbranch_scc1 o_nofl_127
  s_cmp_lg_u32 s66, 0
  s_cbranch_scc1 o_have_143
  s_mov_b32 s67, 0
o_w1_142:
  s_and_b32 s32, s63, 0xff
  s_lshl_b32 s32, s32, 12
  s_add_u32 s32, s32, s14
  buffer_load_dword v37, v36, s[4:7], s32 offen sc1
  s_add_u32 s67, s67, 1
  s_cmp_gt_u32 s67, 1048576
  s_cbranch_scc1 L_end
  s_waitcnt vmcnt(0)
  s_mov_b64 exec, 1
  buffer_store_dword v38, off, s[4:7], s84 sc1
  s_mov_b64 exec, -1
  s_mov_b32 s84, 268435456
  v_cmp_eq_u32 vcc, 0, v37
  s_cbranch_vccnz o_w1_142
  s_and_b32 s87, s63, 0xff
  s_lshl_b32 s33, s87, 18
  s_lshl_b32 s32, s87, 19
  s_add_u32 m0, s22, 0
  s_add_u32 s33, s33, s19
  buffer_load_dwordx4 v0, s[4:7], s33 offen offset:0 sc1 lds
  buffer_load_dwordx4 v0, s[4:7], s33 offen offset:1024 sc1 lds
  buffer_load_dwordx4 v0, s[4:7], s33 offen offset:2048 sc1 lds
  buffer_load_dwordx4 v0, s[4:7], s33 offen offset:3072 sc1 lds
  s_add_u32 m0, s23, 0
  s_add_u32 s32, s32, s18
  buffer_load_dwordx4 v0, s[4:7], s32 offen offset:0 sc1 lds
  buffer_load_dwordx4 v0, s[4:7], s32 offen offset:1024 sc1 lds
  buffer_load_dwordx4 v0, s[4:7], s32 offen offset:2048 sc1 lds
  buffer_load_dwordx4 v0, s[4:7], s32 offen offset:3072 sc1 lds
  s_add_u32 m0, m0, 4096
  s_add_u32 s32, s32, 4096
  buffer_load_dwordx4 v0, s[4:7], s32 offen offset:0 sc1 lds
  buffer_load_dwordx4 v0, s[4:7], s32 offen offset:1024 sc1 lds
  buffer_load_dwordx4 v0, s[4:7], s32 offen offset:2048 sc1 lds
  buffer_load_dwordx4 v0, s[4:7], s32 offen offset:3072 sc1 lds
  s_waitcnt vmcnt(0)
  s_barrier
o_have_143:
  ds_read_b128 v[120:123], v33 offset:0
  ds_read_b128 v[40:43], v32 offset:0
  ds_read_b128 v[56:59], v32 offset:1024
  ds_read_b128 v[124:127], v33 offset:2048
  ds_read_b128 v[44:47], v32 offset:4096
  ds_read_b128 v[60:63], v32 offset:5120
  ds_read_b128 v[128:131], v33 offset:4096
  ds_read_b128 v[48:51], v32 offset:8192
  ds_read_b128 v[64:67], v32 offset:9216
  ds_read_b128 v[132:135], v33 offset:6144
  ds_read_b128 v[52:55], v32 offset:12288
  ds_read_b128 v[68:71], v32 offset:13312
  s_cmp_lt_u32 s17, 2
  s_cselect_b32 s65, s65, 0
  s_cmp_lg_u32 s65, 0
  s_cselect_b64 s[44:45], -1, 0
  s_mov_b32 s95, s86
  s_mov_b32 s96, s42
  s_lshl_b32 s97, s43, 14
  s_add_u32 s97, s97, s95
  s_and_b32 s87, s64, 0xff
  s_lshl_b32 s87, s87, 12
  s_add_u32 s87, s87, s14
  s_and_b32 s88, s63, 0xff00
  s_lshl_b32 s88, s88, 3
  s_add_u32 s88, s88, s15
  s_and_b32 s91, s65, 63
  s_lshl_b32 s90, s91, 5
  s_add_u32 s94, s90, s85
  s_add_u32 s90, s90, s43
  s_lshl_b32 s94, s94, 10
  s_lshr_b32 s92, s65, 22
  s_xor_b32 s93, s43, 32
  s_lshl_b32 s91, s90, 10
  s_add_u32 s94, s94, 25165824
  s_cmp_eq_u32 s92, s93
  s_cselect_b32 s92, s94, s91
  s_add_u32 s92, s92, 10485760
  s_and_b32 s93, s65, 49152
  s_cselect_b32 s92, s92, s91
  s_cselect_b64 s[80:81], s[4:5], s[72:73]
  s_cselect_b32 s82, s6, s74
  s_waitcnt lgkmcnt(9)
  v_mfma_f32_16x16x32_bf16 v[104:107], v[40:43], v[120:123], v[24:27]
  v_mfma_f32_16x16x32_bf16 v[108:111], v[56:59], v[120:123], v[28:31]
  s_mov_b64 exec, s[44:45]
  buffer_load_dword v7, v255, s[4:7], s97 offen sc1
  buffer_load_dwordx4 v[184:187], v0, s[80:83], s92 offen sc1
  s_not_b64 exec, exec
  buffer_load_dword v37, v36, s[4:7], s87 offen sc1
  s_mov_b64 exec, -1
  buffer_load_dword v244, v252, s[4:7], s88 offen sc1
  s_waitcnt lgkmcnt(6)
  v_mfma_f32_16x16x32_bf16 v[104:107], v[44:47], v[124:127], v[104:107]
  v_mfma_f32_16x16x32_bf16 v[108:111], v[60:63], v[124:127], v[108:111]
  s_waitcnt lgkmcnt(3)
  v_mfma_f32_16x16x32_bf16 v[104:107], v[48:51], v[128:131], v[104:107]
  v_mfma_f32_16x16x32_bf16 v[108:111], v[64:67], v[128:131], v[108:111]
  s_waitcnt lgkmcnt(0)
  v_mfma_f32_16x16x32_bf16 v[104:107], v[52:55], v[132:135], v[104:107]
  v_mfma_f32_16x16x32_bf16 v[108:111], v[68:71], v[132:135], v[108:111]
  s_cmp_lg_u32 s76, 0
  s_cbranch_scc1 o_klds_146
  v_mov_b32 v196, 0
  v_mov_b32 v199, 0
  v_exp_f32 v56, v104
  v_exp_f32 v57, v105
  v_exp_f32 v58, v106
  v_exp_f32 v59, v107
  v_exp_f32 v60, v108
  v_exp_f32 v61, v109
  v_exp_f32 v62, v110
  v_exp_f32 v63, v111
  v_max3_f32 v116, v104, v105, v106
  v_max3_f32 v116, v107, v108, v116
  v_max3_f32 v116, v109, v110, v116
  v_add_f32 v117, v56, v57
  v_add_f32 v118, v58, v59
  v_add_f32 v117, v117, v60
  v_add_f32 v118, v118, v61
  v_add_f32 v117, v117, v62
  v_add_f32 v118, v118, v63
  s_mov_b32 s67, 0
  s_and_b32 s32, s63, 0xff00
  s_lshl_b32 s32, s32, 10
  s_add_u32 s32, s32, s20
  s_add_u32 s33, s32, 4096
o_w2_144:
  s_waitcnt vmcnt(0)
  v_cmp_eq_u32 vcc, 0, v244
  s_cbranch_vccz o_kgo_154
  s_mov_b64 exec, 1
  buffer_store_dword v38, off, s[4:7], s84 sc1
  s_mov_b64 exec, -1
  s_mov_b32 s84, 268435456
  buffer_load_dword v244, v252, s[4:7], s88 offen sc1
  s_add_u32 s67, s67, 1
  s_cmp_gt_u32 s67, 1048576
  s_cbranch_scc1 L_end
  s_branch o_w2_144
o_kgo_154:
  buffer_load_dwordx4 v[136:139], v0, s[4:7], s32 offen offset:0 sc1
  buffer_load_dwordx4 v[140:143], v0, s[4:7], s32 offen offset:1024 sc1
  buffer_load_dwordx4 v[144:147], v0, s[4:7], s32 offen offset:2048 sc1
  buffer_load_dwordx4 v[148:151], v0, s[4:7], s32 offen offset:3072 sc1
  buffer_load_dwordx2 v[200:201], v1, s[4:7], s33 offen offset:0 sc1
  buffer_load_dwordx2 v[202:203], v1, s[4:7], s33 offen offset:512 sc1
  buffer_load_dwordx2 v[204:205], v1, s[4:7], s33 offen offset:1024 sc1
  buffer_load_dwordx2 v[206:207], v1, s[4:7], s33 offen offset:1536 sc1
  buffer_load_dword v37, v36, s[4:7], s87 offen sc1
  buffer_load_dword v244, v252, s[4:7], s88 offen sc1
  s_barrier
  ds_read_b128 v[152:155], v32 offset:2048
  ds_read_b128 v[156:159], v32 offset:3072
  ds_read_b128 v[160:163], v32 offset:6144
  ds_read_b128 v[164:167], v32 offset:7168
  ds_read_b128 v[168:171], v32 offset:10240
  ds_read_b128 v[172:175], v32 offset:11264
  ds_read_b128 v[176:179], v32 offset:14336
  ds_read_b128 v[180:183], v32 offset:15360
  s_waitcnt vmcnt(9)
  v_mfma_f32_16x16x32_bf16 v[112:115], v[136:139], v[120:123], 0
  s_waitcnt vmcnt(8)
  v_mfma_f32_16x16x32_bf16 v[112:115], v[140:143], v[124:127], v[112:115]
  s_waitcnt vmcnt(7)
  v_mfma_f32_16x16x32_bf16 v[112:115], v[144:147], v[128:131], v[112:115]
  s_waitcnt vmcnt(6)
  v_mfma_f32_16x16x32_bf16 v[112:115], v[148:151], v[132:135], v[112:115]
  s_waitcnt vmcnt(2)
  s_branch o_havek_145
o_klds_146:
  s_waitcnt vmcnt(12)
  s_barrier
  ds_read_b128 v[136:139], v34 offset:0
  ds_read_b128 v[140:143], v34 offset:1024
  ds_read_b128 v[144:147], v34 offset:2048
  ds_read_b128 v[148:151], v34 offset:3072
  ds_read_b64 v[200:201], v35 offset:4096
  ds_read_b64 v[202:203], v35 offset:4608
  ds_read_b64 v[204:205], v35 offset:5120
  ds_read_b64 v[206:207], v35 offset:5632
  v_mov_b32 v196, 0
  v_mov_b32 v199, 0
  v_exp_f32 v56, v104
  v_exp_f32 v57, v105
  v_exp_f32 v58, v106
  v_exp_f32 v59, v107
  v_exp_f32 v60, v108
  v_exp_f32 v61, v109
  v_exp_f32 v62, v110
  v_exp_f32 v63, v111
  v_max3_f32 v116, v104, v105, v106
  v_max3_f32 v116, v107, v108, v116
  v_max3_f32 v116, v109, v110, v116
  s_waitcnt lgkmcnt(4)
  v_mfma_f32_16x16x32_bf16 v[112:115], v[136:139], v[120:123], 0
  ds_read_b128 v[152:155], v32 offset:2048
  ds_read_b128 v[156:159], v32 offset:3072
  v_mfma_f32_16x16x32_bf16 v[112:115], v[140:143], v[124:127], v[112:115]
  ds_read_b128 v[160:163], v32 offset:6144
  ds_read_b128 v[164:167], v32 offset:7168
  v_mfma_f32_16x16x32_bf16 v[112:115], v[144:147], v[128:131], v[112:115]
  ds_read_b128 v[168:171], v32 offset:10240
  ds_read_b128 v[172:175], v32 offset:11264
  v_mfma_f32_16x16x32_bf16 v[112:115], v[148:151], v[132:135], v[112:115]
  ds_read_b128 v[176:179], v32 offset:14336
  ds_read_b128 v[180:183], v32 offset:15360
  v_add_f32 v117, v56, v57
  v_add_f32 v118, v58, v59
  v_add_f32 v117, v117, v60
  v_add_f32 v118, v118, v61
  v_add_f32 v117, v117, v62
  v_add_f32 v118, v118, v63
o_havek_145:
  s_cmp_lg_u32 s65, 0
  s_cbranch_scc1 o_wr1_151
  s_nop 3
  v_mul_f32 v112, s24, v112
  v_mul_f32 v113, s24, v113
  v_exp_f32 v64, v112
  v_exp_f32 v65, v113
  v_max_f32 v116, v111, v116
  v_max3_f32 v116, v112, v113, v116
  v_add_f32 v117, v117, v64
  v_add_f32 v118, v118, v65
  v_add_f32 v117, v117, v118
  s_mov_b32 s28, 0x21800000
  v_mov_b32 v118, v117
  s_nop 1
  v_permlane16_swap_b32 v117, v118
  v_add_f32 v117, v117, v118
  v_mov_b32 v118, v117
  s_nop 0
  s_nop 0
  v_permlane32_swap_b32 v117, v118
  v_add_f32 v117, v117, v118
  v_cmp_lt_f32 vcc, 0x42700000, v116
  v_cmp_gt_f32 s[30:31], s28, v117
  v_rcp_f32 v117, v117
  s_or_b64 vcc, vcc, s[30:31]
  s_cbranch_vccnz o_fb_155
o_fbr_156:
  v_pk_mul_f32 v[56:57], v[56:57], v[116:117] op_sel:[0,1] op_sel_hi:[1,1]
  v_pk_mul_f32 v[58:59], v[58:59], v[116:117] op_sel:[0,1] op_sel_hi:[1,1]
  v_pk_mul_f32 v[60:61], v[60:61], v[116:117] op_sel:[0,1] op_sel_hi:[1,1]
  v_pk_mul_f32 v[62:63], v[62:63], v[116:117] op_sel:[0,1] op_sel_hi:[1,1]
  v_pk_mul_f32 v[64:65], v[64:65], v[116:117] op_sel:[0,1] op_sel_hi:[1,1]
  v_cvt_pk_bf16_f32 v116, v56, v57
  v_cvt_pk_bf16_f32 v117, v58, v59
  v_cvt_pk_bf16_f32 v118, v60, v61
  v_cvt_pk_bf16_f32 v119, v62, v63
  s_waitcnt lgkmcnt(0)
  s_nop 0
  v_mfma_f32_16x16x32_bf16 v[72:75], v[152:155], v[116:119], 0
  s_add_u32 s62, s62, 1
  v_cvt_pk_bf16_f32 v197, v64, v65
  v_cvt_pk_bf16_f32 v198, v64, v65
  v_mfma_f32_16x16x32_bf16 v[76:79], v[156:159], v[116:119], 0
  s_xor_b32 s86, s86, 524288
  v_mfma_f32_16x16x32_bf16 v[80:83], v[160:163], v[116:119], 0
  s_bfe_u32 s42, s62, 0x10001
  v_mfma_f32_16x16x32_bf16 v[84:87], v[164:167], v[116:119], 0
  s_bfe_u32 s26, s64, 65556
  v_mfma_f32_16x16x32_bf16 v[88:91], v[168:171], v[116:119], 0
  s_and_b32 s87, s64, 0xff
  v_mfma_f32_16x16x32_bf16 v[92:95], v[172:175], v[116:119], 0
  s_bfe_u32 s88, s64, 0x80008
  v_mfma_f32_16x16x32_bf16 v[96:99], v[176:179], v[116:119], 0
  s_nop 0
  v_mfma_f32_16x16x32_bf16 v[100:103], v[180:183], v[116:119], 0
  s_nop 0
  v_mfma_f32_16x16x16_bf16 v[72:75], v[200:201], v[198:199], v[72:75]
  s_nop 1
  v_mfma_f32_16x16x16_bf16 v[76:79], v[200:201], v[196:197], v[76:79]
  s_nop 1
  v_mfma_f32_16x16x16_bf16 v[80:83], v[202:203], v[198:199], v[80:83]
  s_nop 1
  v_mfma_f32_16x16x16_bf16 v[84:87], v[202:203], v[196:197], v[84:87]
  s_nop 1
  v_mfma_f32_16x16x16_bf16 v[88:91], v[204:205], v[198:199], v[88:91]
  s_nop 0
  v_cvt_pk_bf16_f32 v40, v72, v73
  v_cvt_pk_bf16_f32 v41, v74, v75
  v_mfma_f32_16x16x16_bf16 v[92:95], v[204:205], v[196:197], v[92:95]
  s_nop 0
  v_cvt_pk_bf16_f32 v42, v76, v77
  v_cvt_pk_bf16_f32 v43, v78, v79
  v_mfma_f32_16x16x16_bf16 v[96:99], v[206:207], v[198:199], v[96:99]
  s_nop 0
  ds_write_b128 v6, v[40:43] offset:0
  v_cvt_pk_bf16_f32 v44, v80, v81
  v_mfma_f32_16x16x16_bf16 v[100:103], v[206:207], v[196:197], v[100:103]
  s_nop 0
  v_cvt_pk_bf16_f32 v45, v82, v83
  v_cvt_pk_bf16_f32 v46, v84, v85
  v_cvt_pk_bf16_f32 v47, v86, v87
  ds_write_b128 v6, v[44:47] offset:1024
  v_cvt_pk_bf16_f32 v48, v88, v89
  v_cvt_pk_bf16_f32 v49, v90, v91
  v_cvt_pk_bf16_f32 v50, v92, v93
  v_cvt_pk_bf16_f32 v51, v94, v95
  ds_write_b128 v6, v[48:51] offset:2048
  v_cvt_pk_bf16_f32 v52, v96, v97
  v_cvt_pk_bf16_f32 v53, v98, v99
  v_cvt_pk_bf16_f32 v54, v100, v101
  v_cvt_pk_bf16_f32 v55, v102, v103
  ds_write_b128 v6, v[52:55] offset:3072
  s_cmp_lt_u32 s17, 2
  s_cbranch_scc1 o_wr0_150
  s_waitcnt lgkmcnt(0)
  s_barrier
  ds_read_b128 v[104:107], v3 offset:0
  ds_read_b128 v[108:111], v3 offset:512
  ds_read_b128 v[112:115], v3 offset:1024
  s_waitcnt lgkmcnt(2)
  v_mfma_f32_32x32x16_bf16 v[40:55], v[104:107], a[0:3], 0
  s_waitcnt vmcnt(0)
  v_cmp_eq_u32 vcc, 0, v37
  s_cmp_eq_u64 vcc, 0
  s_cselect_b32 s66, s26, 0
  s_cmp_eq_u32 s66, 1
  s_cselect_b32 s87, s87, 1024
  s_cselect_b32 s34, 0, 0x28000
  v_mfma_f32_32x32x16_bf16 v[56:71], v[104:107], a[4:7], 0
  ds_read_b128 v[116:119], v3 offset:1536
  s_lshl_b32 s33, s87, 18
  s_lshl_b32 s32, s87, 19
  s_add_u32 m0, s22, s34
  s_add_u32 s33, s33, s19
  s_min_u32 s28, s49, 67
  v_mfma_f32_32x32x16_bf16 v[72:87], v[104:107], a[8:11], 0
  s_lshl1_add_u32 s28, s17, s28
  s_lshl_b32 s28, s28, 12
  s_add_u32 s28, s28, 243486720
  v_mfma_f32_32x32x16_bf16 v[88:103], v[104:107], a[12:15], 0
  buffer_load_dword v249, v246, s[4:7], s28 offen sc1
  s_waitcnt lgkmcnt(2)
  v_mfma_f32_32x32x16_bf16 v[40:55], v[108:111], a[16:19], v[40:55]
  buffer_load_dwordx4 v0, s[4:7], s33 offen offset:0 sc1 lds
  v_mfma_f32_32x32x16_bf16 v[56:71], v[108:111], a[20:23], v[56:71]
  ds_read_b128 v[104:107], v3 offset:2048
  v_mfma_f32_32x32x16_bf16 v[72:87], v[108:111], a[24:27], v[72:87]
  buffer_load_dwordx4 v0, s[4:7], s33 offen offset:1024 sc1 lds
  v_mfma_f32_32x32x16_bf16 v[88:103], v[108:111], a[28:31], v[88:103]
  buffer_load_dwordx4 v0, s[4:7], s33 offen offset:2048 sc1 lds
  s_waitcnt lgkmcnt(2)
  v_mfma_f32_32x32x16_bf16 v[40:55], v[112:115], a[32:35], v[40:55]
  v_mfma_f32_32x32x16_bf16 v[56:71], v[112:115], a[36:39], v[56:71]
  ds_read_b128 v[108:111], v3 offset:2560
  buffer_load_dwordx4 v0, s[4:7], s33 offen offset:3072 sc1 lds
  s_sub_u32 m0, m0, 8192
  s_sub_u32 s33, s33, 8192
  v_mfma_f32_32x32x16_bf16 v[72:87], v[112:115], a[40:43], v[72:87]
  buffer_load_dwordx4 v0, s[4:7], s33 offen offset:0 sc1 lds
  v_mfma_f32_32x32x16_bf16 v[88:103], v[112:115], a[44:47], v[88:103]
  s_waitcnt lgkmcnt(2)
  v_mfma_f32_32x32x16_bf16 v[40:55], v[116:119], a[48:51], v[40:55]
  buffer_load_dwordx4 v0, s[4:7], s33 offen offset:1024 sc1 lds
  v_mfma_f32_32x32x16_bf16 v[56:71], v[116:119], a[52:55], v[56:71]
  ds_read_b128 v[112:115], v3 offset:3072
  buffer_load_dwordx4 v0, s[4:7], s33 offen offset:2048 sc1 lds
  v_mfma_f32_32x32x16_bf16 v[72:87], v[116:119], a[56:59], v[72:87]
  v_mfma_f32_32x32x16_bf16 v[88:103], v[116:119], a[60:63], v[88:103]
  buffer_load_dwordx4 v0, s[4:7], s33 offen offset:3072 sc1 lds
  s_add_u32 m0, s23, s34
  s_add_u32 s32, s32, s18
  s_waitcnt lgkmcnt(2)
  v_mfma_f32_32x32x16_bf16 v[40:55], v[104:107], a[64:67], v[40:55]
  buffer_load_dwordx4 v0, s[4:7], s32 offen offset:0 sc1 lds
  v_mfma_f32_32x32x16_bf16 v[56:71], v[104:107], a[68:71], v[56:71]
  ds_read_b128 v[116:119], v3 offset:3584
  v_mfma_f32_32x32x16_bf16 v[72:87], v[104:107], a[72:75], v[72:87]
  buffer_load_dwordx4 v0, s[4:7], s32 offen offset:1024 sc1 lds
  s_add_i32 m0, m0, 4096
  s_add_i32 s32, s32, 4096
  v_mfma_f32_32x32x16_bf16 v[88:103], v[104:107], a[76:79], v[88:103]
  buffer_load_dwordx4 v0, s[4:7], s32 offen offset:0 sc1 lds
  s_waitcnt lgkmcnt(2)
  v_mfma_f32_32x32x16_bf16 v[40:55], v[108:111], a[80:83], v[40:55]
  v_mfma_f32_32x32x16_bf16 v[56:71], v[108:111], a[84:87], v[56:71]
  ds_read_b128 v[104:107], v3 offset:8192
  buffer_load_dwordx4 v0, s[4:7], s32 offen offset:1024 sc1 lds
  s_add_i32 m0, m0, -16384
  s_add_i32 s32, s32, -16384
  v_mfma_f32_32x32x16_bf16 v[72:87], v[108:111], a[88:91], v[72:87]
  s_and_b32 s29, s64, 0xff00
  s_lshl_b32 s29, s29, 3
  s_add_u32 s29, s29, s15
  buffer_load_dword v245, v252, s[4:7], s29 offen sc1
  v_mfma_f32_32x32x16_bf16 v[88:103], v[108:111], a[92:95], v[88:103]
  s_waitcnt lgkmcnt(2)
  v_mfma_f32_32x32x16_bf16 v[40:55], v[112:115], a[96:99], v[40:55]
  buffer_load_dwordx4 v0, s[4:7], s32 offen offset:0 sc1 lds
  v_mfma_f32_32x32x16_bf16 v[56:71], v[112:115], a[100:103], v[56:71]
  ds_read_b128 v[108:111], v3 offset:8704
  buffer_load_dwordx4 v0, s[4:7], s32 offen offset:1024 sc1 lds
  s_add_i32 m0, m0, -4096
  s_add_i32 s32, s32, -4096
  v_mfma_f32_32x32x16_bf16 v[72:87], v[112:115], a[104:107], v[72:87]
  v_mfma_f32_32x32x16_bf16 v[88:103], v[112:115], a[108:111], v[88:103]
  buffer_load_dwordx4 v0, s[4:7], s32 offen offset:0 sc1 lds
  s_waitcnt lgkmcnt(2)
  v_mfma_f32_32x32x16_bf16 v[40:55], v[116:119], a[112:115], v[40:55]
  buffer_load_dwordx4 v0, s[4:7], s32 offen offset:1024 sc1 lds
  v_mfma_f32_32x32x16_bf16 v[56:71], v[116:119], a[116:119], v[56:71]
  ds_read_b128 v[112:115], v3 offset:9216
  v_mfma_f32_32x32x16_bf16 v[72:87], v[116:119], a[120:123], v[72:87]
  buffer_load_dwordx4 v0, s[4:7], s32 offen offset:2048 sc1 lds
  v_mfma_f32_32x32x16_bf16 v[88:103], v[116:119], a[124:127], v[88:103]
  buffer_load_dwordx4 v0, s[4:7], s32 offen offset:3072 sc1 lds
  s_add_i32 m0, m0, 4096
  s_add_i32 s32, s32, 4096
  s_waitcnt lgkmcnt(2)
  v_mfma_f32_32x32x16_bf16 v[40:55], v[104:107], a[128:131], v[40:55]
  v_mfma_f32_32x32x16_bf16 v[56:71], v[104:107], a[132:135], v[56:71]
  ds_read_b128 v[116:119], v3 offset:9728
  buffer_load_dwordx4 v0, s[4:7], s32 offen offset:2048 sc1 lds
  v_mfma_f32_32x32x16_bf16 v[72:87], v[104:107], a[136:139], v[72:87]
  buffer_load_dwordx4 v0, s[4:7], s32 offen offset:3072 sc1 lds
  s_add_i32 m0, m0, 16384
  s_add_i32 s32, s32, 16384
  v_mfma_f32_32x32x16_bf16 v[88:103], v[104:107], a[140:143], v[88:103]
  s_waitcnt lgkmcnt(2)
  v_mfma_f32_32x32x16_bf16 v[40:55], v[108:111], a[144:147], v[40:55]
  buffer_load_dwordx4 v0, s[4:7], s32 offen offset:2048 sc1 lds
  v_mfma_f32_32x32x16_bf16 v[56:71], v[108:111], a[148:151], v[56:71]
  ds_read_b128 v[104:107], v3 offset:10240
  buffer_load_dwordx4 v0, s[4:7], s32 offen offset:3072 sc1 lds
  s_add_i32 m0, m0, -4096
  s_add_i32 s32, s32, -4096
  v_mfma_f32_32x32x16_bf16 v[72:87], v[108:111], a[152:155], v[72:87]
  v_mfma_f32_32x32x16_bf16 v[88:103], v[108:111], a[156:159], v[88:103]
  buffer_load_dwordx4 v0, s[4:7], s32 offen offset:2048 sc1 lds
  s_waitcnt lgkmcnt(2)
  v_mfma_f32_32x32x16_bf16 v[40:55], v[112:115], a[160:163], v[40:55]
  buffer_load_dwordx4 v0, s[4:7], s32 offen offset:3072 sc1 lds
  v_mfma_f32_32x32x16_bf16 v[56:71], v[112:115], a[164:167], v[56:71]
  ds_read_b128 v[108:111], v3 offset:10752
  v_mfma_f32_32x32x16_bf16 v[72:87], v[112:115], a[168:171], v[72:87]
  v_mfma_f32_32x32x16_bf16 v[88:103], v[112:115], a[172:175], v[88:103]
  s_waitcnt lgkmcnt(2)
  v_mfma_f32_32x32x16_bf16 v[40:55], v[116:119], a[176:179], v[40:55]
  v_mfma_f32_32x32x16_bf16 v[56:71], v[116:119], a[180:183], v[56:71]
  ds_read_b128 v[112:115], v3 offset:11264
  v_mfma_f32_32x32x16_bf16 v[72:87], v[116:119], a[184:187], v[72:87]
  v_mfma_f32_32x32x16_bf16 v[88:103], v[116:119], a[188:191], v[88:103]
  s_waitcnt lgkmcnt(2)
  v_mfma_f32_32x32x16_bf16 v[40:55], v[104:107], a[192:195], v[40:55]
  v_mfma_f32_32x32x16_bf16 v[56:71], v[104:107], a[196:199], v[56:71]
  ds_read_b128 v[116:119], v3 offset:11776
  s_waitcnt vmcnt(12)
  v_cmp_eq_u32 vcc, 0, v245
  s_cmp_eq_u64 vcc, 0
  s_cselect_b32 s76, s26, 0
  s_and_b32 s76, s76, 1
  s_cselect_b32 s88, s88, 1024
  s_waitcnt lgkmcnt(2)
  v_mfma_f32_32x32x16_bf16 v[40:55], v[108:111], a[208:211], v[40:55]
  s_lshl_b32 s32, s88, 18
  s_mov_b32 m0, s40
  s_add_u32 s32, s32, s21
  buffer_load_dwordx4 v0, s[4:7], s32 offen offset:0 sc1 lds
  v_mfma_f32_32x32x16_bf16 v[56:71], v[108:111], a[212:215], v[56:71]
  buffer_load_dwordx4 v0, s[4:7], s32 offen offset:1024 sc1 lds
  s_waitcnt lgkmcnt(1)
  v_mfma_f32_32x32x16_bf16 v[40:55], v[112:115], a[224:227], v[40:55]
  buffer_load_dwordx4 v0, s[4:7], s32 offen offset:2048 sc1 lds
  s_sub_u32 m0, m0, 8192
  s_sub_u32 s32, s32, 8192
  v_mfma_f32_32x32x16_bf16 v[56:71], v[112:115], a[228:231], v[56:71]
  buffer_load_dwordx4 v0, s[4:7], s32 offen offset:0 sc1 lds
  s_waitcnt lgkmcnt(0)
  v_mfma_f32_32x32x16_bf16 v[40:55], v[116:119], a[240:243], v[40:55]
  buffer_load_dwordx4 v0, s[4:7], s32 offen offset:1024 sc1 lds
  v_mfma_f32_32x32x16_bf16 v[56:71], v[116:119], a[244:247], v[56:71]
  buffer_load_dwordx4 v0, s[4:7], s32 offen offset:2048 sc1 lds
  v_cmp_eq_u32 vcc, 0, v249
  v_max_u32_dpp v249, v249, v249 row_ror:8 row_mask:0xf bank_mask:0xf
  s_nop 0
  v_mfma_f32_32x32x16_bf16 v[72:87], v[104:107], a[200:203], v[72:87]
  v_max_u32_dpp v249, v249, v249 row_ror:4 row_mask:0xf bank_mask:0xf
  s_nop 0
  s_nop 0
  v_max_u32_dpp v249, v249, v249 row_ror:2 row_mask:0xf bank_mask:0xf
  s_nop 0
  s_nop 0
  v_max_u32_dpp v249, v249, v249 row_ror:1 row_mask:0xf bank_mask:0xf
  s_nop 0
  v_mfma_f32_32x32x16_bf16 v[88:103], v[104:107], a[204:207], v[88:103]
  v_mov_b32 v248, v249
  s_nop 0
  s_nop 0
  v_permlane16_swap_b32 v249, v248
  v_max_u32 v249, v249, v248
  v_mfma_f32_32x32x16_bf16 v[72:87], v[108:111], a[216:219], v[72:87]
  v_mov_b32 v248, v249
  s_nop 0
  s_nop 0
  v_permlane32_swap_b32 v249, v248
  v_max_u32 v249, v249, v248
  s_cmp_eq_u64 vcc, 0
  s_cselect_b32 s28, 4, 0
  v_mfma_f32_32x32x16_bf16 v[88:103], v[108:111], a[220:223], v[88:103]
  s_lshl_b32 s26, s76, 1
  s_or_b32 s26, s26, s66
  s_or_b32 s26, s26, s28
  v_mov_b32 v248, s26
  ds_write_b64 v39, v[248:249]
  v_mfma_f32_32x32x16_bf16 v[72:87], v[112:115], a[232:235], v[72:87]
  v_cvt_pk_bf16_f32 v212, v40, v56
  v_cvt_pk_bf16_f32 v214, v41, v57
  v_cvt_pk_bf16_f32 v216, v42, v58
  v_cvt_pk_bf16_f32 v218, v43, v59
  v_permlane16_swap_b32 v212, v214
  v_mfma_f32_32x32x16_bf16 v[88:103], v[112:115], a[236:239], v[88:103]
  v_cvt_pk_bf16_f32 v220, v44, v60
  v_cvt_pk_bf16_f32 v222, v45, v61
  v_permlane16_swap_b32 v216, v218
  v_bfi_b32 v212, v254, s42, v212
  v_mfma_f32_32x32x16_bf16 v[72:87], v[116:119], a[248:251], v[72:87]
  v_cvt_pk_bf16_f32 v224, v46, v62
  v_cvt_pk_bf16_f32 v226, v47, v63
  v_permlane16_swap_b32 v220, v222
  v_bfi_b32 v216, v254, s42, v216
  v_cvt_pk_bf16_f32 v228, v48, v64
  v_mfma_f32_32x32x16_bf16 v[88:103], v[116:119], a[252:255], v[88:103]
  v_cvt_pk_bf16_f32 v230, v49, v65
  v_permlane16_swap_b32 v224, v226
  v_bfi_b32 v220, v254, s42, v220
  v_cvt_pk_bf16_f32 v232, v50, v66
  v_cvt_pk_bf16_f32 v234, v51, v67
  v_permlane16_swap_b32 v228, v230
  v_bfi_b32 v224, v254, s42, v224
  v_cvt_pk_bf16_f32 v236, v52, v68
  v_cvt_pk_bf16_f32 v238, v53, v69
  v_permlane16_swap_b32 v232, v234
  v_bfi_b32 v228, v254, s42, v228
  v_cvt_pk_bf16_f32 v240, v54, v70
  v_cvt_pk_bf16_f32 v242, v55, v71
  v_permlane16_swap_b32 v236, v238
  v_bfi_b32 v232, v254, s42, v232
  v_permlane16_swap_b32 v240, v242
  v_bfi_b32 v236, v254, s42, v236
  v_bfi_b32 v240, v254, s42, v240
  v_cvt_pk_bf16_f32 v213, v72, v88
  v_cvt_pk_bf16_f32 v215, v73, v89
  v_cvt_pk_bf16_f32 v217, v74, v90
  v_cvt_pk_bf16_f32 v219, v75, v91
  s_add_u32 s78, s86, 0
  v_permlane16_swap_b32 v213, v215
  buffer_store_dwordx4 v[212:215], v4, s[4:7], s78 offen
  v_cvt_pk_bf16_f32 v221, v76, v92
  v_cvt_pk_bf16_f32 v223, v77, v93
  s_add_u32 s78, s86, 32768
  v_permlane16_swap_b32 v217, v219
  buffer_store_dwordx4 v[216:219], v4, s[4:7], s78 offen
  v_cvt_pk_bf16_f32 v225, v78, v94
  v_cvt_pk_bf16_f32 v227, v79, v95
  s_add_u32 s78, s86, 131072
  v_permlane16_swap_b32 v221, v223
  buffer_store_dwordx4 v[220:223], v4, s[4:7], s78 offen
  v_cvt_pk_bf16_f32 v229, v80, v96
  v_cvt_pk_bf16_f32 v231, v81, v97
  s_add_u32 s78, s86, 163840
  v_permlane16_swap_b32 v225, v227
  buffer_store_dwordx4 v[224:227], v4, s[4:7], s78 offen
  v_cvt_pk_bf16_f32 v233, v82, v98
  v_cvt_pk_bf16_f32 v235, v83, v99
  s_add_u32 s78, s86, 262144
  v_permlane16_swap_b32 v229, v231
  buffer_store_dwordx4 v[228:231], v4, s[4:7], s78 offen
  v_cvt_pk_bf16_f32 v237, v84, v100
  v_cvt_pk_bf16_f32 v239, v85, v101
  s_add_u32 s78, s86, 294912
  v_permlane16_swap_b32 v233, v235
  buffer_store_dwordx4 v[232:235], v4, s[4:7], s78 offen
  v_cvt_pk_bf16_f32 v241, v86, v102
  v_cvt_pk_bf16_f32 v243, v87, v103
  s_add_u32 s78, s86, 393216
  v_permlane16_swap_b32 v237, v239
  buffer_store_dwordx4 v[236:239], v4, s[4:7], s78 offen
  s_add_u32 s78, s86, 425984
  v_permlane16_swap_b32 v241, v243
  buffer_store_dwordx4 v[240:243], v4, s[4:7], s78 offen
  s_waitcnt vmcnt(22)
  s_branch o_we_153
o_wr0_150:
  s_waitcnt lgkmcnt(0)
  s_barrier
  ds_read_b128 v[104:107], v3 offset:0
  ds_read_b128 v[108:111], v3 offset:512
  ds_read_b128 v[112:115], v3 offset:1024
  s_waitcnt lgkmcnt(2)
  v_mfma_f32_32x32x16_bf16 v[40:55], v[104:107], a[0:3], 0
  v_mfma_f32_32x32x16_bf16 v[56:71], v[104:107], a[4:7], 0
  ds_read_b128 v[116:119], v3 offset:1536
  v_mfma_f32_32x32x16_bf16 v[72:87], v[104:107], a[8:11], 0
  v_mfma_f32_32x32x16_bf16 v[88:103], v[104:107], a[12:15], 0
  s_waitcnt lgkmcnt(2)
  v_mfma_f32_32x32x16_bf16 v[40:55], v[108:111], a[16:19], v[40:55]
  v_mfma_f32_32x32x16_bf16 v[56:71], v[108:111], a[20:23], v[56:71]
  ds_read_b128 v[104:107], v3 offset:2048
  v_mfma_f32_32x32x16_bf16 v[72:87], v[108:111], a[24:27], v[72:87]
  v_mfma_f32_32x32x16_bf16 v[88:103], v[108:111], a[28:31], v[88:103]
  s_waitcnt lgkmcnt(2)
  v_mfma_f32_32x32x16_bf16 v[40:55], v[112:115], a[32:35], v[40:55]
  v_mfma_f32_32x32x16_bf16 v[56:71], v[112:115], a[36:39], v[56:71]
  ds_read_b128 v[108:111], v3 offset:2560
  v_mfma_f32_32x32x16_bf16 v[72:87], v[112:115], a[40:43], v[72:87]
  v_mfma_f32_32x32x16_bf16 v[88:103], v[112:115], a[44:47], v[88:103]
  s_waitcnt lgkmcnt(2)
  v_mfma_f32_32x32x16_bf16 v[40:55], v[116:119], a[48:51], v[40:55]
  v_mfma_f32_32x32x16_bf16 v[56:71], v[116:119], a[52:55], v[56:71]
  ds_read_b128 v[112:115], v3 offset:3072
  v_mfma_f32_32x32x16_bf16 v[72:87], v[116:119], a[56:59], v[72:87]
  v_mfma_f32_32x32x16_bf16 v[88:103], v[116:119], a[60:63], v[88:103]
  s_waitcnt lgkmcnt(2)
  v_mfma_f32_32x32x16_bf16 v[40:55], v[104:107], a[64:67], v[40:55]
  v_mfma_f32_32x32x16_bf16 v[56:71], v[104:107], a[68:71], v[56:71]
  ds_read_b128 v[116:119], v3 offset:3584
  v_mfma_f32_32x32x16_bf16 v[72:87], v[104:107], a[72:75], v[72:87]
  v_mfma_f32_32x32x16_bf16 v[88:103], v[104:107], a[76:79], v[88:103]
  s_waitcnt lgkmcnt(2)
  v_mfma_f32_32x32x16_bf16 v[40:55], v[108:111], a[80:83], v[40:55]
  v_mfma_f32_32x32x16_bf16 v[56:71], v[108:111], a[84:87], v[56:71]
  ds_read_b128 v[104:107], v3 offset:8192
  v_mfma_f32_32x32x16_bf16 v[72:87], v[108:111], a[88:91], v[72:87]
  v_mfma_f32_32x32x16_bf16 v[88:103], v[108:111], a[92:95], v[88:103]
  s_waitcnt lgkmcnt(2)
  v_mfma_f32_32x32x16_bf16 v[40:55], v[112:115], a[96:99], v[40:55]
  v_mfma_f32_32x32x16_bf16 v[56:71], v[112:115], a[100:103], v[56:71]
  ds_read_b128 v[108:111], v3 offset:8704
  v_mfma_f32_32x32x16_bf16 v[72:87], v[112:115], a[104:107], v[72:87]
  v_mfma_f32_32x32x16_bf16 v[88:103], v[112:115], a[108:111], v[88:103]
  s_waitcnt lgkmcnt(2)
  v_mfma_f32_32x32x16_bf16 v[40:55], v[116:119], a[112:115], v[40:55]
  v_mfma_f32_32x32x16_bf16 v[56:71], v[116:119], a[116:119], v[56:71]
  ds_read_b128 v[112:115], v3 offset:9216
  v_mfma_f32_32x32x16_bf16 v[72:87], v[116:119], a[120:123], v[72:87]
  v_mfma_f32_32x32x16_bf16 v[88:103], v[116:119], a[124:127], v[88:103]
  s_waitcnt lgkmcnt(2)
  v_mfma_f32_32x32x16_bf16 v[40:55], v[104:107], a[128:131], v[40:55]
  v_mfma_f32_32x32x16_bf16 v[56:71], v[104:107], a[132:135], v[56:71]
  ds_read_b128 v[116:119], v3 offset:9728
  v_mfma_f32_32x32x16_bf16 v[72:87], v[104:107], a[136:139], v[72:87]
  v_mfma_f32_32x32x16_bf16 v[88:103], v[104:107], a[140:143], v[88:103]
  s_waitcnt lgkmcnt(2)
  v_mfma_f32_32x32x16_bf16 v[40:55], v[108:111], a[144:147], v[40:55]
  v_mfma_f32_32x32x16_bf16 v[56:71], v[108:111], a[148:151], v[56:71]
  ds_read_b128 v[104:107], v3 offset:10240
  v_mfma_f32_32x32x16_bf16 v[72:87], v[108:111], a[152:155], v[72:87]
  v_mfma_f32_32x32x16_bf16 v[88:103], v[108:111], a[156:159], v[88:103]
  s_waitcnt lgkmcnt(2)
  v_mfma_f32_32x32x16_bf16 v[40:55], v[112:115], a[160:163], v[40:55]
  v_mfma_f32_32x32x16_bf16 v[56:71], v[112:115], a[164:167], v[56:71]
  ds_read_b128 v[108:111], v3 offset:10752
  v_mfma_f32_32x32x16_bf16 v[72:87], v[112:115], a[168:171], v[72:87]
  v_mfma_f32_32x32x16_bf16 v[88:103], v[112:115], a[172:175], v[88:103]
  s_waitcnt lgkmcnt(2)
  v_mfma_f32_32x32x16_bf16 v[40:55], v[116:119], a[176:179], v[40:55]
  v_mfma_f32_32x32x16_bf16 v[56:71], v[116:119], a[180:183], v[56:71]
  ds_read_b128 v[112:115], v3 offset:11264
  v_mfma_f32_32x32x16_bf16 v[72:87], v[116:119], a[184:187], v[72:87]
  v_mfma_f32_32x32x16_bf16 v[88:103], v[116:119], a[188:191], v[88:103]
  s_waitcnt lgkmcnt(2)
  v_mfma_f32_32x32x16_bf16 v[40:55], v[104:107], a[192:195], v[40:55]
  v_mfma_f32_32x32x16_bf16 v[56:71], v[104:107], a[196:199], v[56:71]
  ds_read_b128 v[116:119], v3 offset:11776
  s_waitcnt lgkmcnt(2)
  v_mfma_f32_32x32x16_bf16 v[40:55], v[108:111], a[208:211], v[40:55]
  v_mfma_f32_32x32x16_bf16 v[56:71], v[108:111], a[212:215], v[56:71]
  s_waitcnt lgkmcnt(1)
  v_mfma_f32_32x32x16_bf16 v[40:55], v[112:115], a[224:227], v[40:55]
  v_mfma_f32_32x32x16_bf16 v[56:71], v[112:115], a[228:231], v[56:71]
  s_waitcnt lgkmcnt(0)
  v_mfma_f32_32x32x16_bf16 v[40:55], v[116:119], a[240:243], v[40:55]
  v_mfma_f32_32x32x16_bf16 v[56:71], v[116:119], a[244:247], v[56:71]
  v_mfma_f32_32x32x16_bf16 v[72:87], v[104:107], a[200:203], v[72:87]
  v_mfma_f32_32x32x16_bf16 v[88:103], v[104:107], a[204:207], v[88:103]
  v_cvt_pk_bf16_f32 v212, v40, v56
  v_cvt_pk_bf16_f32 v214, v41, v57
  v_cvt_pk_bf16_f32 v216, v42, v58
  v_cvt_pk_bf16_f32 v218, v43, v59
  v_permlane16_swap_b32 v212, v214
  v_mfma_f32_32x32x16_bf16 v[72:87], v[108:111], a[216:219], v[72:87]
  v_cvt_pk_bf16_f32 v220, v44, v60
  v_cvt_pk_bf16_f32 v222, v45, v61
  v_permlane16_swap_b32 v216, v218
  v_bfi_b32 v212, v254, s42, v212
  v_cvt_pk_bf16_f32 v224, v46, v62
  v_mfma_f32_32x32x16_bf16 v[88:103], v[108:111], a[220:223], v[88:103]
  v_cvt_pk_bf16_f32 v226, v47, v63
  v_permlane16_swap_b32 v220, v222
  v_bfi_b32 v216, v254, s42, v216
  v_cvt_pk_bf16_f32 v228, v48, v64
  v_mfma_f32_32x32x16_bf16 v[72:87], v[112:115], a[232:235], v[72:87]
  v_cvt_pk_bf16_f32 v230, v49, v65
  v_permlane16_swap_b32 v224, v226
  v_bfi_b32 v220, v254, s42, v220
  v_cvt_pk_bf16_f32 v232, v50, v66
  v_cvt_pk_bf16_f32 v234, v51, v67
  v_mfma_f32_32x32x16_bf16 v[88:103], v[112:115], a[236:239], v[88:103]
  v_permlane16_swap_b32 v228, v230
  v_bfi_b32 v224, v254, s42, v224
  v_cvt_pk_bf16_f32 v236, v52, v68
  v_cvt_pk_bf16_f32 v238, v53, v69
  v_mfma_f32_32x32x16_bf16 v[72:87], v[116:119], a[248:251], v[72:87]
  v_permlane16_swap_b32 v232, v234
  v_bfi_b32 v228, v254, s42, v228
  v_cvt_pk_bf16_f32 v240, v54, v70
  v_cvt_pk_bf16_f32 v242, v55, v71
  v_permlane16_swap_b32 v236, v238
  v_mfma_f32_32x32x16_bf16 v[88:103], v[116:119], a[252:255], v[88:103]
  v_bfi_b32 v232, v254, s42, v232
  v_permlane16_swap_b32 v240, v242
  v_bfi_b32 v236, v254, s42, v236
  v_bfi_b32 v240, v254, s42, v240
  s_nop 7
  v_cvt_pk_bf16_f32 v213, v72, v88
  v_cvt_pk_bf16_f32 v215, v73, v89
  v_cvt_pk_bf16_f32 v217, v74, v90
  v_cvt_pk_bf16_f32 v219, v75, v91
  s_add_u32 s78, s86, 0
  v_permlane16_swap_b32 v213, v215
  buffer_store_dwordx4 v[212:215], v4, s[4:7], s78 offen
  v_cvt_pk_bf16_f32 v221, v76, v92
  v_cvt_pk_bf16_f32 v223, v77, v93
  s_add_u32 s78, s86, 32768
  v_permlane16_swap_b32 v217, v219
  buffer_store_dwordx4 v[216:219], v4, s[4:7], s78 offen
  v_cvt_pk_bf16_f32 v225, v78, v94
  v_cvt_pk_bf16_f32 v227, v79, v95
  s_add_u32 s78, s86, 131072
  v_permlane16_swap_b32 v221, v223
  buffer_store_dwordx4 v[220:223], v4, s[4:7], s78 offen
  v_cvt_pk_bf16_f32 v229, v80, v96
  v_cvt_pk_bf16_f32 v231, v81, v97
  s_add_u32 s78, s86, 163840
  v_permlane16_swap_b32 v225, v227
  buffer_store_dwordx4 v[224:227], v4, s[4:7], s78 offen
  v_cvt_pk_bf16_f32 v233, v82, v98
  v_cvt_pk_bf16_f32 v235, v83, v99
  s_add_u32 s78, s86, 262144
  v_permlane16_swap_b32 v229, v231
  buffer_store_dwordx4 v[228:231], v4, s[4:7], s78 offen
  v_cvt_pk_bf16_f32 v237, v84, v100
  v_cvt_pk_bf16_f32 v239, v85, v101
  s_add_u32 s78, s86, 294912
  v_permlane16_swap_b32 v233, v235
  buffer_store_dwordx4 v[232:235], v4, s[4:7], s78 offen
  v_cvt_pk_bf16_f32 v241, v86, v102
  v_cvt_pk_bf16_f32 v243, v87, v103
  s_add_u32 s78, s86, 393216
  v_permlane16_swap_b32 v237, v239
  buffer_store_dwordx4 v[236:239], v4, s[4:7], s78 offen
  s_add_u32 s78, s86, 425984
  v_permlane16_swap_b32 v241, v243
  buffer_store_dwordx4 v[240:243], v4, s[4:7], s78 offen
  s_branch o_we_153
o_wr1_151:
  s_nop 3
  v_mul_f32 v112, s24, v112
  v_mul_f32 v113, s24, v113
  v_exp_f32 v64, v112
  v_exp_f32 v65, v113
  v_max_f32 v116, v111, v116
  v_max3_f32 v116, v112, v113, v116
  v_add_f32 v117, v117, v64
  v_add_f32 v118, v118, v65
  v_add_f32 v117, v117, v118
  s_mov_b32 s28, 0x21800000
  v_mov_b32 v118, v117
  s_nop 1
  v_permlane16_swap_b32 v117, v118
  v_add_f32 v117, v117, v118
  v_mov_b32 v118, v117
  s_nop 0
  s_nop 0
  v_permlane32_swap_b32 v117, v118
  v_add_f32 v117, v117, v118
  s_mov_b32 s67, 0
  s_mov_b64 vcc, 0
  s_waitcnt vmcnt(3)
o_pl_159:
  v_and_b32 v7, 1, v7
  v_cmp_ne_u32 vcc, s96, v7
  s_cbranch_vccz o_pk_160
  buffer_load_dword v7, v255, s[4:7], s97 offen sc1
  s_add_u32 s67, s67, 1
  s_cmp_gt_u32 s67, 1048576
  s_cbranch_scc1 L_end
  s_waitcnt vmcnt(0)
  s_branch o_pl_159
o_pk_160:
  s_lshl_b32 s94, s43, 14
  s_add_u32 s94, s94, s95
  buffer_load_dwordx4 v[120:123], v5, s[4:7], s94 offen offset:0 sc1
  v_cmp_lt_f32 vcc, 0x42700000, v116
  v_cmp_gt_f32 s[30:31], s28, v117
  v_rcp_f32 v117, v117
  buffer_load_dwordx4 v[124:127], v5, s[4:7], s94 offen offset:512 sc1
  s_or_b64 vcc, vcc, s[30:31]
  s_cbranch_vccnz o_fb_157
o_fbr_158:
  buffer_load_dwordx4 v[128:131], v5, s[4:7], s94 offen offset:256 sc1
  v_pk_mul_f32 v[56:57], v[56:57], v[116:117] op_sel:[0,1] op_sel_hi:[1,1]
  v_pk_mul_f32 v[58:59], v[58:59], v[116:117] op_sel:[0,1] op_sel_hi:[1,1]
  v_pk_mul_f32 v[60:61], v[60:61], v[116:117] op_sel:[0,1] op_sel_hi:[1,1]
  v_pk_mul_f32 v[62:63], v[62:63], v[116:117] op_sel:[0,1] op_sel_hi:[1,1]
  v_pk_mul_f32 v[64:65], v[64:65], v[116:117] op_sel:[0,1] op_sel_hi:[1,1]
  buffer_load_dwordx4 v[132:135], v5, s[4:7], s94 offen offset:768 sc1
  v_cvt_pk_bf16_f32 v116, v56, v57
  v_cvt_pk_bf16_f32 v117, v58, v59
  v_cvt_pk_bf16_f32 v118, v60, v61
  v_cvt_pk_bf16_f32 v119, v62, v63
  s_waitcnt lgkmcnt(0)
  s_nop 0
  v_mfma_f32_16x16x32_bf16 v[72:75], v[152:155], v[116:119], 0
  s_add_u32 s62, s62, 1
  v_cvt_pk_bf16_f32 v197, v64, v65
  v_cvt_pk_bf16_f32 v198, v64, v65
  v_mfma_f32_16x16x32_bf16 v[76:79], v[156:159], v[116:119], 0
  s_add_u32 s94, s94, 4096
  buffer_load_dwordx4 v[136:139], v5, s[4:7], s94 offen offset:0 sc1
  s_xor_b32 s86, s86, 524288
  v_mfma_f32_16x16x32_bf16 v[80:83], v[160:163], v[116:119], 0
  s_bfe_u32 s42, s62, 0x10001
  v_mfma_f32_16x16x32_bf16 v[84:87], v[164:167], v[116:119], 0
  buffer_load_dwordx4 v[140:143], v5, s[4:7], s94 offen offset:512 sc1
  v_mfma_f32_16x16x32_bf16 v[88:91], v[168:171], v[116:119], 0
  v_mfma_f32_16x16x32_bf16 v[92:95], v[172:175], v[116:119], 0
  buffer_load_dwordx4 v[144:147], v5, s[4:7], s94 offen offset:256 sc1
  v_mfma_f32_16x16x32_bf16 v[96:99], v[176:179], v[116:119], 0
  v_mfma_f32_16x16x32_bf16 v[100:103], v[180:183], v[116:119], 0
  buffer_load_dwordx4 v[148:151], v5, s[4:7], s94 offen offset:768 sc1
  v_mfma_f32_16x16x16_bf16 v[72:75], v[200:201], v[198:199], v[72:75]
  s_nop 1
  v_mfma_f32_16x16x16_bf16 v[76:79], v[200:201], v[196:197], v[76:79]
  s_add_u32 s94, s94, 4096
  buffer_load_dwordx4 v[152:155], v5, s[4:7], s94 offen offset:0 sc1
  v_mfma_f32_16x16x16_bf16 v[80:83], v[202:203], v[198:199], v[80:83]
  s_nop 1
  v_mfma_f32_16x16x16_bf16 v[84:87], v[202:203], v[196:197], v[84:87]
  buffer_load_dwordx4 v[156:159], v5, s[4:7], s94 offen offset:512 sc1
  v_mfma_f32_16x16x16_bf16 v[88:91], v[204:205], v[198:199], v[88:91]
  s_nop 0
  v_cvt_pk_bf16_f32 v40, v72, v73
  v_cvt_pk_bf16_f32 v41, v74, v75
  v_mfma_f32_16x16x16_bf16 v[92:95], v[204:205], v[196:197], v[92:95]
  buffer_load_dwordx4 v[160:163], v5, s[4:7], s94 offen offset:256 sc1
  v_cvt_pk_bf16_f32 v42, v76, v77
  v_cvt_pk_bf16_f32 v43, v78, v79
  v_mfma_f32_16x16x16_bf16 v[96:99], v[206:207], v[198:199], v[96:99]
  s_nop 0
  ds_write_b128 v6, v[40:43] offset:0
  v_cvt_pk_bf16_f32 v44, v80, v81
  v_mfma_f32_16x16x16_bf16 v[100:103], v[206:207], v[196:197], v[100:103]
  buffer_load_dwordx4 v[164:167], v5, s[4:7], s94 offen offset:768 sc1
  v_cvt_pk_bf16_f32 v45, v82, v83
  v_cvt_pk_bf16_f32 v46, v84, v85
  v_cvt_pk_bf16_f32 v47, v86, v87
  ds_write_b128 v6, v[44:47] offset:1024
  v_cvt_pk_bf16_f32 v48, v88, v89
  v_cvt_pk_bf16_f32 v49, v90, v91
  v_cvt_pk_bf16_f32 v50, v92, v93
  v_cvt_pk_bf16_f32 v51, v94, v95
  s_add_u32 s94, s94, 4096
  buffer_load_dwordx4 v[168:171], v5, s[4:7], s94 offen offset:0 sc1
  ds_write_b128 v6, v[48:51] offset:2048
  v_cvt_pk_bf16_f32 v52, v96, v97
  v_cvt_pk_bf16_f32 v53, v98, v99
  v_cvt_pk_bf16_f32 v54, v100, v101
  v_cvt_pk_bf16_f32 v55, v102, v103
  ds_write_b128 v6, v[52:55] offset:3072
  buffer_load_dwordx4 v[172:175], v5, s[4:7], s94 offen offset:512 sc1
  s_and_b32 s26, s65, 49152
  s_cbranch_scc1 o_wr2_152
  s_waitcnt lgkmcnt(0)
  s_barrier
  ds_read_b128 v[104:107], v3 offset:0
  ds_read_b128 v[108:111], v3 offset:512
  ds_read_b128 v[112:115], v3 offset:1024
  buffer_load_dwordx4 v[176:179], v5, s[4:7], s94 offen offset:256 sc1
  buffer_load_dwordx4 v[180:183], v5, s[4:7], s94 offen offset:768 sc1
  s_waitcnt lgkmcnt(2)
  v_mfma_f32_32x32x16_bf16 v[40:55], v[104:107], a[0:3], 0
  v_mov_b64 v[188:189], 0
  v_mov_b64 v[190:191], 0
  v_mov_b64 v[192:193], 0
  v_mov_b64 v[194:195], 0
  s_mov_b64 exec, 1
  buffer_store_dword v38, off, s[4:7], s84 sc1
  s_mov_b64 exec, -1
  s_mov_b32 s84, 268435456
  v_mfma_f32_32x32x16_bf16 v[56:71], v[104:107], a[4:7], 0
  ds_read_b128 v[116:119], v3 offset:1536
  v_mfma_f32_32x32x16_bf16 v[72:87], v[104:107], a[8:11], 0
  v_mfma_f32_32x32x16_bf16 v[88:103], v[104:107], a[12:15], 0
  s_waitcnt vmcnt(13)
  v_xor_b32 v7, s96, v120
  v_bitop3_b32 v7, v7, v124, s96 bitop3:0xf6
  v_bitop3_b32 v7, v7, v128, s96 bitop3:0xf6
  v_bitop3_b32 v7, v7, v132, s96 bitop3:0xf6
  s_waitcnt lgkmcnt(2)
  v_mfma_f32_32x32x16_bf16 v[40:55], v[108:111], a[16:19], v[40:55]
  s_waitcnt vmcnt(9)
  v_bitop3_b32 v7, v7, v136, s96 bitop3:0xf6
  v_bitop3_b32 v7, v7, v140, s96 bitop3:0xf6
  v_bitop3_b32 v7, v7, v144, s96 bitop3:0xf6
  v_bitop3_b32 v7, v7, v148, s96 bitop3:0xf6
  s_waitcnt vmcnt(5)
  v_mfma_f32_32x32x16_bf16 v[56:71], v[108:111], a[20:23], v[56:71]
  ds_read_b128 v[104:107], v3 offset:2048
  v_bitop3_b32 v7, v7, v152, s96 bitop3:0xf6
  v_bitop3_b32 v7, v7, v156, s96 bitop3:0xf6
  v_bitop3_b32 v7, v7, v160, s96 bitop3:0xf6
  v_bitop3_b32 v7, v7, v164, s96 bitop3:0xf6
  s_waitcnt vmcnt(1)
  v_mfma_f32_32x32x16_bf16 v[72:87], v[108:111], a[24:27], v[72:87]
  v_bitop3_b32 v7, v7, v168, s96 bitop3:0xf6
  v_bitop3_b32 v7, v7, v172, s96 bitop3:0xf6
  v_bitop3_b32 v7, v7, v176, s96 bitop3:0xf6
  v_bitop3_b32 v7, v7, v180, s96 bitop3:0xf6
  v_and_b32 v7, v254, v7
  v_cmp_ne_u32 vcc, 0, v7
  s_cbranch_vccnz o_rt_161
o_bk_162:
  v_mfma_f32_32x32x16_bf16 v[88:103], v[108:111], a[28:31], v[88:103]
  v_smfmac_f32_16x16x64_bf16 v[188:191], v[16:19], v[120:127], v20
  v_lshlrev_b32 v196, 16, v184
  v_smfmac_f32_16x16x64_bf16 v[192:195], v[16:19], v[128:135], v20
  v_and_b32 v197, 0xffff0000, v184
  v_smfmac_f32_16x16x64_bf16 v[188:191], v[16:19], v[136:143], v20
  v_lshlrev_b32 v198, 16, v185
  s_waitcnt lgkmcnt(2)
  v_mfma_f32_32x32x16_bf16 v[40:55], v[112:115], a[32:35], v[40:55]
  v_smfmac_f32_16x16x64_bf16 v[192:195], v[16:19], v[144:151], v20
  v_and_b32 v199, 0xffff0000, v185
  v_smfmac_f32_16x16x64_bf16 v[188:191], v[16:19], v[152:159], v20
  v_lshlrev_b32 v200, 16, v186
  v_smfmac_f32_16x16x64_bf16 v[192:195], v[16:19], v[160:167], v20
  v_and_b32 v201, 0xffff0000, v186
  v_mfma_f32_32x32x16_bf16 v[56:71], v[112:115], a[36:39], v[56:71]
  ds_read_b128 v[108:111], v3 offset:2560
  v_smfmac_f32_16x16x64_bf16 v[188:191], v[16:19], v[168:175], v20
  v_lshlrev_b32 v202, 16, v187
  v_smfmac_f32_16x16x64_bf16 v[192:195], v[16:19], v[176:183], v20
  v_and_b32 v203, 0xffff0000, v187
  s_bfe_u32 s92, s65, 131086
  v_mfma_f32_32x32x16_bf16 v[72:87], v[112:115], a[40:43], v[72:87]
  s_lshl_b32 s92, s92, 21
  s_add_u32 s92, s92, s91
  s_add_u32 s93, s92, 27262976
  s_add_u32 s92, s92, 20971520
  v_permlane16_swap_b32 v188, v192
  v_mfma_f32_32x32x16_bf16 v[88:103], v[112:115], a[44:47], v[88:103]
  v_permlane16_swap_b32 v189, v193
  v_permlane16_swap_b32 v190, v194
  v_permlane16_swap_b32 v191, v195
  s_waitcnt lgkmcnt(2)
  v_mfma_f32_32x32x16_bf16 v[40:55], v[116:119], a[48:51], v[40:55]
  v_cvt_pk_bf16_f32 v188, 0, v188
  v_cvt_pk_bf16_f32 v189, 0, v189
  v_cvt_pk_bf16_f32 v190, 0, v190
  v_cvt_pk_bf16_f32 v191, 0, v191
  v_cvt_pk_bf16_f32 v192, 0, v192
  v_cvt_pk_bf16_f32 v193, 0, v193
  v_mfma_f32_32x32x16_bf16 v[56:71], v[116:119], a[52:55], v[56:71]
  ds_read_b128 v[112:115], v3 offset:3072
  v_cvt_pk_bf16_f32 v194, 0, v194
  v_cvt_pk_bf16_f32 v195, 0, v195
  v_add_f32 v196, v196, v188
  v_add_f32 v197, v197, v189
  v_add_f32 v198, v198, v190
  v_mfma_f32_32x32x16_bf16 v[72:87], v[116:119], a[56:59], v[72:87]
  v_add_f32 v199, v199, v191
  v_add_f32 v200, v200, v192
  v_add_f32 v201, v201, v193
  v_add_f32 v202, v202, v194
  v_add_f32 v203, v203, v195
  v_cvt_pk_bf16_f32 v120, v196, v197
  v_mfma_f32_32x32x16_bf16 v[88:103], v[116:119], a[60:63], v[88:103]
  v_cvt_pk_bf16_f32 v121, v198, v199
  v_cvt_pk_bf16_f32 v122, v200, v201
  v_cvt_pk_bf16_f32 v123, v202, v203
  v_lshlrev_b32 v196, 16, v120
  v_and_b32 v197, 0xffff0000, v120
  s_waitcnt lgkmcnt(2)
  v_mfma_f32_32x32x16_bf16 v[40:55], v[104:107], a[64:67], v[40:55]
  v_lshlrev_b32 v198, 16, v121
  v_and_b32 v199, 0xffff0000, v121
  v_lshlrev_b32 v200, 16, v122
  v_and_b32 v201, 0xffff0000, v122
  v_lshlrev_b32 v202, 16, v123
  v_and_b32 v203, 0xffff0000, v123
  v_mfma_f32_32x32x16_bf16 v[56:71], v[104:107], a[68:71], v[56:71]
  ds_read_b128 v[116:119], v3 offset:3584
  buffer_store_dwordx4 v[120:123], v0, s[4:7], s92 offen sc1
  v_add_f32 v136, v196, v197
  v_mul_f32 v137, v196, v196
  v_mfma_f32_32x32x16_bf16 v[72:87], v[104:107], a[72:75], v[72:87]
  v_add_f32 v138, v198, v199
  v_mul_f32 v139, v197, v197
  v_fmac_f32 v137, v198, v198
  v_fmac_f32 v139, v199, v199
  v_add_f32 v136, v136, v200
  v_fmac_f32 v137, v200, v200
  v_mfma_f32_32x32x16_bf16 v[88:103], v[104:107], a[76:79], v[88:103]
  v_add_f32 v138, v138, v201
  v_fmac_f32 v139, v201, v201
  v_add_f32 v136, v136, v202
  v_fmac_f32 v137, v202, v202
  v_add_f32 v138, v138, v203
  s_waitcnt lgkmcnt(2)
  v_mfma_f32_32x32x16_bf16 v[40:55], v[108:111], a[80:83], v[40:55]
  v_fmac_f32 v139, v203, v203
  v_add_f32 v136, v136, v138
  v_add_f32 v137, v137, v139
  s_nop 0
  v_add_f32_dpp v136, v136, v136 row_ror:8 row_mask:0xf bank_mask:0xf
  v_add_f32_dpp v137, v137, v137 row_ror:8 row_mask:0xf bank_mask:0xf
  s_nop 0
  v_add_f32_dpp v136, v136, v136 row_ror:4 row_mask:0xf bank_mask:0xf
  v_mfma_f32_32x32x16_bf16 v[56:71], v[108:111], a[84:87], v[56:71]
  ds_read_b128 v[104:107], v3 offset:8192
  v_add_f32_dpp v137, v137, v137 row_ror:4 row_mask:0xf bank_mask:0xf
  v_add_f32_dpp v136, v136, v136 row_ror:2 row_mask:0xf bank_mask:0xf
  s_nop 0
  v_add_f32_dpp v137, v137, v137 row_ror:2 row_mask:0xf bank_mask:0xf
  v_add_f32_dpp v136, v136, v136 row_ror:1 row_mask:0xf bank_mask:0xf
  s_nop 0
  v_add_f32_dpp v137, v137, v137 row_ror:1 row_mask:0xf bank_mask:0xf
  v_mfma_f32_32x32x16_bf16 v[72:87], v[108:111], a[88:91], v[72:87]
  v_mov_b32 v140, v136
  v_mov_b32 v141, v137
  s_nop 0
  v_permlane16_swap_b32 v136, v140
  v_permlane16_swap_b32 v137, v141
  v_mfma_f32_32x32x16_bf16 v[88:103], v[108:111], a[92:95], v[88:103]
  v_add_f32 v136, v136, v140
  v_add_f32 v137, v137, v141
  v_mov_b32 v140, v136
  v_mov_b32 v141, v137
  s_nop 0
  v_permlane32_swap_b32 v136, v140
  s_waitcnt lgkmcnt(2)
  v_mfma_f32_32x32x16_bf16 v[40:55], v[112:115], a[96:99], v[40:55]
  v_permlane32_swap_b32 v137, v141
  v_add_f32 v136, v136, v140
  v_add_f32 v137, v137, v141
  v_mul_f32 v136, 0x3b000000, v136
  v_mul_f32 v137, 0x3b000000, v137
  v_mfma_f32_32x32x16_bf16 v[56:71], v[112:115], a[100:103], v[56:71]
  ds_read_b128 v[108:111], v3 offset:8704
  v_fma_f32 v137, -v136, v136, v137
  v_cvt_pk_bf16_f32 v136, 0, v136
  v_max_f32 v137, 0, v137
  v_sub_f32 v140, v196, v136
  v_sub_f32 v141, v197, v136
  v_mfma_f32_32x32x16_bf16 v[72:87], v[112:115], a[104:107], v[72:87]
  v_cvt_pk_bf16_f32 v137, 0, v137
  v_sub_f32 v142, v198, v136
  v_sub_f32 v143, v199, v136
  v_add_f32 v137, 0x3727c5ac, v137
  v_sub_f32 v144, v200, v136
  v_sub_f32 v145, v201, v136
  v_mfma_f32_32x32x16_bf16 v[88:103], v[112:115], a[108:111], v[88:103]
  v_cvt_pk_bf16_f32 v137, 0, v137
  v_sub_f32 v146, v202, v136
  v_sub_f32 v147, v203, v136
  v_sqrt_f32 v137, v137
  s_waitcnt lgkmcnt(2)
  v_mfma_f32_32x32x16_bf16 v[40:55], v[116:119], a[112:115], v[40:55]
  v_cvt_pk_bf16_f32 v140, 0, v140
  v_cvt_pk_bf16_f32 v141, 0, v141
  v_cvt_pk_bf16_f32 v137, 0, v137
  v_cvt_pk_bf16_f32 v142, 0, v142
  v_cvt_pk_bf16_f32 v143, 0, v143
  v_rcp_f32 v137, v137
  v_mfma_f32_32x32x16_bf16 v[56:71], v[116:119], a[116:119], v[56:71]
  ds_read_b128 v[112:115], v3 offset:9216
  v_cvt_pk_bf16_f32 v144, 0, v144
  v_cvt_pk_bf16_f32 v145, 0, v145
  v_cvt_pk_bf16_f32 v146, 0, v146
  v_cvt_pk_bf16_f32 v147, 0, v147
  v_mul_f32 v140, v140, v137
  v_mfma_f32_32x32x16_bf16 v[72:87], v[116:119], a[120:123], v[72:87]
  v_mul_f32 v141, v141, v137
  v_mul_f32 v142, v142, v137
  v_mul_f32 v143, v143, v137
  v_mul_f32 v144, v144, v137
  v_mul_f32 v145, v145, v137
  v_mul_f32 v146, v146, v137
  v_mfma_f32_32x32x16_bf16 v[88:103], v[116:119], a[124:127], v[88:103]
  v_mul_f32 v147, v147, v137
  v_cvt_pk_bf16_f32 v124, v140, v141
  v_cvt_pk_bf16_f32 v125, v142, v143
  v_cvt_pk_bf16_f32 v126, v144, v145
  v_cvt_pk_bf16_f32 v127, v146, v147
  s_waitcnt lgkmcnt(2)
  v_mfma_f32_32x32x16_bf16 v[40:55], v[104:107], a[128:131], v[40:55]
  v_lshlrev_b32 v204, 16, v124
  v_and_b32 v205, 0xffff0000, v124
  v_lshlrev_b32 v206, 16, v125
  v_and_b32 v207, 0xffff0000, v125
  v_lshlrev_b32 v208, 16, v126
  v_and_b32 v209, 0xffff0000, v126
  v_mfma_f32_32x32x16_bf16 v[56:71], v[104:107], a[132:135], v[56:71]
  ds_read_b128 v[116:119], v3 offset:9728
  v_lshlrev_b32 v210, 16, v127
  v_and_b32 v211, 0xffff0000, v127
  buffer_store_dwordx4 v[124:127], v0, s[4:7], s93 offen sc1
  v_mfma_f32_32x32x16_bf16 v[72:87], v[104:107], a[136:139], v[72:87]
  v_add_f32 v196, v196, v204
  v_add_f32 v197, v197, v205
  v_add_f32 v198, v198, v206
  v_add_f32 v199, v199, v207
  v_add_f32 v200, v200, v208
  v_add_f32 v201, v201, v209
  v_mfma_f32_32x32x16_bf16 v[88:103], v[104:107], a[140:143], v[88:103]
  v_add_f32 v202, v202, v210
  v_add_f32 v203, v203, v211
  v_cvt_pk_bf16_f32 v128, v196, v197
  v_cvt_pk_bf16_f32 v129, v198, v199
  v_cvt_pk_bf16_f32 v130, v200, v201
  s_waitcnt lgkmcnt(2)
  v_mfma_f32_32x32x16_bf16 v[40:55], v[108:111], a[144:147], v[40:55]
  v_cvt_pk_bf16_f32 v131, v202, v203
  v_mul_f32 v188, v204, v8
  v_mul_f32 v189, v205, v9
  v_fmac_f32 v188, v206, v10
  v_fmac_f32 v189, v207, v11
  v_fmac_f32 v188, v208, v12
  v_mfma_f32_32x32x16_bf16 v[56:71], v[108:111], a[148:151], v[56:71]
  ds_read_b128 v[104:107], v3 offset:10240
  v_fmac_f32 v189, v209, v13
  v_fmac_f32 v188, v210, v14
  v_fmac_f32 v189, v211, v15
  v_add_f32 v188, v188, v189
  s_add_u32 s92, s91, 10485760
  v_mfma_f32_32x32x16_bf16 v[72:87], v[108:111], a[152:155], v[72:87]
  s_add_u32 s93, s91, 8388608
  buffer_store_dwordx4 v[128:131], v0, s[4:7], s92 offen sc1
  v_lshlrev_b32 v196, 16, v128
  v_and_b32 v197, 0xffff0000, v128
  v_mfma_f32_32x32x16_bf16 v[88:103], v[108:111], a[156:159], v[88:103]
  v_lshlrev_b32 v198, 16, v129
  v_and_b32 v199, 0xffff0000, v129
  v_lshlrev_b32 v200, 16, v130
  v_and_b32 v201, 0xffff0000, v130
  v_lshlrev_b32 v202, 16, v131
  s_waitcnt lgkmcnt(2)
  v_mfma_f32_32x32x16_bf16 v[40:55], v[112:115], a[160:163], v[40:55]
  v_and_b32 v203, 0xffff0000, v131
  v_add_f32 v136, v196, v197
  v_mul_f32 v137, v196, v196
  v_add_f32 v138, v198, v199
  v_mul_f32 v139, v197, v197
  v_fmac_f32 v137, v198, v198
  v_mfma_f32_32x32x16_bf16 v[56:71], v[112:115], a[164:167], v[56:71]
  ds_read_b128 v[108:111], v3 offset:10752
  v_fmac_f32 v139, v199, v199
  v_add_f32 v136, v136, v200
  v_fmac_f32 v137, v200, v200
  v_add_f32 v138, v138, v201
  v_fmac_f32 v139, v201, v201
  v_mfma_f32_32x32x16_bf16 v[72:87], v[112:115], a[168:171], v[72:87]
  v_add_f32 v136, v136, v202
  v_fmac_f32 v137, v202, v202
  v_add_f32 v138, v138, v203
  v_fmac_f32 v139, v203, v203
  v_add_f32 v136, v136, v138
  v_add_f32 v137, v137, v139
  v_mfma_f32_32x32x16_bf16 v[88:103], v[112:115], a[172:175], v[88:103]
  v_add_f32_dpp v136, v136, v136 row_ror:8 row_mask:0xf bank_mask:0xf
  v_add_f32_dpp v137, v137, v137 row_ror:8 row_mask:0xf bank_mask:0xf
  v_add_f32_dpp v188, v188, v188 row_ror:8 row_mask:0xf bank_mask:0xf
  v_add_f32_dpp v136, v136, v136 row_ror:4 row_mask:0xf bank_mask:0xf
  v_add_f32_dpp v137, v137, v137 row_ror:4 row_mask:0xf bank_mask:0xf
  s_waitcnt lgkmcnt(2)
  v_mfma_f32_32x32x16_bf16 v[40:55], v[116:119], a[176:179], v[40:55]
  v_add_f32_dpp v188, v188, v188 row_ror:4 row_mask:0xf bank_mask:0xf
  v_add_f32_dpp v136, v136, v136 row_ror:2 row_mask:0xf bank_mask:0xf
  v_add_f32_dpp v137, v137, v137 row_ror:2 row_mask:0xf bank_mask:0xf
  v_add_f32_dpp v188, v188, v188 row_ror:2 row_mask:0xf bank_mask:0xf
  v_add_f32_dpp v136, v136, v136 row_ror:1 row_mask:0xf bank_mask:0xf
  v_add_f32_dpp v137, v137, v137 row_ror:1 row_mask:0xf bank_mask:0xf
  v_mfma_f32_32x32x16_bf16 v[56:71], v[116:119], a[180:183], v[56:71]
  ds_read_b128 v[112:115], v3 offset:11264
  v_add_f32_dpp v188, v188, v188 row_ror:1 row_mask:0xf bank_mask:0xf
  v_mov_b32 v140, v136
  v_mov_b32 v141, v137
  v_mov_b32 v142, v188
  v_permlane16_swap_b32 v136, v140
  v_mfma_f32_32x32x16_bf16 v[72:87], v[116:119], a[184:187], v[72:87]
  v_permlane16_swap_b32 v137, v141
  v_permlane16_swap_b32 v188, v142
  v_add_f32 v136, v136, v140
  v_add_f32 v137, v137, v141
  v_mfma_f32_32x32x16_bf16 v[88:103], v[116:119], a[188:191], v[88:103]
  v_add_f32 v188, v188, v142
  v_mov_b32 v140, v136
  v_mov_b32 v141, v137
  v_mov_b32 v142, v188
  v_permlane32_swap_b32 v136, v140
  s_waitcnt lgkmcnt(2)
  v_mfma_f32_32x32x16_bf16 v[40:55], v[104:107], a[192:195], v[40:55]
  v_permlane32_swap_b32 v137, v141
  v_permlane32_swap_b32 v188, v142
  v_add_f32 v136, v136, v140
  v_add_f32 v137, v137, v141
  v_mfma_f32_32x32x16_bf16 v[56:71], v[104:107], a[196:199], v[56:71]
  ds_read_b128 v[116:119], v3 offset:11776
  v_add_f32 v188, v188, v142
  v_mul_f32 v136, 0x3b000000, v136
  v_mul_f32 v137, 0x3b000000, v137
  v_fma_f32 v137, -v136, v136, v137
  v_cvt_pk_bf16_f32 v136, 0, v136
  s_waitcnt lgkmcnt(2)
  v_mfma_f32_32x32x16_bf16 v[40:55], v[108:111], a[208:211], v[40:55]
  v_max_f32 v137, 0, v137
  v_sub_f32 v140, v196, v136
  v_sub_f32 v141, v197, v136
  v_cvt_pk_bf16_f32 v137, 0, v137
  v_sub_f32 v142, v198, v136
  v_sub_f32 v143, v199, v136
  v_mfma_f32_32x32x16_bf16 v[56:71], v[108:111], a[212:215], v[56:71]
  v_add_f32 v137, 0x3727c5ac, v137
  v_sub_f32 v144, v200, v136
  v_sub_f32 v145, v201, v136
  v_cvt_pk_bf16_f32 v137, 0, v137
  v_sub_f32 v146, v202, v136
  v_sub_f32 v147, v203, v136
  s_waitcnt lgkmcnt(1)
  v_mfma_f32_32x32x16_bf16 v[40:55], v[112:115], a[224:227], v[40:55]
  v_sqrt_f32 v137, v137
  v_cvt_pk_bf16_f32 v140, 0, v140
  v_cvt_pk_bf16_f32 v141, 0, v141
  v_cvt_pk_bf16_f32 v137, 0, v137
  v_cvt_pk_bf16_f32 v142, 0, v142
  v_mfma_f32_32x32x16_bf16 v[56:71], v[112:115], a[228:231], v[56:71]
  v_cvt_pk_bf16_f32 v143, 0, v143
  v_rcp_f32 v137, v137
  v_cvt_pk_bf16_f32 v144, 0, v144
  v_cvt_pk_bf16_f32 v145, 0, v145
  v_cvt_pk_bf16_f32 v146, 0, v146
  s_waitcnt lgkmcnt(0)
  v_mfma_f32_32x32x16_bf16 v[40:55], v[116:119], a[240:243], v[40:55]
  v_cvt_pk_bf16_f32 v147, 0, v147
  v_mul_f32 v140, v140, v137
  v_mul_f32 v141, v141, v137
  v_mul_f32 v142, v142, v137
  v_mul_f32 v143, v143, v137
  v_mul_f32 v144, v144, v137
  v_mfma_f32_32x32x16_bf16 v[56:71], v[116:119], a[244:247], v[56:71]
  v_mul_f32 v145, v145, v137
  v_mul_f32 v146, v146, v137
  v_mul_f32 v147, v147, v137
  v_cvt_pk_bf16_f32 v132, v140, v141
  v_cvt_pk_bf16_f32 v133, v142, v143
  v_cvt_pk_bf16_f32 v134, v144, v145
  v_mfma_f32_32x32x16_bf16 v[72:87], v[104:107], a[200:203], v[72:87]
  v_cvt_pk_bf16_f32 v135, v146, v147
  buffer_store_dwordx4 v[132:135], v0, s[4:7], s93 offen sc1
  v_cvt_pk_bf16_f32 v188, 0, v188
  v_ashrrev_i32 v189, 31, v188
  v_mfma_f32_32x32x16_bf16 v[88:103], v[104:107], a[204:207], v[88:103]
  v_or_b32 v189, 0x80000000, v189
  v_xor_b32 v188, v188, v189
  s_sub_u32 s92, 4095, s90
  v_and_b32 v188, 0xffff0000, v188
  v_or_b32 v38, s92, v188
  v_mfma_f32_32x32x16_bf16 v[72:87], v[108:111], a[216:219], v[72:87]
  s_bfe_u32 s92, s65, 196625
  s_lshl_b32 s92, s92, 18
  s_lshl_b32 s93, s90, 7
  s_add_u32 s92, s92, s93
  s_add_u32 s84, s92, 243269632
  v_cvt_pk_bf16_f32 v212, v40, v56
  v_mfma_f32_32x32x16_bf16 v[88:103], v[108:111], a[220:223], v[88:103]
  v_cvt_pk_bf16_f32 v214, v41, v57
  v_cvt_pk_bf16_f32 v216, v42, v58
  v_cvt_pk_bf16_f32 v218, v43, v59
  v_permlane16_swap_b32 v212, v214
  v_mfma_f32_32x32x16_bf16 v[72:87], v[112:115], a[232:235], v[72:87]
  v_cvt_pk_bf16_f32 v220, v44, v60
  v_cvt_pk_bf16_f32 v222, v45, v61
  v_permlane16_swap_b32 v216, v218
  v_bfi_b32 v212, v254, s42, v212
  v_cvt_pk_bf16_f32 v224, v46, v62
  v_mfma_f32_32x32x16_bf16 v[88:103], v[112:115], a[236:239], v[88:103]
  v_cvt_pk_bf16_f32 v226, v47, v63
  v_permlane16_swap_b32 v220, v222
  v_bfi_b32 v216, v254, s42, v216
  v_cvt_pk_bf16_f32 v228, v48, v64
  v_mfma_f32_32x32x16_bf16 v[72:87], v[116:119], a[248:251], v[72:87]
  v_cvt_pk_bf16_f32 v230, v49, v65
  v_permlane16_swap_b32 v224, v226
  v_bfi_b32 v220, v254, s42, v220
  v_cvt_pk_bf16_f32 v232, v50, v66
  v_cvt_pk_bf16_f32 v234, v51, v67
  v_mfma_f32_32x32x16_bf16 v[88:103], v[116:119], a[252:255], v[88:103]
  v_permlane16_swap_b32 v228, v230
  v_bfi_b32 v224, v254, s42, v224
  v_cvt_pk_bf16_f32 v236, v52, v68
  v_cvt_pk_bf16_f32 v238, v53, v69
  v_permlane16_swap_b32 v232, v234
  v_bfi_b32 v228, v254, s42, v228
  v_cvt_pk_bf16_f32 v240, v54, v70
  v_cvt_pk_bf16_f32 v242, v55, v71
  v_permlane16_swap_b32 v236, v238
  v_bfi_b32 v232, v254, s42, v232
  v_permlane16_swap_b32 v240, v242
  v_bfi_b32 v236, v254, s42, v236
  v_bfi_b32 v240, v254, s42, v240
  v_cvt_pk_bf16_f32 v213, v72, v88
  v_cvt_pk_bf16_f32 v215, v73, v89
  v_cvt_pk_bf16_f32 v217, v74, v90
  v_cvt_pk_bf16_f32 v219, v75, v91
  s_add_u32 s78, s86, 0
  v_permlane16_swap_b32 v213, v215
  buffer_store_dwordx4 v[212:215], v4, s[4:7], s78 offen
  v_cvt_pk_bf16_f32 v221, v76, v92
  v_cvt_pk_bf16_f32 v223, v77, v93
  s_add_u32 s78, s86, 32768
  v_permlane16_swap_b32 v217, v219
  buffer_store_dwordx4 v[216:219], v4, s[4:7], s78 offen
  v_cvt_pk_bf16_f32 v225, v78, v94
  v_cvt_pk_bf16_f32 v227, v79, v95
  s_add_u32 s78, s86, 131072
  v_permlane16_swap_b32 v221, v223
  buffer_store_dwordx4 v[220:223], v4, s[4:7], s78 offen
  v_cvt_pk_bf16_f32 v229, v80, v96
  v_cvt_pk_bf16_f32 v231, v81, v97
  s_add_u32 s78, s86, 163840
  v_permlane16_swap_b32 v225, v227
  buffer_store_dwordx4 v[224:227], v4, s[4:7], s78 offen
  v_cvt_pk_bf16_f32 v233, v82, v98
  v_cvt_pk_bf16_f32 v235, v83, v99
  s_add_u32 s78, s86, 262144
  v_permlane16_swap_b32 v229, v231
  buffer_store_dwordx4 v[228:231], v4, s[4:7], s78 offen
  v_cvt_pk_bf16_f32 v237, v84, v100
  v_cvt_pk_bf16_f32 v239, v85, v101
  s_add_u32 s78, s86, 294912
  v_permlane16_swap_b32 v233, v235
  buffer_store_dwordx4 v[232:235], v4, s[4:7], s78 offen
  v_cvt_pk_bf16_f32 v241, v86, v102
  v_cvt_pk_bf16_f32 v243, v87, v103
  s_add_u32 s78, s86, 393216
  v_permlane16_swap_b32 v237, v239
  buffer_store_dwordx4 v[236:239], v4, s[4:7], s78 offen
  s_add_u32 s78, s86, 425984
  v_permlane16_swap_b32 v241, v243
  buffer_store_dwordx4 v[240:243], v4, s[4:7], s78 offen
  s_waitcnt vmcnt(8)
  s_mov_b64 exec, 1
  buffer_store_dword v38, off, s[4:7], s84 sc1
  s_mov_b64 exec, -1
  s_mov_b32 s84, 268435456
  s_branch o_we_153
o_rt_161:
  s_mov_b32 s67, 0
o_rl_165:
  s_lshl_b32 s94, s43, 14
  s_add_u32 s94, s94, s95
  buffer_load_dwordx4 v[120:123], v5, s[4:7], s94 offen offset:0 sc1
  buffer_load_dwordx4 v[124:127], v5, s[4:7], s94 offen offset:512 sc1
  buffer_load_dwordx4 v[128:131], v5, s[4:7], s94 offen offset:256 sc1
  buffer_load_dwordx4 v[132:135], v5, s[4:7], s94 offen offset:768 sc1
  s_add_u32 s94, s94, 4096
  buffer_load_dwordx4 v[136:139], v5, s[4:7], s94 offen offset:0 sc1
  buffer_load_dwordx4 v[140:143], v5, s[4:7], s94 offen offset:512 sc1
  buffer_load_dwordx4 v[144:147], v5, s[4:7], s94 offen offset:256 sc1
  buffer_load_dwordx4 v[148:151], v5, s[4:7], s94 offen offset:768 sc1
  s_add_u32 s94, s94, 4096
  buffer_load_dwordx4 v[152:155], v5, s[4:7], s94 offen offset:0 sc1
  buffer_load_dwordx4 v[156:159], v5, s[4:7], s94 offen offset:512 sc1
  buffer_load_dwordx4 v[160:163], v5, s[4:7], s94 offen offset:256 sc1
  buffer_load_dwordx4 v[164:167], v5, s[4:7], s94 offen offset:768 sc1
  s_add_u32 s94, s94, 4096
  buffer_load_dwordx4 v[168:171], v5, s[4:7], s94 offen offset:0 sc1
  buffer_load_dwordx4 v[172:175], v5, s[4:7], s94 offen offset:512 sc1
  buffer_load_dwordx4 v[176:179], v5, s[4:7], s94 offen offset:256 sc1
  buffer_load_dwordx4 v[180:183], v5, s[4:7], s94 offen offset:768 sc1
  s_add_u32 s67, s67, 1
  s_cmp_gt_u32 s67, 1048576
  s_cbranch_scc1 L_end
  s_waitcnt vmcnt(0)
  v_xor_b32 v7, s96, v120
  v_bitop3_b32 v7, v7, v124, s96 bitop3:0xf6
  v_bitop3_b32 v7, v7, v128, s96 bitop3:0xf6
  v_bitop3_b32 v7, v7, v132, s96 bitop3:0xf6
  v_bitop3_b32 v7, v7, v136, s96 bitop3:0xf6
  v_bitop3_b32 v7, v7, v140, s96 bitop3:0xf6
  v_bitop3_b32 v7, v7, v144, s96 bitop3:0xf6
  v_bitop3_b32 v7, v7, v148, s96 bitop3:0xf6
  v_bitop3_b32 v7, v7, v152, s96 bitop3:0xf6
  v_bitop3_b32 v7, v7, v156, s96 bitop3:0xf6
  v_bitop3_b32 v7, v7, v160, s96 bitop3:0xf6
  v_bitop3_b32 v7, v7, v164, s96 bitop3:0xf6
  v_bitop3_b32 v7, v7, v168, s96 bitop3:0xf6
  v_bitop3_b32 v7, v7, v172, s96 bitop3:0xf6
  v_bitop3_b32 v7, v7, v176, s96 bitop3:0xf6
  v_bitop3_b32 v7, v7, v180, s96 bitop3:0xf6
  v_and_b32 v7, v254, v7
  v_cmp_ne_u32 vcc, 0, v7
  s_cbranch_vccnz o_rl_165
  s_branch o_bk_162
o_rt_163:
  s_mov_b32 s67, 0
o_rl_166:
  s_lshl_b32 s94, s43, 14
  s_add_u32 s94, s94, s95
  buffer_load_dwordx4 v[120:123], v5, s[4:7], s94 offen offset:0 sc1
  buffer_load_dwordx4 v[124:127], v5, s[4:7], s94 offen offset:512 sc1
  buffer_load_dwordx4 v[128:131], v5, s[4:7], s94 offen offset:256 sc1
  buffer_load_dwordx4 v[132:135], v5, s[4:7], s94 offen offset:768 sc1
  s_add_u32 s94, s94, 4096
  buffer_load_dwordx4 v[136:139], v5, s[4:7], s94 offen offset:0 sc1
  buffer_load_dwordx4 v[140:143], v5, s[4:7], s94 offen offset:512 sc1
  buffer_load_dwordx4 v[144:147], v5, s[4:7], s94 offen offset:256 sc1
  buffer_load_dwordx4 v[148:151], v5, s[4:7], s94 offen offset:768 sc1
  s_add_u32 s94, s94, 4096
  buffer_load_dwordx4 v[152:155], v5, s[4:7], s94 offen offset:0 sc1
  buffer_load_dwordx4 v[156:159], v5, s[4:7], s94 offen offset:512 sc1
  buffer_load_dwordx4 v[160:163], v5, s[4:7], s94 offen offset:256 sc1
  buffer_load_dwordx4 v[164:167], v5, s[4:7], s94 offen offset:768 sc1
  s_add_u32 s94, s94, 4096
  buffer_load_dwordx4 v[168:171], v5, s[4:7], s94 offen offset:0 sc1
  buffer_load_dwordx4 v[172:175], v5, s[4:7], s94 offen offset:512 sc1
  buffer_load_dwordx4 v[176:179], v5, s[4:7], s94 offen offset:256 sc1
  buffer_load_dwordx4 v[180:183], v5, s[4:7], s94 offen offset:768 sc1
  s_add_u32 s67, s67, 1
  s_cmp_gt_u32 s67, 1048576
  s_cbranch_scc1 L_end
  s_waitcnt vmcnt(0)
  v_xor_b32 v7, s96, v120
  v_bitop3_b32 v7, v7, v124, s96 bitop3:0xf6
  v_bitop3_b32 v7, v7, v128, s96 bitop3:0xf6
  v_bitop3_b32 v7, v7, v132, s96 bitop3:0xf6
  v_bitop3_b32 v7, v7, v136, s96 bitop3:0xf6
  v_bitop3_b32 v7, v7, v140, s96 bitop3:0xf6
  v_bitop3_b32 v7, v7, v144, s96 bitop3:0xf6
  v_bitop3_b32 v7, v7, v148, s96 bitop3:0xf6
  v_bitop3_b32 v7, v7, v152, s96 bitop3:0xf6
  v_bitop3_b32 v7, v7, v156, s96 bitop3:0xf6
  v_bitop3_b32 v7, v7, v160, s96 bitop3:0xf6
  v_bitop3_b32 v7, v7, v164, s96 bitop3:0xf6
  v_bitop3_b32 v7, v7, v168, s96 bitop3:0xf6
  v_bitop3_b32 v7, v7, v172, s96 bitop3:0xf6
  v_bitop3_b32 v7, v7, v176, s96 bitop3:0xf6
  v_bitop3_b32 v7, v7, v180, s96 bitop3:0xf6
  v_and_b32 v7, v254, v7
  v_cmp_ne_u32 vcc, 0, v7
  s_cbranch_vccnz o_rl_166
  s_branch o_bk_164
o_fb_155:
  v_mov_b32 v118, v116
  s_nop 1
  v_permlane16_swap_b32 v116, v118
  v_max_f32 v116, v116, v118
  v_mov_b32 v118, v116
  s_nop 0
  s_nop 0
  v_permlane32_swap_b32 v116, v118
  v_max_f32 v116, v116, v118
  v_sub_f32 v56, v104, v116
  v_sub_f32 v57, v105, v116
  v_sub_f32 v58, v106, v116
  v_sub_f32 v59, v107, v116
  v_sub_f32 v60, v108, v116
  v_sub_f32 v61, v109, v116
  v_sub_f32 v62, v110, v116
  v_sub_f32 v63, v111, v116
  v_sub_f32 v64, v112, v116
  v_sub_f32 v65, v113, v116
  v_exp_f32 v56, v56
  v_exp_f32 v57, v57
  v_exp_f32 v58, v58
  v_exp_f32 v59, v59
  v_exp_f32 v60, v60
  v_exp_f32 v61, v61
  v_exp_f32 v62, v62
  v_exp_f32 v63, v63
  v_exp_f32 v64, v64
  v_exp_f32 v65, v65
  v_add_f32 v117, v56, v57
  v_add_f32 v117, v117, v58
  v_add_f32 v117, v117, v59
  v_add_f32 v117, v117, v60
  v_add_f32 v117, v117, v61
  v_add_f32 v117, v117, v62
  v_add_f32 v117, v117, v63
  v_add_f32 v117, v117, v64
  v_add_f32 v117, v117, v65
  v_mov_b32 v118, v117
  s_nop 0
  s_nop 0
  v_permlane16_swap_b32 v117, v118
  v_add_f32 v117, v117, v118
  v_mov_b32 v118, v117
  s_nop 0
  s_nop 0
  v_permlane32_swap_b32 v117, v118
  v_add_f32 v117, v117, v118
  v_rcp_f32 v117, v117
  s_branch o_fbr_156
o_fb_157:
  v_mov_b32 v118, v116
  s_nop 1
  v_permlane16_swap_b32 v116, v118
  v_max_f32 v116, v116, v118
  v_mov_b32 v118, v116
  s_nop 0
  s_nop 0
  v_permlane32_swap_b32 v116, v118
  v_max_f32 v116, v116, v118
  v_sub_f32 v56, v104, v116
  v_sub_f32 v57, v105, v116
  v_sub_f32 v58, v106, v116
  v_sub_f32 v59, v107, v116
  v_sub_f32 v60, v108, v116
  v_sub_f32 v61, v109, v116
  v_sub_f32 v62, v110, v116
  v_sub_f32 v63, v111, v116
  v_sub_f32 v64, v112, v116
  v_sub_f32 v65, v113, v116
  v_exp_f32 v56, v56
  v_exp_f32 v57, v57
  v_exp_f32 v58, v58
  v_exp_f32 v59, v59
  v_exp_f32 v60, v60
  v_exp_f32 v61, v61
  v_exp_f32 v62, v62
  v_exp_f32 v63, v63
  v_exp_f32 v64, v64
  v_exp_f32 v65, v65
  v_add_f32 v117, v56, v57
  v_add_f32 v117, v117, v58
  v_add_f32 v117, v117, v59
  v_add_f32 v117, v117, v60
  v_add_f32 v117, v117, v61
  v_add_f32 v117, v117, v62
  v_add_f32 v117, v117, v63
  v_add_f32 v117, v117, v64
  v_add_f32 v117, v117, v65
  v_mov_b32 v118, v117
  s_nop 0
  s_nop 0
  v_permlane16_swap_b32 v117, v118
  v_add_f32 v117, v117, v118
  v_mov_b32 v118, v117
  s_nop 0
  s_nop 0
  v_permlane32_swap_b32 v117, v118
  v_add_f32 v117, v117, v118
  v_rcp_f32 v117, v117
  s_branch o_fbr_158
o_wr2_152:
  s_waitcnt lgkmcnt(0)
  s_barrier
  ds_read_b128 v[104:107], v3 offset:0
  ds_read_b128 v[108:111], v3 offset:512
  ds_read_b128 v[112:115], v3 offset:1024
  buffer_load_dwordx4 v[176:179], v5, s[4:7], s94 offen offset:256 sc1
  buffer_load_dwordx4 v[180:183], v5, s[4:7], s94 offen offset:768 sc1
  s_waitcnt lgkmcnt(2)
  v_mfma_f32_32x32x16_bf16 v[40:55], v[104:107], a[0:3], 0
  v_mov_b64 v[188:189], 0
  v_mov_b64 v[190:191], 0
  v_mov_b64 v[192:193], 0
  v_mov_b64 v[194:195], 0
  s_mov_b64 exec, 1
  buffer_store_dword v38, off, s[4:7], s84 sc1
  s_mov_b64 exec, -1
  s_mov_b32 s84, 268435456
  v_mfma_f32_32x32x16_bf16 v[56:71], v[104:107], a[4:7], 0
  ds_read_b128 v[116:119], v3 offset:1536
  v_mfma_f32_32x32x16_bf16 v[72:87], v[104:107], a[8:11], 0
  v_mfma_f32_32x32x16_bf16 v[88:103], v[104:107], a[12:15], 0
  s_waitcnt vmcnt(13)
  v_xor_b32 v7, s96, v120
  v_bitop3_b32 v7, v7, v124, s96 bitop3:0xf6
  v_bitop3_b32 v7, v7, v128, s96 bitop3:0xf6
  v_bitop3_b32 v7, v7, v132, s96 bitop3:0xf6
  s_waitcnt lgkmcnt(2)
  v_mfma_f32_32x32x16_bf16 v[40:55], v[108:111], a[16:19], v[40:55]
  s_waitcnt vmcnt(9)
  v_bitop3_b32 v7, v7, v136, s96 bitop3:0xf6
  v_bitop3_b32 v7, v7, v140, s96 bitop3:0xf6
  v_bitop3_b32 v7, v7, v144, s96 bitop3:0xf6
  v_bitop3_b32 v7, v7, v148, s96 bitop3:0xf6
  s_waitcnt vmcnt(5)
  v_mfma_f32_32x32x16_bf16 v[56:71], v[108:111], a[20:23], v[56:71]
  ds_read_b128 v[104:107], v3 offset:2048
  v_bitop3_b32 v7, v7, v152, s96 bitop3:0xf6
  v_bitop3_b32 v7, v7, v156, s96 bitop3:0xf6
  v_bitop3_b32 v7, v7, v160, s96 bitop3:0xf6
  v_bitop3_b32 v7, v7, v164, s96 bitop3:0xf6
  s_waitcnt vmcnt(1)
  v_mfma_f32_32x32x16_bf16 v[72:87], v[108:111], a[24:27], v[72:87]
  v_bitop3_b32 v7, v7, v168, s96 bitop3:0xf6
  v_bitop3_b32 v7, v7, v172, s96 bitop3:0xf6
  v_bitop3_b32 v7, v7, v176, s96 bitop3:0xf6
  v_bitop3_b32 v7, v7, v180, s96 bitop3:0xf6
  v_and_b32 v7, v254, v7
  v_cmp_ne_u32 vcc, 0, v7
  s_cbranch_vccnz o_rt_163
o_bk_164:
  v_mfma_f32_32x32x16_bf16 v[88:103], v[108:111], a[28:31], v[88:103]
  v_smfmac_f32_16x16x64_bf16 v[188:191], v[16:19], v[120:127], v20
  v_lshlrev_b32 v196, 16, v184
  v_smfmac_f32_16x16x64_bf16 v[192:195], v[16:19], v[128:135], v20
  v_and_b32 v197, 0xffff0000, v184
  v_smfmac_f32_16x16x64_bf16 v[188:191], v[16:19], v[136:143], v20
  v_lshlrev_b32 v198, 16, v185
  s_waitcnt lgkmcnt(2)
  v_mfma_f32_32x32x16_bf16 v[40:55], v[112:115], a[32:35], v[40:55]
  v_smfmac_f32_16x16x64_bf16 v[192:195], v[16:19], v[144:151], v20
  v_and_b32 v199, 0xffff0000, v185
  v_smfmac_f32_16x16x64_bf16 v[188:191], v[16:19], v[152:159], v20
  v_lshlrev_b32 v200, 16, v186
  v_smfmac_f32_16x16x64_bf16 v[192:195], v[16:19], v[160:167], v20
  v_and_b32 v201, 0xffff0000, v186
  v_mfma_f32_32x32x16_bf16 v[56:71], v[112:115], a[36:39], v[56:71]
  ds_read_b128 v[108:111], v3 offset:2560
  v_smfmac_f32_16x16x64_bf16 v[188:191], v[16:19], v[168:175], v20
  v_lshlrev_b32 v202, 16, v187
  v_smfmac_f32_16x16x64_bf16 v[192:195], v[16:19], v[176:183], v20
  v_and_b32 v203, 0xffff0000, v187
  s_bfe_u32 s92, s65, 131086
  v_mfma_f32_32x32x16_bf16 v[72:87], v[112:115], a[40:43], v[72:87]
  s_lshl_b32 s92, s92, 21
  s_add_u32 s92, s92, s91
  s_add_u32 s93, s92, 27262976
  s_add_u32 s92, s92, 20971520
  v_permlane16_swap_b32 v188, v192
  v_mfma_f32_32x32x16_bf16 v[88:103], v[112:115], a[44:47], v[88:103]
  v_permlane16_swap_b32 v189, v193
  v_permlane16_swap_b32 v190, v194
  v_permlane16_swap_b32 v191, v195
  s_waitcnt lgkmcnt(2)
  v_mfma_f32_32x32x16_bf16 v[40:55], v[116:119], a[48:51], v[40:55]
  v_cvt_pk_bf16_f32 v188, 0, v188
  v_cvt_pk_bf16_f32 v189, 0, v189
  v_cvt_pk_bf16_f32 v190, 0, v190
  v_cvt_pk_bf16_f32 v191, 0, v191
  v_cvt_pk_bf16_f32 v192, 0, v192
  v_cvt_pk_bf16_f32 v193, 0, v193
  v_mfma_f32_32x32x16_bf16 v[56:71], v[116:119], a[52:55], v[56:71]
  ds_read_b128 v[112:115], v3 offset:3072
  v_cvt_pk_bf16_f32 v194, 0, v194
  v_cvt_pk_bf16_f32 v195, 0, v195
  v_add_f32 v196, v196, v188
  v_add_f32 v197, v197, v189
  v_add_f32 v198, v198, v190
  v_mfma_f32_32x32x16_bf16 v[72:87], v[116:119], a[56:59], v[72:87]
  v_add_f32 v199, v199, v191
  v_add_f32 v200, v200, v192
  v_add_f32 v201, v201, v193
  v_add_f32 v202, v202, v194
  v_add_f32 v203, v203, v195
  v_cvt_pk_bf16_f32 v120, v196, v197
  v_mfma_f32_32x32x16_bf16 v[88:103], v[116:119], a[60:63], v[88:103]
  v_cvt_pk_bf16_f32 v121, v198, v199
  v_cvt_pk_bf16_f32 v122, v200, v201
  v_cvt_pk_bf16_f32 v123, v202, v203
  v_lshlrev_b32 v196, 16, v120
  v_and_b32 v197, 0xffff0000, v120
  s_waitcnt lgkmcnt(2)
  v_mfma_f32_32x32x16_bf16 v[40:55], v[104:107], a[64:67], v[40:55]
  v_lshlrev_b32 v198, 16, v121
  v_and_b32 v199, 0xffff0000, v121
  v_lshlrev_b32 v200, 16, v122
  v_and_b32 v201, 0xffff0000, v122
  v_lshlrev_b32 v202, 16, v123
  v_and_b32 v203, 0xffff0000, v123
  v_mfma_f32_32x32x16_bf16 v[56:71], v[104:107], a[68:71], v[56:71]
  ds_read_b128 v[116:119], v3 offset:3584
  buffer_store_dwordx4 v[120:123], v0, s[4:7], s92 offen sc1
  v_add_f32 v136, v196, v197
  v_mul_f32 v137, v196, v196
  v_mfma_f32_32x32x16_bf16 v[72:87], v[104:107], a[72:75], v[72:87]
  v_add_f32 v138, v198, v199
  v_mul_f32 v139, v197, v197
  v_fmac_f32 v137, v198, v198
  v_fmac_f32 v139, v199, v199
  v_add_f32 v136, v136, v200
  v_fmac_f32 v137, v200, v200
  v_mfma_f32_32x32x16_bf16 v[88:103], v[104:107], a[76:79], v[88:103]
  v_add_f32 v138, v138, v201
  v_fmac_f32 v139, v201, v201
  v_add_f32 v136, v136, v202
  v_fmac_f32 v137, v202, v202
  v_add_f32 v138, v138, v203
  s_waitcnt lgkmcnt(2)
  v_mfma_f32_32x32x16_bf16 v[40:55], v[108:111], a[80:83], v[40:55]
  v_fmac_f32 v139, v203, v203
  v_add_f32 v136, v136, v138
  v_add_f32 v137, v137, v139
  s_nop 0
  v_add_f32_dpp v136, v136, v136 row_ror:8 row_mask:0xf bank_mask:0xf
  v_add_f32_dpp v137, v137, v137 row_ror:8 row_mask:0xf bank_mask:0xf
  s_nop 0
  v_add_f32_dpp v136, v136, v136 row_ror:4 row_mask:0xf bank_mask:0xf
  v_mfma_f32_32x32x16_bf16 v[56:71], v[108:111], a[84:87], v[56:71]
  ds_read_b128 v[104:107], v3 offset:8192
  v_add_f32_dpp v137, v137, v137 row_ror:4 row_mask:0xf bank_mask:0xf
  v_add_f32_dpp v136, v136, v136 row_ror:2 row_mask:0xf bank_mask:0xf
  s_nop 0
  v_add_f32_dpp v137, v137, v137 row_ror:2 row_mask:0xf bank_mask:0xf
  v_add_f32_dpp v136, v136, v136 row_ror:1 row_mask:0xf bank_mask:0xf
  s_nop 0
  v_add_f32_dpp v137, v137, v137 row_ror:1 row_mask:0xf bank_mask:0xf
  v_mfma_f32_32x32x16_bf16 v[72:87], v[108:111], a[88:91], v[72:87]
  v_mov_b32 v140, v136
  v_mov_b32 v141, v137
  s_nop 0
  v_permlane16_swap_b32 v136, v140
  v_permlane16_swap_b32 v137, v141
  v_mfma_f32_32x32x16_bf16 v[88:103], v[108:111], a[92:95], v[88:103]
  v_add_f32 v136, v136, v140
  v_add_f32 v137, v137, v141
  v_mov_b32 v140, v136
  v_mov_b32 v141, v137
  s_nop 0
  v_permlane32_swap_b32 v136, v140
  s_waitcnt lgkmcnt(2)
  v_mfma_f32_32x32x16_bf16 v[40:55], v[112:115], a[96:99], v[40:55]
  v_permlane32_swap_b32 v137, v141
  v_add_f32 v136, v136, v140
  v_add_f32 v137, v137, v141
  v_mul_f32 v136, 0x3b000000, v136
  v_mul_f32 v137, 0x3b000000, v137
  v_mfma_f32_32x32x16_bf16 v[56:71], v[112:115], a[100:103], v[56:71]
  ds_read_b128 v[108:111], v3 offset:8704
  v_fma_f32 v137, -v136, v136, v137
  v_cvt_pk_bf16_f32 v136, 0, v136
  v_max_f32 v137, 0, v137
  v_sub_f32 v140, v196, v136
  v_sub_f32 v141, v197, v136
  v_mfma_f32_32x32x16_bf16 v[72:87], v[112:115], a[104:107], v[72:87]
  v_cvt_pk_bf16_f32 v137, 0, v137
  v_sub_f32 v142, v198, v136
  v_sub_f32 v143, v199, v136
  v_add_f32 v137, 0x3727c5ac, v137
  v_sub_f32 v144, v200, v136
  v_sub_f32 v145, v201, v136
  v_mfma_f32_32x32x16_bf16 v[88:103], v[112:115], a[108:111], v[88:103]
  v_cvt_pk_bf16_f32 v137, 0, v137
  v_sub_f32 v146, v202, v136
  v_sub_f32 v147, v203, v136
  v_sqrt_f32 v137, v137
  s_waitcnt lgkmcnt(2)
  v_mfma_f32_32x32x16_bf16 v[40:55], v[116:119], a[112:115], v[40:55]
  v_cvt_pk_bf16_f32 v140, 0, v140
  v_cvt_pk_bf16_f32 v141, 0, v141
  v_cvt_pk_bf16_f32 v137, 0, v137
  v_cvt_pk_bf16_f32 v142, 0, v142
  v_cvt_pk_bf16_f32 v143, 0, v143
  v_rcp_f32 v137, v137
  v_mfma_f32_32x32x16_bf16 v[56:71], v[116:119], a[116:119], v[56:71]
  ds_read_b128 v[112:115], v3 offset:9216
  v_cvt_pk_bf16_f32 v144, 0, v144
  v_cvt_pk_bf16_f32 v145, 0, v145
  v_cvt_pk_bf16_f32 v146, 0, v146
  v_cvt_pk_bf16_f32 v147, 0, v147
  v_mul_f32 v140, v140, v137
  v_mfma_f32_32x32x16_bf16 v[72:87], v[116:119], a[120:123], v[72:87]
  v_mul_f32 v141, v141, v137
  v_mul_f32 v142, v142, v137
  v_mul_f32 v143, v143, v137
  v_mul_f32 v144, v144, v137
  v_mul_f32 v145, v145, v137
  v_mul_f32 v146, v146, v137
  v_mfma_f32_32x32x16_bf16 v[88:103], v[116:119], a[124:127], v[88:103]
  v_mul_f32 v147, v147, v137
  v_cvt_pk_bf16_f32 v124, v140, v141
  v_cvt_pk_bf16_f32 v125, v142, v143
  v_cvt_pk_bf16_f32 v126, v144, v145
  v_cvt_pk_bf16_f32 v127, v146, v147
  s_waitcnt lgkmcnt(2)
  v_mfma_f32_32x32x16_bf16 v[40:55], v[104:107], a[128:131], v[40:55]
  v_lshlrev_b32 v204, 16, v124
  v_and_b32 v205, 0xffff0000, v124
  v_lshlrev_b32 v206, 16, v125
  v_and_b32 v207, 0xffff0000, v125
  v_lshlrev_b32 v208, 16, v126
  v_and_b32 v209, 0xffff0000, v126
  v_mfma_f32_32x32x16_bf16 v[56:71], v[104:107], a[132:135], v[56:71]
  ds_read_b128 v[116:119], v3 offset:9728
  v_lshlrev_b32 v210, 16, v127
  v_and_b32 v211, 0xffff0000, v127
  buffer_store_dwordx4 v[124:127], v0, s[4:7], s93 offen sc1
  v_mfma_f32_32x32x16_bf16 v[72:87], v[104:107], a[136:139], v[72:87]
  v_add_f32 v196, v196, v204
  v_add_f32 v197, v197, v205
  v_add_f32 v198, v198, v206
  v_add_f32 v199, v199, v207
  v_add_f32 v200, v200, v208
  v_add_f32 v201, v201, v209
  v_mfma_f32_32x32x16_bf16 v[88:103], v[104:107], a[140:143], v[88:103]
  v_add_f32 v202, v202, v210
  v_add_f32 v203, v203, v211
  v_cvt_pk_bf16_f32 v128, v196, v197
  v_cvt_pk_bf16_f32 v129, v198, v199
  v_cvt_pk_bf16_f32 v130, v200, v201
  s_waitcnt lgkmcnt(2)
  v_mfma_f32_32x32x16_bf16 v[40:55], v[108:111], a[144:147], v[40:55]
  v_cvt_pk_bf16_f32 v131, v202, v203
  v_mul_f32 v188, v204, v8
  v_mul_f32 v189, v205, v9
  v_fmac_f32 v188, v206, v10
  v_fmac_f32 v189, v207, v11
  v_fmac_f32 v188, v208, v12
  v_mfma_f32_32x32x16_bf16 v[56:71], v[108:111], a[148:151], v[56:71]
  ds_read_b128 v[104:107], v3 offset:10240
  v_fmac_f32 v189, v209, v13
  v_fmac_f32 v188, v210, v14
  v_fmac_f32 v189, v211, v15
  v_add_f32 v188, v188, v189
  buffer_store_dwordx4 v[128:131], v0, s[68:71], s91 offen sc1
  v_mfma_f32_32x32x16_bf16 v[72:87], v[108:111], a[152:155], v[72:87]
  v_add_f32_dpp v188, v188, v188 row_ror:8 row_mask:0xf bank_mask:0xf
  s_nop 1
  v_add_f32_dpp v188, v188, v188 row_ror:4 row_mask:0xf bank_mask:0xf
  s_nop 1
  v_add_f32_dpp v188, v188, v188 row_ror:2 row_mask:0xf bank_mask:0xf
  s_nop 1
  v_add_f32_dpp v188, v188, v188 row_ror:1 row_mask:0xf bank_mask:0xf
  v_mov_b32 v189, v188
  s_nop 0
  s_nop 0
  v_permlane16_swap_b32 v188, v189
  v_mfma_f32_32x32x16_bf16 v[88:103], v[108:111], a[156:159], v[88:103]
  v_add_f32 v188, v188, v189
  v_mov_b32 v189, v188
  s_nop 0
  s_nop 0
  v_permlane32_swap_b32 v188, v189
  v_add_f32 v188, v188, v189
  s_waitcnt lgkmcnt(2)
  v_mfma_f32_32x32x16_bf16 v[40:55], v[112:115], a[160:163], v[40:55]
  v_cvt_pk_bf16_f32 v188, 0, v188
  v_ashrrev_i32 v189, 31, v188
  v_or_b32 v189, 0x80000000, v189
  v_xor_b32 v188, v188, v189
  s_sub_u32 s92, 4095, s90
  v_and_b32 v188, 0xffff0000, v188
  v_mfma_f32_32x32x16_bf16 v[56:71], v[112:115], a[164:167], v[56:71]
  ds_read_b128 v[108:111], v3 offset:10752
  v_or_b32 v38, s92, v188
  s_bfe_u32 s92, s65, 196625
  s_lshl_b32 s92, s92, 18
  s_lshl_b32 s93, s90, 7
  s_add_u32 s92, s92, s93
  v_mfma_f32_32x32x16_bf16 v[72:87], v[112:115], a[168:171], v[72:87]
  s_add_u32 s84, s92, 243269632
  v_mfma_f32_32x32x16_bf16 v[88:103], v[112:115], a[172:175], v[88:103]
  s_waitcnt lgkmcnt(2)
  v_mfma_f32_32x32x16_bf16 v[40:55], v[116:119], a[176:179], v[40:55]
  v_mfma_f32_32x32x16_bf16 v[56:71], v[116:119], a[180:183], v[56:71]
  ds_read_b128 v[112:115], v3 offset:11264
  v_mfma_f32_32x32x16_bf16 v[72:87], v[116:119], a[184:187], v[72:87]
  v_mfma_f32_32x32x16_bf16 v[88:103], v[116:119], a[188:191], v[88:103]
  s_waitcnt lgkmcnt(2)
  v_mfma_f32_32x32x16_bf16 v[40:55], v[104:107], a[192:195], v[40:55]
  v_mfma_f32_32x32x16_bf16 v[56:71], v[104:107], a[196:199], v[56:71]
  ds_read_b128 v[116:119], v3 offset:11776
  s_waitcnt lgkmcnt(2)
  v_mfma_f32_32x32x16_bf16 v[40:55], v[108:111], a[208:211], v[40:55]
  v_mfma_f32_32x32x16_bf16 v[56:71], v[108:111], a[212:215], v[56:71]
  s_waitcnt lgkmcnt(1)
  v_mfma_f32_32x32x16_bf16 v[40:55], v[112:115], a[224:227], v[40:55]
  v_mfma_f32_32x32x16_bf16 v[56:71], v[112:115], a[228:231], v[56:71]
  s_waitcnt lgkmcnt(0)
  v_mfma_f32_32x32x16_bf16 v[40:55], v[116:119], a[240:243], v[40:55]
  v_mfma_f32_32x32x16_bf16 v[56:71], v[116:119], a[244:247], v[56:71]
  v_mfma_f32_32x32x16_bf16 v[72:87], v[104:107], a[200:203], v[72:87]
  v_mfma_f32_32x32x16_bf16 v[88:103], v[104:107], a[204:207], v[88:103]
  v_cvt_pk_bf16_f32 v212, v40, v56
  v_cvt_pk_bf16_f32 v214, v41, v57
  v_cvt_pk_bf16_f32 v216, v42, v58
  v_cvt_pk_bf16_f32 v218, v43, v59
  v_permlane16_swap_b32 v212, v214
  v_mfma_f32_32x32x16_bf16 v[72:87], v[108:111], a[216:219], v[72:87]
  v_cvt_pk_bf16_f32 v220, v44, v60
  v_cvt_pk_bf16_f32 v222, v45, v61
  v_permlane16_swap_b32 v216, v218
  v_bfi_b32 v212, v254, s42, v212
  v_cvt_pk_bf16_f32 v224, v46, v62
  v_mfma_f32_32x32x16_bf16 v[88:103], v[108:111], a[220:223], v[88:103]
  v_cvt_pk_bf16_f32 v226, v47, v63
  v_permlane16_swap_b32 v220, v222
  v_bfi_b32 v216, v254, s42, v216
  v_cvt_pk_bf16_f32 v228, v48, v64
  v_mfma_f32_32x32x16_bf16 v[72:87], v[112:115], a[232:235], v[72:87]
  v_cvt_pk_bf16_f32 v230, v49, v65
  v_permlane16_swap_b32 v224, v226
  v_bfi_b32 v220, v254, s42, v220
  v_cvt_pk_bf16_f32 v232, v50, v66
  v_cvt_pk_bf16_f32 v234, v51, v67
  v_mfma_f32_32x32x16_bf16 v[88:103], v[112:115], a[236:239], v[88:103]
  v_permlane16_swap_b32 v228, v230
  v_bfi_b32 v224, v254, s42, v224
  v_cvt_pk_bf16_f32 v236, v52, v68
  v_cvt_pk_bf16_f32 v238, v53, v69
  v_mfma_f32_32x32x16_bf16 v[72:87], v[116:119], a[248:251], v[72:87]
  v_permlane16_swap_b32 v232, v234
  v_bfi_b32 v228, v254, s42, v228
  v_cvt_pk_bf16_f32 v240, v54, v70
  v_cvt_pk_bf16_f32 v242, v55, v71
  v_permlane16_swap_b32 v236, v238
  v_mfma_f32_32x32x16_bf16 v[88:103], v[116:119], a[252:255], v[88:103]
  v_bfi_b32 v232, v254, s42, v232
  v_permlane16_swap_b32 v240, v242
  v_bfi_b32 v236, v254, s42, v236
  v_bfi_b32 v240, v254, s42, v240
  s_nop 7
  v_cvt_pk_bf16_f32 v213, v72, v88
  v_cvt_pk_bf16_f32 v215, v73, v89
  v_cvt_pk_bf16_f32 v217, v74, v90
  v_cvt_pk_bf16_f32 v219, v75, v91
  s_add_u32 s78, s86, 0
  v_permlane16_swap_b32 v213, v215
  buffer_store_dwordx4 v[212:215], v4, s[4:7], s78 offen
  v_cvt_pk_bf16_f32 v221, v76, v92
  v_cvt_pk_bf16_f32 v223, v77, v93
  s_add_u32 s78, s86, 32768
  v_permlane16_swap_b32 v217, v219
  buffer_store_dwordx4 v[216:219], v4, s[4:7], s78 offen
  v_cvt_pk_bf16_f32 v225, v78, v94
  v_cvt_pk_bf16_f32 v227, v79, v95
  s_add_u32 s78, s86, 131072
  v_permlane16_swap_b32 v221, v223
  buffer_store_dwordx4 v[220:223], v4, s[4:7], s78 offen
  v_cvt_pk_bf16_f32 v229, v80, v96
  v_cvt_pk_bf16_f32 v231, v81, v97
  s_add_u32 s78, s86, 163840
  v_permlane16_swap_b32 v225, v227
  buffer_store_dwordx4 v[224:227], v4, s[4:7], s78 offen
  v_cvt_pk_bf16_f32 v233, v82, v98
  v_cvt_pk_bf16_f32 v235, v83, v99
  s_add_u32 s78, s86, 262144
  v_permlane16_swap_b32 v229, v231
  buffer_store_dwordx4 v[228:231], v4, s[4:7], s78 offen
  v_cvt_pk_bf16_f32 v237, v84, v100
  v_cvt_pk_bf16_f32 v239, v85, v101
  s_add_u32 s78, s86, 294912
  v_permlane16_swap_b32 v233, v235
  buffer_store_dwordx4 v[232:235], v4, s[4:7], s78 offen
  v_cvt_pk_bf16_f32 v241, v86, v102
  v_cvt_pk_bf16_f32 v243, v87, v103
  s_add_u32 s78, s86, 393216
  v_permlane16_swap_b32 v237, v239
  buffer_store_dwordx4 v[236:239], v4, s[4:7], s78 offen
  s_add_u32 s78, s86, 425984
  v_permlane16_swap_b32 v241, v243
  buffer_store_dwordx4 v[240:243], v4, s[4:7], s78 offen
o_we_153:
  v_and_b32 v37, -32, v39
  s_waitcnt lgkmcnt(0)
  s_barrier
  ds_read_b128 v[104:107], v37 offset:16
  s_mov_b32 s65, s63
  s_waitcnt lgkmcnt(0)
  v_and_b32 v104, v104, v106
  v_max_u32 v105, v105, v107
  v_readfirstlane_b32 s26, v104
  v_readfirstlane_b32 s3, v105
  s_and_b32 s66, s26, 1
  s_and_b32 s76, s26, 2
  s_bitcmp1_b32 s26, 2
  s_cselect_b32 s3, s3, 0
  s_cmp_lg_u32 s76, 0
  s_cbranch_scc1 o_nofl_127
  s_and_b32 s26, s63, 49152
  s_cbranch_scc0 o_fl_128
  s_and_b32 s26, s64, s50
  s_cbranch_scc1 o_nofl_127
o_fl_128:
  s_cmp_ge_u32 s17, 2
  s_cbranch_scc1 o_fd_167
  s_cmp_eq_u32 s65, 0
  s_cbranch_scc1 o_fd_167
  s_mov_b32 s96, s42
  s_lshl_b32 s97, s43, 14
  s_add_u32 s97, s97, s86
  buffer_load_dword v7, v255, s[4:7], s97 offen sc1
  s_and_b32 s91, s65, 63
  s_lshl_b32 s90, s91, 5
  s_add_u32 s94, s90, s85
  s_add_u32 s90, s90, s43
  s_lshl_b32 s94, s94, 10
  s_lshr_b32 s92, s65, 22
  s_xor_b32 s93, s43, 32
  s_lshl_b32 s91, s90, 10
  s_add_u32 s94, s94, 25165824
  s_cmp_eq_u32 s92, s93
  s_cselect_b32 s92, s94, s91
  s_add_u32 s92, s92, 10485760
  s_and_b32 s93, s65, 49152
  s_cselect_b32 s92, s92, s91
  s_cselect_b64 s[80:81], s[4:5], s[72:73]
  s_cselect_b32 s82, s6, s74
  buffer_load_dwordx4 v[184:187], v0, s[80:83], s92 offen sc1
  s_mov_b32 s67, 0
  s_mov_b64 vcc, 0
  s_waitcnt vmcnt(1)
o_pl_169:
  v_and_b32 v7, 1, v7
  v_cmp_ne_u32 vcc, s96, v7
  s_cbranch_vccz o_pk_170
  s_mov_b64 exec, 1
  buffer_store_dword v38, off, s[4:7], s84 sc1
  s_mov_b64 exec, -1
  s_mov_b32 s84, 268435456
  buffer_load_dword v7, v255, s[4:7], s97 offen sc1
  s_add_u32 s67, s67, 1
  s_cmp_gt_u32 s67, 1048576
  s_cbranch_scc1 L_end
  s_waitcnt vmcnt(0)
  s_branch o_pl_169
o_pk_170:
  s_and_b32 s26, s65, 49152
  s_cbranch_scc1 o_f2_168
  s_lshl_b32 s94, s43, 14
  s_add_u32 s94, s94, s86
  buffer_load_dwordx4 v[120:123], v5, s[4:7], s94 offen offset:0 sc1
  buffer_load_dwordx4 v[124:127], v5, s[4:7], s94 offen offset:512 sc1
  buffer_load_dwordx4 v[128:131], v5, s[4:7], s94 offen offset:256 sc1
  buffer_load_dwordx4 v[132:135], v5, s[4:7], s94 offen offset:768 sc1
  s_add_u32 s94, s94, 4096
  buffer_load_dwordx4 v[136:139], v5, s[4:7], s94 offen offset:0 sc1
  buffer_load_dwordx4 v[140:143], v5, s[4:7], s94 offen offset:512 sc1
  buffer_load_dwordx4 v[144:147], v5, s[4:7], s94 offen offset:256 sc1
  buffer_load_dwordx4 v[148:151], v5, s[4:7], s94 offen offset:768 sc1
  s_add_u32 s94, s94, 4096
  buffer_load_dwordx4 v[152:155], v5, s[4:7], s94 offen offset:0 sc1
  buffer_load_dwordx4 v[156:159], v5, s[4:7], s94 offen offset:512 sc1
  buffer_load_dwordx4 v[160:163], v5, s[4:7], s94 offen offset:256 sc1
  buffer_load_dwordx4 v[164:167], v5, s[4:7], s94 offen offset:768 sc1
  s_add_u32 s94, s94, 4096
  buffer_load_dwordx4 v[168:171], v5, s[4:7], s94 offen offset:0 sc1
  buffer_load_dwordx4 v[172:175], v5, s[4:7], s94 offen offset:512 sc1
  buffer_load_dwordx4 v[176:179], v5, s[4:7], s94 offen offset:256 sc1
  buffer_load_dwordx4 v[180:183], v5, s[4:7], s94 offen offset:768 sc1
  s_mov_b64 exec, 1
  buffer_store_dword v38, off, s[4:7], s84 sc1
  s_mov_b64 exec, -1
  s_mov_b32 s84, 268435456
  v_mov_b64 v[188:189], 0
  v_mov_b64 v[190:191], 0
  v_mov_b64 v[192:193], 0
  v_mov_b64 v[194:195], 0
  s_waitcnt vmcnt(13)
  v_xor_b32 v7, s96, v120
  v_bitop3_b32 v7, v7, v124, s96 bitop3:0xf6
  v_bitop3_b32 v7, v7, v128, s96 bitop3:0xf6
  v_bitop3_b32 v7, v7, v132, s96 bitop3:0xf6
  s_waitcnt vmcnt(9)
  v_bitop3_b32 v7, v7, v136, s96 bitop3:0xf6
  v_bitop3_b32 v7, v7, v140, s96 bitop3:0xf6
  v_bitop3_b32 v7, v7, v144, s96 bitop3:0xf6
  v_bitop3_b32 v7, v7, v148, s96 bitop3:0xf6
  s_waitcnt vmcnt(5)
  v_bitop3_b32 v7, v7, v152, s96 bitop3:0xf6
  v_bitop3_b32 v7, v7, v156, s96 bitop3:0xf6
  v_bitop3_b32 v7, v7, v160, s96 bitop3:0xf6
  v_bitop3_b32 v7, v7, v164, s96 bitop3:0xf6
  s_waitcnt vmcnt(1)
  v_bitop3_b32 v7, v7, v168, s96 bitop3:0xf6
  v_bitop3_b32 v7, v7, v172, s96 bitop3:0xf6
  v_bitop3_b32 v7, v7, v176, s96 bitop3:0xf6
  v_bitop3_b32 v7, v7, v180, s96 bitop3:0xf6
  v_and_b32 v7, v254, v7
  v_cmp_ne_u32 vcc, 0, v7
  s_cbranch_vccnz o_rt_171
o_bk_172:
  v_smfmac_f32_16x16x64_bf16 v[188:191], v[16:19], v[120:127], v20
  v_lshlrev_b32 v196, 16, v184
  v_smfmac_f32_16x16x64_bf16 v[192:195], v[16:19], v[128:135], v20
  v_and_b32 v197, 0xffff0000, v184
  v_smfmac_f32_16x16x64_bf16 v[188:191], v[16:19], v[136:143], v20
  v_lshlrev_b32 v198, 16, v185
  v_smfmac_f32_16x16x64_bf16 v[192:195], v[16:19], v[144:151], v20
  v_and_b32 v199, 0xffff0000, v185
  v_smfmac_f32_16x16x64_bf16 v[188:191], v[16:19], v[152:159], v20
  v_lshlrev_b32 v200, 16, v186
  v_smfmac_f32_16x16x64_bf16 v[192:195], v[16:19], v[160:167], v20
  v_and_b32 v201, 0xffff0000, v186
  v_smfmac_f32_16x16x64_bf16 v[188:191], v[16:19], v[168:175], v20
  v_lshlrev_b32 v202, 16, v187
  v_smfmac_f32_16x16x64_bf16 v[192:195], v[16:19], v[176:183], v20
  v_and_b32 v203, 0xffff0000, v187
  s_bfe_u32 s92, s65, 131086
  s_lshl_b32 s92, s92, 21
  s_add_u32 s92, s92, s91
  s_add_u32 s93, s92, 27262976
  s_add_u32 s92, s92, 20971520
  s_nop 1
  v_permlane16_swap_b32 v188, v192
  v_permlane16_swap_b32 v189, v193
  v_permlane16_swap_b32 v190, v194
  v_permlane16_swap_b32 v191, v195
  v_cvt_pk_bf16_f32 v188, 0, v188
  v_cvt_pk_bf16_f32 v189, 0, v189
  v_cvt_pk_bf16_f32 v190, 0, v190
  v_cvt_pk_bf16_f32 v191, 0, v191
  v_cvt_pk_bf16_f32 v192, 0, v192
  v_cvt_pk_bf16_f32 v193, 0, v193
  v_cvt_pk_bf16_f32 v194, 0, v194
  v_cvt_pk_bf16_f32 v195, 0, v195
  v_add_f32 v196, v196, v188
  v_add_f32 v197, v197, v189
  v_add_f32 v198, v198, v190
  v_add_f32 v199, v199, v191
  v_add_f32 v200, v200, v192
  v_add_f32 v201, v201, v193
  v_add_f32 v202, v202, v194
  v_add_f32 v203, v203, v195
  v_cvt_pk_bf16_f32 v120, v196, v197
  v_cvt_pk_bf16_f32 v121, v198, v199
  v_cvt_pk_bf16_f32 v122, v200, v201
  v_cvt_pk_bf16_f32 v123, v202, v203
  v_lshlrev_b32 v196, 16, v120
  v_and_b32 v197, 0xffff0000, v120
  v_lshlrev_b32 v198, 16, v121
  v_and_b32 v199, 0xffff0000, v121
  v_lshlrev_b32 v200, 16, v122
  v_and_b32 v201, 0xffff0000, v122
  v_lshlrev_b32 v202, 16, v123
  v_and_b32 v203, 0xffff0000, v123
  buffer_store_dwordx4 v[120:123], v0, s[4:7], s92 offen sc1
  v_add_f32 v136, v196, v197
  v_mul_f32 v137, v196, v196
  v_add_f32 v138, v198, v199
  v_mul_f32 v139, v197, v197
  v_fmac_f32 v137, v198, v198
  v_fmac_f32 v139, v199, v199
  v_add_f32 v136, v136, v200
  v_fmac_f32 v137, v200, v200
  v_add_f32 v138, v138, v201
  v_fmac_f32 v139, v201, v201
  v_add_f32 v136, v136, v202
  v_fmac_f32 v137, v202, v202
  v_add_f32 v138, v138, v203
  v_fmac_f32 v139, v203, v203
  v_add_f32 v136, v136, v138
  v_add_f32 v137, v137, v139
  s_nop 0
  v_add_f32_dpp v136, v136, v136 row_ror:8 row_mask:0xf bank_mask:0xf
  v_add_f32_dpp v137, v137, v137 row_ror:8 row_mask:0xf bank_mask:0xf
  s_nop 0
  v_add_f32_dpp v136, v136, v136 row_ror:4 row_mask:0xf bank_mask:0xf
  v_add_f32_dpp v137, v137, v137 row_ror:4 row_mask:0xf bank_mask:0xf
  s_nop 0
  v_add_f32_dpp v136, v136, v136 row_ror:2 row_mask:0xf bank_mask:0xf
  v_add_f32_dpp v137, v137, v137 row_ror:2 row_mask:0xf bank_mask:0xf
  s_nop 0
  v_add_f32_dpp v136, v136, v136 row_ror:1 row_mask:0xf bank_mask:0xf
  v_add_f32_dpp v137, v137, v137 row_ror:1 row_mask:0xf bank_mask:0xf
  v_mov_b32 v140, v136
  v_mov_b32 v141, v137
  s_nop 0
  v_permlane16_swap_b32 v136, v140
  v_permlane16_swap_b32 v137, v141
  v_add_f32 v136, v136, v140
  v_add_f32 v137, v137, v141
  v_mov_b32 v140, v136
  v_mov_b32 v141, v137
  s_nop 0
  v_permlane32_swap_b32 v136, v140
  v_permlane32_swap_b32 v137, v141
  v_add_f32 v136, v136, v140
  v_add_f32 v137, v137, v141
  v_mul_f32 v136, 0x3b000000, v136
  v_mul_f32 v137, 0x3b000000, v137
  v_fma_f32 v137, -v136, v136, v137
  v_cvt_pk_bf16_f32 v136, 0, v136
  v_max_f32 v137, 0, v137
  v_sub_f32 v140, v196, v136
  v_sub_f32 v141, v197, v136
  v_cvt_pk_bf16_f32 v137, 0, v137
  v_sub_f32 v142, v198, v136
  v_sub_f32 v143, v199, v136
  v_add_f32 v137, 0x3727c5ac, v137
  v_sub_f32 v144, v200, v136
  v_sub_f32 v145, v201, v136
  v_cvt_pk_bf16_f32 v137, 0, v137
  v_sub_f32 v146, v202, v136
  v_sub_f32 v147, v203, v136
  v_sqrt_f32 v137, v137
  v_cvt_pk_bf16_f32 v140, 0, v140
  v_cvt_pk_bf16_f32 v141, 0, v141
  v_cvt_pk_bf16_f32 v137, 0, v137
  v_cvt_pk_bf16_f32 v142, 0, v142
  v_cvt_pk_bf16_f32 v143, 0, v143
  v_rcp_f32 v137, v137
  v_cvt_pk_bf16_f32 v144, 0, v144
  v_cvt_pk_bf16_f32 v145, 0, v145
  v_cvt_pk_bf16_f32 v146, 0, v146
  v_cvt_pk_bf16_f32 v147, 0, v147
  v_mul_f32 v140, v140, v137
  v_mul_f32 v141, v141, v137
  v_mul_f32 v142, v142, v137
  v_mul_f32 v143, v143, v137
  v_mul_f32 v144, v144, v137
  v_mul_f32 v145, v145, v137
  v_mul_f32 v146, v146, v137
  v_mul_f32 v147, v147, v137
  v_cvt_pk_bf16_f32 v124, v140, v141
  v_cvt_pk_bf16_f32 v125, v142, v143
  v_cvt_pk_bf16_f32 v126, v144, v145
  v_cvt_pk_bf16_f32 v127, v146, v147
  v_lshlrev_b32 v204, 16, v124
  v_and_b32 v205, 0xffff0000, v124
  v_lshlrev_b32 v206, 16, v125
  v_and_b32 v207, 0xffff0000, v125
  v_lshlrev_b32 v208, 16, v126
  v_and_b32 v209, 0xffff0000, v126
  v_lshlrev_b32 v210, 16, v127
  v_and_b32 v211, 0xffff0000, v127
  buffer_store_dwordx4 v[124:127], v0, s[4:7], s93 offen sc1
  v_add_f32 v196, v196, v204
  v_add_f32 v197, v197, v205
  v_add_f32 v198, v198, v206
  v_add_f32 v199, v199, v207
  v_add_f32 v200, v200, v208
  v_add_f32 v201, v201, v209
  v_add_f32 v202, v202, v210
  v_add_f32 v203, v203, v211
  v_cvt_pk_bf16_f32 v128, v196, v197
  v_cvt_pk_bf16_f32 v129, v198, v199
  v_cvt_pk_bf16_f32 v130, v200, v201
  v_cvt_pk_bf16_f32 v131, v202, v203
  v_mul_f32 v188, v204, v8
  v_mul_f32 v189, v205, v9
  v_fmac_f32 v188, v206, v10
  v_fmac_f32 v189, v207, v11
  v_fmac_f32 v188, v208, v12
  v_fmac_f32 v189, v209, v13
  v_fmac_f32 v188, v210, v14
  v_fmac_f32 v189, v211, v15
  v_add_f32 v188, v188, v189
  s_add_u32 s92, s91, 10485760
  s_add_u32 s93, s91, 8388608
  buffer_store_dwordx4 v[128:131], v0, s[4:7], s92 offen sc1
  v_lshlrev_b32 v196, 16, v128
  v_and_b32 v197, 0xffff0000, v128
  v_lshlrev_b32 v198, 16, v129
  v_and_b32 v199, 0xffff0000, v129
  v_lshlrev_b32 v200, 16, v130
  v_and_b32 v201, 0xffff0000, v130
  v_lshlrev_b32 v202, 16, v131
  v_and_b32 v203, 0xffff0000, v131
  v_add_f32 v136, v196, v197
  v_mul_f32 v137, v196, v196
  v_add_f32 v138, v198, v199
  v_mul_f32 v139, v197, v197
  v_fmac_f32 v137, v198, v198
  v_fmac_f32 v139, v199, v199
  v_add_f32 v136, v136, v200
  v_fmac_f32 v137, v200, v200
  v_add_f32 v138, v138, v201
  v_fmac_f32 v139, v201, v201
  v_add_f32 v136, v136, v202
  v_fmac_f32 v137, v202, v202
  v_add_f32 v138, v138, v203
  v_fmac_f32 v139, v203, v203
  v_add_f32 v136, v136, v138
  v_add_f32 v137, v137, v139
  s_nop 0
  v_add_f32_dpp v136, v136, v136 row_ror:8 row_mask:0xf bank_mask:0xf
  v_add_f32_dpp v137, v137, v137 row_ror:8 row_mask:0xf bank_mask:0xf
  v_add_f32_dpp v188, v188, v188 row_ror:8 row_mask:0xf bank_mask:0xf
  v_add_f32_dpp v136, v136, v136 row_ror:4 row_mask:0xf bank_mask:0xf
  v_add_f32_dpp v137, v137, v137 row_ror:4 row_mask:0xf bank_mask:0xf
  v_add_f32_dpp v188, v188, v188 row_ror:4 row_mask:0xf bank_mask:0xf
  v_add_f32_dpp v136, v136, v136 row_ror:2 row_mask:0xf bank_mask:0xf
  v_add_f32_dpp v137, v137, v137 row_ror:2 row_mask:0xf bank_mask:0xf
  v_add_f32_dpp v188, v188, v188 row_ror:2 row_mask:0xf bank_mask:0xf
  v_add_f32_dpp v136, v136, v136 row_ror:1 row_mask:0xf bank_mask:0xf
  v_add_f32_dpp v137, v137, v137 row_ror:1 row_mask:0xf bank_mask:0xf
  v_add_f32_dpp v188, v188, v188 row_ror:1 row_mask:0xf bank_mask:0xf
  v_mov_b32 v140, v136
  v_mov_b32 v141, v137
  v_mov_b32 v142, v188
  v_permlane16_swap_b32 v136, v140
  v_permlane16_swap_b32 v137, v141
  v_permlane16_swap_b32 v188, v142
  v_add_f32 v136, v136, v140
  v_add_f32 v137, v137, v141
  v_add_f32 v188, v188, v142
  v_mov_b32 v140, v136
  v_mov_b32 v141, v137
  v_mov_b32 v142, v188
  v_permlane32_swap_b32 v136, v140
  v_permlane32_swap_b32 v137, v141
  v_permlane32_swap_b32 v188, v142
  v_add_f32 v136, v136, v140
  v_add_f32 v137, v137, v141
  v_add_f32 v188, v188, v142
  v_mul_f32 v136, 0x3b000000, v136
  v_mul_f32 v137, 0x3b000000, v137
  v_fma_f32 v137, -v136, v136, v137
  v_cvt_pk_bf16_f32 v136, 0, v136
  v_max_f32 v137, 0, v137
  v_sub_f32 v140, v196, v136
  v_sub_f32 v141, v197, v136
  v_cvt_pk_bf16_f32 v137, 0, v137
  v_sub_f32 v142, v198, v136
  v_sub_f32 v143, v199, v136
  v_add_f32 v137, 0x3727c5ac, v137
  v_sub_f32 v144, v200, v136
  v_sub_f32 v145, v201, v136
  v_cvt_pk_bf16_f32 v137, 0, v137
  v_sub_f32 v146, v202, v136
  v_sub_f32 v147, v203, v136
  v_sqrt_f32 v137, v137
  v_cvt_pk_bf16_f32 v140, 0, v140
  v_cvt_pk_bf16_f32 v141, 0, v141
  v_cvt_pk_bf16_f32 v137, 0, v137
  v_cvt_pk_bf16_f32 v142, 0, v142
  v_cvt_pk_bf16_f32 v143, 0, v143
  v_rcp_f32 v137, v137
  v_cvt_pk_bf16_f32 v144, 0, v144
  v_cvt_pk_bf16_f32 v145, 0, v145
  v_cvt_pk_bf16_f32 v146, 0, v146
  v_cvt_pk_bf16_f32 v147, 0, v147
  v_mul_f32 v140, v140, v137
  v_mul_f32 v141, v141, v137
  v_mul_f32 v142, v142, v137
  v_mul_f32 v143, v143, v137
  v_mul_f32 v144, v144, v137
  v_mul_f32 v145, v145, v137
  v_mul_f32 v146, v146, v137
  v_mul_f32 v147, v147, v137
  v_cvt_pk_bf16_f32 v132, v140, v141
  v_cvt_pk_bf16_f32 v133, v142, v143
  v_cvt_pk_bf16_f32 v134, v144, v145
  v_cvt_pk_bf16_f32 v135, v146, v147
  buffer_store_dwordx4 v[132:135], v0, s[4:7], s93 offen sc1
  v_cvt_pk_bf16_f32 v188, 0, v188
  v_ashrrev_i32 v189, 31, v188
  v_or_b32 v189, 0x80000000, v189
  v_xor_b32 v188, v188, v189
  s_sub_u32 s92, 4095, s90
  v_and_b32 v188, 0xffff0000, v188
  v_or_b32 v38, s92, v188
  s_bfe_u32 s92, s65, 196625
  s_lshl_b32 s92, s92, 18
  s_lshl_b32 s93, s90, 7
  s_add_u32 s92, s92, s93
  s_add_u32 s84, s92, 243269632
  s_waitcnt vmcnt(0)
  s_mov_b64 exec, 1
  buffer_store_dword v38, off, s[4:7], s84 sc1
  s_mov_b64 exec, -1
  s_mov_b32 s84, 268435456
  s_branch o_fd_167
o_rt_171:
  s_mov_b32 s67, 0
o_rl_173:
  s_lshl_b32 s94, s43, 14
  s_add_u32 s94, s94, s86
  buffer_load_dwordx4 v[120:123], v5, s[4:7], s94 offen offset:0 sc1
  buffer_load_dwordx4 v[124:127], v5, s[4:7], s94 offen offset:512 sc1
  buffer_load_dwordx4 v[128:131], v5, s[4:7], s94 offen offset:256 sc1
  buffer_load_dwordx4 v[132:135], v5, s[4:7], s94 offen offset:768 sc1
  s_add_u32 s94, s94, 4096
  buffer_load_dwordx4 v[136:139], v5, s[4:7], s94 offen offset:0 sc1
  buffer_load_dwordx4 v[140:143], v5, s[4:7], s94 offen offset:512 sc1
  buffer_load_dwordx4 v[144:147], v5, s[4:7], s94 offen offset:256 sc1
  buffer_load_dwordx4 v[148:151], v5, s[4:7], s94 offen offset:768 sc1
  s_add_u32 s94, s94, 4096
  buffer_load_dwordx4 v[152:155], v5, s[4:7], s94 offen offset:0 sc1
  buffer_load_dwordx4 v[156:159], v5, s[4:7], s94 offen offset:512 sc1
  buffer_load_dwordx4 v[160:163], v5, s[4:7], s94 offen offset:256 sc1
  buffer_load_dwordx4 v[164:167], v5, s[4:7], s94 offen offset:768 sc1
  s_add_u32 s94, s94, 4096
  buffer_load_dwordx4 v[168:171], v5, s[4:7], s94 offen offset:0 sc1
  buffer_load_dwordx4 v[172:175], v5, s[4:7], s94 offen offset:512 sc1
  buffer_load_dwordx4 v[176:179], v5, s[4:7], s94 offen offset:256 sc1
  buffer_load_dwordx4 v[180:183], v5, s[4:7], s94 offen offset:768 sc1
  s_add_u32 s67, s67, 1
  s_cmp_gt_u32 s67, 1048576
  s_cbranch_scc1 L_end
  s_waitcnt vmcnt(0)
  v_xor_b32 v7, s96, v120
  v_bitop3_b32 v7, v7, v124, s96 bitop3:0xf6
  v_bitop3_b32 v7, v7, v128, s96 bitop3:0xf6
  v_bitop3_b32 v7, v7, v132, s96 bitop3:0xf6
  v_bitop3_b32 v7, v7, v136, s96 bitop3:0xf6
  v_bitop3_b32 v7, v7, v140, s96 bitop3:0xf6
  v_bitop3_b32 v7, v7, v144, s96 bitop3:0xf6
  v_bitop3_b32 v7, v7, v148, s96 bitop3:0xf6
  v_bitop3_b32 v7, v7, v152, s96 bitop3:0xf6
  v_bitop3_b32 v7, v7, v156, s96 bitop3:0xf6
  v_bitop3_b32 v7, v7, v160, s96 bitop3:0xf6
  v_bitop3_b32 v7, v7, v164, s96 bitop3:0xf6
  v_bitop3_b32 v7, v7, v168, s96 bitop3:0xf6
  v_bitop3_b32 v7, v7, v172, s96 bitop3:0xf6
  v_bitop3_b32 v7, v7, v176, s96 bitop3:0xf6
  v_bitop3_b32 v7, v7, v180, s96 bitop3:0xf6
  v_and_b32 v7, v254, v7
  v_cmp_ne_u32 vcc, 0, v7
  s_cbranch_vccnz o_rl_173
  s_branch o_bk_172
o_f2_168:
  s_lshl_b32 s94, s43, 14
  s_add_u32 s94, s94, s86
  buffer_load_dwordx4 v[120:123], v5, s[4:7], s94 offen offset:0 sc1
  buffer_load_dwordx4 v[124:127], v5, s[4:7], s94 offen offset:512 sc1
  buffer_load_dwordx4 v[128:131], v5, s[4:7], s94 offen offset:256 sc1
  buffer_load_dwordx4 v[132:135], v5, s[4:7], s94 offen offset:768 sc1
  s_add_u32 s94, s94, 4096
  buffer_load_dwordx4 v[136:139], v5, s[4:7], s94 offen offset:0 sc1
  buffer_load_dwordx4 v[140:143], v5, s[4:7], s94 offen offset:512 sc1
  buffer_load_dwordx4 v[144:147], v5, s[4:7], s94 offen offset:256 sc1
  buffer_load_dwordx4 v[148:151], v5, s[4:7], s94 offen offset:768 sc1
  s_add_u32 s94, s94, 4096
  buffer_load_dwordx4 v[152:155], v5, s[4:7], s94 offen offset:0 sc1
  buffer_load_dwordx4 v[156:159], v5, s[4:7], s94 offen offset:512 sc1
  buffer_load_dwordx4 v[160:163], v5, s[4:7], s94 offen offset:256 sc1
  buffer_load_dwordx4 v[164:167], v5, s[4:7], s94 offen offset:768 sc1
  s_add_u32 s94, s94, 4096
  buffer_load_dwordx4 v[168:171], v5, s[4:7], s94 offen offset:0 sc1
  buffer_load_dwordx4 v[172:175], v5, s[4:7], s94 offen offset:512 sc1
  buffer_load_dwordx4 v[176:179], v5, s[4:7], s94 offen offset:256 sc1
  buffer_load_dwordx4 v[180:183], v5, s[4:7], s94 offen offset:768 sc1
  s_mov_b64 exec, 1
  buffer_store_dword v38, off, s[4:7], s84 sc1
  s_mov_b64 exec, -1
  s_mov_b32 s84, 268435456
  v_mov_b64 v[188:189], 0
  v_mov_b64 v[190:191], 0
  v_mov_b64 v[192:193], 0
  v_mov_b64 v[194:195], 0
  s_waitcnt vmcnt(13)
  v_xor_b32 v7, s96, v120
  v_bitop3_b32 v7, v7, v124, s96 bitop3:0xf6
  v_bitop3_b32 v7, v7, v128, s96 bitop3:0xf6
  v_bitop3_b32 v7, v7, v132, s96 bitop3:0xf6
  s_waitcnt vmcnt(9)
  v_bitop3_b32 v7, v7, v136, s96 bitop3:0xf6
  v_bitop3_b32 v7, v7, v140, s96 bitop3:0xf6
  v_bitop3_b32 v7, v7, v144, s96 bitop3:0xf6
  v_bitop3_b32 v7, v7, v148, s96 bitop3:0xf6
  s_waitcnt vmcnt(5)
  v_bitop3_b32 v7, v7, v152, s96 bitop3:0xf6
  v_bitop3_b32 v7, v7, v156, s96 bitop3:0xf6
  v_bitop3_b32 v7, v7, v160, s96 bitop3:0xf6
  v_bitop3_b32 v7, v7, v164, s96 bitop3:0xf6
  s_waitcnt vmcnt(1)
  v_bitop3_b32 v7, v7, v168, s96 bitop3:0xf6
  v_bitop3_b32 v7, v7, v172, s96 bitop3:0xf6
  v_bitop3_b32 v7, v7, v176, s96 bitop3:0xf6
  v_bitop3_b32 v7, v7, v180, s96 bitop3:0xf6
  v_and_b32 v7, v254, v7
  v_cmp_ne_u32 vcc, 0, v7
  s_cbranch_vccnz o_rt_174
o_bk_175:
  v_smfmac_f32_16x16x64_bf16 v[188:191], v[16:19], v[120:127], v20
  v_lshlrev_b32 v196, 16, v184
  v_smfmac_f32_16x16x64_bf16 v[192:195], v[16:19], v[128:135], v20
  v_and_b32 v197, 0xffff0000, v184
  v_smfmac_f32_16x16x64_bf16 v[188:191], v[16:19], v[136:143], v20
  v_lshlrev_b32 v198, 16, v185
  v_smfmac_f32_16x16x64_bf16 v[192:195], v[16:19], v[144:151], v20
  v_and_b32 v199, 0xffff0000, v185
  v_smfmac_f32_16x16x64_bf16 v[188:191], v[16:19], v[152:159], v20
  v_lshlrev_b32 v200, 16, v186
  v_smfmac_f32_16x16x64_bf16 v[192:195], v[16:19], v[160:167], v20
  v_and_b32 v201, 0xffff0000, v186
  v_smfmac_f32_16x16x64_bf16 v[188:191], v[16:19], v[168:175], v20
  v_lshlrev_b32 v202, 16, v187
  v_smfmac_f32_16x16x64_bf16 v[192:195], v[16:19], v[176:183], v20
  v_and_b32 v203, 0xffff0000, v187
  s_bfe_u32 s92, s65, 131086
  s_lshl_b32 s92, s92, 21
  s_add_u32 s92, s92, s91
  s_add_u32 s93, s92, 27262976
  s_add_u32 s92, s92, 20971520
  s_nop 1
  v_permlane16_swap_b32 v188, v192
  v_permlane16_swap_b32 v189, v193
  v_permlane16_swap_b32 v190, v194
  v_permlane16_swap_b32 v191, v195
  v_cvt_pk_bf16_f32 v188, 0, v188
  v_cvt_pk_bf16_f32 v189, 0, v189
  v_cvt_pk_bf16_f32 v190, 0, v190
  v_cvt_pk_bf16_f32 v191, 0, v191
  v_cvt_pk_bf16_f32 v192, 0, v192
  v_cvt_pk_bf16_f32 v193, 0, v193
  v_cvt_pk_bf16_f32 v194, 0, v194
  v_cvt_pk_bf16_f32 v195, 0, v195
  v_add_f32 v196, v196, v188
  v_add_f32 v197, v197, v189
  v_add_f32 v198, v198, v190
  v_add_f32 v199, v199, v191
  v_add_f32 v200, v200, v192
  v_add_f32 v201, v201, v193
  v_add_f32 v202, v202, v194
  v_add_f32 v203, v203, v195
  v_cvt_pk_bf16_f32 v120, v196, v197
  v_cvt_pk_bf16_f32 v121, v198, v199
  v_cvt_pk_bf16_f32 v122, v200, v201
  v_cvt_pk_bf16_f32 v123, v202, v203
  v_lshlrev_b32 v196, 16, v120
  v_and_b32 v197, 0xffff0000, v120
  v_lshlrev_b32 v198, 16, v121
  v_and_b32 v199, 0xffff0000, v121
  v_lshlrev_b32 v200, 16, v122
  v_and_b32 v201, 0xffff0000, v122
  v_lshlrev_b32 v202, 16, v123
  v_and_b32 v203, 0xffff0000, v123
  buffer_store_dwordx4 v[120:123], v0, s[4:7], s92 offen sc1
  v_add_f32 v136, v196, v197
  v_mul_f32 v137, v196, v196
  v_add_f32 v138, v198, v199
  v_mul_f32 v139, v197, v197
  v_fmac_f32 v137, v198, v198
  v_fmac_f32 v139, v199, v199
  v_add_f32 v136, v136, v200
  v_fmac_f32 v137, v200, v200
  v_add_f32 v138, v138, v201
  v_fmac_f32 v139, v201, v201
  v_add_f32 v136, v136, v202
  v_fmac_f32 v137, v202, v202
  v_add_f32 v138, v138, v203
  v_fmac_f32 v139, v203, v203
  v_add_f32 v136, v136, v138
  v_add_f32 v137, v137, v139
  s_nop 0
  v_add_f32_dpp v136, v136, v136 row_ror:8 row_mask:0xf bank_mask:0xf
  v_add_f32_dpp v137, v137, v137 row_ror:8 row_mask:0xf bank_mask:0xf
  s_nop 0
  v_add_f32_dpp v136, v136, v136 row_ror:4 row_mask:0xf bank_mask:0xf
  v_add_f32_dpp v137, v137, v137 row_ror:4 row_mask:0xf bank_mask:0xf
  s_nop 0
  v_add_f32_dpp v136, v136, v136 row_ror:2 row_mask:0xf bank_mask:0xf
  v_add_f32_dpp v137, v137, v137 row_ror:2 row_mask:0xf bank_mask:0xf
  s_nop 0
  v_add_f32_dpp v136, v136, v136 row_ror:1 row_mask:0xf bank_mask:0xf
  v_add_f32_dpp v137, v137, v137 row_ror:1 row_mask:0xf bank_mask:0xf
  v_mov_b32 v140, v136
  v_mov_b32 v141, v137
  s_nop 0
  v_permlane16_swap_b32 v136, v140
  v_permlane16_swap_b32 v137, v141
  v_add_f32 v136, v136, v140
  v_add_f32 v137, v137, v141
  v_mov_b32 v140, v136
  v_mov_b32 v141, v137
  s_nop 0
  v_permlane32_swap_b32 v136, v140
  v_permlane32_swap_b32 v137, v141
  v_add_f32 v136, v136, v140
  v_add_f32 v137, v137, v141
  v_mul_f32 v136, 0x3b000000, v136
  v_mul_f32 v137, 0x3b000000, v137
  v_fma_f32 v137, -v136, v136, v137
  v_cvt_pk_bf16_f32 v136, 0, v136
  v_max_f32 v137, 0, v137
  v_sub_f32 v140, v196, v136
  v_sub_f32 v141, v197, v136
  v_cvt_pk_bf16_f32 v137, 0, v137
  v_sub_f32 v142, v198, v136
  v_sub_f32 v143, v199, v136
  v_add_f32 v137, 0x3727c5ac, v137
  v_sub_f32 v144, v200, v136
  v_sub_f32 v145, v201, v136
  v_cvt_pk_bf16_f32 v137, 0, v137
  v_sub_f32 v146, v202, v136
  v_sub_f32 v147, v203, v136
  v_sqrt_f32 v137, v137
  v_cvt_pk_bf16_f32 v140, 0, v140
  v_cvt_pk_bf16_f32 v141, 0, v141
  v_cvt_pk_bf16_f32 v137, 0, v137
  v_cvt_pk_bf16_f32 v142, 0, v142
  v_cvt_pk_bf16_f32 v143, 0, v143
  v_rcp_f32 v137, v137
  v_cvt_pk_bf16_f32 v144, 0, v144
  v_cvt_pk_bf16_f32 v145, 0, v145
  v_cvt_pk_bf16_f32 v146, 0, v146
  v_cvt_pk_bf16_f32 v147, 0, v147
  v_mul_f32 v140, v140, v137
  v_mul_f32 v141, v141, v137
  v_mul_f32 v142, v142, v137
  v_mul_f32 v143, v143, v137
  v_mul_f32 v144, v144, v137
  v_mul_f32 v145, v145, v137
  v_mul_f32 v146, v146, v137
  v_mul_f32 v147, v147, v137
  v_cvt_pk_bf16_f32 v124, v140, v141
  v_cvt_pk_bf16_f32 v125, v142, v143
  v_cvt_pk_bf16_f32 v126, v144, v145
  v_cvt_pk_bf16_f32 v127, v146, v147
  v_lshlrev_b32 v204, 16, v124
  v_and_b32 v205, 0xffff0000, v124
  v_lshlrev_b32 v206, 16, v125
  v_and_b32 v207, 0xffff0000, v125
  v_lshlrev_b32 v208, 16, v126
  v_and_b32 v209, 0xffff0000, v126
  v_lshlrev_b32 v210, 16, v127
  v_and_b32 v211, 0xffff0000, v127
  buffer_store_dwordx4 v[124:127], v0, s[4:7], s93 offen sc1
  v_add_f32 v196, v196, v204
  v_add_f32 v197, v197, v205
  v_add_f32 v198, v198, v206
  v_add_f32 v199, v199, v207
  v_add_f32 v200, v200, v208
  v_add_f32 v201, v201, v209
  v_add_f32 v202, v202, v210
  v_add_f32 v203, v203, v211
  v_cvt_pk_bf16_f32 v128, v196, v197
  v_cvt_pk_bf16_f32 v129, v198, v199
  v_cvt_pk_bf16_f32 v130, v200, v201
  v_cvt_pk_bf16_f32 v131, v202, v203
  v_mul_f32 v188, v204, v8
  v_mul_f32 v189, v205, v9
  v_fmac_f32 v188, v206, v10
  v_fmac_f32 v189, v207, v11
  v_fmac_f32 v188, v208, v12
  v_fmac_f32 v189, v209, v13
  v_fmac_f32 v188, v210, v14
  v_fmac_f32 v189, v211, v15
  v_add_f32 v188, v188, v189
  buffer_store_dwordx4 v[128:131], v0, s[68:71], s91 offen sc1
  s_nop 0
  v_add_f32_dpp v188, v188, v188 row_ror:8 row_mask:0xf bank_mask:0xf
  s_nop 1
  v_add_f32_dpp v188, v188, v188 row_ror:4 row_mask:0xf bank_mask:0xf
  s_nop 1
  v_add_f32_dpp v188, v188, v188 row_ror:2 row_mask:0xf bank_mask:0xf
  s_nop 1
  v_add_f32_dpp v188, v188, v188 row_ror:1 row_mask:0xf bank_mask:0xf
  v_mov_b32 v189, v188
  s_nop 0
  s_nop 0
  v_permlane16_swap_b32 v188, v189
  v_add_f32 v188, v188, v189
  v_mov_b32 v189, v188
  s_nop 0
  s_nop 0
  v_permlane32_swap_b32 v188, v189
  v_add_f32 v188, v188, v189
  v_cvt_pk_bf16_f32 v188, 0, v188
  v_ashrrev_i32 v189, 31, v188
  v_or_b32 v189, 0x80000000, v189
  v_xor_b32 v188, v188, v189
  s_sub_u32 s92, 4095, s90
  v_and_b32 v188, 0xffff0000, v188
  v_or_b32 v38, s92, v188
  s_bfe_u32 s92, s65, 196625
  s_lshl_b32 s92, s92, 18
  s_lshl_b32 s93, s90, 7
  s_add_u32 s92, s92, s93
  s_add_u32 s84, s92, 243269632
  s_waitcnt vmcnt(0)
  s_mov_b64 exec, 1
  buffer_store_dword v38, off, s[4:7], s84 sc1
  s_mov_b64 exec, -1
  s_mov_b32 s84, 268435456
  s_branch o_fd_167
o_rt_174:
  s_mov_b32 s67, 0
o_rl_176:
  s_lshl_b32 s94, s43, 14
  s_add_u32 s94, s94, s86
  buffer_load_dwordx4 v[120:123], v5, s[4:7], s94 offen offset:0 sc1
  buffer_load_dwordx4 v[124:127], v5, s[4:7], s94 offen offset:512 sc1
  buffer_load_dwordx4 v[128:131], v5, s[4:7], s94 offen offset:256 sc1
  buffer_load_dwordx4 v[132:135], v5, s[4:7], s94 offen offset:768 sc1
  s_add_u32 s94, s94, 4096
  buffer_load_dwordx4 v[136:139], v5, s[4:7], s94 offen offset:0 sc1
  buffer_load_dwordx4 v[140:143], v5, s[4:7], s94 offen offset:512 sc1
  buffer_load_dwordx4 v[144:147], v5, s[4:7], s94 offen offset:256 sc1
  buffer_load_dwordx4 v[148:151], v5, s[4:7], s94 offen offset:768 sc1
  s_add_u32 s94, s94, 4096
  buffer_load_dwordx4 v[152:155], v5, s[4:7], s94 offen offset:0 sc1
  buffer_load_dwordx4 v[156:159], v5, s[4:7], s94 offen offset:512 sc1
  buffer_load_dwordx4 v[160:163], v5, s[4:7], s94 offen offset:256 sc1
  buffer_load_dwordx4 v[164:167], v5, s[4:7], s94 offen offset:768 sc1
  s_add_u32 s94, s94, 4096
  buffer_load_dwordx4 v[168:171], v5, s[4:7], s94 offen offset:0 sc1
  buffer_load_dwordx4 v[172:175], v5, s[4:7], s94 offen offset:512 sc1
  buffer_load_dwordx4 v[176:179], v5, s[4:7], s94 offen offset:256 sc1
  buffer_load_dwordx4 v[180:183], v5, s[4:7], s94 offen offset:768 sc1
  s_add_u32 s67, s67, 1
  s_cmp_gt_u32 s67, 1048576
  s_cbranch_scc1 L_end
  s_waitcnt vmcnt(0)
  v_xor_b32 v7, s96, v120
  v_bitop3_b32 v7, v7, v124, s96 bitop3:0xf6
  v_bitop3_b32 v7, v7, v128, s96 bitop3:0xf6
  v_bitop3_b32 v7, v7, v132, s96 bitop3:0xf6
  v_bitop3_b32 v7, v7, v136, s96 bitop3:0xf6
  v_bitop3_b32 v7, v7, v140, s96 bitop3:0xf6
  v_bitop3_b32 v7, v7, v144, s96 bitop3:0xf6
  v_bitop3_b32 v7, v7, v148, s96 bitop3:0xf6
  v_bitop3_b32 v7, v7, v152, s96 bitop3:0xf6
  v_bitop3_b32 v7, v7, v156, s96 bitop3:0xf6
  v_bitop3_b32 v7, v7, v160, s96 bitop3:0xf6
  v_bitop3_b32 v7, v7, v164, s96 bitop3:0xf6
  v_bitop3_b32 v7, v7, v168, s96 bitop3:0xf6
  v_bitop3_b32 v7, v7, v172, s96 bitop3:0xf6
  v_bitop3_b32 v7, v7, v176, s96 bitop3:0xf6
  v_bitop3_b32 v7, v7, v180, s96 bitop3:0xf6
  v_and_b32 v7, v254, v7
  v_cmp_ne_u32 vcc, 0, v7
  s_cbranch_vccnz o_rl_176
  s_branch o_bk_175
o_fd_167:
  s_mov_b32 s65, 0
o_nofl_127:
  s_mov_b32 s63, s64
  s_cmp_lg_u32 s51, 0
  s_cbranch_scc1 o_pick_129
  s_cmp_eq_u32 s50, 0
  s_cbranch_scc1 o_help_136_n
o_adv_135:
  s_add_u32 s49, s49, 4
  s_branch o_round_125
o_dl_137_a:
  s_andn2_b32 s26, s58, s55
  s_and_b32 s29, s26, s54
  s_bcnt1_i32_b32 s27, s29
  s_add_u32 s27, s27, 2
  s_max_u32 s27, s27, 4
  s_andn2_b32 s26, s26, s56
  s_and_b32 s26, s26, 0x3fff
  s_or_b32 s26, s26, s29
  s_cselect_b32 s27, s27, 0
  s_mul_i32 s27, s27, 0
  s_cmp_ge_u32 s46, s89
  s_cselect_b32 s30, s54, -1
  s_mov_b32 s31, 243269696
  s_branch o_dl_137_b
o_dl_137:
  s_and_b32 s26, s55, s54
  s_andn2_b32 s27, s56, s54
  s_or_b32 s26, s26, s27
  s_andn2_b32 s26, s58, s26
  s_bcnt1_i32_b32 s27, s26
  s_bcnt1_i32_b32 s28, s47
  s_mul_i32 s28, s28, -5
  s_lshl1_add_u32 s27, s27, s28
  s_add_i32 s27, s27, 1
  s_max_i32 s27, s27, 0
  s_mul_i32 s27, s27, 37
  s_mov_b32 s30, s54
  s_mov_b32 s31, 243269704
  s_and_b32 s29, s26, s47
  s_andn2_b32 s26, s26, s29
  s_branch o_dl_137_c
o_dl_137_b:
  s_mov_b32 s29, 0
o_dl_137_c:
  s_bfe_u32 s28, s48, 262144
  s_bitset0_b32 s26, s28
  s_bfe_u32 s28, s48, 262148
  s_bitset0_b32 s26, s28
  s_bfe_u32 s28, s48, 262152
  s_bitset0_b32 s26, s28
  s_bfe_u32 s28, s48, 262156
  s_bitset0_b32 s26, s28
  s_lshr_b32 s27, s27, 8
o_dl1_138:
  s_cbranch_scc0 o_dl2_139
  s_ff1_i32_b32 s28, s26
  s_bitset0_b32 s26, s28
  s_bitset1_b32 s29, s28
  s_sub_u32 s27, s27, 1
  s_cmp_lg_u32 s27, 0
  s_branch o_dl1_138
o_dl2_139:
  s_and_b32 s47, s29, 0xffff
  s_and_b32 s30, s30, s47
  s_or_b32 s55, s55, s30
  s_andn2_b32 s26, s47, s30
  s_or_b32 s56, s56, s26
  s_pack_ll_b32_b16 s26, s47, s30
  s_lshl_b32 s27, s60, 7
  s_add_u32 s27, s27, s31
  s_cmp_lg_u32 s43, 0
  s_cbranch_scc1 o_pick_129
  v_mov_b32 v162, s26
  v_mov_b32 v163, s46
  s_mov_b64 exec, 1
  buffer_store_dwordx2 v[162:163], off, s[4:7], s27 sc1
  s_mov_b64 exec, -1
  s_branch o_pick_129
o_help_136:
  s_lshl_b32 s60, s60, 1
  s_and_b32 s60, s60, 2
  s_lshl_b32 s47, s60, 7
  s_add_u32 s47, s47, 243269688
o_help_136_n:
  s_add_u32 s47, s47, 8
  s_lshr_b32 s26, s47, 4
  s_andn2_b32 s26, s57, s26
  s_cbranch_scc0 L_end
  s_mov_b32 s67, 0
o_help_136_w:
  buffer_load_dwordx2 v[162:163], off, s[4:7], s47 sc1
  buffer_load_dwordx2 v[164:165], off, s[4:7], s47 offset:128 sc1
  s_add_u32 s67, s67, 1
  s_cmp_gt_u32 s67, 1048576
  s_cbranch_scc1 L_end
  s_waitcnt vmcnt(0)
  v_readfirstlane_b32 s28, v162
  v_readfirstlane_b32 s30, v164
  v_readfirstlane_b32 s46, v163
  v_readfirstlane_b32 s27, v165
  s_min_u32 s26, s46, s27
  s_cmp_eq_u32 s26, 0
  s_cbranch_scc1 o_help_136_w
  s_max_u32 s46, s46, s27
  s_bitreplicate_b64_b32 s[28:29], s28
  s_bitreplicate_b64_b32 s[30:31], s30
  s_mov_b32 s26, 0x55555555
  s_mov_b32 s27, 0x55555555
  s_and_b64 s[28:29], s[28:29], s[26:27]
  s_andn2_b64 s[30:31], s[30:31], s[26:27]
  s_or_b32 s58, s28, s30
  s_or_b32 s54, s29, s31
  s_andn2_b32 s52, 0xfff, s46
  s_lshr_b32 s52, s52, 5
  s_mov_b32 s53, 0
  s_mov_b32 s63, 0
  s_mov_b32 s49, 72
  s_mov_b32 s59, 64
  s_mov_b32 s50, 0
  s_mov_b32 s89, 0
  s_branch o_pick_129
L_o_x:
  s_mov_b32 s62, 1
  s_mov_b32 s42, 0
  s_mov_b32 s3, 0
  s_mov_b32 s46, 0
  s_mov_b32 s65, 0
  s_mov_b32 s66, 0
  s_mov_b32 s76, 0
  s_mov_b32 s55, 0
  s_mov_b32 s48, 0
  s_mov_b32 s56, 0
  s_mov_b32 s84, 268435456
  s_mov_b32 s86, s41
  s_mov_b32 s49, s60
  s_mul_i32 s63, s49, 257
  s_or_b32 s63, s63, 1179648
  s_lshr_b32 s57, s60, 2
  s_cbranch_scc1 o_help_188
o_round_177:
  s_max_u32 s46, s46, s3
  s_cmp_lg_u32 s3, 0
  s_mov_b32 s3, 0
  s_cbranch_scc1 d_g_193
  s_mov_b32 s67, 0
d_w_192:
  s_min_u32 s26, s49, 71
  s_lshl_b32 s26, s26, 12
  s_add_u32 s27, s26, 243494912
  s_add_u32 s26, s26, 243486720
  buffer_load_dword v248, v246, s[4:7], s26 offen sc1
  buffer_load_dword v249, v246, s[4:7], s27 offen sc1
  s_add_u32 s67, s67, 1
  s_cmp_gt_u32 s67, 1048576
  s_cbranch_scc1 L_end
  s_waitcnt vmcnt(0)
  s_mov_b64 exec, 1
  buffer_store_dword v38, off, s[4:7], s84 sc1
  s_mov_b64 exec, -1
  s_mov_b32 s84, 268435456
  v_min_u32 v162, v248, v249
  v_max_u32 v163, v248, v249
  v_cmp_eq_u32 vcc, 0, v162
  s_cbranch_vccnz d_w_192
  v_max_u32_dpp v163, v163, v163 row_ror:8 row_mask:0xf bank_mask:0xf
  s_nop 1
  v_max_u32_dpp v163, v163, v163 row_ror:4 row_mask:0xf bank_mask:0xf
  s_nop 1
  v_max_u32_dpp v163, v163, v163 row_ror:2 row_mask:0xf bank_mask:0xf
  s_nop 1
  v_max_u32_dpp v163, v163, v163 row_ror:1 row_mask:0xf bank_mask:0xf
  s_nop 0
  v_readlane_b32 s28, v163, 0
  v_readlane_b32 s29, v163, 16
  v_readlane_b32 s30, v163, 32
  v_readlane_b32 s31, v163, 48
  s_max_u32 s28, s28, s29
  s_max_u32 s30, s30, s31
  s_max_u32 s46, s46, s28
  s_max_u32 s46, s46, s30
d_g_193:
  s_lshr_b32 s27, s49, 2
  s_andn2_b32 s52, 0xfff, s46
  s_lshr_b32 s52, s52, 5
  s_min_u32 s52, s52, 64
  s_add_u32 s26, s52, 3
  v_readlane_b32 s89, v247, s27
  s_sub_u32 s26, s26, s60
  s_lshr_b32 s26, s26, 2
  s_bfm_b32 s54, s26, 0
  s_add_u32 s53, s63, 1028
  s_cmp_lt_u32 s49, 60
  s_cselect_b32 s53, s53, 0
  s_cmp_lt_u32 s49, 64
  s_cselect_b32 s26, 2, 1
  s_sub_i32 s26, s27, s26
  s_max_i32 s26, s26, 0
  s_min_u32 s26, s26, 16
  s_bfm_b32 s58, s26, 0
  s_cmp_eq_u32 s27, 16
  s_cselect_b32 s59, 1, 1
  s_cmp_eq_u32 s27, 17
  s_cselect_b32 s59, 0, s59
  s_cmp_eq_u32 s27, 18
  s_cselect_b32 s59, 64, s59
  s_cselect_b32 s50, 0, -1
  s_cselect_b32 s89, 0, s89
  s_cbranch_scc1 o_dl_189
  s_cmp_eq_u32 s27, 16
  s_cbranch_scc1 o_dl_189_a
o_pick_181:
  s_cmp_eq_u32 s59, 0
  s_cbranch_scc1 o_none_185
  s_sub_u32 s59, s59, 1
  s_andn2_b32 s26, s58, s55
  s_and_b32 s26, s26, s54
  s_cbranch_scc1 o_ga_182
  s_and_b32 s26, s55, s50
  s_or_b32 s26, s26, s56
  s_or_b32 s26, s26, s54
  s_andn2_b32 s26, s58, s26
  s_cbranch_scc0 o_none_185
  s_cmp_ge_u32 s46, s89
  s_cbranch_scc1 o_gb_183
o_ga_182:
  s_ff1_i32_b32 s26, s26
  s_bitset1_b32 s55, s26
  s_mov_b32 s64, 1327168
  s_mov_b32 s27, s64
  s_branch o_gd_184
o_none_185:
  s_cmp_lt_u32 s49, 60
  s_cbranch_scc1 o_nn_186
  s_cmp_eq_u32 s50, 0
  s_cbranch_scc1 o_nn_186
  s_and_b32 s26, s63, 1097728
  s_cmp_eq_u32 s26, 1048576
  s_cbranch_scc1 o_nn_186
  s_cmp_lt_u32 s49, 64
  s_cbranch_scc1 o_adv_187
  s_and_b32 s26, s65, 1097728
  s_cmp_lg_u32 s26, 1048576
  s_cbranch_scc1 o_adv_187
o_nn_186:
  s_mov_b32 s64, s53
  s_mov_b32 s51, 0
  s_branch o_task_178
o_gb_183:
  s_ff1_i32_b32 s26, s26
  s_bitset1_b32 s56, s26
  s_andn2_b32 s27, 31, s46
  s_or_b32 s27, s27, 32
  s_lshl_b32 s27, s27, 22
  s_or_b32 s27, s27, 1474688
  s_mov_b32 s64, 1474624
o_gd_184:
  s_lshl4_add_u32 s48, s48, s26
  s_and_b32 s28, s26, s57
  s_lshr_b32 s26, s26, s57
  s_lshl2_add_u32 s26, s26, s60
  s_add_u32 s26, s26, s28
  s_cmp_eq_u32 s26, s52
  s_cselect_b32 s64, s27, s64
  s_mul_i32 s26, s26, 257
  s_or_b32 s64, s64, s26
  s_mov_b32 s51, 1
o_task_178:
  s_cmp_eq_u32 s63, 0
  s_cbranch_scc1 o_nofl_179
  s_cmp_lg_u32 s66, 0
  s_cbranch_scc1 o_have_195
  s_mov_b32 s67, 0
o_w1_194:
  s_and_b32 s32, s63, 0xff
  s_lshl_b32 s32, s32, 12
  s_add_u32 s32, s32, s14
  buffer_load_dword v37, v36, s[4:7], s32 offen sc1
  s_add_u32 s67, s67, 1
  s_cmp_gt_u32 s67, 1048576
  s_cbranch_scc1 L_end
  s_waitcnt vmcnt(0)
  s_mov_b64 exec, 1
  buffer_store_dword v38, off, s[4:7], s84 sc1
  s_mov_b64 exec, -1
  s_mov_b32 s84, 268435456
  v_cmp_eq_u32 vcc, 0, v37
  s_cbranch_vccnz o_w1_194
  s_and_b32 s87, s63, 0xff
  s_lshl_b32 s33, s87, 18
  s_lshl_b32 s32, s87, 19
  s_add_u32 m0, s22, 0
  s_add_u32 s33, s33, s19
  buffer_load_dwordx4 v0, s[4:7], s33 offen offset:0 sc1 lds
  buffer_load_dwordx4 v0, s[4:7], s33 offen offset:1024 sc1 lds
  buffer_load_dwordx4 v0, s[4:7], s33 offen offset:2048 sc1 lds
  buffer_load_dwordx4 v0, s[4:7], s33 offen offset:3072 sc1 lds
  s_add_u32 m0, s23, 0
  s_add_u32 s32, s32, s18
  buffer_load_dwordx4 v0, s[4:7], s32 offen offset:0 sc1 lds
  buffer_load_dwordx4 v0, s[4:7], s32 offen offset:1024 sc1 lds
  buffer_load_dwordx4 v0, s[4:7], s32 offen offset:2048 sc1 lds
  buffer_load_dwordx4 v0, s[4:7], s32 offen offset:3072 sc1 lds
  s_add_u32 m0, m0, 4096
  s_add_u32 s32, s32, 4096
  buffer_load_dwordx4 v0, s[4:7], s32 offen offset:0 sc1 lds
  buffer_load_dwordx4 v0, s[4:7], s32 offen offset:1024 sc1 lds
  buffer_load_dwordx4 v0, s[4:7], s32 offen offset:2048 sc1 lds
  buffer_load_dwordx4 v0, s[4:7], s32 offen offset:3072 sc1 lds
  s_waitcnt vmcnt(0)
  s_barrier
o_have_195:
  ds_read_b128 v[120:123], v33 offset:0
  ds_read_b128 v[40:43], v32 offset:0
  ds_read_b128 v[56:59], v32 offset:1024
  ds_read_b128 v[124:127], v33 offset:2048
  ds_read_b128 v[44:47], v32 offset:4096
  ds_read_b128 v[60:63], v32 offset:5120
  ds_read_b128 v[128:131], v33 offset:4096
  ds_read_b128 v[48:51], v32 offset:8192
  ds_read_b128 v[64:67], v32 offset:9216
  ds_read_b128 v[132:135], v33 offset:6144
  ds_read_b128 v[52:55], v32 offset:12288
  ds_read_b128 v[68:71], v32 offset:13312
  s_cmp_lt_u32 s17, 2
  s_cselect_b32 s65, s65, 0
  s_cmp_lg_u32 s65, 0
  s_cselect_b64 s[44:45], -1, 0
  s_mov_b32 s95, s86
  s_mov_b32 s96, s42
  s_lshl_b32 s97, s43, 14
  s_add_u32 s97, s97, s95
  s_and_b32 s87, s64, 0xff
  s_lshl_b32 s87, s87, 12
  s_add_u32 s87, s87, s14
  s_and_b32 s88, s63, 0xff00
  s_lshl_b32 s88, s88, 3
  s_add_u32 s88, s88, s15
  s_and_b32 s91, s65, 63
  s_lshl_b32 s90, s91, 5
  s_add_u32 s94, s90, s85
  s_add_u32 s90, s90, s43
  s_lshl_b32 s94, s94, 10
  s_lshr_b32 s92, s65, 22
  s_xor_b32 s93, s43, 32
  s_lshl_b32 s91, s90, 10
  s_add_u32 s94, s94, 25165824
  s_cmp_eq_u32 s92, s93
  s_cselect_b32 s92, s94, s91
  s_add_u32 s92, s92, 10485760
  s_and_b32 s93, s65, 49152
  s_cselect_b32 s92, s92, s91
  s_cselect_b64 s[80:81], s[4:5], s[72:73]
  s_cselect_b32 s82, s6, s74
  s_waitcnt lgkmcnt(9)
  v_mfma_f32_16x16x32_bf16 v[104:107], v[40:43], v[120:123], v[24:27]
  v_mfma_f32_16x16x32_bf16 v[108:111], v[56:59], v[120:123], v[28:31]
  s_mov_b64 exec, s[44:45]
  buffer_load_dword v7, v255, s[4:7], s97 offen sc1
  buffer_load_dwordx4 v[184:187], v0, s[80:83], s92 offen sc1
  s_not_b64 exec, exec
  buffer_load_dword v37, v36, s[4:7], s87 offen sc1
  s_mov_b64 exec, -1
  buffer_load_dword v244, v252, s[4:7], s88 offen sc1
  s_waitcnt lgkmcnt(6)
  v_mfma_f32_16x16x32_bf16 v[104:107], v[44:47], v[124:127], v[104:107]
  v_mfma_f32_16x16x32_bf16 v[108:111], v[60:63], v[124:127], v[108:111]
  s_waitcnt lgkmcnt(3)
  v_mfma_f32_16x16x32_bf16 v[104:107], v[48:51], v[128:131], v[104:107]
  v_mfma_f32_16x16x32_bf16 v[108:111], v[64:67], v[128:131], v[108:111]
  s_waitcnt lgkmcnt(0)
  v_mfma_f32_16x16x32_bf16 v[104:107], v[52:55], v[132:135], v[104:107]
  v_mfma_f32_16x16x32_bf16 v[108:111], v[68:71], v[132:135], v[108:111]
  s_cmp_lg_u32 s76, 0
  s_cbranch_scc1 o_klds_198
  v_mov_b32 v196, 0
  v_mov_b32 v199, 0
  v_exp_f32 v56, v104
  v_exp_f32 v57, v105
  v_exp_f32 v58, v106
  v_exp_f32 v59, v107
  v_exp_f32 v60, v108
  v_exp_f32 v61, v109
  v_exp_f32 v62, v110
  v_exp_f32 v63, v111
  v_max3_f32 v116, v104, v105, v106
  v_max3_f32 v116, v107, v108, v116
  v_max3_f32 v116, v109, v110, v116
  v_add_f32 v117, v56, v57
  v_add_f32 v118, v58, v59
  v_add_f32 v117, v117, v60
  v_add_f32 v118, v118, v61
  v_add_f32 v117, v117, v62
  v_add_f32 v118, v118, v63
  s_mov_b32 s67, 0
  s_and_b32 s32, s63, 0xff00
  s_lshl_b32 s32, s32, 10
  s_add_u32 s32, s32, s20
  s_add_u32 s33, s32, 4096
o_w2_196:
  s_waitcnt vmcnt(0)
  v_cmp_eq_u32 vcc, 0, v244
  s_cbranch_vccz o_kgo_206
  s_mov_b64 exec, 1
  buffer_store_dword v38, off, s[4:7], s84 sc1
  s_mov_b64 exec, -1
  s_mov_b32 s84, 268435456
  buffer_load_dword v244, v252, s[4:7], s88 offen sc1
  s_add_u32 s67, s67, 1
  s_cmp_gt_u32 s67, 1048576
  s_cbranch_scc1 L_end
  s_branch o_w2_196
o_kgo_206:
  buffer_load_dwordx4 v[136:139], v0, s[4:7], s32 offen offset:0 sc1
  buffer_load_dwordx4 v[140:143], v0, s[4:7], s32 offen offset:1024 sc1
  buffer_load_dwordx4 v[144:147], v0, s[4:7], s32 offen offset:2048 sc1
  buffer_load_dwordx4 v[148:151], v0, s[4:7], s32 offen offset:3072 sc1
  buffer_load_dwordx2 v[200:201], v1, s[4:7], s33 offen offset:0 sc1
  buffer_load_dwordx2 v[202:203], v1, s[4:7], s33 offen offset:512 sc1
  buffer_load_dwordx2 v[204:205], v1, s[4:7], s33 offen offset:1024 sc1
  buffer_load_dwordx2 v[206:207], v1, s[4:7], s33 offen offset:1536 sc1
  buffer_load_dword v37, v36, s[4:7], s87 offen sc1
  buffer_load_dword v244, v252, s[4:7], s88 offen sc1
  s_barrier
  ds_read_b128 v[152:155], v32 offset:2048
  ds_read_b128 v[156:159], v32 offset:3072
  ds_read_b128 v[160:163], v32 offset:6144
  ds_read_b128 v[164:167], v32 offset:7168
  ds_read_b128 v[168:171], v32 offset:10240
  ds_read_b128 v[172:175], v32 offset:11264
  ds_read_b128 v[176:179], v32 offset:14336
  ds_read_b128 v[180:183], v32 offset:15360
  s_waitcnt vmcnt(9)
  v_mfma_f32_16x16x32_bf16 v[112:115], v[136:139], v[120:123], 0
  s_waitcnt vmcnt(8)
  v_mfma_f32_16x16x32_bf16 v[112:115], v[140:143], v[124:127], v[112:115]
  s_waitcnt vmcnt(7)
  v_mfma_f32_16x16x32_bf16 v[112:115], v[144:147], v[128:131], v[112:115]
  s_waitcnt vmcnt(6)
  v_mfma_f32_16x16x32_bf16 v[112:115], v[148:151], v[132:135], v[112:115]
  s_waitcnt vmcnt(2)
  s_branch o_havek_197
o_klds_198:
  s_waitcnt vmcnt(12)
  s_barrier
  ds_read_b128 v[136:139], v34 offset:0
  ds_read_b128 v[140:143], v34 offset:1024
  ds_read_b128 v[144:147], v34 offset:2048
  ds_read_b128 v[148:151], v34 offset:3072
  ds_read_b64 v[200:201], v35 offset:4096
  ds_read_b64 v[202:203], v35 offset:4608
  ds_read_b64 v[204:205], v35 offset:5120
  ds_read_b64 v[206:207], v35 offset:5632
  v_mov_b32 v196, 0
  v_mov_b32 v199, 0
  v_exp_f32 v56, v104
  v_exp_f32 v57, v105
  v_exp_f32 v58, v106
  v_exp_f32 v59, v107
  v_exp_f32 v60, v108
  v_exp_f32 v61, v109
  v_exp_f32 v62, v110
  v_exp_f32 v63, v111
  v_max3_f32 v116, v104, v105, v106
  v_max3_f32 v116, v107, v108, v116
  v_max3_f32 v116, v109, v110, v116
  s_waitcnt lgkmcnt(4)
  v_mfma_f32_16x16x32_bf16 v[112:115], v[136:139], v[120:123], 0
  ds_read_b128 v[152:155], v32 offset:2048
  ds_read_b128 v[156:159], v32 offset:3072
  v_mfma_f32_16x16x32_bf16 v[112:115], v[140:143], v[124:127], v[112:115]
  ds_read_b128 v[160:163], v32 offset:6144
  ds_read_b128 v[164:167], v32 offset:7168
  v_mfma_f32_16x16x32_bf16 v[112:115], v[144:147], v[128:131], v[112:115]
  ds_read_b128 v[168:171], v32 offset:10240
  ds_read_b128 v[172:175], v32 offset:11264
  v_mfma_f32_16x16x32_bf16 v[112:115], v[148:151], v[132:135], v[112:115]
  ds_read_b128 v[176:179], v32 offset:14336
  ds_read_b128 v[180:183], v32 offset:15360
  v_add_f32 v117, v56, v57
  v_add_f32 v118, v58, v59
  v_add_f32 v117, v117, v60
  v_add_f32 v118, v118, v61
  v_add_f32 v117, v117, v62
  v_add_f32 v118, v118, v63
o_havek_197:
  s_cmp_lg_u32 s65, 0
  s_cbranch_scc1 o_wr1_203
  s_nop 3
  v_mul_f32 v112, s24, v112
  v_mul_f32 v113, s24, v113
  v_exp_f32 v64, v112
  v_exp_f32 v65, v113
  v_max_f32 v116, v111, v116
  v_max3_f32 v116, v112, v113, v116
  v_add_f32 v117, v117, v64
  v_add_f32 v118, v118, v65
  v_add_f32 v117, v117, v118
  s_mov_b32 s28, 0x21800000
  v_mov_b32 v118, v117
  s_nop 1
  v_permlane16_swap_b32 v117, v118
  v_add_f32 v117, v117, v118
  v_mov_b32 v118, v117
  s_nop 0
  s_nop 0
  v_permlane32_swap_b32 v117, v118
  v_add_f32 v117, v117, v118
  v_cmp_lt_f32 vcc, 0x42700000, v116
  v_cmp_gt_f32 s[30:31], s28, v117
  v_rcp_f32 v117, v117
  s_or_b64 vcc, vcc, s[30:31]
  s_cbranch_vccnz o_fb_207
o_fbr_208:
  v_pk_mul_f32 v[56:57], v[56:57], v[116:117] op_sel:[0,1] op_sel_hi:[1,1]
  v_pk_mul_f32 v[58:59], v[58:59], v[116:117] op_sel:[0,1] op_sel_hi:[1,1]
  v_pk_mul_f32 v[60:61], v[60:61], v[116:117] op_sel:[0,1] op_sel_hi:[1,1]
  v_pk_mul_f32 v[62:63], v[62:63], v[116:117] op_sel:[0,1] op_sel_hi:[1,1]
  v_pk_mul_f32 v[64:65], v[64:65], v[116:117] op_sel:[0,1] op_sel_hi:[1,1]
  v_cvt_pk_bf16_f32 v116, v56, v57
  v_cvt_pk_bf16_f32 v117, v58, v59
  v_cvt_pk_bf16_f32 v118, v60, v61
  v_cvt_pk_bf16_f32 v119, v62, v63
  s_waitcnt lgkmcnt(0)
  s_nop 0
  v_mfma_f32_16x16x32_bf16 v[72:75], v[152:155], v[116:119], 0
  s_add_u32 s62, s62, 1
  v_cvt_pk_bf16_f32 v197, v64, v65
  v_cvt_pk_bf16_f32 v198, v64, v65
  v_mfma_f32_16x16x32_bf16 v[76:79], v[156:159], v[116:119], 0
  s_xor_b32 s86, s86, 524288
  v_mfma_f32_16x16x32_bf16 v[80:83], v[160:163], v[116:119], 0
  s_bfe_u32 s42, s62, 0x10001
  v_mfma_f32_16x16x32_bf16 v[84:87], v[164:167], v[116:119], 0
  s_bfe_u32 s26, s64, 65556
  v_mfma_f32_16x16x32_bf16 v[88:91], v[168:171], v[116:119], 0
  s_and_b32 s87, s64, 0xff
  v_mfma_f32_16x16x32_bf16 v[92:95], v[172:175], v[116:119], 0
  s_bfe_u32 s88, s64, 0x80008
  v_mfma_f32_16x16x32_bf16 v[96:99], v[176:179], v[116:119], 0
  s_nop 0
  v_mfma_f32_16x16x32_bf16 v[100:103], v[180:183], v[116:119], 0
  s_nop 0
  v_mfma_f32_16x16x16_bf16 v[72:75], v[200:201], v[198:199], v[72:75]
  s_nop 1
  v_mfma_f32_16x16x16_bf16 v[76:79], v[200:201], v[196:197], v[76:79]
  s_nop 1
  v_mfma_f32_16x16x16_bf16 v[80:83], v[202:203], v[198:199], v[80:83]
  s_nop 1
  v_mfma_f32_16x16x16_bf16 v[84:87], v[202:203], v[196:197], v[84:87]
  s_nop 1
  v_mfma_f32_16x16x16_bf16 v[88:91], v[204:205], v[198:199], v[88:91]
  s_nop 0
  v_cvt_pk_bf16_f32 v40, v72, v73
  v_cvt_pk_bf16_f32 v41, v74, v75
  v_mfma_f32_16x16x16_bf16 v[92:95], v[204:205], v[196:197], v[92:95]
  s_nop 0
  v_cvt_pk_bf16_f32 v42, v76, v77
  v_cvt_pk_bf16_f32 v43, v78, v79
  v_mfma_f32_16x16x16_bf16 v[96:99], v[206:207], v[198:199], v[96:99]
  s_nop 0
  ds_write_b128 v6, v[40:43] offset:0
  v_cvt_pk_bf16_f32 v44, v80, v81
  v_mfma_f32_16x16x16_bf16 v[100:103], v[206:207], v[196:197], v[100:103]
  s_nop 0
  v_cvt_pk_bf16_f32 v45, v82, v83
  v_cvt_pk_bf16_f32 v46, v84, v85
  v_cvt_pk_bf16_f32 v47, v86, v87
  ds_write_b128 v6, v[44:47] offset:1024
  v_cvt_pk_bf16_f32 v48, v88, v89
  v_cvt_pk_bf16_f32 v49, v90, v91
  v_cvt_pk_bf16_f32 v50, v92, v93
  v_cvt_pk_bf16_f32 v51, v94, v95
  ds_write_b128 v6, v[48:51] offset:2048
  v_cvt_pk_bf16_f32 v52, v96, v97
  v_cvt_pk_bf16_f32 v53, v98, v99
  v_cvt_pk_bf16_f32 v54, v100, v101
  v_cvt_pk_bf16_f32 v55, v102, v103
  ds_write_b128 v6, v[52:55] offset:3072
  s_cmp_lt_u32 s17, 2
  s_cbranch_scc1 o_wr0_202
  s_waitcnt lgkmcnt(0)
  s_barrier
  ds_read_b128 v[104:107], v3 offset:0
  ds_read_b128 v[108:111], v3 offset:512
  ds_read_b128 v[112:115], v3 offset:1024
  s_waitcnt lgkmcnt(2)
  v_mfma_f32_32x32x16_bf16 v[40:55], v[104:107], a[0:3], 0
  s_waitcnt vmcnt(0)
  v_cmp_eq_u32 vcc, 0, v37
  s_cmp_eq_u64 vcc, 0
  s_cselect_b32 s66, s26, 0
  s_cmp_eq_u32 s66, 1
  s_cselect_b32 s87, s87, 1024
  s_cselect_b32 s34, 0, 0x28000
  v_mfma_f32_32x32x16_bf16 v[56:71], v[104:107], a[4:7], 0
  ds_read_b128 v[116:119], v3 offset:1536
  s_lshl_b32 s33, s87, 18
  s_lshl_b32 s32, s87, 19
  s_add_u32 m0, s22, s34
  s_add_u32 s33, s33, s19
  s_min_u32 s28, s49, 67
  v_mfma_f32_32x32x16_bf16 v[72:87], v[104:107], a[8:11], 0
  s_lshl1_add_u32 s28, s17, s28
  s_lshl_b32 s28, s28, 12
  s_add_u32 s28, s28, 243486720
  v_mfma_f32_32x32x16_bf16 v[88:103], v[104:107], a[12:15], 0
  buffer_load_dword v249, v246, s[4:7], s28 offen sc1
  s_waitcnt lgkmcnt(2)
  v_mfma_f32_32x32x16_bf16 v[40:55], v[108:111], a[16:19], v[40:55]
  buffer_load_dwordx4 v0, s[4:7], s33 offen offset:0 sc1 lds
  v_mfma_f32_32x32x16_bf16 v[56:71], v[108:111], a[20:23], v[56:71]
  ds_read_b128 v[104:107], v3 offset:2048
  v_mfma_f32_32x32x16_bf16 v[72:87], v[108:111], a[24:27], v[72:87]
  buffer_load_dwordx4 v0, s[4:7], s33 offen offset:1024 sc1 lds
  v_mfma_f32_32x32x16_bf16 v[88:103], v[108:111], a[28:31], v[88:103]
  buffer_load_dwordx4 v0, s[4:7], s33 offen offset:2048 sc1 lds
  s_waitcnt lgkmcnt(2)
  v_mfma_f32_32x32x16_bf16 v[40:55], v[112:115], a[32:35], v[40:55]
  v_mfma_f32_32x32x16_bf16 v[56:71], v[112:115], a[36:39], v[56:71]
  ds_read_b128 v[108:111], v3 offset:2560
  buffer_load_dwordx4 v0, s[4:7], s33 offen offset:3072 sc1 lds
  s_sub_u32 m0, m0, 8192
  s_sub_u32 s33, s33, 8192
  v_mfma_f32_32x32x16_bf16 v[72:87], v[112:115], a[40:43], v[72:87]
  buffer_load_dwordx4 v0, s[4:7], s33 offen offset:0 sc1 lds
  v_mfma_f32_32x32x16_bf16 v[88:103], v[112:115], a[44:47], v[88:103]
  s_waitcnt lgkmcnt(2)
  v_mfma_f32_32x32x16_bf16 v[40:55], v[116:119], a[48:51], v[40:55]
  buffer_load_dwordx4 v0, s[4:7], s33 offen offset:1024 sc1 lds
  v_mfma_f32_32x32x16_bf16 v[56:71], v[116:119], a[52:55], v[56:71]
  ds_read_b128 v[112:115], v3 offset:3072
  buffer_load_dwordx4 v0, s[4:7], s33 offen offset:2048 sc1 lds
  v_mfma_f32_32x32x16_bf16 v[72:87], v[116:119], a[56:59], v[72:87]
  v_mfma_f32_32x32x16_bf16 v[88:103], v[116:119], a[60:63], v[88:103]
  buffer_load_dwordx4 v0, s[4:7], s33 offen offset:3072 sc1 lds
  s_add_u32 m0, s23, s34
  s_add_u32 s32, s32, s18
  s_waitcnt lgkmcnt(2)
  v_mfma_f32_32x32x16_bf16 v[40:55], v[104:107], a[64:67], v[40:55]
  buffer_load_dwordx4 v0, s[4:7], s32 offen offset:0 sc1 lds
  v_mfma_f32_32x32x16_bf16 v[56:71], v[104:107], a[68:71], v[56:71]
  ds_read_b128 v[116:119], v3 offset:3584
  v_mfma_f32_32x32x16_bf16 v[72:87], v[104:107], a[72:75], v[72:87]
  buffer_load_dwordx4 v0, s[4:7], s32 offen offset:1024 sc1 lds
  s_add_i32 m0, m0, 4096
  s_add_i32 s32, s32, 4096
  v_mfma_f32_32x32x16_bf16 v[88:103], v[104:107], a[76:79], v[88:103]
  buffer_load_dwordx4 v0, s[4:7], s32 offen offset:0 sc1 lds
  s_waitcnt lgkmcnt(2)
  v_mfma_f32_32x32x16_bf16 v[40:55], v[108:111], a[80:83], v[40:55]
  v_mfma_f32_32x32x16_bf16 v[56:71], v[108:111], a[84:87], v[56:71]
  ds_read_b128 v[104:107], v3 offset:8192
  buffer_load_dwordx4 v0, s[4:7], s32 offen offset:1024 sc1 lds
  s_add_i32 m0, m0, -16384
  s_add_i32 s32, s32, -16384
  v_mfma_f32_32x32x16_bf16 v[72:87], v[108:111], a[88:91], v[72:87]
  s_and_b32 s29, s64, 0xff00
  s_lshl_b32 s29, s29, 3
  s_add_u32 s29, s29, s15
  buffer_load_dword v245, v252, s[4:7], s29 offen sc1
  v_mfma_f32_32x32x16_bf16 v[88:103], v[108:111], a[92:95], v[88:103]
  s_waitcnt lgkmcnt(2)
  v_mfma_f32_32x32x16_bf16 v[40:55], v[112:115], a[96:99], v[40:55]
  buffer_load_dwordx4 v0, s[4:7], s32 offen offset:0 sc1 lds
  v_mfma_f32_32x32x16_bf16 v[56:71], v[112:115], a[100:103], v[56:71]
  ds_read_b128 v[108:111], v3 offset:8704
  buffer_load_dwordx4 v0, s[4:7], s32 offen offset:1024 sc1 lds
  s_add_i32 m0, m0, -4096
  s_add_i32 s32, s32, -4096
  v_mfma_f32_32x32x16_bf16 v[72:87], v[112:115], a[104:107], v[72:87]
  v_mfma_f32_32x32x16_bf16 v[88:103], v[112:115], a[108:111], v[88:103]
  buffer_load_dwordx4 v0, s[4:7], s32 offen offset:0 sc1 lds
  s_waitcnt lgkmcnt(2)
  v_mfma_f32_32x32x16_bf16 v[40:55], v[116:119], a[112:115], v[40:55]
  buffer_load_dwordx4 v0, s[4:7], s32 offen offset:1024 sc1 lds
  v_mfma_f32_32x32x16_bf16 v[56:71], v[116:119], a[116:119], v[56:71]
  ds_read_b128 v[112:115], v3 offset:9216
  v_mfma_f32_32x32x16_bf16 v[72:87], v[116:119], a[120:123], v[72:87]
  buffer_load_dwordx4 v0, s[4:7], s32 offen offset:2048 sc1 lds
  v_mfma_f32_32x32x16_bf16 v[88:103], v[116:119], a[124:127], v[88:103]
  buffer_load_dwordx4 v0, s[4:7], s32 offen offset:3072 sc1 lds
  s_add_i32 m0, m0, 4096
  s_add_i32 s32, s32, 4096
  s_waitcnt lgkmcnt(2)
  v_mfma_f32_32x32x16_bf16 v[40:55], v[104:107], a[128:131], v[40:55]
  v_mfma_f32_32x32x16_bf16 v[56:71], v[104:107], a[132:135], v[56:71]
  ds_read_b128 v[116:119], v3 offset:9728
  buffer_load_dwordx4 v0, s[4:7], s32 offen offset:2048 sc1 lds
  v_mfma_f32_32x32x16_bf16 v[72:87], v[104:107], a[136:139], v[72:87]
  buffer_load_dwordx4 v0, s[4:7], s32 offen offset:3072 sc1 lds
  s_add_i32 m0, m0, 16384
  s_add_i32 s32, s32, 16384
  v_mfma_f32_32x32x16_bf16 v[88:103], v[104:107], a[140:143], v[88:103]
  s_waitcnt lgkmcnt(2)
  v_mfma_f32_32x32x16_bf16 v[40:55], v[108:111], a[144:147], v[40:55]
  buffer_load_dwordx4 v0, s[4:7], s32 offen offset:2048 sc1 lds
  v_mfma_f32_32x32x16_bf16 v[56:71], v[108:111], a[148:151], v[56:71]
  ds_read_b128 v[104:107], v3 offset:10240
  buffer_load_dwordx4 v0, s[4:7], s32 offen offset:3072 sc1 lds
  s_add_i32 m0, m0, -4096
  s_add_i32 s32, s32, -4096
  v_mfma_f32_32x32x16_bf16 v[72:87], v[108:111], a[152:155], v[72:87]
  v_mfma_f32_32x32x16_bf16 v[88:103], v[108:111], a[156:159], v[88:103]
  buffer_load_dwordx4 v0, s[4:7], s32 offen offset:2048 sc1 lds
  s_waitcnt lgkmcnt(2)
  v_mfma_f32_32x32x16_bf16 v[40:55], v[112:115], a[160:163], v[40:55]
  buffer_load_dwordx4 v0, s[4:7], s32 offen offset:3072 sc1 lds
  v_mfma_f32_32x32x16_bf16 v[56:71], v[112:115], a[164:167], v[56:71]
  ds_read_b128 v[108:111], v3 offset:10752
  v_mfma_f32_32x32x16_bf16 v[72:87], v[112:115], a[168:171], v[72:87]
  v_mfma_f32_32x32x16_bf16 v[88:103], v[112:115], a[172:175], v[88:103]
  s_waitcnt lgkmcnt(2)
  v_mfma_f32_32x32x16_bf16 v[40:55], v[116:119], a[176:179], v[40:55]
  v_mfma_f32_32x32x16_bf16 v[56:71], v[116:119], a[180:183], v[56:71]
  ds_read_b128 v[112:115], v3 offset:11264
  v_mfma_f32_32x32x16_bf16 v[72:87], v[116:119], a[184:187], v[72:87]
  v_mfma_f32_32x32x16_bf16 v[88:103], v[116:119], a[188:191], v[88:103]
  s_waitcnt lgkmcnt(2)
  v_mfma_f32_32x32x16_bf16 v[40:55], v[104:107], a[192:195], v[40:55]
  v_mfma_f32_32x32x16_bf16 v[56:71], v[104:107], a[196:199], v[56:71]
  ds_read_b128 v[116:119], v3 offset:11776
  s_waitcnt vmcnt(12)
  v_cmp_eq_u32 vcc, 0, v245
  s_cmp_eq_u64 vcc, 0
  s_cselect_b32 s76, s26, 0
  s_and_b32 s76, s76, 1
  s_cselect_b32 s88, s88, 1024
  s_waitcnt lgkmcnt(2)
  v_mfma_f32_32x32x16_bf16 v[40:55], v[108:111], a[208:211], v[40:55]
  s_lshl_b32 s32, s88, 18
  s_mov_b32 m0, s40
  s_add_u32 s32, s32, s21
  buffer_load_dwordx4 v0, s[4:7], s32 offen offset:0 sc1 lds
  v_mfma_f32_32x32x16_bf16 v[56:71], v[108:111], a[212:215], v[56:71]
  buffer_load_dwordx4 v0, s[4:7], s32 offen offset:1024 sc1 lds
  s_waitcnt lgkmcnt(1)
  v_mfma_f32_32x32x16_bf16 v[40:55], v[112:115], a[224:227], v[40:55]
  buffer_load_dwordx4 v0, s[4:7], s32 offen offset:2048 sc1 lds
  s_sub_u32 m0, m0, 8192
  s_sub_u32 s32, s32, 8192
  v_mfma_f32_32x32x16_bf16 v[56:71], v[112:115], a[228:231], v[56:71]
  buffer_load_dwordx4 v0, s[4:7], s32 offen offset:0 sc1 lds
  s_waitcnt lgkmcnt(0)
  v_mfma_f32_32x32x16_bf16 v[40:55], v[116:119], a[240:243], v[40:55]
  buffer_load_dwordx4 v0, s[4:7], s32 offen offset:1024 sc1 lds
  v_mfma_f32_32x32x16_bf16 v[56:71], v[116:119], a[244:247], v[56:71]
  buffer_load_dwordx4 v0, s[4:7], s32 offen offset:2048 sc1 lds
  v_cmp_eq_u32 vcc, 0, v249
  v_max_u32_dpp v249, v249, v249 row_ror:8 row_mask:0xf bank_mask:0xf
  s_nop 0
  v_mfma_f32_32x32x16_bf16 v[72:87], v[104:107], a[200:203], v[72:87]
  v_max_u32_dpp v249, v249, v249 row_ror:4 row_mask:0xf bank_mask:0xf
  s_nop 0
  s_nop 0
  v_max_u32_dpp v249, v249, v249 row_ror:2 row_mask:0xf bank_mask:0xf
  s_nop 0
  s_nop 0
  v_max_u32_dpp v249, v249, v249 row_ror:1 row_mask:0xf bank_mask:0xf
  s_nop 0
  v_mfma_f32_32x32x16_bf16 v[88:103], v[104:107], a[204:207], v[88:103]
  v_mov_b32 v248, v249
  s_nop 0
  s_nop 0
  v_permlane16_swap_b32 v249, v248
  v_max_u32 v249, v249, v248
  v_mfma_f32_32x32x16_bf16 v[72:87], v[108:111], a[216:219], v[72:87]
  v_mov_b32 v248, v249
  s_nop 0
  s_nop 0
  v_permlane32_swap_b32 v249, v248
  v_max_u32 v249, v249, v248
  s_cmp_eq_u64 vcc, 0
  s_cselect_b32 s28, 4, 0
  v_mfma_f32_32x32x16_bf16 v[88:103], v[108:111], a[220:223], v[88:103]
  s_lshl_b32 s26, s76, 1
  s_or_b32 s26, s26, s66
  s_or_b32 s26, s26, s28
  v_mov_b32 v248, s26
  ds_write_b64 v39, v[248:249]
  v_mfma_f32_32x32x16_bf16 v[72:87], v[112:115], a[232:235], v[72:87]
  v_cvt_pk_bf16_f32 v212, v40, v56
  v_cvt_pk_bf16_f32 v214, v41, v57
  v_cvt_pk_bf16_f32 v216, v42, v58
  v_cvt_pk_bf16_f32 v218, v43, v59
  v_permlane16_swap_b32 v212, v214
  v_mfma_f32_32x32x16_bf16 v[88:103], v[112:115], a[236:239], v[88:103]
  v_cvt_pk_bf16_f32 v220, v44, v60
  v_cvt_pk_bf16_f32 v222, v45, v61
  v_permlane16_swap_b32 v216, v218
  v_bfi_b32 v212, v254, s42, v212
  v_mfma_f32_32x32x16_bf16 v[72:87], v[116:119], a[248:251], v[72:87]
  v_cvt_pk_bf16_f32 v224, v46, v62
  v_cvt_pk_bf16_f32 v226, v47, v63
  v_permlane16_swap_b32 v220, v222
  v_bfi_b32 v216, v254, s42, v216
  v_cvt_pk_bf16_f32 v228, v48, v64
  v_mfma_f32_32x32x16_bf16 v[88:103], v[116:119], a[252:255], v[88:103]
  v_cvt_pk_bf16_f32 v230, v49, v65
  v_permlane16_swap_b32 v224, v226
  v_bfi_b32 v220, v254, s42, v220
  v_cvt_pk_bf16_f32 v232, v50, v66
  v_cvt_pk_bf16_f32 v234, v51, v67
  v_permlane16_swap_b32 v228, v230
  v_bfi_b32 v224, v254, s42, v224
  v_cvt_pk_bf16_f32 v236, v52, v68
  v_cvt_pk_bf16_f32 v238, v53, v69
  v_permlane16_swap_b32 v232, v234
  v_bfi_b32 v228, v254, s42, v228
  v_cvt_pk_bf16_f32 v240, v54, v70
  v_cvt_pk_bf16_f32 v242, v55, v71
  v_permlane16_swap_b32 v236, v238
  v_bfi_b32 v232, v254, s42, v232
  v_permlane16_swap_b32 v240, v242
  v_bfi_b32 v236, v254, s42, v236
  v_bfi_b32 v240, v254, s42, v240
  v_cvt_pk_bf16_f32 v213, v72, v88
  v_cvt_pk_bf16_f32 v215, v73, v89
  v_cvt_pk_bf16_f32 v217, v74, v90
  v_cvt_pk_bf16_f32 v219, v75, v91
  s_add_u32 s78, s86, 0
  v_permlane16_swap_b32 v213, v215
  buffer_store_dwordx4 v[212:215], v4, s[4:7], s78 offen sc1
  v_cvt_pk_bf16_f32 v221, v76, v92
  v_cvt_pk_bf16_f32 v223, v77, v93
  s_add_u32 s78, s86, 32768
  v_permlane16_swap_b32 v217, v219
  buffer_store_dwordx4 v[216:219], v4, s[4:7], s78 offen sc1
  v_cvt_pk_bf16_f32 v225, v78, v94
  v_cvt_pk_bf16_f32 v227, v79, v95
  s_add_u32 s78, s86, 131072
  v_permlane16_swap_b32 v221, v223
  buffer_store_dwordx4 v[220:223], v4, s[4:7], s78 offen sc1
  v_cvt_pk_bf16_f32 v229, v80, v96
  v_cvt_pk_bf16_f32 v231, v81, v97
  s_add_u32 s78, s86, 163840
  v_permlane16_swap_b32 v225, v227
  buffer_store_dwordx4 v[224:227], v4, s[4:7], s78 offen sc1
  v_cvt_pk_bf16_f32 v233, v82, v98
  v_cvt_pk_bf16_f32 v235, v83, v99
  s_add_u32 s78, s86, 262144
  v_permlane16_swap_b32 v229, v231
  buffer_store_dwordx4 v[228:231], v4, s[4:7], s78 offen sc1
  v_cvt_pk_bf16_f32 v237, v84, v100
  v_cvt_pk_bf16_f32 v239, v85, v101
  s_add_u32 s78, s86, 294912
  v_permlane16_swap_b32 v233, v235
  buffer_store_dwordx4 v[232:235], v4, s[4:7], s78 offen sc1
  v_cvt_pk_bf16_f32 v241, v86, v102
  v_cvt_pk_bf16_f32 v243, v87, v103
  s_add_u32 s78, s86, 393216
  v_permlane16_swap_b32 v237, v239
  buffer_store_dwordx4 v[236:239], v4, s[4:7], s78 offen sc1
  s_add_u32 s78, s86, 425984
  v_permlane16_swap_b32 v241, v243
  buffer_store_dwordx4 v[240:243], v4, s[4:7], s78 offen sc1
  s_waitcnt vmcnt(22)
  s_branch o_we_205
o_wr0_202:
  s_waitcnt lgkmcnt(0)
  s_barrier
  ds_read_b128 v[104:107], v3 offset:0
  ds_read_b128 v[108:111], v3 offset:512
  ds_read_b128 v[112:115], v3 offset:1024
  s_waitcnt lgkmcnt(2)
  v_mfma_f32_32x32x16_bf16 v[40:55], v[104:107], a[0:3], 0
  v_mfma_f32_32x32x16_bf16 v[56:71], v[104:107], a[4:7], 0
  ds_read_b128 v[116:119], v3 offset:1536
  v_mfma_f32_32x32x16_bf16 v[72:87], v[104:107], a[8:11], 0
  v_mfma_f32_32x32x16_bf16 v[88:103], v[104:107], a[12:15], 0
  s_waitcnt lgkmcnt(2)
  v_mfma_f32_32x32x16_bf16 v[40:55], v[108:111], a[16:19], v[40:55]
  v_mfma_f32_32x32x16_bf16 v[56:71], v[108:111], a[20:23], v[56:71]
  ds_read_b128 v[104:107], v3 offset:2048
  v_mfma_f32_32x32x16_bf16 v[72:87], v[108:111], a[24:27], v[72:87]
  v_mfma_f32_32x32x16_bf16 v[88:103], v[108:111], a[28:31], v[88:103]
  s_waitcnt lgkmcnt(2)
  v_mfma_f32_32x32x16_bf16 v[40:55], v[112:115], a[32:35], v[40:55]
  v_mfma_f32_32x32x16_bf16 v[56:71], v[112:115], a[36:39], v[56:71]
  ds_read_b128 v[108:111], v3 offset:2560
  v_mfma_f32_32x32x16_bf16 v[72:87], v[112:115], a[40:43], v[72:87]
  v_mfma_f32_32x32x16_bf16 v[88:103], v[112:115], a[44:47], v[88:103]
  s_waitcnt lgkmcnt(2)
  v_mfma_f32_32x32x16_bf16 v[40:55], v[116:119], a[48:51], v[40:55]
  v_mfma_f32_32x32x16_bf16 v[56:71], v[116:119], a[52:55], v[56:71]
  ds_read_b128 v[112:115], v3 offset:3072
  v_mfma_f32_32x32x16_bf16 v[72:87], v[116:119], a[56:59], v[72:87]
  v_mfma_f32_32x32x16_bf16 v[88:103], v[116:119], a[60:63], v[88:103]
  s_waitcnt lgkmcnt(2)
  v_mfma_f32_32x32x16_bf16 v[40:55], v[104:107], a[64:67], v[40:55]
  v_mfma_f32_32x32x16_bf16 v[56:71], v[104:107], a[68:71], v[56:71]
  ds_read_b128 v[116:119], v3 offset:3584
  v_mfma_f32_32x32x16_bf16 v[72:87], v[104:107], a[72:75], v[72:87]
  v_mfma_f32_32x32x16_bf16 v[88:103], v[104:107], a[76:79], v[88:103]
  s_waitcnt lgkmcnt(2)
  v_mfma_f32_32x32x16_bf16 v[40:55], v[108:111], a[80:83], v[40:55]
  v_mfma_f32_32x32x16_bf16 v[56:71], v[108:111], a[84:87], v[56:71]
  ds_read_b128 v[104:107], v3 offset:8192
  v_mfma_f32_32x32x16_bf16 v[72:87], v[108:111], a[88:91], v[72:87]
  v_mfma_f32_32x32x16_bf16 v[88:103], v[108:111], a[92:95], v[88:103]
  s_waitcnt lgkmcnt(2)
  v_mfma_f32_32x32x16_bf16 v[40:55], v[112:115], a[96:99], v[40:55]
  v_mfma_f32_32x32x16_bf16 v[56:71], v[112:115], a[100:103], v[56:71]
  ds_read_b128 v[108:111], v3 offset:8704
  v_mfma_f32_32x32x16_bf16 v[72:87], v[112:115], a[104:107], v[72:87]
  v_mfma_f32_32x32x16_bf16 v[88:103], v[112:115], a[108:111], v[88:103]
  s_waitcnt lgkmcnt(2)
  v_mfma_f32_32x32x16_bf16 v[40:55], v[116:119], a[112:115], v[40:55]
  v_mfma_f32_32x32x16_bf16 v[56:71], v[116:119], a[116:119], v[56:71]
  ds_read_b128 v[112:115], v3 offset:9216
  v_mfma_f32_32x32x16_bf16 v[72:87], v[116:119], a[120:123], v[72:87]
  v_mfma_f32_32x32x16_bf16 v[88:103], v[116:119], a[124:127], v[88:103]
  s_waitcnt lgkmcnt(2)
  v_mfma_f32_32x32x16_bf16 v[40:55], v[104:107], a[128:131], v[40:55]
  v_mfma_f32_32x32x16_bf16 v[56:71], v[104:107], a[132:135], v[56:71]
  ds_read_b128 v[116:119], v3 offset:9728
  v_mfma_f32_32x32x16_bf16 v[72:87], v[104:107], a[136:139], v[72:87]
  v_mfma_f32_32x32x16_bf16 v[88:103], v[104:107], a[140:143], v[88:103]
  s_waitcnt lgkmcnt(2)
  v_mfma_f32_32x32x16_bf16 v[40:55], v[108:111], a[144:147], v[40:55]
  v_mfma_f32_32x32x16_bf16 v[56:71], v[108:111], a[148:151], v[56:71]
  ds_read_b128 v[104:107], v3 offset:10240
  v_mfma_f32_32x32x16_bf16 v[72:87], v[108:111], a[152:155], v[72:87]
  v_mfma_f32_32x32x16_bf16 v[88:103], v[108:111], a[156:159], v[88:103]
  s_waitcnt lgkmcnt(2)
  v_mfma_f32_32x32x16_bf16 v[40:55], v[112:115], a[160:163], v[40:55]
  v_mfma_f32_32x32x16_bf16 v[56:71], v[112:115], a[164:167], v[56:71]
  ds_read_b128 v[108:111], v3 offset:10752
  v_mfma_f32_32x32x16_bf16 v[72:87], v[112:115], a[168:171], v[72:87]
  v_mfma_f32_32x32x16_bf16 v[88:103], v[112:115], a[172:175], v[88:103]
  s_waitcnt lgkmcnt(2)
  v_mfma_f32_32x32x16_bf16 v[40:55], v[116:119], a[176:179], v[40:55]
  v_mfma_f32_32x32x16_bf16 v[56:71], v[116:119], a[180:183], v[56:71]
  ds_read_b128 v[112:115], v3 offset:11264
  v_mfma_f32_32x32x16_bf16 v[72:87], v[116:119], a[184:187], v[72:87]
  v_mfma_f32_32x32x16_bf16 v[88:103], v[116:119], a[188:191], v[88:103]
  s_waitcnt lgkmcnt(2)
  v_mfma_f32_32x32x16_bf16 v[40:55], v[104:107], a[192:195], v[40:55]
  v_mfma_f32_32x32x16_bf16 v[56:71], v[104:107], a[196:199], v[56:71]
  ds_read_b128 v[116:119], v3 offset:11776
  s_waitcnt lgkmcnt(2)
  v_mfma_f32_32x32x16_bf16 v[40:55], v[108:111], a[208:211], v[40:55]
  v_mfma_f32_32x32x16_bf16 v[56:71], v[108:111], a[212:215], v[56:71]
  s_waitcnt lgkmcnt(1)
  v_mfma_f32_32x32x16_bf16 v[40:55], v[112:115], a[224:227], v[40:55]
  v_mfma_f32_32x32x16_bf16 v[56:71], v[112:115], a[228:231], v[56:71]
  s_waitcnt lgkmcnt(0)
  v_mfma_f32_32x32x16_bf16 v[40:55], v[116:119], a[240:243], v[40:55]
  v_mfma_f32_32x32x16_bf16 v[56:71], v[116:119], a[244:247], v[56:71]
  v_mfma_f32_32x32x16_bf16 v[72:87], v[104:107], a[200:203], v[72:87]
  v_mfma_f32_32x32x16_bf16 v[88:103], v[104:107], a[204:207], v[88:103]
  v_cvt_pk_bf16_f32 v212, v40, v56
  v_cvt_pk_bf16_f32 v214, v41, v57
  v_cvt_pk_bf16_f32 v216, v42, v58
  v_cvt_pk_bf16_f32 v218, v43, v59
  v_permlane16_swap_b32 v212, v214
  v_mfma_f32_32x32x16_bf16 v[72:87], v[108:111], a[216:219], v[72:87]
  v_cvt_pk_bf16_f32 v220, v44, v60
  v_cvt_pk_bf16_f32 v222, v45, v61
  v_permlane16_swap_b32 v216, v218
  v_bfi_b32 v212, v254, s42, v212
  v_cvt_pk_bf16_f32 v224, v46, v62
  v_mfma_f32_32x32x16_bf16 v[88:103], v[108:111], a[220:223], v[88:103]
  v_cvt_pk_bf16_f32 v226, v47, v63
  v_permlane16_swap_b32 v220, v222
  v_bfi_b32 v216, v254, s42, v216
  v_cvt_pk_bf16_f32 v228, v48, v64
  v_mfma_f32_32x32x16_bf16 v[72:87], v[112:115], a[232:235], v[72:87]
  v_cvt_pk_bf16_f32 v230, v49, v65
  v_permlane16_swap_b32 v224, v226
  v_bfi_b32 v220, v254, s42, v220
  v_cvt_pk_bf16_f32 v232, v50, v66
  v_cvt_pk_bf16_f32 v234, v51, v67
  v_mfma_f32_32x32x16_bf16 v[88:103], v[112:115], a[236:239], v[88:103]
  v_permlane16_swap_b32 v228, v230
  v_bfi_b32 v224, v254, s42, v224
  v_cvt_pk_bf16_f32 v236, v52, v68
  v_cvt_pk_bf16_f32 v238, v53, v69
  v_mfma_f32_32x32x16_bf16 v[72:87], v[116:119], a[248:251], v[72:87]
  v_permlane16_swap_b32 v232, v234
  v_bfi_b32 v228, v254, s42, v228
  v_cvt_pk_bf16_f32 v240, v54, v70
  v_cvt_pk_bf16_f32 v242, v55, v71
  v_permlane16_swap_b32 v236, v238
  v_mfma_f32_32x32x16_bf16 v[88:103], v[116:119], a[252:255], v[88:103]
  v_bfi_b32 v232, v254, s42, v232
  v_permlane16_swap_b32 v240, v242
  v_bfi_b32 v236, v254, s42, v236
  v_bfi_b32 v240, v254, s42, v240
  s_nop 7
  v_cvt_pk_bf16_f32 v213, v72, v88
  v_cvt_pk_bf16_f32 v215, v73, v89
  v_cvt_pk_bf16_f32 v217, v74, v90
  v_cvt_pk_bf16_f32 v219, v75, v91
  s_add_u32 s78, s86, 0
  v_permlane16_swap_b32 v213, v215
  buffer_store_dwordx4 v[212:215], v4, s[4:7], s78 offen sc1
  v_cvt_pk_bf16_f32 v221, v76, v92
  v_cvt_pk_bf16_f32 v223, v77, v93
  s_add_u32 s78, s86, 32768
  v_permlane16_swap_b32 v217, v219
  buffer_store_dwordx4 v[216:219], v4, s[4:7], s78 offen sc1
  v_cvt_pk_bf16_f32 v225, v78, v94
  v_cvt_pk_bf16_f32 v227, v79, v95
  s_add_u32 s78, s86, 131072
  v_permlane16_swap_b32 v221, v223
  buffer_store_dwordx4 v[220:223], v4, s[4:7], s78 offen sc1
  v_cvt_pk_bf16_f32 v229, v80, v96
  v_cvt_pk_bf16_f32 v231, v81, v97
  s_add_u32 s78, s86, 163840
  v_permlane16_swap_b32 v225, v227
  buffer_store_dwordx4 v[224:227], v4, s[4:7], s78 offen sc1
  v_cvt_pk_bf16_f32 v233, v82, v98
  v_cvt_pk_bf16_f32 v235, v83, v99
  s_add_u32 s78, s86, 262144
  v_permlane16_swap_b32 v229, v231
  buffer_store_dwordx4 v[228:231], v4, s[4:7], s78 offen sc1
  v_cvt_pk_bf16_f32 v237, v84, v100
  v_cvt_pk_bf16_f32 v239, v85, v101
  s_add_u32 s78, s86, 294912
  v_permlane16_swap_b32 v233, v235
  buffer_store_dwordx4 v[232:235], v4, s[4:7], s78 offen sc1
  v_cvt_pk_bf16_f32 v241, v86, v102
  v_cvt_pk_bf16_f32 v243, v87, v103
  s_add_u32 s78, s86, 393216
  v_permlane16_swap_b32 v237, v239
  buffer_store_dwordx4 v[236:239], v4, s[4:7], s78 offen sc1
  s_add_u32 s78, s86, 425984
  v_permlane16_swap_b32 v241, v243
  buffer_store_dwordx4 v[240:243], v4, s[4:7], s78 offen sc1
  s_branch o_we_205
o_wr1_203:
  s_nop 3
  v_mul_f32 v112, s24, v112
  v_mul_f32 v113, s24, v113
  v_exp_f32 v64, v112
  v_exp_f32 v65, v113
  v_max_f32 v116, v111, v116
  v_max3_f32 v116, v112, v113, v116
  v_add_f32 v117, v117, v64
  v_add_f32 v118, v118, v65
  v_add_f32 v117, v117, v118
  s_mov_b32 s28, 0x21800000
  v_mov_b32 v118, v117
  s_nop 1
  v_permlane16_swap_b32 v117, v118
  v_add_f32 v117, v117, v118
  v_mov_b32 v118, v117
  s_nop 0
  s_nop 0
  v_permlane32_swap_b32 v117, v118
  v_add_f32 v117, v117, v118
  s_mov_b32 s67, 0
  s_mov_b64 vcc, 0
  s_waitcnt vmcnt(3)
o_pl_211:
  v_and_b32 v7, 1, v7
  v_cmp_ne_u32 vcc, s96, v7
  s_cbranch_vccz o_pk_212
  buffer_load_dword v7, v255, s[4:7], s97 offen sc1
  s_add_u32 s67, s67, 1
  s_cmp_gt_u32 s67, 1048576
  s_cbranch_scc1 L_end
  s_waitcnt vmcnt(0)
  s_branch o_pl_211
o_pk_212:
  s_lshl_b32 s94, s43, 14
  s_add_u32 s94, s94, s95
  buffer_load_dwordx4 v[120:123], v5, s[4:7], s94 offen offset:0 sc1
  v_cmp_lt_f32 vcc, 0x42700000, v116
  v_cmp_gt_f32 s[30:31], s28, v117
  v_rcp_f32 v117, v117
  buffer_load_dwordx4 v[124:127], v5, s[4:7], s94 offen offset:512 sc1
  s_or_b64 vcc, vcc, s[30:31]
  s_cbranch_vccnz o_fb_209
o_fbr_210:
  buffer_load_dwordx4 v[128:131], v5, s[4:7], s94 offen offset:256 sc1
  v_pk_mul_f32 v[56:57], v[56:57], v[116:117] op_sel:[0,1] op_sel_hi:[1,1]
  v_pk_mul_f32 v[58:59], v[58:59], v[116:117] op_sel:[0,1] op_sel_hi:[1,1]
  v_pk_mul_f32 v[60:61], v[60:61], v[116:117] op_sel:[0,1] op_sel_hi:[1,1]
  v_pk_mul_f32 v[62:63], v[62:63], v[116:117] op_sel:[0,1] op_sel_hi:[1,1]
  v_pk_mul_f32 v[64:65], v[64:65], v[116:117] op_sel:[0,1] op_sel_hi:[1,1]
  buffer_load_dwordx4 v[132:135], v5, s[4:7], s94 offen offset:768 sc1
  v_cvt_pk_bf16_f32 v116, v56, v57
  v_cvt_pk_bf16_f32 v117, v58, v59
  v_cvt_pk_bf16_f32 v118, v60, v61
  v_cvt_pk_bf16_f32 v119, v62, v63
  s_waitcnt lgkmcnt(0)
  s_nop 0
  v_mfma_f32_16x16x32_bf16 v[72:75], v[152:155], v[116:119], 0
  s_add_u32 s62, s62, 1
  v_cvt_pk_bf16_f32 v197, v64, v65
  v_cvt_pk_bf16_f32 v198, v64, v65
  v_mfma_f32_16x16x32_bf16 v[76:79], v[156:159], v[116:119], 0
  s_add_u32 s94, s94, 4096
  buffer_load_dwordx4 v[136:139], v5, s[4:7], s94 offen offset:0 sc1
  s_xor_b32 s86, s86, 524288
  v_mfma_f32_16x16x32_bf16 v[80:83], v[160:163], v[116:119], 0
  s_bfe_u32 s42, s62, 0x10001
  v_mfma_f32_16x16x32_bf16 v[84:87], v[164:167], v[116:119], 0
  buffer_load_dwordx4 v[140:143], v5, s[4:7], s94 offen offset:512 sc1
  v_mfma_f32_16x16x32_bf16 v[88:91], v[168:171], v[116:119], 0
  v_mfma_f32_16x16x32_bf16 v[92:95], v[172:175], v[116:119], 0
  buffer_load_dwordx4 v[144:147], v5, s[4:7], s94 offen offset:256 sc1
  v_mfma_f32_16x16x32_bf16 v[96:99], v[176:179], v[116:119], 0
  v_mfma_f32_16x16x32_bf16 v[100:103], v[180:183], v[116:119], 0
  buffer_load_dwordx4 v[148:151], v5, s[4:7], s94 offen offset:768 sc1
  v_mfma_f32_16x16x16_bf16 v[72:75], v[200:201], v[198:199], v[72:75]
  s_nop 1
  v_mfma_f32_16x16x16_bf16 v[76:79], v[200:201], v[196:197], v[76:79]
  s_add_u32 s94, s94, 4096
  buffer_load_dwordx4 v[152:155], v5, s[4:7], s94 offen offset:0 sc1
  v_mfma_f32_16x16x16_bf16 v[80:83], v[202:203], v[198:199], v[80:83]
  s_nop 1
  v_mfma_f32_16x16x16_bf16 v[84:87], v[202:203], v[196:197], v[84:87]
  buffer_load_dwordx4 v[156:159], v5, s[4:7], s94 offen offset:512 sc1
  v_mfma_f32_16x16x16_bf16 v[88:91], v[204:205], v[198:199], v[88:91]
  s_nop 0
  v_cvt_pk_bf16_f32 v40, v72, v73
  v_cvt_pk_bf16_f32 v41, v74, v75
  v_mfma_f32_16x16x16_bf16 v[92:95], v[204:205], v[196:197], v[92:95]
  buffer_load_dwordx4 v[160:163], v5, s[4:7], s94 offen offset:256 sc1
  v_cvt_pk_bf16_f32 v42, v76, v77
  v_cvt_pk_bf16_f32 v43, v78, v79
  v_mfma_f32_16x16x16_bf16 v[96:99], v[206:207], v[198:199], v[96:99]
  s_nop 0
  ds_write_b128 v6, v[40:43] offset:0
  v_cvt_pk_bf16_f32 v44, v80, v81
  v_mfma_f32_16x16x16_bf16 v[100:103], v[206:207], v[196:197], v[100:103]
  buffer_load_dwordx4 v[164:167], v5, s[4:7], s94 offen offset:768 sc1
  v_cvt_pk_bf16_f32 v45, v82, v83
  v_cvt_pk_bf16_f32 v46, v84, v85
  v_cvt_pk_bf16_f32 v47, v86, v87
  ds_write_b128 v6, v[44:47] offset:1024
  v_cvt_pk_bf16_f32 v48, v88, v89
  v_cvt_pk_bf16_f32 v49, v90, v91
  v_cvt_pk_bf16_f32 v50, v92, v93
  v_cvt_pk_bf16_f32 v51, v94, v95
  s_add_u32 s94, s94, 4096
  buffer_load_dwordx4 v[168:171], v5, s[4:7], s94 offen offset:0 sc1
  ds_write_b128 v6, v[48:51] offset:2048
  v_cvt_pk_bf16_f32 v52, v96, v97
  v_cvt_pk_bf16_f32 v53, v98, v99
  v_cvt_pk_bf16_f32 v54, v100, v101
  v_cvt_pk_bf16_f32 v55, v102, v103
  ds_write_b128 v6, v[52:55] offset:3072
  buffer_load_dwordx4 v[172:175], v5, s[4:7], s94 offen offset:512 sc1
  s_and_b32 s26, s65, 49152
  s_cbranch_scc1 o_wr2_204
  s_waitcnt lgkmcnt(0)
  s_barrier
  ds_read_b128 v[104:107], v3 offset:0
  ds_read_b128 v[108:111], v3 offset:512
  ds_read_b128 v[112:115], v3 offset:1024
  buffer_load_dwordx4 v[176:179], v5, s[4:7], s94 offen offset:256 sc1
  buffer_load_dwordx4 v[180:183], v5, s[4:7], s94 offen offset:768 sc1
  s_waitcnt lgkmcnt(2)
  v_mfma_f32_32x32x16_bf16 v[40:55], v[104:107], a[0:3], 0
  v_mov_b64 v[188:189], 0
  v_mov_b64 v[190:191], 0
  v_mov_b64 v[192:193], 0
  v_mov_b64 v[194:195], 0
  s_mov_b64 exec, 1
  buffer_store_dword v38, off, s[4:7], s84 sc1
  s_mov_b64 exec, -1
  s_mov_b32 s84, 268435456
  v_mfma_f32_32x32x16_bf16 v[56:71], v[104:107], a[4:7], 0
  ds_read_b128 v[116:119], v3 offset:1536
  v_mfma_f32_32x32x16_bf16 v[72:87], v[104:107], a[8:11], 0
  v_mfma_f32_32x32x16_bf16 v[88:103], v[104:107], a[12:15], 0
  s_waitcnt vmcnt(13)
  v_xor_b32 v7, s96, v120
  v_bitop3_b32 v7, v7, v124, s96 bitop3:0xf6
  v_bitop3_b32 v7, v7, v128, s96 bitop3:0xf6
  v_bitop3_b32 v7, v7, v132, s96 bitop3:0xf6
  s_waitcnt lgkmcnt(2)
  v_mfma_f32_32x32x16_bf16 v[40:55], v[108:111], a[16:19], v[40:55]
  s_waitcnt vmcnt(9)
  v_bitop3_b32 v7, v7, v136, s96 bitop3:0xf6
  v_bitop3_b32 v7, v7, v140, s96 bitop3:0xf6
  v_bitop3_b32 v7, v7, v144, s96 bitop3:0xf6
  v_bitop3_b32 v7, v7, v148, s96 bitop3:0xf6
  s_waitcnt vmcnt(5)
  v_mfma_f32_32x32x16_bf16 v[56:71], v[108:111], a[20:23], v[56:71]
  ds_read_b128 v[104:107], v3 offset:2048
  v_bitop3_b32 v7, v7, v152, s96 bitop3:0xf6
  v_bitop3_b32 v7, v7, v156, s96 bitop3:0xf6
  v_bitop3_b32 v7, v7, v160, s96 bitop3:0xf6
  v_bitop3_b32 v7, v7, v164, s96 bitop3:0xf6
  s_waitcnt vmcnt(1)
  v_mfma_f32_32x32x16_bf16 v[72:87], v[108:111], a[24:27], v[72:87]
  v_bitop3_b32 v7, v7, v168, s96 bitop3:0xf6
  v_bitop3_b32 v7, v7, v172, s96 bitop3:0xf6
  v_bitop3_b32 v7, v7, v176, s96 bitop3:0xf6
  v_bitop3_b32 v7, v7, v180, s96 bitop3:0xf6
  v_and_b32 v7, v254, v7
  v_cmp_ne_u32 vcc, 0, v7
  s_cbranch_vccnz o_rt_213
o_bk_214:
  v_mfma_f32_32x32x16_bf16 v[88:103], v[108:111], a[28:31], v[88:103]
  v_smfmac_f32_16x16x64_bf16 v[188:191], v[16:19], v[120:127], v20
  v_lshlrev_b32 v196, 16, v184
  v_smfmac_f32_16x16x64_bf16 v[192:195], v[16:19], v[128:135], v20
  v_and_b32 v197, 0xffff0000, v184
  v_smfmac_f32_16x16x64_bf16 v[188:191], v[16:19], v[136:143], v20
  v_lshlrev_b32 v198, 16, v185
  s_waitcnt lgkmcnt(2)
  v_mfma_f32_32x32x16_bf16 v[40:55], v[112:115], a[32:35], v[40:55]
  v_smfmac_f32_16x16x64_bf16 v[192:195], v[16:19], v[144:151], v20
  v_and_b32 v199, 0xffff0000, v185
  v_smfmac_f32_16x16x64_bf16 v[188:191], v[16:19], v[152:159], v20
  v_lshlrev_b32 v200, 16, v186
  v_smfmac_f32_16x16x64_bf16 v[192:195], v[16:19], v[160:167], v20
  v_and_b32 v201, 0xffff0000, v186
  v_mfma_f32_32x32x16_bf16 v[56:71], v[112:115], a[36:39], v[56:71]
  ds_read_b128 v[108:111], v3 offset:2560
  v_smfmac_f32_16x16x64_bf16 v[188:191], v[16:19], v[168:175], v20
  v_lshlrev_b32 v202, 16, v187
  v_smfmac_f32_16x16x64_bf16 v[192:195], v[16:19], v[176:183], v20
  v_and_b32 v203, 0xffff0000, v187
  s_bfe_u32 s92, s65, 131086
  v_mfma_f32_32x32x16_bf16 v[72:87], v[112:115], a[40:43], v[72:87]
  s_lshl_b32 s92, s92, 21
  s_add_u32 s92, s92, s91
  s_add_u32 s93, s92, 27262976
  s_add_u32 s92, s92, 20971520
  v_permlane16_swap_b32 v188, v192
  v_mfma_f32_32x32x16_bf16 v[88:103], v[112:115], a[44:47], v[88:103]
  v_permlane16_swap_b32 v189, v193
  v_permlane16_swap_b32 v190, v194
  v_permlane16_swap_b32 v191, v195
  s_waitcnt lgkmcnt(2)
  v_mfma_f32_32x32x16_bf16 v[40:55], v[116:119], a[48:51], v[40:55]
  v_cvt_pk_bf16_f32 v188, 0, v188
  v_cvt_pk_bf16_f32 v189, 0, v189
  v_cvt_pk_bf16_f32 v190, 0, v190
  v_cvt_pk_bf16_f32 v191, 0, v191
  v_cvt_pk_bf16_f32 v192, 0, v192
  v_cvt_pk_bf16_f32 v193, 0, v193
  v_mfma_f32_32x32x16_bf16 v[56:71], v[116:119], a[52:55], v[56:71]
  ds_read_b128 v[112:115], v3 offset:3072
  v_cvt_pk_bf16_f32 v194, 0, v194
  v_cvt_pk_bf16_f32 v195, 0, v195
  v_add_f32 v196, v196, v188
  v_add_f32 v197, v197, v189
  v_add_f32 v198, v198, v190
  v_mfma_f32_32x32x16_bf16 v[72:87], v[116:119], a[56:59], v[72:87]
  v_add_f32 v199, v199, v191
  v_add_f32 v200, v200, v192
  v_add_f32 v201, v201, v193
  v_add_f32 v202, v202, v194
  v_add_f32 v203, v203, v195
  v_cvt_pk_bf16_f32 v120, v196, v197
  v_mfma_f32_32x32x16_bf16 v[88:103], v[116:119], a[60:63], v[88:103]
  v_cvt_pk_bf16_f32 v121, v198, v199
  v_cvt_pk_bf16_f32 v122, v200, v201
  v_cvt_pk_bf16_f32 v123, v202, v203
  v_lshlrev_b32 v196, 16, v120
  v_and_b32 v197, 0xffff0000, v120
  s_waitcnt lgkmcnt(2)
  v_mfma_f32_32x32x16_bf16 v[40:55], v[104:107], a[64:67], v[40:55]
  v_lshlrev_b32 v198, 16, v121
  v_and_b32 v199, 0xffff0000, v121
  v_lshlrev_b32 v200, 16, v122
  v_and_b32 v201, 0xffff0000, v122
  v_lshlrev_b32 v202, 16, v123
  v_and_b32 v203, 0xffff0000, v123
  v_mfma_f32_32x32x16_bf16 v[56:71], v[104:107], a[68:71], v[56:71]
  ds_read_b128 v[116:119], v3 offset:3584
  buffer_store_dwordx4 v[120:123], v0, s[4:7], s92 offen sc1
  v_add_f32 v136, v196, v197
  v_mul_f32 v137, v196, v196
  v_mfma_f32_32x32x16_bf16 v[72:87], v[104:107], a[72:75], v[72:87]
  v_add_f32 v138, v198, v199
  v_mul_f32 v139, v197, v197
  v_fmac_f32 v137, v198, v198
  v_fmac_f32 v139, v199, v199
  v_add_f32 v136, v136, v200
  v_fmac_f32 v137, v200, v200
  v_mfma_f32_32x32x16_bf16 v[88:103], v[104:107], a[76:79], v[88:103]
  v_add_f32 v138, v138, v201
  v_fmac_f32 v139, v201, v201
  v_add_f32 v136, v136, v202
  v_fmac_f32 v137, v202, v202
  v_add_f32 v138, v138, v203
  s_waitcnt lgkmcnt(2)
  v_mfma_f32_32x32x16_bf16 v[40:55], v[108:111], a[80:83], v[40:55]
  v_fmac_f32 v139, v203, v203
  v_add_f32 v136, v136, v138
  v_add_f32 v137, v137, v139
  s_nop 0
  v_add_f32_dpp v136, v136, v136 row_ror:8 row_mask:0xf bank_mask:0xf
  v_add_f32_dpp v137, v137, v137 row_ror:8 row_mask:0xf bank_mask:0xf
  s_nop 0
  v_add_f32_dpp v136, v136, v136 row_ror:4 row_mask:0xf bank_mask:0xf
  v_mfma_f32_32x32x16_bf16 v[56:71], v[108:111], a[84:87], v[56:71]
  ds_read_b128 v[104:107], v3 offset:8192
  v_add_f32_dpp v137, v137, v137 row_ror:4 row_mask:0xf bank_mask:0xf
  v_add_f32_dpp v136, v136, v136 row_ror:2 row_mask:0xf bank_mask:0xf
  s_nop 0
  v_add_f32_dpp v137, v137, v137 row_ror:2 row_mask:0xf bank_mask:0xf
  v_add_f32_dpp v136, v136, v136 row_ror:1 row_mask:0xf bank_mask:0xf
  s_nop 0
  v_add_f32_dpp v137, v137, v137 row_ror:1 row_mask:0xf bank_mask:0xf
  v_mfma_f32_32x32x16_bf16 v[72:87], v[108:111], a[88:91], v[72:87]
  v_mov_b32 v140, v136
  v_mov_b32 v141, v137
  s_nop 0
  v_permlane16_swap_b32 v136, v140
  v_permlane16_swap_b32 v137, v141
  v_mfma_f32_32x32x16_bf16 v[88:103], v[108:111], a[92:95], v[88:103]
  v_add_f32 v136, v136, v140
  v_add_f32 v137, v137, v141
  v_mov_b32 v140, v136
  v_mov_b32 v141, v137
  s_nop 0
  v_permlane32_swap_b32 v136, v140
  s_waitcnt lgkmcnt(2)
  v_mfma_f32_32x32x16_bf16 v[40:55], v[112:115], a[96:99], v[40:55]
  v_permlane32_swap_b32 v137, v141
  v_add_f32 v136, v136, v140
  v_add_f32 v137, v137, v141
  v_mul_f32 v136, 0x3b000000, v136
  v_mul_f32 v137, 0x3b000000, v137
  v_mfma_f32_32x32x16_bf16 v[56:71], v[112:115], a[100:103], v[56:71]
  ds_read_b128 v[108:111], v3 offset:8704
  v_fma_f32 v137, -v136, v136, v137
  v_cvt_pk_bf16_f32 v136, 0, v136
  v_max_f32 v137, 0, v137
  v_sub_f32 v140, v196, v136
  v_sub_f32 v141, v197, v136
  v_mfma_f32_32x32x16_bf16 v[72:87], v[112:115], a[104:107], v[72:87]
  v_cvt_pk_bf16_f32 v137, 0, v137
  v_sub_f32 v142, v198, v136
  v_sub_f32 v143, v199, v136
  v_add_f32 v137, 0x3727c5ac, v137
  v_sub_f32 v144, v200, v136
  v_sub_f32 v145, v201, v136
  v_mfma_f32_32x32x16_bf16 v[88:103], v[112:115], a[108:111], v[88:103]
  v_cvt_pk_bf16_f32 v137, 0, v137
  v_sub_f32 v146, v202, v136
  v_sub_f32 v147, v203, v136
  v_sqrt_f32 v137, v137
  s_waitcnt lgkmcnt(2)
  v_mfma_f32_32x32x16_bf16 v[40:55], v[116:119], a[112:115], v[40:55]
  v_cvt_pk_bf16_f32 v140, 0, v140
  v_cvt_pk_bf16_f32 v141, 0, v141
  v_cvt_pk_bf16_f32 v137, 0, v137
  v_cvt_pk_bf16_f32 v142, 0, v142
  v_cvt_pk_bf16_f32 v143, 0, v143
  v_rcp_f32 v137, v137
  v_mfma_f32_32x32x16_bf16 v[56:71], v[116:119], a[116:119], v[56:71]
  ds_read_b128 v[112:115], v3 offset:9216
  v_cvt_pk_bf16_f32 v144, 0, v144
  v_cvt_pk_bf16_f32 v145, 0, v145
  v_cvt_pk_bf16_f32 v146, 0, v146
  v_cvt_pk_bf16_f32 v147, 0, v147
  v_mul_f32 v140, v140, v137
  v_mfma_f32_32x32x16_bf16 v[72:87], v[116:119], a[120:123], v[72:87]
  v_mul_f32 v141, v141, v137
  v_mul_f32 v142, v142, v137
  v_mul_f32 v143, v143, v137
  v_mul_f32 v144, v144, v137
  v_mul_f32 v145, v145, v137
  v_mul_f32 v146, v146, v137
  v_mfma_f32_32x32x16_bf16 v[88:103], v[116:119], a[124:127], v[88:103]
  v_mul_f32 v147, v147, v137
  v_cvt_pk_bf16_f32 v124, v140, v141
  v_cvt_pk_bf16_f32 v125, v142, v143
  v_cvt_pk_bf16_f32 v126, v144, v145
  v_cvt_pk_bf16_f32 v127, v146, v147
  s_waitcnt lgkmcnt(2)
  v_mfma_f32_32x32x16_bf16 v[40:55], v[104:107], a[128:131], v[40:55]
  v_lshlrev_b32 v204, 16, v124
  v_and_b32 v205, 0xffff0000, v124
  v_lshlrev_b32 v206, 16, v125
  v_and_b32 v207, 0xffff0000, v125
  v_lshlrev_b32 v208, 16, v126
  v_and_b32 v209, 0xffff0000, v126
  v_mfma_f32_32x32x16_bf16 v[56:71], v[104:107], a[132:135], v[56:71]
  ds_read_b128 v[116:119], v3 offset:9728
  v_lshlrev_b32 v210, 16, v127
  v_and_b32 v211, 0xffff0000, v127
  buffer_store_dwordx4 v[124:127], v0, s[4:7], s93 offen sc1
  v_mfma_f32_32x32x16_bf16 v[72:87], v[104:107], a[136:139], v[72:87]
  v_add_f32 v196, v196, v204
  v_add_f32 v197, v197, v205
  v_add_f32 v198, v198, v206
  v_add_f32 v199, v199, v207
  v_add_f32 v200, v200, v208
  v_add_f32 v201, v201, v209
  v_mfma_f32_32x32x16_bf16 v[88:103], v[104:107], a[140:143], v[88:103]
  v_add_f32 v202, v202, v210
  v_add_f32 v203, v203, v211
  v_cvt_pk_bf16_f32 v128, v196, v197
  v_cvt_pk_bf16_f32 v129, v198, v199
  v_cvt_pk_bf16_f32 v130, v200, v201
  s_waitcnt lgkmcnt(2)
  v_mfma_f32_32x32x16_bf16 v[40:55], v[108:111], a[144:147], v[40:55]
  v_cvt_pk_bf16_f32 v131, v202, v203
  v_mul_f32 v188, v204, v8
  v_mul_f32 v189, v205, v9
  v_fmac_f32 v188, v206, v10
  v_fmac_f32 v189, v207, v11
  v_fmac_f32 v188, v208, v12
  v_mfma_f32_32x32x16_bf16 v[56:71], v[108:111], a[148:151], v[56:71]
  ds_read_b128 v[104:107], v3 offset:10240
  v_fmac_f32 v189, v209, v13
  v_fmac_f32 v188, v210, v14
  v_fmac_f32 v189, v211, v15
  v_add_f32 v188, v188, v189
  s_add_u32 s92, s91, 10485760
  v_mfma_f32_32x32x16_bf16 v[72:87], v[108:111], a[152:155], v[72:87]
  s_add_u32 s93, s91, 8388608
  buffer_store_dwordx4 v[128:131], v0, s[4:7], s92 offen sc1
  v_lshlrev_b32 v196, 16, v128
  v_and_b32 v197, 0xffff0000, v128
  v_mfma_f32_32x32x16_bf16 v[88:103], v[108:111], a[156:159], v[88:103]
  v_lshlrev_b32 v198, 16, v129
  v_and_b32 v199, 0xffff0000, v129
  v_lshlrev_b32 v200, 16, v130
  v_and_b32 v201, 0xffff0000, v130
  v_lshlrev_b32 v202, 16, v131
  s_waitcnt lgkmcnt(2)
  v_mfma_f32_32x32x16_bf16 v[40:55], v[112:115], a[160:163], v[40:55]
  v_and_b32 v203, 0xffff0000, v131
  v_add_f32 v136, v196, v197
  v_mul_f32 v137, v196, v196
  v_add_f32 v138, v198, v199
  v_mul_f32 v139, v197, v197
  v_fmac_f32 v137, v198, v198
  v_mfma_f32_32x32x16_bf16 v[56:71], v[112:115], a[164:167], v[56:71]
  ds_read_b128 v[108:111], v3 offset:10752
  v_fmac_f32 v139, v199, v199
  v_add_f32 v136, v136, v200
  v_fmac_f32 v137, v200, v200
  v_add_f32 v138, v138, v201
  v_fmac_f32 v139, v201, v201
  v_mfma_f32_32x32x16_bf16 v[72:87], v[112:115], a[168:171], v[72:87]
  v_add_f32 v136, v136, v202
  v_fmac_f32 v137, v202, v202
  v_add_f32 v138, v138, v203
  v_fmac_f32 v139, v203, v203
  v_add_f32 v136, v136, v138
  v_add_f32 v137, v137, v139
  v_mfma_f32_32x32x16_bf16 v[88:103], v[112:115], a[172:175], v[88:103]
  v_add_f32_dpp v136, v136, v136 row_ror:8 row_mask:0xf bank_mask:0xf
  v_add_f32_dpp v137, v137, v137 row_ror:8 row_mask:0xf bank_mask:0xf
  v_add_f32_dpp v188, v188, v188 row_ror:8 row_mask:0xf bank_mask:0xf
  v_add_f32_dpp v136, v136, v136 row_ror:4 row_mask:0xf bank_mask:0xf
  v_add_f32_dpp v137, v137, v137 row_ror:4 row_mask:0xf bank_mask:0xf
  s_waitcnt lgkmcnt(2)
  v_mfma_f32_32x32x16_bf16 v[40:55], v[116:119], a[176:179], v[40:55]
  v_add_f32_dpp v188, v188, v188 row_ror:4 row_mask:0xf bank_mask:0xf
  v_add_f32_dpp v136, v136, v136 row_ror:2 row_mask:0xf bank_mask:0xf
  v_add_f32_dpp v137, v137, v137 row_ror:2 row_mask:0xf bank_mask:0xf
  v_add_f32_dpp v188, v188, v188 row_ror:2 row_mask:0xf bank_mask:0xf
  v_add_f32_dpp v136, v136, v136 row_ror:1 row_mask:0xf bank_mask:0xf
  v_add_f32_dpp v137, v137, v137 row_ror:1 row_mask:0xf bank_mask:0xf
  v_mfma_f32_32x32x16_bf16 v[56:71], v[116:119], a[180:183], v[56:71]
  ds_read_b128 v[112:115], v3 offset:11264
  v_add_f32_dpp v188, v188, v188 row_ror:1 row_mask:0xf bank_mask:0xf
  v_mov_b32 v140, v136
  v_mov_b32 v141, v137
  v_mov_b32 v142, v188
  v_permlane16_swap_b32 v136, v140
  v_mfma_f32_32x32x16_bf16 v[72:87], v[116:119], a[184:187], v[72:87]
  v_permlane16_swap_b32 v137, v141
  v_permlane16_swap_b32 v188, v142
  v_add_f32 v136, v136, v140
  v_add_f32 v137, v137, v141
  v_mfma_f32_32x32x16_bf16 v[88:103], v[116:119], a[188:191], v[88:103]
  v_add_f32 v188, v188, v142
  v_mov_b32 v140, v136
  v_mov_b32 v141, v137
  v_mov_b32 v142, v188
  v_permlane32_swap_b32 v136, v140
  s_waitcnt lgkmcnt(2)
  v_mfma_f32_32x32x16_bf16 v[40:55], v[104:107], a[192:195], v[40:55]
  v_permlane32_swap_b32 v137, v141
  v_permlane32_swap_b32 v188, v142
  v_add_f32 v136, v136, v140
  v_add_f32 v137, v137, v141
  v_mfma_f32_32x32x16_bf16 v[56:71], v[104:107], a[196:199], v[56:71]
  ds_read_b128 v[116:119], v3 offset:11776
  v_add_f32 v188, v188, v142
  v_mul_f32 v136, 0x3b000000, v136
  v_mul_f32 v137, 0x3b000000, v137
  v_fma_f32 v137, -v136, v136, v137
  v_cvt_pk_bf16_f32 v136, 0, v136
  s_waitcnt lgkmcnt(2)
  v_mfma_f32_32x32x16_bf16 v[40:55], v[108:111], a[208:211], v[40:55]
  v_max_f32 v137, 0, v137
  v_sub_f32 v140, v196, v136
  v_sub_f32 v141, v197, v136
  v_cvt_pk_bf16_f32 v137, 0, v137
  v_sub_f32 v142, v198, v136
  v_sub_f32 v143, v199, v136
  v_mfma_f32_32x32x16_bf16 v[56:71], v[108:111], a[212:215], v[56:71]
  v_add_f32 v137, 0x3727c5ac, v137
  v_sub_f32 v144, v200, v136
  v_sub_f32 v145, v201, v136
  v_cvt_pk_bf16_f32 v137, 0, v137
  v_sub_f32 v146, v202, v136
  v_sub_f32 v147, v203, v136
  s_waitcnt lgkmcnt(1)
  v_mfma_f32_32x32x16_bf16 v[40:55], v[112:115], a[224:227], v[40:55]
  v_sqrt_f32 v137, v137
  v_cvt_pk_bf16_f32 v140, 0, v140
  v_cvt_pk_bf16_f32 v141, 0, v141
  v_cvt_pk_bf16_f32 v137, 0, v137
  v_cvt_pk_bf16_f32 v142, 0, v142
  v_mfma_f32_32x32x16_bf16 v[56:71], v[112:115], a[228:231], v[56:71]
  v_cvt_pk_bf16_f32 v143, 0, v143
  v_rcp_f32 v137, v137
  v_cvt_pk_bf16_f32 v144, 0, v144
  v_cvt_pk_bf16_f32 v145, 0, v145
  v_cvt_pk_bf16_f32 v146, 0, v146
  s_waitcnt lgkmcnt(0)
  v_mfma_f32_32x32x16_bf16 v[40:55], v[116:119], a[240:243], v[40:55]
  v_cvt_pk_bf16_f32 v147, 0, v147
  v_mul_f32 v140, v140, v137
  v_mul_f32 v141, v141, v137
  v_mul_f32 v142, v142, v137
  v_mul_f32 v143, v143, v137
  v_mul_f32 v144, v144, v137
  v_mfma_f32_32x32x16_bf16 v[56:71], v[116:119], a[244:247], v[56:71]
  v_mul_f32 v145, v145, v137
  v_mul_f32 v146, v146, v137
  v_mul_f32 v147, v147, v137
  v_cvt_pk_bf16_f32 v132, v140, v141
  v_cvt_pk_bf16_f32 v133, v142, v143
  v_cvt_pk_bf16_f32 v134, v144, v145
  v_mfma_f32_32x32x16_bf16 v[72:87], v[104:107], a[200:203], v[72:87]
  v_cvt_pk_bf16_f32 v135, v146, v147
  buffer_store_dwordx4 v[132:135], v0, s[4:7], s93 offen sc1
  v_cvt_pk_bf16_f32 v188, 0, v188
  v_ashrrev_i32 v189, 31, v188
  v_mfma_f32_32x32x16_bf16 v[88:103], v[104:107], a[204:207], v[88:103]
  v_or_b32 v189, 0x80000000, v189
  v_xor_b32 v188, v188, v189
  s_sub_u32 s92, 4095, s90
  v_and_b32 v188, 0xffff0000, v188
  v_or_b32 v38, s92, v188
  v_mfma_f32_32x32x16_bf16 v[72:87], v[108:111], a[216:219], v[72:87]
  s_bfe_u32 s92, s65, 196625
  s_lshl_b32 s92, s92, 18
  s_lshl_b32 s93, s90, 7
  s_add_u32 s92, s92, s93
  s_add_u32 s84, s92, 243269632
  v_cvt_pk_bf16_f32 v212, v40, v56
  v_mfma_f32_32x32x16_bf16 v[88:103], v[108:111], a[220:223], v[88:103]
  v_cvt_pk_bf16_f32 v214, v41, v57
  v_cvt_pk_bf16_f32 v216, v42, v58
  v_cvt_pk_bf16_f32 v218, v43, v59
  v_permlane16_swap_b32 v212, v214
  v_mfma_f32_32x32x16_bf16 v[72:87], v[112:115], a[232:235], v[72:87]
  v_cvt_pk_bf16_f32 v220, v44, v60
  v_cvt_pk_bf16_f32 v222, v45, v61
  v_permlane16_swap_b32 v216, v218
  v_bfi_b32 v212, v254, s42, v212
  v_cvt_pk_bf16_f32 v224, v46, v62
  v_mfma_f32_32x32x16_bf16 v[88:103], v[112:115], a[236:239], v[88:103]
  v_cvt_pk_bf16_f32 v226, v47, v63
  v_permlane16_swap_b32 v220, v222
  v_bfi_b32 v216, v254, s42, v216
  v_cvt_pk_bf16_f32 v228, v48, v64
  v_mfma_f32_32x32x16_bf16 v[72:87], v[116:119], a[248:251], v[72:87]
  v_cvt_pk_bf16_f32 v230, v49, v65
  v_permlane16_swap_b32 v224, v226
  v_bfi_b32 v220, v254, s42, v220
  v_cvt_pk_bf16_f32 v232, v50, v66
  v_cvt_pk_bf16_f32 v234, v51, v67
  v_mfma_f32_32x32x16_bf16 v[88:103], v[116:119], a[252:255], v[88:103]
  v_permlane16_swap_b32 v228, v230
  v_bfi_b32 v224, v254, s42, v224
  v_cvt_pk_bf16_f32 v236, v52, v68
  v_cvt_pk_bf16_f32 v238, v53, v69
  v_permlane16_swap_b32 v232, v234
  v_bfi_b32 v228, v254, s42, v228
  v_cvt_pk_bf16_f32 v240, v54, v70
  v_cvt_pk_bf16_f32 v242, v55, v71
  v_permlane16_swap_b32 v236, v238
  v_bfi_b32 v232, v254, s42, v232
  v_permlane16_swap_b32 v240, v242
  v_bfi_b32 v236, v254, s42, v236
  v_bfi_b32 v240, v254, s42, v240
  v_cvt_pk_bf16_f32 v213, v72, v88
  v_cvt_pk_bf16_f32 v215, v73, v89
  v_cvt_pk_bf16_f32 v217, v74, v90
  v_cvt_pk_bf16_f32 v219, v75, v91
  s_add_u32 s78, s86, 0
  v_permlane16_swap_b32 v213, v215
  buffer_store_dwordx4 v[212:215], v4, s[4:7], s78 offen sc1
  v_cvt_pk_bf16_f32 v221, v76, v92
  v_cvt_pk_bf16_f32 v223, v77, v93
  s_add_u32 s78, s86, 32768
  v_permlane16_swap_b32 v217, v219
  buffer_store_dwordx4 v[216:219], v4, s[4:7], s78 offen sc1
  v_cvt_pk_bf16_f32 v225, v78, v94
  v_cvt_pk_bf16_f32 v227, v79, v95
  s_add_u32 s78, s86, 131072
  v_permlane16_swap_b32 v221, v223
  buffer_store_dwordx4 v[220:223], v4, s[4:7], s78 offen sc1
  v_cvt_pk_bf16_f32 v229, v80, v96
  v_cvt_pk_bf16_f32 v231, v81, v97
  s_add_u32 s78, s86, 163840
  v_permlane16_swap_b32 v225, v227
  buffer_store_dwordx4 v[224:227], v4, s[4:7], s78 offen sc1
  v_cvt_pk_bf16_f32 v233, v82, v98
  v_cvt_pk_bf16_f32 v235, v83, v99
  s_add_u32 s78, s86, 262144
  v_permlane16_swap_b32 v229, v231
  buffer_store_dwordx4 v[228:231], v4, s[4:7], s78 offen sc1
  v_cvt_pk_bf16_f32 v237, v84, v100
  v_cvt_pk_bf16_f32 v239, v85, v101
  s_add_u32 s78, s86, 294912
  v_permlane16_swap_b32 v233, v235
  buffer_store_dwordx4 v[232:235], v4, s[4:7], s78 offen sc1
  v_cvt_pk_bf16_f32 v241, v86, v102
  v_cvt_pk_bf16_f32 v243, v87, v103
  s_add_u32 s78, s86, 393216
  v_permlane16_swap_b32 v237, v239
  buffer_store_dwordx4 v[236:239], v4, s[4:7], s78 offen sc1
  s_add_u32 s78, s86, 425984
  v_permlane16_swap_b32 v241, v243
  buffer_store_dwordx4 v[240:243], v4, s[4:7], s78 offen sc1
  s_waitcnt vmcnt(8)
  s_mov_b64 exec, 1
  buffer_store_dword v38, off, s[4:7], s84 sc1
  s_mov_b64 exec, -1
  s_mov_b32 s84, 268435456
  s_branch o_we_205
o_rt_213:
  s_mov_b32 s67, 0
o_rl_217:
  s_lshl_b32 s94, s43, 14
  s_add_u32 s94, s94, s95
  buffer_load_dwordx4 v[120:123], v5, s[4:7], s94 offen offset:0 sc1
  buffer_load_dwordx4 v[124:127], v5, s[4:7], s94 offen offset:512 sc1
  buffer_load_dwordx4 v[128:131], v5, s[4:7], s94 offen offset:256 sc1
  buffer_load_dwordx4 v[132:135], v5, s[4:7], s94 offen offset:768 sc1
  s_add_u32 s94, s94, 4096
  buffer_load_dwordx4 v[136:139], v5, s[4:7], s94 offen offset:0 sc1
  buffer_load_dwordx4 v[140:143], v5, s[4:7], s94 offen offset:512 sc1
  buffer_load_dwordx4 v[144:147], v5, s[4:7], s94 offen offset:256 sc1
  buffer_load_dwordx4 v[148:151], v5, s[4:7], s94 offen offset:768 sc1
  s_add_u32 s94, s94, 4096
  buffer_load_dwordx4 v[152:155], v5, s[4:7], s94 offen offset:0 sc1
  buffer_load_dwordx4 v[156:159], v5, s[4:7], s94 offen offset:512 sc1
  buffer_load_dwordx4 v[160:163], v5, s[4:7], s94 offen offset:256 sc1
  buffer_load_dwordx4 v[164:167], v5, s[4:7], s94 offen offset:768 sc1
  s_add_u32 s94, s94, 4096
  buffer_load_dwordx4 v[168:171], v5, s[4:7], s94 offen offset:0 sc1
  buffer_load_dwordx4 v[172:175], v5, s[4:7], s94 offen offset:512 sc1
  buffer_load_dwordx4 v[176:179], v5, s[4:7], s94 offen offset:256 sc1
  buffer_load_dwordx4 v[180:183], v5, s[4:7], s94 offen offset:768 sc1
  s_add_u32 s67, s67, 1
  s_cmp_gt_u32 s67, 1048576
  s_cbranch_scc1 L_end
  s_waitcnt vmcnt(0)
  v_xor_b32 v7, s96, v120
  v_bitop3_b32 v7, v7, v124, s96 bitop3:0xf6
  v_bitop3_b32 v7, v7, v128, s96 bitop3:0xf6
  v_bitop3_b32 v7, v7, v132, s96 bitop3:0xf6
  v_bitop3_b32 v7, v7, v136, s96 bitop3:0xf6
  v_bitop3_b32 v7, v7, v140, s96 bitop3:0xf6
  v_bitop3_b32 v7, v7, v144, s96 bitop3:0xf6
  v_bitop3_b32 v7, v7, v148, s96 bitop3:0xf6
  v_bitop3_b32 v7, v7, v152, s96 bitop3:0xf6
  v_bitop3_b32 v7, v7, v156, s96 bitop3:0xf6
  v_bitop3_b32 v7, v7, v160, s96 bitop3:0xf6
  v_bitop3_b32 v7, v7, v164, s96 bitop3:0xf6
  v_bitop3_b32 v7, v7, v168, s96 bitop3:0xf6
  v_bitop3_b32 v7, v7, v172, s96 bitop3:0xf6
  v_bitop3_b32 v7, v7, v176, s96 bitop3:0xf6
  v_bitop3_b32 v7, v7, v180, s96 bitop3:0xf6
  v_and_b32 v7, v254, v7
  v_cmp_ne_u32 vcc, 0, v7
  s_cbranch_vccnz o_rl_217
  s_branch o_bk_214
o_rt_215:
  s_mov_b32 s67, 0
o_rl_218:
  s_lshl_b32 s94, s43, 14
  s_add_u32 s94, s94, s95
  buffer_load_dwordx4 v[120:123], v5, s[4:7], s94 offen offset:0 sc1
  buffer_load_dwordx4 v[124:127], v5, s[4:7], s94 offen offset:512 sc1
  buffer_load_dwordx4 v[128:131], v5, s[4:7], s94 offen offset:256 sc1
  buffer_load_dwordx4 v[132:135], v5, s[4:7], s94 offen offset:768 sc1
  s_add_u32 s94, s94, 4096
  buffer_load_dwordx4 v[136:139], v5, s[4:7], s94 offen offset:0 sc1
  buffer_load_dwordx4 v[140:143], v5, s[4:7], s94 offen offset:512 sc1
  buffer_load_dwordx4 v[144:147], v5, s[4:7], s94 offen offset:256 sc1
  buffer_load_dwordx4 v[148:151], v5, s[4:7], s94 offen offset:768 sc1
  s_add_u32 s94, s94, 4096
  buffer_load_dwordx4 v[152:155], v5, s[4:7], s94 offen offset:0 sc1
  buffer_load_dwordx4 v[156:159], v5, s[4:7], s94 offen offset:512 sc1
  buffer_load_dwordx4 v[160:163], v5, s[4:7], s94 offen offset:256 sc1
  buffer_load_dwordx4 v[164:167], v5, s[4:7], s94 offen offset:768 sc1
  s_add_u32 s94, s94, 4096
  buffer_load_dwordx4 v[168:171], v5, s[4:7], s94 offen offset:0 sc1
  buffer_load_dwordx4 v[172:175], v5, s[4:7], s94 offen offset:512 sc1
  buffer_load_dwordx4 v[176:179], v5, s[4:7], s94 offen offset:256 sc1
  buffer_load_dwordx4 v[180:183], v5, s[4:7], s94 offen offset:768 sc1
  s_add_u32 s67, s67, 1
  s_cmp_gt_u32 s67, 1048576
  s_cbranch_scc1 L_end
  s_waitcnt vmcnt(0)
  v_xor_b32 v7, s96, v120
  v_bitop3_b32 v7, v7, v124, s96 bitop3:0xf6
  v_bitop3_b32 v7, v7, v128, s96 bitop3:0xf6
  v_bitop3_b32 v7, v7, v132, s96 bitop3:0xf6
  v_bitop3_b32 v7, v7, v136, s96 bitop3:0xf6
  v_bitop3_b32 v7, v7, v140, s96 bitop3:0xf6
  v_bitop3_b32 v7, v7, v144, s96 bitop3:0xf6
  v_bitop3_b32 v7, v7, v148, s96 bitop3:0xf6
  v_bitop3_b32 v7, v7, v152, s96 bitop3:0xf6
  v_bitop3_b32 v7, v7, v156, s96 bitop3:0xf6
  v_bitop3_b32 v7, v7, v160, s96 bitop3:0xf6
  v_bitop3_b32 v7, v7, v164, s96 bitop3:0xf6
  v_bitop3_b32 v7, v7, v168, s96 bitop3:0xf6
  v_bitop3_b32 v7, v7, v172, s96 bitop3:0xf6
  v_bitop3_b32 v7, v7, v176, s96 bitop3:0xf6
  v_bitop3_b32 v7, v7, v180, s96 bitop3:0xf6
  v_and_b32 v7, v254, v7
  v_cmp_ne_u32 vcc, 0, v7
  s_cbranch_vccnz o_rl_218
  s_branch o_bk_216
o_fb_207:
  v_mov_b32 v118, v116
  s_nop 1
  v_permlane16_swap_b32 v116, v118
  v_max_f32 v116, v116, v118
  v_mov_b32 v118, v116
  s_nop 0
  s_nop 0
  v_permlane32_swap_b32 v116, v118
  v_max_f32 v116, v116, v118
  v_sub_f32 v56, v104, v116
  v_sub_f32 v57, v105, v116
  v_sub_f32 v58, v106, v116
  v_sub_f32 v59, v107, v116
  v_sub_f32 v60, v108, v116
  v_sub_f32 v61, v109, v116
  v_sub_f32 v62, v110, v116
  v_sub_f32 v63, v111, v116
  v_sub_f32 v64, v112, v116
  v_sub_f32 v65, v113, v116
  v_exp_f32 v56, v56
  v_exp_f32 v57, v57
  v_exp_f32 v58, v58
  v_exp_f32 v59, v59
  v_exp_f32 v60, v60
  v_exp_f32 v61, v61
  v_exp_f32 v62, v62
  v_exp_f32 v63, v63
  v_exp_f32 v64, v64
  v_exp_f32 v65, v65
  v_add_f32 v117, v56, v57
  v_add_f32 v117, v117, v58
  v_add_f32 v117, v117, v59
  v_add_f32 v117, v117, v60
  v_add_f32 v117, v117, v61
  v_add_f32 v117, v117, v62
  v_add_f32 v117, v117, v63
  v_add_f32 v117, v117, v64
  v_add_f32 v117, v117, v65
  v_mov_b32 v118, v117
  s_nop 0
  s_nop 0
  v_permlane16_swap_b32 v117, v118
  v_add_f32 v117, v117, v118
  v_mov_b32 v118, v117
  s_nop 0
  s_nop 0
  v_permlane32_swap_b32 v117, v118
  v_add_f32 v117, v117, v118
  v_rcp_f32 v117, v117
  s_branch o_fbr_208
o_fb_209:
  v_mov_b32 v118, v116
  s_nop 1
  v_permlane16_swap_b32 v116, v118
  v_max_f32 v116, v116, v118
  v_mov_b32 v118, v116
  s_nop 0
  s_nop 0
  v_permlane32_swap_b32 v116, v118
  v_max_f32 v116, v116, v118
  v_sub_f32 v56, v104, v116
  v_sub_f32 v57, v105, v116
  v_sub_f32 v58, v106, v116
  v_sub_f32 v59, v107, v116
  v_sub_f32 v60, v108, v116
  v_sub_f32 v61, v109, v116
  v_sub_f32 v62, v110, v116
  v_sub_f32 v63, v111, v116
  v_sub_f32 v64, v112, v116
  v_sub_f32 v65, v113, v116
  v_exp_f32 v56, v56
  v_exp_f32 v57, v57
  v_exp_f32 v58, v58
  v_exp_f32 v59, v59
  v_exp_f32 v60, v60
  v_exp_f32 v61, v61
  v_exp_f32 v62, v62
  v_exp_f32 v63, v63
  v_exp_f32 v64, v64
  v_exp_f32 v65, v65
  v_add_f32 v117, v56, v57
  v_add_f32 v117, v117, v58
  v_add_f32 v117, v117, v59
  v_add_f32 v117, v117, v60
  v_add_f32 v117, v117, v61
  v_add_f32 v117, v117, v62
  v_add_f32 v117, v117, v63
  v_add_f32 v117, v117, v64
  v_add_f32 v117, v117, v65
  v_mov_b32 v118, v117
  s_nop 0
  s_nop 0
  v_permlane16_swap_b32 v117, v118
  v_add_f32 v117, v117, v118
  v_mov_b32 v118, v117
  s_nop 0
  s_nop 0
  v_permlane32_swap_b32 v117, v118
  v_add_f32 v117, v117, v118
  v_rcp_f32 v117, v117
  s_branch o_fbr_210
o_wr2_204:
  s_waitcnt lgkmcnt(0)
  s_barrier
  ds_read_b128 v[104:107], v3 offset:0
  ds_read_b128 v[108:111], v3 offset:512
  ds_read_b128 v[112:115], v3 offset:1024
  buffer_load_dwordx4 v[176:179], v5, s[4:7], s94 offen offset:256 sc1
  buffer_load_dwordx4 v[180:183], v5, s[4:7], s94 offen offset:768 sc1
  s_waitcnt lgkmcnt(2)
  v_mfma_f32_32x32x16_bf16 v[40:55], v[104:107], a[0:3], 0
  v_mov_b64 v[188:189], 0
  v_mov_b64 v[190:191], 0
  v_mov_b64 v[192:193], 0
  v_mov_b64 v[194:195], 0
  s_mov_b64 exec, 1
  buffer_store_dword v38, off, s[4:7], s84 sc1
  s_mov_b64 exec, -1
  s_mov_b32 s84, 268435456
  v_mfma_f32_32x32x16_bf16 v[56:71], v[104:107], a[4:7], 0
  ds_read_b128 v[116:119], v3 offset:1536
  v_mfma_f32_32x32x16_bf16 v[72:87], v[104:107], a[8:11], 0
  v_mfma_f32_32x32x16_bf16 v[88:103], v[104:107], a[12:15], 0
  s_waitcnt vmcnt(13)
  v_xor_b32 v7, s96, v120
  v_bitop3_b32 v7, v7, v124, s96 bitop3:0xf6
  v_bitop3_b32 v7, v7, v128, s96 bitop3:0xf6
  v_bitop3_b32 v7, v7, v132, s96 bitop3:0xf6
  s_waitcnt lgkmcnt(2)
  v_mfma_f32_32x32x16_bf16 v[40:55], v[108:111], a[16:19], v[40:55]
  s_waitcnt vmcnt(9)
  v_bitop3_b32 v7, v7, v136, s96 bitop3:0xf6
  v_bitop3_b32 v7, v7, v140, s96 bitop3:0xf6
  v_bitop3_b32 v7, v7, v144, s96 bitop3:0xf6
  v_bitop3_b32 v7, v7, v148, s96 bitop3:0xf6
  s_waitcnt vmcnt(5)
  v_mfma_f32_32x32x16_bf16 v[56:71], v[108:111], a[20:23], v[56:71]
  ds_read_b128 v[104:107], v3 offset:2048
  v_bitop3_b32 v7, v7, v152, s96 bitop3:0xf6
  v_bitop3_b32 v7, v7, v156, s96 bitop3:0xf6
  v_bitop3_b32 v7, v7, v160, s96 bitop3:0xf6
  v_bitop3_b32 v7, v7, v164, s96 bitop3:0xf6
  s_waitcnt vmcnt(1)
  v_mfma_f32_32x32x16_bf16 v[72:87], v[108:111], a[24:27], v[72:87]
  v_bitop3_b32 v7, v7, v168, s96 bitop3:0xf6
  v_bitop3_b32 v7, v7, v172, s96 bitop3:0xf6
  v_bitop3_b32 v7, v7, v176, s96 bitop3:0xf6
  v_bitop3_b32 v7, v7, v180, s96 bitop3:0xf6
  v_and_b32 v7, v254, v7
  v_cmp_ne_u32 vcc, 0, v7
  s_cbranch_vccnz o_rt_215
o_bk_216:
  v_mfma_f32_32x32x16_bf16 v[88:103], v[108:111], a[28:31], v[88:103]
  v_smfmac_f32_16x16x64_bf16 v[188:191], v[16:19], v[120:127], v20
  v_lshlrev_b32 v196, 16, v184
  v_smfmac_f32_16x16x64_bf16 v[192:195], v[16:19], v[128:135], v20
  v_and_b32 v197, 0xffff0000, v184
  v_smfmac_f32_16x16x64_bf16 v[188:191], v[16:19], v[136:143], v20
  v_lshlrev_b32 v198, 16, v185
  s_waitcnt lgkmcnt(2)
  v_mfma_f32_32x32x16_bf16 v[40:55], v[112:115], a[32:35], v[40:55]
  v_smfmac_f32_16x16x64_bf16 v[192:195], v[16:19], v[144:151], v20
  v_and_b32 v199, 0xffff0000, v185
  v_smfmac_f32_16x16x64_bf16 v[188:191], v[16:19], v[152:159], v20
  v_lshlrev_b32 v200, 16, v186
  v_smfmac_f32_16x16x64_bf16 v[192:195], v[16:19], v[160:167], v20
  v_and_b32 v201, 0xffff0000, v186
  v_mfma_f32_32x32x16_bf16 v[56:71], v[112:115], a[36:39], v[56:71]
  ds_read_b128 v[108:111], v3 offset:2560
  v_smfmac_f32_16x16x64_bf16 v[188:191], v[16:19], v[168:175], v20
  v_lshlrev_b32 v202, 16, v187
  v_smfmac_f32_16x16x64_bf16 v[192:195], v[16:19], v[176:183], v20
  v_and_b32 v203, 0xffff0000, v187
  s_bfe_u32 s92, s65, 131086
  v_mfma_f32_32x32x16_bf16 v[72:87], v[112:115], a[40:43], v[72:87]
  s_lshl_b32 s92, s92, 21
  s_add_u32 s92, s92, s91
  s_add_u32 s93, s92, 27262976
  s_add_u32 s92, s92, 20971520
  v_permlane16_swap_b32 v188, v192
  v_mfma_f32_32x32x16_bf16 v[88:103], v[112:115], a[44:47], v[88:103]
  v_permlane16_swap_b32 v189, v193
  v_permlane16_swap_b32 v190, v194
  v_permlane16_swap_b32 v191, v195
  s_waitcnt lgkmcnt(2)
  v_mfma_f32_32x32x16_bf16 v[40:55], v[116:119], a[48:51], v[40:55]
  v_cvt_pk_bf16_f32 v188, 0, v188
  v_cvt_pk_bf16_f32 v189, 0, v189
  v_cvt_pk_bf16_f32 v190, 0, v190
  v_cvt_pk_bf16_f32 v191, 0, v191
  v_cvt_pk_bf16_f32 v192, 0, v192
  v_cvt_pk_bf16_f32 v193, 0, v193
  v_mfma_f32_32x32x16_bf16 v[56:71], v[116:119], a[52:55], v[56:71]
  ds_read_b128 v[112:115], v3 offset:3072
  v_cvt_pk_bf16_f32 v194, 0, v194
  v_cvt_pk_bf16_f32 v195, 0, v195
  v_add_f32 v196, v196, v188
  v_add_f32 v197, v197, v189
  v_add_f32 v198, v198, v190
  v_mfma_f32_32x32x16_bf16 v[72:87], v[116:119], a[56:59], v[72:87]
  v_add_f32 v199, v199, v191
  v_add_f32 v200, v200, v192
  v_add_f32 v201, v201, v193
  v_add_f32 v202, v202, v194
  v_add_f32 v203, v203, v195
  v_cvt_pk_bf16_f32 v120, v196, v197
  v_mfma_f32_32x32x16_bf16 v[88:103], v[116:119], a[60:63], v[88:103]
  v_cvt_pk_bf16_f32 v121, v198, v199
  v_cvt_pk_bf16_f32 v122, v200, v201
  v_cvt_pk_bf16_f32 v123, v202, v203
  v_lshlrev_b32 v196, 16, v120
  v_and_b32 v197, 0xffff0000, v120
  s_waitcnt lgkmcnt(2)
  v_mfma_f32_32x32x16_bf16 v[40:55], v[104:107], a[64:67], v[40:55]
  v_lshlrev_b32 v198, 16, v121
  v_and_b32 v199, 0xffff0000, v121
  v_lshlrev_b32 v200, 16, v122
  v_and_b32 v201, 0xffff0000, v122
  v_lshlrev_b32 v202, 16, v123
  v_and_b32 v203, 0xffff0000, v123
  v_mfma_f32_32x32x16_bf16 v[56:71], v[104:107], a[68:71], v[56:71]
  ds_read_b128 v[116:119], v3 offset:3584
  buffer_store_dwordx4 v[120:123], v0, s[4:7], s92 offen sc1
  v_add_f32 v136, v196, v197
  v_mul_f32 v137, v196, v196
  v_mfma_f32_32x32x16_bf16 v[72:87], v[104:107], a[72:75], v[72:87]
  v_add_f32 v138, v198, v199
  v_mul_f32 v139, v197, v197
  v_fmac_f32 v137, v198, v198
  v_fmac_f32 v139, v199, v199
  v_add_f32 v136, v136, v200
  v_fmac_f32 v137, v200, v200
  v_mfma_f32_32x32x16_bf16 v[88:103], v[104:107], a[76:79], v[88:103]
  v_add_f32 v138, v138, v201
  v_fmac_f32 v139, v201, v201
  v_add_f32 v136, v136, v202
  v_fmac_f32 v137, v202, v202
  v_add_f32 v138, v138, v203
  s_waitcnt lgkmcnt(2)
  v_mfma_f32_32x32x16_bf16 v[40:55], v[108:111], a[80:83], v[40:55]
  v_fmac_f32 v139, v203, v203
  v_add_f32 v136, v136, v138
  v_add_f32 v137, v137, v139
  s_nop 0
  v_add_f32_dpp v136, v136, v136 row_ror:8 row_mask:0xf bank_mask:0xf
  v_add_f32_dpp v137, v137, v137 row_ror:8 row_mask:0xf bank_mask:0xf
  s_nop 0
  v_add_f32_dpp v136, v136, v136 row_ror:4 row_mask:0xf bank_mask:0xf
  v_mfma_f32_32x32x16_bf16 v[56:71], v[108:111], a[84:87], v[56:71]
  ds_read_b128 v[104:107], v3 offset:8192
  v_add_f32_dpp v137, v137, v137 row_ror:4 row_mask:0xf bank_mask:0xf
  v_add_f32_dpp v136, v136, v136 row_ror:2 row_mask:0xf bank_mask:0xf
  s_nop 0
  v_add_f32_dpp v137, v137, v137 row_ror:2 row_mask:0xf bank_mask:0xf
  v_add_f32_dpp v136, v136, v136 row_ror:1 row_mask:0xf bank_mask:0xf
  s_nop 0
  v_add_f32_dpp v137, v137, v137 row_ror:1 row_mask:0xf bank_mask:0xf
  v_mfma_f32_32x32x16_bf16 v[72:87], v[108:111], a[88:91], v[72:87]
  v_mov_b32 v140, v136
  v_mov_b32 v141, v137
  s_nop 0
  v_permlane16_swap_b32 v136, v140
  v_permlane16_swap_b32 v137, v141
  v_mfma_f32_32x32x16_bf16 v[88:103], v[108:111], a[92:95], v[88:103]
  v_add_f32 v136, v136, v140
  v_add_f32 v137, v137, v141
  v_mov_b32 v140, v136
  v_mov_b32 v141, v137
  s_nop 0
  v_permlane32_swap_b32 v136, v140
  s_waitcnt lgkmcnt(2)
  v_mfma_f32_32x32x16_bf16 v[40:55], v[112:115], a[96:99], v[40:55]
  v_permlane32_swap_b32 v137, v141
  v_add_f32 v136, v136, v140
  v_add_f32 v137, v137, v141
  v_mul_f32 v136, 0x3b000000, v136
  v_mul_f32 v137, 0x3b000000, v137
  v_mfma_f32_32x32x16_bf16 v[56:71], v[112:115], a[100:103], v[56:71]
  ds_read_b128 v[108:111], v3 offset:8704
  v_fma_f32 v137, -v136, v136, v137
  v_cvt_pk_bf16_f32 v136, 0, v136
  v_max_f32 v137, 0, v137
  v_sub_f32 v140, v196, v136
  v_sub_f32 v141, v197, v136
  v_mfma_f32_32x32x16_bf16 v[72:87], v[112:115], a[104:107], v[72:87]
  v_cvt_pk_bf16_f32 v137, 0, v137
  v_sub_f32 v142, v198, v136
  v_sub_f32 v143, v199, v136
  v_add_f32 v137, 0x3727c5ac, v137
  v_sub_f32 v144, v200, v136
  v_sub_f32 v145, v201, v136
  v_mfma_f32_32x32x16_bf16 v[88:103], v[112:115], a[108:111], v[88:103]
  v_cvt_pk_bf16_f32 v137, 0, v137
  v_sub_f32 v146, v202, v136
  v_sub_f32 v147, v203, v136
  v_sqrt_f32 v137, v137
  s_waitcnt lgkmcnt(2)
  v_mfma_f32_32x32x16_bf16 v[40:55], v[116:119], a[112:115], v[40:55]
  v_cvt_pk_bf16_f32 v140, 0, v140
  v_cvt_pk_bf16_f32 v141, 0, v141
  v_cvt_pk_bf16_f32 v137, 0, v137
  v_cvt_pk_bf16_f32 v142, 0, v142
  v_cvt_pk_bf16_f32 v143, 0, v143
  v_rcp_f32 v137, v137
  v_mfma_f32_32x32x16_bf16 v[56:71], v[116:119], a[116:119], v[56:71]
  ds_read_b128 v[112:115], v3 offset:9216
  v_cvt_pk_bf16_f32 v144, 0, v144
  v_cvt_pk_bf16_f32 v145, 0, v145
  v_cvt_pk_bf16_f32 v146, 0, v146
  v_cvt_pk_bf16_f32 v147, 0, v147
  v_mul_f32 v140, v140, v137
  v_mfma_f32_32x32x16_bf16 v[72:87], v[116:119], a[120:123], v[72:87]
  v_mul_f32 v141, v141, v137
  v_mul_f32 v142, v142, v137
  v_mul_f32 v143, v143, v137
  v_mul_f32 v144, v144, v137
  v_mul_f32 v145, v145, v137
  v_mul_f32 v146, v146, v137
  v_mfma_f32_32x32x16_bf16 v[88:103], v[116:119], a[124:127], v[88:103]
  v_mul_f32 v147, v147, v137
  v_cvt_pk_bf16_f32 v124, v140, v141
  v_cvt_pk_bf16_f32 v125, v142, v143
  v_cvt_pk_bf16_f32 v126, v144, v145
  v_cvt_pk_bf16_f32 v127, v146, v147
  s_waitcnt lgkmcnt(2)
  v_mfma_f32_32x32x16_bf16 v[40:55], v[104:107], a[128:131], v[40:55]
  v_lshlrev_b32 v204, 16, v124
  v_and_b32 v205, 0xffff0000, v124
  v_lshlrev_b32 v206, 16, v125
  v_and_b32 v207, 0xffff0000, v125
  v_lshlrev_b32 v208, 16, v126
  v_and_b32 v209, 0xffff0000, v126
  v_mfma_f32_32x32x16_bf16 v[56:71], v[104:107], a[132:135], v[56:71]
  ds_read_b128 v[116:119], v3 offset:9728
  v_lshlrev_b32 v210, 16, v127
  v_and_b32 v211, 0xffff0000, v127
  buffer_store_dwordx4 v[124:127], v0, s[4:7], s93 offen sc1
  v_mfma_f32_32x32x16_bf16 v[72:87], v[104:107], a[136:139], v[72:87]
  v_add_f32 v196, v196, v204
  v_add_f32 v197, v197, v205
  v_add_f32 v198, v198, v206
  v_add_f32 v199, v199, v207
  v_add_f32 v200, v200, v208
  v_add_f32 v201, v201, v209
  v_mfma_f32_32x32x16_bf16 v[88:103], v[104:107], a[140:143], v[88:103]
  v_add_f32 v202, v202, v210
  v_add_f32 v203, v203, v211
  v_cvt_pk_bf16_f32 v128, v196, v197
  v_cvt_pk_bf16_f32 v129, v198, v199
  v_cvt_pk_bf16_f32 v130, v200, v201
  s_waitcnt lgkmcnt(2)
  v_mfma_f32_32x32x16_bf16 v[40:55], v[108:111], a[144:147], v[40:55]
  v_cvt_pk_bf16_f32 v131, v202, v203
  v_mul_f32 v188, v204, v8
  v_mul_f32 v189, v205, v9
  v_fmac_f32 v188, v206, v10
  v_fmac_f32 v189, v207, v11
  v_fmac_f32 v188, v208, v12
  v_mfma_f32_32x32x16_bf16 v[56:71], v[108:111], a[148:151], v[56:71]
  ds_read_b128 v[104:107], v3 offset:10240
  v_fmac_f32 v189, v209, v13
  v_fmac_f32 v188, v210, v14
  v_fmac_f32 v189, v211, v15
  v_add_f32 v188, v188, v189
  buffer_store_dwordx4 v[128:131], v0, s[68:71], s91 offen sc1
  v_mfma_f32_32x32x16_bf16 v[72:87], v[108:111], a[152:155], v[72:87]
  v_add_f32_dpp v188, v188, v188 row_ror:8 row_mask:0xf bank_mask:0xf
  s_nop 1
  v_add_f32_dpp v188, v188, v188 row_ror:4 row_mask:0xf bank_mask:0xf
  s_nop 1
  v_add_f32_dpp v188, v188, v188 row_ror:2 row_mask:0xf bank_mask:0xf
  s_nop 1
  v_add_f32_dpp v188, v188, v188 row_ror:1 row_mask:0xf bank_mask:0xf
  v_mov_b32 v189, v188
  s_nop 0
  s_nop 0
  v_permlane16_swap_b32 v188, v189
  v_mfma_f32_32x32x16_bf16 v[88:103], v[108:111], a[156:159], v[88:103]
  v_add_f32 v188, v188, v189
  v_mov_b32 v189, v188
  s_nop 0
  s_nop 0
  v_permlane32_swap_b32 v188, v189
  v_add_f32 v188, v188, v189
  s_waitcnt lgkmcnt(2)
  v_mfma_f32_32x32x16_bf16 v[40:55], v[112:115], a[160:163], v[40:55]
  v_cvt_pk_bf16_f32 v188, 0, v188
  v_ashrrev_i32 v189, 31, v188
  v_or_b32 v189, 0x80000000, v189
  v_xor_b32 v188, v188, v189
  s_sub_u32 s92, 4095, s90
  v_and_b32 v188, 0xffff0000, v188
  v_mfma_f32_32x32x16_bf16 v[56:71], v[112:115], a[164:167], v[56:71]
  ds_read_b128 v[108:111], v3 offset:10752
  v_or_b32 v38, s92, v188
  s_bfe_u32 s92, s65, 196625
  s_lshl_b32 s92, s92, 18
  s_lshl_b32 s93, s90, 7
  s_add_u32 s92, s92, s93
  v_mfma_f32_32x32x16_bf16 v[72:87], v[112:115], a[168:171], v[72:87]
  s_add_u32 s84, s92, 243269632
  v_mfma_f32_32x32x16_bf16 v[88:103], v[112:115], a[172:175], v[88:103]
  s_waitcnt lgkmcnt(2)
  v_mfma_f32_32x32x16_bf16 v[40:55], v[116:119], a[176:179], v[40:55]
  v_mfma_f32_32x32x16_bf16 v[56:71], v[116:119], a[180:183], v[56:71]
  ds_read_b128 v[112:115], v3 offset:11264
  v_mfma_f32_32x32x16_bf16 v[72:87], v[116:119], a[184:187], v[72:87]
  v_mfma_f32_32x32x16_bf16 v[88:103], v[116:119], a[188:191], v[88:103]
  s_waitcnt lgkmcnt(2)
  v_mfma_f32_32x32x16_bf16 v[40:55], v[104:107], a[192:195], v[40:55]
  v_mfma_f32_32x32x16_bf16 v[56:71], v[104:107], a[196:199], v[56:71]
  ds_read_b128 v[116:119], v3 offset:11776
  s_waitcnt lgkmcnt(2)
  v_mfma_f32_32x32x16_bf16 v[40:55], v[108:111], a[208:211], v[40:55]
  v_mfma_f32_32x32x16_bf16 v[56:71], v[108:111], a[212:215], v[56:71]
  s_waitcnt lgkmcnt(1)
  v_mfma_f32_32x32x16_bf16 v[40:55], v[112:115], a[224:227], v[40:55]
  v_mfma_f32_32x32x16_bf16 v[56:71], v[112:115], a[228:231], v[56:71]
  s_waitcnt lgkmcnt(0)
  v_mfma_f32_32x32x16_bf16 v[40:55], v[116:119], a[240:243], v[40:55]
  v_mfma_f32_32x32x16_bf16 v[56:71], v[116:119], a[244:247], v[56:71]
  v_mfma_f32_32x32x16_bf16 v[72:87], v[104:107], a[200:203], v[72:87]
  v_mfma_f32_32x32x16_bf16 v[88:103], v[104:107], a[204:207], v[88:103]
  v_cvt_pk_bf16_f32 v212, v40, v56
  v_cvt_pk_bf16_f32 v214, v41, v57
  v_cvt_pk_bf16_f32 v216, v42, v58
  v_cvt_pk_bf16_f32 v218, v43, v59
  v_permlane16_swap_b32 v212, v214
  v_mfma_f32_32x32x16_bf16 v[72:87], v[108:111], a[216:219], v[72:87]
  v_cvt_pk_bf16_f32 v220, v44, v60
  v_cvt_pk_bf16_f32 v222, v45, v61
  v_permlane16_swap_b32 v216, v218
  v_bfi_b32 v212, v254, s42, v212
  v_cvt_pk_bf16_f32 v224, v46, v62
  v_mfma_f32_32x32x16_bf16 v[88:103], v[108:111], a[220:223], v[88:103]
  v_cvt_pk_bf16_f32 v226, v47, v63
  v_permlane16_swap_b32 v220, v222
  v_bfi_b32 v216, v254, s42, v216
  v_cvt_pk_bf16_f32 v228, v48, v64
  v_mfma_f32_32x32x16_bf16 v[72:87], v[112:115], a[232:235], v[72:87]
  v_cvt_pk_bf16_f32 v230, v49, v65
  v_permlane16_swap_b32 v224, v226
  v_bfi_b32 v220, v254, s42, v220
  v_cvt_pk_bf16_f32 v232, v50, v66
  v_cvt_pk_bf16_f32 v234, v51, v67
  v_mfma_f32_32x32x16_bf16 v[88:103], v[112:115], a[236:239], v[88:103]
  v_permlane16_swap_b32 v228, v230
  v_bfi_b32 v224, v254, s42, v224
  v_cvt_pk_bf16_f32 v236, v52, v68
  v_cvt_pk_bf16_f32 v238, v53, v69
  v_mfma_f32_32x32x16_bf16 v[72:87], v[116:119], a[248:251], v[72:87]
  v_permlane16_swap_b32 v232, v234
  v_bfi_b32 v228, v254, s42, v228
  v_cvt_pk_bf16_f32 v240, v54, v70
  v_cvt_pk_bf16_f32 v242, v55, v71
  v_permlane16_swap_b32 v236, v238
  v_mfma_f32_32x32x16_bf16 v[88:103], v[116:119], a[252:255], v[88:103]
  v_bfi_b32 v232, v254, s42, v232
  v_permlane16_swap_b32 v240, v242
  v_bfi_b32 v236, v254, s42, v236
  v_bfi_b32 v240, v254, s42, v240
  s_nop 7
  v_cvt_pk_bf16_f32 v213, v72, v88
  v_cvt_pk_bf16_f32 v215, v73, v89
  v_cvt_pk_bf16_f32 v217, v74, v90
  v_cvt_pk_bf16_f32 v219, v75, v91
  s_add_u32 s78, s86, 0
  v_permlane16_swap_b32 v213, v215
  buffer_store_dwordx4 v[212:215], v4, s[4:7], s78 offen sc1
  v_cvt_pk_bf16_f32 v221, v76, v92
  v_cvt_pk_bf16_f32 v223, v77, v93
  s_add_u32 s78, s86, 32768
  v_permlane16_swap_b32 v217, v219
  buffer_store_dwordx4 v[216:219], v4, s[4:7], s78 offen sc1
  v_cvt_pk_bf16_f32 v225, v78, v94
  v_cvt_pk_bf16_f32 v227, v79, v95
  s_add_u32 s78, s86, 131072
  v_permlane16_swap_b32 v221, v223
  buffer_store_dwordx4 v[220:223], v4, s[4:7], s78 offen sc1
  v_cvt_pk_bf16_f32 v229, v80, v96
  v_cvt_pk_bf16_f32 v231, v81, v97
  s_add_u32 s78, s86, 163840
  v_permlane16_swap_b32 v225, v227
  buffer_store_dwordx4 v[224:227], v4, s[4:7], s78 offen sc1
  v_cvt_pk_bf16_f32 v233, v82, v98
  v_cvt_pk_bf16_f32 v235, v83, v99
  s_add_u32 s78, s86, 262144
  v_permlane16_swap_b32 v229, v231
  buffer_store_dwordx4 v[228:231], v4, s[4:7], s78 offen sc1
  v_cvt_pk_bf16_f32 v237, v84, v100
  v_cvt_pk_bf16_f32 v239, v85, v101
  s_add_u32 s78, s86, 294912
  v_permlane16_swap_b32 v233, v235
  buffer_store_dwordx4 v[232:235], v4, s[4:7], s78 offen sc1
  v_cvt_pk_bf16_f32 v241, v86, v102
  v_cvt_pk_bf16_f32 v243, v87, v103
  s_add_u32 s78, s86, 393216
  v_permlane16_swap_b32 v237, v239
  buffer_store_dwordx4 v[236:239], v4, s[4:7], s78 offen sc1
  s_add_u32 s78, s86, 425984
  v_permlane16_swap_b32 v241, v243
  buffer_store_dwordx4 v[240:243], v4, s[4:7], s78 offen sc1
o_we_205:
  v_and_b32 v37, -32, v39
  s_waitcnt lgkmcnt(0)
  s_barrier
  ds_read_b128 v[104:107], v37 offset:16
  s_mov_b32 s65, s63
  s_waitcnt lgkmcnt(0)
  v_and_b32 v104, v104, v106
  v_max_u32 v105, v105, v107
  v_readfirstlane_b32 s26, v104
  v_readfirstlane_b32 s3, v105
  s_and_b32 s66, s26, 1
  s_and_b32 s76, s26, 2
  s_bitcmp1_b32 s26, 2
  s_cselect_b32 s3, s3, 0
  s_cmp_lg_u32 s76, 0
  s_cbranch_scc1 o_nofl_179
  s_and_b32 s26, s63, 49152
  s_cbranch_scc0 o_fl_180
  s_and_b32 s26, s64, s50
  s_cbranch_scc1 o_nofl_179
o_fl_180:
  s_cmp_ge_u32 s17, 2
  s_cbranch_scc1 o_fd_219
  s_cmp_eq_u32 s65, 0
  s_cbranch_scc1 o_fd_219
  s_mov_b32 s96, s42
  s_lshl_b32 s97, s43, 14
  s_add_u32 s97, s97, s86
  buffer_load_dword v7, v255, s[4:7], s97 offen sc1
  s_and_b32 s91, s65, 63
  s_lshl_b32 s90, s91, 5
  s_add_u32 s94, s90, s85
  s_add_u32 s90, s90, s43
  s_lshl_b32 s94, s94, 10
  s_lshr_b32 s92, s65, 22
  s_xor_b32 s93, s43, 32
  s_lshl_b32 s91, s90, 10
  s_add_u32 s94, s94, 25165824
  s_cmp_eq_u32 s92, s93
  s_cselect_b32 s92, s94, s91
  s_add_u32 s92, s92, 10485760
  s_and_b32 s93, s65, 49152
  s_cselect_b32 s92, s92, s91
  s_cselect_b64 s[80:81], s[4:5], s[72:73]
  s_cselect_b32 s82, s6, s74
  buffer_load_dwordx4 v[184:187], v0, s[80:83], s92 offen sc1
  s_mov_b32 s67, 0
  s_mov_b64 vcc, 0
  s_waitcnt vmcnt(1)
o_pl_221:
  v_and_b32 v7, 1, v7
  v_cmp_ne_u32 vcc, s96, v7
  s_cbranch_vccz o_pk_222
  s_mov_b64 exec, 1
  buffer_store_dword v38, off, s[4:7], s84 sc1
  s_mov_b64 exec, -1
  s_mov_b32 s84, 268435456
  buffer_load_dword v7, v255, s[4:7], s97 offen sc1
  s_add_u32 s67, s67, 1
  s_cmp_gt_u32 s67, 1048576
  s_cbranch_scc1 L_end
  s_waitcnt vmcnt(0)
  s_branch o_pl_221
o_pk_222:
  s_and_b32 s26, s65, 49152
  s_cbranch_scc1 o_f2_220
  s_lshl_b32 s94, s43, 14
  s_add_u32 s94, s94, s86
  buffer_load_dwordx4 v[120:123], v5, s[4:7], s94 offen offset:0 sc1
  buffer_load_dwordx4 v[124:127], v5, s[4:7], s94 offen offset:512 sc1
  buffer_load_dwordx4 v[128:131], v5, s[4:7], s94 offen offset:256 sc1
  buffer_load_dwordx4 v[132:135], v5, s[4:7], s94 offen offset:768 sc1
  s_add_u32 s94, s94, 4096
  buffer_load_dwordx4 v[136:139], v5, s[4:7], s94 offen offset:0 sc1
  buffer_load_dwordx4 v[140:143], v5, s[4:7], s94 offen offset:512 sc1
  buffer_load_dwordx4 v[144:147], v5, s[4:7], s94 offen offset:256 sc1
  buffer_load_dwordx4 v[148:151], v5, s[4:7], s94 offen offset:768 sc1
  s_add_u32 s94, s94, 4096
  buffer_load_dwordx4 v[152:155], v5, s[4:7], s94 offen offset:0 sc1
  buffer_load_dwordx4 v[156:159], v5, s[4:7], s94 offen offset:512 sc1
  buffer_load_dwordx4 v[160:163], v5, s[4:7], s94 offen offset:256 sc1
  buffer_load_dwordx4 v[164:167], v5, s[4:7], s94 offen offset:768 sc1
  s_add_u32 s94, s94, 4096
  buffer_load_dwordx4 v[168:171], v5, s[4:7], s94 offen offset:0 sc1
  buffer_load_dwordx4 v[172:175], v5, s[4:7], s94 offen offset:512 sc1
  buffer_load_dwordx4 v[176:179], v5, s[4:7], s94 offen offset:256 sc1
  buffer_load_dwordx4 v[180:183], v5, s[4:7], s94 offen offset:768 sc1
  s_mov_b64 exec, 1
  buffer_store_dword v38, off, s[4:7], s84 sc1
  s_mov_b64 exec, -1
  s_mov_b32 s84, 268435456
  v_mov_b64 v[188:189], 0
  v_mov_b64 v[190:191], 0
  v_mov_b64 v[192:193], 0
  v_mov_b64 v[194:195], 0
  s_waitcnt vmcnt(13)
  v_xor_b32 v7, s96, v120
  v_bitop3_b32 v7, v7, v124, s96 bitop3:0xf6
  v_bitop3_b32 v7, v7, v128, s96 bitop3:0xf6
  v_bitop3_b32 v7, v7, v132, s96 bitop3:0xf6
  s_waitcnt vmcnt(9)
  v_bitop3_b32 v7, v7, v136, s96 bitop3:0xf6
  v_bitop3_b32 v7, v7, v140, s96 bitop3:0xf6
  v_bitop3_b32 v7, v7, v144, s96 bitop3:0xf6
  v_bitop3_b32 v7, v7, v148, s96 bitop3:0xf6
  s_waitcnt vmcnt(5)
  v_bitop3_b32 v7, v7, v152, s96 bitop3:0xf6
  v_bitop3_b32 v7, v7, v156, s96 bitop3:0xf6
  v_bitop3_b32 v7, v7, v160, s96 bitop3:0xf6
  v_bitop3_b32 v7, v7, v164, s96 bitop3:0xf6
  s_waitcnt vmcnt(1)
  v_bitop3_b32 v7, v7, v168, s96 bitop3:0xf6
  v_bitop3_b32 v7, v7, v172, s96 bitop3:0xf6
  v_bitop3_b32 v7, v7, v176, s96 bitop3:0xf6
  v_bitop3_b32 v7, v7, v180, s96 bitop3:0xf6
  v_and_b32 v7, v254, v7
  v_cmp_ne_u32 vcc, 0, v7
  s_cbranch_vccnz o_rt_223
o_bk_224:
  v_smfmac_f32_16x16x64_bf16 v[188:191], v[16:19], v[120:127], v20
  v_lshlrev_b32 v196, 16, v184
  v_smfmac_f32_16x16x64_bf16 v[192:195], v[16:19], v[128:135], v20
  v_and_b32 v197, 0xffff0000, v184
  v_smfmac_f32_16x16x64_bf16 v[188:191], v[16:19], v[136:143], v20
  v_lshlrev_b32 v198, 16, v185
  v_smfmac_f32_16x16x64_bf16 v[192:195], v[16:19], v[144:151], v20
  v_and_b32 v199, 0xffff0000, v185
  v_smfmac_f32_16x16x64_bf16 v[188:191], v[16:19], v[152:159], v20
  v_lshlrev_b32 v200, 16, v186
  v_smfmac_f32_16x16x64_bf16 v[192:195], v[16:19], v[160:167], v20
  v_and_b32 v201, 0xffff0000, v186
  v_smfmac_f32_16x16x64_bf16 v[188:191], v[16:19], v[168:175], v20
  v_lshlrev_b32 v202, 16, v187
  v_smfmac_f32_16x16x64_bf16 v[192:195], v[16:19], v[176:183], v20
  v_and_b32 v203, 0xffff0000, v187
  s_bfe_u32 s92, s65, 131086
  s_lshl_b32 s92, s92, 21
  s_add_u32 s92, s92, s91
  s_add_u32 s93, s92, 27262976
  s_add_u32 s92, s92, 20971520
  s_nop 1
  v_permlane16_swap_b32 v188, v192
  v_permlane16_swap_b32 v189, v193
  v_permlane16_swap_b32 v190, v194
  v_permlane16_swap_b32 v191, v195
  v_cvt_pk_bf16_f32 v188, 0, v188
  v_cvt_pk_bf16_f32 v189, 0, v189
  v_cvt_pk_bf16_f32 v190, 0, v190
  v_cvt_pk_bf16_f32 v191, 0, v191
  v_cvt_pk_bf16_f32 v192, 0, v192
  v_cvt_pk_bf16_f32 v193, 0, v193
  v_cvt_pk_bf16_f32 v194, 0, v194
  v_cvt_pk_bf16_f32 v195, 0, v195
  v_add_f32 v196, v196, v188
  v_add_f32 v197, v197, v189
  v_add_f32 v198, v198, v190
  v_add_f32 v199, v199, v191
  v_add_f32 v200, v200, v192
  v_add_f32 v201, v201, v193
  v_add_f32 v202, v202, v194
  v_add_f32 v203, v203, v195
  v_cvt_pk_bf16_f32 v120, v196, v197
  v_cvt_pk_bf16_f32 v121, v198, v199
  v_cvt_pk_bf16_f32 v122, v200, v201
  v_cvt_pk_bf16_f32 v123, v202, v203
  v_lshlrev_b32 v196, 16, v120
  v_and_b32 v197, 0xffff0000, v120
  v_lshlrev_b32 v198, 16, v121
  v_and_b32 v199, 0xffff0000, v121
  v_lshlrev_b32 v200, 16, v122
  v_and_b32 v201, 0xffff0000, v122
  v_lshlrev_b32 v202, 16, v123
  v_and_b32 v203, 0xffff0000, v123
  buffer_store_dwordx4 v[120:123], v0, s[4:7], s92 offen sc1
  v_add_f32 v136, v196, v197
  v_mul_f32 v137, v196, v196
  v_add_f32 v138, v198, v199
  v_mul_f32 v139, v197, v197
  v_fmac_f32 v137, v198, v198
  v_fmac_f32 v139, v199, v199
  v_add_f32 v136, v136, v200
  v_fmac_f32 v137, v200, v200
  v_add_f32 v138, v138, v201
  v_fmac_f32 v139, v201, v201
  v_add_f32 v136, v136, v202
  v_fmac_f32 v137, v202, v202
  v_add_f32 v138, v138, v203
  v_fmac_f32 v139, v203, v203
  v_add_f32 v136, v136, v138
  v_add_f32 v137, v137, v139
  s_nop 0
  v_add_f32_dpp v136, v136, v136 row_ror:8 row_mask:0xf bank_mask:0xf
  v_add_f32_dpp v137, v137, v137 row_ror:8 row_mask:0xf bank_mask:0xf
  s_nop 0
  v_add_f32_dpp v136, v136, v136 row_ror:4 row_mask:0xf bank_mask:0xf
  v_add_f32_dpp v137, v137, v137 row_ror:4 row_mask:0xf bank_mask:0xf
  s_nop 0
  v_add_f32_dpp v136, v136, v136 row_ror:2 row_mask:0xf bank_mask:0xf
  v_add_f32_dpp v137, v137, v137 row_ror:2 row_mask:0xf bank_mask:0xf
  s_nop 0
  v_add_f32_dpp v136, v136, v136 row_ror:1 row_mask:0xf bank_mask:0xf
  v_add_f32_dpp v137, v137, v137 row_ror:1 row_mask:0xf bank_mask:0xf
  v_mov_b32 v140, v136
  v_mov_b32 v141, v137
  s_nop 0
  v_permlane16_swap_b32 v136, v140
  v_permlane16_swap_b32 v137, v141
  v_add_f32 v136, v136, v140
  v_add_f32 v137, v137, v141
  v_mov_b32 v140, v136
  v_mov_b32 v141, v137
  s_nop 0
  v_permlane32_swap_b32 v136, v140
  v_permlane32_swap_b32 v137, v141
  v_add_f32 v136, v136, v140
  v_add_f32 v137, v137, v141
  v_mul_f32 v136, 0x3b000000, v136
  v_mul_f32 v137, 0x3b000000, v137
  v_fma_f32 v137, -v136, v136, v137
  v_cvt_pk_bf16_f32 v136, 0, v136
  v_max_f32 v137, 0, v137
  v_sub_f32 v140, v196, v136
  v_sub_f32 v141, v197, v136
  v_cvt_pk_bf16_f32 v137, 0, v137
  v_sub_f32 v142, v198, v136
  v_sub_f32 v143, v199, v136
  v_add_f32 v137, 0x3727c5ac, v137
  v_sub_f32 v144, v200, v136
  v_sub_f32 v145, v201, v136
  v_cvt_pk_bf16_f32 v137, 0, v137
  v_sub_f32 v146, v202, v136
  v_sub_f32 v147, v203, v136
  v_sqrt_f32 v137, v137
  v_cvt_pk_bf16_f32 v140, 0, v140
  v_cvt_pk_bf16_f32 v141, 0, v141
  v_cvt_pk_bf16_f32 v137, 0, v137
  v_cvt_pk_bf16_f32 v142, 0, v142
  v_cvt_pk_bf16_f32 v143, 0, v143
  v_rcp_f32 v137, v137
  v_cvt_pk_bf16_f32 v144, 0, v144
  v_cvt_pk_bf16_f32 v145, 0, v145
  v_cvt_pk_bf16_f32 v146, 0, v146
  v_cvt_pk_bf16_f32 v147, 0, v147
  v_mul_f32 v140, v140, v137
  v_mul_f32 v141, v141, v137
  v_mul_f32 v142, v142, v137
  v_mul_f32 v143, v143, v137
  v_mul_f32 v144, v144, v137
  v_mul_f32 v145, v145, v137
  v_mul_f32 v146, v146, v137
  v_mul_f32 v147, v147, v137
  v_cvt_pk_bf16_f32 v124, v140, v141
  v_cvt_pk_bf16_f32 v125, v142, v143
  v_cvt_pk_bf16_f32 v126, v144, v145
  v_cvt_pk_bf16_f32 v127, v146, v147
  v_lshlrev_b32 v204, 16, v124
  v_and_b32 v205, 0xffff0000, v124
  v_lshlrev_b32 v206, 16, v125
  v_and_b32 v207, 0xffff0000, v125
  v_lshlrev_b32 v208, 16, v126
  v_and_b32 v209, 0xffff0000, v126
  v_lshlrev_b32 v210, 16, v127
  v_and_b32 v211, 0xffff0000, v127
  buffer_store_dwordx4 v[124:127], v0, s[4:7], s93 offen sc1
  v_add_f32 v196, v196, v204
  v_add_f32 v197, v197, v205
  v_add_f32 v198, v198, v206
  v_add_f32 v199, v199, v207
  v_add_f32 v200, v200, v208
  v_add_f32 v201, v201, v209
  v_add_f32 v202, v202, v210
  v_add_f32 v203, v203, v211
  v_cvt_pk_bf16_f32 v128, v196, v197
  v_cvt_pk_bf16_f32 v129, v198, v199
  v_cvt_pk_bf16_f32 v130, v200, v201
  v_cvt_pk_bf16_f32 v131, v202, v203
  v_mul_f32 v188, v204, v8
  v_mul_f32 v189, v205, v9
  v_fmac_f32 v188, v206, v10
  v_fmac_f32 v189, v207, v11
  v_fmac_f32 v188, v208, v12
  v_fmac_f32 v189, v209, v13
  v_fmac_f32 v188, v210, v14
  v_fmac_f32 v189, v211, v15
  v_add_f32 v188, v188, v189
  s_add_u32 s92, s91, 10485760
  s_add_u32 s93, s91, 8388608
  buffer_store_dwordx4 v[128:131], v0, s[4:7], s92 offen sc1
  v_lshlrev_b32 v196, 16, v128
  v_and_b32 v197, 0xffff0000, v128
  v_lshlrev_b32 v198, 16, v129
  v_and_b32 v199, 0xffff0000, v129
  v_lshlrev_b32 v200, 16, v130
  v_and_b32 v201, 0xffff0000, v130
  v_lshlrev_b32 v202, 16, v131
  v_and_b32 v203, 0xffff0000, v131
  v_add_f32 v136, v196, v197
  v_mul_f32 v137, v196, v196
  v_add_f32 v138, v198, v199
  v_mul_f32 v139, v197, v197
  v_fmac_f32 v137, v198, v198
  v_fmac_f32 v139, v199, v199
  v_add_f32 v136, v136, v200
  v_fmac_f32 v137, v200, v200
  v_add_f32 v138, v138, v201
  v_fmac_f32 v139, v201, v201
  v_add_f32 v136, v136, v202
  v_fmac_f32 v137, v202, v202
  v_add_f32 v138, v138, v203
  v_fmac_f32 v139, v203, v203
  v_add_f32 v136, v136, v138
  v_add_f32 v137, v137, v139
  s_nop 0
  v_add_f32_dpp v136, v136, v136 row_ror:8 row_mask:0xf bank_mask:0xf
  v_add_f32_dpp v137, v137, v137 row_ror:8 row_mask:0xf bank_mask:0xf
  v_add_f32_dpp v188, v188, v188 row_ror:8 row_mask:0xf bank_mask:0xf
  v_add_f32_dpp v136, v136, v136 row_ror:4 row_mask:0xf bank_mask:0xf
  v_add_f32_dpp v137, v137, v137 row_ror:4 row_mask:0xf bank_mask:0xf
  v_add_f32_dpp v188, v188, v188 row_ror:4 row_mask:0xf bank_mask:0xf
  v_add_f32_dpp v136, v136, v136 row_ror:2 row_mask:0xf bank_mask:0xf
  v_add_f32_dpp v137, v137, v137 row_ror:2 row_mask:0xf bank_mask:0xf
  v_add_f32_dpp v188, v188, v188 row_ror:2 row_mask:0xf bank_mask:0xf
  v_add_f32_dpp v136, v136, v136 row_ror:1 row_mask:0xf bank_mask:0xf
  v_add_f32_dpp v137, v137, v137 row_ror:1 row_mask:0xf bank_mask:0xf
  v_add_f32_dpp v188, v188, v188 row_ror:1 row_mask:0xf bank_mask:0xf
  v_mov_b32 v140, v136
  v_mov_b32 v141, v137
  v_mov_b32 v142, v188
  v_permlane16_swap_b32 v136, v140
  v_permlane16_swap_b32 v137, v141
  v_permlane16_swap_b32 v188, v142
  v_add_f32 v136, v136, v140
  v_add_f32 v137, v137, v141
  v_add_f32 v188, v188, v142
  v_mov_b32 v140, v136
  v_mov_b32 v141, v137
  v_mov_b32 v142, v188
  v_permlane32_swap_b32 v136, v140
  v_permlane32_swap_b32 v137, v141
  v_permlane32_swap_b32 v188, v142
  v_add_f32 v136, v136, v140
  v_add_f32 v137, v137, v141
  v_add_f32 v188, v188, v142
  v_mul_f32 v136, 0x3b000000, v136
  v_mul_f32 v137, 0x3b000000, v137
  v_fma_f32 v137, -v136, v136, v137
  v_cvt_pk_bf16_f32 v136, 0, v136
  v_max_f32 v137, 0, v137
  v_sub_f32 v140, v196, v136
  v_sub_f32 v141, v197, v136
  v_cvt_pk_bf16_f32 v137, 0, v137
  v_sub_f32 v142, v198, v136
  v_sub_f32 v143, v199, v136
  v_add_f32 v137, 0x3727c5ac, v137
  v_sub_f32 v144, v200, v136
  v_sub_f32 v145, v201, v136
  v_cvt_pk_bf16_f32 v137, 0, v137
  v_sub_f32 v146, v202, v136
  v_sub_f32 v147, v203, v136
  v_sqrt_f32 v137, v137
  v_cvt_pk_bf16_f32 v140, 0, v140
  v_cvt_pk_bf16_f32 v141, 0, v141
  v_cvt_pk_bf16_f32 v137, 0, v137
  v_cvt_pk_bf16_f32 v142, 0, v142
  v_cvt_pk_bf16_f32 v143, 0, v143
  v_rcp_f32 v137, v137
  v_cvt_pk_bf16_f32 v144, 0, v144
  v_cvt_pk_bf16_f32 v145, 0, v145
  v_cvt_pk_bf16_f32 v146, 0, v146
  v_cvt_pk_bf16_f32 v147, 0, v147
  v_mul_f32 v140, v140, v137
  v_mul_f32 v141, v141, v137
  v_mul_f32 v142, v142, v137
  v_mul_f32 v143, v143, v137
  v_mul_f32 v144, v144, v137
  v_mul_f32 v145, v145, v137
  v_mul_f32 v146, v146, v137
  v_mul_f32 v147, v147, v137
  v_cvt_pk_bf16_f32 v132, v140, v141
  v_cvt_pk_bf16_f32 v133, v142, v143
  v_cvt_pk_bf16_f32 v134, v144, v145
  v_cvt_pk_bf16_f32 v135, v146, v147
  buffer_store_dwordx4 v[132:135], v0, s[4:7], s93 offen sc1
  v_cvt_pk_bf16_f32 v188, 0, v188
  v_ashrrev_i32 v189, 31, v188
  v_or_b32 v189, 0x80000000, v189
  v_xor_b32 v188, v188, v189
  s_sub_u32 s92, 4095, s90
  v_and_b32 v188, 0xffff0000, v188
  v_or_b32 v38, s92, v188
  s_bfe_u32 s92, s65, 196625
  s_lshl_b32 s92, s92, 18
  s_lshl_b32 s93, s90, 7
  s_add_u32 s92, s92, s93
  s_add_u32 s84, s92, 243269632
  s_waitcnt vmcnt(0)
  s_mov_b64 exec, 1
  buffer_store_dword v38, off, s[4:7], s84 sc1
  s_mov_b64 exec, -1
  s_mov_b32 s84, 268435456
  s_branch o_fd_219
o_rt_223:
  s_mov_b32 s67, 0
o_rl_225:
  s_lshl_b32 s94, s43, 14
  s_add_u32 s94, s94, s86
  buffer_load_dwordx4 v[120:123], v5, s[4:7], s94 offen offset:0 sc1
  buffer_load_dwordx4 v[124:127], v5, s[4:7], s94 offen offset:512 sc1
  buffer_load_dwordx4 v[128:131], v5, s[4:7], s94 offen offset:256 sc1
  buffer_load_dwordx4 v[132:135], v5, s[4:7], s94 offen offset:768 sc1
  s_add_u32 s94, s94, 4096
  buffer_load_dwordx4 v[136:139], v5, s[4:7], s94 offen offset:0 sc1
  buffer_load_dwordx4 v[140:143], v5, s[4:7], s94 offen offset:512 sc1
  buffer_load_dwordx4 v[144:147], v5, s[4:7], s94 offen offset:256 sc1
  buffer_load_dwordx4 v[148:151], v5, s[4:7], s94 offen offset:768 sc1
  s_add_u32 s94, s94, 4096
  buffer_load_dwordx4 v[152:155], v5, s[4:7], s94 offen offset:0 sc1
  buffer_load_dwordx4 v[156:159], v5, s[4:7], s94 offen offset:512 sc1
  buffer_load_dwordx4 v[160:163], v5, s[4:7], s94 offen offset:256 sc1
  buffer_load_dwordx4 v[164:167], v5, s[4:7], s94 offen offset:768 sc1
  s_add_u32 s94, s94, 4096
  buffer_load_dwordx4 v[168:171], v5, s[4:7], s94 offen offset:0 sc1
  buffer_load_dwordx4 v[172:175], v5, s[4:7], s94 offen offset:512 sc1
  buffer_load_dwordx4 v[176:179], v5, s[4:7], s94 offen offset:256 sc1
  buffer_load_dwordx4 v[180:183], v5, s[4:7], s94 offen offset:768 sc1
  s_add_u32 s67, s67, 1
  s_cmp_gt_u32 s67, 1048576
  s_cbranch_scc1 L_end
  s_waitcnt vmcnt(0)
  v_xor_b32 v7, s96, v120
  v_bitop3_b32 v7, v7, v124, s96 bitop3:0xf6
  v_bitop3_b32 v7, v7, v128, s96 bitop3:0xf6
  v_bitop3_b32 v7, v7, v132, s96 bitop3:0xf6
  v_bitop3_b32 v7, v7, v136, s96 bitop3:0xf6
  v_bitop3_b32 v7, v7, v140, s96 bitop3:0xf6
  v_bitop3_b32 v7, v7, v144, s96 bitop3:0xf6
  v_bitop3_b32 v7, v7, v148, s96 bitop3:0xf6
  v_bitop3_b32 v7, v7, v152, s96 bitop3:0xf6
  v_bitop3_b32 v7, v7, v156, s96 bitop3:0xf6
  v_bitop3_b32 v7, v7, v160, s96 bitop3:0xf6
  v_bitop3_b32 v7, v7, v164, s96 bitop3:0xf6
  v_bitop3_b32 v7, v7, v168, s96 bitop3:0xf6
  v_bitop3_b32 v7, v7, v172, s96 bitop3:0xf6
  v_bitop3_b32 v7, v7, v176, s96 bitop3:0xf6
  v_bitop3_b32 v7, v7, v180, s96 bitop3:0xf6
  v_and_b32 v7, v254, v7
  v_cmp_ne_u32 vcc, 0, v7
  s_cbranch_vccnz o_rl_225
  s_branch o_bk_224
o_f2_220:
  s_lshl_b32 s94, s43, 14
  s_add_u32 s94, s94, s86
  buffer_load_dwordx4 v[120:123], v5, s[4:7], s94 offen offset:0 sc1
  buffer_load_dwordx4 v[124:127], v5, s[4:7], s94 offen offset:512 sc1
  buffer_load_dwordx4 v[128:131], v5, s[4:7], s94 offen offset:256 sc1
  buffer_load_dwordx4 v[132:135], v5, s[4:7], s94 offen offset:768 sc1
  s_add_u32 s94, s94, 4096
  buffer_load_dwordx4 v[136:139], v5, s[4:7], s94 offen offset:0 sc1
  buffer_load_dwordx4 v[140:143], v5, s[4:7], s94 offen offset:512 sc1
  buffer_load_dwordx4 v[144:147], v5, s[4:7], s94 offen offset:256 sc1
  buffer_load_dwordx4 v[148:151], v5, s[4:7], s94 offen offset:768 sc1
  s_add_u32 s94, s94, 4096
  buffer_load_dwordx4 v[152:155], v5, s[4:7], s94 offen offset:0 sc1
  buffer_load_dwordx4 v[156:159], v5, s[4:7], s94 offen offset:512 sc1
  buffer_load_dwordx4 v[160:163], v5, s[4:7], s94 offen offset:256 sc1
  buffer_load_dwordx4 v[164:167], v5, s[4:7], s94 offen offset:768 sc1
  s_add_u32 s94, s94, 4096
  buffer_load_dwordx4 v[168:171], v5, s[4:7], s94 offen offset:0 sc1
  buffer_load_dwordx4 v[172:175], v5, s[4:7], s94 offen offset:512 sc1
  buffer_load_dwordx4 v[176:179], v5, s[4:7], s94 offen offset:256 sc1
  buffer_load_dwordx4 v[180:183], v5, s[4:7], s94 offen offset:768 sc1
  s_mov_b64 exec, 1
  buffer_store_dword v38, off, s[4:7], s84 sc1
  s_mov_b64 exec, -1
  s_mov_b32 s84, 268435456
  v_mov_b64 v[188:189], 0
  v_mov_b64 v[190:191], 0
  v_mov_b64 v[192:193], 0
  v_mov_b64 v[194:195], 0
  s_waitcnt vmcnt(13)
  v_xor_b32 v7, s96, v120
  v_bitop3_b32 v7, v7, v124, s96 bitop3:0xf6
  v_bitop3_b32 v7, v7, v128, s96 bitop3:0xf6
  v_bitop3_b32 v7, v7, v132, s96 bitop3:0xf6
  s_waitcnt vmcnt(9)
  v_bitop3_b32 v7, v7, v136, s96 bitop3:0xf6
  v_bitop3_b32 v7, v7, v140, s96 bitop3:0xf6
  v_bitop3_b32 v7, v7, v144, s96 bitop3:0xf6
  v_bitop3_b32 v7, v7, v148, s96 bitop3:0xf6
  s_waitcnt vmcnt(5)
  v_bitop3_b32 v7, v7, v152, s96 bitop3:0xf6
  v_bitop3_b32 v7, v7, v156, s96 bitop3:0xf6
  v_bitop3_b32 v7, v7, v160, s96 bitop3:0xf6
  v_bitop3_b32 v7, v7, v164, s96 bitop3:0xf6
  s_waitcnt vmcnt(1)
  v_bitop3_b32 v7, v7, v168, s96 bitop3:0xf6
  v_bitop3_b32 v7, v7, v172, s96 bitop3:0xf6
  v_bitop3_b32 v7, v7, v176, s96 bitop3:0xf6
  v_bitop3_b32 v7, v7, v180, s96 bitop3:0xf6
  v_and_b32 v7, v254, v7
  v_cmp_ne_u32 vcc, 0, v7
  s_cbranch_vccnz o_rt_226
o_bk_227:
  v_smfmac_f32_16x16x64_bf16 v[188:191], v[16:19], v[120:127], v20
  v_lshlrev_b32 v196, 16, v184
  v_smfmac_f32_16x16x64_bf16 v[192:195], v[16:19], v[128:135], v20
  v_and_b32 v197, 0xffff0000, v184
  v_smfmac_f32_16x16x64_bf16 v[188:191], v[16:19], v[136:143], v20
  v_lshlrev_b32 v198, 16, v185
  v_smfmac_f32_16x16x64_bf16 v[192:195], v[16:19], v[144:151], v20
  v_and_b32 v199, 0xffff0000, v185
  v_smfmac_f32_16x16x64_bf16 v[188:191], v[16:19], v[152:159], v20
  v_lshlrev_b32 v200, 16, v186
  v_smfmac_f32_16x16x64_bf16 v[192:195], v[16:19], v[160:167], v20
  v_and_b32 v201, 0xffff0000, v186
  v_smfmac_f32_16x16x64_bf16 v[188:191], v[16:19], v[168:175], v20
  v_lshlrev_b32 v202, 16, v187
  v_smfmac_f32_16x16x64_bf16 v[192:195], v[16:19], v[176:183], v20
  v_and_b32 v203, 0xffff0000, v187
  s_bfe_u32 s92, s65, 131086
  s_lshl_b32 s92, s92, 21
  s_add_u32 s92, s92, s91
  s_add_u32 s93, s92, 27262976
  s_add_u32 s92, s92, 20971520
  s_nop 1
  v_permlane16_swap_b32 v188, v192
  v_permlane16_swap_b32 v189, v193
  v_permlane16_swap_b32 v190, v194
  v_permlane16_swap_b32 v191, v195
  v_cvt_pk_bf16_f32 v188, 0, v188
  v_cvt_pk_bf16_f32 v189, 0, v189
  v_cvt_pk_bf16_f32 v190, 0, v190
  v_cvt_pk_bf16_f32 v191, 0, v191
  v_cvt_pk_bf16_f32 v192, 0, v192
  v_cvt_pk_bf16_f32 v193, 0, v193
  v_cvt_pk_bf16_f32 v194, 0, v194
  v_cvt_pk_bf16_f32 v195, 0, v195
  v_add_f32 v196, v196, v188
  v_add_f32 v197, v197, v189
  v_add_f32 v198, v198, v190
  v_add_f32 v199, v199, v191
  v_add_f32 v200, v200, v192
  v_add_f32 v201, v201, v193
  v_add_f32 v202, v202, v194
  v_add_f32 v203, v203, v195
  v_cvt_pk_bf16_f32 v120, v196, v197
  v_cvt_pk_bf16_f32 v121, v198, v199
  v_cvt_pk_bf16_f32 v122, v200, v201
  v_cvt_pk_bf16_f32 v123, v202, v203
  v_lshlrev_b32 v196, 16, v120
  v_and_b32 v197, 0xffff0000, v120
  v_lshlrev_b32 v198, 16, v121
  v_and_b32 v199, 0xffff0000, v121
  v_lshlrev_b32 v200, 16, v122
  v_and_b32 v201, 0xffff0000, v122
  v_lshlrev_b32 v202, 16, v123
  v_and_b32 v203, 0xffff0000, v123
  buffer_store_dwordx4 v[120:123], v0, s[4:7], s92 offen sc1
  v_add_f32 v136, v196, v197
  v_mul_f32 v137, v196, v196
  v_add_f32 v138, v198, v199
  v_mul_f32 v139, v197, v197
  v_fmac_f32 v137, v198, v198
  v_fmac_f32 v139, v199, v199
  v_add_f32 v136, v136, v200
  v_fmac_f32 v137, v200, v200
  v_add_f32 v138, v138, v201
  v_fmac_f32 v139, v201, v201
  v_add_f32 v136, v136, v202
  v_fmac_f32 v137, v202, v202
  v_add_f32 v138, v138, v203
  v_fmac_f32 v139, v203, v203
  v_add_f32 v136, v136, v138
  v_add_f32 v137, v137, v139
  s_nop 0
  v_add_f32_dpp v136, v136, v136 row_ror:8 row_mask:0xf bank_mask:0xf
  v_add_f32_dpp v137, v137, v137 row_ror:8 row_mask:0xf bank_mask:0xf
  s_nop 0
  v_add_f32_dpp v136, v136, v136 row_ror:4 row_mask:0xf bank_mask:0xf
  v_add_f32_dpp v137, v137, v137 row_ror:4 row_mask:0xf bank_mask:0xf
  s_nop 0
  v_add_f32_dpp v136, v136, v136 row_ror:2 row_mask:0xf bank_mask:0xf
  v_add_f32_dpp v137, v137, v137 row_ror:2 row_mask:0xf bank_mask:0xf
  s_nop 0
  v_add_f32_dpp v136, v136, v136 row_ror:1 row_mask:0xf bank_mask:0xf
  v_add_f32_dpp v137, v137, v137 row_ror:1 row_mask:0xf bank_mask:0xf
  v_mov_b32 v140, v136
  v_mov_b32 v141, v137
  s_nop 0
  v_permlane16_swap_b32 v136, v140
  v_permlane16_swap_b32 v137, v141
  v_add_f32 v136, v136, v140
  v_add_f32 v137, v137, v141
  v_mov_b32 v140, v136
  v_mov_b32 v141, v137
  s_nop 0
  v_permlane32_swap_b32 v136, v140
  v_permlane32_swap_b32 v137, v141
  v_add_f32 v136, v136, v140
  v_add_f32 v137, v137, v141
  v_mul_f32 v136, 0x3b000000, v136
  v_mul_f32 v137, 0x3b000000, v137
  v_fma_f32 v137, -v136, v136, v137
  v_cvt_pk_bf16_f32 v136, 0, v136
  v_max_f32 v137, 0, v137
  v_sub_f32 v140, v196, v136
  v_sub_f32 v141, v197, v136
  v_cvt_pk_bf16_f32 v137, 0, v137
  v_sub_f32 v142, v198, v136
  v_sub_f32 v143, v199, v136
  v_add_f32 v137, 0x3727c5ac, v137
  v_sub_f32 v144, v200, v136
  v_sub_f32 v145, v201, v136
  v_cvt_pk_bf16_f32 v137, 0, v137
  v_sub_f32 v146, v202, v136
  v_sub_f32 v147, v203, v136
  v_sqrt_f32 v137, v137
  v_cvt_pk_bf16_f32 v140, 0, v140
  v_cvt_pk_bf16_f32 v141, 0, v141
  v_cvt_pk_bf16_f32 v137, 0, v137
  v_cvt_pk_bf16_f32 v142, 0, v142
  v_cvt_pk_bf16_f32 v143, 0, v143
  v_rcp_f32 v137, v137
  v_cvt_pk_bf16_f32 v144, 0, v144
  v_cvt_pk_bf16_f32 v145, 0, v145
  v_cvt_pk_bf16_f32 v146, 0, v146
  v_cvt_pk_bf16_f32 v147, 0, v147
  v_mul_f32 v140, v140, v137
  v_mul_f32 v141, v141, v137
  v_mul_f32 v142, v142, v137
  v_mul_f32 v143, v143, v137
  v_mul_f32 v144, v144, v137
  v_mul_f32 v145, v145, v137
  v_mul_f32 v146, v146, v137
  v_mul_f32 v147, v147, v137
  v_cvt_pk_bf16_f32 v124, v140, v141
  v_cvt_pk_bf16_f32 v125, v142, v143
  v_cvt_pk_bf16_f32 v126, v144, v145
  v_cvt_pk_bf16_f32 v127, v146, v147
  v_lshlrev_b32 v204, 16, v124
  v_and_b32 v205, 0xffff0000, v124
  v_lshlrev_b32 v206, 16, v125
  v_and_b32 v207, 0xffff0000, v125
  v_lshlrev_b32 v208, 16, v126
  v_and_b32 v209, 0xffff0000, v126
  v_lshlrev_b32 v210, 16, v127
  v_and_b32 v211, 0xffff0000, v127
  buffer_store_dwordx4 v[124:127], v0, s[4:7], s93 offen sc1
  v_add_f32 v196, v196, v204
  v_add_f32 v197, v197, v205
  v_add_f32 v198, v198, v206
  v_add_f32 v199, v199, v207
  v_add_f32 v200, v200, v208
  v_add_f32 v201, v201, v209
  v_add_f32 v202, v202, v210
  v_add_f32 v203, v203, v211
  v_cvt_pk_bf16_f32 v128, v196, v197
  v_cvt_pk_bf16_f32 v129, v198, v199
  v_cvt_pk_bf16_f32 v130, v200, v201
  v_cvt_pk_bf16_f32 v131, v202, v203
  v_mul_f32 v188, v204, v8
  v_mul_f32 v189, v205, v9
  v_fmac_f32 v188, v206, v10
  v_fmac_f32 v189, v207, v11
  v_fmac_f32 v188, v208, v12
  v_fmac_f32 v189, v209, v13
  v_fmac_f32 v188, v210, v14
  v_fmac_f32 v189, v211, v15
  v_add_f32 v188, v188, v189
  buffer_store_dwordx4 v[128:131], v0, s[68:71], s91 offen sc1
  s_nop 0
  v_add_f32_dpp v188, v188, v188 row_ror:8 row_mask:0xf bank_mask:0xf
  s_nop 1
  v_add_f32_dpp v188, v188, v188 row_ror:4 row_mask:0xf bank_mask:0xf
  s_nop 1
  v_add_f32_dpp v188, v188, v188 row_ror:2 row_mask:0xf bank_mask:0xf
  s_nop 1
  v_add_f32_dpp v188, v188, v188 row_ror:1 row_mask:0xf bank_mask:0xf
  v_mov_b32 v189, v188
  s_nop 0
  s_nop 0
  v_permlane16_swap_b32 v188, v189
  v_add_f32 v188, v188, v189
  v_mov_b32 v189, v188
  s_nop 0
  s_nop 0
  v_permlane32_swap_b32 v188, v189
  v_add_f32 v188, v188, v189
  v_cvt_pk_bf16_f32 v188, 0, v188
  v_ashrrev_i32 v189, 31, v188
  v_or_b32 v189, 0x80000000, v189
  v_xor_b32 v188, v188, v189
  s_sub_u32 s92, 4095, s90
  v_and_b32 v188, 0xffff0000, v188
  v_or_b32 v38, s92, v188
  s_bfe_u32 s92, s65, 196625
  s_lshl_b32 s92, s92, 18
  s_lshl_b32 s93, s90, 7
  s_add_u32 s92, s92, s93
  s_add_u32 s84, s92, 243269632
  s_waitcnt vmcnt(0)
  s_mov_b64 exec, 1
  buffer_store_dword v38, off, s[4:7], s84 sc1
  s_mov_b64 exec, -1
  s_mov_b32 s84, 268435456
  s_branch o_fd_219
o_rt_226:
  s_mov_b32 s67, 0
o_rl_228:
  s_lshl_b32 s94, s43, 14
  s_add_u32 s94, s94, s86
  buffer_load_dwordx4 v[120:123], v5, s[4:7], s94 offen offset:0 sc1
  buffer_load_dwordx4 v[124:127], v5, s[4:7], s94 offen offset:512 sc1
  buffer_load_dwordx4 v[128:131], v5, s[4:7], s94 offen offset:256 sc1
  buffer_load_dwordx4 v[132:135], v5, s[4:7], s94 offen offset:768 sc1
  s_add_u32 s94, s94, 4096
  buffer_load_dwordx4 v[136:139], v5, s[4:7], s94 offen offset:0 sc1
  buffer_load_dwordx4 v[140:143], v5, s[4:7], s94 offen offset:512 sc1
  buffer_load_dwordx4 v[144:147], v5, s[4:7], s94 offen offset:256 sc1
  buffer_load_dwordx4 v[148:151], v5, s[4:7], s94 offen offset:768 sc1
  s_add_u32 s94, s94, 4096
  buffer_load_dwordx4 v[152:155], v5, s[4:7], s94 offen offset:0 sc1
  buffer_load_dwordx4 v[156:159], v5, s[4:7], s94 offen offset:512 sc1
  buffer_load_dwordx4 v[160:163], v5, s[4:7], s94 offen offset:256 sc1
  buffer_load_dwordx4 v[164:167], v5, s[4:7], s94 offen offset:768 sc1
  s_add_u32 s94, s94, 4096
  buffer_load_dwordx4 v[168:171], v5, s[4:7], s94 offen offset:0 sc1
  buffer_load_dwordx4 v[172:175], v5, s[4:7], s94 offen offset:512 sc1
  buffer_load_dwordx4 v[176:179], v5, s[4:7], s94 offen offset:256 sc1
  buffer_load_dwordx4 v[180:183], v5, s[4:7], s94 offen offset:768 sc1
  s_add_u32 s67, s67, 1
  s_cmp_gt_u32 s67, 1048576
  s_cbranch_scc1 L_end
  s_waitcnt vmcnt(0)
  v_xor_b32 v7, s96, v120
  v_bitop3_b32 v7, v7, v124, s96 bitop3:0xf6
  v_bitop3_b32 v7, v7, v128, s96 bitop3:0xf6
  v_bitop3_b32 v7, v7, v132, s96 bitop3:0xf6
  v_bitop3_b32 v7, v7, v136, s96 bitop3:0xf6
  v_bitop3_b32 v7, v7, v140, s96 bitop3:0xf6
  v_bitop3_b32 v7, v7, v144, s96 bitop3:0xf6
  v_bitop3_b32 v7, v7, v148, s96 bitop3:0xf6
  v_bitop3_b32 v7, v7, v152, s96 bitop3:0xf6
  v_bitop3_b32 v7, v7, v156, s96 bitop3:0xf6
  v_bitop3_b32 v7, v7, v160, s96 bitop3:0xf6
  v_bitop3_b32 v7, v7, v164, s96 bitop3:0xf6
  v_bitop3_b32 v7, v7, v168, s96 bitop3:0xf6
  v_bitop3_b32 v7, v7, v172, s96 bitop3:0xf6
  v_bitop3_b32 v7, v7, v176, s96 bitop3:0xf6
  v_bitop3_b32 v7, v7, v180, s96 bitop3:0xf6
  v_and_b32 v7, v254, v7
  v_cmp_ne_u32 vcc, 0, v7
  s_cbranch_vccnz o_rl_228
  s_branch o_bk_227
o_fd_219:
  s_mov_b32 s65, 0
o_nofl_179:
  s_mov_b32 s63, s64
  s_cmp_lg_u32 s51, 0
  s_cbranch_scc1 o_pick_181
  s_cmp_eq_u32 s50, 0
  s_cbranch_scc1 o_help_188_n
o_adv_187:
  s_add_u32 s49, s49, 4
  s_branch o_round_177
o_dl_189_a:
  s_andn2_b32 s26, s58, s55
  s_and_b32 s29, s26, s54
  s_bcnt1_i32_b32 s27, s29
  s_add_u32 s27, s27, 2
  s_max_u32 s27, s27, 4
  s_andn2_b32 s26, s26, s56
  s_and_b32 s26, s26, 0x3fff
  s_or_b32 s26, s26, s29
  s_cselect_b32 s27, s27, 0
  s_mul_i32 s27, s27, 0
  s_cmp_ge_u32 s46, s89
  s_cselect_b32 s30, s54, -1
  s_mov_b32 s31, 243269696
  s_branch o_dl_189_b
o_dl_189:
  s_and_b32 s26, s55, s54
  s_andn2_b32 s27, s56, s54
  s_or_b32 s26, s26, s27
  s_andn2_b32 s26, s58, s26
  s_bcnt1_i32_b32 s27, s26
  s_bcnt1_i32_b32 s28, s47
  s_mul_i32 s28, s28, -5
  s_lshl1_add_u32 s27, s27, s28
  s_add_i32 s27, s27, 1
  s_max_i32 s27, s27, 0
  s_mul_i32 s27, s27, 37
  s_mov_b32 s30, s54
  s_mov_b32 s31, 243269704
  s_and_b32 s29, s26, s47
  s_andn2_b32 s26, s26, s29
  s_branch o_dl_189_c
o_dl_189_b:
  s_mov_b32 s29, 0
o_dl_189_c:
  s_bfe_u32 s28, s48, 262144
  s_bitset0_b32 s26, s28
  s_bfe_u32 s28, s48, 262148
  s_bitset0_b32 s26, s28
  s_bfe_u32 s28, s48, 262152
  s_bitset0_b32 s26, s28
  s_bfe_u32 s28, s48, 262156
  s_bitset0_b32 s26, s28
  s_lshr_b32 s27, s27, 8
o_dl1_190:
  s_cbranch_scc0 o_dl2_191
  s_ff1_i32_b32 s28, s26
  s_bitset0_b32 s26, s28
  s_bitset1_b32 s29, s28
  s_sub_u32 s27, s27, 1
  s_cmp_lg_u32 s27, 0
  s_branch o_dl1_190
o_dl2_191:
  s_and_b32 s47, s29, 0xffff
  s_and_b32 s30, s30, s47
  s_or_b32 s55, s55, s30
  s_andn2_b32 s26, s47, s30
  s_or_b32 s56, s56, s26
  s_pack_ll_b32_b16 s26, s47, s30
  s_lshl_b32 s27, s60, 7
  s_add_u32 s27, s27, s31
  s_cmp_lg_u32 s43, 0
  s_cbranch_scc1 o_pick_181
  v_mov_b32 v162, s26
  v_mov_b32 v163, s46
  s_mov_b64 exec, 1
  buffer_store_dwordx2 v[162:163], off, s[4:7], s27 sc1
  s_mov_b64 exec, -1
  s_branch o_pick_181
o_help_188:
  s_lshl_b32 s60, s60, 1
  s_and_b32 s60, s60, 2
  s_lshl_b32 s47, s60, 7
  s_add_u32 s47, s47, 243269688
o_help_188_n:
  s_add_u32 s47, s47, 8
  s_lshr_b32 s26, s47, 4
  s_andn2_b32 s26, s57, s26
  s_cbranch_scc0 L_end
  s_mov_b32 s67, 0
o_help_188_w:
  buffer_load_dwordx2 v[162:163], off, s[4:7], s47 sc1
  buffer_load_dwordx2 v[164:165], off, s[4:7], s47 offset:128 sc1
  s_add_u32 s67, s67, 1
  s_cmp_gt_u32 s67, 1048576
  s_cbranch_scc1 L_end
  s_waitcnt vmcnt(0)
  v_readfirstlane_b32 s28, v162
  v_readfirstlane_b32 s30, v164
  v_readfirstlane_b32 s46, v163
  v_readfirstlane_b32 s27, v165
  s_min_u32 s26, s46, s27
  s_cmp_eq_u32 s26, 0
  s_cbranch_scc1 o_help_188_w
  s_max_u32 s46, s46, s27
  s_bitreplicate_b64_b32 s[28:29], s28
  s_bitreplicate_b64_b32 s[30:31], s30
  s_mov_b32 s26, 0x55555555
  s_mov_b32 s27, 0x55555555
  s_and_b64 s[28:29], s[28:29], s[26:27]
  s_andn2_b64 s[30:31], s[30:31], s[26:27]
  s_or_b32 s58, s28, s30
  s_or_b32 s54, s29, s31
  s_andn2_b32 s52, 0xfff, s46
  s_lshr_b32 s52, s52, 5
  s_mov_b32 s53, 0
  s_mov_b32 s63, 0
  s_mov_b32 s49, 72
  s_mov_b32 s59, 64
  s_mov_b32 s50, 0
  s_mov_b32 s89, 0
  s_branch o_pick_181

.section .rodata,"a"
.p2align 6
.amdhsa_kernel interleave_layers__memory_aug_recurrent_mem_tr__moe_arch_mod__prompt_kernel
  .amdhsa_next_free_vgpr 512
  .amdhsa_next_free_sgpr 102
  .amdhsa_accum_offset 256
  .amdhsa_group_segment_fixed_size 0
  .amdhsa_kernarg_size 120
  .amdhsa_user_sgpr_count 2
  .amdhsa_user_sgpr_kernarg_segment_ptr 1
  .amdhsa_system_sgpr_workgroup_id_x 1
  .amdhsa_float_denorm_mode_32 3
.end_amdhsa_kernel
```

```asm
; @launch grid=(256,1,1) block=(256,1,1) lds=163840
.amdgcn_target "amdgcn-amd-amdhsa--gfx950"
.text
.globl interleave_layers__memory_aug_recurrent_mem_tr__moe_arch_mod__prompt_kernel
.p2align 8
.type interleave_layers__memory_aug_recurrent_mem_tr__moe_arch_mod__prompt_kernel,@function
interleave_layers__memory_aug_recurrent_mem_tr__moe_arch_mod__prompt_kernel:
  s_cmp_ge_u32 s2, 256
  s_cbranch_scc1 L_end
  s_mov_b32 s6, 268435456
  s_mov_b32 s7, 0x20000
  s_mov_b32 s11, 0x20000
  s_getreg_b32 s89, hwreg(HW_REG_XCC_ID)
  s_and_b32 s89, s89, 7
  v_lshrrev_b32 v1, 6, v0
  s_and_b32 s91, s2, 7
  s_lshr_b32 s90, s2, 3
  v_readfirstlane_b32 s17, v1
  s_lshl_b32 s100, s91, 5
  s_add_u32 s100, s100, s90
  s_lshl_b32 s100, s100, 2
  s_add_u32 s100, s100, s17
  s_lshl_b32 s100, s100, 12
  s_add_u32 s100, s100, 37748736
  s_cmp_lt_u32 s91, 3
  s_cbranch_scc1 L_chain
  s_cmp_eq_u32 s91, 7
  s_cbranch_scc1 L_qkv
  s_bitcmp1_b32 s90, 4
  s_cbranch_scc1 L_qkv
  s_branch L_o
L_end:
  s_endpgm
L_chain:
  s_load_dwordx2 s[4:5], s[0:1], 112
  s_load_dwordx2 s[12:13], s[0:1], 104
  s_mov_b32 s16, s90
  s_mov_b32 s60, s91
  s_min_u32 s61, s91, 1
  v_lshrrev_b32 v18, 6, v0
  v_and_b32 v19, 63, v0
  v_readfirstlane_b32 s17, v18
  v_and_b32 v7, 15, v19
  v_lshrrev_b32 v17, 4, v19
  v_lshlrev_b32 v0, 4, v19
  s_load_dwordx2 s[56:57], s[0:1], 8
  s_mov_b32 s44, 0x05040100
  s_mov_b32 s45, 0x07060302
  s_mov_b32 s18, 0xcccccccc
  s_mov_b32 s19, 0xcccccccc
  s_mov_b32 s24, 0x3e0293ee
  s_lshl_b32 s26, s17, 10
  v_add_u32 v8, s26, v0
  v_xor_b32 v9, 1024, v8
  v_xor_b32 v10, 2048, v8
  v_xor_b32 v11, 3072, v8
  s_mov_b32 s14, 0x3f803f80
  s_mov_b32 s15, 0x3f803f80
  s_mul_i32 s27, s17, 24576
  s_add_u32 s27, s27, 65536
  v_add_u32 v1, s27, v0
  v_lshrrev_b32 v20, 2, v7
  v_xor_b32 v21, v17, v20
  v_lshlrev_b32 v22, 5, v7
  v_add_u32 v22, s26, v22
  v_lshl_add_u32 v2, v21, 3, v22
  v_and_b32 v21, 3, v7
  v_xor_b32 v21, v21, v17
  v_lshl_add_u32 v22, v17, 2, v20
  v_lshlrev_b32 v22, 5, v22
  v_lshl_add_u32 v3, v21, 3, v22
  v_add_u32 v12, s26, v3
  v_xor_b32 v13, 1024, v12
  v_xor_b32 v14, 2048, v12
  v_xor_b32 v15, 3072, v12
  v_lshlrev_b32 v21, 13, v20
  v_and_b32 v22, 3, v7
  v_lshl_add_u32 v22, v17, 2, v22
  v_lshl_add_u32 v21, v22, 4, v21
  s_lshl_b32 s27, s17, 16
  s_lshl_b32 s28, s16, 8
  s_add_u32 s27, s27, s28
  v_add_u32 v4, s27, v21
  v_and_b32 v21, 1, v7
  v_lshl_add_u32 v21, v17, 2, v21
  v_bfe_u32 v22, v7, 2, 1
  v_lshl_add_u32 v21, v22, 1, v21
  v_lshlrev_b32 v21, 4, v21
  v_bfe_u32 v22, v7, 1, 1
  v_lshl_add_u32 v21, v22, 3, v21
  v_add_u32 v5, s28, v21
  v_cmp_lt_u32 vcc, 7, v7
  v_mov_b32 v22, 0x7ff00000
  s_nop 0
  v_cndmask_b32 v5, v5, v22, vcc
  v_mov_b32 v21, 0x4444
  v_mov_b32 v22, 0xeeee
  v_cndmask_b32 v6, v21, v22, s[18:19]
  s_lshl_b32 s40, s60, 20
  s_add_u32 s40, s40, 0
  s_add_u32 s41, s40, 32768
  s_lshl_b32 s62, s60, 16
  s_add_u32 s62, s62, 4194304
  v_mov_b32 v24, -1
  v_mov_b32 v25, -1
  v_mov_b32 v26, -1
  v_mov_b32 v27, -1
  s_waitcnt lgkmcnt(0)
  buffer_store_dwordx4 v[24:27], v4, s[4:7], s40 offen sc1
  buffer_store_dwordx4 v[24:27], v4, s[4:7], s41 offen sc1
  s_add_u32 s27, s62, 0
  buffer_store_dwordx2 v[24:25], v5, s[4:7], s27 offen sc1
  s_add_u32 s27, s62, 8192
  buffer_store_dwordx2 v[24:25], v5, s[4:7], s27 offen sc1
  s_add_u32 s27, s62, 16384
  buffer_store_dwordx2 v[24:25], v5, s[4:7], s27 offen sc1
  s_add_u32 s27, s62, 24576
  buffer_store_dwordx2 v[24:25], v5, s[4:7], s27 offen sc1
  v_mov_b64 v[28:29], 0
  v_mov_b64 v[30:31], 0
  s_lshl_b32 s26, s16, 12
  s_cmp_eq_u32 s91, 0
  s_cbranch_scc1 L_ch1
  s_cmp_eq_u32 s91, 2
  s_cbranch_scc1 L_ch2
  s_add_u32 s27, s26, 243269632
  buffer_store_dwordx4 v[28:31], v8, s[4:7], s27 offen sc1
  s_add_u32 s27, s26, 243400704
  buffer_store_dwordx4 v[28:31], v8, s[4:7], s27 offen sc1
  s_add_u32 s27, s26, 243531776
  buffer_store_dwordx4 v[28:31], v8, s[4:7], s27 offen sc1
  s_add_u32 s27, s26, 243662848
  buffer_store_dwordx4 v[28:31], v8, s[4:7], s27 offen sc1
  s_add_u32 s27, s26, 243793920
  buffer_store_dwordx4 v[28:31], v8, s[4:7], s27 offen sc1
  s_add_u32 s27, s26, 243924992
  buffer_store_dwordx4 v[28:31], v8, s[4:7], s27 offen sc1
  s_add_u32 s27, s26, 244056064
  buffer_store_dwordx4 v[28:31], v8, s[4:7], s27 offen sc1
  s_add_u32 s27, s26, 244187136
  buffer_store_dwordx4 v[28:31], v8, s[4:7], s27 offen sc1
  s_add_u32 s27, s26, 244318208
  buffer_store_dwordx4 v[28:31], v8, s[4:7], s27 offen sc1
  s_add_u32 s27, s26, 244449280
  buffer_store_dwordx4 v[28:31], v8, s[4:7], s27 offen sc1
  s_add_u32 s27, s26, 244580352
  buffer_store_dwordx4 v[28:31], v8, s[4:7], s27 offen sc1
  s_add_u32 s27, s26, 244711424
  buffer_store_dwordx4 v[28:31], v8, s[4:7], s27 offen sc1
  s_add_u32 s27, s26, 244842496
  buffer_store_dwordx4 v[28:31], v8, s[4:7], s27 offen sc1
  s_add_u32 s27, s26, 244973568
  buffer_store_dwordx4 v[28:31], v8, s[4:7], s27 offen sc1
  s_add_u32 s27, s26, 245104640
  buffer_store_dwordx4 v[28:31], v8, s[4:7], s27 offen sc1
  s_add_u32 s27, s26, 245235712
  buffer_store_dwordx4 v[28:31], v8, s[4:7], s27 offen sc1
  s_add_u32 s27, s26, 245366784
  buffer_store_dwordx4 v[28:31], v8, s[4:7], s27 offen sc1
  s_branch L_ch0
L_ch2:
  s_add_u32 s27, s26, 245891072
  buffer_store_dwordx4 v[24:27], v8, s[4:7], s27 offen sc1
  s_add_u32 s27, s26, 246022144
  buffer_store_dwordx4 v[24:27], v8, s[4:7], s27 offen sc1
  s_add_u32 s27, s26, 246153216
  buffer_store_dwordx4 v[24:27], v8, s[4:7], s27 offen sc1
  s_add_u32 s27, s26, 246284288
  buffer_store_dwordx4 v[24:27], v8, s[4:7], s27 offen sc1
  s_add_u32 s27, s26, 246415360
  buffer_store_dwordx4 v[24:27], v8, s[4:7], s27 offen sc1
  s_add_u32 s27, s26, 246546432
  buffer_store_dwordx4 v[24:27], v8, s[4:7], s27 offen sc1
  s_add_u32 s27, s26, 246677504
  buffer_store_dwordx4 v[24:27], v8, s[4:7], s27 offen sc1
  s_add_u32 s27, s26, 246808576
  buffer_store_dwordx4 v[24:27], v8, s[4:7], s27 offen sc1
  s_add_u32 s27, s26, 246939648
  buffer_store_dwordx4 v[24:27], v8, s[4:7], s27 offen sc1
  s_add_u32 s27, s26, 247070720
  buffer_store_dwordx4 v[24:27], v8, s[4:7], s27 offen sc1
  s_add_u32 s27, s26, 247201792
  buffer_store_dwordx4 v[24:27], v8, s[4:7], s27 offen sc1
  s_add_u32 s27, s26, 247332864
  buffer_store_dwordx4 v[24:27], v8, s[4:7], s27 offen sc1
  s_add_u32 s27, s26, 247463936
  buffer_store_dwordx4 v[24:27], v8, s[4:7], s27 offen sc1
  s_add_u32 s27, s26, 247595008
  buffer_store_dwordx4 v[24:27], v8, s[4:7], s27 offen sc1
  s_add_u32 s27, s26, 247726080
  buffer_store_dwordx4 v[24:27], v8, s[4:7], s27 offen sc1
  s_add_u32 s27, s26, 247857152
  buffer_store_dwordx4 v[24:27], v8, s[4:7], s27 offen sc1
  s_add_u32 s27, s26, 247988224
  buffer_store_dwordx4 v[24:27], v8, s[4:7], s27 offen sc1
  s_add_u32 s27, s26, 248119296
  buffer_store_dwordx4 v[24:27], v8, s[4:7], s27 offen sc1
  s_add_u32 s27, s26, 248250368
  buffer_store_dwordx4 v[24:27], v8, s[4:7], s27 offen sc1
  s_add_u32 s27, s26, 248381440
  buffer_store_dwordx4 v[24:27], v8, s[4:7], s27 offen sc1
  s_add_u32 s27, s26, 248512512
  buffer_store_dwordx4 v[24:27], v8, s[4:7], s27 offen sc1
  s_add_u32 s27, s26, 248643584
  buffer_store_dwordx4 v[24:27], v8, s[4:7], s27 offen sc1
  s_add_u32 s27, s26, 16777216
  buffer_store_dwordx4 v[28:31], v8, s[4:7], s27 offen sc1
  s_add_u32 s27, s26, 16908288
  buffer_store_dwordx4 v[28:31], v8, s[4:7], s27 offen sc1
  s_add_u32 s27, s26, 17039360
  buffer_store_dwordx4 v[28:31], v8, s[4:7], s27 offen sc1
  s_add_u32 s27, s26, 17170432
  buffer_store_dwordx4 v[28:31], v8, s[4:7], s27 offen sc1
  s_add_u32 s27, s26, 17301504
  buffer_store_dwordx4 v[28:31], v8, s[4:7], s27 offen sc1
  s_add_u32 s27, s26, 17432576
  buffer_store_dwordx4 v[28:31], v8, s[4:7], s27 offen sc1
  s_add_u32 s27, s26, 17563648
  buffer_store_dwordx4 v[28:31], v8, s[4:7], s27 offen sc1
  s_add_u32 s27, s26, 17694720
  buffer_store_dwordx4 v[28:31], v8, s[4:7], s27 offen sc1
  s_add_u32 s27, s26, 17825792
  buffer_store_dwordx4 v[28:31], v8, s[4:7], s27 offen sc1
  s_add_u32 s27, s26, 17956864
  buffer_store_dwordx4 v[28:31], v8, s[4:7], s27 offen sc1
  s_add_u32 s27, s26, 18087936
  buffer_store_dwordx4 v[28:31], v8, s[4:7], s27 offen sc1
  s_add_u32 s27, s26, 18219008
  buffer_store_dwordx4 v[28:31], v8, s[4:7], s27 offen sc1
  s_add_u32 s27, s26, 18350080
  buffer_store_dwordx4 v[28:31], v8, s[4:7], s27 offen sc1
  s_add_u32 s27, s26, 18481152
  buffer_store_dwordx4 v[28:31], v8, s[4:7], s27 offen sc1
  s_add_u32 s27, s26, 18612224
  buffer_store_dwordx4 v[28:31], v8, s[4:7], s27 offen sc1
  s_add_u32 s27, s26, 18743296
  buffer_store_dwordx4 v[28:31], v8, s[4:7], s27 offen sc1
L_ch0:
  s_waitcnt vmcnt(0)
  s_barrier
  s_cmp_lg_u32 s17, 0
  s_cbranch_scc1 g_ar_1
  s_lshl_b32 s36, s89, 3
  s_lshl_b64 s[36:37], 1, s36
  v_lshlrev_b32 v124, 3, s91
  v_mov_b32 v120, s36
  v_mov_b32 v121, s37
  s_mov_b64 exec, 1
  global_atomic_add_x2 v[122:123], v124, v[120:121], s[12:13] sc0
  s_mov_b64 exec, -1
g_ar_1:
  s_waitcnt vmcnt(0)
  s_cmp_lg_u32 s17, 0
  s_cbranch_scc1 g_af_2
  v_readfirstlane_b32 s36, v122
  v_readfirstlane_b32 s37, v123
  s_add_u32 s38, s36, s37
  s_mul_i32 s38, s38, 0x01010101
  s_lshr_b32 s38, s38, 24
  s_cmp_lg_u32 s38, 31
  s_cbranch_scc1 g_af_2
  s_lshl_b32 s38, s89, 3
  s_lshr_b64 s[36:37], s[36:37], s38
  s_and_b32 s36, s36, 0xff
  s_cmp_eq_u32 s36, 31
  s_cselect_b32 s36, 1, 2
  v_mov_b32 v120, s36
  v_lshrrev_b32 v124, 1, v124
  s_mov_b64 exec, 1
  global_store_dword v124, v120, s[12:13] offset:128 sc1
  s_mov_b64 exec, -1
g_af_2:
L_ch1:
  s_mov_b32 s58, 8192
  s_mov_b32 s59, 0x20000
  v_and_b32 v21, 1, v7
  v_lshl_add_u32 v21, v17, 1, v21
  v_lshlrev_b32 v21, 10, v21
  v_bfe_u32 v22, v7, 1, 2
  v_lshl_add_u32 v21, v22, 1, v21
  s_lshr_b32 s27, s16, 3
  s_lshl_b32 s27, s27, 8
  s_and_b32 s28, s16, 3
  s_lshl_b32 s28, s28, 6
  s_add_u32 s27, s27, s28
  s_and_b32 s28, s16, 4
  s_lshl_b32 s28, s28, 1
  s_add_u32 s27, s27, s28
  s_waitcnt lgkmcnt(0)
  buffer_load_ushort v28, v21, s[56:59], s27 offen offset:0
  buffer_load_ushort v29, v21, s[56:59], s27 offen offset:16
  buffer_load_ushort v30, v21, s[56:59], s27 offen offset:32
  buffer_load_ushort v31, v21, s[56:59], s27 offen offset:48
  s_cmp_eq_u32 s91, 0
  s_cbranch_scc1 L_ha
  v_mbcnt_lo_u32_b32 v116, -1, 0
  v_and_b32 v116, 0, v116
  v_add_lshl_u32 v116, v116, 1, 2
  s_mov_b32 s26, 0
g_wt_3:
  global_load_dword v117, v116, s[12:13] offset:128 sc1
  s_add_u32 s26, s26, 1
  s_cmp_gt_u32 s26, 1048576
  s_cbranch_scc1 L_end
  s_waitcnt vmcnt(0)
  v_cmp_eq_u32 vcc, 0, v117
  v_readfirstlane_b32 s27, v117
  s_cbranch_vccnz g_wt_3
  s_and_b32 s28, s16, 28
  s_or_b32 s28, s28, 1
  s_lshl_b32 s27, s28, 6
  s_add_u32 s27, s27, 245104640
  s_mov_b32 s26, 0
g_h_4:
  buffer_load_dwordx2 v[116:117], off, s[4:7], s27 sc1
  s_add_u32 s26, s26, 1
  s_cmp_gt_u32 s26, 1048576
  s_cbranch_scc1 L_end
  s_waitcnt vmcnt(0)
  v_and_or_b32 v116, v117, -1, v116
  v_cmp_eq_u32 vcc, 0, v116
  s_cbranch_vccnz g_h_4
L_ha:
  s_load_dwordx2 s[8:9], s[0:1], 40
  s_load_dwordx2 s[52:53], s[0:1], 16
  s_load_dwordx2 s[32:33], s[0:1], 24
  s_load_dwordx2 s[48:49], s[0:1], 32
  s_mov_b32 s10, 4194304
  s_mov_b32 s11, 0x20000
  s_mov_b32 s54, 4194304
  s_mov_b32 s55, 0x20000
  s_mov_b32 s34, 4194304
  s_mov_b32 s35, 0x20000
  s_mov_b32 s50, 4194304
  s_mov_b32 s51, 0x20000
  v_and_b32 v20, 1, v17
  v_lshlrev_b32 v20, 5, v20
  v_lshrrev_b32 v21, 1, v17
  v_lshl_add_u32 v20, v21, 2, v20
  v_lshlrev_b32 v20, 10, v20
  v_lshl_add_u32 v20, v7, 4, v20
  s_lshl_b32 s26, s16, 17
  s_lshl_b32 s27, s17, 8
  s_add_u32 s26, s26, s27
  s_waitcnt lgkmcnt(0)
  s_add_u32 s27, s26, 0
  buffer_load_dwordx4 v[128:131], v20, s[8:11], s27 offen
  s_add_u32 s27, s26, 1024
  buffer_load_dwordx4 v[132:135], v20, s[8:11], s27 offen
  s_add_u32 s27, s26, 16384
  buffer_load_dwordx4 v[136:139], v20, s[8:11], s27 offen
  s_add_u32 s27, s26, 17408
  buffer_load_dwordx4 v[140:143], v20, s[8:11], s27 offen
  s_add_u32 s27, s26, 2048
  buffer_load_dwordx4 v[144:147], v20, s[8:11], s27 offen
  s_add_u32 s27, s26, 3072
  buffer_load_dwordx4 v[148:151], v20, s[8:11], s27 offen
  s_add_u32 s27, s26, 18432
  buffer_load_dwordx4 v[152:155], v20, s[8:11], s27 offen
  s_add_u32 s27, s26, 19456
  buffer_load_dwordx4 v[156:159], v20, s[8:11], s27 offen
  s_add_u32 s27, s26, 8192
  buffer_load_dwordx4 v[160:163], v20, s[8:11], s27 offen
  s_add_u32 s27, s26, 9216
  buffer_load_dwordx4 v[164:167], v20, s[8:11], s27 offen
  s_add_u32 s27, s26, 24576
  buffer_load_dwordx4 v[168:171], v20, s[8:11], s27 offen
  s_add_u32 s27, s26, 25600
  buffer_load_dwordx4 v[172:175], v20, s[8:11], s27 offen
  s_add_u32 s27, s26, 10240
  buffer_load_dwordx4 v[176:179], v20, s[8:11], s27 offen
  s_add_u32 s27, s26, 11264
  buffer_load_dwordx4 v[180:183], v20, s[8:11], s27 offen
  s_add_u32 s27, s26, 26624
  buffer_load_dwordx4 v[184:187], v20, s[8:11], s27 offen
  s_add_u32 s27, s26, 27648
  buffer_load_dwordx4 v[188:191], v20, s[8:11], s27 offen
  s_add_u32 s27, s26, 65536
  buffer_load_dwordx4 v[192:195], v20, s[8:11], s27 offen
  s_add_u32 s27, s26, 66560
  buffer_load_dwordx4 v[196:199], v20, s[8:11], s27 offen
  s_add_u32 s27, s26, 81920
  buffer_load_dwordx4 v[200:203], v20, s[8:11], s27 offen
  s_add_u32 s27, s26, 82944
  buffer_load_dwordx4 v[204:207], v20, s[8:11], s27 offen
  s_add_u32 s27, s26, 67584
  buffer_load_dwordx4 v[208:211], v20, s[8:11], s27 offen
  s_add_u32 s27, s26, 68608
  buffer_load_dwordx4 v[212:215], v20, s[8:11], s27 offen
  s_add_u32 s27, s26, 83968
  buffer_load_dwordx4 v[216:219], v20, s[8:11], s27 offen
  s_add_u32 s27, s26, 84992
  buffer_load_dwordx4 v[220:223], v20, s[8:11], s27 offen
  s_add_u32 s27, s26, 73728
  buffer_load_dwordx4 v[224:227], v20, s[8:11], s27 offen
  s_add_u32 s27, s26, 74752
  buffer_load_dwordx4 v[228:231], v20, s[8:11], s27 offen
  s_add_u32 s27, s26, 90112
  buffer_load_dwordx4 v[232:235], v20, s[8:11], s27 offen
  s_add_u32 s27, s26, 91136
  buffer_load_dwordx4 v[236:239], v20, s[8:11], s27 offen
  s_add_u32 s27, s26, 75776
  buffer_load_dwordx4 v[240:243], v20, s[8:11], s27 offen
  s_add_u32 s27, s26, 76800
  buffer_load_dwordx4 v[244:247], v20, s[8:11], s27 offen
  s_add_u32 s27, s26, 92160
  buffer_load_dwordx4 v[248:251], v20, s[8:11], s27 offen
  s_add_u32 s27, s26, 93184
  buffer_load_dwordx4 v[252:255], v20, s[8:11], s27 offen
  v_lshrrev_b32 v20, 8, v0
  v_and_b32 v22, 0xf0, v0
  v_lshlrev_b32 v23, 6, v20
  v_xor_b32 v22, v22, v23
  v_lshl_add_u32 v22, v20, 13, v22
  v_xor_b32 v23, 32, v22
  s_lshr_b32 s26, s17, 1
  s_lshl_b32 s26, s26, 20
  s_and_b32 s27, s17, 1
  s_lshl_b32 s27, s27, 18
  s_add_u32 s26, s26, s27
  s_lshl_b32 s27, s16, 8
  s_add_u32 s26, s26, s27
  s_lshl_b32 s28, s17, 13
  s_add_u32 s27, s26, 0
  s_add_u32 m0, s28, 65536
  s_nop 0
  buffer_load_dwordx4 v22, s[32:35], s27 offen lds
  s_add_u32 m0, s28, 66560
  s_add_u32 s27, s27, 32768
  buffer_load_dwordx4 v22, s[32:35], s27 offen lds
  s_add_u32 m0, s28, 67584
  s_add_u32 s27, s27, 32768
  buffer_load_dwordx4 v23, s[32:35], s27 offen lds
  s_add_u32 m0, s28, 68608
  s_add_u32 s27, s27, 32768
  buffer_load_dwordx4 v23, s[32:35], s27 offen lds
  s_add_u32 m0, s28, 69632
  s_add_u32 s27, s27, 32768
  buffer_load_dwordx4 v22, s[32:35], s27 offen lds
  s_add_u32 m0, s28, 70656
  s_add_u32 s27, s27, 32768
  buffer_load_dwordx4 v22, s[32:35], s27 offen lds
  s_add_u32 m0, s28, 71680
  s_add_u32 s27, s27, 32768
  buffer_load_dwordx4 v23, s[32:35], s27 offen lds
  s_add_u32 m0, s28, 72704
  s_add_u32 s27, s27, 32768
  buffer_load_dwordx4 v23, s[32:35], s27 offen lds
  s_add_u32 s27, s26, 524288
  s_add_u32 m0, s28, 98304
  s_nop 0
  buffer_load_dwordx4 v22, s[32:35], s27 offen lds
  s_add_u32 m0, s28, 99328
  s_add_u32 s27, s27, 32768
  buffer_load_dwordx4 v22, s[32:35], s27 offen lds
  s_add_u32 m0, s28, 100352
  s_add_u32 s27, s27, 32768
  buffer_load_dwordx4 v23, s[32:35], s27 offen lds
  s_add_u32 m0, s28, 101376
  s_add_u32 s27, s27, 32768
  buffer_load_dwordx4 v23, s[32:35], s27 offen lds
  s_add_u32 m0, s28, 102400
  s_add_u32 s27, s27, 32768
  buffer_load_dwordx4 v22, s[32:35], s27 offen lds
  s_add_u32 m0, s28, 103424
  s_add_u32 s27, s27, 32768
  buffer_load_dwordx4 v22, s[32:35], s27 offen lds
  s_add_u32 m0, s28, 104448
  s_add_u32 s27, s27, 32768
  buffer_load_dwordx4 v23, s[32:35], s27 offen lds
  s_add_u32 m0, s28, 105472
  s_add_u32 s27, s27, 32768
  buffer_load_dwordx4 v23, s[32:35], s27 offen lds
  s_waitcnt vmcnt(48)
  v_lshl_or_b32 v28, v29, 16, v28
  v_lshl_or_b32 v29, v31, 16, v30
  v_min_u32 v28, -2, v28
  v_min_u32 v29, -2, v29
  buffer_store_dwordx2 v[28:29], v5, s[4:7], s62 offen sc1
  s_add_u32 s27, s26, 2097152
  s_add_u32 m0, s28, 131072
  s_nop 0
  buffer_load_dwordx4 v22, s[32:35], s27 offen lds
  s_add_u32 m0, s28, 132096
  s_add_u32 s27, s27, 32768
  buffer_load_dwordx4 v22, s[32:35], s27 offen lds
  s_add_u32 m0, s28, 133120
  s_add_u32 s27, s27, 32768
  buffer_load_dwordx4 v23, s[32:35], s27 offen lds
  s_add_u32 m0, s28, 134144
  s_add_u32 s27, s27, 32768
  buffer_load_dwordx4 v23, s[32:35], s27 offen lds
  s_add_u32 m0, s28, 135168
  s_add_u32 s27, s27, 32768
  buffer_load_dwordx4 v22, s[32:35], s27 offen lds
  s_add_u32 m0, s28, 136192
  s_add_u32 s27, s27, 32768
  buffer_load_dwordx4 v22, s[32:35], s27 offen lds
  s_add_u32 m0, s28, 137216
  s_add_u32 s27, s27, 32768
  buffer_load_dwordx4 v23, s[32:35], s27 offen lds
  s_add_u32 m0, s28, 138240
  s_add_u32 s27, s27, 32768
  buffer_load_dwordx4 v23, s[32:35], s27 offen lds
  v_bfe_u32 v20, v7, 2, 1
  v_lshrrev_b32 v21, 3, v7
  v_and_b32 v104, 1, v17
  v_lshl_add_u32 v21, v21, 1, v104
  v_lshl_add_u32 v104, v20, 3, v21
  v_lshrrev_b32 v105, 1, v17
  v_lshl_add_u32 v104, v105, 5, v104
  v_lshl_add_u32 v20, v21, 1, v20
  s_lshl_b32 s29, s17, 1
  v_xor_b32 v20, s29, v20
  v_lshlrev_b32 v20, 5, v20
  v_lshl_add_u32 v20, v104, 8, v20
  v_and_b32 v21, 3, v7
  v_lshl_add_u32 v20, v21, 3, v20
  s_lshr_b32 s29, s17, 1
  s_lshl_b32 s29, s29, 14
  s_and_b32 s30, s17, 1
  s_lshl_b32 s30, s30, 10
  s_add_u32 s29, s29, s30
  s_add_u32 s29, s29, 65536
  v_add_u32 v20, s29, v20
  v_xor_b32 v104, 0, v20
  v_xor_b32 v105, 32, v20
  v_xor_b32 v106, 1024, v20
  v_xor_b32 v107, 1056, v20
  v_xor_b32 v108, 16384, v20
  v_xor_b32 v109, 16416, v20
  v_xor_b32 v110, 17408, v20
  v_xor_b32 v111, 17440, v20
  s_waitcnt vmcnt(49)
  v_perm_b32 v120, v132, v128, s44
  v_perm_b32 v121, v140, v136, s44
  v_perm_b32 v122, v148, v144, s44
  v_perm_b32 v123, v156, v152, s44
  v_accvgpr_write_b32 a248, v120
  v_accvgpr_write_b32 a249, v121
  v_accvgpr_write_b32 a250, v122
  v_accvgpr_write_b32 a251, v123
  v_perm_b32 v124, v132, v128, s45
  v_perm_b32 v125, v140, v136, s45
  v_perm_b32 v126, v148, v144, s45
  v_perm_b32 v127, v156, v152, s45
  v_accvgpr_write_b32 a232, v124
  v_accvgpr_write_b32 a233, v125
  v_accvgpr_write_b32 a234, v126
  v_accvgpr_write_b32 a235, v127
  v_perm_b32 v120, v133, v129, s44
  v_perm_b32 v121, v141, v137, s44
  v_perm_b32 v122, v149, v145, s44
  v_perm_b32 v123, v157, v153, s44
  v_accvgpr_write_b32 a216, v120
  v_accvgpr_write_b32 a217, v121
  v_accvgpr_write_b32 a218, v122
  v_accvgpr_write_b32 a219, v123
  v_perm_b32 v124, v133, v129, s45
  v_perm_b32 v125, v141, v137, s45
  v_perm_b32 v126, v149, v145, s45
  v_perm_b32 v127, v157, v153, s45
  v_accvgpr_write_b32 a200, v124
  v_accvgpr_write_b32 a201, v125
  v_accvgpr_write_b32 a202, v126
  v_accvgpr_write_b32 a203, v127
  v_perm_b32 v120, v134, v130, s44
  v_perm_b32 v121, v142, v138, s44
  v_perm_b32 v122, v150, v146, s44
  v_perm_b32 v123, v158, v154, s44
  v_accvgpr_write_b32 a184, v120
  v_accvgpr_write_b32 a185, v121
  v_accvgpr_write_b32 a186, v122
  v_accvgpr_write_b32 a187, v123
  v_perm_b32 v24, v134, v130, s45
  v_perm_b32 v25, v142, v138, s45
  v_perm_b32 v26, v150, v146, s45
  v_perm_b32 v27, v158, v154, s45
  v_perm_b32 v40, v135, v131, s44
  v_perm_b32 v41, v143, v139, s44
  v_perm_b32 v42, v151, v147, s44
  v_perm_b32 v43, v159, v155, s44
  v_perm_b32 v56, v135, v131, s45
  v_perm_b32 v57, v143, v139, s45
  v_perm_b32 v58, v151, v147, s45
  v_perm_b32 v59, v159, v155, s45
  s_waitcnt vmcnt(41)
  v_perm_b32 v120, v164, v160, s44
  v_perm_b32 v121, v172, v168, s44
  v_perm_b32 v122, v180, v176, s44
  v_perm_b32 v123, v188, v184, s44
  v_accvgpr_write_b32 a252, v120
  v_accvgpr_write_b32 a253, v121
  v_accvgpr_write_b32 a254, v122
  v_accvgpr_write_b32 a255, v123
  v_perm_b32 v124, v164, v160, s45
  v_perm_b32 v125, v172, v168, s45
  v_perm_b32 v126, v180, v176, s45
  v_perm_b32 v127, v188, v184, s45
  v_accvgpr_write_b32 a236, v124
  v_accvgpr_write_b32 a237, v125
  v_accvgpr_write_b32 a238, v126
  v_accvgpr_write_b32 a239, v127
  v_perm_b32 v120, v165, v161, s44
  v_perm_b32 v121, v173, v169, s44
  v_perm_b32 v122, v181, v177, s44
  v_perm_b32 v123, v189, v185, s44
  v_accvgpr_write_b32 a220, v120
  v_accvgpr_write_b32 a221, v121
  v_accvgpr_write_b32 a222, v122
  v_accvgpr_write_b32 a223, v123
  v_perm_b32 v124, v165, v161, s45
  v_perm_b32 v125, v173, v169, s45
  v_perm_b32 v126, v181, v177, s45
  v_perm_b32 v127, v189, v185, s45
  v_accvgpr_write_b32 a204, v124
  v_accvgpr_write_b32 a205, v125
  v_accvgpr_write_b32 a206, v126
  v_accvgpr_write_b32 a207, v127
  v_perm_b32 v120, v166, v162, s44
  v_perm_b32 v121, v174, v170, s44
  v_perm_b32 v122, v182, v178, s44
  v_perm_b32 v123, v190, v186, s44
  v_accvgpr_write_b32 a188, v120
  v_accvgpr_write_b32 a189, v121
  v_accvgpr_write_b32 a190, v122
  v_accvgpr_write_b32 a191, v123
  v_perm_b32 v28, v166, v162, s45
  v_perm_b32 v29, v174, v170, s45
  v_perm_b32 v30, v182, v178, s45
  v_perm_b32 v31, v190, v186, s45
  v_perm_b32 v44, v167, v163, s44
  v_perm_b32 v45, v175, v171, s44
  v_perm_b32 v46, v183, v179, s44
  v_perm_b32 v47, v191, v187, s44
  v_perm_b32 v60, v167, v163, s45
  v_perm_b32 v61, v175, v171, s45
  v_perm_b32 v62, v183, v179, s45
  v_perm_b32 v63, v191, v187, s45
  s_waitcnt vmcnt(33)
  v_perm_b32 v120, v196, v192, s44
  v_perm_b32 v121, v204, v200, s44
  v_perm_b32 v122, v212, v208, s44
  v_perm_b32 v123, v220, v216, s44
  v_accvgpr_write_b32 a240, v120
  v_accvgpr_write_b32 a241, v121
  v_accvgpr_write_b32 a242, v122
  v_accvgpr_write_b32 a243, v123
  v_perm_b32 v124, v196, v192, s45
  v_perm_b32 v125, v204, v200, s45
  v_perm_b32 v126, v212, v208, s45
  v_perm_b32 v127, v220, v216, s45
  v_accvgpr_write_b32 a224, v124
  v_accvgpr_write_b32 a225, v125
  v_accvgpr_write_b32 a226, v126
  v_accvgpr_write_b32 a227, v127
  v_perm_b32 v120, v197, v193, s44
  v_perm_b32 v121, v205, v201, s44
  v_perm_b32 v122, v213, v209, s44
  v_perm_b32 v123, v221, v217, s44
  v_accvgpr_write_b32 a208, v120
  v_accvgpr_write_b32 a209, v121
  v_accvgpr_write_b32 a210, v122
  v_accvgpr_write_b32 a211, v123
  v_perm_b32 v124, v197, v193, s45
  v_perm_b32 v125, v205, v201, s45
  v_perm_b32 v126, v213, v209, s45
  v_perm_b32 v127, v221, v217, s45
  v_accvgpr_write_b32 a192, v124
  v_accvgpr_write_b32 a193, v125
  v_accvgpr_write_b32 a194, v126
  v_accvgpr_write_b32 a195, v127
  v_perm_b32 v120, v198, v194, s44
  v_perm_b32 v121, v206, v202, s44
  v_perm_b32 v122, v214, v210, s44
  v_perm_b32 v123, v222, v218, s44
  v_accvgpr_write_b32 a176, v120
  v_accvgpr_write_b32 a177, v121
  v_accvgpr_write_b32 a178, v122
  v_accvgpr_write_b32 a179, v123
  v_perm_b32 v32, v198, v194, s45
  v_perm_b32 v33, v206, v202, s45
  v_perm_b32 v34, v214, v210, s45
  v_perm_b32 v35, v222, v218, s45
  v_perm_b32 v48, v199, v195, s44
  v_perm_b32 v49, v207, v203, s44
  v_perm_b32 v50, v215, v211, s44
  v_perm_b32 v51, v223, v219, s44
  v_perm_b32 v64, v199, v195, s45
  v_perm_b32 v65, v207, v203, s45
  v_perm_b32 v66, v215, v211, s45
  v_perm_b32 v67, v223, v219, s45
  s_waitcnt vmcnt(25)
  v_perm_b32 v120, v228, v224, s44
  v_perm_b32 v121, v236, v232, s44
  v_perm_b32 v122, v244, v240, s44
  v_perm_b32 v123, v252, v248, s44
  v_accvgpr_write_b32 a244, v120
  v_accvgpr_write_b32 a245, v121
  v_accvgpr_write_b32 a246, v122
  v_accvgpr_write_b32 a247, v123
  v_perm_b32 v124, v228, v224, s45
  v_perm_b32 v125, v236, v232, s45
  v_perm_b32 v126, v244, v240, s45
  v_perm_b32 v127, v252, v248, s45
  v_accvgpr_write_b32 a228, v124
  v_accvgpr_write_b32 a229, v125
  v_accvgpr_write_b32 a230, v126
  v_accvgpr_write_b32 a231, v127
  v_perm_b32 v120, v229, v225, s44
  v_perm_b32 v121, v237, v233, s44
  v_perm_b32 v122, v245, v241, s44
  v_perm_b32 v123, v253, v249, s44
  v_accvgpr_write_b32 a212, v120
  v_accvgpr_write_b32 a213, v121
  v_accvgpr_write_b32 a214, v122
  v_accvgpr_write_b32 a215, v123
  v_perm_b32 v124, v229, v225, s45
  v_perm_b32 v125, v237, v233, s45
  v_perm_b32 v126, v245, v241, s45
  v_perm_b32 v127, v253, v249, s45
  v_accvgpr_write_b32 a196, v124
  v_accvgpr_write_b32 a197, v125
  v_accvgpr_write_b32 a198, v126
  v_accvgpr_write_b32 a199, v127
  v_perm_b32 v120, v230, v226, s44
  v_perm_b32 v121, v238, v234, s44
  v_perm_b32 v122, v246, v242, s44
  v_perm_b32 v123, v254, v250, s44
  v_accvgpr_write_b32 a180, v120
  v_accvgpr_write_b32 a181, v121
  v_accvgpr_write_b32 a182, v122
  v_accvgpr_write_b32 a183, v123
  v_perm_b32 v36, v230, v226, s45
  v_perm_b32 v37, v238, v234, s45
  v_perm_b32 v38, v246, v242, s45
  v_perm_b32 v39, v254, v250, s45
  v_perm_b32 v52, v231, v227, s44
  v_perm_b32 v53, v239, v235, s44
  v_perm_b32 v54, v247, v243, s44
  v_perm_b32 v55, v255, v251, s44
  v_perm_b32 v68, v231, v227, s45
  v_perm_b32 v69, v239, v235, s45
  v_perm_b32 v70, v247, v243, s45
  v_perm_b32 v71, v255, v251, s45
  v_mov_b64 v[128:129], v[24:25]
  v_mov_b64 v[130:131], v[26:27]
  v_mov_b64 v[132:133], v[28:29]
  v_mov_b64 v[134:135], v[30:31]
  v_mov_b64 v[136:137], v[32:33]
  v_mov_b64 v[138:139], v[34:35]
  v_mov_b64 v[140:141], v[36:37]
  v_mov_b64 v[142:143], v[38:39]
  v_mov_b64 v[144:145], v[40:41]
  v_mov_b64 v[146:147], v[42:43]
  v_mov_b64 v[148:149], v[44:45]
  v_mov_b64 v[150:151], v[46:47]
  v_mov_b64 v[152:153], v[48:49]
  v_mov_b64 v[154:155], v[50:51]
  v_mov_b64 v[156:157], v[52:53]
  v_mov_b64 v[158:159], v[54:55]
  v_mov_b64 v[184:185], v[56:57]
  v_mov_b64 v[186:187], v[58:59]
  v_mov_b64 v[188:189], v[60:61]
  v_mov_b64 v[190:191], v[62:63]
  v_mov_b64 v[192:193], v[64:65]
  v_mov_b64 v[194:195], v[66:67]
  v_mov_b64 v[196:197], v[68:69]
  v_mov_b64 v[198:199], v[70:71]
  s_waitcnt vmcnt(17)
  s_barrier
  s_add_u32 s27, s26, 2621440
  s_add_u32 m0, s28, 0
  s_nop 0
  buffer_load_dwordx4 v22, s[32:35], s27 offen lds
  s_add_u32 m0, s28, 1024
  s_add_u32 s27, s27, 32768
  buffer_load_dwordx4 v22, s[32:35], s27 offen lds
  s_add_u32 m0, s28, 2048
  s_add_u32 s27, s27, 32768
  buffer_load_dwordx4 v23, s[32:35], s27 offen lds
  s_add_u32 m0, s28, 3072
  s_add_u32 s27, s27, 32768
  buffer_load_dwordx4 v23, s[32:35], s27 offen lds
  s_add_u32 m0, s28, 4096
  s_add_u32 s27, s27, 32768
  buffer_load_dwordx4 v22, s[32:35], s27 offen lds
  s_add_u32 m0, s28, 5120
  s_add_u32 s27, s27, 32768
  buffer_load_dwordx4 v22, s[32:35], s27 offen lds
  s_add_u32 m0, s28, 6144
  s_add_u32 s27, s27, 32768
  buffer_load_dwordx4 v23, s[32:35], s27 offen lds
  s_add_u32 m0, s28, 7168
  s_add_u32 s27, s27, 32768
  buffer_load_dwordx4 v23, s[32:35], s27 offen lds
  s_cmp_lg_u32 s91, 0
  s_cbranch_scc1 g_o0_5
  s_cmp_lg_u32 s17, 0
  s_cbranch_scc1 g_ar_6
  s_lshl_b32 s36, s89, 3
  s_lshl_b64 s[36:37], 1, s36
  v_lshlrev_b32 v124, 3, 0
  v_mov_b32 v120, s36
  v_mov_b32 v121, s37
  s_mov_b64 exec, 1
  global_atomic_add_x2 v[122:123], v124, v[120:121], s[12:13] sc0
  s_mov_b64 exec, -1
g_ar_6:
g_o0_5:
  ds_read_b64_tr_b16 v[40:41], v104 offset:0
  ds_read_b64_tr_b16 v[42:43], v104 offset:4096
  ds_read_b64_tr_b16 v[48:49], v105 offset:0
  ds_read_b64_tr_b16 v[50:51], v105 offset:4096
  ds_read_b64_tr_b16 a[72:73], v106 offset:0
  ds_read_b64_tr_b16 a[74:75], v106 offset:4096
  ds_read_b64_tr_b16 a[24:25], v107 offset:0
  ds_read_b64_tr_b16 a[26:27], v107 offset:4096
  ds_read_b64_tr_b16 a[64:65], v108 offset:0
  ds_read_b64_tr_b16 a[66:67], v108 offset:4096
  ds_read_b64_tr_b16 a[16:17], v109 offset:0
  ds_read_b64_tr_b16 a[18:19], v109 offset:4096
  ds_read_b64_tr_b16 a[56:57], v110 offset:0
  ds_read_b64_tr_b16 a[58:59], v110 offset:4096
  ds_read_b64_tr_b16 a[8:9], v111 offset:0
  ds_read_b64_tr_b16 a[10:11], v111 offset:4096
  s_waitcnt lgkmcnt(0)
  s_waitcnt vmcnt(17)
  s_barrier
  s_add_u32 s27, s26, 0
  s_add_u32 m0, s28, 32768
  s_nop 0
  buffer_load_dwordx4 v22, s[52:55], s27 offen lds
  s_add_u32 m0, s28, 33792
  s_add_u32 s27, s27, 32768
  buffer_load_dwordx4 v22, s[52:55], s27 offen lds
  s_add_u32 m0, s28, 34816
  s_add_u32 s27, s27, 32768
  buffer_load_dwordx4 v23, s[52:55], s27 offen lds
  s_add_u32 m0, s28, 35840
  s_add_u32 s27, s27, 32768
  buffer_load_dwordx4 v23, s[52:55], s27 offen lds
  s_add_u32 m0, s28, 36864
  s_add_u32 s27, s27, 32768
  buffer_load_dwordx4 v22, s[52:55], s27 offen lds
  s_add_u32 m0, s28, 37888
  s_add_u32 s27, s27, 32768
  buffer_load_dwordx4 v22, s[52:55], s27 offen lds
  s_add_u32 m0, s28, 38912
  s_add_u32 s27, s27, 32768
  buffer_load_dwordx4 v23, s[52:55], s27 offen lds
  s_add_u32 m0, s28, 39936
  s_add_u32 s27, s27, 32768
  buffer_load_dwordx4 v23, s[52:55], s27 offen lds
  ds_read_b64_tr_b16 v[44:45], v104 offset:32768
  ds_read_b64_tr_b16 v[46:47], v104 offset:36864
  ds_read_b64_tr_b16 v[52:53], v105 offset:32768
  ds_read_b64_tr_b16 v[54:55], v105 offset:36864
  ds_read_b64_tr_b16 a[76:77], v106 offset:32768
  ds_read_b64_tr_b16 a[78:79], v106 offset:36864
  ds_read_b64_tr_b16 a[28:29], v107 offset:32768
  ds_read_b64_tr_b16 a[30:31], v107 offset:36864
  ds_read_b64_tr_b16 a[68:69], v108 offset:32768
  ds_read_b64_tr_b16 a[70:71], v108 offset:36864
  ds_read_b64_tr_b16 a[20:21], v109 offset:32768
  ds_read_b64_tr_b16 a[22:23], v109 offset:36864
  ds_read_b64_tr_b16 a[60:61], v110 offset:32768
  ds_read_b64_tr_b16 a[62:63], v110 offset:36864
  ds_read_b64_tr_b16 a[12:13], v111 offset:32768
  ds_read_b64_tr_b16 a[14:15], v111 offset:36864
  s_waitcnt lgkmcnt(0)
  v_add_u32 v104, 65536, v104
  v_add_u32 v105, 65536, v105
  v_add_u32 v106, 65536, v106
  v_add_u32 v107, 65536, v107
  v_add_u32 v108, 65536, v108
  v_add_u32 v109, 65536, v109
  v_add_u32 v110, 65536, v110
  v_add_u32 v111, 65536, v111
  s_waitcnt vmcnt(16)
  s_barrier
  s_add_u32 s27, s26, 524288
  s_add_u32 m0, s28, 65536
  s_nop 0
  buffer_load_dwordx4 v22, s[52:55], s27 offen lds
  s_add_u32 m0, s28, 66560
  s_add_u32 s27, s27, 32768
  buffer_load_dwordx4 v22, s[52:55], s27 offen lds
  s_add_u32 m0, s28, 67584
  s_add_u32 s27, s27, 32768
  buffer_load_dwordx4 v23, s[52:55], s27 offen lds
  s_add_u32 m0, s28, 68608
  s_add_u32 s27, s27, 32768
  buffer_load_dwordx4 v23, s[52:55], s27 offen lds
  s_add_u32 m0, s28, 69632
  s_add_u32 s27, s27, 32768
  buffer_load_dwordx4 v22, s[52:55], s27 offen lds
  s_add_u32 m0, s28, 70656
  s_add_u32 s27, s27, 32768
  buffer_load_dwordx4 v22, s[52:55], s27 offen lds
  s_add_u32 m0, s28, 71680
  s_add_u32 s27, s27, 32768
  buffer_load_dwordx4 v23, s[52:55], s27 offen lds
  s_add_u32 m0, s28, 72704
  s_add_u32 s27, s27, 32768
  buffer_load_dwordx4 v23, s[52:55], s27 offen lds
  ds_read_b64_tr_b16 v[72:73], v104 offset:0
  ds_read_b64_tr_b16 v[74:75], v104 offset:4096
  ds_read_b64_tr_b16 v[80:81], v105 offset:0
  ds_read_b64_tr_b16 v[82:83], v105 offset:4096
  ds_read_b64_tr_b16 a[48:49], v106 offset:0
  ds_read_b64_tr_b16 a[50:51], v106 offset:4096
  ds_read_b64_tr_b16 a[0:1], v107 offset:0
  ds_read_b64_tr_b16 a[2:3], v107 offset:4096
  ds_read_b64_tr_b16 a[40:41], v108 offset:0
  ds_read_b64_tr_b16 a[42:43], v108 offset:4096
  ds_read_b64_tr_b16 v[248:249], v109 offset:0
  ds_read_b64_tr_b16 v[250:251], v109 offset:4096
  ds_read_b64_tr_b16 a[32:33], v110 offset:0
  ds_read_b64_tr_b16 a[34:35], v110 offset:4096
  ds_read_b64_tr_b16 v[240:241], v111 offset:0
  ds_read_b64_tr_b16 v[242:243], v111 offset:4096
  s_waitcnt lgkmcnt(0)
  v_add_u32 v104, -131072, v104
  v_add_u32 v105, -131072, v105
  v_add_u32 v106, -131072, v106
  v_add_u32 v107, -131072, v107
  v_add_u32 v108, -131072, v108
  v_add_u32 v109, -131072, v109
  v_add_u32 v110, -131072, v110
  v_add_u32 v111, -131072, v111
  s_waitcnt vmcnt(16)
  s_barrier
  s_add_u32 s27, s26, 2097152
  s_add_u32 m0, s28, 98304
  s_nop 0
  buffer_load_dwordx4 v22, s[52:55], s27 offen lds
  s_add_u32 m0, s28, 99328
  s_add_u32 s27, s27, 32768
  buffer_load_dwordx4 v22, s[52:55], s27 offen lds
  s_add_u32 m0, s28, 100352
  s_add_u32 s27, s27, 32768
  buffer_load_dwordx4 v23, s[52:55], s27 offen lds
  s_add_u32 m0, s28, 101376
  s_add_u32 s27, s27, 32768
  buffer_load_dwordx4 v23, s[52:55], s27 offen lds
  s_add_u32 m0, s28, 102400
  s_add_u32 s27, s27, 32768
  buffer_load_dwordx4 v22, s[52:55], s27 offen lds
  s_add_u32 m0, s28, 103424
  s_add_u32 s27, s27, 32768
  buffer_load_dwordx4 v22, s[52:55], s27 offen lds
  s_add_u32 m0, s28, 104448
  s_add_u32 s27, s27, 32768
  buffer_load_dwordx4 v23, s[52:55], s27 offen lds
  s_add_u32 m0, s28, 105472
  s_add_u32 s27, s27, 32768
  buffer_load_dwordx4 v23, s[52:55], s27 offen lds
  ds_read_b64_tr_b16 v[76:77], v104 offset:0
  ds_read_b64_tr_b16 v[78:79], v104 offset:4096
  ds_read_b64_tr_b16 v[84:85], v105 offset:0
  ds_read_b64_tr_b16 v[86:87], v105 offset:4096
  ds_read_b64_tr_b16 a[52:53], v106 offset:0
  ds_read_b64_tr_b16 a[54:55], v106 offset:4096
  ds_read_b64_tr_b16 a[4:5], v107 offset:0
  ds_read_b64_tr_b16 a[6:7], v107 offset:4096
  ds_read_b64_tr_b16 a[44:45], v108 offset:0
  ds_read_b64_tr_b16 a[46:47], v108 offset:4096
  ds_read_b64_tr_b16 v[252:253], v109 offset:0
  ds_read_b64_tr_b16 v[254:255], v109 offset:4096
  ds_read_b64_tr_b16 a[36:37], v110 offset:0
  ds_read_b64_tr_b16 a[38:39], v110 offset:4096
  ds_read_b64_tr_b16 v[244:245], v111 offset:0
  ds_read_b64_tr_b16 v[246:247], v111 offset:4096
  s_waitcnt lgkmcnt(0)
  s_waitcnt vmcnt(16)
  s_barrier
  s_add_u32 s27, s26, 2621440
  s_add_u32 m0, s28, 131072
  s_nop 0
  buffer_load_dwordx4 v22, s[52:55], s27 offen lds
  s_add_u32 m0, s28, 132096
  s_add_u32 s27, s27, 32768
  buffer_load_dwordx4 v22, s[52:55], s27 offen lds
  s_add_u32 m0, s28, 133120
  s_add_u32 s27, s27, 32768
  buffer_load_dwordx4 v23, s[52:55], s27 offen lds
  s_add_u32 m0, s28, 134144
  s_add_u32 s27, s27, 32768
  buffer_load_dwordx4 v23, s[52:55], s27 offen lds
  s_add_u32 m0, s28, 135168
  s_add_u32 s27, s27, 32768
  buffer_load_dwordx4 v22, s[52:55], s27 offen lds
  s_add_u32 m0, s28, 136192
  s_add_u32 s27, s27, 32768
  buffer_load_dwordx4 v22, s[52:55], s27 offen lds
  s_add_u32 m0, s28, 137216
  s_add_u32 s27, s27, 32768
  buffer_load_dwordx4 v23, s[52:55], s27 offen lds
  s_add_u32 m0, s28, 138240
  s_add_u32 s27, s27, 32768
  buffer_load_dwordx4 v23, s[52:55], s27 offen lds
  s_cmp_lg_u32 s91, 0
  s_cbranch_scc1 g_o0_7
  s_cmp_lg_u32 s17, 0
  s_cbranch_scc1 g_af_8
  v_readfirstlane_b32 s36, v122
  v_readfirstlane_b32 s37, v123
  s_add_u32 s38, s36, s37
  s_mul_i32 s38, s38, 0x01010101
  s_lshr_b32 s38, s38, 24
  s_cmp_lg_u32 s38, 31
  s_cbranch_scc1 g_af_8
  s_lshl_b32 s38, s89, 3
  s_lshr_b64 s[36:37], s[36:37], s38
  s_and_b32 s36, s36, 0xff
  s_cmp_eq_u32 s36, 31
  s_cselect_b32 s36, 1, 2
  v_mov_b32 v120, s36
  v_lshrrev_b32 v124, 1, v124
  s_mov_b64 exec, 1
  global_store_dword v124, v120, s[12:13] offset:128 sc1
  s_mov_b64 exec, -1
g_af_8:
g_o0_7:
  ds_read_b64_tr_b16 v[24:25], v104 offset:32768
  ds_read_b64_tr_b16 v[26:27], v104 offset:36864
  ds_read_b64_tr_b16 v[32:33], v105 offset:32768
  ds_read_b64_tr_b16 v[34:35], v105 offset:36864
  ds_read_b64_tr_b16 a[168:169], v106 offset:32768
  ds_read_b64_tr_b16 a[170:171], v106 offset:36864
  ds_read_b64_tr_b16 a[120:121], v107 offset:32768
  ds_read_b64_tr_b16 a[122:123], v107 offset:36864
  ds_read_b64_tr_b16 a[160:161], v108 offset:32768
  ds_read_b64_tr_b16 a[162:163], v108 offset:36864
  ds_read_b64_tr_b16 a[112:113], v109 offset:32768
  ds_read_b64_tr_b16 a[114:115], v109 offset:36864
  ds_read_b64_tr_b16 a[152:153], v110 offset:32768
  ds_read_b64_tr_b16 a[154:155], v110 offset:36864
  ds_read_b64_tr_b16 a[104:105], v111 offset:32768
  ds_read_b64_tr_b16 a[106:107], v111 offset:36864
  s_waitcnt lgkmcnt(0)
  v_add_u32 v104, 65536, v104
  v_add_u32 v105, 65536, v105
  v_add_u32 v106, 65536, v106
  v_add_u32 v107, 65536, v107
  v_add_u32 v108, 65536, v108
  v_add_u32 v109, 65536, v109
  v_add_u32 v110, 65536, v110
  v_add_u32 v111, 65536, v111
  s_waitcnt vmcnt(16)
  s_barrier
  s_add_u32 s27, s26, 0
  s_add_u32 m0, s28, 0
  s_nop 0
  buffer_load_dwordx4 v22, s[48:51], s27 offen lds
  s_add_u32 m0, s28, 1024
  s_add_u32 s27, s27, 32768
  buffer_load_dwordx4 v22, s[48:51], s27 offen lds
  s_add_u32 m0, s28, 2048
  s_add_u32 s27, s27, 32768
  buffer_load_dwordx4 v23, s[48:51], s27 offen lds
  s_add_u32 m0, s28, 3072
  s_add_u32 s27, s27, 32768
  buffer_load_dwordx4 v23, s[48:51], s27 offen lds
  s_add_u32 m0, s28, 4096
  s_add_u32 s27, s27, 32768
  buffer_load_dwordx4 v22, s[48:51], s27 offen lds
  s_add_u32 m0, s28, 5120
  s_add_u32 s27, s27, 32768
  buffer_load_dwordx4 v22, s[48:51], s27 offen lds
  s_add_u32 m0, s28, 6144
  s_add_u32 s27, s27, 32768
  buffer_load_dwordx4 v23, s[48:51], s27 offen lds
  s_add_u32 m0, s28, 7168
  s_add_u32 s27, s27, 32768
  buffer_load_dwordx4 v23, s[48:51], s27 offen lds
  ds_read_b64_tr_b16 v[28:29], v104 offset:0
  ds_read_b64_tr_b16 v[30:31], v104 offset:4096
  ds_read_b64_tr_b16 v[36:37], v105 offset:0
  ds_read_b64_tr_b16 v[38:39], v105 offset:4096
  ds_read_b64_tr_b16 a[172:173], v106 offset:0
  ds_read_b64_tr_b16 a[174:175], v106 offset:4096
  ds_read_b64_tr_b16 a[124:125], v107 offset:0
  ds_read_b64_tr_b16 a[126:127], v107 offset:4096
  ds_read_b64_tr_b16 a[164:165], v108 offset:0
  ds_read_b64_tr_b16 a[166:167], v108 offset:4096
  ds_read_b64_tr_b16 a[116:117], v109 offset:0
  ds_read_b64_tr_b16 a[118:119], v109 offset:4096
  ds_read_b64_tr_b16 a[156:157], v110 offset:0
  ds_read_b64_tr_b16 a[158:159], v110 offset:4096
  ds_read_b64_tr_b16 a[108:109], v111 offset:0
  ds_read_b64_tr_b16 a[110:111], v111 offset:4096
  s_waitcnt lgkmcnt(0)
  s_waitcnt vmcnt(16)
  s_barrier
  s_add_u32 s27, s26, 524288
  s_add_u32 m0, s28, 32768
  s_nop 0
  buffer_load_dwordx4 v22, s[48:51], s27 offen lds
  s_add_u32 m0, s28, 33792
  s_add_u32 s27, s27, 32768
  buffer_load_dwordx4 v22, s[48:51], s27 offen lds
  s_add_u32 m0, s28, 34816
  s_add_u32 s27, s27, 32768
  buffer_load_dwordx4 v23, s[48:51], s27 offen lds
  s_add_u32 m0, s28, 35840
  s_add_u32 s27, s27, 32768
  buffer_load_dwordx4 v23, s[48:51], s27 offen lds
  s_add_u32 m0, s28, 36864
  s_add_u32 s27, s27, 32768
  buffer_load_dwordx4 v22, s[48:51], s27 offen lds
  s_add_u32 m0, s28, 37888
  s_add_u32 s27, s27, 32768
  buffer_load_dwordx4 v22, s[48:51], s27 offen lds
  s_add_u32 m0, s28, 38912
  s_add_u32 s27, s27, 32768
  buffer_load_dwordx4 v23, s[48:51], s27 offen lds
  s_add_u32 m0, s28, 39936
  s_add_u32 s27, s27, 32768
  buffer_load_dwordx4 v23, s[48:51], s27 offen lds
  v_mbcnt_lo_u32_b32 v116, -1, 0
  v_and_b32 v116, 1, v116
  v_lshlrev_b32 v118, 2, v116
  global_load_dword v117, v118, s[12:13] offset:128 sc1
  ds_read_b64_tr_b16 v[56:57], v104 offset:32768
  ds_read_b64_tr_b16 v[58:59], v104 offset:36864
  ds_read_b64_tr_b16 v[64:65], v105 offset:32768
  ds_read_b64_tr_b16 v[66:67], v105 offset:36864
  ds_read_b64_tr_b16 a[144:145], v106 offset:32768
  ds_read_b64_tr_b16 a[146:147], v106 offset:36864
  ds_read_b64_tr_b16 a[96:97], v107 offset:32768
  ds_read_b64_tr_b16 a[98:99], v107 offset:36864
  ds_read_b64_tr_b16 a[136:137], v108 offset:32768
  ds_read_b64_tr_b16 a[138:139], v108 offset:36864
  ds_read_b64_tr_b16 a[88:89], v109 offset:32768
  ds_read_b64_tr_b16 a[90:91], v109 offset:36864
  ds_read_b64_tr_b16 a[128:129], v110 offset:32768
  ds_read_b64_tr_b16 a[130:131], v110 offset:36864
  ds_read_b64_tr_b16 a[80:81], v111 offset:32768
  ds_read_b64_tr_b16 a[82:83], v111 offset:36864
  s_waitcnt lgkmcnt(0)
  v_add_u32 v104, 65536, v104
  v_add_u32 v105, 65536, v105
  v_add_u32 v106, 65536, v106
  v_add_u32 v107, 65536, v107
  v_add_u32 v108, 65536, v108
  v_add_u32 v109, 65536, v109
  v_add_u32 v110, 65536, v110
  v_add_u32 v111, 65536, v111
  s_waitcnt vmcnt(16)
  s_barrier
  s_add_u32 s27, s26, 2097152
  s_add_u32 m0, s28, 65536
  s_nop 0
  buffer_load_dwordx4 v22, s[48:51], s27 offen lds
  s_add_u32 m0, s28, 66560
  s_add_u32 s27, s27, 32768
  buffer_load_dwordx4 v22, s[48:51], s27 offen lds
  s_add_u32 m0, s28, 67584
  s_add_u32 s27, s27, 32768
  buffer_load_dwordx4 v23, s[48:51], s27 offen lds
  s_add_u32 m0, s28, 68608
  s_add_u32 s27, s27, 32768
  buffer_load_dwordx4 v23, s[48:51], s27 offen lds
  s_add_u32 m0, s28, 69632
  s_add_u32 s27, s27, 32768
  buffer_load_dwordx4 v22, s[48:51], s27 offen lds
  s_add_u32 m0, s28, 70656
  s_add_u32 s27, s27, 32768
  buffer_load_dwordx4 v22, s[48:51], s27 offen lds
  s_add_u32 m0, s28, 71680
  s_add_u32 s27, s27, 32768
  buffer_load_dwordx4 v23, s[48:51], s27 offen lds
  s_add_u32 m0, s28, 72704
  s_add_u32 s27, s27, 32768
  buffer_load_dwordx4 v23, s[48:51], s27 offen lds
  ds_read_b64_tr_b16 v[60:61], v104 offset:0
  ds_read_b64_tr_b16 v[62:63], v104 offset:4096
  ds_read_b64_tr_b16 v[68:69], v105 offset:0
  ds_read_b64_tr_b16 v[70:71], v105 offset:4096
  ds_read_b64_tr_b16 a[148:149], v106 offset:0
  ds_read_b64_tr_b16 a[150:151], v106 offset:4096
  ds_read_b64_tr_b16 a[100:101], v107 offset:0
  ds_read_b64_tr_b16 a[102:103], v107 offset:4096
  ds_read_b64_tr_b16 a[140:141], v108 offset:0
  ds_read_b64_tr_b16 a[142:143], v108 offset:4096
  ds_read_b64_tr_b16 a[92:93], v109 offset:0
  ds_read_b64_tr_b16 a[94:95], v109 offset:4096
  ds_read_b64_tr_b16 a[132:133], v110 offset:0
  ds_read_b64_tr_b16 a[134:135], v110 offset:4096
  ds_read_b64_tr_b16 a[84:85], v111 offset:0
  ds_read_b64_tr_b16 a[86:87], v111 offset:4096
  s_waitcnt lgkmcnt(0)
  v_add_u32 v104, -131072, v104
  v_add_u32 v105, -131072, v105
  v_add_u32 v106, -131072, v106
  v_add_u32 v107, -131072, v107
  v_add_u32 v108, -131072, v108
  v_add_u32 v109, -131072, v109
  v_add_u32 v110, -131072, v110
  v_add_u32 v111, -131072, v111
  s_waitcnt vmcnt(16)
  s_barrier
  s_add_u32 s27, s26, 2621440
  s_add_u32 m0, s28, 98304
  s_nop 0
  buffer_load_dwordx4 v22, s[48:51], s27 offen lds
  s_add_u32 m0, s28, 99328
  s_add_u32 s27, s27, 32768
  buffer_load_dwordx4 v22, s[48:51], s27 offen lds
  s_add_u32 m0, s28, 100352
  s_add_u32 s27, s27, 32768
  buffer_load_dwordx4 v23, s[48:51], s27 offen lds
  s_add_u32 m0, s28, 101376
  s_add_u32 s27, s27, 32768
  buffer_load_dwordx4 v23, s[48:51], s27 offen lds
  s_add_u32 m0, s28, 102400
  s_add_u32 s27, s27, 32768
  buffer_load_dwordx4 v22, s[48:51], s27 offen lds
  s_add_u32 m0, s28, 103424
  s_add_u32 s27, s27, 32768
  buffer_load_dwordx4 v22, s[48:51], s27 offen lds
  s_add_u32 m0, s28, 104448
  s_add_u32 s27, s27, 32768
  buffer_load_dwordx4 v23, s[48:51], s27 offen lds
  s_add_u32 m0, s28, 105472
  s_add_u32 s27, s27, 32768
  buffer_load_dwordx4 v23, s[48:51], s27 offen lds
  s_or_b32 s36, s91, s17
  s_cbranch_scc1 L_sig
  s_lshl_b32 s36, s16, 6
  s_add_u32 s36, s36, 245104644
  v_mov_b32 v120, 1
  s_mov_b64 exec, 1
  buffer_store_dword v120, off, s[4:7], s36 sc1
  s_mov_b64 exec, -1
L_sig:
  ds_read_b64_tr_b16 v[88:89], v104 offset:0
  ds_read_b64_tr_b16 v[90:91], v104 offset:4096
  ds_read_b64_tr_b16 v[96:97], v105 offset:0
  ds_read_b64_tr_b16 v[98:99], v105 offset:4096
  ds_read_b64_tr_b16 v[232:233], v106 offset:0
  ds_read_b64_tr_b16 v[234:235], v106 offset:4096
  ds_read_b64_tr_b16 v[176:177], v107 offset:0
  ds_read_b64_tr_b16 v[178:179], v107 offset:4096
  ds_read_b64_tr_b16 v[224:225], v108 offset:0
  ds_read_b64_tr_b16 v[226:227], v108 offset:4096
  ds_read_b64_tr_b16 v[168:169], v109 offset:0
  ds_read_b64_tr_b16 v[170:171], v109 offset:4096
  ds_read_b64_tr_b16 v[216:217], v110 offset:0
  ds_read_b64_tr_b16 v[218:219], v110 offset:4096
  ds_read_b64_tr_b16 v[160:161], v111 offset:0
  ds_read_b64_tr_b16 v[162:163], v111 offset:4096
  s_waitcnt lgkmcnt(0)
  s_waitcnt vmcnt(16)
  s_barrier
  ds_read_b64_tr_b16 v[92:93], v104 offset:32768
  ds_read_b64_tr_b16 v[94:95], v104 offset:36864
  ds_read_b64_tr_b16 v[100:101], v105 offset:32768
  ds_read_b64_tr_b16 v[102:103], v105 offset:36864
  ds_read_b64_tr_b16 v[236:237], v106 offset:32768
  ds_read_b64_tr_b16 v[238:239], v106 offset:36864
  ds_read_b64_tr_b16 v[180:181], v107 offset:32768
  ds_read_b64_tr_b16 v[182:183], v107 offset:36864
  ds_read_b64_tr_b16 v[228:229], v108 offset:32768
  ds_read_b64_tr_b16 v[230:231], v108 offset:36864
  ds_read_b64_tr_b16 v[172:173], v109 offset:32768
  ds_read_b64_tr_b16 v[174:175], v109 offset:36864
  ds_read_b64_tr_b16 v[220:221], v110 offset:32768
  ds_read_b64_tr_b16 v[222:223], v110 offset:36864
  ds_read_b64_tr_b16 v[164:165], v111 offset:32768
  ds_read_b64_tr_b16 v[166:167], v111 offset:36864
  s_waitcnt lgkmcnt(0)
  s_barrier
  v_add_u32 v104, 65536, v104
  v_add_u32 v105, 65536, v105
  v_add_u32 v106, 65536, v106
  v_add_u32 v107, 65536, v107
  v_add_u32 v108, 65536, v108
  v_add_u32 v109, 65536, v109
  v_add_u32 v110, 65536, v110
  v_add_u32 v111, 65536, v111
  ds_write_b128 v8, v[128:131] offset:16384
  ds_write_b128 v8, v[132:135] offset:20480
  ds_write_b128 v8, v[136:139] offset:24576
  ds_write_b128 v8, v[140:143] offset:28672
  ds_write_b128 v8, v[144:147] offset:32768
  ds_write_b128 v8, v[148:151] offset:36864
  ds_write_b128 v8, v[152:155] offset:40960
  ds_write_b128 v8, v[156:159] offset:45056
  ds_write_b128 v8, v[184:187] offset:49152
  ds_write_b128 v8, v[188:191] offset:53248
  ds_write_b128 v8, v[192:195] offset:57344
  ds_write_b128 v8, v[196:199] offset:61440
  s_waitcnt lgkmcnt(0)
  s_waitcnt vmcnt(8)
  s_barrier
  v_cmp_eq_u32 vcc, 0, v117
  v_lshlrev_b32 v116, 12, v116
  s_or_b32 s66, vcc_lo, s91
  s_cselect_b32 s66, 0, 1
  s_lshl2_add_u32 s36, s16, s17
  s_lshl_b32 s36, s36, 5
  s_add_u32 s36, s36, 244318208
  buffer_load_dword v118, v116, s[4:7], s36 offen sc1
  ds_read_b64_tr_b16 v[208:209], v104 offset:0
  ds_read_b64_tr_b16 v[210:211], v104 offset:4096
  ds_read_b64_tr_b16 v[152:153], v105 offset:0
  ds_read_b64_tr_b16 v[154:155], v105 offset:4096
  ds_read_b64_tr_b16 v[200:201], v106 offset:0
  ds_read_b64_tr_b16 v[202:203], v106 offset:4096
  ds_read_b64_tr_b16 v[144:145], v107 offset:0
  ds_read_b64_tr_b16 v[146:147], v107 offset:4096
  ds_read_b64_tr_b16 v[192:193], v108 offset:0
  ds_read_b64_tr_b16 v[194:195], v108 offset:4096
  ds_read_b64_tr_b16 v[136:137], v109 offset:0
  ds_read_b64_tr_b16 v[138:139], v109 offset:4096
  ds_read_b64_tr_b16 v[184:185], v110 offset:0
  ds_read_b64_tr_b16 v[186:187], v110 offset:4096
  ds_read_b64_tr_b16 v[128:129], v111 offset:0
  ds_read_b64_tr_b16 v[130:131], v111 offset:4096
  s_waitcnt lgkmcnt(0)
  s_waitcnt vmcnt(0)
  s_barrier
  ds_read_b64_tr_b16 v[212:213], v104 offset:32768
  ds_read_b64_tr_b16 v[214:215], v104 offset:36864
  ds_read_b64_tr_b16 v[156:157], v105 offset:32768
  ds_read_b64_tr_b16 v[158:159], v105 offset:36864
  ds_read_b64_tr_b16 v[204:205], v106 offset:32768
  ds_read_b64_tr_b16 v[206:207], v106 offset:36864
  ds_read_b64_tr_b16 v[148:149], v107 offset:32768
  ds_read_b64_tr_b16 v[150:151], v107 offset:36864
  ds_read_b64_tr_b16 v[196:197], v108 offset:32768
  ds_read_b64_tr_b16 v[198:199], v108 offset:36864
  ds_read_b64_tr_b16 v[140:141], v109 offset:32768
  ds_read_b64_tr_b16 v[142:143], v109 offset:36864
  ds_read_b64_tr_b16 v[188:189], v110 offset:32768
  ds_read_b64_tr_b16 v[190:191], v110 offset:36864
  ds_read_b64_tr_b16 v[132:133], v111 offset:32768
  ds_read_b64_tr_b16 v[134:135], v111 offset:36864
  s_waitcnt lgkmcnt(0)
  s_barrier
  s_waitcnt vmcnt(0)
  s_lshl_b32 s26, s16, 13
  s_add_u32 s26, s26, s40
  s_add_u32 s27, s26, 4096
  s_lshl_b32 s28, s17, 13
  s_add_u32 s28, s28, s62
  buffer_load_dwordx4 v[104:107], v8, s[4:7], s26 offen sc1
  buffer_load_dwordx4 v[104:107], v8, s[4:7], s27 offen sc1
  buffer_load_dwordx2 v[104:105], v5, s[4:7], s28 offen sc1
  ds_write_b128 v1, v[24:27] offset:0
  ds_write_b128 v1, v[28:31] offset:1024
  ds_write_b128 v1, v[32:35] offset:2048
  ds_write_b128 v1, v[36:39] offset:3072
  ds_write_b128 v1, v[40:43] offset:4096
  ds_write_b128 v1, v[44:47] offset:5120
  ds_write_b128 v1, v[48:51] offset:6144
  ds_write_b128 v1, v[52:55] offset:7168
  ds_write_b128 v1, v[56:59] offset:8192
  ds_write_b128 v1, v[60:63] offset:9216
  ds_write_b128 v1, v[64:67] offset:10240
  ds_write_b128 v1, v[68:71] offset:11264
  ds_write_b128 v1, v[72:75] offset:12288
  ds_write_b128 v1, v[76:79] offset:13312
  ds_write_b128 v1, v[80:83] offset:14336
  ds_write_b128 v1, v[84:87] offset:15360
  ds_write_b128 v1, v[88:91] offset:16384
  ds_write_b128 v1, v[92:95] offset:17408
  ds_write_b128 v1, v[96:99] offset:18432
  ds_write_b128 v1, v[100:103] offset:19456
  s_mul_i32 s27, s17, 24576
  s_add_u32 m0, s27, 86016
  s_waitcnt lgkmcnt(0)
  v_readlane_b32 s67, v118, 1
  v_readlane_b32 s26, v118, 0
  v_mov_b32 v21, v117
  s_and_b32 s66, s66, s26
  s_cbranch_scc1 L_pk
  v_mbcnt_lo_u32_b32 v20, -1, 0
  v_and_b32 v20, 1, v20
  v_add_lshl_u32 v20, v20, s61, 2
  s_mov_b32 s26, 0
g_wt_9:
  global_load_dword v21, v20, s[12:13] offset:128 sc1
  s_add_u32 s26, s26, 1
  s_cmp_gt_u32 s26, 1048576
  s_cbranch_scc1 L_end
  s_waitcnt vmcnt(0)
  v_cmp_eq_u32 vcc, 0, v21
  v_readfirstlane_b32 s27, v21
  s_cbranch_vccnz g_wt_9
L_pk:
  s_lshr_b32 s26, s91, 1
  s_nop 3
  v_readlane_b32 s27, v21, s26
  s_cmp_lg_u32 s27, 1
  s_cbranch_scc1 L_chain_x
  s_mov_b32 s22, 0
  s_mov_b32 s21, 0
  s_mov_b32 s42, s62
  s_add_u32 s43, s62, 4096
  s_mov_b32 s46, 0
  s_mov_b32 s47, 0
  s_lshl_b32 s26, s16, 2
  s_add_u32 s26, s26, s17
  s_lshl_b32 s27, s60, 13
  s_add_u32 s27, s27, s26
  s_lshr_b32 s25, s27, 2
  s_lshl_b32 s25, s25, 13
  s_add_u32 s25, s25, 192937984
  s_lshr_b32 s64, s27, 2
  s_lshl_b32 s64, s64, 6
  s_add_u32 s64, s64, 513538048
  s_cmp_eq_u32 s17, 3
  s_cselect_b32 s2, 268435456, 0
  s_lshl_b32 s27, s61, 13
  s_add_u32 s27, s27, s26
  s_lshl_b32 s23, s27, 12
  s_add_u32 s23, s23, 41943040
  s_lshl_b32 s63, s27, 5
  s_add_u32 s63, s63, 244318208
  s_mov_b32 s97, 268435456
  s_cmp_eq_u32 s60, 2
  s_cselect_b32 s20, 262144, s97
  s_cselect_b32 s93, 1, 3
  s_lshl_b32 s26, s17, 2
  s_add_u32 s26, s26, s60
  s_cmp_eq_u32 s26, 1
  s_cselect_b32 s97, 245891072, s97
  s_mov_b32 s95, 0
  s_mov_b32 s96, s23
  s_add_u32 s23, s23, 524288
  s_add_u32 s63, s63, 4096
  s_cmp_eq_u32 s66, 0
  s_cbranch_scc1 c_pk_18
  s_sub_u32 s96, s23, 524288
  s_mov_b32 s65, s67
  s_mov_b32 s94, 0
  buffer_load_dwordx4 v0, s[4:7], s96 offen offset:0  lds
  buffer_load_dwordx4 v0, s[4:7], s96 offen offset:1024  lds
  buffer_load_dwordx4 v0, s[4:7], s96 offen offset:2048  lds
  buffer_load_dwordx4 v0, s[4:7], s96 offen offset:3072  lds
  s_branch c_pk2_19
c_pk_18:
  s_mov_b32 s29, 0
  s_sub_u32 s92, s63, 4096
  s_sub_u32 s96, s23, 524288
  s_mov_b32 s95, 0
c_gw_20:
  buffer_load_dword v7, off, s[4:7], s92 sc1
  s_add_u32 s29, s29, 1
  s_cmp_gt_u32 s29, 1048576
  s_cbranch_scc1 c_fail_16
  s_waitcnt vmcnt(0) lgkmcnt(0)
  v_readfirstlane_b32 s65, v7
  s_cmp_eq_u32 s65, 0
  s_cbranch_scc1 c_gw_20
  s_and_b32 s65, s65, s93
  s_cbranch_scc1 c_kvx_22
  s_mov_b32 s95, 1
  s_add_u32 s96, s96, 33554432
  s_add_u32 s92, s92, 262144
c_kvw_21:
  buffer_load_dword v7, off, s[4:7], s92 sc1
  s_add_u32 s29, s29, 1
  s_cmp_gt_u32 s29, 1048576
  s_cbranch_scc1 c_fail_16
  s_waitcnt vmcnt(0) lgkmcnt(0)
  v_readfirstlane_b32 s65, v7
  s_cmp_eq_u32 s65, 0
  s_cbranch_scc1 c_kvw_21
c_kvx_22:
  buffer_load_dword v7, off, s[4:7], s63 sc1
  buffer_load_dwordx4 v0, s[4:7], s96 offen offset:0  lds
  buffer_load_dwordx4 v0, s[4:7], s96 offen offset:1024  lds
  buffer_load_dwordx4 v0, s[4:7], s96 offen offset:2048  lds
  buffer_load_dwordx4 v0, s[4:7], s96 offen offset:3072  lds
  s_waitcnt vmcnt(4)
  v_readfirstlane_b32 s65, v7
  s_mov_b32 s94, 0
c_pk2_19:
  s_waitcnt vmcnt(4)
  ds_read_b128 v[72:75], v1 offset:6144
  ds_read_b128 v[76:79], v1 offset:7168
  ds_read_b128 v[80:83], v1 offset:8192
  ds_read_b128 v[84:87], v1 offset:9216
  ds_read_b128 v[88:91], v1 offset:10240
  ds_read_b128 v[92:95], v1 offset:11264
  ds_read_b128 v[96:99], v1 offset:12288
  ds_read_b128 v[100:103], v1 offset:13312
  ds_read_b128 v[104:107], v1 offset:14336
  ds_read_b128 v[108:111], v1 offset:15360
  ds_read_b128 v[112:115], v1 offset:16384
  ds_read_b128 v[116:119], v1 offset:17408
  ds_read_b128 v[120:123], v1 offset:18432
  ds_read_b128 v[124:127], v1 offset:19456
  v_mov_b64 v[48:49], 0
  v_mov_b64 v[50:51], 0
  v_mov_b64 v[52:53], 0
  v_mov_b64 v[54:55], 0
  v_mov_b64 v[56:57], 0
  v_mov_b64 v[58:59], 0
  v_mov_b64 v[60:61], 0
  v_mov_b64 v[62:63], 0
  v_mov_b64 v[64:65], 0
  v_mov_b64 v[66:67], 0
  v_mov_b64 v[68:69], 0
  v_mov_b64 v[70:71], 0
  s_lshl_b32 s38, s16, 13
  s_add_u32 s38, s38, s40
  s_add_u32 s39, s38, 4096
  ds_read_b128 v[24:27], v1 offset:0
  ds_read_b128 v[28:31], v1 offset:1024
  ds_read_b128 v[32:35], v1 offset:2048
  ds_read_b128 v[36:39], v1 offset:3072
  ds_read_b128 v[40:43], v1 offset:4096
  ds_read_b128 v[44:47], v1 offset:5120
  s_waitcnt lgkmcnt(0)
c_loop_10:
  buffer_load_dwordx4 v[16:19], v8, s[4:7], s42 offen sc1
  buffer_load_dwordx4 v[20:23], v8, s[4:7], s43 offen sc1
  s_mov_b32 s28, 0
  v_mov_b64 v[48:49], 0
  v_mov_b64 v[50:51], 0
  v_mov_b64 v[52:53], 0
  v_mov_b64 v[54:55], 0
  v_mov_b64 v[56:57], 0
  v_mov_b64 v[58:59], 0
  v_mov_b64 v[60:61], 0
  v_mov_b64 v[62:63], 0
  v_mov_b64 v[64:65], 0
  v_mov_b64 v[66:67], 0
  v_mov_b64 v[68:69], 0
  v_mov_b64 v[70:71], 0
  buffer_load_dwordx4 v[16:19], v8, s[4:7], s42 offen sc1
  buffer_load_dwordx4 v[20:23], v8, s[4:7], s43 offen sc1
  s_waitcnt lgkmcnt(0)
  s_and_b32 s29, s65, s93
  s_cbranch_scc0 c_xb_25
c_xr_26:
  s_waitcnt vmcnt(3)
  v_max3_u32 v7, v16, v17, v18
  v_max_u32 v7, v7, v19
  ds_write_b128 v8, v[16:19] offset:4096
  v_smfmac_f32_16x16x64_bf16 v[48:51], v[16:19], v[24:31], v6
  s_waitcnt vmcnt(2)
  v_max3_u32 v7, v20, v21, v7
  v_max3_u32 v7, v22, v23, v7
  ds_write_b128 v8, v[20:23] offset:8192
  v_smfmac_f32_16x16x64_bf16 v[52:55], v[16:19], v[32:39], v6
  v_cmp_eq_u32 vcc, -1, v7
  v_smfmac_f32_16x16x64_bf16 v[56:59], v[16:19], v[40:47], v6
  s_cbranch_vccnz c_retry_11
c_got_12:
  v_smfmac_f32_16x16x64_bf16 v[60:63], v[16:19], v[72:79], v6
  ds_read_b128 v[72:75], v1 offset:20480
  s_and_b32 s65, s65, s93
  s_cselect_b32 s96, s23, 268435456
  v_smfmac_f32_16x16x64_bf16 v[48:51], v[20:23], v[80:87], v6
  ds_read_b128 v[76:79], v1 offset:21504
  v_mov_b32 v7, 1
  v_smfmac_f32_16x16x64_bf16 v[52:55], v[20:23], v[88:95], v6
  ds_read_b128 v[80:83], v1 offset:22528
  v_smfmac_f32_16x16x64_bf16 v[56:59], v[20:23], v[96:103], v6
  ds_read_b128 v[84:87], v1 offset:23552
  s_waitcnt lgkmcnt(4)
  s_barrier
  ds_read_b128 v[24:27], v9 offset:4096
  ds_read_b128 v[28:31], v10 offset:4096
  v_smfmac_f32_16x16x64_bf16 v[60:63], v[20:23], v[104:111], v6
  ds_read_b128 v[32:35], v11 offset:4096
  v_smfmac_f32_16x16x64_bf16 v[64:67], v[16:19], v[112:119], v6
  ds_read_b128 v[36:39], v9 offset:8192
  v_smfmac_f32_16x16x64_bf16 v[68:71], v[16:19], v[120:127], v6
  ds_read_b128 v[40:43], v10 offset:8192
  v_smfmac_f32_16x16x64_bf16 v[64:67], v[20:23], v[208:215], v6
  ds_read_b128 v[44:47], v11 offset:8192
  s_waitcnt lgkmcnt(5)
  v_smfmac_f32_16x16x64_bf16 v[48:51], v[24:27], a[168:175], v6
  buffer_load_dwordx4 v0, s[4:7], s96 offen offset:0  lds
  s_waitcnt lgkmcnt(4)
  v_smfmac_f32_16x16x64_bf16 v[48:51], v[28:31], a[160:167], v6
  ds_read_b128 v[104:107], v8 offset:16384
  s_waitcnt lgkmcnt(4)
  v_smfmac_f32_16x16x64_bf16 v[48:51], v[32:35], a[152:159], v6
  buffer_load_dwordx4 v0, s[4:7], s96 offen offset:1024  lds
  s_waitcnt lgkmcnt(3)
  v_smfmac_f32_16x16x64_bf16 v[48:51], v[36:39], a[144:151], v6
  ds_read_b128 v[108:111], v8 offset:20480
  s_waitcnt lgkmcnt(3)
  v_smfmac_f32_16x16x64_bf16 v[48:51], v[40:43], a[136:143], v6
  buffer_load_dwordx4 v0, s[4:7], s96 offen offset:2048  lds
  s_waitcnt lgkmcnt(2)
  v_smfmac_f32_16x16x64_bf16 v[48:51], v[44:47], a[128:135], v6
  v_smfmac_f32_16x16x64_bf16 v[52:55], v[24:27], a[120:127], v6
  buffer_load_dwordx4 v0, s[4:7], s96 offen offset:3072  lds
  v_smfmac_f32_16x16x64_bf16 v[52:55], v[28:31], a[112:119], v6
  ds_read_b64 v[100:101], v5 offset:4096
  v_add_f32 v48, v48, v50
  v_smfmac_f32_16x16x64_bf16 v[52:55], v[32:35], a[104:111], v6
  ds_read_b128 v[112:115], v8 offset:24576
  v_add_f32 v49, v49, v51
  v_smfmac_f32_16x16x64_bf16 v[52:55], v[36:39], a[96:103], v6
  ds_read_b128 v[116:119], v8 offset:28672
  v_cvt_pk_bf16_f32 v50, v48, v49
  v_smfmac_f32_16x16x64_bf16 v[52:55], v[40:43], a[88:95], v6
  ds_write2_b32 v2, v50, v50 offset0:0 offset1:1
  v_smfmac_f32_16x16x64_bf16 v[52:55], v[44:47], a[80:87], v6
  ds_read_b64_tr_b16 v[88:89], v12 offset:0
  v_smfmac_f32_16x16x64_bf16 v[56:59], v[24:27], a[72:79], v6
  s_mov_b64 exec, 1
  buffer_store_dword v7, off, s[4:7], s64 sc1
  s_mov_b64 exec, -1
  v_smfmac_f32_16x16x64_bf16 v[56:59], v[28:31], a[64:71], v6
  ds_read_b128 v[120:123], v8 offset:32768
  v_add_f32 v52, v52, v54
  v_smfmac_f32_16x16x64_bf16 v[56:59], v[32:35], a[56:63], v6
  ds_read_b128 v[124:127], v8 offset:36864
  v_add_f32 v53, v53, v55
  v_cvt_pk_bf16_f32 v54, v52, v53
  v_smfmac_f32_16x16x64_bf16 v[56:59], v[36:39], a[48:55], v6
  ds_write2_b32 v2, v54, v54 offset0:128 offset1:129
  ds_read_b64_tr_b16 v[90:91], v12 offset:512
  v_smfmac_f32_16x16x64_bf16 v[56:59], v[40:43], a[40:47], v6
  v_smfmac_f32_16x16x64_bf16 v[56:59], v[44:47], a[32:39], v6
  v_smfmac_f32_16x16x64_bf16 v[60:63], v[24:27], a[24:31], v6
  v_smfmac_f32_16x16x64_bf16 v[60:63], v[28:31], a[16:23], v6
  s_waitcnt lgkmcnt(0)
  v_add_f32 v56, v56, v58
  v_mfma_f32_16x16x32_bf16 v[92:95], v[72:75], v[88:91], 0
  buffer_store_dwordx2 v[100:101], v5, s[4:7], s97 offen sc1
  v_add_f32 v57, v57, v59
  v_cvt_pk_bf16_f32 v58, v56, v57
  v_mfma_f32_16x16x32_bf16 v[96:99], v[76:79], v[88:91], 0
  ds_write_b32 v2, v58
  v_smfmac_f32_16x16x64_bf16 v[60:63], v[32:35], a[8:15], v6
  v_mov_b32 v76, 0
  v_smfmac_f32_16x16x64_bf16 v[60:63], v[36:39], a[0:7], v6
  v_cndmask_b32 v48, v92, v96, s[18:19]
  v_smfmac_f32_16x16x64_bf16 v[60:63], v[40:43], v[248:255], v6
  v_cndmask_b32 v49, v93, v97, s[18:19]
  v_smfmac_f32_16x16x64_bf16 v[60:63], v[44:47], v[240:247], v6
  v_cndmask_b32 v50, v94, v98, s[18:19]
  v_smfmac_f32_16x16x64_bf16 v[68:71], v[20:23], v[152:159], v6
  v_cndmask_b32 v51, v95, v99, s[18:19]
  v_smfmac_f32_16x16x64_bf16 v[64:67], v[24:27], v[232:239], v6
  ds_write_b128 v8, v[48:51] offset:12288
  v_add_f32 v60, v60, v62
  v_add_f32 v61, v61, v63
  v_cvt_pk_bf16_f32 v62, v60, v61
  v_smfmac_f32_16x16x64_bf16 v[64:67], v[28:31], v[224:231], v6
  ds_write_b32 v2, v62 offset:512
  s_waitcnt vmcnt(6)
  v_mov_b32 v79, 0
  v_smfmac_f32_16x16x64_bf16 v[64:67], v[32:35], v[216:223], v6
  v_mov_b64 v[20:21], s[14:15]
  v_smfmac_f32_16x16x64_bf16 v[64:67], v[36:39], v[200:207], v6
  v_mov_b64 v[22:23], s[14:15]
  v_smfmac_f32_16x16x64_bf16 v[64:67], v[40:43], v[192:199], v6
  s_waitcnt lgkmcnt(0)
  s_barrier
  ds_read_b128 v[52:55], v9 offset:12288
  ds_read_b128 v[56:59], v10 offset:12288
  v_smfmac_f32_16x16x64_bf16 v[64:67], v[44:47], v[184:191], v6
  ds_read_b128 v[60:63], v11 offset:12288
  v_smfmac_f32_16x16x64_bf16 v[68:71], v[24:27], v[176:183], v6
  ds_read_b64_tr_b16 v[88:89], v12 offset:0
  ds_read_b64_tr_b16 v[90:91], v12 offset:512
  v_smfmac_f32_16x16x64_bf16 v[68:71], v[28:31], v[168:175], v6
  ds_read_b64_tr_b16 v[92:93], v13 offset:0
  ds_read_b64_tr_b16 v[94:95], v13 offset:512
  v_add_f32 v64, v64, v66
  v_smfmac_f32_16x16x64_bf16 v[68:71], v[32:35], v[160:167], v6
  ds_read_b64_tr_b16 v[96:97], v14 offset:0
  ds_read_b64_tr_b16 v[98:99], v14 offset:512
  v_add_f32 v65, v65, v67
  v_smfmac_f32_16x16x64_bf16 v[68:71], v[36:39], v[144:151], v6
  ds_read_b64_tr_b16 v[100:101], v15 offset:0
  ds_read_b64_tr_b16 v[102:103], v15 offset:512
  s_waitcnt lgkmcnt(8)
  v_cvt_pk_bf16_f32 v66, v64, v65
  v_smfmac_f32_16x16x64_bf16 v[68:71], v[40:43], v[136:143], v6
  v_add_f32 v48, v48, v52
  v_smfmac_f32_16x16x64_bf16 v[68:71], v[44:47], v[128:135], v6
  s_waitcnt lgkmcnt(4)
  v_add_f32 v49, v49, v53
  v_mfma_f32_16x16x32_bf16 v[16:19], v[88:91], v[88:91], 0
  buffer_store_dwordx4 v[88:91], v8, s[4:7], s25 offen sc1
  v_add_f32 v50, v50, v54
  v_add_f32 v51, v51, v55
  v_mfma_f32_16x16x32_bf16 v[16:19], v[92:95], v[92:95], v[16:19]
  s_waitcnt lgkmcnt(0)
  v_add_f32 v56, v56, v60
  v_add_f32 v57, v57, v61
  v_mfma_f32_16x16x32_bf16 v[16:19], v[96:99], v[96:99], v[16:19]
  v_add_f32 v58, v58, v62
  v_add_f32 v59, v59, v63
  v_mfma_f32_16x16x32_bf16 v[16:19], v[100:103], v[100:103], v[16:19]
  v_add_f32 v48, v48, v56
  v_add_f32 v49, v49, v57
  v_add_f32 v50, v50, v58
  v_add_f32 v51, v51, v59
  v_exp_f32 v24, v48
  v_exp_f32 v25, v49
  v_exp_f32 v26, v50
  v_exp_f32 v27, v51
  v_cvt_pk_bf16_f32 v24, v24, v25
  v_mul_f32 v16, s24, v16
  v_cvt_pk_bf16_f32 v25, v26, v27
  v_cndmask_b32 v72, v24, 0, s[18:19]
  v_cndmask_b32 v73, v25, 0, s[18:19]
  v_cndmask_b32 v74, 0, v24, s[18:19]
  v_cndmask_b32 v75, 0, v25, s[18:19]
  v_mul_f32 v17, s24, v17
  v_exp_f32 v28, v16
  v_mfma_f32_16x16x32_bf16 v[60:63], v[72:75], v[20:23], 0
  v_exp_f32 v29, v17
  v_add_f32 v68, v68, v70
  v_mfma_f32_16x16x32_bf16 v[52:55], v[72:75], v[80:83], 0
  s_add_u32 s30, s25, 4096
  v_cvt_pk_bf16_f32 v28, v28, v29
  v_add_f32 v69, v69, v71
  v_mfma_f32_16x16x32_bf16 v[56:59], v[72:75], v[84:87], 0
  v_cndmask_b32 v77, 0, v28, s[18:19]
  v_cndmask_b32 v78, 0, v28, s[18:19]
  v_cvt_pk_bf16_f32 v67, v68, v69
  v_lshrrev_b32 v92, 1, v8
  v_mfma_f32_16x16x16_bf16 v[60:63], v[76:77], v[20:21], v[60:63]
  buffer_store_dwordx2 v[66:67], v92, s[4:7], s30 offen sc1
  v_max3_f32 v7, |v48|, |v49|, |v50|
  v_max_f32 v26, |v16|, |v17|
  v_mfma_f32_16x16x16_bf16 v[52:55], v[78:79], v[66:67], v[52:55]
  v_cndmask_b32 v26, 0, v26, s[18:19]
  v_max3_f32 v7, |v51|, v26, v7
  v_mfma_f32_16x16x16_bf16 v[56:59], v[76:77], v[66:67], v[56:59]
  v_cmp_lt_f32 vcc, 0x42700000, v7
  v_mov_b64 v[44:45], 0
  v_add_f32 v60, v60, v62
  v_add_f32 v61, v61, v63
  s_cbranch_vccnz c_fb_14
c_fbr_15:
  v_rcp_f32 v60, v60
  v_rcp_f32 v61, v61
  v_pk_add_f32 v[52:53], v[52:53], v[54:55]
  v_pk_add_f32 v[56:57], v[56:57], v[58:59]
  v_pk_mul_f32 v[52:53], v[52:53], v[60:61]
  v_pk_mul_f32 v[56:57], v[56:57], v[60:61]
  v_cvt_pk_bf16_f32 v54, v52, v53
  v_cvt_pk_bf16_f32 v55, v56, v57
  ds_write_b64 v2, v[54:55] offset:4096
  v_mov_b64 v[46:47], 0
  v_mov_b64 v[40:41], 0
  v_mov_b64 v[42:43], 0
  v_mov_b64 v[36:37], 0
  v_mov_b64 v[38:39], 0
  v_mov_b64 v[32:33], 0
  v_mov_b64 v[34:35], 0
  v_mov_b64 v[28:29], 0
  v_mov_b64 v[30:31], 0
  v_mov_b64 v[24:25], 0
  v_mov_b64 v[26:27], 0
  v_mov_b64 v[80:81], 0
  v_mov_b64 v[82:83], 0
  v_mov_b64 v[84:85], 0
  v_mov_b64 v[86:87], 0
  s_waitcnt lgkmcnt(0)
  s_barrier
  ds_read_b64_tr_b16 v[72:73], v3 offset:4096
  ds_read_b64_tr_b16 v[74:75], v3 offset:5120
  ds_read_b64_tr_b16 v[76:77], v3 offset:6144
  ds_read_b64_tr_b16 v[78:79], v3 offset:7168
  s_and_b32 s3, s21, 1
  s_add_u32 s21, s21, 1
  s_add_u32 s22, s22, 1
  s_and_b32 s42, s21, 3
  s_lshl_b32 s42, s42, 13
  s_cmp_eq_u32 s22, 64
  s_cbranch_scc1 c_last_17
  s_waitcnt lgkmcnt(2)
  v_smfmac_f32_16x16x64_bf16 v[44:47], v[72:75], a[248:255], v6
  s_waitcnt lgkmcnt(0)
  ds_read_b128 v[16:19], v8 offset:40960
  v_smfmac_f32_16x16x64_bf16 v[44:47], v[76:79], a[240:247], v6
  ds_read_b128 v[20:23], v8 offset:45056
  v_smfmac_f32_16x16x64_bf16 v[40:43], v[72:75], a[232:239], v6
  ds_read_b128 v[88:91], v8 offset:49152
  v_smfmac_f32_16x16x64_bf16 v[40:43], v[76:79], a[224:231], v6
  ds_read_b128 v[92:95], v8 offset:53248
  v_add_f32 v44, v44, v46
  v_add_f32 v45, v45, v47
  v_smfmac_f32_16x16x64_bf16 v[36:39], v[72:75], a[216:223], v6
  ds_read_b128 v[96:99], v8 offset:57344
  v_cvt_pk_bf16_f32 v48, v44, v45
  v_and_or_b32 v48, v48, -2, s3
  v_smfmac_f32_16x16x64_bf16 v[36:39], v[76:79], a[208:215], v6
  ds_read_b128 v[100:103], v8 offset:61440
  v_add_f32 v40, v40, v42
  v_add_f32 v41, v41, v43
  v_smfmac_f32_16x16x64_bf16 v[32:35], v[72:75], a[200:207], v6
  v_cvt_pk_bf16_f32 v49, v40, v41
  v_smfmac_f32_16x16x64_bf16 v[32:35], v[76:79], a[192:199], v6
  v_add_f32 v36, v36, v38
  v_add_f32 v37, v37, v39
  v_smfmac_f32_16x16x64_bf16 v[28:31], v[72:75], a[184:191], v6
  v_cvt_pk_bf16_f32 v50, v36, v37
  v_smfmac_f32_16x16x64_bf16 v[28:31], v[76:79], a[176:183], v6
  v_add_f32 v32, v32, v34
  v_add_f32 v33, v33, v35
  v_smfmac_f32_16x16x64_bf16 v[24:27], v[72:75], v[104:111], v6
  v_cvt_pk_bf16_f32 v51, v32, v33
  v_smfmac_f32_16x16x64_bf16 v[24:27], v[76:79], v[112:119], v6
  buffer_store_dwordx4 v[48:51], v4, s[4:7], s40 offen
  v_add_f32 v28, v28, v30
  v_add_f32 v29, v29, v31
  v_smfmac_f32_16x16x64_bf16 v[80:83], v[72:75], v[120:127], v6
  s_waitcnt lgkmcnt(0)
  v_cvt_pk_bf16_f32 v52, v28, v29
  v_and_or_b32 v52, v52, -2, s3
  v_smfmac_f32_16x16x64_bf16 v[80:83], v[76:79], v[16:23], v6
  v_add_f32 v24, v24, v26
  v_add_f32 v25, v25, v27
  v_smfmac_f32_16x16x64_bf16 v[84:87], v[72:75], v[88:95], v6
  v_cvt_pk_bf16_f32 v53, v24, v25
  v_smfmac_f32_16x16x64_bf16 v[84:87], v[76:79], v[96:103], v6
  v_add_f32 v80, v80, v82
  v_add_f32 v81, v81, v83
  v_cvt_pk_bf16_f32 v54, v80, v81
  s_nop 0
  s_nop 3
  v_pk_add_f32 v[84:85], v[84:85], v[86:87]
  v_cvt_pk_bf16_f32 v55, v84, v85
  buffer_store_dwordx4 v[52:55], v4, s[4:7], s41 offen
  s_add_u32 s42, s42, s62
  s_add_u32 s43, s42, 4096
  s_add_u32 s23, s23, 524288
  s_add_u32 s25, s25, 262144
  s_add_u32 s63, s63, 4096
  s_add_u32 s64, s64, 2048
  s_andn2_b32 s64, s64, s2
  s_add_u32 s97, s97, 8192
  s_add_u32 s92, s63, s20
  s_cmp_lg_u32 s17, 0
  s_cbranch_scc1 c_oth_29
  s_mov_b32 s28, 0
  s_add_u32 s46, s46, 1
  v_mov_b64 v[64:65], -1
  s_xor_b32 s34, s42, 16384
  buffer_store_dwordx2 v[64:65], v5, s[4:7], s34 offen
  s_mov_b32 vcc_lo, 0xaaaaaaaa
  s_mov_b32 vcc_hi, 0xaaaaaaaa
  v_mov_b32 v7, 0x3f80
  v_cndmask_b32 v7, v7, 1.0, vcc
  s_mov_b32 vcc_lo, 0x30003
  s_mov_b32 vcc_hi, 0x30003
  v_cndmask_b32 v68, 0, v7, vcc
  s_mov_b32 vcc_lo, 0xc000c
  s_mov_b32 vcc_hi, 0xc000c
  v_cndmask_b32 v69, 0, v7, vcc
  s_mov_b32 vcc_lo, 0x300030
  s_mov_b32 vcc_hi, 0x300030
  v_cndmask_b32 v70, 0, v7, vcc
  s_mov_b32 vcc_lo, 0xc000c0
  s_mov_b32 vcc_hi, 0xc000c0
  v_cndmask_b32 v71, 0, v7, vcc
  ds_read_b128 v[104:107], v1 offset:14336
  ds_read_b128 v[108:111], v1 offset:15360
  s_waitcnt lgkmcnt(0)
  ds_read_b128 v[112:115], v1 offset:16384
  ds_read_b128 v[116:119], v1 offset:17408
  ds_read_b128 v[120:123], v1 offset:18432
  ds_read_b128 v[124:127], v1 offset:19456
  s_waitcnt lgkmcnt(0)
  buffer_load_dwordx4 v[16:19], v0, s[4:7], s38 offen offset:0 sc1
  buffer_load_dwordx4 v[20:23], v0, s[4:7], s38 offen offset:1024 sc1
  buffer_load_dwordx4 v[24:27], v0, s[4:7], s38 offen offset:2048 sc1
  buffer_load_dwordx4 v[28:31], v0, s[4:7], s38 offen offset:3072 sc1
  buffer_load_dwordx4 v[32:35], v0, s[4:7], s39 offen offset:0 sc1
  buffer_load_dwordx4 v[36:39], v0, s[4:7], s39 offen offset:1024 sc1
  buffer_load_dwordx4 v[40:43], v0, s[4:7], s39 offen offset:2048 sc1
  buffer_load_dwordx4 v[44:47], v0, s[4:7], s39 offen offset:3072 sc1
  buffer_load_dwordx4 v[72:75], v0, s[4:7], s38 offen offset:0 sc1
  buffer_load_dwordx4 v[76:79], v0, s[4:7], s38 offen offset:1024 sc1
  buffer_load_dwordx4 v[80:83], v0, s[4:7], s38 offen offset:2048 sc1
  buffer_load_dwordx4 v[84:87], v0, s[4:7], s38 offen offset:3072 sc1
  buffer_load_dwordx4 v[88:91], v0, s[4:7], s39 offen offset:0 sc1
  buffer_load_dwordx4 v[92:95], v0, s[4:7], s39 offen offset:1024 sc1
  buffer_load_dwordx4 v[96:99], v0, s[4:7], s39 offen offset:2048 sc1
  buffer_load_dwordx4 v[100:103], v0, s[4:7], s39 offen offset:3072 sc1
  s_buffer_load_dword s65, s[4:7], s63
  s_waitcnt vmcnt(15)
  v_mfma_f32_16x16x32_bf16 v[64:67], v[16:19], v[68:71], 0
  v_xor_b32 v7, s3, v16
  s_waitcnt vmcnt(14)
  v_mfma_f32_16x16x32_bf16 v[64:67], v[20:23], v[68:71], v[64:67]
  v_bitop3_b32 v7, v7, v20, s3 bitop3:0xf6
  s_waitcnt vmcnt(13)
  v_mfma_f32_16x16x32_bf16 v[64:67], v[24:27], v[68:71], v[64:67]
  v_bitop3_b32 v7, v7, v24, s3 bitop3:0xf6
  s_waitcnt vmcnt(12)
  v_mfma_f32_16x16x32_bf16 v[64:67], v[28:31], v[68:71], v[64:67]
  v_bitop3_b32 v7, v7, v28, s3 bitop3:0xf6
  s_waitcnt vmcnt(11)
  v_mfma_f32_16x16x32_bf16 v[64:67], v[32:35], v[68:71], v[64:67]
  v_bitop3_b32 v7, v7, v32, s3 bitop3:0xf6
  s_waitcnt vmcnt(10)
  v_mfma_f32_16x16x32_bf16 v[64:67], v[36:39], v[68:71], v[64:67]
  v_bitop3_b32 v7, v7, v36, s3 bitop3:0xf6
  s_waitcnt vmcnt(9)
  v_mfma_f32_16x16x32_bf16 v[64:67], v[40:43], v[68:71], v[64:67]
  v_bitop3_b32 v7, v7, v40, s3 bitop3:0xf6
  s_waitcnt vmcnt(8)
  v_mfma_f32_16x16x32_bf16 v[64:67], v[44:47], v[68:71], v[64:67]
  v_bitop3_b32 v7, v7, v44, s3 bitop3:0xf6
  v_and_b32 v7, 1, v7
  v_cmp_ne_u32 vcc, 0, v7
  v_mov_b32 v7, 0
  v_mov_b32 v7, 0
  s_cbranch_vccnz c_p1r_30
c_publ_31:
  s_nop 1
  s_nop 0
  v_cvt_pk_bf16_f32 v64, v64, v65
  v_cvt_pk_bf16_f32 v65, v66, v67
  v_min_u32 v64, -2, v64
  v_min_u32 v65, -2, v65
  buffer_store_dwordx2 v[64:65], v5, s[4:7], s42 offen
  s_waitcnt vmcnt(1)
  ds_read_b128 v[24:27], v1 offset:0
  ds_read_b128 v[28:31], v1 offset:1024
  ds_read_b128 v[32:35], v1 offset:2048
  ds_read_b128 v[36:39], v1 offset:3072
  ds_read_b128 v[40:43], v1 offset:4096
  ds_read_b128 v[44:47], v1 offset:5120
  ds_read_b128 v[72:75], v1 offset:6144
  ds_read_b128 v[76:79], v1 offset:7168
  ds_read_b128 v[80:83], v1 offset:8192
  ds_read_b128 v[84:87], v1 offset:9216
  ds_read_b128 v[88:91], v1 offset:10240
  ds_read_b128 v[92:95], v1 offset:11264
  ds_read_b128 v[96:99], v1 offset:12288
  ds_read_b128 v[100:103], v1 offset:13312
c_hop2_13:
  s_barrier
  s_cmp_le_u32 s96, s23
  s_cbranch_scc1 c_loop_10
  s_cmp_lg_u32 s96, 268435456
  s_cbranch_scc1 c_fk0_32
  buffer_store_dwordx2 v[64:65], v5, s[4:7], s97 offen sc1
  s_mov_b32 s29, 0
  s_sub_u32 s92, s63, 4096
  s_sub_u32 s96, s23, 524288
  s_mov_b32 s95, 0
c_gw_33:
  buffer_load_dword v7, off, s[4:7], s92 sc1
  s_add_u32 s29, s29, 1
  s_cmp_gt_u32 s29, 1048576
  s_cbranch_scc1 c_fail_16
  s_waitcnt vmcnt(0) lgkmcnt(0)
  v_readfirstlane_b32 s65, v7
  s_cmp_eq_u32 s65, 0
  s_cbranch_scc1 c_gw_33
  s_and_b32 s65, s65, s93
  s_cbranch_scc1 c_kvx_35
  s_mov_b32 s95, 1
  s_add_u32 s96, s96, 33554432
  s_add_u32 s92, s92, 262144
c_kvw_34:
  buffer_load_dword v7, off, s[4:7], s92 sc1
  s_add_u32 s29, s29, 1
  s_cmp_gt_u32 s29, 1048576
  s_cbranch_scc1 c_fail_16
  s_waitcnt vmcnt(0) lgkmcnt(0)
  v_readfirstlane_b32 s65, v7
  s_cmp_eq_u32 s65, 0
  s_cbranch_scc1 c_kvw_34
c_kvx_35:
  buffer_load_dword v7, off, s[4:7], s63 sc1
  buffer_load_dwordx4 v0, s[4:7], s96 offen offset:0  lds
  buffer_load_dwordx4 v0, s[4:7], s96 offen offset:1024  lds
  buffer_load_dwordx4 v0, s[4:7], s96 offen offset:2048  lds
  buffer_load_dwordx4 v0, s[4:7], s96 offen offset:3072  lds
  s_waitcnt vmcnt(4)
  v_readfirstlane_b32 s65, v7
  s_mov_b32 s94, 0
  s_cmp_eq_u32 s95, 0
  s_cbranch_scc1 c_loop_10
c_fk0_32:
  s_mov_b32 s29, 0
c_fk_36:
  buffer_load_dwordx4 v[16:19], v8, s[4:7], s42 offen sc1
  buffer_load_dwordx4 v[20:23], v8, s[4:7], s43 offen sc1
  s_add_u32 s29, s29, 1
  s_cmp_gt_u32 s29, 1048576
  s_cbranch_scc1 c_fail_16
  s_waitcnt vmcnt(0)
  v_max3_u32 v7, v16, v17, v18
  v_max3_u32 v7, v19, v20, v7
  v_max3_u32 v7, v21, v22, v7
  v_max_u32 v7, v7, v23
  v_cmp_eq_u32 vcc, -1, v7
  s_cbranch_vccnz c_fk_36
c_fk1_37:
  s_lshl_b32 s42, s22, 13
  s_add_u32 s42, s42, 245891072
  s_add_u32 s43, s42, 4096
  s_mov_b32 s95, 0
  s_branch c_loop_10
c_xb_25:
  s_cmp_lg_u32 s93, 1
  s_cbranch_scc1 c_xr_26
  s_cmp_ge_u32 s22, 63
  s_cbranch_scc1 c_xr_26
c_xp_38:
  s_cmp_lg_u32 s65, 0
  s_cbranch_scc1 c_xs_39
  buffer_load_dword v7, off, s[4:7], s63 sc1
  s_add_u32 s29, s29, 1
  s_cmp_gt_u32 s29, 1048576
  s_cbranch_scc1 c_fail_16
  s_waitcnt vmcnt(0)
  v_readfirstlane_b32 s65, v7
  s_branch c_xp_38
c_xs_39:
  s_cmp_eq_u32 s65, 1
  s_cbranch_scc1 c_xr_26
  s_mov_b32 s29, 0
c_xw_40:
  buffer_load_dwordx4 v[16:19], v8, s[4:7], s42 offen sc1
  buffer_load_dwordx4 v[20:23], v8, s[4:7], s43 offen sc1
  s_add_u32 s29, s29, 1
  s_cmp_gt_u32 s29, 1048576
  s_cbranch_scc1 c_fail_16
  s_waitcnt vmcnt(0)
  v_max3_u32 v7, v16, v17, v18
  v_max3_u32 v7, v19, v20, v7
  v_max3_u32 v7, v21, v22, v7
  v_max_u32 v7, v7, v23
  v_cmp_eq_u32 vcc, -1, v7
  s_cbranch_vccnz c_xw_40
  v_mov_b32 v7, 1
  s_barrier
  s_mov_b64 exec, 1
  buffer_store_dword v7, off, s[4:7], s64 sc1
  s_mov_b64 exec, -1
  s_add_u32 s22, s22, 1
  s_add_u32 s23, s23, 524288
  s_add_u32 s25, s25, 262144
  s_add_u32 s63, s63, 4096
  s_add_u32 s64, s64, 2048
  s_andn2_b32 s64, s64, s2
  s_mov_b32 s29, 0
  s_sub_u32 s92, s63, 4096
  s_sub_u32 s96, s23, 524288
  s_mov_b32 s95, 0
  s_mov_b32 s95, 1
  s_add_u32 s96, s96, 33554432
  s_add_u32 s92, s92, 262144
c_kvw_42:
  buffer_load_dword v7, off, s[4:7], s92 sc1
  s_add_u32 s29, s29, 1
  s_cmp_gt_u32 s29, 1048576
  s_cbranch_scc1 c_fail_16
  s_waitcnt vmcnt(0) lgkmcnt(0)
  v_readfirstlane_b32 s65, v7
  s_cmp_eq_u32 s65, 0
  s_cbranch_scc1 c_kvw_42
c_kvx_43:
  buffer_load_dword v7, off, s[4:7], s63 sc1
  buffer_load_dwordx4 v0, s[4:7], s96 offen offset:0  lds
  buffer_load_dwordx4 v0, s[4:7], s96 offen offset:1024  lds
  buffer_load_dwordx4 v0, s[4:7], s96 offen offset:2048  lds
  buffer_load_dwordx4 v0, s[4:7], s96 offen offset:3072  lds
  s_waitcnt vmcnt(4)
  v_readfirstlane_b32 s65, v7
  s_mov_b32 s94, 0
  s_branch c_fk1_37
c_last_17:
  s_add_u32 s64, s64, 2048
  v_mov_b32 v7, 1
  s_waitcnt vmcnt(0)
  s_barrier
  s_mov_b64 exec, 1
  buffer_store_dword v7, off, s[4:7], s64 sc1
  s_mov_b64 exec, -1
  s_branch L_chdone
c_oth_29:
  s_buffer_load_dword s65, s[4:7], s63
  ds_read_b128 v[24:27], v1 offset:0
  ds_read_b128 v[28:31], v1 offset:1024
  ds_read_b128 v[32:35], v1 offset:2048
  ds_read_b128 v[36:39], v1 offset:3072
  ds_read_b128 v[40:43], v1 offset:4096
  ds_read_b128 v[44:47], v1 offset:5120
  ds_read_b128 v[72:75], v1 offset:6144
  ds_read_b128 v[76:79], v1 offset:7168
  ds_read_b128 v[80:83], v1 offset:8192
  ds_read_b128 v[84:87], v1 offset:9216
  ds_read_b128 v[88:91], v1 offset:10240
  ds_read_b128 v[92:95], v1 offset:11264
  ds_read_b128 v[96:99], v1 offset:12288
  ds_read_b128 v[100:103], v1 offset:13312
  ds_read_b128 v[104:107], v1 offset:14336
  ds_read_b128 v[108:111], v1 offset:15360
  ds_read_b128 v[112:115], v1 offset:16384
  ds_read_b128 v[116:119], v1 offset:17408
  ds_read_b128 v[120:123], v1 offset:18432
  ds_read_b128 v[124:127], v1 offset:19456
  s_branch c_hop2_13
c_p1r_30:
  s_waitcnt vmcnt(7)
  s_nop 0
  v_mfma_f32_16x16x32_bf16 v[64:67], v[72:75], v[68:71], 0
  v_xor_b32 v7, s3, v72
  s_waitcnt vmcnt(6)
  v_mfma_f32_16x16x32_bf16 v[64:67], v[76:79], v[68:71], v[64:67]
  v_bitop3_b32 v7, v7, v76, s3 bitop3:0xf6
  s_waitcnt vmcnt(5)
  v_mfma_f32_16x16x32_bf16 v[64:67], v[80:83], v[68:71], v[64:67]
  v_bitop3_b32 v7, v7, v80, s3 bitop3:0xf6
  s_waitcnt vmcnt(4)
  v_mfma_f32_16x16x32_bf16 v[64:67], v[84:87], v[68:71], v[64:67]
  v_bitop3_b32 v7, v7, v84, s3 bitop3:0xf6
  s_waitcnt vmcnt(3)
  v_mfma_f32_16x16x32_bf16 v[64:67], v[88:91], v[68:71], v[64:67]
  v_bitop3_b32 v7, v7, v88, s3 bitop3:0xf6
  s_waitcnt vmcnt(2)
  v_mfma_f32_16x16x32_bf16 v[64:67], v[92:95], v[68:71], v[64:67]
  v_bitop3_b32 v7, v7, v92, s3 bitop3:0xf6
  s_waitcnt vmcnt(1)
  v_mfma_f32_16x16x32_bf16 v[64:67], v[96:99], v[68:71], v[64:67]
  v_bitop3_b32 v7, v7, v96, s3 bitop3:0xf6
  s_waitcnt vmcnt(0)
  v_mfma_f32_16x16x32_bf16 v[64:67], v[100:103], v[68:71], v[64:67]
  v_bitop3_b32 v7, v7, v100, s3 bitop3:0xf6
  v_and_b32 v7, 1, v7
  v_cmp_ne_u32 vcc, 0, v7
  s_add_u32 s46, s46, 1
  s_cbranch_vccz c_publ_31
  buffer_load_dwordx4 v[72:75], v0, s[4:7], s38 offen offset:0 sc1
  buffer_load_dwordx4 v[76:79], v0, s[4:7], s38 offen offset:1024 sc1
  buffer_load_dwordx4 v[80:83], v0, s[4:7], s38 offen offset:2048 sc1
  buffer_load_dwordx4 v[84:87], v0, s[4:7], s38 offen offset:3072 sc1
  buffer_load_dwordx4 v[88:91], v0, s[4:7], s39 offen offset:0 sc1
  buffer_load_dwordx4 v[92:95], v0, s[4:7], s39 offen offset:1024 sc1
  buffer_load_dwordx4 v[96:99], v0, s[4:7], s39 offen offset:2048 sc1
  buffer_load_dwordx4 v[100:103], v0, s[4:7], s39 offen offset:3072 sc1
  s_add_u32 s28, s28, 1
  s_cmp_gt_u32 s28, 1048576
  s_cbranch_scc0 c_p1r_30
  s_branch c_fail_16
c_retry_11:
  v_mov_b64 v[48:49], 0
  v_mov_b64 v[50:51], 0
  s_nop 0
  v_mov_b64 v[52:53], 0
  v_mov_b64 v[54:55], 0
  s_nop 1
  v_mov_b64 v[56:57], 0
  v_mov_b64 v[58:59], 0
c_rl_44:
  buffer_load_dwordx4 v[16:19], v8, s[4:7], s42 offen sc1
  buffer_load_dwordx4 v[20:23], v8, s[4:7], s43 offen sc1
  s_add_u32 s28, s28, 1
  s_add_u32 s47, s47, 1
  s_cmp_gt_u32 s28, 1048576
  s_cbranch_scc1 c_fail_16
  s_waitcnt vmcnt(2)
  v_max3_u32 v7, v16, v17, v18
  v_max3_u32 v7, v19, v20, v7
  v_max3_u32 v7, v21, v22, v7
  v_max_u32 v7, v7, v23
  v_cmp_eq_u32 vcc, -1, v7
  s_cbranch_vccnz c_rl_44
  ds_write_b128 v8, v[16:19] offset:4096
  v_smfmac_f32_16x16x64_bf16 v[48:51], v[16:19], v[24:31], v6
  ds_write_b128 v8, v[20:23] offset:8192
  v_smfmac_f32_16x16x64_bf16 v[52:55], v[16:19], v[32:39], v6
  v_smfmac_f32_16x16x64_bf16 v[56:59], v[16:19], v[40:47], v6
  s_branch c_got_12
c_fb_14:
  v_max3_f32 v7, v48, v49, v50
  v_max_f32 v7, v51, v7
  s_mov_b64 exec, s[18:19]
  v_max3_f32 v7, v16, v17, v7
  s_mov_b64 exec, -1
  s_nop 0
  v_max_f32_dpp v7, v7, v7 quad_perm:[2,3,0,1] row_mask:0xf bank_mask:0xf
  v_mov_b32 v24, v7
  s_nop 0
  s_nop 0
  v_permlane16_swap_b32 v7, v24
  v_max_f32 v7, v7, v24
  v_mov_b32 v24, v7
  s_nop 0
  s_nop 0
  v_permlane32_swap_b32 v7, v24
  v_max_f32 v7, v7, v24
  v_sub_f32 v24, v48, v7
  v_sub_f32 v25, v49, v7
  v_sub_f32 v26, v50, v7
  v_sub_f32 v27, v51, v7
  v_sub_f32 v28, v16, v7
  v_sub_f32 v29, v17, v7
  v_exp_f32 v24, v24
  v_exp_f32 v25, v25
  v_exp_f32 v26, v26
  v_exp_f32 v27, v27
  v_exp_f32 v28, v28
  v_exp_f32 v29, v29
  v_cvt_pk_bf16_f32 v24, v24, v25
  v_cvt_pk_bf16_f32 v25, v26, v27
  v_cvt_pk_bf16_f32 v28, v28, v29
  v_cndmask_b32 v72, v24, 0, s[18:19]
  v_cndmask_b32 v73, v25, 0, s[18:19]
  v_cndmask_b32 v74, 0, v24, s[18:19]
  v_cndmask_b32 v75, 0, v25, s[18:19]
  v_cndmask_b32 v77, 0, v28, s[18:19]
  v_cndmask_b32 v78, 0, v28, s[18:19]
  v_mfma_f32_16x16x32_bf16 v[60:63], v[72:75], v[20:23], 0
  v_mfma_f32_16x16x32_bf16 v[52:55], v[72:75], v[80:83], 0
  v_mfma_f32_16x16x32_bf16 v[56:59], v[72:75], v[84:87], 0
  v_mfma_f32_16x16x16_bf16 v[60:63], v[76:77], v[20:21], v[60:63]
  v_mfma_f32_16x16x16_bf16 v[52:55], v[78:79], v[66:67], v[52:55]
  s_nop 2
  v_mfma_f32_16x16x16_bf16 v[56:59], v[76:77], v[66:67], v[56:59]
  s_nop 7
  v_add_f32 v60, v60, v62
  v_add_f32 v61, v61, v63
  s_branch c_fbr_15
c_fail_16:
  s_endpgm
L_chain_x:
  s_mov_b32 s22, 0
  s_mov_b32 s21, 0
  s_mov_b32 s42, s62
  s_add_u32 s43, s62, 4096
  s_mov_b32 s46, 0
  s_mov_b32 s47, 0
  s_lshl_b32 s26, s16, 2
  s_add_u32 s26, s26, s17
  s_lshl_b32 s27, s60, 13
  s_add_u32 s27, s27, s26
  s_lshr_b32 s25, s27, 2
  s_lshl_b32 s25, s25, 13
  s_add_u32 s25, s25, 192937984
  s_lshr_b32 s64, s27, 2
  s_lshl_b32 s64, s64, 6
  s_add_u32 s64, s64, 513538048
  s_cmp_eq_u32 s17, 3
  s_cselect_b32 s2, 268435456, 0
  s_lshl_b32 s27, s61, 13
  s_add_u32 s27, s27, s26
  s_lshl_b32 s23, s27, 12
  s_add_u32 s23, s23, 41943040
  s_lshl_b32 s63, s27, 5
  s_add_u32 s63, s63, 244318208
  s_mov_b32 s97, 268435456
  s_cmp_eq_u32 s60, 2
  s_cselect_b32 s20, 262144, s97
  s_cselect_b32 s93, 1, 3
  s_lshl_b32 s26, s17, 2
  s_add_u32 s26, s26, s60
  s_cmp_eq_u32 s26, 1
  s_cselect_b32 s97, 245891072, s97
  s_mov_b32 s95, 0
  s_mov_b32 s96, s23
  s_add_u32 s23, s23, 524288
  s_add_u32 s63, s63, 4096
  s_cmp_eq_u32 s66, 0
  s_cbranch_scc1 c_pk_53
  s_sub_u32 s96, s23, 524288
  s_mov_b32 s65, s67
  s_mov_b32 s94, 0
  buffer_load_dwordx4 v0, s[4:7], s96 offen offset:0  lds
  buffer_load_dwordx4 v0, s[4:7], s96 offen offset:1024  lds
  buffer_load_dwordx4 v0, s[4:7], s96 offen offset:2048  lds
  buffer_load_dwordx4 v0, s[4:7], s96 offen offset:3072  lds
  s_branch c_pk2_54
c_pk_53:
  s_mov_b32 s29, 0
  s_sub_u32 s92, s63, 4096
  s_sub_u32 s96, s23, 524288
  s_mov_b32 s95, 0
c_gw_55:
  buffer_load_dword v7, off, s[4:7], s92 sc1
  s_add_u32 s29, s29, 1
  s_cmp_gt_u32 s29, 1048576
  s_cbranch_scc1 c_fail_51
  s_waitcnt vmcnt(0) lgkmcnt(0)
  v_readfirstlane_b32 s65, v7
  s_cmp_eq_u32 s65, 0
  s_cbranch_scc1 c_gw_55
  s_and_b32 s65, s65, s93
  s_cbranch_scc1 c_kvx_57
  s_mov_b32 s95, 1
  s_add_u32 s96, s96, 33554432
  s_add_u32 s92, s92, 262144
c_kvw_56:
  buffer_load_dword v7, off, s[4:7], s92 sc1
  s_add_u32 s29, s29, 1
  s_cmp_gt_u32 s29, 1048576
  s_cbranch_scc1 c_fail_51
  s_waitcnt vmcnt(0) lgkmcnt(0)
  v_readfirstlane_b32 s65, v7
  s_cmp_eq_u32 s65, 0
  s_cbranch_scc1 c_kvw_56
c_kvx_57:
  buffer_load_dword v7, off, s[4:7], s63 sc1
  buffer_load_dwordx4 v0, s[4:7], s96 offen offset:0  lds
  buffer_load_dwordx4 v0, s[4:7], s96 offen offset:1024  lds
  buffer_load_dwordx4 v0, s[4:7], s96 offen offset:2048  lds
  buffer_load_dwordx4 v0, s[4:7], s96 offen offset:3072  lds
  s_waitcnt vmcnt(4)
  v_readfirstlane_b32 s65, v7
  s_mov_b32 s94, 0
c_pk2_54:
  s_waitcnt vmcnt(4)
  ds_read_b128 v[72:75], v1 offset:6144
  ds_read_b128 v[76:79], v1 offset:7168
  ds_read_b128 v[80:83], v1 offset:8192
  ds_read_b128 v[84:87], v1 offset:9216
  ds_read_b128 v[88:91], v1 offset:10240
  ds_read_b128 v[92:95], v1 offset:11264
  ds_read_b128 v[96:99], v1 offset:12288
  ds_read_b128 v[100:103], v1 offset:13312
  ds_read_b128 v[104:107], v1 offset:14336
  ds_read_b128 v[108:111], v1 offset:15360
  ds_read_b128 v[112:115], v1 offset:16384
  ds_read_b128 v[116:119], v1 offset:17408
  ds_read_b128 v[120:123], v1 offset:18432
  ds_read_b128 v[124:127], v1 offset:19456
  v_mov_b64 v[48:49], 0
  v_mov_b64 v[50:51], 0
  v_mov_b64 v[52:53], 0
  v_mov_b64 v[54:55], 0
  v_mov_b64 v[56:57], 0
  v_mov_b64 v[58:59], 0
  v_mov_b64 v[60:61], 0
  v_mov_b64 v[62:63], 0
  v_mov_b64 v[64:65], 0
  v_mov_b64 v[66:67], 0
  v_mov_b64 v[68:69], 0
  v_mov_b64 v[70:71], 0
  s_lshl_b32 s38, s16, 13
  s_add_u32 s38, s38, s40
  s_add_u32 s39, s38, 4096
  ds_read_b128 v[24:27], v1 offset:0
  ds_read_b128 v[28:31], v1 offset:1024
  ds_read_b128 v[32:35], v1 offset:2048
  ds_read_b128 v[36:39], v1 offset:3072
  ds_read_b128 v[40:43], v1 offset:4096
  ds_read_b128 v[44:47], v1 offset:5120
  s_waitcnt lgkmcnt(0)
c_loop_45:
  buffer_load_dwordx4 v[16:19], v8, s[4:7], s42 offen sc1
  buffer_load_dwordx4 v[20:23], v8, s[4:7], s43 offen sc1
  s_mov_b32 s28, 0
  v_mov_b64 v[48:49], 0
  v_mov_b64 v[50:51], 0
  v_mov_b64 v[52:53], 0
  v_mov_b64 v[54:55], 0
  v_mov_b64 v[56:57], 0
  v_mov_b64 v[58:59], 0
  v_mov_b64 v[60:61], 0
  v_mov_b64 v[62:63], 0
  v_mov_b64 v[64:65], 0
  v_mov_b64 v[66:67], 0
  v_mov_b64 v[68:69], 0
  v_mov_b64 v[70:71], 0
  buffer_load_dwordx4 v[16:19], v8, s[4:7], s42 offen sc1
  buffer_load_dwordx4 v[20:23], v8, s[4:7], s43 offen sc1
  s_waitcnt lgkmcnt(0)
  s_and_b32 s29, s65, s93
  s_cbranch_scc0 c_xb_60
c_xr_61:
  s_waitcnt vmcnt(3)
  v_max3_u32 v7, v16, v17, v18
  v_max_u32 v7, v7, v19
  ds_write_b128 v8, v[16:19] offset:4096
  v_smfmac_f32_16x16x64_bf16 v[48:51], v[16:19], v[24:31], v6
  s_waitcnt vmcnt(2)
  v_max3_u32 v7, v20, v21, v7
  v_max3_u32 v7, v22, v23, v7
  ds_write_b128 v8, v[20:23] offset:8192
  v_smfmac_f32_16x16x64_bf16 v[52:55], v[16:19], v[32:39], v6
  v_cmp_eq_u32 vcc, -1, v7
  v_smfmac_f32_16x16x64_bf16 v[56:59], v[16:19], v[40:47], v6
  s_cbranch_vccnz c_retry_46
c_got_47:
  v_smfmac_f32_16x16x64_bf16 v[60:63], v[16:19], v[72:79], v6
  ds_read_b128 v[72:75], v1 offset:20480
  s_and_b32 s65, s65, s93
  s_cselect_b32 s96, s23, 268435456
  v_smfmac_f32_16x16x64_bf16 v[48:51], v[20:23], v[80:87], v6
  ds_read_b128 v[76:79], v1 offset:21504
  v_mov_b32 v7, 1
  v_smfmac_f32_16x16x64_bf16 v[52:55], v[20:23], v[88:95], v6
  ds_read_b128 v[80:83], v1 offset:22528
  v_smfmac_f32_16x16x64_bf16 v[56:59], v[20:23], v[96:103], v6
  ds_read_b128 v[84:87], v1 offset:23552
  s_waitcnt lgkmcnt(4)
  s_barrier
  ds_read_b128 v[24:27], v9 offset:4096
  ds_read_b128 v[28:31], v10 offset:4096
  v_smfmac_f32_16x16x64_bf16 v[60:63], v[20:23], v[104:111], v6
  ds_read_b128 v[32:35], v11 offset:4096
  v_smfmac_f32_16x16x64_bf16 v[64:67], v[16:19], v[112:119], v6
  ds_read_b128 v[36:39], v9 offset:8192
  v_smfmac_f32_16x16x64_bf16 v[68:71], v[16:19], v[120:127], v6
  ds_read_b128 v[40:43], v10 offset:8192
  v_smfmac_f32_16x16x64_bf16 v[64:67], v[20:23], v[208:215], v6
  ds_read_b128 v[44:47], v11 offset:8192
  s_waitcnt lgkmcnt(5)
  v_smfmac_f32_16x16x64_bf16 v[48:51], v[24:27], a[168:175], v6
  buffer_load_dwordx4 v0, s[4:7], s96 offen offset:0  lds
  s_waitcnt lgkmcnt(4)
  v_smfmac_f32_16x16x64_bf16 v[48:51], v[28:31], a[160:167], v6
  ds_read_b128 v[104:107], v8 offset:16384
  s_waitcnt lgkmcnt(4)
  v_smfmac_f32_16x16x64_bf16 v[48:51], v[32:35], a[152:159], v6
  buffer_load_dwordx4 v0, s[4:7], s96 offen offset:1024  lds
  s_waitcnt lgkmcnt(3)
  v_smfmac_f32_16x16x64_bf16 v[48:51], v[36:39], a[144:151], v6
  ds_read_b128 v[108:111], v8 offset:20480
  s_waitcnt lgkmcnt(3)
  v_smfmac_f32_16x16x64_bf16 v[48:51], v[40:43], a[136:143], v6
  buffer_load_dwordx4 v0, s[4:7], s96 offen offset:2048  lds
  s_waitcnt lgkmcnt(2)
  v_smfmac_f32_16x16x64_bf16 v[48:51], v[44:47], a[128:135], v6
  v_smfmac_f32_16x16x64_bf16 v[52:55], v[24:27], a[120:127], v6
  buffer_load_dwordx4 v0, s[4:7], s96 offen offset:3072  lds
  v_smfmac_f32_16x16x64_bf16 v[52:55], v[28:31], a[112:119], v6
  ds_read_b64 v[100:101], v5 offset:4096
  v_add_f32 v48, v48, v50
  v_smfmac_f32_16x16x64_bf16 v[52:55], v[32:35], a[104:111], v6
  ds_read_b128 v[112:115], v8 offset:24576
  v_add_f32 v49, v49, v51
  v_smfmac_f32_16x16x64_bf16 v[52:55], v[36:39], a[96:103], v6
  ds_read_b128 v[116:119], v8 offset:28672
  v_cvt_pk_bf16_f32 v50, v48, v49
  v_smfmac_f32_16x16x64_bf16 v[52:55], v[40:43], a[88:95], v6
  ds_write2_b32 v2, v50, v50 offset0:0 offset1:1
  v_smfmac_f32_16x16x64_bf16 v[52:55], v[44:47], a[80:87], v6
  ds_read_b64_tr_b16 v[88:89], v12 offset:0
  v_smfmac_f32_16x16x64_bf16 v[56:59], v[24:27], a[72:79], v6
  s_mov_b64 exec, 1
  buffer_store_dword v7, off, s[4:7], s64 sc1
  s_mov_b64 exec, -1
  v_smfmac_f32_16x16x64_bf16 v[56:59], v[28:31], a[64:71], v6
  ds_read_b128 v[120:123], v8 offset:32768
  v_add_f32 v52, v52, v54
  v_smfmac_f32_16x16x64_bf16 v[56:59], v[32:35], a[56:63], v6
  ds_read_b128 v[124:127], v8 offset:36864
  v_add_f32 v53, v53, v55
  v_cvt_pk_bf16_f32 v54, v52, v53
  v_smfmac_f32_16x16x64_bf16 v[56:59], v[36:39], a[48:55], v6
  ds_write2_b32 v2, v54, v54 offset0:128 offset1:129
  ds_read_b64_tr_b16 v[90:91], v12 offset:512
  v_smfmac_f32_16x16x64_bf16 v[56:59], v[40:43], a[40:47], v6
  v_smfmac_f32_16x16x64_bf16 v[56:59], v[44:47], a[32:39], v6
  v_smfmac_f32_16x16x64_bf16 v[60:63], v[24:27], a[24:31], v6
  v_smfmac_f32_16x16x64_bf16 v[60:63], v[28:31], a[16:23], v6
  s_waitcnt lgkmcnt(0)
  v_add_f32 v56, v56, v58
  v_mfma_f32_16x16x32_bf16 v[92:95], v[72:75], v[88:91], 0
  buffer_store_dwordx2 v[100:101], v5, s[4:7], s97 offen sc1
  v_add_f32 v57, v57, v59
  v_cvt_pk_bf16_f32 v58, v56, v57
  v_mfma_f32_16x16x32_bf16 v[96:99], v[76:79], v[88:91], 0
  ds_write_b32 v2, v58
  v_smfmac_f32_16x16x64_bf16 v[60:63], v[32:35], a[8:15], v6
  v_mov_b32 v76, 0
  v_smfmac_f32_16x16x64_bf16 v[60:63], v[36:39], a[0:7], v6
  v_cndmask_b32 v48, v92, v96, s[18:19]
  v_smfmac_f32_16x16x64_bf16 v[60:63], v[40:43], v[248:255], v6
  v_cndmask_b32 v49, v93, v97, s[18:19]
  v_smfmac_f32_16x16x64_bf16 v[60:63], v[44:47], v[240:247], v6
  v_cndmask_b32 v50, v94, v98, s[18:19]
  v_smfmac_f32_16x16x64_bf16 v[68:71], v[20:23], v[152:159], v6
  v_cndmask_b32 v51, v95, v99, s[18:19]
  v_smfmac_f32_16x16x64_bf16 v[64:67], v[24:27], v[232:239], v6
  ds_write_b128 v8, v[48:51] offset:12288
  v_add_f32 v60, v60, v62
  v_add_f32 v61, v61, v63
  v_cvt_pk_bf16_f32 v62, v60, v61
  v_smfmac_f32_16x16x64_bf16 v[64:67], v[28:31], v[224:231], v6
  ds_write_b32 v2, v62 offset:512
  s_waitcnt vmcnt(6)
  v_mov_b32 v79, 0
  v_smfmac_f32_16x16x64_bf16 v[64:67], v[32:35], v[216:223], v6
  v_mov_b64 v[20:21], s[14:15]
  v_smfmac_f32_16x16x64_bf16 v[64:67], v[36:39], v[200:207], v6
  v_mov_b64 v[22:23], s[14:15]
  v_smfmac_f32_16x16x64_bf16 v[64:67], v[40:43], v[192:199], v6
  s_waitcnt lgkmcnt(0)
  s_barrier
  ds_read_b128 v[52:55], v9 offset:12288
  ds_read_b128 v[56:59], v10 offset:12288
  v_smfmac_f32_16x16x64_bf16 v[64:67], v[44:47], v[184:191], v6
  ds_read_b128 v[60:63], v11 offset:12288
  v_smfmac_f32_16x16x64_bf16 v[68:71], v[24:27], v[176:183], v6
  ds_read_b64_tr_b16 v[88:89], v12 offset:0
  ds_read_b64_tr_b16 v[90:91], v12 offset:512
  v_smfmac_f32_16x16x64_bf16 v[68:71], v[28:31], v[168:175], v6
  ds_read_b64_tr_b16 v[92:93], v13 offset:0
  ds_read_b64_tr_b16 v[94:95], v13 offset:512
  v_add_f32 v64, v64, v66
  v_smfmac_f32_16x16x64_bf16 v[68:71], v[32:35], v[160:167], v6
  ds_read_b64_tr_b16 v[96:97], v14 offset:0
  ds_read_b64_tr_b16 v[98:99], v14 offset:512
  v_add_f32 v65, v65, v67
  v_smfmac_f32_16x16x64_bf16 v[68:71], v[36:39], v[144:151], v6
  ds_read_b64_tr_b16 v[100:101], v15 offset:0
  ds_read_b64_tr_b16 v[102:103], v15 offset:512
  s_waitcnt lgkmcnt(8)
  v_cvt_pk_bf16_f32 v66, v64, v65
  v_smfmac_f32_16x16x64_bf16 v[68:71], v[40:43], v[136:143], v6
  v_add_f32 v48, v48, v52
  v_smfmac_f32_16x16x64_bf16 v[68:71], v[44:47], v[128:135], v6
  s_waitcnt lgkmcnt(4)
  v_add_f32 v49, v49, v53
  v_mfma_f32_16x16x32_bf16 v[16:19], v[88:91], v[88:91], 0
  buffer_store_dwordx4 v[88:91], v8, s[4:7], s25 offen sc1
  v_add_f32 v50, v50, v54
  v_add_f32 v51, v51, v55
  v_mfma_f32_16x16x32_bf16 v[16:19], v[92:95], v[92:95], v[16:19]
  s_waitcnt lgkmcnt(0)
  v_add_f32 v56, v56, v60
  v_add_f32 v57, v57, v61
  v_mfma_f32_16x16x32_bf16 v[16:19], v[96:99], v[96:99], v[16:19]
  v_add_f32 v58, v58, v62
  v_add_f32 v59, v59, v63
  v_mfma_f32_16x16x32_bf16 v[16:19], v[100:103], v[100:103], v[16:19]
  v_add_f32 v48, v48, v56
  v_add_f32 v49, v49, v57
  v_add_f32 v50, v50, v58
  v_add_f32 v51, v51, v59
  v_exp_f32 v24, v48
  v_exp_f32 v25, v49
  v_exp_f32 v26, v50
  v_exp_f32 v27, v51
  v_cvt_pk_bf16_f32 v24, v24, v25
  v_mul_f32 v16, s24, v16
  v_cvt_pk_bf16_f32 v25, v26, v27
  v_cndmask_b32 v72, v24, 0, s[18:19]
  v_cndmask_b32 v73, v25, 0, s[18:19]
  v_cndmask_b32 v74, 0, v24, s[18:19]
  v_cndmask_b32 v75, 0, v25, s[18:19]
  v_mul_f32 v17, s24, v17
  v_exp_f32 v28, v16
  v_mfma_f32_16x16x32_bf16 v[60:63], v[72:75], v[20:23], 0
  v_exp_f32 v29, v17
  v_add_f32 v68, v68, v70
  v_mfma_f32_16x16x32_bf16 v[52:55], v[72:75], v[80:83], 0
  s_add_u32 s30, s25, 4096
  v_cvt_pk_bf16_f32 v28, v28, v29
  v_add_f32 v69, v69, v71
  v_mfma_f32_16x16x32_bf16 v[56:59], v[72:75], v[84:87], 0
  v_cndmask_b32 v77, 0, v28, s[18:19]
  v_cndmask_b32 v78, 0, v28, s[18:19]
  v_cvt_pk_bf16_f32 v67, v68, v69
  v_lshrrev_b32 v92, 1, v8
  v_mfma_f32_16x16x16_bf16 v[60:63], v[76:77], v[20:21], v[60:63]
  buffer_store_dwordx2 v[66:67], v92, s[4:7], s30 offen sc1
  v_max3_f32 v7, |v48|, |v49|, |v50|
  v_max_f32 v26, |v16|, |v17|
  v_mfma_f32_16x16x16_bf16 v[52:55], v[78:79], v[66:67], v[52:55]
  v_cndmask_b32 v26, 0, v26, s[18:19]
  v_max3_f32 v7, |v51|, v26, v7
  v_mfma_f32_16x16x16_bf16 v[56:59], v[76:77], v[66:67], v[56:59]
  v_cmp_lt_f32 vcc, 0x42700000, v7
  v_mov_b64 v[44:45], 0
  v_add_f32 v60, v60, v62
  v_add_f32 v61, v61, v63
  s_cbranch_vccnz c_fb_49
c_fbr_50:
  v_rcp_f32 v60, v60
  v_rcp_f32 v61, v61
  v_pk_add_f32 v[52:53], v[52:53], v[54:55]
  v_pk_add_f32 v[56:57], v[56:57], v[58:59]
  v_pk_mul_f32 v[52:53], v[52:53], v[60:61]
  v_pk_mul_f32 v[56:57], v[56:57], v[60:61]
  v_cvt_pk_bf16_f32 v54, v52, v53
  v_cvt_pk_bf16_f32 v55, v56, v57
  ds_write_b64 v2, v[54:55] offset:4096
  v_mov_b64 v[46:47], 0
  v_mov_b64 v[40:41], 0
  v_mov_b64 v[42:43], 0
  v_mov_b64 v[36:37], 0
  v_mov_b64 v[38:39], 0
  v_mov_b64 v[32:33], 0
  v_mov_b64 v[34:35], 0
  v_mov_b64 v[28:29], 0
  v_mov_b64 v[30:31], 0
  v_mov_b64 v[24:25], 0
  v_mov_b64 v[26:27], 0
  v_mov_b64 v[80:81], 0
  v_mov_b64 v[82:83], 0
  v_mov_b64 v[84:85], 0
  v_mov_b64 v[86:87], 0
  s_waitcnt lgkmcnt(0)
  s_barrier
  ds_read_b64_tr_b16 v[72:73], v3 offset:4096
  ds_read_b64_tr_b16 v[74:75], v3 offset:5120
  ds_read_b64_tr_b16 v[76:77], v3 offset:6144
  ds_read_b64_tr_b16 v[78:79], v3 offset:7168
  s_and_b32 s3, s21, 1
  s_add_u32 s21, s21, 1
  s_add_u32 s22, s22, 1
  s_and_b32 s42, s21, 3
  s_lshl_b32 s42, s42, 13
  s_cmp_eq_u32 s22, 64
  s_cbranch_scc1 c_last_52
  s_waitcnt lgkmcnt(2)
  v_smfmac_f32_16x16x64_bf16 v[44:47], v[72:75], a[248:255], v6
  s_waitcnt lgkmcnt(0)
  ds_read_b128 v[16:19], v8 offset:40960
  v_smfmac_f32_16x16x64_bf16 v[44:47], v[76:79], a[240:247], v6
  ds_read_b128 v[20:23], v8 offset:45056
  v_smfmac_f32_16x16x64_bf16 v[40:43], v[72:75], a[232:239], v6
  ds_read_b128 v[88:91], v8 offset:49152
  v_smfmac_f32_16x16x64_bf16 v[40:43], v[76:79], a[224:231], v6
  ds_read_b128 v[92:95], v8 offset:53248
  v_add_f32 v44, v44, v46
  v_add_f32 v45, v45, v47
  v_smfmac_f32_16x16x64_bf16 v[36:39], v[72:75], a[216:223], v6
  ds_read_b128 v[96:99], v8 offset:57344
  v_cvt_pk_bf16_f32 v48, v44, v45
  v_and_or_b32 v48, v48, -2, s3
  v_smfmac_f32_16x16x64_bf16 v[36:39], v[76:79], a[208:215], v6
  ds_read_b128 v[100:103], v8 offset:61440
  v_add_f32 v40, v40, v42
  v_add_f32 v41, v41, v43
  v_smfmac_f32_16x16x64_bf16 v[32:35], v[72:75], a[200:207], v6
  v_cvt_pk_bf16_f32 v49, v40, v41
  v_smfmac_f32_16x16x64_bf16 v[32:35], v[76:79], a[192:199], v6
  v_add_f32 v36, v36, v38
  v_add_f32 v37, v37, v39
  v_smfmac_f32_16x16x64_bf16 v[28:31], v[72:75], a[184:191], v6
  v_cvt_pk_bf16_f32 v50, v36, v37
  v_smfmac_f32_16x16x64_bf16 v[28:31], v[76:79], a[176:183], v6
  v_add_f32 v32, v32, v34
  v_add_f32 v33, v33, v35
  v_smfmac_f32_16x16x64_bf16 v[24:27], v[72:75], v[104:111], v6
  v_cvt_pk_bf16_f32 v51, v32, v33
  v_smfmac_f32_16x16x64_bf16 v[24:27], v[76:79], v[112:119], v6
  buffer_store_dwordx4 v[48:51], v4, s[4:7], s40 offen sc1
  v_add_f32 v28, v28, v30
  v_add_f32 v29, v29, v31
  v_smfmac_f32_16x16x64_bf16 v[80:83], v[72:75], v[120:127], v6
  s_waitcnt lgkmcnt(0)
  v_cvt_pk_bf16_f32 v52, v28, v29
  v_and_or_b32 v52, v52, -2, s3
  v_smfmac_f32_16x16x64_bf16 v[80:83], v[76:79], v[16:23], v6
  v_add_f32 v24, v24, v26
  v_add_f32 v25, v25, v27
  v_smfmac_f32_16x16x64_bf16 v[84:87], v[72:75], v[88:95], v6
  v_cvt_pk_bf16_f32 v53, v24, v25
  v_smfmac_f32_16x16x64_bf16 v[84:87], v[76:79], v[96:103], v6
  v_add_f32 v80, v80, v82
  v_add_f32 v81, v81, v83
  v_cvt_pk_bf16_f32 v54, v80, v81
  s_nop 0
  s_nop 3
  v_pk_add_f32 v[84:85], v[84:85], v[86:87]
  v_cvt_pk_bf16_f32 v55, v84, v85
  buffer_store_dwordx4 v[52:55], v4, s[4:7], s41 offen sc1
  s_add_u32 s42, s42, s62
  s_add_u32 s43, s42, 4096
  s_add_u32 s23, s23, 524288
  s_add_u32 s25, s25, 262144
  s_add_u32 s63, s63, 4096
  s_add_u32 s64, s64, 2048
  s_andn2_b32 s64, s64, s2
  s_add_u32 s97, s97, 8192
  s_add_u32 s92, s63, s20
  s_cmp_lg_u32 s17, 0
  s_cbranch_scc1 c_oth_64
  s_mov_b32 s28, 0
  s_add_u32 s46, s46, 1
  v_mov_b64 v[64:65], -1
  s_xor_b32 s34, s42, 16384
  buffer_store_dwordx2 v[64:65], v5, s[4:7], s34 offen sc1
  s_mov_b32 vcc_lo, 0xaaaaaaaa
  s_mov_b32 vcc_hi, 0xaaaaaaaa
  v_mov_b32 v7, 0x3f80
  v_cndmask_b32 v7, v7, 1.0, vcc
  s_mov_b32 vcc_lo, 0x30003
  s_mov_b32 vcc_hi, 0x30003
  v_cndmask_b32 v68, 0, v7, vcc
  s_mov_b32 vcc_lo, 0xc000c
  s_mov_b32 vcc_hi, 0xc000c
  v_cndmask_b32 v69, 0, v7, vcc
  s_mov_b32 vcc_lo, 0x300030
  s_mov_b32 vcc_hi, 0x300030
  v_cndmask_b32 v70, 0, v7, vcc
  s_mov_b32 vcc_lo, 0xc000c0
  s_mov_b32 vcc_hi, 0xc000c0
  v_cndmask_b32 v71, 0, v7, vcc
  ds_read_b128 v[104:107], v1 offset:14336
  ds_read_b128 v[108:111], v1 offset:15360
  s_waitcnt lgkmcnt(0)
  ds_read_b128 v[112:115], v1 offset:16384
  ds_read_b128 v[116:119], v1 offset:17408
  ds_read_b128 v[120:123], v1 offset:18432
  ds_read_b128 v[124:127], v1 offset:19456
  s_waitcnt lgkmcnt(0)
  buffer_load_dwordx4 v[16:19], v0, s[4:7], s38 offen offset:0 sc1
  buffer_load_dwordx4 v[20:23], v0, s[4:7], s38 offen offset:1024 sc1
  buffer_load_dwordx4 v[24:27], v0, s[4:7], s38 offen offset:2048 sc1
  buffer_load_dwordx4 v[28:31], v0, s[4:7], s38 offen offset:3072 sc1
  buffer_load_dwordx4 v[32:35], v0, s[4:7], s39 offen offset:0 sc1
  buffer_load_dwordx4 v[36:39], v0, s[4:7], s39 offen offset:1024 sc1
  buffer_load_dwordx4 v[40:43], v0, s[4:7], s39 offen offset:2048 sc1
  buffer_load_dwordx4 v[44:47], v0, s[4:7], s39 offen offset:3072 sc1
  buffer_load_dwordx4 v[72:75], v0, s[4:7], s38 offen offset:0 sc1
  buffer_load_dwordx4 v[76:79], v0, s[4:7], s38 offen offset:1024 sc1
  buffer_load_dwordx4 v[80:83], v0, s[4:7], s38 offen offset:2048 sc1
  buffer_load_dwordx4 v[84:87], v0, s[4:7], s38 offen offset:3072 sc1
  buffer_load_dwordx4 v[88:91], v0, s[4:7], s39 offen offset:0 sc1
  buffer_load_dwordx4 v[92:95], v0, s[4:7], s39 offen offset:1024 sc1
  buffer_load_dwordx4 v[96:99], v0, s[4:7], s39 offen offset:2048 sc1
  buffer_load_dwordx4 v[100:103], v0, s[4:7], s39 offen offset:3072 sc1
  s_buffer_load_dword s65, s[4:7], s63
  s_waitcnt vmcnt(15)
  v_mfma_f32_16x16x32_bf16 v[64:67], v[16:19], v[68:71], 0
  v_xor_b32 v7, s3, v16
  s_waitcnt vmcnt(14)
  v_mfma_f32_16x16x32_bf16 v[64:67], v[20:23], v[68:71], v[64:67]
  v_bitop3_b32 v7, v7, v20, s3 bitop3:0xf6
  s_waitcnt vmcnt(13)
  v_mfma_f32_16x16x32_bf16 v[64:67], v[24:27], v[68:71], v[64:67]
  v_bitop3_b32 v7, v7, v24, s3 bitop3:0xf6
  s_waitcnt vmcnt(12)
  v_mfma_f32_16x16x32_bf16 v[64:67], v[28:31], v[68:71], v[64:67]
  v_bitop3_b32 v7, v7, v28, s3 bitop3:0xf6
  s_waitcnt vmcnt(11)
  v_mfma_f32_16x16x32_bf16 v[64:67], v[32:35], v[68:71], v[64:67]
  v_bitop3_b32 v7, v7, v32, s3 bitop3:0xf6
  s_waitcnt vmcnt(10)
  v_mfma_f32_16x16x32_bf16 v[64:67], v[36:39], v[68:71], v[64:67]
  v_bitop3_b32 v7, v7, v36, s3 bitop3:0xf6
  s_waitcnt vmcnt(9)
  v_mfma_f32_16x16x32_bf16 v[64:67], v[40:43], v[68:71], v[64:67]
  v_bitop3_b32 v7, v7, v40, s3 bitop3:0xf6
  s_waitcnt vmcnt(8)
  v_mfma_f32_16x16x32_bf16 v[64:67], v[44:47], v[68:71], v[64:67]
  v_bitop3_b32 v7, v7, v44, s3 bitop3:0xf6
  v_and_b32 v7, 1, v7
  v_cmp_ne_u32 vcc, 0, v7
  v_mov_b32 v7, 0
  v_mov_b32 v7, 0
  s_cbranch_vccnz c_p1r_65
c_publ_66:
  s_nop 1
  s_nop 0
  v_cvt_pk_bf16_f32 v64, v64, v65
  v_cvt_pk_bf16_f32 v65, v66, v67
  v_min_u32 v64, -2, v64
  v_min_u32 v65, -2, v65
  buffer_store_dwordx2 v[64:65], v5, s[4:7], s42 offen sc1
  s_waitcnt vmcnt(1)
  ds_read_b128 v[24:27], v1 offset:0
  ds_read_b128 v[28:31], v1 offset:1024
  ds_read_b128 v[32:35], v1 offset:2048
  ds_read_b128 v[36:39], v1 offset:3072
  ds_read_b128 v[40:43], v1 offset:4096
  ds_read_b128 v[44:47], v1 offset:5120
  ds_read_b128 v[72:75], v1 offset:6144
  ds_read_b128 v[76:79], v1 offset:7168
  ds_read_b128 v[80:83], v1 offset:8192
  ds_read_b128 v[84:87], v1 offset:9216
  ds_read_b128 v[88:91], v1 offset:10240
  ds_read_b128 v[92:95], v1 offset:11264
  ds_read_b128 v[96:99], v1 offset:12288
  ds_read_b128 v[100:103], v1 offset:13312
c_hop2_48:
  s_barrier
  s_cmp_le_u32 s96, s23
  s_cbranch_scc1 c_loop_45
  s_cmp_lg_u32 s96, 268435456
  s_cbranch_scc1 c_fk0_67
  buffer_store_dwordx2 v[64:65], v5, s[4:7], s97 offen sc1
  s_mov_b32 s29, 0
  s_sub_u32 s92, s63, 4096
  s_sub_u32 s96, s23, 524288
  s_mov_b32 s95, 0
c_gw_68:
  buffer_load_dword v7, off, s[4:7], s92 sc1
  s_add_u32 s29, s29, 1
  s_cmp_gt_u32 s29, 1048576
  s_cbranch_scc1 c_fail_51
  s_waitcnt vmcnt(0) lgkmcnt(0)
  v_readfirstlane_b32 s65, v7
  s_cmp_eq_u32 s65, 0
  s_cbranch_scc1 c_gw_68
  s_and_b32 s65, s65, s93
  s_cbranch_scc1 c_kvx_70
  s_mov_b32 s95, 1
  s_add_u32 s96, s96, 33554432
  s_add_u32 s92, s92, 262144
c_kvw_69:
  buffer_load_dword v7, off, s[4:7], s92 sc1
  s_add_u32 s29, s29, 1
  s_cmp_gt_u32 s29, 1048576
  s_cbranch_scc1 c_fail_51
  s_waitcnt vmcnt(0) lgkmcnt(0)
  v_readfirstlane_b32 s65, v7
  s_cmp_eq_u32 s65, 0
  s_cbranch_scc1 c_kvw_69
c_kvx_70:
  buffer_load_dword v7, off, s[4:7], s63 sc1
  buffer_load_dwordx4 v0, s[4:7], s96 offen offset:0  lds
  buffer_load_dwordx4 v0, s[4:7], s96 offen offset:1024  lds
  buffer_load_dwordx4 v0, s[4:7], s96 offen offset:2048  lds
  buffer_load_dwordx4 v0, s[4:7], s96 offen offset:3072  lds
  s_waitcnt vmcnt(4)
  v_readfirstlane_b32 s65, v7
  s_mov_b32 s94, 0
  s_cmp_eq_u32 s95, 0
  s_cbranch_scc1 c_loop_45
c_fk0_67:
  s_mov_b32 s29, 0
c_fk_71:
  buffer_load_dwordx4 v[16:19], v8, s[4:7], s42 offen sc1
  buffer_load_dwordx4 v[20:23], v8, s[4:7], s43 offen sc1
  s_add_u32 s29, s29, 1
  s_cmp_gt_u32 s29, 1048576
  s_cbranch_scc1 c_fail_51
  s_waitcnt vmcnt(0)
  v_max3_u32 v7, v16, v17, v18
  v_max3_u32 v7, v19, v20, v7
  v_max3_u32 v7, v21, v22, v7
  v_max_u32 v7, v7, v23
  v_cmp_eq_u32 vcc, -1, v7
  s_cbranch_vccnz c_fk_71
c_fk1_72:
  s_lshl_b32 s42, s22, 13
  s_add_u32 s42, s42, 245891072
  s_add_u32 s43, s42, 4096
  s_mov_b32 s95, 0
  s_branch c_loop_45
c_xb_60:
  s_cmp_lg_u32 s93, 1
  s_cbranch_scc1 c_xr_61
  s_cmp_ge_u32 s22, 63
  s_cbranch_scc1 c_xr_61
c_xp_73:
  s_cmp_lg_u32 s65, 0
  s_cbranch_scc1 c_xs_74
  buffer_load_dword v7, off, s[4:7], s63 sc1
  s_add_u32 s29, s29, 1
  s_cmp_gt_u32 s29, 1048576
  s_cbranch_scc1 c_fail_51
  s_waitcnt vmcnt(0)
  v_readfirstlane_b32 s65, v7
  s_branch c_xp_73
c_xs_74:
  s_cmp_eq_u32 s65, 1
  s_cbranch_scc1 c_xr_61
  s_mov_b32 s29, 0
c_xw_75:
  buffer_load_dwordx4 v[16:19], v8, s[4:7], s42 offen sc1
  buffer_load_dwordx4 v[20:23], v8, s[4:7], s43 offen sc1
  s_add_u32 s29, s29, 1
  s_cmp_gt_u32 s29, 1048576
  s_cbranch_scc1 c_fail_51
  s_waitcnt vmcnt(0)
  v_max3_u32 v7, v16, v17, v18
  v_max3_u32 v7, v19, v20, v7
  v_max3_u32 v7, v21, v22, v7
  v_max_u32 v7, v7, v23
  v_cmp_eq_u32 vcc, -1, v7
  s_cbranch_vccnz c_xw_75
  v_mov_b32 v7, 1
  s_barrier
  s_mov_b64 exec, 1
  buffer_store_dword v7, off, s[4:7], s64 sc1
  s_mov_b64 exec, -1
  s_add_u32 s22, s22, 1
  s_add_u32 s23, s23, 524288
  s_add_u32 s25, s25, 262144
  s_add_u32 s63, s63, 4096
  s_add_u32 s64, s64, 2048
  s_andn2_b32 s64, s64, s2
  s_mov_b32 s29, 0
  s_sub_u32 s92, s63, 4096
  s_sub_u32 s96, s23, 524288
  s_mov_b32 s95, 0
  s_mov_b32 s95, 1
  s_add_u32 s96, s96, 33554432
  s_add_u32 s92, s92, 262144
c_kvw_77:
  buffer_load_dword v7, off, s[4:7], s92 sc1
  s_add_u32 s29, s29, 1
  s_cmp_gt_u32 s29, 1048576
  s_cbranch_scc1 c_fail_51
  s_waitcnt vmcnt(0) lgkmcnt(0)
  v_readfirstlane_b32 s65, v7
  s_cmp_eq_u32 s65, 0
  s_cbranch_scc1 c_kvw_77
c_kvx_78:
  buffer_load_dword v7, off, s[4:7], s63 sc1
  buffer_load_dwordx4 v0, s[4:7], s96 offen offset:0  lds
  buffer_load_dwordx4 v0, s[4:7], s96 offen offset:1024  lds
  buffer_load_dwordx4 v0, s[4:7], s96 offen offset:2048  lds
  buffer_load_dwordx4 v0, s[4:7], s96 offen offset:3072  lds
  s_waitcnt vmcnt(4)
  v_readfirstlane_b32 s65, v7
  s_mov_b32 s94, 0
  s_branch c_fk1_72
c_last_52:
  s_add_u32 s64, s64, 2048
  v_mov_b32 v7, 1
  s_waitcnt vmcnt(0)
  s_barrier
  s_mov_b64 exec, 1
  buffer_store_dword v7, off, s[4:7], s64 sc1
  s_mov_b64 exec, -1
  s_branch L_chdone
c_oth_64:
  s_buffer_load_dword s65, s[4:7], s63
  ds_read_b128 v[24:27], v1 offset:0
  ds_read_b128 v[28:31], v1 offset:1024
  ds_read_b128 v[32:35], v1 offset:2048
  ds_read_b128 v[36:39], v1 offset:3072
  ds_read_b128 v[40:43], v1 offset:4096
  ds_read_b128 v[44:47], v1 offset:5120
  ds_read_b128 v[72:75], v1 offset:6144
  ds_read_b128 v[76:79], v1 offset:7168
  ds_read_b128 v[80:83], v1 offset:8192
  ds_read_b128 v[84:87], v1 offset:9216
  ds_read_b128 v[88:91], v1 offset:10240
  ds_read_b128 v[92:95], v1 offset:11264
  ds_read_b128 v[96:99], v1 offset:12288
  ds_read_b128 v[100:103], v1 offset:13312
  ds_read_b128 v[104:107], v1 offset:14336
  ds_read_b128 v[108:111], v1 offset:15360
  ds_read_b128 v[112:115], v1 offset:16384
  ds_read_b128 v[116:119], v1 offset:17408
  ds_read_b128 v[120:123], v1 offset:18432
  ds_read_b128 v[124:127], v1 offset:19456
  s_branch c_hop2_48
c_p1r_65:
  s_waitcnt vmcnt(7)
  s_nop 0
  v_mfma_f32_16x16x32_bf16 v[64:67], v[72:75], v[68:71], 0
  v_xor_b32 v7, s3, v72
  s_waitcnt vmcnt(6)
  v_mfma_f32_16x16x32_bf16 v[64:67], v[76:79], v[68:71], v[64:67]
  v_bitop3_b32 v7, v7, v76, s3 bitop3:0xf6
  s_waitcnt vmcnt(5)
  v_mfma_f32_16x16x32_bf16 v[64:67], v[80:83], v[68:71], v[64:67]
  v_bitop3_b32 v7, v7, v80, s3 bitop3:0xf6
  s_waitcnt vmcnt(4)
  v_mfma_f32_16x16x32_bf16 v[64:67], v[84:87], v[68:71], v[64:67]
  v_bitop3_b32 v7, v7, v84, s3 bitop3:0xf6
  s_waitcnt vmcnt(3)
  v_mfma_f32_16x16x32_bf16 v[64:67], v[88:91], v[68:71], v[64:67]
  v_bitop3_b32 v7, v7, v88, s3 bitop3:0xf6
  s_waitcnt vmcnt(2)
  v_mfma_f32_16x16x32_bf16 v[64:67], v[92:95], v[68:71], v[64:67]
  v_bitop3_b32 v7, v7, v92, s3 bitop3:0xf6
  s_waitcnt vmcnt(1)
  v_mfma_f32_16x16x32_bf16 v[64:67], v[96:99], v[68:71], v[64:67]
  v_bitop3_b32 v7, v7, v96, s3 bitop3:0xf6
  s_waitcnt vmcnt(0)
  v_mfma_f32_16x16x32_bf16 v[64:67], v[100:103], v[68:71], v[64:67]
  v_bitop3_b32 v7, v7, v100, s3 bitop3:0xf6
  v_and_b32 v7, 1, v7
  v_cmp_ne_u32 vcc, 0, v7
  s_add_u32 s46, s46, 1
  s_cbranch_vccz c_publ_66
  buffer_load_dwordx4 v[72:75], v0, s[4:7], s38 offen offset:0 sc1
  buffer_load_dwordx4 v[76:79], v0, s[4:7], s38 offen offset:1024 sc1
  buffer_load_dwordx4 v[80:83], v0, s[4:7], s38 offen offset:2048 sc1
  buffer_load_dwordx4 v[84:87], v0, s[4:7], s38 offen offset:3072 sc1
  buffer_load_dwordx4 v[88:91], v0, s[4:7], s39 offen offset:0 sc1
  buffer_load_dwordx4 v[92:95], v0, s[4:7], s39 offen offset:1024 sc1
  buffer_load_dwordx4 v[96:99], v0, s[4:7], s39 offen offset:2048 sc1
  buffer_load_dwordx4 v[100:103], v0, s[4:7], s39 offen offset:3072 sc1
  s_add_u32 s28, s28, 1
  s_cmp_gt_u32 s28, 1048576
  s_cbranch_scc0 c_p1r_65
  s_branch c_fail_51
c_retry_46:
  v_mov_b64 v[48:49], 0
  v_mov_b64 v[50:51], 0
  s_nop 0
  v_mov_b64 v[52:53], 0
  v_mov_b64 v[54:55], 0
  s_nop 1
  v_mov_b64 v[56:57], 0
  v_mov_b64 v[58:59], 0
c_rl_79:
  buffer_load_dwordx4 v[16:19], v8, s[4:7], s42 offen sc1
  buffer_load_dwordx4 v[20:23], v8, s[4:7], s43 offen sc1
  s_add_u32 s28, s28, 1
  s_add_u32 s47, s47, 1
  s_cmp_gt_u32 s28, 1048576
  s_cbranch_scc1 c_fail_51
  s_waitcnt vmcnt(2)
  v_max3_u32 v7, v16, v17, v18
  v_max3_u32 v7, v19, v20, v7
  v_max3_u32 v7, v21, v22, v7
  v_max_u32 v7, v7, v23
  v_cmp_eq_u32 vcc, -1, v7
  s_cbranch_vccnz c_rl_79
  ds_write_b128 v8, v[16:19] offset:4096
  v_smfmac_f32_16x16x64_bf16 v[48:51], v[16:19], v[24:31], v6
  ds_write_b128 v8, v[20:23] offset:8192
  v_smfmac_f32_16x16x64_bf16 v[52:55], v[16:19], v[32:39], v6
  v_smfmac_f32_16x16x64_bf16 v[56:59], v[16:19], v[40:47], v6
  s_branch c_got_47
c_fb_49:
  v_max3_f32 v7, v48, v49, v50
  v_max_f32 v7, v51, v7
  s_mov_b64 exec, s[18:19]
  v_max3_f32 v7, v16, v17, v7
  s_mov_b64 exec, -1
  s_nop 0
  v_max_f32_dpp v7, v7, v7 quad_perm:[2,3,0,1] row_mask:0xf bank_mask:0xf
  v_mov_b32 v24, v7
  s_nop 0
  s_nop 0
  v_permlane16_swap_b32 v7, v24
  v_max_f32 v7, v7, v24
  v_mov_b32 v24, v7
  s_nop 0
  s_nop 0
  v_permlane32_swap_b32 v7, v24
  v_max_f32 v7, v7, v24
  v_sub_f32 v24, v48, v7
  v_sub_f32 v25, v49, v7
  v_sub_f32 v26, v50, v7
  v_sub_f32 v27, v51, v7
  v_sub_f32 v28, v16, v7
  v_sub_f32 v29, v17, v7
  v_exp_f32 v24, v24
  v_exp_f32 v25, v25
  v_exp_f32 v26, v26
  v_exp_f32 v27, v27
  v_exp_f32 v28, v28
  v_exp_f32 v29, v29
  v_cvt_pk_bf16_f32 v24, v24, v25
  v_cvt_pk_bf16_f32 v25, v26, v27
  v_cvt_pk_bf16_f32 v28, v28, v29
  v_cndmask_b32 v72, v24, 0, s[18:19]
  v_cndmask_b32 v73, v25, 0, s[18:19]
  v_cndmask_b32 v74, 0, v24, s[18:19]
  v_cndmask_b32 v75, 0, v25, s[18:19]
  v_cndmask_b32 v77, 0, v28, s[18:19]
  v_cndmask_b32 v78, 0, v28, s[18:19]
  v_mfma_f32_16x16x32_bf16 v[60:63], v[72:75], v[20:23], 0
  v_mfma_f32_16x16x32_bf16 v[52:55], v[72:75], v[80:83], 0
  v_mfma_f32_16x16x32_bf16 v[56:59], v[72:75], v[84:87], 0
  v_mfma_f32_16x16x16_bf16 v[60:63], v[76:77], v[20:21], v[60:63]
  v_mfma_f32_16x16x16_bf16 v[52:55], v[78:79], v[66:67], v[52:55]
  s_nop 2
  v_mfma_f32_16x16x16_bf16 v[56:59], v[76:77], v[66:67], v[56:59]
  s_nop 7
  v_add_f32 v60, v60, v62
  v_add_f32 v61, v61, v63
  s_branch c_fbr_50
c_fail_51:
  s_endpgm
L_chdone:
  s_cmp_lg_u32 s91, 0
  s_cbranch_scc1 L_end
  s_lshr_b32 s91, s90, 4
  s_add_u32 s91, s91, 7
  v_lshrrev_b32 v0, 4, v0
  s_waitcnt vmcnt(0) lgkmcnt(0)
  v_mbcnt_lo_u32_b32 v20, -1, 0
  v_and_b32 v20, 3, v20
  v_add_lshl_u32 v20, v20, 0, 2
  s_mov_b32 s26, 0
g_wt_80:
  global_load_dword v21, v20, s[12:13] offset:128 sc1
  s_add_u32 s26, s26, 1
  s_cmp_gt_u32 s26, 1048576
  s_cbranch_scc1 L_end
  s_waitcnt vmcnt(0)
  v_cmp_eq_u32 vcc, 0, v21
  v_readfirstlane_b32 s27, v21
  s_cbranch_vccnz g_wt_80
  s_mov_b32 s89, s27
  s_branch L_o
L_qkv:
  s_mul_i32 s26, s91, 15
  s_add_u32 s26, s26, s90
  s_sub_u32 s26, s26, 61
  s_add_u32 s27, s91, 89
  s_cmp_eq_u32 s90, 31
  s_cselect_b32 s26, s27, s26
  s_add_u32 s27, s90, 60
  s_cmp_eq_u32 s91, 7
  s_cselect_b32 s26, s27, s26
  s_mul_i32 s16, s26, 171
  s_lshr_b32 s16, s16, 9
  s_mul_i32 s27, s16, 3
  s_sub_u32 s60, s26, s27
  s_add_u32 s16, s16, 4
  s_and_b32 s16, s16, 31
  v_and_b32 v19, 63, v0
  v_and_b32 v6, 15, v19
  v_lshrrev_b32 v7, 4, v19
  v_lshlrev_b32 v1, 2, v19
  v_lshlrev_b32 v0, 4, v19
  v_lshlrev_b32 v9, 7, v19
  s_mov_b32 s24, 0x3e0293ee
  s_lshl_b32 s57, s16, 2
  s_add_u32 s57, s57, s17
  v_and_b32 v24, 1, v7
  v_lshlrev_b32 v24, 10, v24
  v_lshl_add_u32 v24, v6, 4, v24
  v_lshrrev_b32 v25, 1, v7
  v_lshl_add_u32 v8, v25, 8, v24
  v_lshrrev_b32 v96, 9, v0
  v_lshlrev_b32 v96, 4, v96
  v_and_b32 v97, 0xf0, v0
  v_xor_b32 v96, v96, v97
  v_and_b32 v97, 0x1f0, v0
  v_lshl_add_u32 v96, v97, 6, v96
  v_xor_b32 v120, 0, v96
  v_xor_b32 v121, 32, v96
  v_xor_b32 v122, 64, v96
  v_xor_b32 v123, 96, v96
  v_xor_b32 v124, 128, v96
  v_xor_b32 v125, 160, v96
  v_xor_b32 v126, 192, v96
  v_xor_b32 v127, 224, v96
  s_and_b32 s26, s17, 1
  s_lshl_b32 s26, s26, 7
  v_xor_b32 v96, s26, v0
  v_xor_b32 v12, 0, v96
  v_xor_b32 v13, 16, v96
  v_xor_b32 v14, 32, v96
  v_xor_b32 v15, 48, v96
  v_xor_b32 v16, 64, v96
  v_xor_b32 v17, 80, v96
  v_xor_b32 v18, 96, v96
  v_xor_b32 v19, 112, v96
  s_lshl_b32 s26, s17, 2
  s_add_u32 s26, s26, 162816
  v_lshrrev_b32 v24, 7, v0
  v_lshl_add_u32 v118, v24, 4, s26
  v_and_b32 v24, 48, v0
  v_add_u32 v119, 162816, v24
  v_lshrrev_b32 v25, 8, v0
  v_and_b32 v20, 0xf0, v0
  v_lshlrev_b32 v21, 6, v25
  v_xor_b32 v20, v20, v21
  v_lshl_add_u32 v20, v25, 13, v20
  v_xor_b32 v21, 32, v20
  s_load_dwordx2 s[64:65], s[0:1], 24
  s_load_dwordx2 s[68:69], s[0:1], 32
  s_load_dwordx2 s[8:9], s[0:1], 16
  s_mov_b32 s10, 4194304
  s_mov_b32 s11, 0x20000
  s_mov_b32 s66, 4194304
  s_mov_b32 s67, 0x20000
  s_mov_b32 s70, 4194304
  s_mov_b32 s71, 0x20000
  v_lshrrev_b32 v25, 2, v6
  v_lshrrev_b32 v26, 1, v7
  v_lshl_add_u32 v27, v26, 3, v25
  v_lshlrev_b32 v27, 8, v27
  v_lshl_add_u32 v26, v25, 1, v26
  v_and_b32 v25, 1, v7
  v_xor_b32 v26, v26, v25
  s_lshl_b32 s26, s17, 1
  v_xor_b32 v26, s26, v26
  v_lshl_add_u32 v27, v26, 5, v27
  v_and_b32 v25, 3, v6
  v_lshl_add_u32 v22, v25, 3, v27
  v_add_u32 v23, 65536, v22
  v_add_u32 v24, 131072, v22
  s_lshl_b32 s28, s17, 13
  s_lshl_b32 s26, s17, 18
  s_lshl_b32 s27, s16, 8
  s_add_u32 s26, s26, s27
  s_waitcnt lgkmcnt(0)
  s_cmp_eq_u32 s60, 1
  s_cbranch_scc1 q_ld_82
  s_cmp_eq_u32 s60, 2
  s_cbranch_scc1 q_ld_83
q_ld_81:
  s_add_u32 s27, s26, 0
  s_add_u32 m0, s28, 0
  s_nop 0
  buffer_load_dwordx4 v20, s[64:67], s27 offen lds
  s_add_u32 m0, s28, 1024
  s_add_u32 s27, s27, 32768
  buffer_load_dwordx4 v20, s[64:67], s27 offen lds
  s_add_u32 m0, s28, 2048
  s_add_u32 s27, s27, 32768
  buffer_load_dwordx4 v21, s[64:67], s27 offen lds
  s_add_u32 m0, s28, 3072
  s_add_u32 s27, s27, 32768
  buffer_load_dwordx4 v21, s[64:67], s27 offen lds
  s_add_u32 m0, s28, 4096
  s_add_u32 s27, s27, 32768
  buffer_load_dwordx4 v20, s[64:67], s27 offen lds
  s_add_u32 m0, s28, 5120
  s_add_u32 s27, s27, 32768
  buffer_load_dwordx4 v20, s[64:67], s27 offen lds
  s_add_u32 m0, s28, 6144
  s_add_u32 s27, s27, 32768
  buffer_load_dwordx4 v21, s[64:67], s27 offen lds
  s_add_u32 m0, s28, 7168
  s_add_u32 s27, s27, 32768
  buffer_load_dwordx4 v21, s[64:67], s27 offen lds
  s_add_u32 s27, s26, 1048576
  s_add_u32 m0, s28, 32768
  s_nop 0
  buffer_load_dwordx4 v20, s[64:67], s27 offen lds
  s_add_u32 m0, s28, 33792
  s_add_u32 s27, s27, 32768
  buffer_load_dwordx4 v20, s[64:67], s27 offen lds
  s_add_u32 m0, s28, 34816
  s_add_u32 s27, s27, 32768
  buffer_load_dwordx4 v21, s[64:67], s27 offen lds
  s_add_u32 m0, s28, 35840
  s_add_u32 s27, s27, 32768
  buffer_load_dwordx4 v21, s[64:67], s27 offen lds
  s_add_u32 m0, s28, 36864
  s_add_u32 s27, s27, 32768
  buffer_load_dwordx4 v20, s[64:67], s27 offen lds
  s_add_u32 m0, s28, 37888
  s_add_u32 s27, s27, 32768
  buffer_load_dwordx4 v20, s[64:67], s27 offen lds
  s_add_u32 m0, s28, 38912
  s_add_u32 s27, s27, 32768
  buffer_load_dwordx4 v21, s[64:67], s27 offen lds
  s_add_u32 m0, s28, 39936
  s_add_u32 s27, s27, 32768
  buffer_load_dwordx4 v21, s[64:67], s27 offen lds
  s_add_u32 s27, s26, 2097152
  s_add_u32 m0, s28, 65536
  s_nop 0
  buffer_load_dwordx4 v20, s[64:67], s27 offen lds
  s_add_u32 m0, s28, 66560
  s_add_u32 s27, s27, 32768
  buffer_load_dwordx4 v20, s[64:67], s27 offen lds
  s_add_u32 m0, s28, 67584
  s_add_u32 s27, s27, 32768
  buffer_load_dwordx4 v21, s[64:67], s27 offen lds
  s_add_u32 m0, s28, 68608
  s_add_u32 s27, s27, 32768
  buffer_load_dwordx4 v21, s[64:67], s27 offen lds
  s_add_u32 m0, s28, 69632
  s_add_u32 s27, s27, 32768
  buffer_load_dwordx4 v20, s[64:67], s27 offen lds
  s_add_u32 m0, s28, 70656
  s_add_u32 s27, s27, 32768
  buffer_load_dwordx4 v20, s[64:67], s27 offen lds
  s_add_u32 m0, s28, 71680
  s_add_u32 s27, s27, 32768
  buffer_load_dwordx4 v21, s[64:67], s27 offen lds
  s_add_u32 m0, s28, 72704
  s_add_u32 s27, s27, 32768
  buffer_load_dwordx4 v21, s[64:67], s27 offen lds
  s_load_dwordx2 s[4:5], s[0:1], 112
  s_load_dwordx2 s[12:13], s[0:1], 104
  s_waitcnt vmcnt(16)
  s_barrier
  s_add_u32 s27, s26, 3145728
  s_add_u32 m0, s28, 98304
  s_nop 0
  buffer_load_dwordx4 v20, s[64:67], s27 offen lds
  s_add_u32 m0, s28, 99328
  s_add_u32 s27, s27, 32768
  buffer_load_dwordx4 v20, s[64:67], s27 offen lds
  s_add_u32 m0, s28, 100352
  s_add_u32 s27, s27, 32768
  buffer_load_dwordx4 v21, s[64:67], s27 offen lds
  s_add_u32 m0, s28, 101376
  s_add_u32 s27, s27, 32768
  buffer_load_dwordx4 v21, s[64:67], s27 offen lds
  s_add_u32 m0, s28, 102400
  s_add_u32 s27, s27, 32768
  buffer_load_dwordx4 v20, s[64:67], s27 offen lds
  s_add_u32 m0, s28, 103424
  s_add_u32 s27, s27, 32768
  buffer_load_dwordx4 v20, s[64:67], s27 offen lds
  s_add_u32 m0, s28, 104448
  s_add_u32 s27, s27, 32768
  buffer_load_dwordx4 v21, s[64:67], s27 offen lds
  s_add_u32 m0, s28, 105472
  s_add_u32 s27, s27, 32768
  buffer_load_dwordx4 v21, s[64:67], s27 offen lds
  ds_read_b64_tr_b16 v[128:129], v22 offset:0
  ds_read_b64_tr_b16 v[130:131], v22 offset:1024
  ds_read_b64_tr_b16 v[132:133], v22 offset:4096
  ds_read_b64_tr_b16 v[134:135], v22 offset:5120
  ds_read_b64_tr_b16 v[136:137], v22 offset:8192
  ds_read_b64_tr_b16 v[138:139], v22 offset:9216
  ds_read_b64_tr_b16 v[140:141], v22 offset:12288
  ds_read_b64_tr_b16 v[142:143], v22 offset:13312
  ds_read_b64_tr_b16 v[144:145], v22 offset:16384
  ds_read_b64_tr_b16 v[146:147], v22 offset:17408
  ds_read_b64_tr_b16 v[148:149], v22 offset:20480
  ds_read_b64_tr_b16 v[150:151], v22 offset:21504
  ds_read_b64_tr_b16 v[152:153], v22 offset:24576
  ds_read_b64_tr_b16 v[154:155], v22 offset:25600
  ds_read_b64_tr_b16 v[156:157], v22 offset:28672
  ds_read_b64_tr_b16 v[158:159], v22 offset:29696
  s_waitcnt lgkmcnt(0)
  s_waitcnt vmcnt(16)
  s_barrier
  s_add_u32 s27, s26, 0
  s_add_u32 m0, s28, 131072
  s_nop 0
  buffer_load_dwordx4 v20, s[68:71], s27 offen lds
  s_add_u32 m0, s28, 132096
  s_add_u32 s27, s27, 32768
  buffer_load_dwordx4 v20, s[68:71], s27 offen lds
  s_add_u32 m0, s28, 133120
  s_add_u32 s27, s27, 32768
  buffer_load_dwordx4 v21, s[68:71], s27 offen lds
  s_add_u32 m0, s28, 134144
  s_add_u32 s27, s27, 32768
  buffer_load_dwordx4 v21, s[68:71], s27 offen lds
  s_add_u32 m0, s28, 135168
  s_add_u32 s27, s27, 32768
  buffer_load_dwordx4 v20, s[68:71], s27 offen lds
  s_add_u32 m0, s28, 136192
  s_add_u32 s27, s27, 32768
  buffer_load_dwordx4 v20, s[68:71], s27 offen lds
  s_add_u32 m0, s28, 137216
  s_add_u32 s27, s27, 32768
  buffer_load_dwordx4 v21, s[68:71], s27 offen lds
  s_add_u32 m0, s28, 138240
  s_add_u32 s27, s27, 32768
  buffer_load_dwordx4 v21, s[68:71], s27 offen lds
  ds_read_b64_tr_b16 v[160:161], v22 offset:32768
  ds_read_b64_tr_b16 v[162:163], v22 offset:33792
  ds_read_b64_tr_b16 v[164:165], v22 offset:36864
  ds_read_b64_tr_b16 v[166:167], v22 offset:37888
  ds_read_b64_tr_b16 v[168:169], v22 offset:40960
  ds_read_b64_tr_b16 v[170:171], v22 offset:41984
  ds_read_b64_tr_b16 v[172:173], v22 offset:45056
  ds_read_b64_tr_b16 v[174:175], v22 offset:46080
  ds_read_b64_tr_b16 v[176:177], v22 offset:49152
  ds_read_b64_tr_b16 v[178:179], v22 offset:50176
  ds_read_b64_tr_b16 v[180:181], v22 offset:53248
  ds_read_b64_tr_b16 v[182:183], v22 offset:54272
  ds_read_b64_tr_b16 v[184:185], v22 offset:57344
  ds_read_b64_tr_b16 v[186:187], v22 offset:58368
  ds_read_b64_tr_b16 v[188:189], v22 offset:61440
  ds_read_b64_tr_b16 v[190:191], v22 offset:62464
  s_waitcnt lgkmcnt(0)
  s_waitcnt vmcnt(16)
  s_barrier
  s_add_u32 s27, s26, 1048576
  s_add_u32 m0, s28, 0
  s_nop 0
  buffer_load_dwordx4 v20, s[68:71], s27 offen lds
  s_add_u32 m0, s28, 1024
  s_add_u32 s27, s27, 32768
  buffer_load_dwordx4 v20, s[68:71], s27 offen lds
  s_add_u32 m0, s28, 2048
  s_add_u32 s27, s27, 32768
  buffer_load_dwordx4 v21, s[68:71], s27 offen lds
  s_add_u32 m0, s28, 3072
  s_add_u32 s27, s27, 32768
  buffer_load_dwordx4 v21, s[68:71], s27 offen lds
  s_add_u32 m0, s28, 4096
  s_add_u32 s27, s27, 32768
  buffer_load_dwordx4 v20, s[68:71], s27 offen lds
  s_add_u32 m0, s28, 5120
  s_add_u32 s27, s27, 32768
  buffer_load_dwordx4 v20, s[68:71], s27 offen lds
  s_add_u32 m0, s28, 6144
  s_add_u32 s27, s27, 32768
  buffer_load_dwordx4 v21, s[68:71], s27 offen lds
  s_add_u32 m0, s28, 7168
  s_add_u32 s27, s27, 32768
  buffer_load_dwordx4 v21, s[68:71], s27 offen lds
  ds_read_b64_tr_b16 v[192:193], v23 offset:0
  ds_read_b64_tr_b16 v[194:195], v23 offset:1024
  ds_read_b64_tr_b16 v[196:197], v23 offset:4096
  ds_read_b64_tr_b16 v[198:199], v23 offset:5120
  ds_read_b64_tr_b16 v[200:201], v23 offset:8192
  ds_read_b64_tr_b16 v[202:203], v23 offset:9216
  ds_read_b64_tr_b16 v[204:205], v23 offset:12288
  ds_read_b64_tr_b16 v[206:207], v23 offset:13312
  ds_read_b64_tr_b16 v[208:209], v23 offset:16384
  ds_read_b64_tr_b16 v[210:211], v23 offset:17408
  ds_read_b64_tr_b16 v[212:213], v23 offset:20480
  ds_read_b64_tr_b16 v[214:215], v23 offset:21504
  ds_read_b64_tr_b16 v[216:217], v23 offset:24576
  ds_read_b64_tr_b16 v[218:219], v23 offset:25600
  ds_read_b64_tr_b16 v[220:221], v23 offset:28672
  ds_read_b64_tr_b16 v[222:223], v23 offset:29696
  s_waitcnt lgkmcnt(0)
  s_waitcnt vmcnt(16)
  s_barrier
  s_add_u32 s27, s26, 2097152
  s_add_u32 m0, s28, 32768
  s_nop 0
  buffer_load_dwordx4 v20, s[68:71], s27 offen lds
  s_add_u32 m0, s28, 33792
  s_add_u32 s27, s27, 32768
  buffer_load_dwordx4 v20, s[68:71], s27 offen lds
  s_add_u32 m0, s28, 34816
  s_add_u32 s27, s27, 32768
  buffer_load_dwordx4 v21, s[68:71], s27 offen lds
  s_add_u32 m0, s28, 35840
  s_add_u32 s27, s27, 32768
  buffer_load_dwordx4 v21, s[68:71], s27 offen lds
  s_add_u32 m0, s28, 36864
  s_add_u32 s27, s27, 32768
  buffer_load_dwordx4 v20, s[68:71], s27 offen lds
  s_add_u32 m0, s28, 37888
  s_add_u32 s27, s27, 32768
  buffer_load_dwordx4 v20, s[68:71], s27 offen lds
  s_add_u32 m0, s28, 38912
  s_add_u32 s27, s27, 32768
  buffer_load_dwordx4 v21, s[68:71], s27 offen lds
  s_add_u32 m0, s28, 39936
  s_add_u32 s27, s27, 32768
  buffer_load_dwordx4 v21, s[68:71], s27 offen lds
  ds_read_b64_tr_b16 v[224:225], v23 offset:32768
  ds_read_b64_tr_b16 v[226:227], v23 offset:33792
  ds_read_b64_tr_b16 v[228:229], v23 offset:36864
  ds_read_b64_tr_b16 v[230:231], v23 offset:37888
  ds_read_b64_tr_b16 v[232:233], v23 offset:40960
  ds_read_b64_tr_b16 v[234:235], v23 offset:41984
  ds_read_b64_tr_b16 v[236:237], v23 offset:45056
  ds_read_b64_tr_b16 v[238:239], v23 offset:46080
  ds_read_b64_tr_b16 v[240:241], v23 offset:49152
  ds_read_b64_tr_b16 v[242:243], v23 offset:50176
  ds_read_b64_tr_b16 v[244:245], v23 offset:53248
  ds_read_b64_tr_b16 v[246:247], v23 offset:54272
  ds_read_b64_tr_b16 v[248:249], v23 offset:57344
  ds_read_b64_tr_b16 v[250:251], v23 offset:58368
  ds_read_b64_tr_b16 v[252:253], v23 offset:61440
  ds_read_b64_tr_b16 v[254:255], v23 offset:62464
  s_waitcnt lgkmcnt(0)
  s_waitcnt vmcnt(16)
  s_barrier
  s_add_u32 s27, s26, 3145728
  s_add_u32 m0, s28, 65536
  s_nop 0
  buffer_load_dwordx4 v20, s[68:71], s27 offen lds
  s_add_u32 m0, s28, 66560
  s_add_u32 s27, s27, 32768
  buffer_load_dwordx4 v20, s[68:71], s27 offen lds
  s_add_u32 m0, s28, 67584
  s_add_u32 s27, s27, 32768
  buffer_load_dwordx4 v21, s[68:71], s27 offen lds
  s_add_u32 m0, s28, 68608
  s_add_u32 s27, s27, 32768
  buffer_load_dwordx4 v21, s[68:71], s27 offen lds
  s_add_u32 m0, s28, 69632
  s_add_u32 s27, s27, 32768
  buffer_load_dwordx4 v20, s[68:71], s27 offen lds
  s_add_u32 m0, s28, 70656
  s_add_u32 s27, s27, 32768
  buffer_load_dwordx4 v20, s[68:71], s27 offen lds
  s_add_u32 m0, s28, 71680
  s_add_u32 s27, s27, 32768
  buffer_load_dwordx4 v21, s[68:71], s27 offen lds
  s_add_u32 m0, s28, 72704
  s_add_u32 s27, s27, 32768
  buffer_load_dwordx4 v21, s[68:71], s27 offen lds
  ds_read_b64_tr_b16 a[0:1], v24 offset:0
  ds_read_b64_tr_b16 a[2:3], v24 offset:1024
  ds_read_b64_tr_b16 a[4:5], v24 offset:4096
  ds_read_b64_tr_b16 a[6:7], v24 offset:5120
  ds_read_b64_tr_b16 a[8:9], v24 offset:8192
  ds_read_b64_tr_b16 a[10:11], v24 offset:9216
  ds_read_b64_tr_b16 a[12:13], v24 offset:12288
  ds_read_b64_tr_b16 a[14:15], v24 offset:13312
  ds_read_b64_tr_b16 a[16:17], v24 offset:16384
  ds_read_b64_tr_b16 a[18:19], v24 offset:17408
  ds_read_b64_tr_b16 a[20:21], v24 offset:20480
  ds_read_b64_tr_b16 a[22:23], v24 offset:21504
  ds_read_b64_tr_b16 a[24:25], v24 offset:24576
  ds_read_b64_tr_b16 a[26:27], v24 offset:25600
  ds_read_b64_tr_b16 a[28:29], v24 offset:28672
  ds_read_b64_tr_b16 a[30:31], v24 offset:29696
  s_waitcnt lgkmcnt(0)
  s_waitcnt vmcnt(16)
  s_barrier
  s_add_u32 s27, s26, 0
  s_add_u32 m0, s28, 98304
  s_nop 0
  buffer_load_dwordx4 v20, s[8:11], s27 offen lds
  s_add_u32 m0, s28, 99328
  s_add_u32 s27, s27, 32768
  buffer_load_dwordx4 v20, s[8:11], s27 offen lds
  s_add_u32 m0, s28, 100352
  s_add_u32 s27, s27, 32768
  buffer_load_dwordx4 v21, s[8:11], s27 offen lds
  s_add_u32 m0, s28, 101376
  s_add_u32 s27, s27, 32768
  buffer_load_dwordx4 v21, s[8:11], s27 offen lds
  s_add_u32 m0, s28, 102400
  s_add_u32 s27, s27, 32768
  buffer_load_dwordx4 v20, s[8:11], s27 offen lds
  s_add_u32 m0, s28, 103424
  s_add_u32 s27, s27, 32768
  buffer_load_dwordx4 v20, s[8:11], s27 offen lds
  s_add_u32 m0, s28, 104448
  s_add_u32 s27, s27, 32768
  buffer_load_dwordx4 v21, s[8:11], s27 offen lds
  s_add_u32 m0, s28, 105472
  s_add_u32 s27, s27, 32768
  buffer_load_dwordx4 v21, s[8:11], s27 offen lds
  ds_read_b64_tr_b16 a[32:33], v22 offset:0
  ds_read_b64_tr_b16 a[34:35], v22 offset:1024
  ds_read_b64_tr_b16 a[36:37], v22 offset:4096
  ds_read_b64_tr_b16 a[38:39], v22 offset:5120
  ds_read_b64_tr_b16 a[40:41], v22 offset:8192
  ds_read_b64_tr_b16 a[42:43], v22 offset:9216
  ds_read_b64_tr_b16 a[44:45], v22 offset:12288
  ds_read_b64_tr_b16 a[46:47], v22 offset:13312
  ds_read_b64_tr_b16 a[48:49], v22 offset:16384
  ds_read_b64_tr_b16 a[50:51], v22 offset:17408
  ds_read_b64_tr_b16 a[52:53], v22 offset:20480
  ds_read_b64_tr_b16 a[54:55], v22 offset:21504
  ds_read_b64_tr_b16 a[56:57], v22 offset:24576
  ds_read_b64_tr_b16 a[58:59], v22 offset:25600
  ds_read_b64_tr_b16 a[60:61], v22 offset:28672
  ds_read_b64_tr_b16 a[62:63], v22 offset:29696
  s_waitcnt lgkmcnt(0)
  s_waitcnt vmcnt(16)
  s_barrier
  s_add_u32 s27, s26, 1048576
  s_add_u32 m0, s28, 131072
  s_nop 0
  buffer_load_dwordx4 v20, s[8:11], s27 offen lds
  s_add_u32 m0, s28, 132096
  s_add_u32 s27, s27, 32768
  buffer_load_dwordx4 v20, s[8:11], s27 offen lds
  s_add_u32 m0, s28, 133120
  s_add_u32 s27, s27, 32768
  buffer_load_dwordx4 v21, s[8:11], s27 offen lds
  s_add_u32 m0, s28, 134144
  s_add_u32 s27, s27, 32768
  buffer_load_dwordx4 v21, s[8:11], s27 offen lds
  s_add_u32 m0, s28, 135168
  s_add_u32 s27, s27, 32768
  buffer_load_dwordx4 v20, s[8:11], s27 offen lds
  s_add_u32 m0, s28, 136192
  s_add_u32 s27, s27, 32768
  buffer_load_dwordx4 v20, s[8:11], s27 offen lds
  s_add_u32 m0, s28, 137216
  s_add_u32 s27, s27, 32768
  buffer_load_dwordx4 v21, s[8:11], s27 offen lds
  s_add_u32 m0, s28, 138240
  s_add_u32 s27, s27, 32768
  buffer_load_dwordx4 v21, s[8:11], s27 offen lds
  ds_read_b64_tr_b16 a[64:65], v22 offset:32768
  ds_read_b64_tr_b16 a[66:67], v22 offset:33792
  ds_read_b64_tr_b16 a[68:69], v22 offset:36864
  ds_read_b64_tr_b16 a[70:71], v22 offset:37888
  ds_read_b64_tr_b16 a[72:73], v22 offset:40960
  ds_read_b64_tr_b16 a[74:75], v22 offset:41984
  ds_read_b64_tr_b16 a[76:77], v22 offset:45056
  ds_read_b64_tr_b16 a[78:79], v22 offset:46080
  ds_read_b64_tr_b16 a[80:81], v22 offset:49152
  ds_read_b64_tr_b16 a[82:83], v22 offset:50176
  ds_read_b64_tr_b16 a[84:85], v22 offset:53248
  ds_read_b64_tr_b16 a[86:87], v22 offset:54272
  ds_read_b64_tr_b16 a[88:89], v22 offset:57344
  ds_read_b64_tr_b16 a[90:91], v22 offset:58368
  ds_read_b64_tr_b16 a[92:93], v22 offset:61440
  ds_read_b64_tr_b16 a[94:95], v22 offset:62464
  s_waitcnt lgkmcnt(0)
  s_waitcnt vmcnt(16)
  s_barrier
  s_add_u32 s27, s26, 2097152
  s_add_u32 m0, s28, 0
  s_nop 0
  buffer_load_dwordx4 v20, s[8:11], s27 offen lds
  s_add_u32 m0, s28, 1024
  s_add_u32 s27, s27, 32768
  buffer_load_dwordx4 v20, s[8:11], s27 offen lds
  s_add_u32 m0, s28, 2048
  s_add_u32 s27, s27, 32768
  buffer_load_dwordx4 v21, s[8:11], s27 offen lds
  s_add_u32 m0, s28, 3072
  s_add_u32 s27, s27, 32768
  buffer_load_dwordx4 v21, s[8:11], s27 offen lds
  s_add_u32 m0, s28, 4096
  s_add_u32 s27, s27, 32768
  buffer_load_dwordx4 v20, s[8:11], s27 offen lds
  s_add_u32 m0, s28, 5120
  s_add_u32 s27, s27, 32768
  buffer_load_dwordx4 v20, s[8:11], s27 offen lds
  s_add_u32 m0, s28, 6144
  s_add_u32 s27, s27, 32768
  buffer_load_dwordx4 v21, s[8:11], s27 offen lds
  s_add_u32 m0, s28, 7168
  s_add_u32 s27, s27, 32768
  buffer_load_dwordx4 v21, s[8:11], s27 offen lds
  ds_read_b64_tr_b16 a[96:97], v23 offset:0
  ds_read_b64_tr_b16 a[98:99], v23 offset:1024
  ds_read_b64_tr_b16 a[100:101], v23 offset:4096
  ds_read_b64_tr_b16 a[102:103], v23 offset:5120
  ds_read_b64_tr_b16 a[104:105], v23 offset:8192
  ds_read_b64_tr_b16 a[106:107], v23 offset:9216
  ds_read_b64_tr_b16 a[108:109], v23 offset:12288
  ds_read_b64_tr_b16 a[110:111], v23 offset:13312
  ds_read_b64_tr_b16 a[112:113], v23 offset:16384
  ds_read_b64_tr_b16 a[114:115], v23 offset:17408
  ds_read_b64_tr_b16 a[116:117], v23 offset:20480
  ds_read_b64_tr_b16 a[118:119], v23 offset:21504
  ds_read_b64_tr_b16 a[120:121], v23 offset:24576
  ds_read_b64_tr_b16 a[122:123], v23 offset:25600
  ds_read_b64_tr_b16 a[124:125], v23 offset:28672
  ds_read_b64_tr_b16 a[126:127], v23 offset:29696
  s_waitcnt lgkmcnt(0)
  s_waitcnt vmcnt(16)
  s_barrier
  s_add_u32 s27, s26, 3145728
  s_add_u32 m0, s28, 32768
  s_nop 0
  buffer_load_dwordx4 v20, s[8:11], s27 offen lds
  s_add_u32 m0, s28, 33792
  s_add_u32 s27, s27, 32768
  buffer_load_dwordx4 v20, s[8:11], s27 offen lds
  s_add_u32 m0, s28, 34816
  s_add_u32 s27, s27, 32768
  buffer_load_dwordx4 v21, s[8:11], s27 offen lds
  s_add_u32 m0, s28, 35840
  s_add_u32 s27, s27, 32768
  buffer_load_dwordx4 v21, s[8:11], s27 offen lds
  s_add_u32 m0, s28, 36864
  s_add_u32 s27, s27, 32768
  buffer_load_dwordx4 v20, s[8:11], s27 offen lds
  s_add_u32 m0, s28, 37888
  s_add_u32 s27, s27, 32768
  buffer_load_dwordx4 v20, s[8:11], s27 offen lds
  s_add_u32 m0, s28, 38912
  s_add_u32 s27, s27, 32768
  buffer_load_dwordx4 v21, s[8:11], s27 offen lds
  s_add_u32 m0, s28, 39936
  s_add_u32 s27, s27, 32768
  buffer_load_dwordx4 v21, s[8:11], s27 offen lds
  ds_read_b64_tr_b16 a[128:129], v23 offset:32768
  ds_read_b64_tr_b16 a[130:131], v23 offset:33792
  ds_read_b64_tr_b16 a[132:133], v23 offset:36864
  ds_read_b64_tr_b16 a[134:135], v23 offset:37888
  ds_read_b64_tr_b16 a[136:137], v23 offset:40960
  ds_read_b64_tr_b16 a[138:139], v23 offset:41984
  ds_read_b64_tr_b16 a[140:141], v23 offset:45056
  ds_read_b64_tr_b16 a[142:143], v23 offset:46080
  ds_read_b64_tr_b16 a[144:145], v23 offset:49152
  ds_read_b64_tr_b16 a[146:147], v23 offset:50176
  ds_read_b64_tr_b16 a[148:149], v23 offset:53248
  ds_read_b64_tr_b16 a[150:151], v23 offset:54272
  ds_read_b64_tr_b16 a[152:153], v23 offset:57344
  ds_read_b64_tr_b16 a[154:155], v23 offset:58368
  ds_read_b64_tr_b16 a[156:157], v23 offset:61440
  ds_read_b64_tr_b16 a[158:159], v23 offset:62464
  s_waitcnt lgkmcnt(0)
  s_waitcnt vmcnt(16)
  s_barrier
  ds_read_b64_tr_b16 a[160:161], v24 offset:0
  ds_read_b64_tr_b16 a[162:163], v24 offset:1024
  ds_read_b64_tr_b16 a[164:165], v24 offset:4096
  ds_read_b64_tr_b16 a[166:167], v24 offset:5120
  ds_read_b64_tr_b16 a[168:169], v24 offset:8192
  ds_read_b64_tr_b16 a[170:171], v24 offset:9216
  ds_read_b64_tr_b16 a[172:173], v24 offset:12288
  ds_read_b64_tr_b16 a[174:175], v24 offset:13312
  ds_read_b64_tr_b16 a[176:177], v24 offset:16384
  ds_read_b64_tr_b16 a[178:179], v24 offset:17408
  ds_read_b64_tr_b16 a[180:181], v24 offset:20480
  ds_read_b64_tr_b16 a[182:183], v24 offset:21504
  ds_read_b64_tr_b16 a[184:185], v24 offset:24576
  ds_read_b64_tr_b16 a[186:187], v24 offset:25600
  ds_read_b64_tr_b16 a[188:189], v24 offset:28672
  ds_read_b64_tr_b16 a[190:191], v24 offset:29696
  s_waitcnt lgkmcnt(0)
  s_waitcnt vmcnt(8)
  s_barrier
  ds_read_b64_tr_b16 a[192:193], v22 offset:0
  ds_read_b64_tr_b16 a[194:195], v22 offset:1024
  ds_read_b64_tr_b16 a[196:197], v22 offset:4096
  ds_read_b64_tr_b16 a[198:199], v22 offset:5120
  ds_read_b64_tr_b16 a[200:201], v22 offset:8192
  ds_read_b64_tr_b16 a[202:203], v22 offset:9216
  ds_read_b64_tr_b16 a[204:205], v22 offset:12288
  ds_read_b64_tr_b16 a[206:207], v22 offset:13312
  ds_read_b64_tr_b16 a[208:209], v22 offset:16384
  ds_read_b64_tr_b16 a[210:211], v22 offset:17408
  ds_read_b64_tr_b16 a[212:213], v22 offset:20480
  ds_read_b64_tr_b16 a[214:215], v22 offset:21504
  ds_read_b64_tr_b16 a[216:217], v22 offset:24576
  ds_read_b64_tr_b16 a[218:219], v22 offset:25600
  ds_read_b64_tr_b16 a[220:221], v22 offset:28672
  ds_read_b64_tr_b16 a[222:223], v22 offset:29696
  s_waitcnt lgkmcnt(0)
  s_waitcnt vmcnt(0)
  s_barrier
  ds_read_b64_tr_b16 a[224:225], v22 offset:32768
  ds_read_b64_tr_b16 a[226:227], v22 offset:33792
  ds_read_b64_tr_b16 a[228:229], v22 offset:36864
  ds_read_b64_tr_b16 a[230:231], v22 offset:37888
  ds_read_b64_tr_b16 a[232:233], v22 offset:40960
  ds_read_b64_tr_b16 a[234:235], v22 offset:41984
  ds_read_b64_tr_b16 a[236:237], v22 offset:45056
  ds_read_b64_tr_b16 a[238:239], v22 offset:46080
  ds_read_b64_tr_b16 a[240:241], v22 offset:49152
  ds_read_b64_tr_b16 a[242:243], v22 offset:50176
  ds_read_b64_tr_b16 a[244:245], v22 offset:53248
  ds_read_b64_tr_b16 a[246:247], v22 offset:54272
  ds_read_b64_tr_b16 a[248:249], v22 offset:57344
  ds_read_b64_tr_b16 a[250:251], v22 offset:58368
  ds_read_b64_tr_b16 a[252:253], v22 offset:61440
  ds_read_b64_tr_b16 a[254:255], v22 offset:62464
  s_waitcnt lgkmcnt(0)
  s_branch q_ld_84
q_ld_82:
  s_add_u32 s27, s26, 0
  s_add_u32 m0, s28, 0
  s_nop 0
  buffer_load_dwordx4 v20, s[68:71], s27 offen lds
  s_add_u32 m0, s28, 1024
  s_add_u32 s27, s27, 32768
  buffer_load_dwordx4 v20, s[68:71], s27 offen lds
  s_add_u32 m0, s28, 2048
  s_add_u32 s27, s27, 32768
  buffer_load_dwordx4 v21, s[68:71], s27 offen lds
  s_add_u32 m0, s28, 3072
  s_add_u32 s27, s27, 32768
  buffer_load_dwordx4 v21, s[68:71], s27 offen lds
  s_add_u32 m0, s28, 4096
  s_add_u32 s27, s27, 32768
  buffer_load_dwordx4 v20, s[68:71], s27 offen lds
  s_add_u32 m0, s28, 5120
  s_add_u32 s27, s27, 32768
  buffer_load_dwordx4 v20, s[68:71], s27 offen lds
  s_add_u32 m0, s28, 6144
  s_add_u32 s27, s27, 32768
  buffer_load_dwordx4 v21, s[68:71], s27 offen lds
  s_add_u32 m0, s28, 7168
  s_add_u32 s27, s27, 32768
  buffer_load_dwordx4 v21, s[68:71], s27 offen lds
  s_add_u32 s27, s26, 1048576
  s_add_u32 m0, s28, 32768
  s_nop 0
  buffer_load_dwordx4 v20, s[68:71], s27 offen lds
  s_add_u32 m0, s28, 33792
  s_add_u32 s27, s27, 32768
  buffer_load_dwordx4 v20, s[68:71], s27 offen lds
  s_add_u32 m0, s28, 34816
  s_add_u32 s27, s27, 32768
  buffer_load_dwordx4 v21, s[68:71], s27 offen lds
  s_add_u32 m0, s28, 35840
  s_add_u32 s27, s27, 32768
  buffer_load_dwordx4 v21, s[68:71], s27 offen lds
  s_add_u32 m0, s28, 36864
  s_add_u32 s27, s27, 32768
  buffer_load_dwordx4 v20, s[68:71], s27 offen lds
  s_add_u32 m0, s28, 37888
  s_add_u32 s27, s27, 32768
  buffer_load_dwordx4 v20, s[68:71], s27 offen lds
  s_add_u32 m0, s28, 38912
  s_add_u32 s27, s27, 32768
  buffer_load_dwordx4 v21, s[68:71], s27 offen lds
  s_add_u32 m0, s28, 39936
  s_add_u32 s27, s27, 32768
  buffer_load_dwordx4 v21, s[68:71], s27 offen lds
  s_add_u32 s27, s26, 2097152
  s_add_u32 m0, s28, 65536
  s_nop 0
  buffer_load_dwordx4 v20, s[68:71], s27 offen lds
  s_add_u32 m0, s28, 66560
  s_add_u32 s27, s27, 32768
  buffer_load_dwordx4 v20, s[68:71], s27 offen lds
  s_add_u32 m0, s28, 67584
  s_add_u32 s27, s27, 32768
  buffer_load_dwordx4 v21, s[68:71], s27 offen lds
  s_add_u32 m0, s28, 68608
  s_add_u32 s27, s27, 32768
  buffer_load_dwordx4 v21, s[68:71], s27 offen lds
  s_add_u32 m0, s28, 69632
  s_add_u32 s27, s27, 32768
  buffer_load_dwordx4 v20, s[68:71], s27 offen lds
  s_add_u32 m0, s28, 70656
  s_add_u32 s27, s27, 32768
  buffer_load_dwordx4 v20, s[68:71], s27 offen lds
  s_add_u32 m0, s28, 71680
  s_add_u32 s27, s27, 32768
  buffer_load_dwordx4 v21, s[68:71], s27 offen lds
  s_add_u32 m0, s28, 72704
  s_add_u32 s27, s27, 32768
  buffer_load_dwordx4 v21, s[68:71], s27 offen lds
  s_load_dwordx2 s[4:5], s[0:1], 112
  s_load_dwordx2 s[12:13], s[0:1], 104
  s_waitcnt vmcnt(16)
  s_barrier
  s_add_u32 s27, s26, 3145728
  s_add_u32 m0, s28, 98304
  s_nop 0
  buffer_load_dwordx4 v20, s[68:71], s27 offen lds
  s_add_u32 m0, s28, 99328
  s_add_u32 s27, s27, 32768
  buffer_load_dwordx4 v20, s[68:71], s27 offen lds
  s_add_u32 m0, s28, 100352
  s_add_u32 s27, s27, 32768
  buffer_load_dwordx4 v21, s[68:71], s27 offen lds
  s_add_u32 m0, s28, 101376
  s_add_u32 s27, s27, 32768
  buffer_load_dwordx4 v21, s[68:71], s27 offen lds
  s_add_u32 m0, s28, 102400
  s_add_u32 s27, s27, 32768
  buffer_load_dwordx4 v20, s[68:71], s27 offen lds
  s_add_u32 m0, s28, 103424
  s_add_u32 s27, s27, 32768
  buffer_load_dwordx4 v20, s[68:71], s27 offen lds
  s_add_u32 m0, s28, 104448
  s_add_u32 s27, s27, 32768
  buffer_load_dwordx4 v21, s[68:71], s27 offen lds
  s_add_u32 m0, s28, 105472
  s_add_u32 s27, s27, 32768
  buffer_load_dwordx4 v21, s[68:71], s27 offen lds
  ds_read_b64_tr_b16 a[0:1], v22 offset:0
  ds_read_b64_tr_b16 a[2:3], v22 offset:1024
  ds_read_b64_tr_b16 a[4:5], v22 offset:4096
  ds_read_b64_tr_b16 a[6:7], v22 offset:5120
  ds_read_b64_tr_b16 a[8:9], v22 offset:8192
  ds_read_b64_tr_b16 a[10:11], v22 offset:9216
  ds_read_b64_tr_b16 a[12:13], v22 offset:12288
  ds_read_b64_tr_b16 a[14:15], v22 offset:13312
  ds_read_b64_tr_b16 a[16:17], v22 offset:16384
  ds_read_b64_tr_b16 a[18:19], v22 offset:17408
  ds_read_b64_tr_b16 a[20:21], v22 offset:20480
  ds_read_b64_tr_b16 a[22:23], v22 offset:21504
  ds_read_b64_tr_b16 a[24:25], v22 offset:24576
  ds_read_b64_tr_b16 a[26:27], v22 offset:25600
  ds_read_b64_tr_b16 a[28:29], v22 offset:28672
  ds_read_b64_tr_b16 a[30:31], v22 offset:29696
  s_waitcnt lgkmcnt(0)
  s_waitcnt vmcnt(16)
  s_barrier
  s_add_u32 s27, s26, 0
  s_add_u32 m0, s28, 131072
  s_nop 0
  buffer_load_dwordx4 v20, s[8:11], s27 offen lds
  s_add_u32 m0, s28, 132096
  s_add_u32 s27, s27, 32768
  buffer_load_dwordx4 v20, s[8:11], s27 offen lds
  s_add_u32 m0, s28, 133120
  s_add_u32 s27, s27, 32768
  buffer_load_dwordx4 v21, s[8:11], s27 offen lds
  s_add_u32 m0, s28, 134144
  s_add_u32 s27, s27, 32768
  buffer_load_dwordx4 v21, s[8:11], s27 offen lds
  s_add_u32 m0, s28, 135168
  s_add_u32 s27, s27, 32768
  buffer_load_dwordx4 v20, s[8:11], s27 offen lds
  s_add_u32 m0, s28, 136192
  s_add_u32 s27, s27, 32768
  buffer_load_dwordx4 v20, s[8:11], s27 offen lds
  s_add_u32 m0, s28, 137216
  s_add_u32 s27, s27, 32768
  buffer_load_dwordx4 v21, s[8:11], s27 offen lds
  s_add_u32 m0, s28, 138240
  s_add_u32 s27, s27, 32768
  buffer_load_dwordx4 v21, s[8:11], s27 offen lds
  ds_read_b64_tr_b16 a[32:33], v22 offset:32768
  ds_read_b64_tr_b16 a[34:35], v22 offset:33792
  ds_read_b64_tr_b16 a[36:37], v22 offset:36864
  ds_read_b64_tr_b16 a[38:39], v22 offset:37888
  ds_read_b64_tr_b16 a[40:41], v22 offset:40960
  ds_read_b64_tr_b16 a[42:43], v22 offset:41984
  ds_read_b64_tr_b16 a[44:45], v22 offset:45056
  ds_read_b64_tr_b16 a[46:47], v22 offset:46080
  ds_read_b64_tr_b16 a[48:49], v22 offset:49152
  ds_read_b64_tr_b16 a[50:51], v22 offset:50176
  ds_read_b64_tr_b16 a[52:53], v22 offset:53248
  ds_read_b64_tr_b16 a[54:55], v22 offset:54272
  ds_read_b64_tr_b16 a[56:57], v22 offset:57344
  ds_read_b64_tr_b16 a[58:59], v22 offset:58368
  ds_read_b64_tr_b16 a[60:61], v22 offset:61440
  ds_read_b64_tr_b16 a[62:63], v22 offset:62464
  s_waitcnt lgkmcnt(0)
  s_waitcnt vmcnt(16)
  s_barrier
  s_add_u32 s27, s26, 1048576
  s_add_u32 m0, s28, 0
  s_nop 0
  buffer_load_dwordx4 v20, s[8:11], s27 offen lds
  s_add_u32 m0, s28, 1024
  s_add_u32 s27, s27, 32768
  buffer_load_dwordx4 v20, s[8:11], s27 offen lds
  s_add_u32 m0, s28, 2048
  s_add_u32 s27, s27, 32768
  buffer_load_dwordx4 v21, s[8:11], s27 offen lds
  s_add_u32 m0, s28, 3072
  s_add_u32 s27, s27, 32768
  buffer_load_dwordx4 v21, s[8:11], s27 offen lds
  s_add_u32 m0, s28, 4096
  s_add_u32 s27, s27, 32768
  buffer_load_dwordx4 v20, s[8:11], s27 offen lds
  s_add_u32 m0, s28, 5120
  s_add_u32 s27, s27, 32768
  buffer_load_dwordx4 v20, s[8:11], s27 offen lds
  s_add_u32 m0, s28, 6144
  s_add_u32 s27, s27, 32768
  buffer_load_dwordx4 v21, s[8:11], s27 offen lds
  s_add_u32 m0, s28, 7168
  s_add_u32 s27, s27, 32768
  buffer_load_dwordx4 v21, s[8:11], s27 offen lds
  ds_read_b64_tr_b16 a[64:65], v23 offset:0
  ds_read_b64_tr_b16 a[66:67], v23 offset:1024
  ds_read_b64_tr_b16 a[68:69], v23 offset:4096
  ds_read_b64_tr_b16 a[70:71], v23 offset:5120
  ds_read_b64_tr_b16 a[72:73], v23 offset:8192
  ds_read_b64_tr_b16 a[74:75], v23 offset:9216
  ds_read_b64_tr_b16 a[76:77], v23 offset:12288
  ds_read_b64_tr_b16 a[78:79], v23 offset:13312
  ds_read_b64_tr_b16 a[80:81], v23 offset:16384
  ds_read_b64_tr_b16 a[82:83], v23 offset:17408
  ds_read_b64_tr_b16 a[84:85], v23 offset:20480
  ds_read_b64_tr_b16 a[86:87], v23 offset:21504
  ds_read_b64_tr_b16 a[88:89], v23 offset:24576
  ds_read_b64_tr_b16 a[90:91], v23 offset:25600
  ds_read_b64_tr_b16 a[92:93], v23 offset:28672
  ds_read_b64_tr_b16 a[94:95], v23 offset:29696
  s_waitcnt lgkmcnt(0)
  s_waitcnt vmcnt(16)
  s_barrier
  s_add_u32 s27, s26, 2097152
  s_add_u32 m0, s28, 32768
  s_nop 0
  buffer_load_dwordx4 v20, s[8:11], s27 offen lds
  s_add_u32 m0, s28, 33792
  s_add_u32 s27, s27, 32768
  buffer_load_dwordx4 v20, s[8:11], s27 offen lds
  s_add_u32 m0, s28, 34816
  s_add_u32 s27, s27, 32768
  buffer_load_dwordx4 v21, s[8:11], s27 offen lds
  s_add_u32 m0, s28, 35840
  s_add_u32 s27, s27, 32768
  buffer_load_dwordx4 v21, s[8:11], s27 offen lds
  s_add_u32 m0, s28, 36864
  s_add_u32 s27, s27, 32768
  buffer_load_dwordx4 v20, s[8:11], s27 offen lds
  s_add_u32 m0, s28, 37888
  s_add_u32 s27, s27, 32768
  buffer_load_dwordx4 v20, s[8:11], s27 offen lds
  s_add_u32 m0, s28, 38912
  s_add_u32 s27, s27, 32768
  buffer_load_dwordx4 v21, s[8:11], s27 offen lds
  s_add_u32 m0, s28, 39936
  s_add_u32 s27, s27, 32768
  buffer_load_dwordx4 v21, s[8:11], s27 offen lds
  ds_read_b64_tr_b16 a[96:97], v23 offset:32768
  ds_read_b64_tr_b16 a[98:99], v23 offset:33792
  ds_read_b64_tr_b16 a[100:101], v23 offset:36864
  ds_read_b64_tr_b16 a[102:103], v23 offset:37888
  ds_read_b64_tr_b16 a[104:105], v23 offset:40960
  ds_read_b64_tr_b16 a[106:107], v23 offset:41984
  ds_read_b64_tr_b16 a[108:109], v23 offset:45056
  ds_read_b64_tr_b16 a[110:111], v23 offset:46080
  ds_read_b64_tr_b16 a[112:113], v23 offset:49152
  ds_read_b64_tr_b16 a[114:115], v23 offset:50176
  ds_read_b64_tr_b16 a[116:117], v23 offset:53248
  ds_read_b64_tr_b16 a[118:119], v23 offset:54272
  ds_read_b64_tr_b16 a[120:121], v23 offset:57344
  ds_read_b64_tr_b16 a[122:123], v23 offset:58368
  ds_read_b64_tr_b16 a[124:125], v23 offset:61440
  ds_read_b64_tr_b16 a[126:127], v23 offset:62464
  s_waitcnt lgkmcnt(0)
  s_waitcnt vmcnt(16)
  s_barrier
  s_add_u32 s27, s26, 3145728
  s_add_u32 m0, s28, 65536
  s_nop 0
  buffer_load_dwordx4 v20, s[8:11], s27 offen lds
  s_add_u32 m0, s28, 66560
  s_add_u32 s27, s27, 32768
  buffer_load_dwordx4 v20, s[8:11], s27 offen lds
  s_add_u32 m0, s28, 67584
  s_add_u32 s27, s27, 32768
  buffer_load_dwordx4 v21, s[8:11], s27 offen lds
  s_add_u32 m0, s28, 68608
  s_add_u32 s27, s27, 32768
  buffer_load_dwordx4 v21, s[8:11], s27 offen lds
  s_add_u32 m0, s28, 69632
  s_add_u32 s27, s27, 32768
  buffer_load_dwordx4 v20, s[8:11], s27 offen lds
  s_add_u32 m0, s28, 70656
  s_add_u32 s27, s27, 32768
  buffer_load_dwordx4 v20, s[8:11], s27 offen lds
  s_add_u32 m0, s28, 71680
  s_add_u32 s27, s27, 32768
  buffer_load_dwordx4 v21, s[8:11], s27 offen lds
  s_add_u32 m0, s28, 72704
  s_add_u32 s27, s27, 32768
  buffer_load_dwordx4 v21, s[8:11], s27 offen lds
  ds_read_b64_tr_b16 a[128:129], v24 offset:0
  ds_read_b64_tr_b16 a[130:131], v24 offset:1024
  ds_read_b64_tr_b16 a[132:133], v24 offset:4096
  ds_read_b64_tr_b16 a[134:135], v24 offset:5120
  ds_read_b64_tr_b16 a[136:137], v24 offset:8192
  ds_read_b64_tr_b16 a[138:139], v24 offset:9216
  ds_read_b64_tr_b16 a[140:141], v24 offset:12288
  ds_read_b64_tr_b16 a[142:143], v24 offset:13312
  ds_read_b64_tr_b16 a[144:145], v24 offset:16384
  ds_read_b64_tr_b16 a[146:147], v24 offset:17408
  ds_read_b64_tr_b16 a[148:149], v24 offset:20480
  ds_read_b64_tr_b16 a[150:151], v24 offset:21504
  ds_read_b64_tr_b16 a[152:153], v24 offset:24576
  ds_read_b64_tr_b16 a[154:155], v24 offset:25600
  ds_read_b64_tr_b16 a[156:157], v24 offset:28672
  ds_read_b64_tr_b16 a[158:159], v24 offset:29696
  s_waitcnt lgkmcnt(0)
  s_waitcnt vmcnt(16)
  s_barrier
  s_add_u32 s27, s26, 0
  s_add_u32 m0, s28, 98304
  s_nop 0
  buffer_load_dwordx4 v20, s[64:67], s27 offen lds
  s_add_u32 m0, s28, 99328
  s_add_u32 s27, s27, 32768
  buffer_load_dwordx4 v20, s[64:67], s27 offen lds
  s_add_u32 m0, s28, 100352
  s_add_u32 s27, s27, 32768
  buffer_load_dwordx4 v21, s[64:67], s27 offen lds
  s_add_u32 m0, s28, 101376
  s_add_u32 s27, s27, 32768
  buffer_load_dwordx4 v21, s[64:67], s27 offen lds
  s_add_u32 m0, s28, 102400
  s_add_u32 s27, s27, 32768
  buffer_load_dwordx4 v20, s[64:67], s27 offen lds
  s_add_u32 m0, s28, 103424
  s_add_u32 s27, s27, 32768
  buffer_load_dwordx4 v20, s[64:67], s27 offen lds
  s_add_u32 m0, s28, 104448
  s_add_u32 s27, s27, 32768
  buffer_load_dwordx4 v21, s[64:67], s27 offen lds
  s_add_u32 m0, s28, 105472
  s_add_u32 s27, s27, 32768
  buffer_load_dwordx4 v21, s[64:67], s27 offen lds
  ds_read_b64_tr_b16 a[160:161], v22 offset:0
  ds_read_b64_tr_b16 a[162:163], v22 offset:1024
  ds_read_b64_tr_b16 a[164:165], v22 offset:4096
  ds_read_b64_tr_b16 a[166:167], v22 offset:5120
  ds_read_b64_tr_b16 a[168:169], v22 offset:8192
  ds_read_b64_tr_b16 a[170:171], v22 offset:9216
  ds_read_b64_tr_b16 a[172:173], v22 offset:12288
  ds_read_b64_tr_b16 a[174:175], v22 offset:13312
  ds_read_b64_tr_b16 a[176:177], v22 offset:16384
  ds_read_b64_tr_b16 a[178:179], v22 offset:17408
  ds_read_b64_tr_b16 a[180:181], v22 offset:20480
  ds_read_b64_tr_b16 a[182:183], v22 offset:21504
  ds_read_b64_tr_b16 a[184:185], v22 offset:24576
  ds_read_b64_tr_b16 a[186:187], v22 offset:25600
  ds_read_b64_tr_b16 a[188:189], v22 offset:28672
  ds_read_b64_tr_b16 a[190:191], v22 offset:29696
  s_waitcnt lgkmcnt(0)
  s_waitcnt vmcnt(16)
  s_barrier
  s_add_u32 s27, s26, 1048576
  s_add_u32 m0, s28, 131072
  s_nop 0
  buffer_load_dwordx4 v20, s[64:67], s27 offen lds
  s_add_u32 m0, s28, 132096
  s_add_u32 s27, s27, 32768
  buffer_load_dwordx4 v20, s[64:67], s27 offen lds
  s_add_u32 m0, s28, 133120
  s_add_u32 s27, s27, 32768
  buffer_load_dwordx4 v21, s[64:67], s27 offen lds
  s_add_u32 m0, s28, 134144
  s_add_u32 s27, s27, 32768
  buffer_load_dwordx4 v21, s[64:67], s27 offen lds
  s_add_u32 m0, s28, 135168
  s_add_u32 s27, s27, 32768
  buffer_load_dwordx4 v20, s[64:67], s27 offen lds
  s_add_u32 m0, s28, 136192
  s_add_u32 s27, s27, 32768
  buffer_load_dwordx4 v20, s[64:67], s27 offen lds
  s_add_u32 m0, s28, 137216
  s_add_u32 s27, s27, 32768
  buffer_load_dwordx4 v21, s[64:67], s27 offen lds
  s_add_u32 m0, s28, 138240
  s_add_u32 s27, s27, 32768
  buffer_load_dwordx4 v21, s[64:67], s27 offen lds
  ds_read_b64_tr_b16 a[192:193], v22 offset:32768
  ds_read_b64_tr_b16 a[194:195], v22 offset:33792
  ds_read_b64_tr_b16 a[196:197], v22 offset:36864
  ds_read_b64_tr_b16 a[198:199], v22 offset:37888
  ds_read_b64_tr_b16 a[200:201], v22 offset:40960
  ds_read_b64_tr_b16 a[202:203], v22 offset:41984
  ds_read_b64_tr_b16 a[204:205], v22 offset:45056
  ds_read_b64_tr_b16 a[206:207], v22 offset:46080
  ds_read_b64_tr_b16 a[208:209], v22 offset:49152
  ds_read_b64_tr_b16 a[210:211], v22 offset:50176
  ds_read_b64_tr_b16 a[212:213], v22 offset:53248
  ds_read_b64_tr_b16 a[214:215], v22 offset:54272
  ds_read_b64_tr_b16 a[216:217], v22 offset:57344
  ds_read_b64_tr_b16 a[218:219], v22 offset:58368
  ds_read_b64_tr_b16 a[220:221], v22 offset:61440
  ds_read_b64_tr_b16 a[222:223], v22 offset:62464
  s_waitcnt lgkmcnt(0)
  s_waitcnt vmcnt(16)
  s_barrier
  s_add_u32 s27, s26, 2097152
  s_add_u32 m0, s28, 0
  s_nop 0
  buffer_load_dwordx4 v20, s[64:67], s27 offen lds
  s_add_u32 m0, s28, 1024
  s_add_u32 s27, s27, 32768
  buffer_load_dwordx4 v20, s[64:67], s27 offen lds
  s_add_u32 m0, s28, 2048
  s_add_u32 s27, s27, 32768
  buffer_load_dwordx4 v21, s[64:67], s27 offen lds
  s_add_u32 m0, s28, 3072
  s_add_u32 s27, s27, 32768
  buffer_load_dwordx4 v21, s[64:67], s27 offen lds
  s_add_u32 m0, s28, 4096
  s_add_u32 s27, s27, 32768
  buffer_load_dwordx4 v20, s[64:67], s27 offen lds
  s_add_u32 m0, s28, 5120
  s_add_u32 s27, s27, 32768
  buffer_load_dwordx4 v20, s[64:67], s27 offen lds
  s_add_u32 m0, s28, 6144
  s_add_u32 s27, s27, 32768
  buffer_load_dwordx4 v21, s[64:67], s27 offen lds
  s_add_u32 m0, s28, 7168
  s_add_u32 s27, s27, 32768
  buffer_load_dwordx4 v21, s[64:67], s27 offen lds
  ds_read_b64_tr_b16 a[224:225], v23 offset:0
  ds_read_b64_tr_b16 a[226:227], v23 offset:1024
  ds_read_b64_tr_b16 a[228:229], v23 offset:4096
  ds_read_b64_tr_b16 a[230:231], v23 offset:5120
  ds_read_b64_tr_b16 a[232:233], v23 offset:8192
  ds_read_b64_tr_b16 a[234:235], v23 offset:9216
  ds_read_b64_tr_b16 a[236:237], v23 offset:12288
  ds_read_b64_tr_b16 a[238:239], v23 offset:13312
  ds_read_b64_tr_b16 a[240:241], v23 offset:16384
  ds_read_b64_tr_b16 a[242:243], v23 offset:17408
  ds_read_b64_tr_b16 a[244:245], v23 offset:20480
  ds_read_b64_tr_b16 a[246:247], v23 offset:21504
  ds_read_b64_tr_b16 a[248:249], v23 offset:24576
  ds_read_b64_tr_b16 a[250:251], v23 offset:25600
  ds_read_b64_tr_b16 a[252:253], v23 offset:28672
  ds_read_b64_tr_b16 a[254:255], v23 offset:29696
  s_waitcnt lgkmcnt(0)
  s_waitcnt vmcnt(16)
  s_barrier
  s_add_u32 s27, s26, 3145728
  s_add_u32 m0, s28, 32768
  s_nop 0
  buffer_load_dwordx4 v20, s[64:67], s27 offen lds
  s_add_u32 m0, s28, 33792
  s_add_u32 s27, s27, 32768
  buffer_load_dwordx4 v20, s[64:67], s27 offen lds
  s_add_u32 m0, s28, 34816
  s_add_u32 s27, s27, 32768
  buffer_load_dwordx4 v21, s[64:67], s27 offen lds
  s_add_u32 m0, s28, 35840
  s_add_u32 s27, s27, 32768
  buffer_load_dwordx4 v21, s[64:67], s27 offen lds
  s_add_u32 m0, s28, 36864
  s_add_u32 s27, s27, 32768
  buffer_load_dwordx4 v20, s[64:67], s27 offen lds
  s_add_u32 m0, s28, 37888
  s_add_u32 s27, s27, 32768
  buffer_load_dwordx4 v20, s[64:67], s27 offen lds
  s_add_u32 m0, s28, 38912
  s_add_u32 s27, s27, 32768
  buffer_load_dwordx4 v21, s[64:67], s27 offen lds
  s_add_u32 m0, s28, 39936
  s_add_u32 s27, s27, 32768
  buffer_load_dwordx4 v21, s[64:67], s27 offen lds
  ds_read_b64_tr_b16 v[128:129], v23 offset:32768
  ds_read_b64_tr_b16 v[130:131], v23 offset:33792
  ds_read_b64_tr_b16 v[132:133], v23 offset:36864
  ds_read_b64_tr_b16 v[134:135], v23 offset:37888
  ds_read_b64_tr_b16 v[136:137], v23 offset:40960
  ds_read_b64_tr_b16 v[138:139], v23 offset:41984
  ds_read_b64_tr_b16 v[140:141], v23 offset:45056
  ds_read_b64_tr_b16 v[142:143], v23 offset:46080
  ds_read_b64_tr_b16 v[144:145], v23 offset:49152
  ds_read_b64_tr_b16 v[146:147], v23 offset:50176
  ds_read_b64_tr_b16 v[148:149], v23 offset:53248
  ds_read_b64_tr_b16 v[150:151], v23 offset:54272
  ds_read_b64_tr_b16 v[152:153], v23 offset:57344
  ds_read_b64_tr_b16 v[154:155], v23 offset:58368
  ds_read_b64_tr_b16 v[156:157], v23 offset:61440
  ds_read_b64_tr_b16 v[158:159], v23 offset:62464
  s_waitcnt lgkmcnt(0)
  s_waitcnt vmcnt(16)
  s_barrier
  ds_read_b64_tr_b16 v[160:161], v24 offset:0
  ds_read_b64_tr_b16 v[162:163], v24 offset:1024
  ds_read_b64_tr_b16 v[164:165], v24 offset:4096
  ds_read_b64_tr_b16 v[166:167], v24 offset:5120
  ds_read_b64_tr_b16 v[168:169], v24 offset:8192
  ds_read_b64_tr_b16 v[170:171], v24 offset:9216
  ds_read_b64_tr_b16 v[172:173], v24 offset:12288
  ds_read_b64_tr_b16 v[174:175], v24 offset:13312
  ds_read_b64_tr_b16 v[176:177], v24 offset:16384
  ds_read_b64_tr_b16 v[178:179], v24 offset:17408
  ds_read_b64_tr_b16 v[180:181], v24 offset:20480
  ds_read_b64_tr_b16 v[182:183], v24 offset:21504
  ds_read_b64_tr_b16 v[184:185], v24 offset:24576
  ds_read_b64_tr_b16 v[186:187], v24 offset:25600
  ds_read_b64_tr_b16 v[188:189], v24 offset:28672
  ds_read_b64_tr_b16 v[190:191], v24 offset:29696
  s_waitcnt lgkmcnt(0)
  s_waitcnt vmcnt(8)
  s_barrier
  ds_read_b64_tr_b16 v[192:193], v22 offset:0
  ds_read_b64_tr_b16 v[194:195], v22 offset:1024
  ds_read_b64_tr_b16 v[196:197], v22 offset:4096
  ds_read_b64_tr_b16 v[198:199], v22 offset:5120
  ds_read_b64_tr_b16 v[200:201], v22 offset:8192
  ds_read_b64_tr_b16 v[202:203], v22 offset:9216
  ds_read_b64_tr_b16 v[204:205], v22 offset:12288
  ds_read_b64_tr_b16 v[206:207], v22 offset:13312
  ds_read_b64_tr_b16 v[208:209], v22 offset:16384
  ds_read_b64_tr_b16 v[210:211], v22 offset:17408
  ds_read_b64_tr_b16 v[212:213], v22 offset:20480
  ds_read_b64_tr_b16 v[214:215], v22 offset:21504
  ds_read_b64_tr_b16 v[216:217], v22 offset:24576
  ds_read_b64_tr_b16 v[218:219], v22 offset:25600
  ds_read_b64_tr_b16 v[220:221], v22 offset:28672
  ds_read_b64_tr_b16 v[222:223], v22 offset:29696
  s_waitcnt lgkmcnt(0)
  s_waitcnt vmcnt(0)
  s_barrier
  ds_read_b64_tr_b16 v[224:225], v22 offset:32768
  ds_read_b64_tr_b16 v[226:227], v22 offset:33792
  ds_read_b64_tr_b16 v[228:229], v22 offset:36864
  ds_read_b64_tr_b16 v[230:231], v22 offset:37888
  ds_read_b64_tr_b16 v[232:233], v22 offset:40960
  ds_read_b64_tr_b16 v[234:235], v22 offset:41984
  ds_read_b64_tr_b16 v[236:237], v22 offset:45056
  ds_read_b64_tr_b16 v[238:239], v22 offset:46080
  ds_read_b64_tr_b16 v[240:241], v22 offset:49152
  ds_read_b64_tr_b16 v[242:243], v22 offset:50176
  ds_read_b64_tr_b16 v[244:245], v22 offset:53248
  ds_read_b64_tr_b16 v[246:247], v22 offset:54272
  ds_read_b64_tr_b16 v[248:249], v22 offset:57344
  ds_read_b64_tr_b16 v[250:251], v22 offset:58368
  ds_read_b64_tr_b16 v[252:253], v22 offset:61440
  ds_read_b64_tr_b16 v[254:255], v22 offset:62464
  s_waitcnt lgkmcnt(0)
  s_branch q_ld_84
q_ld_83:
  s_add_u32 s27, s26, 0
  s_add_u32 m0, s28, 0
  s_nop 0
  buffer_load_dwordx4 v20, s[8:11], s27 offen lds
  s_add_u32 m0, s28, 1024
  s_add_u32 s27, s27, 32768
  buffer_load_dwordx4 v20, s[8:11], s27 offen lds
  s_add_u32 m0, s28, 2048
  s_add_u32 s27, s27, 32768
  buffer_load_dwordx4 v21, s[8:11], s27 offen lds
  s_add_u32 m0, s28, 3072
  s_add_u32 s27, s27, 32768
  buffer_load_dwordx4 v21, s[8:11], s27 offen lds
  s_add_u32 m0, s28, 4096
  s_add_u32 s27, s27, 32768
  buffer_load_dwordx4 v20, s[8:11], s27 offen lds
  s_add_u32 m0, s28, 5120
  s_add_u32 s27, s27, 32768
  buffer_load_dwordx4 v20, s[8:11], s27 offen lds
  s_add_u32 m0, s28, 6144
  s_add_u32 s27, s27, 32768
  buffer_load_dwordx4 v21, s[8:11], s27 offen lds
  s_add_u32 m0, s28, 7168
  s_add_u32 s27, s27, 32768
  buffer_load_dwordx4 v21, s[8:11], s27 offen lds
  s_add_u32 s27, s26, 1048576
  s_add_u32 m0, s28, 32768
  s_nop 0
  buffer_load_dwordx4 v20, s[8:11], s27 offen lds
  s_add_u32 m0, s28, 33792
  s_add_u32 s27, s27, 32768
  buffer_load_dwordx4 v20, s[8:11], s27 offen lds
  s_add_u32 m0, s28, 34816
  s_add_u32 s27, s27, 32768
  buffer_load_dwordx4 v21, s[8:11], s27 offen lds
  s_add_u32 m0, s28, 35840
  s_add_u32 s27, s27, 32768
  buffer_load_dwordx4 v21, s[8:11], s27 offen lds
  s_add_u32 m0, s28, 36864
  s_add_u32 s27, s27, 32768
  buffer_load_dwordx4 v20, s[8:11], s27 offen lds
  s_add_u32 m0, s28, 37888
  s_add_u32 s27, s27, 32768
  buffer_load_dwordx4 v20, s[8:11], s27 offen lds
  s_add_u32 m0, s28, 38912
  s_add_u32 s27, s27, 32768
  buffer_load_dwordx4 v21, s[8:11], s27 offen lds
  s_add_u32 m0, s28, 39936
  s_add_u32 s27, s27, 32768
  buffer_load_dwordx4 v21, s[8:11], s27 offen lds
  s_add_u32 s27, s26, 2097152
  s_add_u32 m0, s28, 65536
  s_nop 0
  buffer_load_dwordx4 v20, s[8:11], s27 offen lds
  s_add_u32 m0, s28, 66560
  s_add_u32 s27, s27, 32768
  buffer_load_dwordx4 v20, s[8:11], s27 offen lds
  s_add_u32 m0, s28, 67584
  s_add_u32 s27, s27, 32768
  buffer_load_dwordx4 v21, s[8:11], s27 offen lds
  s_add_u32 m0, s28, 68608
  s_add_u32 s27, s27, 32768
  buffer_load_dwordx4 v21, s[8:11], s27 offen lds
  s_add_u32 m0, s28, 69632
  s_add_u32 s27, s27, 32768
  buffer_load_dwordx4 v20, s[8:11], s27 offen lds
  s_add_u32 m0, s28, 70656
  s_add_u32 s27, s27, 32768
  buffer_load_dwordx4 v20, s[8:11], s27 offen lds
  s_add_u32 m0, s28, 71680
  s_add_u32 s27, s27, 32768
  buffer_load_dwordx4 v21, s[8:11], s27 offen lds
  s_add_u32 m0, s28, 72704
  s_add_u32 s27, s27, 32768
  buffer_load_dwordx4 v21, s[8:11], s27 offen lds
  s_load_dwordx2 s[4:5], s[0:1], 112
  s_load_dwordx2 s[12:13], s[0:1], 104
  s_waitcnt vmcnt(16)
  s_barrier
  s_add_u32 s27, s26, 3145728
  s_add_u32 m0, s28, 98304
  s_nop 0
  buffer_load_dwordx4 v20, s[8:11], s27 offen lds
  s_add_u32 m0, s28, 99328
  s_add_u32 s27, s27, 32768
  buffer_load_dwordx4 v20, s[8:11], s27 offen lds
  s_add_u32 m0, s28, 100352
  s_add_u32 s27, s27, 32768
  buffer_load_dwordx4 v21, s[8:11], s27 offen lds
  s_add_u32 m0, s28, 101376
  s_add_u32 s27, s27, 32768
  buffer_load_dwordx4 v21, s[8:11], s27 offen lds
  s_add_u32 m0, s28, 102400
  s_add_u32 s27, s27, 32768
  buffer_load_dwordx4 v20, s[8:11], s27 offen lds
  s_add_u32 m0, s28, 103424
  s_add_u32 s27, s27, 32768
  buffer_load_dwordx4 v20, s[8:11], s27 offen lds
  s_add_u32 m0, s28, 104448
  s_add_u32 s27, s27, 32768
  buffer_load_dwordx4 v21, s[8:11], s27 offen lds
  s_add_u32 m0, s28, 105472
  s_add_u32 s27, s27, 32768
  buffer_load_dwordx4 v21, s[8:11], s27 offen lds
  ds_read_b64_tr_b16 a[128:129], v22 offset:0
  ds_read_b64_tr_b16 a[130:131], v22 offset:1024
  ds_read_b64_tr_b16 a[132:133], v22 offset:4096
  ds_read_b64_tr_b16 a[134:135], v22 offset:5120
  ds_read_b64_tr_b16 a[136:137], v22 offset:8192
  ds_read_b64_tr_b16 a[138:139], v22 offset:9216
  ds_read_b64_tr_b16 a[140:141], v22 offset:12288
  ds_read_b64_tr_b16 a[142:143], v22 offset:13312
  ds_read_b64_tr_b16 a[144:145], v22 offset:16384
  ds_read_b64_tr_b16 a[146:147], v22 offset:17408
  ds_read_b64_tr_b16 a[148:149], v22 offset:20480
  ds_read_b64_tr_b16 a[150:151], v22 offset:21504
  ds_read_b64_tr_b16 a[152:153], v22 offset:24576
  ds_read_b64_tr_b16 a[154:155], v22 offset:25600
  ds_read_b64_tr_b16 a[156:157], v22 offset:28672
  ds_read_b64_tr_b16 a[158:159], v22 offset:29696
  s_waitcnt lgkmcnt(0)
  s_waitcnt vmcnt(16)
  s_barrier
  s_add_u32 s27, s26, 0
  s_add_u32 m0, s28, 131072
  s_nop 0
  buffer_load_dwordx4 v20, s[64:67], s27 offen lds
  s_add_u32 m0, s28, 132096
  s_add_u32 s27, s27, 32768
  buffer_load_dwordx4 v20, s[64:67], s27 offen lds
  s_add_u32 m0, s28, 133120
  s_add_u32 s27, s27, 32768
  buffer_load_dwordx4 v21, s[64:67], s27 offen lds
  s_add_u32 m0, s28, 134144
  s_add_u32 s27, s27, 32768
  buffer_load_dwordx4 v21, s[64:67], s27 offen lds
  s_add_u32 m0, s28, 135168
  s_add_u32 s27, s27, 32768
  buffer_load_dwordx4 v20, s[64:67], s27 offen lds
  s_add_u32 m0, s28, 136192
  s_add_u32 s27, s27, 32768
  buffer_load_dwordx4 v20, s[64:67], s27 offen lds
  s_add_u32 m0, s28, 137216
  s_add_u32 s27, s27, 32768
  buffer_load_dwordx4 v21, s[64:67], s27 offen lds
  s_add_u32 m0, s28, 138240
  s_add_u32 s27, s27, 32768
  buffer_load_dwordx4 v21, s[64:67], s27 offen lds
  ds_read_b64_tr_b16 a[160:161], v22 offset:32768
  ds_read_b64_tr_b16 a[162:163], v22 offset:33792
  ds_read_b64_tr_b16 a[164:165], v22 offset:36864
  ds_read_b64_tr_b16 a[166:167], v22 offset:37888
  ds_read_b64_tr_b16 a[168:169], v22 offset:40960
  ds_read_b64_tr_b16 a[170:171], v22 offset:41984
  ds_read_b64_tr_b16 a[172:173], v22 offset:45056
  ds_read_b64_tr_b16 a[174:175], v22 offset:46080
  ds_read_b64_tr_b16 a[176:177], v22 offset:49152
  ds_read_b64_tr_b16 a[178:179], v22 offset:50176
  ds_read_b64_tr_b16 a[180:181], v22 offset:53248
  ds_read_b64_tr_b16 a[182:183], v22 offset:54272
  ds_read_b64_tr_b16 a[184:185], v22 offset:57344
  ds_read_b64_tr_b16 a[186:187], v22 offset:58368
  ds_read_b64_tr_b16 a[188:189], v22 offset:61440
  ds_read_b64_tr_b16 a[190:191], v22 offset:62464
  s_waitcnt lgkmcnt(0)
  s_waitcnt vmcnt(16)
  s_barrier
  s_add_u32 s27, s26, 1048576
  s_add_u32 m0, s28, 0
  s_nop 0
  buffer_load_dwordx4 v20, s[64:67], s27 offen lds
  s_add_u32 m0, s28, 1024
  s_add_u32 s27, s27, 32768
  buffer_load_dwordx4 v20, s[64:67], s27 offen lds
  s_add_u32 m0, s28, 2048
  s_add_u32 s27, s27, 32768
  buffer_load_dwordx4 v21, s[64:67], s27 offen lds
  s_add_u32 m0, s28, 3072
  s_add_u32 s27, s27, 32768
  buffer_load_dwordx4 v21, s[64:67], s27 offen lds
  s_add_u32 m0, s28, 4096
  s_add_u32 s27, s27, 32768
  buffer_load_dwordx4 v20, s[64:67], s27 offen lds
  s_add_u32 m0, s28, 5120
  s_add_u32 s27, s27, 32768
  buffer_load_dwordx4 v20, s[64:67], s27 offen lds
  s_add_u32 m0, s28, 6144
  s_add_u32 s27, s27, 32768
  buffer_load_dwordx4 v21, s[64:67], s27 offen lds
  s_add_u32 m0, s28, 7168
  s_add_u32 s27, s27, 32768
  buffer_load_dwordx4 v21, s[64:67], s27 offen lds
  ds_read_b64_tr_b16 a[192:193], v23 offset:0
  ds_read_b64_tr_b16 a[194:195], v23 offset:1024
  ds_read_b64_tr_b16 a[196:197], v23 offset:4096
  ds_read_b64_tr_b16 a[198:199], v23 offset:5120
  ds_read_b64_tr_b16 a[200:201], v23 offset:8192
  ds_read_b64_tr_b16 a[202:203], v23 offset:9216
  ds_read_b64_tr_b16 a[204:205], v23 offset:12288
  ds_read_b64_tr_b16 a[206:207], v23 offset:13312
  ds_read_b64_tr_b16 a[208:209], v23 offset:16384
  ds_read_b64_tr_b16 a[210:211], v23 offset:17408
  ds_read_b64_tr_b16 a[212:213], v23 offset:20480
  ds_read_b64_tr_b16 a[214:215], v23 offset:21504
  ds_read_b64_tr_b16 a[216:217], v23 offset:24576
  ds_read_b64_tr_b16 a[218:219], v23 offset:25600
  ds_read_b64_tr_b16 a[220:221], v23 offset:28672
  ds_read_b64_tr_b16 a[222:223], v23 offset:29696
  s_waitcnt lgkmcnt(0)
  s_waitcnt vmcnt(16)
  s_barrier
  s_add_u32 s27, s26, 2097152
  s_add_u32 m0, s28, 32768
  s_nop 0
  buffer_load_dwordx4 v20, s[64:67], s27 offen lds
  s_add_u32 m0, s28, 33792
  s_add_u32 s27, s27, 32768
  buffer_load_dwordx4 v20, s[64:67], s27 offen lds
  s_add_u32 m0, s28, 34816
  s_add_u32 s27, s27, 32768
  buffer_load_dwordx4 v21, s[64:67], s27 offen lds
  s_add_u32 m0, s28, 35840
  s_add_u32 s27, s27, 32768
  buffer_load_dwordx4 v21, s[64:67], s27 offen lds
  s_add_u32 m0, s28, 36864
  s_add_u32 s27, s27, 32768
  buffer_load_dwordx4 v20, s[64:67], s27 offen lds
  s_add_u32 m0, s28, 37888
  s_add_u32 s27, s27, 32768
  buffer_load_dwordx4 v20, s[64:67], s27 offen lds
  s_add_u32 m0, s28, 38912
  s_add_u32 s27, s27, 32768
  buffer_load_dwordx4 v21, s[64:67], s27 offen lds
  s_add_u32 m0, s28, 39936
  s_add_u32 s27, s27, 32768
  buffer_load_dwordx4 v21, s[64:67], s27 offen lds
  ds_read_b64_tr_b16 a[224:225], v23 offset:32768
  ds_read_b64_tr_b16 a[226:227], v23 offset:33792
  ds_read_b64_tr_b16 a[228:229], v23 offset:36864
  ds_read_b64_tr_b16 a[230:231], v23 offset:37888
  ds_read_b64_tr_b16 a[232:233], v23 offset:40960
  ds_read_b64_tr_b16 a[234:235], v23 offset:41984
  ds_read_b64_tr_b16 a[236:237], v23 offset:45056
  ds_read_b64_tr_b16 a[238:239], v23 offset:46080
  ds_read_b64_tr_b16 a[240:241], v23 offset:49152
  ds_read_b64_tr_b16 a[242:243], v23 offset:50176
  ds_read_b64_tr_b16 a[244:245], v23 offset:53248
  ds_read_b64_tr_b16 a[246:247], v23 offset:54272
  ds_read_b64_tr_b16 a[248:249], v23 offset:57344
  ds_read_b64_tr_b16 a[250:251], v23 offset:58368
  ds_read_b64_tr_b16 a[252:253], v23 offset:61440
  ds_read_b64_tr_b16 a[254:255], v23 offset:62464
  s_waitcnt lgkmcnt(0)
  s_waitcnt vmcnt(16)
  s_barrier
  s_add_u32 s27, s26, 3145728
  s_add_u32 m0, s28, 65536
  s_nop 0
  buffer_load_dwordx4 v20, s[64:67], s27 offen lds
  s_add_u32 m0, s28, 66560
  s_add_u32 s27, s27, 32768
  buffer_load_dwordx4 v20, s[64:67], s27 offen lds
  s_add_u32 m0, s28, 67584
  s_add_u32 s27, s27, 32768
  buffer_load_dwordx4 v21, s[64:67], s27 offen lds
  s_add_u32 m0, s28, 68608
  s_add_u32 s27, s27, 32768
  buffer_load_dwordx4 v21, s[64:67], s27 offen lds
  s_add_u32 m0, s28, 69632
  s_add_u32 s27, s27, 32768
  buffer_load_dwordx4 v20, s[64:67], s27 offen lds
  s_add_u32 m0, s28, 70656
  s_add_u32 s27, s27, 32768
  buffer_load_dwordx4 v20, s[64:67], s27 offen lds
  s_add_u32 m0, s28, 71680
  s_add_u32 s27, s27, 32768
  buffer_load_dwordx4 v21, s[64:67], s27 offen lds
  s_add_u32 m0, s28, 72704
  s_add_u32 s27, s27, 32768
  buffer_load_dwordx4 v21, s[64:67], s27 offen lds
  ds_read_b64_tr_b16 v[128:129], v24 offset:0
  ds_read_b64_tr_b16 v[130:131], v24 offset:1024
  ds_read_b64_tr_b16 v[132:133], v24 offset:4096
  ds_read_b64_tr_b16 v[134:135], v24 offset:5120
  ds_read_b64_tr_b16 v[136:137], v24 offset:8192
  ds_read_b64_tr_b16 v[138:139], v24 offset:9216
  ds_read_b64_tr_b16 v[140:141], v24 offset:12288
  ds_read_b64_tr_b16 v[142:143], v24 offset:13312
  ds_read_b64_tr_b16 v[144:145], v24 offset:16384
  ds_read_b64_tr_b16 v[146:147], v24 offset:17408
  ds_read_b64_tr_b16 v[148:149], v24 offset:20480
  ds_read_b64_tr_b16 v[150:151], v24 offset:21504
  ds_read_b64_tr_b16 v[152:153], v24 offset:24576
  ds_read_b64_tr_b16 v[154:155], v24 offset:25600
  ds_read_b64_tr_b16 v[156:157], v24 offset:28672
  ds_read_b64_tr_b16 v[158:159], v24 offset:29696
  s_waitcnt lgkmcnt(0)
  s_waitcnt vmcnt(16)
  s_barrier
  s_add_u32 s27, s26, 0
  s_add_u32 m0, s28, 98304
  s_nop 0
  buffer_load_dwordx4 v20, s[68:71], s27 offen lds
  s_add_u32 m0, s28, 99328
  s_add_u32 s27, s27, 32768
  buffer_load_dwordx4 v20, s[68:71], s27 offen lds
  s_add_u32 m0, s28, 100352
  s_add_u32 s27, s27, 32768
  buffer_load_dwordx4 v21, s[68:71], s27 offen lds
  s_add_u32 m0, s28, 101376
  s_add_u32 s27, s27, 32768
  buffer_load_dwordx4 v21, s[68:71], s27 offen lds
  s_add_u32 m0, s28, 102400
  s_add_u32 s27, s27, 32768
  buffer_load_dwordx4 v20, s[68:71], s27 offen lds
  s_add_u32 m0, s28, 103424
  s_add_u32 s27, s27, 32768
  buffer_load_dwordx4 v20, s[68:71], s27 offen lds
  s_add_u32 m0, s28, 104448
  s_add_u32 s27, s27, 32768
  buffer_load_dwordx4 v21, s[68:71], s27 offen lds
  s_add_u32 m0, s28, 105472
  s_add_u32 s27, s27, 32768
  buffer_load_dwordx4 v21, s[68:71], s27 offen lds
  ds_read_b64_tr_b16 v[160:161], v22 offset:0
  ds_read_b64_tr_b16 v[162:163], v22 offset:1024
  ds_read_b64_tr_b16 v[164:165], v22 offset:4096
  ds_read_b64_tr_b16 v[166:167], v22 offset:5120
  ds_read_b64_tr_b16 v[168:169], v22 offset:8192
  ds_read_b64_tr_b16 v[170:171], v22 offset:9216
  ds_read_b64_tr_b16 v[172:173], v22 offset:12288
  ds_read_b64_tr_b16 v[174:175], v22 offset:13312
  ds_read_b64_tr_b16 v[176:177], v22 offset:16384
  ds_read_b64_tr_b16 v[178:179], v22 offset:17408
  ds_read_b64_tr_b16 v[180:181], v22 offset:20480
  ds_read_b64_tr_b16 v[182:183], v22 offset:21504
  ds_read_b64_tr_b16 v[184:185], v22 offset:24576
  ds_read_b64_tr_b16 v[186:187], v22 offset:25600
  ds_read_b64_tr_b16 v[188:189], v22 offset:28672
  ds_read_b64_tr_b16 v[190:191], v22 offset:29696
  s_waitcnt lgkmcnt(0)
  s_waitcnt vmcnt(16)
  s_barrier
  s_add_u32 s27, s26, 1048576
  s_add_u32 m0, s28, 131072
  s_nop 0
  buffer_load_dwordx4 v20, s[68:71], s27 offen lds
  s_add_u32 m0, s28, 132096
  s_add_u32 s27, s27, 32768
  buffer_load_dwordx4 v20, s[68:71], s27 offen lds
  s_add_u32 m0, s28, 133120
  s_add_u32 s27, s27, 32768
  buffer_load_dwordx4 v21, s[68:71], s27 offen lds
  s_add_u32 m0, s28, 134144
  s_add_u32 s27, s27, 32768
  buffer_load_dwordx4 v21, s[68:71], s27 offen lds
  s_add_u32 m0, s28, 135168
  s_add_u32 s27, s27, 32768
  buffer_load_dwordx4 v20, s[68:71], s27 offen lds
  s_add_u32 m0, s28, 136192
  s_add_u32 s27, s27, 32768
  buffer_load_dwordx4 v20, s[68:71], s27 offen lds
  s_add_u32 m0, s28, 137216
  s_add_u32 s27, s27, 32768
  buffer_load_dwordx4 v21, s[68:71], s27 offen lds
  s_add_u32 m0, s28, 138240
  s_add_u32 s27, s27, 32768
  buffer_load_dwordx4 v21, s[68:71], s27 offen lds
  ds_read_b64_tr_b16 v[192:193], v22 offset:32768
  ds_read_b64_tr_b16 v[194:195], v22 offset:33792
  ds_read_b64_tr_b16 v[196:197], v22 offset:36864
  ds_read_b64_tr_b16 v[198:199], v22 offset:37888
  ds_read_b64_tr_b16 v[200:201], v22 offset:40960
  ds_read_b64_tr_b16 v[202:203], v22 offset:41984
  ds_read_b64_tr_b16 v[204:205], v22 offset:45056
  ds_read_b64_tr_b16 v[206:207], v22 offset:46080
  ds_read_b64_tr_b16 v[208:209], v22 offset:49152
  ds_read_b64_tr_b16 v[210:211], v22 offset:50176
  ds_read_b64_tr_b16 v[212:213], v22 offset:53248
  ds_read_b64_tr_b16 v[214:215], v22 offset:54272
  ds_read_b64_tr_b16 v[216:217], v22 offset:57344
  ds_read_b64_tr_b16 v[218:219], v22 offset:58368
  ds_read_b64_tr_b16 v[220:221], v22 offset:61440
  ds_read_b64_tr_b16 v[222:223], v22 offset:62464
  s_waitcnt lgkmcnt(0)
  s_waitcnt vmcnt(16)
  s_barrier
  s_add_u32 s27, s26, 2097152
  s_add_u32 m0, s28, 0
  s_nop 0
  buffer_load_dwordx4 v20, s[68:71], s27 offen lds
  s_add_u32 m0, s28, 1024
  s_add_u32 s27, s27, 32768
  buffer_load_dwordx4 v20, s[68:71], s27 offen lds
  s_add_u32 m0, s28, 2048
  s_add_u32 s27, s27, 32768
  buffer_load_dwordx4 v21, s[68:71], s27 offen lds
  s_add_u32 m0, s28, 3072
  s_add_u32 s27, s27, 32768
  buffer_load_dwordx4 v21, s[68:71], s27 offen lds
  s_add_u32 m0, s28, 4096
  s_add_u32 s27, s27, 32768
  buffer_load_dwordx4 v20, s[68:71], s27 offen lds
  s_add_u32 m0, s28, 5120
  s_add_u32 s27, s27, 32768
  buffer_load_dwordx4 v20, s[68:71], s27 offen lds
  s_add_u32 m0, s28, 6144
  s_add_u32 s27, s27, 32768
  buffer_load_dwordx4 v21, s[68:71], s27 offen lds
  s_add_u32 m0, s28, 7168
  s_add_u32 s27, s27, 32768
  buffer_load_dwordx4 v21, s[68:71], s27 offen lds
  ds_read_b64_tr_b16 v[224:225], v23 offset:0
  ds_read_b64_tr_b16 v[226:227], v23 offset:1024
  ds_read_b64_tr_b16 v[228:229], v23 offset:4096
  ds_read_b64_tr_b16 v[230:231], v23 offset:5120
  ds_read_b64_tr_b16 v[232:233], v23 offset:8192
  ds_read_b64_tr_b16 v[234:235], v23 offset:9216
  ds_read_b64_tr_b16 v[236:237], v23 offset:12288
  ds_read_b64_tr_b16 v[238:239], v23 offset:13312
  ds_read_b64_tr_b16 v[240:241], v23 offset:16384
  ds_read_b64_tr_b16 v[242:243], v23 offset:17408
  ds_read_b64_tr_b16 v[244:245], v23 offset:20480
  ds_read_b64_tr_b16 v[246:247], v23 offset:21504
  ds_read_b64_tr_b16 v[248:249], v23 offset:24576
  ds_read_b64_tr_b16 v[250:251], v23 offset:25600
  ds_read_b64_tr_b16 v[252:253], v23 offset:28672
  ds_read_b64_tr_b16 v[254:255], v23 offset:29696
  s_waitcnt lgkmcnt(0)
  s_waitcnt vmcnt(16)
  s_barrier
  s_add_u32 s27, s26, 3145728
  s_add_u32 m0, s28, 32768
  s_nop 0
  buffer_load_dwordx4 v20, s[68:71], s27 offen lds
  s_add_u32 m0, s28, 33792
  s_add_u32 s27, s27, 32768
  buffer_load_dwordx4 v20, s[68:71], s27 offen lds
  s_add_u32 m0, s28, 34816
  s_add_u32 s27, s27, 32768
  buffer_load_dwordx4 v21, s[68:71], s27 offen lds
  s_add_u32 m0, s28, 35840
  s_add_u32 s27, s27, 32768
  buffer_load_dwordx4 v21, s[68:71], s27 offen lds
  s_add_u32 m0, s28, 36864
  s_add_u32 s27, s27, 32768
  buffer_load_dwordx4 v20, s[68:71], s27 offen lds
  s_add_u32 m0, s28, 37888
  s_add_u32 s27, s27, 32768
  buffer_load_dwordx4 v20, s[68:71], s27 offen lds
  s_add_u32 m0, s28, 38912
  s_add_u32 s27, s27, 32768
  buffer_load_dwordx4 v21, s[68:71], s27 offen lds
  s_add_u32 m0, s28, 39936
  s_add_u32 s27, s27, 32768
  buffer_load_dwordx4 v21, s[68:71], s27 offen lds
  ds_read_b64_tr_b16 a[0:1], v23 offset:32768
  ds_read_b64_tr_b16 a[2:3], v23 offset:33792
  ds_read_b64_tr_b16 a[4:5], v23 offset:36864
  ds_read_b64_tr_b16 a[6:7], v23 offset:37888
  ds_read_b64_tr_b16 a[8:9], v23 offset:40960
  ds_read_b64_tr_b16 a[10:11], v23 offset:41984
  ds_read_b64_tr_b16 a[12:13], v23 offset:45056
  ds_read_b64_tr_b16 a[14:15], v23 offset:46080
  ds_read_b64_tr_b16 a[16:17], v23 offset:49152
  ds_read_b64_tr_b16 a[18:19], v23 offset:50176
  ds_read_b64_tr_b16 a[20:21], v23 offset:53248
  ds_read_b64_tr_b16 a[22:23], v23 offset:54272
  ds_read_b64_tr_b16 a[24:25], v23 offset:57344
  ds_read_b64_tr_b16 a[26:27], v23 offset:58368
  ds_read_b64_tr_b16 a[28:29], v23 offset:61440
  ds_read_b64_tr_b16 a[30:31], v23 offset:62464
  s_waitcnt lgkmcnt(0)
  s_waitcnt vmcnt(16)
  s_barrier
  ds_read_b64_tr_b16 a[32:33], v24 offset:0
  ds_read_b64_tr_b16 a[34:35], v24 offset:1024
  ds_read_b64_tr_b16 a[36:37], v24 offset:4096
  ds_read_b64_tr_b16 a[38:39], v24 offset:5120
  ds_read_b64_tr_b16 a[40:41], v24 offset:8192
  ds_read_b64_tr_b16 a[42:43], v24 offset:9216
  ds_read_b64_tr_b16 a[44:45], v24 offset:12288
  ds_read_b64_tr_b16 a[46:47], v24 offset:13312
  ds_read_b64_tr_b16 a[48:49], v24 offset:16384
  ds_read_b64_tr_b16 a[50:51], v24 offset:17408
  ds_read_b64_tr_b16 a[52:53], v24 offset:20480
  ds_read_b64_tr_b16 a[54:55], v24 offset:21504
  ds_read_b64_tr_b16 a[56:57], v24 offset:24576
  ds_read_b64_tr_b16 a[58:59], v24 offset:25600
  ds_read_b64_tr_b16 a[60:61], v24 offset:28672
  ds_read_b64_tr_b16 a[62:63], v24 offset:29696
  s_waitcnt lgkmcnt(0)
  s_waitcnt vmcnt(8)
  s_barrier
  ds_read_b64_tr_b16 a[64:65], v22 offset:0
  ds_read_b64_tr_b16 a[66:67], v22 offset:1024
  ds_read_b64_tr_b16 a[68:69], v22 offset:4096
  ds_read_b64_tr_b16 a[70:71], v22 offset:5120
  ds_read_b64_tr_b16 a[72:73], v22 offset:8192
  ds_read_b64_tr_b16 a[74:75], v22 offset:9216
  ds_read_b64_tr_b16 a[76:77], v22 offset:12288
  ds_read_b64_tr_b16 a[78:79], v22 offset:13312
  ds_read_b64_tr_b16 a[80:81], v22 offset:16384
  ds_read_b64_tr_b16 a[82:83], v22 offset:17408
  ds_read_b64_tr_b16 a[84:85], v22 offset:20480
  ds_read_b64_tr_b16 a[86:87], v22 offset:21504
  ds_read_b64_tr_b16 a[88:89], v22 offset:24576
  ds_read_b64_tr_b16 a[90:91], v22 offset:25600
  ds_read_b64_tr_b16 a[92:93], v22 offset:28672
  ds_read_b64_tr_b16 a[94:95], v22 offset:29696
  s_waitcnt lgkmcnt(0)
  s_waitcnt vmcnt(0)
  s_barrier
  ds_read_b64_tr_b16 a[96:97], v22 offset:32768
  ds_read_b64_tr_b16 a[98:99], v22 offset:33792
  ds_read_b64_tr_b16 a[100:101], v22 offset:36864
  ds_read_b64_tr_b16 a[102:103], v22 offset:37888
  ds_read_b64_tr_b16 a[104:105], v22 offset:40960
  ds_read_b64_tr_b16 a[106:107], v22 offset:41984
  ds_read_b64_tr_b16 a[108:109], v22 offset:45056
  ds_read_b64_tr_b16 a[110:111], v22 offset:46080
  ds_read_b64_tr_b16 a[112:113], v22 offset:49152
  ds_read_b64_tr_b16 a[114:115], v22 offset:50176
  ds_read_b64_tr_b16 a[116:117], v22 offset:53248
  ds_read_b64_tr_b16 a[118:119], v22 offset:54272
  ds_read_b64_tr_b16 a[120:121], v22 offset:57344
  ds_read_b64_tr_b16 a[122:123], v22 offset:58368
  ds_read_b64_tr_b16 a[124:125], v22 offset:61440
  ds_read_b64_tr_b16 a[126:127], v22 offset:62464
  s_waitcnt lgkmcnt(0)
q_ld_84:
  s_waitcnt lgkmcnt(0)
  s_barrier
  v_mbcnt_lo_u32_b32 v20, -1, 0
  v_and_b32 v20, 0, v20
  v_add_lshl_u32 v20, v20, 1, 2
  s_mov_b32 s26, 0
g_wt_85:
  global_load_dword v21, v20, s[12:13] offset:128 sc1
  s_add_u32 s26, s26, 1
  s_cmp_gt_u32 s26, 1048576
  s_cbranch_scc1 L_end
  s_waitcnt vmcnt(0)
  v_cmp_eq_u32 vcc, 0, v21
  v_readfirstlane_b32 s27, v21
  s_cbranch_vccnz g_wt_85
  v_lshrrev_b32 v7, 7, v0
  v_lshlrev_b32 v7, 12, v7
  v_and_b32 v2, 1023, v9
  s_lshl_b32 s26, s17, 10
  v_add3_u32 v7, v7, v2, s26
  v_mov_b32 v116, 0
  s_mov_b32 s47, s60
  s_add_u32 s76, s60, 3
  s_add_u32 s41, s60, 64
  s_mov_b32 s40, 18
  s_mov_b32 s42, 0
  s_mov_b32 s48, 0
  s_mov_b32 s49, 268435456
  s_mov_b32 s43, 268435456
  s_mov_b32 s50, 32768
  s_mov_b32 s56, 1
  s_mov_b32 s61, 0
  s_mov_b32 s62, 0
  s_lshl_b32 s54, s17, 13
  s_mov_b32 s50, 0
  v_mov_b32 v4, 1
q_slow_86:
  s_nop 1
  s_nop 7
  v_cvt_pk_bf16_f32 v100, v52, v53
  v_cvt_pk_bf16_f32 v101, v54, v55
  v_cvt_pk_bf16_f32 v102, v60, v61
  v_cvt_pk_bf16_f32 v103, v62, v63
  v_cvt_pk_bf16_f32 v104, v56, v57
  v_cvt_pk_bf16_f32 v105, v58, v59
  v_cvt_pk_bf16_f32 v106, v64, v65
  v_cvt_pk_bf16_f32 v107, v66, v67
  s_waitcnt vmcnt(0)
  s_mov_b64 exec, 1
  buffer_store_dword v4, off, s[4:7], s49 sc1
  s_mov_b64 exec, -1
  buffer_store_dwordx4 v[100:103], v8, s[4:7], s43 offen offset:0 sc1
  buffer_store_dwordx4 v[104:107], v8, s[4:7], s43 offen offset:512 sc1
  s_mov_b32 s43, 268435456
  s_xor_b32 s50, s50, 32768
q_nxt_96:
  s_cmp_ge_u32 s47, 128
  s_cbranch_scc1 q_end_87
  s_cmp_lg_u32 s48, 0
  s_cbranch_scc1 q_have_88
  s_mov_b32 s53, 0
q_poll_89:
  s_cmp_lt_u32 s47, 64
  s_cselect_b32 s26, 2, 0
  s_add_u32 s26, s26, s47
  s_lshl_b32 s26, s26, 12
  s_add_u32 s26, s26, 243261440
  s_mov_b64 exec, 0xffffff
  buffer_load_dword v116, v7, s[4:7], s26 offen sc1
  s_mov_b64 exec, -1
  s_add_u32 s53, s53, 1
  s_cmp_gt_u32 s53, 1048576
  s_cbranch_scc1 q_fail_90
  s_waitcnt vmcnt(0)
  s_mov_b64 exec, 3
  buffer_store_dword v4, v0, s[4:7], s49 offen sc1
  s_mov_b64 exec, -1
  s_mov_b32 s49, 268435456
  v_cmp_eq_u32 vcc, 0, v116
  s_nop 0
  s_and_b32 s26, vcc_lo, 0xffffff
  s_cbranch_scc1 q_poll_89
  s_and_b32 s63, s47, 127
  s_lshl_b32 s63, s63, 15
  s_xor_b32 s27, s50, 32768
  s_add_u32 m0, s27, s54
  s_add_u32 s63, s63, s54
  s_add_u32 s63, s63, 6291456
  buffer_load_dwordx4 v12, s[4:7], s63 offen offset:0 sc1 lds
  buffer_load_dwordx4 v13, s[4:7], s63 offen offset:1024 sc1 lds
  buffer_load_dwordx4 v14, s[4:7], s63 offen offset:2048 sc1 lds
  buffer_load_dwordx4 v15, s[4:7], s63 offen offset:3072 sc1 lds
  s_add_u32 m0, m0, 4096
  s_add_u32 s63, s63, 4096
  buffer_load_dwordx4 v16, s[4:7], s63 offen offset:0 sc1 lds
  buffer_load_dwordx4 v17, s[4:7], s63 offen offset:1024 sc1 lds
  buffer_load_dwordx4 v18, s[4:7], s63 offen offset:2048 sc1 lds
  buffer_load_dwordx4 v19, s[4:7], s63 offen offset:3072 sc1 lds
  v_cmp_eq_u32 vcc, 0, v116
  v_max_u32_dpp v117, v116, v116 quad_perm:[1,0,3,2] row_mask:0xf bank_mask:0xf
  s_and_b32 s48, vcc_lo, 0xffffff
  s_cselect_b32 s48, 0, -1
  v_max_u32_dpp v117, v117, v117 quad_perm:[2,3,0,1] row_mask:0xf bank_mask:0xf
  s_nop 1
  v_max_u32_dpp v117, v117, v117 row_half_mirror row_mask:0xf bank_mask:0xf
  v_and_b32 v117, s48, v117
q_have_88:
  ds_write_b32 v118, v117 offset:256
  s_xor_b32 s50, s50, 32768
  s_waitcnt lgkmcnt(0)
  s_barrier
  ds_read_b128 v[108:111], v119 offset:256
  s_cmp_lt_u32 s47, 64
  s_cbranch_scc1 q_nopre_92
  s_waitcnt lgkmcnt(0)
  v_min3_u32 v112, v108, v109, v110
  v_max3_u32 v108, v108, v109, v110
  v_min_u32 v112, v112, v111
  v_max_u32 v108, v108, v111
  v_readfirstlane_b32 s45, v112
  v_readlane_b32 s28, v108, 0
  v_readlane_b32 s29, v108, 1
  v_readlane_b32 s30, v108, 2
  s_cmp_gt_u32 s28, s56
  s_addc_u32 s42, s42, s42
  s_max_u32 s56, s56, s28
  s_and_b32 s26, s42, 1
  s_cselect_b32 s26, s40, 0
  s_cmp_gt_u32 s26, 10
  s_subb_u32 s40, s40, 0
  s_cmp_gt_u32 s29, s56
  s_addc_u32 s42, s42, s42
  s_max_u32 s56, s56, s29
  s_and_b32 s26, s42, 1
  s_cselect_b32 s26, s40, 0
  s_cmp_gt_u32 s26, 10
  s_subb_u32 s40, s40, 0
  s_cmp_gt_u32 s30, s56
  s_addc_u32 s42, s42, s42
  s_max_u32 s56, s56, s30
  s_add_u32 s76, s47, s40
  s_add_u32 s41, s47, 3
  s_sub_u32 s76, s76, 64
  s_and_b32 s26, s42, 1
  s_cselect_b32 s26, s40, 0
  s_cmp_gt_u32 s26, 10
  s_cselect_b32 s76, 64, s76
  s_subb_u32 s40, s40, 0
  s_cmp_lt_u32 s76, 64
  s_cselect_b32 s76, s76, s41
  s_bitcmp1_b32 s42, 0
  s_cbranch_scc1 q_fork_93
q_nopre_92:
  s_waitcnt vmcnt(0)
  s_sub_u32 s26, s47, s60
  s_cmp_lg_u32 s26, 15
  s_cbranch_scc1 q_cold_94
  v_mbcnt_lo_u32_b32 v20, -1, 0
  v_and_b32 v20, 0, v20
  v_add_lshl_u32 v20, v20, 2, 2
  s_mov_b32 s26, 0
g_wt_101:
  global_load_dword v21, v20, s[12:13] offset:128 sc1
  s_add_u32 s26, s26, 1
  s_cmp_gt_u32 s26, 1048576
  s_cbranch_scc1 L_end
  s_waitcnt vmcnt(0)
  v_cmp_eq_u32 vcc, 0, v21
  v_readfirstlane_b32 s27, v21
  s_cbranch_vccnz g_wt_101
  s_load_dwordx2 s[64:65], s[0:1], 72
  s_load_dwordx2 s[68:69], s[0:1], 80
  s_load_dwordx2 s[8:9], s[0:1], 88
  s_mov_b32 s66, 1835008
  s_mov_b32 s70, 1835008
  s_mov_b32 s10, 1835008
  v_lshrrev_b32 v2, 7, v0
  v_and_b32 v3, 0x70, v0
  v_mul_u32_u24 v6, 57344, v2
  v_add_u32 v6, v6, v3
  v_cmp_eq_u32 vcc, 0x70, v3
  v_mov_b32 v3, 0x7ff00000
  s_nop 0
  v_cndmask_b32 v6, v6, v3, vcc
  v_lshrrev_b32 v2, 8, v0
  v_mul_u32_u24 v7, 14336, v2
  v_and_b32 v3, 0xf0, v0
  v_add_u32 v7, v7, v3
  s_mul_i32 s34, s17, 458752
  s_mul_i32 s27, s16, 112
  s_add_u32 s34, s34, s27
  s_mul_i32 s35, s16, 57344
  s_lshl_b32 s27, s17, 8
  s_add_u32 s35, s35, s27
  s_waitcnt lgkmcnt(0)
  s_mul_i32 s26, s17, 23552
  s_add_u32 m0, s26, 65536
  s_add_u32 s36, s34, 0
  buffer_load_dwordx4 v6, s[64:67], s36 offen lds
  s_add_u32 m0, m0, 1024
  s_add_u32 s36, s34, 0
  buffer_load_dwordx4 v6, s[68:71], s36 offen lds
  s_add_u32 m0, m0, 1024
  s_add_u32 s36, s34, 3584
  buffer_load_dwordx4 v6, s[64:67], s36 offen lds
  s_add_u32 m0, m0, 1024
  s_add_u32 s36, s34, 3584
  buffer_load_dwordx4 v6, s[68:71], s36 offen lds
  s_add_u32 m0, m0, 1024
  s_add_u32 s36, s34, 7168
  buffer_load_dwordx4 v6, s[64:67], s36 offen lds
  s_add_u32 m0, m0, 1024
  s_add_u32 s36, s34, 7168
  buffer_load_dwordx4 v6, s[68:71], s36 offen lds
  s_add_u32 m0, m0, 1024
  s_add_u32 s36, s34, 10752
  buffer_load_dwordx4 v6, s[64:67], s36 offen lds
  s_add_u32 m0, m0, 1024
  s_add_u32 s36, s34, 10752
  buffer_load_dwordx4 v6, s[68:71], s36 offen lds
  s_add_u32 m0, m0, 1024
  s_add_u32 s36, s34, 14336
  buffer_load_dwordx4 v6, s[64:67], s36 offen lds
  s_add_u32 m0, m0, 1024
  s_add_u32 s36, s34, 14336
  buffer_load_dwordx4 v6, s[68:71], s36 offen lds
  s_add_u32 m0, m0, 1024
  s_add_u32 s36, s34, 17920
  buffer_load_dwordx4 v6, s[64:67], s36 offen lds
  s_add_u32 m0, m0, 1024
  s_add_u32 s36, s34, 17920
  buffer_load_dwordx4 v6, s[68:71], s36 offen lds
  s_add_u32 m0, m0, 1024
  s_add_u32 s36, s34, 21504
  buffer_load_dwordx4 v6, s[64:67], s36 offen lds
  s_add_u32 m0, m0, 1024
  s_add_u32 s36, s34, 21504
  buffer_load_dwordx4 v6, s[68:71], s36 offen lds
  s_add_u32 m0, m0, 1024
  s_add_u32 s36, s34, 25088
  buffer_load_dwordx4 v6, s[64:67], s36 offen lds
  s_add_u32 m0, m0, 1024
  s_add_u32 s36, s34, 25088
  buffer_load_dwordx4 v6, s[68:71], s36 offen lds
  s_add_u32 m0, m0, 1024
  s_add_u32 s36, s34, 28672
  buffer_load_dwordx4 v6, s[64:67], s36 offen lds
  s_add_u32 m0, m0, 1024
  s_add_u32 s36, s34, 28672
  buffer_load_dwordx4 v6, s[68:71], s36 offen lds
  s_add_u32 m0, m0, 1024
  s_add_u32 s36, s34, 32256
  buffer_load_dwordx4 v6, s[64:67], s36 offen lds
  s_add_u32 m0, m0, 1024
  s_add_u32 s36, s34, 32256
  buffer_load_dwordx4 v6, s[68:71], s36 offen lds
  s_add_u32 m0, m0, 1024
  s_add_u32 s36, s34, 35840
  buffer_load_dwordx4 v6, s[64:67], s36 offen lds
  s_add_u32 m0, m0, 1024
  s_add_u32 s36, s34, 35840
  buffer_load_dwordx4 v6, s[68:71], s36 offen lds
  s_add_u32 m0, m0, 1024
  s_add_u32 s36, s34, 39424
  buffer_load_dwordx4 v6, s[64:67], s36 offen lds
  s_add_u32 m0, m0, 1024
  v_lshrrev_b32 v7, 7, v0
  v_lshlrev_b32 v7, 12, v7
  v_and_b32 v2, 1023, v9
  s_lshl_b32 s26, s17, 10
  v_add3_u32 v7, v7, v2, s26
  v_mov_b32 v116, 0
q_cold_94:
  s_waitcnt lgkmcnt(0)
  s_barrier
  s_cmp_lg_u32 s50, 0
  s_cbranch_scc1 q_c1_98
q_c0_97:
  ds_read_b128 v[68:71], v120 offset:0
  ds_read_b128 v[72:75], v121 offset:0
  ds_read_b128 v[76:79], v122 offset:0
q_w0_99:
  s_waitcnt lgkmcnt(2)
  v_mfma_f32_32x32x16_bf16 v[20:35], v[128:131], v[68:71], 0
  ds_read_b128 v[80:83], v123 offset:0
  s_mov_b32 s46, s47
  s_mov_b32 s47, s76
  s_lshl_b32 s52, s46, 7
  s_add_u32 s52, s52, s57
  v_mfma_f32_32x32x16_bf16 v[36:51], v[68:71], a[0:3], 0
  s_waitcnt vmcnt(0)
  s_mov_b64 exec, 1
  buffer_store_dword v4, off, s[4:7], s49 sc1
  s_mov_b64 exec, -1
  s_lshl_b32 s44, s52, 12
  s_waitcnt lgkmcnt(2)
  v_mfma_f32_32x32x16_bf16 v[20:35], v[132:135], v[72:75], v[20:35]
  ds_read_b128 v[84:87], v124 offset:0
  s_add_u32 s44, s44, 41943040
  s_lshl_b32 s51, s52, 5
  s_add_u32 s51, s51, 244318208
  s_lshr_b32 s55, s47, 7
  v_mfma_f32_32x32x16_bf16 v[36:51], v[72:75], a[4:7], v[36:51]
  s_sub_u32 s27, s47, s60
  s_cmp_eq_u32 s27, 15
  s_cselect_b32 s55, 1, s55
  s_add_u32 s76, s47, 3
  s_cmp_lt_u32 s76, 18
  s_cselect_b32 s76, s76, s41
  s_waitcnt lgkmcnt(2)
  v_mfma_f32_32x32x16_bf16 v[20:35], v[136:139], v[76:79], v[20:35]
  ds_read_b128 v[88:91], v125 offset:0
  v_cvt_pk_bf16_f32 v100, v52, v53
  v_cvt_pk_bf16_f32 v101, v54, v55
  v_cvt_pk_bf16_f32 v102, v60, v61
  v_cvt_pk_bf16_f32 v103, v62, v63
  v_mfma_f32_32x32x16_bf16 v[36:51], v[76:79], a[8:11], v[36:51]
  buffer_store_dwordx4 v[100:103], v8, s[4:7], s43 offen offset:0 sc1
  v_cvt_pk_bf16_f32 v104, v56, v57
  v_cvt_pk_bf16_f32 v105, v58, v59
  s_waitcnt lgkmcnt(2)
  v_mfma_f32_32x32x16_bf16 v[20:35], v[140:143], v[80:83], v[20:35]
  ds_read_b128 v[92:95], v126 offset:0
  v_cvt_pk_bf16_f32 v106, v64, v65
  v_cvt_pk_bf16_f32 v107, v66, v67
  v_mfma_f32_32x32x16_bf16 v[36:51], v[80:83], a[12:15], v[36:51]
  s_waitcnt lgkmcnt(2)
  v_mfma_f32_32x32x16_bf16 v[20:35], v[144:147], v[84:87], v[20:35]
  ds_read_b128 v[96:99], v127 offset:0
  buffer_store_dwordx4 v[104:107], v8, s[4:7], s43 offen offset:512 sc1
  s_lshl_b32 s43, s52, 11
  v_mfma_f32_32x32x16_bf16 v[36:51], v[84:87], a[16:19], v[36:51]
  s_add_u32 s43, s43, 142606336
  s_waitcnt lgkmcnt(2)
  v_mfma_f32_32x32x16_bf16 v[20:35], v[148:151], v[88:91], v[20:35]
  ds_read_b128 v[68:71], v120 offset:256
  v_mfma_f32_32x32x16_bf16 v[36:51], v[88:91], a[20:23], v[36:51]
  s_waitcnt lgkmcnt(2)
  v_mfma_f32_32x32x16_bf16 v[20:35], v[152:155], v[92:95], v[20:35]
  ds_read_b128 v[72:75], v121 offset:256
  s_cmp_lt_u32 s47, 64
  s_cselect_b32 s26, 2, 0
  s_add_u32 s26, s26, s47
  s_lshl_b32 s26, s26, 12
  v_mfma_f32_32x32x16_bf16 v[36:51], v[92:95], a[24:27], v[36:51]
  s_add_u32 s26, s26, 243261440
  s_mov_b64 exec, 0xffffff
  buffer_load_dword v116, v7, s[4:7], s26 offen sc1
  s_mov_b64 exec, -1
  s_waitcnt lgkmcnt(2)
  v_mfma_f32_32x32x16_bf16 v[20:35], v[156:159], v[96:99], v[20:35]
  ds_read_b128 v[76:79], v122 offset:256
  v_mfma_f32_32x32x16_bf16 v[36:51], v[96:99], a[28:31], v[36:51]
  s_waitcnt lgkmcnt(2)
  v_mfma_f32_32x32x16_bf16 v[20:35], v[160:163], v[68:71], v[20:35]
  ds_read_b128 v[80:83], v123 offset:256
  v_mfma_f32_32x32x16_bf16 v[36:51], v[68:71], a[32:35], v[36:51]
  s_waitcnt lgkmcnt(2)
  v_mfma_f32_32x32x16_bf16 v[20:35], v[164:167], v[72:75], v[20:35]
  ds_read_b128 v[84:87], v124 offset:256
  v_mfma_f32_32x32x16_bf16 v[36:51], v[72:75], a[36:39], v[36:51]
  s_waitcnt lgkmcnt(2)
  v_mfma_f32_32x32x16_bf16 v[20:35], v[168:171], v[76:79], v[20:35]
  ds_read_b128 v[88:91], v125 offset:256
  v_mfma_f32_32x32x16_bf16 v[36:51], v[76:79], a[40:43], v[36:51]
  s_waitcnt lgkmcnt(2)
  v_mfma_f32_32x32x16_bf16 v[20:35], v[172:175], v[80:83], v[20:35]
  ds_read_b128 v[92:95], v126 offset:256
  v_mfma_f32_32x32x16_bf16 v[36:51], v[80:83], a[44:47], v[36:51]
  s_waitcnt lgkmcnt(2)
  v_mfma_f32_32x32x16_bf16 v[20:35], v[176:179], v[84:87], v[20:35]
  ds_read_b128 v[96:99], v127 offset:256
  v_mfma_f32_32x32x16_bf16 v[36:51], v[84:87], a[48:51], v[36:51]
  s_waitcnt lgkmcnt(2)
  v_mfma_f32_32x32x16_bf16 v[20:35], v[180:183], v[88:91], v[20:35]
  ds_read_b128 v[68:71], v120 offset:512
  v_mfma_f32_32x32x16_bf16 v[36:51], v[88:91], a[52:55], v[36:51]
  s_waitcnt lgkmcnt(2)
  v_mfma_f32_32x32x16_bf16 v[20:35], v[184:187], v[92:95], v[20:35]
  ds_read_b128 v[72:75], v121 offset:512
  v_mfma_f32_32x32x16_bf16 v[36:51], v[92:95], a[56:59], v[36:51]
  s_waitcnt lgkmcnt(2)
  v_mfma_f32_32x32x16_bf16 v[20:35], v[188:191], v[96:99], v[20:35]
  ds_read_b128 v[76:79], v122 offset:512
  v_mfma_f32_32x32x16_bf16 v[36:51], v[96:99], a[60:63], v[36:51]
  s_waitcnt lgkmcnt(2)
  v_mfma_f32_32x32x16_bf16 v[20:35], v[192:195], v[68:71], v[20:35]
  ds_read_b128 v[80:83], v123 offset:512
  v_mfma_f32_32x32x16_bf16 v[36:51], v[68:71], a[64:67], v[36:51]
  s_waitcnt lgkmcnt(2)
  v_mfma_f32_32x32x16_bf16 v[20:35], v[196:199], v[72:75], v[20:35]
  ds_read_b128 v[84:87], v124 offset:512
  s_waitcnt vmcnt(0)
  s_mov_b64 exec, 3
  buffer_store_dword v4, v0, s[4:7], s49 offen sc1
  s_mov_b64 exec, -1
  v_mfma_f32_32x32x16_bf16 v[36:51], v[72:75], a[68:71], v[36:51]
  v_cmp_eq_u32 vcc, 0, v116
  v_max_u32_dpp v117, v116, v116 quad_perm:[1,0,3,2] row_mask:0xf bank_mask:0xf
  s_and_b32 s48, vcc_lo, 0xffffff
  s_cselect_b32 s48, 0, -1
  v_max_u32_dpp v117, v117, v117 quad_perm:[2,3,0,1] row_mask:0xf bank_mask:0xf
  s_waitcnt lgkmcnt(2)
  v_mfma_f32_32x32x16_bf16 v[20:35], v[200:203], v[76:79], v[20:35]
  ds_read_b128 v[88:91], v125 offset:512
  s_nop 1
  v_max_u32_dpp v117, v117, v117 row_half_mirror row_mask:0xf bank_mask:0xf
  v_and_b32 v117, s48, v117
  s_cmp_lg_u32 s48, 0
  s_cselect_b32 s28, s47, s46
  v_mfma_f32_32x32x16_bf16 v[36:51], v[76:79], a[72:75], v[36:51]
  s_and_b32 s63, s28, 127
  s_lshl_b32 s63, s63, 15
  s_xor_b32 s27, s50, 32768
  s_add_u32 m0, s27, s54
  s_add_u32 s63, s63, s54
  s_waitcnt lgkmcnt(2)
  v_mfma_f32_32x32x16_bf16 v[20:35], v[204:207], v[80:83], v[20:35]
  ds_read_b128 v[92:95], v126 offset:512
  s_add_u32 s63, s63, 6291456
  buffer_load_dwordx4 v12, s[4:7], s63 offen offset:0 sc1 lds
  v_mfma_f32_32x32x16_bf16 v[36:51], v[80:83], a[76:79], v[36:51]
  s_waitcnt lgkmcnt(2)
  v_mfma_f32_32x32x16_bf16 v[20:35], v[208:211], v[84:87], v[20:35]
  ds_read_b128 v[96:99], v127 offset:512
  v_mfma_f32_32x32x16_bf16 v[36:51], v[84:87], a[80:83], v[36:51]
  buffer_load_dwordx4 v13, s[4:7], s63 offen offset:1024 sc1 lds
  s_waitcnt lgkmcnt(2)
  v_mfma_f32_32x32x16_bf16 v[20:35], v[212:215], v[88:91], v[20:35]
  ds_read_b128 v[68:71], v120 offset:768
  v_mfma_f32_32x32x16_bf16 v[36:51], v[88:91], a[84:87], v[36:51]
  s_waitcnt lgkmcnt(2)
  v_mfma_f32_32x32x16_bf16 v[20:35], v[216:219], v[92:95], v[20:35]
  ds_read_b128 v[72:75], v121 offset:768
  buffer_load_dwordx4 v14, s[4:7], s63 offen offset:2048 sc1 lds
  v_mfma_f32_32x32x16_bf16 v[36:51], v[92:95], a[88:91], v[36:51]
  s_waitcnt lgkmcnt(2)
  v_mfma_f32_32x32x16_bf16 v[20:35], v[220:223], v[96:99], v[20:35]
  ds_read_b128 v[76:79], v122 offset:768
  v_mfma_f32_32x32x16_bf16 v[36:51], v[96:99], a[92:95], v[36:51]
  buffer_load_dwordx4 v15, s[4:7], s63 offen offset:3072 sc1 lds
  s_add_u32 m0, m0, 4096
  s_add_u32 s63, s63, 4096
  s_waitcnt lgkmcnt(2)
  v_mfma_f32_32x32x16_bf16 v[20:35], v[224:227], v[68:71], v[20:35]
  ds_read_b128 v[80:83], v123 offset:768
  v_mfma_f32_32x32x16_bf16 v[36:51], v[68:71], a[96:99], v[36:51]
  s_waitcnt lgkmcnt(2)
  v_mfma_f32_32x32x16_bf16 v[20:35], v[228:231], v[72:75], v[20:35]
  ds_read_b128 v[84:87], v124 offset:768
  buffer_load_dwordx4 v16, s[4:7], s63 offen offset:0 sc1 lds
  v_mfma_f32_32x32x16_bf16 v[36:51], v[72:75], a[100:103], v[36:51]
  s_waitcnt lgkmcnt(2)
  v_mfma_f32_32x32x16_bf16 v[20:35], v[232:235], v[76:79], v[20:35]
  ds_read_b128 v[88:91], v125 offset:768
  v_mfma_f32_32x32x16_bf16 v[36:51], v[76:79], a[104:107], v[36:51]
  buffer_load_dwordx4 v17, s[4:7], s63 offen offset:1024 sc1 lds
  s_waitcnt lgkmcnt(2)
  v_mfma_f32_32x32x16_bf16 v[20:35], v[236:239], v[80:83], v[20:35]
  ds_read_b128 v[92:95], v126 offset:768
  v_mfma_f32_32x32x16_bf16 v[36:51], v[80:83], a[108:111], v[36:51]
  s_waitcnt lgkmcnt(2)
  v_mfma_f32_32x32x16_bf16 v[20:35], v[240:243], v[84:87], v[20:35]
  ds_read_b128 v[96:99], v127 offset:768
  buffer_load_dwordx4 v18, s[4:7], s63 offen offset:2048 sc1 lds
  v_mfma_f32_32x32x16_bf16 v[36:51], v[84:87], a[112:115], v[36:51]
  s_waitcnt lgkmcnt(2)
  v_mfma_f32_32x32x16_bf16 v[20:35], v[244:247], v[88:91], v[20:35]
  ds_read_b128 v[68:71], v120 offset:0
  v_mfma_f32_32x32x16_bf16 v[36:51], v[88:91], a[116:119], v[36:51]
  ds_read_b128 v[72:75], v121 offset:0
  buffer_load_dwordx4 v19, s[4:7], s63 offen offset:3072 sc1 lds
  s_mov_b32 s49, s51
  s_waitcnt lgkmcnt(3)
  v_mfma_f32_32x32x16_bf16 v[20:35], v[248:251], v[92:95], v[20:35]
  ds_read_b128 v[76:79], v122 offset:0
  ds_write_b32 v118, v117 offset:0
  v_mfma_f32_32x32x16_bf16 v[36:51], v[92:95], a[120:123], v[36:51]
  ds_read_b128 v[80:83], v123 offset:0
  s_waitcnt lgkmcnt(5)
  v_mfma_f32_32x32x16_bf16 v[20:35], v[252:255], v[96:99], v[20:35]
  ds_read_b128 v[84:87], v124 offset:0
  v_mfma_f32_32x32x16_bf16 v[36:51], v[96:99], a[124:127], v[36:51]
  ds_read_b128 v[88:91], v125 offset:0
  s_waitcnt lgkmcnt(5)
  v_mfma_f32_32x32x16_bf16 v[52:67], a[128:131], v[68:71], 0
  ds_read_b128 v[92:95], v126 offset:0
  v_mfma_f32_32x32x16_bf16 v[52:67], a[132:135], v[72:75], v[52:67]
  ds_read_b128 v[96:99], v127 offset:0
  v_mul_f32 v20, s24, v20
  v_mul_f32 v21, s24, v21
  v_mul_f32 v22, s24, v22
  v_mul_f32 v23, s24, v23
  s_waitcnt lgkmcnt(4)
  v_mfma_f32_32x32x16_bf16 v[52:67], a[136:139], v[76:79], v[52:67]
  ds_read_b128 v[68:71], v120 offset:256
  v_mul_f32 v24, s24, v24
  v_mul_f32 v25, s24, v25
  v_cvt_pk_bf16_f32 v100, v36, v37
  v_cvt_pk_bf16_f32 v101, v38, v39
  v_mfma_f32_32x32x16_bf16 v[52:67], a[140:143], v[80:83], v[52:67]
  ds_read_b128 v[72:75], v121 offset:256
  v_cvt_pk_bf16_f32 v102, v44, v45
  v_cvt_pk_bf16_f32 v103, v46, v47
  buffer_store_dwordx4 v[100:103], v8, s[4:7], s44 offen offset:2048 sc1
  s_waitcnt lgkmcnt(4)
  v_mfma_f32_32x32x16_bf16 v[52:67], a[144:147], v[84:87], v[52:67]
  ds_read_b128 v[76:79], v122 offset:256
  v_cvt_pk_bf16_f32 v104, v40, v41
  v_cvt_pk_bf16_f32 v105, v42, v43
  v_cvt_pk_bf16_f32 v106, v48, v49
  v_cvt_pk_bf16_f32 v107, v50, v51
  v_mfma_f32_32x32x16_bf16 v[52:67], a[148:151], v[88:91], v[52:67]
  ds_read_b128 v[80:83], v123 offset:256
  buffer_store_dwordx4 v[104:107], v8, s[4:7], s44 offen offset:2560 sc1
  v_mul_f32 v26, s24, v26
  s_waitcnt lgkmcnt(4)
  v_mfma_f32_32x32x16_bf16 v[52:67], a[152:155], v[92:95], v[52:67]
  ds_read_b128 v[84:87], v124 offset:256
  v_mul_f32 v27, s24, v27
  v_mul_f32 v28, s24, v28
  v_mul_f32 v29, s24, v29
  v_mul_f32 v30, s24, v30
  v_mfma_f32_32x32x16_bf16 v[52:67], a[156:159], v[96:99], v[52:67]
  ds_read_b128 v[88:91], v125 offset:256
  v_mul_f32 v31, s24, v31
  v_mul_f32 v32, s24, v32
  v_mul_f32 v33, s24, v33
  v_mul_f32 v34, s24, v34
  s_waitcnt lgkmcnt(4)
  v_mfma_f32_32x32x16_bf16 v[52:67], a[160:163], v[68:71], v[52:67]
  ds_read_b128 v[92:95], v126 offset:256
  v_mul_f32 v35, s24, v35
  v_cvt_pk_bf16_f32 v108, v20, v21
  v_cvt_pk_bf16_f32 v109, v22, v23
  v_cvt_pk_bf16_f32 v110, v28, v29
  v_mfma_f32_32x32x16_bf16 v[52:67], a[164:167], v[72:75], v[52:67]
  ds_read_b128 v[96:99], v127 offset:256
  v_cvt_pk_bf16_f32 v111, v30, v31
  buffer_store_dwordx4 v[108:111], v8, s[4:7], s44 offen offset:0 sc1
  s_waitcnt lgkmcnt(4)
  v_mfma_f32_32x32x16_bf16 v[52:67], a[168:171], v[76:79], v[52:67]
  ds_read_b128 v[68:71], v120 offset:512
  v_cvt_pk_bf16_f32 v112, v24, v25
  v_cvt_pk_bf16_f32 v113, v26, v27
  v_cvt_pk_bf16_f32 v114, v32, v33
  v_cvt_pk_bf16_f32 v115, v34, v35
  v_mfma_f32_32x32x16_bf16 v[52:67], a[172:175], v[80:83], v[52:67]
  ds_read_b128 v[72:75], v121 offset:512
  buffer_store_dwordx4 v[112:115], v8, s[4:7], s44 offen offset:512 sc1
  s_waitcnt lgkmcnt(4)
  v_mfma_f32_32x32x16_bf16 v[52:67], a[176:179], v[84:87], v[52:67]
  ds_read_b128 v[76:79], v122 offset:512
  v_mfma_f32_32x32x16_bf16 v[52:67], a[180:183], v[88:91], v[52:67]
  ds_read_b128 v[80:83], v123 offset:512
  s_waitcnt lgkmcnt(4)
  v_mfma_f32_32x32x16_bf16 v[52:67], a[184:187], v[92:95], v[52:67]
  ds_read_b128 v[84:87], v124 offset:512
  v_mfma_f32_32x32x16_bf16 v[52:67], a[188:191], v[96:99], v[52:67]
  ds_read_b128 v[88:91], v125 offset:512
  s_waitcnt lgkmcnt(4)
  v_mfma_f32_32x32x16_bf16 v[52:67], a[192:195], v[68:71], v[52:67]
  ds_read_b128 v[92:95], v126 offset:512
  v_mfma_f32_32x32x16_bf16 v[52:67], a[196:199], v[72:75], v[52:67]
  ds_read_b128 v[96:99], v127 offset:512
  s_waitcnt lgkmcnt(4)
  v_mfma_f32_32x32x16_bf16 v[52:67], a[200:203], v[76:79], v[52:67]
  ds_read_b128 v[68:71], v120 offset:768
  v_mfma_f32_32x32x16_bf16 v[52:67], a[204:207], v[80:83], v[52:67]
  ds_read_b128 v[72:75], v121 offset:768
  s_waitcnt lgkmcnt(4)
  v_mfma_f32_32x32x16_bf16 v[52:67], a[208:211], v[84:87], v[52:67]
  ds_read_b128 v[76:79], v122 offset:768
  ds_read_b128 v[80:83], v123 offset:768
  v_mfma_f32_32x32x16_bf16 v[52:67], a[212:215], v[88:91], v[52:67]
  ds_read_b128 v[84:87], v124 offset:768
  ds_read_b128 v[88:91], v125 offset:768
  s_waitcnt lgkmcnt(6)
  v_mfma_f32_32x32x16_bf16 v[52:67], a[216:219], v[92:95], v[52:67]
  ds_read_b128 v[92:95], v126 offset:768
  v_mfma_f32_32x32x16_bf16 v[52:67], a[220:223], v[96:99], v[52:67]
  ds_read_b128 v[96:99], v127 offset:768
  s_waitcnt lgkmcnt(6)
  v_mfma_f32_32x32x16_bf16 v[52:67], a[224:227], v[68:71], v[52:67]
  v_mfma_f32_32x32x16_bf16 v[52:67], a[228:231], v[72:75], v[52:67]
  s_waitcnt vmcnt(4) lgkmcnt(0)
  s_barrier
  ds_read_b128 v[100:103], v119 offset:0
  v_mfma_f32_32x32x16_bf16 v[52:67], a[232:235], v[76:79], v[52:67]
  ds_read_b128 v[68:71], v120 offset:32768
  v_mfma_f32_32x32x16_bf16 v[52:67], a[236:239], v[80:83], v[52:67]
  ds_read_b128 v[72:75], v121 offset:32768
  s_xor_b32 s50, s50, 32768
  v_mfma_f32_32x32x16_bf16 v[52:67], a[240:243], v[84:87], v[52:67]
  ds_read_b128 v[76:79], v122 offset:32768
  v_mfma_f32_32x32x16_bf16 v[52:67], a[244:247], v[88:91], v[52:67]
  s_waitcnt lgkmcnt(3)
  v_min3_u32 v104, v100, v101, v102
  v_max3_u32 v100, v100, v101, v102
  v_min_u32 v104, v104, v103
  v_max_u32 v100, v100, v103
  v_readfirstlane_b32 s45, v104
  v_mfma_f32_32x32x16_bf16 v[52:67], a[248:251], v[92:95], v[52:67]
  v_readlane_b32 s28, v100, 0
  v_readlane_b32 s29, v100, 1
  v_readlane_b32 s30, v100, 2
  s_cmp_gt_u32 s55, 0
  s_cselect_b32 s45, 0, s45
  v_mfma_f32_32x32x16_bf16 v[52:67], a[252:255], v[96:99], v[52:67]
  s_cmp_eq_u32 s45, 0
  s_cbranch_scc1 q_slow_86
  s_cmp_lt_u32 s47, 64
  s_cbranch_scc1 q_w1_100
  s_cmp_gt_u32 s28, s56
  s_addc_u32 s42, s42, s42
  s_max_u32 s56, s56, s28
  s_and_b32 s26, s42, 1
  s_cselect_b32 s26, s40, 0
  s_cmp_gt_u32 s26, 10
  s_subb_u32 s40, s40, 0
  s_cmp_gt_u32 s29, s56
  s_addc_u32 s42, s42, s42
  s_max_u32 s56, s56, s29
  s_and_b32 s26, s42, 1
  s_cselect_b32 s26, s40, 0
  s_cmp_gt_u32 s26, 10
  s_subb_u32 s40, s40, 0
  s_cmp_gt_u32 s30, s56
  s_addc_u32 s42, s42, s42
  s_max_u32 s56, s56, s30
  s_add_u32 s76, s47, s40
  s_add_u32 s41, s47, 3
  s_sub_u32 s76, s76, 64
  s_and_b32 s26, s42, 1
  s_cselect_b32 s26, s40, 0
  s_cmp_gt_u32 s26, 10
  s_cselect_b32 s76, 64, s76
  s_subb_u32 s40, s40, 0
  s_cmp_lt_u32 s76, 64
  s_cselect_b32 s76, s76, s41
  s_bitcmp1_b32 s42, 0
  s_cbranch_scc0 q_w1_100
  s_branch q_forkw_95
q_c1_98:
  ds_read_b128 v[68:71], v120 offset:32768
  ds_read_b128 v[72:75], v121 offset:32768
  ds_read_b128 v[76:79], v122 offset:32768
q_w1_100:
  s_waitcnt lgkmcnt(2)
  v_mfma_f32_32x32x16_bf16 v[20:35], v[128:131], v[68:71], 0
  ds_read_b128 v[80:83], v123 offset:32768
  s_mov_b32 s46, s47
  s_mov_b32 s47, s76
  s_lshl_b32 s52, s46, 7
  s_add_u32 s52, s52, s57
  v_mfma_f32_32x32x16_bf16 v[36:51], v[68:71], a[0:3], 0
  s_waitcnt vmcnt(0)
  s_mov_b64 exec, 1
  buffer_store_dword v4, off, s[4:7], s49 sc1
  s_mov_b64 exec, -1
  s_lshl_b32 s44, s52, 12
  s_waitcnt lgkmcnt(2)
  v_mfma_f32_32x32x16_bf16 v[20:35], v[132:135], v[72:75], v[20:35]
  ds_read_b128 v[84:87], v124 offset:32768
  s_add_u32 s44, s44, 41943040
  s_lshl_b32 s51, s52, 5
  s_add_u32 s51, s51, 244318208
  s_lshr_b32 s55, s47, 7
  v_mfma_f32_32x32x16_bf16 v[36:51], v[72:75], a[4:7], v[36:51]
  s_sub_u32 s27, s47, s60
  s_cmp_eq_u32 s27, 15
  s_cselect_b32 s55, 1, s55
  s_add_u32 s76, s47, 3
  s_cmp_lt_u32 s76, 18
  s_cselect_b32 s76, s76, s41
  s_waitcnt lgkmcnt(2)
  v_mfma_f32_32x32x16_bf16 v[20:35], v[136:139], v[76:79], v[20:35]
  ds_read_b128 v[88:91], v125 offset:32768
  v_cvt_pk_bf16_f32 v100, v52, v53
  v_cvt_pk_bf16_f32 v101, v54, v55
  v_cvt_pk_bf16_f32 v102, v60, v61
  v_cvt_pk_bf16_f32 v103, v62, v63
  v_mfma_f32_32x32x16_bf16 v[36:51], v[76:79], a[8:11], v[36:51]
  buffer_store_dwordx4 v[100:103], v8, s[4:7], s43 offen offset:0 sc1
  v_cvt_pk_bf16_f32 v104, v56, v57
  v_cvt_pk_bf16_f32 v105, v58, v59
  s_waitcnt lgkmcnt(2)
  v_mfma_f32_32x32x16_bf16 v[20:35], v[140:143], v[80:83], v[20:35]
  ds_read_b128 v[92:95], v126 offset:32768
  v_cvt_pk_bf16_f32 v106, v64, v65
  v_cvt_pk_bf16_f32 v107, v66, v67
  v_mfma_f32_32x32x16_bf16 v[36:51], v[80:83], a[12:15], v[36:51]
  s_waitcnt lgkmcnt(2)
  v_mfma_f32_32x32x16_bf16 v[20:35], v[144:147], v[84:87], v[20:35]
  ds_read_b128 v[96:99], v127 offset:32768
  buffer_store_dwordx4 v[104:107], v8, s[4:7], s43 offen offset:512 sc1
  s_lshl_b32 s43, s52, 11
  v_mfma_f32_32x32x16_bf16 v[36:51], v[84:87], a[16:19], v[36:51]
  s_add_u32 s43, s43, 142606336
  s_waitcnt lgkmcnt(2)
  v_mfma_f32_32x32x16_bf16 v[20:35], v[148:151], v[88:91], v[20:35]
  ds_read_b128 v[68:71], v120 offset:33024
  v_mfma_f32_32x32x16_bf16 v[36:51], v[88:91], a[20:23], v[36:51]
  s_waitcnt lgkmcnt(2)
  v_mfma_f32_32x32x16_bf16 v[20:35], v[152:155], v[92:95], v[20:35]
  ds_read_b128 v[72:75], v121 offset:33024
  s_cmp_lt_u32 s47, 64
  s_cselect_b32 s26, 2, 0
  s_add_u32 s26, s26, s47
  s_lshl_b32 s26, s26, 12
  v_mfma_f32_32x32x16_bf16 v[36:51], v[92:95], a[24:27], v[36:51]
  s_add_u32 s26, s26, 243261440
  s_mov_b64 exec, 0xffffff
  buffer_load_dword v116, v7, s[4:7], s26 offen sc1
  s_mov_b64 exec, -1
  s_waitcnt lgkmcnt(2)
  v_mfma_f32_32x32x16_bf16 v[20:35], v[156:159], v[96:99], v[20:35]
  ds_read_b128 v[76:79], v122 offset:33024
  v_mfma_f32_32x32x16_bf16 v[36:51], v[96:99], a[28:31], v[36:51]
  s_waitcnt lgkmcnt(2)
  v_mfma_f32_32x32x16_bf16 v[20:35], v[160:163], v[68:71], v[20:35]
  ds_read_b128 v[80:83], v123 offset:33024
  v_mfma_f32_32x32x16_bf16 v[36:51], v[68:71], a[32:35], v[36:51]
  s_waitcnt lgkmcnt(2)
  v_mfma_f32_32x32x16_bf16 v[20:35], v[164:167], v[72:75], v[20:35]
  ds_read_b128 v[84:87], v124 offset:33024
  v_mfma_f32_32x32x16_bf16 v[36:51], v[72:75], a[36:39], v[36:51]
  s_waitcnt lgkmcnt(2)
  v_mfma_f32_32x32x16_bf16 v[20:35], v[168:171], v[76:79], v[20:35]
  ds_read_b128 v[88:91], v125 offset:33024
  v_mfma_f32_32x32x16_bf16 v[36:51], v[76:79], a[40:43], v[36:51]
  s_waitcnt lgkmcnt(2)
  v_mfma_f32_32x32x16_bf16 v[20:35], v[172:175], v[80:83], v[20:35]
  ds_read_b128 v[92:95], v126 offset:33024
  v_mfma_f32_32x32x16_bf16 v[36:51], v[80:83], a[44:47], v[36:51]
  s_waitcnt lgkmcnt(2)
  v_mfma_f32_32x32x16_bf16 v[20:35], v[176:179], v[84:87], v[20:35]
  ds_read_b128 v[96:99], v127 offset:33024
  v_mfma_f32_32x32x16_bf16 v[36:51], v[84:87], a[48:51], v[36:51]
  s_waitcnt lgkmcnt(2)
  v_mfma_f32_32x32x16_bf16 v[20:35], v[180:183], v[88:91], v[20:35]
  ds_read_b128 v[68:71], v120 offset:33280
  v_mfma_f32_32x32x16_bf16 v[36:51], v[88:91], a[52:55], v[36:51]
  s_waitcnt lgkmcnt(2)
  v_mfma_f32_32x32x16_bf16 v[20:35], v[184:187], v[92:95], v[20:35]
  ds_read_b128 v[72:75], v121 offset:33280
  v_mfma_f32_32x32x16_bf16 v[36:51], v[92:95], a[56:59], v[36:51]
  s_waitcnt lgkmcnt(2)
  v_mfma_f32_32x32x16_bf16 v[20:35], v[188:191], v[96:99], v[20:35]
  ds_read_b128 v[76:79], v122 offset:33280
  v_mfma_f32_32x32x16_bf16 v[36:51], v[96:99], a[60:63], v[36:51]
  s_waitcnt lgkmcnt(2)
  v_mfma_f32_32x32x16_bf16 v[20:35], v[192:195], v[68:71], v[20:35]
  ds_read_b128 v[80:83], v123 offset:33280
  v_mfma_f32_32x32x16_bf16 v[36:51], v[68:71], a[64:67], v[36:51]
  s_waitcnt lgkmcnt(2)
  v_mfma_f32_32x32x16_bf16 v[20:35], v[196:199], v[72:75], v[20:35]
  ds_read_b128 v[84:87], v124 offset:33280
  s_waitcnt vmcnt(0)
  s_mov_b64 exec, 3
  buffer_store_dword v4, v0, s[4:7], s49 offen sc1
  s_mov_b64 exec, -1
  v_mfma_f32_32x32x16_bf16 v[36:51], v[72:75], a[68:71], v[36:51]
  v_cmp_eq_u32 vcc, 0, v116
  v_max_u32_dpp v117, v116, v116 quad_perm:[1,0,3,2] row_mask:0xf bank_mask:0xf
  s_and_b32 s48, vcc_lo, 0xffffff
  s_cselect_b32 s48, 0, -1
  v_max_u32_dpp v117, v117, v117 quad_perm:[2,3,0,1] row_mask:0xf bank_mask:0xf
  s_waitcnt lgkmcnt(2)
  v_mfma_f32_32x32x16_bf16 v[20:35], v[200:203], v[76:79], v[20:35]
  ds_read_b128 v[88:91], v125 offset:33280
  s_nop 1
  v_max_u32_dpp v117, v117, v117 row_half_mirror row_mask:0xf bank_mask:0xf
  v_and_b32 v117, s48, v117
  s_cmp_lg_u32 s48, 0
  s_cselect_b32 s28, s47, s46
  v_mfma_f32_32x32x16_bf16 v[36:51], v[76:79], a[72:75], v[36:51]
  s_and_b32 s63, s28, 127
  s_lshl_b32 s63, s63, 15
  s_xor_b32 s27, s50, 32768
  s_add_u32 m0, s27, s54
  s_add_u32 s63, s63, s54
  s_waitcnt lgkmcnt(2)
  v_mfma_f32_32x32x16_bf16 v[20:35], v[204:207], v[80:83], v[20:35]
  ds_read_b128 v[92:95], v126 offset:33280
  s_add_u32 s63, s63, 6291456
  buffer_load_dwordx4 v12, s[4:7], s63 offen offset:0 sc1 lds
  v_mfma_f32_32x32x16_bf16 v[36:51], v[80:83], a[76:79], v[36:51]
  s_waitcnt lgkmcnt(2)
  v_mfma_f32_32x32x16_bf16 v[20:35], v[208:211], v[84:87], v[20:35]
  ds_read_b128 v[96:99], v127 offset:33280
  v_mfma_f32_32x32x16_bf16 v[36:51], v[84:87], a[80:83], v[36:51]
  buffer_load_dwordx4 v13, s[4:7], s63 offen offset:1024 sc1 lds
  s_waitcnt lgkmcnt(2)
  v_mfma_f32_32x32x16_bf16 v[20:35], v[212:215], v[88:91], v[20:35]
  ds_read_b128 v[68:71], v120 offset:33536
  v_mfma_f32_32x32x16_bf16 v[36:51], v[88:91], a[84:87], v[36:51]
  s_waitcnt lgkmcnt(2)
  v_mfma_f32_32x32x16_bf16 v[20:35], v[216:219], v[92:95], v[20:35]
  ds_read_b128 v[72:75], v121 offset:33536
  buffer_load_dwordx4 v14, s[4:7], s63 offen offset:2048 sc1 lds
  v_mfma_f32_32x32x16_bf16 v[36:51], v[92:95], a[88:91], v[36:51]
  s_waitcnt lgkmcnt(2)
  v_mfma_f32_32x32x16_bf16 v[20:35], v[220:223], v[96:99], v[20:35]
  ds_read_b128 v[76:79], v122 offset:33536
  v_mfma_f32_32x32x16_bf16 v[36:51], v[96:99], a[92:95], v[36:51]
  buffer_load_dwordx4 v15, s[4:7], s63 offen offset:3072 sc1 lds
  s_add_u32 m0, m0, 4096
  s_add_u32 s63, s63, 4096
  s_waitcnt lgkmcnt(2)
  v_mfma_f32_32x32x16_bf16 v[20:35], v[224:227], v[68:71], v[20:35]
  ds_read_b128 v[80:83], v123 offset:33536
  v_mfma_f32_32x32x16_bf16 v[36:51], v[68:71], a[96:99], v[36:51]
  s_waitcnt lgkmcnt(2)
  v_mfma_f32_32x32x16_bf16 v[20:35], v[228:231], v[72:75], v[20:35]
  ds_read_b128 v[84:87], v124 offset:33536
  buffer_load_dwordx4 v16, s[4:7], s63 offen offset:0 sc1 lds
  v_mfma_f32_32x32x16_bf16 v[36:51], v[72:75], a[100:103], v[36:51]
  s_waitcnt lgkmcnt(2)
  v_mfma_f32_32x32x16_bf16 v[20:35], v[232:235], v[76:79], v[20:35]
  ds_read_b128 v[88:91], v125 offset:33536
  v_mfma_f32_32x32x16_bf16 v[36:51], v[76:79], a[104:107], v[36:51]
  buffer_load_dwordx4 v17, s[4:7], s63 offen offset:1024 sc1 lds
  s_waitcnt lgkmcnt(2)
  v_mfma_f32_32x32x16_bf16 v[20:35], v[236:239], v[80:83], v[20:35]
  ds_read_b128 v[92:95], v126 offset:33536
  v_mfma_f32_32x32x16_bf16 v[36:51], v[80:83], a[108:111], v[36:51]
  s_waitcnt lgkmcnt(2)
  v_mfma_f32_32x32x16_bf16 v[20:35], v[240:243], v[84:87], v[20:35]
  ds_read_b128 v[96:99], v127 offset:33536
  buffer_load_dwordx4 v18, s[4:7], s63 offen offset:2048 sc1 lds
  v_mfma_f32_32x32x16_bf16 v[36:51], v[84:87], a[112:115], v[36:51]
  s_waitcnt lgkmcnt(2)
  v_mfma_f32_32x32x16_bf16 v[20:35], v[244:247], v[88:91], v[20:35]
  ds_read_b128 v[68:71], v120 offset:32768
  v_mfma_f32_32x32x16_bf16 v[36:51], v[88:91], a[116:119], v[36:51]
  ds_read_b128 v[72:75], v121 offset:32768
  buffer_load_dwordx4 v19, s[4:7], s63 offen offset:3072 sc1 lds
  s_mov_b32 s49, s51
  s_waitcnt lgkmcnt(3)
  v_mfma_f32_32x32x16_bf16 v[20:35], v[248:251], v[92:95], v[20:35]
  ds_read_b128 v[76:79], v122 offset:32768
  ds_write_b32 v118, v117 offset:128
  v_mfma_f32_32x32x16_bf16 v[36:51], v[92:95], a[120:123], v[36:51]
  ds_read_b128 v[80:83], v123 offset:32768
  s_waitcnt lgkmcnt(5)
  v_mfma_f32_32x32x16_bf16 v[20:35], v[252:255], v[96:99], v[20:35]
  ds_read_b128 v[84:87], v124 offset:32768
  v_mfma_f32_32x32x16_bf16 v[36:51], v[96:99], a[124:127], v[36:51]
  ds_read_b128 v[88:91], v125 offset:32768
  s_waitcnt lgkmcnt(5)
  v_mfma_f32_32x32x16_bf16 v[52:67], a[128:131], v[68:71], 0
  ds_read_b128 v[92:95], v126 offset:32768
  v_mfma_f32_32x32x16_bf16 v[52:67], a[132:135], v[72:75], v[52:67]
  ds_read_b128 v[96:99], v127 offset:32768
  v_mul_f32 v20, s24, v20
  v_mul_f32 v21, s24, v21
  v_mul_f32 v22, s24, v22
  v_mul_f32 v23, s24, v23
  s_waitcnt lgkmcnt(4)
  v_mfma_f32_32x32x16_bf16 v[52:67], a[136:139], v[76:79], v[52:67]
  ds_read_b128 v[68:71], v120 offset:33024
  v_mul_f32 v24, s24, v24
  v_mul_f32 v25, s24, v25
  v_cvt_pk_bf16_f32 v100, v36, v37
  v_cvt_pk_bf16_f32 v101, v38, v39
  v_mfma_f32_32x32x16_bf16 v[52:67], a[140:143], v[80:83], v[52:67]
  ds_read_b128 v[72:75], v121 offset:33024
  v_cvt_pk_bf16_f32 v102, v44, v45
  v_cvt_pk_bf16_f32 v103, v46, v47
  buffer_store_dwordx4 v[100:103], v8, s[4:7], s44 offen offset:2048 sc1
  s_waitcnt lgkmcnt(4)
  v_mfma_f32_32x32x16_bf16 v[52:67], a[144:147], v[84:87], v[52:67]
  ds_read_b128 v[76:79], v122 offset:33024
  v_cvt_pk_bf16_f32 v104, v40, v41
  v_cvt_pk_bf16_f32 v105, v42, v43
  v_cvt_pk_bf16_f32 v106, v48, v49
  v_cvt_pk_bf16_f32 v107, v50, v51
  v_mfma_f32_32x32x16_bf16 v[52:67], a[148:151], v[88:91], v[52:67]
  ds_read_b128 v[80:83], v123 offset:33024
  buffer_store_dwordx4 v[104:107], v8, s[4:7], s44 offen offset:2560 sc1
  v_mul_f32 v26, s24, v26
  s_waitcnt lgkmcnt(4)
  v_mfma_f32_32x32x16_bf16 v[52:67], a[152:155], v[92:95], v[52:67]
  ds_read_b128 v[84:87], v124 offset:33024
  v_mul_f32 v27, s24, v27
  v_mul_f32 v28, s24, v28
  v_mul_f32 v29, s24, v29
  v_mul_f32 v30, s24, v30
  v_mfma_f32_32x32x16_bf16 v[52:67], a[156:159], v[96:99], v[52:67]
  ds_read_b128 v[88:91], v125 offset:33024
  v_mul_f32 v31, s24, v31
  v_mul_f32 v32, s24, v32
  v_mul_f32 v33, s24, v33
  v_mul_f32 v34, s24, v34
  s_waitcnt lgkmcnt(4)
  v_mfma_f32_32x32x16_bf16 v[52:67], a[160:163], v[68:71], v[52:67]
  ds_read_b128 v[92:95], v126 offset:33024
  v_mul_f32 v35, s24, v35
  v_cvt_pk_bf16_f32 v108, v20, v21
  v_cvt_pk_bf16_f32 v109, v22, v23
  v_cvt_pk_bf16_f32 v110, v28, v29
  v_mfma_f32_32x32x16_bf16 v[52:67], a[164:167], v[72:75], v[52:67]
  ds_read_b128 v[96:99], v127 offset:33024
  v_cvt_pk_bf16_f32 v111, v30, v31
  buffer_store_dwordx4 v[108:111], v8, s[4:7], s44 offen offset:0 sc1
  s_waitcnt lgkmcnt(4)
  v_mfma_f32_32x32x16_bf16 v[52:67], a[168:171], v[76:79], v[52:67]
  ds_read_b128 v[68:71], v120 offset:33280
  v_cvt_pk_bf16_f32 v112, v24, v25
  v_cvt_pk_bf16_f32 v113, v26, v27
  v_cvt_pk_bf16_f32 v114, v32, v33
  v_cvt_pk_bf16_f32 v115, v34, v35
  v_mfma_f32_32x32x16_bf16 v[52:67], a[172:175], v[80:83], v[52:67]
  ds_read_b128 v[72:75], v121 offset:33280
  buffer_store_dwordx4 v[112:115], v8, s[4:7], s44 offen offset:512 sc1
  s_waitcnt lgkmcnt(4)
  v_mfma_f32_32x32x16_bf16 v[52:67], a[176:179], v[84:87], v[52:67]
  ds_read_b128 v[76:79], v122 offset:33280
  v_mfma_f32_32x32x16_bf16 v[52:67], a[180:183], v[88:91], v[52:67]
  ds_read_b128 v[80:83], v123 offset:33280
  s_waitcnt lgkmcnt(4)
  v_mfma_f32_32x32x16_bf16 v[52:67], a[184:187], v[92:95], v[52:67]
  ds_read_b128 v[84:87], v124 offset:33280
  v_mfma_f32_32x32x16_bf16 v[52:67], a[188:191], v[96:99], v[52:67]
  ds_read_b128 v[88:91], v125 offset:33280
  s_waitcnt lgkmcnt(4)
  v_mfma_f32_32x32x16_bf16 v[52:67], a[192:195], v[68:71], v[52:67]
  ds_read_b128 v[92:95], v126 offset:33280
  v_mfma_f32_32x32x16_bf16 v[52:67], a[196:199], v[72:75], v[52:67]
  ds_read_b128 v[96:99], v127 offset:33280
  s_waitcnt lgkmcnt(4)
  v_mfma_f32_32x32x16_bf16 v[52:67], a[200:203], v[76:79], v[52:67]
  ds_read_b128 v[68:71], v120 offset:33536
  v_mfma_f32_32x32x16_bf16 v[52:67], a[204:207], v[80:83], v[52:67]
  ds_read_b128 v[72:75], v121 offset:33536
  s_waitcnt lgkmcnt(4)
  v_mfma_f32_32x32x16_bf16 v[52:67], a[208:211], v[84:87], v[52:67]
  ds_read_b128 v[76:79], v122 offset:33536
  ds_read_b128 v[80:83], v123 offset:33536
  v_mfma_f32_32x32x16_bf16 v[52:67], a[212:215], v[88:91], v[52:67]
  ds_read_b128 v[84:87], v124 offset:33536
  ds_read_b128 v[88:91], v125 offset:33536
  s_waitcnt lgkmcnt(6)
  v_mfma_f32_32x32x16_bf16 v[52:67], a[216:219], v[92:95], v[52:67]
  ds_read_b128 v[92:95], v126 offset:33536
  v_mfma_f32_32x32x16_bf16 v[52:67], a[220:223], v[96:99], v[52:67]
  ds_read_b128 v[96:99], v127 offset:33536
  s_waitcnt lgkmcnt(6)
  v_mfma_f32_32x32x16_bf16 v[52:67], a[224:227], v[68:71], v[52:67]
  v_mfma_f32_32x32x16_bf16 v[52:67], a[228:231], v[72:75], v[52:67]
  s_waitcnt vmcnt(4) lgkmcnt(0)
  s_barrier
  ds_read_b128 v[100:103], v119 offset:128
  v_mfma_f32_32x32x16_bf16 v[52:67], a[232:235], v[76:79], v[52:67]
  ds_read_b128 v[68:71], v120 offset:0
  v_mfma_f32_32x32x16_bf16 v[52:67], a[236:239], v[80:83], v[52:67]
  ds_read_b128 v[72:75], v121 offset:0
  s_xor_b32 s50, s50, 32768
  v_mfma_f32_32x32x16_bf16 v[52:67], a[240:243], v[84:87], v[52:67]
  ds_read_b128 v[76:79], v122 offset:0
  v_mfma_f32_32x32x16_bf16 v[52:67], a[244:247], v[88:91], v[52:67]
  s_waitcnt lgkmcnt(3)
  v_min3_u32 v104, v100, v101, v102
  v_max3_u32 v100, v100, v101, v102
  v_min_u32 v104, v104, v103
  v_max_u32 v100, v100, v103
  v_readfirstlane_b32 s45, v104
  v_mfma_f32_32x32x16_bf16 v[52:67], a[248:251], v[92:95], v[52:67]
  v_readlane_b32 s28, v100, 0
  v_readlane_b32 s29, v100, 1
  v_readlane_b32 s30, v100, 2
  s_cmp_gt_u32 s55, 0
  s_cselect_b32 s45, 0, s45
  v_mfma_f32_32x32x16_bf16 v[52:67], a[252:255], v[96:99], v[52:67]
  s_cmp_eq_u32 s45, 0
  s_cbranch_scc1 q_slow_86
  s_cmp_lt_u32 s47, 64
  s_cbranch_scc1 q_w0_99
  s_cmp_gt_u32 s28, s56
  s_addc_u32 s42, s42, s42
  s_max_u32 s56, s56, s28
  s_and_b32 s26, s42, 1
  s_cselect_b32 s26, s40, 0
  s_cmp_gt_u32 s26, 10
  s_subb_u32 s40, s40, 0
  s_cmp_gt_u32 s29, s56
  s_addc_u32 s42, s42, s42
  s_max_u32 s56, s56, s29
  s_and_b32 s26, s42, 1
  s_cselect_b32 s26, s40, 0
  s_cmp_gt_u32 s26, 10
  s_subb_u32 s40, s40, 0
  s_cmp_gt_u32 s30, s56
  s_addc_u32 s42, s42, s42
  s_max_u32 s56, s56, s30
  s_add_u32 s76, s47, s40
  s_add_u32 s41, s47, 3
  s_sub_u32 s76, s76, 64
  s_and_b32 s26, s42, 1
  s_cselect_b32 s26, s40, 0
  s_cmp_gt_u32 s26, 10
  s_cselect_b32 s76, 64, s76
  s_subb_u32 s40, s40, 0
  s_cmp_lt_u32 s76, 64
  s_cselect_b32 s76, s76, s41
  s_bitcmp1_b32 s42, 0
  s_cbranch_scc0 q_w0_99
  s_branch q_forkw_95
q_forkw_95:
  v_cvt_pk_bf16_f32 v100, v52, v53
  v_cvt_pk_bf16_f32 v101, v54, v55
  v_cvt_pk_bf16_f32 v102, v60, v61
  v_cvt_pk_bf16_f32 v103, v62, v63
  v_cvt_pk_bf16_f32 v104, v56, v57
  v_cvt_pk_bf16_f32 v105, v58, v59
  v_cvt_pk_bf16_f32 v106, v64, v65
  v_cvt_pk_bf16_f32 v107, v66, v67
  s_waitcnt vmcnt(0)
  s_mov_b64 exec, 1
  buffer_store_dword v4, off, s[4:7], s49 sc1
  s_mov_b64 exec, -1
  buffer_store_dwordx4 v[100:103], v8, s[4:7], s43 offen offset:0 sc1
  buffer_store_dwordx4 v[104:107], v8, s[4:7], s43 offen offset:512 sc1
  s_mov_b32 s43, 268435456
  s_waitcnt lgkmcnt(0)
q_fork_93:
  s_mov_b32 s58, s56
  s_mov_b32 s46, s47
  s_mov_b32 s47, s76
  s_add_u32 s76, s47, 3
  s_cmp_lt_u32 s76, 18
  s_cselect_b32 s76, s76, s41
  s_andn2_b32 s59, 0xfff, s58
  s_lshl_b32 s26, s61, 21
  s_lshl_b32 s27, s59, 10
  s_add_u32 s26, s26, s27
  s_lshl_b32 s27, s17, 8
  s_add_u32 s26, s26, s27
  s_add_u32 s26, s26, 27262976
  v_lshrrev_b32 v5, 7, v0
  v_lshlrev_b32 v5, 5, v5
  buffer_load_dwordx4 v[52:55], v5, s[4:7], s26 offen offset:0 sc1
  buffer_load_dwordx4 v[56:59], v5, s[4:7], s26 offen offset:16 sc1
  s_load_dwordx2 s[64:65], s[0:1], 72
  s_load_dwordx2 s[68:69], s[0:1], 80
  s_load_dwordx2 s[8:9], s[0:1], 88
  s_mov_b32 s66, 1835008
  s_mov_b32 s70, 1835008
  s_mov_b32 s10, 1835008
  v_lshrrev_b32 v2, 7, v0
  v_and_b32 v3, 0x70, v0
  v_mul_u32_u24 v6, 57344, v2
  v_add_u32 v6, v6, v3
  v_cmp_eq_u32 vcc, 0x70, v3
  v_mov_b32 v3, 0x7ff00000
  s_nop 0
  v_cndmask_b32 v6, v6, v3, vcc
  v_lshrrev_b32 v2, 8, v0
  v_mul_u32_u24 v7, 14336, v2
  v_and_b32 v3, 0xf0, v0
  v_add_u32 v7, v7, v3
  s_mul_i32 s34, s17, 458752
  s_mul_i32 s27, s16, 112
  s_add_u32 s34, s34, s27
  s_mul_i32 s35, s16, 57344
  s_lshl_b32 s27, s17, 8
  s_add_u32 s35, s35, s27
  s_waitcnt lgkmcnt(0)
  s_xor_b32 s37, s50, 32768
  s_add_u32 s37, s37, s54
  s_mov_b32 m0, s37
  s_add_u32 s36, s34, 39424
  buffer_load_dwordx4 v6, s[68:71], s36 offen lds
  s_add_u32 m0, m0, 1024
  s_add_u32 s36, s34, 43008
  buffer_load_dwordx4 v6, s[64:67], s36 offen lds
  s_add_u32 m0, m0, 1024
  s_add_u32 s36, s34, 43008
  buffer_load_dwordx4 v6, s[68:71], s36 offen lds
  s_add_u32 m0, m0, 1024
  s_add_u32 s36, s34, 46592
  buffer_load_dwordx4 v6, s[64:67], s36 offen lds
  s_add_u32 m0, m0, 1024
  s_add_u32 s36, s34, 46592
  buffer_load_dwordx4 v6, s[68:71], s36 offen lds
  s_add_u32 m0, m0, 1024
  s_add_u32 s36, s34, 50176
  buffer_load_dwordx4 v6, s[64:67], s36 offen lds
  s_add_u32 m0, m0, 1024
  s_add_u32 s36, s34, 50176
  buffer_load_dwordx4 v6, s[68:71], s36 offen lds
  s_add_u32 m0, m0, 1024
  s_add_u32 s36, s34, 53760
  buffer_load_dwordx4 v6, s[64:67], s36 offen lds
  s_add_u32 m0, m0, 1024
  s_add_u32 s36, s34, 53760
  buffer_load_dwordx4 v[60:63], v6, s[68:71], s36 offen
  buffer_load_dwordx4 v[64:67], v7, s[8:11], s35 offen offset:0
  v_add_u32 v120, s50, v120
  v_add_u32 v121, s50, v121
  v_add_u32 v122, s50, v122
  v_add_u32 v123, s50, v123
  v_add_u32 v124, s50, v124
  v_add_u32 v125, s50, v125
  v_add_u32 v126, s50, v126
  v_add_u32 v127, s50, v127
  s_lshl_b32 s52, s46, 7
  s_add_u32 s52, s52, s57
  s_lshl_b32 s77, s52, 12
  s_add_u32 s44, s77, 75497472
  s_add_u32 s77, s77, 41943040
  s_lshl_b32 s51, s52, 5
  s_add_u32 s51, s51, 244318208
  s_waitcnt vmcnt(12)
  s_barrier
  s_mov_b64 exec, 3
  buffer_store_dword v4, v0, s[4:7], s49 offen sc1
  s_mov_b64 exec, -1
  v_mov_b32 v4, 2
  s_mov_b32 s49, s51
  ds_read_b128 v[68:71], v120 offset:0
  ds_read_b128 v[72:75], v121 offset:0
  ds_read_b128 v[76:79], v122 offset:0
  ds_read_b128 v[80:83], v123 offset:0
  s_waitcnt lgkmcnt(3)
  v_mfma_f32_32x32x16_bf16 v[20:35], v[128:131], v[68:71], 0
  v_mfma_f32_32x32x16_bf16 v[36:51], v[68:71], a[0:3], 0
  s_waitcnt lgkmcnt(2)
  v_mfma_f32_32x32x16_bf16 v[20:35], v[132:135], v[72:75], v[20:35]
  ds_read_b128 v[84:87], v124 offset:0
  v_mfma_f32_32x32x16_bf16 v[36:51], v[72:75], a[4:7], v[36:51]
  s_waitcnt lgkmcnt(2)
  v_mfma_f32_32x32x16_bf16 v[20:35], v[136:139], v[76:79], v[20:35]
  ds_read_b128 v[88:91], v125 offset:0
  v_mfma_f32_32x32x16_bf16 v[36:51], v[76:79], a[8:11], v[36:51]
  s_waitcnt lgkmcnt(2)
  v_mfma_f32_32x32x16_bf16 v[20:35], v[140:143], v[80:83], v[20:35]
  ds_read_b128 v[92:95], v126 offset:0
  v_mfma_f32_32x32x16_bf16 v[36:51], v[80:83], a[12:15], v[36:51]
  s_waitcnt lgkmcnt(2)
  v_mfma_f32_32x32x16_bf16 v[20:35], v[144:147], v[84:87], v[20:35]
  ds_read_b128 v[96:99], v127 offset:0
  v_mfma_f32_32x32x16_bf16 v[36:51], v[84:87], a[16:19], v[36:51]
  s_waitcnt lgkmcnt(2)
  v_mfma_f32_32x32x16_bf16 v[20:35], v[148:151], v[88:91], v[20:35]
  ds_read_b128 v[68:71], v120 offset:256
  v_mfma_f32_32x32x16_bf16 v[36:51], v[88:91], a[20:23], v[36:51]
  s_waitcnt lgkmcnt(2)
  v_mfma_f32_32x32x16_bf16 v[20:35], v[152:155], v[92:95], v[20:35]
  ds_read_b128 v[72:75], v121 offset:256
  v_mfma_f32_32x32x16_bf16 v[36:51], v[92:95], a[24:27], v[36:51]
  s_waitcnt lgkmcnt(2)
  v_mfma_f32_32x32x16_bf16 v[20:35], v[156:159], v[96:99], v[20:35]
  ds_read_b128 v[76:79], v122 offset:256
  v_mfma_f32_32x32x16_bf16 v[36:51], v[96:99], a[28:31], v[36:51]
  s_waitcnt lgkmcnt(2)
  v_mfma_f32_32x32x16_bf16 v[20:35], v[160:163], v[68:71], v[20:35]
  ds_read_b128 v[80:83], v123 offset:256
  v_mfma_f32_32x32x16_bf16 v[36:51], v[68:71], a[32:35], v[36:51]
  s_waitcnt lgkmcnt(2)
  v_mfma_f32_32x32x16_bf16 v[20:35], v[164:167], v[72:75], v[20:35]
  ds_read_b128 v[84:87], v124 offset:256
  v_mfma_f32_32x32x16_bf16 v[36:51], v[72:75], a[36:39], v[36:51]
  s_waitcnt lgkmcnt(2)
  v_mfma_f32_32x32x16_bf16 v[20:35], v[168:171], v[76:79], v[20:35]
  ds_read_b128 v[88:91], v125 offset:256
  v_mfma_f32_32x32x16_bf16 v[36:51], v[76:79], a[40:43], v[36:51]
  s_waitcnt lgkmcnt(2)
  v_mfma_f32_32x32x16_bf16 v[20:35], v[172:175], v[80:83], v[20:35]
  ds_read_b128 v[92:95], v126 offset:256
  v_mfma_f32_32x32x16_bf16 v[36:51], v[80:83], a[44:47], v[36:51]
  s_waitcnt lgkmcnt(2)
  v_mfma_f32_32x32x16_bf16 v[20:35], v[176:179], v[84:87], v[20:35]
  ds_read_b128 v[96:99], v127 offset:256
  v_mfma_f32_32x32x16_bf16 v[36:51], v[84:87], a[48:51], v[36:51]
  s_waitcnt lgkmcnt(2)
  v_mfma_f32_32x32x16_bf16 v[20:35], v[180:183], v[88:91], v[20:35]
  ds_read_b128 v[68:71], v120 offset:512
  v_mfma_f32_32x32x16_bf16 v[36:51], v[88:91], a[52:55], v[36:51]
  s_waitcnt lgkmcnt(2)
  v_mfma_f32_32x32x16_bf16 v[20:35], v[184:187], v[92:95], v[20:35]
  ds_read_b128 v[72:75], v121 offset:512
  v_mfma_f32_32x32x16_bf16 v[36:51], v[92:95], a[56:59], v[36:51]
  s_waitcnt lgkmcnt(2)
  v_mfma_f32_32x32x16_bf16 v[20:35], v[188:191], v[96:99], v[20:35]
  ds_read_b128 v[76:79], v122 offset:512
  v_mfma_f32_32x32x16_bf16 v[36:51], v[96:99], a[60:63], v[36:51]
  s_waitcnt lgkmcnt(2)
  v_mfma_f32_32x32x16_bf16 v[20:35], v[192:195], v[68:71], v[20:35]
  ds_read_b128 v[80:83], v123 offset:512
  v_mfma_f32_32x32x16_bf16 v[36:51], v[68:71], a[64:67], v[36:51]
  s_waitcnt lgkmcnt(2)
  v_mfma_f32_32x32x16_bf16 v[20:35], v[196:199], v[72:75], v[20:35]
  ds_read_b128 v[84:87], v124 offset:512
  v_mfma_f32_32x32x16_bf16 v[36:51], v[72:75], a[68:71], v[36:51]
  s_waitcnt lgkmcnt(2)
  v_mfma_f32_32x32x16_bf16 v[20:35], v[200:203], v[76:79], v[20:35]
  ds_read_b128 v[88:91], v125 offset:512
  v_mfma_f32_32x32x16_bf16 v[36:51], v[76:79], a[72:75], v[36:51]
  s_waitcnt lgkmcnt(2)
  v_mfma_f32_32x32x16_bf16 v[20:35], v[204:207], v[80:83], v[20:35]
  ds_read_b128 v[92:95], v126 offset:512
  v_mfma_f32_32x32x16_bf16 v[36:51], v[80:83], a[76:79], v[36:51]
  s_waitcnt lgkmcnt(2)
  v_mfma_f32_32x32x16_bf16 v[20:35], v[208:211], v[84:87], v[20:35]
  ds_read_b128 v[96:99], v127 offset:512
  v_mfma_f32_32x32x16_bf16 v[36:51], v[84:87], a[80:83], v[36:51]
  s_waitcnt lgkmcnt(2)
  v_mfma_f32_32x32x16_bf16 v[20:35], v[212:215], v[88:91], v[20:35]
  ds_read_b128 v[68:71], v120 offset:768
  v_mfma_f32_32x32x16_bf16 v[36:51], v[88:91], a[84:87], v[36:51]
  s_waitcnt lgkmcnt(2)
  v_mfma_f32_32x32x16_bf16 v[20:35], v[216:219], v[92:95], v[20:35]
  ds_read_b128 v[72:75], v121 offset:768
  v_mfma_f32_32x32x16_bf16 v[36:51], v[92:95], a[88:91], v[36:51]
  s_waitcnt lgkmcnt(2)
  v_mfma_f32_32x32x16_bf16 v[20:35], v[220:223], v[96:99], v[20:35]
  ds_read_b128 v[76:79], v122 offset:768
  v_mfma_f32_32x32x16_bf16 v[36:51], v[96:99], a[92:95], v[36:51]
  s_waitcnt lgkmcnt(2)
  v_mfma_f32_32x32x16_bf16 v[20:35], v[224:227], v[68:71], v[20:35]
  ds_read_b128 v[80:83], v123 offset:768
  v_mfma_f32_32x32x16_bf16 v[36:51], v[68:71], a[96:99], v[36:51]
  s_waitcnt lgkmcnt(2)
  v_mfma_f32_32x32x16_bf16 v[20:35], v[228:231], v[72:75], v[20:35]
  ds_read_b128 v[84:87], v124 offset:768
  v_mfma_f32_32x32x16_bf16 v[36:51], v[72:75], a[100:103], v[36:51]
  s_waitcnt lgkmcnt(2)
  v_mfma_f32_32x32x16_bf16 v[20:35], v[232:235], v[76:79], v[20:35]
  ds_read_b128 v[88:91], v125 offset:768
  v_mfma_f32_32x32x16_bf16 v[36:51], v[76:79], a[104:107], v[36:51]
  s_waitcnt lgkmcnt(2)
  v_mfma_f32_32x32x16_bf16 v[20:35], v[236:239], v[80:83], v[20:35]
  ds_read_b128 v[92:95], v126 offset:768
  v_mfma_f32_32x32x16_bf16 v[36:51], v[80:83], a[108:111], v[36:51]
  s_waitcnt lgkmcnt(2)
  v_mfma_f32_32x32x16_bf16 v[20:35], v[240:243], v[84:87], v[20:35]
  ds_read_b128 v[96:99], v127 offset:768
  v_mfma_f32_32x32x16_bf16 v[36:51], v[84:87], a[112:115], v[36:51]
  s_waitcnt lgkmcnt(2)
  v_mfma_f32_32x32x16_bf16 v[20:35], v[244:247], v[88:91], v[20:35]
  v_mfma_f32_32x32x16_bf16 v[36:51], v[88:91], a[116:119], v[36:51]
  s_waitcnt lgkmcnt(1)
  v_mfma_f32_32x32x16_bf16 v[20:35], v[248:251], v[92:95], v[20:35]
  v_mfma_f32_32x32x16_bf16 v[36:51], v[92:95], a[120:123], v[36:51]
  s_waitcnt lgkmcnt(0)
  v_mfma_f32_32x32x16_bf16 v[20:35], v[252:255], v[96:99], v[20:35]
  v_mfma_f32_32x32x16_bf16 v[36:51], v[96:99], a[124:127], v[36:51]
  s_nop 3
  v_mul_f32 v20, s24, v20
  v_mul_f32 v21, s24, v21
  v_mul_f32 v22, s24, v22
  v_mul_f32 v23, s24, v23
  v_mul_f32 v24, s24, v24
  v_mul_f32 v25, s24, v25
  v_mul_f32 v26, s24, v26
  v_mul_f32 v27, s24, v27
  v_mul_f32 v28, s24, v28
  v_mul_f32 v29, s24, v29
  v_mul_f32 v30, s24, v30
  v_mul_f32 v31, s24, v31
  v_mul_f32 v32, s24, v32
  v_mul_f32 v33, s24, v33
  v_mul_f32 v34, s24, v34
  v_mul_f32 v35, s24, v35
  v_cvt_pk_bf16_f32 v108, v20, v21
  v_cvt_pk_bf16_f32 v109, v22, v23
  v_cvt_pk_bf16_f32 v110, v28, v29
  v_cvt_pk_bf16_f32 v111, v30, v31
  buffer_store_dwordx4 v[108:111], v8, s[4:7], s77 offen offset:0 sc1
  v_cvt_pk_bf16_f32 v112, v24, v25
  v_cvt_pk_bf16_f32 v113, v26, v27
  v_cvt_pk_bf16_f32 v114, v32, v33
  v_cvt_pk_bf16_f32 v115, v34, v35
  buffer_store_dwordx4 v[112:115], v8, s[4:7], s77 offen offset:512 sc1
  v_cvt_pk_bf16_f32 v100, v36, v37
  v_cvt_pk_bf16_f32 v101, v38, v39
  v_cvt_pk_bf16_f32 v102, v44, v45
  v_cvt_pk_bf16_f32 v103, v46, v47
  buffer_store_dwordx4 v[100:103], v8, s[4:7], s77 offen offset:2048 sc1
  v_cvt_pk_bf16_f32 v104, v40, v41
  v_cvt_pk_bf16_f32 v105, v42, v43
  v_cvt_pk_bf16_f32 v106, v48, v49
  v_cvt_pk_bf16_f32 v107, v50, v51
  buffer_store_dwordx4 v[104:107], v8, s[4:7], s77 offen offset:2560 sc1
  buffer_store_dwordx4 v[108:111], v8, s[4:7], s44 offen offset:0 sc1
  buffer_store_dwordx4 v[112:115], v8, s[4:7], s44 offen offset:512 sc1
  buffer_store_dwordx4 v[100:103], v8, s[4:7], s44 offen offset:2048 sc1
  buffer_store_dwordx4 v[104:107], v8, s[4:7], s44 offen offset:2560 sc1
  buffer_load_dwordx4 v[68:71], v7, s[8:11], s35 offen offset:1024
  buffer_load_dwordx4 v[72:75], v7, s[8:11], s35 offen offset:2048
  buffer_load_dwordx4 v[76:79], v7, s[8:11], s35 offen offset:3072
  s_add_u32 s35, s35, 4096
  buffer_load_dwordx4 v[80:83], v7, s[8:11], s35 offen offset:0
  buffer_load_dwordx4 v[84:87], v7, s[8:11], s35 offen offset:1024
  buffer_load_dwordx4 v[88:91], v7, s[8:11], s35 offen offset:2048
  buffer_load_dwordx4 v[92:95], v7, s[8:11], s35 offen offset:3072
  s_add_u32 s35, s35, 4096
  buffer_load_dwordx4 v[96:99], v7, s[8:11], s35 offen offset:0
  buffer_load_dwordx4 v[100:103], v7, s[8:11], s35 offen offset:1024
  buffer_load_dwordx4 v[104:107], v7, s[8:11], s35 offen offset:2048
  buffer_load_dwordx4 v[108:111], v7, s[8:11], s35 offen offset:3072
  s_add_u32 s35, s35, 4096
  buffer_load_dwordx4 v[112:115], v7, s[8:11], s35 offen offset:0
  buffer_load_dwordx4 v[48:51], v7, s[8:11], s35 offen offset:1024
  s_mov_b32 vcc_lo, 0xaaaaaaaa
  s_mov_b32 vcc_hi, 0xaaaaaaaa
  v_mov_b32 v3, 0xffff
  v_mov_b32 v24, 0xffff0000
  v_cndmask_b32 v3, v3, v24, vcc
  s_mov_b32 vcc_lo, 0x3030303
  s_mov_b32 vcc_hi, 0x3030303
  v_cndmask_b32 v24, 0, v3, vcc
  s_mov_b32 vcc_lo, 0xc0c0c0c
  s_mov_b32 vcc_hi, 0xc0c0c0c
  v_cndmask_b32 v25, 0, v3, vcc
  s_mov_b32 vcc_lo, 0x30303030
  s_mov_b32 vcc_hi, 0x30303030
  v_cndmask_b32 v26, 0, v3, vcc
  s_mov_b32 vcc_lo, 0xc0c0c0c0
  s_mov_b32 vcc_hi, 0xc0c0c0c0
  v_cndmask_b32 v27, 0, v3, vcc
  s_mov_b32 s30, 0x01000100
  s_mov_b32 s31, 0x03020302
  s_mul_i32 s26, s17, 23552
  s_add_u32 s26, s26, 65536
  v_add_u32 v5, s26, v0
  v_add_u32 v2, s37, v0
  ds_read_b128 v[36:39], v5 offset:0
  ds_read_b128 v[40:43], v5 offset:1024
  ds_read_b128 v[44:47], v5 offset:2048
  ds_read_b128 v[12:15], v5 offset:3072
  ds_read_b128 v[16:19], v5 offset:4096
  ds_read_b128 v[120:123], v5 offset:5120
  ds_read_b128 v[124:127], v5 offset:6144
  s_waitcnt vmcnt(32)
  s_waitcnt vmcnt(17)
  s_mov_b64 exec, 1
  buffer_store_dword v4, off, s[4:7], s51 sc1
  s_mov_b64 exec, -1
  v_perm_b32 v3, v52, v52, s30
  v_and_b32 v20, v24, v3
  v_and_b32 v21, v25, v3
  v_and_b32 v22, v26, v3
  v_and_b32 v23, v27, v3
  s_waitcnt lgkmcnt(5)
  s_nop 0
  v_mfma_f32_16x16x32_bf16 v[28:31], v[20:23], v[36:39], 0
  ds_read_b128 v[36:39], v5 offset:7168
  v_mfma_f32_16x16x32_bf16 v[32:35], v[20:23], v[40:43], 0
  ds_read_b128 v[40:43], v5 offset:8192
  v_perm_b32 v3, v52, v52, s31
  v_and_b32 v20, v24, v3
  v_and_b32 v21, v25, v3
  v_and_b32 v22, v26, v3
  v_and_b32 v23, v27, v3
  s_waitcnt lgkmcnt(5)
  s_nop 0
  v_mfma_f32_16x16x32_bf16 v[28:31], v[20:23], v[44:47], v[28:31]
  ds_read_b128 v[44:47], v5 offset:9216
  v_mfma_f32_16x16x32_bf16 v[32:35], v[20:23], v[12:15], v[32:35]
  ds_read_b128 v[12:15], v5 offset:10240
  v_perm_b32 v3, v53, v53, s30
  v_and_b32 v20, v24, v3
  v_and_b32 v21, v25, v3
  v_and_b32 v22, v26, v3
  v_and_b32 v23, v27, v3
  s_waitcnt lgkmcnt(5)
  s_nop 0
  v_mfma_f32_16x16x32_bf16 v[28:31], v[20:23], v[16:19], v[28:31]
  ds_read_b128 v[16:19], v5 offset:11264
  v_mfma_f32_16x16x32_bf16 v[32:35], v[20:23], v[120:123], v[32:35]
  ds_read_b128 v[120:123], v5 offset:12288
  v_perm_b32 v3, v53, v53, s31
  v_and_b32 v20, v24, v3
  v_and_b32 v21, v25, v3
  v_and_b32 v22, v26, v3
  v_and_b32 v23, v27, v3
  s_waitcnt lgkmcnt(5)
  s_nop 0
  v_mfma_f32_16x16x32_bf16 v[28:31], v[20:23], v[124:127], v[28:31]
  ds_read_b128 v[124:127], v5 offset:13312
  v_mfma_f32_16x16x32_bf16 v[32:35], v[20:23], v[36:39], v[32:35]
  ds_read_b128 v[36:39], v5 offset:14336
  v_perm_b32 v3, v54, v54, s30
  v_and_b32 v20, v24, v3
  v_and_b32 v21, v25, v3
  v_and_b32 v22, v26, v3
  v_and_b32 v23, v27, v3
  s_waitcnt lgkmcnt(5)
  s_nop 0
  v_mfma_f32_16x16x32_bf16 v[28:31], v[20:23], v[40:43], v[28:31]
  ds_read_b128 v[40:43], v5 offset:15360
  v_mfma_f32_16x16x32_bf16 v[32:35], v[20:23], v[44:47], v[32:35]
  ds_read_b128 v[44:47], v5 offset:16384
  v_perm_b32 v3, v54, v54, s31
  v_and_b32 v20, v24, v3
  v_and_b32 v21, v25, v3
  v_and_b32 v22, v26, v3
  v_and_b32 v23, v27, v3
  s_waitcnt lgkmcnt(5)
  s_nop 0
  v_mfma_f32_16x16x32_bf16 v[28:31], v[20:23], v[12:15], v[28:31]
  ds_read_b128 v[12:15], v5 offset:17408
  v_mfma_f32_16x16x32_bf16 v[32:35], v[20:23], v[16:19], v[32:35]
  ds_read_b128 v[16:19], v5 offset:18432
  v_perm_b32 v3, v55, v55, s30
  v_and_b32 v20, v24, v3
  v_and_b32 v21, v25, v3
  v_and_b32 v22, v26, v3
  v_and_b32 v23, v27, v3
  s_waitcnt lgkmcnt(5)
  s_nop 0
  v_mfma_f32_16x16x32_bf16 v[28:31], v[20:23], v[120:123], v[28:31]
  ds_read_b128 v[120:123], v5 offset:19456
  v_mfma_f32_16x16x32_bf16 v[32:35], v[20:23], v[124:127], v[32:35]
  ds_read_b128 v[124:127], v5 offset:20480
  v_perm_b32 v3, v55, v55, s31
  v_and_b32 v20, v24, v3
  v_and_b32 v21, v25, v3
  v_and_b32 v22, v26, v3
  v_and_b32 v23, v27, v3
  s_waitcnt lgkmcnt(5)
  s_nop 0
  v_mfma_f32_16x16x32_bf16 v[28:31], v[20:23], v[36:39], v[28:31]
  ds_read_b128 v[36:39], v5 offset:21504
  v_mfma_f32_16x16x32_bf16 v[32:35], v[20:23], v[40:43], v[32:35]
  ds_read_b128 v[40:43], v5 offset:22528
  v_perm_b32 v3, v56, v56, s30
  v_and_b32 v20, v24, v3
  v_and_b32 v21, v25, v3
  v_and_b32 v22, v26, v3
  v_and_b32 v23, v27, v3
  s_waitcnt lgkmcnt(5)
  s_nop 0
  v_mfma_f32_16x16x32_bf16 v[28:31], v[20:23], v[44:47], v[28:31]
  ds_read_b128 v[44:47], v2 offset:0
  v_mfma_f32_16x16x32_bf16 v[32:35], v[20:23], v[12:15], v[32:35]
  ds_read_b128 v[12:15], v2 offset:1024
  v_perm_b32 v3, v56, v56, s31
  v_and_b32 v20, v24, v3
  v_and_b32 v21, v25, v3
  v_and_b32 v22, v26, v3
  v_and_b32 v23, v27, v3
  s_waitcnt lgkmcnt(5)
  s_nop 0
  v_mfma_f32_16x16x32_bf16 v[28:31], v[20:23], v[16:19], v[28:31]
  ds_read_b128 v[16:19], v2 offset:2048
  v_mfma_f32_16x16x32_bf16 v[32:35], v[20:23], v[120:123], v[32:35]
  ds_read_b128 v[120:123], v2 offset:3072
  v_perm_b32 v3, v57, v57, s30
  v_and_b32 v20, v24, v3
  v_and_b32 v21, v25, v3
  v_and_b32 v22, v26, v3
  v_and_b32 v23, v27, v3
  s_waitcnt lgkmcnt(5)
  s_nop 0
  v_mfma_f32_16x16x32_bf16 v[28:31], v[20:23], v[124:127], v[28:31]
  ds_read_b128 v[124:127], v2 offset:4096
  v_mfma_f32_16x16x32_bf16 v[32:35], v[20:23], v[36:39], v[32:35]
  ds_read_b128 v[36:39], v2 offset:5120
  v_perm_b32 v3, v57, v57, s31
  v_and_b32 v20, v24, v3
  v_and_b32 v21, v25, v3
  v_and_b32 v22, v26, v3
  v_and_b32 v23, v27, v3
  s_waitcnt lgkmcnt(5)
  s_nop 0
  v_mfma_f32_16x16x32_bf16 v[28:31], v[20:23], v[40:43], v[28:31]
  ds_read_b128 v[40:43], v2 offset:6144
  v_mfma_f32_16x16x32_bf16 v[32:35], v[20:23], v[44:47], v[32:35]
  ds_read_b128 v[44:47], v2 offset:7168
  v_perm_b32 v3, v58, v58, s30
  v_and_b32 v20, v24, v3
  v_and_b32 v21, v25, v3
  v_and_b32 v22, v26, v3
  v_and_b32 v23, v27, v3
  s_waitcnt lgkmcnt(5)
  s_nop 0
  v_mfma_f32_16x16x32_bf16 v[28:31], v[20:23], v[12:15], v[28:31]
  v_mfma_f32_16x16x32_bf16 v[32:35], v[20:23], v[16:19], v[32:35]
  v_perm_b32 v3, v58, v58, s31
  v_and_b32 v20, v24, v3
  v_and_b32 v21, v25, v3
  v_and_b32 v22, v26, v3
  v_and_b32 v23, v27, v3
  s_waitcnt lgkmcnt(3)
  s_nop 0
  v_mfma_f32_16x16x32_bf16 v[28:31], v[20:23], v[120:123], v[28:31]
  v_mfma_f32_16x16x32_bf16 v[32:35], v[20:23], v[124:127], v[32:35]
  v_perm_b32 v3, v59, v59, s30
  v_and_b32 v20, v24, v3
  v_and_b32 v21, v25, v3
  v_and_b32 v22, v26, v3
  v_and_b32 v23, v27, v3
  s_waitcnt lgkmcnt(1)
  s_nop 0
  v_mfma_f32_16x16x32_bf16 v[28:31], v[20:23], v[36:39], v[28:31]
  v_mfma_f32_16x16x32_bf16 v[32:35], v[20:23], v[40:43], v[32:35]
  v_perm_b32 v3, v59, v59, s31
  v_and_b32 v20, v24, v3
  v_and_b32 v21, v25, v3
  v_and_b32 v22, v26, v3
  v_and_b32 v23, v27, v3
  s_waitcnt lgkmcnt(0)
  s_nop 0
  v_mfma_f32_16x16x32_bf16 v[28:31], v[20:23], v[44:47], v[28:31]
  v_mfma_f32_16x16x32_bf16 v[32:35], v[20:23], v[60:63], v[32:35]
  v_lshrrev_b32 v2, 8, v0
  v_and_b32 v3, 0xf0, v0
  v_lshlrev_b32 v3, 1, v3
  v_and_b32 v5, 1, v2
  v_lshl_add_u32 v5, v5, 4, v3
  v_add_u32 v5, s37, v5
  s_mov_b32 exec_lo, 0x00ff00ff
  s_mov_b32 exec_hi, 0xff00ff00
  ds_write_b128 v5, v[28:31]
  ds_write_b128 v5, v[32:35] offset:512
  s_mov_b64 exec, -1
  s_xor_b32 s26, s50, 32768
  v_add_u32 v5, s26, v1
  v_lshl_add_u32 v3, v2, 4, v3
  s_waitcnt lgkmcnt(0)
  s_barrier
  ds_read2st64_b32 v[36:37], v5 offset0:0 offset1:1
  ds_read2st64_b32 v[52:53], v5 offset0:2 offset1:3
  ds_read2st64_b32 v[38:39], v5 offset0:32 offset1:33
  ds_read2st64_b32 v[54:55], v5 offset0:34 offset1:35
  ds_read2st64_b32 v[40:41], v5 offset0:64 offset1:65
  ds_read2st64_b32 v[56:57], v5 offset0:66 offset1:67
  ds_read2st64_b32 v[42:43], v5 offset0:96 offset1:97
  ds_read2st64_b32 v[58:59], v5 offset0:98 offset1:99
  s_waitcnt lgkmcnt(0)
  v_add_f32 v36, v36, v40
  v_add_f32 v37, v37, v41
  v_add_f32 v38, v38, v42
  v_add_f32 v39, v39, v43
  v_add_f32 v52, v52, v56
  v_add_f32 v53, v53, v57
  v_add_f32 v54, v54, v58
  v_add_f32 v55, v55, v59
  v_add_f32 v36, v36, v38
  v_add_f32 v37, v37, v39
  v_add_f32 v52, v52, v54
  v_add_f32 v53, v53, v55
  v_add_f32 v36, v36, v37
  v_add_f32 v52, v52, v53
  v_cvt_pk_bf16_f32 v36, 0, v36
  v_cvt_pk_bf16_f32 v52, 0, v52
  v_mul_f32 v40, 0xbfb8aa3b, v36
  v_exp_f32 v40, v40
  s_nop 0
  v_add_f32 v40, 1.0, v40
  v_rcp_f32 v40, v40
  s_nop 0
  v_mul_f32 v36, v36, v40
  v_cvt_pk_bf16_f32 v36, 0, v36
  v_mul_f32 v36, v36, v52
  v_cvt_pk_bf16_f32 v36, v36, v36
  s_lshl_b32 s26, s17, 8
  s_add_u32 s26, s26, 161792
  v_add_u32 v5, s26, v1
  ds_write_b32 v5, v36
  v_mul_u32_u24 v5, 56, v2
  v_add_u32 v5, s26, v5
  ds_read_b64 v[36:37], v5 offset:0
  ds_read_b64 v[38:39], v5 offset:8
  ds_read_b64 v[40:41], v5 offset:16
  ds_read_b64 v[42:43], v5 offset:24
  ds_read_b64 v[44:45], v5 offset:32
  ds_read_b64 v[46:47], v5 offset:40
  ds_read_b64 v[52:53], v5 offset:48
  s_waitcnt lgkmcnt(0)
  v_and_b32 v20, v24, v36
  v_and_b32 v21, v25, v36
  v_and_b32 v22, v26, v36
  v_and_b32 v23, v27, v36
  s_nop 0
  s_nop 0
  v_mfma_f32_16x16x32_bf16 v[28:31], v[20:23], v[64:67], 0
  v_and_b32 v32, v24, v37
  v_and_b32 v33, v25, v37
  v_and_b32 v34, v26, v37
  v_and_b32 v35, v27, v37
  s_waitcnt vmcnt(13)
  s_nop 0
  v_mfma_f32_16x16x32_bf16 v[28:31], v[32:35], v[68:71], v[28:31]
  v_and_b32 v20, v24, v38
  v_and_b32 v21, v25, v38
  v_and_b32 v22, v26, v38
  v_and_b32 v23, v27, v38
  s_waitcnt vmcnt(12)
  s_nop 0
  v_mfma_f32_16x16x32_bf16 v[28:31], v[20:23], v[72:75], v[28:31]
  v_and_b32 v32, v24, v39
  v_and_b32 v33, v25, v39
  v_and_b32 v34, v26, v39
  v_and_b32 v35, v27, v39
  s_waitcnt vmcnt(11)
  s_nop 0
  v_mfma_f32_16x16x32_bf16 v[28:31], v[32:35], v[76:79], v[28:31]
  v_and_b32 v20, v24, v40
  v_and_b32 v21, v25, v40
  v_and_b32 v22, v26, v40
  v_and_b32 v23, v27, v40
  s_waitcnt vmcnt(10)
  s_nop 0
  v_mfma_f32_16x16x32_bf16 v[28:31], v[20:23], v[80:83], v[28:31]
  v_and_b32 v32, v24, v41
  v_and_b32 v33, v25, v41
  v_and_b32 v34, v26, v41
  v_and_b32 v35, v27, v41
  s_waitcnt vmcnt(9)
  s_nop 0
  v_mfma_f32_16x16x32_bf16 v[28:31], v[32:35], v[84:87], v[28:31]
  v_and_b32 v20, v24, v42
  v_and_b32 v21, v25, v42
  v_and_b32 v22, v26, v42
  v_and_b32 v23, v27, v42
  s_waitcnt vmcnt(8)
  s_nop 0
  v_mfma_f32_16x16x32_bf16 v[28:31], v[20:23], v[88:91], v[28:31]
  v_and_b32 v32, v24, v43
  v_and_b32 v33, v25, v43
  v_and_b32 v34, v26, v43
  v_and_b32 v35, v27, v43
  s_waitcnt vmcnt(7)
  s_nop 0
  v_mfma_f32_16x16x32_bf16 v[28:31], v[32:35], v[92:95], v[28:31]
  v_and_b32 v20, v24, v44
  v_and_b32 v21, v25, v44
  v_and_b32 v22, v26, v44
  v_and_b32 v23, v27, v44
  s_waitcnt vmcnt(6)
  s_nop 0
  v_mfma_f32_16x16x32_bf16 v[28:31], v[20:23], v[96:99], v[28:31]
  v_and_b32 v32, v24, v45
  v_and_b32 v33, v25, v45
  v_and_b32 v34, v26, v45
  v_and_b32 v35, v27, v45
  s_waitcnt vmcnt(5)
  s_nop 0
  v_mfma_f32_16x16x32_bf16 v[28:31], v[32:35], v[100:103], v[28:31]
  v_and_b32 v20, v24, v46
  v_and_b32 v21, v25, v46
  v_and_b32 v22, v26, v46
  v_and_b32 v23, v27, v46
  s_waitcnt vmcnt(4)
  s_nop 0
  v_mfma_f32_16x16x32_bf16 v[28:31], v[20:23], v[104:107], v[28:31]
  v_and_b32 v32, v24, v47
  v_and_b32 v33, v25, v47
  v_and_b32 v34, v26, v47
  v_and_b32 v35, v27, v47
  s_waitcnt vmcnt(3)
  s_nop 0
  v_mfma_f32_16x16x32_bf16 v[28:31], v[32:35], v[108:111], v[28:31]
  v_and_b32 v20, v24, v52
  v_and_b32 v21, v25, v52
  v_and_b32 v22, v26, v52
  v_and_b32 v23, v27, v52
  s_waitcnt vmcnt(2)
  s_nop 0
  v_mfma_f32_16x16x32_bf16 v[28:31], v[20:23], v[112:115], v[28:31]
  v_and_b32 v32, v24, v53
  v_and_b32 v33, v25, v53
  v_and_b32 v34, v26, v53
  v_and_b32 v35, v27, v53
  s_waitcnt vmcnt(1)
  s_nop 0
  v_mfma_f32_16x16x32_bf16 v[28:31], v[32:35], v[48:51], v[28:31]
  v_lshrrev_b32 v3, 1, v3
  s_lshl_b32 s26, s46, 7
  s_add_u32 s26, s26, s57
  s_lshl_b32 s26, s26, 8
  s_add_u32 s26, s26, 244318208
  s_nop 2
  v_cvt_pk_bf16_f32 v28, v28, v29
  v_cvt_pk_bf16_f32 v29, v30, v31
  v_min_u32 v28, -2, v28
  v_min_u32 v29, -2, v29
  s_mov_b32 exec_hi, 0
  buffer_store_dwordx2 v[28:29], v3, s[4:7], s26 offen sc1
  s_mov_b32 exec_hi, -1
  v_lshrrev_b32 v7, 7, v0
  v_lshlrev_b32 v7, 12, v7
  v_and_b32 v2, 1023, v9
  s_lshl_b32 s26, s17, 10
  v_add3_u32 v7, v7, v2, s26
  v_mov_b32 v116, 0
  v_lshrrev_b32 v96, 9, v0
  v_lshlrev_b32 v96, 4, v96
  v_and_b32 v97, 0xf0, v0
  v_xor_b32 v96, v96, v97
  v_and_b32 v97, 0x1f0, v0
  v_lshl_add_u32 v96, v97, 6, v96
  v_add_u32 v96, s50, v96
  v_xor_b32 v120, 0, v96
  v_xor_b32 v121, 32, v96
  v_xor_b32 v122, 64, v96
  v_xor_b32 v123, 96, v96
  v_xor_b32 v124, 128, v96
  v_xor_b32 v125, 160, v96
  v_xor_b32 v126, 192, v96
  v_xor_b32 v127, 224, v96
  s_and_b32 s26, s17, 1
  s_lshl_b32 s26, s26, 7
  v_xor_b32 v96, s26, v0
  v_xor_b32 v12, 0, v96
  v_xor_b32 v13, 16, v96
  v_xor_b32 v14, 32, v96
  v_xor_b32 v15, 48, v96
  v_xor_b32 v16, 64, v96
  v_xor_b32 v17, 80, v96
  v_xor_b32 v18, 96, v96
  v_xor_b32 v19, 112, v96
  s_cmp_lt_u32 s47, 64
  s_cselect_b32 s26, 2, 0
  s_add_u32 s26, s26, s47
  s_lshl_b32 s26, s26, 12
  s_add_u32 s26, s26, 243261440
  s_mov_b64 exec, 0xffffff
  buffer_load_dword v116, v7, s[4:7], s26 offen sc1
  s_mov_b64 exec, -1
  s_lshl_b32 s26, s61, 21
  s_lshl_b32 s27, s59, 10
  s_add_u32 s26, s26, s27
  s_add_u32 s27, s26, 20971520
  s_add_u32 s28, s26, 27262976
  s_lshl_b32 s26, s46, 7
  s_add_u32 s26, s26, s17
  s_lshl_b32 s26, s26, 8
  s_add_u32 s26, s26, 244318208
  v_lshrrev_b32 v2, 8, v0
  v_and_b32 v3, 0xf0, v0
  v_lshl_add_u32 v5, v2, 10, v3
  buffer_load_dwordx4 v[108:111], v0, s[4:7], s27 offen sc1
  buffer_load_dwordx4 v[112:115], v0, s[4:7], s28 offen sc1
  s_mov_b32 s53, 0
  ds_read_b128 v[68:71], v120 offset:0
  ds_read_b128 v[72:75], v121 offset:0
  ds_read_b128 v[76:79], v122 offset:0
  ds_read_b128 v[80:83], v123 offset:0
  s_waitcnt lgkmcnt(2)
  v_mfma_f32_32x32x16_bf16 v[52:67], a[128:131], v[68:71], 0
  ds_read_b128 v[84:87], v124 offset:0
  ds_read_b128 v[88:91], v125 offset:0
  ds_read_b128 v[92:95], v126 offset:0
  v_mfma_f32_32x32x16_bf16 v[52:67], a[132:135], v[72:75], v[52:67]
  ds_read_b128 v[96:99], v127 offset:0
  s_waitcnt lgkmcnt(4)
  v_mfma_f32_32x32x16_bf16 v[52:67], a[136:139], v[76:79], v[52:67]
  ds_read_b128 v[68:71], v120 offset:256
  v_mfma_f32_32x32x16_bf16 v[52:67], a[140:143], v[80:83], v[52:67]
  ds_read_b128 v[72:75], v121 offset:256
  s_waitcnt lgkmcnt(4)
  v_mfma_f32_32x32x16_bf16 v[52:67], a[144:147], v[84:87], v[52:67]
  ds_read_b128 v[76:79], v122 offset:256
  v_mfma_f32_32x32x16_bf16 v[52:67], a[148:151], v[88:91], v[52:67]
  ds_read_b128 v[80:83], v123 offset:256
  s_waitcnt lgkmcnt(4)
  v_mfma_f32_32x32x16_bf16 v[52:67], a[152:155], v[92:95], v[52:67]
  ds_read_b128 v[84:87], v124 offset:256
  v_mfma_f32_32x32x16_bf16 v[52:67], a[156:159], v[96:99], v[52:67]
  ds_read_b128 v[88:91], v125 offset:256
  s_waitcnt lgkmcnt(4)
  v_mfma_f32_32x32x16_bf16 v[52:67], a[160:163], v[68:71], v[52:67]
  ds_read_b128 v[92:95], v126 offset:256
  v_mfma_f32_32x32x16_bf16 v[52:67], a[164:167], v[72:75], v[52:67]
  ds_read_b128 v[96:99], v127 offset:256
  s_waitcnt lgkmcnt(4)
  v_mfma_f32_32x32x16_bf16 v[52:67], a[168:171], v[76:79], v[52:67]
  ds_read_b128 v[68:71], v120 offset:512
  v_mfma_f32_32x32x16_bf16 v[52:67], a[172:175], v[80:83], v[52:67]
  ds_read_b128 v[72:75], v121 offset:512
  s_waitcnt lgkmcnt(4)
  v_mfma_f32_32x32x16_bf16 v[52:67], a[176:179], v[84:87], v[52:67]
  ds_read_b128 v[76:79], v122 offset:512
  v_mfma_f32_32x32x16_bf16 v[52:67], a[180:183], v[88:91], v[52:67]
  ds_read_b128 v[80:83], v123 offset:512
  s_waitcnt lgkmcnt(4)
  v_mfma_f32_32x32x16_bf16 v[52:67], a[184:187], v[92:95], v[52:67]
  ds_read_b128 v[84:87], v124 offset:512
  v_mfma_f32_32x32x16_bf16 v[52:67], a[188:191], v[96:99], v[52:67]
  ds_read_b128 v[88:91], v125 offset:512
  s_waitcnt lgkmcnt(4)
  v_mfma_f32_32x32x16_bf16 v[52:67], a[192:195], v[68:71], v[52:67]
  ds_read_b128 v[92:95], v126 offset:512
  v_mfma_f32_32x32x16_bf16 v[52:67], a[196:199], v[72:75], v[52:67]
  ds_read_b128 v[96:99], v127 offset:512
  s_waitcnt lgkmcnt(4)
  v_mfma_f32_32x32x16_bf16 v[52:67], a[200:203], v[76:79], v[52:67]
  ds_read_b128 v[68:71], v120 offset:768
  v_mfma_f32_32x32x16_bf16 v[52:67], a[204:207], v[80:83], v[52:67]
  ds_read_b128 v[72:75], v121 offset:768
  s_waitcnt lgkmcnt(4)
  v_mfma_f32_32x32x16_bf16 v[52:67], a[208:211], v[84:87], v[52:67]
  ds_read_b128 v[76:79], v122 offset:768
  v_mfma_f32_32x32x16_bf16 v[52:67], a[212:215], v[88:91], v[52:67]
  ds_read_b128 v[80:83], v123 offset:768
  s_waitcnt lgkmcnt(4)
  v_mfma_f32_32x32x16_bf16 v[52:67], a[216:219], v[92:95], v[52:67]
  ds_read_b128 v[84:87], v124 offset:768
  v_mfma_f32_32x32x16_bf16 v[52:67], a[220:223], v[96:99], v[52:67]
  ds_read_b128 v[88:91], v125 offset:768
  s_waitcnt lgkmcnt(4)
  v_mfma_f32_32x32x16_bf16 v[52:67], a[224:227], v[68:71], v[52:67]
  ds_read_b128 v[92:95], v126 offset:768
  v_mfma_f32_32x32x16_bf16 v[52:67], a[228:231], v[72:75], v[52:67]
  ds_read_b128 v[96:99], v127 offset:768
  s_waitcnt lgkmcnt(4)
  v_mfma_f32_32x32x16_bf16 v[52:67], a[232:235], v[76:79], v[52:67]
  v_mfma_f32_32x32x16_bf16 v[52:67], a[236:239], v[80:83], v[52:67]
  s_waitcnt lgkmcnt(2)
  v_mfma_f32_32x32x16_bf16 v[52:67], a[240:243], v[84:87], v[52:67]
  v_mfma_f32_32x32x16_bf16 v[52:67], a[244:247], v[88:91], v[52:67]
  s_waitcnt lgkmcnt(0)
  v_mfma_f32_32x32x16_bf16 v[52:67], a[248:251], v[92:95], v[52:67]
  v_mfma_f32_32x32x16_bf16 v[52:67], a[252:255], v[96:99], v[52:67]
  s_lshl_b32 s28, s52, 11
  s_add_u32 s77, s28, 159383552
  s_add_u32 s28, s28, 142606336
  s_add_u32 s51, s51, 262144
  s_nop 7
  v_cvt_pk_bf16_f32 v100, v52, v53
  v_cvt_pk_bf16_f32 v101, v54, v55
  v_cvt_pk_bf16_f32 v102, v60, v61
  v_cvt_pk_bf16_f32 v103, v62, v63
  v_cvt_pk_bf16_f32 v104, v56, v57
  v_cvt_pk_bf16_f32 v105, v58, v59
  v_cvt_pk_bf16_f32 v106, v64, v65
  v_cvt_pk_bf16_f32 v107, v66, v67
m_w_103:
  s_add_u32 s27, s26, 0
  buffer_load_dwordx4 v[20:23], v5, s[4:7], s27 offen sc1
  s_add_u32 s27, s26, 4096
  buffer_load_dwordx4 v[24:27], v5, s[4:7], s27 offen sc1
  s_add_u32 s27, s26, 8192
  buffer_load_dwordx4 v[28:31], v5, s[4:7], s27 offen sc1
  s_add_u32 s27, s26, 12288
  buffer_load_dwordx4 v[32:35], v5, s[4:7], s27 offen sc1
  s_add_u32 s27, s26, 16384
  buffer_load_dwordx4 v[36:39], v5, s[4:7], s27 offen sc1
  s_add_u32 s27, s26, 20480
  buffer_load_dwordx4 v[40:43], v5, s[4:7], s27 offen sc1
  s_add_u32 s27, s26, 24576
  buffer_load_dwordx4 v[44:47], v5, s[4:7], s27 offen sc1
  s_add_u32 s27, s26, 28672
  buffer_load_dwordx4 v[48:51], v5, s[4:7], s27 offen sc1
  s_add_u32 s53, s53, 1
  s_cmp_gt_u32 s53, 1048576
  s_cbranch_scc1 q_fail_90
  s_mov_b32 vcc_lo, 0xaaaaaaaa
  s_mov_b32 vcc_hi, 0xaaaaaaaa
  v_mov_b32 v72, 0x3f80
  v_mov_b32 v68, 1.0
  v_cndmask_b32 v72, v72, v68, vcc
  s_mov_b32 vcc_lo, 0x30003
  s_mov_b32 vcc_hi, 0x30003
  v_cndmask_b32 v68, 0, v72, vcc
  s_mov_b32 vcc_lo, 0xc000c
  s_mov_b32 vcc_hi, 0xc000c
  v_cndmask_b32 v69, 0, v72, vcc
  s_mov_b32 vcc_lo, 0x300030
  s_mov_b32 vcc_hi, 0x300030
  v_cndmask_b32 v70, 0, v72, vcc
  s_mov_b32 vcc_lo, 0xc000c0
  s_mov_b32 vcc_hi, 0xc000c0
  v_cndmask_b32 v71, 0, v72, vcc
  s_waitcnt vmcnt(7)
  s_nop 0
  v_mfma_f32_16x16x32_bf16 v[72:75], v[68:71], v[20:23], 0
  v_max3_u32 v80, v20, v21, 0
  v_max3_u32 v80, v22, v23, v80
  s_waitcnt vmcnt(6)
  v_mfma_f32_16x16x32_bf16 v[72:75], v[68:71], v[24:27], v[72:75]
  v_max3_u32 v80, v24, v25, v80
  v_max3_u32 v80, v26, v27, v80
  s_waitcnt vmcnt(5)
  v_mfma_f32_16x16x32_bf16 v[72:75], v[68:71], v[28:31], v[72:75]
  v_max3_u32 v80, v28, v29, v80
  v_max3_u32 v80, v30, v31, v80
  s_waitcnt vmcnt(4)
  v_mfma_f32_16x16x32_bf16 v[72:75], v[68:71], v[32:35], v[72:75]
  v_max3_u32 v80, v32, v33, v80
  v_max3_u32 v80, v34, v35, v80
  s_waitcnt vmcnt(3)
  v_mfma_f32_16x16x32_bf16 v[72:75], v[68:71], v[36:39], v[72:75]
  v_max3_u32 v80, v36, v37, v80
  v_max3_u32 v80, v38, v39, v80
  s_waitcnt vmcnt(2)
  v_mfma_f32_16x16x32_bf16 v[72:75], v[68:71], v[40:43], v[72:75]
  v_max3_u32 v80, v40, v41, v80
  v_max3_u32 v80, v42, v43, v80
  s_waitcnt vmcnt(1)
  v_mfma_f32_16x16x32_bf16 v[72:75], v[68:71], v[44:47], v[72:75]
  v_max3_u32 v80, v44, v45, v80
  v_max3_u32 v80, v46, v47, v80
  s_waitcnt vmcnt(0)
  v_mfma_f32_16x16x32_bf16 v[72:75], v[68:71], v[48:51], v[72:75]
  v_max3_u32 v80, v48, v49, v80
  v_max3_u32 v80, v50, v51, v80
  v_cmp_eq_u32 vcc, -1, v80
  s_cbranch_vccnz m_w_103
  v_lshlrev_b32 v3, 1, v3
  v_lshl_add_u32 v3, v2, 4, v3
  s_lshl_b32 s26, s17, 9
  s_add_u32 s26, s26, 159744
  v_add_u32 v3, s26, v3
  s_mov_b32 exec_hi, 0
  ds_write_b128 v3, v[72:75]
  s_mov_b32 exec_hi, -1
  v_lshlrev_b32 v3, 1, v0
  v_add_u32 v3, 159744, v3
  buffer_store_dwordx4 v[100:103], v8, s[4:7], s77 offen offset:0 sc1
  buffer_store_dwordx4 v[104:107], v8, s[4:7], s77 offen offset:512 sc1
  buffer_store_dwordx4 v[100:103], v8, s[4:7], s28 offen offset:0 sc1
  buffer_store_dwordx4 v[104:107], v8, s[4:7], s28 offen offset:512 sc1
  v_lshlrev_b32 v80, 16, v108
  v_and_b32 v81, 0xffff0000, v108
  v_lshlrev_b32 v82, 16, v109
  v_and_b32 v83, 0xffff0000, v109
  v_lshlrev_b32 v84, 16, v110
  v_and_b32 v85, 0xffff0000, v110
  v_lshlrev_b32 v86, 16, v111
  v_and_b32 v87, 0xffff0000, v111
  v_lshlrev_b32 v88, 16, v112
  v_and_b32 v89, 0xffff0000, v112
  v_lshlrev_b32 v90, 16, v113
  v_and_b32 v91, 0xffff0000, v113
  v_lshlrev_b32 v92, 16, v114
  v_and_b32 v93, 0xffff0000, v114
  v_lshlrev_b32 v94, 16, v115
  v_and_b32 v95, 0xffff0000, v115
  s_waitcnt lgkmcnt(0)
  s_barrier
  s_cmp_lg_u32 s17, 0
  s_cbranch_scc1 m_done_102
  ds_read_b128 v[72:75], v3
  ds_read_b128 v[76:79], v3 offset:16
  s_and_b32 s29, s58, 0xffff0000
  s_xor_b32 s27, s29, 0x80000000
  s_xor_b32 s28, s29, 0xffff0000
  s_bitcmp1_b32 s29, 31
  s_cselect_b32 s29, s27, s28
  v_mov_b32 v108, s29
  v_mul_f32 v108, 0xbfb8aa3b, v108
  v_exp_f32 v108, v108
  s_nop 0
  v_add_f32 v108, 1.0, v108
  v_rcp_f32 v108, v108
  s_nop 0
  v_cvt_pk_bf16_f32 v108, 0, v108
  s_waitcnt lgkmcnt(0)
  v_cvt_pk_bf16_f32 v72, 0, v72
  v_cvt_pk_bf16_f32 v73, 0, v73
  v_cvt_pk_bf16_f32 v74, 0, v74
  v_cvt_pk_bf16_f32 v75, 0, v75
  v_cvt_pk_bf16_f32 v76, 0, v76
  v_cvt_pk_bf16_f32 v77, 0, v77
  v_cvt_pk_bf16_f32 v78, 0, v78
  v_cvt_pk_bf16_f32 v79, 0, v79
  v_mul_f32 v72, v72, v108
  v_mul_f32 v73, v73, v108
  v_mul_f32 v74, v74, v108
  v_mul_f32 v75, v75, v108
  v_mul_f32 v76, v76, v108
  v_mul_f32 v77, v77, v108
  v_mul_f32 v78, v78, v108
  v_mul_f32 v79, v79, v108
  v_cvt_pk_bf16_f32 v72, 0, v72
  v_cvt_pk_bf16_f32 v73, 0, v73
  v_cvt_pk_bf16_f32 v74, 0, v74
  v_cvt_pk_bf16_f32 v75, 0, v75
  v_cvt_pk_bf16_f32 v76, 0, v76
  v_cvt_pk_bf16_f32 v77, 0, v77
  v_cvt_pk_bf16_f32 v78, 0, v78
  v_cvt_pk_bf16_f32 v79, 0, v79
  v_add_f32 v72, v72, v88
  v_add_f32 v73, v73, v89
  v_add_f32 v74, v74, v90
  v_add_f32 v75, v75, v91
  v_add_f32 v76, v76, v92
  v_add_f32 v77, v77, v93
  v_add_f32 v78, v78, v94
  v_add_f32 v79, v79, v95
  v_cvt_pk_bf16_f32 v72, 0, v72
  v_cvt_pk_bf16_f32 v73, 0, v73
  v_cvt_pk_bf16_f32 v74, 0, v74
  v_cvt_pk_bf16_f32 v75, 0, v75
  v_cvt_pk_bf16_f32 v76, 0, v76
  v_cvt_pk_bf16_f32 v77, 0, v77
  v_cvt_pk_bf16_f32 v78, 0, v78
  v_cvt_pk_bf16_f32 v79, 0, v79
  v_add_f32 v80, v80, v72
  v_add_f32 v81, v81, v73
  v_add_f32 v82, v82, v74
  v_add_f32 v83, v83, v75
  v_add_f32 v84, v84, v76
  v_add_f32 v85, v85, v77
  v_add_f32 v86, v86, v78
  v_add_f32 v87, v87, v79
  v_cvt_pk_bf16_f32 v112, v80, v81
  v_cvt_pk_bf16_f32 v113, v82, v83
  v_cvt_pk_bf16_f32 v114, v84, v85
  v_cvt_pk_bf16_f32 v115, v86, v87
  v_lshlrev_b32 v80, 16, v112
  v_and_b32 v81, 0xffff0000, v112
  v_lshlrev_b32 v82, 16, v113
  v_and_b32 v83, 0xffff0000, v113
  v_lshlrev_b32 v84, 16, v114
  v_and_b32 v85, 0xffff0000, v114
  v_lshlrev_b32 v86, 16, v115
  v_and_b32 v87, 0xffff0000, v115
  s_lshl_b32 s27, s46, 5
  s_add_u32 s27, s27, s16
  s_lshl_b32 s27, s27, 10
  s_add_u32 s27, s27, 33554432
  buffer_store_dwordx4 v[112:115], v0, s[4:7], s27 offen sc1
  v_add_f32 v20, v80, v81
  v_mul_f32 v21, v80, v80
  v_add_f32 v22, v82, v83
  v_mul_f32 v23, v81, v81
  v_fmac_f32 v21, v82, v82
  v_fmac_f32 v23, v83, v83
  v_add_f32 v20, v20, v84
  v_fmac_f32 v21, v84, v84
  v_add_f32 v22, v22, v85
  v_fmac_f32 v23, v85, v85
  v_add_f32 v20, v20, v86
  v_fmac_f32 v21, v86, v86
  v_add_f32 v22, v22, v87
  v_fmac_f32 v23, v87, v87
  v_add_f32 v20, v20, v22
  v_add_f32 v21, v21, v23
  s_nop 0
  v_add_f32_dpp v20, v20, v20 row_ror:8 row_mask:0xf bank_mask:0xf
  v_add_f32_dpp v21, v21, v21 row_ror:8 row_mask:0xf bank_mask:0xf
  s_nop 0
  v_add_f32_dpp v20, v20, v20 row_ror:4 row_mask:0xf bank_mask:0xf
  v_add_f32_dpp v21, v21, v21 row_ror:4 row_mask:0xf bank_mask:0xf
  s_nop 0
  v_add_f32_dpp v20, v20, v20 row_ror:2 row_mask:0xf bank_mask:0xf
  v_add_f32_dpp v21, v21, v21 row_ror:2 row_mask:0xf bank_mask:0xf
  s_nop 0
  v_add_f32_dpp v20, v20, v20 row_ror:1 row_mask:0xf bank_mask:0xf
  v_add_f32_dpp v21, v21, v21 row_ror:1 row_mask:0xf bank_mask:0xf
  v_mov_b32 v24, v20
  v_mov_b32 v25, v21
  s_nop 0
  v_permlane16_swap_b32 v20, v24
  v_permlane16_swap_b32 v21, v25
  v_add_f32 v20, v20, v24
  v_add_f32 v21, v21, v25
  v_mov_b32 v24, v20
  v_mov_b32 v25, v21
  s_nop 0
  v_permlane32_swap_b32 v20, v24
  v_permlane32_swap_b32 v21, v25
  v_add_f32 v20, v20, v24
  v_add_f32 v21, v21, v25
  v_mul_f32 v20, 0x3b000000, v20
  v_mul_f32 v21, 0x3b000000, v21
  v_fma_f32 v21, -v20, v20, v21
  v_cvt_pk_bf16_f32 v20, 0, v20
  v_max_f32 v21, 0, v21
  v_sub_f32 v24, v80, v20
  v_sub_f32 v25, v81, v20
  v_cvt_pk_bf16_f32 v21, 0, v21
  v_sub_f32 v26, v82, v20
  v_sub_f32 v27, v83, v20
  v_add_f32 v21, 0x3727c5ac, v21
  v_sub_f32 v28, v84, v20
  v_sub_f32 v29, v85, v20
  v_cvt_pk_bf16_f32 v21, 0, v21
  v_sub_f32 v30, v86, v20
  v_sub_f32 v31, v87, v20
  v_sqrt_f32 v21, v21
  v_cvt_pk_bf16_f32 v24, 0, v24
  v_cvt_pk_bf16_f32 v25, 0, v25
  v_cvt_pk_bf16_f32 v21, 0, v21
  v_cvt_pk_bf16_f32 v26, 0, v26
  v_cvt_pk_bf16_f32 v27, 0, v27
  v_rcp_f32 v21, v21
  v_cvt_pk_bf16_f32 v28, 0, v28
  v_cvt_pk_bf16_f32 v29, 0, v29
  v_cvt_pk_bf16_f32 v30, 0, v30
  v_cvt_pk_bf16_f32 v31, 0, v31
  v_mul_f32 v24, v24, v21
  v_mul_f32 v25, v25, v21
  v_mul_f32 v26, v26, v21
  v_mul_f32 v27, v27, v21
  v_mul_f32 v28, v28, v21
  v_mul_f32 v29, v29, v21
  v_mul_f32 v30, v30, v21
  v_mul_f32 v31, v31, v21
  v_cvt_pk_bf16_f32 v32, v24, v25
  v_cvt_pk_bf16_f32 v33, v26, v27
  v_cvt_pk_bf16_f32 v34, v28, v29
  v_cvt_pk_bf16_f32 v35, v30, v31
  v_lshl_add_u32 v3, v0, 2, s50
  v_mov_b64 v[20:21], 0
  v_mov_b64 v[24:25], 0
  v_mov_b64 v[28:29], 0
  v_mov_b32 v22, v32
  v_mov_b32 v23, v34
  v_mov_b32 v26, v33
  v_mov_b32 v27, v35
  ds_write_b128 v3, v[22:25] offset:4096
  ds_write_b128 v3, v[20:23] offset:4112
  ds_write_b128 v3, v[26:29] offset:4128
  ds_write_b128 v3, v[24:27] offset:4144
m_done_102:
  v_lshrrev_b32 v96, 9, v0
  v_lshlrev_b32 v96, 4, v96
  v_and_b32 v97, 0xf0, v0
  v_xor_b32 v96, v96, v97
  v_and_b32 v97, 0x1f0, v0
  v_lshl_add_u32 v96, v97, 6, v96
  v_xor_b32 v120, 0, v96
  v_xor_b32 v121, 32, v96
  v_xor_b32 v122, 64, v96
  v_xor_b32 v123, 96, v96
  v_xor_b32 v124, 128, v96
  v_xor_b32 v125, 160, v96
  v_xor_b32 v126, 192, v96
  v_xor_b32 v127, 224, v96
  s_and_b32 s26, s17, 1
  s_lshl_b32 s26, s26, 7
  v_xor_b32 v96, s26, v0
  v_xor_b32 v12, 0, v96
  v_xor_b32 v13, 16, v96
  v_xor_b32 v14, 32, v96
  v_xor_b32 v15, 48, v96
  v_xor_b32 v16, 64, v96
  v_xor_b32 v17, 80, v96
  v_xor_b32 v18, 96, v96
  v_xor_b32 v19, 112, v96
  v_cmp_eq_u32 vcc, 0, v116
  v_max_u32_dpp v117, v116, v116 quad_perm:[1,0,3,2] row_mask:0xf bank_mask:0xf
  s_and_b32 s48, vcc_lo, 0xffffff
  s_cselect_b32 s48, 0, -1
  v_max_u32_dpp v117, v117, v117 quad_perm:[2,3,0,1] row_mask:0xf bank_mask:0xf
  s_nop 1
  v_max_u32_dpp v117, v117, v117 row_half_mirror row_mask:0xf bank_mask:0xf
  v_and_b32 v117, s48, v117
  s_cmp_eq_u32 s48, 0
  s_cbranch_scc1 q_nb_104
  s_and_b32 s63, s47, 127
  s_lshl_b32 s63, s63, 15
  s_xor_b32 s27, s50, 32768
  s_add_u32 m0, s27, s54
  s_add_u32 s63, s63, s54
  s_add_u32 s63, s63, 6291456
  buffer_load_dwordx4 v12, s[4:7], s63 offen offset:0 sc1 lds
  buffer_load_dwordx4 v13, s[4:7], s63 offen offset:1024 sc1 lds
  buffer_load_dwordx4 v14, s[4:7], s63 offen offset:2048 sc1 lds
  buffer_load_dwordx4 v15, s[4:7], s63 offen offset:3072 sc1 lds
  s_add_u32 m0, m0, 4096
  s_add_u32 s63, s63, 4096
  buffer_load_dwordx4 v16, s[4:7], s63 offen offset:0 sc1 lds
  buffer_load_dwordx4 v17, s[4:7], s63 offen offset:1024 sc1 lds
  buffer_load_dwordx4 v18, s[4:7], s63 offen offset:2048 sc1 lds
  buffer_load_dwordx4 v19, s[4:7], s63 offen offset:3072 sc1 lds
q_nb_104:
  v_lshrrev_b32 v2, 8, v0
  v_and_b32 v3, 48, v0
  v_lshl_add_u32 v3, v2, 6, v3
  v_add_u32 v3, s50, v3
  s_mov_b32 vcc_lo, 0xcccccccc
  s_mov_b32 vcc_hi, 0xcccccccc
  v_mov_b32 v32, 0x4444
  v_mov_b32 v33, 0xeeee
  v_cndmask_b32 v32, v32, v33, vcc
  s_waitcnt lgkmcnt(0)
  s_barrier
  ds_read_b128 v[36:39], v3 offset:4096
  ds_read_b128 v[40:43], v3 offset:4352
  ds_read_b128 v[44:47], v3 offset:4608
  ds_read_b128 v[48:51], v3 offset:4864
  ds_read_b128 v[52:55], v3 offset:5120
  ds_read_b128 v[56:59], v3 offset:5376
  ds_read_b128 v[60:63], v3 offset:5632
  ds_read_b128 v[64:67], v3 offset:5888
  v_mov_b64 v[20:21], 0
  v_mov_b64 v[22:23], 0
  v_mov_b64 v[24:25], 0
  v_mov_b64 v[26:27], 0
  v_mov_b64 v[28:29], 0
  v_mov_b64 v[30:31], 0
  s_waitcnt lgkmcnt(7)
  v_smfmac_f32_16x16x64_bf16 v[20:23], v[36:39], v[128:135], v32
  ds_read_b128 v[68:71], v3 offset:6144
  v_smfmac_f32_16x16x64_bf16 v[24:27], v[36:39], a[0:7], v32
  s_and_b32 s26, s59, 16
  v_smfmac_f32_16x16x64_bf16 v[28:31], v[36:39], a[128:135], v32
  s_lshl_b32 s27, s26, 6
  s_waitcnt lgkmcnt(7)
  v_smfmac_f32_16x16x64_bf16 v[20:23], v[40:43], v[136:143], v32
  ds_read_b128 v[72:75], v3 offset:6400
  v_smfmac_f32_16x16x64_bf16 v[24:27], v[40:43], a[8:15], v32
  s_and_b32 s28, s59, 15
  v_smfmac_f32_16x16x64_bf16 v[28:31], v[40:43], a[136:143], v32
  s_lshl4_add_u32 s27, s28, s27
  s_waitcnt lgkmcnt(7)
  v_smfmac_f32_16x16x64_bf16 v[20:23], v[44:47], v[144:151], v32
  ds_read_b128 v[76:79], v3 offset:6656
  v_smfmac_f32_16x16x64_bf16 v[24:27], v[44:47], a[16:23], v32
  s_add_u32 s77, s77, s27
  v_smfmac_f32_16x16x64_bf16 v[28:31], v[44:47], a[144:151], v32
  s_add_u32 s27, s27, s44
  s_waitcnt lgkmcnt(7)
  v_smfmac_f32_16x16x64_bf16 v[20:23], v[48:51], v[152:159], v32
  ds_read_b128 v[80:83], v3 offset:6912
  v_smfmac_f32_16x16x64_bf16 v[24:27], v[48:51], a[24:31], v32
  s_lshr_b32 s26, s26, 1
  v_smfmac_f32_16x16x64_bf16 v[28:31], v[48:51], a[152:159], v32
  s_and_b32 s28, s59, 3
  s_waitcnt lgkmcnt(7)
  v_smfmac_f32_16x16x64_bf16 v[20:23], v[52:55], v[160:167], v32
  ds_read_b128 v[84:87], v3 offset:7168
  v_smfmac_f32_16x16x64_bf16 v[24:27], v[52:55], a[32:39], v32
  s_lshl1_add_u32 s26, s28, s26
  v_smfmac_f32_16x16x64_bf16 v[28:31], v[52:55], a[160:167], v32
  s_and_b32 s28, s59, 12
  s_waitcnt lgkmcnt(7)
  v_smfmac_f32_16x16x64_bf16 v[20:23], v[56:59], v[168:175], v32
  ds_read_b128 v[88:91], v3 offset:7424
  v_smfmac_f32_16x16x64_bf16 v[24:27], v[56:59], a[40:47], v32
  s_lshl_b32 s28, s28, 6
  v_smfmac_f32_16x16x64_bf16 v[28:31], v[56:59], a[168:175], v32
  s_add_u32 s26, s26, s28
  s_waitcnt lgkmcnt(7)
  v_smfmac_f32_16x16x64_bf16 v[20:23], v[60:63], v[176:183], v32
  ds_read_b128 v[92:95], v3 offset:7680
  v_smfmac_f32_16x16x64_bf16 v[24:27], v[60:63], a[48:55], v32
  s_add_u32 s26, s26, s44
  v_smfmac_f32_16x16x64_bf16 v[28:31], v[60:63], a[176:183], v32
  v_and_b32 v2, 0xc0, v0
  s_waitcnt lgkmcnt(7)
  v_smfmac_f32_16x16x64_bf16 v[20:23], v[64:67], v[184:191], v32
  ds_read_b128 v[96:99], v3 offset:7936
  v_smfmac_f32_16x16x64_bf16 v[24:27], v[64:67], a[56:63], v32
  v_and_b32 v5, 12, v1
  v_smfmac_f32_16x16x64_bf16 v[28:31], v[64:67], a[184:191], v32
  v_lshrrev_b32 v5, 1, v5
  s_waitcnt lgkmcnt(7)
  v_smfmac_f32_16x16x64_bf16 v[20:23], v[68:71], v[192:199], v32
  v_lshl_add_u32 v2, v2, 2, v5
  v_smfmac_f32_16x16x64_bf16 v[24:27], v[68:71], a[64:71], v32
  v_smfmac_f32_16x16x64_bf16 v[28:31], v[68:71], a[192:199], v32
  s_waitcnt lgkmcnt(6)
  v_smfmac_f32_16x16x64_bf16 v[20:23], v[72:75], v[200:207], v32
  v_smfmac_f32_16x16x64_bf16 v[24:27], v[72:75], a[72:79], v32
  v_smfmac_f32_16x16x64_bf16 v[28:31], v[72:75], a[200:207], v32
  s_waitcnt lgkmcnt(5)
  v_smfmac_f32_16x16x64_bf16 v[20:23], v[76:79], v[208:215], v32
  v_smfmac_f32_16x16x64_bf16 v[24:27], v[76:79], a[80:87], v32
  v_smfmac_f32_16x16x64_bf16 v[28:31], v[76:79], a[208:215], v32
  s_waitcnt lgkmcnt(4)
  v_smfmac_f32_16x16x64_bf16 v[20:23], v[80:83], v[216:223], v32
  v_smfmac_f32_16x16x64_bf16 v[24:27], v[80:83], a[88:95], v32
  v_smfmac_f32_16x16x64_bf16 v[28:31], v[80:83], a[216:223], v32
  s_waitcnt lgkmcnt(3)
  v_smfmac_f32_16x16x64_bf16 v[20:23], v[84:87], v[224:231], v32
  v_smfmac_f32_16x16x64_bf16 v[24:27], v[84:87], a[96:103], v32
  v_smfmac_f32_16x16x64_bf16 v[28:31], v[84:87], a[224:231], v32
  s_waitcnt lgkmcnt(2)
  v_smfmac_f32_16x16x64_bf16 v[20:23], v[88:91], v[232:239], v32
  v_smfmac_f32_16x16x64_bf16 v[24:27], v[88:91], a[104:111], v32
  v_smfmac_f32_16x16x64_bf16 v[28:31], v[88:91], a[232:239], v32
  s_waitcnt lgkmcnt(1)
  v_smfmac_f32_16x16x64_bf16 v[20:23], v[92:95], v[240:247], v32
  v_smfmac_f32_16x16x64_bf16 v[24:27], v[92:95], a[112:119], v32
  v_smfmac_f32_16x16x64_bf16 v[28:31], v[92:95], a[240:247], v32
  s_waitcnt lgkmcnt(0)
  v_smfmac_f32_16x16x64_bf16 v[20:23], v[96:99], v[248:255], v32
  v_smfmac_f32_16x16x64_bf16 v[24:27], v[96:99], a[120:127], v32
  v_smfmac_f32_16x16x64_bf16 v[28:31], v[96:99], a[248:255], v32
  v_add_f32 v20, v20, v22
  v_add_f32 v21, v21, v23
  s_nop 1
  v_add_f32 v24, v24, v26
  v_add_f32 v25, v25, v27
  s_nop 1
  v_add_f32 v28, v28, v30
  v_add_f32 v29, v29, v31
  v_mul_f32 v20, s24, v20
  v_mul_f32 v21, s24, v21
  v_cvt_pk_bf16_f32 v20, v20, v21
  v_cvt_pk_bf16_f32 v24, v24, v25
  v_cvt_pk_bf16_f32 v28, v28, v29
  s_mov_b64 exec, 0xffff
  s_waitcnt vmcnt(0)
  buffer_store_short v20, v2, s[4:7], s27 offen sc1
  buffer_store_short_d16_hi v20, v2, s[4:7], s27 offen offset:8 sc1
  buffer_store_short v24, v0, s[4:7], s26 offen offset:2048 sc1
  buffer_store_short_d16_hi v24, v0, s[4:7], s26 offen offset:3072 sc1
  buffer_store_short v28, v2, s[4:7], s77 offen sc1
  buffer_store_short_d16_hi v28, v2, s[4:7], s77 offen offset:8 sc1
  s_mov_b64 exec, 3
  s_waitcnt vmcnt(0)
  buffer_store_dword v4, v0, s[4:7], s51 offen sc1
  s_mov_b64 exec, 3
  buffer_store_dword v4, v0, s[4:7], s49 offen sc1
  s_mov_b64 exec, -1
  s_mov_b32 s49, 268435456
  v_mov_b32 v4, 1
  s_branch q_nxt_96
q_end_87:
  s_waitcnt vmcnt(0)
  s_mov_b64 exec, 3
  buffer_store_dword v4, v0, s[4:7], s49 offen sc1
  s_mov_b64 exec, -1
  s_cmp_lg_u32 s60, 0
  s_cbranch_scc1 q_fail_90
  s_load_dwordx2 s[72:73], s[0:1], 96
  s_mov_b32 s74, 2097152
  s_mov_b32 s75, 0x20000
  s_mov_b32 s58, 0
  s_cmp_eq_u32 s17, 3
  s_cselect_b32 s48, 7, 15
k_fin_105:
  s_load_dwordx2 s[64:65], s[0:1], 72
  s_load_dwordx2 s[68:69], s[0:1], 80
  s_load_dwordx2 s[8:9], s[0:1], 88
  s_mov_b32 s66, 1835008
  s_mov_b32 s70, 1835008
  s_mov_b32 s10, 1835008
  v_lshrrev_b32 v2, 7, v0
  v_and_b32 v3, 0x70, v0
  v_mul_u32_u24 v6, 57344, v2
  v_add_u32 v6, v6, v3
  v_cmp_eq_u32 vcc, 0x70, v3
  v_mov_b32 v3, 0x7ff00000
  s_nop 0
  v_cndmask_b32 v6, v6, v3, vcc
  v_lshrrev_b32 v2, 8, v0
  v_mul_u32_u24 v7, 14336, v2
  v_and_b32 v3, 0xf0, v0
  v_add_u32 v7, v7, v3
  s_mul_i32 s34, s17, 458752
  s_mul_i32 s27, s16, 112
  s_add_u32 s34, s34, s27
  s_mul_i32 s35, s16, 57344
  s_lshl_b32 s27, s17, 8
  s_add_u32 s35, s35, s27
  s_waitcnt lgkmcnt(0)
  s_xor_b32 s37, s50, 32768
  s_add_u32 s37, s37, s54
  s_mov_b32 m0, s37
  s_add_u32 s36, s34, 39424
  buffer_load_dwordx4 v6, s[68:71], s36 offen lds
  s_add_u32 m0, m0, 1024
  s_add_u32 s36, s34, 43008
  buffer_load_dwordx4 v6, s[64:67], s36 offen lds
  s_add_u32 m0, m0, 1024
  s_add_u32 s36, s34, 43008
  buffer_load_dwordx4 v6, s[68:71], s36 offen lds
  s_add_u32 m0, m0, 1024
  s_add_u32 s36, s34, 46592
  buffer_load_dwordx4 v6, s[64:67], s36 offen lds
  s_add_u32 m0, m0, 1024
  s_add_u32 s36, s34, 46592
  buffer_load_dwordx4 v6, s[68:71], s36 offen lds
  s_add_u32 m0, m0, 1024
  s_add_u32 s36, s34, 50176
  buffer_load_dwordx4 v6, s[64:67], s36 offen lds
  s_add_u32 m0, m0, 1024
  s_add_u32 s36, s34, 50176
  buffer_load_dwordx4 v6, s[68:71], s36 offen lds
  s_add_u32 m0, m0, 1024
  s_add_u32 s36, s34, 53760
  buffer_load_dwordx4 v6, s[64:67], s36 offen lds
  s_add_u32 m0, m0, 1024
  s_add_u32 s36, s34, 53760
  buffer_load_dwordx4 v[60:63], v6, s[68:71], s36 offen
  buffer_load_dwordx4 v[64:67], v7, s[8:11], s35 offen offset:0
  buffer_load_dwordx4 v[68:71], v7, s[8:11], s35 offen offset:1024
  buffer_load_dwordx4 v[72:75], v7, s[8:11], s35 offen offset:2048
  buffer_load_dwordx4 v[76:79], v7, s[8:11], s35 offen offset:3072
  s_add_u32 s35, s35, 4096
  buffer_load_dwordx4 v[80:83], v7, s[8:11], s35 offen offset:0
  buffer_load_dwordx4 v[84:87], v7, s[8:11], s35 offen offset:1024
  buffer_load_dwordx4 v[88:91], v7, s[8:11], s35 offen offset:2048
  buffer_load_dwordx4 v[92:95], v7, s[8:11], s35 offen offset:3072
  s_add_u32 s35, s35, 4096
  buffer_load_dwordx4 v[96:99], v7, s[8:11], s35 offen offset:0
  buffer_load_dwordx4 v[100:103], v7, s[8:11], s35 offen offset:1024
  buffer_load_dwordx4 v[104:107], v7, s[8:11], s35 offen offset:2048
  buffer_load_dwordx4 v[108:111], v7, s[8:11], s35 offen offset:3072
  s_add_u32 s35, s35, 4096
  buffer_load_dwordx4 v[112:115], v7, s[8:11], s35 offen offset:0
  buffer_load_dwordx4 v[48:51], v7, s[8:11], s35 offen offset:1024
  s_andn2_b32 s28, 0xfe0, s56
  s_lshl_b32 s28, s28, 7
  s_mov_b32 s29, 243793920
  v_mov_b32 v24, 262144
  s_mov_b32 s53, 0
  s_mov_b32 s33, 3
  v_mov_b32 v53, s58
  s_and_b32 s32, s48, 15
  s_cbranch_scc0 k_x_108
k_w_107:
  s_add_u32 s33, s33, 1
  s_and_b32 s33, s33, 3
  s_bitcmp1_b32 s32, s33
  s_cbranch_scc0 k_w_107
  s_lshl2_add_u32 s26, s33, s17
  s_lshl_b32 s26, s26, 14
  s_add_u32 s27, s26, 8192
  v_add_u32 v22, s26, v9
  v_cmp_le_u32 vcc, s28, v22
  s_nop 1
  v_cndmask_b32 v25, 0, v24, vcc
  v_add_u32 v22, v22, v25
  buffer_load_dword v20, v22, s[4:7], s29 offen sc1
  v_add_u32 v23, s27, v9
  v_cmp_le_u32 vcc, s28, v23
  s_nop 1
  v_cndmask_b32 v25, 0, v24, vcc
  v_add_u32 v23, v23, v25
  buffer_load_dword v21, v23, s[4:7], s29 offen sc1
  s_add_u32 s53, s53, 1
  s_cmp_gt_u32 s53, 1048576
  s_cbranch_scc1 q_fail_90
  s_waitcnt vmcnt(0)
  v_min_u32 v52, v20, v21
  v_max3_u32 v53, v20, v21, v53
  v_cmp_eq_u32 vcc, 0, v52
  s_cbranch_vccnz k_w_107
  s_bitset0_b32 s32, s33
  s_cmp_lg_u32 s32, 0
  s_cbranch_scc1 k_w_107
  v_max_u32_dpp v53, v53, v53 row_ror:8 row_mask:0xf bank_mask:0xf
  s_nop 1
  v_max_u32_dpp v53, v53, v53 row_ror:4 row_mask:0xf bank_mask:0xf
  s_nop 1
  v_max_u32_dpp v53, v53, v53 row_ror:2 row_mask:0xf bank_mask:0xf
  s_nop 1
  v_max_u32_dpp v53, v53, v53 row_ror:1 row_mask:0xf bank_mask:0xf
  v_mov_b32 v52, v53
  s_nop 0
  s_nop 0
  v_permlane16_swap_b32 v53, v52
  v_max_u32 v53, v53, v52
  v_mov_b32 v52, v53
  s_nop 0
  s_nop 0
  v_permlane32_swap_b32 v53, v52
  v_max_u32 v53, v53, v52
k_x_108:
  ds_write_b32 v118, v53 offset:256
  s_waitcnt vmcnt(0) lgkmcnt(0)
  s_barrier
  ds_read_b128 v[20:23], v119 offset:256
  s_waitcnt lgkmcnt(0)
  v_max3_u32 v20, v20, v21, v22
  v_max_u32 v20, v20, v23
  s_nop 0
  v_readfirstlane_b32 s26, v20
  s_cmp_eq_u32 s26, s58
  s_cbranch_scc1 q_fail_90
  s_cmp_eq_u32 s58, 0
  s_mov_b32 s58, s26
  s_cbranch_scc1 k_r_109
  s_cmp_lg_u32 s57, 0
  s_cbranch_scc1 k_r_109
  s_lshl_b32 s26, s59, 10
  buffer_store_dwordx4 a[0:3], v0, s[72:75], s26 offen sc1
k_r_109:
  s_andn2_b32 s26, 0xfe0, s56
  s_andn2_b32 s27, 0xfe0, s58
  s_cmp_lt_u32 s27, s26
  s_cselect_b32 s61, 1, 2
  s_andn2_b32 s59, 0xfff, s58
  s_lshl_b32 s26, s61, 21
  s_lshl_b32 s27, s59, 10
  s_add_u32 s26, s26, s27
  s_lshl_b32 s27, s17, 8
  s_add_u32 s26, s26, s27
  s_add_u32 s26, s26, 27262976
  v_lshrrev_b32 v5, 7, v0
  v_lshlrev_b32 v5, 5, v5
  buffer_load_dwordx4 v[52:55], v5, s[4:7], s26 offen offset:0 sc1
  buffer_load_dwordx4 v[56:59], v5, s[4:7], s26 offen offset:16 sc1
  s_mov_b32 vcc_lo, 0xaaaaaaaa
  s_mov_b32 vcc_hi, 0xaaaaaaaa
  v_mov_b32 v3, 0xffff
  v_mov_b32 v24, 0xffff0000
  v_cndmask_b32 v3, v3, v24, vcc
  s_mov_b32 vcc_lo, 0x3030303
  s_mov_b32 vcc_hi, 0x3030303
  v_cndmask_b32 v24, 0, v3, vcc
  s_mov_b32 vcc_lo, 0xc0c0c0c
  s_mov_b32 vcc_hi, 0xc0c0c0c
  v_cndmask_b32 v25, 0, v3, vcc
  s_mov_b32 vcc_lo, 0x30303030
  s_mov_b32 vcc_hi, 0x30303030
  v_cndmask_b32 v26, 0, v3, vcc
  s_mov_b32 vcc_lo, 0xc0c0c0c0
  s_mov_b32 vcc_hi, 0xc0c0c0c0
  v_cndmask_b32 v27, 0, v3, vcc
  s_mov_b32 s30, 0x01000100
  s_mov_b32 s31, 0x03020302
  s_mul_i32 s26, s17, 23552
  s_add_u32 s26, s26, 65536
  v_add_u32 v5, s26, v0
  v_add_u32 v2, s37, v0
  ds_read_b128 v[36:39], v5 offset:0
  ds_read_b128 v[40:43], v5 offset:1024
  ds_read_b128 v[44:47], v5 offset:2048
  ds_read_b128 v[12:15], v5 offset:3072
  ds_read_b128 v[16:19], v5 offset:4096
  ds_read_b128 v[120:123], v5 offset:5120
  ds_read_b128 v[124:127], v5 offset:6144
  s_waitcnt vmcnt(0)
  v_perm_b32 v3, v52, v52, s30
  v_and_b32 v20, v24, v3
  v_and_b32 v21, v25, v3
  v_and_b32 v22, v26, v3
  v_and_b32 v23, v27, v3
  s_waitcnt lgkmcnt(5)
  s_nop 0
  v_mfma_f32_16x16x32_bf16 v[28:31], v[20:23], v[36:39], 0
  ds_read_b128 v[36:39], v5 offset:7168
  v_mfma_f32_16x16x32_bf16 v[32:35], v[20:23], v[40:43], 0
  ds_read_b128 v[40:43], v5 offset:8192
  v_perm_b32 v3, v52, v52, s31
  v_and_b32 v20, v24, v3
  v_and_b32 v21, v25, v3
  v_and_b32 v22, v26, v3
  v_and_b32 v23, v27, v3
  s_waitcnt lgkmcnt(5)
  s_nop 0
  v_mfma_f32_16x16x32_bf16 v[28:31], v[20:23], v[44:47], v[28:31]
  ds_read_b128 v[44:47], v5 offset:9216
  v_mfma_f32_16x16x32_bf16 v[32:35], v[20:23], v[12:15], v[32:35]
  ds_read_b128 v[12:15], v5 offset:10240
  v_perm_b32 v3, v53, v53, s30
  v_and_b32 v20, v24, v3
  v_and_b32 v21, v25, v3
  v_and_b32 v22, v26, v3
  v_and_b32 v23, v27, v3
  s_waitcnt lgkmcnt(5)
  s_nop 0
  v_mfma_f32_16x16x32_bf16 v[28:31], v[20:23], v[16:19], v[28:31]
  ds_read_b128 v[16:19], v5 offset:11264
  v_mfma_f32_16x16x32_bf16 v[32:35], v[20:23], v[120:123], v[32:35]
  ds_read_b128 v[120:123], v5 offset:12288
  v_perm_b32 v3, v53, v53, s31
  v_and_b32 v20, v24, v3
  v_and_b32 v21, v25, v3
  v_and_b32 v22, v26, v3
  v_and_b32 v23, v27, v3
  s_waitcnt lgkmcnt(5)
  s_nop 0
  v_mfma_f32_16x16x32_bf16 v[28:31], v[20:23], v[124:127], v[28:31]
  ds_read_b128 v[124:127], v5 offset:13312
  v_mfma_f32_16x16x32_bf16 v[32:35], v[20:23], v[36:39], v[32:35]
  ds_read_b128 v[36:39], v5 offset:14336
  v_perm_b32 v3, v54, v54, s30
  v_and_b32 v20, v24, v3
  v_and_b32 v21, v25, v3
  v_and_b32 v22, v26, v3
  v_and_b32 v23, v27, v3
  s_waitcnt lgkmcnt(5)
  s_nop 0
  v_mfma_f32_16x16x32_bf16 v[28:31], v[20:23], v[40:43], v[28:31]
  ds_read_b128 v[40:43], v5 offset:15360
  v_mfma_f32_16x16x32_bf16 v[32:35], v[20:23], v[44:47], v[32:35]
  ds_read_b128 v[44:47], v5 offset:16384
  v_perm_b32 v3, v54, v54, s31
  v_and_b32 v20, v24, v3
  v_and_b32 v21, v25, v3
  v_and_b32 v22, v26, v3
  v_and_b32 v23, v27, v3
  s_waitcnt lgkmcnt(5)
  s_nop 0
  v_mfma_f32_16x16x32_bf16 v[28:31], v[20:23], v[12:15], v[28:31]
  ds_read_b128 v[12:15], v5 offset:17408
  v_mfma_f32_16x16x32_bf16 v[32:35], v[20:23], v[16:19], v[32:35]
  ds_read_b128 v[16:19], v5 offset:18432
  v_perm_b32 v3, v55, v55, s30
  v_and_b32 v20, v24, v3
  v_and_b32 v21, v25, v3
  v_and_b32 v22, v26, v3
  v_and_b32 v23, v27, v3
  s_waitcnt lgkmcnt(5)
  s_nop 0
  v_mfma_f32_16x16x32_bf16 v[28:31], v[20:23], v[120:123], v[28:31]
  ds_read_b128 v[120:123], v5 offset:19456
  v_mfma_f32_16x16x32_bf16 v[32:35], v[20:23], v[124:127], v[32:35]
  ds_read_b128 v[124:127], v5 offset:20480
  v_perm_b32 v3, v55, v55, s31
  v_and_b32 v20, v24, v3
  v_and_b32 v21, v25, v3
  v_and_b32 v22, v26, v3
  v_and_b32 v23, v27, v3
  s_waitcnt lgkmcnt(5)
  s_nop 0
  v_mfma_f32_16x16x32_bf16 v[28:31], v[20:23], v[36:39], v[28:31]
  ds_read_b128 v[36:39], v5 offset:21504
  v_mfma_f32_16x16x32_bf16 v[32:35], v[20:23], v[40:43], v[32:35]
  ds_read_b128 v[40:43], v5 offset:22528
  v_perm_b32 v3, v56, v56, s30
  v_and_b32 v20, v24, v3
  v_and_b32 v21, v25, v3
  v_and_b32 v22, v26, v3
  v_and_b32 v23, v27, v3
  s_waitcnt lgkmcnt(5)
  s_nop 0
  v_mfma_f32_16x16x32_bf16 v[28:31], v[20:23], v[44:47], v[28:31]
  ds_read_b128 v[44:47], v2 offset:0
  v_mfma_f32_16x16x32_bf16 v[32:35], v[20:23], v[12:15], v[32:35]
  ds_read_b128 v[12:15], v2 offset:1024
  v_perm_b32 v3, v56, v56, s31
  v_and_b32 v20, v24, v3
  v_and_b32 v21, v25, v3
  v_and_b32 v22, v26, v3
  v_and_b32 v23, v27, v3
  s_waitcnt lgkmcnt(5)
  s_nop 0
  v_mfma_f32_16x16x32_bf16 v[28:31], v[20:23], v[16:19], v[28:31]
  ds_read_b128 v[16:19], v2 offset:2048
  v_mfma_f32_16x16x32_bf16 v[32:35], v[20:23], v[120:123], v[32:35]
  ds_read_b128 v[120:123], v2 offset:3072
  v_perm_b32 v3, v57, v57, s30
  v_and_b32 v20, v24, v3
  v_and_b32 v21, v25, v3
  v_and_b32 v22, v26, v3
  v_and_b32 v23, v27, v3
  s_waitcnt lgkmcnt(5)
  s_nop 0
  v_mfma_f32_16x16x32_bf16 v[28:31], v[20:23], v[124:127], v[28:31]
  ds_read_b128 v[124:127], v2 offset:4096
  v_mfma_f32_16x16x32_bf16 v[32:35], v[20:23], v[36:39], v[32:35]
  ds_read_b128 v[36:39], v2 offset:5120
  v_perm_b32 v3, v57, v57, s31
  v_and_b32 v20, v24, v3
  v_and_b32 v21, v25, v3
  v_and_b32 v22, v26, v3
  v_and_b32 v23, v27, v3
  s_waitcnt lgkmcnt(5)
  s_nop 0
  v_mfma_f32_16x16x32_bf16 v[28:31], v[20:23], v[40:43], v[28:31]
  ds_read_b128 v[40:43], v2 offset:6144
  v_mfma_f32_16x16x32_bf16 v[32:35], v[20:23], v[44:47], v[32:35]
  ds_read_b128 v[44:47], v2 offset:7168
  v_perm_b32 v3, v58, v58, s30
  v_and_b32 v20, v24, v3
  v_and_b32 v21, v25, v3
  v_and_b32 v22, v26, v3
  v_and_b32 v23, v27, v3
  s_waitcnt lgkmcnt(5)
  s_nop 0
  v_mfma_f32_16x16x32_bf16 v[28:31], v[20:23], v[12:15], v[28:31]
  v_mfma_f32_16x16x32_bf16 v[32:35], v[20:23], v[16:19], v[32:35]
  v_perm_b32 v3, v58, v58, s31
  v_and_b32 v20, v24, v3
  v_and_b32 v21, v25, v3
  v_and_b32 v22, v26, v3
  v_and_b32 v23, v27, v3
  s_waitcnt lgkmcnt(3)
  s_nop 0
  v_mfma_f32_16x16x32_bf16 v[28:31], v[20:23], v[120:123], v[28:31]
  v_mfma_f32_16x16x32_bf16 v[32:35], v[20:23], v[124:127], v[32:35]
  v_perm_b32 v3, v59, v59, s30
  v_and_b32 v20, v24, v3
  v_and_b32 v21, v25, v3
  v_and_b32 v22, v26, v3
  v_and_b32 v23, v27, v3
  s_waitcnt lgkmcnt(1)
  s_nop 0
  v_mfma_f32_16x16x32_bf16 v[28:31], v[20:23], v[36:39], v[28:31]
  v_mfma_f32_16x16x32_bf16 v[32:35], v[20:23], v[40:43], v[32:35]
  v_perm_b32 v3, v59, v59, s31
  v_and_b32 v20, v24, v3
  v_and_b32 v21, v25, v3
  v_and_b32 v22, v26, v3
  v_and_b32 v23, v27, v3
  s_waitcnt lgkmcnt(0)
  s_nop 0
  v_mfma_f32_16x16x32_bf16 v[28:31], v[20:23], v[44:47], v[28:31]
  v_mfma_f32_16x16x32_bf16 v[32:35], v[20:23], v[60:63], v[32:35]
  v_lshrrev_b32 v2, 8, v0
  v_and_b32 v3, 0xf0, v0
  v_lshlrev_b32 v3, 1, v3
  v_and_b32 v5, 1, v2
  v_lshl_add_u32 v5, v5, 4, v3
  v_add_u32 v5, s37, v5
  s_mov_b32 exec_lo, 0x00ff00ff
  s_mov_b32 exec_hi, 0xff00ff00
  ds_write_b128 v5, v[28:31]
  ds_write_b128 v5, v[32:35] offset:512
  s_mov_b64 exec, -1
  s_xor_b32 s26, s50, 32768
  v_add_u32 v5, s26, v1
  v_lshl_add_u32 v3, v2, 4, v3
  s_waitcnt lgkmcnt(0)
  s_barrier
  ds_read2st64_b32 v[36:37], v5 offset0:0 offset1:1
  ds_read2st64_b32 v[52:53], v5 offset0:2 offset1:3
  ds_read2st64_b32 v[38:39], v5 offset0:32 offset1:33
  ds_read2st64_b32 v[54:55], v5 offset0:34 offset1:35
  ds_read2st64_b32 v[40:41], v5 offset0:64 offset1:65
  ds_read2st64_b32 v[56:57], v5 offset0:66 offset1:67
  ds_read2st64_b32 v[42:43], v5 offset0:96 offset1:97
  ds_read2st64_b32 v[58:59], v5 offset0:98 offset1:99
  s_waitcnt lgkmcnt(0)
  v_add_f32 v36, v36, v40
  v_add_f32 v37, v37, v41
  v_add_f32 v38, v38, v42
  v_add_f32 v39, v39, v43
  v_add_f32 v52, v52, v56
  v_add_f32 v53, v53, v57
  v_add_f32 v54, v54, v58
  v_add_f32 v55, v55, v59
  v_add_f32 v36, v36, v38
  v_add_f32 v37, v37, v39
  v_add_f32 v52, v52, v54
  v_add_f32 v53, v53, v55
  v_add_f32 v36, v36, v37
  v_add_f32 v52, v52, v53
  v_cvt_pk_bf16_f32 v36, 0, v36
  v_cvt_pk_bf16_f32 v52, 0, v52
  v_mul_f32 v40, 0xbfb8aa3b, v36
  v_exp_f32 v40, v40
  s_nop 0
  v_add_f32 v40, 1.0, v40
  v_rcp_f32 v40, v40
  s_nop 0
  v_mul_f32 v36, v36, v40
  v_cvt_pk_bf16_f32 v36, 0, v36
  v_mul_f32 v36, v36, v52
  v_cvt_pk_bf16_f32 v36, v36, v36
  s_lshl_b32 s26, s17, 8
  s_add_u32 s26, s26, 161792
  v_add_u32 v5, s26, v1
  ds_write_b32 v5, v36
  v_mul_u32_u24 v5, 56, v2
  v_add_u32 v5, s26, v5
  ds_read_b64 v[36:37], v5 offset:0
  ds_read_b64 v[38:39], v5 offset:8
  ds_read_b64 v[40:41], v5 offset:16
  ds_read_b64 v[42:43], v5 offset:24
  ds_read_b64 v[44:45], v5 offset:32
  ds_read_b64 v[46:47], v5 offset:40
  ds_read_b64 v[52:53], v5 offset:48
  s_waitcnt lgkmcnt(0)
  v_and_b32 v20, v24, v36
  v_and_b32 v21, v25, v36
  v_and_b32 v22, v26, v36
  v_and_b32 v23, v27, v36
  s_nop 0
  s_nop 0
  v_mfma_f32_16x16x32_bf16 v[28:31], v[20:23], v[64:67], 0
  v_and_b32 v32, v24, v37
  v_and_b32 v33, v25, v37
  v_and_b32 v34, v26, v37
  v_and_b32 v35, v27, v37
  s_nop 0
  s_nop 0
  v_mfma_f32_16x16x32_bf16 v[28:31], v[32:35], v[68:71], v[28:31]
  v_and_b32 v20, v24, v38
  v_and_b32 v21, v25, v38
  v_and_b32 v22, v26, v38
  v_and_b32 v23, v27, v38
  s_nop 0
  s_nop 0
  v_mfma_f32_16x16x32_bf16 v[28:31], v[20:23], v[72:75], v[28:31]
  v_and_b32 v32, v24, v39
  v_and_b32 v33, v25, v39
  v_and_b32 v34, v26, v39
  v_and_b32 v35, v27, v39
  s_nop 0
  s_nop 0
  v_mfma_f32_16x16x32_bf16 v[28:31], v[32:35], v[76:79], v[28:31]
  v_and_b32 v20, v24, v40
  v_and_b32 v21, v25, v40
  v_and_b32 v22, v26, v40
  v_and_b32 v23, v27, v40
  s_nop 0
  s_nop 0
  v_mfma_f32_16x16x32_bf16 v[28:31], v[20:23], v[80:83], v[28:31]
  v_and_b32 v32, v24, v41
  v_and_b32 v33, v25, v41
  v_and_b32 v34, v26, v41
  v_and_b32 v35, v27, v41
  s_nop 0
  s_nop 0
  v_mfma_f32_16x16x32_bf16 v[28:31], v[32:35], v[84:87], v[28:31]
  v_and_b32 v20, v24, v42
  v_and_b32 v21, v25, v42
  v_and_b32 v22, v26, v42
  v_and_b32 v23, v27, v42
  s_nop 0
  s_nop 0
  v_mfma_f32_16x16x32_bf16 v[28:31], v[20:23], v[88:91], v[28:31]
  v_and_b32 v32, v24, v43
  v_and_b32 v33, v25, v43
  v_and_b32 v34, v26, v43
  v_and_b32 v35, v27, v43
  s_nop 0
  s_nop 0
  v_mfma_f32_16x16x32_bf16 v[28:31], v[32:35], v[92:95], v[28:31]
  v_and_b32 v20, v24, v44
  v_and_b32 v21, v25, v44
  v_and_b32 v22, v26, v44
  v_and_b32 v23, v27, v44
  s_nop 0
  s_nop 0
  v_mfma_f32_16x16x32_bf16 v[28:31], v[20:23], v[96:99], v[28:31]
  v_and_b32 v32, v24, v45
  v_and_b32 v33, v25, v45
  v_and_b32 v34, v26, v45
  v_and_b32 v35, v27, v45
  s_nop 0
  s_nop 0
  v_mfma_f32_16x16x32_bf16 v[28:31], v[32:35], v[100:103], v[28:31]
  v_and_b32 v20, v24, v46
  v_and_b32 v21, v25, v46
  v_and_b32 v22, v26, v46
  v_and_b32 v23, v27, v46
  s_nop 0
  s_nop 0
  v_mfma_f32_16x16x32_bf16 v[28:31], v[20:23], v[104:107], v[28:31]
  v_and_b32 v32, v24, v47
  v_and_b32 v33, v25, v47
  v_and_b32 v34, v26, v47
  v_and_b32 v35, v27, v47
  s_nop 0
  s_nop 0
  v_mfma_f32_16x16x32_bf16 v[28:31], v[32:35], v[108:111], v[28:31]
  v_and_b32 v20, v24, v52
  v_and_b32 v21, v25, v52
  v_and_b32 v22, v26, v52
  v_and_b32 v23, v27, v52
  s_nop 0
  s_nop 0
  v_mfma_f32_16x16x32_bf16 v[28:31], v[20:23], v[112:115], v[28:31]
  v_and_b32 v32, v24, v53
  v_and_b32 v33, v25, v53
  v_and_b32 v34, v26, v53
  v_and_b32 v35, v27, v53
  s_nop 0
  s_nop 0
  v_mfma_f32_16x16x32_bf16 v[28:31], v[32:35], v[48:51], v[28:31]
  v_lshrrev_b32 v3, 1, v3
  s_lshl_b32 s26, s47, 7
  s_add_u32 s26, s26, s57
  s_lshl_b32 s26, s26, 8
  s_add_u32 s26, s26, 244318208
  s_nop 2
  v_cvt_pk_bf16_f32 v28, v28, v29
  v_cvt_pk_bf16_f32 v29, v30, v31
  v_min_u32 v28, -2, v28
  v_min_u32 v29, -2, v29
  s_mov_b32 exec_hi, 0
  buffer_store_dwordx2 v[28:29], v3, s[4:7], s26 offen sc1
  s_mov_b32 exec_hi, -1
  s_cmp_lg_u32 s16, 0
  s_cbranch_scc1 k_nx_106
  s_barrier
  s_lshl_b32 s26, s61, 21
  s_lshl_b32 s27, s59, 10
  s_add_u32 s26, s26, s27
  s_add_u32 s27, s26, 20971520
  s_add_u32 s28, s26, 27262976
  s_lshl_b32 s26, s47, 7
  s_add_u32 s26, s26, s17
  s_lshl_b32 s26, s26, 8
  s_add_u32 s26, s26, 244318208
  v_lshrrev_b32 v2, 8, v0
  v_and_b32 v3, 0xf0, v0
  v_lshl_add_u32 v5, v2, 10, v3
  buffer_load_dwordx4 v[108:111], v0, s[4:7], s27 offen sc1
  buffer_load_dwordx4 v[112:115], v0, s[4:7], s28 offen sc1
  s_mov_b32 s53, 0
m_w_111:
  s_add_u32 s27, s26, 0
  buffer_load_dwordx4 v[20:23], v5, s[4:7], s27 offen sc1
  s_add_u32 s27, s26, 4096
  buffer_load_dwordx4 v[24:27], v5, s[4:7], s27 offen sc1
  s_add_u32 s27, s26, 8192
  buffer_load_dwordx4 v[28:31], v5, s[4:7], s27 offen sc1
  s_add_u32 s27, s26, 12288
  buffer_load_dwordx4 v[32:35], v5, s[4:7], s27 offen sc1
  s_add_u32 s27, s26, 16384
  buffer_load_dwordx4 v[36:39], v5, s[4:7], s27 offen sc1
  s_add_u32 s27, s26, 20480
  buffer_load_dwordx4 v[40:43], v5, s[4:7], s27 offen sc1
  s_add_u32 s27, s26, 24576
  buffer_load_dwordx4 v[44:47], v5, s[4:7], s27 offen sc1
  s_add_u32 s27, s26, 28672
  buffer_load_dwordx4 v[48:51], v5, s[4:7], s27 offen sc1
  s_add_u32 s53, s53, 1
  s_cmp_gt_u32 s53, 1048576
  s_cbranch_scc1 q_fail_90
  s_mov_b32 vcc_lo, 0xaaaaaaaa
  s_mov_b32 vcc_hi, 0xaaaaaaaa
  v_mov_b32 v72, 0x3f80
  v_mov_b32 v68, 1.0
  v_cndmask_b32 v72, v72, v68, vcc
  s_mov_b32 vcc_lo, 0x30003
  s_mov_b32 vcc_hi, 0x30003
  v_cndmask_b32 v68, 0, v72, vcc
  s_mov_b32 vcc_lo, 0xc000c
  s_mov_b32 vcc_hi, 0xc000c
  v_cndmask_b32 v69, 0, v72, vcc
  s_mov_b32 vcc_lo, 0x300030
  s_mov_b32 vcc_hi, 0x300030
  v_cndmask_b32 v70, 0, v72, vcc
  s_mov_b32 vcc_lo, 0xc000c0
  s_mov_b32 vcc_hi, 0xc000c0
  v_cndmask_b32 v71, 0, v72, vcc
  s_waitcnt vmcnt(7)
  s_nop 0
  v_mfma_f32_16x16x32_bf16 v[72:75], v[68:71], v[20:23], 0
  v_max3_u32 v80, v20, v21, 0
  v_max3_u32 v80, v22, v23, v80
  s_waitcnt vmcnt(6)
  v_mfma_f32_16x16x32_bf16 v[72:75], v[68:71], v[24:27], v[72:75]
  v_max3_u32 v80, v24, v25, v80
  v_max3_u32 v80, v26, v27, v80
  s_waitcnt vmcnt(5)
  v_mfma_f32_16x16x32_bf16 v[72:75], v[68:71], v[28:31], v[72:75]
  v_max3_u32 v80, v28, v29, v80
  v_max3_u32 v80, v30, v31, v80
  s_waitcnt vmcnt(4)
  v_mfma_f32_16x16x32_bf16 v[72:75], v[68:71], v[32:35], v[72:75]
  v_max3_u32 v80, v32, v33, v80
  v_max3_u32 v80, v34, v35, v80
  s_waitcnt vmcnt(3)
  v_mfma_f32_16x16x32_bf16 v[72:75], v[68:71], v[36:39], v[72:75]
  v_max3_u32 v80, v36, v37, v80
  v_max3_u32 v80, v38, v39, v80
  s_waitcnt vmcnt(2)
  v_mfma_f32_16x16x32_bf16 v[72:75], v[68:71], v[40:43], v[72:75]
  v_max3_u32 v80, v40, v41, v80
  v_max3_u32 v80, v42, v43, v80
  s_waitcnt vmcnt(1)
  v_mfma_f32_16x16x32_bf16 v[72:75], v[68:71], v[44:47], v[72:75]
  v_max3_u32 v80, v44, v45, v80
  v_max3_u32 v80, v46, v47, v80
  s_waitcnt vmcnt(0)
  v_mfma_f32_16x16x32_bf16 v[72:75], v[68:71], v[48:51], v[72:75]
  v_max3_u32 v80, v48, v49, v80
  v_max3_u32 v80, v50, v51, v80
  v_cmp_eq_u32 vcc, -1, v80
  s_cbranch_vccnz m_w_111
  v_lshlrev_b32 v3, 1, v3
  v_lshl_add_u32 v3, v2, 4, v3
  s_lshl_b32 s26, s17, 9
  s_add_u32 s26, s26, 159744
  v_add_u32 v3, s26, v3
  s_mov_b32 exec_hi, 0
  ds_write_b128 v3, v[72:75]
  s_mov_b32 exec_hi, -1
  v_lshlrev_b32 v3, 1, v0
  v_add_u32 v3, 159744, v3
  v_lshlrev_b32 v80, 16, v108
  v_and_b32 v81, 0xffff0000, v108
  v_lshlrev_b32 v82, 16, v109
  v_and_b32 v83, 0xffff0000, v109
  v_lshlrev_b32 v84, 16, v110
  v_and_b32 v85, 0xffff0000, v110
  v_lshlrev_b32 v86, 16, v111
  v_and_b32 v87, 0xffff0000, v111
  v_lshlrev_b32 v88, 16, v112
  v_and_b32 v89, 0xffff0000, v112
  v_lshlrev_b32 v90, 16, v113
  v_and_b32 v91, 0xffff0000, v113
  v_lshlrev_b32 v92, 16, v114
  v_and_b32 v93, 0xffff0000, v114
  v_lshlrev_b32 v94, 16, v115
  v_and_b32 v95, 0xffff0000, v115
  s_waitcnt lgkmcnt(0)
  s_barrier
  s_cmp_lg_u32 s17, 0
  s_cbranch_scc1 m_done_110
  ds_read_b128 v[72:75], v3
  ds_read_b128 v[76:79], v3 offset:16
  s_and_b32 s29, s58, 0xffff0000
  s_xor_b32 s27, s29, 0x80000000
  s_xor_b32 s28, s29, 0xffff0000
  s_bitcmp1_b32 s29, 31
  s_cselect_b32 s29, s27, s28
  v_mov_b32 v108, s29
  v_mul_f32 v108, 0xbfb8aa3b, v108
  v_exp_f32 v108, v108
  s_nop 0
  v_add_f32 v108, 1.0, v108
  v_rcp_f32 v108, v108
  s_nop 0
  v_cvt_pk_bf16_f32 v108, 0, v108
  v_add_f32 v20, v80, v88
  v_add_f32 v21, v81, v89
  v_add_f32 v22, v82, v90
  v_add_f32 v23, v83, v91
  v_add_f32 v24, v84, v92
  v_add_f32 v25, v85, v93
  v_add_f32 v26, v86, v94
  v_add_f32 v27, v87, v95
  v_cvt_pk_bf16_f32 v28, v20, v21
  v_cvt_pk_bf16_f32 v29, v22, v23
  v_cvt_pk_bf16_f32 v30, v24, v25
  v_cvt_pk_bf16_f32 v31, v26, v27
  v_accvgpr_write_b32 a0, v28
  v_accvgpr_write_b32 a1, v29
  v_accvgpr_write_b32 a2, v30
  v_accvgpr_write_b32 a3, v31
  s_waitcnt lgkmcnt(0)
  v_cvt_pk_bf16_f32 v72, 0, v72
  v_cvt_pk_bf16_f32 v73, 0, v73
  v_cvt_pk_bf16_f32 v74, 0, v74
  v_cvt_pk_bf16_f32 v75, 0, v75
  v_cvt_pk_bf16_f32 v76, 0, v76
  v_cvt_pk_bf16_f32 v77, 0, v77
  v_cvt_pk_bf16_f32 v78, 0, v78
  v_cvt_pk_bf16_f32 v79, 0, v79
  v_mul_f32 v72, v72, v108
  v_mul_f32 v73, v73, v108
  v_mul_f32 v74, v74, v108
  v_mul_f32 v75, v75, v108
  v_mul_f32 v76, v76, v108
  v_mul_f32 v77, v77, v108
  v_mul_f32 v78, v78, v108
  v_mul_f32 v79, v79, v108
  v_cvt_pk_bf16_f32 v72, 0, v72
  v_cvt_pk_bf16_f32 v73, 0, v73
  v_cvt_pk_bf16_f32 v74, 0, v74
  v_cvt_pk_bf16_f32 v75, 0, v75
  v_cvt_pk_bf16_f32 v76, 0, v76
  v_cvt_pk_bf16_f32 v77, 0, v77
  v_cvt_pk_bf16_f32 v78, 0, v78
  v_cvt_pk_bf16_f32 v79, 0, v79
  v_add_f32 v72, v72, v88
  v_add_f32 v73, v73, v89
  v_add_f32 v74, v74, v90
  v_add_f32 v75, v75, v91
  v_add_f32 v76, v76, v92
  v_add_f32 v77, v77, v93
  v_add_f32 v78, v78, v94
  v_add_f32 v79, v79, v95
  v_cvt_pk_bf16_f32 v72, 0, v72
  v_cvt_pk_bf16_f32 v73, 0, v73
  v_cvt_pk_bf16_f32 v74, 0, v74
  v_cvt_pk_bf16_f32 v75, 0, v75
  v_cvt_pk_bf16_f32 v76, 0, v76
  v_cvt_pk_bf16_f32 v77, 0, v77
  v_cvt_pk_bf16_f32 v78, 0, v78
  v_cvt_pk_bf16_f32 v79, 0, v79
  v_add_f32 v80, v80, v72
  v_add_f32 v81, v81, v73
  v_add_f32 v82, v82, v74
  v_add_f32 v83, v83, v75
  v_add_f32 v84, v84, v76
  v_add_f32 v85, v85, v77
  v_add_f32 v86, v86, v78
  v_add_f32 v87, v87, v79
  v_cvt_pk_bf16_f32 v112, v80, v81
  v_cvt_pk_bf16_f32 v113, v82, v83
  v_cvt_pk_bf16_f32 v114, v84, v85
  v_cvt_pk_bf16_f32 v115, v86, v87
  v_lshlrev_b32 v80, 16, v112
  v_and_b32 v81, 0xffff0000, v112
  v_lshlrev_b32 v82, 16, v113
  v_and_b32 v83, 0xffff0000, v113
  v_lshlrev_b32 v84, 16, v114
  v_and_b32 v85, 0xffff0000, v114
  v_lshlrev_b32 v86, 16, v115
  v_and_b32 v87, 0xffff0000, v115
  s_lshl_b32 s26, s59, 10
  buffer_store_dwordx4 v[112:115], v0, s[72:75], s26 offen sc1
m_done_110:
k_nx_106:
  s_add_u32 s47, s47, 3
  s_xor_b32 s48, s48, 31
  s_andn2_b32 s28, 0xfe0, s56
  s_lshl_b32 s28, s28, 7
  s_mov_b32 s29, 243793920
  v_mov_b32 v24, 262144
  s_mov_b32 s53, 0
  s_mov_b32 s33, 3
  v_mov_b32 v53, s58
  s_and_b32 s32, s48, 15
  s_cbranch_scc0 k_x_113
k_w_112:
  s_add_u32 s33, s33, 1
  s_and_b32 s33, s33, 3
  s_bitcmp1_b32 s32, s33
  s_cbranch_scc0 k_w_112
  s_lshl2_add_u32 s26, s33, s17
  s_lshl_b32 s26, s26, 14
  s_add_u32 s27, s26, 8192
  v_add_u32 v22, s26, v9
  v_cmp_le_u32 vcc, s28, v22
  s_nop 1
  v_cndmask_b32 v25, 0, v24, vcc
  v_add_u32 v22, v22, v25
  buffer_load_dword v20, v22, s[4:7], s29 offen sc1
  v_add_u32 v23, s27, v9
  v_cmp_le_u32 vcc, s28, v23
  s_nop 1
  v_cndmask_b32 v25, 0, v24, vcc
  v_add_u32 v23, v23, v25
  buffer_load_dword v21, v23, s[4:7], s29 offen sc1
  s_add_u32 s53, s53, 1
  s_cmp_gt_u32 s53, 1048576
  s_cbranch_scc1 q_fail_90
  s_waitcnt vmcnt(0)
  v_min_u32 v52, v20, v21
  v_max3_u32 v53, v20, v21, v53
  v_cmp_eq_u32 vcc, 0, v52
  s_cbranch_vccnz k_w_112
  s_bitset0_b32 s32, s33
  s_cmp_lg_u32 s32, 0
  s_cbranch_scc1 k_w_112
  v_max_u32_dpp v53, v53, v53 row_ror:8 row_mask:0xf bank_mask:0xf
  s_nop 1
  v_max_u32_dpp v53, v53, v53 row_ror:4 row_mask:0xf bank_mask:0xf
  s_nop 1
  v_max_u32_dpp v53, v53, v53 row_ror:2 row_mask:0xf bank_mask:0xf
  s_nop 1
  v_max_u32_dpp v53, v53, v53 row_ror:1 row_mask:0xf bank_mask:0xf
  v_mov_b32 v52, v53
  s_nop 0
  s_nop 0
  v_permlane16_swap_b32 v53, v52
  v_max_u32 v53, v53, v52
  v_mov_b32 v52, v53
  s_nop 0
  s_nop 0
  v_permlane32_swap_b32 v53, v52
  v_max_u32 v53, v53, v52
k_x_113:
  ds_write_b32 v118, v53 offset:256
  s_waitcnt vmcnt(0) lgkmcnt(0)
  s_barrier
  ds_read_b128 v[20:23], v119 offset:256
  s_waitcnt lgkmcnt(0)
  v_max3_u32 v20, v20, v21, v22
  v_max_u32 v20, v20, v23
  s_nop 0
  v_readfirstlane_b32 s26, v20
  s_cmp_eq_u32 s26, s58
  s_cbranch_scc1 q_fail_90
  s_cmp_eq_u32 s58, 0
  s_mov_b32 s58, s26
  s_cbranch_scc1 k_r_114
  s_cmp_lg_u32 s57, 0
  s_cbranch_scc1 k_r_114
  s_lshl_b32 s26, s59, 10
  buffer_store_dwordx4 a[0:3], v0, s[72:75], s26 offen sc1
k_r_114:
  s_andn2_b32 s26, 0xfe0, s56
  s_andn2_b32 s27, 0xfe0, s58
  s_cmp_lt_u32 s27, s26
  s_cselect_b32 s61, 1, 2
  s_andn2_b32 s59, 0xfff, s58
  s_lshl_b32 s26, s61, 21
  s_lshl_b32 s27, s59, 10
  s_add_u32 s26, s26, s27
  s_lshl_b32 s27, s17, 8
  s_add_u32 s26, s26, s27
  s_add_u32 s26, s26, 27262976
  v_lshrrev_b32 v5, 7, v0
  v_lshlrev_b32 v5, 5, v5
  buffer_load_dwordx4 v[52:55], v5, s[4:7], s26 offen offset:0 sc1
  buffer_load_dwordx4 v[56:59], v5, s[4:7], s26 offen offset:16 sc1
  s_load_dwordx2 s[64:65], s[0:1], 72
  s_load_dwordx2 s[68:69], s[0:1], 80
  s_load_dwordx2 s[8:9], s[0:1], 88
  s_mov_b32 s66, 1835008
  s_mov_b32 s70, 1835008
  s_mov_b32 s10, 1835008
  v_lshrrev_b32 v2, 7, v0
  v_and_b32 v3, 0x70, v0
  v_mul_u32_u24 v6, 57344, v2
  v_add_u32 v6, v6, v3
  v_cmp_eq_u32 vcc, 0x70, v3
  v_mov_b32 v3, 0x7ff00000
  s_nop 0
  v_cndmask_b32 v6, v6, v3, vcc
  v_lshrrev_b32 v2, 8, v0
  v_mul_u32_u24 v7, 14336, v2
  v_and_b32 v3, 0xf0, v0
  v_add_u32 v7, v7, v3
  s_mul_i32 s34, s17, 458752
  s_mul_i32 s27, s16, 112
  s_add_u32 s34, s34, s27
  s_mul_i32 s35, s16, 57344
  s_lshl_b32 s27, s17, 8
  s_add_u32 s35, s35, s27
  s_waitcnt lgkmcnt(0)
  s_xor_b32 s37, s50, 32768
  s_add_u32 s37, s37, s54
  s_mov_b32 m0, s37
  s_add_u32 s36, s34, 39424
  buffer_load_dwordx4 v6, s[68:71], s36 offen lds
  s_add_u32 m0, m0, 1024
  s_add_u32 s36, s34, 43008
  buffer_load_dwordx4 v6, s[64:67], s36 offen lds
  s_add_u32 m0, m0, 1024
  s_add_u32 s36, s34, 43008
  buffer_load_dwordx4 v6, s[68:71], s36 offen lds
  s_add_u32 m0, m0, 1024
  s_add_u32 s36, s34, 46592
  buffer_load_dwordx4 v6, s[64:67], s36 offen lds
  s_add_u32 m0, m0, 1024
  s_add_u32 s36, s34, 46592
  buffer_load_dwordx4 v6, s[68:71], s36 offen lds
  s_add_u32 m0, m0, 1024
  s_add_u32 s36, s34, 50176
  buffer_load_dwordx4 v6, s[64:67], s36 offen lds
  s_add_u32 m0, m0, 1024
  s_add_u32 s36, s34, 50176
  buffer_load_dwordx4 v6, s[68:71], s36 offen lds
  s_add_u32 m0, m0, 1024
  s_add_u32 s36, s34, 53760
  buffer_load_dwordx4 v6, s[64:67], s36 offen lds
  s_add_u32 m0, m0, 1024
  s_add_u32 s36, s34, 53760
  buffer_load_dwordx4 v[60:63], v6, s[68:71], s36 offen
  buffer_load_dwordx4 v[64:67], v7, s[8:11], s35 offen offset:0
  buffer_load_dwordx4 v[68:71], v7, s[8:11], s35 offen offset:1024
  buffer_load_dwordx4 v[72:75], v7, s[8:11], s35 offen offset:2048
  buffer_load_dwordx4 v[76:79], v7, s[8:11], s35 offen offset:3072
  s_add_u32 s35, s35, 4096
  buffer_load_dwordx4 v[80:83], v7, s[8:11], s35 offen offset:0
  buffer_load_dwordx4 v[84:87], v7, s[8:11], s35 offen offset:1024
  buffer_load_dwordx4 v[88:91], v7, s[8:11], s35 offen offset:2048
  buffer_load_dwordx4 v[92:95], v7, s[8:11], s35 offen offset:3072
  s_add_u32 s35, s35, 4096
  buffer_load_dwordx4 v[96:99], v7, s[8:11], s35 offen offset:0
  buffer_load_dwordx4 v[100:103], v7, s[8:11], s35 offen offset:1024
  buffer_load_dwordx4 v[104:107], v7, s[8:11], s35 offen offset:2048
  buffer_load_dwordx4 v[108:111], v7, s[8:11], s35 offen offset:3072
  s_add_u32 s35, s35, 4096
  buffer_load_dwordx4 v[112:115], v7, s[8:11], s35 offen offset:0
  buffer_load_dwordx4 v[48:51], v7, s[8:11], s35 offen offset:1024
  s_mov_b32 vcc_lo, 0xaaaaaaaa
  s_mov_b32 vcc_hi, 0xaaaaaaaa
  v_mov_b32 v3, 0xffff
  v_mov_b32 v24, 0xffff0000
  v_cndmask_b32 v3, v3, v24, vcc
  s_mov_b32 vcc_lo, 0x3030303
  s_mov_b32 vcc_hi, 0x3030303
  v_cndmask_b32 v24, 0, v3, vcc
  s_mov_b32 vcc_lo, 0xc0c0c0c
  s_mov_b32 vcc_hi, 0xc0c0c0c
  v_cndmask_b32 v25, 0, v3, vcc
  s_mov_b32 vcc_lo, 0x30303030
  s_mov_b32 vcc_hi, 0x30303030
  v_cndmask_b32 v26, 0, v3, vcc
  s_mov_b32 vcc_lo, 0xc0c0c0c0
  s_mov_b32 vcc_hi, 0xc0c0c0c0
  v_cndmask_b32 v27, 0, v3, vcc
  s_mov_b32 s30, 0x01000100
  s_mov_b32 s31, 0x03020302
  s_mul_i32 s26, s17, 23552
  s_add_u32 s26, s26, 65536
  v_add_u32 v5, s26, v0
  v_add_u32 v2, s37, v0
  ds_read_b128 v[36:39], v5 offset:0
  ds_read_b128 v[40:43], v5 offset:1024
  ds_read_b128 v[44:47], v5 offset:2048
  ds_read_b128 v[12:15], v5 offset:3072
  ds_read_b128 v[16:19], v5 offset:4096
  ds_read_b128 v[120:123], v5 offset:5120
  ds_read_b128 v[124:127], v5 offset:6144
  s_waitcnt vmcnt(23)
  v_perm_b32 v3, v52, v52, s30
  v_and_b32 v20, v24, v3
  v_and_b32 v21, v25, v3
  v_and_b32 v22, v26, v3
  v_and_b32 v23, v27, v3
  s_waitcnt lgkmcnt(5)
  s_nop 0
  v_mfma_f32_16x16x32_bf16 v[28:31], v[20:23], v[36:39], 0
  ds_read_b128 v[36:39], v5 offset:7168
  v_mfma_f32_16x16x32_bf16 v[32:35], v[20:23], v[40:43], 0
  ds_read_b128 v[40:43], v5 offset:8192
  v_perm_b32 v3, v52, v52, s31
  v_and_b32 v20, v24, v3
  v_and_b32 v21, v25, v3
  v_and_b32 v22, v26, v3
  v_and_b32 v23, v27, v3
  s_waitcnt lgkmcnt(5)
  s_nop 0
  v_mfma_f32_16x16x32_bf16 v[28:31], v[20:23], v[44:47], v[28:31]
  ds_read_b128 v[44:47], v5 offset:9216
  v_mfma_f32_16x16x32_bf16 v[32:35], v[20:23], v[12:15], v[32:35]
  ds_read_b128 v[12:15], v5 offset:10240
  v_perm_b32 v3, v53, v53, s30
  v_and_b32 v20, v24, v3
  v_and_b32 v21, v25, v3
  v_and_b32 v22, v26, v3
  v_and_b32 v23, v27, v3
  s_waitcnt lgkmcnt(5)
  s_nop 0
  v_mfma_f32_16x16x32_bf16 v[28:31], v[20:23], v[16:19], v[28:31]
  ds_read_b128 v[16:19], v5 offset:11264
  v_mfma_f32_16x16x32_bf16 v[32:35], v[20:23], v[120:123], v[32:35]
  ds_read_b128 v[120:123], v5 offset:12288
  v_perm_b32 v3, v53, v53, s31
  v_and_b32 v20, v24, v3
  v_and_b32 v21, v25, v3
  v_and_b32 v22, v26, v3
  v_and_b32 v23, v27, v3
  s_waitcnt lgkmcnt(5)
  s_nop 0
  v_mfma_f32_16x16x32_bf16 v[28:31], v[20:23], v[124:127], v[28:31]
  ds_read_b128 v[124:127], v5 offset:13312
  v_mfma_f32_16x16x32_bf16 v[32:35], v[20:23], v[36:39], v[32:35]
  ds_read_b128 v[36:39], v5 offset:14336
  v_perm_b32 v3, v54, v54, s30
  v_and_b32 v20, v24, v3
  v_and_b32 v21, v25, v3
  v_and_b32 v22, v26, v3
  v_and_b32 v23, v27, v3
  s_waitcnt lgkmcnt(5)
  s_nop 0
  v_mfma_f32_16x16x32_bf16 v[28:31], v[20:23], v[40:43], v[28:31]
  ds_read_b128 v[40:43], v5 offset:15360
  v_mfma_f32_16x16x32_bf16 v[32:35], v[20:23], v[44:47], v[32:35]
  ds_read_b128 v[44:47], v5 offset:16384
  v_perm_b32 v3, v54, v54, s31
  v_and_b32 v20, v24, v3
  v_and_b32 v21, v25, v3
  v_and_b32 v22, v26, v3
  v_and_b32 v23, v27, v3
  s_waitcnt lgkmcnt(5)
  s_nop 0
  v_mfma_f32_16x16x32_bf16 v[28:31], v[20:23], v[12:15], v[28:31]
  ds_read_b128 v[12:15], v5 offset:17408
  v_mfma_f32_16x16x32_bf16 v[32:35], v[20:23], v[16:19], v[32:35]
  ds_read_b128 v[16:19], v5 offset:18432
  v_perm_b32 v3, v55, v55, s30
  v_and_b32 v20, v24, v3
  v_and_b32 v21, v25, v3
  v_and_b32 v22, v26, v3
  v_and_b32 v23, v27, v3
  s_waitcnt lgkmcnt(5)
  s_nop 0
  v_mfma_f32_16x16x32_bf16 v[28:31], v[20:23], v[120:123], v[28:31]
  ds_read_b128 v[120:123], v5 offset:19456
  v_mfma_f32_16x16x32_bf16 v[32:35], v[20:23], v[124:127], v[32:35]
  ds_read_b128 v[124:127], v5 offset:20480
  v_perm_b32 v3, v55, v55, s31
  v_and_b32 v20, v24, v3
  v_and_b32 v21, v25, v3
  v_and_b32 v22, v26, v3
  v_and_b32 v23, v27, v3
  s_waitcnt lgkmcnt(5)
  s_nop 0
  v_mfma_f32_16x16x32_bf16 v[28:31], v[20:23], v[36:39], v[28:31]
  ds_read_b128 v[36:39], v5 offset:21504
  v_mfma_f32_16x16x32_bf16 v[32:35], v[20:23], v[40:43], v[32:35]
  ds_read_b128 v[40:43], v5 offset:22528
  v_perm_b32 v3, v56, v56, s30
  v_and_b32 v20, v24, v3
  v_and_b32 v21, v25, v3
  v_and_b32 v22, v26, v3
  v_and_b32 v23, v27, v3
  s_waitcnt lgkmcnt(5)
  s_nop 0
  v_mfma_f32_16x16x32_bf16 v[28:31], v[20:23], v[44:47], v[28:31]
  s_waitcnt vmcnt(22)
  ds_read_b128 v[44:47], v2 offset:0
  v_mfma_f32_16x16x32_bf16 v[32:35], v[20:23], v[12:15], v[32:35]
  s_waitcnt vmcnt(21)
  ds_read_b128 v[12:15], v2 offset:1024
  v_perm_b32 v3, v56, v56, s31
  v_and_b32 v20, v24, v3
  v_and_b32 v21, v25, v3
  v_and_b32 v22, v26, v3
  v_and_b32 v23, v27, v3
  s_waitcnt lgkmcnt(5)
  s_nop 0
  v_mfma_f32_16x16x32_bf16 v[28:31], v[20:23], v[16:19], v[28:31]
  s_waitcnt vmcnt(20)
  ds_read_b128 v[16:19], v2 offset:2048
  v_mfma_f32_16x16x32_bf16 v[32:35], v[20:23], v[120:123], v[32:35]
  s_waitcnt vmcnt(19)
  ds_read_b128 v[120:123], v2 offset:3072
  v_perm_b32 v3, v57, v57, s30
  v_and_b32 v20, v24, v3
  v_and_b32 v21, v25, v3
  v_and_b32 v22, v26, v3
  v_and_b32 v23, v27, v3
  s_waitcnt lgkmcnt(5)
  s_nop 0
  v_mfma_f32_16x16x32_bf16 v[28:31], v[20:23], v[124:127], v[28:31]
  s_waitcnt vmcnt(18)
  ds_read_b128 v[124:127], v2 offset:4096
  v_mfma_f32_16x16x32_bf16 v[32:35], v[20:23], v[36:39], v[32:35]
  s_waitcnt vmcnt(17)
  ds_read_b128 v[36:39], v2 offset:5120
  v_perm_b32 v3, v57, v57, s31
  v_and_b32 v20, v24, v3
  v_and_b32 v21, v25, v3
  v_and_b32 v22, v26, v3
  v_and_b32 v23, v27, v3
  s_waitcnt lgkmcnt(5)
  s_nop 0
  v_mfma_f32_16x16x32_bf16 v[28:31], v[20:23], v[40:43], v[28:31]
  s_waitcnt vmcnt(16)
  ds_read_b128 v[40:43], v2 offset:6144
  v_mfma_f32_16x16x32_bf16 v[32:35], v[20:23], v[44:47], v[32:35]
  s_waitcnt vmcnt(15)
  ds_read_b128 v[44:47], v2 offset:7168
  v_perm_b32 v3, v58, v58, s30
  v_and_b32 v20, v24, v3
  v_and_b32 v21, v25, v3
  v_and_b32 v22, v26, v3
  v_and_b32 v23, v27, v3
  s_waitcnt lgkmcnt(5)
  s_nop 0
  v_mfma_f32_16x16x32_bf16 v[28:31], v[20:23], v[12:15], v[28:31]
  v_mfma_f32_16x16x32_bf16 v[32:35], v[20:23], v[16:19], v[32:35]
  v_perm_b32 v3, v58, v58, s31
  v_and_b32 v20, v24, v3
  v_and_b32 v21, v25, v3
  v_and_b32 v22, v26, v3
  v_and_b32 v23, v27, v3
  s_waitcnt lgkmcnt(3)
  s_nop 0
  v_mfma_f32_16x16x32_bf16 v[28:31], v[20:23], v[120:123], v[28:31]
  v_mfma_f32_16x16x32_bf16 v[32:35], v[20:23], v[124:127], v[32:35]
  v_perm_b32 v3, v59, v59, s30
  v_and_b32 v20, v24, v3
  v_and_b32 v21, v25, v3
  v_and_b32 v22, v26, v3
  v_and_b32 v23, v27, v3
  s_waitcnt lgkmcnt(1)
  s_nop 0
  v_mfma_f32_16x16x32_bf16 v[28:31], v[20:23], v[36:39], v[28:31]
  v_mfma_f32_16x16x32_bf16 v[32:35], v[20:23], v[40:43], v[32:35]
  v_perm_b32 v3, v59, v59, s31
  v_and_b32 v20, v24, v3
  v_and_b32 v21, v25, v3
  v_and_b32 v22, v26, v3
  v_and_b32 v23, v27, v3
  s_waitcnt lgkmcnt(0)
  s_waitcnt vmcnt(14)
  v_mfma_f32_16x16x32_bf16 v[28:31], v[20:23], v[44:47], v[28:31]
  v_mfma_f32_16x16x32_bf16 v[32:35], v[20:23], v[60:63], v[32:35]
  v_lshrrev_b32 v2, 8, v0
  v_and_b32 v3, 0xf0, v0
  v_lshlrev_b32 v3, 1, v3
  v_and_b32 v5, 1, v2
  v_lshl_add_u32 v5, v5, 4, v3
  v_add_u32 v5, s37, v5
  s_mov_b32 exec_lo, 0x00ff00ff
  s_mov_b32 exec_hi, 0xff00ff00
  ds_write_b128 v5, v[28:31]
  ds_write_b128 v5, v[32:35] offset:512
  s_mov_b64 exec, -1
  s_xor_b32 s26, s50, 32768
  v_add_u32 v5, s26, v1
  v_lshl_add_u32 v3, v2, 4, v3
  s_waitcnt lgkmcnt(0)
  s_barrier
  ds_read2st64_b32 v[36:37], v5 offset0:0 offset1:1
  ds_read2st64_b32 v[52:53], v5 offset0:2 offset1:3
  ds_read2st64_b32 v[38:39], v5 offset0:32 offset1:33
  ds_read2st64_b32 v[54:55], v5 offset0:34 offset1:35
  ds_read2st64_b32 v[40:41], v5 offset0:64 offset1:65
  ds_read2st64_b32 v[56:57], v5 offset0:66 offset1:67
  ds_read2st64_b32 v[42:43], v5 offset0:96 offset1:97
  ds_read2st64_b32 v[58:59], v5 offset0:98 offset1:99
  s_waitcnt lgkmcnt(0)
  v_add_f32 v36, v36, v40
  v_add_f32 v37, v37, v41
  v_add_f32 v38, v38, v42
  v_add_f32 v39, v39, v43
  v_add_f32 v52, v52, v56
  v_add_f32 v53, v53, v57
  v_add_f32 v54, v54, v58
  v_add_f32 v55, v55, v59
  v_add_f32 v36, v36, v38
  v_add_f32 v37, v37, v39
  v_add_f32 v52, v52, v54
  v_add_f32 v53, v53, v55
  v_add_f32 v36, v36, v37
  v_add_f32 v52, v52, v53
  v_cvt_pk_bf16_f32 v36, 0, v36
  v_cvt_pk_bf16_f32 v52, 0, v52
  v_mul_f32 v40, 0xbfb8aa3b, v36
  v_exp_f32 v40, v40
  s_nop 0
  v_add_f32 v40, 1.0, v40
  v_rcp_f32 v40, v40
  s_nop 0
  v_mul_f32 v36, v36, v40
  v_cvt_pk_bf16_f32 v36, 0, v36
  v_mul_f32 v36, v36, v52
  v_cvt_pk_bf16_f32 v36, v36, v36
  s_lshl_b32 s26, s17, 8
  s_add_u32 s26, s26, 161792
  v_add_u32 v5, s26, v1
  ds_write_b32 v5, v36
  v_mul_u32_u24 v5, 56, v2
  v_add_u32 v5, s26, v5
  ds_read_b64 v[36:37], v5 offset:0
  ds_read_b64 v[38:39], v5 offset:8
  ds_read_b64 v[40:41], v5 offset:16
  ds_read_b64 v[42:43], v5 offset:24
  ds_read_b64 v[44:45], v5 offset:32
  ds_read_b64 v[46:47], v5 offset:40
  ds_read_b64 v[52:53], v5 offset:48
  s_waitcnt lgkmcnt(0)
  v_and_b32 v20, v24, v36
  v_and_b32 v21, v25, v36
  v_and_b32 v22, v26, v36
  v_and_b32 v23, v27, v36
  s_waitcnt vmcnt(13)
  s_nop 0
  v_mfma_f32_16x16x32_bf16 v[28:31], v[20:23], v[64:67], 0
  v_and_b32 v32, v24, v37
  v_and_b32 v33, v25, v37
  v_and_b32 v34, v26, v37
  v_and_b32 v35, v27, v37
  s_waitcnt vmcnt(12)
  s_nop 0
  v_mfma_f32_16x16x32_bf16 v[28:31], v[32:35], v[68:71], v[28:31]
  v_and_b32 v20, v24, v38
  v_and_b32 v21, v25, v38
  v_and_b32 v22, v26, v38
  v_and_b32 v23, v27, v38
  s_waitcnt vmcnt(11)
  s_nop 0
  v_mfma_f32_16x16x32_bf16 v[28:31], v[20:23], v[72:75], v[28:31]
  v_and_b32 v32, v24, v39
  v_and_b32 v33, v25, v39
  v_and_b32 v34, v26, v39
  v_and_b32 v35, v27, v39
  s_waitcnt vmcnt(10)
  s_nop 0
  v_mfma_f32_16x16x32_bf16 v[28:31], v[32:35], v[76:79], v[28:31]
  v_and_b32 v20, v24, v40
  v_and_b32 v21, v25, v40
  v_and_b32 v22, v26, v40
  v_and_b32 v23, v27, v40
  s_waitcnt vmcnt(9)
  s_nop 0
  v_mfma_f32_16x16x32_bf16 v[28:31], v[20:23], v[80:83], v[28:31]
  v_and_b32 v32, v24, v41
  v_and_b32 v33, v25, v41
  v_and_b32 v34, v26, v41
  v_and_b32 v35, v27, v41
  s_waitcnt vmcnt(8)
  s_nop 0
  v_mfma_f32_16x16x32_bf16 v[28:31], v[32:35], v[84:87], v[28:31]
  v_and_b32 v20, v24, v42
  v_and_b32 v21, v25, v42
  v_and_b32 v22, v26, v42
  v_and_b32 v23, v27, v42
  s_waitcnt vmcnt(7)
  s_nop 0
  v_mfma_f32_16x16x32_bf16 v[28:31], v[20:23], v[88:91], v[28:31]
  v_and_b32 v32, v24, v43
  v_and_b32 v33, v25, v43
  v_and_b32 v34, v26, v43
  v_and_b32 v35, v27, v43
  s_waitcnt vmcnt(6)
  s_nop 0
  v_mfma_f32_16x16x32_bf16 v[28:31], v[32:35], v[92:95], v[28:31]
  v_and_b32 v20, v24, v44
  v_and_b32 v21, v25, v44
  v_and_b32 v22, v26, v44
  v_and_b32 v23, v27, v44
  s_waitcnt vmcnt(5)
  s_nop 0
  v_mfma_f32_16x16x32_bf16 v[28:31], v[20:23], v[96:99], v[28:31]
  v_and_b32 v32, v24, v45
  v_and_b32 v33, v25, v45
  v_and_b32 v34, v26, v45
  v_and_b32 v35, v27, v45
  s_waitcnt vmcnt(4)
  s_nop 0
  v_mfma_f32_16x16x32_bf16 v[28:31], v[32:35], v[100:103], v[28:31]
  v_and_b32 v20, v24, v46
  v_and_b32 v21, v25, v46
  v_and_b32 v22, v26, v46
  v_and_b32 v23, v27, v46
  s_waitcnt vmcnt(3)
  s_nop 0
  v_mfma_f32_16x16x32_bf16 v[28:31], v[20:23], v[104:107], v[28:31]
  v_and_b32 v32, v24, v47
  v_and_b32 v33, v25, v47
  v_and_b32 v34, v26, v47
  v_and_b32 v35, v27, v47
  s_waitcnt vmcnt(2)
  s_nop 0
  v_mfma_f32_16x16x32_bf16 v[28:31], v[32:35], v[108:111], v[28:31]
  v_and_b32 v20, v24, v52
  v_and_b32 v21, v25, v52
  v_and_b32 v22, v26, v52
  v_and_b32 v23, v27, v52
  s_waitcnt vmcnt(1)
  s_nop 0
  v_mfma_f32_16x16x32_bf16 v[28:31], v[20:23], v[112:115], v[28:31]
  v_and_b32 v32, v24, v53
  v_and_b32 v33, v25, v53
  v_and_b32 v34, v26, v53
  v_and_b32 v35, v27, v53
  s_waitcnt vmcnt(0)
  s_nop 0
  v_mfma_f32_16x16x32_bf16 v[28:31], v[32:35], v[48:51], v[28:31]
  v_lshrrev_b32 v3, 1, v3
  s_lshl_b32 s26, s47, 7
  s_add_u32 s26, s26, s57
  s_lshl_b32 s26, s26, 8
  s_add_u32 s26, s26, 244318208
  s_nop 2
  v_cvt_pk_bf16_f32 v28, v28, v29
  v_cvt_pk_bf16_f32 v29, v30, v31
  v_min_u32 v28, -2, v28
  v_min_u32 v29, -2, v29
  s_mov_b32 exec_hi, 0
  buffer_store_dwordx2 v[28:29], v3, s[4:7], s26 offen sc1
  s_mov_b32 exec_hi, -1
  s_cmp_lg_u32 s16, 0
  s_cbranch_scc1 q_fail_90
  s_barrier
  s_lshl_b32 s26, s61, 21
  s_lshl_b32 s27, s59, 10
  s_add_u32 s26, s26, s27
  s_add_u32 s27, s26, 20971520
  s_add_u32 s28, s26, 27262976
  s_lshl_b32 s26, s47, 7
  s_add_u32 s26, s26, s17
  s_lshl_b32 s26, s26, 8
  s_add_u32 s26, s26, 244318208
  v_lshrrev_b32 v2, 8, v0
  v_and_b32 v3, 0xf0, v0
  v_lshl_add_u32 v5, v2, 10, v3
  buffer_load_dwordx4 v[108:111], v0, s[4:7], s27 offen sc1
  buffer_load_dwordx4 v[112:115], v0, s[4:7], s28 offen sc1
  s_mov_b32 s53, 0
m_w_116:
  s_add_u32 s27, s26, 0
  buffer_load_dwordx4 v[20:23], v5, s[4:7], s27 offen sc1
  s_add_u32 s27, s26, 4096
  buffer_load_dwordx4 v[24:27], v5, s[4:7], s27 offen sc1
  s_add_u32 s27, s26, 8192
  buffer_load_dwordx4 v[28:31], v5, s[4:7], s27 offen sc1
  s_add_u32 s27, s26, 12288
  buffer_load_dwordx4 v[32:35], v5, s[4:7], s27 offen sc1
  s_add_u32 s27, s26, 16384
  buffer_load_dwordx4 v[36:39], v5, s[4:7], s27 offen sc1
  s_add_u32 s27, s26, 20480
  buffer_load_dwordx4 v[40:43], v5, s[4:7], s27 offen sc1
  s_add_u32 s27, s26, 24576
  buffer_load_dwordx4 v[44:47], v5, s[4:7], s27 offen sc1
  s_add_u32 s27, s26, 28672
  buffer_load_dwordx4 v[48:51], v5, s[4:7], s27 offen sc1
  s_add_u32 s53, s53, 1
  s_cmp_gt_u32 s53, 1048576
  s_cbranch_scc1 q_fail_90
  s_mov_b32 vcc_lo, 0xaaaaaaaa
  s_mov_b32 vcc_hi, 0xaaaaaaaa
  v_mov_b32 v72, 0x3f80
  v_mov_b32 v68, 1.0
  v_cndmask_b32 v72, v72, v68, vcc
  s_mov_b32 vcc_lo, 0x30003
  s_mov_b32 vcc_hi, 0x30003
  v_cndmask_b32 v68, 0, v72, vcc
  s_mov_b32 vcc_lo, 0xc000c
  s_mov_b32 vcc_hi, 0xc000c
  v_cndmask_b32 v69, 0, v72, vcc
  s_mov_b32 vcc_lo, 0x300030
  s_mov_b32 vcc_hi, 0x300030
  v_cndmask_b32 v70, 0, v72, vcc
  s_mov_b32 vcc_lo, 0xc000c0
  s_mov_b32 vcc_hi, 0xc000c0
  v_cndmask_b32 v71, 0, v72, vcc
  s_waitcnt vmcnt(7)
  s_nop 0
  v_mfma_f32_16x16x32_bf16 v[72:75], v[68:71], v[20:23], 0
  v_max3_u32 v80, v20, v21, 0
  v_max3_u32 v80, v22, v23, v80
  s_waitcnt vmcnt(6)
  v_mfma_f32_16x16x32_bf16 v[72:75], v[68:71], v[24:27], v[72:75]
  v_max3_u32 v80, v24, v25, v80
  v_max3_u32 v80, v26, v27, v80
  s_waitcnt vmcnt(5)
  v_mfma_f32_16x16x32_bf16 v[72:75], v[68:71], v[28:31], v[72:75]
  v_max3_u32 v80, v28, v29, v80
  v_max3_u32 v80, v30, v31, v80
  s_waitcnt vmcnt(4)
  v_mfma_f32_16x16x32_bf16 v[72:75], v[68:71], v[32:35], v[72:75]
  v_max3_u32 v80, v32, v33, v80
  v_max3_u32 v80, v34, v35, v80
  s_waitcnt vmcnt(3)
  v_mfma_f32_16x16x32_bf16 v[72:75], v[68:71], v[36:39], v[72:75]
  v_max3_u32 v80, v36, v37, v80
  v_max3_u32 v80, v38, v39, v80
  s_waitcnt vmcnt(2)
  v_mfma_f32_16x16x32_bf16 v[72:75], v[68:71], v[40:43], v[72:75]
  v_max3_u32 v80, v40, v41, v80
  v_max3_u32 v80, v42, v43, v80
  s_waitcnt vmcnt(1)
  v_mfma_f32_16x16x32_bf16 v[72:75], v[68:71], v[44:47], v[72:75]
  v_max3_u32 v80, v44, v45, v80
  v_max3_u32 v80, v46, v47, v80
  s_waitcnt vmcnt(0)
  v_mfma_f32_16x16x32_bf16 v[72:75], v[68:71], v[48:51], v[72:75]
  v_max3_u32 v80, v48, v49, v80
  v_max3_u32 v80, v50, v51, v80
  v_cmp_eq_u32 vcc, -1, v80
  s_cbranch_vccnz m_w_116
  v_lshlrev_b32 v3, 1, v3
  v_lshl_add_u32 v3, v2, 4, v3
  s_lshl_b32 s26, s17, 9
  s_add_u32 s26, s26, 159744
  v_add_u32 v3, s26, v3
  s_mov_b32 exec_hi, 0
  ds_write_b128 v3, v[72:75]
  s_mov_b32 exec_hi, -1
  v_lshlrev_b32 v3, 1, v0
  v_add_u32 v3, 159744, v3
  v_lshlrev_b32 v80, 16, v108
  v_and_b32 v81, 0xffff0000, v108
  v_lshlrev_b32 v82, 16, v109
  v_and_b32 v83, 0xffff0000, v109
  v_lshlrev_b32 v84, 16, v110
  v_and_b32 v85, 0xffff0000, v110
  v_lshlrev_b32 v86, 16, v111
  v_and_b32 v87, 0xffff0000, v111
  v_lshlrev_b32 v88, 16, v112
  v_and_b32 v89, 0xffff0000, v112
  v_lshlrev_b32 v90, 16, v113
  v_and_b32 v91, 0xffff0000, v113
  v_lshlrev_b32 v92, 16, v114
  v_and_b32 v93, 0xffff0000, v114
  v_lshlrev_b32 v94, 16, v115
  v_and_b32 v95, 0xffff0000, v115
  s_waitcnt lgkmcnt(0)
  s_barrier
  s_cmp_lg_u32 s17, 0
  s_cbranch_scc1 m_done_115
  ds_read_b128 v[72:75], v3
  ds_read_b128 v[76:79], v3 offset:16
  s_and_b32 s29, s58, 0xffff0000
  s_xor_b32 s27, s29, 0x80000000
  s_xor_b32 s28, s29, 0xffff0000
  s_bitcmp1_b32 s29, 31
  s_cselect_b32 s29, s27, s28
  v_mov_b32 v108, s29
  v_mul_f32 v108, 0xbfb8aa3b, v108
  v_exp_f32 v108, v108
  s_nop 0
  v_add_f32 v108, 1.0, v108
  v_rcp_f32 v108, v108
  s_nop 0
  v_cvt_pk_bf16_f32 v108, 0, v108
  s_waitcnt lgkmcnt(0)
  v_cvt_pk_bf16_f32 v72, 0, v72
  v_cvt_pk_bf16_f32 v73, 0, v73
  v_cvt_pk_bf16_f32 v74, 0, v74
  v_cvt_pk_bf16_f32 v75, 0, v75
  v_cvt_pk_bf16_f32 v76, 0, v76
  v_cvt_pk_bf16_f32 v77, 0, v77
  v_cvt_pk_bf16_f32 v78, 0, v78
  v_cvt_pk_bf16_f32 v79, 0, v79
  v_mul_f32 v72, v72, v108
  v_mul_f32 v73, v73, v108
  v_mul_f32 v74, v74, v108
  v_mul_f32 v75, v75, v108
  v_mul_f32 v76, v76, v108
  v_mul_f32 v77, v77, v108
  v_mul_f32 v78, v78, v108
  v_mul_f32 v79, v79, v108
  v_cvt_pk_bf16_f32 v72, 0, v72
  v_cvt_pk_bf16_f32 v73, 0, v73
  v_cvt_pk_bf16_f32 v74, 0, v74
  v_cvt_pk_bf16_f32 v75, 0, v75
  v_cvt_pk_bf16_f32 v76, 0, v76
  v_cvt_pk_bf16_f32 v77, 0, v77
  v_cvt_pk_bf16_f32 v78, 0, v78
  v_cvt_pk_bf16_f32 v79, 0, v79
  v_add_f32 v72, v72, v88
  v_add_f32 v73, v73, v89
  v_add_f32 v74, v74, v90
  v_add_f32 v75, v75, v91
  v_add_f32 v76, v76, v92
  v_add_f32 v77, v77, v93
  v_add_f32 v78, v78, v94
  v_add_f32 v79, v79, v95
  v_cvt_pk_bf16_f32 v72, 0, v72
  v_cvt_pk_bf16_f32 v73, 0, v73
  v_cvt_pk_bf16_f32 v74, 0, v74
  v_cvt_pk_bf16_f32 v75, 0, v75
  v_cvt_pk_bf16_f32 v76, 0, v76
  v_cvt_pk_bf16_f32 v77, 0, v77
  v_cvt_pk_bf16_f32 v78, 0, v78
  v_cvt_pk_bf16_f32 v79, 0, v79
  v_add_f32 v80, v80, v72
  v_add_f32 v81, v81, v73
  v_add_f32 v82, v82, v74
  v_add_f32 v83, v83, v75
  v_add_f32 v84, v84, v76
  v_add_f32 v85, v85, v77
  v_add_f32 v86, v86, v78
  v_add_f32 v87, v87, v79
  v_cvt_pk_bf16_f32 v112, v80, v81
  v_cvt_pk_bf16_f32 v113, v82, v83
  v_cvt_pk_bf16_f32 v114, v84, v85
  v_cvt_pk_bf16_f32 v115, v86, v87
  v_lshlrev_b32 v80, 16, v112
  v_and_b32 v81, 0xffff0000, v112
  v_lshlrev_b32 v82, 16, v113
  v_and_b32 v83, 0xffff0000, v113
  v_lshlrev_b32 v84, 16, v114
  v_and_b32 v85, 0xffff0000, v114
  v_lshlrev_b32 v86, 16, v115
  v_and_b32 v87, 0xffff0000, v115
  s_lshl_b32 s26, s59, 10
  buffer_store_dwordx4 v[112:115], v0, s[72:75], s26 offen sc1
m_done_115:
q_fail_90:
  s_endpgm
L_o:
  s_sub_u32 s60, s91, 3
  s_and_b32 s61, s90, 15
  s_load_dwordx2 s[80:81], s[0:1], 40
  s_load_dwordx2 s[72:73], s[0:1], 0
  s_mov_b32 s82, 4194304
  v_and_b32 v42, 63, v0
  v_and_b32 v40, 15, v42
  v_lshrrev_b32 v41, 4, v42
  v_lshlrev_b32 v1, 3, v42
  v_lshlrev_b32 v2, 2, v42
  v_lshlrev_b32 v0, 4, v42
  s_mov_b32 s24, 0x3e0293ee
  s_mov_b32 s44, 0x05040100
  s_mov_b32 s45, 0x07060302
  s_and_b32 s26, s17, 1
  s_lshl_b32 s26, s26, 4
  v_lshlrev_b32 v43, 2, v41
  v_sub_u32 v43, v40, v43
  v_add_u32 v43, s26, v43
  v_mov_b32 v7, 0xfe000000
  v_cmp_le_i32 vcc, 0, v43
  s_nop 1
  v_cndmask_b32 v24, v7, 0, vcc
  v_cmp_le_i32 vcc, 1, v43
  s_nop 1
  v_cndmask_b32 v25, v7, 0, vcc
  v_cmp_le_i32 vcc, 2, v43
  s_nop 1
  v_cndmask_b32 v26, v7, 0, vcc
  v_cmp_le_i32 vcc, 3, v43
  s_nop 1
  v_cndmask_b32 v27, v7, 0, vcc
  v_cmp_le_i32 vcc, 16, v43
  s_nop 1
  v_cndmask_b32 v28, v7, 0, vcc
  v_cmp_le_i32 vcc, 17, v43
  s_nop 1
  v_cndmask_b32 v29, v7, 0, vcc
  v_cmp_le_i32 vcc, 18, v43
  s_nop 1
  v_cndmask_b32 v30, v7, 0, vcc
  v_cmp_le_i32 vcc, 19, v43
  s_nop 1
  v_cndmask_b32 v31, v7, 0, vcc
  v_lshrrev_b32 v43, 5, v42
  v_lshlrev_b32 v43, 16, v43
  v_and_b32 v4, 1, v41
  v_lshl_add_u32 v43, v4, 14, v43
  v_lshl_add_u32 v43, v40, 4, v43
  s_lshl_b32 s26, s61, 10
  s_lshl_b32 s27, s17, 8
  s_add_u32 s26, s26, s27
  v_add_u32 v4, s26, v43
  v_lshlrev_b32 v43, 10, v41
  v_lshl_add_u32 v5, v40, 4, v43
  s_lshl_b32 s26, s17, 12
  v_add_u32 v6, s26, v0
  v_and_b32 v43, 1, v41
  v_lshlrev_b32 v43, 12, v43
  v_lshl_add_u32 v43, v40, 4, v43
  v_lshrrev_b32 v3, 1, v41
  v_lshl_add_u32 v3, v3, 8, v43
  s_lshr_b32 s26, s17, 1
  s_lshl_b32 s27, s26, 14
  s_add_u32 s27, s27, 16384
  v_add_u32 v32, s27, v0
  s_lshl_b32 s27, s26, 13
  s_and_b32 s28, s17, 1
  s_lshl_b32 s28, s28, 10
  s_add_u32 s28, s28, s27
  s_add_u32 s28, s28, 49152
  v_add_u32 v33, s28, v0
  s_add_u32 s27, s27, 65536
  v_add_u32 v34, s27, v0
  v_add_u32 v35, s27, v1
  v_and_b32 v36, 0xf0, v0
  v_and_b32 v252, 64, v0
  v_mov_b32 v248, 0
  v_lshlrev_b32 v255, 4, v0
  v_and_b32 v43, 1, v42
  v_xor_b32 v254, 1, v43
  s_lshl_b32 s26, s17, 3
  s_add_u32 s26, s26, 81920
  v_mov_b32 v39, s26
  s_mov_b32 vcc_lo, 0xaaaaaaaa
  s_mov_b32 vcc_hi, 0xaaaaaaaa
  v_mov_b32 v43, 0x3f80
  v_cndmask_b32 v43, v43, 1.0, vcc
  s_mov_b32 vcc_lo, 0xf000f
  s_mov_b32 vcc_hi, 0xf000f00
  v_cndmask_b32 v16, 0, v43, vcc
  v_cndmask_b32 v18, 0, v43, vcc
  s_mov_b32 vcc_lo, 0xf000f0
  s_mov_b32 vcc_hi, 0xf000f000
  v_cndmask_b32 v17, 0, v43, vcc
  v_cndmask_b32 v19, 0, v43, vcc
  s_mov_b32 vcc_lo, 0xcccccccc
  s_mov_b32 vcc_hi, 0xcccccccc
  v_mov_b32 v43, 0x4444
  v_mov_b32 v20, 0xeeee
  v_cndmask_b32 v20, v43, v20, vcc
  s_mov_b32 s70, 2097152
  s_mov_b32 s71, 0x20000
  s_mov_b32 s74, 2097152
  s_mov_b32 s75, 0x20000
  s_mov_b32 s10, 1024
  s_mov_b32 s83, 0x20000
  s_lshr_b32 s85, s17, 1
  s_lshl_b32 s26, s61, 1
  s_add_u32 s85, s85, s26
  s_add_u32 s43, s26, s17
  s_lshl_b32 s14, s61, 8
  s_lshl_b32 s15, s61, 7
  s_add_u32 s15, s15, 245104640
  s_add_u32 s14, s14, 244318208
  s_lshl_b32 s26, s61, 2
  s_add_u32 s26, s26, s17
  s_lshl_b32 s18, s26, 13
  s_add_u32 s18, s18, 41943040
  s_lshl_b32 s19, s26, 12
  s_add_u32 s19, s19, 142606336
  s_lshl_b32 s20, s85, 13
  s_add_u32 s20, s20, 192937984
  s_and_b32 s26, s17, 1
  s_mul_i32 s26, s26, 3072
  s_add_u32 s21, s20, s26
  s_lshr_b32 s40, s17, 1
  s_lshl_b32 s40, s40, 13
  s_add_u32 s40, s40, s26
  s_add_u32 s40, s40, 65536
  s_lshl_b32 s22, s17, 12
  s_add_u32 s22, s22, 49152
  s_lshl_b32 s23, s17, 13
  s_add_u32 s23, s23, 16384
  s_lshl_b32 s41, s60, 20
  s_add_u32 s41, s41, 12582912
  v_lshlrev_b32 v246, 3, v0
  s_mov_b32 s11, 0x20000
  s_waitcnt lgkmcnt(0)
  s_lshl_b32 s77, s60, 4
  s_add_u32 s77, s77, s61
  s_lshl_b32 s77, s77, 2
  s_add_u32 s77, s77, s17
  s_lshl_b32 s26, s77, 10
  buffer_load_dwordx4 v[176:179], v0, s[72:75], s26 offen
  s_add_u32 s26, s26, 262144
  buffer_load_dwordx4 v[180:183], v0, s[72:75], s26 offen
  s_add_u32 s26, s26, 262144
  buffer_load_dwordx4 v[184:187], v0, s[72:75], s26 offen
  s_add_u32 s26, s26, 262144
  buffer_load_dwordx4 v[188:191], v0, s[72:75], s26 offen
  s_add_u32 s26, s26, 262144
  buffer_load_dwordx4 v[192:195], v0, s[72:75], s26 offen
  s_add_u32 s26, s26, 262144
  buffer_load_dwordx4 v[196:199], v0, s[72:75], s26 offen
  s_add_u32 s26, s26, 262144
  buffer_load_dwordx4 v[200:203], v0, s[72:75], s26 offen
  s_add_u32 s26, s26, 262144
  buffer_load_dwordx4 v[204:207], v0, s[72:75], s26 offen
  s_add_u32 s26, s26, 262144
  v_lshrrev_b32 v44, 9, v0
  v_lshlrev_b32 v44, 12, v44
  v_and_b32 v45, 0xf0, v0
  v_add_u32 v44, v44, v45
  v_bfe_u32 v45, v0, 8, 1
  v_lshl_add_u32 v44, v45, 3, v44
  s_lshl_b32 s30, s61, 18
  s_lshl_b32 s27, s17, 8
  s_add_u32 s30, s30, s27
  s_add_u32 s27, s30, 0
  buffer_load_dwordx2 v[64:65], v44, s[80:83], s27 offen
  s_add_u32 s27, s30, 1024
  buffer_load_dwordx2 v[66:67], v44, s[80:83], s27 offen
  s_add_u32 s27, s30, 2048
  buffer_load_dwordx2 v[68:69], v44, s[80:83], s27 offen
  s_add_u32 s27, s30, 3072
  buffer_load_dwordx2 v[70:71], v44, s[80:83], s27 offen
  s_add_u32 s27, s30, 16384
  buffer_load_dwordx2 v[72:73], v44, s[80:83], s27 offen
  s_add_u32 s27, s30, 17408
  buffer_load_dwordx2 v[74:75], v44, s[80:83], s27 offen
  s_add_u32 s27, s30, 18432
  buffer_load_dwordx2 v[76:77], v44, s[80:83], s27 offen
  s_add_u32 s27, s30, 19456
  buffer_load_dwordx2 v[78:79], v44, s[80:83], s27 offen
  s_add_u32 s27, s30, 8192
  buffer_load_dwordx2 v[80:81], v44, s[80:83], s27 offen
  s_add_u32 s27, s30, 9216
  buffer_load_dwordx2 v[82:83], v44, s[80:83], s27 offen
  s_add_u32 s27, s30, 10240
  buffer_load_dwordx2 v[84:85], v44, s[80:83], s27 offen
  s_add_u32 s27, s30, 11264
  buffer_load_dwordx2 v[86:87], v44, s[80:83], s27 offen
  s_add_u32 s27, s30, 24576
  buffer_load_dwordx2 v[88:89], v44, s[80:83], s27 offen
  s_add_u32 s27, s30, 25600
  buffer_load_dwordx2 v[90:91], v44, s[80:83], s27 offen
  s_add_u32 s27, s30, 26624
  buffer_load_dwordx2 v[92:93], v44, s[80:83], s27 offen
  s_add_u32 s27, s30, 27648
  buffer_load_dwordx2 v[94:95], v44, s[80:83], s27 offen
  s_add_u32 s27, s30, 32768
  buffer_load_dwordx2 v[96:97], v44, s[80:83], s27 offen
  s_add_u32 s27, s30, 33792
  buffer_load_dwordx2 v[98:99], v44, s[80:83], s27 offen
  s_add_u32 s27, s30, 34816
  buffer_load_dwordx2 v[100:101], v44, s[80:83], s27 offen
  s_add_u32 s27, s30, 35840
  buffer_load_dwordx2 v[102:103], v44, s[80:83], s27 offen
  s_add_u32 s27, s30, 49152
  buffer_load_dwordx2 v[104:105], v44, s[80:83], s27 offen
  s_add_u32 s27, s30, 50176
  buffer_load_dwordx2 v[106:107], v44, s[80:83], s27 offen
  s_add_u32 s27, s30, 51200
  buffer_load_dwordx2 v[108:109], v44, s[80:83], s27 offen
  s_add_u32 s27, s30, 52224
  buffer_load_dwordx2 v[110:111], v44, s[80:83], s27 offen
  s_add_u32 s27, s30, 40960
  buffer_load_dwordx2 v[112:113], v44, s[80:83], s27 offen
  s_add_u32 s27, s30, 41984
  buffer_load_dwordx2 v[114:115], v44, s[80:83], s27 offen
  s_add_u32 s27, s30, 43008
  buffer_load_dwordx2 v[116:117], v44, s[80:83], s27 offen
  s_add_u32 s27, s30, 44032
  buffer_load_dwordx2 v[118:119], v44, s[80:83], s27 offen
  s_add_u32 s27, s30, 57344
  buffer_load_dwordx2 v[120:121], v44, s[80:83], s27 offen
  s_add_u32 s27, s30, 58368
  buffer_load_dwordx2 v[122:123], v44, s[80:83], s27 offen
  s_add_u32 s27, s30, 59392
  buffer_load_dwordx2 v[124:125], v44, s[80:83], s27 offen
  s_add_u32 s27, s30, 60416
  buffer_load_dwordx2 v[126:127], v44, s[80:83], s27 offen
  s_load_dwordx2 s[4:5], s[0:1], 112
  s_load_dwordx2 s[12:13], s[0:1], 104
  s_load_dwordx2 s[68:69], s[0:1], 96
  s_load_dwordx2 s[8:9], s[0:1], 64
  s_waitcnt lgkmcnt(0)
  buffer_load_dwordx4 v[56:59], v0, s[8:11], 0 offen
  s_lshl_b32 s29, s77, 10
  s_add_u32 s29, s29, 6291456
  s_cmp_lt_u32 s60, 4
  s_cbranch_scc1 o_s1_117
  s_waitcnt vmcnt(0)
  s_branch o_s2_118
o_s1_117:
  s_waitcnt vmcnt(40)
  v_lshlrev_b32 v212, 16, v176
  v_and_b32 v213, 0xffff0000, v176
  v_lshlrev_b32 v214, 16, v177
  v_and_b32 v215, 0xffff0000, v177
  v_lshlrev_b32 v216, 16, v178
  v_and_b32 v217, 0xffff0000, v178
  v_lshlrev_b32 v218, 16, v179
  v_and_b32 v219, 0xffff0000, v179
  v_add_f32 v220, v212, v213
  v_add_f32 v221, v214, v215
  v_add_f32 v222, v216, v217
  v_add_f32 v223, v218, v219
  v_add_f32 v220, v220, v221
  v_add_f32 v222, v222, v223
  v_add_f32 v220, v220, v222
  s_nop 1
  v_add_f32_dpp v220, v220, v220 row_ror:8 row_mask:0xf bank_mask:0xf
  s_nop 1
  v_add_f32_dpp v220, v220, v220 row_ror:4 row_mask:0xf bank_mask:0xf
  s_nop 1
  v_add_f32_dpp v220, v220, v220 row_ror:2 row_mask:0xf bank_mask:0xf
  s_nop 1
  v_add_f32_dpp v220, v220, v220 row_ror:1 row_mask:0xf bank_mask:0xf
  v_mov_b32 v222, v220
  s_nop 0
  s_nop 0
  v_permlane16_swap_b32 v220, v222
  v_add_f32 v220, v220, v222
  v_mov_b32 v222, v220
  s_nop 0
  s_nop 0
  v_permlane32_swap_b32 v220, v222
  v_add_f32 v220, v220, v222
  v_mul_f32 v220, 0x3b000000, v220
  v_sub_f32 v224, v212, v220
  v_sub_f32 v225, v213, v220
  v_sub_f32 v226, v214, v220
  v_sub_f32 v227, v215, v220
  v_sub_f32 v228, v216, v220
  v_sub_f32 v229, v217, v220
  v_sub_f32 v230, v218, v220
  v_sub_f32 v231, v219, v220
  v_mul_f32 v221, v224, v224
  v_mul_f32 v222, v225, v225
  v_fmac_f32 v221, v226, v226
  v_fmac_f32 v222, v227, v227
  v_fmac_f32 v221, v228, v228
  v_fmac_f32 v222, v229, v229
  v_fmac_f32 v221, v230, v230
  v_fmac_f32 v222, v231, v231
  v_add_f32 v221, v221, v222
  v_cvt_pk_bf16_f32 v220, 0, v220
  s_nop 0
  v_add_f32_dpp v221, v221, v221 row_ror:8 row_mask:0xf bank_mask:0xf
  v_sub_f32 v224, v212, v220
  v_sub_f32 v225, v213, v220
  v_add_f32_dpp v221, v221, v221 row_ror:4 row_mask:0xf bank_mask:0xf
  v_sub_f32 v226, v214, v220
  v_sub_f32 v227, v215, v220
  v_add_f32_dpp v221, v221, v221 row_ror:2 row_mask:0xf bank_mask:0xf
  v_sub_f32 v228, v216, v220
  v_sub_f32 v229, v217, v220
  v_add_f32_dpp v221, v221, v221 row_ror:1 row_mask:0xf bank_mask:0xf
  v_sub_f32 v230, v218, v220
  v_sub_f32 v231, v219, v220
  v_mov_b32 v222, v221
  v_cvt_pk_bf16_f32 v224, 0, v224
  v_cvt_pk_bf16_f32 v225, 0, v225
  v_permlane16_swap_b32 v221, v222
  v_cvt_pk_bf16_f32 v226, 0, v226
  v_cvt_pk_bf16_f32 v227, 0, v227
  v_add_f32 v221, v221, v222
  v_cvt_pk_bf16_f32 v228, 0, v228
  v_cvt_pk_bf16_f32 v229, 0, v229
  v_mov_b32 v222, v221
  v_cvt_pk_bf16_f32 v230, 0, v230
  v_cvt_pk_bf16_f32 v231, 0, v231
  v_permlane32_swap_b32 v221, v222
  v_add_f32 v221, v221, v222
  v_mul_f32 v221, 0x3b000000, v221
  v_cvt_pk_bf16_f32 v221, 0, v221
  v_add_f32 v221, 0x3727c5ac, v221
  v_cvt_pk_bf16_f32 v221, 0, v221
  v_sqrt_f32 v221, v221
  s_nop 0
  v_cvt_pk_bf16_f32 v221, 0, v221
  v_rcp_f32 v221, v221
  s_nop 0
  v_mul_f32 v224, v224, v221
  v_mul_f32 v225, v225, v221
  v_mul_f32 v226, v226, v221
  v_mul_f32 v227, v227, v221
  v_mul_f32 v228, v228, v221
  v_mul_f32 v229, v229, v221
  v_mul_f32 v230, v230, v221
  v_mul_f32 v231, v231, v221
  v_cvt_pk_bf16_f32 v176, v224, v225
  v_cvt_pk_bf16_f32 v177, v226, v227
  v_cvt_pk_bf16_f32 v178, v228, v229
  v_cvt_pk_bf16_f32 v179, v230, v231
  buffer_store_dwordx4 v[176:179], v0, s[4:7], s29 offen sc1
  s_add_u32 s29, s29, 262144
  s_waitcnt vmcnt(40)
  v_lshlrev_b32 v212, 16, v180
  v_and_b32 v213, 0xffff0000, v180
  v_lshlrev_b32 v214, 16, v181
  v_and_b32 v215, 0xffff0000, v181
  v_lshlrev_b32 v216, 16, v182
  v_and_b32 v217, 0xffff0000, v182
  v_lshlrev_b32 v218, 16, v183
  v_and_b32 v219, 0xffff0000, v183
  v_add_f32 v220, v212, v213
  v_add_f32 v221, v214, v215
  v_add_f32 v222, v216, v217
  v_add_f32 v223, v218, v219
  v_add_f32 v220, v220, v221
  v_add_f32 v222, v222, v223
  v_add_f32 v220, v220, v222
  s_nop 1
  v_add_f32_dpp v220, v220, v220 row_ror:8 row_mask:0xf bank_mask:0xf
  s_nop 1
  v_add_f32_dpp v220, v220, v220 row_ror:4 row_mask:0xf bank_mask:0xf
  s_nop 1
  v_add_f32_dpp v220, v220, v220 row_ror:2 row_mask:0xf bank_mask:0xf
  s_nop 1
  v_add_f32_dpp v220, v220, v220 row_ror:1 row_mask:0xf bank_mask:0xf
  v_mov_b32 v222, v220
  s_nop 0
  s_nop 0
  v_permlane16_swap_b32 v220, v222
  v_add_f32 v220, v220, v222
  v_mov_b32 v222, v220
  s_nop 0
  s_nop 0
  v_permlane32_swap_b32 v220, v222
  v_add_f32 v220, v220, v222
  v_mul_f32 v220, 0x3b000000, v220
  v_sub_f32 v224, v212, v220
  v_sub_f32 v225, v213, v220
  v_sub_f32 v226, v214, v220
  v_sub_f32 v227, v215, v220
  v_sub_f32 v228, v216, v220
  v_sub_f32 v229, v217, v220
  v_sub_f32 v230, v218, v220
  v_sub_f32 v231, v219, v220
  v_mul_f32 v221, v224, v224
  v_mul_f32 v222, v225, v225
  v_fmac_f32 v221, v226, v226
  v_fmac_f32 v222, v227, v227
  v_fmac_f32 v221, v228, v228
  v_fmac_f32 v222, v229, v229
  v_fmac_f32 v221, v230, v230
  v_fmac_f32 v222, v231, v231
  v_add_f32 v221, v221, v222
  v_cvt_pk_bf16_f32 v220, 0, v220
  s_nop 0
  v_add_f32_dpp v221, v221, v221 row_ror:8 row_mask:0xf bank_mask:0xf
  v_sub_f32 v224, v212, v220
  v_sub_f32 v225, v213, v220
  v_add_f32_dpp v221, v221, v221 row_ror:4 row_mask:0xf bank_mask:0xf
  v_sub_f32 v226, v214, v220
  v_sub_f32 v227, v215, v220
  v_add_f32_dpp v221, v221, v221 row_ror:2 row_mask:0xf bank_mask:0xf
  v_sub_f32 v228, v216, v220
  v_sub_f32 v229, v217, v220
  v_add_f32_dpp v221, v221, v221 row_ror:1 row_mask:0xf bank_mask:0xf
  v_sub_f32 v230, v218, v220
  v_sub_f32 v231, v219, v220
  v_mov_b32 v222, v221
  v_cvt_pk_bf16_f32 v224, 0, v224
  v_cvt_pk_bf16_f32 v225, 0, v225
  v_permlane16_swap_b32 v221, v222
  v_cvt_pk_bf16_f32 v226, 0, v226
  v_cvt_pk_bf16_f32 v227, 0, v227
  v_add_f32 v221, v221, v222
  v_cvt_pk_bf16_f32 v228, 0, v228
  v_cvt_pk_bf16_f32 v229, 0, v229
  v_mov_b32 v222, v221
  v_cvt_pk_bf16_f32 v230, 0, v230
  v_cvt_pk_bf16_f32 v231, 0, v231
  v_permlane32_swap_b32 v221, v222
  v_add_f32 v221, v221, v222
  v_mul_f32 v221, 0x3b000000, v221
  v_cvt_pk_bf16_f32 v221, 0, v221
  v_add_f32 v221, 0x3727c5ac, v221
  v_cvt_pk_bf16_f32 v221, 0, v221
  v_sqrt_f32 v221, v221
  s_nop 0
  v_cvt_pk_bf16_f32 v221, 0, v221
  v_rcp_f32 v221, v221
  s_nop 0
  v_mul_f32 v224, v224, v221
  v_mul_f32 v225, v225, v221
  v_mul_f32 v226, v226, v221
  v_mul_f32 v227, v227, v221
  v_mul_f32 v228, v228, v221
  v_mul_f32 v229, v229, v221
  v_mul_f32 v230, v230, v221
  v_mul_f32 v231, v231, v221
  v_cvt_pk_bf16_f32 v180, v224, v225
  v_cvt_pk_bf16_f32 v181, v226, v227
  v_cvt_pk_bf16_f32 v182, v228, v229
  v_cvt_pk_bf16_f32 v183, v230, v231
  buffer_store_dwordx4 v[180:183], v0, s[4:7], s29 offen sc1
  s_add_u32 s29, s29, 262144
  s_waitcnt vmcnt(40)
  v_lshlrev_b32 v212, 16, v184
  v_and_b32 v213, 0xffff0000, v184
  v_lshlrev_b32 v214, 16, v185
  v_and_b32 v215, 0xffff0000, v185
  v_lshlrev_b32 v216, 16, v186
  v_and_b32 v217, 0xffff0000, v186
  v_lshlrev_b32 v218, 16, v187
  v_and_b32 v219, 0xffff0000, v187
  v_add_f32 v220, v212, v213
  v_add_f32 v221, v214, v215
  v_add_f32 v222, v216, v217
  v_add_f32 v223, v218, v219
  v_add_f32 v220, v220, v221
  v_add_f32 v222, v222, v223
  v_add_f32 v220, v220, v222
  s_nop 1
  v_add_f32_dpp v220, v220, v220 row_ror:8 row_mask:0xf bank_mask:0xf
  s_nop 1
  v_add_f32_dpp v220, v220, v220 row_ror:4 row_mask:0xf bank_mask:0xf
  s_nop 1
  v_add_f32_dpp v220, v220, v220 row_ror:2 row_mask:0xf bank_mask:0xf
  s_nop 1
  v_add_f32_dpp v220, v220, v220 row_ror:1 row_mask:0xf bank_mask:0xf
  v_mov_b32 v222, v220
  s_nop 0
  s_nop 0
  v_permlane16_swap_b32 v220, v222
  v_add_f32 v220, v220, v222
  v_mov_b32 v222, v220
  s_nop 0
  s_nop 0
  v_permlane32_swap_b32 v220, v222
  v_add_f32 v220, v220, v222
  v_mul_f32 v220, 0x3b000000, v220
  v_sub_f32 v224, v212, v220
  v_sub_f32 v225, v213, v220
  v_sub_f32 v226, v214, v220
  v_sub_f32 v227, v215, v220
  v_sub_f32 v228, v216, v220
  v_sub_f32 v229, v217, v220
  v_sub_f32 v230, v218, v220
  v_sub_f32 v231, v219, v220
  v_mul_f32 v221, v224, v224
  v_mul_f32 v222, v225, v225
  v_fmac_f32 v221, v226, v226
  v_fmac_f32 v222, v227, v227
  v_fmac_f32 v221, v228, v228
  v_fmac_f32 v222, v229, v229
  v_fmac_f32 v221, v230, v230
  v_fmac_f32 v222, v231, v231
  v_add_f32 v221, v221, v222
  v_cvt_pk_bf16_f32 v220, 0, v220
  s_nop 0
  v_add_f32_dpp v221, v221, v221 row_ror:8 row_mask:0xf bank_mask:0xf
  v_sub_f32 v224, v212, v220
  v_sub_f32 v225, v213, v220
  v_add_f32_dpp v221, v221, v221 row_ror:4 row_mask:0xf bank_mask:0xf
  v_sub_f32 v226, v214, v220
  v_sub_f32 v227, v215, v220
  v_add_f32_dpp v221, v221, v221 row_ror:2 row_mask:0xf bank_mask:0xf
  v_sub_f32 v228, v216, v220
  v_sub_f32 v229, v217, v220
  v_add_f32_dpp v221, v221, v221 row_ror:1 row_mask:0xf bank_mask:0xf
  v_sub_f32 v230, v218, v220
  v_sub_f32 v231, v219, v220
  v_mov_b32 v222, v221
  v_cvt_pk_bf16_f32 v224, 0, v224
  v_cvt_pk_bf16_f32 v225, 0, v225
  v_permlane16_swap_b32 v221, v222
  v_cvt_pk_bf16_f32 v226, 0, v226
  v_cvt_pk_bf16_f32 v227, 0, v227
  v_add_f32 v221, v221, v222
  v_cvt_pk_bf16_f32 v228, 0, v228
  v_cvt_pk_bf16_f32 v229, 0, v229
  v_mov_b32 v222, v221
  v_cvt_pk_bf16_f32 v230, 0, v230
  v_cvt_pk_bf16_f32 v231, 0, v231
  v_permlane32_swap_b32 v221, v222
  v_add_f32 v221, v221, v222
  v_mul_f32 v221, 0x3b000000, v221
  v_cvt_pk_bf16_f32 v221, 0, v221
  v_add_f32 v221, 0x3727c5ac, v221
  v_cvt_pk_bf16_f32 v221, 0, v221
  v_sqrt_f32 v221, v221
  s_nop 0
  v_cvt_pk_bf16_f32 v221, 0, v221
  v_rcp_f32 v221, v221
  s_nop 0
  v_mul_f32 v224, v224, v221
  v_mul_f32 v225, v225, v221
  v_mul_f32 v226, v226, v221
  v_mul_f32 v227, v227, v221
  v_mul_f32 v228, v228, v221
  v_mul_f32 v229, v229, v221
  v_mul_f32 v230, v230, v221
  v_mul_f32 v231, v231, v221
  v_cvt_pk_bf16_f32 v184, v224, v225
  v_cvt_pk_bf16_f32 v185, v226, v227
  v_cvt_pk_bf16_f32 v186, v228, v229
  v_cvt_pk_bf16_f32 v187, v230, v231
  buffer_store_dwordx4 v[184:187], v0, s[4:7], s29 offen sc1
  s_add_u32 s29, s29, 262144
  s_waitcnt vmcnt(40)
  v_lshlrev_b32 v212, 16, v188
  v_and_b32 v213, 0xffff0000, v188
  v_lshlrev_b32 v214, 16, v189
  v_and_b32 v215, 0xffff0000, v189
  v_lshlrev_b32 v216, 16, v190
  v_and_b32 v217, 0xffff0000, v190
  v_lshlrev_b32 v218, 16, v191
  v_and_b32 v219, 0xffff0000, v191
  v_add_f32 v220, v212, v213
  v_add_f32 v221, v214, v215
  v_add_f32 v222, v216, v217
  v_add_f32 v223, v218, v219
  v_add_f32 v220, v220, v221
  v_add_f32 v222, v222, v223
  v_add_f32 v220, v220, v222
  s_nop 1
  v_add_f32_dpp v220, v220, v220 row_ror:8 row_mask:0xf bank_mask:0xf
  s_nop 1
  v_add_f32_dpp v220, v220, v220 row_ror:4 row_mask:0xf bank_mask:0xf
  s_nop 1
  v_add_f32_dpp v220, v220, v220 row_ror:2 row_mask:0xf bank_mask:0xf
  s_nop 1
  v_add_f32_dpp v220, v220, v220 row_ror:1 row_mask:0xf bank_mask:0xf
  v_mov_b32 v222, v220
  s_nop 0
  s_nop 0
  v_permlane16_swap_b32 v220, v222
  v_add_f32 v220, v220, v222
  v_mov_b32 v222, v220
  s_nop 0
  s_nop 0
  v_permlane32_swap_b32 v220, v222
  v_add_f32 v220, v220, v222
  v_mul_f32 v220, 0x3b000000, v220
  v_sub_f32 v224, v212, v220
  v_sub_f32 v225, v213, v220
  v_sub_f32 v226, v214, v220
  v_sub_f32 v227, v215, v220
  v_sub_f32 v228, v216, v220
  v_sub_f32 v229, v217, v220
  v_sub_f32 v230, v218, v220
  v_sub_f32 v231, v219, v220
  v_mul_f32 v221, v224, v224
  v_mul_f32 v222, v225, v225
  v_fmac_f32 v221, v226, v226
  v_fmac_f32 v222, v227, v227
  v_fmac_f32 v221, v228, v228
  v_fmac_f32 v222, v229, v229
  v_fmac_f32 v221, v230, v230
  v_fmac_f32 v222, v231, v231
  v_add_f32 v221, v221, v222
  v_cvt_pk_bf16_f32 v220, 0, v220
  s_nop 0
  v_add_f32_dpp v221, v221, v221 row_ror:8 row_mask:0xf bank_mask:0xf
  v_sub_f32 v224, v212, v220
  v_sub_f32 v225, v213, v220
  v_add_f32_dpp v221, v221, v221 row_ror:4 row_mask:0xf bank_mask:0xf
  v_sub_f32 v226, v214, v220
  v_sub_f32 v227, v215, v220
  v_add_f32_dpp v221, v221, v221 row_ror:2 row_mask:0xf bank_mask:0xf
  v_sub_f32 v228, v216, v220
  v_sub_f32 v229, v217, v220
  v_add_f32_dpp v221, v221, v221 row_ror:1 row_mask:0xf bank_mask:0xf
  v_sub_f32 v230, v218, v220
  v_sub_f32 v231, v219, v220
  v_mov_b32 v222, v221
  v_cvt_pk_bf16_f32 v224, 0, v224
  v_cvt_pk_bf16_f32 v225, 0, v225
  v_permlane16_swap_b32 v221, v222
  v_cvt_pk_bf16_f32 v226, 0, v226
  v_cvt_pk_bf16_f32 v227, 0, v227
  v_add_f32 v221, v221, v222
  v_cvt_pk_bf16_f32 v228, 0, v228
  v_cvt_pk_bf16_f32 v229, 0, v229
  v_mov_b32 v222, v221
  v_cvt_pk_bf16_f32 v230, 0, v230
  v_cvt_pk_bf16_f32 v231, 0, v231
  v_permlane32_swap_b32 v221, v222
  v_add_f32 v221, v221, v222
  v_mul_f32 v221, 0x3b000000, v221
  v_cvt_pk_bf16_f32 v221, 0, v221
  v_add_f32 v221, 0x3727c5ac, v221
  v_cvt_pk_bf16_f32 v221, 0, v221
  v_sqrt_f32 v221, v221
  s_nop 0
  v_cvt_pk_bf16_f32 v221, 0, v221
  v_rcp_f32 v221, v221
  s_nop 0
  v_mul_f32 v224, v224, v221
  v_mul_f32 v225, v225, v221
  v_mul_f32 v226, v226, v221
  v_mul_f32 v227, v227, v221
  v_mul_f32 v228, v228, v221
  v_mul_f32 v229, v229, v221
  v_mul_f32 v230, v230, v221
  v_mul_f32 v231, v231, v221
  v_cvt_pk_bf16_f32 v188, v224, v225
  v_cvt_pk_bf16_f32 v189, v226, v227
  v_cvt_pk_bf16_f32 v190, v228, v229
  v_cvt_pk_bf16_f32 v191, v230, v231
  buffer_store_dwordx4 v[188:191], v0, s[4:7], s29 offen sc1
  s_add_u32 s29, s29, 262144
  s_waitcnt vmcnt(40)
  v_lshlrev_b32 v212, 16, v192
  v_and_b32 v213, 0xffff0000, v192
  v_lshlrev_b32 v214, 16, v193
  v_and_b32 v215, 0xffff0000, v193
  v_lshlrev_b32 v216, 16, v194
  v_and_b32 v217, 0xffff0000, v194
  v_lshlrev_b32 v218, 16, v195
  v_and_b32 v219, 0xffff0000, v195
  v_add_f32 v220, v212, v213
  v_add_f32 v221, v214, v215
  v_add_f32 v222, v216, v217
  v_add_f32 v223, v218, v219
  v_add_f32 v220, v220, v221
  v_add_f32 v222, v222, v223
  v_add_f32 v220, v220, v222
  s_nop 1
  v_add_f32_dpp v220, v220, v220 row_ror:8 row_mask:0xf bank_mask:0xf
  s_nop 1
  v_add_f32_dpp v220, v220, v220 row_ror:4 row_mask:0xf bank_mask:0xf
  s_nop 1
  v_add_f32_dpp v220, v220, v220 row_ror:2 row_mask:0xf bank_mask:0xf
  s_nop 1
  v_add_f32_dpp v220, v220, v220 row_ror:1 row_mask:0xf bank_mask:0xf
  v_mov_b32 v222, v220
  s_nop 0
  s_nop 0
  v_permlane16_swap_b32 v220, v222
  v_add_f32 v220, v220, v222
  v_mov_b32 v222, v220
  s_nop 0
  s_nop 0
  v_permlane32_swap_b32 v220, v222
  v_add_f32 v220, v220, v222
  v_mul_f32 v220, 0x3b000000, v220
  v_sub_f32 v224, v212, v220
  v_sub_f32 v225, v213, v220
  v_sub_f32 v226, v214, v220
  v_sub_f32 v227, v215, v220
  v_sub_f32 v228, v216, v220
  v_sub_f32 v229, v217, v220
  v_sub_f32 v230, v218, v220
  v_sub_f32 v231, v219, v220
  v_mul_f32 v221, v224, v224
  v_mul_f32 v222, v225, v225
  v_fmac_f32 v221, v226, v226
  v_fmac_f32 v222, v227, v227
  v_fmac_f32 v221, v228, v228
  v_fmac_f32 v222, v229, v229
  v_fmac_f32 v221, v230, v230
  v_fmac_f32 v222, v231, v231
  v_add_f32 v221, v221, v222
  v_cvt_pk_bf16_f32 v220, 0, v220
  s_nop 0
  v_add_f32_dpp v221, v221, v221 row_ror:8 row_mask:0xf bank_mask:0xf
  v_sub_f32 v224, v212, v220
  v_sub_f32 v225, v213, v220
  v_add_f32_dpp v221, v221, v221 row_ror:4 row_mask:0xf bank_mask:0xf
  v_sub_f32 v226, v214, v220
  v_sub_f32 v227, v215, v220
  v_add_f32_dpp v221, v221, v221 row_ror:2 row_mask:0xf bank_mask:0xf
  v_sub_f32 v228, v216, v220
  v_sub_f32 v229, v217, v220
  v_add_f32_dpp v221, v221, v221 row_ror:1 row_mask:0xf bank_mask:0xf
  v_sub_f32 v230, v218, v220
  v_sub_f32 v231, v219, v220
  v_mov_b32 v222, v221
  v_cvt_pk_bf16_f32 v224, 0, v224
  v_cvt_pk_bf16_f32 v225, 0, v225
  v_permlane16_swap_b32 v221, v222
  v_cvt_pk_bf16_f32 v226, 0, v226
  v_cvt_pk_bf16_f32 v227, 0, v227
  v_add_f32 v221, v221, v222
  v_cvt_pk_bf16_f32 v228, 0, v228
  v_cvt_pk_bf16_f32 v229, 0, v229
  v_mov_b32 v222, v221
  v_cvt_pk_bf16_f32 v230, 0, v230
  v_cvt_pk_bf16_f32 v231, 0, v231
  v_permlane32_swap_b32 v221, v222
  v_add_f32 v221, v221, v222
  v_mul_f32 v221, 0x3b000000, v221
  v_cvt_pk_bf16_f32 v221, 0, v221
  v_add_f32 v221, 0x3727c5ac, v221
  v_cvt_pk_bf16_f32 v221, 0, v221
  v_sqrt_f32 v221, v221
  s_nop 0
  v_cvt_pk_bf16_f32 v221, 0, v221
  v_rcp_f32 v221, v221
  s_nop 0
  v_mul_f32 v224, v224, v221
  v_mul_f32 v225, v225, v221
  v_mul_f32 v226, v226, v221
  v_mul_f32 v227, v227, v221
  v_mul_f32 v228, v228, v221
  v_mul_f32 v229, v229, v221
  v_mul_f32 v230, v230, v221
  v_mul_f32 v231, v231, v221
  v_cvt_pk_bf16_f32 v192, v224, v225
  v_cvt_pk_bf16_f32 v193, v226, v227
  v_cvt_pk_bf16_f32 v194, v228, v229
  v_cvt_pk_bf16_f32 v195, v230, v231
  buffer_store_dwordx4 v[192:195], v0, s[4:7], s29 offen sc1
  s_add_u32 s29, s29, 262144
  s_waitcnt vmcnt(40)
  v_lshlrev_b32 v212, 16, v196
  v_and_b32 v213, 0xffff0000, v196
  v_lshlrev_b32 v214, 16, v197
  v_and_b32 v215, 0xffff0000, v197
  v_lshlrev_b32 v216, 16, v198
  v_and_b32 v217, 0xffff0000, v198
  v_lshlrev_b32 v218, 16, v199
  v_and_b32 v219, 0xffff0000, v199
  v_add_f32 v220, v212, v213
  v_add_f32 v221, v214, v215
  v_add_f32 v222, v216, v217
  v_add_f32 v223, v218, v219
  v_add_f32 v220, v220, v221
  v_add_f32 v222, v222, v223
  v_add_f32 v220, v220, v222
  s_nop 1
  v_add_f32_dpp v220, v220, v220 row_ror:8 row_mask:0xf bank_mask:0xf
  s_nop 1
  v_add_f32_dpp v220, v220, v220 row_ror:4 row_mask:0xf bank_mask:0xf
  s_nop 1
  v_add_f32_dpp v220, v220, v220 row_ror:2 row_mask:0xf bank_mask:0xf
  s_nop 1
  v_add_f32_dpp v220, v220, v220 row_ror:1 row_mask:0xf bank_mask:0xf
  v_mov_b32 v222, v220
  s_nop 0
  s_nop 0
  v_permlane16_swap_b32 v220, v222
  v_add_f32 v220, v220, v222
  v_mov_b32 v222, v220
  s_nop 0
  s_nop 0
  v_permlane32_swap_b32 v220, v222
  v_add_f32 v220, v220, v222
  v_mul_f32 v220, 0x3b000000, v220
  v_sub_f32 v224, v212, v220
  v_sub_f32 v225, v213, v220
  v_sub_f32 v226, v214, v220
  v_sub_f32 v227, v215, v220
  v_sub_f32 v228, v216, v220
  v_sub_f32 v229, v217, v220
  v_sub_f32 v230, v218, v220
  v_sub_f32 v231, v219, v220
  v_mul_f32 v221, v224, v224
  v_mul_f32 v222, v225, v225
  v_fmac_f32 v221, v226, v226
  v_fmac_f32 v222, v227, v227
  v_fmac_f32 v221, v228, v228
  v_fmac_f32 v222, v229, v229
  v_fmac_f32 v221, v230, v230
  v_fmac_f32 v222, v231, v231
  v_add_f32 v221, v221, v222
  v_cvt_pk_bf16_f32 v220, 0, v220
  s_nop 0
  v_add_f32_dpp v221, v221, v221 row_ror:8 row_mask:0xf bank_mask:0xf
  v_sub_f32 v224, v212, v220
  v_sub_f32 v225, v213, v220
  v_add_f32_dpp v221, v221, v221 row_ror:4 row_mask:0xf bank_mask:0xf
  v_sub_f32 v226, v214, v220
  v_sub_f32 v227, v215, v220
  v_add_f32_dpp v221, v221, v221 row_ror:2 row_mask:0xf bank_mask:0xf
  v_sub_f32 v228, v216, v220
  v_sub_f32 v229, v217, v220
  v_add_f32_dpp v221, v221, v221 row_ror:1 row_mask:0xf bank_mask:0xf
  v_sub_f32 v230, v218, v220
  v_sub_f32 v231, v219, v220
  v_mov_b32 v222, v221
  v_cvt_pk_bf16_f32 v224, 0, v224
  v_cvt_pk_bf16_f32 v225, 0, v225
  v_permlane16_swap_b32 v221, v222
  v_cvt_pk_bf16_f32 v226, 0, v226
  v_cvt_pk_bf16_f32 v227, 0, v227
  v_add_f32 v221, v221, v222
  v_cvt_pk_bf16_f32 v228, 0, v228
  v_cvt_pk_bf16_f32 v229, 0, v229
  v_mov_b32 v222, v221
  v_cvt_pk_bf16_f32 v230, 0, v230
  v_cvt_pk_bf16_f32 v231, 0, v231
  v_permlane32_swap_b32 v221, v222
  v_add_f32 v221, v221, v222
  v_mul_f32 v221, 0x3b000000, v221
  v_cvt_pk_bf16_f32 v221, 0, v221
  v_add_f32 v221, 0x3727c5ac, v221
  v_cvt_pk_bf16_f32 v221, 0, v221
  v_sqrt_f32 v221, v221
  s_nop 0
  v_cvt_pk_bf16_f32 v221, 0, v221
  v_rcp_f32 v221, v221
  s_nop 0
  v_mul_f32 v224, v224, v221
  v_mul_f32 v225, v225, v221
  v_mul_f32 v226, v226, v221
  v_mul_f32 v227, v227, v221
  v_mul_f32 v228, v228, v221
  v_mul_f32 v229, v229, v221
  v_mul_f32 v230, v230, v221
  v_mul_f32 v231, v231, v221
  v_cvt_pk_bf16_f32 v196, v224, v225
  v_cvt_pk_bf16_f32 v197, v226, v227
  v_cvt_pk_bf16_f32 v198, v228, v229
  v_cvt_pk_bf16_f32 v199, v230, v231
  buffer_store_dwordx4 v[196:199], v0, s[4:7], s29 offen sc1
  s_add_u32 s29, s29, 262144
  s_waitcnt vmcnt(40)
  v_lshlrev_b32 v212, 16, v200
  v_and_b32 v213, 0xffff0000, v200
  v_lshlrev_b32 v214, 16, v201
  v_and_b32 v215, 0xffff0000, v201
  v_lshlrev_b32 v216, 16, v202
  v_and_b32 v217, 0xffff0000, v202
  v_lshlrev_b32 v218, 16, v203
  v_and_b32 v219, 0xffff0000, v203
  v_add_f32 v220, v212, v213
  v_add_f32 v221, v214, v215
  v_add_f32 v222, v216, v217
  v_add_f32 v223, v218, v219
  v_add_f32 v220, v220, v221
  v_add_f32 v222, v222, v223
  v_add_f32 v220, v220, v222
  s_nop 1
  v_add_f32_dpp v220, v220, v220 row_ror:8 row_mask:0xf bank_mask:0xf
  s_nop 1
  v_add_f32_dpp v220, v220, v220 row_ror:4 row_mask:0xf bank_mask:0xf
  s_nop 1
  v_add_f32_dpp v220, v220, v220 row_ror:2 row_mask:0xf bank_mask:0xf
  s_nop 1
  v_add_f32_dpp v220, v220, v220 row_ror:1 row_mask:0xf bank_mask:0xf
  v_mov_b32 v222, v220
  s_nop 0
  s_nop 0
  v_permlane16_swap_b32 v220, v222
  v_add_f32 v220, v220, v222
  v_mov_b32 v222, v220
  s_nop 0
  s_nop 0
  v_permlane32_swap_b32 v220, v222
  v_add_f32 v220, v220, v222
  v_mul_f32 v220, 0x3b000000, v220
  v_sub_f32 v224, v212, v220
  v_sub_f32 v225, v213, v220
  v_sub_f32 v226, v214, v220
  v_sub_f32 v227, v215, v220
  v_sub_f32 v228, v216, v220
  v_sub_f32 v229, v217, v220
  v_sub_f32 v230, v218, v220
  v_sub_f32 v231, v219, v220
  v_mul_f32 v221, v224, v224
  v_mul_f32 v222, v225, v225
  v_fmac_f32 v221, v226, v226
  v_fmac_f32 v222, v227, v227
  v_fmac_f32 v221, v228, v228
  v_fmac_f32 v222, v229, v229
  v_fmac_f32 v221, v230, v230
  v_fmac_f32 v222, v231, v231
  v_add_f32 v221, v221, v222
  v_cvt_pk_bf16_f32 v220, 0, v220
  s_nop 0
  v_add_f32_dpp v221, v221, v221 row_ror:8 row_mask:0xf bank_mask:0xf
  v_sub_f32 v224, v212, v220
  v_sub_f32 v225, v213, v220
  v_add_f32_dpp v221, v221, v221 row_ror:4 row_mask:0xf bank_mask:0xf
  v_sub_f32 v226, v214, v220
  v_sub_f32 v227, v215, v220
  v_add_f32_dpp v221, v221, v221 row_ror:2 row_mask:0xf bank_mask:0xf
  v_sub_f32 v228, v216, v220
  v_sub_f32 v229, v217, v220
  v_add_f32_dpp v221, v221, v221 row_ror:1 row_mask:0xf bank_mask:0xf
  v_sub_f32 v230, v218, v220
  v_sub_f32 v231, v219, v220
  v_mov_b32 v222, v221
  v_cvt_pk_bf16_f32 v224, 0, v224
  v_cvt_pk_bf16_f32 v225, 0, v225
  v_permlane16_swap_b32 v221, v222
  v_cvt_pk_bf16_f32 v226, 0, v226
  v_cvt_pk_bf16_f32 v227, 0, v227
  v_add_f32 v221, v221, v222
  v_cvt_pk_bf16_f32 v228, 0, v228
  v_cvt_pk_bf16_f32 v229, 0, v229
  v_mov_b32 v222, v221
  v_cvt_pk_bf16_f32 v230, 0, v230
  v_cvt_pk_bf16_f32 v231, 0, v231
  v_permlane32_swap_b32 v221, v222
  v_add_f32 v221, v221, v222
  v_mul_f32 v221, 0x3b000000, v221
  v_cvt_pk_bf16_f32 v221, 0, v221
  v_add_f32 v221, 0x3727c5ac, v221
  v_cvt_pk_bf16_f32 v221, 0, v221
  v_sqrt_f32 v221, v221
  s_nop 0
  v_cvt_pk_bf16_f32 v221, 0, v221
  v_rcp_f32 v221, v221
  s_nop 0
  v_mul_f32 v224, v224, v221
  v_mul_f32 v225, v225, v221
  v_mul_f32 v226, v226, v221
  v_mul_f32 v227, v227, v221
  v_mul_f32 v228, v228, v221
  v_mul_f32 v229, v229, v221
  v_mul_f32 v230, v230, v221
  v_mul_f32 v231, v231, v221
  v_cvt_pk_bf16_f32 v200, v224, v225
  v_cvt_pk_bf16_f32 v201, v226, v227
  v_cvt_pk_bf16_f32 v202, v228, v229
  v_cvt_pk_bf16_f32 v203, v230, v231
  buffer_store_dwordx4 v[200:203], v0, s[4:7], s29 offen sc1
  s_add_u32 s29, s29, 262144
  s_waitcnt vmcnt(40)
  v_lshlrev_b32 v212, 16, v204
  v_and_b32 v213, 0xffff0000, v204
  v_lshlrev_b32 v214, 16, v205
  v_and_b32 v215, 0xffff0000, v205
  v_lshlrev_b32 v216, 16, v206
  v_and_b32 v217, 0xffff0000, v206
  v_lshlrev_b32 v218, 16, v207
  v_and_b32 v219, 0xffff0000, v207
  v_add_f32 v220, v212, v213
  v_add_f32 v221, v214, v215
  v_add_f32 v222, v216, v217
  v_add_f32 v223, v218, v219
  v_add_f32 v220, v220, v221
  v_add_f32 v222, v222, v223
  v_add_f32 v220, v220, v222
  s_nop 1
  v_add_f32_dpp v220, v220, v220 row_ror:8 row_mask:0xf bank_mask:0xf
  s_nop 1
  v_add_f32_dpp v220, v220, v220 row_ror:4 row_mask:0xf bank_mask:0xf
  s_nop 1
  v_add_f32_dpp v220, v220, v220 row_ror:2 row_mask:0xf bank_mask:0xf
  s_nop 1
  v_add_f32_dpp v220, v220, v220 row_ror:1 row_mask:0xf bank_mask:0xf
  v_mov_b32 v222, v220
  s_nop 0
  s_nop 0
  v_permlane16_swap_b32 v220, v222
  v_add_f32 v220, v220, v222
  v_mov_b32 v222, v220
  s_nop 0
  s_nop 0
  v_permlane32_swap_b32 v220, v222
  v_add_f32 v220, v220, v222
  v_mul_f32 v220, 0x3b000000, v220
  v_sub_f32 v224, v212, v220
  v_sub_f32 v225, v213, v220
  v_sub_f32 v226, v214, v220
  v_sub_f32 v227, v215, v220
  v_sub_f32 v228, v216, v220
  v_sub_f32 v229, v217, v220
  v_sub_f32 v230, v218, v220
  v_sub_f32 v231, v219, v220
  v_mul_f32 v221, v224, v224
  v_mul_f32 v222, v225, v225
  v_fmac_f32 v221, v226, v226
  v_fmac_f32 v222, v227, v227
  v_fmac_f32 v221, v228, v228
  v_fmac_f32 v222, v229, v229
  v_fmac_f32 v221, v230, v230
  v_fmac_f32 v222, v231, v231
  v_add_f32 v221, v221, v222
  v_cvt_pk_bf16_f32 v220, 0, v220
  s_nop 0
  v_add_f32_dpp v221, v221, v221 row_ror:8 row_mask:0xf bank_mask:0xf
  v_sub_f32 v224, v212, v220
  v_sub_f32 v225, v213, v220
  v_add_f32_dpp v221, v221, v221 row_ror:4 row_mask:0xf bank_mask:0xf
  v_sub_f32 v226, v214, v220
  v_sub_f32 v227, v215, v220
  v_add_f32_dpp v221, v221, v221 row_ror:2 row_mask:0xf bank_mask:0xf
  v_sub_f32 v228, v216, v220
  v_sub_f32 v229, v217, v220
  v_add_f32_dpp v221, v221, v221 row_ror:1 row_mask:0xf bank_mask:0xf
  v_sub_f32 v230, v218, v220
  v_sub_f32 v231, v219, v220
  v_mov_b32 v222, v221
  v_cvt_pk_bf16_f32 v224, 0, v224
  v_cvt_pk_bf16_f32 v225, 0, v225
  v_permlane16_swap_b32 v221, v222
  v_cvt_pk_bf16_f32 v226, 0, v226
  v_cvt_pk_bf16_f32 v227, 0, v227
  v_add_f32 v221, v221, v222
  v_cvt_pk_bf16_f32 v228, 0, v228
  v_cvt_pk_bf16_f32 v229, 0, v229
  v_mov_b32 v222, v221
  v_cvt_pk_bf16_f32 v230, 0, v230
  v_cvt_pk_bf16_f32 v231, 0, v231
  v_permlane32_swap_b32 v221, v222
  v_add_f32 v221, v221, v222
  v_mul_f32 v221, 0x3b000000, v221
  v_cvt_pk_bf16_f32 v221, 0, v221
  v_add_f32 v221, 0x3727c5ac, v221
  v_cvt_pk_bf16_f32 v221, 0, v221
  v_sqrt_f32 v221, v221
  s_nop 0
  v_cvt_pk_bf16_f32 v221, 0, v221
  v_rcp_f32 v221, v221
  s_nop 0
  v_mul_f32 v224, v224, v221
  v_mul_f32 v225, v225, v221
  v_mul_f32 v226, v226, v221
  v_mul_f32 v227, v227, v221
  v_mul_f32 v228, v228, v221
  v_mul_f32 v229, v229, v221
  v_mul_f32 v230, v230, v221
  v_mul_f32 v231, v231, v221
  v_cvt_pk_bf16_f32 v204, v224, v225
  v_cvt_pk_bf16_f32 v205, v226, v227
  v_cvt_pk_bf16_f32 v206, v228, v229
  v_cvt_pk_bf16_f32 v207, v230, v231
  buffer_store_dwordx4 v[204:207], v0, s[4:7], s29 offen sc1
  s_add_u32 s29, s29, 262144
o_s2_118:
  s_waitcnt vmcnt(33)
  v_perm_b32 v48, v66, v64, s44
  v_perm_b32 v49, v70, v68, s44
  v_perm_b32 v50, v74, v72, s44
  v_perm_b32 v51, v78, v76, s44
  v_accvgpr_write_b32 a0, v48
  v_accvgpr_write_b32 a1, v49
  v_accvgpr_write_b32 a2, v50
  v_accvgpr_write_b32 a3, v51
  v_perm_b32 v52, v66, v64, s45
  v_perm_b32 v53, v70, v68, s45
  v_perm_b32 v54, v74, v72, s45
  v_perm_b32 v55, v78, v76, s45
  v_accvgpr_write_b32 a4, v52
  v_accvgpr_write_b32 a5, v53
  v_accvgpr_write_b32 a6, v54
  v_accvgpr_write_b32 a7, v55
  v_perm_b32 v48, v67, v65, s44
  v_perm_b32 v49, v71, v69, s44
  v_perm_b32 v50, v75, v73, s44
  v_perm_b32 v51, v79, v77, s44
  v_accvgpr_write_b32 a8, v48
  v_accvgpr_write_b32 a9, v49
  v_accvgpr_write_b32 a10, v50
  v_accvgpr_write_b32 a11, v51
  v_perm_b32 v52, v67, v65, s45
  v_perm_b32 v53, v71, v69, s45
  v_perm_b32 v54, v75, v73, s45
  v_perm_b32 v55, v79, v77, s45
  v_accvgpr_write_b32 a12, v52
  v_accvgpr_write_b32 a13, v53
  v_accvgpr_write_b32 a14, v54
  v_accvgpr_write_b32 a15, v55
  s_waitcnt vmcnt(25)
  v_perm_b32 v48, v82, v80, s44
  v_perm_b32 v49, v86, v84, s44
  v_perm_b32 v50, v90, v88, s44
  v_perm_b32 v51, v94, v92, s44
  v_accvgpr_write_b32 a16, v48
  v_accvgpr_write_b32 a17, v49
  v_accvgpr_write_b32 a18, v50
  v_accvgpr_write_b32 a19, v51
  v_perm_b32 v52, v82, v80, s45
  v_perm_b32 v53, v86, v84, s45
  v_perm_b32 v54, v90, v88, s45
  v_perm_b32 v55, v94, v92, s45
  v_accvgpr_write_b32 a20, v52
  v_accvgpr_write_b32 a21, v53
  v_accvgpr_write_b32 a22, v54
  v_accvgpr_write_b32 a23, v55
  v_perm_b32 v48, v83, v81, s44
  v_perm_b32 v49, v87, v85, s44
  v_perm_b32 v50, v91, v89, s44
  v_perm_b32 v51, v95, v93, s44
  v_accvgpr_write_b32 a24, v48
  v_accvgpr_write_b32 a25, v49
  v_accvgpr_write_b32 a26, v50
  v_accvgpr_write_b32 a27, v51
  v_perm_b32 v52, v83, v81, s45
  v_perm_b32 v53, v87, v85, s45
  v_perm_b32 v54, v91, v89, s45
  v_perm_b32 v55, v95, v93, s45
  v_accvgpr_write_b32 a28, v52
  v_accvgpr_write_b32 a29, v53
  v_accvgpr_write_b32 a30, v54
  v_accvgpr_write_b32 a31, v55
  s_waitcnt vmcnt(17)
  v_perm_b32 v48, v98, v96, s44
  v_perm_b32 v49, v102, v100, s44
  v_perm_b32 v50, v106, v104, s44
  v_perm_b32 v51, v110, v108, s44
  v_accvgpr_write_b32 a32, v48
  v_accvgpr_write_b32 a33, v49
  v_accvgpr_write_b32 a34, v50
  v_accvgpr_write_b32 a35, v51
  v_perm_b32 v52, v98, v96, s45
  v_perm_b32 v53, v102, v100, s45
  v_perm_b32 v54, v106, v104, s45
  v_perm_b32 v55, v110, v108, s45
  v_accvgpr_write_b32 a36, v52
  v_accvgpr_write_b32 a37, v53
  v_accvgpr_write_b32 a38, v54
  v_accvgpr_write_b32 a39, v55
  v_perm_b32 v48, v99, v97, s44
  v_perm_b32 v49, v103, v101, s44
  v_perm_b32 v50, v107, v105, s44
  v_perm_b32 v51, v111, v109, s44
  v_accvgpr_write_b32 a40, v48
  v_accvgpr_write_b32 a41, v49
  v_accvgpr_write_b32 a42, v50
  v_accvgpr_write_b32 a43, v51
  v_perm_b32 v52, v99, v97, s45
  v_perm_b32 v53, v103, v101, s45
  v_perm_b32 v54, v107, v105, s45
  v_perm_b32 v55, v111, v109, s45
  v_accvgpr_write_b32 a44, v52
  v_accvgpr_write_b32 a45, v53
  v_accvgpr_write_b32 a46, v54
  v_accvgpr_write_b32 a47, v55
  s_waitcnt vmcnt(9)
  v_perm_b32 v48, v114, v112, s44
  v_perm_b32 v49, v118, v116, s44
  v_perm_b32 v50, v122, v120, s44
  v_perm_b32 v51, v126, v124, s44
  v_accvgpr_write_b32 a48, v48
  v_accvgpr_write_b32 a49, v49
  v_accvgpr_write_b32 a50, v50
  v_accvgpr_write_b32 a51, v51
  v_perm_b32 v52, v114, v112, s45
  v_perm_b32 v53, v118, v116, s45
  v_perm_b32 v54, v122, v120, s45
  v_perm_b32 v55, v126, v124, s45
  v_accvgpr_write_b32 a52, v52
  v_accvgpr_write_b32 a53, v53
  v_accvgpr_write_b32 a54, v54
  v_accvgpr_write_b32 a55, v55
  v_perm_b32 v48, v115, v113, s44
  v_perm_b32 v49, v119, v117, s44
  v_perm_b32 v50, v123, v121, s44
  v_perm_b32 v51, v127, v125, s44
  v_accvgpr_write_b32 a56, v48
  v_accvgpr_write_b32 a57, v49
  v_accvgpr_write_b32 a58, v50
  v_accvgpr_write_b32 a59, v51
  v_perm_b32 v52, v115, v113, s45
  v_perm_b32 v53, v119, v117, s45
  v_perm_b32 v54, v123, v121, s45
  v_perm_b32 v55, v127, v125, s45
  v_accvgpr_write_b32 a60, v52
  v_accvgpr_write_b32 a61, v53
  v_accvgpr_write_b32 a62, v54
  v_accvgpr_write_b32 a63, v55
  s_cmp_ge_u32 s60, 4
  s_cbranch_scc1 o_s3_119
  v_mbcnt_lo_u32_b32 v60, -1, 0
  v_and_b32 v60, 0, v60
  v_add_lshl_u32 v60, v60, 1, 2
  s_mov_b32 s26, 0
g_wt_120:
  global_load_dword v61, v60, s[12:13] offset:128 sc1
  s_add_u32 s26, s26, 1
  s_cmp_gt_u32 s26, 1048576
  s_cbranch_scc1 L_end
  s_waitcnt vmcnt(0)
  v_cmp_eq_u32 vcc, 0, v61
  v_readfirstlane_b32 s27, v61
  s_cbranch_vccnz g_wt_120
  s_lshl_b32 s27, s77, 7
  s_add_u32 s27, s27, 243269632
  v_lshlrev_b32 v61, 11, v0
  v_mov_b32 v60, 1
  s_mov_b64 exec, 255
  buffer_store_dword v60, v61, s[4:7], s27 offen sc1
  s_mov_b64 exec, -1
o_s3_119:
  s_add_u32 s27, s30, 65536
  buffer_load_dwordx2 v[128:129], v44, s[80:83], s27 offen
  s_add_u32 s27, s30, 66560
  buffer_load_dwordx2 v[130:131], v44, s[80:83], s27 offen
  s_add_u32 s27, s30, 67584
  buffer_load_dwordx2 v[132:133], v44, s[80:83], s27 offen
  s_add_u32 s27, s30, 68608
  buffer_load_dwordx2 v[134:135], v44, s[80:83], s27 offen
  s_add_u32 s27, s30, 81920
  buffer_load_dwordx2 v[136:137], v44, s[80:83], s27 offen
  s_add_u32 s27, s30, 82944
  buffer_load_dwordx2 v[138:139], v44, s[80:83], s27 offen
  s_add_u32 s27, s30, 83968
  buffer_load_dwordx2 v[140:141], v44, s[80:83], s27 offen
  s_add_u32 s27, s30, 84992
  buffer_load_dwordx2 v[142:143], v44, s[80:83], s27 offen
  s_add_u32 s27, s30, 73728
  buffer_load_dwordx2 v[144:145], v44, s[80:83], s27 offen
  s_add_u32 s27, s30, 74752
  buffer_load_dwordx2 v[146:147], v44, s[80:83], s27 offen
  s_add_u32 s27, s30, 75776
  buffer_load_dwordx2 v[148:149], v44, s[80:83], s27 offen
  s_add_u32 s27, s30, 76800
  buffer_load_dwordx2 v[150:151], v44, s[80:83], s27 offen
  s_add_u32 s27, s30, 90112
  buffer_load_dwordx2 v[152:153], v44, s[80:83], s27 offen
  s_add_u32 s27, s30, 91136
  buffer_load_dwordx2 v[154:155], v44, s[80:83], s27 offen
  s_add_u32 s27, s30, 92160
  buffer_load_dwordx2 v[156:157], v44, s[80:83], s27 offen
  s_add_u32 s27, s30, 93184
  buffer_load_dwordx2 v[158:159], v44, s[80:83], s27 offen
  s_add_u32 s27, s30, 98304
  buffer_load_dwordx2 v[160:161], v44, s[80:83], s27 offen
  s_add_u32 s27, s30, 99328
  buffer_load_dwordx2 v[162:163], v44, s[80:83], s27 offen
  s_add_u32 s27, s30, 100352
  buffer_load_dwordx2 v[164:165], v44, s[80:83], s27 offen
  s_add_u32 s27, s30, 101376
  buffer_load_dwordx2 v[166:167], v44, s[80:83], s27 offen
  s_add_u32 s27, s30, 114688
  buffer_load_dwordx2 v[168:169], v44, s[80:83], s27 offen
  s_add_u32 s27, s30, 115712
  buffer_load_dwordx2 v[170:171], v44, s[80:83], s27 offen
  s_add_u32 s27, s30, 116736
  buffer_load_dwordx2 v[172:173], v44, s[80:83], s27 offen
  s_add_u32 s27, s30, 117760
  buffer_load_dwordx2 v[174:175], v44, s[80:83], s27 offen
  s_add_u32 s27, s30, 106496
  buffer_load_dwordx2 v[64:65], v44, s[80:83], s27 offen
  s_add_u32 s27, s30, 107520
  buffer_load_dwordx2 v[66:67], v44, s[80:83], s27 offen
  s_add_u32 s27, s30, 108544
  buffer_load_dwordx2 v[68:69], v44, s[80:83], s27 offen
  s_add_u32 s27, s30, 109568
  buffer_load_dwordx2 v[70:71], v44, s[80:83], s27 offen
  s_add_u32 s27, s30, 122880
  buffer_load_dwordx2 v[72:73], v44, s[80:83], s27 offen
  s_add_u32 s27, s30, 123904
  buffer_load_dwordx2 v[74:75], v44, s[80:83], s27 offen
  s_add_u32 s27, s30, 124928
  buffer_load_dwordx2 v[76:77], v44, s[80:83], s27 offen
  s_add_u32 s27, s30, 125952
  buffer_load_dwordx2 v[78:79], v44, s[80:83], s27 offen
  s_add_u32 s27, s30, 131072
  buffer_load_dwordx2 v[80:81], v44, s[80:83], s27 offen
  s_add_u32 s27, s30, 132096
  buffer_load_dwordx2 v[82:83], v44, s[80:83], s27 offen
  s_add_u32 s27, s30, 133120
  buffer_load_dwordx2 v[84:85], v44, s[80:83], s27 offen
  s_add_u32 s27, s30, 134144
  buffer_load_dwordx2 v[86:87], v44, s[80:83], s27 offen
  s_add_u32 s27, s30, 147456
  buffer_load_dwordx2 v[88:89], v44, s[80:83], s27 offen
  s_add_u32 s27, s30, 148480
  buffer_load_dwordx2 v[90:91], v44, s[80:83], s27 offen
  s_add_u32 s27, s30, 149504
  buffer_load_dwordx2 v[92:93], v44, s[80:83], s27 offen
  s_add_u32 s27, s30, 150528
  buffer_load_dwordx2 v[94:95], v44, s[80:83], s27 offen
  s_add_u32 s27, s30, 139264
  buffer_load_dwordx2 v[96:97], v44, s[80:83], s27 offen
  s_add_u32 s27, s30, 140288
  buffer_load_dwordx2 v[98:99], v44, s[80:83], s27 offen
  s_add_u32 s27, s30, 141312
  buffer_load_dwordx2 v[100:101], v44, s[80:83], s27 offen
  s_add_u32 s27, s30, 142336
  buffer_load_dwordx2 v[102:103], v44, s[80:83], s27 offen
  s_add_u32 s27, s30, 155648
  buffer_load_dwordx2 v[104:105], v44, s[80:83], s27 offen
  s_add_u32 s27, s30, 156672
  buffer_load_dwordx2 v[106:107], v44, s[80:83], s27 offen
  s_add_u32 s27, s30, 157696
  buffer_load_dwordx2 v[108:109], v44, s[80:83], s27 offen
  s_add_u32 s27, s30, 158720
  buffer_load_dwordx2 v[110:111], v44, s[80:83], s27 offen
  s_add_u32 s27, s30, 163840
  buffer_load_dwordx2 v[112:113], v44, s[80:83], s27 offen
  s_add_u32 s27, s30, 164864
  buffer_load_dwordx2 v[114:115], v44, s[80:83], s27 offen
  s_add_u32 s27, s30, 165888
  buffer_load_dwordx2 v[116:117], v44, s[80:83], s27 offen
  s_add_u32 s27, s30, 166912
  buffer_load_dwordx2 v[118:119], v44, s[80:83], s27 offen
  s_add_u32 s27, s30, 180224
  buffer_load_dwordx2 v[120:121], v44, s[80:83], s27 offen
  s_add_u32 s27, s30, 181248
  buffer_load_dwordx2 v[122:123], v44, s[80:83], s27 offen
  s_add_u32 s27, s30, 182272
  buffer_load_dwordx2 v[124:125], v44, s[80:83], s27 offen
  s_add_u32 s27, s30, 183296
  buffer_load_dwordx2 v[126:127], v44, s[80:83], s27 offen
  v_lshlrev_b32 v8, 16, v56
  v_and_b32 v9, 0xffff0000, v56
  v_lshlrev_b32 v10, 16, v57
  v_and_b32 v11, 0xffff0000, v57
  v_lshlrev_b32 v12, 16, v58
  v_and_b32 v13, 0xffff0000, v58
  v_lshlrev_b32 v14, 16, v59
  v_and_b32 v15, 0xffff0000, v59
  v_mul_f32 v56, v8, v8
  v_fmac_f32 v56, v9, v9
  v_fmac_f32 v56, v10, v10
  v_fmac_f32 v56, v11, v11
  v_fmac_f32 v56, v12, v12
  v_fmac_f32 v56, v13, v13
  v_fmac_f32 v56, v14, v14
  v_fmac_f32 v56, v15, v15
  s_nop 0
  s_nop 0
  v_add_f32_dpp v56, v56, v56 row_ror:8 row_mask:0xf bank_mask:0xf
  s_nop 1
  v_add_f32_dpp v56, v56, v56 row_ror:4 row_mask:0xf bank_mask:0xf
  s_nop 1
  v_add_f32_dpp v56, v56, v56 row_ror:2 row_mask:0xf bank_mask:0xf
  s_nop 1
  v_add_f32_dpp v56, v56, v56 row_ror:1 row_mask:0xf bank_mask:0xf
  v_mov_b32 v57, v56
  s_nop 0
  s_nop 0
  v_permlane16_swap_b32 v56, v57
  v_add_f32 v56, v56, v57
  v_mov_b32 v57, v56
  s_nop 0
  s_nop 0
  v_permlane32_swap_b32 v56, v57
  v_add_f32 v56, v56, v57
  v_sqrt_f32 v56, v56
  s_mov_b32 s28, 0x404d8eb7
  v_writelane_b32 v247, s28, 0
  s_mov_b32 s28, 0x404d8eb7
  v_writelane_b32 v247, s28, 1
  s_mov_b32 s28, 0x404cc30f
  v_writelane_b32 v247, s28, 2
  s_mov_b32 s28, 0x404ba22b
  v_writelane_b32 v247, s28, 3
  s_mov_b32 s28, 0x404a6ab0
  v_writelane_b32 v247, s28, 4
  s_mov_b32 s28, 0x404918ea
  v_writelane_b32 v247, s28, 5
  s_mov_b32 s28, 0x4047a82a
  v_writelane_b32 v247, s28, 6
  s_mov_b32 s28, 0x40461267
  v_writelane_b32 v247, s28, 7
  s_mov_b32 s28, 0x40444faa
  v_writelane_b32 v247, s28, 8
  s_mov_b32 s28, 0x40425526
  v_writelane_b32 v247, s28, 9
  s_mov_b32 s28, 0x404013b2
  v_writelane_b32 v247, s28, 10
  s_mov_b32 s28, 0x403d751c
  v_writelane_b32 v247, s28, 11
  s_mov_b32 s28, 0x403a570a
  v_writelane_b32 v247, s28, 12
  s_mov_b32 s28, 0x4036803f
  v_writelane_b32 v247, s28, 13
  s_mov_b32 s28, 0x403186a2
  v_writelane_b32 v247, s28, 14
  s_mov_b32 s28, 0x402a8231
  v_writelane_b32 v247, s28, 15
  s_mov_b32 s28, 0x401ec2e6
  v_writelane_b32 v247, s28, 16
  s_mov_b32 s28, 0x3ff46943
  v_writelane_b32 v247, s28, 17
  s_mov_b32 s28, 0x3ff46943
  v_writelane_b32 v247, s28, 18
  v_mul_f32 v247, v247, v56
  v_or_b32 v247, 0x80000000, v247
  s_lshl_b32 s29, s61, 2
  s_add_u32 s29, s29, s17
  s_lshl_b32 s29, s29, 13
  s_add_u32 s29, s29, s41
  s_cmp_ge_u32 s60, 4
  s_cselect_b32 s29, 268435456, s29
  v_mov_b64 v[208:209], 0
  v_mov_b64 v[210:211], 0
  s_waitcnt vmcnt(48)
  v_perm_b32 v48, v130, v128, s44
  v_perm_b32 v49, v134, v132, s44
  v_perm_b32 v50, v138, v136, s44
  v_perm_b32 v51, v142, v140, s44
  v_accvgpr_write_b32 a64, v48
  v_accvgpr_write_b32 a65, v49
  v_accvgpr_write_b32 a66, v50
  v_accvgpr_write_b32 a67, v51
  v_perm_b32 v52, v130, v128, s45
  v_perm_b32 v53, v134, v132, s45
  v_perm_b32 v54, v138, v136, s45
  v_perm_b32 v55, v142, v140, s45
  v_accvgpr_write_b32 a68, v52
  v_accvgpr_write_b32 a69, v53
  v_accvgpr_write_b32 a70, v54
  v_accvgpr_write_b32 a71, v55
  v_perm_b32 v48, v131, v129, s44
  v_perm_b32 v49, v135, v133, s44
  v_perm_b32 v50, v139, v137, s44
  v_perm_b32 v51, v143, v141, s44
  v_accvgpr_write_b32 a72, v48
  v_accvgpr_write_b32 a73, v49
  v_accvgpr_write_b32 a74, v50
  v_accvgpr_write_b32 a75, v51
  v_perm_b32 v52, v131, v129, s45
  v_perm_b32 v53, v135, v133, s45
  v_perm_b32 v54, v139, v137, s45
  v_perm_b32 v55, v143, v141, s45
  v_accvgpr_write_b32 a76, v52
  v_accvgpr_write_b32 a77, v53
  v_accvgpr_write_b32 a78, v54
  v_accvgpr_write_b32 a79, v55
  s_add_u32 s27, s30, 172032
  buffer_load_dwordx2 v[128:129], v44, s[80:83], s27 offen
  s_add_u32 s27, s30, 173056
  buffer_load_dwordx2 v[130:131], v44, s[80:83], s27 offen
  s_add_u32 s27, s30, 174080
  buffer_load_dwordx2 v[132:133], v44, s[80:83], s27 offen
  s_add_u32 s27, s30, 175104
  buffer_load_dwordx2 v[134:135], v44, s[80:83], s27 offen
  s_add_u32 s27, s30, 188416
  buffer_load_dwordx2 v[136:137], v44, s[80:83], s27 offen
  s_add_u32 s27, s30, 189440
  buffer_load_dwordx2 v[138:139], v44, s[80:83], s27 offen
  s_add_u32 s27, s30, 190464
  buffer_load_dwordx2 v[140:141], v44, s[80:83], s27 offen
  s_add_u32 s27, s30, 191488
  buffer_load_dwordx2 v[142:143], v44, s[80:83], s27 offen
  s_waitcnt vmcnt(48)
  v_perm_b32 v48, v146, v144, s44
  v_perm_b32 v49, v150, v148, s44
  v_perm_b32 v50, v154, v152, s44
  v_perm_b32 v51, v158, v156, s44
  v_accvgpr_write_b32 a80, v48
  v_accvgpr_write_b32 a81, v49
  v_accvgpr_write_b32 a82, v50
  v_accvgpr_write_b32 a83, v51
  v_perm_b32 v52, v146, v144, s45
  v_perm_b32 v53, v150, v148, s45
  v_perm_b32 v54, v154, v152, s45
  v_perm_b32 v55, v158, v156, s45
  v_accvgpr_write_b32 a84, v52
  v_accvgpr_write_b32 a85, v53
  v_accvgpr_write_b32 a86, v54
  v_accvgpr_write_b32 a87, v55
  v_perm_b32 v48, v147, v145, s44
  v_perm_b32 v49, v151, v149, s44
  v_perm_b32 v50, v155, v153, s44
  v_perm_b32 v51, v159, v157, s44
  v_accvgpr_write_b32 a88, v48
  v_accvgpr_write_b32 a89, v49
  v_accvgpr_write_b32 a90, v50
  v_accvgpr_write_b32 a91, v51
  v_perm_b32 v52, v147, v145, s45
  v_perm_b32 v53, v151, v149, s45
  v_perm_b32 v54, v155, v153, s45
  v_perm_b32 v55, v159, v157, s45
  v_accvgpr_write_b32 a92, v52
  v_accvgpr_write_b32 a93, v53
  v_accvgpr_write_b32 a94, v54
  v_accvgpr_write_b32 a95, v55
  s_add_u32 s27, s30, 196608
  buffer_load_dwordx2 v[144:145], v44, s[80:83], s27 offen
  s_add_u32 s27, s30, 197632
  buffer_load_dwordx2 v[146:147], v44, s[80:83], s27 offen
  s_add_u32 s27, s30, 198656
  buffer_load_dwordx2 v[148:149], v44, s[80:83], s27 offen
  s_add_u32 s27, s30, 199680
  buffer_load_dwordx2 v[150:151], v44, s[80:83], s27 offen
  s_add_u32 s27, s30, 212992
  buffer_load_dwordx2 v[152:153], v44, s[80:83], s27 offen
  s_add_u32 s27, s30, 214016
  buffer_load_dwordx2 v[154:155], v44, s[80:83], s27 offen
  s_add_u32 s27, s30, 215040
  buffer_load_dwordx2 v[156:157], v44, s[80:83], s27 offen
  s_add_u32 s27, s30, 216064
  buffer_load_dwordx2 v[158:159], v44, s[80:83], s27 offen
  s_waitcnt vmcnt(48)
  v_perm_b32 v48, v162, v160, s44
  v_perm_b32 v49, v166, v164, s44
  v_perm_b32 v50, v170, v168, s44
  v_perm_b32 v51, v174, v172, s44
  v_accvgpr_write_b32 a96, v48
  v_accvgpr_write_b32 a97, v49
  v_accvgpr_write_b32 a98, v50
  v_accvgpr_write_b32 a99, v51
  v_perm_b32 v52, v162, v160, s45
  v_perm_b32 v53, v166, v164, s45
  v_perm_b32 v54, v170, v168, s45
  v_perm_b32 v55, v174, v172, s45
  v_accvgpr_write_b32 a100, v52
  v_accvgpr_write_b32 a101, v53
  v_accvgpr_write_b32 a102, v54
  v_accvgpr_write_b32 a103, v55
  v_perm_b32 v48, v163, v161, s44
  v_perm_b32 v49, v167, v165, s44
  v_perm_b32 v50, v171, v169, s44
  v_perm_b32 v51, v175, v173, s44
  v_accvgpr_write_b32 a104, v48
  v_accvgpr_write_b32 a105, v49
  v_accvgpr_write_b32 a106, v50
  v_accvgpr_write_b32 a107, v51
  v_perm_b32 v52, v163, v161, s45
  v_perm_b32 v53, v167, v165, s45
  v_perm_b32 v54, v171, v169, s45
  v_perm_b32 v55, v175, v173, s45
  v_accvgpr_write_b32 a108, v52
  v_accvgpr_write_b32 a109, v53
  v_accvgpr_write_b32 a110, v54
  v_accvgpr_write_b32 a111, v55
  s_add_u32 s27, s30, 204800
  buffer_load_dwordx2 v[160:161], v44, s[80:83], s27 offen
  s_add_u32 s27, s30, 205824
  buffer_load_dwordx2 v[162:163], v44, s[80:83], s27 offen
  s_add_u32 s27, s30, 206848
  buffer_load_dwordx2 v[164:165], v44, s[80:83], s27 offen
  s_add_u32 s27, s30, 207872
  buffer_load_dwordx2 v[166:167], v44, s[80:83], s27 offen
  s_add_u32 s27, s30, 221184
  buffer_load_dwordx2 v[168:169], v44, s[80:83], s27 offen
  s_add_u32 s27, s30, 222208
  buffer_load_dwordx2 v[170:171], v44, s[80:83], s27 offen
  s_add_u32 s27, s30, 223232
  buffer_load_dwordx2 v[172:173], v44, s[80:83], s27 offen
  s_add_u32 s27, s30, 224256
  buffer_load_dwordx2 v[174:175], v44, s[80:83], s27 offen
  s_waitcnt vmcnt(48)
  v_perm_b32 v48, v66, v64, s44
  v_perm_b32 v49, v70, v68, s44
  v_perm_b32 v50, v74, v72, s44
  v_perm_b32 v51, v78, v76, s44
  v_accvgpr_write_b32 a112, v48
  v_accvgpr_write_b32 a113, v49
  v_accvgpr_write_b32 a114, v50
  v_accvgpr_write_b32 a115, v51
  v_perm_b32 v52, v66, v64, s45
  v_perm_b32 v53, v70, v68, s45
  v_perm_b32 v54, v74, v72, s45
  v_perm_b32 v55, v78, v76, s45
  v_accvgpr_write_b32 a116, v52
  v_accvgpr_write_b32 a117, v53
  v_accvgpr_write_b32 a118, v54
  v_accvgpr_write_b32 a119, v55
  v_perm_b32 v48, v67, v65, s44
  v_perm_b32 v49, v71, v69, s44
  v_perm_b32 v50, v75, v73, s44
  v_perm_b32 v51, v79, v77, s44
  v_accvgpr_write_b32 a120, v48
  v_accvgpr_write_b32 a121, v49
  v_accvgpr_write_b32 a122, v50
  v_accvgpr_write_b32 a123, v51
  v_perm_b32 v52, v67, v65, s45
  v_perm_b32 v53, v71, v69, s45
  v_perm_b32 v54, v75, v73, s45
  v_perm_b32 v55, v79, v77, s45
  v_accvgpr_write_b32 a124, v52
  v_accvgpr_write_b32 a125, v53
  v_accvgpr_write_b32 a126, v54
  v_accvgpr_write_b32 a127, v55
  s_add_u32 s27, s30, 229376
  buffer_load_dwordx2 v[64:65], v44, s[80:83], s27 offen
  s_add_u32 s27, s30, 230400
  buffer_load_dwordx2 v[66:67], v44, s[80:83], s27 offen
  s_add_u32 s27, s30, 231424
  buffer_load_dwordx2 v[68:69], v44, s[80:83], s27 offen
  s_add_u32 s27, s30, 232448
  buffer_load_dwordx2 v[70:71], v44, s[80:83], s27 offen
  s_add_u32 s27, s30, 245760
  buffer_load_dwordx2 v[72:73], v44, s[80:83], s27 offen
  s_add_u32 s27, s30, 246784
  buffer_load_dwordx2 v[74:75], v44, s[80:83], s27 offen
  s_add_u32 s27, s30, 247808
  buffer_load_dwordx2 v[76:77], v44, s[80:83], s27 offen
  s_add_u32 s27, s30, 248832
  buffer_load_dwordx2 v[78:79], v44, s[80:83], s27 offen
  s_waitcnt vmcnt(48)
  v_perm_b32 v48, v82, v80, s44
  v_perm_b32 v49, v86, v84, s44
  v_perm_b32 v50, v90, v88, s44
  v_perm_b32 v51, v94, v92, s44
  v_accvgpr_write_b32 a128, v48
  v_accvgpr_write_b32 a129, v49
  v_accvgpr_write_b32 a130, v50
  v_accvgpr_write_b32 a131, v51
  v_perm_b32 v52, v82, v80, s45
  v_perm_b32 v53, v86, v84, s45
  v_perm_b32 v54, v90, v88, s45
  v_perm_b32 v55, v94, v92, s45
  v_accvgpr_write_b32 a132, v52
  v_accvgpr_write_b32 a133, v53
  v_accvgpr_write_b32 a134, v54
  v_accvgpr_write_b32 a135, v55
  v_perm_b32 v48, v83, v81, s44
  v_perm_b32 v49, v87, v85, s44
  v_perm_b32 v50, v91, v89, s44
  v_perm_b32 v51, v95, v93, s44
  v_accvgpr_write_b32 a136, v48
  v_accvgpr_write_b32 a137, v49
  v_accvgpr_write_b32 a138, v50
  v_accvgpr_write_b32 a139, v51
  v_perm_b32 v52, v83, v81, s45
  v_perm_b32 v53, v87, v85, s45
  v_perm_b32 v54, v91, v89, s45
  v_perm_b32 v55, v95, v93, s45
  v_accvgpr_write_b32 a140, v52
  v_accvgpr_write_b32 a141, v53
  v_accvgpr_write_b32 a142, v54
  v_accvgpr_write_b32 a143, v55
  s_add_u32 s27, s30, 237568
  buffer_load_dwordx2 v[80:81], v44, s[80:83], s27 offen
  s_add_u32 s27, s30, 238592
  buffer_load_dwordx2 v[82:83], v44, s[80:83], s27 offen
  s_add_u32 s27, s30, 239616
  buffer_load_dwordx2 v[84:85], v44, s[80:83], s27 offen
  s_add_u32 s27, s30, 240640
  buffer_load_dwordx2 v[86:87], v44, s[80:83], s27 offen
  s_add_u32 s27, s30, 253952
  buffer_load_dwordx2 v[88:89], v44, s[80:83], s27 offen
  s_add_u32 s27, s30, 254976
  buffer_load_dwordx2 v[90:91], v44, s[80:83], s27 offen
  s_add_u32 s27, s30, 256000
  buffer_load_dwordx2 v[92:93], v44, s[80:83], s27 offen
  s_add_u32 s27, s30, 257024
  buffer_load_dwordx2 v[94:95], v44, s[80:83], s27 offen
  s_waitcnt vmcnt(48)
  v_perm_b32 v48, v98, v96, s44
  v_perm_b32 v49, v102, v100, s44
  v_perm_b32 v50, v106, v104, s44
  v_perm_b32 v51, v110, v108, s44
  v_accvgpr_write_b32 a144, v48
  v_accvgpr_write_b32 a145, v49
  v_accvgpr_write_b32 a146, v50
  v_accvgpr_write_b32 a147, v51
  v_perm_b32 v52, v98, v96, s45
  v_perm_b32 v53, v102, v100, s45
  v_perm_b32 v54, v106, v104, s45
  v_perm_b32 v55, v110, v108, s45
  v_accvgpr_write_b32 a148, v52
  v_accvgpr_write_b32 a149, v53
  v_accvgpr_write_b32 a150, v54
  v_accvgpr_write_b32 a151, v55
  v_perm_b32 v48, v99, v97, s44
  v_perm_b32 v49, v103, v101, s44
  v_perm_b32 v50, v107, v105, s44
  v_perm_b32 v51, v111, v109, s44
  v_accvgpr_write_b32 a152, v48
  v_accvgpr_write_b32 a153, v49
  v_accvgpr_write_b32 a154, v50
  v_accvgpr_write_b32 a155, v51
  v_perm_b32 v52, v99, v97, s45
  v_perm_b32 v53, v103, v101, s45
  v_perm_b32 v54, v107, v105, s45
  v_perm_b32 v55, v111, v109, s45
  v_accvgpr_write_b32 a156, v52
  v_accvgpr_write_b32 a157, v53
  v_accvgpr_write_b32 a158, v54
  v_accvgpr_write_b32 a159, v55
  buffer_store_dwordx4 v[208:211], v0, s[4:7], s29 offen offset:0 sc1
  buffer_store_dwordx4 v[208:211], v0, s[4:7], s29 offen offset:1024 sc1
  buffer_store_dwordx4 v[208:211], v0, s[4:7], s29 offen offset:2048 sc1
  buffer_store_dwordx4 v[208:211], v0, s[4:7], s29 offen offset:3072 sc1
  s_add_u32 s29, s29, 4096
  s_waitcnt vmcnt(44)
  v_perm_b32 v48, v114, v112, s44
  v_perm_b32 v49, v118, v116, s44
  v_perm_b32 v50, v122, v120, s44
  v_perm_b32 v51, v126, v124, s44
  v_accvgpr_write_b32 a160, v48
  v_accvgpr_write_b32 a161, v49
  v_accvgpr_write_b32 a162, v50
  v_accvgpr_write_b32 a163, v51
  v_perm_b32 v52, v114, v112, s45
  v_perm_b32 v53, v118, v116, s45
  v_perm_b32 v54, v122, v120, s45
  v_perm_b32 v55, v126, v124, s45
  v_accvgpr_write_b32 a164, v52
  v_accvgpr_write_b32 a165, v53
  v_accvgpr_write_b32 a166, v54
  v_accvgpr_write_b32 a167, v55
  v_perm_b32 v48, v115, v113, s44
  v_perm_b32 v49, v119, v117, s44
  v_perm_b32 v50, v123, v121, s44
  v_perm_b32 v51, v127, v125, s44
  v_accvgpr_write_b32 a168, v48
  v_accvgpr_write_b32 a169, v49
  v_accvgpr_write_b32 a170, v50
  v_accvgpr_write_b32 a171, v51
  v_perm_b32 v52, v115, v113, s45
  v_perm_b32 v53, v119, v117, s45
  v_perm_b32 v54, v123, v121, s45
  v_perm_b32 v55, v127, v125, s45
  v_accvgpr_write_b32 a172, v52
  v_accvgpr_write_b32 a173, v53
  v_accvgpr_write_b32 a174, v54
  v_accvgpr_write_b32 a175, v55
  buffer_store_dwordx4 v[208:211], v0, s[4:7], s29 offen offset:0 sc1
  buffer_store_dwordx4 v[208:211], v0, s[4:7], s29 offen offset:1024 sc1
  buffer_store_dwordx4 v[208:211], v0, s[4:7], s29 offen offset:2048 sc1
  buffer_store_dwordx4 v[208:211], v0, s[4:7], s29 offen offset:3072 sc1
  s_add_u32 s29, s29, 520192
  s_waitcnt vmcnt(40)
  v_perm_b32 v48, v130, v128, s44
  v_perm_b32 v49, v134, v132, s44
  v_perm_b32 v50, v138, v136, s44
  v_perm_b32 v51, v142, v140, s44
  v_accvgpr_write_b32 a176, v48
  v_accvgpr_write_b32 a177, v49
  v_accvgpr_write_b32 a178, v50
  v_accvgpr_write_b32 a179, v51
  v_perm_b32 v52, v130, v128, s45
  v_perm_b32 v53, v134, v132, s45
  v_perm_b32 v54, v138, v136, s45
  v_perm_b32 v55, v142, v140, s45
  v_accvgpr_write_b32 a180, v52
  v_accvgpr_write_b32 a181, v53
  v_accvgpr_write_b32 a182, v54
  v_accvgpr_write_b32 a183, v55
  v_perm_b32 v48, v131, v129, s44
  v_perm_b32 v49, v135, v133, s44
  v_perm_b32 v50, v139, v137, s44
  v_perm_b32 v51, v143, v141, s44
  v_accvgpr_write_b32 a184, v48
  v_accvgpr_write_b32 a185, v49
  v_accvgpr_write_b32 a186, v50
  v_accvgpr_write_b32 a187, v51
  v_perm_b32 v52, v131, v129, s45
  v_perm_b32 v53, v135, v133, s45
  v_perm_b32 v54, v139, v137, s45
  v_perm_b32 v55, v143, v141, s45
  v_accvgpr_write_b32 a188, v52
  v_accvgpr_write_b32 a189, v53
  v_accvgpr_write_b32 a190, v54
  v_accvgpr_write_b32 a191, v55
  buffer_store_dwordx4 v[208:211], v0, s[4:7], s29 offen offset:0 sc1
  buffer_store_dwordx4 v[208:211], v0, s[4:7], s29 offen offset:1024 sc1
  buffer_store_dwordx4 v[208:211], v0, s[4:7], s29 offen offset:2048 sc1
  buffer_store_dwordx4 v[208:211], v0, s[4:7], s29 offen offset:3072 sc1
  s_add_u32 s29, s29, 4096
  s_waitcnt vmcnt(36)
  v_perm_b32 v48, v146, v144, s44
  v_perm_b32 v49, v150, v148, s44
  v_perm_b32 v50, v154, v152, s44
  v_perm_b32 v51, v158, v156, s44
  v_accvgpr_write_b32 a192, v48
  v_accvgpr_write_b32 a193, v49
  v_accvgpr_write_b32 a194, v50
  v_accvgpr_write_b32 a195, v51
  v_perm_b32 v52, v146, v144, s45
  v_perm_b32 v53, v150, v148, s45
  v_perm_b32 v54, v154, v152, s45
  v_perm_b32 v55, v158, v156, s45
  v_accvgpr_write_b32 a196, v52
  v_accvgpr_write_b32 a197, v53
  v_accvgpr_write_b32 a198, v54
  v_accvgpr_write_b32 a199, v55
  v_perm_b32 v48, v147, v145, s44
  v_perm_b32 v49, v151, v149, s44
  v_perm_b32 v50, v155, v153, s44
  v_perm_b32 v51, v159, v157, s44
  v_accvgpr_write_b32 a200, v48
  v_accvgpr_write_b32 a201, v49
  v_accvgpr_write_b32 a202, v50
  v_accvgpr_write_b32 a203, v51
  v_perm_b32 v52, v147, v145, s45
  v_perm_b32 v53, v151, v149, s45
  v_perm_b32 v54, v155, v153, s45
  v_perm_b32 v55, v159, v157, s45
  v_accvgpr_write_b32 a204, v52
  v_accvgpr_write_b32 a205, v53
  v_accvgpr_write_b32 a206, v54
  v_accvgpr_write_b32 a207, v55
  buffer_store_dwordx4 v[208:211], v0, s[4:7], s29 offen offset:0 sc1
  buffer_store_dwordx4 v[208:211], v0, s[4:7], s29 offen offset:1024 sc1
  buffer_store_dwordx4 v[208:211], v0, s[4:7], s29 offen offset:2048 sc1
  buffer_store_dwordx4 v[208:211], v0, s[4:7], s29 offen offset:3072 sc1
  s_add_u32 s29, s29, 4096
  s_waitcnt vmcnt(32)
  v_perm_b32 v48, v162, v160, s44
  v_perm_b32 v49, v166, v164, s44
  v_perm_b32 v50, v170, v168, s44
  v_perm_b32 v51, v174, v172, s44
  v_accvgpr_write_b32 a208, v48
  v_accvgpr_write_b32 a209, v49
  v_accvgpr_write_b32 a210, v50
  v_accvgpr_write_b32 a211, v51
  v_perm_b32 v52, v162, v160, s45
  v_perm_b32 v53, v166, v164, s45
  v_perm_b32 v54, v170, v168, s45
  v_perm_b32 v55, v174, v172, s45
  v_accvgpr_write_b32 a212, v52
  v_accvgpr_write_b32 a213, v53
  v_accvgpr_write_b32 a214, v54
  v_accvgpr_write_b32 a215, v55
  v_perm_b32 v48, v163, v161, s44
  v_perm_b32 v49, v167, v165, s44
  v_perm_b32 v50, v171, v169, s44
  v_perm_b32 v51, v175, v173, s44
  v_accvgpr_write_b32 a216, v48
  v_accvgpr_write_b32 a217, v49
  v_accvgpr_write_b32 a218, v50
  v_accvgpr_write_b32 a219, v51
  v_perm_b32 v52, v163, v161, s45
  v_perm_b32 v53, v167, v165, s45
  v_perm_b32 v54, v171, v169, s45
  v_perm_b32 v55, v175, v173, s45
  v_accvgpr_write_b32 a220, v52
  v_accvgpr_write_b32 a221, v53
  v_accvgpr_write_b32 a222, v54
  v_accvgpr_write_b32 a223, v55
  s_waitcnt vmcnt(24)
  v_perm_b32 v48, v66, v64, s44
  v_perm_b32 v49, v70, v68, s44
  v_perm_b32 v50, v74, v72, s44
  v_perm_b32 v51, v78, v76, s44
  v_accvgpr_write_b32 a224, v48
  v_accvgpr_write_b32 a225, v49
  v_accvgpr_write_b32 a226, v50
  v_accvgpr_write_b32 a227, v51
  v_perm_b32 v52, v66, v64, s45
  v_perm_b32 v53, v70, v68, s45
  v_perm_b32 v54, v74, v72, s45
  v_perm_b32 v55, v78, v76, s45
  v_accvgpr_write_b32 a228, v52
  v_accvgpr_write_b32 a229, v53
  v_accvgpr_write_b32 a230, v54
  v_accvgpr_write_b32 a231, v55
  v_perm_b32 v48, v67, v65, s44
  v_perm_b32 v49, v71, v69, s44
  v_perm_b32 v50, v75, v73, s44
  v_perm_b32 v51, v79, v77, s44
  v_accvgpr_write_b32 a232, v48
  v_accvgpr_write_b32 a233, v49
  v_accvgpr_write_b32 a234, v50
  v_accvgpr_write_b32 a235, v51
  v_perm_b32 v52, v67, v65, s45
  v_perm_b32 v53, v71, v69, s45
  v_perm_b32 v54, v75, v73, s45
  v_perm_b32 v55, v79, v77, s45
  v_accvgpr_write_b32 a236, v52
  v_accvgpr_write_b32 a237, v53
  v_accvgpr_write_b32 a238, v54
  v_accvgpr_write_b32 a239, v55
  s_waitcnt vmcnt(16)
  v_perm_b32 v48, v82, v80, s44
  v_perm_b32 v49, v86, v84, s44
  v_perm_b32 v50, v90, v88, s44
  v_perm_b32 v51, v94, v92, s44
  v_accvgpr_write_b32 a240, v48
  v_accvgpr_write_b32 a241, v49
  v_accvgpr_write_b32 a242, v50
  v_accvgpr_write_b32 a243, v51
  v_perm_b32 v52, v82, v80, s45
  v_perm_b32 v53, v86, v84, s45
  v_perm_b32 v54, v90, v88, s45
  v_perm_b32 v55, v94, v92, s45
  v_accvgpr_write_b32 a244, v52
  v_accvgpr_write_b32 a245, v53
  v_accvgpr_write_b32 a246, v54
  v_accvgpr_write_b32 a247, v55
  v_perm_b32 v48, v83, v81, s44
  v_perm_b32 v49, v87, v85, s44
  v_perm_b32 v50, v91, v89, s44
  v_perm_b32 v51, v95, v93, s44
  v_accvgpr_write_b32 a248, v48
  v_accvgpr_write_b32 a249, v49
  v_accvgpr_write_b32 a250, v50
  v_accvgpr_write_b32 a251, v51
  v_perm_b32 v52, v83, v81, s45
  v_perm_b32 v53, v87, v85, s45
  v_perm_b32 v54, v91, v89, s45
  v_perm_b32 v55, v95, v93, s45
  v_accvgpr_write_b32 a252, v52
  v_accvgpr_write_b32 a253, v53
  v_accvgpr_write_b32 a254, v54
  v_accvgpr_write_b32 a255, v55
  s_waitcnt vmcnt(0)
  s_barrier
  s_cmp_ge_u32 s60, 4
  s_cbranch_scc1 L_oh
  s_cmp_lg_u32 s17, 0
  s_cbranch_scc1 g_ar_121
  s_lshl_b32 s36, s89, 3
  s_lshl_b64 s[36:37], 1, s36
  v_lshlrev_b32 v52, 3, s91
  v_mov_b32 v48, s36
  v_mov_b32 v49, s37
  s_mov_b64 exec, 1
  global_atomic_add_x2 v[50:51], v52, v[48:49], s[12:13] sc0
  s_mov_b64 exec, -1
g_ar_121:
  s_waitcnt vmcnt(0)
  s_cmp_lg_u32 s17, 0
  s_cbranch_scc1 g_af_122
  v_readfirstlane_b32 s36, v50
  v_readfirstlane_b32 s37, v51
  s_add_u32 s38, s36, s37
  s_mul_i32 s38, s38, 0x01010101
  s_lshr_b32 s38, s38, 24
  s_cmp_lg_u32 s38, 15
  s_cbranch_scc1 g_af_122
  s_lshl_b32 s38, s89, 3
  s_lshr_b64 s[36:37], s[36:37], s38
  s_and_b32 s36, s36, 0xff
  s_cmp_eq_u32 s36, 15
  s_cselect_b32 s36, 1, 2
  v_mov_b32 v48, s36
  v_lshrrev_b32 v52, 1, v52
  s_mov_b64 exec, 1
  global_store_dword v52, v48, s[12:13] offset:128 sc1
  s_mov_b64 exec, -1
g_af_122:
  s_lshr_b32 s26, s60, 1
  s_cmp_lg_u32 s26, 1
  s_cbranch_scc1 L_ow
  s_and_b32 s28, s85, 28
  s_or_b32 s28, s28, 1
  s_lshl_b32 s27, s28, 6
  s_add_u32 s27, s27, 245104640
  s_mov_b32 s26, 0
g_h_123:
  buffer_load_dwordx2 v[60:61], off, s[4:7], s27 sc1
  s_add_u32 s26, s26, 1
  s_cmp_gt_u32 s26, 1048576
  s_cbranch_scc1 L_end
  s_waitcnt vmcnt(0)
  v_and_or_b32 v60, v61, -1, v60
  v_cmp_eq_u32 vcc, 0, v60
  s_cbranch_vccnz g_h_123
  s_mov_b32 s10, 1835008
  s_load_dwordx2 s[8:9], s[0:1], 72
  s_mul_i32 s26, s77, 14336
  s_sub_u32 s26, s26, 1835008
  s_waitcnt lgkmcnt(0)
  buffer_load_dwordx4 v[64:67], v0, s[8:11], s26 offen offset:0
  buffer_load_dwordx4 v[64:67], v0, s[8:11], s26 offen offset:1024
  buffer_load_dwordx4 v[64:67], v0, s[8:11], s26 offen offset:2048
  buffer_load_dwordx4 v[64:67], v0, s[8:11], s26 offen offset:3072
  s_add_u32 s26, s26, 4096
  buffer_load_dwordx4 v[64:67], v0, s[8:11], s26 offen offset:0
  buffer_load_dwordx4 v[64:67], v0, s[8:11], s26 offen offset:1024
  buffer_load_dwordx4 v[64:67], v0, s[8:11], s26 offen offset:2048
  buffer_load_dwordx4 v[64:67], v0, s[8:11], s26 offen offset:3072
  s_add_u32 s26, s26, 4096
  buffer_load_dwordx4 v[64:67], v0, s[8:11], s26 offen offset:0
  buffer_load_dwordx4 v[64:67], v0, s[8:11], s26 offen offset:1024
  buffer_load_dwordx4 v[64:67], v0, s[8:11], s26 offen offset:2048
  buffer_load_dwordx4 v[64:67], v0, s[8:11], s26 offen offset:3072
  s_add_u32 s26, s26, 4096
  buffer_load_dwordx4 v[64:67], v0, s[8:11], s26 offen offset:0
  buffer_load_dwordx4 v[64:67], v0, s[8:11], s26 offen offset:1024
  s_load_dwordx2 s[8:9], s[0:1], 80
  s_mul_i32 s26, s77, 14336
  s_sub_u32 s26, s26, 1835008
  s_waitcnt lgkmcnt(0)
  buffer_load_dwordx4 v[64:67], v0, s[8:11], s26 offen offset:0
  buffer_load_dwordx4 v[64:67], v0, s[8:11], s26 offen offset:1024
  buffer_load_dwordx4 v[64:67], v0, s[8:11], s26 offen offset:2048
  buffer_load_dwordx4 v[64:67], v0, s[8:11], s26 offen offset:3072
  s_add_u32 s26, s26, 4096
  buffer_load_dwordx4 v[64:67], v0, s[8:11], s26 offen offset:0
  buffer_load_dwordx4 v[64:67], v0, s[8:11], s26 offen offset:1024
  buffer_load_dwordx4 v[64:67], v0, s[8:11], s26 offen offset:2048
  buffer_load_dwordx4 v[64:67], v0, s[8:11], s26 offen offset:3072
  s_add_u32 s26, s26, 4096
  buffer_load_dwordx4 v[64:67], v0, s[8:11], s26 offen offset:0
  buffer_load_dwordx4 v[64:67], v0, s[8:11], s26 offen offset:1024
  buffer_load_dwordx4 v[64:67], v0, s[8:11], s26 offen offset:2048
  buffer_load_dwordx4 v[64:67], v0, s[8:11], s26 offen offset:3072
  s_add_u32 s26, s26, 4096
  buffer_load_dwordx4 v[64:67], v0, s[8:11], s26 offen offset:0
  buffer_load_dwordx4 v[64:67], v0, s[8:11], s26 offen offset:1024
  s_load_dwordx2 s[8:9], s[0:1], 88
  s_mul_i32 s26, s77, 14336
  s_sub_u32 s26, s26, 1835008
  s_waitcnt lgkmcnt(0)
  buffer_load_dwordx4 v[64:67], v0, s[8:11], s26 offen offset:0
  buffer_load_dwordx4 v[64:67], v0, s[8:11], s26 offen offset:1024
  buffer_load_dwordx4 v[64:67], v0, s[8:11], s26 offen offset:2048
  buffer_load_dwordx4 v[64:67], v0, s[8:11], s26 offen offset:3072
  s_add_u32 s26, s26, 4096
  buffer_load_dwordx4 v[64:67], v0, s[8:11], s26 offen offset:0
  buffer_load_dwordx4 v[64:67], v0, s[8:11], s26 offen offset:1024
  buffer_load_dwordx4 v[64:67], v0, s[8:11], s26 offen offset:2048
  buffer_load_dwordx4 v[64:67], v0, s[8:11], s26 offen offset:3072
  s_add_u32 s26, s26, 4096
  buffer_load_dwordx4 v[64:67], v0, s[8:11], s26 offen offset:0
  buffer_load_dwordx4 v[64:67], v0, s[8:11], s26 offen offset:1024
  buffer_load_dwordx4 v[64:67], v0, s[8:11], s26 offen offset:2048
  buffer_load_dwordx4 v[64:67], v0, s[8:11], s26 offen offset:3072
  s_add_u32 s26, s26, 4096
  buffer_load_dwordx4 v[64:67], v0, s[8:11], s26 offen offset:0
  buffer_load_dwordx4 v[64:67], v0, s[8:11], s26 offen offset:1024
L_ow:
  v_mbcnt_lo_u32_b32 v60, -1, 0
  v_and_b32 v60, 0, v60
  v_add_lshl_u32 v60, v60, s91, 2
  s_mov_b32 s26, 0
g_wt_124:
  global_load_dword v61, v60, s[12:13] offset:128 sc1
  s_add_u32 s26, s26, 1
  s_cmp_gt_u32 s26, 1048576
  s_cbranch_scc1 L_end
  s_waitcnt vmcnt(0)
  v_cmp_eq_u32 vcc, 0, v61
  v_readfirstlane_b32 s27, v61
  s_cbranch_vccnz g_wt_124
  s_mov_b32 s89, s27
L_oh:
  s_cmp_lg_u32 s89, 1
  s_cbranch_scc1 L_o_x
  s_mov_b32 s62, 1
  s_mov_b32 s42, 0
  s_mov_b32 s3, 0
  s_mov_b32 s46, 0
  s_mov_b32 s65, 0
  s_mov_b32 s66, 0
  s_mov_b32 s76, 0
  s_mov_b32 s55, 0
  s_mov_b32 s48, 0
  s_mov_b32 s56, 0
  s_mov_b32 s84, 268435456
  s_mov_b32 s86, s41
  s_mov_b32 s49, s60
  s_mul_i32 s63, s49, 257
  s_or_b32 s63, s63, 1179648
  s_lshr_b32 s57, s60, 2
  s_cbranch_scc1 o_help_136
o_round_125:
  s_max_u32 s46, s46, s3
  s_cmp_lg_u32 s3, 0
  s_mov_b32 s3, 0
  s_cbranch_scc1 d_g_141
  s_mov_b32 s67, 0
d_w_140:
  s_min_u32 s26, s49, 71
  s_lshl_b32 s26, s26, 12
  s_add_u32 s27, s26, 243494912
  s_add_u32 s26, s26, 243486720
  buffer_load_dword v248, v246, s[4:7], s26 offen sc1
  buffer_load_dword v249, v246, s[4:7], s27 offen sc1
  s_add_u32 s67, s67, 1
  s_cmp_gt_u32 s67, 1048576
  s_cbranch_scc1 L_end
  s_waitcnt vmcnt(0)
  s_mov_b64 exec, 1
  buffer_store_dword v38, off, s[4:7], s84 sc1
  s_mov_b64 exec, -1
  s_mov_b32 s84, 268435456
  v_min_u32 v162, v248, v249
  v_max_u32 v163, v248, v249
  v_cmp_eq_u32 vcc, 0, v162
  s_cbranch_vccnz d_w_140
  v_max_u32_dpp v163, v163, v163 row_ror:8 row_mask:0xf bank_mask:0xf
  s_nop 1
  v_max_u32_dpp v163, v163, v163 row_ror:4 row_mask:0xf bank_mask:0xf
  s_nop 1
  v_max_u32_dpp v163, v163, v163 row_ror:2 row_mask:0xf bank_mask:0xf
  s_nop 1
  v_max_u32_dpp v163, v163, v163 row_ror:1 row_mask:0xf bank_mask:0xf
  s_nop 0
  v_readlane_b32 s28, v163, 0
  v_readlane_b32 s29, v163, 16
  v_readlane_b32 s30, v163, 32
  v_readlane_b32 s31, v163, 48
  s_max_u32 s28, s28, s29
  s_max_u32 s30, s30, s31
  s_max_u32 s46, s46, s28
  s_max_u32 s46, s46, s30
d_g_141:
  s_lshr_b32 s27, s49, 2
  s_andn2_b32 s52, 0xfff, s46
  s_lshr_b32 s52, s52, 5
  s_min_u32 s52, s52, 64
  s_add_u32 s26, s52, 3
  v_readlane_b32 s89, v247, s27
  s_sub_u32 s26, s26, s60
  s_lshr_b32 s26, s26, 2
  s_bfm_b32 s54, s26, 0
  s_add_u32 s53, s63, 1028
  s_cmp_lt_u32 s49, 60
  s_cselect_b32 s53, s53, 0
  s_cmp_lt_u32 s49, 64
  s_cselect_b32 s26, 3, 1
  s_sub_i32 s26, s27, s26
  s_max_i32 s26, s26, 0
  s_min_u32 s26, s26, 16
  s_bfm_b32 s58, s26, 0
  s_cmp_eq_u32 s27, 16
  s_cselect_b32 s59, 2, 1
  s_cmp_eq_u32 s27, 17
  s_cselect_b32 s59, 0, s59
  s_cmp_eq_u32 s27, 18
  s_cselect_b32 s59, 64, s59
  s_cselect_b32 s50, 0, -1
  s_cselect_b32 s89, 0, s89
  s_cbranch_scc1 o_dl_137
  s_cmp_eq_u32 s27, 16
  s_cbranch_scc1 o_dl_137_a
o_pick_129:
  s_cmp_eq_u32 s59, 0
  s_cbranch_scc1 o_none_133
  s_sub_u32 s59, s59, 1
  s_andn2_b32 s26, s58, s55
  s_and_b32 s26, s26, s54
  s_cbranch_scc1 o_ga_130
  s_and_b32 s26, s55, s50
  s_or_b32 s26, s26, s56
  s_or_b32 s26, s26, s54
  s_andn2_b32 s26, s58, s26
  s_cbranch_scc0 o_none_133
  s_cmp_ge_u32 s46, s89
  s_cbranch_scc1 o_gb_131
o_ga_130:
  s_ff1_i32_b32 s26, s26
  s_bitset1_b32 s55, s26
  s_mov_b32 s64, 1327168
  s_mov_b32 s27, s64
  s_branch o_gd_132
o_none_133:
  s_cmp_lt_u32 s49, 60
  s_cbranch_scc1 o_nn_134
  s_cmp_eq_u32 s50, 0
  s_cbranch_scc1 o_nn_134
  s_and_b32 s26, s63, 1097728
  s_cmp_eq_u32 s26, 1048576
  s_cbranch_scc1 o_nn_134
  s_cmp_lt_u32 s49, 64
  s_cbranch_scc1 o_adv_135
  s_and_b32 s26, s65, 1097728
  s_cmp_lg_u32 s26, 1048576
  s_cbranch_scc1 o_adv_135
o_nn_134:
  s_mov_b32 s64, s53
  s_mov_b32 s51, 0
  s_branch o_task_126
o_gb_131:
  s_ff1_i32_b32 s26, s26
  s_bitset1_b32 s56, s26
  s_andn2_b32 s27, 31, s46
  s_or_b32 s27, s27, 32
  s_lshl_b32 s27, s27, 22
  s_or_b32 s27, s27, 1474688
  s_mov_b32 s64, 1474624
o_gd_132:
  s_lshl4_add_u32 s48, s48, s26
  s_and_b32 s28, s26, s57
  s_lshr_b32 s26, s26, s57
  s_lshl2_add_u32 s26, s26, s60
  s_add_u32 s26, s26, s28
  s_cmp_eq_u32 s26, s52
  s_cselect_b32 s64, s27, s64
  s_mul_i32 s26, s26, 257
  s_or_b32 s64, s64, s26
  s_mov_b32 s51, 1
o_task_126:
  s_cmp_eq_u32 s63, 0
  s_cbranch_scc1 o_nofl_127
  s_cmp_lg_u32 s66, 0
  s_cbranch_scc1 o_have_143
  s_mov_b32 s67, 0
o_w1_142:
  s_and_b32 s32, s63, 0xff
  s_lshl_b32 s32, s32, 12
  s_add_u32 s32, s32, s14
  buffer_load_dword v37, v36, s[4:7], s32 offen sc1
  s_add_u32 s67, s67, 1
  s_cmp_gt_u32 s67, 1048576
  s_cbranch_scc1 L_end
  s_waitcnt vmcnt(0)
  s_mov_b64 exec, 1
  buffer_store_dword v38, off, s[4:7], s84 sc1
  s_mov_b64 exec, -1
  s_mov_b32 s84, 268435456
  v_cmp_eq_u32 vcc, 0, v37
  s_cbranch_vccnz o_w1_142
  s_and_b32 s87, s63, 0xff
  s_lshl_b32 s33, s87, 18
  s_lshl_b32 s32, s87, 19
  s_add_u32 m0, s22, 0
  s_add_u32 s33, s33, s19
  buffer_load_dwordx4 v0, s[4:7], s33 offen offset:0 sc1 lds
  buffer_load_dwordx4 v0, s[4:7], s33 offen offset:1024 sc1 lds
  buffer_load_dwordx4 v0, s[4:7], s33 offen offset:2048 sc1 lds
  buffer_load_dwordx4 v0, s[4:7], s33 offen offset:3072 sc1 lds
  s_add_u32 m0, s23, 0
  s_add_u32 s32, s32, s18
  buffer_load_dwordx4 v0, s[4:7], s32 offen offset:0 sc1 lds
  buffer_load_dwordx4 v0, s[4:7], s32 offen offset:1024 sc1 lds
  buffer_load_dwordx4 v0, s[4:7], s32 offen offset:2048 sc1 lds
  buffer_load_dwordx4 v0, s[4:7], s32 offen offset:3072 sc1 lds
  s_add_u32 m0, m0, 4096
  s_add_u32 s32, s32, 4096
  buffer_load_dwordx4 v0, s[4:7], s32 offen offset:0 sc1 lds
  buffer_load_dwordx4 v0, s[4:7], s32 offen offset:1024 sc1 lds
  buffer_load_dwordx4 v0, s[4:7], s32 offen offset:2048 sc1 lds
  buffer_load_dwordx4 v0, s[4:7], s32 offen offset:3072 sc1 lds
  s_waitcnt vmcnt(0)
  s_barrier
o_have_143:
  ds_read_b128 v[120:123], v33 offset:0
  ds_read_b128 v[40:43], v32 offset:0
  ds_read_b128 v[56:59], v32 offset:1024
  ds_read_b128 v[124:127], v33 offset:2048
  ds_read_b128 v[44:47], v32 offset:4096
  ds_read_b128 v[60:63], v32 offset:5120
  ds_read_b128 v[128:131], v33 offset:4096
  ds_read_b128 v[48:51], v32 offset:8192
  ds_read_b128 v[64:67], v32 offset:9216
  ds_read_b128 v[132:135], v33 offset:6144
  ds_read_b128 v[52:55], v32 offset:12288
  ds_read_b128 v[68:71], v32 offset:13312
  s_cmp_lt_u32 s17, 2
  s_cselect_b32 s65, s65, 0
  s_cmp_lg_u32 s65, 0
  s_cselect_b64 s[44:45], -1, 0
  s_mov_b32 s95, s86
  s_mov_b32 s96, s42
  s_lshl_b32 s97, s43, 14
  s_add_u32 s97, s97, s95
  s_and_b32 s87, s64, 0xff
  s_lshl_b32 s87, s87, 12
  s_add_u32 s87, s87, s14
  s_and_b32 s88, s63, 0xff00
  s_lshl_b32 s88, s88, 3
  s_add_u32 s88, s88, s15
  s_and_b32 s91, s65, 63
  s_lshl_b32 s90, s91, 5
  s_add_u32 s94, s90, s85
  s_add_u32 s90, s90, s43
  s_lshl_b32 s94, s94, 10
  s_lshr_b32 s92, s65, 22
  s_xor_b32 s93, s43, 32
  s_lshl_b32 s91, s90, 10
  s_add_u32 s94, s94, 25165824
  s_cmp_eq_u32 s92, s93
  s_cselect_b32 s92, s94, s91
  s_add_u32 s92, s92, 10485760
  s_and_b32 s93, s65, 49152
  s_cselect_b32 s92, s92, s91
  s_cselect_b64 s[80:81], s[4:5], s[72:73]
  s_cselect_b32 s82, s6, s74
  s_waitcnt lgkmcnt(9)
  v_mfma_f32_16x16x32_bf16 v[104:107], v[40:43], v[120:123], v[24:27]
  v_mfma_f32_16x16x32_bf16 v[108:111], v[56:59], v[120:123], v[28:31]
  s_mov_b64 exec, s[44:45]
  buffer_load_dword v7, v255, s[4:7], s97 offen sc1
  buffer_load_dwordx4 v[184:187], v0, s[80:83], s92 offen sc1
  s_not_b64 exec, exec
  buffer_load_dword v37, v36, s[4:7], s87 offen sc1
  s_mov_b64 exec, -1
  buffer_load_dword v244, v252, s[4:7], s88 offen sc1
  s_waitcnt lgkmcnt(6)
  v_mfma_f32_16x16x32_bf16 v[104:107], v[44:47], v[124:127], v[104:107]
  v_mfma_f32_16x16x32_bf16 v[108:111], v[60:63], v[124:127], v[108:111]
  s_waitcnt lgkmcnt(3)
  v_mfma_f32_16x16x32_bf16 v[104:107], v[48:51], v[128:131], v[104:107]
  v_mfma_f32_16x16x32_bf16 v[108:111], v[64:67], v[128:131], v[108:111]
  s_waitcnt lgkmcnt(0)
  v_mfma_f32_16x16x32_bf16 v[104:107], v[52:55], v[132:135], v[104:107]
  v_mfma_f32_16x16x32_bf16 v[108:111], v[68:71], v[132:135], v[108:111]
  s_cmp_lg_u32 s76, 0
  s_cbranch_scc1 o_klds_146
  v_mov_b32 v196, 0
  v_mov_b32 v199, 0
  v_exp_f32 v56, v104
  v_exp_f32 v57, v105
  v_exp_f32 v58, v106
  v_exp_f32 v59, v107
  v_exp_f32 v60, v108
  v_exp_f32 v61, v109
  v_exp_f32 v62, v110
  v_exp_f32 v63, v111
  v_max3_f32 v116, v104, v105, v106
  v_max3_f32 v116, v107, v108, v116
  v_max3_f32 v116, v109, v110, v116
  v_add_f32 v117, v56, v57
  v_add_f32 v118, v58, v59
  v_add_f32 v117, v117, v60
  v_add_f32 v118, v118, v61
  v_add_f32 v117, v117, v62
  v_add_f32 v118, v118, v63
  s_mov_b32 s67, 0
  s_and_b32 s32, s63, 0xff00
  s_lshl_b32 s32, s32, 10
  s_add_u32 s32, s32, s20
  s_add_u32 s33, s32, 4096
o_w2_144:
  s_waitcnt vmcnt(0)
  v_cmp_eq_u32 vcc, 0, v244
  s_cbranch_vccz o_kgo_154
  s_mov_b64 exec, 1
  buffer_store_dword v38, off, s[4:7], s84 sc1
  s_mov_b64 exec, -1
  s_mov_b32 s84, 268435456
  buffer_load_dword v244, v252, s[4:7], s88 offen sc1
  s_add_u32 s67, s67, 1
  s_cmp_gt_u32 s67, 1048576
  s_cbranch_scc1 L_end
  s_branch o_w2_144
o_kgo_154:
  buffer_load_dwordx4 v[136:139], v0, s[4:7], s32 offen offset:0 sc1
  buffer_load_dwordx4 v[140:143], v0, s[4:7], s32 offen offset:1024 sc1
  buffer_load_dwordx4 v[144:147], v0, s[4:7], s32 offen offset:2048 sc1
  buffer_load_dwordx4 v[148:151], v0, s[4:7], s32 offen offset:3072 sc1
  buffer_load_dwordx2 v[200:201], v1, s[4:7], s33 offen offset:0 sc1
  buffer_load_dwordx2 v[202:203], v1, s[4:7], s33 offen offset:512 sc1
  buffer_load_dwordx2 v[204:205], v1, s[4:7], s33 offen offset:1024 sc1
  buffer_load_dwordx2 v[206:207], v1, s[4:7], s33 offen offset:1536 sc1
  buffer_load_dword v37, v36, s[4:7], s87 offen sc1
  buffer_load_dword v244, v252, s[4:7], s88 offen sc1
  s_barrier
  ds_read_b128 v[152:155], v32 offset:2048
  ds_read_b128 v[156:159], v32 offset:3072
  ds_read_b128 v[160:163], v32 offset:6144
  ds_read_b128 v[164:167], v32 offset:7168
  ds_read_b128 v[168:171], v32 offset:10240
  ds_read_b128 v[172:175], v32 offset:11264
  ds_read_b128 v[176:179], v32 offset:14336
  ds_read_b128 v[180:183], v32 offset:15360
  s_waitcnt vmcnt(9)
  v_mfma_f32_16x16x32_bf16 v[112:115], v[136:139], v[120:123], 0
  s_waitcnt vmcnt(8)
  v_mfma_f32_16x16x32_bf16 v[112:115], v[140:143], v[124:127], v[112:115]
  s_waitcnt vmcnt(7)
  v_mfma_f32_16x16x32_bf16 v[112:115], v[144:147], v[128:131], v[112:115]
  s_waitcnt vmcnt(6)
  v_mfma_f32_16x16x32_bf16 v[112:115], v[148:151], v[132:135], v[112:115]
  s_waitcnt vmcnt(2)
  s_branch o_havek_145
o_klds_146:
  s_waitcnt vmcnt(12)
  s_barrier
  ds_read_b128 v[136:139], v34 offset:0
  ds_read_b128 v[140:143], v34 offset:1024
  ds_read_b128 v[144:147], v34 offset:2048
  ds_read_b128 v[148:151], v34 offset:3072
  ds_read_b64 v[200:201], v35 offset:4096
  ds_read_b64 v[202:203], v35 offset:4608
  ds_read_b64 v[204:205], v35 offset:5120
  ds_read_b64 v[206:207], v35 offset:5632
  v_mov_b32 v196, 0
  v_mov_b32 v199, 0
  v_exp_f32 v56, v104
  v_exp_f32 v57, v105
  v_exp_f32 v58, v106
  v_exp_f32 v59, v107
  v_exp_f32 v60, v108
  v_exp_f32 v61, v109
  v_exp_f32 v62, v110
  v_exp_f32 v63, v111
  v_max3_f32 v116, v104, v105, v106
  v_max3_f32 v116, v107, v108, v116
  v_max3_f32 v116, v109, v110, v116
  s_waitcnt lgkmcnt(4)
  v_mfma_f32_16x16x32_bf16 v[112:115], v[136:139], v[120:123], 0
  ds_read_b128 v[152:155], v32 offset:2048
  ds_read_b128 v[156:159], v32 offset:3072
  v_mfma_f32_16x16x32_bf16 v[112:115], v[140:143], v[124:127], v[112:115]
  ds_read_b128 v[160:163], v32 offset:6144
  ds_read_b128 v[164:167], v32 offset:7168
  v_mfma_f32_16x16x32_bf16 v[112:115], v[144:147], v[128:131], v[112:115]
  ds_read_b128 v[168:171], v32 offset:10240
  ds_read_b128 v[172:175], v32 offset:11264
  v_mfma_f32_16x16x32_bf16 v[112:115], v[148:151], v[132:135], v[112:115]
  ds_read_b128 v[176:179], v32 offset:14336
  ds_read_b128 v[180:183], v32 offset:15360
  v_add_f32 v117, v56, v57
  v_add_f32 v118, v58, v59
  v_add_f32 v117, v117, v60
  v_add_f32 v118, v118, v61
  v_add_f32 v117, v117, v62
  v_add_f32 v118, v118, v63
o_havek_145:
  s_cmp_lg_u32 s65, 0
  s_cbranch_scc1 o_wr1_151
  s_nop 3
  v_mul_f32 v112, s24, v112
  v_mul_f32 v113, s24, v113
  v_exp_f32 v64, v112
  v_exp_f32 v65, v113
  v_max_f32 v116, v111, v116
  v_max3_f32 v116, v112, v113, v116
  v_add_f32 v117, v117, v64
  v_add_f32 v118, v118, v65
  v_add_f32 v117, v117, v118
  s_mov_b32 s28, 0x21800000
  v_mov_b32 v118, v117
  s_nop 1
  v_permlane16_swap_b32 v117, v118
  v_add_f32 v117, v117, v118
  v_mov_b32 v118, v117
  s_nop 0
  s_nop 0
  v_permlane32_swap_b32 v117, v118
  v_add_f32 v117, v117, v118
  v_cmp_lt_f32 vcc, 0x42700000, v116
  v_cmp_gt_f32 s[30:31], s28, v117
  v_rcp_f32 v117, v117
  s_or_b64 vcc, vcc, s[30:31]
  s_cbranch_vccnz o_fb_155
o_fbr_156:
  v_pk_mul_f32 v[56:57], v[56:57], v[116:117] op_sel:[0,1] op_sel_hi:[1,1]
  v_pk_mul_f32 v[58:59], v[58:59], v[116:117] op_sel:[0,1] op_sel_hi:[1,1]
  v_pk_mul_f32 v[60:61], v[60:61], v[116:117] op_sel:[0,1] op_sel_hi:[1,1]
  v_pk_mul_f32 v[62:63], v[62:63], v[116:117] op_sel:[0,1] op_sel_hi:[1,1]
  v_pk_mul_f32 v[64:65], v[64:65], v[116:117] op_sel:[0,1] op_sel_hi:[1,1]
  v_cvt_pk_bf16_f32 v116, v56, v57
  v_cvt_pk_bf16_f32 v117, v58, v59
  v_cvt_pk_bf16_f32 v118, v60, v61
  v_cvt_pk_bf16_f32 v119, v62, v63
  s_waitcnt lgkmcnt(0)
  s_nop 0
  v_mfma_f32_16x16x32_bf16 v[72:75], v[152:155], v[116:119], 0
  s_add_u32 s62, s62, 1
  v_cvt_pk_bf16_f32 v197, v64, v65
  v_cvt_pk_bf16_f32 v198, v64, v65
  v_mfma_f32_16x16x32_bf16 v[76:79], v[156:159], v[116:119], 0
  s_xor_b32 s86, s86, 524288
  v_mfma_f32_16x16x32_bf16 v[80:83], v[160:163], v[116:119], 0
  s_bfe_u32 s42, s62, 0x10001
  v_mfma_f32_16x16x32_bf16 v[84:87], v[164:167], v[116:119], 0
  s_bfe_u32 s26, s64, 65556
  v_mfma_f32_16x16x32_bf16 v[88:91], v[168:171], v[116:119], 0
  s_and_b32 s87, s64, 0xff
  v_mfma_f32_16x16x32_bf16 v[92:95], v[172:175], v[116:119], 0
  s_bfe_u32 s88, s64, 0x80008
  v_mfma_f32_16x16x32_bf16 v[96:99], v[176:179], v[116:119], 0
  s_nop 0
  v_mfma_f32_16x16x32_bf16 v[100:103], v[180:183], v[116:119], 0
  s_nop 0
  v_mfma_f32_16x16x16_bf16 v[72:75], v[200:201], v[198:199], v[72:75]
  s_nop 1
  v_mfma_f32_16x16x16_bf16 v[76:79], v[200:201], v[196:197], v[76:79]
  s_nop 1
  v_mfma_f32_16x16x16_bf16 v[80:83], v[202:203], v[198:199], v[80:83]
  s_nop 1
  v_mfma_f32_16x16x16_bf16 v[84:87], v[202:203], v[196:197], v[84:87]
  s_nop 1
  v_mfma_f32_16x16x16_bf16 v[88:91], v[204:205], v[198:199], v[88:91]
  s_nop 0
  v_cvt_pk_bf16_f32 v40, v72, v73
  v_cvt_pk_bf16_f32 v41, v74, v75
  v_mfma_f32_16x16x16_bf16 v[92:95], v[204:205], v[196:197], v[92:95]
  s_nop 0
  v_cvt_pk_bf16_f32 v42, v76, v77
  v_cvt_pk_bf16_f32 v43, v78, v79
  v_mfma_f32_16x16x16_bf16 v[96:99], v[206:207], v[198:199], v[96:99]
  s_nop 0
  ds_write_b128 v6, v[40:43] offset:0
  v_cvt_pk_bf16_f32 v44, v80, v81
  v_mfma_f32_16x16x16_bf16 v[100:103], v[206:207], v[196:197], v[100:103]
  s_nop 0
  v_cvt_pk_bf16_f32 v45, v82, v83
  v_cvt_pk_bf16_f32 v46, v84, v85
  v_cvt_pk_bf16_f32 v47, v86, v87
  ds_write_b128 v6, v[44:47] offset:1024
  v_cvt_pk_bf16_f32 v48, v88, v89
  v_cvt_pk_bf16_f32 v49, v90, v91
  v_cvt_pk_bf16_f32 v50, v92, v93
  v_cvt_pk_bf16_f32 v51, v94, v95
  ds_write_b128 v6, v[48:51] offset:2048
  v_cvt_pk_bf16_f32 v52, v96, v97
  v_cvt_pk_bf16_f32 v53, v98, v99
  v_cvt_pk_bf16_f32 v54, v100, v101
  v_cvt_pk_bf16_f32 v55, v102, v103
  ds_write_b128 v6, v[52:55] offset:3072
  s_cmp_lt_u32 s17, 2
  s_cbranch_scc1 o_wr0_150
  s_waitcnt lgkmcnt(0)
  s_barrier
  ds_read_b128 v[104:107], v3 offset:0
  ds_read_b128 v[108:111], v3 offset:512
  ds_read_b128 v[112:115], v3 offset:1024
  s_waitcnt lgkmcnt(2)
  v_mfma_f32_32x32x16_bf16 v[40:55], v[104:107], a[0:3], 0
  s_waitcnt vmcnt(0)
  v_cmp_eq_u32 vcc, 0, v37
  s_cmp_eq_u64 vcc, 0
  s_cselect_b32 s66, s26, 0
  s_cmp_eq_u32 s66, 1
  s_cselect_b32 s87, s87, 1024
  s_cselect_b32 s34, 0, 0x28000
  v_mfma_f32_32x32x16_bf16 v[56:71], v[104:107], a[4:7], 0
  ds_read_b128 v[116:119], v3 offset:1536
  s_lshl_b32 s33, s87, 18
  s_lshl_b32 s32, s87, 19
  s_add_u32 m0, s22, s34
  s_add_u32 s33, s33, s19
  s_min_u32 s28, s49, 67
  v_mfma_f32_32x32x16_bf16 v[72:87], v[104:107], a[8:11], 0
  s_lshl1_add_u32 s28, s17, s28
  s_lshl_b32 s28, s28, 12
  s_add_u32 s28, s28, 243486720
  v_mfma_f32_32x32x16_bf16 v[88:103], v[104:107], a[12:15], 0
  buffer_load_dword v249, v246, s[4:7], s28 offen sc1
  s_waitcnt lgkmcnt(2)
  v_mfma_f32_32x32x16_bf16 v[40:55], v[108:111], a[16:19], v[40:55]
  buffer_load_dwordx4 v0, s[4:7], s33 offen offset:0 sc1 lds
  v_mfma_f32_32x32x16_bf16 v[56:71], v[108:111], a[20:23], v[56:71]
  ds_read_b128 v[104:107], v3 offset:2048
  v_mfma_f32_32x32x16_bf16 v[72:87], v[108:111], a[24:27], v[72:87]
  buffer_load_dwordx4 v0, s[4:7], s33 offen offset:1024 sc1 lds
  v_mfma_f32_32x32x16_bf16 v[88:103], v[108:111], a[28:31], v[88:103]
  buffer_load_dwordx4 v0, s[4:7], s33 offen offset:2048 sc1 lds
  s_waitcnt lgkmcnt(2)
  v_mfma_f32_32x32x16_bf16 v[40:55], v[112:115], a[32:35], v[40:55]
  v_mfma_f32_32x32x16_bf16 v[56:71], v[112:115], a[36:39], v[56:71]
  ds_read_b128 v[108:111], v3 offset:2560
  buffer_load_dwordx4 v0, s[4:7], s33 offen offset:3072 sc1 lds
  s_sub_u32 m0, m0, 8192
  s_sub_u32 s33, s33, 8192
  v_mfma_f32_32x32x16_bf16 v[72:87], v[112:115], a[40:43], v[72:87]
  buffer_load_dwordx4 v0, s[4:7], s33 offen offset:0 sc1 lds
  v_mfma_f32_32x32x16_bf16 v[88:103], v[112:115], a[44:47], v[88:103]
  s_waitcnt lgkmcnt(2)
  v_mfma_f32_32x32x16_bf16 v[40:55], v[116:119], a[48:51], v[40:55]
  buffer_load_dwordx4 v0, s[4:7], s33 offen offset:1024 sc1 lds
  v_mfma_f32_32x32x16_bf16 v[56:71], v[116:119], a[52:55], v[56:71]
  ds_read_b128 v[112:115], v3 offset:3072
  buffer_load_dwordx4 v0, s[4:7], s33 offen offset:2048 sc1 lds
  v_mfma_f32_32x32x16_bf16 v[72:87], v[116:119], a[56:59], v[72:87]
  v_mfma_f32_32x32x16_bf16 v[88:103], v[116:119], a[60:63], v[88:103]
  buffer_load_dwordx4 v0, s[4:7], s33 offen offset:3072 sc1 lds
  s_add_u32 m0, s23, s34
  s_add_u32 s32, s32, s18
  s_waitcnt lgkmcnt(2)
  v_mfma_f32_32x32x16_bf16 v[40:55], v[104:107], a[64:67], v[40:55]
  buffer_load_dwordx4 v0, s[4:7], s32 offen offset:0 sc1 lds
  v_mfma_f32_32x32x16_bf16 v[56:71], v[104:107], a[68:71], v[56:71]
  ds_read_b128 v[116:119], v3 offset:3584
  v_mfma_f32_32x32x16_bf16 v[72:87], v[104:107], a[72:75], v[72:87]
  buffer_load_dwordx4 v0, s[4:7], s32 offen offset:1024 sc1 lds
  s_add_i32 m0, m0, 4096
  s_add_i32 s32, s32, 4096
  v_mfma_f32_32x32x16_bf16 v[88:103], v[104:107], a[76:79], v[88:103]
  buffer_load_dwordx4 v0, s[4:7], s32 offen offset:0 sc1 lds
  s_waitcnt lgkmcnt(2)
  v_mfma_f32_32x32x16_bf16 v[40:55], v[108:111], a[80:83], v[40:55]
  v_mfma_f32_32x32x16_bf16 v[56:71], v[108:111], a[84:87], v[56:71]
  ds_read_b128 v[104:107], v3 offset:8192
  buffer_load_dwordx4 v0, s[4:7], s32 offen offset:1024 sc1 lds
  s_add_i32 m0, m0, -16384
  s_add_i32 s32, s32, -16384
  v_mfma_f32_32x32x16_bf16 v[72:87], v[108:111], a[88:91], v[72:87]
  s_and_b32 s29, s64, 0xff00
  s_lshl_b32 s29, s29, 3
  s_add_u32 s29, s29, s15
  buffer_load_dword v245, v252, s[4:7], s29 offen sc1
  v_mfma_f32_32x32x16_bf16 v[88:103], v[108:111], a[92:95], v[88:103]
  s_waitcnt lgkmcnt(2)
  v_mfma_f32_32x32x16_bf16 v[40:55], v[112:115], a[96:99], v[40:55]
  buffer_load_dwordx4 v0, s[4:7], s32 offen offset:0 sc1 lds
  v_mfma_f32_32x32x16_bf16 v[56:71], v[112:115], a[100:103], v[56:71]
  ds_read_b128 v[108:111], v3 offset:8704
  buffer_load_dwordx4 v0, s[4:7], s32 offen offset:1024 sc1 lds
  s_add_i32 m0, m0, -4096
  s_add_i32 s32, s32, -4096
  v_mfma_f32_32x32x16_bf16 v[72:87], v[112:115], a[104:107], v[72:87]
  v_mfma_f32_32x32x16_bf16 v[88:103], v[112:115], a[108:111], v[88:103]
  buffer_load_dwordx4 v0, s[4:7], s32 offen offset:0 sc1 lds
  s_waitcnt lgkmcnt(2)
  v_mfma_f32_32x32x16_bf16 v[40:55], v[116:119], a[112:115], v[40:55]
  buffer_load_dwordx4 v0, s[4:7], s32 offen offset:1024 sc1 lds
  v_mfma_f32_32x32x16_bf16 v[56:71], v[116:119], a[116:119], v[56:71]
  ds_read_b128 v[112:115], v3 offset:9216
  v_mfma_f32_32x32x16_bf16 v[72:87], v[116:119], a[120:123], v[72:87]
  buffer_load_dwordx4 v0, s[4:7], s32 offen offset:2048 sc1 lds
  v_mfma_f32_32x32x16_bf16 v[88:103], v[116:119], a[124:127], v[88:103]
  buffer_load_dwordx4 v0, s[4:7], s32 offen offset:3072 sc1 lds
  s_add_i32 m0, m0, 4096
  s_add_i32 s32, s32, 4096
  s_waitcnt lgkmcnt(2)
  v_mfma_f32_32x32x16_bf16 v[40:55], v[104:107], a[128:131], v[40:55]
  v_mfma_f32_32x32x16_bf16 v[56:71], v[104:107], a[132:135], v[56:71]
  ds_read_b128 v[116:119], v3 offset:9728
  buffer_load_dwordx4 v0, s[4:7], s32 offen offset:2048 sc1 lds
  v_mfma_f32_32x32x16_bf16 v[72:87], v[104:107], a[136:139], v[72:87]
  buffer_load_dwordx4 v0, s[4:7], s32 offen offset:3072 sc1 lds
  s_add_i32 m0, m0, 16384
  s_add_i32 s32, s32, 16384
  v_mfma_f32_32x32x16_bf16 v[88:103], v[104:107], a[140:143], v[88:103]
  s_waitcnt lgkmcnt(2)
  v_mfma_f32_32x32x16_bf16 v[40:55], v[108:111], a[144:147], v[40:55]
  buffer_load_dwordx4 v0, s[4:7], s32 offen offset:2048 sc1 lds
  v_mfma_f32_32x32x16_bf16 v[56:71], v[108:111], a[148:151], v[56:71]
  ds_read_b128 v[104:107], v3 offset:10240
  buffer_load_dwordx4 v0, s[4:7], s32 offen offset:3072 sc1 lds
  s_add_i32 m0, m0, -4096
  s_add_i32 s32, s32, -4096
  v_mfma_f32_32x32x16_bf16 v[72:87], v[108:111], a[152:155], v[72:87]
  v_mfma_f32_32x32x16_bf16 v[88:103], v[108:111], a[156:159], v[88:103]
  buffer_load_dwordx4 v0, s[4:7], s32 offen offset:2048 sc1 lds
  s_waitcnt lgkmcnt(2)
  v_mfma_f32_32x32x16_bf16 v[40:55], v[112:115], a[160:163], v[40:55]
  buffer_load_dwordx4 v0, s[4:7], s32 offen offset:3072 sc1 lds
  v_mfma_f32_32x32x16_bf16 v[56:71], v[112:115], a[164:167], v[56:71]
  ds_read_b128 v[108:111], v3 offset:10752
  v_mfma_f32_32x32x16_bf16 v[72:87], v[112:115], a[168:171], v[72:87]
  v_mfma_f32_32x32x16_bf16 v[88:103], v[112:115], a[172:175], v[88:103]
  s_waitcnt lgkmcnt(2)
  v_mfma_f32_32x32x16_bf16 v[40:55], v[116:119], a[176:179], v[40:55]
  v_mfma_f32_32x32x16_bf16 v[56:71], v[116:119], a[180:183], v[56:71]
  ds_read_b128 v[112:115], v3 offset:11264
  v_mfma_f32_32x32x16_bf16 v[72:87], v[116:119], a[184:187], v[72:87]
  v_mfma_f32_32x32x16_bf16 v[88:103], v[116:119], a[188:191], v[88:103]
  s_waitcnt lgkmcnt(2)
  v_mfma_f32_32x32x16_bf16 v[40:55], v[104:107], a[192:195], v[40:55]
  v_mfma_f32_32x32x16_bf16 v[56:71], v[104:107], a[196:199], v[56:71]
  ds_read_b128 v[116:119], v3 offset:11776
  s_waitcnt vmcnt(12)
  v_cmp_eq_u32 vcc, 0, v245
  s_cmp_eq_u64 vcc, 0
  s_cselect_b32 s76, s26, 0
  s_and_b32 s76, s76, 1
  s_cselect_b32 s88, s88, 1024
  s_waitcnt lgkmcnt(2)
  v_mfma_f32_32x32x16_bf16 v[40:55], v[108:111], a[208:211], v[40:55]
  s_lshl_b32 s32, s88, 18
  s_mov_b32 m0, s40
  s_add_u32 s32, s32, s21
  buffer_load_dwordx4 v0, s[4:7], s32 offen offset:0 sc1 lds
  v_mfma_f32_32x32x16_bf16 v[56:71], v[108:111], a[212:215], v[56:71]
  buffer_load_dwordx4 v0, s[4:7], s32 offen offset:1024 sc1 lds
  s_waitcnt lgkmcnt(1)
  v_mfma_f32_32x32x16_bf16 v[40:55], v[112:115], a[224:227], v[40:55]
  buffer_load_dwordx4 v0, s[4:7], s32 offen offset:2048 sc1 lds
  s_sub_u32 m0, m0, 8192
  s_sub_u32 s32, s32, 8192
  v_mfma_f32_32x32x16_bf16 v[56:71], v[112:115], a[228:231], v[56:71]
  buffer_load_dwordx4 v0, s[4:7], s32 offen offset:0 sc1 lds
  s_waitcnt lgkmcnt(0)
  v_mfma_f32_32x32x16_bf16 v[40:55], v[116:119], a[240:243], v[40:55]
  buffer_load_dwordx4 v0, s[4:7], s32 offen offset:1024 sc1 lds
  v_mfma_f32_32x32x16_bf16 v[56:71], v[116:119], a[244:247], v[56:71]
  buffer_load_dwordx4 v0, s[4:7], s32 offen offset:2048 sc1 lds
  v_cmp_eq_u32 vcc, 0, v249
  v_max_u32_dpp v249, v249, v249 row_ror:8 row_mask:0xf bank_mask:0xf
  s_nop 0
  v_mfma_f32_32x32x16_bf16 v[72:87], v[104:107], a[200:203], v[72:87]
  v_max_u32_dpp v249, v249, v249 row_ror:4 row_mask:0xf bank_mask:0xf
  s_nop 0
  s_nop 0
  v_max_u32_dpp v249, v249, v249 row_ror:2 row_mask:0xf bank_mask:0xf
  s_nop 0
  s_nop 0
  v_max_u32_dpp v249, v249, v249 row_ror:1 row_mask:0xf bank_mask:0xf
  s_nop 0
  v_mfma_f32_32x32x16_bf16 v[88:103], v[104:107], a[204:207], v[88:103]
  v_mov_b32 v248, v249
  s_nop 0
  s_nop 0
  v_permlane16_swap_b32 v249, v248
  v_max_u32 v249, v249, v248
  v_mfma_f32_32x32x16_bf16 v[72:87], v[108:111], a[216:219], v[72:87]
  v_mov_b32 v248, v249
  s_nop 0
  s_nop 0
  v_permlane32_swap_b32 v249, v248
  v_max_u32 v249, v249, v248
  s_cmp_eq_u64 vcc, 0
  s_cselect_b32 s28, 4, 0
  v_mfma_f32_32x32x16_bf16 v[88:103], v[108:111], a[220:223], v[88:103]
  s_lshl_b32 s26, s76, 1
  s_or_b32 s26, s26, s66
  s_or_b32 s26, s26, s28
  v_mov_b32 v248, s26
  ds_write_b64 v39, v[248:249]
  v_mfma_f32_32x32x16_bf16 v[72:87], v[112:115], a[232:235], v[72:87]
  v_cvt_pk_bf16_f32 v212, v40, v56
  v_cvt_pk_bf16_f32 v214, v41, v57
  v_cvt_pk_bf16_f32 v216, v42, v58
  v_cvt_pk_bf16_f32 v218, v43, v59
  v_permlane16_swap_b32 v212, v214
  v_mfma_f32_32x32x16_bf16 v[88:103], v[112:115], a[236:239], v[88:103]
  v_cvt_pk_bf16_f32 v220, v44, v60
  v_cvt_pk_bf16_f32 v222, v45, v61
  v_permlane16_swap_b32 v216, v218
  v_bfi_b32 v212, v254, s42, v212
  v_mfma_f32_32x32x16_bf16 v[72:87], v[116:119], a[248:251], v[72:87]
  v_cvt_pk_bf16_f32 v224, v46, v62
  v_cvt_pk_bf16_f32 v226, v47, v63
  v_permlane16_swap_b32 v220, v222
  v_bfi_b32 v216, v254, s42, v216
  v_cvt_pk_bf16_f32 v228, v48, v64
  v_mfma_f32_32x32x16_bf16 v[88:103], v[116:119], a[252:255], v[88:103]
  v_cvt_pk_bf16_f32 v230, v49, v65
  v_permlane16_swap_b32 v224, v226
  v_bfi_b32 v220, v254, s42, v220
  v_cvt_pk_bf16_f32 v232, v50, v66
  v_cvt_pk_bf16_f32 v234, v51, v67
  v_permlane16_swap_b32 v228, v230
  v_bfi_b32 v224, v254, s42, v224
  v_cvt_pk_bf16_f32 v236, v52, v68
  v_cvt_pk_bf16_f32 v238, v53, v69
  v_permlane16_swap_b32 v232, v234
  v_bfi_b32 v228, v254, s42, v228
  v_cvt_pk_bf16_f32 v240, v54, v70
  v_cvt_pk_bf16_f32 v242, v55, v71
  v_permlane16_swap_b32 v236, v238
  v_bfi_b32 v232, v254, s42, v232
  v_permlane16_swap_b32 v240, v242
  v_bfi_b32 v236, v254, s42, v236
  v_bfi_b32 v240, v254, s42, v240
  v_cvt_pk_bf16_f32 v213, v72, v88
  v_cvt_pk_bf16_f32 v215, v73, v89
  v_cvt_pk_bf16_f32 v217, v74, v90
  v_cvt_pk_bf16_f32 v219, v75, v91
  s_add_u32 s78, s86, 0
  v_permlane16_swap_b32 v213, v215
  buffer_store_dwordx4 v[212:215], v4, s[4:7], s78 offen
  v_cvt_pk_bf16_f32 v221, v76, v92
  v_cvt_pk_bf16_f32 v223, v77, v93
  s_add_u32 s78, s86, 32768
  v_permlane16_swap_b32 v217, v219
  buffer_store_dwordx4 v[216:219], v4, s[4:7], s78 offen
  v_cvt_pk_bf16_f32 v225, v78, v94
  v_cvt_pk_bf16_f32 v227, v79, v95
  s_add_u32 s78, s86, 131072
  v_permlane16_swap_b32 v221, v223
  buffer_store_dwordx4 v[220:223], v4, s[4:7], s78 offen
  v_cvt_pk_bf16_f32 v229, v80, v96
  v_cvt_pk_bf16_f32 v231, v81, v97
  s_add_u32 s78, s86, 163840
  v_permlane16_swap_b32 v225, v227
  buffer_store_dwordx4 v[224:227], v4, s[4:7], s78 offen
  v_cvt_pk_bf16_f32 v233, v82, v98
  v_cvt_pk_bf16_f32 v235, v83, v99
  s_add_u32 s78, s86, 262144
  v_permlane16_swap_b32 v229, v231
  buffer_store_dwordx4 v[228:231], v4, s[4:7], s78 offen
  v_cvt_pk_bf16_f32 v237, v84, v100
  v_cvt_pk_bf16_f32 v239, v85, v101
  s_add_u32 s78, s86, 294912
  v_permlane16_swap_b32 v233, v235
  buffer_store_dwordx4 v[232:235], v4, s[4:7], s78 offen
  v_cvt_pk_bf16_f32 v241, v86, v102
  v_cvt_pk_bf16_f32 v243, v87, v103
  s_add_u32 s78, s86, 393216
  v_permlane16_swap_b32 v237, v239
  buffer_store_dwordx4 v[236:239], v4, s[4:7], s78 offen
  s_add_u32 s78, s86, 425984
  v_permlane16_swap_b32 v241, v243
  buffer_store_dwordx4 v[240:243], v4, s[4:7], s78 offen
  s_waitcnt vmcnt(22)
  s_branch o_we_153
o_wr0_150:
  s_waitcnt lgkmcnt(0)
  s_barrier
  ds_read_b128 v[104:107], v3 offset:0
  ds_read_b128 v[108:111], v3 offset:512
  ds_read_b128 v[112:115], v3 offset:1024
  s_waitcnt lgkmcnt(2)
  v_mfma_f32_32x32x16_bf16 v[40:55], v[104:107], a[0:3], 0
  v_mfma_f32_32x32x16_bf16 v[56:71], v[104:107], a[4:7], 0
  ds_read_b128 v[116:119], v3 offset:1536
  v_mfma_f32_32x32x16_bf16 v[72:87], v[104:107], a[8:11], 0
  v_mfma_f32_32x32x16_bf16 v[88:103], v[104:107], a[12:15], 0
  s_waitcnt lgkmcnt(2)
  v_mfma_f32_32x32x16_bf16 v[40:55], v[108:111], a[16:19], v[40:55]
  v_mfma_f32_32x32x16_bf16 v[56:71], v[108:111], a[20:23], v[56:71]
  ds_read_b128 v[104:107], v3 offset:2048
  v_mfma_f32_32x32x16_bf16 v[72:87], v[108:111], a[24:27], v[72:87]
  v_mfma_f32_32x32x16_bf16 v[88:103], v[108:111], a[28:31], v[88:103]
  s_waitcnt lgkmcnt(2)
  v_mfma_f32_32x32x16_bf16 v[40:55], v[112:115], a[32:35], v[40:55]
  v_mfma_f32_32x32x16_bf16 v[56:71], v[112:115], a[36:39], v[56:71]
  ds_read_b128 v[108:111], v3 offset:2560
  v_mfma_f32_32x32x16_bf16 v[72:87], v[112:115], a[40:43], v[72:87]
  v_mfma_f32_32x32x16_bf16 v[88:103], v[112:115], a[44:47], v[88:103]
  s_waitcnt lgkmcnt(2)
  v_mfma_f32_32x32x16_bf16 v[40:55], v[116:119], a[48:51], v[40:55]
  v_mfma_f32_32x32x16_bf16 v[56:71], v[116:119], a[52:55], v[56:71]
  ds_read_b128 v[112:115], v3 offset:3072
  v_mfma_f32_32x32x16_bf16 v[72:87], v[116:119], a[56:59], v[72:87]
  v_mfma_f32_32x32x16_bf16 v[88:103], v[116:119], a[60:63], v[88:103]
  s_waitcnt lgkmcnt(2)
  v_mfma_f32_32x32x16_bf16 v[40:55], v[104:107], a[64:67], v[40:55]
  v_mfma_f32_32x32x16_bf16 v[56:71], v[104:107], a[68:71], v[56:71]
  ds_read_b128 v[116:119], v3 offset:3584
  v_mfma_f32_32x32x16_bf16 v[72:87], v[104:107], a[72:75], v[72:87]
  v_mfma_f32_32x32x16_bf16 v[88:103], v[104:107], a[76:79], v[88:103]
  s_waitcnt lgkmcnt(2)
  v_mfma_f32_32x32x16_bf16 v[40:55], v[108:111], a[80:83], v[40:55]
  v_mfma_f32_32x32x16_bf16 v[56:71], v[108:111], a[84:87], v[56:71]
  ds_read_b128 v[104:107], v3 offset:8192
  v_mfma_f32_32x32x16_bf16 v[72:87], v[108:111], a[88:91], v[72:87]
  v_mfma_f32_32x32x16_bf16 v[88:103], v[108:111], a[92:95], v[88:103]
  s_waitcnt lgkmcnt(2)
  v_mfma_f32_32x32x16_bf16 v[40:55], v[112:115], a[96:99], v[40:55]
  v_mfma_f32_32x32x16_bf16 v[56:71], v[112:115], a[100:103], v[56:71]
  ds_read_b128 v[108:111], v3 offset:8704
  v_mfma_f32_32x32x16_bf16 v[72:87], v[112:115], a[104:107], v[72:87]
  v_mfma_f32_32x32x16_bf16 v[88:103], v[112:115], a[108:111], v[88:103]
  s_waitcnt lgkmcnt(2)
  v_mfma_f32_32x32x16_bf16 v[40:55], v[116:119], a[112:115], v[40:55]
  v_mfma_f32_32x32x16_bf16 v[56:71], v[116:119], a[116:119], v[56:71]
  ds_read_b128 v[112:115], v3 offset:9216
  v_mfma_f32_32x32x16_bf16 v[72:87], v[116:119], a[120:123], v[72:87]
  v_mfma_f32_32x32x16_bf16 v[88:103], v[116:119], a[124:127], v[88:103]
  s_waitcnt lgkmcnt(2)
  v_mfma_f32_32x32x16_bf16 v[40:55], v[104:107], a[128:131], v[40:55]
  v_mfma_f32_32x32x16_bf16 v[56:71], v[104:107], a[132:135], v[56:71]
  ds_read_b128 v[116:119], v3 offset:9728
  v_mfma_f32_32x32x16_bf16 v[72:87], v[104:107], a[136:139], v[72:87]
  v_mfma_f32_32x32x16_bf16 v[88:103], v[104:107], a[140:143], v[88:103]
  s_waitcnt lgkmcnt(2)
  v_mfma_f32_32x32x16_bf16 v[40:55], v[108:111], a[144:147], v[40:55]
  v_mfma_f32_32x32x16_bf16 v[56:71], v[108:111], a[148:151], v[56:71]
  ds_read_b128 v[104:107], v3 offset:10240
  v_mfma_f32_32x32x16_bf16 v[72:87], v[108:111], a[152:155], v[72:87]
  v_mfma_f32_32x32x16_bf16 v[88:103], v[108:111], a[156:159], v[88:103]
  s_waitcnt lgkmcnt(2)
  v_mfma_f32_32x32x16_bf16 v[40:55], v[112:115], a[160:163], v[40:55]
  v_mfma_f32_32x32x16_bf16 v[56:71], v[112:115], a[164:167], v[56:71]
  ds_read_b128 v[108:111], v3 offset:10752
  v_mfma_f32_32x32x16_bf16 v[72:87], v[112:115], a[168:171], v[72:87]
  v_mfma_f32_32x32x16_bf16 v[88:103], v[112:115], a[172:175], v[88:103]
  s_waitcnt lgkmcnt(2)
  v_mfma_f32_32x32x16_bf16 v[40:55], v[116:119], a[176:179], v[40:55]
  v_mfma_f32_32x32x16_bf16 v[56:71], v[116:119], a[180:183], v[56:71]
  ds_read_b128 v[112:115], v3 offset:11264
  v_mfma_f32_32x32x16_bf16 v[72:87], v[116:119], a[184:187], v[72:87]
  v_mfma_f32_32x32x16_bf16 v[88:103], v[116:119], a[188:191], v[88:103]
  s_waitcnt lgkmcnt(2)
  v_mfma_f32_32x32x16_bf16 v[40:55], v[104:107], a[192:195], v[40:55]
  v_mfma_f32_32x32x16_bf16 v[56:71], v[104:107], a[196:199], v[56:71]
  ds_read_b128 v[116:119], v3 offset:11776
  s_waitcnt lgkmcnt(2)
  v_mfma_f32_32x32x16_bf16 v[40:55], v[108:111], a[208:211], v[40:55]
  v_mfma_f32_32x32x16_bf16 v[56:71], v[108:111], a[212:215], v[56:71]
  s_waitcnt lgkmcnt(1)
  v_mfma_f32_32x32x16_bf16 v[40:55], v[112:115], a[224:227], v[40:55]
  v_mfma_f32_32x32x16_bf16 v[56:71], v[112:115], a[228:231], v[56:71]
  s_waitcnt lgkmcnt(0)
  v_mfma_f32_32x32x16_bf16 v[40:55], v[116:119], a[240:243], v[40:55]
  v_mfma_f32_32x32x16_bf16 v[56:71], v[116:119], a[244:247], v[56:71]
  v_mfma_f32_32x32x16_bf16 v[72:87], v[104:107], a[200:203], v[72:87]
  v_mfma_f32_32x32x16_bf16 v[88:103], v[104:107], a[204:207], v[88:103]
  v_cvt_pk_bf16_f32 v212, v40, v56
  v_cvt_pk_bf16_f32 v214, v41, v57
  v_cvt_pk_bf16_f32 v216, v42, v58
  v_cvt_pk_bf16_f32 v218, v43, v59
  v_permlane16_swap_b32 v212, v214
  v_mfma_f32_32x32x16_bf16 v[72:87], v[108:111], a[216:219], v[72:87]
  v_cvt_pk_bf16_f32 v220, v44, v60
  v_cvt_pk_bf16_f32 v222, v45, v61
  v_permlane16_swap_b32 v216, v218
  v_bfi_b32 v212, v254, s42, v212
  v_cvt_pk_bf16_f32 v224, v46, v62
  v_mfma_f32_32x32x16_bf16 v[88:103], v[108:111], a[220:223], v[88:103]
  v_cvt_pk_bf16_f32 v226, v47, v63
  v_permlane16_swap_b32 v220, v222
  v_bfi_b32 v216, v254, s42, v216
  v_cvt_pk_bf16_f32 v228, v48, v64
  v_mfma_f32_32x32x16_bf16 v[72:87], v[112:115], a[232:235], v[72:87]
  v_cvt_pk_bf16_f32 v230, v49, v65
  v_permlane16_swap_b32 v224, v226
  v_bfi_b32 v220, v254, s42, v220
  v_cvt_pk_bf16_f32 v232, v50, v66
  v_cvt_pk_bf16_f32 v234, v51, v67
  v_mfma_f32_32x32x16_bf16 v[88:103], v[112:115], a[236:239], v[88:103]
  v_permlane16_swap_b32 v228, v230
  v_bfi_b32 v224, v254, s42, v224
  v_cvt_pk_bf16_f32 v236, v52, v68
  v_cvt_pk_bf16_f32 v238, v53, v69
  v_mfma_f32_32x32x16_bf16 v[72:87], v[116:119], a[248:251], v[72:87]
  v_permlane16_swap_b32 v232, v234
  v_bfi_b32 v228, v254, s42, v228
  v_cvt_pk_bf16_f32 v240, v54, v70
  v_cvt_pk_bf16_f32 v242, v55, v71
  v_permlane16_swap_b32 v236, v238
  v_mfma_f32_32x32x16_bf16 v[88:103], v[116:119], a[252:255], v[88:103]
  v_bfi_b32 v232, v254, s42, v232
  v_permlane16_swap_b32 v240, v242
  v_bfi_b32 v236, v254, s42, v236
  v_bfi_b32 v240, v254, s42, v240
  s_nop 7
  v_cvt_pk_bf16_f32 v213, v72, v88
  v_cvt_pk_bf16_f32 v215, v73, v89
  v_cvt_pk_bf16_f32 v217, v74, v90
  v_cvt_pk_bf16_f32 v219, v75, v91
  s_add_u32 s78, s86, 0
  v_permlane16_swap_b32 v213, v215
  buffer_store_dwordx4 v[212:215], v4, s[4:7], s78 offen
  v_cvt_pk_bf16_f32 v221, v76, v92
  v_cvt_pk_bf16_f32 v223, v77, v93
  s_add_u32 s78, s86, 32768
  v_permlane16_swap_b32 v217, v219
  buffer_store_dwordx4 v[216:219], v4, s[4:7], s78 offen
  v_cvt_pk_bf16_f32 v225, v78, v94
  v_cvt_pk_bf16_f32 v227, v79, v95
  s_add_u32 s78, s86, 131072
  v_permlane16_swap_b32 v221, v223
  buffer_store_dwordx4 v[220:223], v4, s[4:7], s78 offen
  v_cvt_pk_bf16_f32 v229, v80, v96
  v_cvt_pk_bf16_f32 v231, v81, v97
  s_add_u32 s78, s86, 163840
  v_permlane16_swap_b32 v225, v227
  buffer_store_dwordx4 v[224:227], v4, s[4:7], s78 offen
  v_cvt_pk_bf16_f32 v233, v82, v98
  v_cvt_pk_bf16_f32 v235, v83, v99
  s_add_u32 s78, s86, 262144
  v_permlane16_swap_b32 v229, v231
  buffer_store_dwordx4 v[228:231], v4, s[4:7], s78 offen
  v_cvt_pk_bf16_f32 v237, v84, v100
  v_cvt_pk_bf16_f32 v239, v85, v101
  s_add_u32 s78, s86, 294912
  v_permlane16_swap_b32 v233, v235
  buffer_store_dwordx4 v[232:235], v4, s[4:7], s78 offen
  v_cvt_pk_bf16_f32 v241, v86, v102
  v_cvt_pk_bf16_f32 v243, v87, v103
  s_add_u32 s78, s86, 393216
  v_permlane16_swap_b32 v237, v239
  buffer_store_dwordx4 v[236:239], v4, s[4:7], s78 offen
  s_add_u32 s78, s86, 425984
  v_permlane16_swap_b32 v241, v243
  buffer_store_dwordx4 v[240:243], v4, s[4:7], s78 offen
  s_branch o_we_153
o_wr1_151:
  s_nop 3
  v_mul_f32 v112, s24, v112
  v_mul_f32 v113, s24, v113
  v_exp_f32 v64, v112
  v_exp_f32 v65, v113
  v_max_f32 v116, v111, v116
  v_max3_f32 v116, v112, v113, v116
  v_add_f32 v117, v117, v64
  v_add_f32 v118, v118, v65
  v_add_f32 v117, v117, v118
  s_mov_b32 s28, 0x21800000
  v_mov_b32 v118, v117
  s_nop 1
  v_permlane16_swap_b32 v117, v118
  v_add_f32 v117, v117, v118
  v_mov_b32 v118, v117
  s_nop 0
  s_nop 0
  v_permlane32_swap_b32 v117, v118
  v_add_f32 v117, v117, v118
  s_mov_b32 s67, 0
  s_mov_b64 vcc, 0
  s_waitcnt vmcnt(3)
o_pl_159:
  v_and_b32 v7, 1, v7
  v_cmp_ne_u32 vcc, s96, v7
  s_cbranch_vccz o_pk_160
  buffer_load_dword v7, v255, s[4:7], s97 offen sc1
  s_add_u32 s67, s67, 1
  s_cmp_gt_u32 s67, 1048576
  s_cbranch_scc1 L_end
  s_waitcnt vmcnt(0)
  s_branch o_pl_159
o_pk_160:
  s_lshl_b32 s94, s43, 14
  s_add_u32 s94, s94, s95
  buffer_load_dwordx4 v[120:123], v5, s[4:7], s94 offen offset:0 sc1
  v_cmp_lt_f32 vcc, 0x42700000, v116
  v_cmp_gt_f32 s[30:31], s28, v117
  v_rcp_f32 v117, v117
  buffer_load_dwordx4 v[124:127], v5, s[4:7], s94 offen offset:512 sc1
  s_or_b64 vcc, vcc, s[30:31]
  s_cbranch_vccnz o_fb_157
o_fbr_158:
  buffer_load_dwordx4 v[128:131], v5, s[4:7], s94 offen offset:256 sc1
  v_pk_mul_f32 v[56:57], v[56:57], v[116:117] op_sel:[0,1] op_sel_hi:[1,1]
  v_pk_mul_f32 v[58:59], v[58:59], v[116:117] op_sel:[0,1] op_sel_hi:[1,1]
  v_pk_mul_f32 v[60:61], v[60:61], v[116:117] op_sel:[0,1] op_sel_hi:[1,1]
  v_pk_mul_f32 v[62:63], v[62:63], v[116:117] op_sel:[0,1] op_sel_hi:[1,1]
  v_pk_mul_f32 v[64:65], v[64:65], v[116:117] op_sel:[0,1] op_sel_hi:[1,1]
  buffer_load_dwordx4 v[132:135], v5, s[4:7], s94 offen offset:768 sc1
  v_cvt_pk_bf16_f32 v116, v56, v57
  v_cvt_pk_bf16_f32 v117, v58, v59
  v_cvt_pk_bf16_f32 v118, v60, v61
  v_cvt_pk_bf16_f32 v119, v62, v63
  s_waitcnt lgkmcnt(0)
  s_nop 0
  v_mfma_f32_16x16x32_bf16 v[72:75], v[152:155], v[116:119], 0
  s_add_u32 s62, s62, 1
  v_cvt_pk_bf16_f32 v197, v64, v65
  v_cvt_pk_bf16_f32 v198, v64, v65
  v_mfma_f32_16x16x32_bf16 v[76:79], v[156:159], v[116:119], 0
  s_add_u32 s94, s94, 4096
  buffer_load_dwordx4 v[136:139], v5, s[4:7], s94 offen offset:0 sc1
  s_xor_b32 s86, s86, 524288
  v_mfma_f32_16x16x32_bf16 v[80:83], v[160:163], v[116:119], 0
  s_bfe_u32 s42, s62, 0x10001
  v_mfma_f32_16x16x32_bf16 v[84:87], v[164:167], v[116:119], 0
  buffer_load_dwordx4 v[140:143], v5, s[4:7], s94 offen offset:512 sc1
  v_mfma_f32_16x16x32_bf16 v[88:91], v[168:171], v[116:119], 0
  v_mfma_f32_16x16x32_bf16 v[92:95], v[172:175], v[116:119], 0
  buffer_load_dwordx4 v[144:147], v5, s[4:7], s94 offen offset:256 sc1
  v_mfma_f32_16x16x32_bf16 v[96:99], v[176:179], v[116:119], 0
  v_mfma_f32_16x16x32_bf16 v[100:103], v[180:183], v[116:119], 0
  buffer_load_dwordx4 v[148:151], v5, s[4:7], s94 offen offset:768 sc1
  v_mfma_f32_16x16x16_bf16 v[72:75], v[200:201], v[198:199], v[72:75]
  s_nop 1
  v_mfma_f32_16x16x16_bf16 v[76:79], v[200:201], v[196:197], v[76:79]
  s_add_u32 s94, s94, 4096
  buffer_load_dwordx4 v[152:155], v5, s[4:7], s94 offen offset:0 sc1
  v_mfma_f32_16x16x16_bf16 v[80:83], v[202:203], v[198:199], v[80:83]
  s_nop 1
  v_mfma_f32_16x16x16_bf16 v[84:87], v[202:203], v[196:197], v[84:87]
  buffer_load_dwordx4 v[156:159], v5, s[4:7], s94 offen offset:512 sc1
  v_mfma_f32_16x16x16_bf16 v[88:91], v[204:205], v[198:199], v[88:91]
  s_nop 0
  v_cvt_pk_bf16_f32 v40, v72, v73
  v_cvt_pk_bf16_f32 v41, v74, v75
  v_mfma_f32_16x16x16_bf16 v[92:95], v[204:205], v[196:197], v[92:95]
  buffer_load_dwordx4 v[160:163], v5, s[4:7], s94 offen offset:256 sc1
  v_cvt_pk_bf16_f32 v42, v76, v77
  v_cvt_pk_bf16_f32 v43, v78, v79
  v_mfma_f32_16x16x16_bf16 v[96:99], v[206:207], v[198:199], v[96:99]
  s_nop 0
  ds_write_b128 v6, v[40:43] offset:0
  v_cvt_pk_bf16_f32 v44, v80, v81
  v_mfma_f32_16x16x16_bf16 v[100:103], v[206:207], v[196:197], v[100:103]
  buffer_load_dwordx4 v[164:167], v5, s[4:7], s94 offen offset:768 sc1
  v_cvt_pk_bf16_f32 v45, v82, v83
  v_cvt_pk_bf16_f32 v46, v84, v85
  v_cvt_pk_bf16_f32 v47, v86, v87
  ds_write_b128 v6, v[44:47] offset:1024
  v_cvt_pk_bf16_f32 v48, v88, v89
  v_cvt_pk_bf16_f32 v49, v90, v91
  v_cvt_pk_bf16_f32 v50, v92, v93
  v_cvt_pk_bf16_f32 v51, v94, v95
  s_add_u32 s94, s94, 4096
  buffer_load_dwordx4 v[168:171], v5, s[4:7], s94 offen offset:0 sc1
  ds_write_b128 v6, v[48:51] offset:2048
  v_cvt_pk_bf16_f32 v52, v96, v97
  v_cvt_pk_bf16_f32 v53, v98, v99
  v_cvt_pk_bf16_f32 v54, v100, v101
  v_cvt_pk_bf16_f32 v55, v102, v103
  ds_write_b128 v6, v[52:55] offset:3072
  buffer_load_dwordx4 v[172:175], v5, s[4:7], s94 offen offset:512 sc1
  s_and_b32 s26, s65, 49152
  s_cbranch_scc1 o_wr2_152
  s_waitcnt lgkmcnt(0)
  s_barrier
  ds_read_b128 v[104:107], v3 offset:0
  ds_read_b128 v[108:111], v3 offset:512
  ds_read_b128 v[112:115], v3 offset:1024
  buffer_load_dwordx4 v[176:179], v5, s[4:7], s94 offen offset:256 sc1
  buffer_load_dwordx4 v[180:183], v5, s[4:7], s94 offen offset:768 sc1
  s_waitcnt lgkmcnt(2)
  v_mfma_f32_32x32x16_bf16 v[40:55], v[104:107], a[0:3], 0
  v_mov_b64 v[188:189], 0
  v_mov_b64 v[190:191], 0
  v_mov_b64 v[192:193], 0
  v_mov_b64 v[194:195], 0
  s_mov_b64 exec, 1
  buffer_store_dword v38, off, s[4:7], s84 sc1
  s_mov_b64 exec, -1
  s_mov_b32 s84, 268435456
  v_mfma_f32_32x32x16_bf16 v[56:71], v[104:107], a[4:7], 0
  ds_read_b128 v[116:119], v3 offset:1536
  v_mfma_f32_32x32x16_bf16 v[72:87], v[104:107], a[8:11], 0
  v_mfma_f32_32x32x16_bf16 v[88:103], v[104:107], a[12:15], 0
  s_waitcnt vmcnt(13)
  v_xor_b32 v7, s96, v120
  v_bitop3_b32 v7, v7, v124, s96 bitop3:0xf6
  v_bitop3_b32 v7, v7, v128, s96 bitop3:0xf6
  v_bitop3_b32 v7, v7, v132, s96 bitop3:0xf6
  s_waitcnt lgkmcnt(2)
  v_mfma_f32_32x32x16_bf16 v[40:55], v[108:111], a[16:19], v[40:55]
  s_waitcnt vmcnt(9)
  v_bitop3_b32 v7, v7, v136, s96 bitop3:0xf6
  v_bitop3_b32 v7, v7, v140, s96 bitop3:0xf6
  v_bitop3_b32 v7, v7, v144, s96 bitop3:0xf6
  v_bitop3_b32 v7, v7, v148, s96 bitop3:0xf6
  s_waitcnt vmcnt(5)
  v_mfma_f32_32x32x16_bf16 v[56:71], v[108:111], a[20:23], v[56:71]
  ds_read_b128 v[104:107], v3 offset:2048
  v_bitop3_b32 v7, v7, v152, s96 bitop3:0xf6
  v_bitop3_b32 v7, v7, v156, s96 bitop3:0xf6
  v_bitop3_b32 v7, v7, v160, s96 bitop3:0xf6
  v_bitop3_b32 v7, v7, v164, s96 bitop3:0xf6
  s_waitcnt vmcnt(1)
  v_mfma_f32_32x32x16_bf16 v[72:87], v[108:111], a[24:27], v[72:87]
  v_bitop3_b32 v7, v7, v168, s96 bitop3:0xf6
  v_bitop3_b32 v7, v7, v172, s96 bitop3:0xf6
  v_bitop3_b32 v7, v7, v176, s96 bitop3:0xf6
  v_bitop3_b32 v7, v7, v180, s96 bitop3:0xf6
  v_and_b32 v7, v254, v7
  v_cmp_ne_u32 vcc, 0, v7
  s_cbranch_vccnz o_rt_161
o_bk_162:
  v_mfma_f32_32x32x16_bf16 v[88:103], v[108:111], a[28:31], v[88:103]
  v_smfmac_f32_16x16x64_bf16 v[188:191], v[16:19], v[120:127], v20
  v_lshlrev_b32 v196, 16, v184
  v_smfmac_f32_16x16x64_bf16 v[192:195], v[16:19], v[128:135], v20
  v_and_b32 v197, 0xffff0000, v184
  v_smfmac_f32_16x16x64_bf16 v[188:191], v[16:19], v[136:143], v20
  v_lshlrev_b32 v198, 16, v185
  s_waitcnt lgkmcnt(2)
  v_mfma_f32_32x32x16_bf16 v[40:55], v[112:115], a[32:35], v[40:55]
  v_smfmac_f32_16x16x64_bf16 v[192:195], v[16:19], v[144:151], v20
  v_and_b32 v199, 0xffff0000, v185
  v_smfmac_f32_16x16x64_bf16 v[188:191], v[16:19], v[152:159], v20
  v_lshlrev_b32 v200, 16, v186
  v_smfmac_f32_16x16x64_bf16 v[192:195], v[16:19], v[160:167], v20
  v_and_b32 v201, 0xffff0000, v186
  v_mfma_f32_32x32x16_bf16 v[56:71], v[112:115], a[36:39], v[56:71]
  ds_read_b128 v[108:111], v3 offset:2560
  v_smfmac_f32_16x16x64_bf16 v[188:191], v[16:19], v[168:175], v20
  v_lshlrev_b32 v202, 16, v187
  v_smfmac_f32_16x16x64_bf16 v[192:195], v[16:19], v[176:183], v20
  v_and_b32 v203, 0xffff0000, v187
  s_bfe_u32 s92, s65, 131086
  v_mfma_f32_32x32x16_bf16 v[72:87], v[112:115], a[40:43], v[72:87]
  s_lshl_b32 s92, s92, 21
  s_add_u32 s92, s92, s91
  s_add_u32 s93, s92, 27262976
  s_add_u32 s92, s92, 20971520
  v_permlane16_swap_b32 v188, v192
  v_mfma_f32_32x32x16_bf16 v[88:103], v[112:115], a[44:47], v[88:103]
  v_permlane16_swap_b32 v189, v193
  v_permlane16_swap_b32 v190, v194
  v_permlane16_swap_b32 v191, v195
  s_waitcnt lgkmcnt(2)
  v_mfma_f32_32x32x16_bf16 v[40:55], v[116:119], a[48:51], v[40:55]
  v_cvt_pk_bf16_f32 v188, 0, v188
  v_cvt_pk_bf16_f32 v189, 0, v189
  v_cvt_pk_bf16_f32 v190, 0, v190
  v_cvt_pk_bf16_f32 v191, 0, v191
  v_cvt_pk_bf16_f32 v192, 0, v192
  v_cvt_pk_bf16_f32 v193, 0, v193
  v_mfma_f32_32x32x16_bf16 v[56:71], v[116:119], a[52:55], v[56:71]
  ds_read_b128 v[112:115], v3 offset:3072
  v_cvt_pk_bf16_f32 v194, 0, v194
  v_cvt_pk_bf16_f32 v195, 0, v195
  v_add_f32 v196, v196, v188
  v_add_f32 v197, v197, v189
  v_add_f32 v198, v198, v190
  v_mfma_f32_32x32x16_bf16 v[72:87], v[116:119], a[56:59], v[72:87]
  v_add_f32 v199, v199, v191
  v_add_f32 v200, v200, v192
  v_add_f32 v201, v201, v193
  v_add_f32 v202, v202, v194
  v_add_f32 v203, v203, v195
  v_cvt_pk_bf16_f32 v120, v196, v197
  v_mfma_f32_32x32x16_bf16 v[88:103], v[116:119], a[60:63], v[88:103]
  v_cvt_pk_bf16_f32 v121, v198, v199
  v_cvt_pk_bf16_f32 v122, v200, v201
  v_cvt_pk_bf16_f32 v123, v202, v203
  v_lshlrev_b32 v196, 16, v120
  v_and_b32 v197, 0xffff0000, v120
  s_waitcnt lgkmcnt(2)
  v_mfma_f32_32x32x16_bf16 v[40:55], v[104:107], a[64:67], v[40:55]
  v_lshlrev_b32 v198, 16, v121
  v_and_b32 v199, 0xffff0000, v121
  v_lshlrev_b32 v200, 16, v122
  v_and_b32 v201, 0xffff0000, v122
  v_lshlrev_b32 v202, 16, v123
  v_and_b32 v203, 0xffff0000, v123
  v_mfma_f32_32x32x16_bf16 v[56:71], v[104:107], a[68:71], v[56:71]
  ds_read_b128 v[116:119], v3 offset:3584
  buffer_store_dwordx4 v[120:123], v0, s[4:7], s92 offen sc1
  v_add_f32 v136, v196, v197
  v_mul_f32 v137, v196, v196
  v_mfma_f32_32x32x16_bf16 v[72:87], v[104:107], a[72:75], v[72:87]
  v_add_f32 v138, v198, v199
  v_mul_f32 v139, v197, v197
  v_fmac_f32 v137, v198, v198
  v_fmac_f32 v139, v199, v199
  v_add_f32 v136, v136, v200
  v_fmac_f32 v137, v200, v200
  v_mfma_f32_32x32x16_bf16 v[88:103], v[104:107], a[76:79], v[88:103]
  v_add_f32 v138, v138, v201
  v_fmac_f32 v139, v201, v201
  v_add_f32 v136, v136, v202
  v_fmac_f32 v137, v202, v202
  v_add_f32 v138, v138, v203
  s_waitcnt lgkmcnt(2)
  v_mfma_f32_32x32x16_bf16 v[40:55], v[108:111], a[80:83], v[40:55]
  v_fmac_f32 v139, v203, v203
  v_add_f32 v136, v136, v138
  v_add_f32 v137, v137, v139
  s_nop 0
  v_add_f32_dpp v136, v136, v136 row_ror:8 row_mask:0xf bank_mask:0xf
  v_add_f32_dpp v137, v137, v137 row_ror:8 row_mask:0xf bank_mask:0xf
  s_nop 0
  v_add_f32_dpp v136, v136, v136 row_ror:4 row_mask:0xf bank_mask:0xf
  v_mfma_f32_32x32x16_bf16 v[56:71], v[108:111], a[84:87], v[56:71]
  ds_read_b128 v[104:107], v3 offset:8192
  v_add_f32_dpp v137, v137, v137 row_ror:4 row_mask:0xf bank_mask:0xf
  v_add_f32_dpp v136, v136, v136 row_ror:2 row_mask:0xf bank_mask:0xf
  s_nop 0
  v_add_f32_dpp v137, v137, v137 row_ror:2 row_mask:0xf bank_mask:0xf
  v_add_f32_dpp v136, v136, v136 row_ror:1 row_mask:0xf bank_mask:0xf
  s_nop 0
  v_add_f32_dpp v137, v137, v137 row_ror:1 row_mask:0xf bank_mask:0xf
  v_mfma_f32_32x32x16_bf16 v[72:87], v[108:111], a[88:91], v[72:87]
  v_mov_b32 v140, v136
  v_mov_b32 v141, v137
  s_nop 0
  v_permlane16_swap_b32 v136, v140
  v_permlane16_swap_b32 v137, v141
  v_mfma_f32_32x32x16_bf16 v[88:103], v[108:111], a[92:95], v[88:103]
  v_add_f32 v136, v136, v140
  v_add_f32 v137, v137, v141
  v_mov_b32 v140, v136
  v_mov_b32 v141, v137
  s_nop 0
  v_permlane32_swap_b32 v136, v140
  s_waitcnt lgkmcnt(2)
  v_mfma_f32_32x32x16_bf16 v[40:55], v[112:115], a[96:99], v[40:55]
  v_permlane32_swap_b32 v137, v141
  v_add_f32 v136, v136, v140
  v_add_f32 v137, v137, v141
  v_mul_f32 v136, 0x3b000000, v136
  v_mul_f32 v137, 0x3b000000, v137
  v_mfma_f32_32x32x16_bf16 v[56:71], v[112:115], a[100:103], v[56:71]
  ds_read_b128 v[108:111], v3 offset:8704
  v_fma_f32 v137, -v136, v136, v137
  v_cvt_pk_bf16_f32 v136, 0, v136
  v_max_f32 v137, 0, v137
  v_sub_f32 v140, v196, v136
  v_sub_f32 v141, v197, v136
  v_mfma_f32_32x32x16_bf16 v[72:87], v[112:115], a[104:107], v[72:87]
  v_cvt_pk_bf16_f32 v137, 0, v137
  v_sub_f32 v142, v198, v136
  v_sub_f32 v143, v199, v136
  v_add_f32 v137, 0x3727c5ac, v137
  v_sub_f32 v144, v200, v136
  v_sub_f32 v145, v201, v136
  v_mfma_f32_32x32x16_bf16 v[88:103], v[112:115], a[108:111], v[88:103]
  v_cvt_pk_bf16_f32 v137, 0, v137
  v_sub_f32 v146, v202, v136
  v_sub_f32 v147, v203, v136
  v_sqrt_f32 v137, v137
  s_waitcnt lgkmcnt(2)
  v_mfma_f32_32x32x16_bf16 v[40:55], v[116:119], a[112:115], v[40:55]
  v_cvt_pk_bf16_f32 v140, 0, v140
  v_cvt_pk_bf16_f32 v141, 0, v141
  v_cvt_pk_bf16_f32 v137, 0, v137
  v_cvt_pk_bf16_f32 v142, 0, v142
  v_cvt_pk_bf16_f32 v143, 0, v143
  v_rcp_f32 v137, v137
  v_mfma_f32_32x32x16_bf16 v[56:71], v[116:119], a[116:119], v[56:71]
  ds_read_b128 v[112:115], v3 offset:9216
  v_cvt_pk_bf16_f32 v144, 0, v144
  v_cvt_pk_bf16_f32 v145, 0, v145
  v_cvt_pk_bf16_f32 v146, 0, v146
  v_cvt_pk_bf16_f32 v147, 0, v147
  v_mul_f32 v140, v140, v137
  v_mfma_f32_32x32x16_bf16 v[72:87], v[116:119], a[120:123], v[72:87]
  v_mul_f32 v141, v141, v137
  v_mul_f32 v142, v142, v137
  v_mul_f32 v143, v143, v137
  v_mul_f32 v144, v144, v137
  v_mul_f32 v145, v145, v137
  v_mul_f32 v146, v146, v137
  v_mfma_f32_32x32x16_bf16 v[88:103], v[116:119], a[124:127], v[88:103]
  v_mul_f32 v147, v147, v137
  v_cvt_pk_bf16_f32 v124, v140, v141
  v_cvt_pk_bf16_f32 v125, v142, v143
  v_cvt_pk_bf16_f32 v126, v144, v145
  v_cvt_pk_bf16_f32 v127, v146, v147
  s_waitcnt lgkmcnt(2)
  v_mfma_f32_32x32x16_bf16 v[40:55], v[104:107], a[128:131], v[40:55]
  v_lshlrev_b32 v204, 16, v124
  v_and_b32 v205, 0xffff0000, v124
  v_lshlrev_b32 v206, 16, v125
  v_and_b32 v207, 0xffff0000, v125
  v_lshlrev_b32 v208, 16, v126
  v_and_b32 v209, 0xffff0000, v126
  v_mfma_f32_32x32x16_bf16 v[56:71], v[104:107], a[132:135], v[56:71]
  ds_read_b128 v[116:119], v3 offset:9728
  v_lshlrev_b32 v210, 16, v127
  v_and_b32 v211, 0xffff0000, v127
  buffer_store_dwordx4 v[124:127], v0, s[4:7], s93 offen sc1
  v_mfma_f32_32x32x16_bf16 v[72:87], v[104:107], a[136:139], v[72:87]
  v_add_f32 v196, v196, v204
  v_add_f32 v197, v197, v205
  v_add_f32 v198, v198, v206
  v_add_f32 v199, v199, v207
  v_add_f32 v200, v200, v208
  v_add_f32 v201, v201, v209
  v_mfma_f32_32x32x16_bf16 v[88:103], v[104:107], a[140:143], v[88:103]
  v_add_f32 v202, v202, v210
  v_add_f32 v203, v203, v211
  v_cvt_pk_bf16_f32 v128, v196, v197
  v_cvt_pk_bf16_f32 v129, v198, v199
  v_cvt_pk_bf16_f32 v130, v200, v201
  s_waitcnt lgkmcnt(2)
  v_mfma_f32_32x32x16_bf16 v[40:55], v[108:111], a[144:147], v[40:55]
  v_cvt_pk_bf16_f32 v131, v202, v203
  v_mul_f32 v188, v204, v8
  v_mul_f32 v189, v205, v9
  v_fmac_f32 v188, v206, v10
  v_fmac_f32 v189, v207, v11
  v_fmac_f32 v188, v208, v12
  v_mfma_f32_32x32x16_bf16 v[56:71], v[108:111], a[148:151], v[56:71]
  ds_read_b128 v[104:107], v3 offset:10240
  v_fmac_f32 v189, v209, v13
  v_fmac_f32 v188, v210, v14
  v_fmac_f32 v189, v211, v15
  v_add_f32 v188, v188, v189
  s_add_u32 s92, s91, 10485760
  v_mfma_f32_32x32x16_bf16 v[72:87], v[108:111], a[152:155], v[72:87]
  s_add_u32 s93, s91, 8388608
  buffer_store_dwordx4 v[128:131], v0, s[4:7], s92 offen sc1
  v_lshlrev_b32 v196, 16, v128
  v_and_b32 v197, 0xffff0000, v128
  v_mfma_f32_32x32x16_bf16 v[88:103], v[108:111], a[156:159], v[88:103]
  v_lshlrev_b32 v198, 16, v129
  v_and_b32 v199, 0xffff0000, v129
  v_lshlrev_b32 v200, 16, v130
  v_and_b32 v201, 0xffff0000, v130
  v_lshlrev_b32 v202, 16, v131
  s_waitcnt lgkmcnt(2)
  v_mfma_f32_32x32x16_bf16 v[40:55], v[112:115], a[160:163], v[40:55]
  v_and_b32 v203, 0xffff0000, v131
  v_add_f32 v136, v196, v197
  v_mul_f32 v137, v196, v196
  v_add_f32 v138, v198, v199
  v_mul_f32 v139, v197, v197
  v_fmac_f32 v137, v198, v198
  v_mfma_f32_32x32x16_bf16 v[56:71], v[112:115], a[164:167], v[56:71]
  ds_read_b128 v[108:111], v3 offset:10752
  v_fmac_f32 v139, v199, v199
  v_add_f32 v136, v136, v200
  v_fmac_f32 v137, v200, v200
  v_add_f32 v138, v138, v201
  v_fmac_f32 v139, v201, v201
  v_mfma_f32_32x32x16_bf16 v[72:87], v[112:115], a[168:171], v[72:87]
  v_add_f32 v136, v136, v202
  v_fmac_f32 v137, v202, v202
  v_add_f32 v138, v138, v203
  v_fmac_f32 v139, v203, v203
  v_add_f32 v136, v136, v138
  v_add_f32 v137, v137, v139
  v_mfma_f32_32x32x16_bf16 v[88:103], v[112:115], a[172:175], v[88:103]
  v_add_f32_dpp v136, v136, v136 row_ror:8 row_mask:0xf bank_mask:0xf
  v_add_f32_dpp v137, v137, v137 row_ror:8 row_mask:0xf bank_mask:0xf
  v_add_f32_dpp v188, v188, v188 row_ror:8 row_mask:0xf bank_mask:0xf
  v_add_f32_dpp v136, v136, v136 row_ror:4 row_mask:0xf bank_mask:0xf
  v_add_f32_dpp v137, v137, v137 row_ror:4 row_mask:0xf bank_mask:0xf
  s_waitcnt lgkmcnt(2)
  v_mfma_f32_32x32x16_bf16 v[40:55], v[116:119], a[176:179], v[40:55]
  v_add_f32_dpp v188, v188, v188 row_ror:4 row_mask:0xf bank_mask:0xf
  v_add_f32_dpp v136, v136, v136 row_ror:2 row_mask:0xf bank_mask:0xf
  v_add_f32_dpp v137, v137, v137 row_ror:2 row_mask:0xf bank_mask:0xf
  v_add_f32_dpp v188, v188, v188 row_ror:2 row_mask:0xf bank_mask:0xf
  v_add_f32_dpp v136, v136, v136 row_ror:1 row_mask:0xf bank_mask:0xf
  v_add_f32_dpp v137, v137, v137 row_ror:1 row_mask:0xf bank_mask:0xf
  v_mfma_f32_32x32x16_bf16 v[56:71], v[116:119], a[180:183], v[56:71]
  ds_read_b128 v[112:115], v3 offset:11264
  v_add_f32_dpp v188, v188, v188 row_ror:1 row_mask:0xf bank_mask:0xf
  v_mov_b32 v140, v136
  v_mov_b32 v141, v137
  v_mov_b32 v142, v188
  v_permlane16_swap_b32 v136, v140
  v_mfma_f32_32x32x16_bf16 v[72:87], v[116:119], a[184:187], v[72:87]
  v_permlane16_swap_b32 v137, v141
  v_permlane16_swap_b32 v188, v142
  v_add_f32 v136, v136, v140
  v_add_f32 v137, v137, v141
  v_mfma_f32_32x32x16_bf16 v[88:103], v[116:119], a[188:191], v[88:103]
  v_add_f32 v188, v188, v142
  v_mov_b32 v140, v136
  v_mov_b32 v141, v137
  v_mov_b32 v142, v188
  v_permlane32_swap_b32 v136, v140
  s_waitcnt lgkmcnt(2)
  v_mfma_f32_32x32x16_bf16 v[40:55], v[104:107], a[192:195], v[40:55]
  v_permlane32_swap_b32 v137, v141
  v_permlane32_swap_b32 v188, v142
  v_add_f32 v136, v136, v140
  v_add_f32 v137, v137, v141
  v_mfma_f32_32x32x16_bf16 v[56:71], v[104:107], a[196:199], v[56:71]
  ds_read_b128 v[116:119], v3 offset:11776
  v_add_f32 v188, v188, v142
  v_mul_f32 v136, 0x3b000000, v136
  v_mul_f32 v137, 0x3b000000, v137
  v_fma_f32 v137, -v136, v136, v137
  v_cvt_pk_bf16_f32 v136, 0, v136
  s_waitcnt lgkmcnt(2)
  v_mfma_f32_32x32x16_bf16 v[40:55], v[108:111], a[208:211], v[40:55]
  v_max_f32 v137, 0, v137
  v_sub_f32 v140, v196, v136
  v_sub_f32 v141, v197, v136
  v_cvt_pk_bf16_f32 v137, 0, v137
  v_sub_f32 v142, v198, v136
  v_sub_f32 v143, v199, v136
  v_mfma_f32_32x32x16_bf16 v[56:71], v[108:111], a[212:215], v[56:71]
  v_add_f32 v137, 0x3727c5ac, v137
  v_sub_f32 v144, v200, v136
  v_sub_f32 v145, v201, v136
  v_cvt_pk_bf16_f32 v137, 0, v137
  v_sub_f32 v146, v202, v136
  v_sub_f32 v147, v203, v136
  s_waitcnt lgkmcnt(1)
  v_mfma_f32_32x32x16_bf16 v[40:55], v[112:115], a[224:227], v[40:55]
  v_sqrt_f32 v137, v137
  v_cvt_pk_bf16_f32 v140, 0, v140
  v_cvt_pk_bf16_f32 v141, 0, v141
  v_cvt_pk_bf16_f32 v137, 0, v137
  v_cvt_pk_bf16_f32 v142, 0, v142
  v_mfma_f32_32x32x16_bf16 v[56:71], v[112:115], a[228:231], v[56:71]
  v_cvt_pk_bf16_f32 v143, 0, v143
  v_rcp_f32 v137, v137
  v_cvt_pk_bf16_f32 v144, 0, v144
  v_cvt_pk_bf16_f32 v145, 0, v145
  v_cvt_pk_bf16_f32 v146, 0, v146
  s_waitcnt lgkmcnt(0)
  v_mfma_f32_32x32x16_bf16 v[40:55], v[116:119], a[240:243], v[40:55]
  v_cvt_pk_bf16_f32 v147, 0, v147
  v_mul_f32 v140, v140, v137
  v_mul_f32 v141, v141, v137
  v_mul_f32 v142, v142, v137
  v_mul_f32 v143, v143, v137
  v_mul_f32 v144, v144, v137
  v_mfma_f32_32x32x16_bf16 v[56:71], v[116:119], a[244:247], v[56:71]
  v_mul_f32 v145, v145, v137
  v_mul_f32 v146, v146, v137
  v_mul_f32 v147, v147, v137
  v_cvt_pk_bf16_f32 v132, v140, v141
  v_cvt_pk_bf16_f32 v133, v142, v143
  v_cvt_pk_bf16_f32 v134, v144, v145
  v_mfma_f32_32x32x16_bf16 v[72:87], v[104:107], a[200:203], v[72:87]
  v_cvt_pk_bf16_f32 v135, v146, v147
  buffer_store_dwordx4 v[132:135], v0, s[4:7], s93 offen sc1
  v_cvt_pk_bf16_f32 v188, 0, v188
  v_ashrrev_i32 v189, 31, v188
  v_mfma_f32_32x32x16_bf16 v[88:103], v[104:107], a[204:207], v[88:103]
  v_or_b32 v189, 0x80000000, v189
  v_xor_b32 v188, v188, v189
  s_sub_u32 s92, 4095, s90
  v_and_b32 v188, 0xffff0000, v188
  v_or_b32 v38, s92, v188
  v_mfma_f32_32x32x16_bf16 v[72:87], v[108:111], a[216:219], v[72:87]
  s_bfe_u32 s92, s65, 196625
  s_lshl_b32 s92, s92, 18
  s_lshl_b32 s93, s90, 7
  s_add_u32 s92, s92, s93
  s_add_u32 s84, s92, 243269632
  v_cvt_pk_bf16_f32 v212, v40, v56
  v_mfma_f32_32x32x16_bf16 v[88:103], v[108:111], a[220:223], v[88:103]
  v_cvt_pk_bf16_f32 v214, v41, v57
  v_cvt_pk_bf16_f32 v216, v42, v58
  v_cvt_pk_bf16_f32 v218, v43, v59
  v_permlane16_swap_b32 v212, v214
  v_mfma_f32_32x32x16_bf16 v[72:87], v[112:115], a[232:235], v[72:87]
  v_cvt_pk_bf16_f32 v220, v44, v60
  v_cvt_pk_bf16_f32 v222, v45, v61
  v_permlane16_swap_b32 v216, v218
  v_bfi_b32 v212, v254, s42, v212
  v_cvt_pk_bf16_f32 v224, v46, v62
  v_mfma_f32_32x32x16_bf16 v[88:103], v[112:115], a[236:239], v[88:103]
  v_cvt_pk_bf16_f32 v226, v47, v63
  v_permlane16_swap_b32 v220, v222
  v_bfi_b32 v216, v254, s42, v216
  v_cvt_pk_bf16_f32 v228, v48, v64
  v_mfma_f32_32x32x16_bf16 v[72:87], v[116:119], a[248:251], v[72:87]
  v_cvt_pk_bf16_f32 v230, v49, v65
  v_permlane16_swap_b32 v224, v226
  v_bfi_b32 v220, v254, s42, v220
  v_cvt_pk_bf16_f32 v232, v50, v66
  v_cvt_pk_bf16_f32 v234, v51, v67
  v_mfma_f32_32x32x16_bf16 v[88:103], v[116:119], a[252:255], v[88:103]
  v_permlane16_swap_b32 v228, v230
  v_bfi_b32 v224, v254, s42, v224
  v_cvt_pk_bf16_f32 v236, v52, v68
  v_cvt_pk_bf16_f32 v238, v53, v69
  v_permlane16_swap_b32 v232, v234
  v_bfi_b32 v228, v254, s42, v228
  v_cvt_pk_bf16_f32 v240, v54, v70
  v_cvt_pk_bf16_f32 v242, v55, v71
  v_permlane16_swap_b32 v236, v238
  v_bfi_b32 v232, v254, s42, v232
  v_permlane16_swap_b32 v240, v242
  v_bfi_b32 v236, v254, s42, v236
  v_bfi_b32 v240, v254, s42, v240
  v_cvt_pk_bf16_f32 v213, v72, v88
  v_cvt_pk_bf16_f32 v215, v73, v89
  v_cvt_pk_bf16_f32 v217, v74, v90
  v_cvt_pk_bf16_f32 v219, v75, v91
  s_add_u32 s78, s86, 0
  v_permlane16_swap_b32 v213, v215
  buffer_store_dwordx4 v[212:215], v4, s[4:7], s78 offen
  v_cvt_pk_bf16_f32 v221, v76, v92
  v_cvt_pk_bf16_f32 v223, v77, v93
  s_add_u32 s78, s86, 32768
  v_permlane16_swap_b32 v217, v219
  buffer_store_dwordx4 v[216:219], v4, s[4:7], s78 offen
  v_cvt_pk_bf16_f32 v225, v78, v94
  v_cvt_pk_bf16_f32 v227, v79, v95
  s_add_u32 s78, s86, 131072
  v_permlane16_swap_b32 v221, v223
  buffer_store_dwordx4 v[220:223], v4, s[4:7], s78 offen
  v_cvt_pk_bf16_f32 v229, v80, v96
  v_cvt_pk_bf16_f32 v231, v81, v97
  s_add_u32 s78, s86, 163840
  v_permlane16_swap_b32 v225, v227
  buffer_store_dwordx4 v[224:227], v4, s[4:7], s78 offen
  v_cvt_pk_bf16_f32 v233, v82, v98
  v_cvt_pk_bf16_f32 v235, v83, v99
  s_add_u32 s78, s86, 262144
  v_permlane16_swap_b32 v229, v231
  buffer_store_dwordx4 v[228:231], v4, s[4:7], s78 offen
  v_cvt_pk_bf16_f32 v237, v84, v100
  v_cvt_pk_bf16_f32 v239, v85, v101
  s_add_u32 s78, s86, 294912
  v_permlane16_swap_b32 v233, v235
  buffer_store_dwordx4 v[232:235], v4, s[4:7], s78 offen
  v_cvt_pk_bf16_f32 v241, v86, v102
  v_cvt_pk_bf16_f32 v243, v87, v103
  s_add_u32 s78, s86, 393216
  v_permlane16_swap_b32 v237, v239
  buffer_store_dwordx4 v[236:239], v4, s[4:7], s78 offen
  s_add_u32 s78, s86, 425984
  v_permlane16_swap_b32 v241, v243
  buffer_store_dwordx4 v[240:243], v4, s[4:7], s78 offen
  s_waitcnt vmcnt(8)
  s_mov_b64 exec, 1
  buffer_store_dword v38, off, s[4:7], s84 sc1
  s_mov_b64 exec, -1
  s_mov_b32 s84, 268435456
  s_branch o_we_153
o_rt_161:
  s_mov_b32 s67, 0
o_rl_165:
  s_lshl_b32 s94, s43, 14
  s_add_u32 s94, s94, s95
  buffer_load_dwordx4 v[120:123], v5, s[4:7], s94 offen offset:0 sc1
  buffer_load_dwordx4 v[124:127], v5, s[4:7], s94 offen offset:512 sc1
  buffer_load_dwordx4 v[128:131], v5, s[4:7], s94 offen offset:256 sc1
  buffer_load_dwordx4 v[132:135], v5, s[4:7], s94 offen offset:768 sc1
  s_add_u32 s94, s94, 4096
  buffer_load_dwordx4 v[136:139], v5, s[4:7], s94 offen offset:0 sc1
  buffer_load_dwordx4 v[140:143], v5, s[4:7], s94 offen offset:512 sc1
  buffer_load_dwordx4 v[144:147], v5, s[4:7], s94 offen offset:256 sc1
  buffer_load_dwordx4 v[148:151], v5, s[4:7], s94 offen offset:768 sc1
  s_add_u32 s94, s94, 4096
  buffer_load_dwordx4 v[152:155], v5, s[4:7], s94 offen offset:0 sc1
  buffer_load_dwordx4 v[156:159], v5, s[4:7], s94 offen offset:512 sc1
  buffer_load_dwordx4 v[160:163], v5, s[4:7], s94 offen offset:256 sc1
  buffer_load_dwordx4 v[164:167], v5, s[4:7], s94 offen offset:768 sc1
  s_add_u32 s94, s94, 4096
  buffer_load_dwordx4 v[168:171], v5, s[4:7], s94 offen offset:0 sc1
  buffer_load_dwordx4 v[172:175], v5, s[4:7], s94 offen offset:512 sc1
  buffer_load_dwordx4 v[176:179], v5, s[4:7], s94 offen offset:256 sc1
  buffer_load_dwordx4 v[180:183], v5, s[4:7], s94 offen offset:768 sc1
  s_add_u32 s67, s67, 1
  s_cmp_gt_u32 s67, 1048576
  s_cbranch_scc1 L_end
  s_waitcnt vmcnt(0)
  v_xor_b32 v7, s96, v120
  v_bitop3_b32 v7, v7, v124, s96 bitop3:0xf6
  v_bitop3_b32 v7, v7, v128, s96 bitop3:0xf6
  v_bitop3_b32 v7, v7, v132, s96 bitop3:0xf6
  v_bitop3_b32 v7, v7, v136, s96 bitop3:0xf6
  v_bitop3_b32 v7, v7, v140, s96 bitop3:0xf6
  v_bitop3_b32 v7, v7, v144, s96 bitop3:0xf6
  v_bitop3_b32 v7, v7, v148, s96 bitop3:0xf6
  v_bitop3_b32 v7, v7, v152, s96 bitop3:0xf6
  v_bitop3_b32 v7, v7, v156, s96 bitop3:0xf6
  v_bitop3_b32 v7, v7, v160, s96 bitop3:0xf6
  v_bitop3_b32 v7, v7, v164, s96 bitop3:0xf6
  v_bitop3_b32 v7, v7, v168, s96 bitop3:0xf6
  v_bitop3_b32 v7, v7, v172, s96 bitop3:0xf6
  v_bitop3_b32 v7, v7, v176, s96 bitop3:0xf6
  v_bitop3_b32 v7, v7, v180, s96 bitop3:0xf6
  v_and_b32 v7, v254, v7
  v_cmp_ne_u32 vcc, 0, v7
  s_cbranch_vccnz o_rl_165
  s_branch o_bk_162
o_rt_163:
  s_mov_b32 s67, 0
o_rl_166:
  s_lshl_b32 s94, s43, 14
  s_add_u32 s94, s94, s95
  buffer_load_dwordx4 v[120:123], v5, s[4:7], s94 offen offset:0 sc1
  buffer_load_dwordx4 v[124:127], v5, s[4:7], s94 offen offset:512 sc1
  buffer_load_dwordx4 v[128:131], v5, s[4:7], s94 offen offset:256 sc1
  buffer_load_dwordx4 v[132:135], v5, s[4:7], s94 offen offset:768 sc1
  s_add_u32 s94, s94, 4096
  buffer_load_dwordx4 v[136:139], v5, s[4:7], s94 offen offset:0 sc1
  buffer_load_dwordx4 v[140:143], v5, s[4:7], s94 offen offset:512 sc1
  buffer_load_dwordx4 v[144:147], v5, s[4:7], s94 offen offset:256 sc1
  buffer_load_dwordx4 v[148:151], v5, s[4:7], s94 offen offset:768 sc1
  s_add_u32 s94, s94, 4096
  buffer_load_dwordx4 v[152:155], v5, s[4:7], s94 offen offset:0 sc1
  buffer_load_dwordx4 v[156:159], v5, s[4:7], s94 offen offset:512 sc1
  buffer_load_dwordx4 v[160:163], v5, s[4:7], s94 offen offset:256 sc1
  buffer_load_dwordx4 v[164:167], v5, s[4:7], s94 offen offset:768 sc1
  s_add_u32 s94, s94, 4096
  buffer_load_dwordx4 v[168:171], v5, s[4:7], s94 offen offset:0 sc1
  buffer_load_dwordx4 v[172:175], v5, s[4:7], s94 offen offset:512 sc1
  buffer_load_dwordx4 v[176:179], v5, s[4:7], s94 offen offset:256 sc1
  buffer_load_dwordx4 v[180:183], v5, s[4:7], s94 offen offset:768 sc1
  s_add_u32 s67, s67, 1
  s_cmp_gt_u32 s67, 1048576
  s_cbranch_scc1 L_end
  s_waitcnt vmcnt(0)
  v_xor_b32 v7, s96, v120
  v_bitop3_b32 v7, v7, v124, s96 bitop3:0xf6
  v_bitop3_b32 v7, v7, v128, s96 bitop3:0xf6
  v_bitop3_b32 v7, v7, v132, s96 bitop3:0xf6
  v_bitop3_b32 v7, v7, v136, s96 bitop3:0xf6
  v_bitop3_b32 v7, v7, v140, s96 bitop3:0xf6
  v_bitop3_b32 v7, v7, v144, s96 bitop3:0xf6
  v_bitop3_b32 v7, v7, v148, s96 bitop3:0xf6
  v_bitop3_b32 v7, v7, v152, s96 bitop3:0xf6
  v_bitop3_b32 v7, v7, v156, s96 bitop3:0xf6
  v_bitop3_b32 v7, v7, v160, s96 bitop3:0xf6
  v_bitop3_b32 v7, v7, v164, s96 bitop3:0xf6
  v_bitop3_b32 v7, v7, v168, s96 bitop3:0xf6
  v_bitop3_b32 v7, v7, v172, s96 bitop3:0xf6
  v_bitop3_b32 v7, v7, v176, s96 bitop3:0xf6
  v_bitop3_b32 v7, v7, v180, s96 bitop3:0xf6
  v_and_b32 v7, v254, v7
  v_cmp_ne_u32 vcc, 0, v7
  s_cbranch_vccnz o_rl_166
  s_branch o_bk_164
o_fb_155:
  v_mov_b32 v118, v116
  s_nop 1
  v_permlane16_swap_b32 v116, v118
  v_max_f32 v116, v116, v118
  v_mov_b32 v118, v116
  s_nop 0
  s_nop 0
  v_permlane32_swap_b32 v116, v118
  v_max_f32 v116, v116, v118
  v_sub_f32 v56, v104, v116
  v_sub_f32 v57, v105, v116
  v_sub_f32 v58, v106, v116
  v_sub_f32 v59, v107, v116
  v_sub_f32 v60, v108, v116
  v_sub_f32 v61, v109, v116
  v_sub_f32 v62, v110, v116
  v_sub_f32 v63, v111, v116
  v_sub_f32 v64, v112, v116
  v_sub_f32 v65, v113, v116
  v_exp_f32 v56, v56
  v_exp_f32 v57, v57
  v_exp_f32 v58, v58
  v_exp_f32 v59, v59
  v_exp_f32 v60, v60
  v_exp_f32 v61, v61
  v_exp_f32 v62, v62
  v_exp_f32 v63, v63
  v_exp_f32 v64, v64
  v_exp_f32 v65, v65
  v_add_f32 v117, v56, v57
  v_add_f32 v117, v117, v58
  v_add_f32 v117, v117, v59
  v_add_f32 v117, v117, v60
  v_add_f32 v117, v117, v61
  v_add_f32 v117, v117, v62
  v_add_f32 v117, v117, v63
  v_add_f32 v117, v117, v64
  v_add_f32 v117, v117, v65
  v_mov_b32 v118, v117
  s_nop 0
  s_nop 0
  v_permlane16_swap_b32 v117, v118
  v_add_f32 v117, v117, v118
  v_mov_b32 v118, v117
  s_nop 0
  s_nop 0
  v_permlane32_swap_b32 v117, v118
  v_add_f32 v117, v117, v118
  v_rcp_f32 v117, v117
  s_branch o_fbr_156
o_fb_157:
  v_mov_b32 v118, v116
  s_nop 1
  v_permlane16_swap_b32 v116, v118
  v_max_f32 v116, v116, v118
  v_mov_b32 v118, v116
  s_nop 0
  s_nop 0
  v_permlane32_swap_b32 v116, v118
  v_max_f32 v116, v116, v118
  v_sub_f32 v56, v104, v116
  v_sub_f32 v57, v105, v116
  v_sub_f32 v58, v106, v116
  v_sub_f32 v59, v107, v116
  v_sub_f32 v60, v108, v116
  v_sub_f32 v61, v109, v116
  v_sub_f32 v62, v110, v116
  v_sub_f32 v63, v111, v116
  v_sub_f32 v64, v112, v116
  v_sub_f32 v65, v113, v116
  v_exp_f32 v56, v56
  v_exp_f32 v57, v57
  v_exp_f32 v58, v58
  v_exp_f32 v59, v59
  v_exp_f32 v60, v60
  v_exp_f32 v61, v61
  v_exp_f32 v62, v62
  v_exp_f32 v63, v63
  v_exp_f32 v64, v64
  v_exp_f32 v65, v65
  v_add_f32 v117, v56, v57
  v_add_f32 v117, v117, v58
  v_add_f32 v117, v117, v59
  v_add_f32 v117, v117, v60
  v_add_f32 v117, v117, v61
  v_add_f32 v117, v117, v62
  v_add_f32 v117, v117, v63
  v_add_f32 v117, v117, v64
  v_add_f32 v117, v117, v65
  v_mov_b32 v118, v117
  s_nop 0
  s_nop 0
  v_permlane16_swap_b32 v117, v118
  v_add_f32 v117, v117, v118
  v_mov_b32 v118, v117
  s_nop 0
  s_nop 0
  v_permlane32_swap_b32 v117, v118
  v_add_f32 v117, v117, v118
  v_rcp_f32 v117, v117
  s_branch o_fbr_158
o_wr2_152:
  s_waitcnt lgkmcnt(0)
  s_barrier
  ds_read_b128 v[104:107], v3 offset:0
  ds_read_b128 v[108:111], v3 offset:512
  ds_read_b128 v[112:115], v3 offset:1024
  buffer_load_dwordx4 v[176:179], v5, s[4:7], s94 offen offset:256 sc1
  buffer_load_dwordx4 v[180:183], v5, s[4:7], s94 offen offset:768 sc1
  s_waitcnt lgkmcnt(2)
  v_mfma_f32_32x32x16_bf16 v[40:55], v[104:107], a[0:3], 0
  v_mov_b64 v[188:189], 0
  v_mov_b64 v[190:191], 0
  v_mov_b64 v[192:193], 0
  v_mov_b64 v[194:195], 0
  s_mov_b64 exec, 1
  buffer_store_dword v38, off, s[4:7], s84 sc1
  s_mov_b64 exec, -1
  s_mov_b32 s84, 268435456
  v_mfma_f32_32x32x16_bf16 v[56:71], v[104:107], a[4:7], 0
  ds_read_b128 v[116:119], v3 offset:1536
  v_mfma_f32_32x32x16_bf16 v[72:87], v[104:107], a[8:11], 0
  v_mfma_f32_32x32x16_bf16 v[88:103], v[104:107], a[12:15], 0
  s_waitcnt vmcnt(13)
  v_xor_b32 v7, s96, v120
  v_bitop3_b32 v7, v7, v124, s96 bitop3:0xf6
  v_bitop3_b32 v7, v7, v128, s96 bitop3:0xf6
  v_bitop3_b32 v7, v7, v132, s96 bitop3:0xf6
  s_waitcnt lgkmcnt(2)
  v_mfma_f32_32x32x16_bf16 v[40:55], v[108:111], a[16:19], v[40:55]
  s_waitcnt vmcnt(9)
  v_bitop3_b32 v7, v7, v136, s96 bitop3:0xf6
  v_bitop3_b32 v7, v7, v140, s96 bitop3:0xf6
  v_bitop3_b32 v7, v7, v144, s96 bitop3:0xf6
  v_bitop3_b32 v7, v7, v148, s96 bitop3:0xf6
  s_waitcnt vmcnt(5)
  v_mfma_f32_32x32x16_bf16 v[56:71], v[108:111], a[20:23], v[56:71]
  ds_read_b128 v[104:107], v3 offset:2048
  v_bitop3_b32 v7, v7, v152, s96 bitop3:0xf6
  v_bitop3_b32 v7, v7, v156, s96 bitop3:0xf6
  v_bitop3_b32 v7, v7, v160, s96 bitop3:0xf6
  v_bitop3_b32 v7, v7, v164, s96 bitop3:0xf6
  s_waitcnt vmcnt(1)
  v_mfma_f32_32x32x16_bf16 v[72:87], v[108:111], a[24:27], v[72:87]
  v_bitop3_b32 v7, v7, v168, s96 bitop3:0xf6
  v_bitop3_b32 v7, v7, v172, s96 bitop3:0xf6
  v_bitop3_b32 v7, v7, v176, s96 bitop3:0xf6
  v_bitop3_b32 v7, v7, v180, s96 bitop3:0xf6
  v_and_b32 v7, v254, v7
  v_cmp_ne_u32 vcc, 0, v7
  s_cbranch_vccnz o_rt_163
o_bk_164:
  v_mfma_f32_32x32x16_bf16 v[88:103], v[108:111], a[28:31], v[88:103]
  v_smfmac_f32_16x16x64_bf16 v[188:191], v[16:19], v[120:127], v20
  v_lshlrev_b32 v196, 16, v184
  v_smfmac_f32_16x16x64_bf16 v[192:195], v[16:19], v[128:135], v20
  v_and_b32 v197, 0xffff0000, v184
  v_smfmac_f32_16x16x64_bf16 v[188:191], v[16:19], v[136:143], v20
  v_lshlrev_b32 v198, 16, v185
  s_waitcnt lgkmcnt(2)
  v_mfma_f32_32x32x16_bf16 v[40:55], v[112:115], a[32:35], v[40:55]
  v_smfmac_f32_16x16x64_bf16 v[192:195], v[16:19], v[144:151], v20
  v_and_b32 v199, 0xffff0000, v185
  v_smfmac_f32_16x16x64_bf16 v[188:191], v[16:19], v[152:159], v20
  v_lshlrev_b32 v200, 16, v186
  v_smfmac_f32_16x16x64_bf16 v[192:195], v[16:19], v[160:167], v20
  v_and_b32 v201, 0xffff0000, v186
  v_mfma_f32_32x32x16_bf16 v[56:71], v[112:115], a[36:39], v[56:71]
  ds_read_b128 v[108:111], v3 offset:2560
  v_smfmac_f32_16x16x64_bf16 v[188:191], v[16:19], v[168:175], v20
  v_lshlrev_b32 v202, 16, v187
  v_smfmac_f32_16x16x64_bf16 v[192:195], v[16:19], v[176:183], v20
  v_and_b32 v203, 0xffff0000, v187
  s_bfe_u32 s92, s65, 131086
  v_mfma_f32_32x32x16_bf16 v[72:87], v[112:115], a[40:43], v[72:87]
  s_lshl_b32 s92, s92, 21
  s_add_u32 s92, s92, s91
  s_add_u32 s93, s92, 27262976
  s_add_u32 s92, s92, 20971520
  v_permlane16_swap_b32 v188, v192
  v_mfma_f32_32x32x16_bf16 v[88:103], v[112:115], a[44:47], v[88:103]
  v_permlane16_swap_b32 v189, v193
  v_permlane16_swap_b32 v190, v194
  v_permlane16_swap_b32 v191, v195
  s_waitcnt lgkmcnt(2)
  v_mfma_f32_32x32x16_bf16 v[40:55], v[116:119], a[48:51], v[40:55]
  v_cvt_pk_bf16_f32 v188, 0, v188
  v_cvt_pk_bf16_f32 v189, 0, v189
  v_cvt_pk_bf16_f32 v190, 0, v190
  v_cvt_pk_bf16_f32 v191, 0, v191
  v_cvt_pk_bf16_f32 v192, 0, v192
  v_cvt_pk_bf16_f32 v193, 0, v193
  v_mfma_f32_32x32x16_bf16 v[56:71], v[116:119], a[52:55], v[56:71]
  ds_read_b128 v[112:115], v3 offset:3072
  v_cvt_pk_bf16_f32 v194, 0, v194
  v_cvt_pk_bf16_f32 v195, 0, v195
  v_add_f32 v196, v196, v188
  v_add_f32 v197, v197, v189
  v_add_f32 v198, v198, v190
  v_mfma_f32_32x32x16_bf16 v[72:87], v[116:119], a[56:59], v[72:87]
  v_add_f32 v199, v199, v191
  v_add_f32 v200, v200, v192
  v_add_f32 v201, v201, v193
  v_add_f32 v202, v202, v194
  v_add_f32 v203, v203, v195
  v_cvt_pk_bf16_f32 v120, v196, v197
  v_mfma_f32_32x32x16_bf16 v[88:103], v[116:119], a[60:63], v[88:103]
  v_cvt_pk_bf16_f32 v121, v198, v199
  v_cvt_pk_bf16_f32 v122, v200, v201
  v_cvt_pk_bf16_f32 v123, v202, v203
  v_lshlrev_b32 v196, 16, v120
  v_and_b32 v197, 0xffff0000, v120
  s_waitcnt lgkmcnt(2)
  v_mfma_f32_32x32x16_bf16 v[40:55], v[104:107], a[64:67], v[40:55]
  v_lshlrev_b32 v198, 16, v121
  v_and_b32 v199, 0xffff0000, v121
  v_lshlrev_b32 v200, 16, v122
  v_and_b32 v201, 0xffff0000, v122
  v_lshlrev_b32 v202, 16, v123
  v_and_b32 v203, 0xffff0000, v123
  v_mfma_f32_32x32x16_bf16 v[56:71], v[104:107], a[68:71], v[56:71]
  ds_read_b128 v[116:119], v3 offset:3584
  buffer_store_dwordx4 v[120:123], v0, s[4:7], s92 offen sc1
  v_add_f32 v136, v196, v197
  v_mul_f32 v137, v196, v196
  v_mfma_f32_32x32x16_bf16 v[72:87], v[104:107], a[72:75], v[72:87]
  v_add_f32 v138, v198, v199
  v_mul_f32 v139, v197, v197
  v_fmac_f32 v137, v198, v198
  v_fmac_f32 v139, v199, v199
  v_add_f32 v136, v136, v200
  v_fmac_f32 v137, v200, v200
  v_mfma_f32_32x32x16_bf16 v[88:103], v[104:107], a[76:79], v[88:103]
  v_add_f32 v138, v138, v201
  v_fmac_f32 v139, v201, v201
  v_add_f32 v136, v136, v202
  v_fmac_f32 v137, v202, v202
  v_add_f32 v138, v138, v203
  s_waitcnt lgkmcnt(2)
  v_mfma_f32_32x32x16_bf16 v[40:55], v[108:111], a[80:83], v[40:55]
  v_fmac_f32 v139, v203, v203
  v_add_f32 v136, v136, v138
  v_add_f32 v137, v137, v139
  s_nop 0
  v_add_f32_dpp v136, v136, v136 row_ror:8 row_mask:0xf bank_mask:0xf
  v_add_f32_dpp v137, v137, v137 row_ror:8 row_mask:0xf bank_mask:0xf
  s_nop 0
  v_add_f32_dpp v136, v136, v136 row_ror:4 row_mask:0xf bank_mask:0xf
  v_mfma_f32_32x32x16_bf16 v[56:71], v[108:111], a[84:87], v[56:71]
  ds_read_b128 v[104:107], v3 offset:8192
  v_add_f32_dpp v137, v137, v137 row_ror:4 row_mask:0xf bank_mask:0xf
  v_add_f32_dpp v136, v136, v136 row_ror:2 row_mask:0xf bank_mask:0xf
  s_nop 0
  v_add_f32_dpp v137, v137, v137 row_ror:2 row_mask:0xf bank_mask:0xf
  v_add_f32_dpp v136, v136, v136 row_ror:1 row_mask:0xf bank_mask:0xf
  s_nop 0
  v_add_f32_dpp v137, v137, v137 row_ror:1 row_mask:0xf bank_mask:0xf
  v_mfma_f32_32x32x16_bf16 v[72:87], v[108:111], a[88:91], v[72:87]
  v_mov_b32 v140, v136
  v_mov_b32 v141, v137
  s_nop 0
  v_permlane16_swap_b32 v136, v140
  v_permlane16_swap_b32 v137, v141
  v_mfma_f32_32x32x16_bf16 v[88:103], v[108:111], a[92:95], v[88:103]
  v_add_f32 v136, v136, v140
  v_add_f32 v137, v137, v141
  v_mov_b32 v140, v136
  v_mov_b32 v141, v137
  s_nop 0
  v_permlane32_swap_b32 v136, v140
  s_waitcnt lgkmcnt(2)
  v_mfma_f32_32x32x16_bf16 v[40:55], v[112:115], a[96:99], v[40:55]
  v_permlane32_swap_b32 v137, v141
  v_add_f32 v136, v136, v140
  v_add_f32 v137, v137, v141
  v_mul_f32 v136, 0x3b000000, v136
  v_mul_f32 v137, 0x3b000000, v137
  v_mfma_f32_32x32x16_bf16 v[56:71], v[112:115], a[100:103], v[56:71]
  ds_read_b128 v[108:111], v3 offset:8704
  v_fma_f32 v137, -v136, v136, v137
  v_cvt_pk_bf16_f32 v136, 0, v136
  v_max_f32 v137, 0, v137
  v_sub_f32 v140, v196, v136
  v_sub_f32 v141, v197, v136
  v_mfma_f32_32x32x16_bf16 v[72:87], v[112:115], a[104:107], v[72:87]
  v_cvt_pk_bf16_f32 v137, 0, v137
  v_sub_f32 v142, v198, v136
  v_sub_f32 v143, v199, v136
  v_add_f32 v137, 0x3727c5ac, v137
  v_sub_f32 v144, v200, v136
  v_sub_f32 v145, v201, v136
  v_mfma_f32_32x32x16_bf16 v[88:103], v[112:115], a[108:111], v[88:103]
  v_cvt_pk_bf16_f32 v137, 0, v137
  v_sub_f32 v146, v202, v136
  v_sub_f32 v147, v203, v136
  v_sqrt_f32 v137, v137
  s_waitcnt lgkmcnt(2)
  v_mfma_f32_32x32x16_bf16 v[40:55], v[116:119], a[112:115], v[40:55]
  v_cvt_pk_bf16_f32 v140, 0, v140
  v_cvt_pk_bf16_f32 v141, 0, v141
  v_cvt_pk_bf16_f32 v137, 0, v137
  v_cvt_pk_bf16_f32 v142, 0, v142
  v_cvt_pk_bf16_f32 v143, 0, v143
  v_rcp_f32 v137, v137
  v_mfma_f32_32x32x16_bf16 v[56:71], v[116:119], a[116:119], v[56:71]
  ds_read_b128 v[112:115], v3 offset:9216
  v_cvt_pk_bf16_f32 v144, 0, v144
  v_cvt_pk_bf16_f32 v145, 0, v145
  v_cvt_pk_bf16_f32 v146, 0, v146
  v_cvt_pk_bf16_f32 v147, 0, v147
  v_mul_f32 v140, v140, v137
  v_mfma_f32_32x32x16_bf16 v[72:87], v[116:119], a[120:123], v[72:87]
  v_mul_f32 v141, v141, v137
  v_mul_f32 v142, v142, v137
  v_mul_f32 v143, v143, v137
  v_mul_f32 v144, v144, v137
  v_mul_f32 v145, v145, v137
  v_mul_f32 v146, v146, v137
  v_mfma_f32_32x32x16_bf16 v[88:103], v[116:119], a[124:127], v[88:103]
  v_mul_f32 v147, v147, v137
  v_cvt_pk_bf16_f32 v124, v140, v141
  v_cvt_pk_bf16_f32 v125, v142, v143
  v_cvt_pk_bf16_f32 v126, v144, v145
  v_cvt_pk_bf16_f32 v127, v146, v147
  s_waitcnt lgkmcnt(2)
  v_mfma_f32_32x32x16_bf16 v[40:55], v[104:107], a[128:131], v[40:55]
  v_lshlrev_b32 v204, 16, v124
  v_and_b32 v205, 0xffff0000, v124
  v_lshlrev_b32 v206, 16, v125
  v_and_b32 v207, 0xffff0000, v125
  v_lshlrev_b32 v208, 16, v126
  v_and_b32 v209, 0xffff0000, v126
  v_mfma_f32_32x32x16_bf16 v[56:71], v[104:107], a[132:135], v[56:71]
  ds_read_b128 v[116:119], v3 offset:9728
  v_lshlrev_b32 v210, 16, v127
  v_and_b32 v211, 0xffff0000, v127
  buffer_store_dwordx4 v[124:127], v0, s[4:7], s93 offen sc1
  v_mfma_f32_32x32x16_bf16 v[72:87], v[104:107], a[136:139], v[72:87]
  v_add_f32 v196, v196, v204
  v_add_f32 v197, v197, v205
  v_add_f32 v198, v198, v206
  v_add_f32 v199, v199, v207
  v_add_f32 v200, v200, v208
  v_add_f32 v201, v201, v209
  v_mfma_f32_32x32x16_bf16 v[88:103], v[104:107], a[140:143], v[88:103]
  v_add_f32 v202, v202, v210
  v_add_f32 v203, v203, v211
  v_cvt_pk_bf16_f32 v128, v196, v197
  v_cvt_pk_bf16_f32 v129, v198, v199
  v_cvt_pk_bf16_f32 v130, v200, v201
  s_waitcnt lgkmcnt(2)
  v_mfma_f32_32x32x16_bf16 v[40:55], v[108:111], a[144:147], v[40:55]
  v_cvt_pk_bf16_f32 v131, v202, v203
  v_mul_f32 v188, v204, v8
  v_mul_f32 v189, v205, v9
  v_fmac_f32 v188, v206, v10
  v_fmac_f32 v189, v207, v11
  v_fmac_f32 v188, v208, v12
  v_mfma_f32_32x32x16_bf16 v[56:71], v[108:111], a[148:151], v[56:71]
  ds_read_b128 v[104:107], v3 offset:10240
  v_fmac_f32 v189, v209, v13
  v_fmac_f32 v188, v210, v14
  v_fmac_f32 v189, v211, v15
  v_add_f32 v188, v188, v189
  buffer_store_dwordx4 v[128:131], v0, s[68:71], s91 offen sc1
  v_mfma_f32_32x32x16_bf16 v[72:87], v[108:111], a[152:155], v[72:87]
  v_add_f32_dpp v188, v188, v188 row_ror:8 row_mask:0xf bank_mask:0xf
  s_nop 1
  v_add_f32_dpp v188, v188, v188 row_ror:4 row_mask:0xf bank_mask:0xf
  s_nop 1
  v_add_f32_dpp v188, v188, v188 row_ror:2 row_mask:0xf bank_mask:0xf
  s_nop 1
  v_add_f32_dpp v188, v188, v188 row_ror:1 row_mask:0xf bank_mask:0xf
  v_mov_b32 v189, v188
  s_nop 0
  s_nop 0
  v_permlane16_swap_b32 v188, v189
  v_mfma_f32_32x32x16_bf16 v[88:103], v[108:111], a[156:159], v[88:103]
  v_add_f32 v188, v188, v189
  v_mov_b32 v189, v188
  s_nop 0
  s_nop 0
  v_permlane32_swap_b32 v188, v189
  v_add_f32 v188, v188, v189
  s_waitcnt lgkmcnt(2)
  v_mfma_f32_32x32x16_bf16 v[40:55], v[112:115], a[160:163], v[40:55]
  v_cvt_pk_bf16_f32 v188, 0, v188
  v_ashrrev_i32 v189, 31, v188
  v_or_b32 v189, 0x80000000, v189
  v_xor_b32 v188, v188, v189
  s_sub_u32 s92, 4095, s90
  v_and_b32 v188, 0xffff0000, v188
  v_mfma_f32_32x32x16_bf16 v[56:71], v[112:115], a[164:167], v[56:71]
  ds_read_b128 v[108:111], v3 offset:10752
  v_or_b32 v38, s92, v188
  s_bfe_u32 s92, s65, 196625
  s_lshl_b32 s92, s92, 18
  s_lshl_b32 s93, s90, 7
  s_add_u32 s92, s92, s93
  v_mfma_f32_32x32x16_bf16 v[72:87], v[112:115], a[168:171], v[72:87]
  s_add_u32 s84, s92, 243269632
  v_mfma_f32_32x32x16_bf16 v[88:103], v[112:115], a[172:175], v[88:103]
  s_waitcnt lgkmcnt(2)
  v_mfma_f32_32x32x16_bf16 v[40:55], v[116:119], a[176:179], v[40:55]
  v_mfma_f32_32x32x16_bf16 v[56:71], v[116:119], a[180:183], v[56:71]
  ds_read_b128 v[112:115], v3 offset:11264
  v_mfma_f32_32x32x16_bf16 v[72:87], v[116:119], a[184:187], v[72:87]
  v_mfma_f32_32x32x16_bf16 v[88:103], v[116:119], a[188:191], v[88:103]
  s_waitcnt lgkmcnt(2)
  v_mfma_f32_32x32x16_bf16 v[40:55], v[104:107], a[192:195], v[40:55]
  v_mfma_f32_32x32x16_bf16 v[56:71], v[104:107], a[196:199], v[56:71]
  ds_read_b128 v[116:119], v3 offset:11776
  s_waitcnt lgkmcnt(2)
  v_mfma_f32_32x32x16_bf16 v[40:55], v[108:111], a[208:211], v[40:55]
  v_mfma_f32_32x32x16_bf16 v[56:71], v[108:111], a[212:215], v[56:71]
  s_waitcnt lgkmcnt(1)
  v_mfma_f32_32x32x16_bf16 v[40:55], v[112:115], a[224:227], v[40:55]
  v_mfma_f32_32x32x16_bf16 v[56:71], v[112:115], a[228:231], v[56:71]
  s_waitcnt lgkmcnt(0)
  v_mfma_f32_32x32x16_bf16 v[40:55], v[116:119], a[240:243], v[40:55]
  v_mfma_f32_32x32x16_bf16 v[56:71], v[116:119], a[244:247], v[56:71]
  v_mfma_f32_32x32x16_bf16 v[72:87], v[104:107], a[200:203], v[72:87]
  v_mfma_f32_32x32x16_bf16 v[88:103], v[104:107], a[204:207], v[88:103]
  v_cvt_pk_bf16_f32 v212, v40, v56
  v_cvt_pk_bf16_f32 v214, v41, v57
  v_cvt_pk_bf16_f32 v216, v42, v58
  v_cvt_pk_bf16_f32 v218, v43, v59
  v_permlane16_swap_b32 v212, v214
  v_mfma_f32_32x32x16_bf16 v[72:87], v[108:111], a[216:219], v[72:87]
  v_cvt_pk_bf16_f32 v220, v44, v60
  v_cvt_pk_bf16_f32 v222, v45, v61
  v_permlane16_swap_b32 v216, v218
  v_bfi_b32 v212, v254, s42, v212
  v_cvt_pk_bf16_f32 v224, v46, v62
  v_mfma_f32_32x32x16_bf16 v[88:103], v[108:111], a[220:223], v[88:103]
  v_cvt_pk_bf16_f32 v226, v47, v63
  v_permlane16_swap_b32 v220, v222
  v_bfi_b32 v216, v254, s42, v216
  v_cvt_pk_bf16_f32 v228, v48, v64
  v_mfma_f32_32x32x16_bf16 v[72:87], v[112:115], a[232:235], v[72:87]
  v_cvt_pk_bf16_f32 v230, v49, v65
  v_permlane16_swap_b32 v224, v226
  v_bfi_b32 v220, v254, s42, v220
  v_cvt_pk_bf16_f32 v232, v50, v66
  v_cvt_pk_bf16_f32 v234, v51, v67
  v_mfma_f32_32x32x16_bf16 v[88:103], v[112:115], a[236:239], v[88:103]
  v_permlane16_swap_b32 v228, v230
  v_bfi_b32 v224, v254, s42, v224
  v_cvt_pk_bf16_f32 v236, v52, v68
  v_cvt_pk_bf16_f32 v238, v53, v69
  v_mfma_f32_32x32x16_bf16 v[72:87], v[116:119], a[248:251], v[72:87]
  v_permlane16_swap_b32 v232, v234
  v_bfi_b32 v228, v254, s42, v228
  v_cvt_pk_bf16_f32 v240, v54, v70
  v_cvt_pk_bf16_f32 v242, v55, v71
  v_permlane16_swap_b32 v236, v238
  v_mfma_f32_32x32x16_bf16 v[88:103], v[116:119], a[252:255], v[88:103]
  v_bfi_b32 v232, v254, s42, v232
  v_permlane16_swap_b32 v240, v242
  v_bfi_b32 v236, v254, s42, v236
  v_bfi_b32 v240, v254, s42, v240
  s_nop 7
  v_cvt_pk_bf16_f32 v213, v72, v88
  v_cvt_pk_bf16_f32 v215, v73, v89
  v_cvt_pk_bf16_f32 v217, v74, v90
  v_cvt_pk_bf16_f32 v219, v75, v91
  s_add_u32 s78, s86, 0
  v_permlane16_swap_b32 v213, v215
  buffer_store_dwordx4 v[212:215], v4, s[4:7], s78 offen
  v_cvt_pk_bf16_f32 v221, v76, v92
  v_cvt_pk_bf16_f32 v223, v77, v93
  s_add_u32 s78, s86, 32768
  v_permlane16_swap_b32 v217, v219
  buffer_store_dwordx4 v[216:219], v4, s[4:7], s78 offen
  v_cvt_pk_bf16_f32 v225, v78, v94
  v_cvt_pk_bf16_f32 v227, v79, v95
  s_add_u32 s78, s86, 131072
  v_permlane16_swap_b32 v221, v223
  buffer_store_dwordx4 v[220:223], v4, s[4:7], s78 offen
  v_cvt_pk_bf16_f32 v229, v80, v96
  v_cvt_pk_bf16_f32 v231, v81, v97
  s_add_u32 s78, s86, 163840
  v_permlane16_swap_b32 v225, v227
  buffer_store_dwordx4 v[224:227], v4, s[4:7], s78 offen
  v_cvt_pk_bf16_f32 v233, v82, v98
  v_cvt_pk_bf16_f32 v235, v83, v99
  s_add_u32 s78, s86, 262144
  v_permlane16_swap_b32 v229, v231
  buffer_store_dwordx4 v[228:231], v4, s[4:7], s78 offen
  v_cvt_pk_bf16_f32 v237, v84, v100
  v_cvt_pk_bf16_f32 v239, v85, v101
  s_add_u32 s78, s86, 294912
  v_permlane16_swap_b32 v233, v235
  buffer_store_dwordx4 v[232:235], v4, s[4:7], s78 offen
  v_cvt_pk_bf16_f32 v241, v86, v102
  v_cvt_pk_bf16_f32 v243, v87, v103
  s_add_u32 s78, s86, 393216
  v_permlane16_swap_b32 v237, v239
  buffer_store_dwordx4 v[236:239], v4, s[4:7], s78 offen
  s_add_u32 s78, s86, 425984
  v_permlane16_swap_b32 v241, v243
  buffer_store_dwordx4 v[240:243], v4, s[4:7], s78 offen
o_we_153:
  v_and_b32 v37, -32, v39
  s_waitcnt lgkmcnt(0)
  s_barrier
  ds_read_b128 v[104:107], v37 offset:16
  s_mov_b32 s65, s63
  s_waitcnt lgkmcnt(0)
  v_and_b32 v104, v104, v106
  v_max_u32 v105, v105, v107
  v_readfirstlane_b32 s26, v104
  v_readfirstlane_b32 s3, v105
  s_and_b32 s66, s26, 1
  s_and_b32 s76, s26, 2
  s_bitcmp1_b32 s26, 2
  s_cselect_b32 s3, s3, 0
  s_cmp_lg_u32 s76, 0
  s_cbranch_scc1 o_nofl_127
  s_and_b32 s26, s63, 49152
  s_cbranch_scc0 o_fl_128
  s_and_b32 s26, s64, s50
  s_cbranch_scc1 o_nofl_127
o_fl_128:
  s_cmp_ge_u32 s17, 2
  s_cbranch_scc1 o_fd_167
  s_cmp_eq_u32 s65, 0
  s_cbranch_scc1 o_fd_167
  s_mov_b32 s96, s42
  s_lshl_b32 s97, s43, 14
  s_add_u32 s97, s97, s86
  buffer_load_dword v7, v255, s[4:7], s97 offen sc1
  s_and_b32 s91, s65, 63
  s_lshl_b32 s90, s91, 5
  s_add_u32 s94, s90, s85
  s_add_u32 s90, s90, s43
  s_lshl_b32 s94, s94, 10
  s_lshr_b32 s92, s65, 22
  s_xor_b32 s93, s43, 32
  s_lshl_b32 s91, s90, 10
  s_add_u32 s94, s94, 25165824
  s_cmp_eq_u32 s92, s93
  s_cselect_b32 s92, s94, s91
  s_add_u32 s92, s92, 10485760
  s_and_b32 s93, s65, 49152
  s_cselect_b32 s92, s92, s91
  s_cselect_b64 s[80:81], s[4:5], s[72:73]
  s_cselect_b32 s82, s6, s74
  buffer_load_dwordx4 v[184:187], v0, s[80:83], s92 offen sc1
  s_mov_b32 s67, 0
  s_mov_b64 vcc, 0
  s_waitcnt vmcnt(1)
o_pl_169:
  v_and_b32 v7, 1, v7
  v_cmp_ne_u32 vcc, s96, v7
  s_cbranch_vccz o_pk_170
  s_mov_b64 exec, 1
  buffer_store_dword v38, off, s[4:7], s84 sc1
  s_mov_b64 exec, -1
  s_mov_b32 s84, 268435456
  buffer_load_dword v7, v255, s[4:7], s97 offen sc1
  s_add_u32 s67, s67, 1
  s_cmp_gt_u32 s67, 1048576
  s_cbranch_scc1 L_end
  s_waitcnt vmcnt(0)
  s_branch o_pl_169
o_pk_170:
  s_and_b32 s26, s65, 49152
  s_cbranch_scc1 o_f2_168
  s_lshl_b32 s94, s43, 14
  s_add_u32 s94, s94, s86
  buffer_load_dwordx4 v[120:123], v5, s[4:7], s94 offen offset:0 sc1
  buffer_load_dwordx4 v[124:127], v5, s[4:7], s94 offen offset:512 sc1
  buffer_load_dwordx4 v[128:131], v5, s[4:7], s94 offen offset:256 sc1
  buffer_load_dwordx4 v[132:135], v5, s[4:7], s94 offen offset:768 sc1
  s_add_u32 s94, s94, 4096
  buffer_load_dwordx4 v[136:139], v5, s[4:7], s94 offen offset:0 sc1
  buffer_load_dwordx4 v[140:143], v5, s[4:7], s94 offen offset:512 sc1
  buffer_load_dwordx4 v[144:147], v5, s[4:7], s94 offen offset:256 sc1
  buffer_load_dwordx4 v[148:151], v5, s[4:7], s94 offen offset:768 sc1
  s_add_u32 s94, s94, 4096
  buffer_load_dwordx4 v[152:155], v5, s[4:7], s94 offen offset:0 sc1
  buffer_load_dwordx4 v[156:159], v5, s[4:7], s94 offen offset:512 sc1
  buffer_load_dwordx4 v[160:163], v5, s[4:7], s94 offen offset:256 sc1
  buffer_load_dwordx4 v[164:167], v5, s[4:7], s94 offen offset:768 sc1
  s_add_u32 s94, s94, 4096
  buffer_load_dwordx4 v[168:171], v5, s[4:7], s94 offen offset:0 sc1
  buffer_load_dwordx4 v[172:175], v5, s[4:7], s94 offen offset:512 sc1
  buffer_load_dwordx4 v[176:179], v5, s[4:7], s94 offen offset:256 sc1
  buffer_load_dwordx4 v[180:183], v5, s[4:7], s94 offen offset:768 sc1
  s_mov_b64 exec, 1
  buffer_store_dword v38, off, s[4:7], s84 sc1
  s_mov_b64 exec, -1
  s_mov_b32 s84, 268435456
  v_mov_b64 v[188:189], 0
  v_mov_b64 v[190:191], 0
  v_mov_b64 v[192:193], 0
  v_mov_b64 v[194:195], 0
  s_waitcnt vmcnt(13)
  v_xor_b32 v7, s96, v120
  v_bitop3_b32 v7, v7, v124, s96 bitop3:0xf6
  v_bitop3_b32 v7, v7, v128, s96 bitop3:0xf6
  v_bitop3_b32 v7, v7, v132, s96 bitop3:0xf6
  s_waitcnt vmcnt(9)
  v_bitop3_b32 v7, v7, v136, s96 bitop3:0xf6
  v_bitop3_b32 v7, v7, v140, s96 bitop3:0xf6
  v_bitop3_b32 v7, v7, v144, s96 bitop3:0xf6
  v_bitop3_b32 v7, v7, v148, s96 bitop3:0xf6
  s_waitcnt vmcnt(5)
  v_bitop3_b32 v7, v7, v152, s96 bitop3:0xf6
  v_bitop3_b32 v7, v7, v156, s96 bitop3:0xf6
  v_bitop3_b32 v7, v7, v160, s96 bitop3:0xf6
  v_bitop3_b32 v7, v7, v164, s96 bitop3:0xf6
  s_waitcnt vmcnt(1)
  v_bitop3_b32 v7, v7, v168, s96 bitop3:0xf6
  v_bitop3_b32 v7, v7, v172, s96 bitop3:0xf6
  v_bitop3_b32 v7, v7, v176, s96 bitop3:0xf6
  v_bitop3_b32 v7, v7, v180, s96 bitop3:0xf6
  v_and_b32 v7, v254, v7
  v_cmp_ne_u32 vcc, 0, v7
  s_cbranch_vccnz o_rt_171
o_bk_172:
  v_smfmac_f32_16x16x64_bf16 v[188:191], v[16:19], v[120:127], v20
  v_lshlrev_b32 v196, 16, v184
  v_smfmac_f32_16x16x64_bf16 v[192:195], v[16:19], v[128:135], v20
  v_and_b32 v197, 0xffff0000, v184
  v_smfmac_f32_16x16x64_bf16 v[188:191], v[16:19], v[136:143], v20
  v_lshlrev_b32 v198, 16, v185
  v_smfmac_f32_16x16x64_bf16 v[192:195], v[16:19], v[144:151], v20
  v_and_b32 v199, 0xffff0000, v185
  v_smfmac_f32_16x16x64_bf16 v[188:191], v[16:19], v[152:159], v20
  v_lshlrev_b32 v200, 16, v186
  v_smfmac_f32_16x16x64_bf16 v[192:195], v[16:19], v[160:167], v20
  v_and_b32 v201, 0xffff0000, v186
  v_smfmac_f32_16x16x64_bf16 v[188:191], v[16:19], v[168:175], v20
  v_lshlrev_b32 v202, 16, v187
  v_smfmac_f32_16x16x64_bf16 v[192:195], v[16:19], v[176:183], v20
  v_and_b32 v203, 0xffff0000, v187
  s_bfe_u32 s92, s65, 131086
  s_lshl_b32 s92, s92, 21
  s_add_u32 s92, s92, s91
  s_add_u32 s93, s92, 27262976
  s_add_u32 s92, s92, 20971520
  s_nop 1
  v_permlane16_swap_b32 v188, v192
  v_permlane16_swap_b32 v189, v193
  v_permlane16_swap_b32 v190, v194
  v_permlane16_swap_b32 v191, v195
  v_cvt_pk_bf16_f32 v188, 0, v188
  v_cvt_pk_bf16_f32 v189, 0, v189
  v_cvt_pk_bf16_f32 v190, 0, v190
  v_cvt_pk_bf16_f32 v191, 0, v191
  v_cvt_pk_bf16_f32 v192, 0, v192
  v_cvt_pk_bf16_f32 v193, 0, v193
  v_cvt_pk_bf16_f32 v194, 0, v194
  v_cvt_pk_bf16_f32 v195, 0, v195
  v_add_f32 v196, v196, v188
  v_add_f32 v197, v197, v189
  v_add_f32 v198, v198, v190
  v_add_f32 v199, v199, v191
  v_add_f32 v200, v200, v192
  v_add_f32 v201, v201, v193
  v_add_f32 v202, v202, v194
  v_add_f32 v203, v203, v195
  v_cvt_pk_bf16_f32 v120, v196, v197
  v_cvt_pk_bf16_f32 v121, v198, v199
  v_cvt_pk_bf16_f32 v122, v200, v201
  v_cvt_pk_bf16_f32 v123, v202, v203
  v_lshlrev_b32 v196, 16, v120
  v_and_b32 v197, 0xffff0000, v120
  v_lshlrev_b32 v198, 16, v121
  v_and_b32 v199, 0xffff0000, v121
  v_lshlrev_b32 v200, 16, v122
  v_and_b32 v201, 0xffff0000, v122
  v_lshlrev_b32 v202, 16, v123
  v_and_b32 v203, 0xffff0000, v123
  buffer_store_dwordx4 v[120:123], v0, s[4:7], s92 offen sc1
  v_add_f32 v136, v196, v197
  v_mul_f32 v137, v196, v196
  v_add_f32 v138, v198, v199
  v_mul_f32 v139, v197, v197
  v_fmac_f32 v137, v198, v198
  v_fmac_f32 v139, v199, v199
  v_add_f32 v136, v136, v200
  v_fmac_f32 v137, v200, v200
  v_add_f32 v138, v138, v201
  v_fmac_f32 v139, v201, v201
  v_add_f32 v136, v136, v202
  v_fmac_f32 v137, v202, v202
  v_add_f32 v138, v138, v203
  v_fmac_f32 v139, v203, v203
  v_add_f32 v136, v136, v138
  v_add_f32 v137, v137, v139
  s_nop 0
  v_add_f32_dpp v136, v136, v136 row_ror:8 row_mask:0xf bank_mask:0xf
  v_add_f32_dpp v137, v137, v137 row_ror:8 row_mask:0xf bank_mask:0xf
  s_nop 0
  v_add_f32_dpp v136, v136, v136 row_ror:4 row_mask:0xf bank_mask:0xf
  v_add_f32_dpp v137, v137, v137 row_ror:4 row_mask:0xf bank_mask:0xf
  s_nop 0
  v_add_f32_dpp v136, v136, v136 row_ror:2 row_mask:0xf bank_mask:0xf
  v_add_f32_dpp v137, v137, v137 row_ror:2 row_mask:0xf bank_mask:0xf
  s_nop 0
  v_add_f32_dpp v136, v136, v136 row_ror:1 row_mask:0xf bank_mask:0xf
  v_add_f32_dpp v137, v137, v137 row_ror:1 row_mask:0xf bank_mask:0xf
  v_mov_b32 v140, v136
  v_mov_b32 v141, v137
  s_nop 0
  v_permlane16_swap_b32 v136, v140
  v_permlane16_swap_b32 v137, v141
  v_add_f32 v136, v136, v140
  v_add_f32 v137, v137, v141
  v_mov_b32 v140, v136
  v_mov_b32 v141, v137
  s_nop 0
  v_permlane32_swap_b32 v136, v140
  v_permlane32_swap_b32 v137, v141
  v_add_f32 v136, v136, v140
  v_add_f32 v137, v137, v141
  v_mul_f32 v136, 0x3b000000, v136
  v_mul_f32 v137, 0x3b000000, v137
  v_fma_f32 v137, -v136, v136, v137
  v_cvt_pk_bf16_f32 v136, 0, v136
  v_max_f32 v137, 0, v137
  v_sub_f32 v140, v196, v136
  v_sub_f32 v141, v197, v136
  v_cvt_pk_bf16_f32 v137, 0, v137
  v_sub_f32 v142, v198, v136
  v_sub_f32 v143, v199, v136
  v_add_f32 v137, 0x3727c5ac, v137
  v_sub_f32 v144, v200, v136
  v_sub_f32 v145, v201, v136
  v_cvt_pk_bf16_f32 v137, 0, v137
  v_sub_f32 v146, v202, v136
  v_sub_f32 v147, v203, v136
  v_sqrt_f32 v137, v137
  v_cvt_pk_bf16_f32 v140, 0, v140
  v_cvt_pk_bf16_f32 v141, 0, v141
  v_cvt_pk_bf16_f32 v137, 0, v137
  v_cvt_pk_bf16_f32 v142, 0, v142
  v_cvt_pk_bf16_f32 v143, 0, v143
  v_rcp_f32 v137, v137
  v_cvt_pk_bf16_f32 v144, 0, v144
  v_cvt_pk_bf16_f32 v145, 0, v145
  v_cvt_pk_bf16_f32 v146, 0, v146
  v_cvt_pk_bf16_f32 v147, 0, v147
  v_mul_f32 v140, v140, v137
  v_mul_f32 v141, v141, v137
  v_mul_f32 v142, v142, v137
  v_mul_f32 v143, v143, v137
  v_mul_f32 v144, v144, v137
  v_mul_f32 v145, v145, v137
  v_mul_f32 v146, v146, v137
  v_mul_f32 v147, v147, v137
  v_cvt_pk_bf16_f32 v124, v140, v141
  v_cvt_pk_bf16_f32 v125, v142, v143
  v_cvt_pk_bf16_f32 v126, v144, v145
  v_cvt_pk_bf16_f32 v127, v146, v147
  v_lshlrev_b32 v204, 16, v124
  v_and_b32 v205, 0xffff0000, v124
  v_lshlrev_b32 v206, 16, v125
  v_and_b32 v207, 0xffff0000, v125
  v_lshlrev_b32 v208, 16, v126
  v_and_b32 v209, 0xffff0000, v126
  v_lshlrev_b32 v210, 16, v127
  v_and_b32 v211, 0xffff0000, v127
  buffer_store_dwordx4 v[124:127], v0, s[4:7], s93 offen sc1
  v_add_f32 v196, v196, v204
  v_add_f32 v197, v197, v205
  v_add_f32 v198, v198, v206
  v_add_f32 v199, v199, v207
  v_add_f32 v200, v200, v208
  v_add_f32 v201, v201, v209
  v_add_f32 v202, v202, v210
  v_add_f32 v203, v203, v211
  v_cvt_pk_bf16_f32 v128, v196, v197
  v_cvt_pk_bf16_f32 v129, v198, v199
  v_cvt_pk_bf16_f32 v130, v200, v201
  v_cvt_pk_bf16_f32 v131, v202, v203
  v_mul_f32 v188, v204, v8
  v_mul_f32 v189, v205, v9
  v_fmac_f32 v188, v206, v10
  v_fmac_f32 v189, v207, v11
  v_fmac_f32 v188, v208, v12
  v_fmac_f32 v189, v209, v13
  v_fmac_f32 v188, v210, v14
  v_fmac_f32 v189, v211, v15
  v_add_f32 v188, v188, v189
  s_add_u32 s92, s91, 10485760
  s_add_u32 s93, s91, 8388608
  buffer_store_dwordx4 v[128:131], v0, s[4:7], s92 offen sc1
  v_lshlrev_b32 v196, 16, v128
  v_and_b32 v197, 0xffff0000, v128
  v_lshlrev_b32 v198, 16, v129
  v_and_b32 v199, 0xffff0000, v129
  v_lshlrev_b32 v200, 16, v130
  v_and_b32 v201, 0xffff0000, v130
  v_lshlrev_b32 v202, 16, v131
  v_and_b32 v203, 0xffff0000, v131
  v_add_f32 v136, v196, v197
  v_mul_f32 v137, v196, v196
  v_add_f32 v138, v198, v199
  v_mul_f32 v139, v197, v197
  v_fmac_f32 v137, v198, v198
  v_fmac_f32 v139, v199, v199
  v_add_f32 v136, v136, v200
  v_fmac_f32 v137, v200, v200
  v_add_f32 v138, v138, v201
  v_fmac_f32 v139, v201, v201
  v_add_f32 v136, v136, v202
  v_fmac_f32 v137, v202, v202
  v_add_f32 v138, v138, v203
  v_fmac_f32 v139, v203, v203
  v_add_f32 v136, v136, v138
  v_add_f32 v137, v137, v139
  s_nop 0
  v_add_f32_dpp v136, v136, v136 row_ror:8 row_mask:0xf bank_mask:0xf
  v_add_f32_dpp v137, v137, v137 row_ror:8 row_mask:0xf bank_mask:0xf
  v_add_f32_dpp v188, v188, v188 row_ror:8 row_mask:0xf bank_mask:0xf
  v_add_f32_dpp v136, v136, v136 row_ror:4 row_mask:0xf bank_mask:0xf
  v_add_f32_dpp v137, v137, v137 row_ror:4 row_mask:0xf bank_mask:0xf
  v_add_f32_dpp v188, v188, v188 row_ror:4 row_mask:0xf bank_mask:0xf
  v_add_f32_dpp v136, v136, v136 row_ror:2 row_mask:0xf bank_mask:0xf
  v_add_f32_dpp v137, v137, v137 row_ror:2 row_mask:0xf bank_mask:0xf
  v_add_f32_dpp v188, v188, v188 row_ror:2 row_mask:0xf bank_mask:0xf
  v_add_f32_dpp v136, v136, v136 row_ror:1 row_mask:0xf bank_mask:0xf
  v_add_f32_dpp v137, v137, v137 row_ror:1 row_mask:0xf bank_mask:0xf
  v_add_f32_dpp v188, v188, v188 row_ror:1 row_mask:0xf bank_mask:0xf
  v_mov_b32 v140, v136
  v_mov_b32 v141, v137
  v_mov_b32 v142, v188
  v_permlane16_swap_b32 v136, v140
  v_permlane16_swap_b32 v137, v141
  v_permlane16_swap_b32 v188, v142
  v_add_f32 v136, v136, v140
  v_add_f32 v137, v137, v141
  v_add_f32 v188, v188, v142
  v_mov_b32 v140, v136
  v_mov_b32 v141, v137
  v_mov_b32 v142, v188
  v_permlane32_swap_b32 v136, v140
  v_permlane32_swap_b32 v137, v141
  v_permlane32_swap_b32 v188, v142
  v_add_f32 v136, v136, v140
  v_add_f32 v137, v137, v141
  v_add_f32 v188, v188, v142
  v_mul_f32 v136, 0x3b000000, v136
  v_mul_f32 v137, 0x3b000000, v137
  v_fma_f32 v137, -v136, v136, v137
  v_cvt_pk_bf16_f32 v136, 0, v136
  v_max_f32 v137, 0, v137
  v_sub_f32 v140, v196, v136
  v_sub_f32 v141, v197, v136
  v_cvt_pk_bf16_f32 v137, 0, v137
  v_sub_f32 v142, v198, v136
  v_sub_f32 v143, v199, v136
  v_add_f32 v137, 0x3727c5ac, v137
  v_sub_f32 v144, v200, v136
  v_sub_f32 v145, v201, v136
  v_cvt_pk_bf16_f32 v137, 0, v137
  v_sub_f32 v146, v202, v136
  v_sub_f32 v147, v203, v136
  v_sqrt_f32 v137, v137
  v_cvt_pk_bf16_f32 v140, 0, v140
  v_cvt_pk_bf16_f32 v141, 0, v141
  v_cvt_pk_bf16_f32 v137, 0, v137
  v_cvt_pk_bf16_f32 v142, 0, v142
  v_cvt_pk_bf16_f32 v143, 0, v143
  v_rcp_f32 v137, v137
  v_cvt_pk_bf16_f32 v144, 0, v144
  v_cvt_pk_bf16_f32 v145, 0, v145
  v_cvt_pk_bf16_f32 v146, 0, v146
  v_cvt_pk_bf16_f32 v147, 0, v147
  v_mul_f32 v140, v140, v137
  v_mul_f32 v141, v141, v137
  v_mul_f32 v142, v142, v137
  v_mul_f32 v143, v143, v137
  v_mul_f32 v144, v144, v137
  v_mul_f32 v145, v145, v137
  v_mul_f32 v146, v146, v137
  v_mul_f32 v147, v147, v137
  v_cvt_pk_bf16_f32 v132, v140, v141
  v_cvt_pk_bf16_f32 v133, v142, v143
  v_cvt_pk_bf16_f32 v134, v144, v145
  v_cvt_pk_bf16_f32 v135, v146, v147
  buffer_store_dwordx4 v[132:135], v0, s[4:7], s93 offen sc1
  v_cvt_pk_bf16_f32 v188, 0, v188
  v_ashrrev_i32 v189, 31, v188
  v_or_b32 v189, 0x80000000, v189
  v_xor_b32 v188, v188, v189
  s_sub_u32 s92, 4095, s90
  v_and_b32 v188, 0xffff0000, v188
  v_or_b32 v38, s92, v188
  s_bfe_u32 s92, s65, 196625
  s_lshl_b32 s92, s92, 18
  s_lshl_b32 s93, s90, 7
  s_add_u32 s92, s92, s93
  s_add_u32 s84, s92, 243269632
  s_waitcnt vmcnt(0)
  s_mov_b64 exec, 1
  buffer_store_dword v38, off, s[4:7], s84 sc1
  s_mov_b64 exec, -1
  s_mov_b32 s84, 268435456
  s_branch o_fd_167
o_rt_171:
  s_mov_b32 s67, 0
o_rl_173:
  s_lshl_b32 s94, s43, 14
  s_add_u32 s94, s94, s86
  buffer_load_dwordx4 v[120:123], v5, s[4:7], s94 offen offset:0 sc1
  buffer_load_dwordx4 v[124:127], v5, s[4:7], s94 offen offset:512 sc1
  buffer_load_dwordx4 v[128:131], v5, s[4:7], s94 offen offset:256 sc1
  buffer_load_dwordx4 v[132:135], v5, s[4:7], s94 offen offset:768 sc1
  s_add_u32 s94, s94, 4096
  buffer_load_dwordx4 v[136:139], v5, s[4:7], s94 offen offset:0 sc1
  buffer_load_dwordx4 v[140:143], v5, s[4:7], s94 offen offset:512 sc1
  buffer_load_dwordx4 v[144:147], v5, s[4:7], s94 offen offset:256 sc1
  buffer_load_dwordx4 v[148:151], v5, s[4:7], s94 offen offset:768 sc1
  s_add_u32 s94, s94, 4096
  buffer_load_dwordx4 v[152:155], v5, s[4:7], s94 offen offset:0 sc1
  buffer_load_dwordx4 v[156:159], v5, s[4:7], s94 offen offset:512 sc1
  buffer_load_dwordx4 v[160:163], v5, s[4:7], s94 offen offset:256 sc1
  buffer_load_dwordx4 v[164:167], v5, s[4:7], s94 offen offset:768 sc1
  s_add_u32 s94, s94, 4096
  buffer_load_dwordx4 v[168:171], v5, s[4:7], s94 offen offset:0 sc1
  buffer_load_dwordx4 v[172:175], v5, s[4:7], s94 offen offset:512 sc1
  buffer_load_dwordx4 v[176:179], v5, s[4:7], s94 offen offset:256 sc1
  buffer_load_dwordx4 v[180:183], v5, s[4:7], s94 offen offset:768 sc1
  s_add_u32 s67, s67, 1
  s_cmp_gt_u32 s67, 1048576
  s_cbranch_scc1 L_end
  s_waitcnt vmcnt(0)
  v_xor_b32 v7, s96, v120
  v_bitop3_b32 v7, v7, v124, s96 bitop3:0xf6
  v_bitop3_b32 v7, v7, v128, s96 bitop3:0xf6
  v_bitop3_b32 v7, v7, v132, s96 bitop3:0xf6
  v_bitop3_b32 v7, v7, v136, s96 bitop3:0xf6
  v_bitop3_b32 v7, v7, v140, s96 bitop3:0xf6
  v_bitop3_b32 v7, v7, v144, s96 bitop3:0xf6
  v_bitop3_b32 v7, v7, v148, s96 bitop3:0xf6
  v_bitop3_b32 v7, v7, v152, s96 bitop3:0xf6
  v_bitop3_b32 v7, v7, v156, s96 bitop3:0xf6
  v_bitop3_b32 v7, v7, v160, s96 bitop3:0xf6
  v_bitop3_b32 v7, v7, v164, s96 bitop3:0xf6
  v_bitop3_b32 v7, v7, v168, s96 bitop3:0xf6
  v_bitop3_b32 v7, v7, v172, s96 bitop3:0xf6
  v_bitop3_b32 v7, v7, v176, s96 bitop3:0xf6
  v_bitop3_b32 v7, v7, v180, s96 bitop3:0xf6
  v_and_b32 v7, v254, v7
  v_cmp_ne_u32 vcc, 0, v7
  s_cbranch_vccnz o_rl_173
  s_branch o_bk_172
o_f2_168:
  s_lshl_b32 s94, s43, 14
  s_add_u32 s94, s94, s86
  buffer_load_dwordx4 v[120:123], v5, s[4:7], s94 offen offset:0 sc1
  buffer_load_dwordx4 v[124:127], v5, s[4:7], s94 offen offset:512 sc1
  buffer_load_dwordx4 v[128:131], v5, s[4:7], s94 offen offset:256 sc1
  buffer_load_dwordx4 v[132:135], v5, s[4:7], s94 offen offset:768 sc1
  s_add_u32 s94, s94, 4096
  buffer_load_dwordx4 v[136:139], v5, s[4:7], s94 offen offset:0 sc1
  buffer_load_dwordx4 v[140:143], v5, s[4:7], s94 offen offset:512 sc1
  buffer_load_dwordx4 v[144:147], v5, s[4:7], s94 offen offset:256 sc1
  buffer_load_dwordx4 v[148:151], v5, s[4:7], s94 offen offset:768 sc1
  s_add_u32 s94, s94, 4096
  buffer_load_dwordx4 v[152:155], v5, s[4:7], s94 offen offset:0 sc1
  buffer_load_dwordx4 v[156:159], v5, s[4:7], s94 offen offset:512 sc1
  buffer_load_dwordx4 v[160:163], v5, s[4:7], s94 offen offset:256 sc1
  buffer_load_dwordx4 v[164:167], v5, s[4:7], s94 offen offset:768 sc1
  s_add_u32 s94, s94, 4096
  buffer_load_dwordx4 v[168:171], v5, s[4:7], s94 offen offset:0 sc1
  buffer_load_dwordx4 v[172:175], v5, s[4:7], s94 offen offset:512 sc1
  buffer_load_dwordx4 v[176:179], v5, s[4:7], s94 offen offset:256 sc1
  buffer_load_dwordx4 v[180:183], v5, s[4:7], s94 offen offset:768 sc1
  s_mov_b64 exec, 1
  buffer_store_dword v38, off, s[4:7], s84 sc1
  s_mov_b64 exec, -1
  s_mov_b32 s84, 268435456
  v_mov_b64 v[188:189], 0
  v_mov_b64 v[190:191], 0
  v_mov_b64 v[192:193], 0
  v_mov_b64 v[194:195], 0
  s_waitcnt vmcnt(13)
  v_xor_b32 v7, s96, v120
  v_bitop3_b32 v7, v7, v124, s96 bitop3:0xf6
  v_bitop3_b32 v7, v7, v128, s96 bitop3:0xf6
  v_bitop3_b32 v7, v7, v132, s96 bitop3:0xf6
  s_waitcnt vmcnt(9)
  v_bitop3_b32 v7, v7, v136, s96 bitop3:0xf6
  v_bitop3_b32 v7, v7, v140, s96 bitop3:0xf6
  v_bitop3_b32 v7, v7, v144, s96 bitop3:0xf6
  v_bitop3_b32 v7, v7, v148, s96 bitop3:0xf6
  s_waitcnt vmcnt(5)
  v_bitop3_b32 v7, v7, v152, s96 bitop3:0xf6
  v_bitop3_b32 v7, v7, v156, s96 bitop3:0xf6
  v_bitop3_b32 v7, v7, v160, s96 bitop3:0xf6
  v_bitop3_b32 v7, v7, v164, s96 bitop3:0xf6
  s_waitcnt vmcnt(1)
  v_bitop3_b32 v7, v7, v168, s96 bitop3:0xf6
  v_bitop3_b32 v7, v7, v172, s96 bitop3:0xf6
  v_bitop3_b32 v7, v7, v176, s96 bitop3:0xf6
  v_bitop3_b32 v7, v7, v180, s96 bitop3:0xf6
  v_and_b32 v7, v254, v7
  v_cmp_ne_u32 vcc, 0, v7
  s_cbranch_vccnz o_rt_174
o_bk_175:
  v_smfmac_f32_16x16x64_bf16 v[188:191], v[16:19], v[120:127], v20
  v_lshlrev_b32 v196, 16, v184
  v_smfmac_f32_16x16x64_bf16 v[192:195], v[16:19], v[128:135], v20
  v_and_b32 v197, 0xffff0000, v184
  v_smfmac_f32_16x16x64_bf16 v[188:191], v[16:19], v[136:143], v20
  v_lshlrev_b32 v198, 16, v185
  v_smfmac_f32_16x16x64_bf16 v[192:195], v[16:19], v[144:151], v20
  v_and_b32 v199, 0xffff0000, v185
  v_smfmac_f32_16x16x64_bf16 v[188:191], v[16:19], v[152:159], v20
  v_lshlrev_b32 v200, 16, v186
  v_smfmac_f32_16x16x64_bf16 v[192:195], v[16:19], v[160:167], v20
  v_and_b32 v201, 0xffff0000, v186
  v_smfmac_f32_16x16x64_bf16 v[188:191], v[16:19], v[168:175], v20
  v_lshlrev_b32 v202, 16, v187
  v_smfmac_f32_16x16x64_bf16 v[192:195], v[16:19], v[176:183], v20
  v_and_b32 v203, 0xffff0000, v187
  s_bfe_u32 s92, s65, 131086
  s_lshl_b32 s92, s92, 21
  s_add_u32 s92, s92, s91
  s_add_u32 s93, s92, 27262976
  s_add_u32 s92, s92, 20971520
  s_nop 1
  v_permlane16_swap_b32 v188, v192
  v_permlane16_swap_b32 v189, v193
  v_permlane16_swap_b32 v190, v194
  v_permlane16_swap_b32 v191, v195
  v_cvt_pk_bf16_f32 v188, 0, v188
  v_cvt_pk_bf16_f32 v189, 0, v189
  v_cvt_pk_bf16_f32 v190, 0, v190
  v_cvt_pk_bf16_f32 v191, 0, v191
  v_cvt_pk_bf16_f32 v192, 0, v192
  v_cvt_pk_bf16_f32 v193, 0, v193
  v_cvt_pk_bf16_f32 v194, 0, v194
  v_cvt_pk_bf16_f32 v195, 0, v195
  v_add_f32 v196, v196, v188
  v_add_f32 v197, v197, v189
  v_add_f32 v198, v198, v190
  v_add_f32 v199, v199, v191
  v_add_f32 v200, v200, v192
  v_add_f32 v201, v201, v193
  v_add_f32 v202, v202, v194
  v_add_f32 v203, v203, v195
  v_cvt_pk_bf16_f32 v120, v196, v197
  v_cvt_pk_bf16_f32 v121, v198, v199
  v_cvt_pk_bf16_f32 v122, v200, v201
  v_cvt_pk_bf16_f32 v123, v202, v203
  v_lshlrev_b32 v196, 16, v120
  v_and_b32 v197, 0xffff0000, v120
  v_lshlrev_b32 v198, 16, v121
  v_and_b32 v199, 0xffff0000, v121
  v_lshlrev_b32 v200, 16, v122
  v_and_b32 v201, 0xffff0000, v122
  v_lshlrev_b32 v202, 16, v123
  v_and_b32 v203, 0xffff0000, v123
  buffer_store_dwordx4 v[120:123], v0, s[4:7], s92 offen sc1
  v_add_f32 v136, v196, v197
  v_mul_f32 v137, v196, v196
  v_add_f32 v138, v198, v199
  v_mul_f32 v139, v197, v197
  v_fmac_f32 v137, v198, v198
  v_fmac_f32 v139, v199, v199
  v_add_f32 v136, v136, v200
  v_fmac_f32 v137, v200, v200
  v_add_f32 v138, v138, v201
  v_fmac_f32 v139, v201, v201
  v_add_f32 v136, v136, v202
  v_fmac_f32 v137, v202, v202
  v_add_f32 v138, v138, v203
  v_fmac_f32 v139, v203, v203
  v_add_f32 v136, v136, v138
  v_add_f32 v137, v137, v139
  s_nop 0
  v_add_f32_dpp v136, v136, v136 row_ror:8 row_mask:0xf bank_mask:0xf
  v_add_f32_dpp v137, v137, v137 row_ror:8 row_mask:0xf bank_mask:0xf
  s_nop 0
  v_add_f32_dpp v136, v136, v136 row_ror:4 row_mask:0xf bank_mask:0xf
  v_add_f32_dpp v137, v137, v137 row_ror:4 row_mask:0xf bank_mask:0xf
  s_nop 0
  v_add_f32_dpp v136, v136, v136 row_ror:2 row_mask:0xf bank_mask:0xf
  v_add_f32_dpp v137, v137, v137 row_ror:2 row_mask:0xf bank_mask:0xf
  s_nop 0
  v_add_f32_dpp v136, v136, v136 row_ror:1 row_mask:0xf bank_mask:0xf
  v_add_f32_dpp v137, v137, v137 row_ror:1 row_mask:0xf bank_mask:0xf
  v_mov_b32 v140, v136
  v_mov_b32 v141, v137
  s_nop 0
  v_permlane16_swap_b32 v136, v140
  v_permlane16_swap_b32 v137, v141
  v_add_f32 v136, v136, v140
  v_add_f32 v137, v137, v141
  v_mov_b32 v140, v136
  v_mov_b32 v141, v137
  s_nop 0
  v_permlane32_swap_b32 v136, v140
  v_permlane32_swap_b32 v137, v141
  v_add_f32 v136, v136, v140
  v_add_f32 v137, v137, v141
  v_mul_f32 v136, 0x3b000000, v136
  v_mul_f32 v137, 0x3b000000, v137
  v_fma_f32 v137, -v136, v136, v137
  v_cvt_pk_bf16_f32 v136, 0, v136
  v_max_f32 v137, 0, v137
  v_sub_f32 v140, v196, v136
  v_sub_f32 v141, v197, v136
  v_cvt_pk_bf16_f32 v137, 0, v137
  v_sub_f32 v142, v198, v136
  v_sub_f32 v143, v199, v136
  v_add_f32 v137, 0x3727c5ac, v137
  v_sub_f32 v144, v200, v136
  v_sub_f32 v145, v201, v136
  v_cvt_pk_bf16_f32 v137, 0, v137
  v_sub_f32 v146, v202, v136
  v_sub_f32 v147, v203, v136
  v_sqrt_f32 v137, v137
  v_cvt_pk_bf16_f32 v140, 0, v140
  v_cvt_pk_bf16_f32 v141, 0, v141
  v_cvt_pk_bf16_f32 v137, 0, v137
  v_cvt_pk_bf16_f32 v142, 0, v142
  v_cvt_pk_bf16_f32 v143, 0, v143
  v_rcp_f32 v137, v137
  v_cvt_pk_bf16_f32 v144, 0, v144
  v_cvt_pk_bf16_f32 v145, 0, v145
  v_cvt_pk_bf16_f32 v146, 0, v146
  v_cvt_pk_bf16_f32 v147, 0, v147
  v_mul_f32 v140, v140, v137
  v_mul_f32 v141, v141, v137
  v_mul_f32 v142, v142, v137
  v_mul_f32 v143, v143, v137
  v_mul_f32 v144, v144, v137
  v_mul_f32 v145, v145, v137
  v_mul_f32 v146, v146, v137
  v_mul_f32 v147, v147, v137
  v_cvt_pk_bf16_f32 v124, v140, v141
  v_cvt_pk_bf16_f32 v125, v142, v143
  v_cvt_pk_bf16_f32 v126, v144, v145
  v_cvt_pk_bf16_f32 v127, v146, v147
  v_lshlrev_b32 v204, 16, v124
  v_and_b32 v205, 0xffff0000, v124
  v_lshlrev_b32 v206, 16, v125
  v_and_b32 v207, 0xffff0000, v125
  v_lshlrev_b32 v208, 16, v126
  v_and_b32 v209, 0xffff0000, v126
  v_lshlrev_b32 v210, 16, v127
  v_and_b32 v211, 0xffff0000, v127
  buffer_store_dwordx4 v[124:127], v0, s[4:7], s93 offen sc1
  v_add_f32 v196, v196, v204
  v_add_f32 v197, v197, v205
  v_add_f32 v198, v198, v206
  v_add_f32 v199, v199, v207
  v_add_f32 v200, v200, v208
  v_add_f32 v201, v201, v209
  v_add_f32 v202, v202, v210
  v_add_f32 v203, v203, v211
  v_cvt_pk_bf16_f32 v128, v196, v197
  v_cvt_pk_bf16_f32 v129, v198, v199
  v_cvt_pk_bf16_f32 v130, v200, v201
  v_cvt_pk_bf16_f32 v131, v202, v203
  v_mul_f32 v188, v204, v8
  v_mul_f32 v189, v205, v9
  v_fmac_f32 v188, v206, v10
  v_fmac_f32 v189, v207, v11
  v_fmac_f32 v188, v208, v12
  v_fmac_f32 v189, v209, v13
  v_fmac_f32 v188, v210, v14
  v_fmac_f32 v189, v211, v15
  v_add_f32 v188, v188, v189
  buffer_store_dwordx4 v[128:131], v0, s[68:71], s91 offen sc1
  s_nop 0
  v_add_f32_dpp v188, v188, v188 row_ror:8 row_mask:0xf bank_mask:0xf
  s_nop 1
  v_add_f32_dpp v188, v188, v188 row_ror:4 row_mask:0xf bank_mask:0xf
  s_nop 1
  v_add_f32_dpp v188, v188, v188 row_ror:2 row_mask:0xf bank_mask:0xf
  s_nop 1
  v_add_f32_dpp v188, v188, v188 row_ror:1 row_mask:0xf bank_mask:0xf
  v_mov_b32 v189, v188
  s_nop 0
  s_nop 0
  v_permlane16_swap_b32 v188, v189
  v_add_f32 v188, v188, v189
  v_mov_b32 v189, v188
  s_nop 0
  s_nop 0
  v_permlane32_swap_b32 v188, v189
  v_add_f32 v188, v188, v189
  v_cvt_pk_bf16_f32 v188, 0, v188
  v_ashrrev_i32 v189, 31, v188
  v_or_b32 v189, 0x80000000, v189
  v_xor_b32 v188, v188, v189
  s_sub_u32 s92, 4095, s90
  v_and_b32 v188, 0xffff0000, v188
  v_or_b32 v38, s92, v188
  s_bfe_u32 s92, s65, 196625
  s_lshl_b32 s92, s92, 18
  s_lshl_b32 s93, s90, 7
  s_add_u32 s92, s92, s93
  s_add_u32 s84, s92, 243269632
  s_waitcnt vmcnt(0)
  s_mov_b64 exec, 1
  buffer_store_dword v38, off, s[4:7], s84 sc1
  s_mov_b64 exec, -1
  s_mov_b32 s84, 268435456
  s_branch o_fd_167
o_rt_174:
  s_mov_b32 s67, 0
o_rl_176:
  s_lshl_b32 s94, s43, 14
  s_add_u32 s94, s94, s86
  buffer_load_dwordx4 v[120:123], v5, s[4:7], s94 offen offset:0 sc1
  buffer_load_dwordx4 v[124:127], v5, s[4:7], s94 offen offset:512 sc1
  buffer_load_dwordx4 v[128:131], v5, s[4:7], s94 offen offset:256 sc1
  buffer_load_dwordx4 v[132:135], v5, s[4:7], s94 offen offset:768 sc1
  s_add_u32 s94, s94, 4096
  buffer_load_dwordx4 v[136:139], v5, s[4:7], s94 offen offset:0 sc1
  buffer_load_dwordx4 v[140:143], v5, s[4:7], s94 offen offset:512 sc1
  buffer_load_dwordx4 v[144:147], v5, s[4:7], s94 offen offset:256 sc1
  buffer_load_dwordx4 v[148:151], v5, s[4:7], s94 offen offset:768 sc1
  s_add_u32 s94, s94, 4096
  buffer_load_dwordx4 v[152:155], v5, s[4:7], s94 offen offset:0 sc1
  buffer_load_dwordx4 v[156:159], v5, s[4:7], s94 offen offset:512 sc1
  buffer_load_dwordx4 v[160:163], v5, s[4:7], s94 offen offset:256 sc1
  buffer_load_dwordx4 v[164:167], v5, s[4:7], s94 offen offset:768 sc1
  s_add_u32 s94, s94, 4096
  buffer_load_dwordx4 v[168:171], v5, s[4:7], s94 offen offset:0 sc1
  buffer_load_dwordx4 v[172:175], v5, s[4:7], s94 offen offset:512 sc1
  buffer_load_dwordx4 v[176:179], v5, s[4:7], s94 offen offset:256 sc1
  buffer_load_dwordx4 v[180:183], v5, s[4:7], s94 offen offset:768 sc1
  s_add_u32 s67, s67, 1
  s_cmp_gt_u32 s67, 1048576
  s_cbranch_scc1 L_end
  s_waitcnt vmcnt(0)
  v_xor_b32 v7, s96, v120
  v_bitop3_b32 v7, v7, v124, s96 bitop3:0xf6
  v_bitop3_b32 v7, v7, v128, s96 bitop3:0xf6
  v_bitop3_b32 v7, v7, v132, s96 bitop3:0xf6
  v_bitop3_b32 v7, v7, v136, s96 bitop3:0xf6
  v_bitop3_b32 v7, v7, v140, s96 bitop3:0xf6
  v_bitop3_b32 v7, v7, v144, s96 bitop3:0xf6
  v_bitop3_b32 v7, v7, v148, s96 bitop3:0xf6
  v_bitop3_b32 v7, v7, v152, s96 bitop3:0xf6
  v_bitop3_b32 v7, v7, v156, s96 bitop3:0xf6
  v_bitop3_b32 v7, v7, v160, s96 bitop3:0xf6
  v_bitop3_b32 v7, v7, v164, s96 bitop3:0xf6
  v_bitop3_b32 v7, v7, v168, s96 bitop3:0xf6
  v_bitop3_b32 v7, v7, v172, s96 bitop3:0xf6
  v_bitop3_b32 v7, v7, v176, s96 bitop3:0xf6
  v_bitop3_b32 v7, v7, v180, s96 bitop3:0xf6
  v_and_b32 v7, v254, v7
  v_cmp_ne_u32 vcc, 0, v7
  s_cbranch_vccnz o_rl_176
  s_branch o_bk_175
o_fd_167:
  s_mov_b32 s65, 0
o_nofl_127:
  s_mov_b32 s63, s64
  s_cmp_lg_u32 s51, 0
  s_cbranch_scc1 o_pick_129
  s_cmp_eq_u32 s50, 0
  s_cbranch_scc1 o_help_136_n
o_adv_135:
  s_add_u32 s49, s49, 4
  s_branch o_round_125
o_dl_137_a:
  s_andn2_b32 s26, s58, s55
  s_and_b32 s29, s26, s54
  s_bcnt1_i32_b32 s27, s29
  s_add_u32 s27, s27, 2
  s_max_u32 s27, s27, 4
  s_andn2_b32 s26, s26, s56
  s_and_b32 s26, s26, 0x3fff
  s_or_b32 s26, s26, s29
  s_cselect_b32 s27, s27, 0
  s_mul_i32 s27, s27, 0
  s_cmp_ge_u32 s46, s89
  s_cselect_b32 s30, s54, -1
  s_mov_b32 s31, 243269696
  s_branch o_dl_137_b
o_dl_137:
  s_and_b32 s26, s55, s54
  s_andn2_b32 s27, s56, s54
  s_or_b32 s26, s26, s27
  s_andn2_b32 s26, s58, s26
  s_bcnt1_i32_b32 s27, s26
  s_bcnt1_i32_b32 s28, s47
  s_mul_i32 s28, s28, -5
  s_lshl1_add_u32 s27, s27, s28
  s_add_i32 s27, s27, 1
  s_max_i32 s27, s27, 0
  s_mul_i32 s27, s27, 37
  s_mov_b32 s30, s54
  s_mov_b32 s31, 243269704
  s_and_b32 s29, s26, s47
  s_andn2_b32 s26, s26, s29
  s_branch o_dl_137_c
o_dl_137_b:
  s_mov_b32 s29, 0
o_dl_137_c:
  s_bfe_u32 s28, s48, 262144
  s_bitset0_b32 s26, s28
  s_bfe_u32 s28, s48, 262148
  s_bitset0_b32 s26, s28
  s_bfe_u32 s28, s48, 262152
  s_bitset0_b32 s26, s28
  s_bfe_u32 s28, s48, 262156
  s_bitset0_b32 s26, s28
  s_lshr_b32 s27, s27, 8
o_dl1_138:
  s_cbranch_scc0 o_dl2_139
  s_ff1_i32_b32 s28, s26
  s_bitset0_b32 s26, s28
  s_bitset1_b32 s29, s28
  s_sub_u32 s27, s27, 1
  s_cmp_lg_u32 s27, 0
  s_branch o_dl1_138
o_dl2_139:
  s_and_b32 s47, s29, 0xffff
  s_and_b32 s30, s30, s47
  s_or_b32 s55, s55, s30
  s_andn2_b32 s26, s47, s30
  s_or_b32 s56, s56, s26
  s_pack_ll_b32_b16 s26, s47, s30
  s_lshl_b32 s27, s60, 7
  s_add_u32 s27, s27, s31
  s_cmp_lg_u32 s43, 0
  s_cbranch_scc1 o_pick_129
  v_mov_b32 v162, s26
  v_mov_b32 v163, s46
  s_mov_b64 exec, 1
  buffer_store_dwordx2 v[162:163], off, s[4:7], s27 sc1
  s_mov_b64 exec, -1
  s_branch o_pick_129
o_help_136:
  s_lshl_b32 s60, s60, 1
  s_and_b32 s60, s60, 2
  s_lshl_b32 s47, s60, 7
  s_add_u32 s47, s47, 243269688
o_help_136_n:
  s_add_u32 s47, s47, 8
  s_lshr_b32 s26, s47, 4
  s_andn2_b32 s26, s57, s26
  s_cbranch_scc0 L_end
  s_mov_b32 s67, 0
o_help_136_w:
  buffer_load_dwordx2 v[162:163], off, s[4:7], s47 sc1
  buffer_load_dwordx2 v[164:165], off, s[4:7], s47 offset:128 sc1
  s_add_u32 s67, s67, 1
  s_cmp_gt_u32 s67, 1048576
  s_cbranch_scc1 L_end
  s_waitcnt vmcnt(0)
  v_readfirstlane_b32 s28, v162
  v_readfirstlane_b32 s30, v164
  v_readfirstlane_b32 s46, v163
  v_readfirstlane_b32 s27, v165
  s_min_u32 s26, s46, s27
  s_cmp_eq_u32 s26, 0
  s_cbranch_scc1 o_help_136_w
  s_max_u32 s46, s46, s27
  s_bitreplicate_b64_b32 s[28:29], s28
  s_bitreplicate_b64_b32 s[30:31], s30
  s_mov_b32 s26, 0x55555555
  s_mov_b32 s27, 0x55555555
  s_and_b64 s[28:29], s[28:29], s[26:27]
  s_andn2_b64 s[30:31], s[30:31], s[26:27]
  s_or_b32 s58, s28, s30
  s_or_b32 s54, s29, s31
  s_andn2_b32 s52, 0xfff, s46
  s_lshr_b32 s52, s52, 5
  s_mov_b32 s53, 0
  s_mov_b32 s63, 0
  s_mov_b32 s49, 72
  s_mov_b32 s59, 64
  s_mov_b32 s50, 0
  s_mov_b32 s89, 0
  s_branch o_pick_129
L_o_x:
  s_mov_b32 s62, 1
  s_mov_b32 s42, 0
  s_mov_b32 s3, 0
  s_mov_b32 s46, 0
  s_mov_b32 s65, 0
  s_mov_b32 s66, 0
  s_mov_b32 s76, 0
  s_mov_b32 s55, 0
  s_mov_b32 s48, 0
  s_mov_b32 s56, 0
  s_mov_b32 s84, 268435456
  s_mov_b32 s86, s41
  s_mov_b32 s49, s60
  s_mul_i32 s63, s49, 257
  s_or_b32 s63, s63, 1179648
  s_lshr_b32 s57, s60, 2
  s_cbranch_scc1 o_help_188
o_round_177:
  s_max_u32 s46, s46, s3
  s_cmp_lg_u32 s3, 0
  s_mov_b32 s3, 0
  s_cbranch_scc1 d_g_193
  s_mov_b32 s67, 0
d_w_192:
  s_min_u32 s26, s49, 71
  s_lshl_b32 s26, s26, 12
  s_add_u32 s27, s26, 243494912
  s_add_u32 s26, s26, 243486720
  buffer_load_dword v248, v246, s[4:7], s26 offen sc1
  buffer_load_dword v249, v246, s[4:7], s27 offen sc1
  s_add_u32 s67, s67, 1
  s_cmp_gt_u32 s67, 1048576
  s_cbranch_scc1 L_end
  s_waitcnt vmcnt(0)
  s_mov_b64 exec, 1
  buffer_store_dword v38, off, s[4:7], s84 sc1
  s_mov_b64 exec, -1
  s_mov_b32 s84, 268435456
  v_min_u32 v162, v248, v249
  v_max_u32 v163, v248, v249
  v_cmp_eq_u32 vcc, 0, v162
  s_cbranch_vccnz d_w_192
  v_max_u32_dpp v163, v163, v163 row_ror:8 row_mask:0xf bank_mask:0xf
  s_nop 1
  v_max_u32_dpp v163, v163, v163 row_ror:4 row_mask:0xf bank_mask:0xf
  s_nop 1
  v_max_u32_dpp v163, v163, v163 row_ror:2 row_mask:0xf bank_mask:0xf
  s_nop 1
  v_max_u32_dpp v163, v163, v163 row_ror:1 row_mask:0xf bank_mask:0xf
  s_nop 0
  v_readlane_b32 s28, v163, 0
  v_readlane_b32 s29, v163, 16
  v_readlane_b32 s30, v163, 32
  v_readlane_b32 s31, v163, 48
  s_max_u32 s28, s28, s29
  s_max_u32 s30, s30, s31
  s_max_u32 s46, s46, s28
  s_max_u32 s46, s46, s30
d_g_193:
  s_lshr_b32 s27, s49, 2
  s_andn2_b32 s52, 0xfff, s46
  s_lshr_b32 s52, s52, 5
  s_min_u32 s52, s52, 64
  s_add_u32 s26, s52, 3
  v_readlane_b32 s89, v247, s27
  s_sub_u32 s26, s26, s60
  s_lshr_b32 s26, s26, 2
  s_bfm_b32 s54, s26, 0
  s_add_u32 s53, s63, 1028
  s_cmp_lt_u32 s49, 60
  s_cselect_b32 s53, s53, 0
  s_cmp_lt_u32 s49, 64
  s_cselect_b32 s26, 3, 1
  s_sub_i32 s26, s27, s26
  s_max_i32 s26, s26, 0
  s_min_u32 s26, s26, 16
  s_bfm_b32 s58, s26, 0
  s_cmp_eq_u32 s27, 16
  s_cselect_b32 s59, 2, 1
  s_cmp_eq_u32 s27, 17
  s_cselect_b32 s59, 0, s59
  s_cmp_eq_u32 s27, 18
  s_cselect_b32 s59, 64, s59
  s_cselect_b32 s50, 0, -1
  s_cselect_b32 s89, 0, s89
  s_cbranch_scc1 o_dl_189
  s_cmp_eq_u32 s27, 16
  s_cbranch_scc1 o_dl_189_a
o_pick_181:
  s_cmp_eq_u32 s59, 0
  s_cbranch_scc1 o_none_185
  s_sub_u32 s59, s59, 1
  s_andn2_b32 s26, s58, s55
  s_and_b32 s26, s26, s54
  s_cbranch_scc1 o_ga_182
  s_and_b32 s26, s55, s50
  s_or_b32 s26, s26, s56
  s_or_b32 s26, s26, s54
  s_andn2_b32 s26, s58, s26
  s_cbranch_scc0 o_none_185
  s_cmp_ge_u32 s46, s89
  s_cbranch_scc1 o_gb_183
o_ga_182:
  s_ff1_i32_b32 s26, s26
  s_bitset1_b32 s55, s26
  s_mov_b32 s64, 1327168
  s_mov_b32 s27, s64
  s_branch o_gd_184
o_none_185:
  s_cmp_lt_u32 s49, 60
  s_cbranch_scc1 o_nn_186
  s_cmp_eq_u32 s50, 0
  s_cbranch_scc1 o_nn_186
  s_and_b32 s26, s63, 1097728
  s_cmp_eq_u32 s26, 1048576
  s_cbranch_scc1 o_nn_186
  s_cmp_lt_u32 s49, 64
  s_cbranch_scc1 o_adv_187
  s_and_b32 s26, s65, 1097728
  s_cmp_lg_u32 s26, 1048576
  s_cbranch_scc1 o_adv_187
o_nn_186:
  s_mov_b32 s64, s53
  s_mov_b32 s51, 0
  s_branch o_task_178
o_gb_183:
  s_ff1_i32_b32 s26, s26
  s_bitset1_b32 s56, s26
  s_andn2_b32 s27, 31, s46
  s_or_b32 s27, s27, 32
  s_lshl_b32 s27, s27, 22
  s_or_b32 s27, s27, 1474688
  s_mov_b32 s64, 1474624
o_gd_184:
  s_lshl4_add_u32 s48, s48, s26
  s_and_b32 s28, s26, s57
  s_lshr_b32 s26, s26, s57
  s_lshl2_add_u32 s26, s26, s60
  s_add_u32 s26, s26, s28
  s_cmp_eq_u32 s26, s52
  s_cselect_b32 s64, s27, s64
  s_mul_i32 s26, s26, 257
  s_or_b32 s64, s64, s26
  s_mov_b32 s51, 1
o_task_178:
  s_cmp_eq_u32 s63, 0
  s_cbranch_scc1 o_nofl_179
  s_cmp_lg_u32 s66, 0
  s_cbranch_scc1 o_have_195
  s_mov_b32 s67, 0
o_w1_194:
  s_and_b32 s32, s63, 0xff
  s_lshl_b32 s32, s32, 12
  s_add_u32 s32, s32, s14
  buffer_load_dword v37, v36, s[4:7], s32 offen sc1
  s_add_u32 s67, s67, 1
  s_cmp_gt_u32 s67, 1048576
  s_cbranch_scc1 L_end
  s_waitcnt vmcnt(0)
  s_mov_b64 exec, 1
  buffer_store_dword v38, off, s[4:7], s84 sc1
  s_mov_b64 exec, -1
  s_mov_b32 s84, 268435456
  v_cmp_eq_u32 vcc, 0, v37
  s_cbranch_vccnz o_w1_194
  s_and_b32 s87, s63, 0xff
  s_lshl_b32 s33, s87, 18
  s_lshl_b32 s32, s87, 19
  s_add_u32 m0, s22, 0
  s_add_u32 s33, s33, s19
  buffer_load_dwordx4 v0, s[4:7], s33 offen offset:0 sc1 lds
  buffer_load_dwordx4 v0, s[4:7], s33 offen offset:1024 sc1 lds
  buffer_load_dwordx4 v0, s[4:7], s33 offen offset:2048 sc1 lds
  buffer_load_dwordx4 v0, s[4:7], s33 offen offset:3072 sc1 lds
  s_add_u32 m0, s23, 0
  s_add_u32 s32, s32, s18
  buffer_load_dwordx4 v0, s[4:7], s32 offen offset:0 sc1 lds
  buffer_load_dwordx4 v0, s[4:7], s32 offen offset:1024 sc1 lds
  buffer_load_dwordx4 v0, s[4:7], s32 offen offset:2048 sc1 lds
  buffer_load_dwordx4 v0, s[4:7], s32 offen offset:3072 sc1 lds
  s_add_u32 m0, m0, 4096
  s_add_u32 s32, s32, 4096
  buffer_load_dwordx4 v0, s[4:7], s32 offen offset:0 sc1 lds
  buffer_load_dwordx4 v0, s[4:7], s32 offen offset:1024 sc1 lds
  buffer_load_dwordx4 v0, s[4:7], s32 offen offset:2048 sc1 lds
  buffer_load_dwordx4 v0, s[4:7], s32 offen offset:3072 sc1 lds
  s_waitcnt vmcnt(0)
  s_barrier
o_have_195:
  ds_read_b128 v[120:123], v33 offset:0
  ds_read_b128 v[40:43], v32 offset:0
  ds_read_b128 v[56:59], v32 offset:1024
  ds_read_b128 v[124:127], v33 offset:2048
  ds_read_b128 v[44:47], v32 offset:4096
  ds_read_b128 v[60:63], v32 offset:5120
  ds_read_b128 v[128:131], v33 offset:4096
  ds_read_b128 v[48:51], v32 offset:8192
  ds_read_b128 v[64:67], v32 offset:9216
  ds_read_b128 v[132:135], v33 offset:6144
  ds_read_b128 v[52:55], v32 offset:12288
  ds_read_b128 v[68:71], v32 offset:13312
  s_cmp_lt_u32 s17, 2
  s_cselect_b32 s65, s65, 0
  s_cmp_lg_u32 s65, 0
  s_cselect_b64 s[44:45], -1, 0
  s_mov_b32 s95, s86
  s_mov_b32 s96, s42
  s_lshl_b32 s97, s43, 14
  s_add_u32 s97, s97, s95
  s_and_b32 s87, s64, 0xff
  s_lshl_b32 s87, s87, 12
  s_add_u32 s87, s87, s14
  s_and_b32 s88, s63, 0xff00
  s_lshl_b32 s88, s88, 3
  s_add_u32 s88, s88, s15
  s_and_b32 s91, s65, 63
  s_lshl_b32 s90, s91, 5
  s_add_u32 s94, s90, s85
  s_add_u32 s90, s90, s43
  s_lshl_b32 s94, s94, 10
  s_lshr_b32 s92, s65, 22
  s_xor_b32 s93, s43, 32
  s_lshl_b32 s91, s90, 10
  s_add_u32 s94, s94, 25165824
  s_cmp_eq_u32 s92, s93
  s_cselect_b32 s92, s94, s91
  s_add_u32 s92, s92, 10485760
  s_and_b32 s93, s65, 49152
  s_cselect_b32 s92, s92, s91
  s_cselect_b64 s[80:81], s[4:5], s[72:73]
  s_cselect_b32 s82, s6, s74
  s_waitcnt lgkmcnt(9)
  v_mfma_f32_16x16x32_bf16 v[104:107], v[40:43], v[120:123], v[24:27]
  v_mfma_f32_16x16x32_bf16 v[108:111], v[56:59], v[120:123], v[28:31]
  s_mov_b64 exec, s[44:45]
  buffer_load_dword v7, v255, s[4:7], s97 offen sc1
  buffer_load_dwordx4 v[184:187], v0, s[80:83], s92 offen sc1
  s_not_b64 exec, exec
  buffer_load_dword v37, v36, s[4:7], s87 offen sc1
  s_mov_b64 exec, -1
  buffer_load_dword v244, v252, s[4:7], s88 offen sc1
  s_waitcnt lgkmcnt(6)
  v_mfma_f32_16x16x32_bf16 v[104:107], v[44:47], v[124:127], v[104:107]
  v_mfma_f32_16x16x32_bf16 v[108:111], v[60:63], v[124:127], v[108:111]
  s_waitcnt lgkmcnt(3)
  v_mfma_f32_16x16x32_bf16 v[104:107], v[48:51], v[128:131], v[104:107]
  v_mfma_f32_16x16x32_bf16 v[108:111], v[64:67], v[128:131], v[108:111]
  s_waitcnt lgkmcnt(0)
  v_mfma_f32_16x16x32_bf16 v[104:107], v[52:55], v[132:135], v[104:107]
  v_mfma_f32_16x16x32_bf16 v[108:111], v[68:71], v[132:135], v[108:111]
  s_cmp_lg_u32 s76, 0
  s_cbranch_scc1 o_klds_198
  v_mov_b32 v196, 0
  v_mov_b32 v199, 0
  v_exp_f32 v56, v104
  v_exp_f32 v57, v105
  v_exp_f32 v58, v106
  v_exp_f32 v59, v107
  v_exp_f32 v60, v108
  v_exp_f32 v61, v109
  v_exp_f32 v62, v110
  v_exp_f32 v63, v111
  v_max3_f32 v116, v104, v105, v106
  v_max3_f32 v116, v107, v108, v116
  v_max3_f32 v116, v109, v110, v116
  v_add_f32 v117, v56, v57
  v_add_f32 v118, v58, v59
  v_add_f32 v117, v117, v60
  v_add_f32 v118, v118, v61
  v_add_f32 v117, v117, v62
  v_add_f32 v118, v118, v63
  s_mov_b32 s67, 0
  s_and_b32 s32, s63, 0xff00
  s_lshl_b32 s32, s32, 10
  s_add_u32 s32, s32, s20
  s_add_u32 s33, s32, 4096
o_w2_196:
  s_waitcnt vmcnt(0)
  v_cmp_eq_u32 vcc, 0, v244
  s_cbranch_vccz o_kgo_206
  s_mov_b64 exec, 1
  buffer_store_dword v38, off, s[4:7], s84 sc1
  s_mov_b64 exec, -1
  s_mov_b32 s84, 268435456
  buffer_load_dword v244, v252, s[4:7], s88 offen sc1
  s_add_u32 s67, s67, 1
  s_cmp_gt_u32 s67, 1048576
  s_cbranch_scc1 L_end
  s_branch o_w2_196
o_kgo_206:
  buffer_load_dwordx4 v[136:139], v0, s[4:7], s32 offen offset:0 sc1
  buffer_load_dwordx4 v[140:143], v0, s[4:7], s32 offen offset:1024 sc1
  buffer_load_dwordx4 v[144:147], v0, s[4:7], s32 offen offset:2048 sc1
  buffer_load_dwordx4 v[148:151], v0, s[4:7], s32 offen offset:3072 sc1
  buffer_load_dwordx2 v[200:201], v1, s[4:7], s33 offen offset:0 sc1
  buffer_load_dwordx2 v[202:203], v1, s[4:7], s33 offen offset:512 sc1
  buffer_load_dwordx2 v[204:205], v1, s[4:7], s33 offen offset:1024 sc1
  buffer_load_dwordx2 v[206:207], v1, s[4:7], s33 offen offset:1536 sc1
  buffer_load_dword v37, v36, s[4:7], s87 offen sc1
  buffer_load_dword v244, v252, s[4:7], s88 offen sc1
  s_barrier
  ds_read_b128 v[152:155], v32 offset:2048
  ds_read_b128 v[156:159], v32 offset:3072
  ds_read_b128 v[160:163], v32 offset:6144
  ds_read_b128 v[164:167], v32 offset:7168
  ds_read_b128 v[168:171], v32 offset:10240
  ds_read_b128 v[172:175], v32 offset:11264
  ds_read_b128 v[176:179], v32 offset:14336
  ds_read_b128 v[180:183], v32 offset:15360
  s_waitcnt vmcnt(9)
  v_mfma_f32_16x16x32_bf16 v[112:115], v[136:139], v[120:123], 0
  s_waitcnt vmcnt(8)
  v_mfma_f32_16x16x32_bf16 v[112:115], v[140:143], v[124:127], v[112:115]
  s_waitcnt vmcnt(7)
  v_mfma_f32_16x16x32_bf16 v[112:115], v[144:147], v[128:131], v[112:115]
  s_waitcnt vmcnt(6)
  v_mfma_f32_16x16x32_bf16 v[112:115], v[148:151], v[132:135], v[112:115]
  s_waitcnt vmcnt(2)
  s_branch o_havek_197
o_klds_198:
  s_waitcnt vmcnt(12)
  s_barrier
  ds_read_b128 v[136:139], v34 offset:0
  ds_read_b128 v[140:143], v34 offset:1024
  ds_read_b128 v[144:147], v34 offset:2048
  ds_read_b128 v[148:151], v34 offset:3072
  ds_read_b64 v[200:201], v35 offset:4096
  ds_read_b64 v[202:203], v35 offset:4608
  ds_read_b64 v[204:205], v35 offset:5120
  ds_read_b64 v[206:207], v35 offset:5632
  v_mov_b32 v196, 0
  v_mov_b32 v199, 0
  v_exp_f32 v56, v104
  v_exp_f32 v57, v105
  v_exp_f32 v58, v106
  v_exp_f32 v59, v107
  v_exp_f32 v60, v108
  v_exp_f32 v61, v109
  v_exp_f32 v62, v110
  v_exp_f32 v63, v111
  v_max3_f32 v116, v104, v105, v106
  v_max3_f32 v116, v107, v108, v116
  v_max3_f32 v116, v109, v110, v116
  s_waitcnt lgkmcnt(4)
  v_mfma_f32_16x16x32_bf16 v[112:115], v[136:139], v[120:123], 0
  ds_read_b128 v[152:155], v32 offset:2048
  ds_read_b128 v[156:159], v32 offset:3072
  v_mfma_f32_16x16x32_bf16 v[112:115], v[140:143], v[124:127], v[112:115]
  ds_read_b128 v[160:163], v32 offset:6144
  ds_read_b128 v[164:167], v32 offset:7168
  v_mfma_f32_16x16x32_bf16 v[112:115], v[144:147], v[128:131], v[112:115]
  ds_read_b128 v[168:171], v32 offset:10240
  ds_read_b128 v[172:175], v32 offset:11264
  v_mfma_f32_16x16x32_bf16 v[112:115], v[148:151], v[132:135], v[112:115]
  ds_read_b128 v[176:179], v32 offset:14336
  ds_read_b128 v[180:183], v32 offset:15360
  v_add_f32 v117, v56, v57
  v_add_f32 v118, v58, v59
  v_add_f32 v117, v117, v60
  v_add_f32 v118, v118, v61
  v_add_f32 v117, v117, v62
  v_add_f32 v118, v118, v63
o_havek_197:
  s_cmp_lg_u32 s65, 0
  s_cbranch_scc1 o_wr1_203
  s_nop 3
  v_mul_f32 v112, s24, v112
  v_mul_f32 v113, s24, v113
  v_exp_f32 v64, v112
  v_exp_f32 v65, v113
  v_max_f32 v116, v111, v116
  v_max3_f32 v116, v112, v113, v116
  v_add_f32 v117, v117, v64
  v_add_f32 v118, v118, v65
  v_add_f32 v117, v117, v118
  s_mov_b32 s28, 0x21800000
  v_mov_b32 v118, v117
  s_nop 1
  v_permlane16_swap_b32 v117, v118
  v_add_f32 v117, v117, v118
  v_mov_b32 v118, v117
  s_nop 0
  s_nop 0
  v_permlane32_swap_b32 v117, v118
  v_add_f32 v117, v117, v118
  v_cmp_lt_f32 vcc, 0x42700000, v116
  v_cmp_gt_f32 s[30:31], s28, v117
  v_rcp_f32 v117, v117
  s_or_b64 vcc, vcc, s[30:31]
  s_cbranch_vccnz o_fb_207
o_fbr_208:
  v_pk_mul_f32 v[56:57], v[56:57], v[116:117] op_sel:[0,1] op_sel_hi:[1,1]
  v_pk_mul_f32 v[58:59], v[58:59], v[116:117] op_sel:[0,1] op_sel_hi:[1,1]
  v_pk_mul_f32 v[60:61], v[60:61], v[116:117] op_sel:[0,1] op_sel_hi:[1,1]
  v_pk_mul_f32 v[62:63], v[62:63], v[116:117] op_sel:[0,1] op_sel_hi:[1,1]
  v_pk_mul_f32 v[64:65], v[64:65], v[116:117] op_sel:[0,1] op_sel_hi:[1,1]
  v_cvt_pk_bf16_f32 v116, v56, v57
  v_cvt_pk_bf16_f32 v117, v58, v59
  v_cvt_pk_bf16_f32 v118, v60, v61
  v_cvt_pk_bf16_f32 v119, v62, v63
  s_waitcnt lgkmcnt(0)
  s_nop 0
  v_mfma_f32_16x16x32_bf16 v[72:75], v[152:155], v[116:119], 0
  s_add_u32 s62, s62, 1
  v_cvt_pk_bf16_f32 v197, v64, v65
  v_cvt_pk_bf16_f32 v198, v64, v65
  v_mfma_f32_16x16x32_bf16 v[76:79], v[156:159], v[116:119], 0
  s_xor_b32 s86, s86, 524288
  v_mfma_f32_16x16x32_bf16 v[80:83], v[160:163], v[116:119], 0
  s_bfe_u32 s42, s62, 0x10001
  v_mfma_f32_16x16x32_bf16 v[84:87], v[164:167], v[116:119], 0
  s_bfe_u32 s26, s64, 65556
  v_mfma_f32_16x16x32_bf16 v[88:91], v[168:171], v[116:119], 0
  s_and_b32 s87, s64, 0xff
  v_mfma_f32_16x16x32_bf16 v[92:95], v[172:175], v[116:119], 0
  s_bfe_u32 s88, s64, 0x80008
  v_mfma_f32_16x16x32_bf16 v[96:99], v[176:179], v[116:119], 0
  s_nop 0
  v_mfma_f32_16x16x32_bf16 v[100:103], v[180:183], v[116:119], 0
  s_nop 0
  v_mfma_f32_16x16x16_bf16 v[72:75], v[200:201], v[198:199], v[72:75]
  s_nop 1
  v_mfma_f32_16x16x16_bf16 v[76:79], v[200:201], v[196:197], v[76:79]
  s_nop 1
  v_mfma_f32_16x16x16_bf16 v[80:83], v[202:203], v[198:199], v[80:83]
  s_nop 1
  v_mfma_f32_16x16x16_bf16 v[84:87], v[202:203], v[196:197], v[84:87]
  s_nop 1
  v_mfma_f32_16x16x16_bf16 v[88:91], v[204:205], v[198:199], v[88:91]
  s_nop 0
  v_cvt_pk_bf16_f32 v40, v72, v73
  v_cvt_pk_bf16_f32 v41, v74, v75
  v_mfma_f32_16x16x16_bf16 v[92:95], v[204:205], v[196:197], v[92:95]
  s_nop 0
  v_cvt_pk_bf16_f32 v42, v76, v77
  v_cvt_pk_bf16_f32 v43, v78, v79
  v_mfma_f32_16x16x16_bf16 v[96:99], v[206:207], v[198:199], v[96:99]
  s_nop 0
  ds_write_b128 v6, v[40:43] offset:0
  v_cvt_pk_bf16_f32 v44, v80, v81
  v_mfma_f32_16x16x16_bf16 v[100:103], v[206:207], v[196:197], v[100:103]
  s_nop 0
  v_cvt_pk_bf16_f32 v45, v82, v83
  v_cvt_pk_bf16_f32 v46, v84, v85
  v_cvt_pk_bf16_f32 v47, v86, v87
  ds_write_b128 v6, v[44:47] offset:1024
  v_cvt_pk_bf16_f32 v48, v88, v89
  v_cvt_pk_bf16_f32 v49, v90, v91
  v_cvt_pk_bf16_f32 v50, v92, v93
  v_cvt_pk_bf16_f32 v51, v94, v95
  ds_write_b128 v6, v[48:51] offset:2048
  v_cvt_pk_bf16_f32 v52, v96, v97
  v_cvt_pk_bf16_f32 v53, v98, v99
  v_cvt_pk_bf16_f32 v54, v100, v101
  v_cvt_pk_bf16_f32 v55, v102, v103
  ds_write_b128 v6, v[52:55] offset:3072
  s_cmp_lt_u32 s17, 2
  s_cbranch_scc1 o_wr0_202
  s_waitcnt lgkmcnt(0)
  s_barrier
  ds_read_b128 v[104:107], v3 offset:0
  ds_read_b128 v[108:111], v3 offset:512
  ds_read_b128 v[112:115], v3 offset:1024
  s_waitcnt lgkmcnt(2)
  v_mfma_f32_32x32x16_bf16 v[40:55], v[104:107], a[0:3], 0
  s_waitcnt vmcnt(0)
  v_cmp_eq_u32 vcc, 0, v37
  s_cmp_eq_u64 vcc, 0
  s_cselect_b32 s66, s26, 0
  s_cmp_eq_u32 s66, 1
  s_cselect_b32 s87, s87, 1024
  s_cselect_b32 s34, 0, 0x28000
  v_mfma_f32_32x32x16_bf16 v[56:71], v[104:107], a[4:7], 0
  ds_read_b128 v[116:119], v3 offset:1536
  s_lshl_b32 s33, s87, 18
  s_lshl_b32 s32, s87, 19
  s_add_u32 m0, s22, s34
  s_add_u32 s33, s33, s19
  s_min_u32 s28, s49, 67
  v_mfma_f32_32x32x16_bf16 v[72:87], v[104:107], a[8:11], 0
  s_lshl1_add_u32 s28, s17, s28
  s_lshl_b32 s28, s28, 12
  s_add_u32 s28, s28, 243486720
  v_mfma_f32_32x32x16_bf16 v[88:103], v[104:107], a[12:15], 0
  buffer_load_dword v249, v246, s[4:7], s28 offen sc1
  s_waitcnt lgkmcnt(2)
  v_mfma_f32_32x32x16_bf16 v[40:55], v[108:111], a[16:19], v[40:55]
  buffer_load_dwordx4 v0, s[4:7], s33 offen offset:0 sc1 lds
  v_mfma_f32_32x32x16_bf16 v[56:71], v[108:111], a[20:23], v[56:71]
  ds_read_b128 v[104:107], v3 offset:2048
  v_mfma_f32_32x32x16_bf16 v[72:87], v[108:111], a[24:27], v[72:87]
  buffer_load_dwordx4 v0, s[4:7], s33 offen offset:1024 sc1 lds
  v_mfma_f32_32x32x16_bf16 v[88:103], v[108:111], a[28:31], v[88:103]
  buffer_load_dwordx4 v0, s[4:7], s33 offen offset:2048 sc1 lds
  s_waitcnt lgkmcnt(2)
  v_mfma_f32_32x32x16_bf16 v[40:55], v[112:115], a[32:35], v[40:55]
  v_mfma_f32_32x32x16_bf16 v[56:71], v[112:115], a[36:39], v[56:71]
  ds_read_b128 v[108:111], v3 offset:2560
  buffer_load_dwordx4 v0, s[4:7], s33 offen offset:3072 sc1 lds
  s_sub_u32 m0, m0, 8192
  s_sub_u32 s33, s33, 8192
  v_mfma_f32_32x32x16_bf16 v[72:87], v[112:115], a[40:43], v[72:87]
  buffer_load_dwordx4 v0, s[4:7], s33 offen offset:0 sc1 lds
  v_mfma_f32_32x32x16_bf16 v[88:103], v[112:115], a[44:47], v[88:103]
  s_waitcnt lgkmcnt(2)
  v_mfma_f32_32x32x16_bf16 v[40:55], v[116:119], a[48:51], v[40:55]
  buffer_load_dwordx4 v0, s[4:7], s33 offen offset:1024 sc1 lds
  v_mfma_f32_32x32x16_bf16 v[56:71], v[116:119], a[52:55], v[56:71]
  ds_read_b128 v[112:115], v3 offset:3072
  buffer_load_dwordx4 v0, s[4:7], s33 offen offset:2048 sc1 lds
  v_mfma_f32_32x32x16_bf16 v[72:87], v[116:119], a[56:59], v[72:87]
  v_mfma_f32_32x32x16_bf16 v[88:103], v[116:119], a[60:63], v[88:103]
  buffer_load_dwordx4 v0, s[4:7], s33 offen offset:3072 sc1 lds
  s_add_u32 m0, s23, s34
  s_add_u32 s32, s32, s18
  s_waitcnt lgkmcnt(2)
  v_mfma_f32_32x32x16_bf16 v[40:55], v[104:107], a[64:67], v[40:55]
  buffer_load_dwordx4 v0, s[4:7], s32 offen offset:0 sc1 lds
  v_mfma_f32_32x32x16_bf16 v[56:71], v[104:107], a[68:71], v[56:71]
  ds_read_b128 v[116:119], v3 offset:3584
  v_mfma_f32_32x32x16_bf16 v[72:87], v[104:107], a[72:75], v[72:87]
  buffer_load_dwordx4 v0, s[4:7], s32 offen offset:1024 sc1 lds
  s_add_i32 m0, m0, 4096
  s_add_i32 s32, s32, 4096
  v_mfma_f32_32x32x16_bf16 v[88:103], v[104:107], a[76:79], v[88:103]
  buffer_load_dwordx4 v0, s[4:7], s32 offen offset:0 sc1 lds
  s_waitcnt lgkmcnt(2)
  v_mfma_f32_32x32x16_bf16 v[40:55], v[108:111], a[80:83], v[40:55]
  v_mfma_f32_32x32x16_bf16 v[56:71], v[108:111], a[84:87], v[56:71]
  ds_read_b128 v[104:107], v3 offset:8192
  buffer_load_dwordx4 v0, s[4:7], s32 offen offset:1024 sc1 lds
  s_add_i32 m0, m0, -16384
  s_add_i32 s32, s32, -16384
  v_mfma_f32_32x32x16_bf16 v[72:87], v[108:111], a[88:91], v[72:87]
  s_and_b32 s29, s64, 0xff00
  s_lshl_b32 s29, s29, 3
  s_add_u32 s29, s29, s15
  buffer_load_dword v245, v252, s[4:7], s29 offen sc1
  v_mfma_f32_32x32x16_bf16 v[88:103], v[108:111], a[92:95], v[88:103]
  s_waitcnt lgkmcnt(2)
  v_mfma_f32_32x32x16_bf16 v[40:55], v[112:115], a[96:99], v[40:55]
  buffer_load_dwordx4 v0, s[4:7], s32 offen offset:0 sc1 lds
  v_mfma_f32_32x32x16_bf16 v[56:71], v[112:115], a[100:103], v[56:71]
  ds_read_b128 v[108:111], v3 offset:8704
  buffer_load_dwordx4 v0, s[4:7], s32 offen offset:1024 sc1 lds
  s_add_i32 m0, m0, -4096
  s_add_i32 s32, s32, -4096
  v_mfma_f32_32x32x16_bf16 v[72:87], v[112:115], a[104:107], v[72:87]
  v_mfma_f32_32x32x16_bf16 v[88:103], v[112:115], a[108:111], v[88:103]
  buffer_load_dwordx4 v0, s[4:7], s32 offen offset:0 sc1 lds
  s_waitcnt lgkmcnt(2)
  v_mfma_f32_32x32x16_bf16 v[40:55], v[116:119], a[112:115], v[40:55]
  buffer_load_dwordx4 v0, s[4:7], s32 offen offset:1024 sc1 lds
  v_mfma_f32_32x32x16_bf16 v[56:71], v[116:119], a[116:119], v[56:71]
  ds_read_b128 v[112:115], v3 offset:9216
  v_mfma_f32_32x32x16_bf16 v[72:87], v[116:119], a[120:123], v[72:87]
  buffer_load_dwordx4 v0, s[4:7], s32 offen offset:2048 sc1 lds
  v_mfma_f32_32x32x16_bf16 v[88:103], v[116:119], a[124:127], v[88:103]
  buffer_load_dwordx4 v0, s[4:7], s32 offen offset:3072 sc1 lds
  s_add_i32 m0, m0, 4096
  s_add_i32 s32, s32, 4096
  s_waitcnt lgkmcnt(2)
  v_mfma_f32_32x32x16_bf16 v[40:55], v[104:107], a[128:131], v[40:55]
  v_mfma_f32_32x32x16_bf16 v[56:71], v[104:107], a[132:135], v[56:71]
  ds_read_b128 v[116:119], v3 offset:9728
  buffer_load_dwordx4 v0, s[4:7], s32 offen offset:2048 sc1 lds
  v_mfma_f32_32x32x16_bf16 v[72:87], v[104:107], a[136:139], v[72:87]
  buffer_load_dwordx4 v0, s[4:7], s32 offen offset:3072 sc1 lds
  s_add_i32 m0, m0, 16384
  s_add_i32 s32, s32, 16384
  v_mfma_f32_32x32x16_bf16 v[88:103], v[104:107], a[140:143], v[88:103]
  s_waitcnt lgkmcnt(2)
  v_mfma_f32_32x32x16_bf16 v[40:55], v[108:111], a[144:147], v[40:55]
  buffer_load_dwordx4 v0, s[4:7], s32 offen offset:2048 sc1 lds
  v_mfma_f32_32x32x16_bf16 v[56:71], v[108:111], a[148:151], v[56:71]
  ds_read_b128 v[104:107], v3 offset:10240
  buffer_load_dwordx4 v0, s[4:7], s32 offen offset:3072 sc1 lds
  s_add_i32 m0, m0, -4096
  s_add_i32 s32, s32, -4096
  v_mfma_f32_32x32x16_bf16 v[72:87], v[108:111], a[152:155], v[72:87]
  v_mfma_f32_32x32x16_bf16 v[88:103], v[108:111], a[156:159], v[88:103]
  buffer_load_dwordx4 v0, s[4:7], s32 offen offset:2048 sc1 lds
  s_waitcnt lgkmcnt(2)
  v_mfma_f32_32x32x16_bf16 v[40:55], v[112:115], a[160:163], v[40:55]
  buffer_load_dwordx4 v0, s[4:7], s32 offen offset:3072 sc1 lds
  v_mfma_f32_32x32x16_bf16 v[56:71], v[112:115], a[164:167], v[56:71]
  ds_read_b128 v[108:111], v3 offset:10752
  v_mfma_f32_32x32x16_bf16 v[72:87], v[112:115], a[168:171], v[72:87]
  v_mfma_f32_32x32x16_bf16 v[88:103], v[112:115], a[172:175], v[88:103]
  s_waitcnt lgkmcnt(2)
  v_mfma_f32_32x32x16_bf16 v[40:55], v[116:119], a[176:179], v[40:55]
  v_mfma_f32_32x32x16_bf16 v[56:71], v[116:119], a[180:183], v[56:71]
  ds_read_b128 v[112:115], v3 offset:11264
  v_mfma_f32_32x32x16_bf16 v[72:87], v[116:119], a[184:187], v[72:87]
  v_mfma_f32_32x32x16_bf16 v[88:103], v[116:119], a[188:191], v[88:103]
  s_waitcnt lgkmcnt(2)
  v_mfma_f32_32x32x16_bf16 v[40:55], v[104:107], a[192:195], v[40:55]
  v_mfma_f32_32x32x16_bf16 v[56:71], v[104:107], a[196:199], v[56:71]
  ds_read_b128 v[116:119], v3 offset:11776
  s_waitcnt vmcnt(12)
  v_cmp_eq_u32 vcc, 0, v245
  s_cmp_eq_u64 vcc, 0
  s_cselect_b32 s76, s26, 0
  s_and_b32 s76, s76, 1
  s_cselect_b32 s88, s88, 1024
  s_waitcnt lgkmcnt(2)
  v_mfma_f32_32x32x16_bf16 v[40:55], v[108:111], a[208:211], v[40:55]
  s_lshl_b32 s32, s88, 18
  s_mov_b32 m0, s40
  s_add_u32 s32, s32, s21
  buffer_load_dwordx4 v0, s[4:7], s32 offen offset:0 sc1 lds
  v_mfma_f32_32x32x16_bf16 v[56:71], v[108:111], a[212:215], v[56:71]
  buffer_load_dwordx4 v0, s[4:7], s32 offen offset:1024 sc1 lds
  s_waitcnt lgkmcnt(1)
  v_mfma_f32_32x32x16_bf16 v[40:55], v[112:115], a[224:227], v[40:55]
  buffer_load_dwordx4 v0, s[4:7], s32 offen offset:2048 sc1 lds
  s_sub_u32 m0, m0, 8192
  s_sub_u32 s32, s32, 8192
  v_mfma_f32_32x32x16_bf16 v[56:71], v[112:115], a[228:231], v[56:71]
  buffer_load_dwordx4 v0, s[4:7], s32 offen offset:0 sc1 lds
  s_waitcnt lgkmcnt(0)
  v_mfma_f32_32x32x16_bf16 v[40:55], v[116:119], a[240:243], v[40:55]
  buffer_load_dwordx4 v0, s[4:7], s32 offen offset:1024 sc1 lds
  v_mfma_f32_32x32x16_bf16 v[56:71], v[116:119], a[244:247], v[56:71]
  buffer_load_dwordx4 v0, s[4:7], s32 offen offset:2048 sc1 lds
  v_cmp_eq_u32 vcc, 0, v249
  v_max_u32_dpp v249, v249, v249 row_ror:8 row_mask:0xf bank_mask:0xf
  s_nop 0
  v_mfma_f32_32x32x16_bf16 v[72:87], v[104:107], a[200:203], v[72:87]
  v_max_u32_dpp v249, v249, v249 row_ror:4 row_mask:0xf bank_mask:0xf
  s_nop 0
  s_nop 0
  v_max_u32_dpp v249, v249, v249 row_ror:2 row_mask:0xf bank_mask:0xf
  s_nop 0
  s_nop 0
  v_max_u32_dpp v249, v249, v249 row_ror:1 row_mask:0xf bank_mask:0xf
  s_nop 0
  v_mfma_f32_32x32x16_bf16 v[88:103], v[104:107], a[204:207], v[88:103]
  v_mov_b32 v248, v249
  s_nop 0
  s_nop 0
  v_permlane16_swap_b32 v249, v248
  v_max_u32 v249, v249, v248
  v_mfma_f32_32x32x16_bf16 v[72:87], v[108:111], a[216:219], v[72:87]
  v_mov_b32 v248, v249
  s_nop 0
  s_nop 0
  v_permlane32_swap_b32 v249, v248
  v_max_u32 v249, v249, v248
  s_cmp_eq_u64 vcc, 0
  s_cselect_b32 s28, 4, 0
  v_mfma_f32_32x32x16_bf16 v[88:103], v[108:111], a[220:223], v[88:103]
  s_lshl_b32 s26, s76, 1
  s_or_b32 s26, s26, s66
  s_or_b32 s26, s26, s28
  v_mov_b32 v248, s26
  ds_write_b64 v39, v[248:249]
  v_mfma_f32_32x32x16_bf16 v[72:87], v[112:115], a[232:235], v[72:87]
  v_cvt_pk_bf16_f32 v212, v40, v56
  v_cvt_pk_bf16_f32 v214, v41, v57
  v_cvt_pk_bf16_f32 v216, v42, v58
  v_cvt_pk_bf16_f32 v218, v43, v59
  v_permlane16_swap_b32 v212, v214
  v_mfma_f32_32x32x16_bf16 v[88:103], v[112:115], a[236:239], v[88:103]
  v_cvt_pk_bf16_f32 v220, v44, v60
  v_cvt_pk_bf16_f32 v222, v45, v61
  v_permlane16_swap_b32 v216, v218
  v_bfi_b32 v212, v254, s42, v212
  v_mfma_f32_32x32x16_bf16 v[72:87], v[116:119], a[248:251], v[72:87]
  v_cvt_pk_bf16_f32 v224, v46, v62
  v_cvt_pk_bf16_f32 v226, v47, v63
  v_permlane16_swap_b32 v220, v222
  v_bfi_b32 v216, v254, s42, v216
  v_cvt_pk_bf16_f32 v228, v48, v64
  v_mfma_f32_32x32x16_bf16 v[88:103], v[116:119], a[252:255], v[88:103]
  v_cvt_pk_bf16_f32 v230, v49, v65
  v_permlane16_swap_b32 v224, v226
  v_bfi_b32 v220, v254, s42, v220
  v_cvt_pk_bf16_f32 v232, v50, v66
  v_cvt_pk_bf16_f32 v234, v51, v67
  v_permlane16_swap_b32 v228, v230
  v_bfi_b32 v224, v254, s42, v224
  v_cvt_pk_bf16_f32 v236, v52, v68
  v_cvt_pk_bf16_f32 v238, v53, v69
  v_permlane16_swap_b32 v232, v234
  v_bfi_b32 v228, v254, s42, v228
  v_cvt_pk_bf16_f32 v240, v54, v70
  v_cvt_pk_bf16_f32 v242, v55, v71
  v_permlane16_swap_b32 v236, v238
  v_bfi_b32 v232, v254, s42, v232
  v_permlane16_swap_b32 v240, v242
  v_bfi_b32 v236, v254, s42, v236
  v_bfi_b32 v240, v254, s42, v240
  v_cvt_pk_bf16_f32 v213, v72, v88
  v_cvt_pk_bf16_f32 v215, v73, v89
  v_cvt_pk_bf16_f32 v217, v74, v90
  v_cvt_pk_bf16_f32 v219, v75, v91
  s_add_u32 s78, s86, 0
  v_permlane16_swap_b32 v213, v215
  buffer_store_dwordx4 v[212:215], v4, s[4:7], s78 offen sc1
  v_cvt_pk_bf16_f32 v221, v76, v92
  v_cvt_pk_bf16_f32 v223, v77, v93
  s_add_u32 s78, s86, 32768
  v_permlane16_swap_b32 v217, v219
  buffer_store_dwordx4 v[216:219], v4, s[4:7], s78 offen sc1
  v_cvt_pk_bf16_f32 v225, v78, v94
  v_cvt_pk_bf16_f32 v227, v79, v95
  s_add_u32 s78, s86, 131072
  v_permlane16_swap_b32 v221, v223
  buffer_store_dwordx4 v[220:223], v4, s[4:7], s78 offen sc1
  v_cvt_pk_bf16_f32 v229, v80, v96
  v_cvt_pk_bf16_f32 v231, v81, v97
  s_add_u32 s78, s86, 163840
  v_permlane16_swap_b32 v225, v227
  buffer_store_dwordx4 v[224:227], v4, s[4:7], s78 offen sc1
  v_cvt_pk_bf16_f32 v233, v82, v98
  v_cvt_pk_bf16_f32 v235, v83, v99
  s_add_u32 s78, s86, 262144
  v_permlane16_swap_b32 v229, v231
  buffer_store_dwordx4 v[228:231], v4, s[4:7], s78 offen sc1
  v_cvt_pk_bf16_f32 v237, v84, v100
  v_cvt_pk_bf16_f32 v239, v85, v101
  s_add_u32 s78, s86, 294912
  v_permlane16_swap_b32 v233, v235
  buffer_store_dwordx4 v[232:235], v4, s[4:7], s78 offen sc1
  v_cvt_pk_bf16_f32 v241, v86, v102
  v_cvt_pk_bf16_f32 v243, v87, v103
  s_add_u32 s78, s86, 393216
  v_permlane16_swap_b32 v237, v239
  buffer_store_dwordx4 v[236:239], v4, s[4:7], s78 offen sc1
  s_add_u32 s78, s86, 425984
  v_permlane16_swap_b32 v241, v243
  buffer_store_dwordx4 v[240:243], v4, s[4:7], s78 offen sc1
  s_waitcnt vmcnt(22)
  s_branch o_we_205
o_wr0_202:
  s_waitcnt lgkmcnt(0)
  s_barrier
  ds_read_b128 v[104:107], v3 offset:0
  ds_read_b128 v[108:111], v3 offset:512
  ds_read_b128 v[112:115], v3 offset:1024
  s_waitcnt lgkmcnt(2)
  v_mfma_f32_32x32x16_bf16 v[40:55], v[104:107], a[0:3], 0
  v_mfma_f32_32x32x16_bf16 v[56:71], v[104:107], a[4:7], 0
  ds_read_b128 v[116:119], v3 offset:1536
  v_mfma_f32_32x32x16_bf16 v[72:87], v[104:107], a[8:11], 0
  v_mfma_f32_32x32x16_bf16 v[88:103], v[104:107], a[12:15], 0
  s_waitcnt lgkmcnt(2)
  v_mfma_f32_32x32x16_bf16 v[40:55], v[108:111], a[16:19], v[40:55]
  v_mfma_f32_32x32x16_bf16 v[56:71], v[108:111], a[20:23], v[56:71]
  ds_read_b128 v[104:107], v3 offset:2048
  v_mfma_f32_32x32x16_bf16 v[72:87], v[108:111], a[24:27], v[72:87]
  v_mfma_f32_32x32x16_bf16 v[88:103], v[108:111], a[28:31], v[88:103]
  s_waitcnt lgkmcnt(2)
  v_mfma_f32_32x32x16_bf16 v[40:55], v[112:115], a[32:35], v[40:55]
  v_mfma_f32_32x32x16_bf16 v[56:71], v[112:115], a[36:39], v[56:71]
  ds_read_b128 v[108:111], v3 offset:2560
  v_mfma_f32_32x32x16_bf16 v[72:87], v[112:115], a[40:43], v[72:87]
  v_mfma_f32_32x32x16_bf16 v[88:103], v[112:115], a[44:47], v[88:103]
  s_waitcnt lgkmcnt(2)
  v_mfma_f32_32x32x16_bf16 v[40:55], v[116:119], a[48:51], v[40:55]
  v_mfma_f32_32x32x16_bf16 v[56:71], v[116:119], a[52:55], v[56:71]
  ds_read_b128 v[112:115], v3 offset:3072
  v_mfma_f32_32x32x16_bf16 v[72:87], v[116:119], a[56:59], v[72:87]
  v_mfma_f32_32x32x16_bf16 v[88:103], v[116:119], a[60:63], v[88:103]
  s_waitcnt lgkmcnt(2)
  v_mfma_f32_32x32x16_bf16 v[40:55], v[104:107], a[64:67], v[40:55]
  v_mfma_f32_32x32x16_bf16 v[56:71], v[104:107], a[68:71], v[56:71]
  ds_read_b128 v[116:119], v3 offset:3584
  v_mfma_f32_32x32x16_bf16 v[72:87], v[104:107], a[72:75], v[72:87]
  v_mfma_f32_32x32x16_bf16 v[88:103], v[104:107], a[76:79], v[88:103]
  s_waitcnt lgkmcnt(2)
  v_mfma_f32_32x32x16_bf16 v[40:55], v[108:111], a[80:83], v[40:55]
  v_mfma_f32_32x32x16_bf16 v[56:71], v[108:111], a[84:87], v[56:71]
  ds_read_b128 v[104:107], v3 offset:8192
  v_mfma_f32_32x32x16_bf16 v[72:87], v[108:111], a[88:91], v[72:87]
  v_mfma_f32_32x32x16_bf16 v[88:103], v[108:111], a[92:95], v[88:103]
  s_waitcnt lgkmcnt(2)
  v_mfma_f32_32x32x16_bf16 v[40:55], v[112:115], a[96:99], v[40:55]
  v_mfma_f32_32x32x16_bf16 v[56:71], v[112:115], a[100:103], v[56:71]
  ds_read_b128 v[108:111], v3 offset:8704
  v_mfma_f32_32x32x16_bf16 v[72:87], v[112:115], a[104:107], v[72:87]
  v_mfma_f32_32x32x16_bf16 v[88:103], v[112:115], a[108:111], v[88:103]
  s_waitcnt lgkmcnt(2)
  v_mfma_f32_32x32x16_bf16 v[40:55], v[116:119], a[112:115], v[40:55]
  v_mfma_f32_32x32x16_bf16 v[56:71], v[116:119], a[116:119], v[56:71]
  ds_read_b128 v[112:115], v3 offset:9216
  v_mfma_f32_32x32x16_bf16 v[72:87], v[116:119], a[120:123], v[72:87]
  v_mfma_f32_32x32x16_bf16 v[88:103], v[116:119], a[124:127], v[88:103]
  s_waitcnt lgkmcnt(2)
  v_mfma_f32_32x32x16_bf16 v[40:55], v[104:107], a[128:131], v[40:55]
  v_mfma_f32_32x32x16_bf16 v[56:71], v[104:107], a[132:135], v[56:71]
  ds_read_b128 v[116:119], v3 offset:9728
  v_mfma_f32_32x32x16_bf16 v[72:87], v[104:107], a[136:139], v[72:87]
  v_mfma_f32_32x32x16_bf16 v[88:103], v[104:107], a[140:143], v[88:103]
  s_waitcnt lgkmcnt(2)
  v_mfma_f32_32x32x16_bf16 v[40:55], v[108:111], a[144:147], v[40:55]
  v_mfma_f32_32x32x16_bf16 v[56:71], v[108:111], a[148:151], v[56:71]
  ds_read_b128 v[104:107], v3 offset:10240
  v_mfma_f32_32x32x16_bf16 v[72:87], v[108:111], a[152:155], v[72:87]
  v_mfma_f32_32x32x16_bf16 v[88:103], v[108:111], a[156:159], v[88:103]
  s_waitcnt lgkmcnt(2)
  v_mfma_f32_32x32x16_bf16 v[40:55], v[112:115], a[160:163], v[40:55]
  v_mfma_f32_32x32x16_bf16 v[56:71], v[112:115], a[164:167], v[56:71]
  ds_read_b128 v[108:111], v3 offset:10752
  v_mfma_f32_32x32x16_bf16 v[72:87], v[112:115], a[168:171], v[72:87]
  v_mfma_f32_32x32x16_bf16 v[88:103], v[112:115], a[172:175], v[88:103]
  s_waitcnt lgkmcnt(2)
  v_mfma_f32_32x32x16_bf16 v[40:55], v[116:119], a[176:179], v[40:55]
  v_mfma_f32_32x32x16_bf16 v[56:71], v[116:119], a[180:183], v[56:71]
  ds_read_b128 v[112:115], v3 offset:11264
  v_mfma_f32_32x32x16_bf16 v[72:87], v[116:119], a[184:187], v[72:87]
  v_mfma_f32_32x32x16_bf16 v[88:103], v[116:119], a[188:191], v[88:103]
  s_waitcnt lgkmcnt(2)
  v_mfma_f32_32x32x16_bf16 v[40:55], v[104:107], a[192:195], v[40:55]
  v_mfma_f32_32x32x16_bf16 v[56:71], v[104:107], a[196:199], v[56:71]
  ds_read_b128 v[116:119], v3 offset:11776
  s_waitcnt lgkmcnt(2)
  v_mfma_f32_32x32x16_bf16 v[40:55], v[108:111], a[208:211], v[40:55]
  v_mfma_f32_32x32x16_bf16 v[56:71], v[108:111], a[212:215], v[56:71]
  s_waitcnt lgkmcnt(1)
  v_mfma_f32_32x32x16_bf16 v[40:55], v[112:115], a[224:227], v[40:55]
  v_mfma_f32_32x32x16_bf16 v[56:71], v[112:115], a[228:231], v[56:71]
  s_waitcnt lgkmcnt(0)
  v_mfma_f32_32x32x16_bf16 v[40:55], v[116:119], a[240:243], v[40:55]
  v_mfma_f32_32x32x16_bf16 v[56:71], v[116:119], a[244:247], v[56:71]
  v_mfma_f32_32x32x16_bf16 v[72:87], v[104:107], a[200:203], v[72:87]
  v_mfma_f32_32x32x16_bf16 v[88:103], v[104:107], a[204:207], v[88:103]
  v_cvt_pk_bf16_f32 v212, v40, v56
  v_cvt_pk_bf16_f32 v214, v41, v57
  v_cvt_pk_bf16_f32 v216, v42, v58
  v_cvt_pk_bf16_f32 v218, v43, v59
  v_permlane16_swap_b32 v212, v214
  v_mfma_f32_32x32x16_bf16 v[72:87], v[108:111], a[216:219], v[72:87]
  v_cvt_pk_bf16_f32 v220, v44, v60
  v_cvt_pk_bf16_f32 v222, v45, v61
  v_permlane16_swap_b32 v216, v218
  v_bfi_b32 v212, v254, s42, v212
  v_cvt_pk_bf16_f32 v224, v46, v62
  v_mfma_f32_32x32x16_bf16 v[88:103], v[108:111], a[220:223], v[88:103]
  v_cvt_pk_bf16_f32 v226, v47, v63
  v_permlane16_swap_b32 v220, v222
  v_bfi_b32 v216, v254, s42, v216
  v_cvt_pk_bf16_f32 v228, v48, v64
  v_mfma_f32_32x32x16_bf16 v[72:87], v[112:115], a[232:235], v[72:87]
  v_cvt_pk_bf16_f32 v230, v49, v65
  v_permlane16_swap_b32 v224, v226
  v_bfi_b32 v220, v254, s42, v220
  v_cvt_pk_bf16_f32 v232, v50, v66
  v_cvt_pk_bf16_f32 v234, v51, v67
  v_mfma_f32_32x32x16_bf16 v[88:103], v[112:115], a[236:239], v[88:103]
  v_permlane16_swap_b32 v228, v230
  v_bfi_b32 v224, v254, s42, v224
  v_cvt_pk_bf16_f32 v236, v52, v68
  v_cvt_pk_bf16_f32 v238, v53, v69
  v_mfma_f32_32x32x16_bf16 v[72:87], v[116:119], a[248:251], v[72:87]
  v_permlane16_swap_b32 v232, v234
  v_bfi_b32 v228, v254, s42, v228
  v_cvt_pk_bf16_f32 v240, v54, v70
  v_cvt_pk_bf16_f32 v242, v55, v71
  v_permlane16_swap_b32 v236, v238
  v_mfma_f32_32x32x16_bf16 v[88:103], v[116:119], a[252:255], v[88:103]
  v_bfi_b32 v232, v254, s42, v232
  v_permlane16_swap_b32 v240, v242
  v_bfi_b32 v236, v254, s42, v236
  v_bfi_b32 v240, v254, s42, v240
  s_nop 7
  v_cvt_pk_bf16_f32 v213, v72, v88
  v_cvt_pk_bf16_f32 v215, v73, v89
  v_cvt_pk_bf16_f32 v217, v74, v90
  v_cvt_pk_bf16_f32 v219, v75, v91
  s_add_u32 s78, s86, 0
  v_permlane16_swap_b32 v213, v215
  buffer_store_dwordx4 v[212:215], v4, s[4:7], s78 offen sc1
  v_cvt_pk_bf16_f32 v221, v76, v92
  v_cvt_pk_bf16_f32 v223, v77, v93
  s_add_u32 s78, s86, 32768
  v_permlane16_swap_b32 v217, v219
  buffer_store_dwordx4 v[216:219], v4, s[4:7], s78 offen sc1
  v_cvt_pk_bf16_f32 v225, v78, v94
  v_cvt_pk_bf16_f32 v227, v79, v95
  s_add_u32 s78, s86, 131072
  v_permlane16_swap_b32 v221, v223
  buffer_store_dwordx4 v[220:223], v4, s[4:7], s78 offen sc1
  v_cvt_pk_bf16_f32 v229, v80, v96
  v_cvt_pk_bf16_f32 v231, v81, v97
  s_add_u32 s78, s86, 163840
  v_permlane16_swap_b32 v225, v227
  buffer_store_dwordx4 v[224:227], v4, s[4:7], s78 offen sc1
  v_cvt_pk_bf16_f32 v233, v82, v98
  v_cvt_pk_bf16_f32 v235, v83, v99
  s_add_u32 s78, s86, 262144
  v_permlane16_swap_b32 v229, v231
  buffer_store_dwordx4 v[228:231], v4, s[4:7], s78 offen sc1
  v_cvt_pk_bf16_f32 v237, v84, v100
  v_cvt_pk_bf16_f32 v239, v85, v101
  s_add_u32 s78, s86, 294912
  v_permlane16_swap_b32 v233, v235
  buffer_store_dwordx4 v[232:235], v4, s[4:7], s78 offen sc1
  v_cvt_pk_bf16_f32 v241, v86, v102
  v_cvt_pk_bf16_f32 v243, v87, v103
  s_add_u32 s78, s86, 393216
  v_permlane16_swap_b32 v237, v239
  buffer_store_dwordx4 v[236:239], v4, s[4:7], s78 offen sc1
  s_add_u32 s78, s86, 425984
  v_permlane16_swap_b32 v241, v243
  buffer_store_dwordx4 v[240:243], v4, s[4:7], s78 offen sc1
  s_branch o_we_205
o_wr1_203:
  s_nop 3
  v_mul_f32 v112, s24, v112
  v_mul_f32 v113, s24, v113
  v_exp_f32 v64, v112
  v_exp_f32 v65, v113
  v_max_f32 v116, v111, v116
  v_max3_f32 v116, v112, v113, v116
  v_add_f32 v117, v117, v64
  v_add_f32 v118, v118, v65
  v_add_f32 v117, v117, v118
  s_mov_b32 s28, 0x21800000
  v_mov_b32 v118, v117
  s_nop 1
  v_permlane16_swap_b32 v117, v118
  v_add_f32 v117, v117, v118
  v_mov_b32 v118, v117
  s_nop 0
  s_nop 0
  v_permlane32_swap_b32 v117, v118
  v_add_f32 v117, v117, v118
  s_mov_b32 s67, 0
  s_mov_b64 vcc, 0
  s_waitcnt vmcnt(3)
o_pl_211:
  v_and_b32 v7, 1, v7
  v_cmp_ne_u32 vcc, s96, v7
  s_cbranch_vccz o_pk_212
  buffer_load_dword v7, v255, s[4:7], s97 offen sc1
  s_add_u32 s67, s67, 1
  s_cmp_gt_u32 s67, 1048576
  s_cbranch_scc1 L_end
  s_waitcnt vmcnt(0)
  s_branch o_pl_211
o_pk_212:
  s_lshl_b32 s94, s43, 14
  s_add_u32 s94, s94, s95
  buffer_load_dwordx4 v[120:123], v5, s[4:7], s94 offen offset:0 sc1
  v_cmp_lt_f32 vcc, 0x42700000, v116
  v_cmp_gt_f32 s[30:31], s28, v117
  v_rcp_f32 v117, v117
  buffer_load_dwordx4 v[124:127], v5, s[4:7], s94 offen offset:512 sc1
  s_or_b64 vcc, vcc, s[30:31]
  s_cbranch_vccnz o_fb_209
o_fbr_210:
  buffer_load_dwordx4 v[128:131], v5, s[4:7], s94 offen offset:256 sc1
  v_pk_mul_f32 v[56:57], v[56:57], v[116:117] op_sel:[0,1] op_sel_hi:[1,1]
  v_pk_mul_f32 v[58:59], v[58:59], v[116:117] op_sel:[0,1] op_sel_hi:[1,1]
  v_pk_mul_f32 v[60:61], v[60:61], v[116:117] op_sel:[0,1] op_sel_hi:[1,1]
  v_pk_mul_f32 v[62:63], v[62:63], v[116:117] op_sel:[0,1] op_sel_hi:[1,1]
  v_pk_mul_f32 v[64:65], v[64:65], v[116:117] op_sel:[0,1] op_sel_hi:[1,1]
  buffer_load_dwordx4 v[132:135], v5, s[4:7], s94 offen offset:768 sc1
  v_cvt_pk_bf16_f32 v116, v56, v57
  v_cvt_pk_bf16_f32 v117, v58, v59
  v_cvt_pk_bf16_f32 v118, v60, v61
  v_cvt_pk_bf16_f32 v119, v62, v63
  s_waitcnt lgkmcnt(0)
  s_nop 0
  v_mfma_f32_16x16x32_bf16 v[72:75], v[152:155], v[116:119], 0
  s_add_u32 s62, s62, 1
  v_cvt_pk_bf16_f32 v197, v64, v65
  v_cvt_pk_bf16_f32 v198, v64, v65
  v_mfma_f32_16x16x32_bf16 v[76:79], v[156:159], v[116:119], 0
  s_add_u32 s94, s94, 4096
  buffer_load_dwordx4 v[136:139], v5, s[4:7], s94 offen offset:0 sc1
  s_xor_b32 s86, s86, 524288
  v_mfma_f32_16x16x32_bf16 v[80:83], v[160:163], v[116:119], 0
  s_bfe_u32 s42, s62, 0x10001
  v_mfma_f32_16x16x32_bf16 v[84:87], v[164:167], v[116:119], 0
  buffer_load_dwordx4 v[140:143], v5, s[4:7], s94 offen offset:512 sc1
  v_mfma_f32_16x16x32_bf16 v[88:91], v[168:171], v[116:119], 0
  v_mfma_f32_16x16x32_bf16 v[92:95], v[172:175], v[116:119], 0
  buffer_load_dwordx4 v[144:147], v5, s[4:7], s94 offen offset:256 sc1
  v_mfma_f32_16x16x32_bf16 v[96:99], v[176:179], v[116:119], 0
  v_mfma_f32_16x16x32_bf16 v[100:103], v[180:183], v[116:119], 0
  buffer_load_dwordx4 v[148:151], v5, s[4:7], s94 offen offset:768 sc1
  v_mfma_f32_16x16x16_bf16 v[72:75], v[200:201], v[198:199], v[72:75]
  s_nop 1
  v_mfma_f32_16x16x16_bf16 v[76:79], v[200:201], v[196:197], v[76:79]
  s_add_u32 s94, s94, 4096
  buffer_load_dwordx4 v[152:155], v5, s[4:7], s94 offen offset:0 sc1
  v_mfma_f32_16x16x16_bf16 v[80:83], v[202:203], v[198:199], v[80:83]
  s_nop 1
  v_mfma_f32_16x16x16_bf16 v[84:87], v[202:203], v[196:197], v[84:87]
  buffer_load_dwordx4 v[156:159], v5, s[4:7], s94 offen offset:512 sc1
  v_mfma_f32_16x16x16_bf16 v[88:91], v[204:205], v[198:199], v[88:91]
  s_nop 0
  v_cvt_pk_bf16_f32 v40, v72, v73
  v_cvt_pk_bf16_f32 v41, v74, v75
  v_mfma_f32_16x16x16_bf16 v[92:95], v[204:205], v[196:197], v[92:95]
  buffer_load_dwordx4 v[160:163], v5, s[4:7], s94 offen offset:256 sc1
  v_cvt_pk_bf16_f32 v42, v76, v77
  v_cvt_pk_bf16_f32 v43, v78, v79
  v_mfma_f32_16x16x16_bf16 v[96:99], v[206:207], v[198:199], v[96:99]
  s_nop 0
  ds_write_b128 v6, v[40:43] offset:0
  v_cvt_pk_bf16_f32 v44, v80, v81
  v_mfma_f32_16x16x16_bf16 v[100:103], v[206:207], v[196:197], v[100:103]
  buffer_load_dwordx4 v[164:167], v5, s[4:7], s94 offen offset:768 sc1
  v_cvt_pk_bf16_f32 v45, v82, v83
  v_cvt_pk_bf16_f32 v46, v84, v85
  v_cvt_pk_bf16_f32 v47, v86, v87
  ds_write_b128 v6, v[44:47] offset:1024
  v_cvt_pk_bf16_f32 v48, v88, v89
  v_cvt_pk_bf16_f32 v49, v90, v91
  v_cvt_pk_bf16_f32 v50, v92, v93
  v_cvt_pk_bf16_f32 v51, v94, v95
  s_add_u32 s94, s94, 4096
  buffer_load_dwordx4 v[168:171], v5, s[4:7], s94 offen offset:0 sc1
  ds_write_b128 v6, v[48:51] offset:2048
  v_cvt_pk_bf16_f32 v52, v96, v97
  v_cvt_pk_bf16_f32 v53, v98, v99
  v_cvt_pk_bf16_f32 v54, v100, v101
  v_cvt_pk_bf16_f32 v55, v102, v103
  ds_write_b128 v6, v[52:55] offset:3072
  buffer_load_dwordx4 v[172:175], v5, s[4:7], s94 offen offset:512 sc1
  s_and_b32 s26, s65, 49152
  s_cbranch_scc1 o_wr2_204
  s_waitcnt lgkmcnt(0)
  s_barrier
  ds_read_b128 v[104:107], v3 offset:0
  ds_read_b128 v[108:111], v3 offset:512
  ds_read_b128 v[112:115], v3 offset:1024
  buffer_load_dwordx4 v[176:179], v5, s[4:7], s94 offen offset:256 sc1
  buffer_load_dwordx4 v[180:183], v5, s[4:7], s94 offen offset:768 sc1
  s_waitcnt lgkmcnt(2)
  v_mfma_f32_32x32x16_bf16 v[40:55], v[104:107], a[0:3], 0
  v_mov_b64 v[188:189], 0
  v_mov_b64 v[190:191], 0
  v_mov_b64 v[192:193], 0
  v_mov_b64 v[194:195], 0
  s_mov_b64 exec, 1
  buffer_store_dword v38, off, s[4:7], s84 sc1
  s_mov_b64 exec, -1
  s_mov_b32 s84, 268435456
  v_mfma_f32_32x32x16_bf16 v[56:71], v[104:107], a[4:7], 0
  ds_read_b128 v[116:119], v3 offset:1536
  v_mfma_f32_32x32x16_bf16 v[72:87], v[104:107], a[8:11], 0
  v_mfma_f32_32x32x16_bf16 v[88:103], v[104:107], a[12:15], 0
  s_waitcnt vmcnt(13)
  v_xor_b32 v7, s96, v120
  v_bitop3_b32 v7, v7, v124, s96 bitop3:0xf6
  v_bitop3_b32 v7, v7, v128, s96 bitop3:0xf6
  v_bitop3_b32 v7, v7, v132, s96 bitop3:0xf6
  s_waitcnt lgkmcnt(2)
  v_mfma_f32_32x32x16_bf16 v[40:55], v[108:111], a[16:19], v[40:55]
  s_waitcnt vmcnt(9)
  v_bitop3_b32 v7, v7, v136, s96 bitop3:0xf6
  v_bitop3_b32 v7, v7, v140, s96 bitop3:0xf6
  v_bitop3_b32 v7, v7, v144, s96 bitop3:0xf6
  v_bitop3_b32 v7, v7, v148, s96 bitop3:0xf6
  s_waitcnt vmcnt(5)
  v_mfma_f32_32x32x16_bf16 v[56:71], v[108:111], a[20:23], v[56:71]
  ds_read_b128 v[104:107], v3 offset:2048
  v_bitop3_b32 v7, v7, v152, s96 bitop3:0xf6
  v_bitop3_b32 v7, v7, v156, s96 bitop3:0xf6
  v_bitop3_b32 v7, v7, v160, s96 bitop3:0xf6
  v_bitop3_b32 v7, v7, v164, s96 bitop3:0xf6
  s_waitcnt vmcnt(1)
  v_mfma_f32_32x32x16_bf16 v[72:87], v[108:111], a[24:27], v[72:87]
  v_bitop3_b32 v7, v7, v168, s96 bitop3:0xf6
  v_bitop3_b32 v7, v7, v172, s96 bitop3:0xf6
  v_bitop3_b32 v7, v7, v176, s96 bitop3:0xf6
  v_bitop3_b32 v7, v7, v180, s96 bitop3:0xf6
  v_and_b32 v7, v254, v7
  v_cmp_ne_u32 vcc, 0, v7
  s_cbranch_vccnz o_rt_213
o_bk_214:
  v_mfma_f32_32x32x16_bf16 v[88:103], v[108:111], a[28:31], v[88:103]
  v_smfmac_f32_16x16x64_bf16 v[188:191], v[16:19], v[120:127], v20
  v_lshlrev_b32 v196, 16, v184
  v_smfmac_f32_16x16x64_bf16 v[192:195], v[16:19], v[128:135], v20
  v_and_b32 v197, 0xffff0000, v184
  v_smfmac_f32_16x16x64_bf16 v[188:191], v[16:19], v[136:143], v20
  v_lshlrev_b32 v198, 16, v185
  s_waitcnt lgkmcnt(2)
  v_mfma_f32_32x32x16_bf16 v[40:55], v[112:115], a[32:35], v[40:55]
  v_smfmac_f32_16x16x64_bf16 v[192:195], v[16:19], v[144:151], v20
  v_and_b32 v199, 0xffff0000, v185
  v_smfmac_f32_16x16x64_bf16 v[188:191], v[16:19], v[152:159], v20
  v_lshlrev_b32 v200, 16, v186
  v_smfmac_f32_16x16x64_bf16 v[192:195], v[16:19], v[160:167], v20
  v_and_b32 v201, 0xffff0000, v186
  v_mfma_f32_32x32x16_bf16 v[56:71], v[112:115], a[36:39], v[56:71]
  ds_read_b128 v[108:111], v3 offset:2560
  v_smfmac_f32_16x16x64_bf16 v[188:191], v[16:19], v[168:175], v20
  v_lshlrev_b32 v202, 16, v187
  v_smfmac_f32_16x16x64_bf16 v[192:195], v[16:19], v[176:183], v20
  v_and_b32 v203, 0xffff0000, v187
  s_bfe_u32 s92, s65, 131086
  v_mfma_f32_32x32x16_bf16 v[72:87], v[112:115], a[40:43], v[72:87]
  s_lshl_b32 s92, s92, 21
  s_add_u32 s92, s92, s91
  s_add_u32 s93, s92, 27262976
  s_add_u32 s92, s92, 20971520
  v_permlane16_swap_b32 v188, v192
  v_mfma_f32_32x32x16_bf16 v[88:103], v[112:115], a[44:47], v[88:103]
  v_permlane16_swap_b32 v189, v193
  v_permlane16_swap_b32 v190, v194
  v_permlane16_swap_b32 v191, v195
  s_waitcnt lgkmcnt(2)
  v_mfma_f32_32x32x16_bf16 v[40:55], v[116:119], a[48:51], v[40:55]
  v_cvt_pk_bf16_f32 v188, 0, v188
  v_cvt_pk_bf16_f32 v189, 0, v189
  v_cvt_pk_bf16_f32 v190, 0, v190
  v_cvt_pk_bf16_f32 v191, 0, v191
  v_cvt_pk_bf16_f32 v192, 0, v192
  v_cvt_pk_bf16_f32 v193, 0, v193
  v_mfma_f32_32x32x16_bf16 v[56:71], v[116:119], a[52:55], v[56:71]
  ds_read_b128 v[112:115], v3 offset:3072
  v_cvt_pk_bf16_f32 v194, 0, v194
  v_cvt_pk_bf16_f32 v195, 0, v195
  v_add_f32 v196, v196, v188
  v_add_f32 v197, v197, v189
  v_add_f32 v198, v198, v190
  v_mfma_f32_32x32x16_bf16 v[72:87], v[116:119], a[56:59], v[72:87]
  v_add_f32 v199, v199, v191
  v_add_f32 v200, v200, v192
  v_add_f32 v201, v201, v193
  v_add_f32 v202, v202, v194
  v_add_f32 v203, v203, v195
  v_cvt_pk_bf16_f32 v120, v196, v197
  v_mfma_f32_32x32x16_bf16 v[88:103], v[116:119], a[60:63], v[88:103]
  v_cvt_pk_bf16_f32 v121, v198, v199
  v_cvt_pk_bf16_f32 v122, v200, v201
  v_cvt_pk_bf16_f32 v123, v202, v203
  v_lshlrev_b32 v196, 16, v120
  v_and_b32 v197, 0xffff0000, v120
  s_waitcnt lgkmcnt(2)
  v_mfma_f32_32x32x16_bf16 v[40:55], v[104:107], a[64:67], v[40:55]
  v_lshlrev_b32 v198, 16, v121
  v_and_b32 v199, 0xffff0000, v121
  v_lshlrev_b32 v200, 16, v122
  v_and_b32 v201, 0xffff0000, v122
  v_lshlrev_b32 v202, 16, v123
  v_and_b32 v203, 0xffff0000, v123
  v_mfma_f32_32x32x16_bf16 v[56:71], v[104:107], a[68:71], v[56:71]
  ds_read_b128 v[116:119], v3 offset:3584
  buffer_store_dwordx4 v[120:123], v0, s[4:7], s92 offen sc1
  v_add_f32 v136, v196, v197
  v_mul_f32 v137, v196, v196
  v_mfma_f32_32x32x16_bf16 v[72:87], v[104:107], a[72:75], v[72:87]
  v_add_f32 v138, v198, v199
  v_mul_f32 v139, v197, v197
  v_fmac_f32 v137, v198, v198
  v_fmac_f32 v139, v199, v199
  v_add_f32 v136, v136, v200
  v_fmac_f32 v137, v200, v200
  v_mfma_f32_32x32x16_bf16 v[88:103], v[104:107], a[76:79], v[88:103]
  v_add_f32 v138, v138, v201
  v_fmac_f32 v139, v201, v201
  v_add_f32 v136, v136, v202
  v_fmac_f32 v137, v202, v202
  v_add_f32 v138, v138, v203
  s_waitcnt lgkmcnt(2)
  v_mfma_f32_32x32x16_bf16 v[40:55], v[108:111], a[80:83], v[40:55]
  v_fmac_f32 v139, v203, v203
  v_add_f32 v136, v136, v138
  v_add_f32 v137, v137, v139
  s_nop 0
  v_add_f32_dpp v136, v136, v136 row_ror:8 row_mask:0xf bank_mask:0xf
  v_add_f32_dpp v137, v137, v137 row_ror:8 row_mask:0xf bank_mask:0xf
  s_nop 0
  v_add_f32_dpp v136, v136, v136 row_ror:4 row_mask:0xf bank_mask:0xf
  v_mfma_f32_32x32x16_bf16 v[56:71], v[108:111], a[84:87], v[56:71]
  ds_read_b128 v[104:107], v3 offset:8192
  v_add_f32_dpp v137, v137, v137 row_ror:4 row_mask:0xf bank_mask:0xf
  v_add_f32_dpp v136, v136, v136 row_ror:2 row_mask:0xf bank_mask:0xf
  s_nop 0
  v_add_f32_dpp v137, v137, v137 row_ror:2 row_mask:0xf bank_mask:0xf
  v_add_f32_dpp v136, v136, v136 row_ror:1 row_mask:0xf bank_mask:0xf
  s_nop 0
  v_add_f32_dpp v137, v137, v137 row_ror:1 row_mask:0xf bank_mask:0xf
  v_mfma_f32_32x32x16_bf16 v[72:87], v[108:111], a[88:91], v[72:87]
  v_mov_b32 v140, v136
  v_mov_b32 v141, v137
  s_nop 0
  v_permlane16_swap_b32 v136, v140
  v_permlane16_swap_b32 v137, v141
  v_mfma_f32_32x32x16_bf16 v[88:103], v[108:111], a[92:95], v[88:103]
  v_add_f32 v136, v136, v140
  v_add_f32 v137, v137, v141
  v_mov_b32 v140, v136
  v_mov_b32 v141, v137
  s_nop 0
  v_permlane32_swap_b32 v136, v140
  s_waitcnt lgkmcnt(2)
  v_mfma_f32_32x32x16_bf16 v[40:55], v[112:115], a[96:99], v[40:55]
  v_permlane32_swap_b32 v137, v141
  v_add_f32 v136, v136, v140
  v_add_f32 v137, v137, v141
  v_mul_f32 v136, 0x3b000000, v136
  v_mul_f32 v137, 0x3b000000, v137
  v_mfma_f32_32x32x16_bf16 v[56:71], v[112:115], a[100:103], v[56:71]
  ds_read_b128 v[108:111], v3 offset:8704
  v_fma_f32 v137, -v136, v136, v137
  v_cvt_pk_bf16_f32 v136, 0, v136
  v_max_f32 v137, 0, v137
  v_sub_f32 v140, v196, v136
  v_sub_f32 v141, v197, v136
  v_mfma_f32_32x32x16_bf16 v[72:87], v[112:115], a[104:107], v[72:87]
  v_cvt_pk_bf16_f32 v137, 0, v137
  v_sub_f32 v142, v198, v136
  v_sub_f32 v143, v199, v136
  v_add_f32 v137, 0x3727c5ac, v137
  v_sub_f32 v144, v200, v136
  v_sub_f32 v145, v201, v136
  v_mfma_f32_32x32x16_bf16 v[88:103], v[112:115], a[108:111], v[88:103]
  v_cvt_pk_bf16_f32 v137, 0, v137
  v_sub_f32 v146, v202, v136
  v_sub_f32 v147, v203, v136
  v_sqrt_f32 v137, v137
  s_waitcnt lgkmcnt(2)
  v_mfma_f32_32x32x16_bf16 v[40:55], v[116:119], a[112:115], v[40:55]
  v_cvt_pk_bf16_f32 v140, 0, v140
  v_cvt_pk_bf16_f32 v141, 0, v141
  v_cvt_pk_bf16_f32 v137, 0, v137
  v_cvt_pk_bf16_f32 v142, 0, v142
  v_cvt_pk_bf16_f32 v143, 0, v143
  v_rcp_f32 v137, v137
  v_mfma_f32_32x32x16_bf16 v[56:71], v[116:119], a[116:119], v[56:71]
  ds_read_b128 v[112:115], v3 offset:9216
  v_cvt_pk_bf16_f32 v144, 0, v144
  v_cvt_pk_bf16_f32 v145, 0, v145
  v_cvt_pk_bf16_f32 v146, 0, v146
  v_cvt_pk_bf16_f32 v147, 0, v147
  v_mul_f32 v140, v140, v137
  v_mfma_f32_32x32x16_bf16 v[72:87], v[116:119], a[120:123], v[72:87]
  v_mul_f32 v141, v141, v137
  v_mul_f32 v142, v142, v137
  v_mul_f32 v143, v143, v137
  v_mul_f32 v144, v144, v137
  v_mul_f32 v145, v145, v137
  v_mul_f32 v146, v146, v137
  v_mfma_f32_32x32x16_bf16 v[88:103], v[116:119], a[124:127], v[88:103]
  v_mul_f32 v147, v147, v137
  v_cvt_pk_bf16_f32 v124, v140, v141
  v_cvt_pk_bf16_f32 v125, v142, v143
  v_cvt_pk_bf16_f32 v126, v144, v145
  v_cvt_pk_bf16_f32 v127, v146, v147
  s_waitcnt lgkmcnt(2)
  v_mfma_f32_32x32x16_bf16 v[40:55], v[104:107], a[128:131], v[40:55]
  v_lshlrev_b32 v204, 16, v124
  v_and_b32 v205, 0xffff0000, v124
  v_lshlrev_b32 v206, 16, v125
  v_and_b32 v207, 0xffff0000, v125
  v_lshlrev_b32 v208, 16, v126
  v_and_b32 v209, 0xffff0000, v126
  v_mfma_f32_32x32x16_bf16 v[56:71], v[104:107], a[132:135], v[56:71]
  ds_read_b128 v[116:119], v3 offset:9728
  v_lshlrev_b32 v210, 16, v127
  v_and_b32 v211, 0xffff0000, v127
  buffer_store_dwordx4 v[124:127], v0, s[4:7], s93 offen sc1
  v_mfma_f32_32x32x16_bf16 v[72:87], v[104:107], a[136:139], v[72:87]
  v_add_f32 v196, v196, v204
  v_add_f32 v197, v197, v205
  v_add_f32 v198, v198, v206
  v_add_f32 v199, v199, v207
  v_add_f32 v200, v200, v208
  v_add_f32 v201, v201, v209
  v_mfma_f32_32x32x16_bf16 v[88:103], v[104:107], a[140:143], v[88:103]
  v_add_f32 v202, v202, v210
  v_add_f32 v203, v203, v211
  v_cvt_pk_bf16_f32 v128, v196, v197
  v_cvt_pk_bf16_f32 v129, v198, v199
  v_cvt_pk_bf16_f32 v130, v200, v201
  s_waitcnt lgkmcnt(2)
  v_mfma_f32_32x32x16_bf16 v[40:55], v[108:111], a[144:147], v[40:55]
  v_cvt_pk_bf16_f32 v131, v202, v203
  v_mul_f32 v188, v204, v8
  v_mul_f32 v189, v205, v9
  v_fmac_f32 v188, v206, v10
  v_fmac_f32 v189, v207, v11
  v_fmac_f32 v188, v208, v12
  v_mfma_f32_32x32x16_bf16 v[56:71], v[108:111], a[148:151], v[56:71]
  ds_read_b128 v[104:107], v3 offset:10240
  v_fmac_f32 v189, v209, v13
  v_fmac_f32 v188, v210, v14
  v_fmac_f32 v189, v211, v15
  v_add_f32 v188, v188, v189
  s_add_u32 s92, s91, 10485760
  v_mfma_f32_32x32x16_bf16 v[72:87], v[108:111], a[152:155], v[72:87]
  s_add_u32 s93, s91, 8388608
  buffer_store_dwordx4 v[128:131], v0, s[4:7], s92 offen sc1
  v_lshlrev_b32 v196, 16, v128
  v_and_b32 v197, 0xffff0000, v128
  v_mfma_f32_32x32x16_bf16 v[88:103], v[108:111], a[156:159], v[88:103]
  v_lshlrev_b32 v198, 16, v129
  v_and_b32 v199, 0xffff0000, v129
  v_lshlrev_b32 v200, 16, v130
  v_and_b32 v201, 0xffff0000, v130
  v_lshlrev_b32 v202, 16, v131
  s_waitcnt lgkmcnt(2)
  v_mfma_f32_32x32x16_bf16 v[40:55], v[112:115], a[160:163], v[40:55]
  v_and_b32 v203, 0xffff0000, v131
  v_add_f32 v136, v196, v197
  v_mul_f32 v137, v196, v196
  v_add_f32 v138, v198, v199
  v_mul_f32 v139, v197, v197
  v_fmac_f32 v137, v198, v198
  v_mfma_f32_32x32x16_bf16 v[56:71], v[112:115], a[164:167], v[56:71]
  ds_read_b128 v[108:111], v3 offset:10752
  v_fmac_f32 v139, v199, v199
  v_add_f32 v136, v136, v200
  v_fmac_f32 v137, v200, v200
  v_add_f32 v138, v138, v201
  v_fmac_f32 v139, v201, v201
  v_mfma_f32_32x32x16_bf16 v[72:87], v[112:115], a[168:171], v[72:87]
  v_add_f32 v136, v136, v202
  v_fmac_f32 v137, v202, v202
  v_add_f32 v138, v138, v203
  v_fmac_f32 v139, v203, v203
  v_add_f32 v136, v136, v138
  v_add_f32 v137, v137, v139
  v_mfma_f32_32x32x16_bf16 v[88:103], v[112:115], a[172:175], v[88:103]
  v_add_f32_dpp v136, v136, v136 row_ror:8 row_mask:0xf bank_mask:0xf
  v_add_f32_dpp v137, v137, v137 row_ror:8 row_mask:0xf bank_mask:0xf
  v_add_f32_dpp v188, v188, v188 row_ror:8 row_mask:0xf bank_mask:0xf
  v_add_f32_dpp v136, v136, v136 row_ror:4 row_mask:0xf bank_mask:0xf
  v_add_f32_dpp v137, v137, v137 row_ror:4 row_mask:0xf bank_mask:0xf
  s_waitcnt lgkmcnt(2)
  v_mfma_f32_32x32x16_bf16 v[40:55], v[116:119], a[176:179], v[40:55]
  v_add_f32_dpp v188, v188, v188 row_ror:4 row_mask:0xf bank_mask:0xf
  v_add_f32_dpp v136, v136, v136 row_ror:2 row_mask:0xf bank_mask:0xf
  v_add_f32_dpp v137, v137, v137 row_ror:2 row_mask:0xf bank_mask:0xf
  v_add_f32_dpp v188, v188, v188 row_ror:2 row_mask:0xf bank_mask:0xf
  v_add_f32_dpp v136, v136, v136 row_ror:1 row_mask:0xf bank_mask:0xf
  v_add_f32_dpp v137, v137, v137 row_ror:1 row_mask:0xf bank_mask:0xf
  v_mfma_f32_32x32x16_bf16 v[56:71], v[116:119], a[180:183], v[56:71]
  ds_read_b128 v[112:115], v3 offset:11264
  v_add_f32_dpp v188, v188, v188 row_ror:1 row_mask:0xf bank_mask:0xf
  v_mov_b32 v140, v136
  v_mov_b32 v141, v137
  v_mov_b32 v142, v188
  v_permlane16_swap_b32 v136, v140
  v_mfma_f32_32x32x16_bf16 v[72:87], v[116:119], a[184:187], v[72:87]
  v_permlane16_swap_b32 v137, v141
  v_permlane16_swap_b32 v188, v142
  v_add_f32 v136, v136, v140
  v_add_f32 v137, v137, v141
  v_mfma_f32_32x32x16_bf16 v[88:103], v[116:119], a[188:191], v[88:103]
  v_add_f32 v188, v188, v142
  v_mov_b32 v140, v136
  v_mov_b32 v141, v137
  v_mov_b32 v142, v188
  v_permlane32_swap_b32 v136, v140
  s_waitcnt lgkmcnt(2)
  v_mfma_f32_32x32x16_bf16 v[40:55], v[104:107], a[192:195], v[40:55]
  v_permlane32_swap_b32 v137, v141
  v_permlane32_swap_b32 v188, v142
  v_add_f32 v136, v136, v140
  v_add_f32 v137, v137, v141
  v_mfma_f32_32x32x16_bf16 v[56:71], v[104:107], a[196:199], v[56:71]
  ds_read_b128 v[116:119], v3 offset:11776
  v_add_f32 v188, v188, v142
  v_mul_f32 v136, 0x3b000000, v136
  v_mul_f32 v137, 0x3b000000, v137
  v_fma_f32 v137, -v136, v136, v137
  v_cvt_pk_bf16_f32 v136, 0, v136
  s_waitcnt lgkmcnt(2)
  v_mfma_f32_32x32x16_bf16 v[40:55], v[108:111], a[208:211], v[40:55]
  v_max_f32 v137, 0, v137
  v_sub_f32 v140, v196, v136
  v_sub_f32 v141, v197, v136
  v_cvt_pk_bf16_f32 v137, 0, v137
  v_sub_f32 v142, v198, v136
  v_sub_f32 v143, v199, v136
  v_mfma_f32_32x32x16_bf16 v[56:71], v[108:111], a[212:215], v[56:71]
  v_add_f32 v137, 0x3727c5ac, v137
  v_sub_f32 v144, v200, v136
  v_sub_f32 v145, v201, v136
  v_cvt_pk_bf16_f32 v137, 0, v137
  v_sub_f32 v146, v202, v136
  v_sub_f32 v147, v203, v136
  s_waitcnt lgkmcnt(1)
  v_mfma_f32_32x32x16_bf16 v[40:55], v[112:115], a[224:227], v[40:55]
  v_sqrt_f32 v137, v137
  v_cvt_pk_bf16_f32 v140, 0, v140
  v_cvt_pk_bf16_f32 v141, 0, v141
  v_cvt_pk_bf16_f32 v137, 0, v137
  v_cvt_pk_bf16_f32 v142, 0, v142
  v_mfma_f32_32x32x16_bf16 v[56:71], v[112:115], a[228:231], v[56:71]
  v_cvt_pk_bf16_f32 v143, 0, v143
  v_rcp_f32 v137, v137
  v_cvt_pk_bf16_f32 v144, 0, v144
  v_cvt_pk_bf16_f32 v145, 0, v145
  v_cvt_pk_bf16_f32 v146, 0, v146
  s_waitcnt lgkmcnt(0)
  v_mfma_f32_32x32x16_bf16 v[40:55], v[116:119], a[240:243], v[40:55]
  v_cvt_pk_bf16_f32 v147, 0, v147
  v_mul_f32 v140, v140, v137
  v_mul_f32 v141, v141, v137
  v_mul_f32 v142, v142, v137
  v_mul_f32 v143, v143, v137
  v_mul_f32 v144, v144, v137
  v_mfma_f32_32x32x16_bf16 v[56:71], v[116:119], a[244:247], v[56:71]
  v_mul_f32 v145, v145, v137
  v_mul_f32 v146, v146, v137
  v_mul_f32 v147, v147, v137
  v_cvt_pk_bf16_f32 v132, v140, v141
  v_cvt_pk_bf16_f32 v133, v142, v143
  v_cvt_pk_bf16_f32 v134, v144, v145
  v_mfma_f32_32x32x16_bf16 v[72:87], v[104:107], a[200:203], v[72:87]
  v_cvt_pk_bf16_f32 v135, v146, v147
  buffer_store_dwordx4 v[132:135], v0, s[4:7], s93 offen sc1
  v_cvt_pk_bf16_f32 v188, 0, v188
  v_ashrrev_i32 v189, 31, v188
  v_mfma_f32_32x32x16_bf16 v[88:103], v[104:107], a[204:207], v[88:103]
  v_or_b32 v189, 0x80000000, v189
  v_xor_b32 v188, v188, v189
  s_sub_u32 s92, 4095, s90
  v_and_b32 v188, 0xffff0000, v188
  v_or_b32 v38, s92, v188
  v_mfma_f32_32x32x16_bf16 v[72:87], v[108:111], a[216:219], v[72:87]
  s_bfe_u32 s92, s65, 196625
  s_lshl_b32 s92, s92, 18
  s_lshl_b32 s93, s90, 7
  s_add_u32 s92, s92, s93
  s_add_u32 s84, s92, 243269632
  v_cvt_pk_bf16_f32 v212, v40, v56
  v_mfma_f32_32x32x16_bf16 v[88:103], v[108:111], a[220:223], v[88:103]
  v_cvt_pk_bf16_f32 v214, v41, v57
  v_cvt_pk_bf16_f32 v216, v42, v58
  v_cvt_pk_bf16_f32 v218, v43, v59
  v_permlane16_swap_b32 v212, v214
  v_mfma_f32_32x32x16_bf16 v[72:87], v[112:115], a[232:235], v[72:87]
  v_cvt_pk_bf16_f32 v220, v44, v60
  v_cvt_pk_bf16_f32 v222, v45, v61
  v_permlane16_swap_b32 v216, v218
  v_bfi_b32 v212, v254, s42, v212
  v_cvt_pk_bf16_f32 v224, v46, v62
  v_mfma_f32_32x32x16_bf16 v[88:103], v[112:115], a[236:239], v[88:103]
  v_cvt_pk_bf16_f32 v226, v47, v63
  v_permlane16_swap_b32 v220, v222
  v_bfi_b32 v216, v254, s42, v216
  v_cvt_pk_bf16_f32 v228, v48, v64
  v_mfma_f32_32x32x16_bf16 v[72:87], v[116:119], a[248:251], v[72:87]
  v_cvt_pk_bf16_f32 v230, v49, v65
  v_permlane16_swap_b32 v224, v226
  v_bfi_b32 v220, v254, s42, v220
  v_cvt_pk_bf16_f32 v232, v50, v66
  v_cvt_pk_bf16_f32 v234, v51, v67
  v_mfma_f32_32x32x16_bf16 v[88:103], v[116:119], a[252:255], v[88:103]
  v_permlane16_swap_b32 v228, v230
  v_bfi_b32 v224, v254, s42, v224
  v_cvt_pk_bf16_f32 v236, v52, v68
  v_cvt_pk_bf16_f32 v238, v53, v69
  v_permlane16_swap_b32 v232, v234
  v_bfi_b32 v228, v254, s42, v228
  v_cvt_pk_bf16_f32 v240, v54, v70
  v_cvt_pk_bf16_f32 v242, v55, v71
  v_permlane16_swap_b32 v236, v238
  v_bfi_b32 v232, v254, s42, v232
  v_permlane16_swap_b32 v240, v242
  v_bfi_b32 v236, v254, s42, v236
  v_bfi_b32 v240, v254, s42, v240
  v_cvt_pk_bf16_f32 v213, v72, v88
  v_cvt_pk_bf16_f32 v215, v73, v89
  v_cvt_pk_bf16_f32 v217, v74, v90
  v_cvt_pk_bf16_f32 v219, v75, v91
  s_add_u32 s78, s86, 0
  v_permlane16_swap_b32 v213, v215
  buffer_store_dwordx4 v[212:215], v4, s[4:7], s78 offen sc1
  v_cvt_pk_bf16_f32 v221, v76, v92
  v_cvt_pk_bf16_f32 v223, v77, v93
  s_add_u32 s78, s86, 32768
  v_permlane16_swap_b32 v217, v219
  buffer_store_dwordx4 v[216:219], v4, s[4:7], s78 offen sc1
  v_cvt_pk_bf16_f32 v225, v78, v94
  v_cvt_pk_bf16_f32 v227, v79, v95
  s_add_u32 s78, s86, 131072
  v_permlane16_swap_b32 v221, v223
  buffer_store_dwordx4 v[220:223], v4, s[4:7], s78 offen sc1
  v_cvt_pk_bf16_f32 v229, v80, v96
  v_cvt_pk_bf16_f32 v231, v81, v97
  s_add_u32 s78, s86, 163840
  v_permlane16_swap_b32 v225, v227
  buffer_store_dwordx4 v[224:227], v4, s[4:7], s78 offen sc1
  v_cvt_pk_bf16_f32 v233, v82, v98
  v_cvt_pk_bf16_f32 v235, v83, v99
  s_add_u32 s78, s86, 262144
  v_permlane16_swap_b32 v229, v231
  buffer_store_dwordx4 v[228:231], v4, s[4:7], s78 offen sc1
  v_cvt_pk_bf16_f32 v237, v84, v100
  v_cvt_pk_bf16_f32 v239, v85, v101
  s_add_u32 s78, s86, 294912
  v_permlane16_swap_b32 v233, v235
  buffer_store_dwordx4 v[232:235], v4, s[4:7], s78 offen sc1
  v_cvt_pk_bf16_f32 v241, v86, v102
  v_cvt_pk_bf16_f32 v243, v87, v103
  s_add_u32 s78, s86, 393216
  v_permlane16_swap_b32 v237, v239
  buffer_store_dwordx4 v[236:239], v4, s[4:7], s78 offen sc1
  s_add_u32 s78, s86, 425984
  v_permlane16_swap_b32 v241, v243
  buffer_store_dwordx4 v[240:243], v4, s[4:7], s78 offen sc1
  s_waitcnt vmcnt(8)
  s_mov_b64 exec, 1
  buffer_store_dword v38, off, s[4:7], s84 sc1
  s_mov_b64 exec, -1
  s_mov_b32 s84, 268435456
  s_branch o_we_205
o_rt_213:
  s_mov_b32 s67, 0
o_rl_217:
  s_lshl_b32 s94, s43, 14
  s_add_u32 s94, s94, s95
  buffer_load_dwordx4 v[120:123], v5, s[4:7], s94 offen offset:0 sc1
  buffer_load_dwordx4 v[124:127], v5, s[4:7], s94 offen offset:512 sc1
  buffer_load_dwordx4 v[128:131], v5, s[4:7], s94 offen offset:256 sc1
  buffer_load_dwordx4 v[132:135], v5, s[4:7], s94 offen offset:768 sc1
  s_add_u32 s94, s94, 4096
  buffer_load_dwordx4 v[136:139], v5, s[4:7], s94 offen offset:0 sc1
  buffer_load_dwordx4 v[140:143], v5, s[4:7], s94 offen offset:512 sc1
  buffer_load_dwordx4 v[144:147], v5, s[4:7], s94 offen offset:256 sc1
  buffer_load_dwordx4 v[148:151], v5, s[4:7], s94 offen offset:768 sc1
  s_add_u32 s94, s94, 4096
  buffer_load_dwordx4 v[152:155], v5, s[4:7], s94 offen offset:0 sc1
  buffer_load_dwordx4 v[156:159], v5, s[4:7], s94 offen offset:512 sc1
  buffer_load_dwordx4 v[160:163], v5, s[4:7], s94 offen offset:256 sc1
  buffer_load_dwordx4 v[164:167], v5, s[4:7], s94 offen offset:768 sc1
  s_add_u32 s94, s94, 4096
  buffer_load_dwordx4 v[168:171], v5, s[4:7], s94 offen offset:0 sc1
  buffer_load_dwordx4 v[172:175], v5, s[4:7], s94 offen offset:512 sc1
  buffer_load_dwordx4 v[176:179], v5, s[4:7], s94 offen offset:256 sc1
  buffer_load_dwordx4 v[180:183], v5, s[4:7], s94 offen offset:768 sc1
  s_add_u32 s67, s67, 1
  s_cmp_gt_u32 s67, 1048576
  s_cbranch_scc1 L_end
  s_waitcnt vmcnt(0)
  v_xor_b32 v7, s96, v120
  v_bitop3_b32 v7, v7, v124, s96 bitop3:0xf6
  v_bitop3_b32 v7, v7, v128, s96 bitop3:0xf6
  v_bitop3_b32 v7, v7, v132, s96 bitop3:0xf6
  v_bitop3_b32 v7, v7, v136, s96 bitop3:0xf6
  v_bitop3_b32 v7, v7, v140, s96 bitop3:0xf6
  v_bitop3_b32 v7, v7, v144, s96 bitop3:0xf6
  v_bitop3_b32 v7, v7, v148, s96 bitop3:0xf6
  v_bitop3_b32 v7, v7, v152, s96 bitop3:0xf6
  v_bitop3_b32 v7, v7, v156, s96 bitop3:0xf6
  v_bitop3_b32 v7, v7, v160, s96 bitop3:0xf6
  v_bitop3_b32 v7, v7, v164, s96 bitop3:0xf6
  v_bitop3_b32 v7, v7, v168, s96 bitop3:0xf6
  v_bitop3_b32 v7, v7, v172, s96 bitop3:0xf6
  v_bitop3_b32 v7, v7, v176, s96 bitop3:0xf6
  v_bitop3_b32 v7, v7, v180, s96 bitop3:0xf6
  v_and_b32 v7, v254, v7
  v_cmp_ne_u32 vcc, 0, v7
  s_cbranch_vccnz o_rl_217
  s_branch o_bk_214
o_rt_215:
  s_mov_b32 s67, 0
o_rl_218:
  s_lshl_b32 s94, s43, 14
  s_add_u32 s94, s94, s95
  buffer_load_dwordx4 v[120:123], v5, s[4:7], s94 offen offset:0 sc1
  buffer_load_dwordx4 v[124:127], v5, s[4:7], s94 offen offset:512 sc1
  buffer_load_dwordx4 v[128:131], v5, s[4:7], s94 offen offset:256 sc1
  buffer_load_dwordx4 v[132:135], v5, s[4:7], s94 offen offset:768 sc1
  s_add_u32 s94, s94, 4096
  buffer_load_dwordx4 v[136:139], v5, s[4:7], s94 offen offset:0 sc1
  buffer_load_dwordx4 v[140:143], v5, s[4:7], s94 offen offset:512 sc1
  buffer_load_dwordx4 v[144:147], v5, s[4:7], s94 offen offset:256 sc1
  buffer_load_dwordx4 v[148:151], v5, s[4:7], s94 offen offset:768 sc1
  s_add_u32 s94, s94, 4096
  buffer_load_dwordx4 v[152:155], v5, s[4:7], s94 offen offset:0 sc1
  buffer_load_dwordx4 v[156:159], v5, s[4:7], s94 offen offset:512 sc1
  buffer_load_dwordx4 v[160:163], v5, s[4:7], s94 offen offset:256 sc1
  buffer_load_dwordx4 v[164:167], v5, s[4:7], s94 offen offset:768 sc1
  s_add_u32 s94, s94, 4096
  buffer_load_dwordx4 v[168:171], v5, s[4:7], s94 offen offset:0 sc1
  buffer_load_dwordx4 v[172:175], v5, s[4:7], s94 offen offset:512 sc1
  buffer_load_dwordx4 v[176:179], v5, s[4:7], s94 offen offset:256 sc1
  buffer_load_dwordx4 v[180:183], v5, s[4:7], s94 offen offset:768 sc1
  s_add_u32 s67, s67, 1
  s_cmp_gt_u32 s67, 1048576
  s_cbranch_scc1 L_end
  s_waitcnt vmcnt(0)
  v_xor_b32 v7, s96, v120
  v_bitop3_b32 v7, v7, v124, s96 bitop3:0xf6
  v_bitop3_b32 v7, v7, v128, s96 bitop3:0xf6
  v_bitop3_b32 v7, v7, v132, s96 bitop3:0xf6
  v_bitop3_b32 v7, v7, v136, s96 bitop3:0xf6
  v_bitop3_b32 v7, v7, v140, s96 bitop3:0xf6
  v_bitop3_b32 v7, v7, v144, s96 bitop3:0xf6
  v_bitop3_b32 v7, v7, v148, s96 bitop3:0xf6
  v_bitop3_b32 v7, v7, v152, s96 bitop3:0xf6
  v_bitop3_b32 v7, v7, v156, s96 bitop3:0xf6
  v_bitop3_b32 v7, v7, v160, s96 bitop3:0xf6
  v_bitop3_b32 v7, v7, v164, s96 bitop3:0xf6
  v_bitop3_b32 v7, v7, v168, s96 bitop3:0xf6
  v_bitop3_b32 v7, v7, v172, s96 bitop3:0xf6
  v_bitop3_b32 v7, v7, v176, s96 bitop3:0xf6
  v_bitop3_b32 v7, v7, v180, s96 bitop3:0xf6
  v_and_b32 v7, v254, v7
  v_cmp_ne_u32 vcc, 0, v7
  s_cbranch_vccnz o_rl_218
  s_branch o_bk_216
o_fb_207:
  v_mov_b32 v118, v116
  s_nop 1
  v_permlane16_swap_b32 v116, v118
  v_max_f32 v116, v116, v118
  v_mov_b32 v118, v116
  s_nop 0
  s_nop 0
  v_permlane32_swap_b32 v116, v118
  v_max_f32 v116, v116, v118
  v_sub_f32 v56, v104, v116
  v_sub_f32 v57, v105, v116
  v_sub_f32 v58, v106, v116
  v_sub_f32 v59, v107, v116
  v_sub_f32 v60, v108, v116
  v_sub_f32 v61, v109, v116
  v_sub_f32 v62, v110, v116
  v_sub_f32 v63, v111, v116
  v_sub_f32 v64, v112, v116
  v_sub_f32 v65, v113, v116
  v_exp_f32 v56, v56
  v_exp_f32 v57, v57
  v_exp_f32 v58, v58
  v_exp_f32 v59, v59
  v_exp_f32 v60, v60
  v_exp_f32 v61, v61
  v_exp_f32 v62, v62
  v_exp_f32 v63, v63
  v_exp_f32 v64, v64
  v_exp_f32 v65, v65
  v_add_f32 v117, v56, v57
  v_add_f32 v117, v117, v58
  v_add_f32 v117, v117, v59
  v_add_f32 v117, v117, v60
  v_add_f32 v117, v117, v61
  v_add_f32 v117, v117, v62
  v_add_f32 v117, v117, v63
  v_add_f32 v117, v117, v64
  v_add_f32 v117, v117, v65
  v_mov_b32 v118, v117
  s_nop 0
  s_nop 0
  v_permlane16_swap_b32 v117, v118
  v_add_f32 v117, v117, v118
  v_mov_b32 v118, v117
  s_nop 0
  s_nop 0
  v_permlane32_swap_b32 v117, v118
  v_add_f32 v117, v117, v118
  v_rcp_f32 v117, v117
  s_branch o_fbr_208
o_fb_209:
  v_mov_b32 v118, v116
  s_nop 1
  v_permlane16_swap_b32 v116, v118
  v_max_f32 v116, v116, v118
  v_mov_b32 v118, v116
  s_nop 0
  s_nop 0
  v_permlane32_swap_b32 v116, v118
  v_max_f32 v116, v116, v118
  v_sub_f32 v56, v104, v116
  v_sub_f32 v57, v105, v116
  v_sub_f32 v58, v106, v116
  v_sub_f32 v59, v107, v116
  v_sub_f32 v60, v108, v116
  v_sub_f32 v61, v109, v116
  v_sub_f32 v62, v110, v116
  v_sub_f32 v63, v111, v116
  v_sub_f32 v64, v112, v116
  v_sub_f32 v65, v113, v116
  v_exp_f32 v56, v56
  v_exp_f32 v57, v57
  v_exp_f32 v58, v58
  v_exp_f32 v59, v59
  v_exp_f32 v60, v60
  v_exp_f32 v61, v61
  v_exp_f32 v62, v62
  v_exp_f32 v63, v63
  v_exp_f32 v64, v64
  v_exp_f32 v65, v65
  v_add_f32 v117, v56, v57
  v_add_f32 v117, v117, v58
  v_add_f32 v117, v117, v59
  v_add_f32 v117, v117, v60
  v_add_f32 v117, v117, v61
  v_add_f32 v117, v117, v62
  v_add_f32 v117, v117, v63
  v_add_f32 v117, v117, v64
  v_add_f32 v117, v117, v65
  v_mov_b32 v118, v117
  s_nop 0
  s_nop 0
  v_permlane16_swap_b32 v117, v118
  v_add_f32 v117, v117, v118
  v_mov_b32 v118, v117
  s_nop 0
  s_nop 0
  v_permlane32_swap_b32 v117, v118
  v_add_f32 v117, v117, v118
  v_rcp_f32 v117, v117
  s_branch o_fbr_210
o_wr2_204:
  s_waitcnt lgkmcnt(0)
  s_barrier
  ds_read_b128 v[104:107], v3 offset:0
  ds_read_b128 v[108:111], v3 offset:512
  ds_read_b128 v[112:115], v3 offset:1024
  buffer_load_dwordx4 v[176:179], v5, s[4:7], s94 offen offset:256 sc1
  buffer_load_dwordx4 v[180:183], v5, s[4:7], s94 offen offset:768 sc1
  s_waitcnt lgkmcnt(2)
  v_mfma_f32_32x32x16_bf16 v[40:55], v[104:107], a[0:3], 0
  v_mov_b64 v[188:189], 0
  v_mov_b64 v[190:191], 0
  v_mov_b64 v[192:193], 0
  v_mov_b64 v[194:195], 0
  s_mov_b64 exec, 1
  buffer_store_dword v38, off, s[4:7], s84 sc1
  s_mov_b64 exec, -1
  s_mov_b32 s84, 268435456
  v_mfma_f32_32x32x16_bf16 v[56:71], v[104:107], a[4:7], 0
  ds_read_b128 v[116:119], v3 offset:1536
  v_mfma_f32_32x32x16_bf16 v[72:87], v[104:107], a[8:11], 0
  v_mfma_f32_32x32x16_bf16 v[88:103], v[104:107], a[12:15], 0
  s_waitcnt vmcnt(13)
  v_xor_b32 v7, s96, v120
  v_bitop3_b32 v7, v7, v124, s96 bitop3:0xf6
  v_bitop3_b32 v7, v7, v128, s96 bitop3:0xf6
  v_bitop3_b32 v7, v7, v132, s96 bitop3:0xf6
  s_waitcnt lgkmcnt(2)
  v_mfma_f32_32x32x16_bf16 v[40:55], v[108:111], a[16:19], v[40:55]
  s_waitcnt vmcnt(9)
  v_bitop3_b32 v7, v7, v136, s96 bitop3:0xf6
  v_bitop3_b32 v7, v7, v140, s96 bitop3:0xf6
  v_bitop3_b32 v7, v7, v144, s96 bitop3:0xf6
  v_bitop3_b32 v7, v7, v148, s96 bitop3:0xf6
  s_waitcnt vmcnt(5)
  v_mfma_f32_32x32x16_bf16 v[56:71], v[108:111], a[20:23], v[56:71]
  ds_read_b128 v[104:107], v3 offset:2048
  v_bitop3_b32 v7, v7, v152, s96 bitop3:0xf6
  v_bitop3_b32 v7, v7, v156, s96 bitop3:0xf6
  v_bitop3_b32 v7, v7, v160, s96 bitop3:0xf6
  v_bitop3_b32 v7, v7, v164, s96 bitop3:0xf6
  s_waitcnt vmcnt(1)
  v_mfma_f32_32x32x16_bf16 v[72:87], v[108:111], a[24:27], v[72:87]
  v_bitop3_b32 v7, v7, v168, s96 bitop3:0xf6
  v_bitop3_b32 v7, v7, v172, s96 bitop3:0xf6
  v_bitop3_b32 v7, v7, v176, s96 bitop3:0xf6
  v_bitop3_b32 v7, v7, v180, s96 bitop3:0xf6
  v_and_b32 v7, v254, v7
  v_cmp_ne_u32 vcc, 0, v7
  s_cbranch_vccnz o_rt_215
o_bk_216:
  v_mfma_f32_32x32x16_bf16 v[88:103], v[108:111], a[28:31], v[88:103]
  v_smfmac_f32_16x16x64_bf16 v[188:191], v[16:19], v[120:127], v20
  v_lshlrev_b32 v196, 16, v184
  v_smfmac_f32_16x16x64_bf16 v[192:195], v[16:19], v[128:135], v20
  v_and_b32 v197, 0xffff0000, v184
  v_smfmac_f32_16x16x64_bf16 v[188:191], v[16:19], v[136:143], v20
  v_lshlrev_b32 v198, 16, v185
  s_waitcnt lgkmcnt(2)
  v_mfma_f32_32x32x16_bf16 v[40:55], v[112:115], a[32:35], v[40:55]
  v_smfmac_f32_16x16x64_bf16 v[192:195], v[16:19], v[144:151], v20
  v_and_b32 v199, 0xffff0000, v185
  v_smfmac_f32_16x16x64_bf16 v[188:191], v[16:19], v[152:159], v20
  v_lshlrev_b32 v200, 16, v186
  v_smfmac_f32_16x16x64_bf16 v[192:195], v[16:19], v[160:167], v20
  v_and_b32 v201, 0xffff0000, v186
  v_mfma_f32_32x32x16_bf16 v[56:71], v[112:115], a[36:39], v[56:71]
  ds_read_b128 v[108:111], v3 offset:2560
  v_smfmac_f32_16x16x64_bf16 v[188:191], v[16:19], v[168:175], v20
  v_lshlrev_b32 v202, 16, v187
  v_smfmac_f32_16x16x64_bf16 v[192:195], v[16:19], v[176:183], v20
  v_and_b32 v203, 0xffff0000, v187
  s_bfe_u32 s92, s65, 131086
  v_mfma_f32_32x32x16_bf16 v[72:87], v[112:115], a[40:43], v[72:87]
  s_lshl_b32 s92, s92, 21
  s_add_u32 s92, s92, s91
  s_add_u32 s93, s92, 27262976
  s_add_u32 s92, s92, 20971520
  v_permlane16_swap_b32 v188, v192
  v_mfma_f32_32x32x16_bf16 v[88:103], v[112:115], a[44:47], v[88:103]
  v_permlane16_swap_b32 v189, v193
  v_permlane16_swap_b32 v190, v194
  v_permlane16_swap_b32 v191, v195
  s_waitcnt lgkmcnt(2)
  v_mfma_f32_32x32x16_bf16 v[40:55], v[116:119], a[48:51], v[40:55]
  v_cvt_pk_bf16_f32 v188, 0, v188
  v_cvt_pk_bf16_f32 v189, 0, v189
  v_cvt_pk_bf16_f32 v190, 0, v190
  v_cvt_pk_bf16_f32 v191, 0, v191
  v_cvt_pk_bf16_f32 v192, 0, v192
  v_cvt_pk_bf16_f32 v193, 0, v193
  v_mfma_f32_32x32x16_bf16 v[56:71], v[116:119], a[52:55], v[56:71]
  ds_read_b128 v[112:115], v3 offset:3072
  v_cvt_pk_bf16_f32 v194, 0, v194
  v_cvt_pk_bf16_f32 v195, 0, v195
  v_add_f32 v196, v196, v188
  v_add_f32 v197, v197, v189
  v_add_f32 v198, v198, v190
  v_mfma_f32_32x32x16_bf16 v[72:87], v[116:119], a[56:59], v[72:87]
  v_add_f32 v199, v199, v191
  v_add_f32 v200, v200, v192
  v_add_f32 v201, v201, v193
  v_add_f32 v202, v202, v194
  v_add_f32 v203, v203, v195
  v_cvt_pk_bf16_f32 v120, v196, v197
  v_mfma_f32_32x32x16_bf16 v[88:103], v[116:119], a[60:63], v[88:103]
  v_cvt_pk_bf16_f32 v121, v198, v199
  v_cvt_pk_bf16_f32 v122, v200, v201
  v_cvt_pk_bf16_f32 v123, v202, v203
  v_lshlrev_b32 v196, 16, v120
  v_and_b32 v197, 0xffff0000, v120
  s_waitcnt lgkmcnt(2)
  v_mfma_f32_32x32x16_bf16 v[40:55], v[104:107], a[64:67], v[40:55]
  v_lshlrev_b32 v198, 16, v121
  v_and_b32 v199, 0xffff0000, v121
  v_lshlrev_b32 v200, 16, v122
  v_and_b32 v201, 0xffff0000, v122
  v_lshlrev_b32 v202, 16, v123
  v_and_b32 v203, 0xffff0000, v123
  v_mfma_f32_32x32x16_bf16 v[56:71], v[104:107], a[68:71], v[56:71]
  ds_read_b128 v[116:119], v3 offset:3584
  buffer_store_dwordx4 v[120:123], v0, s[4:7], s92 offen sc1
  v_add_f32 v136, v196, v197
  v_mul_f32 v137, v196, v196
  v_mfma_f32_32x32x16_bf16 v[72:87], v[104:107], a[72:75], v[72:87]
  v_add_f32 v138, v198, v199
  v_mul_f32 v139, v197, v197
  v_fmac_f32 v137, v198, v198
  v_fmac_f32 v139, v199, v199
  v_add_f32 v136, v136, v200
  v_fmac_f32 v137, v200, v200
  v_mfma_f32_32x32x16_bf16 v[88:103], v[104:107], a[76:79], v[88:103]
  v_add_f32 v138, v138, v201
  v_fmac_f32 v139, v201, v201
  v_add_f32 v136, v136, v202
  v_fmac_f32 v137, v202, v202
  v_add_f32 v138, v138, v203
  s_waitcnt lgkmcnt(2)
  v_mfma_f32_32x32x16_bf16 v[40:55], v[108:111], a[80:83], v[40:55]
  v_fmac_f32 v139, v203, v203
  v_add_f32 v136, v136, v138
  v_add_f32 v137, v137, v139
  s_nop 0
  v_add_f32_dpp v136, v136, v136 row_ror:8 row_mask:0xf bank_mask:0xf
  v_add_f32_dpp v137, v137, v137 row_ror:8 row_mask:0xf bank_mask:0xf
  s_nop 0
  v_add_f32_dpp v136, v136, v136 row_ror:4 row_mask:0xf bank_mask:0xf
  v_mfma_f32_32x32x16_bf16 v[56:71], v[108:111], a[84:87], v[56:71]
  ds_read_b128 v[104:107], v3 offset:8192
  v_add_f32_dpp v137, v137, v137 row_ror:4 row_mask:0xf bank_mask:0xf
  v_add_f32_dpp v136, v136, v136 row_ror:2 row_mask:0xf bank_mask:0xf
  s_nop 0
  v_add_f32_dpp v137, v137, v137 row_ror:2 row_mask:0xf bank_mask:0xf
  v_add_f32_dpp v136, v136, v136 row_ror:1 row_mask:0xf bank_mask:0xf
  s_nop 0
  v_add_f32_dpp v137, v137, v137 row_ror:1 row_mask:0xf bank_mask:0xf
  v_mfma_f32_32x32x16_bf16 v[72:87], v[108:111], a[88:91], v[72:87]
  v_mov_b32 v140, v136
  v_mov_b32 v141, v137
  s_nop 0
  v_permlane16_swap_b32 v136, v140
  v_permlane16_swap_b32 v137, v141
  v_mfma_f32_32x32x16_bf16 v[88:103], v[108:111], a[92:95], v[88:103]
  v_add_f32 v136, v136, v140
  v_add_f32 v137, v137, v141
  v_mov_b32 v140, v136
  v_mov_b32 v141, v137
  s_nop 0
  v_permlane32_swap_b32 v136, v140
  s_waitcnt lgkmcnt(2)
  v_mfma_f32_32x32x16_bf16 v[40:55], v[112:115], a[96:99], v[40:55]
  v_permlane32_swap_b32 v137, v141
  v_add_f32 v136, v136, v140
  v_add_f32 v137, v137, v141
  v_mul_f32 v136, 0x3b000000, v136
  v_mul_f32 v137, 0x3b000000, v137
  v_mfma_f32_32x32x16_bf16 v[56:71], v[112:115], a[100:103], v[56:71]
  ds_read_b128 v[108:111], v3 offset:8704
  v_fma_f32 v137, -v136, v136, v137
  v_cvt_pk_bf16_f32 v136, 0, v136
  v_max_f32 v137, 0, v137
  v_sub_f32 v140, v196, v136
  v_sub_f32 v141, v197, v136
  v_mfma_f32_32x32x16_bf16 v[72:87], v[112:115], a[104:107], v[72:87]
  v_cvt_pk_bf16_f32 v137, 0, v137
  v_sub_f32 v142, v198, v136
  v_sub_f32 v143, v199, v136
  v_add_f32 v137, 0x3727c5ac, v137
  v_sub_f32 v144, v200, v136
  v_sub_f32 v145, v201, v136
  v_mfma_f32_32x32x16_bf16 v[88:103], v[112:115], a[108:111], v[88:103]
  v_cvt_pk_bf16_f32 v137, 0, v137
  v_sub_f32 v146, v202, v136
  v_sub_f32 v147, v203, v136
  v_sqrt_f32 v137, v137
  s_waitcnt lgkmcnt(2)
  v_mfma_f32_32x32x16_bf16 v[40:55], v[116:119], a[112:115], v[40:55]
  v_cvt_pk_bf16_f32 v140, 0, v140
  v_cvt_pk_bf16_f32 v141, 0, v141
  v_cvt_pk_bf16_f32 v137, 0, v137
  v_cvt_pk_bf16_f32 v142, 0, v142
  v_cvt_pk_bf16_f32 v143, 0, v143
  v_rcp_f32 v137, v137
  v_mfma_f32_32x32x16_bf16 v[56:71], v[116:119], a[116:119], v[56:71]
  ds_read_b128 v[112:115], v3 offset:9216
  v_cvt_pk_bf16_f32 v144, 0, v144
  v_cvt_pk_bf16_f32 v145, 0, v145
  v_cvt_pk_bf16_f32 v146, 0, v146
  v_cvt_pk_bf16_f32 v147, 0, v147
  v_mul_f32 v140, v140, v137
  v_mfma_f32_32x32x16_bf16 v[72:87], v[116:119], a[120:123], v[72:87]
  v_mul_f32 v141, v141, v137
  v_mul_f32 v142, v142, v137
  v_mul_f32 v143, v143, v137
  v_mul_f32 v144, v144, v137
  v_mul_f32 v145, v145, v137
  v_mul_f32 v146, v146, v137
  v_mfma_f32_32x32x16_bf16 v[88:103], v[116:119], a[124:127], v[88:103]
  v_mul_f32 v147, v147, v137
  v_cvt_pk_bf16_f32 v124, v140, v141
  v_cvt_pk_bf16_f32 v125, v142, v143
  v_cvt_pk_bf16_f32 v126, v144, v145
  v_cvt_pk_bf16_f32 v127, v146, v147
  s_waitcnt lgkmcnt(2)
  v_mfma_f32_32x32x16_bf16 v[40:55], v[104:107], a[128:131], v[40:55]
  v_lshlrev_b32 v204, 16, v124
  v_and_b32 v205, 0xffff0000, v124
  v_lshlrev_b32 v206, 16, v125
  v_and_b32 v207, 0xffff0000, v125
  v_lshlrev_b32 v208, 16, v126
  v_and_b32 v209, 0xffff0000, v126
  v_mfma_f32_32x32x16_bf16 v[56:71], v[104:107], a[132:135], v[56:71]
  ds_read_b128 v[116:119], v3 offset:9728
  v_lshlrev_b32 v210, 16, v127
  v_and_b32 v211, 0xffff0000, v127
  buffer_store_dwordx4 v[124:127], v0, s[4:7], s93 offen sc1
  v_mfma_f32_32x32x16_bf16 v[72:87], v[104:107], a[136:139], v[72:87]
  v_add_f32 v196, v196, v204
  v_add_f32 v197, v197, v205
  v_add_f32 v198, v198, v206
  v_add_f32 v199, v199, v207
  v_add_f32 v200, v200, v208
  v_add_f32 v201, v201, v209
  v_mfma_f32_32x32x16_bf16 v[88:103], v[104:107], a[140:143], v[88:103]
  v_add_f32 v202, v202, v210
  v_add_f32 v203, v203, v211
  v_cvt_pk_bf16_f32 v128, v196, v197
  v_cvt_pk_bf16_f32 v129, v198, v199
  v_cvt_pk_bf16_f32 v130, v200, v201
  s_waitcnt lgkmcnt(2)
  v_mfma_f32_32x32x16_bf16 v[40:55], v[108:111], a[144:147], v[40:55]
  v_cvt_pk_bf16_f32 v131, v202, v203
  v_mul_f32 v188, v204, v8
  v_mul_f32 v189, v205, v9
  v_fmac_f32 v188, v206, v10
  v_fmac_f32 v189, v207, v11
  v_fmac_f32 v188, v208, v12
  v_mfma_f32_32x32x16_bf16 v[56:71], v[108:111], a[148:151], v[56:71]
  ds_read_b128 v[104:107], v3 offset:10240
  v_fmac_f32 v189, v209, v13
  v_fmac_f32 v188, v210, v14
  v_fmac_f32 v189, v211, v15
  v_add_f32 v188, v188, v189
  buffer_store_dwordx4 v[128:131], v0, s[68:71], s91 offen sc1
  v_mfma_f32_32x32x16_bf16 v[72:87], v[108:111], a[152:155], v[72:87]
  v_add_f32_dpp v188, v188, v188 row_ror:8 row_mask:0xf bank_mask:0xf
  s_nop 1
  v_add_f32_dpp v188, v188, v188 row_ror:4 row_mask:0xf bank_mask:0xf
  s_nop 1
  v_add_f32_dpp v188, v188, v188 row_ror:2 row_mask:0xf bank_mask:0xf
  s_nop 1
  v_add_f32_dpp v188, v188, v188 row_ror:1 row_mask:0xf bank_mask:0xf
  v_mov_b32 v189, v188
  s_nop 0
  s_nop 0
  v_permlane16_swap_b32 v188, v189
  v_mfma_f32_32x32x16_bf16 v[88:103], v[108:111], a[156:159], v[88:103]
  v_add_f32 v188, v188, v189
  v_mov_b32 v189, v188
  s_nop 0
  s_nop 0
  v_permlane32_swap_b32 v188, v189
  v_add_f32 v188, v188, v189
  s_waitcnt lgkmcnt(2)
  v_mfma_f32_32x32x16_bf16 v[40:55], v[112:115], a[160:163], v[40:55]
  v_cvt_pk_bf16_f32 v188, 0, v188
  v_ashrrev_i32 v189, 31, v188
  v_or_b32 v189, 0x80000000, v189
  v_xor_b32 v188, v188, v189
  s_sub_u32 s92, 4095, s90
  v_and_b32 v188, 0xffff0000, v188
  v_mfma_f32_32x32x16_bf16 v[56:71], v[112:115], a[164:167], v[56:71]
  ds_read_b128 v[108:111], v3 offset:10752
  v_or_b32 v38, s92, v188
  s_bfe_u32 s92, s65, 196625
  s_lshl_b32 s92, s92, 18
  s_lshl_b32 s93, s90, 7
  s_add_u32 s92, s92, s93
  v_mfma_f32_32x32x16_bf16 v[72:87], v[112:115], a[168:171], v[72:87]
  s_add_u32 s84, s92, 243269632
  v_mfma_f32_32x32x16_bf16 v[88:103], v[112:115], a[172:175], v[88:103]
  s_waitcnt lgkmcnt(2)
  v_mfma_f32_32x32x16_bf16 v[40:55], v[116:119], a[176:179], v[40:55]
  v_mfma_f32_32x32x16_bf16 v[56:71], v[116:119], a[180:183], v[56:71]
  ds_read_b128 v[112:115], v3 offset:11264
  v_mfma_f32_32x32x16_bf16 v[72:87], v[116:119], a[184:187], v[72:87]
  v_mfma_f32_32x32x16_bf16 v[88:103], v[116:119], a[188:191], v[88:103]
  s_waitcnt lgkmcnt(2)
  v_mfma_f32_32x32x16_bf16 v[40:55], v[104:107], a[192:195], v[40:55]
  v_mfma_f32_32x32x16_bf16 v[56:71], v[104:107], a[196:199], v[56:71]
  ds_read_b128 v[116:119], v3 offset:11776
  s_waitcnt lgkmcnt(2)
  v_mfma_f32_32x32x16_bf16 v[40:55], v[108:111], a[208:211], v[40:55]
  v_mfma_f32_32x32x16_bf16 v[56:71], v[108:111], a[212:215], v[56:71]
  s_waitcnt lgkmcnt(1)
  v_mfma_f32_32x32x16_bf16 v[40:55], v[112:115], a[224:227], v[40:55]
  v_mfma_f32_32x32x16_bf16 v[56:71], v[112:115], a[228:231], v[56:71]
  s_waitcnt lgkmcnt(0)
  v_mfma_f32_32x32x16_bf16 v[40:55], v[116:119], a[240:243], v[40:55]
  v_mfma_f32_32x32x16_bf16 v[56:71], v[116:119], a[244:247], v[56:71]
  v_mfma_f32_32x32x16_bf16 v[72:87], v[104:107], a[200:203], v[72:87]
  v_mfma_f32_32x32x16_bf16 v[88:103], v[104:107], a[204:207], v[88:103]
  v_cvt_pk_bf16_f32 v212, v40, v56
  v_cvt_pk_bf16_f32 v214, v41, v57
  v_cvt_pk_bf16_f32 v216, v42, v58
  v_cvt_pk_bf16_f32 v218, v43, v59
  v_permlane16_swap_b32 v212, v214
  v_mfma_f32_32x32x16_bf16 v[72:87], v[108:111], a[216:219], v[72:87]
  v_cvt_pk_bf16_f32 v220, v44, v60
  v_cvt_pk_bf16_f32 v222, v45, v61
  v_permlane16_swap_b32 v216, v218
  v_bfi_b32 v212, v254, s42, v212
  v_cvt_pk_bf16_f32 v224, v46, v62
  v_mfma_f32_32x32x16_bf16 v[88:103], v[108:111], a[220:223], v[88:103]
  v_cvt_pk_bf16_f32 v226, v47, v63
  v_permlane16_swap_b32 v220, v222
  v_bfi_b32 v216, v254, s42, v216
  v_cvt_pk_bf16_f32 v228, v48, v64
  v_mfma_f32_32x32x16_bf16 v[72:87], v[112:115], a[232:235], v[72:87]
  v_cvt_pk_bf16_f32 v230, v49, v65
  v_permlane16_swap_b32 v224, v226
  v_bfi_b32 v220, v254, s42, v220
  v_cvt_pk_bf16_f32 v232, v50, v66
  v_cvt_pk_bf16_f32 v234, v51, v67
  v_mfma_f32_32x32x16_bf16 v[88:103], v[112:115], a[236:239], v[88:103]
  v_permlane16_swap_b32 v228, v230
  v_bfi_b32 v224, v254, s42, v224
  v_cvt_pk_bf16_f32 v236, v52, v68
  v_cvt_pk_bf16_f32 v238, v53, v69
  v_mfma_f32_32x32x16_bf16 v[72:87], v[116:119], a[248:251], v[72:87]
  v_permlane16_swap_b32 v232, v234
  v_bfi_b32 v228, v254, s42, v228
  v_cvt_pk_bf16_f32 v240, v54, v70
  v_cvt_pk_bf16_f32 v242, v55, v71
  v_permlane16_swap_b32 v236, v238
  v_mfma_f32_32x32x16_bf16 v[88:103], v[116:119], a[252:255], v[88:103]
  v_bfi_b32 v232, v254, s42, v232
  v_permlane16_swap_b32 v240, v242
  v_bfi_b32 v236, v254, s42, v236
  v_bfi_b32 v240, v254, s42, v240
  s_nop 7
  v_cvt_pk_bf16_f32 v213, v72, v88
  v_cvt_pk_bf16_f32 v215, v73, v89
  v_cvt_pk_bf16_f32 v217, v74, v90
  v_cvt_pk_bf16_f32 v219, v75, v91
  s_add_u32 s78, s86, 0
  v_permlane16_swap_b32 v213, v215
  buffer_store_dwordx4 v[212:215], v4, s[4:7], s78 offen sc1
  v_cvt_pk_bf16_f32 v221, v76, v92
  v_cvt_pk_bf16_f32 v223, v77, v93
  s_add_u32 s78, s86, 32768
  v_permlane16_swap_b32 v217, v219
  buffer_store_dwordx4 v[216:219], v4, s[4:7], s78 offen sc1
  v_cvt_pk_bf16_f32 v225, v78, v94
  v_cvt_pk_bf16_f32 v227, v79, v95
  s_add_u32 s78, s86, 131072
  v_permlane16_swap_b32 v221, v223
  buffer_store_dwordx4 v[220:223], v4, s[4:7], s78 offen sc1
  v_cvt_pk_bf16_f32 v229, v80, v96
  v_cvt_pk_bf16_f32 v231, v81, v97
  s_add_u32 s78, s86, 163840
  v_permlane16_swap_b32 v225, v227
  buffer_store_dwordx4 v[224:227], v4, s[4:7], s78 offen sc1
  v_cvt_pk_bf16_f32 v233, v82, v98
  v_cvt_pk_bf16_f32 v235, v83, v99
  s_add_u32 s78, s86, 262144
  v_permlane16_swap_b32 v229, v231
  buffer_store_dwordx4 v[228:231], v4, s[4:7], s78 offen sc1
  v_cvt_pk_bf16_f32 v237, v84, v100
  v_cvt_pk_bf16_f32 v239, v85, v101
  s_add_u32 s78, s86, 294912
  v_permlane16_swap_b32 v233, v235
  buffer_store_dwordx4 v[232:235], v4, s[4:7], s78 offen sc1
  v_cvt_pk_bf16_f32 v241, v86, v102
  v_cvt_pk_bf16_f32 v243, v87, v103
  s_add_u32 s78, s86, 393216
  v_permlane16_swap_b32 v237, v239
  buffer_store_dwordx4 v[236:239], v4, s[4:7], s78 offen sc1
  s_add_u32 s78, s86, 425984
  v_permlane16_swap_b32 v241, v243
  buffer_store_dwordx4 v[240:243], v4, s[4:7], s78 offen sc1
o_we_205:
  v_and_b32 v37, -32, v39
  s_waitcnt lgkmcnt(0)
  s_barrier
  ds_read_b128 v[104:107], v37 offset:16
  s_mov_b32 s65, s63
  s_waitcnt lgkmcnt(0)
  v_and_b32 v104, v104, v106
  v_max_u32 v105, v105, v107
  v_readfirstlane_b32 s26, v104
  v_readfirstlane_b32 s3, v105
  s_and_b32 s66, s26, 1
  s_and_b32 s76, s26, 2
  s_bitcmp1_b32 s26, 2
  s_cselect_b32 s3, s3, 0
  s_cmp_lg_u32 s76, 0
  s_cbranch_scc1 o_nofl_179
  s_and_b32 s26, s63, 49152
  s_cbranch_scc0 o_fl_180
  s_and_b32 s26, s64, s50
  s_cbranch_scc1 o_nofl_179
o_fl_180:
  s_cmp_ge_u32 s17, 2
  s_cbranch_scc1 o_fd_219
  s_cmp_eq_u32 s65, 0
  s_cbranch_scc1 o_fd_219
  s_mov_b32 s96, s42
  s_lshl_b32 s97, s43, 14
  s_add_u32 s97, s97, s86
  buffer_load_dword v7, v255, s[4:7], s97 offen sc1
  s_and_b32 s91, s65, 63
  s_lshl_b32 s90, s91, 5
  s_add_u32 s94, s90, s85
  s_add_u32 s90, s90, s43
  s_lshl_b32 s94, s94, 10
  s_lshr_b32 s92, s65, 22
  s_xor_b32 s93, s43, 32
  s_lshl_b32 s91, s90, 10
  s_add_u32 s94, s94, 25165824
  s_cmp_eq_u32 s92, s93
  s_cselect_b32 s92, s94, s91
  s_add_u32 s92, s92, 10485760
  s_and_b32 s93, s65, 49152
  s_cselect_b32 s92, s92, s91
  s_cselect_b64 s[80:81], s[4:5], s[72:73]
  s_cselect_b32 s82, s6, s74
  buffer_load_dwordx4 v[184:187], v0, s[80:83], s92 offen sc1
  s_mov_b32 s67, 0
  s_mov_b64 vcc, 0
  s_waitcnt vmcnt(1)
o_pl_221:
  v_and_b32 v7, 1, v7
  v_cmp_ne_u32 vcc, s96, v7
  s_cbranch_vccz o_pk_222
  s_mov_b64 exec, 1
  buffer_store_dword v38, off, s[4:7], s84 sc1
  s_mov_b64 exec, -1
  s_mov_b32 s84, 268435456
  buffer_load_dword v7, v255, s[4:7], s97 offen sc1
  s_add_u32 s67, s67, 1
  s_cmp_gt_u32 s67, 1048576
  s_cbranch_scc1 L_end
  s_waitcnt vmcnt(0)
  s_branch o_pl_221
o_pk_222:
  s_and_b32 s26, s65, 49152
  s_cbranch_scc1 o_f2_220
  s_lshl_b32 s94, s43, 14
  s_add_u32 s94, s94, s86
  buffer_load_dwordx4 v[120:123], v5, s[4:7], s94 offen offset:0 sc1
  buffer_load_dwordx4 v[124:127], v5, s[4:7], s94 offen offset:512 sc1
  buffer_load_dwordx4 v[128:131], v5, s[4:7], s94 offen offset:256 sc1
  buffer_load_dwordx4 v[132:135], v5, s[4:7], s94 offen offset:768 sc1
  s_add_u32 s94, s94, 4096
  buffer_load_dwordx4 v[136:139], v5, s[4:7], s94 offen offset:0 sc1
  buffer_load_dwordx4 v[140:143], v5, s[4:7], s94 offen offset:512 sc1
  buffer_load_dwordx4 v[144:147], v5, s[4:7], s94 offen offset:256 sc1
  buffer_load_dwordx4 v[148:151], v5, s[4:7], s94 offen offset:768 sc1
  s_add_u32 s94, s94, 4096
  buffer_load_dwordx4 v[152:155], v5, s[4:7], s94 offen offset:0 sc1
  buffer_load_dwordx4 v[156:159], v5, s[4:7], s94 offen offset:512 sc1
  buffer_load_dwordx4 v[160:163], v5, s[4:7], s94 offen offset:256 sc1
  buffer_load_dwordx4 v[164:167], v5, s[4:7], s94 offen offset:768 sc1
  s_add_u32 s94, s94, 4096
  buffer_load_dwordx4 v[168:171], v5, s[4:7], s94 offen offset:0 sc1
  buffer_load_dwordx4 v[172:175], v5, s[4:7], s94 offen offset:512 sc1
  buffer_load_dwordx4 v[176:179], v5, s[4:7], s94 offen offset:256 sc1
  buffer_load_dwordx4 v[180:183], v5, s[4:7], s94 offen offset:768 sc1
  s_mov_b64 exec, 1
  buffer_store_dword v38, off, s[4:7], s84 sc1
  s_mov_b64 exec, -1
  s_mov_b32 s84, 268435456
  v_mov_b64 v[188:189], 0
  v_mov_b64 v[190:191], 0
  v_mov_b64 v[192:193], 0
  v_mov_b64 v[194:195], 0
  s_waitcnt vmcnt(13)
  v_xor_b32 v7, s96, v120
  v_bitop3_b32 v7, v7, v124, s96 bitop3:0xf6
  v_bitop3_b32 v7, v7, v128, s96 bitop3:0xf6
  v_bitop3_b32 v7, v7, v132, s96 bitop3:0xf6
  s_waitcnt vmcnt(9)
  v_bitop3_b32 v7, v7, v136, s96 bitop3:0xf6
  v_bitop3_b32 v7, v7, v140, s96 bitop3:0xf6
  v_bitop3_b32 v7, v7, v144, s96 bitop3:0xf6
  v_bitop3_b32 v7, v7, v148, s96 bitop3:0xf6
  s_waitcnt vmcnt(5)
  v_bitop3_b32 v7, v7, v152, s96 bitop3:0xf6
  v_bitop3_b32 v7, v7, v156, s96 bitop3:0xf6
  v_bitop3_b32 v7, v7, v160, s96 bitop3:0xf6
  v_bitop3_b32 v7, v7, v164, s96 bitop3:0xf6
  s_waitcnt vmcnt(1)
  v_bitop3_b32 v7, v7, v168, s96 bitop3:0xf6
  v_bitop3_b32 v7, v7, v172, s96 bitop3:0xf6
  v_bitop3_b32 v7, v7, v176, s96 bitop3:0xf6
  v_bitop3_b32 v7, v7, v180, s96 bitop3:0xf6
  v_and_b32 v7, v254, v7
  v_cmp_ne_u32 vcc, 0, v7
  s_cbranch_vccnz o_rt_223
o_bk_224:
  v_smfmac_f32_16x16x64_bf16 v[188:191], v[16:19], v[120:127], v20
  v_lshlrev_b32 v196, 16, v184
  v_smfmac_f32_16x16x64_bf16 v[192:195], v[16:19], v[128:135], v20
  v_and_b32 v197, 0xffff0000, v184
  v_smfmac_f32_16x16x64_bf16 v[188:191], v[16:19], v[136:143], v20
  v_lshlrev_b32 v198, 16, v185
  v_smfmac_f32_16x16x64_bf16 v[192:195], v[16:19], v[144:151], v20
  v_and_b32 v199, 0xffff0000, v185
  v_smfmac_f32_16x16x64_bf16 v[188:191], v[16:19], v[152:159], v20
  v_lshlrev_b32 v200, 16, v186
  v_smfmac_f32_16x16x64_bf16 v[192:195], v[16:19], v[160:167], v20
  v_and_b32 v201, 0xffff0000, v186
  v_smfmac_f32_16x16x64_bf16 v[188:191], v[16:19], v[168:175], v20
  v_lshlrev_b32 v202, 16, v187
  v_smfmac_f32_16x16x64_bf16 v[192:195], v[16:19], v[176:183], v20
  v_and_b32 v203, 0xffff0000, v187
  s_bfe_u32 s92, s65, 131086
  s_lshl_b32 s92, s92, 21
  s_add_u32 s92, s92, s91
  s_add_u32 s93, s92, 27262976
  s_add_u32 s92, s92, 20971520
  s_nop 1
  v_permlane16_swap_b32 v188, v192
  v_permlane16_swap_b32 v189, v193
  v_permlane16_swap_b32 v190, v194
  v_permlane16_swap_b32 v191, v195
  v_cvt_pk_bf16_f32 v188, 0, v188
  v_cvt_pk_bf16_f32 v189, 0, v189
  v_cvt_pk_bf16_f32 v190, 0, v190
  v_cvt_pk_bf16_f32 v191, 0, v191
  v_cvt_pk_bf16_f32 v192, 0, v192
  v_cvt_pk_bf16_f32 v193, 0, v193
  v_cvt_pk_bf16_f32 v194, 0, v194
  v_cvt_pk_bf16_f32 v195, 0, v195
  v_add_f32 v196, v196, v188
  v_add_f32 v197, v197, v189
  v_add_f32 v198, v198, v190
  v_add_f32 v199, v199, v191
  v_add_f32 v200, v200, v192
  v_add_f32 v201, v201, v193
  v_add_f32 v202, v202, v194
  v_add_f32 v203, v203, v195
  v_cvt_pk_bf16_f32 v120, v196, v197
  v_cvt_pk_bf16_f32 v121, v198, v199
  v_cvt_pk_bf16_f32 v122, v200, v201
  v_cvt_pk_bf16_f32 v123, v202, v203
  v_lshlrev_b32 v196, 16, v120
  v_and_b32 v197, 0xffff0000, v120
  v_lshlrev_b32 v198, 16, v121
  v_and_b32 v199, 0xffff0000, v121
  v_lshlrev_b32 v200, 16, v122
  v_and_b32 v201, 0xffff0000, v122
  v_lshlrev_b32 v202, 16, v123
  v_and_b32 v203, 0xffff0000, v123
  buffer_store_dwordx4 v[120:123], v0, s[4:7], s92 offen sc1
  v_add_f32 v136, v196, v197
  v_mul_f32 v137, v196, v196
  v_add_f32 v138, v198, v199
  v_mul_f32 v139, v197, v197
  v_fmac_f32 v137, v198, v198
  v_fmac_f32 v139, v199, v199
  v_add_f32 v136, v136, v200
  v_fmac_f32 v137, v200, v200
  v_add_f32 v138, v138, v201
  v_fmac_f32 v139, v201, v201
  v_add_f32 v136, v136, v202
  v_fmac_f32 v137, v202, v202
  v_add_f32 v138, v138, v203
  v_fmac_f32 v139, v203, v203
  v_add_f32 v136, v136, v138
  v_add_f32 v137, v137, v139
  s_nop 0
  v_add_f32_dpp v136, v136, v136 row_ror:8 row_mask:0xf bank_mask:0xf
  v_add_f32_dpp v137, v137, v137 row_ror:8 row_mask:0xf bank_mask:0xf
  s_nop 0
  v_add_f32_dpp v136, v136, v136 row_ror:4 row_mask:0xf bank_mask:0xf
  v_add_f32_dpp v137, v137, v137 row_ror:4 row_mask:0xf bank_mask:0xf
  s_nop 0
  v_add_f32_dpp v136, v136, v136 row_ror:2 row_mask:0xf bank_mask:0xf
  v_add_f32_dpp v137, v137, v137 row_ror:2 row_mask:0xf bank_mask:0xf
  s_nop 0
  v_add_f32_dpp v136, v136, v136 row_ror:1 row_mask:0xf bank_mask:0xf
  v_add_f32_dpp v137, v137, v137 row_ror:1 row_mask:0xf bank_mask:0xf
  v_mov_b32 v140, v136
  v_mov_b32 v141, v137
  s_nop 0
  v_permlane16_swap_b32 v136, v140
  v_permlane16_swap_b32 v137, v141
  v_add_f32 v136, v136, v140
  v_add_f32 v137, v137, v141
  v_mov_b32 v140, v136
  v_mov_b32 v141, v137
  s_nop 0
  v_permlane32_swap_b32 v136, v140
  v_permlane32_swap_b32 v137, v141
  v_add_f32 v136, v136, v140
  v_add_f32 v137, v137, v141
  v_mul_f32 v136, 0x3b000000, v136
  v_mul_f32 v137, 0x3b000000, v137
  v_fma_f32 v137, -v136, v136, v137
  v_cvt_pk_bf16_f32 v136, 0, v136
  v_max_f32 v137, 0, v137
  v_sub_f32 v140, v196, v136
  v_sub_f32 v141, v197, v136
  v_cvt_pk_bf16_f32 v137, 0, v137
  v_sub_f32 v142, v198, v136
  v_sub_f32 v143, v199, v136
  v_add_f32 v137, 0x3727c5ac, v137
  v_sub_f32 v144, v200, v136
  v_sub_f32 v145, v201, v136
  v_cvt_pk_bf16_f32 v137, 0, v137
  v_sub_f32 v146, v202, v136
  v_sub_f32 v147, v203, v136
  v_sqrt_f32 v137, v137
  v_cvt_pk_bf16_f32 v140, 0, v140
  v_cvt_pk_bf16_f32 v141, 0, v141
  v_cvt_pk_bf16_f32 v137, 0, v137
  v_cvt_pk_bf16_f32 v142, 0, v142
  v_cvt_pk_bf16_f32 v143, 0, v143
  v_rcp_f32 v137, v137
  v_cvt_pk_bf16_f32 v144, 0, v144
  v_cvt_pk_bf16_f32 v145, 0, v145
  v_cvt_pk_bf16_f32 v146, 0, v146
  v_cvt_pk_bf16_f32 v147, 0, v147
  v_mul_f32 v140, v140, v137
  v_mul_f32 v141, v141, v137
  v_mul_f32 v142, v142, v137
  v_mul_f32 v143, v143, v137
  v_mul_f32 v144, v144, v137
  v_mul_f32 v145, v145, v137
  v_mul_f32 v146, v146, v137
  v_mul_f32 v147, v147, v137
  v_cvt_pk_bf16_f32 v124, v140, v141
  v_cvt_pk_bf16_f32 v125, v142, v143
  v_cvt_pk_bf16_f32 v126, v144, v145
  v_cvt_pk_bf16_f32 v127, v146, v147
  v_lshlrev_b32 v204, 16, v124
  v_and_b32 v205, 0xffff0000, v124
  v_lshlrev_b32 v206, 16, v125
  v_and_b32 v207, 0xffff0000, v125
  v_lshlrev_b32 v208, 16, v126
  v_and_b32 v209, 0xffff0000, v126
  v_lshlrev_b32 v210, 16, v127
  v_and_b32 v211, 0xffff0000, v127
  buffer_store_dwordx4 v[124:127], v0, s[4:7], s93 offen sc1
  v_add_f32 v196, v196, v204
  v_add_f32 v197, v197, v205
  v_add_f32 v198, v198, v206
  v_add_f32 v199, v199, v207
  v_add_f32 v200, v200, v208
  v_add_f32 v201, v201, v209
  v_add_f32 v202, v202, v210
  v_add_f32 v203, v203, v211
  v_cvt_pk_bf16_f32 v128, v196, v197
  v_cvt_pk_bf16_f32 v129, v198, v199
  v_cvt_pk_bf16_f32 v130, v200, v201
  v_cvt_pk_bf16_f32 v131, v202, v203
  v_mul_f32 v188, v204, v8
  v_mul_f32 v189, v205, v9
  v_fmac_f32 v188, v206, v10
  v_fmac_f32 v189, v207, v11
  v_fmac_f32 v188, v208, v12
  v_fmac_f32 v189, v209, v13
  v_fmac_f32 v188, v210, v14
  v_fmac_f32 v189, v211, v15
  v_add_f32 v188, v188, v189
  s_add_u32 s92, s91, 10485760
  s_add_u32 s93, s91, 8388608
  buffer_store_dwordx4 v[128:131], v0, s[4:7], s92 offen sc1
  v_lshlrev_b32 v196, 16, v128
  v_and_b32 v197, 0xffff0000, v128
  v_lshlrev_b32 v198, 16, v129
  v_and_b32 v199, 0xffff0000, v129
  v_lshlrev_b32 v200, 16, v130
  v_and_b32 v201, 0xffff0000, v130
  v_lshlrev_b32 v202, 16, v131
  v_and_b32 v203, 0xffff0000, v131
  v_add_f32 v136, v196, v197
  v_mul_f32 v137, v196, v196
  v_add_f32 v138, v198, v199
  v_mul_f32 v139, v197, v197
  v_fmac_f32 v137, v198, v198
  v_fmac_f32 v139, v199, v199
  v_add_f32 v136, v136, v200
  v_fmac_f32 v137, v200, v200
  v_add_f32 v138, v138, v201
  v_fmac_f32 v139, v201, v201
  v_add_f32 v136, v136, v202
  v_fmac_f32 v137, v202, v202
  v_add_f32 v138, v138, v203
  v_fmac_f32 v139, v203, v203
  v_add_f32 v136, v136, v138
  v_add_f32 v137, v137, v139
  s_nop 0
  v_add_f32_dpp v136, v136, v136 row_ror:8 row_mask:0xf bank_mask:0xf
  v_add_f32_dpp v137, v137, v137 row_ror:8 row_mask:0xf bank_mask:0xf
  v_add_f32_dpp v188, v188, v188 row_ror:8 row_mask:0xf bank_mask:0xf
  v_add_f32_dpp v136, v136, v136 row_ror:4 row_mask:0xf bank_mask:0xf
  v_add_f32_dpp v137, v137, v137 row_ror:4 row_mask:0xf bank_mask:0xf
  v_add_f32_dpp v188, v188, v188 row_ror:4 row_mask:0xf bank_mask:0xf
  v_add_f32_dpp v136, v136, v136 row_ror:2 row_mask:0xf bank_mask:0xf
  v_add_f32_dpp v137, v137, v137 row_ror:2 row_mask:0xf bank_mask:0xf
  v_add_f32_dpp v188, v188, v188 row_ror:2 row_mask:0xf bank_mask:0xf
  v_add_f32_dpp v136, v136, v136 row_ror:1 row_mask:0xf bank_mask:0xf
  v_add_f32_dpp v137, v137, v137 row_ror:1 row_mask:0xf bank_mask:0xf
  v_add_f32_dpp v188, v188, v188 row_ror:1 row_mask:0xf bank_mask:0xf
  v_mov_b32 v140, v136
  v_mov_b32 v141, v137
  v_mov_b32 v142, v188
  v_permlane16_swap_b32 v136, v140
  v_permlane16_swap_b32 v137, v141
  v_permlane16_swap_b32 v188, v142
  v_add_f32 v136, v136, v140
  v_add_f32 v137, v137, v141
  v_add_f32 v188, v188, v142
  v_mov_b32 v140, v136
  v_mov_b32 v141, v137
  v_mov_b32 v142, v188
  v_permlane32_swap_b32 v136, v140
  v_permlane32_swap_b32 v137, v141
  v_permlane32_swap_b32 v188, v142
  v_add_f32 v136, v136, v140
  v_add_f32 v137, v137, v141
  v_add_f32 v188, v188, v142
  v_mul_f32 v136, 0x3b000000, v136
  v_mul_f32 v137, 0x3b000000, v137
  v_fma_f32 v137, -v136, v136, v137
  v_cvt_pk_bf16_f32 v136, 0, v136
  v_max_f32 v137, 0, v137
  v_sub_f32 v140, v196, v136
  v_sub_f32 v141, v197, v136
  v_cvt_pk_bf16_f32 v137, 0, v137
  v_sub_f32 v142, v198, v136
  v_sub_f32 v143, v199, v136
  v_add_f32 v137, 0x3727c5ac, v137
  v_sub_f32 v144, v200, v136
  v_sub_f32 v145, v201, v136
  v_cvt_pk_bf16_f32 v137, 0, v137
  v_sub_f32 v146, v202, v136
  v_sub_f32 v147, v203, v136
  v_sqrt_f32 v137, v137
  v_cvt_pk_bf16_f32 v140, 0, v140
  v_cvt_pk_bf16_f32 v141, 0, v141
  v_cvt_pk_bf16_f32 v137, 0, v137
  v_cvt_pk_bf16_f32 v142, 0, v142
  v_cvt_pk_bf16_f32 v143, 0, v143
  v_rcp_f32 v137, v137
  v_cvt_pk_bf16_f32 v144, 0, v144
  v_cvt_pk_bf16_f32 v145, 0, v145
  v_cvt_pk_bf16_f32 v146, 0, v146
  v_cvt_pk_bf16_f32 v147, 0, v147
  v_mul_f32 v140, v140, v137
  v_mul_f32 v141, v141, v137
  v_mul_f32 v142, v142, v137
  v_mul_f32 v143, v143, v137
  v_mul_f32 v144, v144, v137
  v_mul_f32 v145, v145, v137
  v_mul_f32 v146, v146, v137
  v_mul_f32 v147, v147, v137
  v_cvt_pk_bf16_f32 v132, v140, v141
  v_cvt_pk_bf16_f32 v133, v142, v143
  v_cvt_pk_bf16_f32 v134, v144, v145
  v_cvt_pk_bf16_f32 v135, v146, v147
  buffer_store_dwordx4 v[132:135], v0, s[4:7], s93 offen sc1
  v_cvt_pk_bf16_f32 v188, 0, v188
  v_ashrrev_i32 v189, 31, v188
  v_or_b32 v189, 0x80000000, v189
  v_xor_b32 v188, v188, v189
  s_sub_u32 s92, 4095, s90
  v_and_b32 v188, 0xffff0000, v188
  v_or_b32 v38, s92, v188
  s_bfe_u32 s92, s65, 196625
  s_lshl_b32 s92, s92, 18
  s_lshl_b32 s93, s90, 7
  s_add_u32 s92, s92, s93
  s_add_u32 s84, s92, 243269632
  s_waitcnt vmcnt(0)
  s_mov_b64 exec, 1
  buffer_store_dword v38, off, s[4:7], s84 sc1
  s_mov_b64 exec, -1
  s_mov_b32 s84, 268435456
  s_branch o_fd_219
o_rt_223:
  s_mov_b32 s67, 0
o_rl_225:
  s_lshl_b32 s94, s43, 14
  s_add_u32 s94, s94, s86
  buffer_load_dwordx4 v[120:123], v5, s[4:7], s94 offen offset:0 sc1
  buffer_load_dwordx4 v[124:127], v5, s[4:7], s94 offen offset:512 sc1
  buffer_load_dwordx4 v[128:131], v5, s[4:7], s94 offen offset:256 sc1
  buffer_load_dwordx4 v[132:135], v5, s[4:7], s94 offen offset:768 sc1
  s_add_u32 s94, s94, 4096
  buffer_load_dwordx4 v[136:139], v5, s[4:7], s94 offen offset:0 sc1
  buffer_load_dwordx4 v[140:143], v5, s[4:7], s94 offen offset:512 sc1
  buffer_load_dwordx4 v[144:147], v5, s[4:7], s94 offen offset:256 sc1
  buffer_load_dwordx4 v[148:151], v5, s[4:7], s94 offen offset:768 sc1
  s_add_u32 s94, s94, 4096
  buffer_load_dwordx4 v[152:155], v5, s[4:7], s94 offen offset:0 sc1
  buffer_load_dwordx4 v[156:159], v5, s[4:7], s94 offen offset:512 sc1
  buffer_load_dwordx4 v[160:163], v5, s[4:7], s94 offen offset:256 sc1
  buffer_load_dwordx4 v[164:167], v5, s[4:7], s94 offen offset:768 sc1
  s_add_u32 s94, s94, 4096
  buffer_load_dwordx4 v[168:171], v5, s[4:7], s94 offen offset:0 sc1
  buffer_load_dwordx4 v[172:175], v5, s[4:7], s94 offen offset:512 sc1
  buffer_load_dwordx4 v[176:179], v5, s[4:7], s94 offen offset:256 sc1
  buffer_load_dwordx4 v[180:183], v5, s[4:7], s94 offen offset:768 sc1
  s_add_u32 s67, s67, 1
  s_cmp_gt_u32 s67, 1048576
  s_cbranch_scc1 L_end
  s_waitcnt vmcnt(0)
  v_xor_b32 v7, s96, v120
  v_bitop3_b32 v7, v7, v124, s96 bitop3:0xf6
  v_bitop3_b32 v7, v7, v128, s96 bitop3:0xf6
  v_bitop3_b32 v7, v7, v132, s96 bitop3:0xf6
  v_bitop3_b32 v7, v7, v136, s96 bitop3:0xf6
  v_bitop3_b32 v7, v7, v140, s96 bitop3:0xf6
  v_bitop3_b32 v7, v7, v144, s96 bitop3:0xf6
  v_bitop3_b32 v7, v7, v148, s96 bitop3:0xf6
  v_bitop3_b32 v7, v7, v152, s96 bitop3:0xf6
  v_bitop3_b32 v7, v7, v156, s96 bitop3:0xf6
  v_bitop3_b32 v7, v7, v160, s96 bitop3:0xf6
  v_bitop3_b32 v7, v7, v164, s96 bitop3:0xf6
  v_bitop3_b32 v7, v7, v168, s96 bitop3:0xf6
  v_bitop3_b32 v7, v7, v172, s96 bitop3:0xf6
  v_bitop3_b32 v7, v7, v176, s96 bitop3:0xf6
  v_bitop3_b32 v7, v7, v180, s96 bitop3:0xf6
  v_and_b32 v7, v254, v7
  v_cmp_ne_u32 vcc, 0, v7
  s_cbranch_vccnz o_rl_225
  s_branch o_bk_224
o_f2_220:
  s_lshl_b32 s94, s43, 14
  s_add_u32 s94, s94, s86
  buffer_load_dwordx4 v[120:123], v5, s[4:7], s94 offen offset:0 sc1
  buffer_load_dwordx4 v[124:127], v5, s[4:7], s94 offen offset:512 sc1
  buffer_load_dwordx4 v[128:131], v5, s[4:7], s94 offen offset:256 sc1
  buffer_load_dwordx4 v[132:135], v5, s[4:7], s94 offen offset:768 sc1
  s_add_u32 s94, s94, 4096
  buffer_load_dwordx4 v[136:139], v5, s[4:7], s94 offen offset:0 sc1
  buffer_load_dwordx4 v[140:143], v5, s[4:7], s94 offen offset:512 sc1
  buffer_load_dwordx4 v[144:147], v5, s[4:7], s94 offen offset:256 sc1
  buffer_load_dwordx4 v[148:151], v5, s[4:7], s94 offen offset:768 sc1
  s_add_u32 s94, s94, 4096
  buffer_load_dwordx4 v[152:155], v5, s[4:7], s94 offen offset:0 sc1
  buffer_load_dwordx4 v[156:159], v5, s[4:7], s94 offen offset:512 sc1
  buffer_load_dwordx4 v[160:163], v5, s[4:7], s94 offen offset:256 sc1
  buffer_load_dwordx4 v[164:167], v5, s[4:7], s94 offen offset:768 sc1
  s_add_u32 s94, s94, 4096
  buffer_load_dwordx4 v[168:171], v5, s[4:7], s94 offen offset:0 sc1
  buffer_load_dwordx4 v[172:175], v5, s[4:7], s94 offen offset:512 sc1
  buffer_load_dwordx4 v[176:179], v5, s[4:7], s94 offen offset:256 sc1
  buffer_load_dwordx4 v[180:183], v5, s[4:7], s94 offen offset:768 sc1
  s_mov_b64 exec, 1
  buffer_store_dword v38, off, s[4:7], s84 sc1
  s_mov_b64 exec, -1
  s_mov_b32 s84, 268435456
  v_mov_b64 v[188:189], 0
  v_mov_b64 v[190:191], 0
  v_mov_b64 v[192:193], 0
  v_mov_b64 v[194:195], 0
  s_waitcnt vmcnt(13)
  v_xor_b32 v7, s96, v120
  v_bitop3_b32 v7, v7, v124, s96 bitop3:0xf6
  v_bitop3_b32 v7, v7, v128, s96 bitop3:0xf6
  v_bitop3_b32 v7, v7, v132, s96 bitop3:0xf6
  s_waitcnt vmcnt(9)
  v_bitop3_b32 v7, v7, v136, s96 bitop3:0xf6
  v_bitop3_b32 v7, v7, v140, s96 bitop3:0xf6
  v_bitop3_b32 v7, v7, v144, s96 bitop3:0xf6
  v_bitop3_b32 v7, v7, v148, s96 bitop3:0xf6
  s_waitcnt vmcnt(5)
  v_bitop3_b32 v7, v7, v152, s96 bitop3:0xf6
  v_bitop3_b32 v7, v7, v156, s96 bitop3:0xf6
  v_bitop3_b32 v7, v7, v160, s96 bitop3:0xf6
  v_bitop3_b32 v7, v7, v164, s96 bitop3:0xf6
  s_waitcnt vmcnt(1)
  v_bitop3_b32 v7, v7, v168, s96 bitop3:0xf6
  v_bitop3_b32 v7, v7, v172, s96 bitop3:0xf6
  v_bitop3_b32 v7, v7, v176, s96 bitop3:0xf6
  v_bitop3_b32 v7, v7, v180, s96 bitop3:0xf6
  v_and_b32 v7, v254, v7
  v_cmp_ne_u32 vcc, 0, v7
  s_cbranch_vccnz o_rt_226
o_bk_227:
  v_smfmac_f32_16x16x64_bf16 v[188:191], v[16:19], v[120:127], v20
  v_lshlrev_b32 v196, 16, v184
  v_smfmac_f32_16x16x64_bf16 v[192:195], v[16:19], v[128:135], v20
  v_and_b32 v197, 0xffff0000, v184
  v_smfmac_f32_16x16x64_bf16 v[188:191], v[16:19], v[136:143], v20
  v_lshlrev_b32 v198, 16, v185
  v_smfmac_f32_16x16x64_bf16 v[192:195], v[16:19], v[144:151], v20
  v_and_b32 v199, 0xffff0000, v185
  v_smfmac_f32_16x16x64_bf16 v[188:191], v[16:19], v[152:159], v20
  v_lshlrev_b32 v200, 16, v186
  v_smfmac_f32_16x16x64_bf16 v[192:195], v[16:19], v[160:167], v20
  v_and_b32 v201, 0xffff0000, v186
  v_smfmac_f32_16x16x64_bf16 v[188:191], v[16:19], v[168:175], v20
  v_lshlrev_b32 v202, 16, v187
  v_smfmac_f32_16x16x64_bf16 v[192:195], v[16:19], v[176:183], v20
  v_and_b32 v203, 0xffff0000, v187
  s_bfe_u32 s92, s65, 131086
  s_lshl_b32 s92, s92, 21
  s_add_u32 s92, s92, s91
  s_add_u32 s93, s92, 27262976
  s_add_u32 s92, s92, 20971520
  s_nop 1
  v_permlane16_swap_b32 v188, v192
  v_permlane16_swap_b32 v189, v193
  v_permlane16_swap_b32 v190, v194
  v_permlane16_swap_b32 v191, v195
  v_cvt_pk_bf16_f32 v188, 0, v188
  v_cvt_pk_bf16_f32 v189, 0, v189
  v_cvt_pk_bf16_f32 v190, 0, v190
  v_cvt_pk_bf16_f32 v191, 0, v191
  v_cvt_pk_bf16_f32 v192, 0, v192
  v_cvt_pk_bf16_f32 v193, 0, v193
  v_cvt_pk_bf16_f32 v194, 0, v194
  v_cvt_pk_bf16_f32 v195, 0, v195
  v_add_f32 v196, v196, v188
  v_add_f32 v197, v197, v189
  v_add_f32 v198, v198, v190
  v_add_f32 v199, v199, v191
  v_add_f32 v200, v200, v192
  v_add_f32 v201, v201, v193
  v_add_f32 v202, v202, v194
  v_add_f32 v203, v203, v195
  v_cvt_pk_bf16_f32 v120, v196, v197
  v_cvt_pk_bf16_f32 v121, v198, v199
  v_cvt_pk_bf16_f32 v122, v200, v201
  v_cvt_pk_bf16_f32 v123, v202, v203
  v_lshlrev_b32 v196, 16, v120
  v_and_b32 v197, 0xffff0000, v120
  v_lshlrev_b32 v198, 16, v121
  v_and_b32 v199, 0xffff0000, v121
  v_lshlrev_b32 v200, 16, v122
  v_and_b32 v201, 0xffff0000, v122
  v_lshlrev_b32 v202, 16, v123
  v_and_b32 v203, 0xffff0000, v123
  buffer_store_dwordx4 v[120:123], v0, s[4:7], s92 offen sc1
  v_add_f32 v136, v196, v197
  v_mul_f32 v137, v196, v196
  v_add_f32 v138, v198, v199
  v_mul_f32 v139, v197, v197
  v_fmac_f32 v137, v198, v198
  v_fmac_f32 v139, v199, v199
  v_add_f32 v136, v136, v200
  v_fmac_f32 v137, v200, v200
  v_add_f32 v138, v138, v201
  v_fmac_f32 v139, v201, v201
  v_add_f32 v136, v136, v202
  v_fmac_f32 v137, v202, v202
  v_add_f32 v138, v138, v203
  v_fmac_f32 v139, v203, v203
  v_add_f32 v136, v136, v138
  v_add_f32 v137, v137, v139
  s_nop 0
  v_add_f32_dpp v136, v136, v136 row_ror:8 row_mask:0xf bank_mask:0xf
  v_add_f32_dpp v137, v137, v137 row_ror:8 row_mask:0xf bank_mask:0xf
  s_nop 0
  v_add_f32_dpp v136, v136, v136 row_ror:4 row_mask:0xf bank_mask:0xf
  v_add_f32_dpp v137, v137, v137 row_ror:4 row_mask:0xf bank_mask:0xf
  s_nop 0
  v_add_f32_dpp v136, v136, v136 row_ror:2 row_mask:0xf bank_mask:0xf
  v_add_f32_dpp v137, v137, v137 row_ror:2 row_mask:0xf bank_mask:0xf
  s_nop 0
  v_add_f32_dpp v136, v136, v136 row_ror:1 row_mask:0xf bank_mask:0xf
  v_add_f32_dpp v137, v137, v137 row_ror:1 row_mask:0xf bank_mask:0xf
  v_mov_b32 v140, v136
  v_mov_b32 v141, v137
  s_nop 0
  v_permlane16_swap_b32 v136, v140
  v_permlane16_swap_b32 v137, v141
  v_add_f32 v136, v136, v140
  v_add_f32 v137, v137, v141
  v_mov_b32 v140, v136
  v_mov_b32 v141, v137
  s_nop 0
  v_permlane32_swap_b32 v136, v140
  v_permlane32_swap_b32 v137, v141
  v_add_f32 v136, v136, v140
  v_add_f32 v137, v137, v141
  v_mul_f32 v136, 0x3b000000, v136
  v_mul_f32 v137, 0x3b000000, v137
  v_fma_f32 v137, -v136, v136, v137
  v_cvt_pk_bf16_f32 v136, 0, v136
  v_max_f32 v137, 0, v137
  v_sub_f32 v140, v196, v136
  v_sub_f32 v141, v197, v136
  v_cvt_pk_bf16_f32 v137, 0, v137
  v_sub_f32 v142, v198, v136
  v_sub_f32 v143, v199, v136
  v_add_f32 v137, 0x3727c5ac, v137
  v_sub_f32 v144, v200, v136
  v_sub_f32 v145, v201, v136
  v_cvt_pk_bf16_f32 v137, 0, v137
  v_sub_f32 v146, v202, v136
  v_sub_f32 v147, v203, v136
  v_sqrt_f32 v137, v137
  v_cvt_pk_bf16_f32 v140, 0, v140
  v_cvt_pk_bf16_f32 v141, 0, v141
  v_cvt_pk_bf16_f32 v137, 0, v137
  v_cvt_pk_bf16_f32 v142, 0, v142
  v_cvt_pk_bf16_f32 v143, 0, v143
  v_rcp_f32 v137, v137
  v_cvt_pk_bf16_f32 v144, 0, v144
  v_cvt_pk_bf16_f32 v145, 0, v145
  v_cvt_pk_bf16_f32 v146, 0, v146
  v_cvt_pk_bf16_f32 v147, 0, v147
  v_mul_f32 v140, v140, v137
  v_mul_f32 v141, v141, v137
  v_mul_f32 v142, v142, v137
  v_mul_f32 v143, v143, v137
  v_mul_f32 v144, v144, v137
  v_mul_f32 v145, v145, v137
  v_mul_f32 v146, v146, v137
  v_mul_f32 v147, v147, v137
  v_cvt_pk_bf16_f32 v124, v140, v141
  v_cvt_pk_bf16_f32 v125, v142, v143
  v_cvt_pk_bf16_f32 v126, v144, v145
  v_cvt_pk_bf16_f32 v127, v146, v147
  v_lshlrev_b32 v204, 16, v124
  v_and_b32 v205, 0xffff0000, v124
  v_lshlrev_b32 v206, 16, v125
  v_and_b32 v207, 0xffff0000, v125
  v_lshlrev_b32 v208, 16, v126
  v_and_b32 v209, 0xffff0000, v126
  v_lshlrev_b32 v210, 16, v127
  v_and_b32 v211, 0xffff0000, v127
  buffer_store_dwordx4 v[124:127], v0, s[4:7], s93 offen sc1
  v_add_f32 v196, v196, v204
  v_add_f32 v197, v197, v205
  v_add_f32 v198, v198, v206
  v_add_f32 v199, v199, v207
  v_add_f32 v200, v200, v208
  v_add_f32 v201, v201, v209
  v_add_f32 v202, v202, v210
  v_add_f32 v203, v203, v211
  v_cvt_pk_bf16_f32 v128, v196, v197
  v_cvt_pk_bf16_f32 v129, v198, v199
  v_cvt_pk_bf16_f32 v130, v200, v201
  v_cvt_pk_bf16_f32 v131, v202, v203
  v_mul_f32 v188, v204, v8
  v_mul_f32 v189, v205, v9
  v_fmac_f32 v188, v206, v10
  v_fmac_f32 v189, v207, v11
  v_fmac_f32 v188, v208, v12
  v_fmac_f32 v189, v209, v13
  v_fmac_f32 v188, v210, v14
  v_fmac_f32 v189, v211, v15
  v_add_f32 v188, v188, v189
  buffer_store_dwordx4 v[128:131], v0, s[68:71], s91 offen sc1
  s_nop 0
  v_add_f32_dpp v188, v188, v188 row_ror:8 row_mask:0xf bank_mask:0xf
  s_nop 1
  v_add_f32_dpp v188, v188, v188 row_ror:4 row_mask:0xf bank_mask:0xf
  s_nop 1
  v_add_f32_dpp v188, v188, v188 row_ror:2 row_mask:0xf bank_mask:0xf
  s_nop 1
  v_add_f32_dpp v188, v188, v188 row_ror:1 row_mask:0xf bank_mask:0xf
  v_mov_b32 v189, v188
  s_nop 0
  s_nop 0
  v_permlane16_swap_b32 v188, v189
  v_add_f32 v188, v188, v189
  v_mov_b32 v189, v188
  s_nop 0
  s_nop 0
  v_permlane32_swap_b32 v188, v189
  v_add_f32 v188, v188, v189
  v_cvt_pk_bf16_f32 v188, 0, v188
  v_ashrrev_i32 v189, 31, v188
  v_or_b32 v189, 0x80000000, v189
  v_xor_b32 v188, v188, v189
  s_sub_u32 s92, 4095, s90
  v_and_b32 v188, 0xffff0000, v188
  v_or_b32 v38, s92, v188
  s_bfe_u32 s92, s65, 196625
  s_lshl_b32 s92, s92, 18
  s_lshl_b32 s93, s90, 7
  s_add_u32 s92, s92, s93
  s_add_u32 s84, s92, 243269632
  s_waitcnt vmcnt(0)
  s_mov_b64 exec, 1
  buffer_store_dword v38, off, s[4:7], s84 sc1
  s_mov_b64 exec, -1
  s_mov_b32 s84, 268435456
  s_branch o_fd_219
o_rt_226:
  s_mov_b32 s67, 0
o_rl_228:
  s_lshl_b32 s94, s43, 14
  s_add_u32 s94, s94, s86
  buffer_load_dwordx4 v[120:123], v5, s[4:7], s94 offen offset:0 sc1
  buffer_load_dwordx4 v[124:127], v5, s[4:7], s94 offen offset:512 sc1
  buffer_load_dwordx4 v[128:131], v5, s[4:7], s94 offen offset:256 sc1
  buffer_load_dwordx4 v[132:135], v5, s[4:7], s94 offen offset:768 sc1
  s_add_u32 s94, s94, 4096
  buffer_load_dwordx4 v[136:139], v5, s[4:7], s94 offen offset:0 sc1
  buffer_load_dwordx4 v[140:143], v5, s[4:7], s94 offen offset:512 sc1
  buffer_load_dwordx4 v[144:147], v5, s[4:7], s94 offen offset:256 sc1
  buffer_load_dwordx4 v[148:151], v5, s[4:7], s94 offen offset:768 sc1
  s_add_u32 s94, s94, 4096
  buffer_load_dwordx4 v[152:155], v5, s[4:7], s94 offen offset:0 sc1
  buffer_load_dwordx4 v[156:159], v5, s[4:7], s94 offen offset:512 sc1
  buffer_load_dwordx4 v[160:163], v5, s[4:7], s94 offen offset:256 sc1
  buffer_load_dwordx4 v[164:167], v5, s[4:7], s94 offen offset:768 sc1
  s_add_u32 s94, s94, 4096
  buffer_load_dwordx4 v[168:171], v5, s[4:7], s94 offen offset:0 sc1
  buffer_load_dwordx4 v[172:175], v5, s[4:7], s94 offen offset:512 sc1
  buffer_load_dwordx4 v[176:179], v5, s[4:7], s94 offen offset:256 sc1
  buffer_load_dwordx4 v[180:183], v5, s[4:7], s94 offen offset:768 sc1
  s_add_u32 s67, s67, 1
  s_cmp_gt_u32 s67, 1048576
  s_cbranch_scc1 L_end
  s_waitcnt vmcnt(0)
  v_xor_b32 v7, s96, v120
  v_bitop3_b32 v7, v7, v124, s96 bitop3:0xf6
  v_bitop3_b32 v7, v7, v128, s96 bitop3:0xf6
  v_bitop3_b32 v7, v7, v132, s96 bitop3:0xf6
  v_bitop3_b32 v7, v7, v136, s96 bitop3:0xf6
  v_bitop3_b32 v7, v7, v140, s96 bitop3:0xf6
  v_bitop3_b32 v7, v7, v144, s96 bitop3:0xf6
  v_bitop3_b32 v7, v7, v148, s96 bitop3:0xf6
  v_bitop3_b32 v7, v7, v152, s96 bitop3:0xf6
  v_bitop3_b32 v7, v7, v156, s96 bitop3:0xf6
  v_bitop3_b32 v7, v7, v160, s96 bitop3:0xf6
  v_bitop3_b32 v7, v7, v164, s96 bitop3:0xf6
  v_bitop3_b32 v7, v7, v168, s96 bitop3:0xf6
  v_bitop3_b32 v7, v7, v172, s96 bitop3:0xf6
  v_bitop3_b32 v7, v7, v176, s96 bitop3:0xf6
  v_bitop3_b32 v7, v7, v180, s96 bitop3:0xf6
  v_and_b32 v7, v254, v7
  v_cmp_ne_u32 vcc, 0, v7
  s_cbranch_vccnz o_rl_228
  s_branch o_bk_227
o_fd_219:
  s_mov_b32 s65, 0
o_nofl_179:
  s_mov_b32 s63, s64
  s_cmp_lg_u32 s51, 0
  s_cbranch_scc1 o_pick_181
  s_cmp_eq_u32 s50, 0
  s_cbranch_scc1 o_help_188_n
o_adv_187:
  s_add_u32 s49, s49, 4
  s_branch o_round_177
o_dl_189_a:
  s_andn2_b32 s26, s58, s55
  s_and_b32 s29, s26, s54
  s_bcnt1_i32_b32 s27, s29
  s_add_u32 s27, s27, 2
  s_max_u32 s27, s27, 4
  s_andn2_b32 s26, s26, s56
  s_and_b32 s26, s26, 0x3fff
  s_or_b32 s26, s26, s29
  s_cselect_b32 s27, s27, 0
  s_mul_i32 s27, s27, 0
  s_cmp_ge_u32 s46, s89
  s_cselect_b32 s30, s54, -1
  s_mov_b32 s31, 243269696
  s_branch o_dl_189_b
o_dl_189:
  s_and_b32 s26, s55, s54
  s_andn2_b32 s27, s56, s54
  s_or_b32 s26, s26, s27
  s_andn2_b32 s26, s58, s26
  s_bcnt1_i32_b32 s27, s26
  s_bcnt1_i32_b32 s28, s47
  s_mul_i32 s28, s28, -5
  s_lshl1_add_u32 s27, s27, s28
  s_add_i32 s27, s27, 1
  s_max_i32 s27, s27, 0
  s_mul_i32 s27, s27, 37
  s_mov_b32 s30, s54
  s_mov_b32 s31, 243269704
  s_and_b32 s29, s26, s47
  s_andn2_b32 s26, s26, s29
  s_branch o_dl_189_c
o_dl_189_b:
  s_mov_b32 s29, 0
o_dl_189_c:
  s_bfe_u32 s28, s48, 262144
  s_bitset0_b32 s26, s28
  s_bfe_u32 s28, s48, 262148
  s_bitset0_b32 s26, s28
  s_bfe_u32 s28, s48, 262152
  s_bitset0_b32 s26, s28
  s_bfe_u32 s28, s48, 262156
  s_bitset0_b32 s26, s28
  s_lshr_b32 s27, s27, 8
o_dl1_190:
  s_cbranch_scc0 o_dl2_191
  s_ff1_i32_b32 s28, s26
  s_bitset0_b32 s26, s28
  s_bitset1_b32 s29, s28
  s_sub_u32 s27, s27, 1
  s_cmp_lg_u32 s27, 0
  s_branch o_dl1_190
o_dl2_191:
  s_and_b32 s47, s29, 0xffff
  s_and_b32 s30, s30, s47
  s_or_b32 s55, s55, s30
  s_andn2_b32 s26, s47, s30
  s_or_b32 s56, s56, s26
  s_pack_ll_b32_b16 s26, s47, s30
  s_lshl_b32 s27, s60, 7
  s_add_u32 s27, s27, s31
  s_cmp_lg_u32 s43, 0
  s_cbranch_scc1 o_pick_181
  v_mov_b32 v162, s26
  v_mov_b32 v163, s46
  s_mov_b64 exec, 1
  buffer_store_dwordx2 v[162:163], off, s[4:7], s27 sc1
  s_mov_b64 exec, -1
  s_branch o_pick_181
o_help_188:
  s_lshl_b32 s60, s60, 1
  s_and_b32 s60, s60, 2
  s_lshl_b32 s47, s60, 7
  s_add_u32 s47, s47, 243269688
o_help_188_n:
  s_add_u32 s47, s47, 8
  s_lshr_b32 s26, s47, 4
  s_andn2_b32 s26, s57, s26
  s_cbranch_scc0 L_end
  s_mov_b32 s67, 0
o_help_188_w:
  buffer_load_dwordx2 v[162:163], off, s[4:7], s47 sc1
  buffer_load_dwordx2 v[164:165], off, s[4:7], s47 offset:128 sc1
  s_add_u32 s67, s67, 1
  s_cmp_gt_u32 s67, 1048576
  s_cbranch_scc1 L_end
  s_waitcnt vmcnt(0)
  v_readfirstlane_b32 s28, v162
  v_readfirstlane_b32 s30, v164
  v_readfirstlane_b32 s46, v163
  v_readfirstlane_b32 s27, v165
  s_min_u32 s26, s46, s27
  s_cmp_eq_u32 s26, 0
  s_cbranch_scc1 o_help_188_w
  s_max_u32 s46, s46, s27
  s_bitreplicate_b64_b32 s[28:29], s28
  s_bitreplicate_b64_b32 s[30:31], s30
  s_mov_b32 s26, 0x55555555
  s_mov_b32 s27, 0x55555555
  s_and_b64 s[28:29], s[28:29], s[26:27]
  s_andn2_b64 s[30:31], s[30:31], s[26:27]
  s_or_b32 s58, s28, s30
  s_or_b32 s54, s29, s31
  s_andn2_b32 s52, 0xfff, s46
  s_lshr_b32 s52, s52, 5
  s_mov_b32 s53, 0
  s_mov_b32 s63, 0
  s_mov_b32 s49, 72
  s_mov_b32 s59, 64
  s_mov_b32 s50, 0
  s_mov_b32 s89, 0
  s_branch o_pick_181

.section .rodata,"a"
.p2align 6
.amdhsa_kernel interleave_layers__memory_aug_recurrent_mem_tr__moe_arch_mod__prompt_kernel
  .amdhsa_next_free_vgpr 512
  .amdhsa_next_free_sgpr 102
  .amdhsa_accum_offset 256
  .amdhsa_group_segment_fixed_size 0
  .amdhsa_kernarg_size 120
  .amdhsa_user_sgpr_count 2
  .amdhsa_user_sgpr_kernarg_segment_ptr 1
  .amdhsa_system_sgpr_workgroup_id_x 1
  .amdhsa_float_denorm_mode_32 3
.end_amdhsa_kernel
```

```asm
; @launch grid=(256,1,1) block=(256,1,1) lds=163840
.amdgcn_target "amdgcn-amd-amdhsa--gfx950"
.text
.globl interleave_layers__memory_aug_recurrent_mem_tr__moe_arch_mod__prompt_kernel
.p2align 8
.type interleave_layers__memory_aug_recurrent_mem_tr__moe_arch_mod__prompt_kernel,@function
interleave_layers__memory_aug_recurrent_mem_tr__moe_arch_mod__prompt_kernel:
  s_cmp_ge_u32 s2, 256
  s_cbranch_scc1 L_end
  s_mov_b32 s6, 268435456
  s_mov_b32 s7, 0x20000
  s_mov_b32 s11, 0x20000
  s_getreg_b32 s89, hwreg(HW_REG_XCC_ID)
  s_and_b32 s89, s89, 7
  v_lshrrev_b32 v1, 6, v0
  s_and_b32 s91, s2, 7
  s_lshr_b32 s90, s2, 3
  v_readfirstlane_b32 s17, v1
  s_lshl_b32 s100, s91, 5
  s_add_u32 s100, s100, s90
  s_lshl_b32 s100, s100, 2
  s_add_u32 s100, s100, s17
  s_lshl_b32 s100, s100, 12
  s_add_u32 s100, s100, 37748736
  s_cmp_lt_u32 s91, 3
  s_cbranch_scc1 L_chain
  s_cmp_eq_u32 s91, 7
  s_cbranch_scc1 L_qkv
  s_bitcmp1_b32 s90, 4
  s_cbranch_scc1 L_qkv
  s_branch L_o
L_end:
  s_endpgm
L_chain:
  s_load_dwordx2 s[4:5], s[0:1], 112
  s_load_dwordx2 s[12:13], s[0:1], 104
  s_mov_b32 s16, s90
  s_mov_b32 s60, s91
  s_min_u32 s61, s91, 1
  v_lshrrev_b32 v18, 6, v0
  v_and_b32 v19, 63, v0
  v_readfirstlane_b32 s17, v18
  v_and_b32 v7, 15, v19
  v_lshrrev_b32 v17, 4, v19
  v_lshlrev_b32 v0, 4, v19
  s_load_dwordx2 s[56:57], s[0:1], 8
  s_mov_b32 s44, 0x05040100
  s_mov_b32 s45, 0x07060302
  s_mov_b32 s18, 0xcccccccc
  s_mov_b32 s19, 0xcccccccc
  s_mov_b32 s24, 0x3e0293ee
  s_lshl_b32 s26, s17, 10
  v_add_u32 v8, s26, v0
  v_xor_b32 v9, 1024, v8
  v_xor_b32 v10, 2048, v8
  v_xor_b32 v11, 3072, v8
  s_mov_b32 s14, 0x3f803f80
  s_mov_b32 s15, 0x3f803f80
  s_mul_i32 s27, s17, 24576
  s_add_u32 s27, s27, 65536
  v_add_u32 v1, s27, v0
  v_lshrrev_b32 v20, 2, v7
  v_xor_b32 v21, v17, v20
  v_lshlrev_b32 v22, 5, v7
  v_add_u32 v22, s26, v22
  v_lshl_add_u32 v2, v21, 3, v22
  v_and_b32 v21, 3, v7
  v_xor_b32 v21, v21, v17
  v_lshl_add_u32 v22, v17, 2, v20
  v_lshlrev_b32 v22, 5, v22
  v_lshl_add_u32 v3, v21, 3, v22
  v_add_u32 v12, s26, v3
  v_xor_b32 v13, 1024, v12
  v_xor_b32 v14, 2048, v12
  v_xor_b32 v15, 3072, v12
  v_lshlrev_b32 v21, 13, v20
  v_and_b32 v22, 3, v7
  v_lshl_add_u32 v22, v17, 2, v22
  v_lshl_add_u32 v21, v22, 4, v21
  s_lshl_b32 s27, s17, 16
  s_lshl_b32 s28, s16, 8
  s_add_u32 s27, s27, s28
  v_add_u32 v4, s27, v21
  v_and_b32 v21, 1, v7
  v_lshl_add_u32 v21, v17, 2, v21
  v_bfe_u32 v22, v7, 2, 1
  v_lshl_add_u32 v21, v22, 1, v21
  v_lshlrev_b32 v21, 4, v21
  v_bfe_u32 v22, v7, 1, 1
  v_lshl_add_u32 v21, v22, 3, v21
  v_add_u32 v5, s28, v21
  v_cmp_lt_u32 vcc, 7, v7
  v_mov_b32 v22, 0x7ff00000
  s_nop 0
  v_cndmask_b32 v5, v5, v22, vcc
  v_mov_b32 v21, 0x4444
  v_mov_b32 v22, 0xeeee
  v_cndmask_b32 v6, v21, v22, s[18:19]
  s_lshl_b32 s40, s60, 20
  s_add_u32 s40, s40, 0
  s_add_u32 s41, s40, 32768
  s_lshl_b32 s62, s60, 16
  s_add_u32 s62, s62, 4194304
  v_mov_b32 v24, -1
  v_mov_b32 v25, -1
  v_mov_b32 v26, -1
  v_mov_b32 v27, -1
  s_waitcnt lgkmcnt(0)
  buffer_store_dwordx4 v[24:27], v4, s[4:7], s40 offen sc1
  buffer_store_dwordx4 v[24:27], v4, s[4:7], s41 offen sc1
  s_add_u32 s27, s62, 0
  buffer_store_dwordx2 v[24:25], v5, s[4:7], s27 offen sc1
  s_add_u32 s27, s62, 8192
  buffer_store_dwordx2 v[24:25], v5, s[4:7], s27 offen sc1
  s_add_u32 s27, s62, 16384
  buffer_store_dwordx2 v[24:25], v5, s[4:7], s27 offen sc1
  s_add_u32 s27, s62, 24576
  buffer_store_dwordx2 v[24:25], v5, s[4:7], s27 offen sc1
  v_mov_b64 v[28:29], 0
  v_mov_b64 v[30:31], 0
  s_lshl_b32 s26, s16, 12
  s_cmp_eq_u32 s91, 0
  s_cbranch_scc1 L_ch1
  s_cmp_eq_u32 s91, 2
  s_cbranch_scc1 L_ch2
  s_add_u32 s27, s26, 243269632
  buffer_store_dwordx4 v[28:31], v8, s[4:7], s27 offen sc1
  s_add_u32 s27, s26, 243400704
  buffer_store_dwordx4 v[28:31], v8, s[4:7], s27 offen sc1
  s_add_u32 s27, s26, 243531776
  buffer_store_dwordx4 v[28:31], v8, s[4:7], s27 offen sc1
  s_add_u32 s27, s26, 243662848
  buffer_store_dwordx4 v[28:31], v8, s[4:7], s27 offen sc1
  s_add_u32 s27, s26, 243793920
  buffer_store_dwordx4 v[28:31], v8, s[4:7], s27 offen sc1
  s_add_u32 s27, s26, 243924992
  buffer_store_dwordx4 v[28:31], v8, s[4:7], s27 offen sc1
  s_add_u32 s27, s26, 244056064
  buffer_store_dwordx4 v[28:31], v8, s[4:7], s27 offen sc1
  s_add_u32 s27, s26, 244187136
  buffer_store_dwordx4 v[28:31], v8, s[4:7], s27 offen sc1
  s_add_u32 s27, s26, 244318208
  buffer_store_dwordx4 v[28:31], v8, s[4:7], s27 offen sc1
  s_add_u32 s27, s26, 244449280
  buffer_store_dwordx4 v[28:31], v8, s[4:7], s27 offen sc1
  s_add_u32 s27, s26, 244580352
  buffer_store_dwordx4 v[28:31], v8, s[4:7], s27 offen sc1
  s_add_u32 s27, s26, 244711424
  buffer_store_dwordx4 v[28:31], v8, s[4:7], s27 offen sc1
  s_add_u32 s27, s26, 244842496
  buffer_store_dwordx4 v[28:31], v8, s[4:7], s27 offen sc1
  s_add_u32 s27, s26, 244973568
  buffer_store_dwordx4 v[28:31], v8, s[4:7], s27 offen sc1
  s_add_u32 s27, s26, 245104640
  buffer_store_dwordx4 v[28:31], v8, s[4:7], s27 offen sc1
  s_add_u32 s27, s26, 245235712
  buffer_store_dwordx4 v[28:31], v8, s[4:7], s27 offen sc1
  s_add_u32 s27, s26, 245366784
  buffer_store_dwordx4 v[28:31], v8, s[4:7], s27 offen sc1
  s_branch L_ch0
L_ch2:
  s_add_u32 s27, s26, 245891072
  buffer_store_dwordx4 v[24:27], v8, s[4:7], s27 offen sc1
  s_add_u32 s27, s26, 246022144
  buffer_store_dwordx4 v[24:27], v8, s[4:7], s27 offen sc1
  s_add_u32 s27, s26, 246153216
  buffer_store_dwordx4 v[24:27], v8, s[4:7], s27 offen sc1
  s_add_u32 s27, s26, 246284288
  buffer_store_dwordx4 v[24:27], v8, s[4:7], s27 offen sc1
  s_add_u32 s27, s26, 246415360
  buffer_store_dwordx4 v[24:27], v8, s[4:7], s27 offen sc1
  s_add_u32 s27, s26, 246546432
  buffer_store_dwordx4 v[24:27], v8, s[4:7], s27 offen sc1
  s_add_u32 s27, s26, 246677504
  buffer_store_dwordx4 v[24:27], v8, s[4:7], s27 offen sc1
  s_add_u32 s27, s26, 246808576
  buffer_store_dwordx4 v[24:27], v8, s[4:7], s27 offen sc1
  s_add_u32 s27, s26, 246939648
  buffer_store_dwordx4 v[24:27], v8, s[4:7], s27 offen sc1
  s_add_u32 s27, s26, 247070720
  buffer_store_dwordx4 v[24:27], v8, s[4:7], s27 offen sc1
  s_add_u32 s27, s26, 247201792
  buffer_store_dwordx4 v[24:27], v8, s[4:7], s27 offen sc1
  s_add_u32 s27, s26, 247332864
  buffer_store_dwordx4 v[24:27], v8, s[4:7], s27 offen sc1
  s_add_u32 s27, s26, 247463936
  buffer_store_dwordx4 v[24:27], v8, s[4:7], s27 offen sc1
  s_add_u32 s27, s26, 247595008
  buffer_store_dwordx4 v[24:27], v8, s[4:7], s27 offen sc1
  s_add_u32 s27, s26, 247726080
  buffer_store_dwordx4 v[24:27], v8, s[4:7], s27 offen sc1
  s_add_u32 s27, s26, 247857152
  buffer_store_dwordx4 v[24:27], v8, s[4:7], s27 offen sc1
  s_add_u32 s27, s26, 247988224
  buffer_store_dwordx4 v[24:27], v8, s[4:7], s27 offen sc1
  s_add_u32 s27, s26, 248119296
  buffer_store_dwordx4 v[24:27], v8, s[4:7], s27 offen sc1
  s_add_u32 s27, s26, 248250368
  buffer_store_dwordx4 v[24:27], v8, s[4:7], s27 offen sc1
  s_add_u32 s27, s26, 248381440
  buffer_store_dwordx4 v[24:27], v8, s[4:7], s27 offen sc1
  s_add_u32 s27, s26, 248512512
  buffer_store_dwordx4 v[24:27], v8, s[4:7], s27 offen sc1
  s_add_u32 s27, s26, 248643584
  buffer_store_dwordx4 v[24:27], v8, s[4:7], s27 offen sc1
  s_add_u32 s27, s26, 16777216
  buffer_store_dwordx4 v[28:31], v8, s[4:7], s27 offen sc1
  s_add_u32 s27, s26, 16908288
  buffer_store_dwordx4 v[28:31], v8, s[4:7], s27 offen sc1
  s_add_u32 s27, s26, 17039360
  buffer_store_dwordx4 v[28:31], v8, s[4:7], s27 offen sc1
  s_add_u32 s27, s26, 17170432
  buffer_store_dwordx4 v[28:31], v8, s[4:7], s27 offen sc1
  s_add_u32 s27, s26, 17301504
  buffer_store_dwordx4 v[28:31], v8, s[4:7], s27 offen sc1
  s_add_u32 s27, s26, 17432576
  buffer_store_dwordx4 v[28:31], v8, s[4:7], s27 offen sc1
  s_add_u32 s27, s26, 17563648
  buffer_store_dwordx4 v[28:31], v8, s[4:7], s27 offen sc1
  s_add_u32 s27, s26, 17694720
  buffer_store_dwordx4 v[28:31], v8, s[4:7], s27 offen sc1
  s_add_u32 s27, s26, 17825792
  buffer_store_dwordx4 v[28:31], v8, s[4:7], s27 offen sc1
  s_add_u32 s27, s26, 17956864
  buffer_store_dwordx4 v[28:31], v8, s[4:7], s27 offen sc1
  s_add_u32 s27, s26, 18087936
  buffer_store_dwordx4 v[28:31], v8, s[4:7], s27 offen sc1
  s_add_u32 s27, s26, 18219008
  buffer_store_dwordx4 v[28:31], v8, s[4:7], s27 offen sc1
  s_add_u32 s27, s26, 18350080
  buffer_store_dwordx4 v[28:31], v8, s[4:7], s27 offen sc1
  s_add_u32 s27, s26, 18481152
  buffer_store_dwordx4 v[28:31], v8, s[4:7], s27 offen sc1
  s_add_u32 s27, s26, 18612224
  buffer_store_dwordx4 v[28:31], v8, s[4:7], s27 offen sc1
  s_add_u32 s27, s26, 18743296
  buffer_store_dwordx4 v[28:31], v8, s[4:7], s27 offen sc1
L_ch0:
  s_waitcnt vmcnt(0)
  s_barrier
  s_cmp_lg_u32 s17, 0
  s_cbranch_scc1 g_ar_1
  s_lshl_b32 s36, s89, 3
  s_lshl_b64 s[36:37], 1, s36
  v_lshlrev_b32 v124, 3, s91
  v_mov_b32 v120, s36
  v_mov_b32 v121, s37
  s_mov_b64 exec, 1
  global_atomic_add_x2 v[122:123], v124, v[120:121], s[12:13] sc0
  s_mov_b64 exec, -1
g_ar_1:
  s_waitcnt vmcnt(0)
  s_cmp_lg_u32 s17, 0
  s_cbranch_scc1 g_af_2
  v_readfirstlane_b32 s36, v122
  v_readfirstlane_b32 s37, v123
  s_add_u32 s38, s36, s37
  s_mul_i32 s38, s38, 0x01010101
  s_lshr_b32 s38, s38, 24
  s_cmp_lg_u32 s38, 31
  s_cbranch_scc1 g_af_2
  s_lshl_b32 s38, s89, 3
  s_lshr_b64 s[36:37], s[36:37], s38
  s_and_b32 s36, s36, 0xff
  s_cmp_eq_u32 s36, 31
  s_cselect_b32 s36, 1, 2
  v_mov_b32 v120, s36
  v_lshrrev_b32 v124, 1, v124
  s_mov_b64 exec, 1
  global_store_dword v124, v120, s[12:13] offset:128 sc1
  s_mov_b64 exec, -1
g_af_2:
L_ch1:
  s_mov_b32 s58, 8192
  s_mov_b32 s59, 0x20000
  v_and_b32 v21, 1, v7
  v_lshl_add_u32 v21, v17, 1, v21
  v_lshlrev_b32 v21, 10, v21
  v_bfe_u32 v22, v7, 1, 2
  v_lshl_add_u32 v21, v22, 1, v21
  s_lshr_b32 s27, s16, 3
  s_lshl_b32 s27, s27, 8
  s_and_b32 s28, s16, 3
  s_lshl_b32 s28, s28, 6
  s_add_u32 s27, s27, s28
  s_and_b32 s28, s16, 4
  s_lshl_b32 s28, s28, 1
  s_add_u32 s27, s27, s28
  s_waitcnt lgkmcnt(0)
  buffer_load_ushort v28, v21, s[56:59], s27 offen offset:0
  buffer_load_ushort v29, v21, s[56:59], s27 offen offset:16
  buffer_load_ushort v30, v21, s[56:59], s27 offen offset:32
  buffer_load_ushort v31, v21, s[56:59], s27 offen offset:48
  s_cmp_eq_u32 s91, 0
  s_cbranch_scc1 L_ha
  v_mbcnt_lo_u32_b32 v116, -1, 0
  v_and_b32 v116, 0, v116
  v_add_lshl_u32 v116, v116, 1, 2
  s_mov_b32 s26, 0
g_wt_3:
  global_load_dword v117, v116, s[12:13] offset:128 sc1
  s_add_u32 s26, s26, 1
  s_cmp_gt_u32 s26, 1048576
  s_cbranch_scc1 L_end
  s_waitcnt vmcnt(0)
  v_cmp_eq_u32 vcc, 0, v117
  v_readfirstlane_b32 s27, v117
  s_cbranch_vccnz g_wt_3
  s_and_b32 s28, s16, 28
  s_or_b32 s28, s28, 1
  s_lshl_b32 s27, s28, 6
  s_add_u32 s27, s27, 245104640
  s_mov_b32 s26, 0
g_h_4:
  buffer_load_dwordx2 v[116:117], off, s[4:7], s27 sc1
  s_add_u32 s26, s26, 1
  s_cmp_gt_u32 s26, 1048576
  s_cbranch_scc1 L_end
  s_waitcnt vmcnt(0)
  v_and_or_b32 v116, v117, -1, v116
  v_cmp_eq_u32 vcc, 0, v116
  s_cbranch_vccnz g_h_4
L_ha:
  s_load_dwordx2 s[8:9], s[0:1], 40
  s_load_dwordx2 s[52:53], s[0:1], 16
  s_load_dwordx2 s[32:33], s[0:1], 24
  s_load_dwordx2 s[48:49], s[0:1], 32
  s_mov_b32 s10, 4194304
  s_mov_b32 s11, 0x20000
  s_mov_b32 s54, 4194304
  s_mov_b32 s55, 0x20000
  s_mov_b32 s34, 4194304
  s_mov_b32 s35, 0x20000
  s_mov_b32 s50, 4194304
  s_mov_b32 s51, 0x20000
  v_and_b32 v20, 1, v17
  v_lshlrev_b32 v20, 5, v20
  v_lshrrev_b32 v21, 1, v17
  v_lshl_add_u32 v20, v21, 2, v20
  v_lshlrev_b32 v20, 10, v20
  v_lshl_add_u32 v20, v7, 4, v20
  s_lshl_b32 s26, s16, 17
  s_lshl_b32 s27, s17, 8
  s_add_u32 s26, s26, s27
  s_waitcnt lgkmcnt(0)
  s_add_u32 s27, s26, 0
  buffer_load_dwordx4 v[128:131], v20, s[8:11], s27 offen
  s_add_u32 s27, s26, 1024
  buffer_load_dwordx4 v[132:135], v20, s[8:11], s27 offen
  s_add_u32 s27, s26, 16384
  buffer_load_dwordx4 v[136:139], v20, s[8:11], s27 offen
  s_add_u32 s27, s26, 17408
  buffer_load_dwordx4 v[140:143], v20, s[8:11], s27 offen
  s_add_u32 s27, s26, 2048
  buffer_load_dwordx4 v[144:147], v20, s[8:11], s27 offen
  s_add_u32 s27, s26, 3072
  buffer_load_dwordx4 v[148:151], v20, s[8:11], s27 offen
  s_add_u32 s27, s26, 18432
  buffer_load_dwordx4 v[152:155], v20, s[8:11], s27 offen
  s_add_u32 s27, s26, 19456
  buffer_load_dwordx4 v[156:159], v20, s[8:11], s27 offen
  s_add_u32 s27, s26, 8192
  buffer_load_dwordx4 v[160:163], v20, s[8:11], s27 offen
  s_add_u32 s27, s26, 9216
  buffer_load_dwordx4 v[164:167], v20, s[8:11], s27 offen
  s_add_u32 s27, s26, 24576
  buffer_load_dwordx4 v[168:171], v20, s[8:11], s27 offen
  s_add_u32 s27, s26, 25600
  buffer_load_dwordx4 v[172:175], v20, s[8:11], s27 offen
  s_add_u32 s27, s26, 10240
  buffer_load_dwordx4 v[176:179], v20, s[8:11], s27 offen
  s_add_u32 s27, s26, 11264
  buffer_load_dwordx4 v[180:183], v20, s[8:11], s27 offen
  s_add_u32 s27, s26, 26624
  buffer_load_dwordx4 v[184:187], v20, s[8:11], s27 offen
  s_add_u32 s27, s26, 27648
  buffer_load_dwordx4 v[188:191], v20, s[8:11], s27 offen
  s_add_u32 s27, s26, 65536
  buffer_load_dwordx4 v[192:195], v20, s[8:11], s27 offen
  s_add_u32 s27, s26, 66560
  buffer_load_dwordx4 v[196:199], v20, s[8:11], s27 offen
  s_add_u32 s27, s26, 81920
  buffer_load_dwordx4 v[200:203], v20, s[8:11], s27 offen
  s_add_u32 s27, s26, 82944
  buffer_load_dwordx4 v[204:207], v20, s[8:11], s27 offen
  s_add_u32 s27, s26, 67584
  buffer_load_dwordx4 v[208:211], v20, s[8:11], s27 offen
  s_add_u32 s27, s26, 68608
  buffer_load_dwordx4 v[212:215], v20, s[8:11], s27 offen
  s_add_u32 s27, s26, 83968
  buffer_load_dwordx4 v[216:219], v20, s[8:11], s27 offen
  s_add_u32 s27, s26, 84992
  buffer_load_dwordx4 v[220:223], v20, s[8:11], s27 offen
  s_add_u32 s27, s26, 73728
  buffer_load_dwordx4 v[224:227], v20, s[8:11], s27 offen
  s_add_u32 s27, s26, 74752
  buffer_load_dwordx4 v[228:231], v20, s[8:11], s27 offen
  s_add_u32 s27, s26, 90112
  buffer_load_dwordx4 v[232:235], v20, s[8:11], s27 offen
  s_add_u32 s27, s26, 91136
  buffer_load_dwordx4 v[236:239], v20, s[8:11], s27 offen
  s_add_u32 s27, s26, 75776
  buffer_load_dwordx4 v[240:243], v20, s[8:11], s27 offen
  s_add_u32 s27, s26, 76800
  buffer_load_dwordx4 v[244:247], v20, s[8:11], s27 offen
  s_add_u32 s27, s26, 92160
  buffer_load_dwordx4 v[248:251], v20, s[8:11], s27 offen
  s_add_u32 s27, s26, 93184
  buffer_load_dwordx4 v[252:255], v20, s[8:11], s27 offen
  v_lshrrev_b32 v20, 8, v0
  v_and_b32 v22, 0xf0, v0
  v_lshlrev_b32 v23, 6, v20
  v_xor_b32 v22, v22, v23
  v_lshl_add_u32 v22, v20, 13, v22
  v_xor_b32 v23, 32, v22
  s_lshr_b32 s26, s17, 1
  s_lshl_b32 s26, s26, 20
  s_and_b32 s27, s17, 1
  s_lshl_b32 s27, s27, 18
  s_add_u32 s26, s26, s27
  s_lshl_b32 s27, s16, 8
  s_add_u32 s26, s26, s27
  s_lshl_b32 s28, s17, 13
  s_add_u32 s27, s26, 0
  s_add_u32 m0, s28, 65536
  s_nop 0
  buffer_load_dwordx4 v22, s[32:35], s27 offen lds
  s_add_u32 m0, s28, 66560
  s_add_u32 s27, s27, 32768
  buffer_load_dwordx4 v22, s[32:35], s27 offen lds
  s_add_u32 m0, s28, 67584
  s_add_u32 s27, s27, 32768
  buffer_load_dwordx4 v23, s[32:35], s27 offen lds
  s_add_u32 m0, s28, 68608
  s_add_u32 s27, s27, 32768
  buffer_load_dwordx4 v23, s[32:35], s27 offen lds
  s_add_u32 m0, s28, 69632
  s_add_u32 s27, s27, 32768
  buffer_load_dwordx4 v22, s[32:35], s27 offen lds
  s_add_u32 m0, s28, 70656
  s_add_u32 s27, s27, 32768
  buffer_load_dwordx4 v22, s[32:35], s27 offen lds
  s_add_u32 m0, s28, 71680
  s_add_u32 s27, s27, 32768
  buffer_load_dwordx4 v23, s[32:35], s27 offen lds
  s_add_u32 m0, s28, 72704
  s_add_u32 s27, s27, 32768
  buffer_load_dwordx4 v23, s[32:35], s27 offen lds
  s_add_u32 s27, s26, 524288
  s_add_u32 m0, s28, 98304
  s_nop 0
  buffer_load_dwordx4 v22, s[32:35], s27 offen lds
  s_add_u32 m0, s28, 99328
  s_add_u32 s27, s27, 32768
  buffer_load_dwordx4 v22, s[32:35], s27 offen lds
  s_add_u32 m0, s28, 100352
  s_add_u32 s27, s27, 32768
  buffer_load_dwordx4 v23, s[32:35], s27 offen lds
  s_add_u32 m0, s28, 101376
  s_add_u32 s27, s27, 32768
  buffer_load_dwordx4 v23, s[32:35], s27 offen lds
  s_add_u32 m0, s28, 102400
  s_add_u32 s27, s27, 32768
  buffer_load_dwordx4 v22, s[32:35], s27 offen lds
  s_add_u32 m0, s28, 103424
  s_add_u32 s27, s27, 32768
  buffer_load_dwordx4 v22, s[32:35], s27 offen lds
  s_add_u32 m0, s28, 104448
  s_add_u32 s27, s27, 32768
  buffer_load_dwordx4 v23, s[32:35], s27 offen lds
  s_add_u32 m0, s28, 105472
  s_add_u32 s27, s27, 32768
  buffer_load_dwordx4 v23, s[32:35], s27 offen lds
  s_waitcnt vmcnt(48)
  v_lshl_or_b32 v28, v29, 16, v28
  v_lshl_or_b32 v29, v31, 16, v30
  v_min_u32 v28, -2, v28
  v_min_u32 v29, -2, v29
  buffer_store_dwordx2 v[28:29], v5, s[4:7], s62 offen sc1
  s_add_u32 s27, s26, 2097152
  s_add_u32 m0, s28, 131072
  s_nop 0
  buffer_load_dwordx4 v22, s[32:35], s27 offen lds
  s_add_u32 m0, s28, 132096
  s_add_u32 s27, s27, 32768
  buffer_load_dwordx4 v22, s[32:35], s27 offen lds
  s_add_u32 m0, s28, 133120
  s_add_u32 s27, s27, 32768
  buffer_load_dwordx4 v23, s[32:35], s27 offen lds
  s_add_u32 m0, s28, 134144
  s_add_u32 s27, s27, 32768
  buffer_load_dwordx4 v23, s[32:35], s27 offen lds
  s_add_u32 m0, s28, 135168
  s_add_u32 s27, s27, 32768
  buffer_load_dwordx4 v22, s[32:35], s27 offen lds
  s_add_u32 m0, s28, 136192
  s_add_u32 s27, s27, 32768
  buffer_load_dwordx4 v22, s[32:35], s27 offen lds
  s_add_u32 m0, s28, 137216
  s_add_u32 s27, s27, 32768
  buffer_load_dwordx4 v23, s[32:35], s27 offen lds
  s_add_u32 m0, s28, 138240
  s_add_u32 s27, s27, 32768
  buffer_load_dwordx4 v23, s[32:35], s27 offen lds
  v_bfe_u32 v20, v7, 2, 1
  v_lshrrev_b32 v21, 3, v7
  v_and_b32 v104, 1, v17
  v_lshl_add_u32 v21, v21, 1, v104
  v_lshl_add_u32 v104, v20, 3, v21
  v_lshrrev_b32 v105, 1, v17
  v_lshl_add_u32 v104, v105, 5, v104
  v_lshl_add_u32 v20, v21, 1, v20
  s_lshl_b32 s29, s17, 1
  v_xor_b32 v20, s29, v20
  v_lshlrev_b32 v20, 5, v20
  v_lshl_add_u32 v20, v104, 8, v20
  v_and_b32 v21, 3, v7
  v_lshl_add_u32 v20, v21, 3, v20
  s_lshr_b32 s29, s17, 1
  s_lshl_b32 s29, s29, 14
  s_and_b32 s30, s17, 1
  s_lshl_b32 s30, s30, 10
  s_add_u32 s29, s29, s30
  s_add_u32 s29, s29, 65536
  v_add_u32 v20, s29, v20
  v_xor_b32 v104, 0, v20
  v_xor_b32 v105, 32, v20
  v_xor_b32 v106, 1024, v20
  v_xor_b32 v107, 1056, v20
  v_xor_b32 v108, 16384, v20
  v_xor_b32 v109, 16416, v20
  v_xor_b32 v110, 17408, v20
  v_xor_b32 v111, 17440, v20
  s_waitcnt vmcnt(49)
  v_perm_b32 v120, v132, v128, s44
  v_perm_b32 v121, v140, v136, s44
  v_perm_b32 v122, v148, v144, s44
  v_perm_b32 v123, v156, v152, s44
  v_accvgpr_write_b32 a248, v120
  v_accvgpr_write_b32 a249, v121
  v_accvgpr_write_b32 a250, v122
  v_accvgpr_write_b32 a251, v123
  v_perm_b32 v124, v132, v128, s45
  v_perm_b32 v125, v140, v136, s45
  v_perm_b32 v126, v148, v144, s45
  v_perm_b32 v127, v156, v152, s45
  v_accvgpr_write_b32 a232, v124
  v_accvgpr_write_b32 a233, v125
  v_accvgpr_write_b32 a234, v126
  v_accvgpr_write_b32 a235, v127
  v_perm_b32 v120, v133, v129, s44
  v_perm_b32 v121, v141, v137, s44
  v_perm_b32 v122, v149, v145, s44
  v_perm_b32 v123, v157, v153, s44
  v_accvgpr_write_b32 a216, v120
  v_accvgpr_write_b32 a217, v121
  v_accvgpr_write_b32 a218, v122
  v_accvgpr_write_b32 a219, v123
  v_perm_b32 v124, v133, v129, s45
  v_perm_b32 v125, v141, v137, s45
  v_perm_b32 v126, v149, v145, s45
  v_perm_b32 v127, v157, v153, s45
  v_accvgpr_write_b32 a200, v124
  v_accvgpr_write_b32 a201, v125
  v_accvgpr_write_b32 a202, v126
  v_accvgpr_write_b32 a203, v127
  v_perm_b32 v120, v134, v130, s44
  v_perm_b32 v121, v142, v138, s44
  v_perm_b32 v122, v150, v146, s44
  v_perm_b32 v123, v158, v154, s44
  v_accvgpr_write_b32 a184, v120
  v_accvgpr_write_b32 a185, v121
  v_accvgpr_write_b32 a186, v122
  v_accvgpr_write_b32 a187, v123
  v_perm_b32 v24, v134, v130, s45
  v_perm_b32 v25, v142, v138, s45
  v_perm_b32 v26, v150, v146, s45
  v_perm_b32 v27, v158, v154, s45
  v_perm_b32 v40, v135, v131, s44
  v_perm_b32 v41, v143, v139, s44
  v_perm_b32 v42, v151, v147, s44
  v_perm_b32 v43, v159, v155, s44
  v_perm_b32 v56, v135, v131, s45
  v_perm_b32 v57, v143, v139, s45
  v_perm_b32 v58, v151, v147, s45
  v_perm_b32 v59, v159, v155, s45
  s_waitcnt vmcnt(41)
  v_perm_b32 v120, v164, v160, s44
  v_perm_b32 v121, v172, v168, s44
  v_perm_b32 v122, v180, v176, s44
  v_perm_b32 v123, v188, v184, s44
  v_accvgpr_write_b32 a252, v120
  v_accvgpr_write_b32 a253, v121
  v_accvgpr_write_b32 a254, v122
  v_accvgpr_write_b32 a255, v123
  v_perm_b32 v124, v164, v160, s45
  v_perm_b32 v125, v172, v168, s45
  v_perm_b32 v126, v180, v176, s45
  v_perm_b32 v127, v188, v184, s45
  v_accvgpr_write_b32 a236, v124
  v_accvgpr_write_b32 a237, v125
  v_accvgpr_write_b32 a238, v126
  v_accvgpr_write_b32 a239, v127
  v_perm_b32 v120, v165, v161, s44
  v_perm_b32 v121, v173, v169, s44
  v_perm_b32 v122, v181, v177, s44
  v_perm_b32 v123, v189, v185, s44
  v_accvgpr_write_b32 a220, v120
  v_accvgpr_write_b32 a221, v121
  v_accvgpr_write_b32 a222, v122
  v_accvgpr_write_b32 a223, v123
  v_perm_b32 v124, v165, v161, s45
  v_perm_b32 v125, v173, v169, s45
  v_perm_b32 v126, v181, v177, s45
  v_perm_b32 v127, v189, v185, s45
  v_accvgpr_write_b32 a204, v124
  v_accvgpr_write_b32 a205, v125
  v_accvgpr_write_b32 a206, v126
  v_accvgpr_write_b32 a207, v127
  v_perm_b32 v120, v166, v162, s44
  v_perm_b32 v121, v174, v170, s44
  v_perm_b32 v122, v182, v178, s44
  v_perm_b32 v123, v190, v186, s44
  v_accvgpr_write_b32 a188, v120
  v_accvgpr_write_b32 a189, v121
  v_accvgpr_write_b32 a190, v122
  v_accvgpr_write_b32 a191, v123
  v_perm_b32 v28, v166, v162, s45
  v_perm_b32 v29, v174, v170, s45
  v_perm_b32 v30, v182, v178, s45
  v_perm_b32 v31, v190, v186, s45
  v_perm_b32 v44, v167, v163, s44
  v_perm_b32 v45, v175, v171, s44
  v_perm_b32 v46, v183, v179, s44
  v_perm_b32 v47, v191, v187, s44
  v_perm_b32 v60, v167, v163, s45
  v_perm_b32 v61, v175, v171, s45
  v_perm_b32 v62, v183, v179, s45
  v_perm_b32 v63, v191, v187, s45
  s_waitcnt vmcnt(33)
  v_perm_b32 v120, v196, v192, s44
  v_perm_b32 v121, v204, v200, s44
  v_perm_b32 v122, v212, v208, s44
  v_perm_b32 v123, v220, v216, s44
  v_accvgpr_write_b32 a240, v120
  v_accvgpr_write_b32 a241, v121
  v_accvgpr_write_b32 a242, v122
  v_accvgpr_write_b32 a243, v123
  v_perm_b32 v124, v196, v192, s45
  v_perm_b32 v125, v204, v200, s45
  v_perm_b32 v126, v212, v208, s45
  v_perm_b32 v127, v220, v216, s45
  v_accvgpr_write_b32 a224, v124
  v_accvgpr_write_b32 a225, v125
  v_accvgpr_write_b32 a226, v126
  v_accvgpr_write_b32 a227, v127
  v_perm_b32 v120, v197, v193, s44
  v_perm_b32 v121, v205, v201, s44
  v_perm_b32 v122, v213, v209, s44
  v_perm_b32 v123, v221, v217, s44
  v_accvgpr_write_b32 a208, v120
  v_accvgpr_write_b32 a209, v121
  v_accvgpr_write_b32 a210, v122
  v_accvgpr_write_b32 a211, v123
  v_perm_b32 v124, v197, v193, s45
  v_perm_b32 v125, v205, v201, s45
  v_perm_b32 v126, v213, v209, s45
  v_perm_b32 v127, v221, v217, s45
  v_accvgpr_write_b32 a192, v124
  v_accvgpr_write_b32 a193, v125
  v_accvgpr_write_b32 a194, v126
  v_accvgpr_write_b32 a195, v127
  v_perm_b32 v120, v198, v194, s44
  v_perm_b32 v121, v206, v202, s44
  v_perm_b32 v122, v214, v210, s44
  v_perm_b32 v123, v222, v218, s44
  v_accvgpr_write_b32 a176, v120
  v_accvgpr_write_b32 a177, v121
  v_accvgpr_write_b32 a178, v122
  v_accvgpr_write_b32 a179, v123
  v_perm_b32 v32, v198, v194, s45
  v_perm_b32 v33, v206, v202, s45
  v_perm_b32 v34, v214, v210, s45
  v_perm_b32 v35, v222, v218, s45
  v_perm_b32 v48, v199, v195, s44
  v_perm_b32 v49, v207, v203, s44
  v_perm_b32 v50, v215, v211, s44
  v_perm_b32 v51, v223, v219, s44
  v_perm_b32 v64, v199, v195, s45
  v_perm_b32 v65, v207, v203, s45
  v_perm_b32 v66, v215, v211, s45
  v_perm_b32 v67, v223, v219, s45
  s_waitcnt vmcnt(25)
  v_perm_b32 v120, v228, v224, s44
  v_perm_b32 v121, v236, v232, s44
  v_perm_b32 v122, v244, v240, s44
  v_perm_b32 v123, v252, v248, s44
  v_accvgpr_write_b32 a244, v120
  v_accvgpr_write_b32 a245, v121
  v_accvgpr_write_b32 a246, v122
  v_accvgpr_write_b32 a247, v123
  v_perm_b32 v124, v228, v224, s45
  v_perm_b32 v125, v236, v232, s45
  v_perm_b32 v126, v244, v240, s45
  v_perm_b32 v127, v252, v248, s45
  v_accvgpr_write_b32 a228, v124
  v_accvgpr_write_b32 a229, v125
  v_accvgpr_write_b32 a230, v126
  v_accvgpr_write_b32 a231, v127
  v_perm_b32 v120, v229, v225, s44
  v_perm_b32 v121, v237, v233, s44
  v_perm_b32 v122, v245, v241, s44
  v_perm_b32 v123, v253, v249, s44
  v_accvgpr_write_b32 a212, v120
  v_accvgpr_write_b32 a213, v121
  v_accvgpr_write_b32 a214, v122
  v_accvgpr_write_b32 a215, v123
  v_perm_b32 v124, v229, v225, s45
  v_perm_b32 v125, v237, v233, s45
  v_perm_b32 v126, v245, v241, s45
  v_perm_b32 v127, v253, v249, s45
  v_accvgpr_write_b32 a196, v124
  v_accvgpr_write_b32 a197, v125
  v_accvgpr_write_b32 a198, v126
  v_accvgpr_write_b32 a199, v127
  v_perm_b32 v120, v230, v226, s44
  v_perm_b32 v121, v238, v234, s44
  v_perm_b32 v122, v246, v242, s44
  v_perm_b32 v123, v254, v250, s44
  v_accvgpr_write_b32 a180, v120
  v_accvgpr_write_b32 a181, v121
  v_accvgpr_write_b32 a182, v122
  v_accvgpr_write_b32 a183, v123
  v_perm_b32 v36, v230, v226, s45
  v_perm_b32 v37, v238, v234, s45
  v_perm_b32 v38, v246, v242, s45
  v_perm_b32 v39, v254, v250, s45
  v_perm_b32 v52, v231, v227, s44
  v_perm_b32 v53, v239, v235, s44
  v_perm_b32 v54, v247, v243, s44
  v_perm_b32 v55, v255, v251, s44
  v_perm_b32 v68, v231, v227, s45
  v_perm_b32 v69, v239, v235, s45
  v_perm_b32 v70, v247, v243, s45
  v_perm_b32 v71, v255, v251, s45
  v_mov_b64 v[128:129], v[24:25]
  v_mov_b64 v[130:131], v[26:27]
  v_mov_b64 v[132:133], v[28:29]
  v_mov_b64 v[134:135], v[30:31]
  v_mov_b64 v[136:137], v[32:33]
  v_mov_b64 v[138:139], v[34:35]
  v_mov_b64 v[140:141], v[36:37]
  v_mov_b64 v[142:143], v[38:39]
  v_mov_b64 v[144:145], v[40:41]
  v_mov_b64 v[146:147], v[42:43]
  v_mov_b64 v[148:149], v[44:45]
  v_mov_b64 v[150:151], v[46:47]
  v_mov_b64 v[152:153], v[48:49]
  v_mov_b64 v[154:155], v[50:51]
  v_mov_b64 v[156:157], v[52:53]
  v_mov_b64 v[158:159], v[54:55]
  v_mov_b64 v[184:185], v[56:57]
  v_mov_b64 v[186:187], v[58:59]
  v_mov_b64 v[188:189], v[60:61]
  v_mov_b64 v[190:191], v[62:63]
  v_mov_b64 v[192:193], v[64:65]
  v_mov_b64 v[194:195], v[66:67]
  v_mov_b64 v[196:197], v[68:69]
  v_mov_b64 v[198:199], v[70:71]
  s_waitcnt vmcnt(17)
  s_barrier
  s_add_u32 s27, s26, 2621440
  s_add_u32 m0, s28, 0
  s_nop 0
  buffer_load_dwordx4 v22, s[32:35], s27 offen lds
  s_add_u32 m0, s28, 1024
  s_add_u32 s27, s27, 32768
  buffer_load_dwordx4 v22, s[32:35], s27 offen lds
  s_add_u32 m0, s28, 2048
  s_add_u32 s27, s27, 32768
  buffer_load_dwordx4 v23, s[32:35], s27 offen lds
  s_add_u32 m0, s28, 3072
  s_add_u32 s27, s27, 32768
  buffer_load_dwordx4 v23, s[32:35], s27 offen lds
  s_add_u32 m0, s28, 4096
  s_add_u32 s27, s27, 32768
  buffer_load_dwordx4 v22, s[32:35], s27 offen lds
  s_add_u32 m0, s28, 5120
  s_add_u32 s27, s27, 32768
  buffer_load_dwordx4 v22, s[32:35], s27 offen lds
  s_add_u32 m0, s28, 6144
  s_add_u32 s27, s27, 32768
  buffer_load_dwordx4 v23, s[32:35], s27 offen lds
  s_add_u32 m0, s28, 7168
  s_add_u32 s27, s27, 32768
  buffer_load_dwordx4 v23, s[32:35], s27 offen lds
  s_cmp_lg_u32 s91, 0
  s_cbranch_scc1 g_o0_5
  s_cmp_lg_u32 s17, 0
  s_cbranch_scc1 g_ar_6
  s_lshl_b32 s36, s89, 3
  s_lshl_b64 s[36:37], 1, s36
  v_lshlrev_b32 v124, 3, 0
  v_mov_b32 v120, s36
  v_mov_b32 v121, s37
  s_mov_b64 exec, 1
  global_atomic_add_x2 v[122:123], v124, v[120:121], s[12:13] sc0
  s_mov_b64 exec, -1
g_ar_6:
g_o0_5:
  ds_read_b64_tr_b16 v[40:41], v104 offset:0
  ds_read_b64_tr_b16 v[42:43], v104 offset:4096
  ds_read_b64_tr_b16 v[48:49], v105 offset:0
  ds_read_b64_tr_b16 v[50:51], v105 offset:4096
  ds_read_b64_tr_b16 a[72:73], v106 offset:0
  ds_read_b64_tr_b16 a[74:75], v106 offset:4096
  ds_read_b64_tr_b16 a[24:25], v107 offset:0
  ds_read_b64_tr_b16 a[26:27], v107 offset:4096
  ds_read_b64_tr_b16 a[64:65], v108 offset:0
  ds_read_b64_tr_b16 a[66:67], v108 offset:4096
  ds_read_b64_tr_b16 a[16:17], v109 offset:0
  ds_read_b64_tr_b16 a[18:19], v109 offset:4096
  ds_read_b64_tr_b16 a[56:57], v110 offset:0
  ds_read_b64_tr_b16 a[58:59], v110 offset:4096
  ds_read_b64_tr_b16 a[8:9], v111 offset:0
  ds_read_b64_tr_b16 a[10:11], v111 offset:4096
  s_waitcnt lgkmcnt(0)
  s_waitcnt vmcnt(17)
  s_barrier
  s_add_u32 s27, s26, 0
  s_add_u32 m0, s28, 32768
  s_nop 0
  buffer_load_dwordx4 v22, s[52:55], s27 offen lds
  s_add_u32 m0, s28, 33792
  s_add_u32 s27, s27, 32768
  buffer_load_dwordx4 v22, s[52:55], s27 offen lds
  s_add_u32 m0, s28, 34816
  s_add_u32 s27, s27, 32768
  buffer_load_dwordx4 v23, s[52:55], s27 offen lds
  s_add_u32 m0, s28, 35840
  s_add_u32 s27, s27, 32768
  buffer_load_dwordx4 v23, s[52:55], s27 offen lds
  s_add_u32 m0, s28, 36864
  s_add_u32 s27, s27, 32768
  buffer_load_dwordx4 v22, s[52:55], s27 offen lds
  s_add_u32 m0, s28, 37888
  s_add_u32 s27, s27, 32768
  buffer_load_dwordx4 v22, s[52:55], s27 offen lds
  s_add_u32 m0, s28, 38912
  s_add_u32 s27, s27, 32768
  buffer_load_dwordx4 v23, s[52:55], s27 offen lds
  s_add_u32 m0, s28, 39936
  s_add_u32 s27, s27, 32768
  buffer_load_dwordx4 v23, s[52:55], s27 offen lds
  ds_read_b64_tr_b16 v[44:45], v104 offset:32768
  ds_read_b64_tr_b16 v[46:47], v104 offset:36864
  ds_read_b64_tr_b16 v[52:53], v105 offset:32768
  ds_read_b64_tr_b16 v[54:55], v105 offset:36864
  ds_read_b64_tr_b16 a[76:77], v106 offset:32768
  ds_read_b64_tr_b16 a[78:79], v106 offset:36864
  ds_read_b64_tr_b16 a[28:29], v107 offset:32768
  ds_read_b64_tr_b16 a[30:31], v107 offset:36864
  ds_read_b64_tr_b16 a[68:69], v108 offset:32768
  ds_read_b64_tr_b16 a[70:71], v108 offset:36864
  ds_read_b64_tr_b16 a[20:21], v109 offset:32768
  ds_read_b64_tr_b16 a[22:23], v109 offset:36864
  ds_read_b64_tr_b16 a[60:61], v110 offset:32768
  ds_read_b64_tr_b16 a[62:63], v110 offset:36864
  ds_read_b64_tr_b16 a[12:13], v111 offset:32768
  ds_read_b64_tr_b16 a[14:15], v111 offset:36864
  s_waitcnt lgkmcnt(0)
  v_add_u32 v104, 65536, v104
  v_add_u32 v105, 65536, v105
  v_add_u32 v106, 65536, v106
  v_add_u32 v107, 65536, v107
  v_add_u32 v108, 65536, v108
  v_add_u32 v109, 65536, v109
  v_add_u32 v110, 65536, v110
  v_add_u32 v111, 65536, v111
  s_waitcnt vmcnt(16)
  s_barrier
  s_add_u32 s27, s26, 524288
  s_add_u32 m0, s28, 65536
  s_nop 0
  buffer_load_dwordx4 v22, s[52:55], s27 offen lds
  s_add_u32 m0, s28, 66560
  s_add_u32 s27, s27, 32768
  buffer_load_dwordx4 v22, s[52:55], s27 offen lds
  s_add_u32 m0, s28, 67584
  s_add_u32 s27, s27, 32768
  buffer_load_dwordx4 v23, s[52:55], s27 offen lds
  s_add_u32 m0, s28, 68608
  s_add_u32 s27, s27, 32768
  buffer_load_dwordx4 v23, s[52:55], s27 offen lds
  s_add_u32 m0, s28, 69632
  s_add_u32 s27, s27, 32768
  buffer_load_dwordx4 v22, s[52:55], s27 offen lds
  s_add_u32 m0, s28, 70656
  s_add_u32 s27, s27, 32768
  buffer_load_dwordx4 v22, s[52:55], s27 offen lds
  s_add_u32 m0, s28, 71680
  s_add_u32 s27, s27, 32768
  buffer_load_dwordx4 v23, s[52:55], s27 offen lds
  s_add_u32 m0, s28, 72704
  s_add_u32 s27, s27, 32768
  buffer_load_dwordx4 v23, s[52:55], s27 offen lds
  ds_read_b64_tr_b16 v[72:73], v104 offset:0
  ds_read_b64_tr_b16 v[74:75], v104 offset:4096
  ds_read_b64_tr_b16 v[80:81], v105 offset:0
  ds_read_b64_tr_b16 v[82:83], v105 offset:4096
  ds_read_b64_tr_b16 a[48:49], v106 offset:0
  ds_read_b64_tr_b16 a[50:51], v106 offset:4096
  ds_read_b64_tr_b16 a[0:1], v107 offset:0
  ds_read_b64_tr_b16 a[2:3], v107 offset:4096
  ds_read_b64_tr_b16 a[40:41], v108 offset:0
  ds_read_b64_tr_b16 a[42:43], v108 offset:4096
  ds_read_b64_tr_b16 v[248:249], v109 offset:0
  ds_read_b64_tr_b16 v[250:251], v109 offset:4096
  ds_read_b64_tr_b16 a[32:33], v110 offset:0
  ds_read_b64_tr_b16 a[34:35], v110 offset:4096
  ds_read_b64_tr_b16 v[240:241], v111 offset:0
  ds_read_b64_tr_b16 v[242:243], v111 offset:4096
  s_waitcnt lgkmcnt(0)
  v_add_u32 v104, -131072, v104
  v_add_u32 v105, -131072, v105
  v_add_u32 v106, -131072, v106
  v_add_u32 v107, -131072, v107
  v_add_u32 v108, -131072, v108
  v_add_u32 v109, -131072, v109
  v_add_u32 v110, -131072, v110
  v_add_u32 v111, -131072, v111
  s_waitcnt vmcnt(16)
  s_barrier
  s_add_u32 s27, s26, 2097152
  s_add_u32 m0, s28, 98304
  s_nop 0
  buffer_load_dwordx4 v22, s[52:55], s27 offen lds
  s_add_u32 m0, s28, 99328
  s_add_u32 s27, s27, 32768
  buffer_load_dwordx4 v22, s[52:55], s27 offen lds
  s_add_u32 m0, s28, 100352
  s_add_u32 s27, s27, 32768
  buffer_load_dwordx4 v23, s[52:55], s27 offen lds
  s_add_u32 m0, s28, 101376
  s_add_u32 s27, s27, 32768
  buffer_load_dwordx4 v23, s[52:55], s27 offen lds
  s_add_u32 m0, s28, 102400
  s_add_u32 s27, s27, 32768
  buffer_load_dwordx4 v22, s[52:55], s27 offen lds
  s_add_u32 m0, s28, 103424
  s_add_u32 s27, s27, 32768
  buffer_load_dwordx4 v22, s[52:55], s27 offen lds
  s_add_u32 m0, s28, 104448
  s_add_u32 s27, s27, 32768
  buffer_load_dwordx4 v23, s[52:55], s27 offen lds
  s_add_u32 m0, s28, 105472
  s_add_u32 s27, s27, 32768
  buffer_load_dwordx4 v23, s[52:55], s27 offen lds
  ds_read_b64_tr_b16 v[76:77], v104 offset:0
  ds_read_b64_tr_b16 v[78:79], v104 offset:4096
  ds_read_b64_tr_b16 v[84:85], v105 offset:0
  ds_read_b64_tr_b16 v[86:87], v105 offset:4096
  ds_read_b64_tr_b16 a[52:53], v106 offset:0
  ds_read_b64_tr_b16 a[54:55], v106 offset:4096
  ds_read_b64_tr_b16 a[4:5], v107 offset:0
  ds_read_b64_tr_b16 a[6:7], v107 offset:4096
  ds_read_b64_tr_b16 a[44:45], v108 offset:0
  ds_read_b64_tr_b16 a[46:47], v108 offset:4096
  ds_read_b64_tr_b16 v[252:253], v109 offset:0
  ds_read_b64_tr_b16 v[254:255], v109 offset:4096
  ds_read_b64_tr_b16 a[36:37], v110 offset:0
  ds_read_b64_tr_b16 a[38:39], v110 offset:4096
  ds_read_b64_tr_b16 v[244:245], v111 offset:0
  ds_read_b64_tr_b16 v[246:247], v111 offset:4096
  s_waitcnt lgkmcnt(0)
  s_waitcnt vmcnt(16)
  s_barrier
  s_add_u32 s27, s26, 2621440
  s_add_u32 m0, s28, 131072
  s_nop 0
  buffer_load_dwordx4 v22, s[52:55], s27 offen lds
  s_add_u32 m0, s28, 132096
  s_add_u32 s27, s27, 32768
  buffer_load_dwordx4 v22, s[52:55], s27 offen lds
  s_add_u32 m0, s28, 133120
  s_add_u32 s27, s27, 32768
  buffer_load_dwordx4 v23, s[52:55], s27 offen lds
  s_add_u32 m0, s28, 134144
  s_add_u32 s27, s27, 32768
  buffer_load_dwordx4 v23, s[52:55], s27 offen lds
  s_add_u32 m0, s28, 135168
  s_add_u32 s27, s27, 32768
  buffer_load_dwordx4 v22, s[52:55], s27 offen lds
  s_add_u32 m0, s28, 136192
  s_add_u32 s27, s27, 32768
  buffer_load_dwordx4 v22, s[52:55], s27 offen lds
  s_add_u32 m0, s28, 137216
  s_add_u32 s27, s27, 32768
  buffer_load_dwordx4 v23, s[52:55], s27 offen lds
  s_add_u32 m0, s28, 138240
  s_add_u32 s27, s27, 32768
  buffer_load_dwordx4 v23, s[52:55], s27 offen lds
  s_cmp_lg_u32 s91, 0
  s_cbranch_scc1 g_o0_7
  s_cmp_lg_u32 s17, 0
  s_cbranch_scc1 g_af_8
  v_readfirstlane_b32 s36, v122
  v_readfirstlane_b32 s37, v123
  s_add_u32 s38, s36, s37
  s_mul_i32 s38, s38, 0x01010101
  s_lshr_b32 s38, s38, 24
  s_cmp_lg_u32 s38, 31
  s_cbranch_scc1 g_af_8
  s_lshl_b32 s38, s89, 3
  s_lshr_b64 s[36:37], s[36:37], s38
  s_and_b32 s36, s36, 0xff
  s_cmp_eq_u32 s36, 31
  s_cselect_b32 s36, 1, 2
  v_mov_b32 v120, s36
  v_lshrrev_b32 v124, 1, v124
  s_mov_b64 exec, 1
  global_store_dword v124, v120, s[12:13] offset:128 sc1
  s_mov_b64 exec, -1
g_af_8:
g_o0_7:
  ds_read_b64_tr_b16 v[24:25], v104 offset:32768
  ds_read_b64_tr_b16 v[26:27], v104 offset:36864
  ds_read_b64_tr_b16 v[32:33], v105 offset:32768
  ds_read_b64_tr_b16 v[34:35], v105 offset:36864
  ds_read_b64_tr_b16 a[168:169], v106 offset:32768
  ds_read_b64_tr_b16 a[170:171], v106 offset:36864
  ds_read_b64_tr_b16 a[120:121], v107 offset:32768
  ds_read_b64_tr_b16 a[122:123], v107 offset:36864
  ds_read_b64_tr_b16 a[160:161], v108 offset:32768
  ds_read_b64_tr_b16 a[162:163], v108 offset:36864
  ds_read_b64_tr_b16 a[112:113], v109 offset:32768
  ds_read_b64_tr_b16 a[114:115], v109 offset:36864
  ds_read_b64_tr_b16 a[152:153], v110 offset:32768
  ds_read_b64_tr_b16 a[154:155], v110 offset:36864
  ds_read_b64_tr_b16 a[104:105], v111 offset:32768
  ds_read_b64_tr_b16 a[106:107], v111 offset:36864
  s_waitcnt lgkmcnt(0)
  v_add_u32 v104, 65536, v104
  v_add_u32 v105, 65536, v105
  v_add_u32 v106, 65536, v106
  v_add_u32 v107, 65536, v107
  v_add_u32 v108, 65536, v108
  v_add_u32 v109, 65536, v109
  v_add_u32 v110, 65536, v110
  v_add_u32 v111, 65536, v111
  s_waitcnt vmcnt(16)
  s_barrier
  s_add_u32 s27, s26, 0
  s_add_u32 m0, s28, 0
  s_nop 0
  buffer_load_dwordx4 v22, s[48:51], s27 offen lds
  s_add_u32 m0, s28, 1024
  s_add_u32 s27, s27, 32768
  buffer_load_dwordx4 v22, s[48:51], s27 offen lds
  s_add_u32 m0, s28, 2048
  s_add_u32 s27, s27, 32768
  buffer_load_dwordx4 v23, s[48:51], s27 offen lds
  s_add_u32 m0, s28, 3072
  s_add_u32 s27, s27, 32768
  buffer_load_dwordx4 v23, s[48:51], s27 offen lds
  s_add_u32 m0, s28, 4096
  s_add_u32 s27, s27, 32768
  buffer_load_dwordx4 v22, s[48:51], s27 offen lds
  s_add_u32 m0, s28, 5120
  s_add_u32 s27, s27, 32768
  buffer_load_dwordx4 v22, s[48:51], s27 offen lds
  s_add_u32 m0, s28, 6144
  s_add_u32 s27, s27, 32768
  buffer_load_dwordx4 v23, s[48:51], s27 offen lds
  s_add_u32 m0, s28, 7168
  s_add_u32 s27, s27, 32768
  buffer_load_dwordx4 v23, s[48:51], s27 offen lds
  ds_read_b64_tr_b16 v[28:29], v104 offset:0
  ds_read_b64_tr_b16 v[30:31], v104 offset:4096
  ds_read_b64_tr_b16 v[36:37], v105 offset:0
  ds_read_b64_tr_b16 v[38:39], v105 offset:4096
  ds_read_b64_tr_b16 a[172:173], v106 offset:0
  ds_read_b64_tr_b16 a[174:175], v106 offset:4096
  ds_read_b64_tr_b16 a[124:125], v107 offset:0
  ds_read_b64_tr_b16 a[126:127], v107 offset:4096
  ds_read_b64_tr_b16 a[164:165], v108 offset:0
  ds_read_b64_tr_b16 a[166:167], v108 offset:4096
  ds_read_b64_tr_b16 a[116:117], v109 offset:0
  ds_read_b64_tr_b16 a[118:119], v109 offset:4096
  ds_read_b64_tr_b16 a[156:157], v110 offset:0
  ds_read_b64_tr_b16 a[158:159], v110 offset:4096
  ds_read_b64_tr_b16 a[108:109], v111 offset:0
  ds_read_b64_tr_b16 a[110:111], v111 offset:4096
  s_waitcnt lgkmcnt(0)
  s_waitcnt vmcnt(16)
  s_barrier
  s_add_u32 s27, s26, 524288
  s_add_u32 m0, s28, 32768
  s_nop 0
  buffer_load_dwordx4 v22, s[48:51], s27 offen lds
  s_add_u32 m0, s28, 33792
  s_add_u32 s27, s27, 32768
  buffer_load_dwordx4 v22, s[48:51], s27 offen lds
  s_add_u32 m0, s28, 34816
  s_add_u32 s27, s27, 32768
  buffer_load_dwordx4 v23, s[48:51], s27 offen lds
  s_add_u32 m0, s28, 35840
  s_add_u32 s27, s27, 32768
  buffer_load_dwordx4 v23, s[48:51], s27 offen lds
  s_add_u32 m0, s28, 36864
  s_add_u32 s27, s27, 32768
  buffer_load_dwordx4 v22, s[48:51], s27 offen lds
  s_add_u32 m0, s28, 37888
  s_add_u32 s27, s27, 32768
  buffer_load_dwordx4 v22, s[48:51], s27 offen lds
  s_add_u32 m0, s28, 38912
  s_add_u32 s27, s27, 32768
  buffer_load_dwordx4 v23, s[48:51], s27 offen lds
  s_add_u32 m0, s28, 39936
  s_add_u32 s27, s27, 32768
  buffer_load_dwordx4 v23, s[48:51], s27 offen lds
  v_mbcnt_lo_u32_b32 v116, -1, 0
  v_and_b32 v116, 1, v116
  v_lshlrev_b32 v118, 2, v116
  global_load_dword v117, v118, s[12:13] offset:128 sc1
  ds_read_b64_tr_b16 v[56:57], v104 offset:32768
  ds_read_b64_tr_b16 v[58:59], v104 offset:36864
  ds_read_b64_tr_b16 v[64:65], v105 offset:32768
  ds_read_b64_tr_b16 v[66:67], v105 offset:36864
  ds_read_b64_tr_b16 a[144:145], v106 offset:32768
  ds_read_b64_tr_b16 a[146:147], v106 offset:36864
  ds_read_b64_tr_b16 a[96:97], v107 offset:32768
  ds_read_b64_tr_b16 a[98:99], v107 offset:36864
  ds_read_b64_tr_b16 a[136:137], v108 offset:32768
  ds_read_b64_tr_b16 a[138:139], v108 offset:36864
  ds_read_b64_tr_b16 a[88:89], v109 offset:32768
  ds_read_b64_tr_b16 a[90:91], v109 offset:36864
  ds_read_b64_tr_b16 a[128:129], v110 offset:32768
  ds_read_b64_tr_b16 a[130:131], v110 offset:36864
  ds_read_b64_tr_b16 a[80:81], v111 offset:32768
  ds_read_b64_tr_b16 a[82:83], v111 offset:36864
  s_waitcnt lgkmcnt(0)
  v_add_u32 v104, 65536, v104
  v_add_u32 v105, 65536, v105
  v_add_u32 v106, 65536, v106
  v_add_u32 v107, 65536, v107
  v_add_u32 v108, 65536, v108
  v_add_u32 v109, 65536, v109
  v_add_u32 v110, 65536, v110
  v_add_u32 v111, 65536, v111
  s_waitcnt vmcnt(16)
  s_barrier
  s_add_u32 s27, s26, 2097152
  s_add_u32 m0, s28, 65536
  s_nop 0
  buffer_load_dwordx4 v22, s[48:51], s27 offen lds
  s_add_u32 m0, s28, 66560
  s_add_u32 s27, s27, 32768
  buffer_load_dwordx4 v22, s[48:51], s27 offen lds
  s_add_u32 m0, s28, 67584
  s_add_u32 s27, s27, 32768
  buffer_load_dwordx4 v23, s[48:51], s27 offen lds
  s_add_u32 m0, s28, 68608
  s_add_u32 s27, s27, 32768
  buffer_load_dwordx4 v23, s[48:51], s27 offen lds
  s_add_u32 m0, s28, 69632
  s_add_u32 s27, s27, 32768
  buffer_load_dwordx4 v22, s[48:51], s27 offen lds
  s_add_u32 m0, s28, 70656
  s_add_u32 s27, s27, 32768
  buffer_load_dwordx4 v22, s[48:51], s27 offen lds
  s_add_u32 m0, s28, 71680
  s_add_u32 s27, s27, 32768
  buffer_load_dwordx4 v23, s[48:51], s27 offen lds
  s_add_u32 m0, s28, 72704
  s_add_u32 s27, s27, 32768
  buffer_load_dwordx4 v23, s[48:51], s27 offen lds
  ds_read_b64_tr_b16 v[60:61], v104 offset:0
  ds_read_b64_tr_b16 v[62:63], v104 offset:4096
  ds_read_b64_tr_b16 v[68:69], v105 offset:0
  ds_read_b64_tr_b16 v[70:71], v105 offset:4096
  ds_read_b64_tr_b16 a[148:149], v106 offset:0
  ds_read_b64_tr_b16 a[150:151], v106 offset:4096
  ds_read_b64_tr_b16 a[100:101], v107 offset:0
  ds_read_b64_tr_b16 a[102:103], v107 offset:4096
  ds_read_b64_tr_b16 a[140:141], v108 offset:0
  ds_read_b64_tr_b16 a[142:143], v108 offset:4096
  ds_read_b64_tr_b16 a[92:93], v109 offset:0
  ds_read_b64_tr_b16 a[94:95], v109 offset:4096
  ds_read_b64_tr_b16 a[132:133], v110 offset:0
  ds_read_b64_tr_b16 a[134:135], v110 offset:4096
  ds_read_b64_tr_b16 a[84:85], v111 offset:0
  ds_read_b64_tr_b16 a[86:87], v111 offset:4096
  s_waitcnt lgkmcnt(0)
  v_add_u32 v104, -131072, v104
  v_add_u32 v105, -131072, v105
  v_add_u32 v106, -131072, v106
  v_add_u32 v107, -131072, v107
  v_add_u32 v108, -131072, v108
  v_add_u32 v109, -131072, v109
  v_add_u32 v110, -131072, v110
  v_add_u32 v111, -131072, v111
  s_waitcnt vmcnt(16)
  s_barrier
  s_add_u32 s27, s26, 2621440
  s_add_u32 m0, s28, 98304
  s_nop 0
  buffer_load_dwordx4 v22, s[48:51], s27 offen lds
  s_add_u32 m0, s28, 99328
  s_add_u32 s27, s27, 32768
  buffer_load_dwordx4 v22, s[48:51], s27 offen lds
  s_add_u32 m0, s28, 100352
  s_add_u32 s27, s27, 32768
  buffer_load_dwordx4 v23, s[48:51], s27 offen lds
  s_add_u32 m0, s28, 101376
  s_add_u32 s27, s27, 32768
  buffer_load_dwordx4 v23, s[48:51], s27 offen lds
  s_add_u32 m0, s28, 102400
  s_add_u32 s27, s27, 32768
  buffer_load_dwordx4 v22, s[48:51], s27 offen lds
  s_add_u32 m0, s28, 103424
  s_add_u32 s27, s27, 32768
  buffer_load_dwordx4 v22, s[48:51], s27 offen lds
  s_add_u32 m0, s28, 104448
  s_add_u32 s27, s27, 32768
  buffer_load_dwordx4 v23, s[48:51], s27 offen lds
  s_add_u32 m0, s28, 105472
  s_add_u32 s27, s27, 32768
  buffer_load_dwordx4 v23, s[48:51], s27 offen lds
  s_or_b32 s36, s91, s17
  s_cbranch_scc1 L_sig
  s_lshl_b32 s36, s16, 6
  s_add_u32 s36, s36, 245104644
  v_mov_b32 v120, 1
  s_mov_b64 exec, 1
  buffer_store_dword v120, off, s[4:7], s36 sc1
  s_mov_b64 exec, -1
L_sig:
  ds_read_b64_tr_b16 v[88:89], v104 offset:0
  ds_read_b64_tr_b16 v[90:91], v104 offset:4096
  ds_read_b64_tr_b16 v[96:97], v105 offset:0
  ds_read_b64_tr_b16 v[98:99], v105 offset:4096
  ds_read_b64_tr_b16 v[232:233], v106 offset:0
  ds_read_b64_tr_b16 v[234:235], v106 offset:4096
  ds_read_b64_tr_b16 v[176:177], v107 offset:0
  ds_read_b64_tr_b16 v[178:179], v107 offset:4096
  ds_read_b64_tr_b16 v[224:225], v108 offset:0
  ds_read_b64_tr_b16 v[226:227], v108 offset:4096
  ds_read_b64_tr_b16 v[168:169], v109 offset:0
  ds_read_b64_tr_b16 v[170:171], v109 offset:4096
  ds_read_b64_tr_b16 v[216:217], v110 offset:0
  ds_read_b64_tr_b16 v[218:219], v110 offset:4096
  ds_read_b64_tr_b16 v[160:161], v111 offset:0
  ds_read_b64_tr_b16 v[162:163], v111 offset:4096
  s_waitcnt lgkmcnt(0)
  s_waitcnt vmcnt(16)
  s_barrier
  ds_read_b64_tr_b16 v[92:93], v104 offset:32768
  ds_read_b64_tr_b16 v[94:95], v104 offset:36864
  ds_read_b64_tr_b16 v[100:101], v105 offset:32768
  ds_read_b64_tr_b16 v[102:103], v105 offset:36864
  ds_read_b64_tr_b16 v[236:237], v106 offset:32768
  ds_read_b64_tr_b16 v[238:239], v106 offset:36864
  ds_read_b64_tr_b16 v[180:181], v107 offset:32768
  ds_read_b64_tr_b16 v[182:183], v107 offset:36864
  ds_read_b64_tr_b16 v[228:229], v108 offset:32768
  ds_read_b64_tr_b16 v[230:231], v108 offset:36864
  ds_read_b64_tr_b16 v[172:173], v109 offset:32768
  ds_read_b64_tr_b16 v[174:175], v109 offset:36864
  ds_read_b64_tr_b16 v[220:221], v110 offset:32768
  ds_read_b64_tr_b16 v[222:223], v110 offset:36864
  ds_read_b64_tr_b16 v[164:165], v111 offset:32768
  ds_read_b64_tr_b16 v[166:167], v111 offset:36864
  s_waitcnt lgkmcnt(0)
  s_barrier
  v_add_u32 v104, 65536, v104
  v_add_u32 v105, 65536, v105
  v_add_u32 v106, 65536, v106
  v_add_u32 v107, 65536, v107
  v_add_u32 v108, 65536, v108
  v_add_u32 v109, 65536, v109
  v_add_u32 v110, 65536, v110
  v_add_u32 v111, 65536, v111
  ds_write_b128 v8, v[128:131] offset:16384
  ds_write_b128 v8, v[132:135] offset:20480
  ds_write_b128 v8, v[136:139] offset:24576
  ds_write_b128 v8, v[140:143] offset:28672
  ds_write_b128 v8, v[144:147] offset:32768
  ds_write_b128 v8, v[148:151] offset:36864
  ds_write_b128 v8, v[152:155] offset:40960
  ds_write_b128 v8, v[156:159] offset:45056
  ds_write_b128 v8, v[184:187] offset:49152
  ds_write_b128 v8, v[188:191] offset:53248
  ds_write_b128 v8, v[192:195] offset:57344
  ds_write_b128 v8, v[196:199] offset:61440
  s_waitcnt lgkmcnt(0)
  s_waitcnt vmcnt(8)
  s_barrier
  v_cmp_eq_u32 vcc, 0, v117
  v_lshlrev_b32 v116, 12, v116
  s_or_b32 s66, vcc_lo, s91
  s_cselect_b32 s66, 0, 1
  s_lshl2_add_u32 s36, s16, s17
  s_lshl_b32 s36, s36, 5
  s_add_u32 s36, s36, 244318208
  buffer_load_dword v118, v116, s[4:7], s36 offen sc1
  ds_read_b64_tr_b16 v[208:209], v104 offset:0
  ds_read_b64_tr_b16 v[210:211], v104 offset:4096
  ds_read_b64_tr_b16 v[152:153], v105 offset:0
  ds_read_b64_tr_b16 v[154:155], v105 offset:4096
  ds_read_b64_tr_b16 v[200:201], v106 offset:0
  ds_read_b64_tr_b16 v[202:203], v106 offset:4096
  ds_read_b64_tr_b16 v[144:145], v107 offset:0
  ds_read_b64_tr_b16 v[146:147], v107 offset:4096
  ds_read_b64_tr_b16 v[192:193], v108 offset:0
  ds_read_b64_tr_b16 v[194:195], v108 offset:4096
  ds_read_b64_tr_b16 v[136:137], v109 offset:0
  ds_read_b64_tr_b16 v[138:139], v109 offset:4096
  ds_read_b64_tr_b16 v[184:185], v110 offset:0
  ds_read_b64_tr_b16 v[186:187], v110 offset:4096
  ds_read_b64_tr_b16 v[128:129], v111 offset:0
  ds_read_b64_tr_b16 v[130:131], v111 offset:4096
  s_waitcnt lgkmcnt(0)
  s_waitcnt vmcnt(0)
  s_barrier
  ds_read_b64_tr_b16 v[212:213], v104 offset:32768
  ds_read_b64_tr_b16 v[214:215], v104 offset:36864
  ds_read_b64_tr_b16 v[156:157], v105 offset:32768
  ds_read_b64_tr_b16 v[158:159], v105 offset:36864
  ds_read_b64_tr_b16 v[204:205], v106 offset:32768
  ds_read_b64_tr_b16 v[206:207], v106 offset:36864
  ds_read_b64_tr_b16 v[148:149], v107 offset:32768
  ds_read_b64_tr_b16 v[150:151], v107 offset:36864
  ds_read_b64_tr_b16 v[196:197], v108 offset:32768
  ds_read_b64_tr_b16 v[198:199], v108 offset:36864
  ds_read_b64_tr_b16 v[140:141], v109 offset:32768
  ds_read_b64_tr_b16 v[142:143], v109 offset:36864
  ds_read_b64_tr_b16 v[188:189], v110 offset:32768
  ds_read_b64_tr_b16 v[190:191], v110 offset:36864
  ds_read_b64_tr_b16 v[132:133], v111 offset:32768
  ds_read_b64_tr_b16 v[134:135], v111 offset:36864
  s_waitcnt lgkmcnt(0)
  s_barrier
  s_waitcnt vmcnt(0)
  s_lshl_b32 s26, s16, 13
  s_add_u32 s26, s26, s40
  s_add_u32 s27, s26, 4096
  s_lshl_b32 s28, s17, 13
  s_add_u32 s28, s28, s62
  buffer_load_dwordx4 v[104:107], v8, s[4:7], s26 offen sc1
  buffer_load_dwordx4 v[104:107], v8, s[4:7], s27 offen sc1
  buffer_load_dwordx2 v[104:105], v5, s[4:7], s28 offen sc1
  ds_write_b128 v1, v[24:27] offset:0
  ds_write_b128 v1, v[28:31] offset:1024
  ds_write_b128 v1, v[32:35] offset:2048
  ds_write_b128 v1, v[36:39] offset:3072
  ds_write_b128 v1, v[40:43] offset:4096
  ds_write_b128 v1, v[44:47] offset:5120
  ds_write_b128 v1, v[48:51] offset:6144
  ds_write_b128 v1, v[52:55] offset:7168
  ds_write_b128 v1, v[56:59] offset:8192
  ds_write_b128 v1, v[60:63] offset:9216
  ds_write_b128 v1, v[64:67] offset:10240
  ds_write_b128 v1, v[68:71] offset:11264
  ds_write_b128 v1, v[72:75] offset:12288
  ds_write_b128 v1, v[76:79] offset:13312
  ds_write_b128 v1, v[80:83] offset:14336
  ds_write_b128 v1, v[84:87] offset:15360
  ds_write_b128 v1, v[88:91] offset:16384
  ds_write_b128 v1, v[92:95] offset:17408
  ds_write_b128 v1, v[96:99] offset:18432
  ds_write_b128 v1, v[100:103] offset:19456
  s_mul_i32 s27, s17, 24576
  s_add_u32 m0, s27, 86016
  s_waitcnt lgkmcnt(0)
  v_readlane_b32 s67, v118, 1
  v_readlane_b32 s26, v118, 0
  v_mov_b32 v21, v117
  s_and_b32 s66, s66, s26
  s_cbranch_scc1 L_pk
  v_mbcnt_lo_u32_b32 v20, -1, 0
  v_and_b32 v20, 1, v20
  v_add_lshl_u32 v20, v20, s61, 2
  s_mov_b32 s26, 0
g_wt_9:
  global_load_dword v21, v20, s[12:13] offset:128 sc1
  s_add_u32 s26, s26, 1
  s_cmp_gt_u32 s26, 1048576
  s_cbranch_scc1 L_end
  s_waitcnt vmcnt(0)
  v_cmp_eq_u32 vcc, 0, v21
  v_readfirstlane_b32 s27, v21
  s_cbranch_vccnz g_wt_9
L_pk:
  s_lshr_b32 s26, s91, 1
  s_nop 3
  v_readlane_b32 s27, v21, s26
  s_cmp_lg_u32 s27, 1
  s_cbranch_scc1 L_chain_x
  s_mov_b32 s22, 0
  s_mov_b32 s21, 0
  s_mov_b32 s42, s62
  s_add_u32 s43, s62, 4096
  s_mov_b32 s46, 0
  s_mov_b32 s47, 0
  s_lshl_b32 s26, s16, 2
  s_add_u32 s26, s26, s17
  s_lshl_b32 s27, s60, 13
  s_add_u32 s27, s27, s26
  s_lshr_b32 s25, s27, 2
  s_lshl_b32 s25, s25, 13
  s_add_u32 s25, s25, 192937984
  s_lshr_b32 s64, s27, 2
  s_lshl_b32 s64, s64, 6
  s_add_u32 s64, s64, 513538048
  s_cmp_eq_u32 s17, 3
  s_cselect_b32 s2, 268435456, 0
  s_lshl_b32 s27, s61, 13
  s_add_u32 s27, s27, s26
  s_lshl_b32 s23, s27, 12
  s_add_u32 s23, s23, 41943040
  s_lshl_b32 s63, s27, 5
  s_add_u32 s63, s63, 244318208
  s_mov_b32 s97, 268435456
  s_cmp_eq_u32 s60, 2
  s_cselect_b32 s20, 262144, s97
  s_cselect_b32 s93, 1, 3
  s_lshl_b32 s26, s17, 2
  s_add_u32 s26, s26, s60
  s_cmp_eq_u32 s26, 1
  s_cselect_b32 s97, 245891072, s97
  s_mov_b32 s95, 0
  s_mov_b32 s96, s23
  s_add_u32 s23, s23, 524288
  s_add_u32 s63, s63, 4096
  s_cmp_eq_u32 s66, 0
  s_cbranch_scc1 c_pk_18
  s_sub_u32 s96, s23, 524288
  s_mov_b32 s65, s67
  s_mov_b32 s94, 0
  buffer_load_dwordx4 v0, s[4:7], s96 offen offset:0  lds
  buffer_load_dwordx4 v0, s[4:7], s96 offen offset:1024  lds
  buffer_load_dwordx4 v0, s[4:7], s96 offen offset:2048  lds
  buffer_load_dwordx4 v0, s[4:7], s96 offen offset:3072  lds
  s_branch c_pk2_19
c_pk_18:
  s_mov_b32 s29, 0
  s_sub_u32 s92, s63, 4096
  s_sub_u32 s96, s23, 524288
  s_mov_b32 s95, 0
c_gw_20:
  buffer_load_dword v7, off, s[4:7], s92 sc1
  s_add_u32 s29, s29, 1
  s_cmp_gt_u32 s29, 1048576
  s_cbranch_scc1 c_fail_16
  s_waitcnt vmcnt(0) lgkmcnt(0)
  v_readfirstlane_b32 s65, v7
  s_cmp_eq_u32 s65, 0
  s_cbranch_scc1 c_gw_20
  s_and_b32 s65, s65, s93
  s_cbranch_scc1 c_kvx_22
  s_mov_b32 s95, 1
  s_add_u32 s96, s96, 33554432
  s_add_u32 s92, s92, 262144
c_kvw_21:
  buffer_load_dword v7, off, s[4:7], s92 sc1
  s_add_u32 s29, s29, 1
  s_cmp_gt_u32 s29, 1048576
  s_cbranch_scc1 c_fail_16
  s_waitcnt vmcnt(0) lgkmcnt(0)
  v_readfirstlane_b32 s65, v7
  s_cmp_eq_u32 s65, 0
  s_cbranch_scc1 c_kvw_21
c_kvx_22:
  buffer_load_dword v7, off, s[4:7], s63 sc1
  buffer_load_dwordx4 v0, s[4:7], s96 offen offset:0  lds
  buffer_load_dwordx4 v0, s[4:7], s96 offen offset:1024  lds
  buffer_load_dwordx4 v0, s[4:7], s96 offen offset:2048  lds
  buffer_load_dwordx4 v0, s[4:7], s96 offen offset:3072  lds
  s_waitcnt vmcnt(4)
  v_readfirstlane_b32 s65, v7
  s_mov_b32 s94, 0
c_pk2_19:
  s_waitcnt vmcnt(4)
  ds_read_b128 v[72:75], v1 offset:6144
  ds_read_b128 v[76:79], v1 offset:7168
  ds_read_b128 v[80:83], v1 offset:8192
  ds_read_b128 v[84:87], v1 offset:9216
  ds_read_b128 v[88:91], v1 offset:10240
  ds_read_b128 v[92:95], v1 offset:11264
  ds_read_b128 v[96:99], v1 offset:12288
  ds_read_b128 v[100:103], v1 offset:13312
  ds_read_b128 v[104:107], v1 offset:14336
  ds_read_b128 v[108:111], v1 offset:15360
  ds_read_b128 v[112:115], v1 offset:16384
  ds_read_b128 v[116:119], v1 offset:17408
  ds_read_b128 v[120:123], v1 offset:18432
  ds_read_b128 v[124:127], v1 offset:19456
  v_mov_b64 v[48:49], 0
  v_mov_b64 v[50:51], 0
  v_mov_b64 v[52:53], 0
  v_mov_b64 v[54:55], 0
  v_mov_b64 v[56:57], 0
  v_mov_b64 v[58:59], 0
  v_mov_b64 v[60:61], 0
  v_mov_b64 v[62:63], 0
  v_mov_b64 v[64:65], 0
  v_mov_b64 v[66:67], 0
  v_mov_b64 v[68:69], 0
  v_mov_b64 v[70:71], 0
  s_lshl_b32 s38, s16, 13
  s_add_u32 s38, s38, s40
  s_add_u32 s39, s38, 4096
  ds_read_b128 v[24:27], v1 offset:0
  ds_read_b128 v[28:31], v1 offset:1024
  ds_read_b128 v[32:35], v1 offset:2048
  ds_read_b128 v[36:39], v1 offset:3072
  ds_read_b128 v[40:43], v1 offset:4096
  ds_read_b128 v[44:47], v1 offset:5120
  s_waitcnt lgkmcnt(0)
c_loop_10:
  buffer_load_dwordx4 v[16:19], v8, s[4:7], s42 offen sc1
  buffer_load_dwordx4 v[20:23], v8, s[4:7], s43 offen sc1
  s_mov_b32 s28, 0
  v_mov_b64 v[48:49], 0
  v_mov_b64 v[50:51], 0
  v_mov_b64 v[52:53], 0
  v_mov_b64 v[54:55], 0
  v_mov_b64 v[56:57], 0
  v_mov_b64 v[58:59], 0
  v_mov_b64 v[60:61], 0
  v_mov_b64 v[62:63], 0
  v_mov_b64 v[64:65], 0
  v_mov_b64 v[66:67], 0
  v_mov_b64 v[68:69], 0
  v_mov_b64 v[70:71], 0
  buffer_load_dwordx4 v[16:19], v8, s[4:7], s42 offen sc1
  buffer_load_dwordx4 v[20:23], v8, s[4:7], s43 offen sc1
  s_waitcnt lgkmcnt(0)
  s_and_b32 s29, s65, s93
  s_cbranch_scc0 c_xb_25
c_xr_26:
  s_waitcnt vmcnt(3)
  v_max3_u32 v7, v16, v17, v18
  v_max_u32 v7, v7, v19
  ds_write_b128 v8, v[16:19] offset:4096
  v_smfmac_f32_16x16x64_bf16 v[48:51], v[16:19], v[24:31], v6
  s_waitcnt vmcnt(2)
  v_max3_u32 v7, v20, v21, v7
  v_max3_u32 v7, v22, v23, v7
  ds_write_b128 v8, v[20:23] offset:8192
  v_smfmac_f32_16x16x64_bf16 v[52:55], v[16:19], v[32:39], v6
  v_cmp_eq_u32 vcc, -1, v7
  v_smfmac_f32_16x16x64_bf16 v[56:59], v[16:19], v[40:47], v6
  s_cbranch_vccnz c_retry_11
c_got_12:
  v_smfmac_f32_16x16x64_bf16 v[60:63], v[16:19], v[72:79], v6
  ds_read_b128 v[72:75], v1 offset:20480
  s_and_b32 s65, s65, s93
  s_cselect_b32 s96, s23, 268435456
  v_smfmac_f32_16x16x64_bf16 v[48:51], v[20:23], v[80:87], v6
  ds_read_b128 v[76:79], v1 offset:21504
  v_mov_b32 v7, 1
  v_smfmac_f32_16x16x64_bf16 v[52:55], v[20:23], v[88:95], v6
  ds_read_b128 v[80:83], v1 offset:22528
  v_smfmac_f32_16x16x64_bf16 v[56:59], v[20:23], v[96:103], v6
  ds_read_b128 v[84:87], v1 offset:23552
  s_waitcnt lgkmcnt(4)
  s_barrier
  ds_read_b128 v[24:27], v9 offset:4096
  ds_read_b128 v[28:31], v10 offset:4096
  v_smfmac_f32_16x16x64_bf16 v[60:63], v[20:23], v[104:111], v6
  ds_read_b128 v[32:35], v11 offset:4096
  v_smfmac_f32_16x16x64_bf16 v[64:67], v[16:19], v[112:119], v6
  ds_read_b128 v[36:39], v9 offset:8192
  v_smfmac_f32_16x16x64_bf16 v[68:71], v[16:19], v[120:127], v6
  ds_read_b128 v[40:43], v10 offset:8192
  v_smfmac_f32_16x16x64_bf16 v[64:67], v[20:23], v[208:215], v6
  ds_read_b128 v[44:47], v11 offset:8192
  s_waitcnt lgkmcnt(5)
  v_smfmac_f32_16x16x64_bf16 v[48:51], v[24:27], a[168:175], v6
  buffer_load_dwordx4 v0, s[4:7], s96 offen offset:0  lds
  s_waitcnt lgkmcnt(4)
  v_smfmac_f32_16x16x64_bf16 v[48:51], v[28:31], a[160:167], v6
  ds_read_b128 v[104:107], v8 offset:16384
  s_waitcnt lgkmcnt(4)
  v_smfmac_f32_16x16x64_bf16 v[48:51], v[32:35], a[152:159], v6
  buffer_load_dwordx4 v0, s[4:7], s96 offen offset:1024  lds
  s_waitcnt lgkmcnt(3)
  v_smfmac_f32_16x16x64_bf16 v[48:51], v[36:39], a[144:151], v6
  ds_read_b128 v[108:111], v8 offset:20480
  s_waitcnt lgkmcnt(3)
  v_smfmac_f32_16x16x64_bf16 v[48:51], v[40:43], a[136:143], v6
  buffer_load_dwordx4 v0, s[4:7], s96 offen offset:2048  lds
  s_waitcnt lgkmcnt(2)
  v_smfmac_f32_16x16x64_bf16 v[48:51], v[44:47], a[128:135], v6
  v_smfmac_f32_16x16x64_bf16 v[52:55], v[24:27], a[120:127], v6
  buffer_load_dwordx4 v0, s[4:7], s96 offen offset:3072  lds
  v_smfmac_f32_16x16x64_bf16 v[52:55], v[28:31], a[112:119], v6
  ds_read_b64 v[100:101], v5 offset:4096
  v_add_f32 v48, v48, v50
  v_smfmac_f32_16x16x64_bf16 v[52:55], v[32:35], a[104:111], v6
  ds_read_b128 v[112:115], v8 offset:24576
  v_add_f32 v49, v49, v51
  v_smfmac_f32_16x16x64_bf16 v[52:55], v[36:39], a[96:103], v6
  ds_read_b128 v[116:119], v8 offset:28672
  v_cvt_pk_bf16_f32 v50, v48, v49
  v_smfmac_f32_16x16x64_bf16 v[52:55], v[40:43], a[88:95], v6
  ds_write2_b32 v2, v50, v50 offset0:0 offset1:1
  v_smfmac_f32_16x16x64_bf16 v[52:55], v[44:47], a[80:87], v6
  ds_read_b64_tr_b16 v[88:89], v12 offset:0
  v_smfmac_f32_16x16x64_bf16 v[56:59], v[24:27], a[72:79], v6
  s_mov_b64 exec, 1
  buffer_store_dword v7, off, s[4:7], s64 sc1
  s_mov_b64 exec, -1
  v_smfmac_f32_16x16x64_bf16 v[56:59], v[28:31], a[64:71], v6
  ds_read_b128 v[120:123], v8 offset:32768
  v_add_f32 v52, v52, v54
  v_smfmac_f32_16x16x64_bf16 v[56:59], v[32:35], a[56:63], v6
  ds_read_b128 v[124:127], v8 offset:36864
  v_add_f32 v53, v53, v55
  v_cvt_pk_bf16_f32 v54, v52, v53
  v_smfmac_f32_16x16x64_bf16 v[56:59], v[36:39], a[48:55], v6
  ds_write2_b32 v2, v54, v54 offset0:128 offset1:129
  ds_read_b64_tr_b16 v[90:91], v12 offset:512
  v_smfmac_f32_16x16x64_bf16 v[56:59], v[40:43], a[40:47], v6
  v_smfmac_f32_16x16x64_bf16 v[56:59], v[44:47], a[32:39], v6
  v_smfmac_f32_16x16x64_bf16 v[60:63], v[24:27], a[24:31], v6
  v_smfmac_f32_16x16x64_bf16 v[60:63], v[28:31], a[16:23], v6
  s_waitcnt lgkmcnt(0)
  v_add_f32 v56, v56, v58
  v_mfma_f32_16x16x32_bf16 v[92:95], v[72:75], v[88:91], 0
  buffer_store_dwordx2 v[100:101], v5, s[4:7], s97 offen sc1
  v_add_f32 v57, v57, v59
  v_cvt_pk_bf16_f32 v58, v56, v57
  v_mfma_f32_16x16x32_bf16 v[96:99], v[76:79], v[88:91], 0
  ds_write_b32 v2, v58
  v_smfmac_f32_16x16x64_bf16 v[60:63], v[32:35], a[8:15], v6
  v_mov_b32 v76, 0
  v_smfmac_f32_16x16x64_bf16 v[60:63], v[36:39], a[0:7], v6
  v_cndmask_b32 v48, v92, v96, s[18:19]
  v_smfmac_f32_16x16x64_bf16 v[60:63], v[40:43], v[248:255], v6
  v_cndmask_b32 v49, v93, v97, s[18:19]
  v_smfmac_f32_16x16x64_bf16 v[60:63], v[44:47], v[240:247], v6
  v_cndmask_b32 v50, v94, v98, s[18:19]
  v_smfmac_f32_16x16x64_bf16 v[68:71], v[20:23], v[152:159], v6
  v_cndmask_b32 v51, v95, v99, s[18:19]
  v_smfmac_f32_16x16x64_bf16 v[64:67], v[24:27], v[232:239], v6
  ds_write_b128 v8, v[48:51] offset:12288
  v_add_f32 v60, v60, v62
  v_add_f32 v61, v61, v63
  v_cvt_pk_bf16_f32 v62, v60, v61
  v_smfmac_f32_16x16x64_bf16 v[64:67], v[28:31], v[224:231], v6
  ds_write_b32 v2, v62 offset:512
  s_waitcnt vmcnt(6)
  v_mov_b32 v79, 0
  v_smfmac_f32_16x16x64_bf16 v[64:67], v[32:35], v[216:223], v6
  v_mov_b64 v[20:21], s[14:15]
  v_smfmac_f32_16x16x64_bf16 v[64:67], v[36:39], v[200:207], v6
  v_mov_b64 v[22:23], s[14:15]
  v_smfmac_f32_16x16x64_bf16 v[64:67], v[40:43], v[192:199], v6
  s_waitcnt lgkmcnt(0)
  s_barrier
  ds_read_b128 v[52:55], v9 offset:12288
  ds_read_b128 v[56:59], v10 offset:12288
  v_smfmac_f32_16x16x64_bf16 v[64:67], v[44:47], v[184:191], v6
  ds_read_b128 v[60:63], v11 offset:12288
  v_smfmac_f32_16x16x64_bf16 v[68:71], v[24:27], v[176:183], v6
  ds_read_b64_tr_b16 v[88:89], v12 offset:0
  ds_read_b64_tr_b16 v[90:91], v12 offset:512
  v_smfmac_f32_16x16x64_bf16 v[68:71], v[28:31], v[168:175], v6
  ds_read_b64_tr_b16 v[92:93], v13 offset:0
  ds_read_b64_tr_b16 v[94:95], v13 offset:512
  v_add_f32 v64, v64, v66
  v_smfmac_f32_16x16x64_bf16 v[68:71], v[32:35], v[160:167], v6
  ds_read_b64_tr_b16 v[96:97], v14 offset:0
  ds_read_b64_tr_b16 v[98:99], v14 offset:512
  v_add_f32 v65, v65, v67
  v_smfmac_f32_16x16x64_bf16 v[68:71], v[36:39], v[144:151], v6
  ds_read_b64_tr_b16 v[100:101], v15 offset:0
  ds_read_b64_tr_b16 v[102:103], v15 offset:512
  s_waitcnt lgkmcnt(8)
  v_cvt_pk_bf16_f32 v66, v64, v65
  v_smfmac_f32_16x16x64_bf16 v[68:71], v[40:43], v[136:143], v6
  v_add_f32 v48, v48, v52
  v_smfmac_f32_16x16x64_bf16 v[68:71], v[44:47], v[128:135], v6
  s_waitcnt lgkmcnt(4)
  v_add_f32 v49, v49, v53
  v_mfma_f32_16x16x32_bf16 v[16:19], v[88:91], v[88:91], 0
  buffer_store_dwordx4 v[88:91], v8, s[4:7], s25 offen sc1
  v_add_f32 v50, v50, v54
  v_add_f32 v51, v51, v55
  v_mfma_f32_16x16x32_bf16 v[16:19], v[92:95], v[92:95], v[16:19]
  s_waitcnt lgkmcnt(0)
  v_add_f32 v56, v56, v60
  v_add_f32 v57, v57, v61
  v_mfma_f32_16x16x32_bf16 v[16:19], v[96:99], v[96:99], v[16:19]
  v_add_f32 v58, v58, v62
  v_add_f32 v59, v59, v63
  v_mfma_f32_16x16x32_bf16 v[16:19], v[100:103], v[100:103], v[16:19]
  v_add_f32 v48, v48, v56
  v_add_f32 v49, v49, v57
  v_add_f32 v50, v50, v58
  v_add_f32 v51, v51, v59
  v_exp_f32 v24, v48
  v_exp_f32 v25, v49
  v_exp_f32 v26, v50
  v_exp_f32 v27, v51
  v_cvt_pk_bf16_f32 v24, v24, v25
  v_mul_f32 v16, s24, v16
  v_cvt_pk_bf16_f32 v25, v26, v27
  v_cndmask_b32 v72, v24, 0, s[18:19]
  v_cndmask_b32 v73, v25, 0, s[18:19]
  v_cndmask_b32 v74, 0, v24, s[18:19]
  v_cndmask_b32 v75, 0, v25, s[18:19]
  v_mul_f32 v17, s24, v17
  v_exp_f32 v28, v16
  v_mfma_f32_16x16x32_bf16 v[60:63], v[72:75], v[20:23], 0
  v_exp_f32 v29, v17
  v_add_f32 v68, v68, v70
  v_mfma_f32_16x16x32_bf16 v[52:55], v[72:75], v[80:83], 0
  s_add_u32 s30, s25, 4096
  v_cvt_pk_bf16_f32 v28, v28, v29
  v_add_f32 v69, v69, v71
  v_mfma_f32_16x16x32_bf16 v[56:59], v[72:75], v[84:87], 0
  v_cndmask_b32 v77, 0, v28, s[18:19]
  v_cndmask_b32 v78, 0, v28, s[18:19]
  v_cvt_pk_bf16_f32 v67, v68, v69
  v_lshrrev_b32 v92, 1, v8
  v_mfma_f32_16x16x16_bf16 v[60:63], v[76:77], v[20:21], v[60:63]
  buffer_store_dwordx2 v[66:67], v92, s[4:7], s30 offen sc1
  v_max3_f32 v7, |v48|, |v49|, |v50|
  v_max_f32 v26, |v16|, |v17|
  v_mfma_f32_16x16x16_bf16 v[52:55], v[78:79], v[66:67], v[52:55]
  v_cndmask_b32 v26, 0, v26, s[18:19]
  v_max3_f32 v7, |v51|, v26, v7
  v_mfma_f32_16x16x16_bf16 v[56:59], v[76:77], v[66:67], v[56:59]
  v_cmp_lt_f32 vcc, 0x42700000, v7
  v_mov_b64 v[44:45], 0
  v_add_f32 v60, v60, v62
  v_add_f32 v61, v61, v63
  s_cbranch_vccnz c_fb_14
c_fbr_15:
  v_rcp_f32 v60, v60
  v_rcp_f32 v61, v61
  v_pk_add_f32 v[52:53], v[52:53], v[54:55]
  v_pk_add_f32 v[56:57], v[56:57], v[58:59]
  v_pk_mul_f32 v[52:53], v[52:53], v[60:61]
  v_pk_mul_f32 v[56:57], v[56:57], v[60:61]
  v_cvt_pk_bf16_f32 v54, v52, v53
  v_cvt_pk_bf16_f32 v55, v56, v57
  ds_write_b64 v2, v[54:55] offset:4096
  v_mov_b64 v[46:47], 0
  v_mov_b64 v[40:41], 0
  v_mov_b64 v[42:43], 0
  v_mov_b64 v[36:37], 0
  v_mov_b64 v[38:39], 0
  v_mov_b64 v[32:33], 0
  v_mov_b64 v[34:35], 0
  v_mov_b64 v[28:29], 0
  v_mov_b64 v[30:31], 0
  v_mov_b64 v[24:25], 0
  v_mov_b64 v[26:27], 0
  v_mov_b64 v[80:81], 0
  v_mov_b64 v[82:83], 0
  v_mov_b64 v[84:85], 0
  v_mov_b64 v[86:87], 0
  s_waitcnt lgkmcnt(0)
  s_barrier
  ds_read_b64_tr_b16 v[72:73], v3 offset:4096
  ds_read_b64_tr_b16 v[74:75], v3 offset:5120
  ds_read_b64_tr_b16 v[76:77], v3 offset:6144
  ds_read_b64_tr_b16 v[78:79], v3 offset:7168
  s_and_b32 s3, s21, 1
  s_add_u32 s21, s21, 1
  s_add_u32 s22, s22, 1
  s_and_b32 s42, s21, 3
  s_lshl_b32 s42, s42, 13
  s_cmp_eq_u32 s22, 64
  s_cbranch_scc1 c_last_17
  s_waitcnt lgkmcnt(2)
  v_smfmac_f32_16x16x64_bf16 v[44:47], v[72:75], a[248:255], v6
  s_waitcnt lgkmcnt(0)
  ds_read_b128 v[16:19], v8 offset:40960
  v_smfmac_f32_16x16x64_bf16 v[44:47], v[76:79], a[240:247], v6
  ds_read_b128 v[20:23], v8 offset:45056
  v_smfmac_f32_16x16x64_bf16 v[40:43], v[72:75], a[232:239], v6
  ds_read_b128 v[88:91], v8 offset:49152
  v_smfmac_f32_16x16x64_bf16 v[40:43], v[76:79], a[224:231], v6
  ds_read_b128 v[92:95], v8 offset:53248
  v_add_f32 v44, v44, v46
  v_add_f32 v45, v45, v47
  v_smfmac_f32_16x16x64_bf16 v[36:39], v[72:75], a[216:223], v6
  ds_read_b128 v[96:99], v8 offset:57344
  v_cvt_pk_bf16_f32 v48, v44, v45
  v_and_or_b32 v48, v48, -2, s3
  v_smfmac_f32_16x16x64_bf16 v[36:39], v[76:79], a[208:215], v6
  ds_read_b128 v[100:103], v8 offset:61440
  v_add_f32 v40, v40, v42
  v_add_f32 v41, v41, v43
  v_smfmac_f32_16x16x64_bf16 v[32:35], v[72:75], a[200:207], v6
  v_cvt_pk_bf16_f32 v49, v40, v41
  v_smfmac_f32_16x16x64_bf16 v[32:35], v[76:79], a[192:199], v6
  v_add_f32 v36, v36, v38
  v_add_f32 v37, v37, v39
  v_smfmac_f32_16x16x64_bf16 v[28:31], v[72:75], a[184:191], v6
  v_cvt_pk_bf16_f32 v50, v36, v37
  v_smfmac_f32_16x16x64_bf16 v[28:31], v[76:79], a[176:183], v6
  v_add_f32 v32, v32, v34
  v_add_f32 v33, v33, v35
  v_smfmac_f32_16x16x64_bf16 v[24:27], v[72:75], v[104:111], v6
  v_cvt_pk_bf16_f32 v51, v32, v33
  v_smfmac_f32_16x16x64_bf16 v[24:27], v[76:79], v[112:119], v6
  buffer_store_dwordx4 v[48:51], v4, s[4:7], s40 offen
  v_add_f32 v28, v28, v30
  v_add_f32 v29, v29, v31
  v_smfmac_f32_16x16x64_bf16 v[80:83], v[72:75], v[120:127], v6
  s_waitcnt lgkmcnt(0)
  v_cvt_pk_bf16_f32 v52, v28, v29
  v_and_or_b32 v52, v52, -2, s3
  v_smfmac_f32_16x16x64_bf16 v[80:83], v[76:79], v[16:23], v6
  v_add_f32 v24, v24, v26
  v_add_f32 v25, v25, v27
  v_smfmac_f32_16x16x64_bf16 v[84:87], v[72:75], v[88:95], v6
  v_cvt_pk_bf16_f32 v53, v24, v25
  v_smfmac_f32_16x16x64_bf16 v[84:87], v[76:79], v[96:103], v6
  v_add_f32 v80, v80, v82
  v_add_f32 v81, v81, v83
  v_cvt_pk_bf16_f32 v54, v80, v81
  s_nop 0
  s_nop 3
  v_pk_add_f32 v[84:85], v[84:85], v[86:87]
  v_cvt_pk_bf16_f32 v55, v84, v85
  buffer_store_dwordx4 v[52:55], v4, s[4:7], s41 offen
  s_add_u32 s42, s42, s62
  s_add_u32 s43, s42, 4096
  s_add_u32 s23, s23, 524288
  s_add_u32 s25, s25, 262144
  s_add_u32 s63, s63, 4096
  s_add_u32 s64, s64, 2048
  s_andn2_b32 s64, s64, s2
  s_add_u32 s97, s97, 8192
  s_add_u32 s92, s63, s20
  s_cmp_lg_u32 s17, 0
  s_cbranch_scc1 c_oth_29
  s_mov_b32 s28, 0
  s_add_u32 s46, s46, 1
  v_mov_b64 v[64:65], -1
  s_xor_b32 s34, s42, 16384
  buffer_store_dwordx2 v[64:65], v5, s[4:7], s34 offen
  s_mov_b32 vcc_lo, 0xaaaaaaaa
  s_mov_b32 vcc_hi, 0xaaaaaaaa
  v_mov_b32 v7, 0x3f80
  v_cndmask_b32 v7, v7, 1.0, vcc
  s_mov_b32 vcc_lo, 0x30003
  s_mov_b32 vcc_hi, 0x30003
  v_cndmask_b32 v68, 0, v7, vcc
  s_mov_b32 vcc_lo, 0xc000c
  s_mov_b32 vcc_hi, 0xc000c
  v_cndmask_b32 v69, 0, v7, vcc
  s_mov_b32 vcc_lo, 0x300030
  s_mov_b32 vcc_hi, 0x300030
  v_cndmask_b32 v70, 0, v7, vcc
  s_mov_b32 vcc_lo, 0xc000c0
  s_mov_b32 vcc_hi, 0xc000c0
  v_cndmask_b32 v71, 0, v7, vcc
  ds_read_b128 v[112:115], v1 offset:16384
  ds_read_b128 v[116:119], v1 offset:17408
  s_waitcnt lgkmcnt(0)
  ds_read_b128 v[120:123], v1 offset:18432
  ds_read_b128 v[124:127], v1 offset:19456
  s_waitcnt lgkmcnt(0)
  buffer_load_dwordx4 v[16:19], v0, s[4:7], s38 offen offset:0 sc1
  buffer_load_dwordx4 v[20:23], v0, s[4:7], s38 offen offset:1024 sc1
  buffer_load_dwordx4 v[24:27], v0, s[4:7], s38 offen offset:2048 sc1
  buffer_load_dwordx4 v[28:31], v0, s[4:7], s38 offen offset:3072 sc1
  buffer_load_dwordx4 v[32:35], v0, s[4:7], s39 offen offset:0 sc1
  buffer_load_dwordx4 v[36:39], v0, s[4:7], s39 offen offset:1024 sc1
  buffer_load_dwordx4 v[40:43], v0, s[4:7], s39 offen offset:2048 sc1
  buffer_load_dwordx4 v[44:47], v0, s[4:7], s39 offen offset:3072 sc1
  buffer_load_dwordx4 v[72:75], v0, s[4:7], s38 offen offset:0 sc1
  buffer_load_dwordx4 v[76:79], v0, s[4:7], s38 offen offset:1024 sc1
  buffer_load_dwordx4 v[80:83], v0, s[4:7], s38 offen offset:2048 sc1
  buffer_load_dwordx4 v[84:87], v0, s[4:7], s38 offen offset:3072 sc1
  buffer_load_dwordx4 v[88:91], v0, s[4:7], s39 offen offset:0 sc1
  buffer_load_dwordx4 v[92:95], v0, s[4:7], s39 offen offset:1024 sc1
  buffer_load_dwordx4 v[96:99], v0, s[4:7], s39 offen offset:2048 sc1
  buffer_load_dwordx4 v[100:103], v0, s[4:7], s39 offen offset:3072 sc1
  s_buffer_load_dword s65, s[4:7], s63
  s_waitcnt vmcnt(15)
  v_mfma_f32_16x16x32_bf16 v[64:67], v[16:19], v[68:71], 0
  v_xor_b32 v7, s3, v16
  s_waitcnt vmcnt(14)
  v_mfma_f32_16x16x32_bf16 v[64:67], v[20:23], v[68:71], v[64:67]
  v_bitop3_b32 v7, v7, v20, s3 bitop3:0xf6
  s_waitcnt vmcnt(13)
  v_mfma_f32_16x16x32_bf16 v[64:67], v[24:27], v[68:71], v[64:67]
  v_bitop3_b32 v7, v7, v24, s3 bitop3:0xf6
  s_waitcnt vmcnt(12)
  v_mfma_f32_16x16x32_bf16 v[64:67], v[28:31], v[68:71], v[64:67]
  v_bitop3_b32 v7, v7, v28, s3 bitop3:0xf6
  s_waitcnt vmcnt(11)
  v_mfma_f32_16x16x32_bf16 v[64:67], v[32:35], v[68:71], v[64:67]
  v_bitop3_b32 v7, v7, v32, s3 bitop3:0xf6
  s_waitcnt vmcnt(10)
  v_mfma_f32_16x16x32_bf16 v[64:67], v[36:39], v[68:71], v[64:67]
  v_bitop3_b32 v7, v7, v36, s3 bitop3:0xf6
  s_waitcnt vmcnt(9)
  v_mfma_f32_16x16x32_bf16 v[64:67], v[40:43], v[68:71], v[64:67]
  v_bitop3_b32 v7, v7, v40, s3 bitop3:0xf6
  s_waitcnt vmcnt(8)
  v_mfma_f32_16x16x32_bf16 v[64:67], v[44:47], v[68:71], v[64:67]
  v_bitop3_b32 v7, v7, v44, s3 bitop3:0xf6
  v_and_b32 v7, 1, v7
  v_cmp_ne_u32 vcc, 0, v7
  v_mov_b32 v7, 0
  v_mov_b32 v7, 0
  s_cbranch_vccnz c_p1r_30
c_publ_31:
  s_nop 1
  s_nop 0
  v_cvt_pk_bf16_f32 v64, v64, v65
  v_cvt_pk_bf16_f32 v65, v66, v67
  v_min_u32 v64, -2, v64
  v_min_u32 v65, -2, v65
  buffer_store_dwordx2 v[64:65], v5, s[4:7], s42 offen
  s_waitcnt vmcnt(1)
  ds_read_b128 v[24:27], v1 offset:0
  ds_read_b128 v[28:31], v1 offset:1024
  ds_read_b128 v[32:35], v1 offset:2048
  ds_read_b128 v[36:39], v1 offset:3072
  ds_read_b128 v[40:43], v1 offset:4096
  ds_read_b128 v[44:47], v1 offset:5120
  ds_read_b128 v[72:75], v1 offset:6144
  ds_read_b128 v[76:79], v1 offset:7168
  ds_read_b128 v[80:83], v1 offset:8192
  ds_read_b128 v[84:87], v1 offset:9216
  ds_read_b128 v[88:91], v1 offset:10240
  ds_read_b128 v[92:95], v1 offset:11264
  ds_read_b128 v[96:99], v1 offset:12288
  ds_read_b128 v[100:103], v1 offset:13312
  ds_read_b128 v[104:107], v1 offset:14336
  ds_read_b128 v[108:111], v1 offset:15360
c_hop2_13:
  s_barrier
  s_cmp_le_u32 s96, s23
  s_cbranch_scc1 c_loop_10
  s_cmp_lg_u32 s96, 268435456
  s_cbranch_scc1 c_fk0_32
  buffer_store_dwordx2 v[64:65], v5, s[4:7], s97 offen sc1
  s_mov_b32 s29, 0
  s_sub_u32 s92, s63, 4096
  s_sub_u32 s96, s23, 524288
  s_mov_b32 s95, 0
c_gw_33:
  buffer_load_dword v7, off, s[4:7], s92 sc1
  s_add_u32 s29, s29, 1
  s_cmp_gt_u32 s29, 1048576
  s_cbranch_scc1 c_fail_16
  s_waitcnt vmcnt(0) lgkmcnt(0)
  v_readfirstlane_b32 s65, v7
  s_cmp_eq_u32 s65, 0
  s_cbranch_scc1 c_gw_33
  s_and_b32 s65, s65, s93
  s_cbranch_scc1 c_kvx_35
  s_mov_b32 s95, 1
  s_add_u32 s96, s96, 33554432
  s_add_u32 s92, s92, 262144
c_kvw_34:
  buffer_load_dword v7, off, s[4:7], s92 sc1
  s_add_u32 s29, s29, 1
  s_cmp_gt_u32 s29, 1048576
  s_cbranch_scc1 c_fail_16
  s_waitcnt vmcnt(0) lgkmcnt(0)
  v_readfirstlane_b32 s65, v7
  s_cmp_eq_u32 s65, 0
  s_cbranch_scc1 c_kvw_34
c_kvx_35:
  buffer_load_dword v7, off, s[4:7], s63 sc1
  buffer_load_dwordx4 v0, s[4:7], s96 offen offset:0  lds
  buffer_load_dwordx4 v0, s[4:7], s96 offen offset:1024  lds
  buffer_load_dwordx4 v0, s[4:7], s96 offen offset:2048  lds
  buffer_load_dwordx4 v0, s[4:7], s96 offen offset:3072  lds
  s_waitcnt vmcnt(4)
  v_readfirstlane_b32 s65, v7
  s_mov_b32 s94, 0
  s_cmp_eq_u32 s95, 0
  s_cbranch_scc1 c_loop_10
c_fk0_32:
  s_mov_b32 s29, 0
c_fk_36:
  buffer_load_dwordx4 v[16:19], v8, s[4:7], s42 offen sc1
  buffer_load_dwordx4 v[20:23], v8, s[4:7], s43 offen sc1
  s_add_u32 s29, s29, 1
  s_cmp_gt_u32 s29, 1048576
  s_cbranch_scc1 c_fail_16
  s_waitcnt vmcnt(0)
  v_max3_u32 v7, v16, v17, v18
  v_max3_u32 v7, v19, v20, v7
  v_max3_u32 v7, v21, v22, v7
  v_max_u32 v7, v7, v23
  v_cmp_eq_u32 vcc, -1, v7
  s_cbranch_vccnz c_fk_36
c_fk1_37:
  s_lshl_b32 s42, s22, 13
  s_add_u32 s42, s42, 245891072
  s_add_u32 s43, s42, 4096
  s_mov_b32 s95, 0
  s_branch c_loop_10
c_xb_25:
  s_cmp_lg_u32 s93, 1
  s_cbranch_scc1 c_xr_26
  s_cmp_ge_u32 s22, 63
  s_cbranch_scc1 c_xr_26
c_xp_38:
  s_cmp_lg_u32 s65, 0
  s_cbranch_scc1 c_xs_39
  buffer_load_dword v7, off, s[4:7], s63 sc1
  s_add_u32 s29, s29, 1
  s_cmp_gt_u32 s29, 1048576
  s_cbranch_scc1 c_fail_16
  s_waitcnt vmcnt(0)
  v_readfirstlane_b32 s65, v7
  s_branch c_xp_38
c_xs_39:
  s_cmp_eq_u32 s65, 1
  s_cbranch_scc1 c_xr_26
  s_mov_b32 s29, 0
c_xw_40:
  buffer_load_dwordx4 v[16:19], v8, s[4:7], s42 offen sc1
  buffer_load_dwordx4 v[20:23], v8, s[4:7], s43 offen sc1
  s_add_u32 s29, s29, 1
  s_cmp_gt_u32 s29, 1048576
  s_cbranch_scc1 c_fail_16
  s_waitcnt vmcnt(0)
  v_max3_u32 v7, v16, v17, v18
  v_max3_u32 v7, v19, v20, v7
  v_max3_u32 v7, v21, v22, v7
  v_max_u32 v7, v7, v23
  v_cmp_eq_u32 vcc, -1, v7
  s_cbranch_vccnz c_xw_40
  v_mov_b32 v7, 1
  s_barrier
  s_mov_b64 exec, 1
  buffer_store_dword v7, off, s[4:7], s64 sc1
  s_mov_b64 exec, -1
  s_add_u32 s22, s22, 1
  s_add_u32 s23, s23, 524288
  s_add_u32 s25, s25, 262144
  s_add_u32 s63, s63, 4096
  s_add_u32 s64, s64, 2048
  s_andn2_b32 s64, s64, s2
  s_mov_b32 s29, 0
  s_sub_u32 s92, s63, 4096
  s_sub_u32 s96, s23, 524288
  s_mov_b32 s95, 0
  s_mov_b32 s95, 1
  s_add_u32 s96, s96, 33554432
  s_add_u32 s92, s92, 262144
c_kvw_42:
  buffer_load_dword v7, off, s[4:7], s92 sc1
  s_add_u32 s29, s29, 1
  s_cmp_gt_u32 s29, 1048576
  s_cbranch_scc1 c_fail_16
  s_waitcnt vmcnt(0) lgkmcnt(0)
  v_readfirstlane_b32 s65, v7
  s_cmp_eq_u32 s65, 0
  s_cbranch_scc1 c_kvw_42
c_kvx_43:
  buffer_load_dword v7, off, s[4:7], s63 sc1
  buffer_load_dwordx4 v0, s[4:7], s96 offen offset:0  lds
  buffer_load_dwordx4 v0, s[4:7], s96 offen offset:1024  lds
  buffer_load_dwordx4 v0, s[4:7], s96 offen offset:2048  lds
  buffer_load_dwordx4 v0, s[4:7], s96 offen offset:3072  lds
  s_waitcnt vmcnt(4)
  v_readfirstlane_b32 s65, v7
  s_mov_b32 s94, 0
  s_branch c_fk1_37
c_last_17:
  s_add_u32 s64, s64, 2048
  v_mov_b32 v7, 1
  s_waitcnt vmcnt(0)
  s_barrier
  s_mov_b64 exec, 1
  buffer_store_dword v7, off, s[4:7], s64 sc1
  s_mov_b64 exec, -1
  s_branch L_chdone
c_oth_29:
  s_buffer_load_dword s65, s[4:7], s63
  ds_read_b128 v[24:27], v1 offset:0
  ds_read_b128 v[28:31], v1 offset:1024
  ds_read_b128 v[32:35], v1 offset:2048
  ds_read_b128 v[36:39], v1 offset:3072
  ds_read_b128 v[40:43], v1 offset:4096
  ds_read_b128 v[44:47], v1 offset:5120
  ds_read_b128 v[72:75], v1 offset:6144
  ds_read_b128 v[76:79], v1 offset:7168
  ds_read_b128 v[80:83], v1 offset:8192
  ds_read_b128 v[84:87], v1 offset:9216
  ds_read_b128 v[88:91], v1 offset:10240
  ds_read_b128 v[92:95], v1 offset:11264
  ds_read_b128 v[96:99], v1 offset:12288
  ds_read_b128 v[100:103], v1 offset:13312
  ds_read_b128 v[104:107], v1 offset:14336
  ds_read_b128 v[108:111], v1 offset:15360
  ds_read_b128 v[112:115], v1 offset:16384
  ds_read_b128 v[116:119], v1 offset:17408
  ds_read_b128 v[120:123], v1 offset:18432
  ds_read_b128 v[124:127], v1 offset:19456
  s_branch c_hop2_13
c_p1r_30:
  s_waitcnt vmcnt(7)
  s_nop 0
  v_mfma_f32_16x16x32_bf16 v[64:67], v[72:75], v[68:71], 0
  v_xor_b32 v7, s3, v72
  s_waitcnt vmcnt(6)
  v_mfma_f32_16x16x32_bf16 v[64:67], v[76:79], v[68:71], v[64:67]
  v_bitop3_b32 v7, v7, v76, s3 bitop3:0xf6
  s_waitcnt vmcnt(5)
  v_mfma_f32_16x16x32_bf16 v[64:67], v[80:83], v[68:71], v[64:67]
  v_bitop3_b32 v7, v7, v80, s3 bitop3:0xf6
  s_waitcnt vmcnt(4)
  v_mfma_f32_16x16x32_bf16 v[64:67], v[84:87], v[68:71], v[64:67]
  v_bitop3_b32 v7, v7, v84, s3 bitop3:0xf6
  s_waitcnt vmcnt(3)
  v_mfma_f32_16x16x32_bf16 v[64:67], v[88:91], v[68:71], v[64:67]
  v_bitop3_b32 v7, v7, v88, s3 bitop3:0xf6
  s_waitcnt vmcnt(2)
  v_mfma_f32_16x16x32_bf16 v[64:67], v[92:95], v[68:71], v[64:67]
  v_bitop3_b32 v7, v7, v92, s3 bitop3:0xf6
  s_waitcnt vmcnt(1)
  v_mfma_f32_16x16x32_bf16 v[64:67], v[96:99], v[68:71], v[64:67]
  v_bitop3_b32 v7, v7, v96, s3 bitop3:0xf6
  s_waitcnt vmcnt(0)
  v_mfma_f32_16x16x32_bf16 v[64:67], v[100:103], v[68:71], v[64:67]
  v_bitop3_b32 v7, v7, v100, s3 bitop3:0xf6
  v_and_b32 v7, 1, v7
  v_cmp_ne_u32 vcc, 0, v7
  s_add_u32 s46, s46, 1
  s_cbranch_vccz c_publ_31
  buffer_load_dwordx4 v[72:75], v0, s[4:7], s38 offen offset:0 sc1
  buffer_load_dwordx4 v[76:79], v0, s[4:7], s38 offen offset:1024 sc1
  buffer_load_dwordx4 v[80:83], v0, s[4:7], s38 offen offset:2048 sc1
  buffer_load_dwordx4 v[84:87], v0, s[4:7], s38 offen offset:3072 sc1
  buffer_load_dwordx4 v[88:91], v0, s[4:7], s39 offen offset:0 sc1
  buffer_load_dwordx4 v[92:95], v0, s[4:7], s39 offen offset:1024 sc1
  buffer_load_dwordx4 v[96:99], v0, s[4:7], s39 offen offset:2048 sc1
  buffer_load_dwordx4 v[100:103], v0, s[4:7], s39 offen offset:3072 sc1
  s_add_u32 s28, s28, 1
  s_cmp_gt_u32 s28, 1048576
  s_cbranch_scc0 c_p1r_30
  s_branch c_fail_16
c_retry_11:
  v_mov_b64 v[48:49], 0
  v_mov_b64 v[50:51], 0
  s_nop 0
  v_mov_b64 v[52:53], 0
  v_mov_b64 v[54:55], 0
  s_nop 1
  v_mov_b64 v[56:57], 0
  v_mov_b64 v[58:59], 0
c_rl_44:
  buffer_load_dwordx4 v[16:19], v8, s[4:7], s42 offen sc1
  buffer_load_dwordx4 v[20:23], v8, s[4:7], s43 offen sc1
  s_add_u32 s28, s28, 1
  s_add_u32 s47, s47, 1
  s_cmp_gt_u32 s28, 1048576
  s_cbranch_scc1 c_fail_16
  s_waitcnt vmcnt(2)
  v_max3_u32 v7, v16, v17, v18
  v_max3_u32 v7, v19, v20, v7
  v_max3_u32 v7, v21, v22, v7
  v_max_u32 v7, v7, v23
  v_cmp_eq_u32 vcc, -1, v7
  s_cbranch_vccnz c_rl_44
  ds_write_b128 v8, v[16:19] offset:4096
  v_smfmac_f32_16x16x64_bf16 v[48:51], v[16:19], v[24:31], v6
  ds_write_b128 v8, v[20:23] offset:8192
  v_smfmac_f32_16x16x64_bf16 v[52:55], v[16:19], v[32:39], v6
  v_smfmac_f32_16x16x64_bf16 v[56:59], v[16:19], v[40:47], v6
  s_branch c_got_12
c_fb_14:
  v_max3_f32 v7, v48, v49, v50
  v_max_f32 v7, v51, v7
  s_mov_b64 exec, s[18:19]
  v_max3_f32 v7, v16, v17, v7
  s_mov_b64 exec, -1
  s_nop 0
  v_max_f32_dpp v7, v7, v7 quad_perm:[2,3,0,1] row_mask:0xf bank_mask:0xf
  v_mov_b32 v24, v7
  s_nop 0
  s_nop 0
  v_permlane16_swap_b32 v7, v24
  v_max_f32 v7, v7, v24
  v_mov_b32 v24, v7
  s_nop 0
  s_nop 0
  v_permlane32_swap_b32 v7, v24
  v_max_f32 v7, v7, v24
  v_sub_f32 v24, v48, v7
  v_sub_f32 v25, v49, v7
  v_sub_f32 v26, v50, v7
  v_sub_f32 v27, v51, v7
  v_sub_f32 v28, v16, v7
  v_sub_f32 v29, v17, v7
  v_exp_f32 v24, v24
  v_exp_f32 v25, v25
  v_exp_f32 v26, v26
  v_exp_f32 v27, v27
  v_exp_f32 v28, v28
  v_exp_f32 v29, v29
  v_cvt_pk_bf16_f32 v24, v24, v25
  v_cvt_pk_bf16_f32 v25, v26, v27
  v_cvt_pk_bf16_f32 v28, v28, v29
  v_cndmask_b32 v72, v24, 0, s[18:19]
  v_cndmask_b32 v73, v25, 0, s[18:19]
  v_cndmask_b32 v74, 0, v24, s[18:19]
  v_cndmask_b32 v75, 0, v25, s[18:19]
  v_cndmask_b32 v77, 0, v28, s[18:19]
  v_cndmask_b32 v78, 0, v28, s[18:19]
  v_mfma_f32_16x16x32_bf16 v[60:63], v[72:75], v[20:23], 0
  v_mfma_f32_16x16x32_bf16 v[52:55], v[72:75], v[80:83], 0
  v_mfma_f32_16x16x32_bf16 v[56:59], v[72:75], v[84:87], 0
  v_mfma_f32_16x16x16_bf16 v[60:63], v[76:77], v[20:21], v[60:63]
  v_mfma_f32_16x16x16_bf16 v[52:55], v[78:79], v[66:67], v[52:55]
  s_nop 2
  v_mfma_f32_16x16x16_bf16 v[56:59], v[76:77], v[66:67], v[56:59]
  s_nop 7
  v_add_f32 v60, v60, v62
  v_add_f32 v61, v61, v63
  s_branch c_fbr_15
c_fail_16:
  s_endpgm
L_chain_x:
  s_mov_b32 s22, 0
  s_mov_b32 s21, 0
  s_mov_b32 s42, s62
  s_add_u32 s43, s62, 4096
  s_mov_b32 s46, 0
  s_mov_b32 s47, 0
  s_lshl_b32 s26, s16, 2
  s_add_u32 s26, s26, s17
  s_lshl_b32 s27, s60, 13
  s_add_u32 s27, s27, s26
  s_lshr_b32 s25, s27, 2
  s_lshl_b32 s25, s25, 13
  s_add_u32 s25, s25, 192937984
  s_lshr_b32 s64, s27, 2
  s_lshl_b32 s64, s64, 6
  s_add_u32 s64, s64, 513538048
  s_cmp_eq_u32 s17, 3
  s_cselect_b32 s2, 268435456, 0
  s_lshl_b32 s27, s61, 13
  s_add_u32 s27, s27, s26
  s_lshl_b32 s23, s27, 12
  s_add_u32 s23, s23, 41943040
  s_lshl_b32 s63, s27, 5
  s_add_u32 s63, s63, 244318208
  s_mov_b32 s97, 268435456
  s_cmp_eq_u32 s60, 2
  s_cselect_b32 s20, 262144, s97
  s_cselect_b32 s93, 1, 3
  s_lshl_b32 s26, s17, 2
  s_add_u32 s26, s26, s60
  s_cmp_eq_u32 s26, 1
  s_cselect_b32 s97, 245891072, s97
  s_mov_b32 s95, 0
  s_mov_b32 s96, s23
  s_add_u32 s23, s23, 524288
  s_add_u32 s63, s63, 4096
  s_cmp_eq_u32 s66, 0
  s_cbranch_scc1 c_pk_53
  s_sub_u32 s96, s23, 524288
  s_mov_b32 s65, s67
  s_mov_b32 s94, 0
  buffer_load_dwordx4 v0, s[4:7], s96 offen offset:0  lds
  buffer_load_dwordx4 v0, s[4:7], s96 offen offset:1024  lds
  buffer_load_dwordx4 v0, s[4:7], s96 offen offset:2048  lds
  buffer_load_dwordx4 v0, s[4:7], s96 offen offset:3072  lds
  s_branch c_pk2_54
c_pk_53:
  s_mov_b32 s29, 0
  s_sub_u32 s92, s63, 4096
  s_sub_u32 s96, s23, 524288
  s_mov_b32 s95, 0
c_gw_55:
  buffer_load_dword v7, off, s[4:7], s92 sc1
  s_add_u32 s29, s29, 1
  s_cmp_gt_u32 s29, 1048576
  s_cbranch_scc1 c_fail_51
  s_waitcnt vmcnt(0) lgkmcnt(0)
  v_readfirstlane_b32 s65, v7
  s_cmp_eq_u32 s65, 0
  s_cbranch_scc1 c_gw_55
  s_and_b32 s65, s65, s93
  s_cbranch_scc1 c_kvx_57
  s_mov_b32 s95, 1
  s_add_u32 s96, s96, 33554432
  s_add_u32 s92, s92, 262144
c_kvw_56:
  buffer_load_dword v7, off, s[4:7], s92 sc1
  s_add_u32 s29, s29, 1
  s_cmp_gt_u32 s29, 1048576
  s_cbranch_scc1 c_fail_51
  s_waitcnt vmcnt(0) lgkmcnt(0)
  v_readfirstlane_b32 s65, v7
  s_cmp_eq_u32 s65, 0
  s_cbranch_scc1 c_kvw_56
c_kvx_57:
  buffer_load_dword v7, off, s[4:7], s63 sc1
  buffer_load_dwordx4 v0, s[4:7], s96 offen offset:0  lds
  buffer_load_dwordx4 v0, s[4:7], s96 offen offset:1024  lds
  buffer_load_dwordx4 v0, s[4:7], s96 offen offset:2048  lds
  buffer_load_dwordx4 v0, s[4:7], s96 offen offset:3072  lds
  s_waitcnt vmcnt(4)
  v_readfirstlane_b32 s65, v7
  s_mov_b32 s94, 0
c_pk2_54:
  s_waitcnt vmcnt(4)
  ds_read_b128 v[72:75], v1 offset:6144
  ds_read_b128 v[76:79], v1 offset:7168
  ds_read_b128 v[80:83], v1 offset:8192
  ds_read_b128 v[84:87], v1 offset:9216
  ds_read_b128 v[88:91], v1 offset:10240
  ds_read_b128 v[92:95], v1 offset:11264
  ds_read_b128 v[96:99], v1 offset:12288
  ds_read_b128 v[100:103], v1 offset:13312
  ds_read_b128 v[104:107], v1 offset:14336
  ds_read_b128 v[108:111], v1 offset:15360
  ds_read_b128 v[112:115], v1 offset:16384
  ds_read_b128 v[116:119], v1 offset:17408
  ds_read_b128 v[120:123], v1 offset:18432
  ds_read_b128 v[124:127], v1 offset:19456
  v_mov_b64 v[48:49], 0
  v_mov_b64 v[50:51], 0
  v_mov_b64 v[52:53], 0
  v_mov_b64 v[54:55], 0
  v_mov_b64 v[56:57], 0
  v_mov_b64 v[58:59], 0
  v_mov_b64 v[60:61], 0
  v_mov_b64 v[62:63], 0
  v_mov_b64 v[64:65], 0
  v_mov_b64 v[66:67], 0
  v_mov_b64 v[68:69], 0
  v_mov_b64 v[70:71], 0
  s_lshl_b32 s38, s16, 13
  s_add_u32 s38, s38, s40
  s_add_u32 s39, s38, 4096
  ds_read_b128 v[24:27], v1 offset:0
  ds_read_b128 v[28:31], v1 offset:1024
  ds_read_b128 v[32:35], v1 offset:2048
  ds_read_b128 v[36:39], v1 offset:3072
  ds_read_b128 v[40:43], v1 offset:4096
  ds_read_b128 v[44:47], v1 offset:5120
  s_waitcnt lgkmcnt(0)
c_loop_45:
  buffer_load_dwordx4 v[16:19], v8, s[4:7], s42 offen sc1
  buffer_load_dwordx4 v[20:23], v8, s[4:7], s43 offen sc1
  s_mov_b32 s28, 0
  v_mov_b64 v[48:49], 0
  v_mov_b64 v[50:51], 0
  v_mov_b64 v[52:53], 0
  v_mov_b64 v[54:55], 0
  v_mov_b64 v[56:57], 0
  v_mov_b64 v[58:59], 0
  v_mov_b64 v[60:61], 0
  v_mov_b64 v[62:63], 0
  v_mov_b64 v[64:65], 0
  v_mov_b64 v[66:67], 0
  v_mov_b64 v[68:69], 0
  v_mov_b64 v[70:71], 0
  buffer_load_dwordx4 v[16:19], v8, s[4:7], s42 offen sc1
  buffer_load_dwordx4 v[20:23], v8, s[4:7], s43 offen sc1
  s_waitcnt lgkmcnt(0)
  s_and_b32 s29, s65, s93
  s_cbranch_scc0 c_xb_60
c_xr_61:
  s_waitcnt vmcnt(3)
  v_max3_u32 v7, v16, v17, v18
  v_max_u32 v7, v7, v19
  ds_write_b128 v8, v[16:19] offset:4096
  v_smfmac_f32_16x16x64_bf16 v[48:51], v[16:19], v[24:31], v6
  s_waitcnt vmcnt(2)
  v_max3_u32 v7, v20, v21, v7
  v_max3_u32 v7, v22, v23, v7
  ds_write_b128 v8, v[20:23] offset:8192
  v_smfmac_f32_16x16x64_bf16 v[52:55], v[16:19], v[32:39], v6
  v_cmp_eq_u32 vcc, -1, v7
  v_smfmac_f32_16x16x64_bf16 v[56:59], v[16:19], v[40:47], v6
  s_cbranch_vccnz c_retry_46
c_got_47:
  v_smfmac_f32_16x16x64_bf16 v[60:63], v[16:19], v[72:79], v6
  ds_read_b128 v[72:75], v1 offset:20480
  s_and_b32 s65, s65, s93
  s_cselect_b32 s96, s23, 268435456
  v_smfmac_f32_16x16x64_bf16 v[48:51], v[20:23], v[80:87], v6
  ds_read_b128 v[76:79], v1 offset:21504
  v_mov_b32 v7, 1
  v_smfmac_f32_16x16x64_bf16 v[52:55], v[20:23], v[88:95], v6
  ds_read_b128 v[80:83], v1 offset:22528
  v_smfmac_f32_16x16x64_bf16 v[56:59], v[20:23], v[96:103], v6
  ds_read_b128 v[84:87], v1 offset:23552
  s_waitcnt lgkmcnt(4)
  s_barrier
  ds_read_b128 v[24:27], v9 offset:4096
  ds_read_b128 v[28:31], v10 offset:4096
  v_smfmac_f32_16x16x64_bf16 v[60:63], v[20:23], v[104:111], v6
  ds_read_b128 v[32:35], v11 offset:4096
  v_smfmac_f32_16x16x64_bf16 v[64:67], v[16:19], v[112:119], v6
  ds_read_b128 v[36:39], v9 offset:8192
  v_smfmac_f32_16x16x64_bf16 v[68:71], v[16:19], v[120:127], v6
  ds_read_b128 v[40:43], v10 offset:8192
  v_smfmac_f32_16x16x64_bf16 v[64:67], v[20:23], v[208:215], v6
  ds_read_b128 v[44:47], v11 offset:8192
  s_waitcnt lgkmcnt(5)
  v_smfmac_f32_16x16x64_bf16 v[48:51], v[24:27], a[168:175], v6
  buffer_load_dwordx4 v0, s[4:7], s96 offen offset:0  lds
  s_waitcnt lgkmcnt(4)
  v_smfmac_f32_16x16x64_bf16 v[48:51], v[28:31], a[160:167], v6
  ds_read_b128 v[104:107], v8 offset:16384
  s_waitcnt lgkmcnt(4)
  v_smfmac_f32_16x16x64_bf16 v[48:51], v[32:35], a[152:159], v6
  buffer_load_dwordx4 v0, s[4:7], s96 offen offset:1024  lds
  s_waitcnt lgkmcnt(3)
  v_smfmac_f32_16x16x64_bf16 v[48:51], v[36:39], a[144:151], v6
  ds_read_b128 v[108:111], v8 offset:20480
  s_waitcnt lgkmcnt(3)
  v_smfmac_f32_16x16x64_bf16 v[48:51], v[40:43], a[136:143], v6
  buffer_load_dwordx4 v0, s[4:7], s96 offen offset:2048  lds
  s_waitcnt lgkmcnt(2)
  v_smfmac_f32_16x16x64_bf16 v[48:51], v[44:47], a[128:135], v6
  v_smfmac_f32_16x16x64_bf16 v[52:55], v[24:27], a[120:127], v6
  buffer_load_dwordx4 v0, s[4:7], s96 offen offset:3072  lds
  v_smfmac_f32_16x16x64_bf16 v[52:55], v[28:31], a[112:119], v6
  ds_read_b64 v[100:101], v5 offset:4096
  v_add_f32 v48, v48, v50
  v_smfmac_f32_16x16x64_bf16 v[52:55], v[32:35], a[104:111], v6
  ds_read_b128 v[112:115], v8 offset:24576
  v_add_f32 v49, v49, v51
  v_smfmac_f32_16x16x64_bf16 v[52:55], v[36:39], a[96:103], v6
  ds_read_b128 v[116:119], v8 offset:28672
  v_cvt_pk_bf16_f32 v50, v48, v49
  v_smfmac_f32_16x16x64_bf16 v[52:55], v[40:43], a[88:95], v6
  ds_write2_b32 v2, v50, v50 offset0:0 offset1:1
  v_smfmac_f32_16x16x64_bf16 v[52:55], v[44:47], a[80:87], v6
  ds_read_b64_tr_b16 v[88:89], v12 offset:0
  v_smfmac_f32_16x16x64_bf16 v[56:59], v[24:27], a[72:79], v6
  s_mov_b64 exec, 1
  buffer_store_dword v7, off, s[4:7], s64 sc1
  s_mov_b64 exec, -1
  v_smfmac_f32_16x16x64_bf16 v[56:59], v[28:31], a[64:71], v6
  ds_read_b128 v[120:123], v8 offset:32768
  v_add_f32 v52, v52, v54
  v_smfmac_f32_16x16x64_bf16 v[56:59], v[32:35], a[56:63], v6
  ds_read_b128 v[124:127], v8 offset:36864
  v_add_f32 v53, v53, v55
  v_cvt_pk_bf16_f32 v54, v52, v53
  v_smfmac_f32_16x16x64_bf16 v[56:59], v[36:39], a[48:55], v6
  ds_write2_b32 v2, v54, v54 offset0:128 offset1:129
  ds_read_b64_tr_b16 v[90:91], v12 offset:512
  v_smfmac_f32_16x16x64_bf16 v[56:59], v[40:43], a[40:47], v6
  v_smfmac_f32_16x16x64_bf16 v[56:59], v[44:47], a[32:39], v6
  v_smfmac_f32_16x16x64_bf16 v[60:63], v[24:27], a[24:31], v6
  v_smfmac_f32_16x16x64_bf16 v[60:63], v[28:31], a[16:23], v6
  s_waitcnt lgkmcnt(0)
  v_add_f32 v56, v56, v58
  v_mfma_f32_16x16x32_bf16 v[92:95], v[72:75], v[88:91], 0
  buffer_store_dwordx2 v[100:101], v5, s[4:7], s97 offen sc1
  v_add_f32 v57, v57, v59
  v_cvt_pk_bf16_f32 v58, v56, v57
  v_mfma_f32_16x16x32_bf16 v[96:99], v[76:79], v[88:91], 0
  ds_write_b32 v2, v58
  v_smfmac_f32_16x16x64_bf16 v[60:63], v[32:35], a[8:15], v6
  v_mov_b32 v76, 0
  v_smfmac_f32_16x16x64_bf16 v[60:63], v[36:39], a[0:7], v6
  v_cndmask_b32 v48, v92, v96, s[18:19]
  v_smfmac_f32_16x16x64_bf16 v[60:63], v[40:43], v[248:255], v6
  v_cndmask_b32 v49, v93, v97, s[18:19]
  v_smfmac_f32_16x16x64_bf16 v[60:63], v[44:47], v[240:247], v6
  v_cndmask_b32 v50, v94, v98, s[18:19]
  v_smfmac_f32_16x16x64_bf16 v[68:71], v[20:23], v[152:159], v6
  v_cndmask_b32 v51, v95, v99, s[18:19]
  v_smfmac_f32_16x16x64_bf16 v[64:67], v[24:27], v[232:239], v6
  ds_write_b128 v8, v[48:51] offset:12288
  v_add_f32 v60, v60, v62
  v_add_f32 v61, v61, v63
  v_cvt_pk_bf16_f32 v62, v60, v61
  v_smfmac_f32_16x16x64_bf16 v[64:67], v[28:31], v[224:231], v6
  ds_write_b32 v2, v62 offset:512
  s_waitcnt vmcnt(6)
  v_mov_b32 v79, 0
  v_smfmac_f32_16x16x64_bf16 v[64:67], v[32:35], v[216:223], v6
  v_mov_b64 v[20:21], s[14:15]
  v_smfmac_f32_16x16x64_bf16 v[64:67], v[36:39], v[200:207], v6
  v_mov_b64 v[22:23], s[14:15]
  v_smfmac_f32_16x16x64_bf16 v[64:67], v[40:43], v[192:199], v6
  s_waitcnt lgkmcnt(0)
  s_barrier
  ds_read_b128 v[52:55], v9 offset:12288
  ds_read_b128 v[56:59], v10 offset:12288
  v_smfmac_f32_16x16x64_bf16 v[64:67], v[44:47], v[184:191], v6
  ds_read_b128 v[60:63], v11 offset:12288
  v_smfmac_f32_16x16x64_bf16 v[68:71], v[24:27], v[176:183], v6
  ds_read_b64_tr_b16 v[88:89], v12 offset:0
  ds_read_b64_tr_b16 v[90:91], v12 offset:512
  v_smfmac_f32_16x16x64_bf16 v[68:71], v[28:31], v[168:175], v6
  ds_read_b64_tr_b16 v[92:93], v13 offset:0
  ds_read_b64_tr_b16 v[94:95], v13 offset:512
  v_add_f32 v64, v64, v66
  v_smfmac_f32_16x16x64_bf16 v[68:71], v[32:35], v[160:167], v6
  ds_read_b64_tr_b16 v[96:97], v14 offset:0
  ds_read_b64_tr_b16 v[98:99], v14 offset:512
  v_add_f32 v65, v65, v67
  v_smfmac_f32_16x16x64_bf16 v[68:71], v[36:39], v[144:151], v6
  ds_read_b64_tr_b16 v[100:101], v15 offset:0
  ds_read_b64_tr_b16 v[102:103], v15 offset:512
  s_waitcnt lgkmcnt(8)
  v_cvt_pk_bf16_f32 v66, v64, v65
  v_smfmac_f32_16x16x64_bf16 v[68:71], v[40:43], v[136:143], v6
  v_add_f32 v48, v48, v52
  v_smfmac_f32_16x16x64_bf16 v[68:71], v[44:47], v[128:135], v6
  s_waitcnt lgkmcnt(4)
  v_add_f32 v49, v49, v53
  v_mfma_f32_16x16x32_bf16 v[16:19], v[88:91], v[88:91], 0
  buffer_store_dwordx4 v[88:91], v8, s[4:7], s25 offen sc1
  v_add_f32 v50, v50, v54
  v_add_f32 v51, v51, v55
  v_mfma_f32_16x16x32_bf16 v[16:19], v[92:95], v[92:95], v[16:19]
  s_waitcnt lgkmcnt(0)
  v_add_f32 v56, v56, v60
  v_add_f32 v57, v57, v61
  v_mfma_f32_16x16x32_bf16 v[16:19], v[96:99], v[96:99], v[16:19]
  v_add_f32 v58, v58, v62
  v_add_f32 v59, v59, v63
  v_mfma_f32_16x16x32_bf16 v[16:19], v[100:103], v[100:103], v[16:19]
  v_add_f32 v48, v48, v56
  v_add_f32 v49, v49, v57
  v_add_f32 v50, v50, v58
  v_add_f32 v51, v51, v59
  v_exp_f32 v24, v48
  v_exp_f32 v25, v49
  v_exp_f32 v26, v50
  v_exp_f32 v27, v51
  v_cvt_pk_bf16_f32 v24, v24, v25
  v_mul_f32 v16, s24, v16
  v_cvt_pk_bf16_f32 v25, v26, v27
  v_cndmask_b32 v72, v24, 0, s[18:19]
  v_cndmask_b32 v73, v25, 0, s[18:19]
  v_cndmask_b32 v74, 0, v24, s[18:19]
  v_cndmask_b32 v75, 0, v25, s[18:19]
  v_mul_f32 v17, s24, v17
  v_exp_f32 v28, v16
  v_mfma_f32_16x16x32_bf16 v[60:63], v[72:75], v[20:23], 0
  v_exp_f32 v29, v17
  v_add_f32 v68, v68, v70
  v_mfma_f32_16x16x32_bf16 v[52:55], v[72:75], v[80:83], 0
  s_add_u32 s30, s25, 4096
  v_cvt_pk_bf16_f32 v28, v28, v29
  v_add_f32 v69, v69, v71
  v_mfma_f32_16x16x32_bf16 v[56:59], v[72:75], v[84:87], 0
  v_cndmask_b32 v77, 0, v28, s[18:19]
  v_cndmask_b32 v78, 0, v28, s[18:19]
  v_cvt_pk_bf16_f32 v67, v68, v69
  v_lshrrev_b32 v92, 1, v8
  v_mfma_f32_16x16x16_bf16 v[60:63], v[76:77], v[20:21], v[60:63]
  buffer_store_dwordx2 v[66:67], v92, s[4:7], s30 offen sc1
  v_max3_f32 v7, |v48|, |v49|, |v50|
  v_max_f32 v26, |v16|, |v17|
  v_mfma_f32_16x16x16_bf16 v[52:55], v[78:79], v[66:67], v[52:55]
  v_cndmask_b32 v26, 0, v26, s[18:19]
  v_max3_f32 v7, |v51|, v26, v7
  v_mfma_f32_16x16x16_bf16 v[56:59], v[76:77], v[66:67], v[56:59]
  v_cmp_lt_f32 vcc, 0x42700000, v7
  v_mov_b64 v[44:45], 0
  v_add_f32 v60, v60, v62
  v_add_f32 v61, v61, v63
  s_cbranch_vccnz c_fb_49
c_fbr_50:
  v_rcp_f32 v60, v60
  v_rcp_f32 v61, v61
  v_pk_add_f32 v[52:53], v[52:53], v[54:55]
  v_pk_add_f32 v[56:57], v[56:57], v[58:59]
  v_pk_mul_f32 v[52:53], v[52:53], v[60:61]
  v_pk_mul_f32 v[56:57], v[56:57], v[60:61]
  v_cvt_pk_bf16_f32 v54, v52, v53
  v_cvt_pk_bf16_f32 v55, v56, v57
  ds_write_b64 v2, v[54:55] offset:4096
  v_mov_b64 v[46:47], 0
  v_mov_b64 v[40:41], 0
  v_mov_b64 v[42:43], 0
  v_mov_b64 v[36:37], 0
  v_mov_b64 v[38:39], 0
  v_mov_b64 v[32:33], 0
  v_mov_b64 v[34:35], 0
  v_mov_b64 v[28:29], 0
  v_mov_b64 v[30:31], 0
  v_mov_b64 v[24:25], 0
  v_mov_b64 v[26:27], 0
  v_mov_b64 v[80:81], 0
  v_mov_b64 v[82:83], 0
  v_mov_b64 v[84:85], 0
  v_mov_b64 v[86:87], 0
  s_waitcnt lgkmcnt(0)
  s_barrier
  ds_read_b64_tr_b16 v[72:73], v3 offset:4096
  ds_read_b64_tr_b16 v[74:75], v3 offset:5120
  ds_read_b64_tr_b16 v[76:77], v3 offset:6144
  ds_read_b64_tr_b16 v[78:79], v3 offset:7168
  s_and_b32 s3, s21, 1
  s_add_u32 s21, s21, 1
  s_add_u32 s22, s22, 1
  s_and_b32 s42, s21, 3
  s_lshl_b32 s42, s42, 13
  s_cmp_eq_u32 s22, 64
  s_cbranch_scc1 c_last_52
  s_waitcnt lgkmcnt(2)
  v_smfmac_f32_16x16x64_bf16 v[44:47], v[72:75], a[248:255], v6
  s_waitcnt lgkmcnt(0)
  ds_read_b128 v[16:19], v8 offset:40960
  v_smfmac_f32_16x16x64_bf16 v[44:47], v[76:79], a[240:247], v6
  ds_read_b128 v[20:23], v8 offset:45056
  v_smfmac_f32_16x16x64_bf16 v[40:43], v[72:75], a[232:239], v6
  ds_read_b128 v[88:91], v8 offset:49152
  v_smfmac_f32_16x16x64_bf16 v[40:43], v[76:79], a[224:231], v6
  ds_read_b128 v[92:95], v8 offset:53248
  v_add_f32 v44, v44, v46
  v_add_f32 v45, v45, v47
  v_smfmac_f32_16x16x64_bf16 v[36:39], v[72:75], a[216:223], v6
  ds_read_b128 v[96:99], v8 offset:57344
  v_cvt_pk_bf16_f32 v48, v44, v45
  v_and_or_b32 v48, v48, -2, s3
  v_smfmac_f32_16x16x64_bf16 v[36:39], v[76:79], a[208:215], v6
  ds_read_b128 v[100:103], v8 offset:61440
  v_add_f32 v40, v40, v42
  v_add_f32 v41, v41, v43
  v_smfmac_f32_16x16x64_bf16 v[32:35], v[72:75], a[200:207], v6
  v_cvt_pk_bf16_f32 v49, v40, v41
  v_smfmac_f32_16x16x64_bf16 v[32:35], v[76:79], a[192:199], v6
  v_add_f32 v36, v36, v38
  v_add_f32 v37, v37, v39
  v_smfmac_f32_16x16x64_bf16 v[28:31], v[72:75], a[184:191], v6
  v_cvt_pk_bf16_f32 v50, v36, v37
  v_smfmac_f32_16x16x64_bf16 v[28:31], v[76:79], a[176:183], v6
  v_add_f32 v32, v32, v34
  v_add_f32 v33, v33, v35
  v_smfmac_f32_16x16x64_bf16 v[24:27], v[72:75], v[104:111], v6
  v_cvt_pk_bf16_f32 v51, v32, v33
  v_smfmac_f32_16x16x64_bf16 v[24:27], v[76:79], v[112:119], v6
  buffer_store_dwordx4 v[48:51], v4, s[4:7], s40 offen sc1
  v_add_f32 v28, v28, v30
  v_add_f32 v29, v29, v31
  v_smfmac_f32_16x16x64_bf16 v[80:83], v[72:75], v[120:127], v6
  s_waitcnt lgkmcnt(0)
  v_cvt_pk_bf16_f32 v52, v28, v29
  v_and_or_b32 v52, v52, -2, s3
  v_smfmac_f32_16x16x64_bf16 v[80:83], v[76:79], v[16:23], v6
  v_add_f32 v24, v24, v26
  v_add_f32 v25, v25, v27
  v_smfmac_f32_16x16x64_bf16 v[84:87], v[72:75], v[88:95], v6
  v_cvt_pk_bf16_f32 v53, v24, v25
  v_smfmac_f32_16x16x64_bf16 v[84:87], v[76:79], v[96:103], v6
  v_add_f32 v80, v80, v82
  v_add_f32 v81, v81, v83
  v_cvt_pk_bf16_f32 v54, v80, v81
  s_nop 0
  s_nop 3
  v_pk_add_f32 v[84:85], v[84:85], v[86:87]
  v_cvt_pk_bf16_f32 v55, v84, v85
  buffer_store_dwordx4 v[52:55], v4, s[4:7], s41 offen sc1
  s_add_u32 s42, s42, s62
  s_add_u32 s43, s42, 4096
  s_add_u32 s23, s23, 524288
  s_add_u32 s25, s25, 262144
  s_add_u32 s63, s63, 4096
  s_add_u32 s64, s64, 2048
  s_andn2_b32 s64, s64, s2
  s_add_u32 s97, s97, 8192
  s_add_u32 s92, s63, s20
  s_cmp_lg_u32 s17, 0
  s_cbranch_scc1 c_oth_64
  s_mov_b32 s28, 0
  s_add_u32 s46, s46, 1
  v_mov_b64 v[64:65], -1
  s_xor_b32 s34, s42, 16384
  buffer_store_dwordx2 v[64:65], v5, s[4:7], s34 offen sc1
  s_mov_b32 vcc_lo, 0xaaaaaaaa
  s_mov_b32 vcc_hi, 0xaaaaaaaa
  v_mov_b32 v7, 0x3f80
  v_cndmask_b32 v7, v7, 1.0, vcc
  s_mov_b32 vcc_lo, 0x30003
  s_mov_b32 vcc_hi, 0x30003
  v_cndmask_b32 v68, 0, v7, vcc
  s_mov_b32 vcc_lo, 0xc000c
  s_mov_b32 vcc_hi, 0xc000c
  v_cndmask_b32 v69, 0, v7, vcc
  s_mov_b32 vcc_lo, 0x300030
  s_mov_b32 vcc_hi, 0x300030
  v_cndmask_b32 v70, 0, v7, vcc
  s_mov_b32 vcc_lo, 0xc000c0
  s_mov_b32 vcc_hi, 0xc000c0
  v_cndmask_b32 v71, 0, v7, vcc
  ds_read_b128 v[112:115], v1 offset:16384
  ds_read_b128 v[116:119], v1 offset:17408
  s_waitcnt lgkmcnt(0)
  ds_read_b128 v[120:123], v1 offset:18432
  ds_read_b128 v[124:127], v1 offset:19456
  s_waitcnt lgkmcnt(0)
  buffer_load_dwordx4 v[16:19], v0, s[4:7], s38 offen offset:0 sc1
  buffer_load_dwordx4 v[20:23], v0, s[4:7], s38 offen offset:1024 sc1
  buffer_load_dwordx4 v[24:27], v0, s[4:7], s38 offen offset:2048 sc1
  buffer_load_dwordx4 v[28:31], v0, s[4:7], s38 offen offset:3072 sc1
  buffer_load_dwordx4 v[32:35], v0, s[4:7], s39 offen offset:0 sc1
  buffer_load_dwordx4 v[36:39], v0, s[4:7], s39 offen offset:1024 sc1
  buffer_load_dwordx4 v[40:43], v0, s[4:7], s39 offen offset:2048 sc1
  buffer_load_dwordx4 v[44:47], v0, s[4:7], s39 offen offset:3072 sc1
  buffer_load_dwordx4 v[72:75], v0, s[4:7], s38 offen offset:0 sc1
  buffer_load_dwordx4 v[76:79], v0, s[4:7], s38 offen offset:1024 sc1
  buffer_load_dwordx4 v[80:83], v0, s[4:7], s38 offen offset:2048 sc1
  buffer_load_dwordx4 v[84:87], v0, s[4:7], s38 offen offset:3072 sc1
  buffer_load_dwordx4 v[88:91], v0, s[4:7], s39 offen offset:0 sc1
  buffer_load_dwordx4 v[92:95], v0, s[4:7], s39 offen offset:1024 sc1
  buffer_load_dwordx4 v[96:99], v0, s[4:7], s39 offen offset:2048 sc1
  buffer_load_dwordx4 v[100:103], v0, s[4:7], s39 offen offset:3072 sc1
  s_buffer_load_dword s65, s[4:7], s63
  s_waitcnt vmcnt(15)
  v_mfma_f32_16x16x32_bf16 v[64:67], v[16:19], v[68:71], 0
  v_xor_b32 v7, s3, v16
  s_waitcnt vmcnt(14)
  v_mfma_f32_16x16x32_bf16 v[64:67], v[20:23], v[68:71], v[64:67]
  v_bitop3_b32 v7, v7, v20, s3 bitop3:0xf6
  s_waitcnt vmcnt(13)
  v_mfma_f32_16x16x32_bf16 v[64:67], v[24:27], v[68:71], v[64:67]
  v_bitop3_b32 v7, v7, v24, s3 bitop3:0xf6
  s_waitcnt vmcnt(12)
  v_mfma_f32_16x16x32_bf16 v[64:67], v[28:31], v[68:71], v[64:67]
  v_bitop3_b32 v7, v7, v28, s3 bitop3:0xf6
  s_waitcnt vmcnt(11)
  v_mfma_f32_16x16x32_bf16 v[64:67], v[32:35], v[68:71], v[64:67]
  v_bitop3_b32 v7, v7, v32, s3 bitop3:0xf6
  s_waitcnt vmcnt(10)
  v_mfma_f32_16x16x32_bf16 v[64:67], v[36:39], v[68:71], v[64:67]
  v_bitop3_b32 v7, v7, v36, s3 bitop3:0xf6
  s_waitcnt vmcnt(9)
  v_mfma_f32_16x16x32_bf16 v[64:67], v[40:43], v[68:71], v[64:67]
  v_bitop3_b32 v7, v7, v40, s3 bitop3:0xf6
  s_waitcnt vmcnt(8)
  v_mfma_f32_16x16x32_bf16 v[64:67], v[44:47], v[68:71], v[64:67]
  v_bitop3_b32 v7, v7, v44, s3 bitop3:0xf6
  v_and_b32 v7, 1, v7
  v_cmp_ne_u32 vcc, 0, v7
  v_mov_b32 v7, 0
  v_mov_b32 v7, 0
  s_cbranch_vccnz c_p1r_65
c_publ_66:
  s_nop 1
  s_nop 0
  v_cvt_pk_bf16_f32 v64, v64, v65
  v_cvt_pk_bf16_f32 v65, v66, v67
  v_min_u32 v64, -2, v64
  v_min_u32 v65, -2, v65
  buffer_store_dwordx2 v[64:65], v5, s[4:7], s42 offen sc1
  s_waitcnt vmcnt(1)
  ds_read_b128 v[24:27], v1 offset:0
  ds_read_b128 v[28:31], v1 offset:1024
  ds_read_b128 v[32:35], v1 offset:2048
  ds_read_b128 v[36:39], v1 offset:3072
  ds_read_b128 v[40:43], v1 offset:4096
  ds_read_b128 v[44:47], v1 offset:5120
  ds_read_b128 v[72:75], v1 offset:6144
  ds_read_b128 v[76:79], v1 offset:7168
  ds_read_b128 v[80:83], v1 offset:8192
  ds_read_b128 v[84:87], v1 offset:9216
  ds_read_b128 v[88:91], v1 offset:10240
  ds_read_b128 v[92:95], v1 offset:11264
  ds_read_b128 v[96:99], v1 offset:12288
  ds_read_b128 v[100:103], v1 offset:13312
  ds_read_b128 v[104:107], v1 offset:14336
  ds_read_b128 v[108:111], v1 offset:15360
c_hop2_48:
  s_barrier
  s_cmp_le_u32 s96, s23
  s_cbranch_scc1 c_loop_45
  s_cmp_lg_u32 s96, 268435456
  s_cbranch_scc1 c_fk0_67
  buffer_store_dwordx2 v[64:65], v5, s[4:7], s97 offen sc1
  s_mov_b32 s29, 0
  s_sub_u32 s92, s63, 4096
  s_sub_u32 s96, s23, 524288
  s_mov_b32 s95, 0
c_gw_68:
  buffer_load_dword v7, off, s[4:7], s92 sc1
  s_add_u32 s29, s29, 1
  s_cmp_gt_u32 s29, 1048576
  s_cbranch_scc1 c_fail_51
  s_waitcnt vmcnt(0) lgkmcnt(0)
  v_readfirstlane_b32 s65, v7
  s_cmp_eq_u32 s65, 0
  s_cbranch_scc1 c_gw_68
  s_and_b32 s65, s65, s93
  s_cbranch_scc1 c_kvx_70
  s_mov_b32 s95, 1
  s_add_u32 s96, s96, 33554432
  s_add_u32 s92, s92, 262144
c_kvw_69:
  buffer_load_dword v7, off, s[4:7], s92 sc1
  s_add_u32 s29, s29, 1
  s_cmp_gt_u32 s29, 1048576
  s_cbranch_scc1 c_fail_51
  s_waitcnt vmcnt(0) lgkmcnt(0)
  v_readfirstlane_b32 s65, v7
  s_cmp_eq_u32 s65, 0
  s_cbranch_scc1 c_kvw_69
c_kvx_70:
  buffer_load_dword v7, off, s[4:7], s63 sc1
  buffer_load_dwordx4 v0, s[4:7], s96 offen offset:0  lds
  buffer_load_dwordx4 v0, s[4:7], s96 offen offset:1024  lds
  buffer_load_dwordx4 v0, s[4:7], s96 offen offset:2048  lds
  buffer_load_dwordx4 v0, s[4:7], s96 offen offset:3072  lds
  s_waitcnt vmcnt(4)
  v_readfirstlane_b32 s65, v7
  s_mov_b32 s94, 0
  s_cmp_eq_u32 s95, 0
  s_cbranch_scc1 c_loop_45
c_fk0_67:
  s_mov_b32 s29, 0
c_fk_71:
  buffer_load_dwordx4 v[16:19], v8, s[4:7], s42 offen sc1
  buffer_load_dwordx4 v[20:23], v8, s[4:7], s43 offen sc1
  s_add_u32 s29, s29, 1
  s_cmp_gt_u32 s29, 1048576
  s_cbranch_scc1 c_fail_51
  s_waitcnt vmcnt(0)
  v_max3_u32 v7, v16, v17, v18
  v_max3_u32 v7, v19, v20, v7
  v_max3_u32 v7, v21, v22, v7
  v_max_u32 v7, v7, v23
  v_cmp_eq_u32 vcc, -1, v7
  s_cbranch_vccnz c_fk_71
c_fk1_72:
  s_lshl_b32 s42, s22, 13
  s_add_u32 s42, s42, 245891072
  s_add_u32 s43, s42, 4096
  s_mov_b32 s95, 0
  s_branch c_loop_45
c_xb_60:
  s_cmp_lg_u32 s93, 1
  s_cbranch_scc1 c_xr_61
  s_cmp_ge_u32 s22, 63
  s_cbranch_scc1 c_xr_61
c_xp_73:
  s_cmp_lg_u32 s65, 0
  s_cbranch_scc1 c_xs_74
  buffer_load_dword v7, off, s[4:7], s63 sc1
  s_add_u32 s29, s29, 1
  s_cmp_gt_u32 s29, 1048576
  s_cbranch_scc1 c_fail_51
  s_waitcnt vmcnt(0)
  v_readfirstlane_b32 s65, v7
  s_branch c_xp_73
c_xs_74:
  s_cmp_eq_u32 s65, 1
  s_cbranch_scc1 c_xr_61
  s_mov_b32 s29, 0
c_xw_75:
  buffer_load_dwordx4 v[16:19], v8, s[4:7], s42 offen sc1
  buffer_load_dwordx4 v[20:23], v8, s[4:7], s43 offen sc1
  s_add_u32 s29, s29, 1
  s_cmp_gt_u32 s29, 1048576
  s_cbranch_scc1 c_fail_51
  s_waitcnt vmcnt(0)
  v_max3_u32 v7, v16, v17, v18
  v_max3_u32 v7, v19, v20, v7
  v_max3_u32 v7, v21, v22, v7
  v_max_u32 v7, v7, v23
  v_cmp_eq_u32 vcc, -1, v7
  s_cbranch_vccnz c_xw_75
  v_mov_b32 v7, 1
  s_barrier
  s_mov_b64 exec, 1
  buffer_store_dword v7, off, s[4:7], s64 sc1
  s_mov_b64 exec, -1
  s_add_u32 s22, s22, 1
  s_add_u32 s23, s23, 524288
  s_add_u32 s25, s25, 262144
  s_add_u32 s63, s63, 4096
  s_add_u32 s64, s64, 2048
  s_andn2_b32 s64, s64, s2
  s_mov_b32 s29, 0
  s_sub_u32 s92, s63, 4096
  s_sub_u32 s96, s23, 524288
  s_mov_b32 s95, 0
  s_mov_b32 s95, 1
  s_add_u32 s96, s96, 33554432
  s_add_u32 s92, s92, 262144
c_kvw_77:
  buffer_load_dword v7, off, s[4:7], s92 sc1
  s_add_u32 s29, s29, 1
  s_cmp_gt_u32 s29, 1048576
  s_cbranch_scc1 c_fail_51
  s_waitcnt vmcnt(0) lgkmcnt(0)
  v_readfirstlane_b32 s65, v7
  s_cmp_eq_u32 s65, 0
  s_cbranch_scc1 c_kvw_77
c_kvx_78:
  buffer_load_dword v7, off, s[4:7], s63 sc1
  buffer_load_dwordx4 v0, s[4:7], s96 offen offset:0  lds
  buffer_load_dwordx4 v0, s[4:7], s96 offen offset:1024  lds
  buffer_load_dwordx4 v0, s[4:7], s96 offen offset:2048  lds
  buffer_load_dwordx4 v0, s[4:7], s96 offen offset:3072  lds
  s_waitcnt vmcnt(4)
  v_readfirstlane_b32 s65, v7
  s_mov_b32 s94, 0
  s_branch c_fk1_72
c_last_52:
  s_add_u32 s64, s64, 2048
  v_mov_b32 v7, 1
  s_waitcnt vmcnt(0)
  s_barrier
  s_mov_b64 exec, 1
  buffer_store_dword v7, off, s[4:7], s64 sc1
  s_mov_b64 exec, -1
  s_branch L_chdone
c_oth_64:
  s_buffer_load_dword s65, s[4:7], s63
  ds_read_b128 v[24:27], v1 offset:0
  ds_read_b128 v[28:31], v1 offset:1024
  ds_read_b128 v[32:35], v1 offset:2048
  ds_read_b128 v[36:39], v1 offset:3072
  ds_read_b128 v[40:43], v1 offset:4096
  ds_read_b128 v[44:47], v1 offset:5120
  ds_read_b128 v[72:75], v1 offset:6144
  ds_read_b128 v[76:79], v1 offset:7168
  ds_read_b128 v[80:83], v1 offset:8192
  ds_read_b128 v[84:87], v1 offset:9216
  ds_read_b128 v[88:91], v1 offset:10240
  ds_read_b128 v[92:95], v1 offset:11264
  ds_read_b128 v[96:99], v1 offset:12288
  ds_read_b128 v[100:103], v1 offset:13312
  ds_read_b128 v[104:107], v1 offset:14336
  ds_read_b128 v[108:111], v1 offset:15360
  ds_read_b128 v[112:115], v1 offset:16384
  ds_read_b128 v[116:119], v1 offset:17408
  ds_read_b128 v[120:123], v1 offset:18432
  ds_read_b128 v[124:127], v1 offset:19456
  s_branch c_hop2_48
c_p1r_65:
  s_waitcnt vmcnt(7)
  s_nop 0
  v_mfma_f32_16x16x32_bf16 v[64:67], v[72:75], v[68:71], 0
  v_xor_b32 v7, s3, v72
  s_waitcnt vmcnt(6)
  v_mfma_f32_16x16x32_bf16 v[64:67], v[76:79], v[68:71], v[64:67]
  v_bitop3_b32 v7, v7, v76, s3 bitop3:0xf6
  s_waitcnt vmcnt(5)
  v_mfma_f32_16x16x32_bf16 v[64:67], v[80:83], v[68:71], v[64:67]
  v_bitop3_b32 v7, v7, v80, s3 bitop3:0xf6
  s_waitcnt vmcnt(4)
  v_mfma_f32_16x16x32_bf16 v[64:67], v[84:87], v[68:71], v[64:67]
  v_bitop3_b32 v7, v7, v84, s3 bitop3:0xf6
  s_waitcnt vmcnt(3)
  v_mfma_f32_16x16x32_bf16 v[64:67], v[88:91], v[68:71], v[64:67]
  v_bitop3_b32 v7, v7, v88, s3 bitop3:0xf6
  s_waitcnt vmcnt(2)
  v_mfma_f32_16x16x32_bf16 v[64:67], v[92:95], v[68:71], v[64:67]
  v_bitop3_b32 v7, v7, v92, s3 bitop3:0xf6
  s_waitcnt vmcnt(1)
  v_mfma_f32_16x16x32_bf16 v[64:67], v[96:99], v[68:71], v[64:67]
  v_bitop3_b32 v7, v7, v96, s3 bitop3:0xf6
  s_waitcnt vmcnt(0)
  v_mfma_f32_16x16x32_bf16 v[64:67], v[100:103], v[68:71], v[64:67]
  v_bitop3_b32 v7, v7, v100, s3 bitop3:0xf6
  v_and_b32 v7, 1, v7
  v_cmp_ne_u32 vcc, 0, v7
  s_add_u32 s46, s46, 1
  s_cbranch_vccz c_publ_66
  buffer_load_dwordx4 v[72:75], v0, s[4:7], s38 offen offset:0 sc1
  buffer_load_dwordx4 v[76:79], v0, s[4:7], s38 offen offset:1024 sc1
  buffer_load_dwordx4 v[80:83], v0, s[4:7], s38 offen offset:2048 sc1
  buffer_load_dwordx4 v[84:87], v0, s[4:7], s38 offen offset:3072 sc1
  buffer_load_dwordx4 v[88:91], v0, s[4:7], s39 offen offset:0 sc1
  buffer_load_dwordx4 v[92:95], v0, s[4:7], s39 offen offset:1024 sc1
  buffer_load_dwordx4 v[96:99], v0, s[4:7], s39 offen offset:2048 sc1
  buffer_load_dwordx4 v[100:103], v0, s[4:7], s39 offen offset:3072 sc1
  s_add_u32 s28, s28, 1
  s_cmp_gt_u32 s28, 1048576
  s_cbranch_scc0 c_p1r_65
  s_branch c_fail_51
c_retry_46:
  v_mov_b64 v[48:49], 0
  v_mov_b64 v[50:51], 0
  s_nop 0
  v_mov_b64 v[52:53], 0
  v_mov_b64 v[54:55], 0
  s_nop 1
  v_mov_b64 v[56:57], 0
  v_mov_b64 v[58:59], 0
c_rl_79:
  buffer_load_dwordx4 v[16:19], v8, s[4:7], s42 offen sc1
  buffer_load_dwordx4 v[20:23], v8, s[4:7], s43 offen sc1
  s_add_u32 s28, s28, 1
  s_add_u32 s47, s47, 1
  s_cmp_gt_u32 s28, 1048576
  s_cbranch_scc1 c_fail_51
  s_waitcnt vmcnt(2)
  v_max3_u32 v7, v16, v17, v18
  v_max3_u32 v7, v19, v20, v7
  v_max3_u32 v7, v21, v22, v7
  v_max_u32 v7, v7, v23
  v_cmp_eq_u32 vcc, -1, v7
  s_cbranch_vccnz c_rl_79
  ds_write_b128 v8, v[16:19] offset:4096
  v_smfmac_f32_16x16x64_bf16 v[48:51], v[16:19], v[24:31], v6
  ds_write_b128 v8, v[20:23] offset:8192
  v_smfmac_f32_16x16x64_bf16 v[52:55], v[16:19], v[32:39], v6
  v_smfmac_f32_16x16x64_bf16 v[56:59], v[16:19], v[40:47], v6
  s_branch c_got_47
c_fb_49:
  v_max3_f32 v7, v48, v49, v50
  v_max_f32 v7, v51, v7
  s_mov_b64 exec, s[18:19]
  v_max3_f32 v7, v16, v17, v7
  s_mov_b64 exec, -1
  s_nop 0
  v_max_f32_dpp v7, v7, v7 quad_perm:[2,3,0,1] row_mask:0xf bank_mask:0xf
  v_mov_b32 v24, v7
  s_nop 0
  s_nop 0
  v_permlane16_swap_b32 v7, v24
  v_max_f32 v7, v7, v24
  v_mov_b32 v24, v7
  s_nop 0
  s_nop 0
  v_permlane32_swap_b32 v7, v24
  v_max_f32 v7, v7, v24
  v_sub_f32 v24, v48, v7
  v_sub_f32 v25, v49, v7
  v_sub_f32 v26, v50, v7
  v_sub_f32 v27, v51, v7
  v_sub_f32 v28, v16, v7
  v_sub_f32 v29, v17, v7
  v_exp_f32 v24, v24
  v_exp_f32 v25, v25
  v_exp_f32 v26, v26
  v_exp_f32 v27, v27
  v_exp_f32 v28, v28
  v_exp_f32 v29, v29
  v_cvt_pk_bf16_f32 v24, v24, v25
  v_cvt_pk_bf16_f32 v25, v26, v27
  v_cvt_pk_bf16_f32 v28, v28, v29
  v_cndmask_b32 v72, v24, 0, s[18:19]
  v_cndmask_b32 v73, v25, 0, s[18:19]
  v_cndmask_b32 v74, 0, v24, s[18:19]
  v_cndmask_b32 v75, 0, v25, s[18:19]
  v_cndmask_b32 v77, 0, v28, s[18:19]
  v_cndmask_b32 v78, 0, v28, s[18:19]
  v_mfma_f32_16x16x32_bf16 v[60:63], v[72:75], v[20:23], 0
  v_mfma_f32_16x16x32_bf16 v[52:55], v[72:75], v[80:83], 0
  v_mfma_f32_16x16x32_bf16 v[56:59], v[72:75], v[84:87], 0
  v_mfma_f32_16x16x16_bf16 v[60:63], v[76:77], v[20:21], v[60:63]
  v_mfma_f32_16x16x16_bf16 v[52:55], v[78:79], v[66:67], v[52:55]
  s_nop 2
  v_mfma_f32_16x16x16_bf16 v[56:59], v[76:77], v[66:67], v[56:59]
  s_nop 7
  v_add_f32 v60, v60, v62
  v_add_f32 v61, v61, v63
  s_branch c_fbr_50
c_fail_51:
  s_endpgm
L_chdone:
  s_cmp_lg_u32 s91, 0
  s_cbranch_scc1 L_end
  s_lshr_b32 s91, s90, 4
  s_add_u32 s91, s91, 7
  v_lshrrev_b32 v0, 4, v0
  s_waitcnt vmcnt(0) lgkmcnt(0)
  v_mbcnt_lo_u32_b32 v20, -1, 0
  v_and_b32 v20, 3, v20
  v_add_lshl_u32 v20, v20, 0, 2
  s_mov_b32 s26, 0
g_wt_80:
  global_load_dword v21, v20, s[12:13] offset:128 sc1
  s_add_u32 s26, s26, 1
  s_cmp_gt_u32 s26, 1048576
  s_cbranch_scc1 L_end
  s_waitcnt vmcnt(0)
  v_cmp_eq_u32 vcc, 0, v21
  v_readfirstlane_b32 s27, v21
  s_cbranch_vccnz g_wt_80
  s_mov_b32 s89, s27
  s_branch L_o
L_qkv:
  s_mul_i32 s26, s91, 15
  s_add_u32 s26, s26, s90
  s_sub_u32 s26, s26, 61
  s_add_u32 s27, s91, 89
  s_cmp_eq_u32 s90, 31
  s_cselect_b32 s26, s27, s26
  s_add_u32 s27, s90, 60
  s_cmp_eq_u32 s91, 7
  s_cselect_b32 s26, s27, s26
  s_mul_i32 s16, s26, 171
  s_lshr_b32 s16, s16, 9
  s_mul_i32 s27, s16, 3
  s_sub_u32 s60, s26, s27
  s_add_u32 s16, s16, 4
  s_and_b32 s16, s16, 31
  v_and_b32 v19, 63, v0
  v_and_b32 v6, 15, v19
  v_lshrrev_b32 v7, 4, v19
  v_lshlrev_b32 v1, 2, v19
  v_lshlrev_b32 v0, 4, v19
  v_lshlrev_b32 v9, 7, v19
  s_mov_b32 s24, 0x3e0293ee
  s_lshl_b32 s57, s16, 2
  s_add_u32 s57, s57, s17
  v_and_b32 v24, 1, v7
  v_lshlrev_b32 v24, 10, v24
  v_lshl_add_u32 v24, v6, 4, v24
  v_lshrrev_b32 v25, 1, v7
  v_lshl_add_u32 v8, v25, 8, v24
  v_lshrrev_b32 v96, 9, v0
  v_lshlrev_b32 v96, 4, v96
  v_and_b32 v97, 0xf0, v0
  v_xor_b32 v96, v96, v97
  v_and_b32 v97, 0x1f0, v0
  v_lshl_add_u32 v96, v97, 6, v96
  v_xor_b32 v120, 0, v96
  v_xor_b32 v121, 32, v96
  v_xor_b32 v122, 64, v96
  v_xor_b32 v123, 96, v96
  v_xor_b32 v124, 128, v96
  v_xor_b32 v125, 160, v96
  v_xor_b32 v126, 192, v96
  v_xor_b32 v127, 224, v96
  s_and_b32 s26, s17, 1
  s_lshl_b32 s26, s26, 7
  v_xor_b32 v96, s26, v0
  v_xor_b32 v12, 0, v96
  v_xor_b32 v13, 16, v96
  v_xor_b32 v14, 32, v96
  v_xor_b32 v15, 48, v96
  v_xor_b32 v16, 64, v96
  v_xor_b32 v17, 80, v96
  v_xor_b32 v18, 96, v96
  v_xor_b32 v19, 112, v96
  s_lshl_b32 s26, s17, 2
  s_add_u32 s26, s26, 162816
  v_lshrrev_b32 v24, 7, v0
  v_lshl_add_u32 v118, v24, 4, s26
  v_and_b32 v24, 48, v0
  v_add_u32 v119, 162816, v24
  v_lshrrev_b32 v25, 8, v0
  v_and_b32 v20, 0xf0, v0
  v_lshlrev_b32 v21, 6, v25
  v_xor_b32 v20, v20, v21
  v_lshl_add_u32 v20, v25, 13, v20
  v_xor_b32 v21, 32, v20
  s_load_dwordx2 s[64:65], s[0:1], 24
  s_load_dwordx2 s[68:69], s[0:1], 32
  s_load_dwordx2 s[8:9], s[0:1], 16
  s_mov_b32 s10, 4194304
  s_mov_b32 s11, 0x20000
  s_mov_b32 s66, 4194304
  s_mov_b32 s67, 0x20000
  s_mov_b32 s70, 4194304
  s_mov_b32 s71, 0x20000
  v_lshrrev_b32 v25, 2, v6
  v_lshrrev_b32 v26, 1, v7
  v_lshl_add_u32 v27, v26, 3, v25
  v_lshlrev_b32 v27, 8, v27
  v_lshl_add_u32 v26, v25, 1, v26
  v_and_b32 v25, 1, v7
  v_xor_b32 v26, v26, v25
  s_lshl_b32 s26, s17, 1
  v_xor_b32 v26, s26, v26
  v_lshl_add_u32 v27, v26, 5, v27
  v_and_b32 v25, 3, v6
  v_lshl_add_u32 v22, v25, 3, v27
  v_add_u32 v23, 65536, v22
  v_add_u32 v24, 131072, v22
  s_lshl_b32 s28, s17, 13
  s_lshl_b32 s26, s17, 18
  s_lshl_b32 s27, s16, 8
  s_add_u32 s26, s26, s27
  s_waitcnt lgkmcnt(0)
  s_cmp_eq_u32 s60, 1
  s_cbranch_scc1 q_ld_82
  s_cmp_eq_u32 s60, 2
  s_cbranch_scc1 q_ld_83
q_ld_81:
  s_add_u32 s27, s26, 0
  s_add_u32 m0, s28, 0
  s_nop 0
  buffer_load_dwordx4 v20, s[64:67], s27 offen lds
  s_add_u32 m0, s28, 1024
  s_add_u32 s27, s27, 32768
  buffer_load_dwordx4 v20, s[64:67], s27 offen lds
  s_add_u32 m0, s28, 2048
  s_add_u32 s27, s27, 32768
  buffer_load_dwordx4 v21, s[64:67], s27 offen lds
  s_add_u32 m0, s28, 3072
  s_add_u32 s27, s27, 32768
  buffer_load_dwordx4 v21, s[64:67], s27 offen lds
  s_add_u32 m0, s28, 4096
  s_add_u32 s27, s27, 32768
  buffer_load_dwordx4 v20, s[64:67], s27 offen lds
  s_add_u32 m0, s28, 5120
  s_add_u32 s27, s27, 32768
  buffer_load_dwordx4 v20, s[64:67], s27 offen lds
  s_add_u32 m0, s28, 6144
  s_add_u32 s27, s27, 32768
  buffer_load_dwordx4 v21, s[64:67], s27 offen lds
  s_add_u32 m0, s28, 7168
  s_add_u32 s27, s27, 32768
  buffer_load_dwordx4 v21, s[64:67], s27 offen lds
  s_add_u32 s27, s26, 1048576
  s_add_u32 m0, s28, 32768
  s_nop 0
  buffer_load_dwordx4 v20, s[64:67], s27 offen lds
  s_add_u32 m0, s28, 33792
  s_add_u32 s27, s27, 32768
  buffer_load_dwordx4 v20, s[64:67], s27 offen lds
  s_add_u32 m0, s28, 34816
  s_add_u32 s27, s27, 32768
  buffer_load_dwordx4 v21, s[64:67], s27 offen lds
  s_add_u32 m0, s28, 35840
  s_add_u32 s27, s27, 32768
  buffer_load_dwordx4 v21, s[64:67], s27 offen lds
  s_add_u32 m0, s28, 36864
  s_add_u32 s27, s27, 32768
  buffer_load_dwordx4 v20, s[64:67], s27 offen lds
  s_add_u32 m0, s28, 37888
  s_add_u32 s27, s27, 32768
  buffer_load_dwordx4 v20, s[64:67], s27 offen lds
  s_add_u32 m0, s28, 38912
  s_add_u32 s27, s27, 32768
  buffer_load_dwordx4 v21, s[64:67], s27 offen lds
  s_add_u32 m0, s28, 39936
  s_add_u32 s27, s27, 32768
  buffer_load_dwordx4 v21, s[64:67], s27 offen lds
  s_add_u32 s27, s26, 2097152
  s_add_u32 m0, s28, 65536
  s_nop 0
  buffer_load_dwordx4 v20, s[64:67], s27 offen lds
  s_add_u32 m0, s28, 66560
  s_add_u32 s27, s27, 32768
  buffer_load_dwordx4 v20, s[64:67], s27 offen lds
  s_add_u32 m0, s28, 67584
  s_add_u32 s27, s27, 32768
  buffer_load_dwordx4 v21, s[64:67], s27 offen lds
  s_add_u32 m0, s28, 68608
  s_add_u32 s27, s27, 32768
  buffer_load_dwordx4 v21, s[64:67], s27 offen lds
  s_add_u32 m0, s28, 69632
  s_add_u32 s27, s27, 32768
  buffer_load_dwordx4 v20, s[64:67], s27 offen lds
  s_add_u32 m0, s28, 70656
  s_add_u32 s27, s27, 32768
  buffer_load_dwordx4 v20, s[64:67], s27 offen lds
  s_add_u32 m0, s28, 71680
  s_add_u32 s27, s27, 32768
  buffer_load_dwordx4 v21, s[64:67], s27 offen lds
  s_add_u32 m0, s28, 72704
  s_add_u32 s27, s27, 32768
  buffer_load_dwordx4 v21, s[64:67], s27 offen lds
  s_load_dwordx2 s[4:5], s[0:1], 112
  s_load_dwordx2 s[12:13], s[0:1], 104
  s_waitcnt vmcnt(16)
  s_barrier
  s_add_u32 s27, s26, 3145728
  s_add_u32 m0, s28, 98304
  s_nop 0
  buffer_load_dwordx4 v20, s[64:67], s27 offen lds
  s_add_u32 m0, s28, 99328
  s_add_u32 s27, s27, 32768
  buffer_load_dwordx4 v20, s[64:67], s27 offen lds
  s_add_u32 m0, s28, 100352
  s_add_u32 s27, s27, 32768
  buffer_load_dwordx4 v21, s[64:67], s27 offen lds
  s_add_u32 m0, s28, 101376
  s_add_u32 s27, s27, 32768
  buffer_load_dwordx4 v21, s[64:67], s27 offen lds
  s_add_u32 m0, s28, 102400
  s_add_u32 s27, s27, 32768
  buffer_load_dwordx4 v20, s[64:67], s27 offen lds
  s_add_u32 m0, s28, 103424
  s_add_u32 s27, s27, 32768
  buffer_load_dwordx4 v20, s[64:67], s27 offen lds
  s_add_u32 m0, s28, 104448
  s_add_u32 s27, s27, 32768
  buffer_load_dwordx4 v21, s[64:67], s27 offen lds
  s_add_u32 m0, s28, 105472
  s_add_u32 s27, s27, 32768
  buffer_load_dwordx4 v21, s[64:67], s27 offen lds
  ds_read_b64_tr_b16 v[128:129], v22 offset:0
  ds_read_b64_tr_b16 v[130:131], v22 offset:1024
  ds_read_b64_tr_b16 v[132:133], v22 offset:4096
  ds_read_b64_tr_b16 v[134:135], v22 offset:5120
  ds_read_b64_tr_b16 v[136:137], v22 offset:8192
  ds_read_b64_tr_b16 v[138:139], v22 offset:9216
  ds_read_b64_tr_b16 v[140:141], v22 offset:12288
  ds_read_b64_tr_b16 v[142:143], v22 offset:13312
  ds_read_b64_tr_b16 v[144:145], v22 offset:16384
  ds_read_b64_tr_b16 v[146:147], v22 offset:17408
  ds_read_b64_tr_b16 v[148:149], v22 offset:20480
  ds_read_b64_tr_b16 v[150:151], v22 offset:21504
  ds_read_b64_tr_b16 v[152:153], v22 offset:24576
  ds_read_b64_tr_b16 v[154:155], v22 offset:25600
  ds_read_b64_tr_b16 v[156:157], v22 offset:28672
  ds_read_b64_tr_b16 v[158:159], v22 offset:29696
  s_waitcnt lgkmcnt(0)
  s_waitcnt vmcnt(16)
  s_barrier
  s_add_u32 s27, s26, 0
  s_add_u32 m0, s28, 131072
  s_nop 0
  buffer_load_dwordx4 v20, s[68:71], s27 offen lds
  s_add_u32 m0, s28, 132096
  s_add_u32 s27, s27, 32768
  buffer_load_dwordx4 v20, s[68:71], s27 offen lds
  s_add_u32 m0, s28, 133120
  s_add_u32 s27, s27, 32768
  buffer_load_dwordx4 v21, s[68:71], s27 offen lds
  s_add_u32 m0, s28, 134144
  s_add_u32 s27, s27, 32768
  buffer_load_dwordx4 v21, s[68:71], s27 offen lds
  s_add_u32 m0, s28, 135168
  s_add_u32 s27, s27, 32768
  buffer_load_dwordx4 v20, s[68:71], s27 offen lds
  s_add_u32 m0, s28, 136192
  s_add_u32 s27, s27, 32768
  buffer_load_dwordx4 v20, s[68:71], s27 offen lds
  s_add_u32 m0, s28, 137216
  s_add_u32 s27, s27, 32768
  buffer_load_dwordx4 v21, s[68:71], s27 offen lds
  s_add_u32 m0, s28, 138240
  s_add_u32 s27, s27, 32768
  buffer_load_dwordx4 v21, s[68:71], s27 offen lds
  ds_read_b64_tr_b16 v[160:161], v22 offset:32768
  ds_read_b64_tr_b16 v[162:163], v22 offset:33792
  ds_read_b64_tr_b16 v[164:165], v22 offset:36864
  ds_read_b64_tr_b16 v[166:167], v22 offset:37888
  ds_read_b64_tr_b16 v[168:169], v22 offset:40960
  ds_read_b64_tr_b16 v[170:171], v22 offset:41984
  ds_read_b64_tr_b16 v[172:173], v22 offset:45056
  ds_read_b64_tr_b16 v[174:175], v22 offset:46080
  ds_read_b64_tr_b16 v[176:177], v22 offset:49152
  ds_read_b64_tr_b16 v[178:179], v22 offset:50176
  ds_read_b64_tr_b16 v[180:181], v22 offset:53248
  ds_read_b64_tr_b16 v[182:183], v22 offset:54272
  ds_read_b64_tr_b16 v[184:185], v22 offset:57344
  ds_read_b64_tr_b16 v[186:187], v22 offset:58368
  ds_read_b64_tr_b16 v[188:189], v22 offset:61440
  ds_read_b64_tr_b16 v[190:191], v22 offset:62464
  s_waitcnt lgkmcnt(0)
  s_waitcnt vmcnt(16)
  s_barrier
  s_add_u32 s27, s26, 1048576
  s_add_u32 m0, s28, 0
  s_nop 0
  buffer_load_dwordx4 v20, s[68:71], s27 offen lds
  s_add_u32 m0, s28, 1024
  s_add_u32 s27, s27, 32768
  buffer_load_dwordx4 v20, s[68:71], s27 offen lds
  s_add_u32 m0, s28, 2048
  s_add_u32 s27, s27, 32768
  buffer_load_dwordx4 v21, s[68:71], s27 offen lds
  s_add_u32 m0, s28, 3072
  s_add_u32 s27, s27, 32768
  buffer_load_dwordx4 v21, s[68:71], s27 offen lds
  s_add_u32 m0, s28, 4096
  s_add_u32 s27, s27, 32768
  buffer_load_dwordx4 v20, s[68:71], s27 offen lds
  s_add_u32 m0, s28, 5120
  s_add_u32 s27, s27, 32768
  buffer_load_dwordx4 v20, s[68:71], s27 offen lds
  s_add_u32 m0, s28, 6144
  s_add_u32 s27, s27, 32768
  buffer_load_dwordx4 v21, s[68:71], s27 offen lds
  s_add_u32 m0, s28, 7168
  s_add_u32 s27, s27, 32768
  buffer_load_dwordx4 v21, s[68:71], s27 offen lds
  ds_read_b64_tr_b16 v[192:193], v23 offset:0
  ds_read_b64_tr_b16 v[194:195], v23 offset:1024
  ds_read_b64_tr_b16 v[196:197], v23 offset:4096
  ds_read_b64_tr_b16 v[198:199], v23 offset:5120
  ds_read_b64_tr_b16 v[200:201], v23 offset:8192
  ds_read_b64_tr_b16 v[202:203], v23 offset:9216
  ds_read_b64_tr_b16 v[204:205], v23 offset:12288
  ds_read_b64_tr_b16 v[206:207], v23 offset:13312
  ds_read_b64_tr_b16 v[208:209], v23 offset:16384
  ds_read_b64_tr_b16 v[210:211], v23 offset:17408
  ds_read_b64_tr_b16 v[212:213], v23 offset:20480
  ds_read_b64_tr_b16 v[214:215], v23 offset:21504
  ds_read_b64_tr_b16 v[216:217], v23 offset:24576
  ds_read_b64_tr_b16 v[218:219], v23 offset:25600
  ds_read_b64_tr_b16 v[220:221], v23 offset:28672
  ds_read_b64_tr_b16 v[222:223], v23 offset:29696
  s_waitcnt lgkmcnt(0)
  s_waitcnt vmcnt(16)
  s_barrier
  s_add_u32 s27, s26, 2097152
  s_add_u32 m0, s28, 32768
  s_nop 0
  buffer_load_dwordx4 v20, s[68:71], s27 offen lds
  s_add_u32 m0, s28, 33792
  s_add_u32 s27, s27, 32768
  buffer_load_dwordx4 v20, s[68:71], s27 offen lds
  s_add_u32 m0, s28, 34816
  s_add_u32 s27, s27, 32768
  buffer_load_dwordx4 v21, s[68:71], s27 offen lds
  s_add_u32 m0, s28, 35840
  s_add_u32 s27, s27, 32768
  buffer_load_dwordx4 v21, s[68:71], s27 offen lds
  s_add_u32 m0, s28, 36864
  s_add_u32 s27, s27, 32768
  buffer_load_dwordx4 v20, s[68:71], s27 offen lds
  s_add_u32 m0, s28, 37888
  s_add_u32 s27, s27, 32768
  buffer_load_dwordx4 v20, s[68:71], s27 offen lds
  s_add_u32 m0, s28, 38912
  s_add_u32 s27, s27, 32768
  buffer_load_dwordx4 v21, s[68:71], s27 offen lds
  s_add_u32 m0, s28, 39936
  s_add_u32 s27, s27, 32768
  buffer_load_dwordx4 v21, s[68:71], s27 offen lds
  ds_read_b64_tr_b16 v[224:225], v23 offset:32768
  ds_read_b64_tr_b16 v[226:227], v23 offset:33792
  ds_read_b64_tr_b16 v[228:229], v23 offset:36864
  ds_read_b64_tr_b16 v[230:231], v23 offset:37888
  ds_read_b64_tr_b16 v[232:233], v23 offset:40960
  ds_read_b64_tr_b16 v[234:235], v23 offset:41984
  ds_read_b64_tr_b16 v[236:237], v23 offset:45056
  ds_read_b64_tr_b16 v[238:239], v23 offset:46080
  ds_read_b64_tr_b16 v[240:241], v23 offset:49152
  ds_read_b64_tr_b16 v[242:243], v23 offset:50176
  ds_read_b64_tr_b16 v[244:245], v23 offset:53248
  ds_read_b64_tr_b16 v[246:247], v23 offset:54272
  ds_read_b64_tr_b16 v[248:249], v23 offset:57344
  ds_read_b64_tr_b16 v[250:251], v23 offset:58368
  ds_read_b64_tr_b16 v[252:253], v23 offset:61440
  ds_read_b64_tr_b16 v[254:255], v23 offset:62464
  s_waitcnt lgkmcnt(0)
  s_waitcnt vmcnt(16)
  s_barrier
  s_add_u32 s27, s26, 3145728
  s_add_u32 m0, s28, 65536
  s_nop 0
  buffer_load_dwordx4 v20, s[68:71], s27 offen lds
  s_add_u32 m0, s28, 66560
  s_add_u32 s27, s27, 32768
  buffer_load_dwordx4 v20, s[68:71], s27 offen lds
  s_add_u32 m0, s28, 67584
  s_add_u32 s27, s27, 32768
  buffer_load_dwordx4 v21, s[68:71], s27 offen lds
  s_add_u32 m0, s28, 68608
  s_add_u32 s27, s27, 32768
  buffer_load_dwordx4 v21, s[68:71], s27 offen lds
  s_add_u32 m0, s28, 69632
  s_add_u32 s27, s27, 32768
  buffer_load_dwordx4 v20, s[68:71], s27 offen lds
  s_add_u32 m0, s28, 70656
  s_add_u32 s27, s27, 32768
  buffer_load_dwordx4 v20, s[68:71], s27 offen lds
  s_add_u32 m0, s28, 71680
  s_add_u32 s27, s27, 32768
  buffer_load_dwordx4 v21, s[68:71], s27 offen lds
  s_add_u32 m0, s28, 72704
  s_add_u32 s27, s27, 32768
  buffer_load_dwordx4 v21, s[68:71], s27 offen lds
  ds_read_b64_tr_b16 a[0:1], v24 offset:0
  ds_read_b64_tr_b16 a[2:3], v24 offset:1024
  ds_read_b64_tr_b16 a[4:5], v24 offset:4096
  ds_read_b64_tr_b16 a[6:7], v24 offset:5120
  ds_read_b64_tr_b16 a[8:9], v24 offset:8192
  ds_read_b64_tr_b16 a[10:11], v24 offset:9216
  ds_read_b64_tr_b16 a[12:13], v24 offset:12288
  ds_read_b64_tr_b16 a[14:15], v24 offset:13312
  ds_read_b64_tr_b16 a[16:17], v24 offset:16384
  ds_read_b64_tr_b16 a[18:19], v24 offset:17408
  ds_read_b64_tr_b16 a[20:21], v24 offset:20480
  ds_read_b64_tr_b16 a[22:23], v24 offset:21504
  ds_read_b64_tr_b16 a[24:25], v24 offset:24576
  ds_read_b64_tr_b16 a[26:27], v24 offset:25600
  ds_read_b64_tr_b16 a[28:29], v24 offset:28672
  ds_read_b64_tr_b16 a[30:31], v24 offset:29696
  s_waitcnt lgkmcnt(0)
  s_waitcnt vmcnt(16)
  s_barrier
  s_add_u32 s27, s26, 0
  s_add_u32 m0, s28, 98304
  s_nop 0
  buffer_load_dwordx4 v20, s[8:11], s27 offen lds
  s_add_u32 m0, s28, 99328
  s_add_u32 s27, s27, 32768
  buffer_load_dwordx4 v20, s[8:11], s27 offen lds
  s_add_u32 m0, s28, 100352
  s_add_u32 s27, s27, 32768
  buffer_load_dwordx4 v21, s[8:11], s27 offen lds
  s_add_u32 m0, s28, 101376
  s_add_u32 s27, s27, 32768
  buffer_load_dwordx4 v21, s[8:11], s27 offen lds
  s_add_u32 m0, s28, 102400
  s_add_u32 s27, s27, 32768
  buffer_load_dwordx4 v20, s[8:11], s27 offen lds
  s_add_u32 m0, s28, 103424
  s_add_u32 s27, s27, 32768
  buffer_load_dwordx4 v20, s[8:11], s27 offen lds
  s_add_u32 m0, s28, 104448
  s_add_u32 s27, s27, 32768
  buffer_load_dwordx4 v21, s[8:11], s27 offen lds
  s_add_u32 m0, s28, 105472
  s_add_u32 s27, s27, 32768
  buffer_load_dwordx4 v21, s[8:11], s27 offen lds
  ds_read_b64_tr_b16 a[32:33], v22 offset:0
  ds_read_b64_tr_b16 a[34:35], v22 offset:1024
  ds_read_b64_tr_b16 a[36:37], v22 offset:4096
  ds_read_b64_tr_b16 a[38:39], v22 offset:5120
  ds_read_b64_tr_b16 a[40:41], v22 offset:8192
  ds_read_b64_tr_b16 a[42:43], v22 offset:9216
  ds_read_b64_tr_b16 a[44:45], v22 offset:12288
  ds_read_b64_tr_b16 a[46:47], v22 offset:13312
  ds_read_b64_tr_b16 a[48:49], v22 offset:16384
  ds_read_b64_tr_b16 a[50:51], v22 offset:17408
  ds_read_b64_tr_b16 a[52:53], v22 offset:20480
  ds_read_b64_tr_b16 a[54:55], v22 offset:21504
  ds_read_b64_tr_b16 a[56:57], v22 offset:24576
  ds_read_b64_tr_b16 a[58:59], v22 offset:25600
  ds_read_b64_tr_b16 a[60:61], v22 offset:28672
  ds_read_b64_tr_b16 a[62:63], v22 offset:29696
  s_waitcnt lgkmcnt(0)
  s_waitcnt vmcnt(16)
  s_barrier
  s_add_u32 s27, s26, 1048576
  s_add_u32 m0, s28, 131072
  s_nop 0
  buffer_load_dwordx4 v20, s[8:11], s27 offen lds
  s_add_u32 m0, s28, 132096
  s_add_u32 s27, s27, 32768
  buffer_load_dwordx4 v20, s[8:11], s27 offen lds
  s_add_u32 m0, s28, 133120
  s_add_u32 s27, s27, 32768
  buffer_load_dwordx4 v21, s[8:11], s27 offen lds
  s_add_u32 m0, s28, 134144
  s_add_u32 s27, s27, 32768
  buffer_load_dwordx4 v21, s[8:11], s27 offen lds
  s_add_u32 m0, s28, 135168
  s_add_u32 s27, s27, 32768
  buffer_load_dwordx4 v20, s[8:11], s27 offen lds
  s_add_u32 m0, s28, 136192
  s_add_u32 s27, s27, 32768
  buffer_load_dwordx4 v20, s[8:11], s27 offen lds
  s_add_u32 m0, s28, 137216
  s_add_u32 s27, s27, 32768
  buffer_load_dwordx4 v21, s[8:11], s27 offen lds
  s_add_u32 m0, s28, 138240
  s_add_u32 s27, s27, 32768
  buffer_load_dwordx4 v21, s[8:11], s27 offen lds
  ds_read_b64_tr_b16 a[64:65], v22 offset:32768
  ds_read_b64_tr_b16 a[66:67], v22 offset:33792
  ds_read_b64_tr_b16 a[68:69], v22 offset:36864
  ds_read_b64_tr_b16 a[70:71], v22 offset:37888
  ds_read_b64_tr_b16 a[72:73], v22 offset:40960
  ds_read_b64_tr_b16 a[74:75], v22 offset:41984
  ds_read_b64_tr_b16 a[76:77], v22 offset:45056
  ds_read_b64_tr_b16 a[78:79], v22 offset:46080
  ds_read_b64_tr_b16 a[80:81], v22 offset:49152
  ds_read_b64_tr_b16 a[82:83], v22 offset:50176
  ds_read_b64_tr_b16 a[84:85], v22 offset:53248
  ds_read_b64_tr_b16 a[86:87], v22 offset:54272
  ds_read_b64_tr_b16 a[88:89], v22 offset:57344
  ds_read_b64_tr_b16 a[90:91], v22 offset:58368
  ds_read_b64_tr_b16 a[92:93], v22 offset:61440
  ds_read_b64_tr_b16 a[94:95], v22 offset:62464
  s_waitcnt lgkmcnt(0)
  s_waitcnt vmcnt(16)
  s_barrier
  s_add_u32 s27, s26, 2097152
  s_add_u32 m0, s28, 0
  s_nop 0
  buffer_load_dwordx4 v20, s[8:11], s27 offen lds
  s_add_u32 m0, s28, 1024
  s_add_u32 s27, s27, 32768
  buffer_load_dwordx4 v20, s[8:11], s27 offen lds
  s_add_u32 m0, s28, 2048
  s_add_u32 s27, s27, 32768
  buffer_load_dwordx4 v21, s[8:11], s27 offen lds
  s_add_u32 m0, s28, 3072
  s_add_u32 s27, s27, 32768
  buffer_load_dwordx4 v21, s[8:11], s27 offen lds
  s_add_u32 m0, s28, 4096
  s_add_u32 s27, s27, 32768
  buffer_load_dwordx4 v20, s[8:11], s27 offen lds
  s_add_u32 m0, s28, 5120
  s_add_u32 s27, s27, 32768
  buffer_load_dwordx4 v20, s[8:11], s27 offen lds
  s_add_u32 m0, s28, 6144
  s_add_u32 s27, s27, 32768
  buffer_load_dwordx4 v21, s[8:11], s27 offen lds
  s_add_u32 m0, s28, 7168
  s_add_u32 s27, s27, 32768
  buffer_load_dwordx4 v21, s[8:11], s27 offen lds
  ds_read_b64_tr_b16 a[96:97], v23 offset:0
  ds_read_b64_tr_b16 a[98:99], v23 offset:1024
  ds_read_b64_tr_b16 a[100:101], v23 offset:4096
  ds_read_b64_tr_b16 a[102:103], v23 offset:5120
  ds_read_b64_tr_b16 a[104:105], v23 offset:8192
  ds_read_b64_tr_b16 a[106:107], v23 offset:9216
  ds_read_b64_tr_b16 a[108:109], v23 offset:12288
  ds_read_b64_tr_b16 a[110:111], v23 offset:13312
  ds_read_b64_tr_b16 a[112:113], v23 offset:16384
  ds_read_b64_tr_b16 a[114:115], v23 offset:17408
  ds_read_b64_tr_b16 a[116:117], v23 offset:20480
  ds_read_b64_tr_b16 a[118:119], v23 offset:21504
  ds_read_b64_tr_b16 a[120:121], v23 offset:24576
  ds_read_b64_tr_b16 a[122:123], v23 offset:25600
  ds_read_b64_tr_b16 a[124:125], v23 offset:28672
  ds_read_b64_tr_b16 a[126:127], v23 offset:29696
  s_waitcnt lgkmcnt(0)
  s_waitcnt vmcnt(16)
  s_barrier
  s_add_u32 s27, s26, 3145728
  s_add_u32 m0, s28, 32768
  s_nop 0
  buffer_load_dwordx4 v20, s[8:11], s27 offen lds
  s_add_u32 m0, s28, 33792
  s_add_u32 s27, s27, 32768
  buffer_load_dwordx4 v20, s[8:11], s27 offen lds
  s_add_u32 m0, s28, 34816
  s_add_u32 s27, s27, 32768
  buffer_load_dwordx4 v21, s[8:11], s27 offen lds
  s_add_u32 m0, s28, 35840
  s_add_u32 s27, s27, 32768
  buffer_load_dwordx4 v21, s[8:11], s27 offen lds
  s_add_u32 m0, s28, 36864
  s_add_u32 s27, s27, 32768
  buffer_load_dwordx4 v20, s[8:11], s27 offen lds
  s_add_u32 m0, s28, 37888
  s_add_u32 s27, s27, 32768
  buffer_load_dwordx4 v20, s[8:11], s27 offen lds
  s_add_u32 m0, s28, 38912
  s_add_u32 s27, s27, 32768
  buffer_load_dwordx4 v21, s[8:11], s27 offen lds
  s_add_u32 m0, s28, 39936
  s_add_u32 s27, s27, 32768
  buffer_load_dwordx4 v21, s[8:11], s27 offen lds
  ds_read_b64_tr_b16 a[128:129], v23 offset:32768
  ds_read_b64_tr_b16 a[130:131], v23 offset:33792
  ds_read_b64_tr_b16 a[132:133], v23 offset:36864
  ds_read_b64_tr_b16 a[134:135], v23 offset:37888
  ds_read_b64_tr_b16 a[136:137], v23 offset:40960
  ds_read_b64_tr_b16 a[138:139], v23 offset:41984
  ds_read_b64_tr_b16 a[140:141], v23 offset:45056
  ds_read_b64_tr_b16 a[142:143], v23 offset:46080
  ds_read_b64_tr_b16 a[144:145], v23 offset:49152
  ds_read_b64_tr_b16 a[146:147], v23 offset:50176
  ds_read_b64_tr_b16 a[148:149], v23 offset:53248
  ds_read_b64_tr_b16 a[150:151], v23 offset:54272
  ds_read_b64_tr_b16 a[152:153], v23 offset:57344
  ds_read_b64_tr_b16 a[154:155], v23 offset:58368
  ds_read_b64_tr_b16 a[156:157], v23 offset:61440
  ds_read_b64_tr_b16 a[158:159], v23 offset:62464
  s_waitcnt lgkmcnt(0)
  s_waitcnt vmcnt(16)
  s_barrier
  ds_read_b64_tr_b16 a[160:161], v24 offset:0
  ds_read_b64_tr_b16 a[162:163], v24 offset:1024
  ds_read_b64_tr_b16 a[164:165], v24 offset:4096
  ds_read_b64_tr_b16 a[166:167], v24 offset:5120
  ds_read_b64_tr_b16 a[168:169], v24 offset:8192
  ds_read_b64_tr_b16 a[170:171], v24 offset:9216
  ds_read_b64_tr_b16 a[172:173], v24 offset:12288
  ds_read_b64_tr_b16 a[174:175], v24 offset:13312
  ds_read_b64_tr_b16 a[176:177], v24 offset:16384
  ds_read_b64_tr_b16 a[178:179], v24 offset:17408
  ds_read_b64_tr_b16 a[180:181], v24 offset:20480
  ds_read_b64_tr_b16 a[182:183], v24 offset:21504
  ds_read_b64_tr_b16 a[184:185], v24 offset:24576
  ds_read_b64_tr_b16 a[186:187], v24 offset:25600
  ds_read_b64_tr_b16 a[188:189], v24 offset:28672
  ds_read_b64_tr_b16 a[190:191], v24 offset:29696
  s_waitcnt lgkmcnt(0)
  s_waitcnt vmcnt(8)
  s_barrier
  ds_read_b64_tr_b16 a[192:193], v22 offset:0
  ds_read_b64_tr_b16 a[194:195], v22 offset:1024
  ds_read_b64_tr_b16 a[196:197], v22 offset:4096
  ds_read_b64_tr_b16 a[198:199], v22 offset:5120
  ds_read_b64_tr_b16 a[200:201], v22 offset:8192
  ds_read_b64_tr_b16 a[202:203], v22 offset:9216
  ds_read_b64_tr_b16 a[204:205], v22 offset:12288
  ds_read_b64_tr_b16 a[206:207], v22 offset:13312
  ds_read_b64_tr_b16 a[208:209], v22 offset:16384
  ds_read_b64_tr_b16 a[210:211], v22 offset:17408
  ds_read_b64_tr_b16 a[212:213], v22 offset:20480
  ds_read_b64_tr_b16 a[214:215], v22 offset:21504
  ds_read_b64_tr_b16 a[216:217], v22 offset:24576
  ds_read_b64_tr_b16 a[218:219], v22 offset:25600
  ds_read_b64_tr_b16 a[220:221], v22 offset:28672
  ds_read_b64_tr_b16 a[222:223], v22 offset:29696
  s_waitcnt lgkmcnt(0)
  s_waitcnt vmcnt(0)
  s_barrier
  ds_read_b64_tr_b16 a[224:225], v22 offset:32768
  ds_read_b64_tr_b16 a[226:227], v22 offset:33792
  ds_read_b64_tr_b16 a[228:229], v22 offset:36864
  ds_read_b64_tr_b16 a[230:231], v22 offset:37888
  ds_read_b64_tr_b16 a[232:233], v22 offset:40960
  ds_read_b64_tr_b16 a[234:235], v22 offset:41984
  ds_read_b64_tr_b16 a[236:237], v22 offset:45056
  ds_read_b64_tr_b16 a[238:239], v22 offset:46080
  ds_read_b64_tr_b16 a[240:241], v22 offset:49152
  ds_read_b64_tr_b16 a[242:243], v22 offset:50176
  ds_read_b64_tr_b16 a[244:245], v22 offset:53248
  ds_read_b64_tr_b16 a[246:247], v22 offset:54272
  ds_read_b64_tr_b16 a[248:249], v22 offset:57344
  ds_read_b64_tr_b16 a[250:251], v22 offset:58368
  ds_read_b64_tr_b16 a[252:253], v22 offset:61440
  ds_read_b64_tr_b16 a[254:255], v22 offset:62464
  s_waitcnt lgkmcnt(0)
  s_branch q_ld_84
q_ld_82:
  s_add_u32 s27, s26, 0
  s_add_u32 m0, s28, 0
  s_nop 0
  buffer_load_dwordx4 v20, s[68:71], s27 offen lds
  s_add_u32 m0, s28, 1024
  s_add_u32 s27, s27, 32768
  buffer_load_dwordx4 v20, s[68:71], s27 offen lds
  s_add_u32 m0, s28, 2048
  s_add_u32 s27, s27, 32768
  buffer_load_dwordx4 v21, s[68:71], s27 offen lds
  s_add_u32 m0, s28, 3072
  s_add_u32 s27, s27, 32768
  buffer_load_dwordx4 v21, s[68:71], s27 offen lds
  s_add_u32 m0, s28, 4096
  s_add_u32 s27, s27, 32768
  buffer_load_dwordx4 v20, s[68:71], s27 offen lds
  s_add_u32 m0, s28, 5120
  s_add_u32 s27, s27, 32768
  buffer_load_dwordx4 v20, s[68:71], s27 offen lds
  s_add_u32 m0, s28, 6144
  s_add_u32 s27, s27, 32768
  buffer_load_dwordx4 v21, s[68:71], s27 offen lds
  s_add_u32 m0, s28, 7168
  s_add_u32 s27, s27, 32768
  buffer_load_dwordx4 v21, s[68:71], s27 offen lds
  s_add_u32 s27, s26, 1048576
  s_add_u32 m0, s28, 32768
  s_nop 0
  buffer_load_dwordx4 v20, s[68:71], s27 offen lds
  s_add_u32 m0, s28, 33792
  s_add_u32 s27, s27, 32768
  buffer_load_dwordx4 v20, s[68:71], s27 offen lds
  s_add_u32 m0, s28, 34816
  s_add_u32 s27, s27, 32768
  buffer_load_dwordx4 v21, s[68:71], s27 offen lds
  s_add_u32 m0, s28, 35840
  s_add_u32 s27, s27, 32768
  buffer_load_dwordx4 v21, s[68:71], s27 offen lds
  s_add_u32 m0, s28, 36864
  s_add_u32 s27, s27, 32768
  buffer_load_dwordx4 v20, s[68:71], s27 offen lds
  s_add_u32 m0, s28, 37888
  s_add_u32 s27, s27, 32768
  buffer_load_dwordx4 v20, s[68:71], s27 offen lds
  s_add_u32 m0, s28, 38912
  s_add_u32 s27, s27, 32768
  buffer_load_dwordx4 v21, s[68:71], s27 offen lds
  s_add_u32 m0, s28, 39936
  s_add_u32 s27, s27, 32768
  buffer_load_dwordx4 v21, s[68:71], s27 offen lds
  s_add_u32 s27, s26, 2097152
  s_add_u32 m0, s28, 65536
  s_nop 0
  buffer_load_dwordx4 v20, s[68:71], s27 offen lds
  s_add_u32 m0, s28, 66560
  s_add_u32 s27, s27, 32768
  buffer_load_dwordx4 v20, s[68:71], s27 offen lds
  s_add_u32 m0, s28, 67584
  s_add_u32 s27, s27, 32768
  buffer_load_dwordx4 v21, s[68:71], s27 offen lds
  s_add_u32 m0, s28, 68608
  s_add_u32 s27, s27, 32768
  buffer_load_dwordx4 v21, s[68:71], s27 offen lds
  s_add_u32 m0, s28, 69632
  s_add_u32 s27, s27, 32768
  buffer_load_dwordx4 v20, s[68:71], s27 offen lds
  s_add_u32 m0, s28, 70656
  s_add_u32 s27, s27, 32768
  buffer_load_dwordx4 v20, s[68:71], s27 offen lds
  s_add_u32 m0, s28, 71680
  s_add_u32 s27, s27, 32768
  buffer_load_dwordx4 v21, s[68:71], s27 offen lds
  s_add_u32 m0, s28, 72704
  s_add_u32 s27, s27, 32768
  buffer_load_dwordx4 v21, s[68:71], s27 offen lds
  s_load_dwordx2 s[4:5], s[0:1], 112
  s_load_dwordx2 s[12:13], s[0:1], 104
  s_waitcnt vmcnt(16)
  s_barrier
  s_add_u32 s27, s26, 3145728
  s_add_u32 m0, s28, 98304
  s_nop 0
  buffer_load_dwordx4 v20, s[68:71], s27 offen lds
  s_add_u32 m0, s28, 99328
  s_add_u32 s27, s27, 32768
  buffer_load_dwordx4 v20, s[68:71], s27 offen lds
  s_add_u32 m0, s28, 100352
  s_add_u32 s27, s27, 32768
  buffer_load_dwordx4 v21, s[68:71], s27 offen lds
  s_add_u32 m0, s28, 101376
  s_add_u32 s27, s27, 32768
  buffer_load_dwordx4 v21, s[68:71], s27 offen lds
  s_add_u32 m0, s28, 102400
  s_add_u32 s27, s27, 32768
  buffer_load_dwordx4 v20, s[68:71], s27 offen lds
  s_add_u32 m0, s28, 103424
  s_add_u32 s27, s27, 32768
  buffer_load_dwordx4 v20, s[68:71], s27 offen lds
  s_add_u32 m0, s28, 104448
  s_add_u32 s27, s27, 32768
  buffer_load_dwordx4 v21, s[68:71], s27 offen lds
  s_add_u32 m0, s28, 105472
  s_add_u32 s27, s27, 32768
  buffer_load_dwordx4 v21, s[68:71], s27 offen lds
  ds_read_b64_tr_b16 a[0:1], v22 offset:0
  ds_read_b64_tr_b16 a[2:3], v22 offset:1024
  ds_read_b64_tr_b16 a[4:5], v22 offset:4096
  ds_read_b64_tr_b16 a[6:7], v22 offset:5120
  ds_read_b64_tr_b16 a[8:9], v22 offset:8192
  ds_read_b64_tr_b16 a[10:11], v22 offset:9216
  ds_read_b64_tr_b16 a[12:13], v22 offset:12288
  ds_read_b64_tr_b16 a[14:15], v22 offset:13312
  ds_read_b64_tr_b16 a[16:17], v22 offset:16384
  ds_read_b64_tr_b16 a[18:19], v22 offset:17408
  ds_read_b64_tr_b16 a[20:21], v22 offset:20480
  ds_read_b64_tr_b16 a[22:23], v22 offset:21504
  ds_read_b64_tr_b16 a[24:25], v22 offset:24576
  ds_read_b64_tr_b16 a[26:27], v22 offset:25600
  ds_read_b64_tr_b16 a[28:29], v22 offset:28672
  ds_read_b64_tr_b16 a[30:31], v22 offset:29696
  s_waitcnt lgkmcnt(0)
  s_waitcnt vmcnt(16)
  s_barrier
  s_add_u32 s27, s26, 0
  s_add_u32 m0, s28, 131072
  s_nop 0
  buffer_load_dwordx4 v20, s[8:11], s27 offen lds
  s_add_u32 m0, s28, 132096
  s_add_u32 s27, s27, 32768
  buffer_load_dwordx4 v20, s[8:11], s27 offen lds
  s_add_u32 m0, s28, 133120
  s_add_u32 s27, s27, 32768
  buffer_load_dwordx4 v21, s[8:11], s27 offen lds
  s_add_u32 m0, s28, 134144
  s_add_u32 s27, s27, 32768
  buffer_load_dwordx4 v21, s[8:11], s27 offen lds
  s_add_u32 m0, s28, 135168
  s_add_u32 s27, s27, 32768
  buffer_load_dwordx4 v20, s[8:11], s27 offen lds
  s_add_u32 m0, s28, 136192
  s_add_u32 s27, s27, 32768
  buffer_load_dwordx4 v20, s[8:11], s27 offen lds
  s_add_u32 m0, s28, 137216
  s_add_u32 s27, s27, 32768
  buffer_load_dwordx4 v21, s[8:11], s27 offen lds
  s_add_u32 m0, s28, 138240
  s_add_u32 s27, s27, 32768
  buffer_load_dwordx4 v21, s[8:11], s27 offen lds
  ds_read_b64_tr_b16 a[32:33], v22 offset:32768
  ds_read_b64_tr_b16 a[34:35], v22 offset:33792
  ds_read_b64_tr_b16 a[36:37], v22 offset:36864
  ds_read_b64_tr_b16 a[38:39], v22 offset:37888
  ds_read_b64_tr_b16 a[40:41], v22 offset:40960
  ds_read_b64_tr_b16 a[42:43], v22 offset:41984
  ds_read_b64_tr_b16 a[44:45], v22 offset:45056
  ds_read_b64_tr_b16 a[46:47], v22 offset:46080
  ds_read_b64_tr_b16 a[48:49], v22 offset:49152
  ds_read_b64_tr_b16 a[50:51], v22 offset:50176
  ds_read_b64_tr_b16 a[52:53], v22 offset:53248
  ds_read_b64_tr_b16 a[54:55], v22 offset:54272
  ds_read_b64_tr_b16 a[56:57], v22 offset:57344
  ds_read_b64_tr_b16 a[58:59], v22 offset:58368
  ds_read_b64_tr_b16 a[60:61], v22 offset:61440
  ds_read_b64_tr_b16 a[62:63], v22 offset:62464
  s_waitcnt lgkmcnt(0)
  s_waitcnt vmcnt(16)
  s_barrier
  s_add_u32 s27, s26, 1048576
  s_add_u32 m0, s28, 0
  s_nop 0
  buffer_load_dwordx4 v20, s[8:11], s27 offen lds
  s_add_u32 m0, s28, 1024
  s_add_u32 s27, s27, 32768
  buffer_load_dwordx4 v20, s[8:11], s27 offen lds
  s_add_u32 m0, s28, 2048
  s_add_u32 s27, s27, 32768
  buffer_load_dwordx4 v21, s[8:11], s27 offen lds
  s_add_u32 m0, s28, 3072
  s_add_u32 s27, s27, 32768
  buffer_load_dwordx4 v21, s[8:11], s27 offen lds
  s_add_u32 m0, s28, 4096
  s_add_u32 s27, s27, 32768
  buffer_load_dwordx4 v20, s[8:11], s27 offen lds
  s_add_u32 m0, s28, 5120
  s_add_u32 s27, s27, 32768
  buffer_load_dwordx4 v20, s[8:11], s27 offen lds
  s_add_u32 m0, s28, 6144
  s_add_u32 s27, s27, 32768
  buffer_load_dwordx4 v21, s[8:11], s27 offen lds
  s_add_u32 m0, s28, 7168
  s_add_u32 s27, s27, 32768
  buffer_load_dwordx4 v21, s[8:11], s27 offen lds
  ds_read_b64_tr_b16 a[64:65], v23 offset:0
  ds_read_b64_tr_b16 a[66:67], v23 offset:1024
  ds_read_b64_tr_b16 a[68:69], v23 offset:4096
  ds_read_b64_tr_b16 a[70:71], v23 offset:5120
  ds_read_b64_tr_b16 a[72:73], v23 offset:8192
  ds_read_b64_tr_b16 a[74:75], v23 offset:9216
  ds_read_b64_tr_b16 a[76:77], v23 offset:12288
  ds_read_b64_tr_b16 a[78:79], v23 offset:13312
  ds_read_b64_tr_b16 a[80:81], v23 offset:16384
  ds_read_b64_tr_b16 a[82:83], v23 offset:17408
  ds_read_b64_tr_b16 a[84:85], v23 offset:20480
  ds_read_b64_tr_b16 a[86:87], v23 offset:21504
  ds_read_b64_tr_b16 a[88:89], v23 offset:24576
  ds_read_b64_tr_b16 a[90:91], v23 offset:25600
  ds_read_b64_tr_b16 a[92:93], v23 offset:28672
  ds_read_b64_tr_b16 a[94:95], v23 offset:29696
  s_waitcnt lgkmcnt(0)
  s_waitcnt vmcnt(16)
  s_barrier
  s_add_u32 s27, s26, 2097152
  s_add_u32 m0, s28, 32768
  s_nop 0
  buffer_load_dwordx4 v20, s[8:11], s27 offen lds
  s_add_u32 m0, s28, 33792
  s_add_u32 s27, s27, 32768
  buffer_load_dwordx4 v20, s[8:11], s27 offen lds
  s_add_u32 m0, s28, 34816
  s_add_u32 s27, s27, 32768
  buffer_load_dwordx4 v21, s[8:11], s27 offen lds
  s_add_u32 m0, s28, 35840
  s_add_u32 s27, s27, 32768
  buffer_load_dwordx4 v21, s[8:11], s27 offen lds
  s_add_u32 m0, s28, 36864
  s_add_u32 s27, s27, 32768
  buffer_load_dwordx4 v20, s[8:11], s27 offen lds
  s_add_u32 m0, s28, 37888
  s_add_u32 s27, s27, 32768
  buffer_load_dwordx4 v20, s[8:11], s27 offen lds
  s_add_u32 m0, s28, 38912
  s_add_u32 s27, s27, 32768
  buffer_load_dwordx4 v21, s[8:11], s27 offen lds
  s_add_u32 m0, s28, 39936
  s_add_u32 s27, s27, 32768
  buffer_load_dwordx4 v21, s[8:11], s27 offen lds
  ds_read_b64_tr_b16 a[96:97], v23 offset:32768
  ds_read_b64_tr_b16 a[98:99], v23 offset:33792
  ds_read_b64_tr_b16 a[100:101], v23 offset:36864
  ds_read_b64_tr_b16 a[102:103], v23 offset:37888
  ds_read_b64_tr_b16 a[104:105], v23 offset:40960
  ds_read_b64_tr_b16 a[106:107], v23 offset:41984
  ds_read_b64_tr_b16 a[108:109], v23 offset:45056
  ds_read_b64_tr_b16 a[110:111], v23 offset:46080
  ds_read_b64_tr_b16 a[112:113], v23 offset:49152
  ds_read_b64_tr_b16 a[114:115], v23 offset:50176
  ds_read_b64_tr_b16 a[116:117], v23 offset:53248
  ds_read_b64_tr_b16 a[118:119], v23 offset:54272
  ds_read_b64_tr_b16 a[120:121], v23 offset:57344
  ds_read_b64_tr_b16 a[122:123], v23 offset:58368
  ds_read_b64_tr_b16 a[124:125], v23 offset:61440
  ds_read_b64_tr_b16 a[126:127], v23 offset:62464
  s_waitcnt lgkmcnt(0)
  s_waitcnt vmcnt(16)
  s_barrier
  s_add_u32 s27, s26, 3145728
  s_add_u32 m0, s28, 65536
  s_nop 0
  buffer_load_dwordx4 v20, s[8:11], s27 offen lds
  s_add_u32 m0, s28, 66560
  s_add_u32 s27, s27, 32768
  buffer_load_dwordx4 v20, s[8:11], s27 offen lds
  s_add_u32 m0, s28, 67584
  s_add_u32 s27, s27, 32768
  buffer_load_dwordx4 v21, s[8:11], s27 offen lds
  s_add_u32 m0, s28, 68608
  s_add_u32 s27, s27, 32768
  buffer_load_dwordx4 v21, s[8:11], s27 offen lds
  s_add_u32 m0, s28, 69632
  s_add_u32 s27, s27, 32768
  buffer_load_dwordx4 v20, s[8:11], s27 offen lds
  s_add_u32 m0, s28, 70656
  s_add_u32 s27, s27, 32768
  buffer_load_dwordx4 v20, s[8:11], s27 offen lds
  s_add_u32 m0, s28, 71680
  s_add_u32 s27, s27, 32768
  buffer_load_dwordx4 v21, s[8:11], s27 offen lds
  s_add_u32 m0, s28, 72704
  s_add_u32 s27, s27, 32768
  buffer_load_dwordx4 v21, s[8:11], s27 offen lds
  ds_read_b64_tr_b16 a[128:129], v24 offset:0
  ds_read_b64_tr_b16 a[130:131], v24 offset:1024
  ds_read_b64_tr_b16 a[132:133], v24 offset:4096
  ds_read_b64_tr_b16 a[134:135], v24 offset:5120
  ds_read_b64_tr_b16 a[136:137], v24 offset:8192
  ds_read_b64_tr_b16 a[138:139], v24 offset:9216
  ds_read_b64_tr_b16 a[140:141], v24 offset:12288
  ds_read_b64_tr_b16 a[142:143], v24 offset:13312
  ds_read_b64_tr_b16 a[144:145], v24 offset:16384
  ds_read_b64_tr_b16 a[146:147], v24 offset:17408
  ds_read_b64_tr_b16 a[148:149], v24 offset:20480
  ds_read_b64_tr_b16 a[150:151], v24 offset:21504
  ds_read_b64_tr_b16 a[152:153], v24 offset:24576
  ds_read_b64_tr_b16 a[154:155], v24 offset:25600
  ds_read_b64_tr_b16 a[156:157], v24 offset:28672
  ds_read_b64_tr_b16 a[158:159], v24 offset:29696
  s_waitcnt lgkmcnt(0)
  s_waitcnt vmcnt(16)
  s_barrier
  s_add_u32 s27, s26, 0
  s_add_u32 m0, s28, 98304
  s_nop 0
  buffer_load_dwordx4 v20, s[64:67], s27 offen lds
  s_add_u32 m0, s28, 99328
  s_add_u32 s27, s27, 32768
  buffer_load_dwordx4 v20, s[64:67], s27 offen lds
  s_add_u32 m0, s28, 100352
  s_add_u32 s27, s27, 32768
  buffer_load_dwordx4 v21, s[64:67], s27 offen lds
  s_add_u32 m0, s28, 101376
  s_add_u32 s27, s27, 32768
  buffer_load_dwordx4 v21, s[64:67], s27 offen lds
  s_add_u32 m0, s28, 102400
  s_add_u32 s27, s27, 32768
  buffer_load_dwordx4 v20, s[64:67], s27 offen lds
  s_add_u32 m0, s28, 103424
  s_add_u32 s27, s27, 32768
  buffer_load_dwordx4 v20, s[64:67], s27 offen lds
  s_add_u32 m0, s28, 104448
  s_add_u32 s27, s27, 32768
  buffer_load_dwordx4 v21, s[64:67], s27 offen lds
  s_add_u32 m0, s28, 105472
  s_add_u32 s27, s27, 32768
  buffer_load_dwordx4 v21, s[64:67], s27 offen lds
  ds_read_b64_tr_b16 a[160:161], v22 offset:0
  ds_read_b64_tr_b16 a[162:163], v22 offset:1024
  ds_read_b64_tr_b16 a[164:165], v22 offset:4096
  ds_read_b64_tr_b16 a[166:167], v22 offset:5120
  ds_read_b64_tr_b16 a[168:169], v22 offset:8192
  ds_read_b64_tr_b16 a[170:171], v22 offset:9216
  ds_read_b64_tr_b16 a[172:173], v22 offset:12288
  ds_read_b64_tr_b16 a[174:175], v22 offset:13312
  ds_read_b64_tr_b16 a[176:177], v22 offset:16384
  ds_read_b64_tr_b16 a[178:179], v22 offset:17408
  ds_read_b64_tr_b16 a[180:181], v22 offset:20480
  ds_read_b64_tr_b16 a[182:183], v22 offset:21504
  ds_read_b64_tr_b16 a[184:185], v22 offset:24576
  ds_read_b64_tr_b16 a[186:187], v22 offset:25600
  ds_read_b64_tr_b16 a[188:189], v22 offset:28672
  ds_read_b64_tr_b16 a[190:191], v22 offset:29696
  s_waitcnt lgkmcnt(0)
  s_waitcnt vmcnt(16)
  s_barrier
  s_add_u32 s27, s26, 1048576
  s_add_u32 m0, s28, 131072
  s_nop 0
  buffer_load_dwordx4 v20, s[64:67], s27 offen lds
  s_add_u32 m0, s28, 132096
  s_add_u32 s27, s27, 32768
  buffer_load_dwordx4 v20, s[64:67], s27 offen lds
  s_add_u32 m0, s28, 133120
  s_add_u32 s27, s27, 32768
  buffer_load_dwordx4 v21, s[64:67], s27 offen lds
  s_add_u32 m0, s28, 134144
  s_add_u32 s27, s27, 32768
  buffer_load_dwordx4 v21, s[64:67], s27 offen lds
  s_add_u32 m0, s28, 135168
  s_add_u32 s27, s27, 32768
  buffer_load_dwordx4 v20, s[64:67], s27 offen lds
  s_add_u32 m0, s28, 136192
  s_add_u32 s27, s27, 32768
  buffer_load_dwordx4 v20, s[64:67], s27 offen lds
  s_add_u32 m0, s28, 137216
  s_add_u32 s27, s27, 32768
  buffer_load_dwordx4 v21, s[64:67], s27 offen lds
  s_add_u32 m0, s28, 138240
  s_add_u32 s27, s27, 32768
  buffer_load_dwordx4 v21, s[64:67], s27 offen lds
  ds_read_b64_tr_b16 a[192:193], v22 offset:32768
  ds_read_b64_tr_b16 a[194:195], v22 offset:33792
  ds_read_b64_tr_b16 a[196:197], v22 offset:36864
  ds_read_b64_tr_b16 a[198:199], v22 offset:37888
  ds_read_b64_tr_b16 a[200:201], v22 offset:40960
  ds_read_b64_tr_b16 a[202:203], v22 offset:41984
  ds_read_b64_tr_b16 a[204:205], v22 offset:45056
  ds_read_b64_tr_b16 a[206:207], v22 offset:46080
  ds_read_b64_tr_b16 a[208:209], v22 offset:49152
  ds_read_b64_tr_b16 a[210:211], v22 offset:50176
  ds_read_b64_tr_b16 a[212:213], v22 offset:53248
  ds_read_b64_tr_b16 a[214:215], v22 offset:54272
  ds_read_b64_tr_b16 a[216:217], v22 offset:57344
  ds_read_b64_tr_b16 a[218:219], v22 offset:58368
  ds_read_b64_tr_b16 a[220:221], v22 offset:61440
  ds_read_b64_tr_b16 a[222:223], v22 offset:62464
  s_waitcnt lgkmcnt(0)
  s_waitcnt vmcnt(16)
  s_barrier
  s_add_u32 s27, s26, 2097152
  s_add_u32 m0, s28, 0
  s_nop 0
  buffer_load_dwordx4 v20, s[64:67], s27 offen lds
  s_add_u32 m0, s28, 1024
  s_add_u32 s27, s27, 32768
  buffer_load_dwordx4 v20, s[64:67], s27 offen lds
  s_add_u32 m0, s28, 2048
  s_add_u32 s27, s27, 32768
  buffer_load_dwordx4 v21, s[64:67], s27 offen lds
  s_add_u32 m0, s28, 3072
  s_add_u32 s27, s27, 32768
  buffer_load_dwordx4 v21, s[64:67], s27 offen lds
  s_add_u32 m0, s28, 4096
  s_add_u32 s27, s27, 32768
  buffer_load_dwordx4 v20, s[64:67], s27 offen lds
  s_add_u32 m0, s28, 5120
  s_add_u32 s27, s27, 32768
  buffer_load_dwordx4 v20, s[64:67], s27 offen lds
  s_add_u32 m0, s28, 6144
  s_add_u32 s27, s27, 32768
  buffer_load_dwordx4 v21, s[64:67], s27 offen lds
  s_add_u32 m0, s28, 7168
  s_add_u32 s27, s27, 32768
  buffer_load_dwordx4 v21, s[64:67], s27 offen lds
  ds_read_b64_tr_b16 a[224:225], v23 offset:0
  ds_read_b64_tr_b16 a[226:227], v23 offset:1024
  ds_read_b64_tr_b16 a[228:229], v23 offset:4096
  ds_read_b64_tr_b16 a[230:231], v23 offset:5120
  ds_read_b64_tr_b16 a[232:233], v23 offset:8192
  ds_read_b64_tr_b16 a[234:235], v23 offset:9216
  ds_read_b64_tr_b16 a[236:237], v23 offset:12288
  ds_read_b64_tr_b16 a[238:239], v23 offset:13312
  ds_read_b64_tr_b16 a[240:241], v23 offset:16384
  ds_read_b64_tr_b16 a[242:243], v23 offset:17408
  ds_read_b64_tr_b16 a[244:245], v23 offset:20480
  ds_read_b64_tr_b16 a[246:247], v23 offset:21504
  ds_read_b64_tr_b16 a[248:249], v23 offset:24576
  ds_read_b64_tr_b16 a[250:251], v23 offset:25600
  ds_read_b64_tr_b16 a[252:253], v23 offset:28672
  ds_read_b64_tr_b16 a[254:255], v23 offset:29696
  s_waitcnt lgkmcnt(0)
  s_waitcnt vmcnt(16)
  s_barrier
  s_add_u32 s27, s26, 3145728
  s_add_u32 m0, s28, 32768
  s_nop 0
  buffer_load_dwordx4 v20, s[64:67], s27 offen lds
  s_add_u32 m0, s28, 33792
  s_add_u32 s27, s27, 32768
  buffer_load_dwordx4 v20, s[64:67], s27 offen lds
  s_add_u32 m0, s28, 34816
  s_add_u32 s27, s27, 32768
  buffer_load_dwordx4 v21, s[64:67], s27 offen lds
  s_add_u32 m0, s28, 35840
  s_add_u32 s27, s27, 32768
  buffer_load_dwordx4 v21, s[64:67], s27 offen lds
  s_add_u32 m0, s28, 36864
  s_add_u32 s27, s27, 32768
  buffer_load_dwordx4 v20, s[64:67], s27 offen lds
  s_add_u32 m0, s28, 37888
  s_add_u32 s27, s27, 32768
  buffer_load_dwordx4 v20, s[64:67], s27 offen lds
  s_add_u32 m0, s28, 38912
  s_add_u32 s27, s27, 32768
  buffer_load_dwordx4 v21, s[64:67], s27 offen lds
  s_add_u32 m0, s28, 39936
  s_add_u32 s27, s27, 32768
  buffer_load_dwordx4 v21, s[64:67], s27 offen lds
  ds_read_b64_tr_b16 v[128:129], v23 offset:32768
  ds_read_b64_tr_b16 v[130:131], v23 offset:33792
  ds_read_b64_tr_b16 v[132:133], v23 offset:36864
  ds_read_b64_tr_b16 v[134:135], v23 offset:37888
  ds_read_b64_tr_b16 v[136:137], v23 offset:40960
  ds_read_b64_tr_b16 v[138:139], v23 offset:41984
  ds_read_b64_tr_b16 v[140:141], v23 offset:45056
  ds_read_b64_tr_b16 v[142:143], v23 offset:46080
  ds_read_b64_tr_b16 v[144:145], v23 offset:49152
  ds_read_b64_tr_b16 v[146:147], v23 offset:50176
  ds_read_b64_tr_b16 v[148:149], v23 offset:53248
  ds_read_b64_tr_b16 v[150:151], v23 offset:54272
  ds_read_b64_tr_b16 v[152:153], v23 offset:57344
  ds_read_b64_tr_b16 v[154:155], v23 offset:58368
  ds_read_b64_tr_b16 v[156:157], v23 offset:61440
  ds_read_b64_tr_b16 v[158:159], v23 offset:62464
  s_waitcnt lgkmcnt(0)
  s_waitcnt vmcnt(16)
  s_barrier
  ds_read_b64_tr_b16 v[160:161], v24 offset:0
  ds_read_b64_tr_b16 v[162:163], v24 offset:1024
  ds_read_b64_tr_b16 v[164:165], v24 offset:4096
  ds_read_b64_tr_b16 v[166:167], v24 offset:5120
  ds_read_b64_tr_b16 v[168:169], v24 offset:8192
  ds_read_b64_tr_b16 v[170:171], v24 offset:9216
  ds_read_b64_tr_b16 v[172:173], v24 offset:12288
  ds_read_b64_tr_b16 v[174:175], v24 offset:13312
  ds_read_b64_tr_b16 v[176:177], v24 offset:16384
  ds_read_b64_tr_b16 v[178:179], v24 offset:17408
  ds_read_b64_tr_b16 v[180:181], v24 offset:20480
  ds_read_b64_tr_b16 v[182:183], v24 offset:21504
  ds_read_b64_tr_b16 v[184:185], v24 offset:24576
  ds_read_b64_tr_b16 v[186:187], v24 offset:25600
  ds_read_b64_tr_b16 v[188:189], v24 offset:28672
  ds_read_b64_tr_b16 v[190:191], v24 offset:29696
  s_waitcnt lgkmcnt(0)
  s_waitcnt vmcnt(8)
  s_barrier
  ds_read_b64_tr_b16 v[192:193], v22 offset:0
  ds_read_b64_tr_b16 v[194:195], v22 offset:1024
  ds_read_b64_tr_b16 v[196:197], v22 offset:4096
  ds_read_b64_tr_b16 v[198:199], v22 offset:5120
  ds_read_b64_tr_b16 v[200:201], v22 offset:8192
  ds_read_b64_tr_b16 v[202:203], v22 offset:9216
  ds_read_b64_tr_b16 v[204:205], v22 offset:12288
  ds_read_b64_tr_b16 v[206:207], v22 offset:13312
  ds_read_b64_tr_b16 v[208:209], v22 offset:16384
  ds_read_b64_tr_b16 v[210:211], v22 offset:17408
  ds_read_b64_tr_b16 v[212:213], v22 offset:20480
  ds_read_b64_tr_b16 v[214:215], v22 offset:21504
  ds_read_b64_tr_b16 v[216:217], v22 offset:24576
  ds_read_b64_tr_b16 v[218:219], v22 offset:25600
  ds_read_b64_tr_b16 v[220:221], v22 offset:28672
  ds_read_b64_tr_b16 v[222:223], v22 offset:29696
  s_waitcnt lgkmcnt(0)
  s_waitcnt vmcnt(0)
  s_barrier
  ds_read_b64_tr_b16 v[224:225], v22 offset:32768
  ds_read_b64_tr_b16 v[226:227], v22 offset:33792
  ds_read_b64_tr_b16 v[228:229], v22 offset:36864
  ds_read_b64_tr_b16 v[230:231], v22 offset:37888
  ds_read_b64_tr_b16 v[232:233], v22 offset:40960
  ds_read_b64_tr_b16 v[234:235], v22 offset:41984
  ds_read_b64_tr_b16 v[236:237], v22 offset:45056
  ds_read_b64_tr_b16 v[238:239], v22 offset:46080
  ds_read_b64_tr_b16 v[240:241], v22 offset:49152
  ds_read_b64_tr_b16 v[242:243], v22 offset:50176
  ds_read_b64_tr_b16 v[244:245], v22 offset:53248
  ds_read_b64_tr_b16 v[246:247], v22 offset:54272
  ds_read_b64_tr_b16 v[248:249], v22 offset:57344
  ds_read_b64_tr_b16 v[250:251], v22 offset:58368
  ds_read_b64_tr_b16 v[252:253], v22 offset:61440
  ds_read_b64_tr_b16 v[254:255], v22 offset:62464
  s_waitcnt lgkmcnt(0)
  s_branch q_ld_84
q_ld_83:
  s_add_u32 s27, s26, 0
  s_add_u32 m0, s28, 0
  s_nop 0
  buffer_load_dwordx4 v20, s[8:11], s27 offen lds
  s_add_u32 m0, s28, 1024
  s_add_u32 s27, s27, 32768
  buffer_load_dwordx4 v20, s[8:11], s27 offen lds
  s_add_u32 m0, s28, 2048
  s_add_u32 s27, s27, 32768
  buffer_load_dwordx4 v21, s[8:11], s27 offen lds
  s_add_u32 m0, s28, 3072
  s_add_u32 s27, s27, 32768
  buffer_load_dwordx4 v21, s[8:11], s27 offen lds
  s_add_u32 m0, s28, 4096
  s_add_u32 s27, s27, 32768
  buffer_load_dwordx4 v20, s[8:11], s27 offen lds
  s_add_u32 m0, s28, 5120
  s_add_u32 s27, s27, 32768
  buffer_load_dwordx4 v20, s[8:11], s27 offen lds
  s_add_u32 m0, s28, 6144
  s_add_u32 s27, s27, 32768
  buffer_load_dwordx4 v21, s[8:11], s27 offen lds
  s_add_u32 m0, s28, 7168
  s_add_u32 s27, s27, 32768
  buffer_load_dwordx4 v21, s[8:11], s27 offen lds
  s_add_u32 s27, s26, 1048576
  s_add_u32 m0, s28, 32768
  s_nop 0
  buffer_load_dwordx4 v20, s[8:11], s27 offen lds
  s_add_u32 m0, s28, 33792
  s_add_u32 s27, s27, 32768
  buffer_load_dwordx4 v20, s[8:11], s27 offen lds
  s_add_u32 m0, s28, 34816
  s_add_u32 s27, s27, 32768
  buffer_load_dwordx4 v21, s[8:11], s27 offen lds
  s_add_u32 m0, s28, 35840
  s_add_u32 s27, s27, 32768
  buffer_load_dwordx4 v21, s[8:11], s27 offen lds
  s_add_u32 m0, s28, 36864
  s_add_u32 s27, s27, 32768
  buffer_load_dwordx4 v20, s[8:11], s27 offen lds
  s_add_u32 m0, s28, 37888
  s_add_u32 s27, s27, 32768
  buffer_load_dwordx4 v20, s[8:11], s27 offen lds
  s_add_u32 m0, s28, 38912
  s_add_u32 s27, s27, 32768
  buffer_load_dwordx4 v21, s[8:11], s27 offen lds
  s_add_u32 m0, s28, 39936
  s_add_u32 s27, s27, 32768
  buffer_load_dwordx4 v21, s[8:11], s27 offen lds
  s_add_u32 s27, s26, 2097152
  s_add_u32 m0, s28, 65536
  s_nop 0
  buffer_load_dwordx4 v20, s[8:11], s27 offen lds
  s_add_u32 m0, s28, 66560
  s_add_u32 s27, s27, 32768
  buffer_load_dwordx4 v20, s[8:11], s27 offen lds
  s_add_u32 m0, s28, 67584
  s_add_u32 s27, s27, 32768
  buffer_load_dwordx4 v21, s[8:11], s27 offen lds
  s_add_u32 m0, s28, 68608
  s_add_u32 s27, s27, 32768
  buffer_load_dwordx4 v21, s[8:11], s27 offen lds
  s_add_u32 m0, s28, 69632
  s_add_u32 s27, s27, 32768
  buffer_load_dwordx4 v20, s[8:11], s27 offen lds
  s_add_u32 m0, s28, 70656
  s_add_u32 s27, s27, 32768
  buffer_load_dwordx4 v20, s[8:11], s27 offen lds
  s_add_u32 m0, s28, 71680
  s_add_u32 s27, s27, 32768
  buffer_load_dwordx4 v21, s[8:11], s27 offen lds
  s_add_u32 m0, s28, 72704
  s_add_u32 s27, s27, 32768
  buffer_load_dwordx4 v21, s[8:11], s27 offen lds
  s_load_dwordx2 s[4:5], s[0:1], 112
  s_load_dwordx2 s[12:13], s[0:1], 104
  s_waitcnt vmcnt(16)
  s_barrier
  s_add_u32 s27, s26, 3145728
  s_add_u32 m0, s28, 98304
  s_nop 0
  buffer_load_dwordx4 v20, s[8:11], s27 offen lds
  s_add_u32 m0, s28, 99328
  s_add_u32 s27, s27, 32768
  buffer_load_dwordx4 v20, s[8:11], s27 offen lds
  s_add_u32 m0, s28, 100352
  s_add_u32 s27, s27, 32768
  buffer_load_dwordx4 v21, s[8:11], s27 offen lds
  s_add_u32 m0, s28, 101376
  s_add_u32 s27, s27, 32768
  buffer_load_dwordx4 v21, s[8:11], s27 offen lds
  s_add_u32 m0, s28, 102400
  s_add_u32 s27, s27, 32768
  buffer_load_dwordx4 v20, s[8:11], s27 offen lds
  s_add_u32 m0, s28, 103424
  s_add_u32 s27, s27, 32768
  buffer_load_dwordx4 v20, s[8:11], s27 offen lds
  s_add_u32 m0, s28, 104448
  s_add_u32 s27, s27, 32768
  buffer_load_dwordx4 v21, s[8:11], s27 offen lds
  s_add_u32 m0, s28, 105472
  s_add_u32 s27, s27, 32768
  buffer_load_dwordx4 v21, s[8:11], s27 offen lds
  ds_read_b64_tr_b16 a[128:129], v22 offset:0
  ds_read_b64_tr_b16 a[130:131], v22 offset:1024
  ds_read_b64_tr_b16 a[132:133], v22 offset:4096
  ds_read_b64_tr_b16 a[134:135], v22 offset:5120
  ds_read_b64_tr_b16 a[136:137], v22 offset:8192
  ds_read_b64_tr_b16 a[138:139], v22 offset:9216
  ds_read_b64_tr_b16 a[140:141], v22 offset:12288
  ds_read_b64_tr_b16 a[142:143], v22 offset:13312
  ds_read_b64_tr_b16 a[144:145], v22 offset:16384
  ds_read_b64_tr_b16 a[146:147], v22 offset:17408
  ds_read_b64_tr_b16 a[148:149], v22 offset:20480
  ds_read_b64_tr_b16 a[150:151], v22 offset:21504
  ds_read_b64_tr_b16 a[152:153], v22 offset:24576
  ds_read_b64_tr_b16 a[154:155], v22 offset:25600
  ds_read_b64_tr_b16 a[156:157], v22 offset:28672
  ds_read_b64_tr_b16 a[158:159], v22 offset:29696
  s_waitcnt lgkmcnt(0)
  s_waitcnt vmcnt(16)
  s_barrier
  s_add_u32 s27, s26, 0
  s_add_u32 m0, s28, 131072
  s_nop 0
  buffer_load_dwordx4 v20, s[64:67], s27 offen lds
  s_add_u32 m0, s28, 132096
  s_add_u32 s27, s27, 32768
  buffer_load_dwordx4 v20, s[64:67], s27 offen lds
  s_add_u32 m0, s28, 133120
  s_add_u32 s27, s27, 32768
  buffer_load_dwordx4 v21, s[64:67], s27 offen lds
  s_add_u32 m0, s28, 134144
  s_add_u32 s27, s27, 32768
  buffer_load_dwordx4 v21, s[64:67], s27 offen lds
  s_add_u32 m0, s28, 135168
  s_add_u32 s27, s27, 32768
  buffer_load_dwordx4 v20, s[64:67], s27 offen lds
  s_add_u32 m0, s28, 136192
  s_add_u32 s27, s27, 32768
  buffer_load_dwordx4 v20, s[64:67], s27 offen lds
  s_add_u32 m0, s28, 137216
  s_add_u32 s27, s27, 32768
  buffer_load_dwordx4 v21, s[64:67], s27 offen lds
  s_add_u32 m0, s28, 138240
  s_add_u32 s27, s27, 32768
  buffer_load_dwordx4 v21, s[64:67], s27 offen lds
  ds_read_b64_tr_b16 a[160:161], v22 offset:32768
  ds_read_b64_tr_b16 a[162:163], v22 offset:33792
  ds_read_b64_tr_b16 a[164:165], v22 offset:36864
  ds_read_b64_tr_b16 a[166:167], v22 offset:37888
  ds_read_b64_tr_b16 a[168:169], v22 offset:40960
  ds_read_b64_tr_b16 a[170:171], v22 offset:41984
  ds_read_b64_tr_b16 a[172:173], v22 offset:45056
  ds_read_b64_tr_b16 a[174:175], v22 offset:46080
  ds_read_b64_tr_b16 a[176:177], v22 offset:49152
  ds_read_b64_tr_b16 a[178:179], v22 offset:50176
  ds_read_b64_tr_b16 a[180:181], v22 offset:53248
  ds_read_b64_tr_b16 a[182:183], v22 offset:54272
  ds_read_b64_tr_b16 a[184:185], v22 offset:57344
  ds_read_b64_tr_b16 a[186:187], v22 offset:58368
  ds_read_b64_tr_b16 a[188:189], v22 offset:61440
  ds_read_b64_tr_b16 a[190:191], v22 offset:62464
  s_waitcnt lgkmcnt(0)
  s_waitcnt vmcnt(16)
  s_barrier
  s_add_u32 s27, s26, 1048576
  s_add_u32 m0, s28, 0
  s_nop 0
  buffer_load_dwordx4 v20, s[64:67], s27 offen lds
  s_add_u32 m0, s28, 1024
  s_add_u32 s27, s27, 32768
  buffer_load_dwordx4 v20, s[64:67], s27 offen lds
  s_add_u32 m0, s28, 2048
  s_add_u32 s27, s27, 32768
  buffer_load_dwordx4 v21, s[64:67], s27 offen lds
  s_add_u32 m0, s28, 3072
  s_add_u32 s27, s27, 32768
  buffer_load_dwordx4 v21, s[64:67], s27 offen lds
  s_add_u32 m0, s28, 4096
  s_add_u32 s27, s27, 32768
  buffer_load_dwordx4 v20, s[64:67], s27 offen lds
  s_add_u32 m0, s28, 5120
  s_add_u32 s27, s27, 32768
  buffer_load_dwordx4 v20, s[64:67], s27 offen lds
  s_add_u32 m0, s28, 6144
  s_add_u32 s27, s27, 32768
  buffer_load_dwordx4 v21, s[64:67], s27 offen lds
  s_add_u32 m0, s28, 7168
  s_add_u32 s27, s27, 32768
  buffer_load_dwordx4 v21, s[64:67], s27 offen lds
  ds_read_b64_tr_b16 a[192:193], v23 offset:0
  ds_read_b64_tr_b16 a[194:195], v23 offset:1024
  ds_read_b64_tr_b16 a[196:197], v23 offset:4096
  ds_read_b64_tr_b16 a[198:199], v23 offset:5120
  ds_read_b64_tr_b16 a[200:201], v23 offset:8192
  ds_read_b64_tr_b16 a[202:203], v23 offset:9216
  ds_read_b64_tr_b16 a[204:205], v23 offset:12288
  ds_read_b64_tr_b16 a[206:207], v23 offset:13312
  ds_read_b64_tr_b16 a[208:209], v23 offset:16384
  ds_read_b64_tr_b16 a[210:211], v23 offset:17408
  ds_read_b64_tr_b16 a[212:213], v23 offset:20480
  ds_read_b64_tr_b16 a[214:215], v23 offset:21504
  ds_read_b64_tr_b16 a[216:217], v23 offset:24576
  ds_read_b64_tr_b16 a[218:219], v23 offset:25600
  ds_read_b64_tr_b16 a[220:221], v23 offset:28672
  ds_read_b64_tr_b16 a[222:223], v23 offset:29696
  s_waitcnt lgkmcnt(0)
  s_waitcnt vmcnt(16)
  s_barrier
  s_add_u32 s27, s26, 2097152
  s_add_u32 m0, s28, 32768
  s_nop 0
  buffer_load_dwordx4 v20, s[64:67], s27 offen lds
  s_add_u32 m0, s28, 33792
  s_add_u32 s27, s27, 32768
  buffer_load_dwordx4 v20, s[64:67], s27 offen lds
  s_add_u32 m0, s28, 34816
  s_add_u32 s27, s27, 32768
  buffer_load_dwordx4 v21, s[64:67], s27 offen lds
  s_add_u32 m0, s28, 35840
  s_add_u32 s27, s27, 32768
  buffer_load_dwordx4 v21, s[64:67], s27 offen lds
  s_add_u32 m0, s28, 36864
  s_add_u32 s27, s27, 32768
  buffer_load_dwordx4 v20, s[64:67], s27 offen lds
  s_add_u32 m0, s28, 37888
  s_add_u32 s27, s27, 32768
  buffer_load_dwordx4 v20, s[64:67], s27 offen lds
  s_add_u32 m0, s28, 38912
  s_add_u32 s27, s27, 32768
  buffer_load_dwordx4 v21, s[64:67], s27 offen lds
  s_add_u32 m0, s28, 39936
  s_add_u32 s27, s27, 32768
  buffer_load_dwordx4 v21, s[64:67], s27 offen lds
  ds_read_b64_tr_b16 a[224:225], v23 offset:32768
  ds_read_b64_tr_b16 a[226:227], v23 offset:33792
  ds_read_b64_tr_b16 a[228:229], v23 offset:36864
  ds_read_b64_tr_b16 a[230:231], v23 offset:37888
  ds_read_b64_tr_b16 a[232:233], v23 offset:40960
  ds_read_b64_tr_b16 a[234:235], v23 offset:41984
  ds_read_b64_tr_b16 a[236:237], v23 offset:45056
  ds_read_b64_tr_b16 a[238:239], v23 offset:46080
  ds_read_b64_tr_b16 a[240:241], v23 offset:49152
  ds_read_b64_tr_b16 a[242:243], v23 offset:50176
  ds_read_b64_tr_b16 a[244:245], v23 offset:53248
  ds_read_b64_tr_b16 a[246:247], v23 offset:54272
  ds_read_b64_tr_b16 a[248:249], v23 offset:57344
  ds_read_b64_tr_b16 a[250:251], v23 offset:58368
  ds_read_b64_tr_b16 a[252:253], v23 offset:61440
  ds_read_b64_tr_b16 a[254:255], v23 offset:62464
  s_waitcnt lgkmcnt(0)
  s_waitcnt vmcnt(16)
  s_barrier
  s_add_u32 s27, s26, 3145728
  s_add_u32 m0, s28, 65536
  s_nop 0
  buffer_load_dwordx4 v20, s[64:67], s27 offen lds
  s_add_u32 m0, s28, 66560
  s_add_u32 s27, s27, 32768
  buffer_load_dwordx4 v20, s[64:67], s27 offen lds
  s_add_u32 m0, s28, 67584
  s_add_u32 s27, s27, 32768
  buffer_load_dwordx4 v21, s[64:67], s27 offen lds
  s_add_u32 m0, s28, 68608
  s_add_u32 s27, s27, 32768
  buffer_load_dwordx4 v21, s[64:67], s27 offen lds
  s_add_u32 m0, s28, 69632
  s_add_u32 s27, s27, 32768
  buffer_load_dwordx4 v20, s[64:67], s27 offen lds
  s_add_u32 m0, s28, 70656
  s_add_u32 s27, s27, 32768
  buffer_load_dwordx4 v20, s[64:67], s27 offen lds
  s_add_u32 m0, s28, 71680
  s_add_u32 s27, s27, 32768
  buffer_load_dwordx4 v21, s[64:67], s27 offen lds
  s_add_u32 m0, s28, 72704
  s_add_u32 s27, s27, 32768
  buffer_load_dwordx4 v21, s[64:67], s27 offen lds
  ds_read_b64_tr_b16 v[128:129], v24 offset:0
  ds_read_b64_tr_b16 v[130:131], v24 offset:1024
  ds_read_b64_tr_b16 v[132:133], v24 offset:4096
  ds_read_b64_tr_b16 v[134:135], v24 offset:5120
  ds_read_b64_tr_b16 v[136:137], v24 offset:8192
  ds_read_b64_tr_b16 v[138:139], v24 offset:9216
  ds_read_b64_tr_b16 v[140:141], v24 offset:12288
  ds_read_b64_tr_b16 v[142:143], v24 offset:13312
  ds_read_b64_tr_b16 v[144:145], v24 offset:16384
  ds_read_b64_tr_b16 v[146:147], v24 offset:17408
  ds_read_b64_tr_b16 v[148:149], v24 offset:20480
  ds_read_b64_tr_b16 v[150:151], v24 offset:21504
  ds_read_b64_tr_b16 v[152:153], v24 offset:24576
  ds_read_b64_tr_b16 v[154:155], v24 offset:25600
  ds_read_b64_tr_b16 v[156:157], v24 offset:28672
  ds_read_b64_tr_b16 v[158:159], v24 offset:29696
  s_waitcnt lgkmcnt(0)
  s_waitcnt vmcnt(16)
  s_barrier
  s_add_u32 s27, s26, 0
  s_add_u32 m0, s28, 98304
  s_nop 0
  buffer_load_dwordx4 v20, s[68:71], s27 offen lds
  s_add_u32 m0, s28, 99328
  s_add_u32 s27, s27, 32768
  buffer_load_dwordx4 v20, s[68:71], s27 offen lds
  s_add_u32 m0, s28, 100352
  s_add_u32 s27, s27, 32768
  buffer_load_dwordx4 v21, s[68:71], s27 offen lds
  s_add_u32 m0, s28, 101376
  s_add_u32 s27, s27, 32768
  buffer_load_dwordx4 v21, s[68:71], s27 offen lds
  s_add_u32 m0, s28, 102400
  s_add_u32 s27, s27, 32768
  buffer_load_dwordx4 v20, s[68:71], s27 offen lds
  s_add_u32 m0, s28, 103424
  s_add_u32 s27, s27, 32768
  buffer_load_dwordx4 v20, s[68:71], s27 offen lds
  s_add_u32 m0, s28, 104448
  s_add_u32 s27, s27, 32768
  buffer_load_dwordx4 v21, s[68:71], s27 offen lds
  s_add_u32 m0, s28, 105472
  s_add_u32 s27, s27, 32768
  buffer_load_dwordx4 v21, s[68:71], s27 offen lds
  ds_read_b64_tr_b16 v[160:161], v22 offset:0
  ds_read_b64_tr_b16 v[162:163], v22 offset:1024
  ds_read_b64_tr_b16 v[164:165], v22 offset:4096
  ds_read_b64_tr_b16 v[166:167], v22 offset:5120
  ds_read_b64_tr_b16 v[168:169], v22 offset:8192
  ds_read_b64_tr_b16 v[170:171], v22 offset:9216
  ds_read_b64_tr_b16 v[172:173], v22 offset:12288
  ds_read_b64_tr_b16 v[174:175], v22 offset:13312
  ds_read_b64_tr_b16 v[176:177], v22 offset:16384
  ds_read_b64_tr_b16 v[178:179], v22 offset:17408
  ds_read_b64_tr_b16 v[180:181], v22 offset:20480
  ds_read_b64_tr_b16 v[182:183], v22 offset:21504
  ds_read_b64_tr_b16 v[184:185], v22 offset:24576
  ds_read_b64_tr_b16 v[186:187], v22 offset:25600
  ds_read_b64_tr_b16 v[188:189], v22 offset:28672
  ds_read_b64_tr_b16 v[190:191], v22 offset:29696
  s_waitcnt lgkmcnt(0)
  s_waitcnt vmcnt(16)
  s_barrier
  s_add_u32 s27, s26, 1048576
  s_add_u32 m0, s28, 131072
  s_nop 0
  buffer_load_dwordx4 v20, s[68:71], s27 offen lds
  s_add_u32 m0, s28, 132096
  s_add_u32 s27, s27, 32768
  buffer_load_dwordx4 v20, s[68:71], s27 offen lds
  s_add_u32 m0, s28, 133120
  s_add_u32 s27, s27, 32768
  buffer_load_dwordx4 v21, s[68:71], s27 offen lds
  s_add_u32 m0, s28, 134144
  s_add_u32 s27, s27, 32768
  buffer_load_dwordx4 v21, s[68:71], s27 offen lds
  s_add_u32 m0, s28, 135168
  s_add_u32 s27, s27, 32768
  buffer_load_dwordx4 v20, s[68:71], s27 offen lds
  s_add_u32 m0, s28, 136192
  s_add_u32 s27, s27, 32768
  buffer_load_dwordx4 v20, s[68:71], s27 offen lds
  s_add_u32 m0, s28, 137216
  s_add_u32 s27, s27, 32768
  buffer_load_dwordx4 v21, s[68:71], s27 offen lds
  s_add_u32 m0, s28, 138240
  s_add_u32 s27, s27, 32768
  buffer_load_dwordx4 v21, s[68:71], s27 offen lds
  ds_read_b64_tr_b16 v[192:193], v22 offset:32768
  ds_read_b64_tr_b16 v[194:195], v22 offset:33792
  ds_read_b64_tr_b16 v[196:197], v22 offset:36864
  ds_read_b64_tr_b16 v[198:199], v22 offset:37888
  ds_read_b64_tr_b16 v[200:201], v22 offset:40960
  ds_read_b64_tr_b16 v[202:203], v22 offset:41984
  ds_read_b64_tr_b16 v[204:205], v22 offset:45056
  ds_read_b64_tr_b16 v[206:207], v22 offset:46080
  ds_read_b64_tr_b16 v[208:209], v22 offset:49152
  ds_read_b64_tr_b16 v[210:211], v22 offset:50176
  ds_read_b64_tr_b16 v[212:213], v22 offset:53248
  ds_read_b64_tr_b16 v[214:215], v22 offset:54272
  ds_read_b64_tr_b16 v[216:217], v22 offset:57344
  ds_read_b64_tr_b16 v[218:219], v22 offset:58368
  ds_read_b64_tr_b16 v[220:221], v22 offset:61440
  ds_read_b64_tr_b16 v[222:223], v22 offset:62464
  s_waitcnt lgkmcnt(0)
  s_waitcnt vmcnt(16)
  s_barrier
  s_add_u32 s27, s26, 2097152
  s_add_u32 m0, s28, 0
  s_nop 0
  buffer_load_dwordx4 v20, s[68:71], s27 offen lds
  s_add_u32 m0, s28, 1024
  s_add_u32 s27, s27, 32768
  buffer_load_dwordx4 v20, s[68:71], s27 offen lds
  s_add_u32 m0, s28, 2048
  s_add_u32 s27, s27, 32768
  buffer_load_dwordx4 v21, s[68:71], s27 offen lds
  s_add_u32 m0, s28, 3072
  s_add_u32 s27, s27, 32768
  buffer_load_dwordx4 v21, s[68:71], s27 offen lds
  s_add_u32 m0, s28, 4096
  s_add_u32 s27, s27, 32768
  buffer_load_dwordx4 v20, s[68:71], s27 offen lds
  s_add_u32 m0, s28, 5120
  s_add_u32 s27, s27, 32768
  buffer_load_dwordx4 v20, s[68:71], s27 offen lds
  s_add_u32 m0, s28, 6144
  s_add_u32 s27, s27, 32768
  buffer_load_dwordx4 v21, s[68:71], s27 offen lds
  s_add_u32 m0, s28, 7168
  s_add_u32 s27, s27, 32768
  buffer_load_dwordx4 v21, s[68:71], s27 offen lds
  ds_read_b64_tr_b16 v[224:225], v23 offset:0
  ds_read_b64_tr_b16 v[226:227], v23 offset:1024
  ds_read_b64_tr_b16 v[228:229], v23 offset:4096
  ds_read_b64_tr_b16 v[230:231], v23 offset:5120
  ds_read_b64_tr_b16 v[232:233], v23 offset:8192
  ds_read_b64_tr_b16 v[234:235], v23 offset:9216
  ds_read_b64_tr_b16 v[236:237], v23 offset:12288
  ds_read_b64_tr_b16 v[238:239], v23 offset:13312
  ds_read_b64_tr_b16 v[240:241], v23 offset:16384
  ds_read_b64_tr_b16 v[242:243], v23 offset:17408
  ds_read_b64_tr_b16 v[244:245], v23 offset:20480
  ds_read_b64_tr_b16 v[246:247], v23 offset:21504
  ds_read_b64_tr_b16 v[248:249], v23 offset:24576
  ds_read_b64_tr_b16 v[250:251], v23 offset:25600
  ds_read_b64_tr_b16 v[252:253], v23 offset:28672
  ds_read_b64_tr_b16 v[254:255], v23 offset:29696
  s_waitcnt lgkmcnt(0)
  s_waitcnt vmcnt(16)
  s_barrier
  s_add_u32 s27, s26, 3145728
  s_add_u32 m0, s28, 32768
  s_nop 0
  buffer_load_dwordx4 v20, s[68:71], s27 offen lds
  s_add_u32 m0, s28, 33792
  s_add_u32 s27, s27, 32768
  buffer_load_dwordx4 v20, s[68:71], s27 offen lds
  s_add_u32 m0, s28, 34816
  s_add_u32 s27, s27, 32768
  buffer_load_dwordx4 v21, s[68:71], s27 offen lds
  s_add_u32 m0, s28, 35840
  s_add_u32 s27, s27, 32768
  buffer_load_dwordx4 v21, s[68:71], s27 offen lds
  s_add_u32 m0, s28, 36864
  s_add_u32 s27, s27, 32768
  buffer_load_dwordx4 v20, s[68:71], s27 offen lds
  s_add_u32 m0, s28, 37888
  s_add_u32 s27, s27, 32768
  buffer_load_dwordx4 v20, s[68:71], s27 offen lds
  s_add_u32 m0, s28, 38912
  s_add_u32 s27, s27, 32768
  buffer_load_dwordx4 v21, s[68:71], s27 offen lds
  s_add_u32 m0, s28, 39936
  s_add_u32 s27, s27, 32768
  buffer_load_dwordx4 v21, s[68:71], s27 offen lds
  ds_read_b64_tr_b16 a[0:1], v23 offset:32768
  ds_read_b64_tr_b16 a[2:3], v23 offset:33792
  ds_read_b64_tr_b16 a[4:5], v23 offset:36864
  ds_read_b64_tr_b16 a[6:7], v23 offset:37888
  ds_read_b64_tr_b16 a[8:9], v23 offset:40960
  ds_read_b64_tr_b16 a[10:11], v23 offset:41984
  ds_read_b64_tr_b16 a[12:13], v23 offset:45056
  ds_read_b64_tr_b16 a[14:15], v23 offset:46080
  ds_read_b64_tr_b16 a[16:17], v23 offset:49152
  ds_read_b64_tr_b16 a[18:19], v23 offset:50176
  ds_read_b64_tr_b16 a[20:21], v23 offset:53248
  ds_read_b64_tr_b16 a[22:23], v23 offset:54272
  ds_read_b64_tr_b16 a[24:25], v23 offset:57344
  ds_read_b64_tr_b16 a[26:27], v23 offset:58368
  ds_read_b64_tr_b16 a[28:29], v23 offset:61440
  ds_read_b64_tr_b16 a[30:31], v23 offset:62464
  s_waitcnt lgkmcnt(0)
  s_waitcnt vmcnt(16)
  s_barrier
  ds_read_b64_tr_b16 a[32:33], v24 offset:0
  ds_read_b64_tr_b16 a[34:35], v24 offset:1024
  ds_read_b64_tr_b16 a[36:37], v24 offset:4096
  ds_read_b64_tr_b16 a[38:39], v24 offset:5120
  ds_read_b64_tr_b16 a[40:41], v24 offset:8192
  ds_read_b64_tr_b16 a[42:43], v24 offset:9216
  ds_read_b64_tr_b16 a[44:45], v24 offset:12288
  ds_read_b64_tr_b16 a[46:47], v24 offset:13312
  ds_read_b64_tr_b16 a[48:49], v24 offset:16384
  ds_read_b64_tr_b16 a[50:51], v24 offset:17408
  ds_read_b64_tr_b16 a[52:53], v24 offset:20480
  ds_read_b64_tr_b16 a[54:55], v24 offset:21504
  ds_read_b64_tr_b16 a[56:57], v24 offset:24576
  ds_read_b64_tr_b16 a[58:59], v24 offset:25600
  ds_read_b64_tr_b16 a[60:61], v24 offset:28672
  ds_read_b64_tr_b16 a[62:63], v24 offset:29696
  s_waitcnt lgkmcnt(0)
  s_waitcnt vmcnt(8)
  s_barrier
  ds_read_b64_tr_b16 a[64:65], v22 offset:0
  ds_read_b64_tr_b16 a[66:67], v22 offset:1024
  ds_read_b64_tr_b16 a[68:69], v22 offset:4096
  ds_read_b64_tr_b16 a[70:71], v22 offset:5120
  ds_read_b64_tr_b16 a[72:73], v22 offset:8192
  ds_read_b64_tr_b16 a[74:75], v22 offset:9216
  ds_read_b64_tr_b16 a[76:77], v22 offset:12288
  ds_read_b64_tr_b16 a[78:79], v22 offset:13312
  ds_read_b64_tr_b16 a[80:81], v22 offset:16384
  ds_read_b64_tr_b16 a[82:83], v22 offset:17408
  ds_read_b64_tr_b16 a[84:85], v22 offset:20480
  ds_read_b64_tr_b16 a[86:87], v22 offset:21504
  ds_read_b64_tr_b16 a[88:89], v22 offset:24576
  ds_read_b64_tr_b16 a[90:91], v22 offset:25600
  ds_read_b64_tr_b16 a[92:93], v22 offset:28672
  ds_read_b64_tr_b16 a[94:95], v22 offset:29696
  s_waitcnt lgkmcnt(0)
  s_waitcnt vmcnt(0)
  s_barrier
  ds_read_b64_tr_b16 a[96:97], v22 offset:32768
  ds_read_b64_tr_b16 a[98:99], v22 offset:33792
  ds_read_b64_tr_b16 a[100:101], v22 offset:36864
  ds_read_b64_tr_b16 a[102:103], v22 offset:37888
  ds_read_b64_tr_b16 a[104:105], v22 offset:40960
  ds_read_b64_tr_b16 a[106:107], v22 offset:41984
  ds_read_b64_tr_b16 a[108:109], v22 offset:45056
  ds_read_b64_tr_b16 a[110:111], v22 offset:46080
  ds_read_b64_tr_b16 a[112:113], v22 offset:49152
  ds_read_b64_tr_b16 a[114:115], v22 offset:50176
  ds_read_b64_tr_b16 a[116:117], v22 offset:53248
  ds_read_b64_tr_b16 a[118:119], v22 offset:54272
  ds_read_b64_tr_b16 a[120:121], v22 offset:57344
  ds_read_b64_tr_b16 a[122:123], v22 offset:58368
  ds_read_b64_tr_b16 a[124:125], v22 offset:61440
  ds_read_b64_tr_b16 a[126:127], v22 offset:62464
  s_waitcnt lgkmcnt(0)
q_ld_84:
  s_waitcnt lgkmcnt(0)
  s_barrier
  v_mbcnt_lo_u32_b32 v20, -1, 0
  v_and_b32 v20, 0, v20
  v_add_lshl_u32 v20, v20, 1, 2
  s_mov_b32 s26, 0
g_wt_85:
  global_load_dword v21, v20, s[12:13] offset:128 sc1
  s_add_u32 s26, s26, 1
  s_cmp_gt_u32 s26, 1048576
  s_cbranch_scc1 L_end
  s_waitcnt vmcnt(0)
  v_cmp_eq_u32 vcc, 0, v21
  v_readfirstlane_b32 s27, v21
  s_cbranch_vccnz g_wt_85
  v_lshrrev_b32 v7, 7, v0
  v_lshlrev_b32 v7, 12, v7
  v_and_b32 v2, 1023, v9
  s_lshl_b32 s26, s17, 10
  v_add3_u32 v7, v7, v2, s26
  v_mov_b32 v116, 0
  s_mov_b32 s47, s60
  s_add_u32 s76, s60, 3
  s_add_u32 s41, s60, 64
  s_mov_b32 s40, 18
  s_mov_b32 s42, 0
  s_mov_b32 s48, 0
  s_mov_b32 s49, 268435456
  s_mov_b32 s43, 268435456
  s_mov_b32 s50, 32768
  s_mov_b32 s56, 1
  s_mov_b32 s61, 0
  s_mov_b32 s62, 0
  s_lshl_b32 s54, s17, 13
  s_mov_b32 s50, 0
  v_mov_b32 v4, 1
q_slow_86:
  s_nop 1
  s_nop 7
  v_cvt_pk_bf16_f32 v100, v52, v53
  v_cvt_pk_bf16_f32 v101, v54, v55
  v_cvt_pk_bf16_f32 v102, v60, v61
  v_cvt_pk_bf16_f32 v103, v62, v63
  v_cvt_pk_bf16_f32 v104, v56, v57
  v_cvt_pk_bf16_f32 v105, v58, v59
  v_cvt_pk_bf16_f32 v106, v64, v65
  v_cvt_pk_bf16_f32 v107, v66, v67
  s_waitcnt vmcnt(0)
  s_mov_b64 exec, 1
  buffer_store_dword v4, off, s[4:7], s49 sc1
  s_mov_b64 exec, -1
  buffer_store_dwordx4 v[100:103], v8, s[4:7], s43 offen offset:0 sc1
  buffer_store_dwordx4 v[104:107], v8, s[4:7], s43 offen offset:512 sc1
  s_mov_b32 s43, 268435456
  s_xor_b32 s50, s50, 32768
q_nxt_96:
  s_cmp_ge_u32 s47, 128
  s_cbranch_scc1 q_end_87
  s_cmp_lg_u32 s48, 0
  s_cbranch_scc1 q_have_88
  s_mov_b32 s53, 0
q_poll_89:
  s_cmp_lt_u32 s47, 64
  s_cselect_b32 s26, 2, 0
  s_add_u32 s26, s26, s47
  s_lshl_b32 s26, s26, 12
  s_add_u32 s26, s26, 243261440
  s_mov_b64 exec, 0xffffff
  buffer_load_dword v116, v7, s[4:7], s26 offen sc1
  s_mov_b64 exec, -1
  s_add_u32 s53, s53, 1
  s_cmp_gt_u32 s53, 1048576
  s_cbranch_scc1 q_fail_90
  s_waitcnt vmcnt(0)
  s_mov_b64 exec, 3
  buffer_store_dword v4, v0, s[4:7], s49 offen sc1
  s_mov_b64 exec, -1
  s_mov_b32 s49, 268435456
  v_cmp_eq_u32 vcc, 0, v116
  s_nop 0
  s_and_b32 s26, vcc_lo, 0xffffff
  s_cbranch_scc1 q_poll_89
  s_and_b32 s63, s47, 127
  s_lshl_b32 s63, s63, 15
  s_xor_b32 s27, s50, 32768
  s_add_u32 m0, s27, s54
  s_add_u32 s63, s63, s54
  s_add_u32 s63, s63, 6291456
  buffer_load_dwordx4 v12, s[4:7], s63 offen offset:0 sc1 lds
  buffer_load_dwordx4 v13, s[4:7], s63 offen offset:1024 sc1 lds
  buffer_load_dwordx4 v14, s[4:7], s63 offen offset:2048 sc1 lds
  buffer_load_dwordx4 v15, s[4:7], s63 offen offset:3072 sc1 lds
  s_add_u32 m0, m0, 4096
  s_add_u32 s63, s63, 4096
  buffer_load_dwordx4 v16, s[4:7], s63 offen offset:0 sc1 lds
  buffer_load_dwordx4 v17, s[4:7], s63 offen offset:1024 sc1 lds
  buffer_load_dwordx4 v18, s[4:7], s63 offen offset:2048 sc1 lds
  buffer_load_dwordx4 v19, s[4:7], s63 offen offset:3072 sc1 lds
  v_cmp_eq_u32 vcc, 0, v116
  v_max_u32_dpp v117, v116, v116 quad_perm:[1,0,3,2] row_mask:0xf bank_mask:0xf
  s_and_b32 s48, vcc_lo, 0xffffff
  s_cselect_b32 s48, 0, -1
  v_max_u32_dpp v117, v117, v117 quad_perm:[2,3,0,1] row_mask:0xf bank_mask:0xf
  s_nop 1
  v_max_u32_dpp v117, v117, v117 row_half_mirror row_mask:0xf bank_mask:0xf
  v_and_b32 v117, s48, v117
q_have_88:
  ds_write_b32 v118, v117 offset:256
  s_xor_b32 s50, s50, 32768
  s_waitcnt lgkmcnt(0)
  s_barrier
  ds_read_b128 v[108:111], v119 offset:256
  s_cmp_lt_u32 s47, 64
  s_cbranch_scc1 q_nopre_92
  s_waitcnt lgkmcnt(0)
  v_min3_u32 v112, v108, v109, v110
  v_max3_u32 v108, v108, v109, v110
  v_min_u32 v112, v112, v111
  v_max_u32 v108, v108, v111
  v_readfirstlane_b32 s45, v112
  v_readlane_b32 s28, v108, 0
  v_readlane_b32 s29, v108, 1
  v_readlane_b32 s30, v108, 2
  s_cmp_gt_u32 s28, s56
  s_addc_u32 s42, s42, s42
  s_max_u32 s56, s56, s28
  s_and_b32 s26, s42, 1
  s_cselect_b32 s26, s40, 0
  s_cmp_gt_u32 s26, 10
  s_subb_u32 s40, s40, 0
  s_cmp_gt_u32 s29, s56
  s_addc_u32 s42, s42, s42
  s_max_u32 s56, s56, s29
  s_and_b32 s26, s42, 1
  s_cselect_b32 s26, s40, 0
  s_cmp_gt_u32 s26, 10
  s_subb_u32 s40, s40, 0
  s_cmp_gt_u32 s30, s56
  s_addc_u32 s42, s42, s42
  s_max_u32 s56, s56, s30
  s_add_u32 s76, s47, s40
  s_add_u32 s41, s47, 3
  s_sub_u32 s76, s76, 64
  s_and_b32 s26, s42, 1
  s_cselect_b32 s26, s40, 0
  s_cmp_gt_u32 s26, 10
  s_cselect_b32 s76, 64, s76
  s_subb_u32 s40, s40, 0
  s_cmp_lt_u32 s76, 64
  s_cselect_b32 s76, s76, s41
  s_bitcmp1_b32 s42, 0
  s_cbranch_scc1 q_fork_93
q_nopre_92:
  s_waitcnt vmcnt(0)
  s_sub_u32 s26, s47, s60
  s_cmp_lg_u32 s26, 15
  s_cbranch_scc1 q_cold_94
  v_mbcnt_lo_u32_b32 v20, -1, 0
  v_and_b32 v20, 0, v20
  v_add_lshl_u32 v20, v20, 2, 2
  s_mov_b32 s26, 0
g_wt_101:
  global_load_dword v21, v20, s[12:13] offset:128 sc1
  s_add_u32 s26, s26, 1
  s_cmp_gt_u32 s26, 1048576
  s_cbranch_scc1 L_end
  s_waitcnt vmcnt(0)
  v_cmp_eq_u32 vcc, 0, v21
  v_readfirstlane_b32 s27, v21
  s_cbranch_vccnz g_wt_101
  s_load_dwordx2 s[64:65], s[0:1], 72
  s_load_dwordx2 s[68:69], s[0:1], 80
  s_load_dwordx2 s[8:9], s[0:1], 88
  s_mov_b32 s66, 1835008
  s_mov_b32 s70, 1835008
  s_mov_b32 s10, 1835008
  v_lshrrev_b32 v2, 7, v0
  v_and_b32 v3, 0x70, v0
  v_mul_u32_u24 v6, 57344, v2
  v_add_u32 v6, v6, v3
  v_cmp_eq_u32 vcc, 0x70, v3
  v_mov_b32 v3, 0x7ff00000
  s_nop 0
  v_cndmask_b32 v6, v6, v3, vcc
  v_lshrrev_b32 v2, 8, v0
  v_mul_u32_u24 v7, 14336, v2
  v_and_b32 v3, 0xf0, v0
  v_add_u32 v7, v7, v3
  s_mul_i32 s34, s17, 458752
  s_mul_i32 s27, s16, 112
  s_add_u32 s34, s34, s27
  s_mul_i32 s35, s16, 57344
  s_lshl_b32 s27, s17, 8
  s_add_u32 s35, s35, s27
  s_waitcnt lgkmcnt(0)
  s_mul_i32 s26, s17, 23552
  s_add_u32 m0, s26, 65536
  s_add_u32 s36, s34, 0
  buffer_load_dwordx4 v6, s[64:67], s36 offen lds
  s_add_u32 m0, m0, 1024
  s_add_u32 s36, s34, 0
  buffer_load_dwordx4 v6, s[68:71], s36 offen lds
  s_add_u32 m0, m0, 1024
  s_add_u32 s36, s34, 3584
  buffer_load_dwordx4 v6, s[64:67], s36 offen lds
  s_add_u32 m0, m0, 1024
  s_add_u32 s36, s34, 3584
  buffer_load_dwordx4 v6, s[68:71], s36 offen lds
  s_add_u32 m0, m0, 1024
  s_add_u32 s36, s34, 7168
  buffer_load_dwordx4 v6, s[64:67], s36 offen lds
  s_add_u32 m0, m0, 1024
  s_add_u32 s36, s34, 7168
  buffer_load_dwordx4 v6, s[68:71], s36 offen lds
  s_add_u32 m0, m0, 1024
  s_add_u32 s36, s34, 10752
  buffer_load_dwordx4 v6, s[64:67], s36 offen lds
  s_add_u32 m0, m0, 1024
  s_add_u32 s36, s34, 10752
  buffer_load_dwordx4 v6, s[68:71], s36 offen lds
  s_add_u32 m0, m0, 1024
  s_add_u32 s36, s34, 14336
  buffer_load_dwordx4 v6, s[64:67], s36 offen lds
  s_add_u32 m0, m0, 1024
  s_add_u32 s36, s34, 14336
  buffer_load_dwordx4 v6, s[68:71], s36 offen lds
  s_add_u32 m0, m0, 1024
  s_add_u32 s36, s34, 17920
  buffer_load_dwordx4 v6, s[64:67], s36 offen lds
  s_add_u32 m0, m0, 1024
  s_add_u32 s36, s34, 17920
  buffer_load_dwordx4 v6, s[68:71], s36 offen lds
  s_add_u32 m0, m0, 1024
  s_add_u32 s36, s34, 21504
  buffer_load_dwordx4 v6, s[64:67], s36 offen lds
  s_add_u32 m0, m0, 1024
  s_add_u32 s36, s34, 21504
  buffer_load_dwordx4 v6, s[68:71], s36 offen lds
  s_add_u32 m0, m0, 1024
  s_add_u32 s36, s34, 25088
  buffer_load_dwordx4 v6, s[64:67], s36 offen lds
  s_add_u32 m0, m0, 1024
  s_add_u32 s36, s34, 25088
  buffer_load_dwordx4 v6, s[68:71], s36 offen lds
  s_add_u32 m0, m0, 1024
  s_add_u32 s36, s34, 28672
  buffer_load_dwordx4 v6, s[64:67], s36 offen lds
  s_add_u32 m0, m0, 1024
  s_add_u32 s36, s34, 28672
  buffer_load_dwordx4 v6, s[68:71], s36 offen lds
  s_add_u32 m0, m0, 1024
  s_add_u32 s36, s34, 32256
  buffer_load_dwordx4 v6, s[64:67], s36 offen lds
  s_add_u32 m0, m0, 1024
  s_add_u32 s36, s34, 32256
  buffer_load_dwordx4 v6, s[68:71], s36 offen lds
  s_add_u32 m0, m0, 1024
  s_add_u32 s36, s34, 35840
  buffer_load_dwordx4 v6, s[64:67], s36 offen lds
  s_add_u32 m0, m0, 1024
  s_add_u32 s36, s34, 35840
  buffer_load_dwordx4 v6, s[68:71], s36 offen lds
  s_add_u32 m0, m0, 1024
  s_add_u32 s36, s34, 39424
  buffer_load_dwordx4 v6, s[64:67], s36 offen lds
  s_add_u32 m0, m0, 1024
  v_lshrrev_b32 v7, 7, v0
  v_lshlrev_b32 v7, 12, v7
  v_and_b32 v2, 1023, v9
  s_lshl_b32 s26, s17, 10
  v_add3_u32 v7, v7, v2, s26
  v_mov_b32 v116, 0
q_cold_94:
  s_waitcnt lgkmcnt(0)
  s_barrier
  s_cmp_lg_u32 s50, 0
  s_cbranch_scc1 q_c1_98
q_c0_97:
  ds_read_b128 v[68:71], v120 offset:0
  ds_read_b128 v[72:75], v121 offset:0
  ds_read_b128 v[76:79], v122 offset:0
q_w0_99:
  s_waitcnt lgkmcnt(2)
  v_mfma_f32_32x32x16_bf16 v[20:35], v[128:131], v[68:71], 0
  ds_read_b128 v[80:83], v123 offset:0
  s_mov_b32 s46, s47
  s_mov_b32 s47, s76
  s_lshl_b32 s52, s46, 7
  s_add_u32 s52, s52, s57
  v_mfma_f32_32x32x16_bf16 v[36:51], v[68:71], a[0:3], 0
  s_waitcnt vmcnt(0)
  s_mov_b64 exec, 1
  buffer_store_dword v4, off, s[4:7], s49 sc1
  s_mov_b64 exec, -1
  s_lshl_b32 s44, s52, 12
  s_waitcnt lgkmcnt(2)
  v_mfma_f32_32x32x16_bf16 v[20:35], v[132:135], v[72:75], v[20:35]
  ds_read_b128 v[84:87], v124 offset:0
  s_add_u32 s44, s44, 41943040
  s_lshl_b32 s51, s52, 5
  s_add_u32 s51, s51, 244318208
  s_lshr_b32 s55, s47, 7
  v_mfma_f32_32x32x16_bf16 v[36:51], v[72:75], a[4:7], v[36:51]
  s_sub_u32 s27, s47, s60
  s_cmp_eq_u32 s27, 15
  s_cselect_b32 s55, 1, s55
  s_add_u32 s76, s47, 3
  s_cmp_lt_u32 s76, 18
  s_cselect_b32 s76, s76, s41
  s_waitcnt lgkmcnt(2)
  v_mfma_f32_32x32x16_bf16 v[20:35], v[136:139], v[76:79], v[20:35]
  ds_read_b128 v[88:91], v125 offset:0
  v_cvt_pk_bf16_f32 v100, v52, v53
  v_cvt_pk_bf16_f32 v101, v54, v55
  v_cvt_pk_bf16_f32 v102, v60, v61
  v_cvt_pk_bf16_f32 v103, v62, v63
  v_mfma_f32_32x32x16_bf16 v[36:51], v[76:79], a[8:11], v[36:51]
  buffer_store_dwordx4 v[100:103], v8, s[4:7], s43 offen offset:0 sc1
  v_cvt_pk_bf16_f32 v104, v56, v57
  v_cvt_pk_bf16_f32 v105, v58, v59
  s_waitcnt lgkmcnt(2)
  v_mfma_f32_32x32x16_bf16 v[20:35], v[140:143], v[80:83], v[20:35]
  ds_read_b128 v[92:95], v126 offset:0
  v_cvt_pk_bf16_f32 v106, v64, v65
  v_cvt_pk_bf16_f32 v107, v66, v67
  v_mfma_f32_32x32x16_bf16 v[36:51], v[80:83], a[12:15], v[36:51]
  s_waitcnt lgkmcnt(2)
  v_mfma_f32_32x32x16_bf16 v[20:35], v[144:147], v[84:87], v[20:35]
  ds_read_b128 v[96:99], v127 offset:0
  buffer_store_dwordx4 v[104:107], v8, s[4:7], s43 offen offset:512 sc1
  s_lshl_b32 s43, s52, 11
  v_mfma_f32_32x32x16_bf16 v[36:51], v[84:87], a[16:19], v[36:51]
  s_add_u32 s43, s43, 142606336
  s_waitcnt lgkmcnt(2)
  v_mfma_f32_32x32x16_bf16 v[20:35], v[148:151], v[88:91], v[20:35]
  ds_read_b128 v[68:71], v120 offset:256
  v_mfma_f32_32x32x16_bf16 v[36:51], v[88:91], a[20:23], v[36:51]
  s_waitcnt lgkmcnt(2)
  v_mfma_f32_32x32x16_bf16 v[20:35], v[152:155], v[92:95], v[20:35]
  ds_read_b128 v[72:75], v121 offset:256
  s_cmp_lt_u32 s47, 64
  s_cselect_b32 s26, 2, 0
  s_add_u32 s26, s26, s47
  s_lshl_b32 s26, s26, 12
  v_mfma_f32_32x32x16_bf16 v[36:51], v[92:95], a[24:27], v[36:51]
  s_add_u32 s26, s26, 243261440
  s_mov_b64 exec, 0xffffff
  buffer_load_dword v116, v7, s[4:7], s26 offen sc1
  s_mov_b64 exec, -1
  s_waitcnt lgkmcnt(2)
  v_mfma_f32_32x32x16_bf16 v[20:35], v[156:159], v[96:99], v[20:35]
  ds_read_b128 v[76:79], v122 offset:256
  v_mfma_f32_32x32x16_bf16 v[36:51], v[96:99], a[28:31], v[36:51]
  s_waitcnt lgkmcnt(2)
  v_mfma_f32_32x32x16_bf16 v[20:35], v[160:163], v[68:71], v[20:35]
  ds_read_b128 v[80:83], v123 offset:256
  v_mfma_f32_32x32x16_bf16 v[36:51], v[68:71], a[32:35], v[36:51]
  s_waitcnt lgkmcnt(2)
  v_mfma_f32_32x32x16_bf16 v[20:35], v[164:167], v[72:75], v[20:35]
  ds_read_b128 v[84:87], v124 offset:256
  v_mfma_f32_32x32x16_bf16 v[36:51], v[72:75], a[36:39], v[36:51]
  s_waitcnt lgkmcnt(2)
  v_mfma_f32_32x32x16_bf16 v[20:35], v[168:171], v[76:79], v[20:35]
  ds_read_b128 v[88:91], v125 offset:256
  v_mfma_f32_32x32x16_bf16 v[36:51], v[76:79], a[40:43], v[36:51]
  s_waitcnt lgkmcnt(2)
  v_mfma_f32_32x32x16_bf16 v[20:35], v[172:175], v[80:83], v[20:35]
  ds_read_b128 v[92:95], v126 offset:256
  v_mfma_f32_32x32x16_bf16 v[36:51], v[80:83], a[44:47], v[36:51]
  s_waitcnt lgkmcnt(2)
  v_mfma_f32_32x32x16_bf16 v[20:35], v[176:179], v[84:87], v[20:35]
  ds_read_b128 v[96:99], v127 offset:256
  v_mfma_f32_32x32x16_bf16 v[36:51], v[84:87], a[48:51], v[36:51]
  s_waitcnt lgkmcnt(2)
  v_mfma_f32_32x32x16_bf16 v[20:35], v[180:183], v[88:91], v[20:35]
  ds_read_b128 v[68:71], v120 offset:512
  v_mfma_f32_32x32x16_bf16 v[36:51], v[88:91], a[52:55], v[36:51]
  s_waitcnt lgkmcnt(2)
  v_mfma_f32_32x32x16_bf16 v[20:35], v[184:187], v[92:95], v[20:35]
  ds_read_b128 v[72:75], v121 offset:512
  v_mfma_f32_32x32x16_bf16 v[36:51], v[92:95], a[56:59], v[36:51]
  s_waitcnt lgkmcnt(2)
  v_mfma_f32_32x32x16_bf16 v[20:35], v[188:191], v[96:99], v[20:35]
  ds_read_b128 v[76:79], v122 offset:512
  v_mfma_f32_32x32x16_bf16 v[36:51], v[96:99], a[60:63], v[36:51]
  s_waitcnt lgkmcnt(2)
  v_mfma_f32_32x32x16_bf16 v[20:35], v[192:195], v[68:71], v[20:35]
  ds_read_b128 v[80:83], v123 offset:512
  v_mfma_f32_32x32x16_bf16 v[36:51], v[68:71], a[64:67], v[36:51]
  s_waitcnt lgkmcnt(2)
  v_mfma_f32_32x32x16_bf16 v[20:35], v[196:199], v[72:75], v[20:35]
  ds_read_b128 v[84:87], v124 offset:512
  s_waitcnt vmcnt(0)
  s_mov_b64 exec, 3
  buffer_store_dword v4, v0, s[4:7], s49 offen sc1
  s_mov_b64 exec, -1
  v_mfma_f32_32x32x16_bf16 v[36:51], v[72:75], a[68:71], v[36:51]
  v_cmp_eq_u32 vcc, 0, v116
  v_max_u32_dpp v117, v116, v116 quad_perm:[1,0,3,2] row_mask:0xf bank_mask:0xf
  s_and_b32 s48, vcc_lo, 0xffffff
  s_cselect_b32 s48, 0, -1
  v_max_u32_dpp v117, v117, v117 quad_perm:[2,3,0,1] row_mask:0xf bank_mask:0xf
  s_waitcnt lgkmcnt(2)
  v_mfma_f32_32x32x16_bf16 v[20:35], v[200:203], v[76:79], v[20:35]
  ds_read_b128 v[88:91], v125 offset:512
  s_nop 1
  v_max_u32_dpp v117, v117, v117 row_half_mirror row_mask:0xf bank_mask:0xf
  v_and_b32 v117, s48, v117
  s_cmp_lg_u32 s48, 0
  s_cselect_b32 s28, s47, s46
  v_mfma_f32_32x32x16_bf16 v[36:51], v[76:79], a[72:75], v[36:51]
  s_and_b32 s63, s28, 127
  s_lshl_b32 s63, s63, 15
  s_xor_b32 s27, s50, 32768
  s_add_u32 m0, s27, s54
  s_add_u32 s63, s63, s54
  s_waitcnt lgkmcnt(2)
  v_mfma_f32_32x32x16_bf16 v[20:35], v[204:207], v[80:83], v[20:35]
  ds_read_b128 v[92:95], v126 offset:512
  s_add_u32 s63, s63, 6291456
  buffer_load_dwordx4 v12, s[4:7], s63 offen offset:0 sc1 lds
  v_mfma_f32_32x32x16_bf16 v[36:51], v[80:83], a[76:79], v[36:51]
  s_waitcnt lgkmcnt(2)
  v_mfma_f32_32x32x16_bf16 v[20:35], v[208:211], v[84:87], v[20:35]
  ds_read_b128 v[96:99], v127 offset:512
  v_mfma_f32_32x32x16_bf16 v[36:51], v[84:87], a[80:83], v[36:51]
  buffer_load_dwordx4 v13, s[4:7], s63 offen offset:1024 sc1 lds
  s_waitcnt lgkmcnt(2)
  v_mfma_f32_32x32x16_bf16 v[20:35], v[212:215], v[88:91], v[20:35]
  ds_read_b128 v[68:71], v120 offset:768
  v_mfma_f32_32x32x16_bf16 v[36:51], v[88:91], a[84:87], v[36:51]
  s_waitcnt lgkmcnt(2)
  v_mfma_f32_32x32x16_bf16 v[20:35], v[216:219], v[92:95], v[20:35]
  ds_read_b128 v[72:75], v121 offset:768
  buffer_load_dwordx4 v14, s[4:7], s63 offen offset:2048 sc1 lds
  v_mfma_f32_32x32x16_bf16 v[36:51], v[92:95], a[88:91], v[36:51]
  s_waitcnt lgkmcnt(2)
  v_mfma_f32_32x32x16_bf16 v[20:35], v[220:223], v[96:99], v[20:35]
  ds_read_b128 v[76:79], v122 offset:768
  v_mfma_f32_32x32x16_bf16 v[36:51], v[96:99], a[92:95], v[36:51]
  buffer_load_dwordx4 v15, s[4:7], s63 offen offset:3072 sc1 lds
  s_add_u32 m0, m0, 4096
  s_add_u32 s63, s63, 4096
  s_waitcnt lgkmcnt(2)
  v_mfma_f32_32x32x16_bf16 v[20:35], v[224:227], v[68:71], v[20:35]
  ds_read_b128 v[80:83], v123 offset:768
  v_mfma_f32_32x32x16_bf16 v[36:51], v[68:71], a[96:99], v[36:51]
  s_waitcnt lgkmcnt(2)
  v_mfma_f32_32x32x16_bf16 v[20:35], v[228:231], v[72:75], v[20:35]
  ds_read_b128 v[84:87], v124 offset:768
  buffer_load_dwordx4 v16, s[4:7], s63 offen offset:0 sc1 lds
  v_mfma_f32_32x32x16_bf16 v[36:51], v[72:75], a[100:103], v[36:51]
  s_waitcnt lgkmcnt(2)
  v_mfma_f32_32x32x16_bf16 v[20:35], v[232:235], v[76:79], v[20:35]
  ds_read_b128 v[88:91], v125 offset:768
  v_mfma_f32_32x32x16_bf16 v[36:51], v[76:79], a[104:107], v[36:51]
  buffer_load_dwordx4 v17, s[4:7], s63 offen offset:1024 sc1 lds
  s_waitcnt lgkmcnt(2)
  v_mfma_f32_32x32x16_bf16 v[20:35], v[236:239], v[80:83], v[20:35]
  ds_read_b128 v[92:95], v126 offset:768
  v_mfma_f32_32x32x16_bf16 v[36:51], v[80:83], a[108:111], v[36:51]
  s_waitcnt lgkmcnt(2)
  v_mfma_f32_32x32x16_bf16 v[20:35], v[240:243], v[84:87], v[20:35]
  ds_read_b128 v[96:99], v127 offset:768
  buffer_load_dwordx4 v18, s[4:7], s63 offen offset:2048 sc1 lds
  v_mfma_f32_32x32x16_bf16 v[36:51], v[84:87], a[112:115], v[36:51]
  s_waitcnt lgkmcnt(2)
  v_mfma_f32_32x32x16_bf16 v[20:35], v[244:247], v[88:91], v[20:35]
  ds_read_b128 v[68:71], v120 offset:0
  v_mfma_f32_32x32x16_bf16 v[36:51], v[88:91], a[116:119], v[36:51]
  ds_read_b128 v[72:75], v121 offset:0
  buffer_load_dwordx4 v19, s[4:7], s63 offen offset:3072 sc1 lds
  s_mov_b32 s49, s51
  s_waitcnt lgkmcnt(3)
  v_mfma_f32_32x32x16_bf16 v[20:35], v[248:251], v[92:95], v[20:35]
  ds_read_b128 v[76:79], v122 offset:0
  ds_write_b32 v118, v117 offset:0
  v_mfma_f32_32x32x16_bf16 v[36:51], v[92:95], a[120:123], v[36:51]
  ds_read_b128 v[80:83], v123 offset:0
  s_waitcnt lgkmcnt(5)
  v_mfma_f32_32x32x16_bf16 v[20:35], v[252:255], v[96:99], v[20:35]
  ds_read_b128 v[84:87], v124 offset:0
  v_mfma_f32_32x32x16_bf16 v[36:51], v[96:99], a[124:127], v[36:51]
  ds_read_b128 v[88:91], v125 offset:0
  s_waitcnt lgkmcnt(5)
  v_mfma_f32_32x32x16_bf16 v[52:67], a[128:131], v[68:71], 0
  ds_read_b128 v[92:95], v126 offset:0
  v_mfma_f32_32x32x16_bf16 v[52:67], a[132:135], v[72:75], v[52:67]
  ds_read_b128 v[96:99], v127 offset:0
  v_mul_f32 v20, s24, v20
  v_mul_f32 v21, s24, v21
  v_mul_f32 v22, s24, v22
  v_mul_f32 v23, s24, v23
  s_waitcnt lgkmcnt(4)
  v_mfma_f32_32x32x16_bf16 v[52:67], a[136:139], v[76:79], v[52:67]
  ds_read_b128 v[68:71], v120 offset:256
  v_mul_f32 v24, s24, v24
  v_mul_f32 v25, s24, v25
  v_cvt_pk_bf16_f32 v100, v36, v37
  v_cvt_pk_bf16_f32 v101, v38, v39
  v_mfma_f32_32x32x16_bf16 v[52:67], a[140:143], v[80:83], v[52:67]
  ds_read_b128 v[72:75], v121 offset:256
  v_cvt_pk_bf16_f32 v102, v44, v45
  v_cvt_pk_bf16_f32 v103, v46, v47
  buffer_store_dwordx4 v[100:103], v8, s[4:7], s44 offen offset:2048 sc1
  s_waitcnt lgkmcnt(4)
  v_mfma_f32_32x32x16_bf16 v[52:67], a[144:147], v[84:87], v[52:67]
  ds_read_b128 v[76:79], v122 offset:256
  v_cvt_pk_bf16_f32 v104, v40, v41
  v_cvt_pk_bf16_f32 v105, v42, v43
  v_cvt_pk_bf16_f32 v106, v48, v49
  v_cvt_pk_bf16_f32 v107, v50, v51
  v_mfma_f32_32x32x16_bf16 v[52:67], a[148:151], v[88:91], v[52:67]
  ds_read_b128 v[80:83], v123 offset:256
  buffer_store_dwordx4 v[104:107], v8, s[4:7], s44 offen offset:2560 sc1
  v_mul_f32 v26, s24, v26
  s_waitcnt lgkmcnt(4)
  v_mfma_f32_32x32x16_bf16 v[52:67], a[152:155], v[92:95], v[52:67]
  ds_read_b128 v[84:87], v124 offset:256
  v_mul_f32 v27, s24, v27
  v_mul_f32 v28, s24, v28
  v_mul_f32 v29, s24, v29
  v_mul_f32 v30, s24, v30
  v_mfma_f32_32x32x16_bf16 v[52:67], a[156:159], v[96:99], v[52:67]
  ds_read_b128 v[88:91], v125 offset:256
  v_mul_f32 v31, s24, v31
  v_mul_f32 v32, s24, v32
  v_mul_f32 v33, s24, v33
  v_mul_f32 v34, s24, v34
  s_waitcnt lgkmcnt(4)
  v_mfma_f32_32x32x16_bf16 v[52:67], a[160:163], v[68:71], v[52:67]
  ds_read_b128 v[92:95], v126 offset:256
  v_mul_f32 v35, s24, v35
  v_cvt_pk_bf16_f32 v108, v20, v21
  v_cvt_pk_bf16_f32 v109, v22, v23
  v_cvt_pk_bf16_f32 v110, v28, v29
  v_mfma_f32_32x32x16_bf16 v[52:67], a[164:167], v[72:75], v[52:67]
  ds_read_b128 v[96:99], v127 offset:256
  v_cvt_pk_bf16_f32 v111, v30, v31
  buffer_store_dwordx4 v[108:111], v8, s[4:7], s44 offen offset:0 sc1
  s_waitcnt lgkmcnt(4)
  v_mfma_f32_32x32x16_bf16 v[52:67], a[168:171], v[76:79], v[52:67]
  ds_read_b128 v[68:71], v120 offset:512
  v_cvt_pk_bf16_f32 v112, v24, v25
  v_cvt_pk_bf16_f32 v113, v26, v27
  v_cvt_pk_bf16_f32 v114, v32, v33
  v_cvt_pk_bf16_f32 v115, v34, v35
  v_mfma_f32_32x32x16_bf16 v[52:67], a[172:175], v[80:83], v[52:67]
  ds_read_b128 v[72:75], v121 offset:512
  buffer_store_dwordx4 v[112:115], v8, s[4:7], s44 offen offset:512 sc1
  s_waitcnt lgkmcnt(4)
  v_mfma_f32_32x32x16_bf16 v[52:67], a[176:179], v[84:87], v[52:67]
  ds_read_b128 v[76:79], v122 offset:512
  v_mfma_f32_32x32x16_bf16 v[52:67], a[180:183], v[88:91], v[52:67]
  ds_read_b128 v[80:83], v123 offset:512
  s_waitcnt lgkmcnt(4)
  v_mfma_f32_32x32x16_bf16 v[52:67], a[184:187], v[92:95], v[52:67]
  ds_read_b128 v[84:87], v124 offset:512
  v_mfma_f32_32x32x16_bf16 v[52:67], a[188:191], v[96:99], v[52:67]
  ds_read_b128 v[88:91], v125 offset:512
  s_waitcnt lgkmcnt(4)
  v_mfma_f32_32x32x16_bf16 v[52:67], a[192:195], v[68:71], v[52:67]
  ds_read_b128 v[92:95], v126 offset:512
  v_mfma_f32_32x32x16_bf16 v[52:67], a[196:199], v[72:75], v[52:67]
  ds_read_b128 v[96:99], v127 offset:512
  s_waitcnt lgkmcnt(4)
  v_mfma_f32_32x32x16_bf16 v[52:67], a[200:203], v[76:79], v[52:67]
  ds_read_b128 v[68:71], v120 offset:768
  v_mfma_f32_32x32x16_bf16 v[52:67], a[204:207], v[80:83], v[52:67]
  ds_read_b128 v[72:75], v121 offset:768
  s_waitcnt lgkmcnt(4)
  v_mfma_f32_32x32x16_bf16 v[52:67], a[208:211], v[84:87], v[52:67]
  ds_read_b128 v[76:79], v122 offset:768
  ds_read_b128 v[80:83], v123 offset:768
  v_mfma_f32_32x32x16_bf16 v[52:67], a[212:215], v[88:91], v[52:67]
  ds_read_b128 v[84:87], v124 offset:768
  ds_read_b128 v[88:91], v125 offset:768
  s_waitcnt lgkmcnt(6)
  v_mfma_f32_32x32x16_bf16 v[52:67], a[216:219], v[92:95], v[52:67]
  ds_read_b128 v[92:95], v126 offset:768
  v_mfma_f32_32x32x16_bf16 v[52:67], a[220:223], v[96:99], v[52:67]
  ds_read_b128 v[96:99], v127 offset:768
  s_waitcnt lgkmcnt(6)
  v_mfma_f32_32x32x16_bf16 v[52:67], a[224:227], v[68:71], v[52:67]
  v_mfma_f32_32x32x16_bf16 v[52:67], a[228:231], v[72:75], v[52:67]
  s_waitcnt vmcnt(4) lgkmcnt(0)
  s_barrier
  ds_read_b128 v[100:103], v119 offset:0
  v_mfma_f32_32x32x16_bf16 v[52:67], a[232:235], v[76:79], v[52:67]
  ds_read_b128 v[68:71], v120 offset:32768
  v_mfma_f32_32x32x16_bf16 v[52:67], a[236:239], v[80:83], v[52:67]
  ds_read_b128 v[72:75], v121 offset:32768
  s_xor_b32 s50, s50, 32768
  v_mfma_f32_32x32x16_bf16 v[52:67], a[240:243], v[84:87], v[52:67]
  ds_read_b128 v[76:79], v122 offset:32768
  v_mfma_f32_32x32x16_bf16 v[52:67], a[244:247], v[88:91], v[52:67]
  s_waitcnt lgkmcnt(3)
  v_min3_u32 v104, v100, v101, v102
  v_max3_u32 v100, v100, v101, v102
  v_min_u32 v104, v104, v103
  v_max_u32 v100, v100, v103
  v_readfirstlane_b32 s45, v104
  v_mfma_f32_32x32x16_bf16 v[52:67], a[248:251], v[92:95], v[52:67]
  v_readlane_b32 s28, v100, 0
  v_readlane_b32 s29, v100, 1
  v_readlane_b32 s30, v100, 2
  s_cmp_gt_u32 s55, 0
  s_cselect_b32 s45, 0, s45
  v_mfma_f32_32x32x16_bf16 v[52:67], a[252:255], v[96:99], v[52:67]
  s_cmp_eq_u32 s45, 0
  s_cbranch_scc1 q_slow_86
  s_cmp_lt_u32 s47, 64
  s_cbranch_scc1 q_w1_100
  s_cmp_gt_u32 s28, s56
  s_addc_u32 s42, s42, s42
  s_max_u32 s56, s56, s28
  s_and_b32 s26, s42, 1
  s_cselect_b32 s26, s40, 0
  s_cmp_gt_u32 s26, 10
  s_subb_u32 s40, s40, 0
  s_cmp_gt_u32 s29, s56
  s_addc_u32 s42, s42, s42
  s_max_u32 s56, s56, s29
  s_and_b32 s26, s42, 1
  s_cselect_b32 s26, s40, 0
  s_cmp_gt_u32 s26, 10
  s_subb_u32 s40, s40, 0
  s_cmp_gt_u32 s30, s56
  s_addc_u32 s42, s42, s42
  s_max_u32 s56, s56, s30
  s_add_u32 s76, s47, s40
  s_add_u32 s41, s47, 3
  s_sub_u32 s76, s76, 64
  s_and_b32 s26, s42, 1
  s_cselect_b32 s26, s40, 0
  s_cmp_gt_u32 s26, 10
  s_cselect_b32 s76, 64, s76
  s_subb_u32 s40, s40, 0
  s_cmp_lt_u32 s76, 64
  s_cselect_b32 s76, s76, s41
  s_bitcmp1_b32 s42, 0
  s_cbranch_scc0 q_w1_100
  s_branch q_forkw_95
q_c1_98:
  ds_read_b128 v[68:71], v120 offset:32768
  ds_read_b128 v[72:75], v121 offset:32768
  ds_read_b128 v[76:79], v122 offset:32768
q_w1_100:
  s_waitcnt lgkmcnt(2)
  v_mfma_f32_32x32x16_bf16 v[20:35], v[128:131], v[68:71], 0
  ds_read_b128 v[80:83], v123 offset:32768
  s_mov_b32 s46, s47
  s_mov_b32 s47, s76
  s_lshl_b32 s52, s46, 7
  s_add_u32 s52, s52, s57
  v_mfma_f32_32x32x16_bf16 v[36:51], v[68:71], a[0:3], 0
  s_waitcnt vmcnt(0)
  s_mov_b64 exec, 1
  buffer_store_dword v4, off, s[4:7], s49 sc1
  s_mov_b64 exec, -1
  s_lshl_b32 s44, s52, 12
  s_waitcnt lgkmcnt(2)
  v_mfma_f32_32x32x16_bf16 v[20:35], v[132:135], v[72:75], v[20:35]
  ds_read_b128 v[84:87], v124 offset:32768
  s_add_u32 s44, s44, 41943040
  s_lshl_b32 s51, s52, 5
  s_add_u32 s51, s51, 244318208
  s_lshr_b32 s55, s47, 7
  v_mfma_f32_32x32x16_bf16 v[36:51], v[72:75], a[4:7], v[36:51]
  s_sub_u32 s27, s47, s60
  s_cmp_eq_u32 s27, 15
  s_cselect_b32 s55, 1, s55
  s_add_u32 s76, s47, 3
  s_cmp_lt_u32 s76, 18
  s_cselect_b32 s76, s76, s41
  s_waitcnt lgkmcnt(2)
  v_mfma_f32_32x32x16_bf16 v[20:35], v[136:139], v[76:79], v[20:35]
  ds_read_b128 v[88:91], v125 offset:32768
  v_cvt_pk_bf16_f32 v100, v52, v53
  v_cvt_pk_bf16_f32 v101, v54, v55
  v_cvt_pk_bf16_f32 v102, v60, v61
  v_cvt_pk_bf16_f32 v103, v62, v63
  v_mfma_f32_32x32x16_bf16 v[36:51], v[76:79], a[8:11], v[36:51]
  buffer_store_dwordx4 v[100:103], v8, s[4:7], s43 offen offset:0 sc1
  v_cvt_pk_bf16_f32 v104, v56, v57
  v_cvt_pk_bf16_f32 v105, v58, v59
  s_waitcnt lgkmcnt(2)
  v_mfma_f32_32x32x16_bf16 v[20:35], v[140:143], v[80:83], v[20:35]
  ds_read_b128 v[92:95], v126 offset:32768
  v_cvt_pk_bf16_f32 v106, v64, v65
  v_cvt_pk_bf16_f32 v107, v66, v67
  v_mfma_f32_32x32x16_bf16 v[36:51], v[80:83], a[12:15], v[36:51]
  s_waitcnt lgkmcnt(2)
  v_mfma_f32_32x32x16_bf16 v[20:35], v[144:147], v[84:87], v[20:35]
  ds_read_b128 v[96:99], v127 offset:32768
  buffer_store_dwordx4 v[104:107], v8, s[4:7], s43 offen offset:512 sc1
  s_lshl_b32 s43, s52, 11
  v_mfma_f32_32x32x16_bf16 v[36:51], v[84:87], a[16:19], v[36:51]
  s_add_u32 s43, s43, 142606336
  s_waitcnt lgkmcnt(2)
  v_mfma_f32_32x32x16_bf16 v[20:35], v[148:151], v[88:91], v[20:35]
  ds_read_b128 v[68:71], v120 offset:33024
  v_mfma_f32_32x32x16_bf16 v[36:51], v[88:91], a[20:23], v[36:51]
  s_waitcnt lgkmcnt(2)
  v_mfma_f32_32x32x16_bf16 v[20:35], v[152:155], v[92:95], v[20:35]
  ds_read_b128 v[72:75], v121 offset:33024
  s_cmp_lt_u32 s47, 64
  s_cselect_b32 s26, 2, 0
  s_add_u32 s26, s26, s47
  s_lshl_b32 s26, s26, 12
  v_mfma_f32_32x32x16_bf16 v[36:51], v[92:95], a[24:27], v[36:51]
  s_add_u32 s26, s26, 243261440
  s_mov_b64 exec, 0xffffff
  buffer_load_dword v116, v7, s[4:7], s26 offen sc1
  s_mov_b64 exec, -1
  s_waitcnt lgkmcnt(2)
  v_mfma_f32_32x32x16_bf16 v[20:35], v[156:159], v[96:99], v[20:35]
  ds_read_b128 v[76:79], v122 offset:33024
  v_mfma_f32_32x32x16_bf16 v[36:51], v[96:99], a[28:31], v[36:51]
  s_waitcnt lgkmcnt(2)
  v_mfma_f32_32x32x16_bf16 v[20:35], v[160:163], v[68:71], v[20:35]
  ds_read_b128 v[80:83], v123 offset:33024
  v_mfma_f32_32x32x16_bf16 v[36:51], v[68:71], a[32:35], v[36:51]
  s_waitcnt lgkmcnt(2)
  v_mfma_f32_32x32x16_bf16 v[20:35], v[164:167], v[72:75], v[20:35]
  ds_read_b128 v[84:87], v124 offset:33024
  v_mfma_f32_32x32x16_bf16 v[36:51], v[72:75], a[36:39], v[36:51]
  s_waitcnt lgkmcnt(2)
  v_mfma_f32_32x32x16_bf16 v[20:35], v[168:171], v[76:79], v[20:35]
  ds_read_b128 v[88:91], v125 offset:33024
  v_mfma_f32_32x32x16_bf16 v[36:51], v[76:79], a[40:43], v[36:51]
  s_waitcnt lgkmcnt(2)
  v_mfma_f32_32x32x16_bf16 v[20:35], v[172:175], v[80:83], v[20:35]
  ds_read_b128 v[92:95], v126 offset:33024
  v_mfma_f32_32x32x16_bf16 v[36:51], v[80:83], a[44:47], v[36:51]
  s_waitcnt lgkmcnt(2)
  v_mfma_f32_32x32x16_bf16 v[20:35], v[176:179], v[84:87], v[20:35]
  ds_read_b128 v[96:99], v127 offset:33024
  v_mfma_f32_32x32x16_bf16 v[36:51], v[84:87], a[48:51], v[36:51]
  s_waitcnt lgkmcnt(2)
  v_mfma_f32_32x32x16_bf16 v[20:35], v[180:183], v[88:91], v[20:35]
  ds_read_b128 v[68:71], v120 offset:33280
  v_mfma_f32_32x32x16_bf16 v[36:51], v[88:91], a[52:55], v[36:51]
  s_waitcnt lgkmcnt(2)
  v_mfma_f32_32x32x16_bf16 v[20:35], v[184:187], v[92:95], v[20:35]
  ds_read_b128 v[72:75], v121 offset:33280
  v_mfma_f32_32x32x16_bf16 v[36:51], v[92:95], a[56:59], v[36:51]
  s_waitcnt lgkmcnt(2)
  v_mfma_f32_32x32x16_bf16 v[20:35], v[188:191], v[96:99], v[20:35]
  ds_read_b128 v[76:79], v122 offset:33280
  v_mfma_f32_32x32x16_bf16 v[36:51], v[96:99], a[60:63], v[36:51]
  s_waitcnt lgkmcnt(2)
  v_mfma_f32_32x32x16_bf16 v[20:35], v[192:195], v[68:71], v[20:35]
  ds_read_b128 v[80:83], v123 offset:33280
  v_mfma_f32_32x32x16_bf16 v[36:51], v[68:71], a[64:67], v[36:51]
  s_waitcnt lgkmcnt(2)
  v_mfma_f32_32x32x16_bf16 v[20:35], v[196:199], v[72:75], v[20:35]
  ds_read_b128 v[84:87], v124 offset:33280
  s_waitcnt vmcnt(0)
  s_mov_b64 exec, 3
  buffer_store_dword v4, v0, s[4:7], s49 offen sc1
  s_mov_b64 exec, -1
  v_mfma_f32_32x32x16_bf16 v[36:51], v[72:75], a[68:71], v[36:51]
  v_cmp_eq_u32 vcc, 0, v116
  v_max_u32_dpp v117, v116, v116 quad_perm:[1,0,3,2] row_mask:0xf bank_mask:0xf
  s_and_b32 s48, vcc_lo, 0xffffff
  s_cselect_b32 s48, 0, -1
  v_max_u32_dpp v117, v117, v117 quad_perm:[2,3,0,1] row_mask:0xf bank_mask:0xf
  s_waitcnt lgkmcnt(2)
  v_mfma_f32_32x32x16_bf16 v[20:35], v[200:203], v[76:79], v[20:35]
  ds_read_b128 v[88:91], v125 offset:33280
  s_nop 1
  v_max_u32_dpp v117, v117, v117 row_half_mirror row_mask:0xf bank_mask:0xf
  v_and_b32 v117, s48, v117
  s_cmp_lg_u32 s48, 0
  s_cselect_b32 s28, s47, s46
  v_mfma_f32_32x32x16_bf16 v[36:51], v[76:79], a[72:75], v[36:51]
  s_and_b32 s63, s28, 127
  s_lshl_b32 s63, s63, 15
  s_xor_b32 s27, s50, 32768
  s_add_u32 m0, s27, s54
  s_add_u32 s63, s63, s54
  s_waitcnt lgkmcnt(2)
  v_mfma_f32_32x32x16_bf16 v[20:35], v[204:207], v[80:83], v[20:35]
  ds_read_b128 v[92:95], v126 offset:33280
  s_add_u32 s63, s63, 6291456
  buffer_load_dwordx4 v12, s[4:7], s63 offen offset:0 sc1 lds
  v_mfma_f32_32x32x16_bf16 v[36:51], v[80:83], a[76:79], v[36:51]
  s_waitcnt lgkmcnt(2)
  v_mfma_f32_32x32x16_bf16 v[20:35], v[208:211], v[84:87], v[20:35]
  ds_read_b128 v[96:99], v127 offset:33280
  v_mfma_f32_32x32x16_bf16 v[36:51], v[84:87], a[80:83], v[36:51]
  buffer_load_dwordx4 v13, s[4:7], s63 offen offset:1024 sc1 lds
  s_waitcnt lgkmcnt(2)
  v_mfma_f32_32x32x16_bf16 v[20:35], v[212:215], v[88:91], v[20:35]
  ds_read_b128 v[68:71], v120 offset:33536
  v_mfma_f32_32x32x16_bf16 v[36:51], v[88:91], a[84:87], v[36:51]
  s_waitcnt lgkmcnt(2)
  v_mfma_f32_32x32x16_bf16 v[20:35], v[216:219], v[92:95], v[20:35]
  ds_read_b128 v[72:75], v121 offset:33536
  buffer_load_dwordx4 v14, s[4:7], s63 offen offset:2048 sc1 lds
  v_mfma_f32_32x32x16_bf16 v[36:51], v[92:95], a[88:91], v[36:51]
  s_waitcnt lgkmcnt(2)
  v_mfma_f32_32x32x16_bf16 v[20:35], v[220:223], v[96:99], v[20:35]
  ds_read_b128 v[76:79], v122 offset:33536
  v_mfma_f32_32x32x16_bf16 v[36:51], v[96:99], a[92:95], v[36:51]
  buffer_load_dwordx4 v15, s[4:7], s63 offen offset:3072 sc1 lds
  s_add_u32 m0, m0, 4096
  s_add_u32 s63, s63, 4096
  s_waitcnt lgkmcnt(2)
  v_mfma_f32_32x32x16_bf16 v[20:35], v[224:227], v[68:71], v[20:35]
  ds_read_b128 v[80:83], v123 offset:33536
  v_mfma_f32_32x32x16_bf16 v[36:51], v[68:71], a[96:99], v[36:51]
  s_waitcnt lgkmcnt(2)
  v_mfma_f32_32x32x16_bf16 v[20:35], v[228:231], v[72:75], v[20:35]
  ds_read_b128 v[84:87], v124 offset:33536
  buffer_load_dwordx4 v16, s[4:7], s63 offen offset:0 sc1 lds
  v_mfma_f32_32x32x16_bf16 v[36:51], v[72:75], a[100:103], v[36:51]
  s_waitcnt lgkmcnt(2)
  v_mfma_f32_32x32x16_bf16 v[20:35], v[232:235], v[76:79], v[20:35]
  ds_read_b128 v[88:91], v125 offset:33536
  v_mfma_f32_32x32x16_bf16 v[36:51], v[76:79], a[104:107], v[36:51]
  buffer_load_dwordx4 v17, s[4:7], s63 offen offset:1024 sc1 lds
  s_waitcnt lgkmcnt(2)
  v_mfma_f32_32x32x16_bf16 v[20:35], v[236:239], v[80:83], v[20:35]
  ds_read_b128 v[92:95], v126 offset:33536
  v_mfma_f32_32x32x16_bf16 v[36:51], v[80:83], a[108:111], v[36:51]
  s_waitcnt lgkmcnt(2)
  v_mfma_f32_32x32x16_bf16 v[20:35], v[240:243], v[84:87], v[20:35]
  ds_read_b128 v[96:99], v127 offset:33536
  buffer_load_dwordx4 v18, s[4:7], s63 offen offset:2048 sc1 lds
  v_mfma_f32_32x32x16_bf16 v[36:51], v[84:87], a[112:115], v[36:51]
  s_waitcnt lgkmcnt(2)
  v_mfma_f32_32x32x16_bf16 v[20:35], v[244:247], v[88:91], v[20:35]
  ds_read_b128 v[68:71], v120 offset:32768
  v_mfma_f32_32x32x16_bf16 v[36:51], v[88:91], a[116:119], v[36:51]
  ds_read_b128 v[72:75], v121 offset:32768
  buffer_load_dwordx4 v19, s[4:7], s63 offen offset:3072 sc1 lds
  s_mov_b32 s49, s51
  s_waitcnt lgkmcnt(3)
  v_mfma_f32_32x32x16_bf16 v[20:35], v[248:251], v[92:95], v[20:35]
  ds_read_b128 v[76:79], v122 offset:32768
  ds_write_b32 v118, v117 offset:128
  v_mfma_f32_32x32x16_bf16 v[36:51], v[92:95], a[120:123], v[36:51]
  ds_read_b128 v[80:83], v123 offset:32768
  s_waitcnt lgkmcnt(5)
  v_mfma_f32_32x32x16_bf16 v[20:35], v[252:255], v[96:99], v[20:35]
  ds_read_b128 v[84:87], v124 offset:32768
  v_mfma_f32_32x32x16_bf16 v[36:51], v[96:99], a[124:127], v[36:51]
  ds_read_b128 v[88:91], v125 offset:32768
  s_waitcnt lgkmcnt(5)
  v_mfma_f32_32x32x16_bf16 v[52:67], a[128:131], v[68:71], 0
  ds_read_b128 v[92:95], v126 offset:32768
  v_mfma_f32_32x32x16_bf16 v[52:67], a[132:135], v[72:75], v[52:67]
  ds_read_b128 v[96:99], v127 offset:32768
  v_mul_f32 v20, s24, v20
  v_mul_f32 v21, s24, v21
  v_mul_f32 v22, s24, v22
  v_mul_f32 v23, s24, v23
  s_waitcnt lgkmcnt(4)
  v_mfma_f32_32x32x16_bf16 v[52:67], a[136:139], v[76:79], v[52:67]
  ds_read_b128 v[68:71], v120 offset:33024
  v_mul_f32 v24, s24, v24
  v_mul_f32 v25, s24, v25
  v_cvt_pk_bf16_f32 v100, v36, v37
  v_cvt_pk_bf16_f32 v101, v38, v39
  v_mfma_f32_32x32x16_bf16 v[52:67], a[140:143], v[80:83], v[52:67]
  ds_read_b128 v[72:75], v121 offset:33024
  v_cvt_pk_bf16_f32 v102, v44, v45
  v_cvt_pk_bf16_f32 v103, v46, v47
  buffer_store_dwordx4 v[100:103], v8, s[4:7], s44 offen offset:2048 sc1
  s_waitcnt lgkmcnt(4)
  v_mfma_f32_32x32x16_bf16 v[52:67], a[144:147], v[84:87], v[52:67]
  ds_read_b128 v[76:79], v122 offset:33024
  v_cvt_pk_bf16_f32 v104, v40, v41
  v_cvt_pk_bf16_f32 v105, v42, v43
  v_cvt_pk_bf16_f32 v106, v48, v49
  v_cvt_pk_bf16_f32 v107, v50, v51
  v_mfma_f32_32x32x16_bf16 v[52:67], a[148:151], v[88:91], v[52:67]
  ds_read_b128 v[80:83], v123 offset:33024
  buffer_store_dwordx4 v[104:107], v8, s[4:7], s44 offen offset:2560 sc1
  v_mul_f32 v26, s24, v26
  s_waitcnt lgkmcnt(4)
  v_mfma_f32_32x32x16_bf16 v[52:67], a[152:155], v[92:95], v[52:67]
  ds_read_b128 v[84:87], v124 offset:33024
  v_mul_f32 v27, s24, v27
  v_mul_f32 v28, s24, v28
  v_mul_f32 v29, s24, v29
  v_mul_f32 v30, s24, v30
  v_mfma_f32_32x32x16_bf16 v[52:67], a[156:159], v[96:99], v[52:67]
  ds_read_b128 v[88:91], v125 offset:33024
  v_mul_f32 v31, s24, v31
  v_mul_f32 v32, s24, v32
  v_mul_f32 v33, s24, v33
  v_mul_f32 v34, s24, v34
  s_waitcnt lgkmcnt(4)
  v_mfma_f32_32x32x16_bf16 v[52:67], a[160:163], v[68:71], v[52:67]
  ds_read_b128 v[92:95], v126 offset:33024
  v_mul_f32 v35, s24, v35
  v_cvt_pk_bf16_f32 v108, v20, v21
  v_cvt_pk_bf16_f32 v109, v22, v23
  v_cvt_pk_bf16_f32 v110, v28, v29
  v_mfma_f32_32x32x16_bf16 v[52:67], a[164:167], v[72:75], v[52:67]
  ds_read_b128 v[96:99], v127 offset:33024
  v_cvt_pk_bf16_f32 v111, v30, v31
  buffer_store_dwordx4 v[108:111], v8, s[4:7], s44 offen offset:0 sc1
  s_waitcnt lgkmcnt(4)
  v_mfma_f32_32x32x16_bf16 v[52:67], a[168:171], v[76:79], v[52:67]
  ds_read_b128 v[68:71], v120 offset:33280
  v_cvt_pk_bf16_f32 v112, v24, v25
  v_cvt_pk_bf16_f32 v113, v26, v27
  v_cvt_pk_bf16_f32 v114, v32, v33
  v_cvt_pk_bf16_f32 v115, v34, v35
  v_mfma_f32_32x32x16_bf16 v[52:67], a[172:175], v[80:83], v[52:67]
  ds_read_b128 v[72:75], v121 offset:33280
  buffer_store_dwordx4 v[112:115], v8, s[4:7], s44 offen offset:512 sc1
  s_waitcnt lgkmcnt(4)
  v_mfma_f32_32x32x16_bf16 v[52:67], a[176:179], v[84:87], v[52:67]
  ds_read_b128 v[76:79], v122 offset:33280
  v_mfma_f32_32x32x16_bf16 v[52:67], a[180:183], v[88:91], v[52:67]
  ds_read_b128 v[80:83], v123 offset:33280
  s_waitcnt lgkmcnt(4)
  v_mfma_f32_32x32x16_bf16 v[52:67], a[184:187], v[92:95], v[52:67]
  ds_read_b128 v[84:87], v124 offset:33280
  v_mfma_f32_32x32x16_bf16 v[52:67], a[188:191], v[96:99], v[52:67]
  ds_read_b128 v[88:91], v125 offset:33280
  s_waitcnt lgkmcnt(4)
  v_mfma_f32_32x32x16_bf16 v[52:67], a[192:195], v[68:71], v[52:67]
  ds_read_b128 v[92:95], v126 offset:33280
  v_mfma_f32_32x32x16_bf16 v[52:67], a[196:199], v[72:75], v[52:67]
  ds_read_b128 v[96:99], v127 offset:33280
  s_waitcnt lgkmcnt(4)
  v_mfma_f32_32x32x16_bf16 v[52:67], a[200:203], v[76:79], v[52:67]
  ds_read_b128 v[68:71], v120 offset:33536
  v_mfma_f32_32x32x16_bf16 v[52:67], a[204:207], v[80:83], v[52:67]
  ds_read_b128 v[72:75], v121 offset:33536
  s_waitcnt lgkmcnt(4)
  v_mfma_f32_32x32x16_bf16 v[52:67], a[208:211], v[84:87], v[52:67]
  ds_read_b128 v[76:79], v122 offset:33536
  ds_read_b128 v[80:83], v123 offset:33536
  v_mfma_f32_32x32x16_bf16 v[52:67], a[212:215], v[88:91], v[52:67]
  ds_read_b128 v[84:87], v124 offset:33536
  ds_read_b128 v[88:91], v125 offset:33536
  s_waitcnt lgkmcnt(6)
  v_mfma_f32_32x32x16_bf16 v[52:67], a[216:219], v[92:95], v[52:67]
  ds_read_b128 v[92:95], v126 offset:33536
  v_mfma_f32_32x32x16_bf16 v[52:67], a[220:223], v[96:99], v[52:67]
  ds_read_b128 v[96:99], v127 offset:33536
  s_waitcnt lgkmcnt(6)
  v_mfma_f32_32x32x16_bf16 v[52:67], a[224:227], v[68:71], v[52:67]
  v_mfma_f32_32x32x16_bf16 v[52:67], a[228:231], v[72:75], v[52:67]
  s_waitcnt vmcnt(4) lgkmcnt(0)
  s_barrier
  ds_read_b128 v[100:103], v119 offset:128
  v_mfma_f32_32x32x16_bf16 v[52:67], a[232:235], v[76:79], v[52:67]
  ds_read_b128 v[68:71], v120 offset:0
  v_mfma_f32_32x32x16_bf16 v[52:67], a[236:239], v[80:83], v[52:67]
  ds_read_b128 v[72:75], v121 offset:0
  s_xor_b32 s50, s50, 32768
  v_mfma_f32_32x32x16_bf16 v[52:67], a[240:243], v[84:87], v[52:67]
  ds_read_b128 v[76:79], v122 offset:0
  v_mfma_f32_32x32x16_bf16 v[52:67], a[244:247], v[88:91], v[52:67]
  s_waitcnt lgkmcnt(3)
  v_min3_u32 v104, v100, v101, v102
  v_max3_u32 v100, v100, v101, v102
  v_min_u32 v104, v104, v103
  v_max_u32 v100, v100, v103
  v_readfirstlane_b32 s45, v104
  v_mfma_f32_32x32x16_bf16 v[52:67], a[248:251], v[92:95], v[52:67]
  v_readlane_b32 s28, v100, 0
  v_readlane_b32 s29, v100, 1
  v_readlane_b32 s30, v100, 2
  s_cmp_gt_u32 s55, 0
  s_cselect_b32 s45, 0, s45
  v_mfma_f32_32x32x16_bf16 v[52:67], a[252:255], v[96:99], v[52:67]
  s_cmp_eq_u32 s45, 0
  s_cbranch_scc1 q_slow_86
  s_cmp_lt_u32 s47, 64
  s_cbranch_scc1 q_w0_99
  s_cmp_gt_u32 s28, s56
  s_addc_u32 s42, s42, s42
  s_max_u32 s56, s56, s28
  s_and_b32 s26, s42, 1
  s_cselect_b32 s26, s40, 0
  s_cmp_gt_u32 s26, 10
  s_subb_u32 s40, s40, 0
  s_cmp_gt_u32 s29, s56
  s_addc_u32 s42, s42, s42
  s_max_u32 s56, s56, s29
  s_and_b32 s26, s42, 1
  s_cselect_b32 s26, s40, 0
  s_cmp_gt_u32 s26, 10
  s_subb_u32 s40, s40, 0
  s_cmp_gt_u32 s30, s56
  s_addc_u32 s42, s42, s42
  s_max_u32 s56, s56, s30
  s_add_u32 s76, s47, s40
  s_add_u32 s41, s47, 3
  s_sub_u32 s76, s76, 64
  s_and_b32 s26, s42, 1
  s_cselect_b32 s26, s40, 0
  s_cmp_gt_u32 s26, 10
  s_cselect_b32 s76, 64, s76
  s_subb_u32 s40, s40, 0
  s_cmp_lt_u32 s76, 64
  s_cselect_b32 s76, s76, s41
  s_bitcmp1_b32 s42, 0
  s_cbranch_scc0 q_w0_99
  s_branch q_forkw_95
q_forkw_95:
  v_cvt_pk_bf16_f32 v100, v52, v53
  v_cvt_pk_bf16_f32 v101, v54, v55
  v_cvt_pk_bf16_f32 v102, v60, v61
  v_cvt_pk_bf16_f32 v103, v62, v63
  v_cvt_pk_bf16_f32 v104, v56, v57
  v_cvt_pk_bf16_f32 v105, v58, v59
  v_cvt_pk_bf16_f32 v106, v64, v65
  v_cvt_pk_bf16_f32 v107, v66, v67
  s_waitcnt vmcnt(0)
  s_mov_b64 exec, 1
  buffer_store_dword v4, off, s[4:7], s49 sc1
  s_mov_b64 exec, -1
  buffer_store_dwordx4 v[100:103], v8, s[4:7], s43 offen offset:0 sc1
  buffer_store_dwordx4 v[104:107], v8, s[4:7], s43 offen offset:512 sc1
  s_mov_b32 s43, 268435456
  s_waitcnt lgkmcnt(0)
q_fork_93:
  s_mov_b32 s58, s56
  s_mov_b32 s46, s47
  s_mov_b32 s47, s76
  s_add_u32 s76, s47, 3
  s_cmp_lt_u32 s76, 18
  s_cselect_b32 s76, s76, s41
  s_andn2_b32 s59, 0xfff, s58
  s_lshl_b32 s26, s61, 21
  s_lshl_b32 s27, s59, 10
  s_add_u32 s26, s26, s27
  s_lshl_b32 s27, s17, 8
  s_add_u32 s26, s26, s27
  s_add_u32 s26, s26, 27262976
  v_lshrrev_b32 v5, 7, v0
  v_lshlrev_b32 v5, 5, v5
  buffer_load_dwordx4 v[52:55], v5, s[4:7], s26 offen offset:0 sc1
  buffer_load_dwordx4 v[56:59], v5, s[4:7], s26 offen offset:16 sc1
  s_load_dwordx2 s[64:65], s[0:1], 72
  s_load_dwordx2 s[68:69], s[0:1], 80
  s_load_dwordx2 s[8:9], s[0:1], 88
  s_mov_b32 s66, 1835008
  s_mov_b32 s70, 1835008
  s_mov_b32 s10, 1835008
  v_lshrrev_b32 v2, 7, v0
  v_and_b32 v3, 0x70, v0
  v_mul_u32_u24 v6, 57344, v2
  v_add_u32 v6, v6, v3
  v_cmp_eq_u32 vcc, 0x70, v3
  v_mov_b32 v3, 0x7ff00000
  s_nop 0
  v_cndmask_b32 v6, v6, v3, vcc
  v_lshrrev_b32 v2, 8, v0
  v_mul_u32_u24 v7, 14336, v2
  v_and_b32 v3, 0xf0, v0
  v_add_u32 v7, v7, v3
  s_mul_i32 s34, s17, 458752
  s_mul_i32 s27, s16, 112
  s_add_u32 s34, s34, s27
  s_mul_i32 s35, s16, 57344
  s_lshl_b32 s27, s17, 8
  s_add_u32 s35, s35, s27
  s_waitcnt lgkmcnt(0)
  s_xor_b32 s37, s50, 32768
  s_add_u32 s37, s37, s54
  s_mov_b32 m0, s37
  s_add_u32 s36, s34, 39424
  buffer_load_dwordx4 v6, s[68:71], s36 offen lds
  s_add_u32 m0, m0, 1024
  s_add_u32 s36, s34, 43008
  buffer_load_dwordx4 v6, s[64:67], s36 offen lds
  s_add_u32 m0, m0, 1024
  s_add_u32 s36, s34, 43008
  buffer_load_dwordx4 v6, s[68:71], s36 offen lds
  s_add_u32 m0, m0, 1024
  s_add_u32 s36, s34, 46592
  buffer_load_dwordx4 v6, s[64:67], s36 offen lds
  s_add_u32 m0, m0, 1024
  s_add_u32 s36, s34, 46592
  buffer_load_dwordx4 v6, s[68:71], s36 offen lds
  s_add_u32 m0, m0, 1024
  s_add_u32 s36, s34, 50176
  buffer_load_dwordx4 v6, s[64:67], s36 offen lds
  s_add_u32 m0, m0, 1024
  s_add_u32 s36, s34, 50176
  buffer_load_dwordx4 v6, s[68:71], s36 offen lds
  s_add_u32 m0, m0, 1024
  s_add_u32 s36, s34, 53760
  buffer_load_dwordx4 v6, s[64:67], s36 offen lds
  s_add_u32 m0, m0, 1024
  s_add_u32 s36, s34, 53760
  buffer_load_dwordx4 v[60:63], v6, s[68:71], s36 offen
  buffer_load_dwordx4 v[64:67], v7, s[8:11], s35 offen offset:0
  v_add_u32 v120, s50, v120
  v_add_u32 v121, s50, v121
  v_add_u32 v122, s50, v122
  v_add_u32 v123, s50, v123
  v_add_u32 v124, s50, v124
  v_add_u32 v125, s50, v125
  v_add_u32 v126, s50, v126
  v_add_u32 v127, s50, v127
  s_lshl_b32 s52, s46, 7
  s_add_u32 s52, s52, s57
  s_lshl_b32 s77, s52, 12
  s_add_u32 s44, s77, 75497472
  s_add_u32 s77, s77, 41943040
  s_lshl_b32 s51, s52, 5
  s_add_u32 s51, s51, 244318208
  s_waitcnt vmcnt(12)
  s_barrier
  s_mov_b64 exec, 3
  buffer_store_dword v4, v0, s[4:7], s49 offen sc1
  s_mov_b64 exec, -1
  v_mov_b32 v4, 2
  s_mov_b32 s49, s51
  ds_read_b128 v[68:71], v120 offset:0
  ds_read_b128 v[72:75], v121 offset:0
  ds_read_b128 v[76:79], v122 offset:0
  ds_read_b128 v[80:83], v123 offset:0
  s_waitcnt lgkmcnt(3)
  v_mfma_f32_32x32x16_bf16 v[20:35], v[128:131], v[68:71], 0
  v_mfma_f32_32x32x16_bf16 v[36:51], v[68:71], a[0:3], 0
  s_waitcnt lgkmcnt(2)
  v_mfma_f32_32x32x16_bf16 v[20:35], v[132:135], v[72:75], v[20:35]
  ds_read_b128 v[84:87], v124 offset:0
  v_mfma_f32_32x32x16_bf16 v[36:51], v[72:75], a[4:7], v[36:51]
  s_waitcnt lgkmcnt(2)
  v_mfma_f32_32x32x16_bf16 v[20:35], v[136:139], v[76:79], v[20:35]
  ds_read_b128 v[88:91], v125 offset:0
  v_mfma_f32_32x32x16_bf16 v[36:51], v[76:79], a[8:11], v[36:51]
  s_waitcnt lgkmcnt(2)
  v_mfma_f32_32x32x16_bf16 v[20:35], v[140:143], v[80:83], v[20:35]
  ds_read_b128 v[92:95], v126 offset:0
  v_mfma_f32_32x32x16_bf16 v[36:51], v[80:83], a[12:15], v[36:51]
  s_waitcnt lgkmcnt(2)
  v_mfma_f32_32x32x16_bf16 v[20:35], v[144:147], v[84:87], v[20:35]
  ds_read_b128 v[96:99], v127 offset:0
  v_mfma_f32_32x32x16_bf16 v[36:51], v[84:87], a[16:19], v[36:51]
  s_waitcnt lgkmcnt(2)
  v_mfma_f32_32x32x16_bf16 v[20:35], v[148:151], v[88:91], v[20:35]
  ds_read_b128 v[68:71], v120 offset:256
  v_mfma_f32_32x32x16_bf16 v[36:51], v[88:91], a[20:23], v[36:51]
  s_waitcnt lgkmcnt(2)
  v_mfma_f32_32x32x16_bf16 v[20:35], v[152:155], v[92:95], v[20:35]
  ds_read_b128 v[72:75], v121 offset:256
  v_mfma_f32_32x32x16_bf16 v[36:51], v[92:95], a[24:27], v[36:51]
  s_waitcnt lgkmcnt(2)
  v_mfma_f32_32x32x16_bf16 v[20:35], v[156:159], v[96:99], v[20:35]
  ds_read_b128 v[76:79], v122 offset:256
  v_mfma_f32_32x32x16_bf16 v[36:51], v[96:99], a[28:31], v[36:51]
  s_waitcnt lgkmcnt(2)
  v_mfma_f32_32x32x16_bf16 v[20:35], v[160:163], v[68:71], v[20:35]
  ds_read_b128 v[80:83], v123 offset:256
  v_mfma_f32_32x32x16_bf16 v[36:51], v[68:71], a[32:35], v[36:51]
  s_waitcnt lgkmcnt(2)
  v_mfma_f32_32x32x16_bf16 v[20:35], v[164:167], v[72:75], v[20:35]
  ds_read_b128 v[84:87], v124 offset:256
  v_mfma_f32_32x32x16_bf16 v[36:51], v[72:75], a[36:39], v[36:51]
  s_waitcnt lgkmcnt(2)
  v_mfma_f32_32x32x16_bf16 v[20:35], v[168:171], v[76:79], v[20:35]
  ds_read_b128 v[88:91], v125 offset:256
  v_mfma_f32_32x32x16_bf16 v[36:51], v[76:79], a[40:43], v[36:51]
  s_waitcnt lgkmcnt(2)
  v_mfma_f32_32x32x16_bf16 v[20:35], v[172:175], v[80:83], v[20:35]
  ds_read_b128 v[92:95], v126 offset:256
  v_mfma_f32_32x32x16_bf16 v[36:51], v[80:83], a[44:47], v[36:51]
  s_waitcnt lgkmcnt(2)
  v_mfma_f32_32x32x16_bf16 v[20:35], v[176:179], v[84:87], v[20:35]
  ds_read_b128 v[96:99], v127 offset:256
  v_mfma_f32_32x32x16_bf16 v[36:51], v[84:87], a[48:51], v[36:51]
  s_waitcnt lgkmcnt(2)
  v_mfma_f32_32x32x16_bf16 v[20:35], v[180:183], v[88:91], v[20:35]
  ds_read_b128 v[68:71], v120 offset:512
  v_mfma_f32_32x32x16_bf16 v[36:51], v[88:91], a[52:55], v[36:51]
  s_waitcnt lgkmcnt(2)
  v_mfma_f32_32x32x16_bf16 v[20:35], v[184:187], v[92:95], v[20:35]
  ds_read_b128 v[72:75], v121 offset:512
  v_mfma_f32_32x32x16_bf16 v[36:51], v[92:95], a[56:59], v[36:51]
  s_waitcnt lgkmcnt(2)
  v_mfma_f32_32x32x16_bf16 v[20:35], v[188:191], v[96:99], v[20:35]
  ds_read_b128 v[76:79], v122 offset:512
  v_mfma_f32_32x32x16_bf16 v[36:51], v[96:99], a[60:63], v[36:51]
  s_waitcnt lgkmcnt(2)
  v_mfma_f32_32x32x16_bf16 v[20:35], v[192:195], v[68:71], v[20:35]
  ds_read_b128 v[80:83], v123 offset:512
  v_mfma_f32_32x32x16_bf16 v[36:51], v[68:71], a[64:67], v[36:51]
  s_waitcnt lgkmcnt(2)
  v_mfma_f32_32x32x16_bf16 v[20:35], v[196:199], v[72:75], v[20:35]
  ds_read_b128 v[84:87], v124 offset:512
  v_mfma_f32_32x32x16_bf16 v[36:51], v[72:75], a[68:71], v[36:51]
  s_waitcnt lgkmcnt(2)
  v_mfma_f32_32x32x16_bf16 v[20:35], v[200:203], v[76:79], v[20:35]
  ds_read_b128 v[88:91], v125 offset:512
  v_mfma_f32_32x32x16_bf16 v[36:51], v[76:79], a[72:75], v[36:51]
  s_waitcnt lgkmcnt(2)
  v_mfma_f32_32x32x16_bf16 v[20:35], v[204:207], v[80:83], v[20:35]
  ds_read_b128 v[92:95], v126 offset:512
  v_mfma_f32_32x32x16_bf16 v[36:51], v[80:83], a[76:79], v[36:51]
  s_waitcnt lgkmcnt(2)
  v_mfma_f32_32x32x16_bf16 v[20:35], v[208:211], v[84:87], v[20:35]
  ds_read_b128 v[96:99], v127 offset:512
  v_mfma_f32_32x32x16_bf16 v[36:51], v[84:87], a[80:83], v[36:51]
  s_waitcnt lgkmcnt(2)
  v_mfma_f32_32x32x16_bf16 v[20:35], v[212:215], v[88:91], v[20:35]
  ds_read_b128 v[68:71], v120 offset:768
  v_mfma_f32_32x32x16_bf16 v[36:51], v[88:91], a[84:87], v[36:51]
  s_waitcnt lgkmcnt(2)
  v_mfma_f32_32x32x16_bf16 v[20:35], v[216:219], v[92:95], v[20:35]
  ds_read_b128 v[72:75], v121 offset:768
  v_mfma_f32_32x32x16_bf16 v[36:51], v[92:95], a[88:91], v[36:51]
  s_waitcnt lgkmcnt(2)
  v_mfma_f32_32x32x16_bf16 v[20:35], v[220:223], v[96:99], v[20:35]
  ds_read_b128 v[76:79], v122 offset:768
  v_mfma_f32_32x32x16_bf16 v[36:51], v[96:99], a[92:95], v[36:51]
  s_waitcnt lgkmcnt(2)
  v_mfma_f32_32x32x16_bf16 v[20:35], v[224:227], v[68:71], v[20:35]
  ds_read_b128 v[80:83], v123 offset:768
  v_mfma_f32_32x32x16_bf16 v[36:51], v[68:71], a[96:99], v[36:51]
  s_waitcnt lgkmcnt(2)
  v_mfma_f32_32x32x16_bf16 v[20:35], v[228:231], v[72:75], v[20:35]
  ds_read_b128 v[84:87], v124 offset:768
  v_mfma_f32_32x32x16_bf16 v[36:51], v[72:75], a[100:103], v[36:51]
  s_waitcnt lgkmcnt(2)
  v_mfma_f32_32x32x16_bf16 v[20:35], v[232:235], v[76:79], v[20:35]
  ds_read_b128 v[88:91], v125 offset:768
  v_mfma_f32_32x32x16_bf16 v[36:51], v[76:79], a[104:107], v[36:51]
  s_waitcnt lgkmcnt(2)
  v_mfma_f32_32x32x16_bf16 v[20:35], v[236:239], v[80:83], v[20:35]
  ds_read_b128 v[92:95], v126 offset:768
  v_mfma_f32_32x32x16_bf16 v[36:51], v[80:83], a[108:111], v[36:51]
  s_waitcnt lgkmcnt(2)
  v_mfma_f32_32x32x16_bf16 v[20:35], v[240:243], v[84:87], v[20:35]
  ds_read_b128 v[96:99], v127 offset:768
  v_mfma_f32_32x32x16_bf16 v[36:51], v[84:87], a[112:115], v[36:51]
  s_waitcnt lgkmcnt(2)
  v_mfma_f32_32x32x16_bf16 v[20:35], v[244:247], v[88:91], v[20:35]
  v_mfma_f32_32x32x16_bf16 v[36:51], v[88:91], a[116:119], v[36:51]
  s_waitcnt lgkmcnt(1)
  v_mfma_f32_32x32x16_bf16 v[20:35], v[248:251], v[92:95], v[20:35]
  v_mfma_f32_32x32x16_bf16 v[36:51], v[92:95], a[120:123], v[36:51]
  s_waitcnt lgkmcnt(0)
  v_mfma_f32_32x32x16_bf16 v[20:35], v[252:255], v[96:99], v[20:35]
  v_mfma_f32_32x32x16_bf16 v[36:51], v[96:99], a[124:127], v[36:51]
  s_nop 3
  v_mul_f32 v20, s24, v20
  v_mul_f32 v21, s24, v21
  v_mul_f32 v22, s24, v22
  v_mul_f32 v23, s24, v23
  v_mul_f32 v24, s24, v24
  v_mul_f32 v25, s24, v25
  v_mul_f32 v26, s24, v26
  v_mul_f32 v27, s24, v27
  v_mul_f32 v28, s24, v28
  v_mul_f32 v29, s24, v29
  v_mul_f32 v30, s24, v30
  v_mul_f32 v31, s24, v31
  v_mul_f32 v32, s24, v32
  v_mul_f32 v33, s24, v33
  v_mul_f32 v34, s24, v34
  v_mul_f32 v35, s24, v35
  v_cvt_pk_bf16_f32 v108, v20, v21
  v_cvt_pk_bf16_f32 v109, v22, v23
  v_cvt_pk_bf16_f32 v110, v28, v29
  v_cvt_pk_bf16_f32 v111, v30, v31
  buffer_store_dwordx4 v[108:111], v8, s[4:7], s77 offen offset:0 sc1
  v_cvt_pk_bf16_f32 v112, v24, v25
  v_cvt_pk_bf16_f32 v113, v26, v27
  v_cvt_pk_bf16_f32 v114, v32, v33
  v_cvt_pk_bf16_f32 v115, v34, v35
  buffer_store_dwordx4 v[112:115], v8, s[4:7], s77 offen offset:512 sc1
  v_cvt_pk_bf16_f32 v100, v36, v37
  v_cvt_pk_bf16_f32 v101, v38, v39
  v_cvt_pk_bf16_f32 v102, v44, v45
  v_cvt_pk_bf16_f32 v103, v46, v47
  buffer_store_dwordx4 v[100:103], v8, s[4:7], s77 offen offset:2048 sc1
  v_cvt_pk_bf16_f32 v104, v40, v41
  v_cvt_pk_bf16_f32 v105, v42, v43
  v_cvt_pk_bf16_f32 v106, v48, v49
  v_cvt_pk_bf16_f32 v107, v50, v51
  buffer_store_dwordx4 v[104:107], v8, s[4:7], s77 offen offset:2560 sc1
  buffer_store_dwordx4 v[108:111], v8, s[4:7], s44 offen offset:0 sc1
  buffer_store_dwordx4 v[112:115], v8, s[4:7], s44 offen offset:512 sc1
  buffer_store_dwordx4 v[100:103], v8, s[4:7], s44 offen offset:2048 sc1
  buffer_store_dwordx4 v[104:107], v8, s[4:7], s44 offen offset:2560 sc1
  buffer_load_dwordx4 v[68:71], v7, s[8:11], s35 offen offset:1024
  buffer_load_dwordx4 v[72:75], v7, s[8:11], s35 offen offset:2048
  buffer_load_dwordx4 v[76:79], v7, s[8:11], s35 offen offset:3072
  s_add_u32 s35, s35, 4096
  buffer_load_dwordx4 v[80:83], v7, s[8:11], s35 offen offset:0
  buffer_load_dwordx4 v[84:87], v7, s[8:11], s35 offen offset:1024
  buffer_load_dwordx4 v[88:91], v7, s[8:11], s35 offen offset:2048
  buffer_load_dwordx4 v[92:95], v7, s[8:11], s35 offen offset:3072
  s_add_u32 s35, s35, 4096
  buffer_load_dwordx4 v[96:99], v7, s[8:11], s35 offen offset:0
  buffer_load_dwordx4 v[100:103], v7, s[8:11], s35 offen offset:1024
  buffer_load_dwordx4 v[104:107], v7, s[8:11], s35 offen offset:2048
  buffer_load_dwordx4 v[108:111], v7, s[8:11], s35 offen offset:3072
  s_add_u32 s35, s35, 4096
  buffer_load_dwordx4 v[112:115], v7, s[8:11], s35 offen offset:0
  buffer_load_dwordx4 v[48:51], v7, s[8:11], s35 offen offset:1024
  s_mov_b32 vcc_lo, 0xaaaaaaaa
  s_mov_b32 vcc_hi, 0xaaaaaaaa
  v_mov_b32 v3, 0xffff
  v_mov_b32 v24, 0xffff0000
  v_cndmask_b32 v3, v3, v24, vcc
  s_mov_b32 vcc_lo, 0x3030303
  s_mov_b32 vcc_hi, 0x3030303
  v_cndmask_b32 v24, 0, v3, vcc
  s_mov_b32 vcc_lo, 0xc0c0c0c
  s_mov_b32 vcc_hi, 0xc0c0c0c
  v_cndmask_b32 v25, 0, v3, vcc
  s_mov_b32 vcc_lo, 0x30303030
  s_mov_b32 vcc_hi, 0x30303030
  v_cndmask_b32 v26, 0, v3, vcc
  s_mov_b32 vcc_lo, 0xc0c0c0c0
  s_mov_b32 vcc_hi, 0xc0c0c0c0
  v_cndmask_b32 v27, 0, v3, vcc
  s_mov_b32 s30, 0x01000100
  s_mov_b32 s31, 0x03020302
  s_mul_i32 s26, s17, 23552
  s_add_u32 s26, s26, 65536
  v_add_u32 v5, s26, v0
  v_add_u32 v2, s37, v0
  ds_read_b128 v[36:39], v5 offset:0
  ds_read_b128 v[40:43], v5 offset:1024
  ds_read_b128 v[44:47], v5 offset:2048
  ds_read_b128 v[12:15], v5 offset:3072
  ds_read_b128 v[16:19], v5 offset:4096
  ds_read_b128 v[120:123], v5 offset:5120
  ds_read_b128 v[124:127], v5 offset:6144
  s_waitcnt vmcnt(32)
  s_waitcnt vmcnt(17)
  s_mov_b64 exec, 1
  buffer_store_dword v4, off, s[4:7], s51 sc1
  s_mov_b64 exec, -1
  v_perm_b32 v3, v52, v52, s30
  v_and_b32 v20, v24, v3
  v_and_b32 v21, v25, v3
  v_and_b32 v22, v26, v3
  v_and_b32 v23, v27, v3
  s_waitcnt lgkmcnt(5)
  s_nop 0
  v_mfma_f32_16x16x32_bf16 v[28:31], v[20:23], v[36:39], 0
  ds_read_b128 v[36:39], v5 offset:7168
  v_mfma_f32_16x16x32_bf16 v[32:35], v[20:23], v[40:43], 0
  ds_read_b128 v[40:43], v5 offset:8192
  v_perm_b32 v3, v52, v52, s31
  v_and_b32 v20, v24, v3
  v_and_b32 v21, v25, v3
  v_and_b32 v22, v26, v3
  v_and_b32 v23, v27, v3
  s_waitcnt lgkmcnt(5)
  s_nop 0
  v_mfma_f32_16x16x32_bf16 v[28:31], v[20:23], v[44:47], v[28:31]
  ds_read_b128 v[44:47], v5 offset:9216
  v_mfma_f32_16x16x32_bf16 v[32:35], v[20:23], v[12:15], v[32:35]
  ds_read_b128 v[12:15], v5 offset:10240
  v_perm_b32 v3, v53, v53, s30
  v_and_b32 v20, v24, v3
  v_and_b32 v21, v25, v3
  v_and_b32 v22, v26, v3
  v_and_b32 v23, v27, v3
  s_waitcnt lgkmcnt(5)
  s_nop 0
  v_mfma_f32_16x16x32_bf16 v[28:31], v[20:23], v[16:19], v[28:31]
  ds_read_b128 v[16:19], v5 offset:11264
  v_mfma_f32_16x16x32_bf16 v[32:35], v[20:23], v[120:123], v[32:35]
  ds_read_b128 v[120:123], v5 offset:12288
  v_perm_b32 v3, v53, v53, s31
  v_and_b32 v20, v24, v3
  v_and_b32 v21, v25, v3
  v_and_b32 v22, v26, v3
  v_and_b32 v23, v27, v3
  s_waitcnt lgkmcnt(5)
  s_nop 0
  v_mfma_f32_16x16x32_bf16 v[28:31], v[20:23], v[124:127], v[28:31]
  ds_read_b128 v[124:127], v5 offset:13312
  v_mfma_f32_16x16x32_bf16 v[32:35], v[20:23], v[36:39], v[32:35]
  ds_read_b128 v[36:39], v5 offset:14336
  v_perm_b32 v3, v54, v54, s30
  v_and_b32 v20, v24, v3
  v_and_b32 v21, v25, v3
  v_and_b32 v22, v26, v3
  v_and_b32 v23, v27, v3
  s_waitcnt lgkmcnt(5)
  s_nop 0
  v_mfma_f32_16x16x32_bf16 v[28:31], v[20:23], v[40:43], v[28:31]
  ds_read_b128 v[40:43], v5 offset:15360
  v_mfma_f32_16x16x32_bf16 v[32:35], v[20:23], v[44:47], v[32:35]
  ds_read_b128 v[44:47], v5 offset:16384
  v_perm_b32 v3, v54, v54, s31
  v_and_b32 v20, v24, v3
  v_and_b32 v21, v25, v3
  v_and_b32 v22, v26, v3
  v_and_b32 v23, v27, v3
  s_waitcnt lgkmcnt(5)
  s_nop 0
  v_mfma_f32_16x16x32_bf16 v[28:31], v[20:23], v[12:15], v[28:31]
  ds_read_b128 v[12:15], v5 offset:17408
  v_mfma_f32_16x16x32_bf16 v[32:35], v[20:23], v[16:19], v[32:35]
  ds_read_b128 v[16:19], v5 offset:18432
  v_perm_b32 v3, v55, v55, s30
  v_and_b32 v20, v24, v3
  v_and_b32 v21, v25, v3
  v_and_b32 v22, v26, v3
  v_and_b32 v23, v27, v3
  s_waitcnt lgkmcnt(5)
  s_nop 0
  v_mfma_f32_16x16x32_bf16 v[28:31], v[20:23], v[120:123], v[28:31]
  ds_read_b128 v[120:123], v5 offset:19456
  v_mfma_f32_16x16x32_bf16 v[32:35], v[20:23], v[124:127], v[32:35]
  ds_read_b128 v[124:127], v5 offset:20480
  v_perm_b32 v3, v55, v55, s31
  v_and_b32 v20, v24, v3
  v_and_b32 v21, v25, v3
  v_and_b32 v22, v26, v3
  v_and_b32 v23, v27, v3
  s_waitcnt lgkmcnt(5)
  s_nop 0
  v_mfma_f32_16x16x32_bf16 v[28:31], v[20:23], v[36:39], v[28:31]
  ds_read_b128 v[36:39], v5 offset:21504
  v_mfma_f32_16x16x32_bf16 v[32:35], v[20:23], v[40:43], v[32:35]
  ds_read_b128 v[40:43], v5 offset:22528
  v_perm_b32 v3, v56, v56, s30
  v_and_b32 v20, v24, v3
  v_and_b32 v21, v25, v3
  v_and_b32 v22, v26, v3
  v_and_b32 v23, v27, v3
  s_waitcnt lgkmcnt(5)
  s_nop 0
  v_mfma_f32_16x16x32_bf16 v[28:31], v[20:23], v[44:47], v[28:31]
  ds_read_b128 v[44:47], v2 offset:0
  v_mfma_f32_16x16x32_bf16 v[32:35], v[20:23], v[12:15], v[32:35]
  ds_read_b128 v[12:15], v2 offset:1024
  v_perm_b32 v3, v56, v56, s31
  v_and_b32 v20, v24, v3
  v_and_b32 v21, v25, v3
  v_and_b32 v22, v26, v3
  v_and_b32 v23, v27, v3
  s_waitcnt lgkmcnt(5)
  s_nop 0
  v_mfma_f32_16x16x32_bf16 v[28:31], v[20:23], v[16:19], v[28:31]
  ds_read_b128 v[16:19], v2 offset:2048
  v_mfma_f32_16x16x32_bf16 v[32:35], v[20:23], v[120:123], v[32:35]
  ds_read_b128 v[120:123], v2 offset:3072
  v_perm_b32 v3, v57, v57, s30
  v_and_b32 v20, v24, v3
  v_and_b32 v21, v25, v3
  v_and_b32 v22, v26, v3
  v_and_b32 v23, v27, v3
  s_waitcnt lgkmcnt(5)
  s_nop 0
  v_mfma_f32_16x16x32_bf16 v[28:31], v[20:23], v[124:127], v[28:31]
  ds_read_b128 v[124:127], v2 offset:4096
  v_mfma_f32_16x16x32_bf16 v[32:35], v[20:23], v[36:39], v[32:35]
  ds_read_b128 v[36:39], v2 offset:5120
  v_perm_b32 v3, v57, v57, s31
  v_and_b32 v20, v24, v3
  v_and_b32 v21, v25, v3
  v_and_b32 v22, v26, v3
  v_and_b32 v23, v27, v3
  s_waitcnt lgkmcnt(5)
  s_nop 0
  v_mfma_f32_16x16x32_bf16 v[28:31], v[20:23], v[40:43], v[28:31]
  ds_read_b128 v[40:43], v2 offset:6144
  v_mfma_f32_16x16x32_bf16 v[32:35], v[20:23], v[44:47], v[32:35]
  ds_read_b128 v[44:47], v2 offset:7168
  v_perm_b32 v3, v58, v58, s30
  v_and_b32 v20, v24, v3
  v_and_b32 v21, v25, v3
  v_and_b32 v22, v26, v3
  v_and_b32 v23, v27, v3
  s_waitcnt lgkmcnt(5)
  s_nop 0
  v_mfma_f32_16x16x32_bf16 v[28:31], v[20:23], v[12:15], v[28:31]
  v_mfma_f32_16x16x32_bf16 v[32:35], v[20:23], v[16:19], v[32:35]
  v_perm_b32 v3, v58, v58, s31
  v_and_b32 v20, v24, v3
  v_and_b32 v21, v25, v3
  v_and_b32 v22, v26, v3
  v_and_b32 v23, v27, v3
  s_waitcnt lgkmcnt(3)
  s_nop 0
  v_mfma_f32_16x16x32_bf16 v[28:31], v[20:23], v[120:123], v[28:31]
  v_mfma_f32_16x16x32_bf16 v[32:35], v[20:23], v[124:127], v[32:35]
  v_perm_b32 v3, v59, v59, s30
  v_and_b32 v20, v24, v3
  v_and_b32 v21, v25, v3
  v_and_b32 v22, v26, v3
  v_and_b32 v23, v27, v3
  s_waitcnt lgkmcnt(1)
  s_nop 0
  v_mfma_f32_16x16x32_bf16 v[28:31], v[20:23], v[36:39], v[28:31]
  v_mfma_f32_16x16x32_bf16 v[32:35], v[20:23], v[40:43], v[32:35]
  v_perm_b32 v3, v59, v59, s31
  v_and_b32 v20, v24, v3
  v_and_b32 v21, v25, v3
  v_and_b32 v22, v26, v3
  v_and_b32 v23, v27, v3
  s_waitcnt lgkmcnt(0)
  s_nop 0
  v_mfma_f32_16x16x32_bf16 v[28:31], v[20:23], v[44:47], v[28:31]
  v_mfma_f32_16x16x32_bf16 v[32:35], v[20:23], v[60:63], v[32:35]
  v_lshrrev_b32 v2, 8, v0
  v_and_b32 v3, 0xf0, v0
  v_lshlrev_b32 v3, 1, v3
  v_and_b32 v5, 1, v2
  v_lshl_add_u32 v5, v5, 4, v3
  v_add_u32 v5, s37, v5
  s_mov_b32 exec_lo, 0x00ff00ff
  s_mov_b32 exec_hi, 0xff00ff00
  ds_write_b128 v5, v[28:31]
  ds_write_b128 v5, v[32:35] offset:512
  s_mov_b64 exec, -1
  s_xor_b32 s26, s50, 32768
  v_add_u32 v5, s26, v1
  v_lshl_add_u32 v3, v2, 4, v3
  s_waitcnt lgkmcnt(0)
  s_barrier
  ds_read2st64_b32 v[36:37], v5 offset0:0 offset1:1
  ds_read2st64_b32 v[52:53], v5 offset0:2 offset1:3
  ds_read2st64_b32 v[38:39], v5 offset0:32 offset1:33
  ds_read2st64_b32 v[54:55], v5 offset0:34 offset1:35
  ds_read2st64_b32 v[40:41], v5 offset0:64 offset1:65
  ds_read2st64_b32 v[56:57], v5 offset0:66 offset1:67
  ds_read2st64_b32 v[42:43], v5 offset0:96 offset1:97
  ds_read2st64_b32 v[58:59], v5 offset0:98 offset1:99
  s_waitcnt lgkmcnt(0)
  v_add_f32 v36, v36, v40
  v_add_f32 v37, v37, v41
  v_add_f32 v38, v38, v42
  v_add_f32 v39, v39, v43
  v_add_f32 v52, v52, v56
  v_add_f32 v53, v53, v57
  v_add_f32 v54, v54, v58
  v_add_f32 v55, v55, v59
  v_add_f32 v36, v36, v38
  v_add_f32 v37, v37, v39
  v_add_f32 v52, v52, v54
  v_add_f32 v53, v53, v55
  v_add_f32 v36, v36, v37
  v_add_f32 v52, v52, v53
  v_cvt_pk_bf16_f32 v36, 0, v36
  v_cvt_pk_bf16_f32 v52, 0, v52
  v_mul_f32 v40, 0xbfb8aa3b, v36
  v_exp_f32 v40, v40
  s_nop 0
  v_add_f32 v40, 1.0, v40
  v_rcp_f32 v40, v40
  s_nop 0
  v_mul_f32 v36, v36, v40
  v_cvt_pk_bf16_f32 v36, 0, v36
  v_mul_f32 v36, v36, v52
  v_cvt_pk_bf16_f32 v36, v36, v36
  s_lshl_b32 s26, s17, 8
  s_add_u32 s26, s26, 161792
  v_add_u32 v5, s26, v1
  ds_write_b32 v5, v36
  v_mul_u32_u24 v5, 56, v2
  v_add_u32 v5, s26, v5
  ds_read_b64 v[36:37], v5 offset:0
  ds_read_b64 v[38:39], v5 offset:8
  ds_read_b64 v[40:41], v5 offset:16
  ds_read_b64 v[42:43], v5 offset:24
  ds_read_b64 v[44:45], v5 offset:32
  ds_read_b64 v[46:47], v5 offset:40
  ds_read_b64 v[52:53], v5 offset:48
  s_waitcnt lgkmcnt(0)
  v_and_b32 v20, v24, v36
  v_and_b32 v21, v25, v36
  v_and_b32 v22, v26, v36
  v_and_b32 v23, v27, v36
  s_nop 0
  s_nop 0
  v_mfma_f32_16x16x32_bf16 v[28:31], v[20:23], v[64:67], 0
  v_and_b32 v32, v24, v37
  v_and_b32 v33, v25, v37
  v_and_b32 v34, v26, v37
  v_and_b32 v35, v27, v37
  s_waitcnt vmcnt(13)
  s_nop 0
  v_mfma_f32_16x16x32_bf16 v[28:31], v[32:35], v[68:71], v[28:31]
  v_and_b32 v20, v24, v38
  v_and_b32 v21, v25, v38
  v_and_b32 v22, v26, v38
  v_and_b32 v23, v27, v38
  s_waitcnt vmcnt(12)
  s_nop 0
  v_mfma_f32_16x16x32_bf16 v[28:31], v[20:23], v[72:75], v[28:31]
  v_and_b32 v32, v24, v39
  v_and_b32 v33, v25, v39
  v_and_b32 v34, v26, v39
  v_and_b32 v35, v27, v39
  s_waitcnt vmcnt(11)
  s_nop 0
  v_mfma_f32_16x16x32_bf16 v[28:31], v[32:35], v[76:79], v[28:31]
  v_and_b32 v20, v24, v40
  v_and_b32 v21, v25, v40
  v_and_b32 v22, v26, v40
  v_and_b32 v23, v27, v40
  s_waitcnt vmcnt(10)
  s_nop 0
  v_mfma_f32_16x16x32_bf16 v[28:31], v[20:23], v[80:83], v[28:31]
  v_and_b32 v32, v24, v41
  v_and_b32 v33, v25, v41
  v_and_b32 v34, v26, v41
  v_and_b32 v35, v27, v41
  s_waitcnt vmcnt(9)
  s_nop 0
  v_mfma_f32_16x16x32_bf16 v[28:31], v[32:35], v[84:87], v[28:31]
  v_and_b32 v20, v24, v42
  v_and_b32 v21, v25, v42
  v_and_b32 v22, v26, v42
  v_and_b32 v23, v27, v42
  s_waitcnt vmcnt(8)
  s_nop 0
  v_mfma_f32_16x16x32_bf16 v[28:31], v[20:23], v[88:91], v[28:31]
  v_and_b32 v32, v24, v43
  v_and_b32 v33, v25, v43
  v_and_b32 v34, v26, v43
  v_and_b32 v35, v27, v43
  s_waitcnt vmcnt(7)
  s_nop 0
  v_mfma_f32_16x16x32_bf16 v[28:31], v[32:35], v[92:95], v[28:31]
  v_and_b32 v20, v24, v44
  v_and_b32 v21, v25, v44
  v_and_b32 v22, v26, v44
  v_and_b32 v23, v27, v44
  s_waitcnt vmcnt(6)
  s_nop 0
  v_mfma_f32_16x16x32_bf16 v[28:31], v[20:23], v[96:99], v[28:31]
  v_and_b32 v32, v24, v45
  v_and_b32 v33, v25, v45
  v_and_b32 v34, v26, v45
  v_and_b32 v35, v27, v45
  s_waitcnt vmcnt(5)
  s_nop 0
  v_mfma_f32_16x16x32_bf16 v[28:31], v[32:35], v[100:103], v[28:31]
  v_and_b32 v20, v24, v46
  v_and_b32 v21, v25, v46
  v_and_b32 v22, v26, v46
  v_and_b32 v23, v27, v46
  s_waitcnt vmcnt(4)
  s_nop 0
  v_mfma_f32_16x16x32_bf16 v[28:31], v[20:23], v[104:107], v[28:31]
  v_and_b32 v32, v24, v47
  v_and_b32 v33, v25, v47
  v_and_b32 v34, v26, v47
  v_and_b32 v35, v27, v47
  s_waitcnt vmcnt(3)
  s_nop 0
  v_mfma_f32_16x16x32_bf16 v[28:31], v[32:35], v[108:111], v[28:31]
  v_and_b32 v20, v24, v52
  v_and_b32 v21, v25, v52
  v_and_b32 v22, v26, v52
  v_and_b32 v23, v27, v52
  s_waitcnt vmcnt(2)
  s_nop 0
  v_mfma_f32_16x16x32_bf16 v[28:31], v[20:23], v[112:115], v[28:31]
  v_and_b32 v32, v24, v53
  v_and_b32 v33, v25, v53
  v_and_b32 v34, v26, v53
  v_and_b32 v35, v27, v53
  s_waitcnt vmcnt(1)
  s_nop 0
  v_mfma_f32_16x16x32_bf16 v[28:31], v[32:35], v[48:51], v[28:31]
  v_lshrrev_b32 v3, 1, v3
  s_lshl_b32 s26, s46, 7
  s_add_u32 s26, s26, s57
  s_lshl_b32 s26, s26, 8
  s_add_u32 s26, s26, 244318208
  s_nop 2
  v_cvt_pk_bf16_f32 v28, v28, v29
  v_cvt_pk_bf16_f32 v29, v30, v31
  v_min_u32 v28, -2, v28
  v_min_u32 v29, -2, v29
  s_mov_b32 exec_hi, 0
  buffer_store_dwordx2 v[28:29], v3, s[4:7], s26 offen sc1
  s_mov_b32 exec_hi, -1
  v_lshrrev_b32 v7, 7, v0
  v_lshlrev_b32 v7, 12, v7
  v_and_b32 v2, 1023, v9
  s_lshl_b32 s26, s17, 10
  v_add3_u32 v7, v7, v2, s26
  v_mov_b32 v116, 0
  v_lshrrev_b32 v96, 9, v0
  v_lshlrev_b32 v96, 4, v96
  v_and_b32 v97, 0xf0, v0
  v_xor_b32 v96, v96, v97
  v_and_b32 v97, 0x1f0, v0
  v_lshl_add_u32 v96, v97, 6, v96
  v_add_u32 v96, s50, v96
  v_xor_b32 v120, 0, v96
  v_xor_b32 v121, 32, v96
  v_xor_b32 v122, 64, v96
  v_xor_b32 v123, 96, v96
  v_xor_b32 v124, 128, v96
  v_xor_b32 v125, 160, v96
  v_xor_b32 v126, 192, v96
  v_xor_b32 v127, 224, v96
  s_and_b32 s26, s17, 1
  s_lshl_b32 s26, s26, 7
  v_xor_b32 v96, s26, v0
  v_xor_b32 v12, 0, v96
  v_xor_b32 v13, 16, v96
  v_xor_b32 v14, 32, v96
  v_xor_b32 v15, 48, v96
  v_xor_b32 v16, 64, v96
  v_xor_b32 v17, 80, v96
  v_xor_b32 v18, 96, v96
  v_xor_b32 v19, 112, v96
  s_cmp_lt_u32 s47, 64
  s_cselect_b32 s26, 2, 0
  s_add_u32 s26, s26, s47
  s_lshl_b32 s26, s26, 12
  s_add_u32 s26, s26, 243261440
  s_mov_b64 exec, 0xffffff
  buffer_load_dword v116, v7, s[4:7], s26 offen sc1
  s_mov_b64 exec, -1
  s_lshl_b32 s26, s61, 21
  s_lshl_b32 s27, s59, 10
  s_add_u32 s26, s26, s27
  s_add_u32 s27, s26, 20971520
  s_add_u32 s28, s26, 27262976
  s_lshl_b32 s26, s46, 7
  s_add_u32 s26, s26, s17
  s_lshl_b32 s26, s26, 8
  s_add_u32 s26, s26, 244318208
  v_lshrrev_b32 v2, 8, v0
  v_and_b32 v3, 0xf0, v0
  v_lshl_add_u32 v5, v2, 10, v3
  buffer_load_dwordx4 v[108:111], v0, s[4:7], s27 offen sc1
  buffer_load_dwordx4 v[112:115], v0, s[4:7], s28 offen sc1
  s_mov_b32 s53, 0
  ds_read_b128 v[68:71], v120 offset:0
  ds_read_b128 v[72:75], v121 offset:0
  ds_read_b128 v[76:79], v122 offset:0
  ds_read_b128 v[80:83], v123 offset:0
  s_waitcnt lgkmcnt(2)
  v_mfma_f32_32x32x16_bf16 v[52:67], a[128:131], v[68:71], 0
  ds_read_b128 v[84:87], v124 offset:0
  ds_read_b128 v[88:91], v125 offset:0
  ds_read_b128 v[92:95], v126 offset:0
  v_mfma_f32_32x32x16_bf16 v[52:67], a[132:135], v[72:75], v[52:67]
  ds_read_b128 v[96:99], v127 offset:0
  s_waitcnt lgkmcnt(4)
  v_mfma_f32_32x32x16_bf16 v[52:67], a[136:139], v[76:79], v[52:67]
  ds_read_b128 v[68:71], v120 offset:256
  v_mfma_f32_32x32x16_bf16 v[52:67], a[140:143], v[80:83], v[52:67]
  ds_read_b128 v[72:75], v121 offset:256
  s_waitcnt lgkmcnt(4)
  v_mfma_f32_32x32x16_bf16 v[52:67], a[144:147], v[84:87], v[52:67]
  ds_read_b128 v[76:79], v122 offset:256
  v_mfma_f32_32x32x16_bf16 v[52:67], a[148:151], v[88:91], v[52:67]
  ds_read_b128 v[80:83], v123 offset:256
  s_waitcnt lgkmcnt(4)
  v_mfma_f32_32x32x16_bf16 v[52:67], a[152:155], v[92:95], v[52:67]
  ds_read_b128 v[84:87], v124 offset:256
  v_mfma_f32_32x32x16_bf16 v[52:67], a[156:159], v[96:99], v[52:67]
  ds_read_b128 v[88:91], v125 offset:256
  s_waitcnt lgkmcnt(4)
  v_mfma_f32_32x32x16_bf16 v[52:67], a[160:163], v[68:71], v[52:67]
  ds_read_b128 v[92:95], v126 offset:256
  v_mfma_f32_32x32x16_bf16 v[52:67], a[164:167], v[72:75], v[52:67]
  ds_read_b128 v[96:99], v127 offset:256
  s_waitcnt lgkmcnt(4)
  v_mfma_f32_32x32x16_bf16 v[52:67], a[168:171], v[76:79], v[52:67]
  ds_read_b128 v[68:71], v120 offset:512
  v_mfma_f32_32x32x16_bf16 v[52:67], a[172:175], v[80:83], v[52:67]
  ds_read_b128 v[72:75], v121 offset:512
  s_waitcnt lgkmcnt(4)
  v_mfma_f32_32x32x16_bf16 v[52:67], a[176:179], v[84:87], v[52:67]
  ds_read_b128 v[76:79], v122 offset:512
  v_mfma_f32_32x32x16_bf16 v[52:67], a[180:183], v[88:91], v[52:67]
  ds_read_b128 v[80:83], v123 offset:512
  s_waitcnt lgkmcnt(4)
  v_mfma_f32_32x32x16_bf16 v[52:67], a[184:187], v[92:95], v[52:67]
  ds_read_b128 v[84:87], v124 offset:512
  v_mfma_f32_32x32x16_bf16 v[52:67], a[188:191], v[96:99], v[52:67]
  ds_read_b128 v[88:91], v125 offset:512
  s_waitcnt lgkmcnt(4)
  v_mfma_f32_32x32x16_bf16 v[52:67], a[192:195], v[68:71], v[52:67]
  ds_read_b128 v[92:95], v126 offset:512
  v_mfma_f32_32x32x16_bf16 v[52:67], a[196:199], v[72:75], v[52:67]
  ds_read_b128 v[96:99], v127 offset:512
  s_waitcnt lgkmcnt(4)
  v_mfma_f32_32x32x16_bf16 v[52:67], a[200:203], v[76:79], v[52:67]
  ds_read_b128 v[68:71], v120 offset:768
  v_mfma_f32_32x32x16_bf16 v[52:67], a[204:207], v[80:83], v[52:67]
  ds_read_b128 v[72:75], v121 offset:768
  s_waitcnt lgkmcnt(4)
  v_mfma_f32_32x32x16_bf16 v[52:67], a[208:211], v[84:87], v[52:67]
  ds_read_b128 v[76:79], v122 offset:768
  v_mfma_f32_32x32x16_bf16 v[52:67], a[212:215], v[88:91], v[52:67]
  ds_read_b128 v[80:83], v123 offset:768
  s_waitcnt lgkmcnt(4)
  v_mfma_f32_32x32x16_bf16 v[52:67], a[216:219], v[92:95], v[52:67]
  ds_read_b128 v[84:87], v124 offset:768
  v_mfma_f32_32x32x16_bf16 v[52:67], a[220:223], v[96:99], v[52:67]
  ds_read_b128 v[88:91], v125 offset:768
  s_waitcnt lgkmcnt(4)
  v_mfma_f32_32x32x16_bf16 v[52:67], a[224:227], v[68:71], v[52:67]
  ds_read_b128 v[92:95], v126 offset:768
  v_mfma_f32_32x32x16_bf16 v[52:67], a[228:231], v[72:75], v[52:67]
  ds_read_b128 v[96:99], v127 offset:768
  s_waitcnt lgkmcnt(4)
  v_mfma_f32_32x32x16_bf16 v[52:67], a[232:235], v[76:79], v[52:67]
  v_mfma_f32_32x32x16_bf16 v[52:67], a[236:239], v[80:83], v[52:67]
  s_waitcnt lgkmcnt(2)
  v_mfma_f32_32x32x16_bf16 v[52:67], a[240:243], v[84:87], v[52:67]
  v_mfma_f32_32x32x16_bf16 v[52:67], a[244:247], v[88:91], v[52:67]
  s_waitcnt lgkmcnt(0)
  v_mfma_f32_32x32x16_bf16 v[52:67], a[248:251], v[92:95], v[52:67]
  v_mfma_f32_32x32x16_bf16 v[52:67], a[252:255], v[96:99], v[52:67]
  s_lshl_b32 s28, s52, 11
  s_add_u32 s77, s28, 159383552
  s_add_u32 s28, s28, 142606336
  s_add_u32 s51, s51, 262144
  s_nop 7
  v_cvt_pk_bf16_f32 v100, v52, v53
  v_cvt_pk_bf16_f32 v101, v54, v55
  v_cvt_pk_bf16_f32 v102, v60, v61
  v_cvt_pk_bf16_f32 v103, v62, v63
  v_cvt_pk_bf16_f32 v104, v56, v57
  v_cvt_pk_bf16_f32 v105, v58, v59
  v_cvt_pk_bf16_f32 v106, v64, v65
  v_cvt_pk_bf16_f32 v107, v66, v67
m_w_103:
  s_add_u32 s27, s26, 0
  buffer_load_dwordx4 v[20:23], v5, s[4:7], s27 offen sc1
  s_add_u32 s27, s26, 4096
  buffer_load_dwordx4 v[24:27], v5, s[4:7], s27 offen sc1
  s_add_u32 s27, s26, 8192
  buffer_load_dwordx4 v[28:31], v5, s[4:7], s27 offen sc1
  s_add_u32 s27, s26, 12288
  buffer_load_dwordx4 v[32:35], v5, s[4:7], s27 offen sc1
  s_add_u32 s27, s26, 16384
  buffer_load_dwordx4 v[36:39], v5, s[4:7], s27 offen sc1
  s_add_u32 s27, s26, 20480
  buffer_load_dwordx4 v[40:43], v5, s[4:7], s27 offen sc1
  s_add_u32 s27, s26, 24576
  buffer_load_dwordx4 v[44:47], v5, s[4:7], s27 offen sc1
  s_add_u32 s27, s26, 28672
  buffer_load_dwordx4 v[48:51], v5, s[4:7], s27 offen sc1
  s_add_u32 s53, s53, 1
  s_cmp_gt_u32 s53, 1048576
  s_cbranch_scc1 q_fail_90
  s_mov_b32 vcc_lo, 0xaaaaaaaa
  s_mov_b32 vcc_hi, 0xaaaaaaaa
  v_mov_b32 v72, 0x3f80
  v_mov_b32 v68, 1.0
  v_cndmask_b32 v72, v72, v68, vcc
  s_mov_b32 vcc_lo, 0x30003
  s_mov_b32 vcc_hi, 0x30003
  v_cndmask_b32 v68, 0, v72, vcc
  s_mov_b32 vcc_lo, 0xc000c
  s_mov_b32 vcc_hi, 0xc000c
  v_cndmask_b32 v69, 0, v72, vcc
  s_mov_b32 vcc_lo, 0x300030
  s_mov_b32 vcc_hi, 0x300030
  v_cndmask_b32 v70, 0, v72, vcc
  s_mov_b32 vcc_lo, 0xc000c0
  s_mov_b32 vcc_hi, 0xc000c0
  v_cndmask_b32 v71, 0, v72, vcc
  s_waitcnt vmcnt(7)
  s_nop 0
  v_mfma_f32_16x16x32_bf16 v[72:75], v[68:71], v[20:23], 0
  v_max3_u32 v80, v20, v21, 0
  v_max3_u32 v80, v22, v23, v80
  s_waitcnt vmcnt(6)
  v_mfma_f32_16x16x32_bf16 v[72:75], v[68:71], v[24:27], v[72:75]
  v_max3_u32 v80, v24, v25, v80
  v_max3_u32 v80, v26, v27, v80
  s_waitcnt vmcnt(5)
  v_mfma_f32_16x16x32_bf16 v[72:75], v[68:71], v[28:31], v[72:75]
  v_max3_u32 v80, v28, v29, v80
  v_max3_u32 v80, v30, v31, v80
  s_waitcnt vmcnt(4)
  v_mfma_f32_16x16x32_bf16 v[72:75], v[68:71], v[32:35], v[72:75]
  v_max3_u32 v80, v32, v33, v80
  v_max3_u32 v80, v34, v35, v80
  s_waitcnt vmcnt(3)
  v_mfma_f32_16x16x32_bf16 v[72:75], v[68:71], v[36:39], v[72:75]
  v_max3_u32 v80, v36, v37, v80
  v_max3_u32 v80, v38, v39, v80
  s_waitcnt vmcnt(2)
  v_mfma_f32_16x16x32_bf16 v[72:75], v[68:71], v[40:43], v[72:75]
  v_max3_u32 v80, v40, v41, v80
  v_max3_u32 v80, v42, v43, v80
  s_waitcnt vmcnt(1)
  v_mfma_f32_16x16x32_bf16 v[72:75], v[68:71], v[44:47], v[72:75]
  v_max3_u32 v80, v44, v45, v80
  v_max3_u32 v80, v46, v47, v80
  s_waitcnt vmcnt(0)
  v_mfma_f32_16x16x32_bf16 v[72:75], v[68:71], v[48:51], v[72:75]
  v_max3_u32 v80, v48, v49, v80
  v_max3_u32 v80, v50, v51, v80
  v_cmp_eq_u32 vcc, -1, v80
  s_cbranch_vccnz m_w_103
  v_lshlrev_b32 v3, 1, v3
  v_lshl_add_u32 v3, v2, 4, v3
  s_lshl_b32 s26, s17, 9
  s_add_u32 s26, s26, 159744
  v_add_u32 v3, s26, v3
  s_mov_b32 exec_hi, 0
  ds_write_b128 v3, v[72:75]
  s_mov_b32 exec_hi, -1
  v_lshlrev_b32 v3, 1, v0
  v_add_u32 v3, 159744, v3
  buffer_store_dwordx4 v[100:103], v8, s[4:7], s77 offen offset:0 sc1
  buffer_store_dwordx4 v[104:107], v8, s[4:7], s77 offen offset:512 sc1
  buffer_store_dwordx4 v[100:103], v8, s[4:7], s28 offen offset:0 sc1
  buffer_store_dwordx4 v[104:107], v8, s[4:7], s28 offen offset:512 sc1
  v_lshlrev_b32 v80, 16, v108
  v_and_b32 v81, 0xffff0000, v108
  v_lshlrev_b32 v82, 16, v109
  v_and_b32 v83, 0xffff0000, v109
  v_lshlrev_b32 v84, 16, v110
  v_and_b32 v85, 0xffff0000, v110
  v_lshlrev_b32 v86, 16, v111
  v_and_b32 v87, 0xffff0000, v111
  v_lshlrev_b32 v88, 16, v112
  v_and_b32 v89, 0xffff0000, v112
  v_lshlrev_b32 v90, 16, v113
  v_and_b32 v91, 0xffff0000, v113
  v_lshlrev_b32 v92, 16, v114
  v_and_b32 v93, 0xffff0000, v114
  v_lshlrev_b32 v94, 16, v115
  v_and_b32 v95, 0xffff0000, v115
  s_waitcnt lgkmcnt(0)
  s_barrier
  s_cmp_lg_u32 s17, 0
  s_cbranch_scc1 m_done_102
  ds_read_b128 v[72:75], v3
  ds_read_b128 v[76:79], v3 offset:16
  s_and_b32 s29, s58, 0xffff0000
  s_xor_b32 s27, s29, 0x80000000
  s_xor_b32 s28, s29, 0xffff0000
  s_bitcmp1_b32 s29, 31
  s_cselect_b32 s29, s27, s28
  v_mov_b32 v108, s29
  v_mul_f32 v108, 0xbfb8aa3b, v108
  v_exp_f32 v108, v108
  s_nop 0
  v_add_f32 v108, 1.0, v108
  v_rcp_f32 v108, v108
  s_nop 0
  v_cvt_pk_bf16_f32 v108, 0, v108
  s_waitcnt lgkmcnt(0)
  v_cvt_pk_bf16_f32 v72, 0, v72
  v_cvt_pk_bf16_f32 v73, 0, v73
  v_cvt_pk_bf16_f32 v74, 0, v74
  v_cvt_pk_bf16_f32 v75, 0, v75
  v_cvt_pk_bf16_f32 v76, 0, v76
  v_cvt_pk_bf16_f32 v77, 0, v77
  v_cvt_pk_bf16_f32 v78, 0, v78
  v_cvt_pk_bf16_f32 v79, 0, v79
  v_mul_f32 v72, v72, v108
  v_mul_f32 v73, v73, v108
  v_mul_f32 v74, v74, v108
  v_mul_f32 v75, v75, v108
  v_mul_f32 v76, v76, v108
  v_mul_f32 v77, v77, v108
  v_mul_f32 v78, v78, v108
  v_mul_f32 v79, v79, v108
  v_cvt_pk_bf16_f32 v72, 0, v72
  v_cvt_pk_bf16_f32 v73, 0, v73
  v_cvt_pk_bf16_f32 v74, 0, v74
  v_cvt_pk_bf16_f32 v75, 0, v75
  v_cvt_pk_bf16_f32 v76, 0, v76
  v_cvt_pk_bf16_f32 v77, 0, v77
  v_cvt_pk_bf16_f32 v78, 0, v78
  v_cvt_pk_bf16_f32 v79, 0, v79
  v_add_f32 v72, v72, v88
  v_add_f32 v73, v73, v89
  v_add_f32 v74, v74, v90
  v_add_f32 v75, v75, v91
  v_add_f32 v76, v76, v92
  v_add_f32 v77, v77, v93
  v_add_f32 v78, v78, v94
  v_add_f32 v79, v79, v95
  v_cvt_pk_bf16_f32 v72, 0, v72
  v_cvt_pk_bf16_f32 v73, 0, v73
  v_cvt_pk_bf16_f32 v74, 0, v74
  v_cvt_pk_bf16_f32 v75, 0, v75
  v_cvt_pk_bf16_f32 v76, 0, v76
  v_cvt_pk_bf16_f32 v77, 0, v77
  v_cvt_pk_bf16_f32 v78, 0, v78
  v_cvt_pk_bf16_f32 v79, 0, v79
  v_add_f32 v80, v80, v72
  v_add_f32 v81, v81, v73
  v_add_f32 v82, v82, v74
  v_add_f32 v83, v83, v75
  v_add_f32 v84, v84, v76
  v_add_f32 v85, v85, v77
  v_add_f32 v86, v86, v78
  v_add_f32 v87, v87, v79
  v_cvt_pk_bf16_f32 v112, v80, v81
  v_cvt_pk_bf16_f32 v113, v82, v83
  v_cvt_pk_bf16_f32 v114, v84, v85
  v_cvt_pk_bf16_f32 v115, v86, v87
  v_lshlrev_b32 v80, 16, v112
  v_and_b32 v81, 0xffff0000, v112
  v_lshlrev_b32 v82, 16, v113
  v_and_b32 v83, 0xffff0000, v113
  v_lshlrev_b32 v84, 16, v114
  v_and_b32 v85, 0xffff0000, v114
  v_lshlrev_b32 v86, 16, v115
  v_and_b32 v87, 0xffff0000, v115
  s_lshl_b32 s27, s46, 5
  s_add_u32 s27, s27, s16
  s_lshl_b32 s27, s27, 10
  s_add_u32 s27, s27, 33554432
  buffer_store_dwordx4 v[112:115], v0, s[4:7], s27 offen sc1
  v_add_f32 v20, v80, v81
  v_mul_f32 v21, v80, v80
  v_add_f32 v22, v82, v83
  v_mul_f32 v23, v81, v81
  v_fmac_f32 v21, v82, v82
  v_fmac_f32 v23, v83, v83
  v_add_f32 v20, v20, v84
  v_fmac_f32 v21, v84, v84
  v_add_f32 v22, v22, v85
  v_fmac_f32 v23, v85, v85
  v_add_f32 v20, v20, v86
  v_fmac_f32 v21, v86, v86
  v_add_f32 v22, v22, v87
  v_fmac_f32 v23, v87, v87
  v_add_f32 v20, v20, v22
  v_add_f32 v21, v21, v23
  s_nop 0
  v_add_f32_dpp v20, v20, v20 row_ror:8 row_mask:0xf bank_mask:0xf
  v_add_f32_dpp v21, v21, v21 row_ror:8 row_mask:0xf bank_mask:0xf
  s_nop 0
  v_add_f32_dpp v20, v20, v20 row_ror:4 row_mask:0xf bank_mask:0xf
  v_add_f32_dpp v21, v21, v21 row_ror:4 row_mask:0xf bank_mask:0xf
  s_nop 0
  v_add_f32_dpp v20, v20, v20 row_ror:2 row_mask:0xf bank_mask:0xf
  v_add_f32_dpp v21, v21, v21 row_ror:2 row_mask:0xf bank_mask:0xf
  s_nop 0
  v_add_f32_dpp v20, v20, v20 row_ror:1 row_mask:0xf bank_mask:0xf
  v_add_f32_dpp v21, v21, v21 row_ror:1 row_mask:0xf bank_mask:0xf
  v_mov_b32 v24, v20
  v_mov_b32 v25, v21
  s_nop 0
  v_permlane16_swap_b32 v20, v24
  v_permlane16_swap_b32 v21, v25
  v_add_f32 v20, v20, v24
  v_add_f32 v21, v21, v25
  v_mov_b32 v24, v20
  v_mov_b32 v25, v21
  s_nop 0
  v_permlane32_swap_b32 v20, v24
  v_permlane32_swap_b32 v21, v25
  v_add_f32 v20, v20, v24
  v_add_f32 v21, v21, v25
  v_mul_f32 v20, 0x3b000000, v20
  v_mul_f32 v21, 0x3b000000, v21
  v_fma_f32 v21, -v20, v20, v21
  v_cvt_pk_bf16_f32 v20, 0, v20
  v_max_f32 v21, 0, v21
  v_sub_f32 v24, v80, v20
  v_sub_f32 v25, v81, v20
  v_cvt_pk_bf16_f32 v21, 0, v21
  v_sub_f32 v26, v82, v20
  v_sub_f32 v27, v83, v20
  v_add_f32 v21, 0x3727c5ac, v21
  v_sub_f32 v28, v84, v20
  v_sub_f32 v29, v85, v20
  v_cvt_pk_bf16_f32 v21, 0, v21
  v_sub_f32 v30, v86, v20
  v_sub_f32 v31, v87, v20
  v_sqrt_f32 v21, v21
  v_cvt_pk_bf16_f32 v24, 0, v24
  v_cvt_pk_bf16_f32 v25, 0, v25
  v_cvt_pk_bf16_f32 v21, 0, v21
  v_cvt_pk_bf16_f32 v26, 0, v26
  v_cvt_pk_bf16_f32 v27, 0, v27
  v_rcp_f32 v21, v21
  v_cvt_pk_bf16_f32 v28, 0, v28
  v_cvt_pk_bf16_f32 v29, 0, v29
  v_cvt_pk_bf16_f32 v30, 0, v30
  v_cvt_pk_bf16_f32 v31, 0, v31
  v_mul_f32 v24, v24, v21
  v_mul_f32 v25, v25, v21
  v_mul_f32 v26, v26, v21
  v_mul_f32 v27, v27, v21
  v_mul_f32 v28, v28, v21
  v_mul_f32 v29, v29, v21
  v_mul_f32 v30, v30, v21
  v_mul_f32 v31, v31, v21
  v_cvt_pk_bf16_f32 v32, v24, v25
  v_cvt_pk_bf16_f32 v33, v26, v27
  v_cvt_pk_bf16_f32 v34, v28, v29
  v_cvt_pk_bf16_f32 v35, v30, v31
  v_lshl_add_u32 v3, v0, 2, s50
  v_mov_b64 v[20:21], 0
  v_mov_b64 v[24:25], 0
  v_mov_b64 v[28:29], 0
  v_mov_b32 v22, v32
  v_mov_b32 v23, v34
  v_mov_b32 v26, v33
  v_mov_b32 v27, v35
  ds_write_b128 v3, v[22:25] offset:4096
  ds_write_b128 v3, v[20:23] offset:4112
  ds_write_b128 v3, v[26:29] offset:4128
  ds_write_b128 v3, v[24:27] offset:4144
m_done_102:
  v_lshrrev_b32 v96, 9, v0
  v_lshlrev_b32 v96, 4, v96
  v_and_b32 v97, 0xf0, v0
  v_xor_b32 v96, v96, v97
  v_and_b32 v97, 0x1f0, v0
  v_lshl_add_u32 v96, v97, 6, v96
  v_xor_b32 v120, 0, v96
  v_xor_b32 v121, 32, v96
  v_xor_b32 v122, 64, v96
  v_xor_b32 v123, 96, v96
  v_xor_b32 v124, 128, v96
  v_xor_b32 v125, 160, v96
  v_xor_b32 v126, 192, v96
  v_xor_b32 v127, 224, v96
  s_and_b32 s26, s17, 1
  s_lshl_b32 s26, s26, 7
  v_xor_b32 v96, s26, v0
  v_xor_b32 v12, 0, v96
  v_xor_b32 v13, 16, v96
  v_xor_b32 v14, 32, v96
  v_xor_b32 v15, 48, v96
  v_xor_b32 v16, 64, v96
  v_xor_b32 v17, 80, v96
  v_xor_b32 v18, 96, v96
  v_xor_b32 v19, 112, v96
  v_cmp_eq_u32 vcc, 0, v116
  v_max_u32_dpp v117, v116, v116 quad_perm:[1,0,3,2] row_mask:0xf bank_mask:0xf
  s_and_b32 s48, vcc_lo, 0xffffff
  s_cselect_b32 s48, 0, -1
  v_max_u32_dpp v117, v117, v117 quad_perm:[2,3,0,1] row_mask:0xf bank_mask:0xf
  s_nop 1
  v_max_u32_dpp v117, v117, v117 row_half_mirror row_mask:0xf bank_mask:0xf
  v_and_b32 v117, s48, v117
  s_cmp_eq_u32 s48, 0
  s_cbranch_scc1 q_nb_104
  s_and_b32 s63, s47, 127
  s_lshl_b32 s63, s63, 15
  s_xor_b32 s27, s50, 32768
  s_add_u32 m0, s27, s54
  s_add_u32 s63, s63, s54
  s_add_u32 s63, s63, 6291456
  buffer_load_dwordx4 v12, s[4:7], s63 offen offset:0 sc1 lds
  buffer_load_dwordx4 v13, s[4:7], s63 offen offset:1024 sc1 lds
  buffer_load_dwordx4 v14, s[4:7], s63 offen offset:2048 sc1 lds
  buffer_load_dwordx4 v15, s[4:7], s63 offen offset:3072 sc1 lds
  s_add_u32 m0, m0, 4096
  s_add_u32 s63, s63, 4096
  buffer_load_dwordx4 v16, s[4:7], s63 offen offset:0 sc1 lds
  buffer_load_dwordx4 v17, s[4:7], s63 offen offset:1024 sc1 lds
  buffer_load_dwordx4 v18, s[4:7], s63 offen offset:2048 sc1 lds
  buffer_load_dwordx4 v19, s[4:7], s63 offen offset:3072 sc1 lds
q_nb_104:
  v_lshrrev_b32 v2, 8, v0
  v_and_b32 v3, 48, v0
  v_lshl_add_u32 v3, v2, 6, v3
  v_add_u32 v3, s50, v3
  s_mov_b32 vcc_lo, 0xcccccccc
  s_mov_b32 vcc_hi, 0xcccccccc
  v_mov_b32 v32, 0x4444
  v_mov_b32 v33, 0xeeee
  v_cndmask_b32 v32, v32, v33, vcc
  s_waitcnt lgkmcnt(0)
  s_barrier
  ds_read_b128 v[36:39], v3 offset:4096
  ds_read_b128 v[40:43], v3 offset:4352
  ds_read_b128 v[44:47], v3 offset:4608
  ds_read_b128 v[48:51], v3 offset:4864
  ds_read_b128 v[52:55], v3 offset:5120
  ds_read_b128 v[56:59], v3 offset:5376
  ds_read_b128 v[60:63], v3 offset:5632
  ds_read_b128 v[64:67], v3 offset:5888
  v_mov_b64 v[20:21], 0
  v_mov_b64 v[22:23], 0
  v_mov_b64 v[24:25], 0
  v_mov_b64 v[26:27], 0
  v_mov_b64 v[28:29], 0
  v_mov_b64 v[30:31], 0
  s_waitcnt lgkmcnt(7)
  v_smfmac_f32_16x16x64_bf16 v[20:23], v[36:39], v[128:135], v32
  ds_read_b128 v[68:71], v3 offset:6144
  v_smfmac_f32_16x16x64_bf16 v[24:27], v[36:39], a[0:7], v32
  s_and_b32 s26, s59, 16
  v_smfmac_f32_16x16x64_bf16 v[28:31], v[36:39], a[128:135], v32
  s_lshl_b32 s27, s26, 6
  s_waitcnt lgkmcnt(7)
  v_smfmac_f32_16x16x64_bf16 v[20:23], v[40:43], v[136:143], v32
  ds_read_b128 v[72:75], v3 offset:6400
  v_smfmac_f32_16x16x64_bf16 v[24:27], v[40:43], a[8:15], v32
  s_and_b32 s28, s59, 15
  v_smfmac_f32_16x16x64_bf16 v[28:31], v[40:43], a[136:143], v32
  s_lshl4_add_u32 s27, s28, s27
  s_waitcnt lgkmcnt(7)
  v_smfmac_f32_16x16x64_bf16 v[20:23], v[44:47], v[144:151], v32
  ds_read_b128 v[76:79], v3 offset:6656
  v_smfmac_f32_16x16x64_bf16 v[24:27], v[44:47], a[16:23], v32
  s_add_u32 s77, s77, s27
  v_smfmac_f32_16x16x64_bf16 v[28:31], v[44:47], a[144:151], v32
  s_add_u32 s27, s27, s44
  s_waitcnt lgkmcnt(7)
  v_smfmac_f32_16x16x64_bf16 v[20:23], v[48:51], v[152:159], v32
  ds_read_b128 v[80:83], v3 offset:6912
  v_smfmac_f32_16x16x64_bf16 v[24:27], v[48:51], a[24:31], v32
  s_lshr_b32 s26, s26, 1
  v_smfmac_f32_16x16x64_bf16 v[28:31], v[48:51], a[152:159], v32
  s_and_b32 s28, s59, 3
  s_waitcnt lgkmcnt(7)
  v_smfmac_f32_16x16x64_bf16 v[20:23], v[52:55], v[160:167], v32
  ds_read_b128 v[84:87], v3 offset:7168
  v_smfmac_f32_16x16x64_bf16 v[24:27], v[52:55], a[32:39], v32
  s_lshl1_add_u32 s26, s28, s26
  v_smfmac_f32_16x16x64_bf16 v[28:31], v[52:55], a[160:167], v32
  s_and_b32 s28, s59, 12
  s_waitcnt lgkmcnt(7)
  v_smfmac_f32_16x16x64_bf16 v[20:23], v[56:59], v[168:175], v32
  ds_read_b128 v[88:91], v3 offset:7424
  v_smfmac_f32_16x16x64_bf16 v[24:27], v[56:59], a[40:47], v32
  s_lshl_b32 s28, s28, 6
  v_smfmac_f32_16x16x64_bf16 v[28:31], v[56:59], a[168:175], v32
  s_add_u32 s26, s26, s28
  s_waitcnt lgkmcnt(7)
  v_smfmac_f32_16x16x64_bf16 v[20:23], v[60:63], v[176:183], v32
  ds_read_b128 v[92:95], v3 offset:7680
  v_smfmac_f32_16x16x64_bf16 v[24:27], v[60:63], a[48:55], v32
  s_add_u32 s26, s26, s44
  v_smfmac_f32_16x16x64_bf16 v[28:31], v[60:63], a[176:183], v32
  v_and_b32 v2, 0xc0, v0
  s_waitcnt lgkmcnt(7)
  v_smfmac_f32_16x16x64_bf16 v[20:23], v[64:67], v[184:191], v32
  ds_read_b128 v[96:99], v3 offset:7936
  v_smfmac_f32_16x16x64_bf16 v[24:27], v[64:67], a[56:63], v32
  v_and_b32 v5, 12, v1
  v_smfmac_f32_16x16x64_bf16 v[28:31], v[64:67], a[184:191], v32
  v_lshrrev_b32 v5, 1, v5
  s_waitcnt lgkmcnt(7)
  v_smfmac_f32_16x16x64_bf16 v[20:23], v[68:71], v[192:199], v32
  v_lshl_add_u32 v2, v2, 2, v5
  v_smfmac_f32_16x16x64_bf16 v[24:27], v[68:71], a[64:71], v32
  v_smfmac_f32_16x16x64_bf16 v[28:31], v[68:71], a[192:199], v32
  s_waitcnt lgkmcnt(6)
  v_smfmac_f32_16x16x64_bf16 v[20:23], v[72:75], v[200:207], v32
  v_smfmac_f32_16x16x64_bf16 v[24:27], v[72:75], a[72:79], v32
  v_smfmac_f32_16x16x64_bf16 v[28:31], v[72:75], a[200:207], v32
  s_waitcnt lgkmcnt(5)
  v_smfmac_f32_16x16x64_bf16 v[20:23], v[76:79], v[208:215], v32
  v_smfmac_f32_16x16x64_bf16 v[24:27], v[76:79], a[80:87], v32
  v_smfmac_f32_16x16x64_bf16 v[28:31], v[76:79], a[208:215], v32
  s_waitcnt lgkmcnt(4)
  v_smfmac_f32_16x16x64_bf16 v[20:23], v[80:83], v[216:223], v32
  v_smfmac_f32_16x16x64_bf16 v[24:27], v[80:83], a[88:95], v32
  v_smfmac_f32_16x16x64_bf16 v[28:31], v[80:83], a[216:223], v32
  s_waitcnt lgkmcnt(3)
  v_smfmac_f32_16x16x64_bf16 v[20:23], v[84:87], v[224:231], v32
  v_smfmac_f32_16x16x64_bf16 v[24:27], v[84:87], a[96:103], v32
  v_smfmac_f32_16x16x64_bf16 v[28:31], v[84:87], a[224:231], v32
  s_waitcnt lgkmcnt(2)
  v_smfmac_f32_16x16x64_bf16 v[20:23], v[88:91], v[232:239], v32
  v_smfmac_f32_16x16x64_bf16 v[24:27], v[88:91], a[104:111], v32
  v_smfmac_f32_16x16x64_bf16 v[28:31], v[88:91], a[232:239], v32
  s_waitcnt lgkmcnt(1)
  v_smfmac_f32_16x16x64_bf16 v[20:23], v[92:95], v[240:247], v32
  v_smfmac_f32_16x16x64_bf16 v[24:27], v[92:95], a[112:119], v32
  v_smfmac_f32_16x16x64_bf16 v[28:31], v[92:95], a[240:247], v32
  s_waitcnt lgkmcnt(0)
  v_smfmac_f32_16x16x64_bf16 v[20:23], v[96:99], v[248:255], v32
  v_smfmac_f32_16x16x64_bf16 v[24:27], v[96:99], a[120:127], v32
  v_smfmac_f32_16x16x64_bf16 v[28:31], v[96:99], a[248:255], v32
  v_add_f32 v20, v20, v22
  v_add_f32 v21, v21, v23
  s_nop 1
  v_add_f32 v24, v24, v26
  v_add_f32 v25, v25, v27
  s_nop 1
  v_add_f32 v28, v28, v30
  v_add_f32 v29, v29, v31
  v_mul_f32 v20, s24, v20
  v_mul_f32 v21, s24, v21
  v_cvt_pk_bf16_f32 v20, v20, v21
  v_cvt_pk_bf16_f32 v24, v24, v25
  v_cvt_pk_bf16_f32 v28, v28, v29
  s_mov_b64 exec, 0xffff
  s_waitcnt vmcnt(0)
  buffer_store_short v20, v2, s[4:7], s27 offen sc1
  buffer_store_short_d16_hi v20, v2, s[4:7], s27 offen offset:8 sc1
  buffer_store_short v24, v0, s[4:7], s26 offen offset:2048 sc1
  buffer_store_short_d16_hi v24, v0, s[4:7], s26 offen offset:3072 sc1
  buffer_store_short v28, v2, s[4:7], s77 offen sc1
  buffer_store_short_d16_hi v28, v2, s[4:7], s77 offen offset:8 sc1
  s_mov_b64 exec, 3
  s_waitcnt vmcnt(0)
  buffer_store_dword v4, v0, s[4:7], s51 offen sc1
  s_mov_b64 exec, 3
  buffer_store_dword v4, v0, s[4:7], s49 offen sc1
  s_mov_b64 exec, -1
  s_mov_b32 s49, 268435456
  v_mov_b32 v4, 1
  s_branch q_nxt_96
q_end_87:
  s_waitcnt vmcnt(0)
  s_mov_b64 exec, 3
  buffer_store_dword v4, v0, s[4:7], s49 offen sc1
  s_mov_b64 exec, -1
  s_cmp_lg_u32 s60, 0
  s_cbranch_scc1 q_fail_90
  s_load_dwordx2 s[72:73], s[0:1], 96
  s_mov_b32 s74, 2097152
  s_mov_b32 s75, 0x20000
  s_mov_b32 s58, 0
  s_cmp_eq_u32 s17, 3
  s_cselect_b32 s48, 7, 15
k_fin_105:
  s_load_dwordx2 s[64:65], s[0:1], 72
  s_load_dwordx2 s[68:69], s[0:1], 80
  s_load_dwordx2 s[8:9], s[0:1], 88
  s_mov_b32 s66, 1835008
  s_mov_b32 s70, 1835008
  s_mov_b32 s10, 1835008
  v_lshrrev_b32 v2, 7, v0
  v_and_b32 v3, 0x70, v0
  v_mul_u32_u24 v6, 57344, v2
  v_add_u32 v6, v6, v3
  v_cmp_eq_u32 vcc, 0x70, v3
  v_mov_b32 v3, 0x7ff00000
  s_nop 0
  v_cndmask_b32 v6, v6, v3, vcc
  v_lshrrev_b32 v2, 8, v0
  v_mul_u32_u24 v7, 14336, v2
  v_and_b32 v3, 0xf0, v0
  v_add_u32 v7, v7, v3
  s_mul_i32 s34, s17, 458752
  s_mul_i32 s27, s16, 112
  s_add_u32 s34, s34, s27
  s_mul_i32 s35, s16, 57344
  s_lshl_b32 s27, s17, 8
  s_add_u32 s35, s35, s27
  s_waitcnt lgkmcnt(0)
  s_xor_b32 s37, s50, 32768
  s_add_u32 s37, s37, s54
  s_mov_b32 m0, s37
  s_add_u32 s36, s34, 39424
  buffer_load_dwordx4 v6, s[68:71], s36 offen lds
  s_add_u32 m0, m0, 1024
  s_add_u32 s36, s34, 43008
  buffer_load_dwordx4 v6, s[64:67], s36 offen lds
  s_add_u32 m0, m0, 1024
  s_add_u32 s36, s34, 43008
  buffer_load_dwordx4 v6, s[68:71], s36 offen lds
  s_add_u32 m0, m0, 1024
  s_add_u32 s36, s34, 46592
  buffer_load_dwordx4 v6, s[64:67], s36 offen lds
  s_add_u32 m0, m0, 1024
  s_add_u32 s36, s34, 46592
  buffer_load_dwordx4 v6, s[68:71], s36 offen lds
  s_add_u32 m0, m0, 1024
  s_add_u32 s36, s34, 50176
  buffer_load_dwordx4 v6, s[64:67], s36 offen lds
  s_add_u32 m0, m0, 1024
  s_add_u32 s36, s34, 50176
  buffer_load_dwordx4 v6, s[68:71], s36 offen lds
  s_add_u32 m0, m0, 1024
  s_add_u32 s36, s34, 53760
  buffer_load_dwordx4 v6, s[64:67], s36 offen lds
  s_add_u32 m0, m0, 1024
  s_add_u32 s36, s34, 53760
  buffer_load_dwordx4 v[60:63], v6, s[68:71], s36 offen
  buffer_load_dwordx4 v[64:67], v7, s[8:11], s35 offen offset:0
  buffer_load_dwordx4 v[68:71], v7, s[8:11], s35 offen offset:1024
  buffer_load_dwordx4 v[72:75], v7, s[8:11], s35 offen offset:2048
  buffer_load_dwordx4 v[76:79], v7, s[8:11], s35 offen offset:3072
  s_add_u32 s35, s35, 4096
  buffer_load_dwordx4 v[80:83], v7, s[8:11], s35 offen offset:0
  buffer_load_dwordx4 v[84:87], v7, s[8:11], s35 offen offset:1024
  buffer_load_dwordx4 v[88:91], v7, s[8:11], s35 offen offset:2048
  buffer_load_dwordx4 v[92:95], v7, s[8:11], s35 offen offset:3072
  s_add_u32 s35, s35, 4096
  buffer_load_dwordx4 v[96:99], v7, s[8:11], s35 offen offset:0
  buffer_load_dwordx4 v[100:103], v7, s[8:11], s35 offen offset:1024
  buffer_load_dwordx4 v[104:107], v7, s[8:11], s35 offen offset:2048
  buffer_load_dwordx4 v[108:111], v7, s[8:11], s35 offen offset:3072
  s_add_u32 s35, s35, 4096
  buffer_load_dwordx4 v[112:115], v7, s[8:11], s35 offen offset:0
  buffer_load_dwordx4 v[48:51], v7, s[8:11], s35 offen offset:1024
  s_andn2_b32 s28, 0xfe0, s56
  s_lshl_b32 s28, s28, 7
  s_mov_b32 s29, 243793920
  v_mov_b32 v24, 262144
  s_mov_b32 s53, 0
  s_mov_b32 s33, 3
  v_mov_b32 v53, s58
  s_and_b32 s32, s48, 15
  s_cbranch_scc0 k_x_108
k_w_107:
  s_add_u32 s33, s33, 1
  s_and_b32 s33, s33, 3
  s_bitcmp1_b32 s32, s33
  s_cbranch_scc0 k_w_107
  s_lshl2_add_u32 s26, s33, s17
  s_lshl_b32 s26, s26, 14
  s_add_u32 s27, s26, 8192
  v_add_u32 v22, s26, v9
  v_cmp_le_u32 vcc, s28, v22
  s_nop 1
  v_cndmask_b32 v25, 0, v24, vcc
  v_add_u32 v22, v22, v25
  buffer_load_dword v20, v22, s[4:7], s29 offen sc1
  v_add_u32 v23, s27, v9
  v_cmp_le_u32 vcc, s28, v23
  s_nop 1
  v_cndmask_b32 v25, 0, v24, vcc
  v_add_u32 v23, v23, v25
  buffer_load_dword v21, v23, s[4:7], s29 offen sc1
  s_add_u32 s53, s53, 1
  s_cmp_gt_u32 s53, 1048576
  s_cbranch_scc1 q_fail_90
  s_waitcnt vmcnt(0)
  v_min_u32 v52, v20, v21
  v_max3_u32 v53, v20, v21, v53
  v_cmp_eq_u32 vcc, 0, v52
  s_cbranch_vccnz k_w_107
  s_bitset0_b32 s32, s33
  s_cmp_lg_u32 s32, 0
  s_cbranch_scc1 k_w_107
  v_max_u32_dpp v53, v53, v53 row_ror:8 row_mask:0xf bank_mask:0xf
  s_nop 1
  v_max_u32_dpp v53, v53, v53 row_ror:4 row_mask:0xf bank_mask:0xf
  s_nop 1
  v_max_u32_dpp v53, v53, v53 row_ror:2 row_mask:0xf bank_mask:0xf
  s_nop 1
  v_max_u32_dpp v53, v53, v53 row_ror:1 row_mask:0xf bank_mask:0xf
  v_mov_b32 v52, v53
  s_nop 0
  s_nop 0
  v_permlane16_swap_b32 v53, v52
  v_max_u32 v53, v53, v52
  v_mov_b32 v52, v53
  s_nop 0
  s_nop 0
  v_permlane32_swap_b32 v53, v52
  v_max_u32 v53, v53, v52
k_x_108:
  ds_write_b32 v118, v53 offset:256
  s_waitcnt vmcnt(0) lgkmcnt(0)
  s_barrier
  ds_read_b128 v[20:23], v119 offset:256
  s_waitcnt lgkmcnt(0)
  v_max3_u32 v20, v20, v21, v22
  v_max_u32 v20, v20, v23
  s_nop 0
  v_readfirstlane_b32 s26, v20
  s_cmp_eq_u32 s26, s58
  s_cbranch_scc1 q_fail_90
  s_cmp_eq_u32 s58, 0
  s_mov_b32 s58, s26
  s_cbranch_scc1 k_r_109
  s_cmp_lg_u32 s57, 0
  s_cbranch_scc1 k_r_109
  s_lshl_b32 s26, s59, 10
  buffer_store_dwordx4 a[0:3], v0, s[72:75], s26 offen sc1
k_r_109:
  s_andn2_b32 s26, 0xfe0, s56
  s_andn2_b32 s27, 0xfe0, s58
  s_cmp_lt_u32 s27, s26
  s_cselect_b32 s61, 1, 2
  s_andn2_b32 s59, 0xfff, s58
  s_lshl_b32 s26, s61, 21
  s_lshl_b32 s27, s59, 10
  s_add_u32 s26, s26, s27
  s_lshl_b32 s27, s17, 8
  s_add_u32 s26, s26, s27
  s_add_u32 s26, s26, 27262976
  v_lshrrev_b32 v5, 7, v0
  v_lshlrev_b32 v5, 5, v5
  buffer_load_dwordx4 v[52:55], v5, s[4:7], s26 offen offset:0 sc1
  buffer_load_dwordx4 v[56:59], v5, s[4:7], s26 offen offset:16 sc1
  s_mov_b32 vcc_lo, 0xaaaaaaaa
  s_mov_b32 vcc_hi, 0xaaaaaaaa
  v_mov_b32 v3, 0xffff
  v_mov_b32 v24, 0xffff0000
  v_cndmask_b32 v3, v3, v24, vcc
  s_mov_b32 vcc_lo, 0x3030303
  s_mov_b32 vcc_hi, 0x3030303
  v_cndmask_b32 v24, 0, v3, vcc
  s_mov_b32 vcc_lo, 0xc0c0c0c
  s_mov_b32 vcc_hi, 0xc0c0c0c
  v_cndmask_b32 v25, 0, v3, vcc
  s_mov_b32 vcc_lo, 0x30303030
  s_mov_b32 vcc_hi, 0x30303030
  v_cndmask_b32 v26, 0, v3, vcc
  s_mov_b32 vcc_lo, 0xc0c0c0c0
  s_mov_b32 vcc_hi, 0xc0c0c0c0
  v_cndmask_b32 v27, 0, v3, vcc
  s_mov_b32 s30, 0x01000100
  s_mov_b32 s31, 0x03020302
  s_mul_i32 s26, s17, 23552
  s_add_u32 s26, s26, 65536
  v_add_u32 v5, s26, v0
  v_add_u32 v2, s37, v0
  ds_read_b128 v[36:39], v5 offset:0
  ds_read_b128 v[40:43], v5 offset:1024
  ds_read_b128 v[44:47], v5 offset:2048
  ds_read_b128 v[12:15], v5 offset:3072
  ds_read_b128 v[16:19], v5 offset:4096
  ds_read_b128 v[120:123], v5 offset:5120
  ds_read_b128 v[124:127], v5 offset:6144
  s_waitcnt vmcnt(0)
  v_perm_b32 v3, v52, v52, s30
  v_and_b32 v20, v24, v3
  v_and_b32 v21, v25, v3
  v_and_b32 v22, v26, v3
  v_and_b32 v23, v27, v3
  s_waitcnt lgkmcnt(5)
  s_nop 0
  v_mfma_f32_16x16x32_bf16 v[28:31], v[20:23], v[36:39], 0
  ds_read_b128 v[36:39], v5 offset:7168
  v_mfma_f32_16x16x32_bf16 v[32:35], v[20:23], v[40:43], 0
  ds_read_b128 v[40:43], v5 offset:8192
  v_perm_b32 v3, v52, v52, s31
  v_and_b32 v20, v24, v3
  v_and_b32 v21, v25, v3
  v_and_b32 v22, v26, v3
  v_and_b32 v23, v27, v3
  s_waitcnt lgkmcnt(5)
  s_nop 0
  v_mfma_f32_16x16x32_bf16 v[28:31], v[20:23], v[44:47], v[28:31]
  ds_read_b128 v[44:47], v5 offset:9216
  v_mfma_f32_16x16x32_bf16 v[32:35], v[20:23], v[12:15], v[32:35]
  ds_read_b128 v[12:15], v5 offset:10240
  v_perm_b32 v3, v53, v53, s30
  v_and_b32 v20, v24, v3
  v_and_b32 v21, v25, v3
  v_and_b32 v22, v26, v3
  v_and_b32 v23, v27, v3
  s_waitcnt lgkmcnt(5)
  s_nop 0
  v_mfma_f32_16x16x32_bf16 v[28:31], v[20:23], v[16:19], v[28:31]
  ds_read_b128 v[16:19], v5 offset:11264
  v_mfma_f32_16x16x32_bf16 v[32:35], v[20:23], v[120:123], v[32:35]
  ds_read_b128 v[120:123], v5 offset:12288
  v_perm_b32 v3, v53, v53, s31
  v_and_b32 v20, v24, v3
  v_and_b32 v21, v25, v3
  v_and_b32 v22, v26, v3
  v_and_b32 v23, v27, v3
  s_waitcnt lgkmcnt(5)
  s_nop 0
  v_mfma_f32_16x16x32_bf16 v[28:31], v[20:23], v[124:127], v[28:31]
  ds_read_b128 v[124:127], v5 offset:13312
  v_mfma_f32_16x16x32_bf16 v[32:35], v[20:23], v[36:39], v[32:35]
  ds_read_b128 v[36:39], v5 offset:14336
  v_perm_b32 v3, v54, v54, s30
  v_and_b32 v20, v24, v3
  v_and_b32 v21, v25, v3
  v_and_b32 v22, v26, v3
  v_and_b32 v23, v27, v3
  s_waitcnt lgkmcnt(5)
  s_nop 0
  v_mfma_f32_16x16x32_bf16 v[28:31], v[20:23], v[40:43], v[28:31]
  ds_read_b128 v[40:43], v5 offset:15360
  v_mfma_f32_16x16x32_bf16 v[32:35], v[20:23], v[44:47], v[32:35]
  ds_read_b128 v[44:47], v5 offset:16384
  v_perm_b32 v3, v54, v54, s31
  v_and_b32 v20, v24, v3
  v_and_b32 v21, v25, v3
  v_and_b32 v22, v26, v3
  v_and_b32 v23, v27, v3
  s_waitcnt lgkmcnt(5)
  s_nop 0
  v_mfma_f32_16x16x32_bf16 v[28:31], v[20:23], v[12:15], v[28:31]
  ds_read_b128 v[12:15], v5 offset:17408
  v_mfma_f32_16x16x32_bf16 v[32:35], v[20:23], v[16:19], v[32:35]
  ds_read_b128 v[16:19], v5 offset:18432
  v_perm_b32 v3, v55, v55, s30
  v_and_b32 v20, v24, v3
  v_and_b32 v21, v25, v3
  v_and_b32 v22, v26, v3
  v_and_b32 v23, v27, v3
  s_waitcnt lgkmcnt(5)
  s_nop 0
  v_mfma_f32_16x16x32_bf16 v[28:31], v[20:23], v[120:123], v[28:31]
  ds_read_b128 v[120:123], v5 offset:19456
  v_mfma_f32_16x16x32_bf16 v[32:35], v[20:23], v[124:127], v[32:35]
  ds_read_b128 v[124:127], v5 offset:20480
  v_perm_b32 v3, v55, v55, s31
  v_and_b32 v20, v24, v3
  v_and_b32 v21, v25, v3
  v_and_b32 v22, v26, v3
  v_and_b32 v23, v27, v3
  s_waitcnt lgkmcnt(5)
  s_nop 0
  v_mfma_f32_16x16x32_bf16 v[28:31], v[20:23], v[36:39], v[28:31]
  ds_read_b128 v[36:39], v5 offset:21504
  v_mfma_f32_16x16x32_bf16 v[32:35], v[20:23], v[40:43], v[32:35]
  ds_read_b128 v[40:43], v5 offset:22528
  v_perm_b32 v3, v56, v56, s30
  v_and_b32 v20, v24, v3
  v_and_b32 v21, v25, v3
  v_and_b32 v22, v26, v3
  v_and_b32 v23, v27, v3
  s_waitcnt lgkmcnt(5)
  s_nop 0
  v_mfma_f32_16x16x32_bf16 v[28:31], v[20:23], v[44:47], v[28:31]
  ds_read_b128 v[44:47], v2 offset:0
  v_mfma_f32_16x16x32_bf16 v[32:35], v[20:23], v[12:15], v[32:35]
  ds_read_b128 v[12:15], v2 offset:1024
  v_perm_b32 v3, v56, v56, s31
  v_and_b32 v20, v24, v3
  v_and_b32 v21, v25, v3
  v_and_b32 v22, v26, v3
  v_and_b32 v23, v27, v3
  s_waitcnt lgkmcnt(5)
  s_nop 0
  v_mfma_f32_16x16x32_bf16 v[28:31], v[20:23], v[16:19], v[28:31]
  ds_read_b128 v[16:19], v2 offset:2048
  v_mfma_f32_16x16x32_bf16 v[32:35], v[20:23], v[120:123], v[32:35]
  ds_read_b128 v[120:123], v2 offset:3072
  v_perm_b32 v3, v57, v57, s30
  v_and_b32 v20, v24, v3
  v_and_b32 v21, v25, v3
  v_and_b32 v22, v26, v3
  v_and_b32 v23, v27, v3
  s_waitcnt lgkmcnt(5)
  s_nop 0
  v_mfma_f32_16x16x32_bf16 v[28:31], v[20:23], v[124:127], v[28:31]
  ds_read_b128 v[124:127], v2 offset:4096
  v_mfma_f32_16x16x32_bf16 v[32:35], v[20:23], v[36:39], v[32:35]
  ds_read_b128 v[36:39], v2 offset:5120
  v_perm_b32 v3, v57, v57, s31
  v_and_b32 v20, v24, v3
  v_and_b32 v21, v25, v3
  v_and_b32 v22, v26, v3
  v_and_b32 v23, v27, v3
  s_waitcnt lgkmcnt(5)
  s_nop 0
  v_mfma_f32_16x16x32_bf16 v[28:31], v[20:23], v[40:43], v[28:31]
  ds_read_b128 v[40:43], v2 offset:6144
  v_mfma_f32_16x16x32_bf16 v[32:35], v[20:23], v[44:47], v[32:35]
  ds_read_b128 v[44:47], v2 offset:7168
  v_perm_b32 v3, v58, v58, s30
  v_and_b32 v20, v24, v3
  v_and_b32 v21, v25, v3
  v_and_b32 v22, v26, v3
  v_and_b32 v23, v27, v3
  s_waitcnt lgkmcnt(5)
  s_nop 0
  v_mfma_f32_16x16x32_bf16 v[28:31], v[20:23], v[12:15], v[28:31]
  v_mfma_f32_16x16x32_bf16 v[32:35], v[20:23], v[16:19], v[32:35]
  v_perm_b32 v3, v58, v58, s31
  v_and_b32 v20, v24, v3
  v_and_b32 v21, v25, v3
  v_and_b32 v22, v26, v3
  v_and_b32 v23, v27, v3
  s_waitcnt lgkmcnt(3)
  s_nop 0
  v_mfma_f32_16x16x32_bf16 v[28:31], v[20:23], v[120:123], v[28:31]
  v_mfma_f32_16x16x32_bf16 v[32:35], v[20:23], v[124:127], v[32:35]
  v_perm_b32 v3, v59, v59, s30
  v_and_b32 v20, v24, v3
  v_and_b32 v21, v25, v3
  v_and_b32 v22, v26, v3
  v_and_b32 v23, v27, v3
  s_waitcnt lgkmcnt(1)
  s_nop 0
  v_mfma_f32_16x16x32_bf16 v[28:31], v[20:23], v[36:39], v[28:31]
  v_mfma_f32_16x16x32_bf16 v[32:35], v[20:23], v[40:43], v[32:35]
  v_perm_b32 v3, v59, v59, s31
  v_and_b32 v20, v24, v3
  v_and_b32 v21, v25, v3
  v_and_b32 v22, v26, v3
  v_and_b32 v23, v27, v3
  s_waitcnt lgkmcnt(0)
  s_nop 0
  v_mfma_f32_16x16x32_bf16 v[28:31], v[20:23], v[44:47], v[28:31]
  v_mfma_f32_16x16x32_bf16 v[32:35], v[20:23], v[60:63], v[32:35]
  v_lshrrev_b32 v2, 8, v0
  v_and_b32 v3, 0xf0, v0
  v_lshlrev_b32 v3, 1, v3
  v_and_b32 v5, 1, v2
  v_lshl_add_u32 v5, v5, 4, v3
  v_add_u32 v5, s37, v5
  s_mov_b32 exec_lo, 0x00ff00ff
  s_mov_b32 exec_hi, 0xff00ff00
  ds_write_b128 v5, v[28:31]
  ds_write_b128 v5, v[32:35] offset:512
  s_mov_b64 exec, -1
  s_xor_b32 s26, s50, 32768
  v_add_u32 v5, s26, v1
  v_lshl_add_u32 v3, v2, 4, v3
  s_waitcnt lgkmcnt(0)
  s_barrier
  ds_read2st64_b32 v[36:37], v5 offset0:0 offset1:1
  ds_read2st64_b32 v[52:53], v5 offset0:2 offset1:3
  ds_read2st64_b32 v[38:39], v5 offset0:32 offset1:33
  ds_read2st64_b32 v[54:55], v5 offset0:34 offset1:35
  ds_read2st64_b32 v[40:41], v5 offset0:64 offset1:65
  ds_read2st64_b32 v[56:57], v5 offset0:66 offset1:67
  ds_read2st64_b32 v[42:43], v5 offset0:96 offset1:97
  ds_read2st64_b32 v[58:59], v5 offset0:98 offset1:99
  s_waitcnt lgkmcnt(0)
  v_add_f32 v36, v36, v40
  v_add_f32 v37, v37, v41
  v_add_f32 v38, v38, v42
  v_add_f32 v39, v39, v43
  v_add_f32 v52, v52, v56
  v_add_f32 v53, v53, v57
  v_add_f32 v54, v54, v58
  v_add_f32 v55, v55, v59
  v_add_f32 v36, v36, v38
  v_add_f32 v37, v37, v39
  v_add_f32 v52, v52, v54
  v_add_f32 v53, v53, v55
  v_add_f32 v36, v36, v37
  v_add_f32 v52, v52, v53
  v_cvt_pk_bf16_f32 v36, 0, v36
  v_cvt_pk_bf16_f32 v52, 0, v52
  v_mul_f32 v40, 0xbfb8aa3b, v36
  v_exp_f32 v40, v40
  s_nop 0
  v_add_f32 v40, 1.0, v40
  v_rcp_f32 v40, v40
  s_nop 0
  v_mul_f32 v36, v36, v40
  v_cvt_pk_bf16_f32 v36, 0, v36
  v_mul_f32 v36, v36, v52
  v_cvt_pk_bf16_f32 v36, v36, v36
  s_lshl_b32 s26, s17, 8
  s_add_u32 s26, s26, 161792
  v_add_u32 v5, s26, v1
  ds_write_b32 v5, v36
  v_mul_u32_u24 v5, 56, v2
  v_add_u32 v5, s26, v5
  ds_read_b64 v[36:37], v5 offset:0
  ds_read_b64 v[38:39], v5 offset:8
  ds_read_b64 v[40:41], v5 offset:16
  ds_read_b64 v[42:43], v5 offset:24
  ds_read_b64 v[44:45], v5 offset:32
  ds_read_b64 v[46:47], v5 offset:40
  ds_read_b64 v[52:53], v5 offset:48
  s_waitcnt lgkmcnt(0)
  v_and_b32 v20, v24, v36
  v_and_b32 v21, v25, v36
  v_and_b32 v22, v26, v36
  v_and_b32 v23, v27, v36
  s_nop 0
  s_nop 0
  v_mfma_f32_16x16x32_bf16 v[28:31], v[20:23], v[64:67], 0
  v_and_b32 v32, v24, v37
  v_and_b32 v33, v25, v37
  v_and_b32 v34, v26, v37
  v_and_b32 v35, v27, v37
  s_nop 0
  s_nop 0
  v_mfma_f32_16x16x32_bf16 v[28:31], v[32:35], v[68:71], v[28:31]
  v_and_b32 v20, v24, v38
  v_and_b32 v21, v25, v38
  v_and_b32 v22, v26, v38
  v_and_b32 v23, v27, v38
  s_nop 0
  s_nop 0
  v_mfma_f32_16x16x32_bf16 v[28:31], v[20:23], v[72:75], v[28:31]
  v_and_b32 v32, v24, v39
  v_and_b32 v33, v25, v39
  v_and_b32 v34, v26, v39
  v_and_b32 v35, v27, v39
  s_nop 0
  s_nop 0
  v_mfma_f32_16x16x32_bf16 v[28:31], v[32:35], v[76:79], v[28:31]
  v_and_b32 v20, v24, v40
  v_and_b32 v21, v25, v40
  v_and_b32 v22, v26, v40
  v_and_b32 v23, v27, v40
  s_nop 0
  s_nop 0
  v_mfma_f32_16x16x32_bf16 v[28:31], v[20:23], v[80:83], v[28:31]
  v_and_b32 v32, v24, v41
  v_and_b32 v33, v25, v41
  v_and_b32 v34, v26, v41
  v_and_b32 v35, v27, v41
  s_nop 0
  s_nop 0
  v_mfma_f32_16x16x32_bf16 v[28:31], v[32:35], v[84:87], v[28:31]
  v_and_b32 v20, v24, v42
  v_and_b32 v21, v25, v42
  v_and_b32 v22, v26, v42
  v_and_b32 v23, v27, v42
  s_nop 0
  s_nop 0
  v_mfma_f32_16x16x32_bf16 v[28:31], v[20:23], v[88:91], v[28:31]
  v_and_b32 v32, v24, v43
  v_and_b32 v33, v25, v43
  v_and_b32 v34, v26, v43
  v_and_b32 v35, v27, v43
  s_nop 0
  s_nop 0
  v_mfma_f32_16x16x32_bf16 v[28:31], v[32:35], v[92:95], v[28:31]
  v_and_b32 v20, v24, v44
  v_and_b32 v21, v25, v44
  v_and_b32 v22, v26, v44
  v_and_b32 v23, v27, v44
  s_nop 0
  s_nop 0
  v_mfma_f32_16x16x32_bf16 v[28:31], v[20:23], v[96:99], v[28:31]
  v_and_b32 v32, v24, v45
  v_and_b32 v33, v25, v45
  v_and_b32 v34, v26, v45
  v_and_b32 v35, v27, v45
  s_nop 0
  s_nop 0
  v_mfma_f32_16x16x32_bf16 v[28:31], v[32:35], v[100:103], v[28:31]
  v_and_b32 v20, v24, v46
  v_and_b32 v21, v25, v46
  v_and_b32 v22, v26, v46
  v_and_b32 v23, v27, v46
  s_nop 0
  s_nop 0
  v_mfma_f32_16x16x32_bf16 v[28:31], v[20:23], v[104:107], v[28:31]
  v_and_b32 v32, v24, v47
  v_and_b32 v33, v25, v47
  v_and_b32 v34, v26, v47
  v_and_b32 v35, v27, v47
  s_nop 0
  s_nop 0
  v_mfma_f32_16x16x32_bf16 v[28:31], v[32:35], v[108:111], v[28:31]
  v_and_b32 v20, v24, v52
  v_and_b32 v21, v25, v52
  v_and_b32 v22, v26, v52
  v_and_b32 v23, v27, v52
  s_nop 0
  s_nop 0
  v_mfma_f32_16x16x32_bf16 v[28:31], v[20:23], v[112:115], v[28:31]
  v_and_b32 v32, v24, v53
  v_and_b32 v33, v25, v53
  v_and_b32 v34, v26, v53
  v_and_b32 v35, v27, v53
  s_nop 0
  s_nop 0
  v_mfma_f32_16x16x32_bf16 v[28:31], v[32:35], v[48:51], v[28:31]
  v_lshrrev_b32 v3, 1, v3
  s_lshl_b32 s26, s47, 7
  s_add_u32 s26, s26, s57
  s_lshl_b32 s26, s26, 8
  s_add_u32 s26, s26, 244318208
  s_nop 2
  v_cvt_pk_bf16_f32 v28, v28, v29
  v_cvt_pk_bf16_f32 v29, v30, v31
  v_min_u32 v28, -2, v28
  v_min_u32 v29, -2, v29
  s_mov_b32 exec_hi, 0
  buffer_store_dwordx2 v[28:29], v3, s[4:7], s26 offen sc1
  s_mov_b32 exec_hi, -1
  s_cmp_lg_u32 s16, 0
  s_cbranch_scc1 k_nx_106
  s_barrier
  s_lshl_b32 s26, s61, 21
  s_lshl_b32 s27, s59, 10
  s_add_u32 s26, s26, s27
  s_add_u32 s27, s26, 20971520
  s_add_u32 s28, s26, 27262976
  s_lshl_b32 s26, s47, 7
  s_add_u32 s26, s26, s17
  s_lshl_b32 s26, s26, 8
  s_add_u32 s26, s26, 244318208
  v_lshrrev_b32 v2, 8, v0
  v_and_b32 v3, 0xf0, v0
  v_lshl_add_u32 v5, v2, 10, v3
  buffer_load_dwordx4 v[108:111], v0, s[4:7], s27 offen sc1
  buffer_load_dwordx4 v[112:115], v0, s[4:7], s28 offen sc1
  s_mov_b32 s53, 0
m_w_111:
  s_add_u32 s27, s26, 0
  buffer_load_dwordx4 v[20:23], v5, s[4:7], s27 offen sc1
  s_add_u32 s27, s26, 4096
  buffer_load_dwordx4 v[24:27], v5, s[4:7], s27 offen sc1
  s_add_u32 s27, s26, 8192
  buffer_load_dwordx4 v[28:31], v5, s[4:7], s27 offen sc1
  s_add_u32 s27, s26, 12288
  buffer_load_dwordx4 v[32:35], v5, s[4:7], s27 offen sc1
  s_add_u32 s27, s26, 16384
  buffer_load_dwordx4 v[36:39], v5, s[4:7], s27 offen sc1
  s_add_u32 s27, s26, 20480
  buffer_load_dwordx4 v[40:43], v5, s[4:7], s27 offen sc1
  s_add_u32 s27, s26, 24576
  buffer_load_dwordx4 v[44:47], v5, s[4:7], s27 offen sc1
  s_add_u32 s27, s26, 28672
  buffer_load_dwordx4 v[48:51], v5, s[4:7], s27 offen sc1
  s_add_u32 s53, s53, 1
  s_cmp_gt_u32 s53, 1048576
  s_cbranch_scc1 q_fail_90
  s_mov_b32 vcc_lo, 0xaaaaaaaa
  s_mov_b32 vcc_hi, 0xaaaaaaaa
  v_mov_b32 v72, 0x3f80
  v_mov_b32 v68, 1.0
  v_cndmask_b32 v72, v72, v68, vcc
  s_mov_b32 vcc_lo, 0x30003
  s_mov_b32 vcc_hi, 0x30003
  v_cndmask_b32 v68, 0, v72, vcc
  s_mov_b32 vcc_lo, 0xc000c
  s_mov_b32 vcc_hi, 0xc000c
  v_cndmask_b32 v69, 0, v72, vcc
  s_mov_b32 vcc_lo, 0x300030
  s_mov_b32 vcc_hi, 0x300030
  v_cndmask_b32 v70, 0, v72, vcc
  s_mov_b32 vcc_lo, 0xc000c0
  s_mov_b32 vcc_hi, 0xc000c0
  v_cndmask_b32 v71, 0, v72, vcc
  s_waitcnt vmcnt(7)
  s_nop 0
  v_mfma_f32_16x16x32_bf16 v[72:75], v[68:71], v[20:23], 0
  v_max3_u32 v80, v20, v21, 0
  v_max3_u32 v80, v22, v23, v80
  s_waitcnt vmcnt(6)
  v_mfma_f32_16x16x32_bf16 v[72:75], v[68:71], v[24:27], v[72:75]
  v_max3_u32 v80, v24, v25, v80
  v_max3_u32 v80, v26, v27, v80
  s_waitcnt vmcnt(5)
  v_mfma_f32_16x16x32_bf16 v[72:75], v[68:71], v[28:31], v[72:75]
  v_max3_u32 v80, v28, v29, v80
  v_max3_u32 v80, v30, v31, v80
  s_waitcnt vmcnt(4)
  v_mfma_f32_16x16x32_bf16 v[72:75], v[68:71], v[32:35], v[72:75]
  v_max3_u32 v80, v32, v33, v80
  v_max3_u32 v80, v34, v35, v80
  s_waitcnt vmcnt(3)
  v_mfma_f32_16x16x32_bf16 v[72:75], v[68:71], v[36:39], v[72:75]
  v_max3_u32 v80, v36, v37, v80
  v_max3_u32 v80, v38, v39, v80
  s_waitcnt vmcnt(2)
  v_mfma_f32_16x16x32_bf16 v[72:75], v[68:71], v[40:43], v[72:75]
  v_max3_u32 v80, v40, v41, v80
  v_max3_u32 v80, v42, v43, v80
  s_waitcnt vmcnt(1)
  v_mfma_f32_16x16x32_bf16 v[72:75], v[68:71], v[44:47], v[72:75]
  v_max3_u32 v80, v44, v45, v80
  v_max3_u32 v80, v46, v47, v80
  s_waitcnt vmcnt(0)
  v_mfma_f32_16x16x32_bf16 v[72:75], v[68:71], v[48:51], v[72:75]
  v_max3_u32 v80, v48, v49, v80
  v_max3_u32 v80, v50, v51, v80
  v_cmp_eq_u32 vcc, -1, v80
  s_cbranch_vccnz m_w_111
  v_lshlrev_b32 v3, 1, v3
  v_lshl_add_u32 v3, v2, 4, v3
  s_lshl_b32 s26, s17, 9
  s_add_u32 s26, s26, 159744
  v_add_u32 v3, s26, v3
  s_mov_b32 exec_hi, 0
  ds_write_b128 v3, v[72:75]
  s_mov_b32 exec_hi, -1
  v_lshlrev_b32 v3, 1, v0
  v_add_u32 v3, 159744, v3
  v_lshlrev_b32 v80, 16, v108
  v_and_b32 v81, 0xffff0000, v108
  v_lshlrev_b32 v82, 16, v109
  v_and_b32 v83, 0xffff0000, v109
  v_lshlrev_b32 v84, 16, v110
  v_and_b32 v85, 0xffff0000, v110
  v_lshlrev_b32 v86, 16, v111
  v_and_b32 v87, 0xffff0000, v111
  v_lshlrev_b32 v88, 16, v112
  v_and_b32 v89, 0xffff0000, v112
  v_lshlrev_b32 v90, 16, v113
  v_and_b32 v91, 0xffff0000, v113
  v_lshlrev_b32 v92, 16, v114
  v_and_b32 v93, 0xffff0000, v114
  v_lshlrev_b32 v94, 16, v115
  v_and_b32 v95, 0xffff0000, v115
  s_waitcnt lgkmcnt(0)
  s_barrier
  s_cmp_lg_u32 s17, 0
  s_cbranch_scc1 m_done_110
  ds_read_b128 v[72:75], v3
  ds_read_b128 v[76:79], v3 offset:16
  s_and_b32 s29, s58, 0xffff0000
  s_xor_b32 s27, s29, 0x80000000
  s_xor_b32 s28, s29, 0xffff0000
  s_bitcmp1_b32 s29, 31
  s_cselect_b32 s29, s27, s28
  v_mov_b32 v108, s29
  v_mul_f32 v108, 0xbfb8aa3b, v108
  v_exp_f32 v108, v108
  s_nop 0
  v_add_f32 v108, 1.0, v108
  v_rcp_f32 v108, v108
  s_nop 0
  v_cvt_pk_bf16_f32 v108, 0, v108
  v_add_f32 v20, v80, v88
  v_add_f32 v21, v81, v89
  v_add_f32 v22, v82, v90
  v_add_f32 v23, v83, v91
  v_add_f32 v24, v84, v92
  v_add_f32 v25, v85, v93
  v_add_f32 v26, v86, v94
  v_add_f32 v27, v87, v95
  v_cvt_pk_bf16_f32 v28, v20, v21
  v_cvt_pk_bf16_f32 v29, v22, v23
  v_cvt_pk_bf16_f32 v30, v24, v25
  v_cvt_pk_bf16_f32 v31, v26, v27
  v_accvgpr_write_b32 a0, v28
  v_accvgpr_write_b32 a1, v29
  v_accvgpr_write_b32 a2, v30
  v_accvgpr_write_b32 a3, v31
  s_waitcnt lgkmcnt(0)
  v_cvt_pk_bf16_f32 v72, 0, v72
  v_cvt_pk_bf16_f32 v73, 0, v73
  v_cvt_pk_bf16_f32 v74, 0, v74
  v_cvt_pk_bf16_f32 v75, 0, v75
  v_cvt_pk_bf16_f32 v76, 0, v76
  v_cvt_pk_bf16_f32 v77, 0, v77
  v_cvt_pk_bf16_f32 v78, 0, v78
  v_cvt_pk_bf16_f32 v79, 0, v79
  v_mul_f32 v72, v72, v108
  v_mul_f32 v73, v73, v108
  v_mul_f32 v74, v74, v108
  v_mul_f32 v75, v75, v108
  v_mul_f32 v76, v76, v108
  v_mul_f32 v77, v77, v108
  v_mul_f32 v78, v78, v108
  v_mul_f32 v79, v79, v108
  v_cvt_pk_bf16_f32 v72, 0, v72
  v_cvt_pk_bf16_f32 v73, 0, v73
  v_cvt_pk_bf16_f32 v74, 0, v74
  v_cvt_pk_bf16_f32 v75, 0, v75
  v_cvt_pk_bf16_f32 v76, 0, v76
  v_cvt_pk_bf16_f32 v77, 0, v77
  v_cvt_pk_bf16_f32 v78, 0, v78
  v_cvt_pk_bf16_f32 v79, 0, v79
  v_add_f32 v72, v72, v88
  v_add_f32 v73, v73, v89
  v_add_f32 v74, v74, v90
  v_add_f32 v75, v75, v91
  v_add_f32 v76, v76, v92
  v_add_f32 v77, v77, v93
  v_add_f32 v78, v78, v94
  v_add_f32 v79, v79, v95
  v_cvt_pk_bf16_f32 v72, 0, v72
  v_cvt_pk_bf16_f32 v73, 0, v73
  v_cvt_pk_bf16_f32 v74, 0, v74
  v_cvt_pk_bf16_f32 v75, 0, v75
  v_cvt_pk_bf16_f32 v76, 0, v76
  v_cvt_pk_bf16_f32 v77, 0, v77
  v_cvt_pk_bf16_f32 v78, 0, v78
  v_cvt_pk_bf16_f32 v79, 0, v79
  v_add_f32 v80, v80, v72
  v_add_f32 v81, v81, v73
  v_add_f32 v82, v82, v74
  v_add_f32 v83, v83, v75
  v_add_f32 v84, v84, v76
  v_add_f32 v85, v85, v77
  v_add_f32 v86, v86, v78
  v_add_f32 v87, v87, v79
  v_cvt_pk_bf16_f32 v112, v80, v81
  v_cvt_pk_bf16_f32 v113, v82, v83
  v_cvt_pk_bf16_f32 v114, v84, v85
  v_cvt_pk_bf16_f32 v115, v86, v87
  v_lshlrev_b32 v80, 16, v112
  v_and_b32 v81, 0xffff0000, v112
  v_lshlrev_b32 v82, 16, v113
  v_and_b32 v83, 0xffff0000, v113
  v_lshlrev_b32 v84, 16, v114
  v_and_b32 v85, 0xffff0000, v114
  v_lshlrev_b32 v86, 16, v115
  v_and_b32 v87, 0xffff0000, v115
  s_lshl_b32 s26, s59, 10
  buffer_store_dwordx4 v[112:115], v0, s[72:75], s26 offen sc1
m_done_110:
k_nx_106:
  s_add_u32 s47, s47, 3
  s_xor_b32 s48, s48, 31
  s_andn2_b32 s28, 0xfe0, s56
  s_lshl_b32 s28, s28, 7
  s_mov_b32 s29, 243793920
  v_mov_b32 v24, 262144
  s_mov_b32 s53, 0
  s_mov_b32 s33, 3
  v_mov_b32 v53, s58
  s_and_b32 s32, s48, 15
  s_cbranch_scc0 k_x_113
k_w_112:
  s_add_u32 s33, s33, 1
  s_and_b32 s33, s33, 3
  s_bitcmp1_b32 s32, s33
  s_cbranch_scc0 k_w_112
  s_lshl2_add_u32 s26, s33, s17
  s_lshl_b32 s26, s26, 14
  s_add_u32 s27, s26, 8192
  v_add_u32 v22, s26, v9
  v_cmp_le_u32 vcc, s28, v22
  s_nop 1
  v_cndmask_b32 v25, 0, v24, vcc
  v_add_u32 v22, v22, v25
  buffer_load_dword v20, v22, s[4:7], s29 offen sc1
  v_add_u32 v23, s27, v9
  v_cmp_le_u32 vcc, s28, v23
  s_nop 1
  v_cndmask_b32 v25, 0, v24, vcc
  v_add_u32 v23, v23, v25
  buffer_load_dword v21, v23, s[4:7], s29 offen sc1
  s_add_u32 s53, s53, 1
  s_cmp_gt_u32 s53, 1048576
  s_cbranch_scc1 q_fail_90
  s_waitcnt vmcnt(0)
  v_min_u32 v52, v20, v21
  v_max3_u32 v53, v20, v21, v53
  v_cmp_eq_u32 vcc, 0, v52
  s_cbranch_vccnz k_w_112
  s_bitset0_b32 s32, s33
  s_cmp_lg_u32 s32, 0
  s_cbranch_scc1 k_w_112
  v_max_u32_dpp v53, v53, v53 row_ror:8 row_mask:0xf bank_mask:0xf
  s_nop 1
  v_max_u32_dpp v53, v53, v53 row_ror:4 row_mask:0xf bank_mask:0xf
  s_nop 1
  v_max_u32_dpp v53, v53, v53 row_ror:2 row_mask:0xf bank_mask:0xf
  s_nop 1
  v_max_u32_dpp v53, v53, v53 row_ror:1 row_mask:0xf bank_mask:0xf
  v_mov_b32 v52, v53
  s_nop 0
  s_nop 0
  v_permlane16_swap_b32 v53, v52
  v_max_u32 v53, v53, v52
  v_mov_b32 v52, v53
  s_nop 0
  s_nop 0
  v_permlane32_swap_b32 v53, v52
  v_max_u32 v53, v53, v52
k_x_113:
  ds_write_b32 v118, v53 offset:256
  s_waitcnt vmcnt(0) lgkmcnt(0)
  s_barrier
  ds_read_b128 v[20:23], v119 offset:256
  s_waitcnt lgkmcnt(0)
  v_max3_u32 v20, v20, v21, v22
  v_max_u32 v20, v20, v23
  s_nop 0
  v_readfirstlane_b32 s26, v20
  s_cmp_eq_u32 s26, s58
  s_cbranch_scc1 q_fail_90
  s_cmp_eq_u32 s58, 0
  s_mov_b32 s58, s26
  s_cbranch_scc1 k_r_114
  s_cmp_lg_u32 s57, 0
  s_cbranch_scc1 k_r_114
  s_lshl_b32 s26, s59, 10
  buffer_store_dwordx4 a[0:3], v0, s[72:75], s26 offen sc1
k_r_114:
  s_andn2_b32 s26, 0xfe0, s56
  s_andn2_b32 s27, 0xfe0, s58
  s_cmp_lt_u32 s27, s26
  s_cselect_b32 s61, 1, 2
  s_andn2_b32 s59, 0xfff, s58
  s_lshl_b32 s26, s61, 21
  s_lshl_b32 s27, s59, 10
  s_add_u32 s26, s26, s27
  s_lshl_b32 s27, s17, 8
  s_add_u32 s26, s26, s27
  s_add_u32 s26, s26, 27262976
  v_lshrrev_b32 v5, 7, v0
  v_lshlrev_b32 v5, 5, v5
  buffer_load_dwordx4 v[52:55], v5, s[4:7], s26 offen offset:0 sc1
  buffer_load_dwordx4 v[56:59], v5, s[4:7], s26 offen offset:16 sc1
  s_load_dwordx2 s[64:65], s[0:1], 72
  s_load_dwordx2 s[68:69], s[0:1], 80
  s_load_dwordx2 s[8:9], s[0:1], 88
  s_mov_b32 s66, 1835008
  s_mov_b32 s70, 1835008
  s_mov_b32 s10, 1835008
  v_lshrrev_b32 v2, 7, v0
  v_and_b32 v3, 0x70, v0
  v_mul_u32_u24 v6, 57344, v2
  v_add_u32 v6, v6, v3
  v_cmp_eq_u32 vcc, 0x70, v3
  v_mov_b32 v3, 0x7ff00000
  s_nop 0
  v_cndmask_b32 v6, v6, v3, vcc
  v_lshrrev_b32 v2, 8, v0
  v_mul_u32_u24 v7, 14336, v2
  v_and_b32 v3, 0xf0, v0
  v_add_u32 v7, v7, v3
  s_mul_i32 s34, s17, 458752
  s_mul_i32 s27, s16, 112
  s_add_u32 s34, s34, s27
  s_mul_i32 s35, s16, 57344
  s_lshl_b32 s27, s17, 8
  s_add_u32 s35, s35, s27
  s_waitcnt lgkmcnt(0)
  s_xor_b32 s37, s50, 32768
  s_add_u32 s37, s37, s54
  s_mov_b32 m0, s37
  s_add_u32 s36, s34, 39424
  buffer_load_dwordx4 v6, s[68:71], s36 offen lds
  s_add_u32 m0, m0, 1024
  s_add_u32 s36, s34, 43008
  buffer_load_dwordx4 v6, s[64:67], s36 offen lds
  s_add_u32 m0, m0, 1024
  s_add_u32 s36, s34, 43008
  buffer_load_dwordx4 v6, s[68:71], s36 offen lds
  s_add_u32 m0, m0, 1024
  s_add_u32 s36, s34, 46592
  buffer_load_dwordx4 v6, s[64:67], s36 offen lds
  s_add_u32 m0, m0, 1024
  s_add_u32 s36, s34, 46592
  buffer_load_dwordx4 v6, s[68:71], s36 offen lds
  s_add_u32 m0, m0, 1024
  s_add_u32 s36, s34, 50176
  buffer_load_dwordx4 v6, s[64:67], s36 offen lds
  s_add_u32 m0, m0, 1024
  s_add_u32 s36, s34, 50176
  buffer_load_dwordx4 v6, s[68:71], s36 offen lds
  s_add_u32 m0, m0, 1024
  s_add_u32 s36, s34, 53760
  buffer_load_dwordx4 v6, s[64:67], s36 offen lds
  s_add_u32 m0, m0, 1024
  s_add_u32 s36, s34, 53760
  buffer_load_dwordx4 v[60:63], v6, s[68:71], s36 offen
  buffer_load_dwordx4 v[64:67], v7, s[8:11], s35 offen offset:0
  buffer_load_dwordx4 v[68:71], v7, s[8:11], s35 offen offset:1024
  buffer_load_dwordx4 v[72:75], v7, s[8:11], s35 offen offset:2048
  buffer_load_dwordx4 v[76:79], v7, s[8:11], s35 offen offset:3072
  s_add_u32 s35, s35, 4096
  buffer_load_dwordx4 v[80:83], v7, s[8:11], s35 offen offset:0
  buffer_load_dwordx4 v[84:87], v7, s[8:11], s35 offen offset:1024
  buffer_load_dwordx4 v[88:91], v7, s[8:11], s35 offen offset:2048
  buffer_load_dwordx4 v[92:95], v7, s[8:11], s35 offen offset:3072
  s_add_u32 s35, s35, 4096
  buffer_load_dwordx4 v[96:99], v7, s[8:11], s35 offen offset:0
  buffer_load_dwordx4 v[100:103], v7, s[8:11], s35 offen offset:1024
  buffer_load_dwordx4 v[104:107], v7, s[8:11], s35 offen offset:2048
  buffer_load_dwordx4 v[108:111], v7, s[8:11], s35 offen offset:3072
  s_add_u32 s35, s35, 4096
  buffer_load_dwordx4 v[112:115], v7, s[8:11], s35 offen offset:0
  buffer_load_dwordx4 v[48:51], v7, s[8:11], s35 offen offset:1024
  s_mov_b32 vcc_lo, 0xaaaaaaaa
  s_mov_b32 vcc_hi, 0xaaaaaaaa
  v_mov_b32 v3, 0xffff
  v_mov_b32 v24, 0xffff0000
  v_cndmask_b32 v3, v3, v24, vcc
  s_mov_b32 vcc_lo, 0x3030303
  s_mov_b32 vcc_hi, 0x3030303
  v_cndmask_b32 v24, 0, v3, vcc
  s_mov_b32 vcc_lo, 0xc0c0c0c
  s_mov_b32 vcc_hi, 0xc0c0c0c
  v_cndmask_b32 v25, 0, v3, vcc
  s_mov_b32 vcc_lo, 0x30303030
  s_mov_b32 vcc_hi, 0x30303030
  v_cndmask_b32 v26, 0, v3, vcc
  s_mov_b32 vcc_lo, 0xc0c0c0c0
  s_mov_b32 vcc_hi, 0xc0c0c0c0
  v_cndmask_b32 v27, 0, v3, vcc
  s_mov_b32 s30, 0x01000100
  s_mov_b32 s31, 0x03020302
  s_mul_i32 s26, s17, 23552
  s_add_u32 s26, s26, 65536
  v_add_u32 v5, s26, v0
  v_add_u32 v2, s37, v0
  ds_read_b128 v[36:39], v5 offset:0
  ds_read_b128 v[40:43], v5 offset:1024
  ds_read_b128 v[44:47], v5 offset:2048
  ds_read_b128 v[12:15], v5 offset:3072
  ds_read_b128 v[16:19], v5 offset:4096
  ds_read_b128 v[120:123], v5 offset:5120
  ds_read_b128 v[124:127], v5 offset:6144
  s_waitcnt vmcnt(23)
  v_perm_b32 v3, v52, v52, s30
  v_and_b32 v20, v24, v3
  v_and_b32 v21, v25, v3
  v_and_b32 v22, v26, v3
  v_and_b32 v23, v27, v3
  s_waitcnt lgkmcnt(5)
  s_nop 0
  v_mfma_f32_16x16x32_bf16 v[28:31], v[20:23], v[36:39], 0
  ds_read_b128 v[36:39], v5 offset:7168
  v_mfma_f32_16x16x32_bf16 v[32:35], v[20:23], v[40:43], 0
  ds_read_b128 v[40:43], v5 offset:8192
  v_perm_b32 v3, v52, v52, s31
  v_and_b32 v20, v24, v3
  v_and_b32 v21, v25, v3
  v_and_b32 v22, v26, v3
  v_and_b32 v23, v27, v3
  s_waitcnt lgkmcnt(5)
  s_nop 0
  v_mfma_f32_16x16x32_bf16 v[28:31], v[20:23], v[44:47], v[28:31]
  ds_read_b128 v[44:47], v5 offset:9216
  v_mfma_f32_16x16x32_bf16 v[32:35], v[20:23], v[12:15], v[32:35]
  ds_read_b128 v[12:15], v5 offset:10240
  v_perm_b32 v3, v53, v53, s30
  v_and_b32 v20, v24, v3
  v_and_b32 v21, v25, v3
  v_and_b32 v22, v26, v3
  v_and_b32 v23, v27, v3
  s_waitcnt lgkmcnt(5)
  s_nop 0
  v_mfma_f32_16x16x32_bf16 v[28:31], v[20:23], v[16:19], v[28:31]
  ds_read_b128 v[16:19], v5 offset:11264
  v_mfma_f32_16x16x32_bf16 v[32:35], v[20:23], v[120:123], v[32:35]
  ds_read_b128 v[120:123], v5 offset:12288
  v_perm_b32 v3, v53, v53, s31
  v_and_b32 v20, v24, v3
  v_and_b32 v21, v25, v3
  v_and_b32 v22, v26, v3
  v_and_b32 v23, v27, v3
  s_waitcnt lgkmcnt(5)
  s_nop 0
  v_mfma_f32_16x16x32_bf16 v[28:31], v[20:23], v[124:127], v[28:31]
  ds_read_b128 v[124:127], v5 offset:13312
  v_mfma_f32_16x16x32_bf16 v[32:35], v[20:23], v[36:39], v[32:35]
  ds_read_b128 v[36:39], v5 offset:14336
  v_perm_b32 v3, v54, v54, s30
  v_and_b32 v20, v24, v3
  v_and_b32 v21, v25, v3
  v_and_b32 v22, v26, v3
  v_and_b32 v23, v27, v3
  s_waitcnt lgkmcnt(5)
  s_nop 0
  v_mfma_f32_16x16x32_bf16 v[28:31], v[20:23], v[40:43], v[28:31]
  ds_read_b128 v[40:43], v5 offset:15360
  v_mfma_f32_16x16x32_bf16 v[32:35], v[20:23], v[44:47], v[32:35]
  ds_read_b128 v[44:47], v5 offset:16384
  v_perm_b32 v3, v54, v54, s31
  v_and_b32 v20, v24, v3
  v_and_b32 v21, v25, v3
  v_and_b32 v22, v26, v3
  v_and_b32 v23, v27, v3
  s_waitcnt lgkmcnt(5)
  s_nop 0
  v_mfma_f32_16x16x32_bf16 v[28:31], v[20:23], v[12:15], v[28:31]
  ds_read_b128 v[12:15], v5 offset:17408
  v_mfma_f32_16x16x32_bf16 v[32:35], v[20:23], v[16:19], v[32:35]
  ds_read_b128 v[16:19], v5 offset:18432
  v_perm_b32 v3, v55, v55, s30
  v_and_b32 v20, v24, v3
  v_and_b32 v21, v25, v3
  v_and_b32 v22, v26, v3
  v_and_b32 v23, v27, v3
  s_waitcnt lgkmcnt(5)
  s_nop 0
  v_mfma_f32_16x16x32_bf16 v[28:31], v[20:23], v[120:123], v[28:31]
  ds_read_b128 v[120:123], v5 offset:19456
  v_mfma_f32_16x16x32_bf16 v[32:35], v[20:23], v[124:127], v[32:35]
  ds_read_b128 v[124:127], v5 offset:20480
  v_perm_b32 v3, v55, v55, s31
  v_and_b32 v20, v24, v3
  v_and_b32 v21, v25, v3
  v_and_b32 v22, v26, v3
  v_and_b32 v23, v27, v3
  s_waitcnt lgkmcnt(5)
  s_nop 0
  v_mfma_f32_16x16x32_bf16 v[28:31], v[20:23], v[36:39], v[28:31]
  ds_read_b128 v[36:39], v5 offset:21504
  v_mfma_f32_16x16x32_bf16 v[32:35], v[20:23], v[40:43], v[32:35]
  ds_read_b128 v[40:43], v5 offset:22528
  v_perm_b32 v3, v56, v56, s30
  v_and_b32 v20, v24, v3
  v_and_b32 v21, v25, v3
  v_and_b32 v22, v26, v3
  v_and_b32 v23, v27, v3
  s_waitcnt lgkmcnt(5)
  s_nop 0
  v_mfma_f32_16x16x32_bf16 v[28:31], v[20:23], v[44:47], v[28:31]
  s_waitcnt vmcnt(22)
  ds_read_b128 v[44:47], v2 offset:0
  v_mfma_f32_16x16x32_bf16 v[32:35], v[20:23], v[12:15], v[32:35]
  s_waitcnt vmcnt(21)
  ds_read_b128 v[12:15], v2 offset:1024
  v_perm_b32 v3, v56, v56, s31
  v_and_b32 v20, v24, v3
  v_and_b32 v21, v25, v3
  v_and_b32 v22, v26, v3
  v_and_b32 v23, v27, v3
  s_waitcnt lgkmcnt(5)
  s_nop 0
  v_mfma_f32_16x16x32_bf16 v[28:31], v[20:23], v[16:19], v[28:31]
  s_waitcnt vmcnt(20)
  ds_read_b128 v[16:19], v2 offset:2048
  v_mfma_f32_16x16x32_bf16 v[32:35], v[20:23], v[120:123], v[32:35]
  s_waitcnt vmcnt(19)
  ds_read_b128 v[120:123], v2 offset:3072
  v_perm_b32 v3, v57, v57, s30
  v_and_b32 v20, v24, v3
  v_and_b32 v21, v25, v3
  v_and_b32 v22, v26, v3
  v_and_b32 v23, v27, v3
  s_waitcnt lgkmcnt(5)
  s_nop 0
  v_mfma_f32_16x16x32_bf16 v[28:31], v[20:23], v[124:127], v[28:31]
  s_waitcnt vmcnt(18)
  ds_read_b128 v[124:127], v2 offset:4096
  v_mfma_f32_16x16x32_bf16 v[32:35], v[20:23], v[36:39], v[32:35]
  s_waitcnt vmcnt(17)
  ds_read_b128 v[36:39], v2 offset:5120
  v_perm_b32 v3, v57, v57, s31
  v_and_b32 v20, v24, v3
  v_and_b32 v21, v25, v3
  v_and_b32 v22, v26, v3
  v_and_b32 v23, v27, v3
  s_waitcnt lgkmcnt(5)
  s_nop 0
  v_mfma_f32_16x16x32_bf16 v[28:31], v[20:23], v[40:43], v[28:31]
  s_waitcnt vmcnt(16)
  ds_read_b128 v[40:43], v2 offset:6144
  v_mfma_f32_16x16x32_bf16 v[32:35], v[20:23], v[44:47], v[32:35]
  s_waitcnt vmcnt(15)
  ds_read_b128 v[44:47], v2 offset:7168
  v_perm_b32 v3, v58, v58, s30
  v_and_b32 v20, v24, v3
  v_and_b32 v21, v25, v3
  v_and_b32 v22, v26, v3
  v_and_b32 v23, v27, v3
  s_waitcnt lgkmcnt(5)
  s_nop 0
  v_mfma_f32_16x16x32_bf16 v[28:31], v[20:23], v[12:15], v[28:31]
  v_mfma_f32_16x16x32_bf16 v[32:35], v[20:23], v[16:19], v[32:35]
  v_perm_b32 v3, v58, v58, s31
  v_and_b32 v20, v24, v3
  v_and_b32 v21, v25, v3
  v_and_b32 v22, v26, v3
  v_and_b32 v23, v27, v3
  s_waitcnt lgkmcnt(3)
  s_nop 0
  v_mfma_f32_16x16x32_bf16 v[28:31], v[20:23], v[120:123], v[28:31]
  v_mfma_f32_16x16x32_bf16 v[32:35], v[20:23], v[124:127], v[32:35]
  v_perm_b32 v3, v59, v59, s30
  v_and_b32 v20, v24, v3
  v_and_b32 v21, v25, v3
  v_and_b32 v22, v26, v3
  v_and_b32 v23, v27, v3
  s_waitcnt lgkmcnt(1)
  s_nop 0
  v_mfma_f32_16x16x32_bf16 v[28:31], v[20:23], v[36:39], v[28:31]
  v_mfma_f32_16x16x32_bf16 v[32:35], v[20:23], v[40:43], v[32:35]
  v_perm_b32 v3, v59, v59, s31
  v_and_b32 v20, v24, v3
  v_and_b32 v21, v25, v3
  v_and_b32 v22, v26, v3
  v_and_b32 v23, v27, v3
  s_waitcnt lgkmcnt(0)
  s_waitcnt vmcnt(14)
  v_mfma_f32_16x16x32_bf16 v[28:31], v[20:23], v[44:47], v[28:31]
  v_mfma_f32_16x16x32_bf16 v[32:35], v[20:23], v[60:63], v[32:35]
  v_lshrrev_b32 v2, 8, v0
  v_and_b32 v3, 0xf0, v0
  v_lshlrev_b32 v3, 1, v3
  v_and_b32 v5, 1, v2
  v_lshl_add_u32 v5, v5, 4, v3
  v_add_u32 v5, s37, v5
  s_mov_b32 exec_lo, 0x00ff00ff
  s_mov_b32 exec_hi, 0xff00ff00
  ds_write_b128 v5, v[28:31]
  ds_write_b128 v5, v[32:35] offset:512
  s_mov_b64 exec, -1
  s_xor_b32 s26, s50, 32768
  v_add_u32 v5, s26, v1
  v_lshl_add_u32 v3, v2, 4, v3
  s_waitcnt lgkmcnt(0)
  s_barrier
  ds_read2st64_b32 v[36:37], v5 offset0:0 offset1:1
  ds_read2st64_b32 v[52:53], v5 offset0:2 offset1:3
  ds_read2st64_b32 v[38:39], v5 offset0:32 offset1:33
  ds_read2st64_b32 v[54:55], v5 offset0:34 offset1:35
  ds_read2st64_b32 v[40:41], v5 offset0:64 offset1:65
  ds_read2st64_b32 v[56:57], v5 offset0:66 offset1:67
  ds_read2st64_b32 v[42:43], v5 offset0:96 offset1:97
  ds_read2st64_b32 v[58:59], v5 offset0:98 offset1:99
  s_waitcnt lgkmcnt(0)
  v_add_f32 v36, v36, v40
  v_add_f32 v37, v37, v41
  v_add_f32 v38, v38, v42
  v_add_f32 v39, v39, v43
  v_add_f32 v52, v52, v56
  v_add_f32 v53, v53, v57
  v_add_f32 v54, v54, v58
  v_add_f32 v55, v55, v59
  v_add_f32 v36, v36, v38
  v_add_f32 v37, v37, v39
  v_add_f32 v52, v52, v54
  v_add_f32 v53, v53, v55
  v_add_f32 v36, v36, v37
  v_add_f32 v52, v52, v53
  v_cvt_pk_bf16_f32 v36, 0, v36
  v_cvt_pk_bf16_f32 v52, 0, v52
  v_mul_f32 v40, 0xbfb8aa3b, v36
  v_exp_f32 v40, v40
  s_nop 0
  v_add_f32 v40, 1.0, v40
  v_rcp_f32 v40, v40
  s_nop 0
  v_mul_f32 v36, v36, v40
  v_cvt_pk_bf16_f32 v36, 0, v36
  v_mul_f32 v36, v36, v52
  v_cvt_pk_bf16_f32 v36, v36, v36
  s_lshl_b32 s26, s17, 8
  s_add_u32 s26, s26, 161792
  v_add_u32 v5, s26, v1
  ds_write_b32 v5, v36
  v_mul_u32_u24 v5, 56, v2
  v_add_u32 v5, s26, v5
  ds_read_b64 v[36:37], v5 offset:0
  ds_read_b64 v[38:39], v5 offset:8
  ds_read_b64 v[40:41], v5 offset:16
  ds_read_b64 v[42:43], v5 offset:24
  ds_read_b64 v[44:45], v5 offset:32
  ds_read_b64 v[46:47], v5 offset:40
  ds_read_b64 v[52:53], v5 offset:48
  s_waitcnt lgkmcnt(0)
  v_and_b32 v20, v24, v36
  v_and_b32 v21, v25, v36
  v_and_b32 v22, v26, v36
  v_and_b32 v23, v27, v36
  s_waitcnt vmcnt(13)
  s_nop 0
  v_mfma_f32_16x16x32_bf16 v[28:31], v[20:23], v[64:67], 0
  v_and_b32 v32, v24, v37
  v_and_b32 v33, v25, v37
  v_and_b32 v34, v26, v37
  v_and_b32 v35, v27, v37
  s_waitcnt vmcnt(12)
  s_nop 0
  v_mfma_f32_16x16x32_bf16 v[28:31], v[32:35], v[68:71], v[28:31]
  v_and_b32 v20, v24, v38
  v_and_b32 v21, v25, v38
  v_and_b32 v22, v26, v38
  v_and_b32 v23, v27, v38
  s_waitcnt vmcnt(11)
  s_nop 0
  v_mfma_f32_16x16x32_bf16 v[28:31], v[20:23], v[72:75], v[28:31]
  v_and_b32 v32, v24, v39
  v_and_b32 v33, v25, v39
  v_and_b32 v34, v26, v39
  v_and_b32 v35, v27, v39
  s_waitcnt vmcnt(10)
  s_nop 0
  v_mfma_f32_16x16x32_bf16 v[28:31], v[32:35], v[76:79], v[28:31]
  v_and_b32 v20, v24, v40
  v_and_b32 v21, v25, v40
  v_and_b32 v22, v26, v40
  v_and_b32 v23, v27, v40
  s_waitcnt vmcnt(9)
  s_nop 0
  v_mfma_f32_16x16x32_bf16 v[28:31], v[20:23], v[80:83], v[28:31]
  v_and_b32 v32, v24, v41
  v_and_b32 v33, v25, v41
  v_and_b32 v34, v26, v41
  v_and_b32 v35, v27, v41
  s_waitcnt vmcnt(8)
  s_nop 0
  v_mfma_f32_16x16x32_bf16 v[28:31], v[32:35], v[84:87], v[28:31]
  v_and_b32 v20, v24, v42
  v_and_b32 v21, v25, v42
  v_and_b32 v22, v26, v42
  v_and_b32 v23, v27, v42
  s_waitcnt vmcnt(7)
  s_nop 0
  v_mfma_f32_16x16x32_bf16 v[28:31], v[20:23], v[88:91], v[28:31]
  v_and_b32 v32, v24, v43
  v_and_b32 v33, v25, v43
  v_and_b32 v34, v26, v43
  v_and_b32 v35, v27, v43
  s_waitcnt vmcnt(6)
  s_nop 0
  v_mfma_f32_16x16x32_bf16 v[28:31], v[32:35], v[92:95], v[28:31]
  v_and_b32 v20, v24, v44
  v_and_b32 v21, v25, v44
  v_and_b32 v22, v26, v44
  v_and_b32 v23, v27, v44
  s_waitcnt vmcnt(5)
  s_nop 0
  v_mfma_f32_16x16x32_bf16 v[28:31], v[20:23], v[96:99], v[28:31]
  v_and_b32 v32, v24, v45
  v_and_b32 v33, v25, v45
  v_and_b32 v34, v26, v45
  v_and_b32 v35, v27, v45
  s_waitcnt vmcnt(4)
  s_nop 0
  v_mfma_f32_16x16x32_bf16 v[28:31], v[32:35], v[100:103], v[28:31]
  v_and_b32 v20, v24, v46
  v_and_b32 v21, v25, v46
  v_and_b32 v22, v26, v46
  v_and_b32 v23, v27, v46
  s_waitcnt vmcnt(3)
  s_nop 0
  v_mfma_f32_16x16x32_bf16 v[28:31], v[20:23], v[104:107], v[28:31]
  v_and_b32 v32, v24, v47
  v_and_b32 v33, v25, v47
  v_and_b32 v34, v26, v47
  v_and_b32 v35, v27, v47
  s_waitcnt vmcnt(2)
  s_nop 0
  v_mfma_f32_16x16x32_bf16 v[28:31], v[32:35], v[108:111], v[28:31]
  v_and_b32 v20, v24, v52
  v_and_b32 v21, v25, v52
  v_and_b32 v22, v26, v52
  v_and_b32 v23, v27, v52
  s_waitcnt vmcnt(1)
  s_nop 0
  v_mfma_f32_16x16x32_bf16 v[28:31], v[20:23], v[112:115], v[28:31]
  v_and_b32 v32, v24, v53
  v_and_b32 v33, v25, v53
  v_and_b32 v34, v26, v53
  v_and_b32 v35, v27, v53
  s_waitcnt vmcnt(0)
  s_nop 0
  v_mfma_f32_16x16x32_bf16 v[28:31], v[32:35], v[48:51], v[28:31]
  v_lshrrev_b32 v3, 1, v3
  s_lshl_b32 s26, s47, 7
  s_add_u32 s26, s26, s57
  s_lshl_b32 s26, s26, 8
  s_add_u32 s26, s26, 244318208
  s_nop 2
  v_cvt_pk_bf16_f32 v28, v28, v29
  v_cvt_pk_bf16_f32 v29, v30, v31
  v_min_u32 v28, -2, v28
  v_min_u32 v29, -2, v29
  s_mov_b32 exec_hi, 0
  buffer_store_dwordx2 v[28:29], v3, s[4:7], s26 offen sc1
  s_mov_b32 exec_hi, -1
  s_cmp_lg_u32 s16, 0
  s_cbranch_scc1 q_fail_90
  s_barrier
  s_lshl_b32 s26, s61, 21
  s_lshl_b32 s27, s59, 10
  s_add_u32 s26, s26, s27
  s_add_u32 s27, s26, 20971520
  s_add_u32 s28, s26, 27262976
  s_lshl_b32 s26, s47, 7
  s_add_u32 s26, s26, s17
  s_lshl_b32 s26, s26, 8
  s_add_u32 s26, s26, 244318208
  v_lshrrev_b32 v2, 8, v0
  v_and_b32 v3, 0xf0, v0
  v_lshl_add_u32 v5, v2, 10, v3
  buffer_load_dwordx4 v[108:111], v0, s[4:7], s27 offen sc1
  buffer_load_dwordx4 v[112:115], v0, s[4:7], s28 offen sc1
  s_mov_b32 s53, 0
m_w_116:
  s_add_u32 s27, s26, 0
  buffer_load_dwordx4 v[20:23], v5, s[4:7], s27 offen sc1
  s_add_u32 s27, s26, 4096
  buffer_load_dwordx4 v[24:27], v5, s[4:7], s27 offen sc1
  s_add_u32 s27, s26, 8192
  buffer_load_dwordx4 v[28:31], v5, s[4:7], s27 offen sc1
  s_add_u32 s27, s26, 12288
  buffer_load_dwordx4 v[32:35], v5, s[4:7], s27 offen sc1
  s_add_u32 s27, s26, 16384
  buffer_load_dwordx4 v[36:39], v5, s[4:7], s27 offen sc1
  s_add_u32 s27, s26, 20480
  buffer_load_dwordx4 v[40:43], v5, s[4:7], s27 offen sc1
  s_add_u32 s27, s26, 24576
  buffer_load_dwordx4 v[44:47], v5, s[4:7], s27 offen sc1
  s_add_u32 s27, s26, 28672
  buffer_load_dwordx4 v[48:51], v5, s[4:7], s27 offen sc1
  s_add_u32 s53, s53, 1
  s_cmp_gt_u32 s53, 1048576
  s_cbranch_scc1 q_fail_90
  s_mov_b32 vcc_lo, 0xaaaaaaaa
  s_mov_b32 vcc_hi, 0xaaaaaaaa
  v_mov_b32 v72, 0x3f80
  v_mov_b32 v68, 1.0
  v_cndmask_b32 v72, v72, v68, vcc
  s_mov_b32 vcc_lo, 0x30003
  s_mov_b32 vcc_hi, 0x30003
  v_cndmask_b32 v68, 0, v72, vcc
  s_mov_b32 vcc_lo, 0xc000c
  s_mov_b32 vcc_hi, 0xc000c
  v_cndmask_b32 v69, 0, v72, vcc
  s_mov_b32 vcc_lo, 0x300030
  s_mov_b32 vcc_hi, 0x300030
  v_cndmask_b32 v70, 0, v72, vcc
  s_mov_b32 vcc_lo, 0xc000c0
  s_mov_b32 vcc_hi, 0xc000c0
  v_cndmask_b32 v71, 0, v72, vcc
  s_waitcnt vmcnt(7)
  s_nop 0
  v_mfma_f32_16x16x32_bf16 v[72:75], v[68:71], v[20:23], 0
  v_max3_u32 v80, v20, v21, 0
  v_max3_u32 v80, v22, v23, v80
  s_waitcnt vmcnt(6)
  v_mfma_f32_16x16x32_bf16 v[72:75], v[68:71], v[24:27], v[72:75]
  v_max3_u32 v80, v24, v25, v80
  v_max3_u32 v80, v26, v27, v80
  s_waitcnt vmcnt(5)
  v_mfma_f32_16x16x32_bf16 v[72:75], v[68:71], v[28:31], v[72:75]
  v_max3_u32 v80, v28, v29, v80
  v_max3_u32 v80, v30, v31, v80
  s_waitcnt vmcnt(4)
  v_mfma_f32_16x16x32_bf16 v[72:75], v[68:71], v[32:35], v[72:75]
  v_max3_u32 v80, v32, v33, v80
  v_max3_u32 v80, v34, v35, v80
  s_waitcnt vmcnt(3)
  v_mfma_f32_16x16x32_bf16 v[72:75], v[68:71], v[36:39], v[72:75]
  v_max3_u32 v80, v36, v37, v80
  v_max3_u32 v80, v38, v39, v80
  s_waitcnt vmcnt(2)
  v_mfma_f32_16x16x32_bf16 v[72:75], v[68:71], v[40:43], v[72:75]
  v_max3_u32 v80, v40, v41, v80
  v_max3_u32 v80, v42, v43, v80
  s_waitcnt vmcnt(1)
  v_mfma_f32_16x16x32_bf16 v[72:75], v[68:71], v[44:47], v[72:75]
  v_max3_u32 v80, v44, v45, v80
  v_max3_u32 v80, v46, v47, v80
  s_waitcnt vmcnt(0)
  v_mfma_f32_16x16x32_bf16 v[72:75], v[68:71], v[48:51], v[72:75]
  v_max3_u32 v80, v48, v49, v80
  v_max3_u32 v80, v50, v51, v80
  v_cmp_eq_u32 vcc, -1, v80
  s_cbranch_vccnz m_w_116
  v_lshlrev_b32 v3, 1, v3
  v_lshl_add_u32 v3, v2, 4, v3
  s_lshl_b32 s26, s17, 9
  s_add_u32 s26, s26, 159744
  v_add_u32 v3, s26, v3
  s_mov_b32 exec_hi, 0
  ds_write_b128 v3, v[72:75]
  s_mov_b32 exec_hi, -1
  v_lshlrev_b32 v3, 1, v0
  v_add_u32 v3, 159744, v3
  v_lshlrev_b32 v80, 16, v108
  v_and_b32 v81, 0xffff0000, v108
  v_lshlrev_b32 v82, 16, v109
  v_and_b32 v83, 0xffff0000, v109
  v_lshlrev_b32 v84, 16, v110
  v_and_b32 v85, 0xffff0000, v110
  v_lshlrev_b32 v86, 16, v111
  v_and_b32 v87, 0xffff0000, v111
  v_lshlrev_b32 v88, 16, v112
  v_and_b32 v89, 0xffff0000, v112
  v_lshlrev_b32 v90, 16, v113
  v_and_b32 v91, 0xffff0000, v113
  v_lshlrev_b32 v92, 16, v114
  v_and_b32 v93, 0xffff0000, v114
  v_lshlrev_b32 v94, 16, v115
  v_and_b32 v95, 0xffff0000, v115
  s_waitcnt lgkmcnt(0)
  s_barrier
  s_cmp_lg_u32 s17, 0
  s_cbranch_scc1 m_done_115
  ds_read_b128 v[72:75], v3
  ds_read_b128 v[76:79], v3 offset:16
  s_and_b32 s29, s58, 0xffff0000
  s_xor_b32 s27, s29, 0x80000000
  s_xor_b32 s28, s29, 0xffff0000
  s_bitcmp1_b32 s29, 31
  s_cselect_b32 s29, s27, s28
  v_mov_b32 v108, s29
  v_mul_f32 v108, 0xbfb8aa3b, v108
  v_exp_f32 v108, v108
  s_nop 0
  v_add_f32 v108, 1.0, v108
  v_rcp_f32 v108, v108
  s_nop 0
  v_cvt_pk_bf16_f32 v108, 0, v108
  s_waitcnt lgkmcnt(0)
  v_cvt_pk_bf16_f32 v72, 0, v72
  v_cvt_pk_bf16_f32 v73, 0, v73
  v_cvt_pk_bf16_f32 v74, 0, v74
  v_cvt_pk_bf16_f32 v75, 0, v75
  v_cvt_pk_bf16_f32 v76, 0, v76
  v_cvt_pk_bf16_f32 v77, 0, v77
  v_cvt_pk_bf16_f32 v78, 0, v78
  v_cvt_pk_bf16_f32 v79, 0, v79
  v_mul_f32 v72, v72, v108
  v_mul_f32 v73, v73, v108
  v_mul_f32 v74, v74, v108
  v_mul_f32 v75, v75, v108
  v_mul_f32 v76, v76, v108
  v_mul_f32 v77, v77, v108
  v_mul_f32 v78, v78, v108
  v_mul_f32 v79, v79, v108
  v_cvt_pk_bf16_f32 v72, 0, v72
  v_cvt_pk_bf16_f32 v73, 0, v73
  v_cvt_pk_bf16_f32 v74, 0, v74
  v_cvt_pk_bf16_f32 v75, 0, v75
  v_cvt_pk_bf16_f32 v76, 0, v76
  v_cvt_pk_bf16_f32 v77, 0, v77
  v_cvt_pk_bf16_f32 v78, 0, v78
  v_cvt_pk_bf16_f32 v79, 0, v79
  v_add_f32 v72, v72, v88
  v_add_f32 v73, v73, v89
  v_add_f32 v74, v74, v90
  v_add_f32 v75, v75, v91
  v_add_f32 v76, v76, v92
  v_add_f32 v77, v77, v93
  v_add_f32 v78, v78, v94
  v_add_f32 v79, v79, v95
  v_cvt_pk_bf16_f32 v72, 0, v72
  v_cvt_pk_bf16_f32 v73, 0, v73
  v_cvt_pk_bf16_f32 v74, 0, v74
  v_cvt_pk_bf16_f32 v75, 0, v75
  v_cvt_pk_bf16_f32 v76, 0, v76
  v_cvt_pk_bf16_f32 v77, 0, v77
  v_cvt_pk_bf16_f32 v78, 0, v78
  v_cvt_pk_bf16_f32 v79, 0, v79
  v_add_f32 v80, v80, v72
  v_add_f32 v81, v81, v73
  v_add_f32 v82, v82, v74
  v_add_f32 v83, v83, v75
  v_add_f32 v84, v84, v76
  v_add_f32 v85, v85, v77
  v_add_f32 v86, v86, v78
  v_add_f32 v87, v87, v79
  v_cvt_pk_bf16_f32 v112, v80, v81
  v_cvt_pk_bf16_f32 v113, v82, v83
  v_cvt_pk_bf16_f32 v114, v84, v85
  v_cvt_pk_bf16_f32 v115, v86, v87
  v_lshlrev_b32 v80, 16, v112
  v_and_b32 v81, 0xffff0000, v112
  v_lshlrev_b32 v82, 16, v113
  v_and_b32 v83, 0xffff0000, v113
  v_lshlrev_b32 v84, 16, v114
  v_and_b32 v85, 0xffff0000, v114
  v_lshlrev_b32 v86, 16, v115
  v_and_b32 v87, 0xffff0000, v115
  s_lshl_b32 s26, s59, 10
  buffer_store_dwordx4 v[112:115], v0, s[72:75], s26 offen sc1
m_done_115:
q_fail_90:
  s_endpgm
L_o:
  s_sub_u32 s60, s91, 3
  s_and_b32 s61, s90, 15
  s_load_dwordx2 s[80:81], s[0:1], 40
  s_load_dwordx2 s[72:73], s[0:1], 0
  s_mov_b32 s82, 4194304
  v_and_b32 v42, 63, v0
  v_and_b32 v40, 15, v42
  v_lshrrev_b32 v41, 4, v42
  v_lshlrev_b32 v1, 3, v42
  v_lshlrev_b32 v2, 2, v42
  v_lshlrev_b32 v0, 4, v42
  s_mov_b32 s24, 0x3e0293ee
  s_mov_b32 s44, 0x05040100
  s_mov_b32 s45, 0x07060302
  s_and_b32 s26, s17, 1
  s_lshl_b32 s26, s26, 4
  v_lshlrev_b32 v43, 2, v41
  v_sub_u32 v43, v40, v43
  v_add_u32 v43, s26, v43
  v_mov_b32 v7, 0xfe000000
  v_cmp_le_i32 vcc, 0, v43
  s_nop 1
  v_cndmask_b32 v24, v7, 0, vcc
  v_cmp_le_i32 vcc, 1, v43
  s_nop 1
  v_cndmask_b32 v25, v7, 0, vcc
  v_cmp_le_i32 vcc, 2, v43
  s_nop 1
  v_cndmask_b32 v26, v7, 0, vcc
  v_cmp_le_i32 vcc, 3, v43
  s_nop 1
  v_cndmask_b32 v27, v7, 0, vcc
  v_cmp_le_i32 vcc, 16, v43
  s_nop 1
  v_cndmask_b32 v28, v7, 0, vcc
  v_cmp_le_i32 vcc, 17, v43
  s_nop 1
  v_cndmask_b32 v29, v7, 0, vcc
  v_cmp_le_i32 vcc, 18, v43
  s_nop 1
  v_cndmask_b32 v30, v7, 0, vcc
  v_cmp_le_i32 vcc, 19, v43
  s_nop 1
  v_cndmask_b32 v31, v7, 0, vcc
  v_lshrrev_b32 v43, 5, v42
  v_lshlrev_b32 v43, 16, v43
  v_and_b32 v4, 1, v41
  v_lshl_add_u32 v43, v4, 14, v43
  v_lshl_add_u32 v43, v40, 4, v43
  s_lshl_b32 s26, s61, 10
  s_lshl_b32 s27, s17, 8
  s_add_u32 s26, s26, s27
  v_add_u32 v4, s26, v43
  v_lshlrev_b32 v43, 10, v41
  v_lshl_add_u32 v5, v40, 4, v43
  s_lshl_b32 s26, s17, 12
  v_add_u32 v6, s26, v0
  v_and_b32 v43, 1, v41
  v_lshlrev_b32 v43, 12, v43
  v_lshl_add_u32 v43, v40, 4, v43
  v_lshrrev_b32 v3, 1, v41
  v_lshl_add_u32 v3, v3, 8, v43
  s_lshr_b32 s26, s17, 1
  s_lshl_b32 s27, s26, 14
  s_add_u32 s27, s27, 16384
  v_add_u32 v32, s27, v0
  s_lshl_b32 s27, s26, 13
  s_and_b32 s28, s17, 1
  s_lshl_b32 s28, s28, 10
  s_add_u32 s28, s28, s27
  s_add_u32 s28, s28, 49152
  v_add_u32 v33, s28, v0
  s_add_u32 s27, s27, 65536
  v_add_u32 v34, s27, v0
  v_add_u32 v35, s27, v1
  v_and_b32 v36, 0xf0, v0
  v_and_b32 v252, 64, v0
  v_mov_b32 v248, 0
  v_lshlrev_b32 v255, 4, v0
  v_and_b32 v43, 1, v42
  v_xor_b32 v254, 1, v43
  s_lshl_b32 s26, s17, 3
  s_add_u32 s26, s26, 81920
  v_mov_b32 v39, s26
  s_mov_b32 vcc_lo, 0xaaaaaaaa
  s_mov_b32 vcc_hi, 0xaaaaaaaa
  v_mov_b32 v43, 0x3f80
  v_cndmask_b32 v43, v43, 1.0, vcc
  s_mov_b32 vcc_lo, 0xf000f
  s_mov_b32 vcc_hi, 0xf000f00
  v_cndmask_b32 v16, 0, v43, vcc
  v_cndmask_b32 v18, 0, v43, vcc
  s_mov_b32 vcc_lo, 0xf000f0
  s_mov_b32 vcc_hi, 0xf000f000
  v_cndmask_b32 v17, 0, v43, vcc
  v_cndmask_b32 v19, 0, v43, vcc
  s_mov_b32 vcc_lo, 0xcccccccc
  s_mov_b32 vcc_hi, 0xcccccccc
  v_mov_b32 v43, 0x4444
  v_mov_b32 v20, 0xeeee
  v_cndmask_b32 v20, v43, v20, vcc
  s_mov_b32 s70, 2097152
  s_mov_b32 s71, 0x20000
  s_mov_b32 s74, 2097152
  s_mov_b32 s75, 0x20000
  s_mov_b32 s10, 1024
  s_mov_b32 s83, 0x20000
  s_lshr_b32 s85, s17, 1
  s_lshl_b32 s26, s61, 1
  s_add_u32 s85, s85, s26
  s_add_u32 s43, s26, s17
  s_lshl_b32 s14, s61, 8
  s_lshl_b32 s15, s61, 7
  s_add_u32 s15, s15, 245104640
  s_add_u32 s14, s14, 244318208
  s_lshl_b32 s26, s61, 2
  s_add_u32 s26, s26, s17
  s_lshl_b32 s18, s26, 13
  s_add_u32 s18, s18, 41943040
  s_lshl_b32 s19, s26, 12
  s_add_u32 s19, s19, 142606336
  s_lshl_b32 s20, s85, 13
  s_add_u32 s20, s20, 192937984
  s_and_b32 s26, s17, 1
  s_mul_i32 s26, s26, 3072
  s_add_u32 s21, s20, s26
  s_lshr_b32 s40, s17, 1
  s_lshl_b32 s40, s40, 13
  s_add_u32 s40, s40, s26
  s_add_u32 s40, s40, 65536
  s_lshl_b32 s22, s17, 12
  s_add_u32 s22, s22, 49152
  s_lshl_b32 s23, s17, 13
  s_add_u32 s23, s23, 16384
  s_lshl_b32 s41, s60, 20
  s_add_u32 s41, s41, 12582912
  v_lshlrev_b32 v246, 3, v0
  s_mov_b32 s11, 0x20000
  s_waitcnt lgkmcnt(0)
  s_lshl_b32 s77, s60, 4
  s_add_u32 s77, s77, s61
  s_lshl_b32 s77, s77, 2
  s_add_u32 s77, s77, s17
  s_lshl_b32 s26, s77, 10
  buffer_load_dwordx4 v[176:179], v0, s[72:75], s26 offen
  s_add_u32 s26, s26, 262144
  buffer_load_dwordx4 v[180:183], v0, s[72:75], s26 offen
  s_add_u32 s26, s26, 262144
  buffer_load_dwordx4 v[184:187], v0, s[72:75], s26 offen
  s_add_u32 s26, s26, 262144
  buffer_load_dwordx4 v[188:191], v0, s[72:75], s26 offen
  s_add_u32 s26, s26, 262144
  buffer_load_dwordx4 v[192:195], v0, s[72:75], s26 offen
  s_add_u32 s26, s26, 262144
  buffer_load_dwordx4 v[196:199], v0, s[72:75], s26 offen
  s_add_u32 s26, s26, 262144
  buffer_load_dwordx4 v[200:203], v0, s[72:75], s26 offen
  s_add_u32 s26, s26, 262144
  buffer_load_dwordx4 v[204:207], v0, s[72:75], s26 offen
  s_add_u32 s26, s26, 262144
  v_lshrrev_b32 v44, 9, v0
  v_lshlrev_b32 v44, 12, v44
  v_and_b32 v45, 0xf0, v0
  v_add_u32 v44, v44, v45
  v_bfe_u32 v45, v0, 8, 1
  v_lshl_add_u32 v44, v45, 3, v44
  s_lshl_b32 s30, s61, 18
  s_lshl_b32 s27, s17, 8
  s_add_u32 s30, s30, s27
  s_add_u32 s27, s30, 0
  buffer_load_dwordx2 v[64:65], v44, s[80:83], s27 offen
  s_add_u32 s27, s30, 1024
  buffer_load_dwordx2 v[66:67], v44, s[80:83], s27 offen
  s_add_u32 s27, s30, 2048
  buffer_load_dwordx2 v[68:69], v44, s[80:83], s27 offen
  s_add_u32 s27, s30, 3072
  buffer_load_dwordx2 v[70:71], v44, s[80:83], s27 offen
  s_add_u32 s27, s30, 16384
  buffer_load_dwordx2 v[72:73], v44, s[80:83], s27 offen
  s_add_u32 s27, s30, 17408
  buffer_load_dwordx2 v[74:75], v44, s[80:83], s27 offen
  s_add_u32 s27, s30, 18432
  buffer_load_dwordx2 v[76:77], v44, s[80:83], s27 offen
  s_add_u32 s27, s30, 19456
  buffer_load_dwordx2 v[78:79], v44, s[80:83], s27 offen
  s_add_u32 s27, s30, 8192
  buffer_load_dwordx2 v[80:81], v44, s[80:83], s27 offen
  s_add_u32 s27, s30, 9216
  buffer_load_dwordx2 v[82:83], v44, s[80:83], s27 offen
  s_add_u32 s27, s30, 10240
  buffer_load_dwordx2 v[84:85], v44, s[80:83], s27 offen
  s_add_u32 s27, s30, 11264
  buffer_load_dwordx2 v[86:87], v44, s[80:83], s27 offen
  s_add_u32 s27, s30, 24576
  buffer_load_dwordx2 v[88:89], v44, s[80:83], s27 offen
  s_add_u32 s27, s30, 25600
  buffer_load_dwordx2 v[90:91], v44, s[80:83], s27 offen
  s_add_u32 s27, s30, 26624
  buffer_load_dwordx2 v[92:93], v44, s[80:83], s27 offen
  s_add_u32 s27, s30, 27648
  buffer_load_dwordx2 v[94:95], v44, s[80:83], s27 offen
  s_add_u32 s27, s30, 32768
  buffer_load_dwordx2 v[96:97], v44, s[80:83], s27 offen
  s_add_u32 s27, s30, 33792
  buffer_load_dwordx2 v[98:99], v44, s[80:83], s27 offen
  s_add_u32 s27, s30, 34816
  buffer_load_dwordx2 v[100:101], v44, s[80:83], s27 offen
  s_add_u32 s27, s30, 35840
  buffer_load_dwordx2 v[102:103], v44, s[80:83], s27 offen
  s_add_u32 s27, s30, 49152
  buffer_load_dwordx2 v[104:105], v44, s[80:83], s27 offen
  s_add_u32 s27, s30, 50176
  buffer_load_dwordx2 v[106:107], v44, s[80:83], s27 offen
  s_add_u32 s27, s30, 51200
  buffer_load_dwordx2 v[108:109], v44, s[80:83], s27 offen
  s_add_u32 s27, s30, 52224
  buffer_load_dwordx2 v[110:111], v44, s[80:83], s27 offen
  s_add_u32 s27, s30, 40960
  buffer_load_dwordx2 v[112:113], v44, s[80:83], s27 offen
  s_add_u32 s27, s30, 41984
  buffer_load_dwordx2 v[114:115], v44, s[80:83], s27 offen
  s_add_u32 s27, s30, 43008
  buffer_load_dwordx2 v[116:117], v44, s[80:83], s27 offen
  s_add_u32 s27, s30, 44032
  buffer_load_dwordx2 v[118:119], v44, s[80:83], s27 offen
  s_add_u32 s27, s30, 57344
  buffer_load_dwordx2 v[120:121], v44, s[80:83], s27 offen
  s_add_u32 s27, s30, 58368
  buffer_load_dwordx2 v[122:123], v44, s[80:83], s27 offen
  s_add_u32 s27, s30, 59392
  buffer_load_dwordx2 v[124:125], v44, s[80:83], s27 offen
  s_add_u32 s27, s30, 60416
  buffer_load_dwordx2 v[126:127], v44, s[80:83], s27 offen
  s_load_dwordx2 s[4:5], s[0:1], 112
  s_load_dwordx2 s[12:13], s[0:1], 104
  s_load_dwordx2 s[68:69], s[0:1], 96
  s_load_dwordx2 s[8:9], s[0:1], 64
  s_waitcnt lgkmcnt(0)
  buffer_load_dwordx4 v[56:59], v0, s[8:11], 0 offen
  s_lshl_b32 s29, s77, 10
  s_add_u32 s29, s29, 6291456
  s_cmp_lt_u32 s60, 4
  s_cbranch_scc1 o_s1_117
  s_waitcnt vmcnt(0)
  s_branch o_s2_118
o_s1_117:
  s_waitcnt vmcnt(40)
  v_lshlrev_b32 v212, 16, v176
  v_and_b32 v213, 0xffff0000, v176
  v_lshlrev_b32 v214, 16, v177
  v_and_b32 v215, 0xffff0000, v177
  v_lshlrev_b32 v216, 16, v178
  v_and_b32 v217, 0xffff0000, v178
  v_lshlrev_b32 v218, 16, v179
  v_and_b32 v219, 0xffff0000, v179
  v_add_f32 v220, v212, v213
  v_add_f32 v221, v214, v215
  v_add_f32 v222, v216, v217
  v_add_f32 v223, v218, v219
  v_add_f32 v220, v220, v221
  v_add_f32 v222, v222, v223
  v_add_f32 v220, v220, v222
  s_nop 1
  v_add_f32_dpp v220, v220, v220 row_ror:8 row_mask:0xf bank_mask:0xf
  s_nop 1
  v_add_f32_dpp v220, v220, v220 row_ror:4 row_mask:0xf bank_mask:0xf
  s_nop 1
  v_add_f32_dpp v220, v220, v220 row_ror:2 row_mask:0xf bank_mask:0xf
  s_nop 1
  v_add_f32_dpp v220, v220, v220 row_ror:1 row_mask:0xf bank_mask:0xf
  v_mov_b32 v222, v220
  s_nop 0
  s_nop 0
  v_permlane16_swap_b32 v220, v222
  v_add_f32 v220, v220, v222
  v_mov_b32 v222, v220
  s_nop 0
  s_nop 0
  v_permlane32_swap_b32 v220, v222
  v_add_f32 v220, v220, v222
  v_mul_f32 v220, 0x3b000000, v220
  v_sub_f32 v224, v212, v220
  v_sub_f32 v225, v213, v220
  v_sub_f32 v226, v214, v220
  v_sub_f32 v227, v215, v220
  v_sub_f32 v228, v216, v220
  v_sub_f32 v229, v217, v220
  v_sub_f32 v230, v218, v220
  v_sub_f32 v231, v219, v220
  v_mul_f32 v221, v224, v224
  v_mul_f32 v222, v225, v225
  v_fmac_f32 v221, v226, v226
  v_fmac_f32 v222, v227, v227
  v_fmac_f32 v221, v228, v228
  v_fmac_f32 v222, v229, v229
  v_fmac_f32 v221, v230, v230
  v_fmac_f32 v222, v231, v231
  v_add_f32 v221, v221, v222
  v_cvt_pk_bf16_f32 v220, 0, v220
  s_nop 0
  v_add_f32_dpp v221, v221, v221 row_ror:8 row_mask:0xf bank_mask:0xf
  v_sub_f32 v224, v212, v220
  v_sub_f32 v225, v213, v220
  v_add_f32_dpp v221, v221, v221 row_ror:4 row_mask:0xf bank_mask:0xf
  v_sub_f32 v226, v214, v220
  v_sub_f32 v227, v215, v220
  v_add_f32_dpp v221, v221, v221 row_ror:2 row_mask:0xf bank_mask:0xf
  v_sub_f32 v228, v216, v220
  v_sub_f32 v229, v217, v220
  v_add_f32_dpp v221, v221, v221 row_ror:1 row_mask:0xf bank_mask:0xf
  v_sub_f32 v230, v218, v220
  v_sub_f32 v231, v219, v220
  v_mov_b32 v222, v221
  v_cvt_pk_bf16_f32 v224, 0, v224
  v_cvt_pk_bf16_f32 v225, 0, v225
  v_permlane16_swap_b32 v221, v222
  v_cvt_pk_bf16_f32 v226, 0, v226
  v_cvt_pk_bf16_f32 v227, 0, v227
  v_add_f32 v221, v221, v222
  v_cvt_pk_bf16_f32 v228, 0, v228
  v_cvt_pk_bf16_f32 v229, 0, v229
  v_mov_b32 v222, v221
  v_cvt_pk_bf16_f32 v230, 0, v230
  v_cvt_pk_bf16_f32 v231, 0, v231
  v_permlane32_swap_b32 v221, v222
  v_add_f32 v221, v221, v222
  v_mul_f32 v221, 0x3b000000, v221
  v_cvt_pk_bf16_f32 v221, 0, v221
  v_add_f32 v221, 0x3727c5ac, v221
  v_cvt_pk_bf16_f32 v221, 0, v221
  v_sqrt_f32 v221, v221
  s_nop 0
  v_cvt_pk_bf16_f32 v221, 0, v221
  v_rcp_f32 v221, v221
  s_nop 0
  v_mul_f32 v224, v224, v221
  v_mul_f32 v225, v225, v221
  v_mul_f32 v226, v226, v221
  v_mul_f32 v227, v227, v221
  v_mul_f32 v228, v228, v221
  v_mul_f32 v229, v229, v221
  v_mul_f32 v230, v230, v221
  v_mul_f32 v231, v231, v221
  v_cvt_pk_bf16_f32 v176, v224, v225
  v_cvt_pk_bf16_f32 v177, v226, v227
  v_cvt_pk_bf16_f32 v178, v228, v229
  v_cvt_pk_bf16_f32 v179, v230, v231
  buffer_store_dwordx4 v[176:179], v0, s[4:7], s29 offen sc1
  s_add_u32 s29, s29, 262144
  s_waitcnt vmcnt(40)
  v_lshlrev_b32 v212, 16, v180
  v_and_b32 v213, 0xffff0000, v180
  v_lshlrev_b32 v214, 16, v181
  v_and_b32 v215, 0xffff0000, v181
  v_lshlrev_b32 v216, 16, v182
  v_and_b32 v217, 0xffff0000, v182
  v_lshlrev_b32 v218, 16, v183
  v_and_b32 v219, 0xffff0000, v183
  v_add_f32 v220, v212, v213
  v_add_f32 v221, v214, v215
  v_add_f32 v222, v216, v217
  v_add_f32 v223, v218, v219
  v_add_f32 v220, v220, v221
  v_add_f32 v222, v222, v223
  v_add_f32 v220, v220, v222
  s_nop 1
  v_add_f32_dpp v220, v220, v220 row_ror:8 row_mask:0xf bank_mask:0xf
  s_nop 1
  v_add_f32_dpp v220, v220, v220 row_ror:4 row_mask:0xf bank_mask:0xf
  s_nop 1
  v_add_f32_dpp v220, v220, v220 row_ror:2 row_mask:0xf bank_mask:0xf
  s_nop 1
  v_add_f32_dpp v220, v220, v220 row_ror:1 row_mask:0xf bank_mask:0xf
  v_mov_b32 v222, v220
  s_nop 0
  s_nop 0
  v_permlane16_swap_b32 v220, v222
  v_add_f32 v220, v220, v222
  v_mov_b32 v222, v220
  s_nop 0
  s_nop 0
  v_permlane32_swap_b32 v220, v222
  v_add_f32 v220, v220, v222
  v_mul_f32 v220, 0x3b000000, v220
  v_sub_f32 v224, v212, v220
  v_sub_f32 v225, v213, v220
  v_sub_f32 v226, v214, v220
  v_sub_f32 v227, v215, v220
  v_sub_f32 v228, v216, v220
  v_sub_f32 v229, v217, v220
  v_sub_f32 v230, v218, v220
  v_sub_f32 v231, v219, v220
  v_mul_f32 v221, v224, v224
  v_mul_f32 v222, v225, v225
  v_fmac_f32 v221, v226, v226
  v_fmac_f32 v222, v227, v227
  v_fmac_f32 v221, v228, v228
  v_fmac_f32 v222, v229, v229
  v_fmac_f32 v221, v230, v230
  v_fmac_f32 v222, v231, v231
  v_add_f32 v221, v221, v222
  v_cvt_pk_bf16_f32 v220, 0, v220
  s_nop 0
  v_add_f32_dpp v221, v221, v221 row_ror:8 row_mask:0xf bank_mask:0xf
  v_sub_f32 v224, v212, v220
  v_sub_f32 v225, v213, v220
  v_add_f32_dpp v221, v221, v221 row_ror:4 row_mask:0xf bank_mask:0xf
  v_sub_f32 v226, v214, v220
  v_sub_f32 v227, v215, v220
  v_add_f32_dpp v221, v221, v221 row_ror:2 row_mask:0xf bank_mask:0xf
  v_sub_f32 v228, v216, v220
  v_sub_f32 v229, v217, v220
  v_add_f32_dpp v221, v221, v221 row_ror:1 row_mask:0xf bank_mask:0xf
  v_sub_f32 v230, v218, v220
  v_sub_f32 v231, v219, v220
  v_mov_b32 v222, v221
  v_cvt_pk_bf16_f32 v224, 0, v224
  v_cvt_pk_bf16_f32 v225, 0, v225
  v_permlane16_swap_b32 v221, v222
  v_cvt_pk_bf16_f32 v226, 0, v226
  v_cvt_pk_bf16_f32 v227, 0, v227
  v_add_f32 v221, v221, v222
  v_cvt_pk_bf16_f32 v228, 0, v228
  v_cvt_pk_bf16_f32 v229, 0, v229
  v_mov_b32 v222, v221
  v_cvt_pk_bf16_f32 v230, 0, v230
  v_cvt_pk_bf16_f32 v231, 0, v231
  v_permlane32_swap_b32 v221, v222
  v_add_f32 v221, v221, v222
  v_mul_f32 v221, 0x3b000000, v221
  v_cvt_pk_bf16_f32 v221, 0, v221
  v_add_f32 v221, 0x3727c5ac, v221
  v_cvt_pk_bf16_f32 v221, 0, v221
  v_sqrt_f32 v221, v221
  s_nop 0
  v_cvt_pk_bf16_f32 v221, 0, v221
  v_rcp_f32 v221, v221
  s_nop 0
  v_mul_f32 v224, v224, v221
  v_mul_f32 v225, v225, v221
  v_mul_f32 v226, v226, v221
  v_mul_f32 v227, v227, v221
  v_mul_f32 v228, v228, v221
  v_mul_f32 v229, v229, v221
  v_mul_f32 v230, v230, v221
  v_mul_f32 v231, v231, v221
  v_cvt_pk_bf16_f32 v180, v224, v225
  v_cvt_pk_bf16_f32 v181, v226, v227
  v_cvt_pk_bf16_f32 v182, v228, v229
  v_cvt_pk_bf16_f32 v183, v230, v231
  buffer_store_dwordx4 v[180:183], v0, s[4:7], s29 offen sc1
  s_add_u32 s29, s29, 262144
  s_waitcnt vmcnt(40)
  v_lshlrev_b32 v212, 16, v184
  v_and_b32 v213, 0xffff0000, v184
  v_lshlrev_b32 v214, 16, v185
  v_and_b32 v215, 0xffff0000, v185
  v_lshlrev_b32 v216, 16, v186
  v_and_b32 v217, 0xffff0000, v186
  v_lshlrev_b32 v218, 16, v187
  v_and_b32 v219, 0xffff0000, v187
  v_add_f32 v220, v212, v213
  v_add_f32 v221, v214, v215
  v_add_f32 v222, v216, v217
  v_add_f32 v223, v218, v219
  v_add_f32 v220, v220, v221
  v_add_f32 v222, v222, v223
  v_add_f32 v220, v220, v222
  s_nop 1
  v_add_f32_dpp v220, v220, v220 row_ror:8 row_mask:0xf bank_mask:0xf
  s_nop 1
  v_add_f32_dpp v220, v220, v220 row_ror:4 row_mask:0xf bank_mask:0xf
  s_nop 1
  v_add_f32_dpp v220, v220, v220 row_ror:2 row_mask:0xf bank_mask:0xf
  s_nop 1
  v_add_f32_dpp v220, v220, v220 row_ror:1 row_mask:0xf bank_mask:0xf
  v_mov_b32 v222, v220
  s_nop 0
  s_nop 0
  v_permlane16_swap_b32 v220, v222
  v_add_f32 v220, v220, v222
  v_mov_b32 v222, v220
  s_nop 0
  s_nop 0
  v_permlane32_swap_b32 v220, v222
  v_add_f32 v220, v220, v222
  v_mul_f32 v220, 0x3b000000, v220
  v_sub_f32 v224, v212, v220
  v_sub_f32 v225, v213, v220
  v_sub_f32 v226, v214, v220
  v_sub_f32 v227, v215, v220
  v_sub_f32 v228, v216, v220
  v_sub_f32 v229, v217, v220
  v_sub_f32 v230, v218, v220
  v_sub_f32 v231, v219, v220
  v_mul_f32 v221, v224, v224
  v_mul_f32 v222, v225, v225
  v_fmac_f32 v221, v226, v226
  v_fmac_f32 v222, v227, v227
  v_fmac_f32 v221, v228, v228
  v_fmac_f32 v222, v229, v229
  v_fmac_f32 v221, v230, v230
  v_fmac_f32 v222, v231, v231
  v_add_f32 v221, v221, v222
  v_cvt_pk_bf16_f32 v220, 0, v220
  s_nop 0
  v_add_f32_dpp v221, v221, v221 row_ror:8 row_mask:0xf bank_mask:0xf
  v_sub_f32 v224, v212, v220
  v_sub_f32 v225, v213, v220
  v_add_f32_dpp v221, v221, v221 row_ror:4 row_mask:0xf bank_mask:0xf
  v_sub_f32 v226, v214, v220
  v_sub_f32 v227, v215, v220
  v_add_f32_dpp v221, v221, v221 row_ror:2 row_mask:0xf bank_mask:0xf
  v_sub_f32 v228, v216, v220
  v_sub_f32 v229, v217, v220
  v_add_f32_dpp v221, v221, v221 row_ror:1 row_mask:0xf bank_mask:0xf
  v_sub_f32 v230, v218, v220
  v_sub_f32 v231, v219, v220
  v_mov_b32 v222, v221
  v_cvt_pk_bf16_f32 v224, 0, v224
  v_cvt_pk_bf16_f32 v225, 0, v225
  v_permlane16_swap_b32 v221, v222
  v_cvt_pk_bf16_f32 v226, 0, v226
  v_cvt_pk_bf16_f32 v227, 0, v227
  v_add_f32 v221, v221, v222
  v_cvt_pk_bf16_f32 v228, 0, v228
  v_cvt_pk_bf16_f32 v229, 0, v229
  v_mov_b32 v222, v221
  v_cvt_pk_bf16_f32 v230, 0, v230
  v_cvt_pk_bf16_f32 v231, 0, v231
  v_permlane32_swap_b32 v221, v222
  v_add_f32 v221, v221, v222
  v_mul_f32 v221, 0x3b000000, v221
  v_cvt_pk_bf16_f32 v221, 0, v221
  v_add_f32 v221, 0x3727c5ac, v221
  v_cvt_pk_bf16_f32 v221, 0, v221
  v_sqrt_f32 v221, v221
  s_nop 0
  v_cvt_pk_bf16_f32 v221, 0, v221
  v_rcp_f32 v221, v221
  s_nop 0
  v_mul_f32 v224, v224, v221
  v_mul_f32 v225, v225, v221
  v_mul_f32 v226, v226, v221
  v_mul_f32 v227, v227, v221
  v_mul_f32 v228, v228, v221
  v_mul_f32 v229, v229, v221
  v_mul_f32 v230, v230, v221
  v_mul_f32 v231, v231, v221
  v_cvt_pk_bf16_f32 v184, v224, v225
  v_cvt_pk_bf16_f32 v185, v226, v227
  v_cvt_pk_bf16_f32 v186, v228, v229
  v_cvt_pk_bf16_f32 v187, v230, v231
  buffer_store_dwordx4 v[184:187], v0, s[4:7], s29 offen sc1
  s_add_u32 s29, s29, 262144
  s_waitcnt vmcnt(40)
  v_lshlrev_b32 v212, 16, v188
  v_and_b32 v213, 0xffff0000, v188
  v_lshlrev_b32 v214, 16, v189
  v_and_b32 v215, 0xffff0000, v189
  v_lshlrev_b32 v216, 16, v190
  v_and_b32 v217, 0xffff0000, v190
  v_lshlrev_b32 v218, 16, v191
  v_and_b32 v219, 0xffff0000, v191
  v_add_f32 v220, v212, v213
  v_add_f32 v221, v214, v215
  v_add_f32 v222, v216, v217
  v_add_f32 v223, v218, v219
  v_add_f32 v220, v220, v221
  v_add_f32 v222, v222, v223
  v_add_f32 v220, v220, v222
  s_nop 1
  v_add_f32_dpp v220, v220, v220 row_ror:8 row_mask:0xf bank_mask:0xf
  s_nop 1
  v_add_f32_dpp v220, v220, v220 row_ror:4 row_mask:0xf bank_mask:0xf
  s_nop 1
  v_add_f32_dpp v220, v220, v220 row_ror:2 row_mask:0xf bank_mask:0xf
  s_nop 1
  v_add_f32_dpp v220, v220, v220 row_ror:1 row_mask:0xf bank_mask:0xf
  v_mov_b32 v222, v220
  s_nop 0
  s_nop 0
  v_permlane16_swap_b32 v220, v222
  v_add_f32 v220, v220, v222
  v_mov_b32 v222, v220
  s_nop 0
  s_nop 0
  v_permlane32_swap_b32 v220, v222
  v_add_f32 v220, v220, v222
  v_mul_f32 v220, 0x3b000000, v220
  v_sub_f32 v224, v212, v220
  v_sub_f32 v225, v213, v220
  v_sub_f32 v226, v214, v220
  v_sub_f32 v227, v215, v220
  v_sub_f32 v228, v216, v220
  v_sub_f32 v229, v217, v220
  v_sub_f32 v230, v218, v220
  v_sub_f32 v231, v219, v220
  v_mul_f32 v221, v224, v224
  v_mul_f32 v222, v225, v225
  v_fmac_f32 v221, v226, v226
  v_fmac_f32 v222, v227, v227
  v_fmac_f32 v221, v228, v228
  v_fmac_f32 v222, v229, v229
  v_fmac_f32 v221, v230, v230
  v_fmac_f32 v222, v231, v231
  v_add_f32 v221, v221, v222
  v_cvt_pk_bf16_f32 v220, 0, v220
  s_nop 0
  v_add_f32_dpp v221, v221, v221 row_ror:8 row_mask:0xf bank_mask:0xf
  v_sub_f32 v224, v212, v220
  v_sub_f32 v225, v213, v220
  v_add_f32_dpp v221, v221, v221 row_ror:4 row_mask:0xf bank_mask:0xf
  v_sub_f32 v226, v214, v220
  v_sub_f32 v227, v215, v220
  v_add_f32_dpp v221, v221, v221 row_ror:2 row_mask:0xf bank_mask:0xf
  v_sub_f32 v228, v216, v220
  v_sub_f32 v229, v217, v220
  v_add_f32_dpp v221, v221, v221 row_ror:1 row_mask:0xf bank_mask:0xf
  v_sub_f32 v230, v218, v220
  v_sub_f32 v231, v219, v220
  v_mov_b32 v222, v221
  v_cvt_pk_bf16_f32 v224, 0, v224
  v_cvt_pk_bf16_f32 v225, 0, v225
  v_permlane16_swap_b32 v221, v222
  v_cvt_pk_bf16_f32 v226, 0, v226
  v_cvt_pk_bf16_f32 v227, 0, v227
  v_add_f32 v221, v221, v222
  v_cvt_pk_bf16_f32 v228, 0, v228
  v_cvt_pk_bf16_f32 v229, 0, v229
  v_mov_b32 v222, v221
  v_cvt_pk_bf16_f32 v230, 0, v230
  v_cvt_pk_bf16_f32 v231, 0, v231
  v_permlane32_swap_b32 v221, v222
  v_add_f32 v221, v221, v222
  v_mul_f32 v221, 0x3b000000, v221
  v_cvt_pk_bf16_f32 v221, 0, v221
  v_add_f32 v221, 0x3727c5ac, v221
  v_cvt_pk_bf16_f32 v221, 0, v221
  v_sqrt_f32 v221, v221
  s_nop 0
  v_cvt_pk_bf16_f32 v221, 0, v221
  v_rcp_f32 v221, v221
  s_nop 0
  v_mul_f32 v224, v224, v221
  v_mul_f32 v225, v225, v221
  v_mul_f32 v226, v226, v221
  v_mul_f32 v227, v227, v221
  v_mul_f32 v228, v228, v221
  v_mul_f32 v229, v229, v221
  v_mul_f32 v230, v230, v221
  v_mul_f32 v231, v231, v221
  v_cvt_pk_bf16_f32 v188, v224, v225
  v_cvt_pk_bf16_f32 v189, v226, v227
  v_cvt_pk_bf16_f32 v190, v228, v229
  v_cvt_pk_bf16_f32 v191, v230, v231
  buffer_store_dwordx4 v[188:191], v0, s[4:7], s29 offen sc1
  s_add_u32 s29, s29, 262144
  s_waitcnt vmcnt(40)
  v_lshlrev_b32 v212, 16, v192
  v_and_b32 v213, 0xffff0000, v192
  v_lshlrev_b32 v214, 16, v193
  v_and_b32 v215, 0xffff0000, v193
  v_lshlrev_b32 v216, 16, v194
  v_and_b32 v217, 0xffff0000, v194
  v_lshlrev_b32 v218, 16, v195
  v_and_b32 v219, 0xffff0000, v195
  v_add_f32 v220, v212, v213
  v_add_f32 v221, v214, v215
  v_add_f32 v222, v216, v217
  v_add_f32 v223, v218, v219
  v_add_f32 v220, v220, v221
  v_add_f32 v222, v222, v223
  v_add_f32 v220, v220, v222
  s_nop 1
  v_add_f32_dpp v220, v220, v220 row_ror:8 row_mask:0xf bank_mask:0xf
  s_nop 1
  v_add_f32_dpp v220, v220, v220 row_ror:4 row_mask:0xf bank_mask:0xf
  s_nop 1
  v_add_f32_dpp v220, v220, v220 row_ror:2 row_mask:0xf bank_mask:0xf
  s_nop 1
  v_add_f32_dpp v220, v220, v220 row_ror:1 row_mask:0xf bank_mask:0xf
  v_mov_b32 v222, v220
  s_nop 0
  s_nop 0
  v_permlane16_swap_b32 v220, v222
  v_add_f32 v220, v220, v222
  v_mov_b32 v222, v220
  s_nop 0
  s_nop 0
  v_permlane32_swap_b32 v220, v222
  v_add_f32 v220, v220, v222
  v_mul_f32 v220, 0x3b000000, v220
  v_sub_f32 v224, v212, v220
  v_sub_f32 v225, v213, v220
  v_sub_f32 v226, v214, v220
  v_sub_f32 v227, v215, v220
  v_sub_f32 v228, v216, v220
  v_sub_f32 v229, v217, v220
  v_sub_f32 v230, v218, v220
  v_sub_f32 v231, v219, v220
  v_mul_f32 v221, v224, v224
  v_mul_f32 v222, v225, v225
  v_fmac_f32 v221, v226, v226
  v_fmac_f32 v222, v227, v227
  v_fmac_f32 v221, v228, v228
  v_fmac_f32 v222, v229, v229
  v_fmac_f32 v221, v230, v230
  v_fmac_f32 v222, v231, v231
  v_add_f32 v221, v221, v222
  v_cvt_pk_bf16_f32 v220, 0, v220
  s_nop 0
  v_add_f32_dpp v221, v221, v221 row_ror:8 row_mask:0xf bank_mask:0xf
  v_sub_f32 v224, v212, v220
  v_sub_f32 v225, v213, v220
  v_add_f32_dpp v221, v221, v221 row_ror:4 row_mask:0xf bank_mask:0xf
  v_sub_f32 v226, v214, v220
  v_sub_f32 v227, v215, v220
  v_add_f32_dpp v221, v221, v221 row_ror:2 row_mask:0xf bank_mask:0xf
  v_sub_f32 v228, v216, v220
  v_sub_f32 v229, v217, v220
  v_add_f32_dpp v221, v221, v221 row_ror:1 row_mask:0xf bank_mask:0xf
  v_sub_f32 v230, v218, v220
  v_sub_f32 v231, v219, v220
  v_mov_b32 v222, v221
  v_cvt_pk_bf16_f32 v224, 0, v224
  v_cvt_pk_bf16_f32 v225, 0, v225
  v_permlane16_swap_b32 v221, v222
  v_cvt_pk_bf16_f32 v226, 0, v226
  v_cvt_pk_bf16_f32 v227, 0, v227
  v_add_f32 v221, v221, v222
  v_cvt_pk_bf16_f32 v228, 0, v228
  v_cvt_pk_bf16_f32 v229, 0, v229
  v_mov_b32 v222, v221
  v_cvt_pk_bf16_f32 v230, 0, v230
  v_cvt_pk_bf16_f32 v231, 0, v231
  v_permlane32_swap_b32 v221, v222
  v_add_f32 v221, v221, v222
  v_mul_f32 v221, 0x3b000000, v221
  v_cvt_pk_bf16_f32 v221, 0, v221
  v_add_f32 v221, 0x3727c5ac, v221
  v_cvt_pk_bf16_f32 v221, 0, v221
  v_sqrt_f32 v221, v221
  s_nop 0
  v_cvt_pk_bf16_f32 v221, 0, v221
  v_rcp_f32 v221, v221
  s_nop 0
  v_mul_f32 v224, v224, v221
  v_mul_f32 v225, v225, v221
  v_mul_f32 v226, v226, v221
  v_mul_f32 v227, v227, v221
  v_mul_f32 v228, v228, v221
  v_mul_f32 v229, v229, v221
  v_mul_f32 v230, v230, v221
  v_mul_f32 v231, v231, v221
  v_cvt_pk_bf16_f32 v192, v224, v225
  v_cvt_pk_bf16_f32 v193, v226, v227
  v_cvt_pk_bf16_f32 v194, v228, v229
  v_cvt_pk_bf16_f32 v195, v230, v231
  buffer_store_dwordx4 v[192:195], v0, s[4:7], s29 offen sc1
  s_add_u32 s29, s29, 262144
  s_waitcnt vmcnt(40)
  v_lshlrev_b32 v212, 16, v196
  v_and_b32 v213, 0xffff0000, v196
  v_lshlrev_b32 v214, 16, v197
  v_and_b32 v215, 0xffff0000, v197
  v_lshlrev_b32 v216, 16, v198
  v_and_b32 v217, 0xffff0000, v198
  v_lshlrev_b32 v218, 16, v199
  v_and_b32 v219, 0xffff0000, v199
  v_add_f32 v220, v212, v213
  v_add_f32 v221, v214, v215
  v_add_f32 v222, v216, v217
  v_add_f32 v223, v218, v219
  v_add_f32 v220, v220, v221
  v_add_f32 v222, v222, v223
  v_add_f32 v220, v220, v222
  s_nop 1
  v_add_f32_dpp v220, v220, v220 row_ror:8 row_mask:0xf bank_mask:0xf
  s_nop 1
  v_add_f32_dpp v220, v220, v220 row_ror:4 row_mask:0xf bank_mask:0xf
  s_nop 1
  v_add_f32_dpp v220, v220, v220 row_ror:2 row_mask:0xf bank_mask:0xf
  s_nop 1
  v_add_f32_dpp v220, v220, v220 row_ror:1 row_mask:0xf bank_mask:0xf
  v_mov_b32 v222, v220
  s_nop 0
  s_nop 0
  v_permlane16_swap_b32 v220, v222
  v_add_f32 v220, v220, v222
  v_mov_b32 v222, v220
  s_nop 0
  s_nop 0
  v_permlane32_swap_b32 v220, v222
  v_add_f32 v220, v220, v222
  v_mul_f32 v220, 0x3b000000, v220
  v_sub_f32 v224, v212, v220
  v_sub_f32 v225, v213, v220
  v_sub_f32 v226, v214, v220
  v_sub_f32 v227, v215, v220
  v_sub_f32 v228, v216, v220
  v_sub_f32 v229, v217, v220
  v_sub_f32 v230, v218, v220
  v_sub_f32 v231, v219, v220
  v_mul_f32 v221, v224, v224
  v_mul_f32 v222, v225, v225
  v_fmac_f32 v221, v226, v226
  v_fmac_f32 v222, v227, v227
  v_fmac_f32 v221, v228, v228
  v_fmac_f32 v222, v229, v229
  v_fmac_f32 v221, v230, v230
  v_fmac_f32 v222, v231, v231
  v_add_f32 v221, v221, v222
  v_cvt_pk_bf16_f32 v220, 0, v220
  s_nop 0
  v_add_f32_dpp v221, v221, v221 row_ror:8 row_mask:0xf bank_mask:0xf
  v_sub_f32 v224, v212, v220
  v_sub_f32 v225, v213, v220
  v_add_f32_dpp v221, v221, v221 row_ror:4 row_mask:0xf bank_mask:0xf
  v_sub_f32 v226, v214, v220
  v_sub_f32 v227, v215, v220
  v_add_f32_dpp v221, v221, v221 row_ror:2 row_mask:0xf bank_mask:0xf
  v_sub_f32 v228, v216, v220
  v_sub_f32 v229, v217, v220
  v_add_f32_dpp v221, v221, v221 row_ror:1 row_mask:0xf bank_mask:0xf
  v_sub_f32 v230, v218, v220
  v_sub_f32 v231, v219, v220
  v_mov_b32 v222, v221
  v_cvt_pk_bf16_f32 v224, 0, v224
  v_cvt_pk_bf16_f32 v225, 0, v225
  v_permlane16_swap_b32 v221, v222
  v_cvt_pk_bf16_f32 v226, 0, v226
  v_cvt_pk_bf16_f32 v227, 0, v227
  v_add_f32 v221, v221, v222
  v_cvt_pk_bf16_f32 v228, 0, v228
  v_cvt_pk_bf16_f32 v229, 0, v229
  v_mov_b32 v222, v221
  v_cvt_pk_bf16_f32 v230, 0, v230
  v_cvt_pk_bf16_f32 v231, 0, v231
  v_permlane32_swap_b32 v221, v222
  v_add_f32 v221, v221, v222
  v_mul_f32 v221, 0x3b000000, v221
  v_cvt_pk_bf16_f32 v221, 0, v221
  v_add_f32 v221, 0x3727c5ac, v221
  v_cvt_pk_bf16_f32 v221, 0, v221
  v_sqrt_f32 v221, v221
  s_nop 0
  v_cvt_pk_bf16_f32 v221, 0, v221
  v_rcp_f32 v221, v221
  s_nop 0
  v_mul_f32 v224, v224, v221
  v_mul_f32 v225, v225, v221
  v_mul_f32 v226, v226, v221
  v_mul_f32 v227, v227, v221
  v_mul_f32 v228, v228, v221
  v_mul_f32 v229, v229, v221
  v_mul_f32 v230, v230, v221
  v_mul_f32 v231, v231, v221
  v_cvt_pk_bf16_f32 v196, v224, v225
  v_cvt_pk_bf16_f32 v197, v226, v227
  v_cvt_pk_bf16_f32 v198, v228, v229
  v_cvt_pk_bf16_f32 v199, v230, v231
  buffer_store_dwordx4 v[196:199], v0, s[4:7], s29 offen sc1
  s_add_u32 s29, s29, 262144
  s_waitcnt vmcnt(40)
  v_lshlrev_b32 v212, 16, v200
  v_and_b32 v213, 0xffff0000, v200
  v_lshlrev_b32 v214, 16, v201
  v_and_b32 v215, 0xffff0000, v201
  v_lshlrev_b32 v216, 16, v202
  v_and_b32 v217, 0xffff0000, v202
  v_lshlrev_b32 v218, 16, v203
  v_and_b32 v219, 0xffff0000, v203
  v_add_f32 v220, v212, v213
  v_add_f32 v221, v214, v215
  v_add_f32 v222, v216, v217
  v_add_f32 v223, v218, v219
  v_add_f32 v220, v220, v221
  v_add_f32 v222, v222, v223
  v_add_f32 v220, v220, v222
  s_nop 1
  v_add_f32_dpp v220, v220, v220 row_ror:8 row_mask:0xf bank_mask:0xf
  s_nop 1
  v_add_f32_dpp v220, v220, v220 row_ror:4 row_mask:0xf bank_mask:0xf
  s_nop 1
  v_add_f32_dpp v220, v220, v220 row_ror:2 row_mask:0xf bank_mask:0xf
  s_nop 1
  v_add_f32_dpp v220, v220, v220 row_ror:1 row_mask:0xf bank_mask:0xf
  v_mov_b32 v222, v220
  s_nop 0
  s_nop 0
  v_permlane16_swap_b32 v220, v222
  v_add_f32 v220, v220, v222
  v_mov_b32 v222, v220
  s_nop 0
  s_nop 0
  v_permlane32_swap_b32 v220, v222
  v_add_f32 v220, v220, v222
  v_mul_f32 v220, 0x3b000000, v220
  v_sub_f32 v224, v212, v220
  v_sub_f32 v225, v213, v220
  v_sub_f32 v226, v214, v220
  v_sub_f32 v227, v215, v220
  v_sub_f32 v228, v216, v220
  v_sub_f32 v229, v217, v220
  v_sub_f32 v230, v218, v220
  v_sub_f32 v231, v219, v220
  v_mul_f32 v221, v224, v224
  v_mul_f32 v222, v225, v225
  v_fmac_f32 v221, v226, v226
  v_fmac_f32 v222, v227, v227
  v_fmac_f32 v221, v228, v228
  v_fmac_f32 v222, v229, v229
  v_fmac_f32 v221, v230, v230
  v_fmac_f32 v222, v231, v231
  v_add_f32 v221, v221, v222
  v_cvt_pk_bf16_f32 v220, 0, v220
  s_nop 0
  v_add_f32_dpp v221, v221, v221 row_ror:8 row_mask:0xf bank_mask:0xf
  v_sub_f32 v224, v212, v220
  v_sub_f32 v225, v213, v220
  v_add_f32_dpp v221, v221, v221 row_ror:4 row_mask:0xf bank_mask:0xf
  v_sub_f32 v226, v214, v220
  v_sub_f32 v227, v215, v220
  v_add_f32_dpp v221, v221, v221 row_ror:2 row_mask:0xf bank_mask:0xf
  v_sub_f32 v228, v216, v220
  v_sub_f32 v229, v217, v220
  v_add_f32_dpp v221, v221, v221 row_ror:1 row_mask:0xf bank_mask:0xf
  v_sub_f32 v230, v218, v220
  v_sub_f32 v231, v219, v220
  v_mov_b32 v222, v221
  v_cvt_pk_bf16_f32 v224, 0, v224
  v_cvt_pk_bf16_f32 v225, 0, v225
  v_permlane16_swap_b32 v221, v222
  v_cvt_pk_bf16_f32 v226, 0, v226
  v_cvt_pk_bf16_f32 v227, 0, v227
  v_add_f32 v221, v221, v222
  v_cvt_pk_bf16_f32 v228, 0, v228
  v_cvt_pk_bf16_f32 v229, 0, v229
  v_mov_b32 v222, v221
  v_cvt_pk_bf16_f32 v230, 0, v230
  v_cvt_pk_bf16_f32 v231, 0, v231
  v_permlane32_swap_b32 v221, v222
  v_add_f32 v221, v221, v222
  v_mul_f32 v221, 0x3b000000, v221
  v_cvt_pk_bf16_f32 v221, 0, v221
  v_add_f32 v221, 0x3727c5ac, v221
  v_cvt_pk_bf16_f32 v221, 0, v221
  v_sqrt_f32 v221, v221
  s_nop 0
  v_cvt_pk_bf16_f32 v221, 0, v221
  v_rcp_f32 v221, v221
  s_nop 0
  v_mul_f32 v224, v224, v221
  v_mul_f32 v225, v225, v221
  v_mul_f32 v226, v226, v221
  v_mul_f32 v227, v227, v221
  v_mul_f32 v228, v228, v221
  v_mul_f32 v229, v229, v221
  v_mul_f32 v230, v230, v221
  v_mul_f32 v231, v231, v221
  v_cvt_pk_bf16_f32 v200, v224, v225
  v_cvt_pk_bf16_f32 v201, v226, v227
  v_cvt_pk_bf16_f32 v202, v228, v229
  v_cvt_pk_bf16_f32 v203, v230, v231
  buffer_store_dwordx4 v[200:203], v0, s[4:7], s29 offen sc1
  s_add_u32 s29, s29, 262144
  s_waitcnt vmcnt(40)
  v_lshlrev_b32 v212, 16, v204
  v_and_b32 v213, 0xffff0000, v204
  v_lshlrev_b32 v214, 16, v205
  v_and_b32 v215, 0xffff0000, v205
  v_lshlrev_b32 v216, 16, v206
  v_and_b32 v217, 0xffff0000, v206
  v_lshlrev_b32 v218, 16, v207
  v_and_b32 v219, 0xffff0000, v207
  v_add_f32 v220, v212, v213
  v_add_f32 v221, v214, v215
  v_add_f32 v222, v216, v217
  v_add_f32 v223, v218, v219
  v_add_f32 v220, v220, v221
  v_add_f32 v222, v222, v223
  v_add_f32 v220, v220, v222
  s_nop 1
  v_add_f32_dpp v220, v220, v220 row_ror:8 row_mask:0xf bank_mask:0xf
  s_nop 1
  v_add_f32_dpp v220, v220, v220 row_ror:4 row_mask:0xf bank_mask:0xf
  s_nop 1
  v_add_f32_dpp v220, v220, v220 row_ror:2 row_mask:0xf bank_mask:0xf
  s_nop 1
  v_add_f32_dpp v220, v220, v220 row_ror:1 row_mask:0xf bank_mask:0xf
  v_mov_b32 v222, v220
  s_nop 0
  s_nop 0
  v_permlane16_swap_b32 v220, v222
  v_add_f32 v220, v220, v222
  v_mov_b32 v222, v220
  s_nop 0
  s_nop 0
  v_permlane32_swap_b32 v220, v222
  v_add_f32 v220, v220, v222
  v_mul_f32 v220, 0x3b000000, v220
  v_sub_f32 v224, v212, v220
  v_sub_f32 v225, v213, v220
  v_sub_f32 v226, v214, v220
  v_sub_f32 v227, v215, v220
  v_sub_f32 v228, v216, v220
  v_sub_f32 v229, v217, v220
  v_sub_f32 v230, v218, v220
  v_sub_f32 v231, v219, v220
  v_mul_f32 v221, v224, v224
  v_mul_f32 v222, v225, v225
  v_fmac_f32 v221, v226, v226
  v_fmac_f32 v222, v227, v227
  v_fmac_f32 v221, v228, v228
  v_fmac_f32 v222, v229, v229
  v_fmac_f32 v221, v230, v230
  v_fmac_f32 v222, v231, v231
  v_add_f32 v221, v221, v222
  v_cvt_pk_bf16_f32 v220, 0, v220
  s_nop 0
  v_add_f32_dpp v221, v221, v221 row_ror:8 row_mask:0xf bank_mask:0xf
  v_sub_f32 v224, v212, v220
  v_sub_f32 v225, v213, v220
  v_add_f32_dpp v221, v221, v221 row_ror:4 row_mask:0xf bank_mask:0xf
  v_sub_f32 v226, v214, v220
  v_sub_f32 v227, v215, v220
  v_add_f32_dpp v221, v221, v221 row_ror:2 row_mask:0xf bank_mask:0xf
  v_sub_f32 v228, v216, v220
  v_sub_f32 v229, v217, v220
  v_add_f32_dpp v221, v221, v221 row_ror:1 row_mask:0xf bank_mask:0xf
  v_sub_f32 v230, v218, v220
  v_sub_f32 v231, v219, v220
  v_mov_b32 v222, v221
  v_cvt_pk_bf16_f32 v224, 0, v224
  v_cvt_pk_bf16_f32 v225, 0, v225
  v_permlane16_swap_b32 v221, v222
  v_cvt_pk_bf16_f32 v226, 0, v226
  v_cvt_pk_bf16_f32 v227, 0, v227
  v_add_f32 v221, v221, v222
  v_cvt_pk_bf16_f32 v228, 0, v228
  v_cvt_pk_bf16_f32 v229, 0, v229
  v_mov_b32 v222, v221
  v_cvt_pk_bf16_f32 v230, 0, v230
  v_cvt_pk_bf16_f32 v231, 0, v231
  v_permlane32_swap_b32 v221, v222
  v_add_f32 v221, v221, v222
  v_mul_f32 v221, 0x3b000000, v221
  v_cvt_pk_bf16_f32 v221, 0, v221
  v_add_f32 v221, 0x3727c5ac, v221
  v_cvt_pk_bf16_f32 v221, 0, v221
  v_sqrt_f32 v221, v221
  s_nop 0
  v_cvt_pk_bf16_f32 v221, 0, v221
  v_rcp_f32 v221, v221
  s_nop 0
  v_mul_f32 v224, v224, v221
  v_mul_f32 v225, v225, v221
  v_mul_f32 v226, v226, v221
  v_mul_f32 v227, v227, v221
  v_mul_f32 v228, v228, v221
  v_mul_f32 v229, v229, v221
  v_mul_f32 v230, v230, v221
  v_mul_f32 v231, v231, v221
  v_cvt_pk_bf16_f32 v204, v224, v225
  v_cvt_pk_bf16_f32 v205, v226, v227
  v_cvt_pk_bf16_f32 v206, v228, v229
  v_cvt_pk_bf16_f32 v207, v230, v231
  buffer_store_dwordx4 v[204:207], v0, s[4:7], s29 offen sc1
  s_add_u32 s29, s29, 262144
o_s2_118:
  s_waitcnt vmcnt(33)
  v_perm_b32 v48, v66, v64, s44
  v_perm_b32 v49, v70, v68, s44
  v_perm_b32 v50, v74, v72, s44
  v_perm_b32 v51, v78, v76, s44
  v_accvgpr_write_b32 a0, v48
  v_accvgpr_write_b32 a1, v49
  v_accvgpr_write_b32 a2, v50
  v_accvgpr_write_b32 a3, v51
  v_perm_b32 v52, v66, v64, s45
  v_perm_b32 v53, v70, v68, s45
  v_perm_b32 v54, v74, v72, s45
  v_perm_b32 v55, v78, v76, s45
  v_accvgpr_write_b32 a4, v52
  v_accvgpr_write_b32 a5, v53
  v_accvgpr_write_b32 a6, v54
  v_accvgpr_write_b32 a7, v55
  v_perm_b32 v48, v67, v65, s44
  v_perm_b32 v49, v71, v69, s44
  v_perm_b32 v50, v75, v73, s44
  v_perm_b32 v51, v79, v77, s44
  v_accvgpr_write_b32 a8, v48
  v_accvgpr_write_b32 a9, v49
  v_accvgpr_write_b32 a10, v50
  v_accvgpr_write_b32 a11, v51
  v_perm_b32 v52, v67, v65, s45
  v_perm_b32 v53, v71, v69, s45
  v_perm_b32 v54, v75, v73, s45
  v_perm_b32 v55, v79, v77, s45
  v_accvgpr_write_b32 a12, v52
  v_accvgpr_write_b32 a13, v53
  v_accvgpr_write_b32 a14, v54
  v_accvgpr_write_b32 a15, v55
  s_waitcnt vmcnt(25)
  v_perm_b32 v48, v82, v80, s44
  v_perm_b32 v49, v86, v84, s44
  v_perm_b32 v50, v90, v88, s44
  v_perm_b32 v51, v94, v92, s44
  v_accvgpr_write_b32 a16, v48
  v_accvgpr_write_b32 a17, v49
  v_accvgpr_write_b32 a18, v50
  v_accvgpr_write_b32 a19, v51
  v_perm_b32 v52, v82, v80, s45
  v_perm_b32 v53, v86, v84, s45
  v_perm_b32 v54, v90, v88, s45
  v_perm_b32 v55, v94, v92, s45
  v_accvgpr_write_b32 a20, v52
  v_accvgpr_write_b32 a21, v53
  v_accvgpr_write_b32 a22, v54
  v_accvgpr_write_b32 a23, v55
  v_perm_b32 v48, v83, v81, s44
  v_perm_b32 v49, v87, v85, s44
  v_perm_b32 v50, v91, v89, s44
  v_perm_b32 v51, v95, v93, s44
  v_accvgpr_write_b32 a24, v48
  v_accvgpr_write_b32 a25, v49
  v_accvgpr_write_b32 a26, v50
  v_accvgpr_write_b32 a27, v51
  v_perm_b32 v52, v83, v81, s45
  v_perm_b32 v53, v87, v85, s45
  v_perm_b32 v54, v91, v89, s45
  v_perm_b32 v55, v95, v93, s45
  v_accvgpr_write_b32 a28, v52
  v_accvgpr_write_b32 a29, v53
  v_accvgpr_write_b32 a30, v54
  v_accvgpr_write_b32 a31, v55
  s_waitcnt vmcnt(17)
  v_perm_b32 v48, v98, v96, s44
  v_perm_b32 v49, v102, v100, s44
  v_perm_b32 v50, v106, v104, s44
  v_perm_b32 v51, v110, v108, s44
  v_accvgpr_write_b32 a32, v48
  v_accvgpr_write_b32 a33, v49
  v_accvgpr_write_b32 a34, v50
  v_accvgpr_write_b32 a35, v51
  v_perm_b32 v52, v98, v96, s45
  v_perm_b32 v53, v102, v100, s45
  v_perm_b32 v54, v106, v104, s45
  v_perm_b32 v55, v110, v108, s45
  v_accvgpr_write_b32 a36, v52
  v_accvgpr_write_b32 a37, v53
  v_accvgpr_write_b32 a38, v54
  v_accvgpr_write_b32 a39, v55
  v_perm_b32 v48, v99, v97, s44
  v_perm_b32 v49, v103, v101, s44
  v_perm_b32 v50, v107, v105, s44
  v_perm_b32 v51, v111, v109, s44
  v_accvgpr_write_b32 a40, v48
  v_accvgpr_write_b32 a41, v49
  v_accvgpr_write_b32 a42, v50
  v_accvgpr_write_b32 a43, v51
  v_perm_b32 v52, v99, v97, s45
  v_perm_b32 v53, v103, v101, s45
  v_perm_b32 v54, v107, v105, s45
  v_perm_b32 v55, v111, v109, s45
  v_accvgpr_write_b32 a44, v52
  v_accvgpr_write_b32 a45, v53
  v_accvgpr_write_b32 a46, v54
  v_accvgpr_write_b32 a47, v55
  s_waitcnt vmcnt(9)
  v_perm_b32 v48, v114, v112, s44
  v_perm_b32 v49, v118, v116, s44
  v_perm_b32 v50, v122, v120, s44
  v_perm_b32 v51, v126, v124, s44
  v_accvgpr_write_b32 a48, v48
  v_accvgpr_write_b32 a49, v49
  v_accvgpr_write_b32 a50, v50
  v_accvgpr_write_b32 a51, v51
  v_perm_b32 v52, v114, v112, s45
  v_perm_b32 v53, v118, v116, s45
  v_perm_b32 v54, v122, v120, s45
  v_perm_b32 v55, v126, v124, s45
  v_accvgpr_write_b32 a52, v52
  v_accvgpr_write_b32 a53, v53
  v_accvgpr_write_b32 a54, v54
  v_accvgpr_write_b32 a55, v55
  v_perm_b32 v48, v115, v113, s44
  v_perm_b32 v49, v119, v117, s44
  v_perm_b32 v50, v123, v121, s44
  v_perm_b32 v51, v127, v125, s44
  v_accvgpr_write_b32 a56, v48
  v_accvgpr_write_b32 a57, v49
  v_accvgpr_write_b32 a58, v50
  v_accvgpr_write_b32 a59, v51
  v_perm_b32 v52, v115, v113, s45
  v_perm_b32 v53, v119, v117, s45
  v_perm_b32 v54, v123, v121, s45
  v_perm_b32 v55, v127, v125, s45
  v_accvgpr_write_b32 a60, v52
  v_accvgpr_write_b32 a61, v53
  v_accvgpr_write_b32 a62, v54
  v_accvgpr_write_b32 a63, v55
  s_cmp_ge_u32 s60, 4
  s_cbranch_scc1 o_s3_119
  v_mbcnt_lo_u32_b32 v60, -1, 0
  v_and_b32 v60, 0, v60
  v_add_lshl_u32 v60, v60, 1, 2
  s_mov_b32 s26, 0
g_wt_120:
  global_load_dword v61, v60, s[12:13] offset:128 sc1
  s_add_u32 s26, s26, 1
  s_cmp_gt_u32 s26, 1048576
  s_cbranch_scc1 L_end
  s_waitcnt vmcnt(0)
  v_cmp_eq_u32 vcc, 0, v61
  v_readfirstlane_b32 s27, v61
  s_cbranch_vccnz g_wt_120
  s_lshl_b32 s27, s77, 7
  s_add_u32 s27, s27, 243269632
  v_lshlrev_b32 v61, 11, v0
  v_mov_b32 v60, 1
  s_mov_b64 exec, 255
  buffer_store_dword v60, v61, s[4:7], s27 offen sc1
  s_mov_b64 exec, -1
o_s3_119:
  s_add_u32 s27, s30, 65536
  buffer_load_dwordx2 v[128:129], v44, s[80:83], s27 offen
  s_add_u32 s27, s30, 66560
  buffer_load_dwordx2 v[130:131], v44, s[80:83], s27 offen
  s_add_u32 s27, s30, 67584
  buffer_load_dwordx2 v[132:133], v44, s[80:83], s27 offen
  s_add_u32 s27, s30, 68608
  buffer_load_dwordx2 v[134:135], v44, s[80:83], s27 offen
  s_add_u32 s27, s30, 81920
  buffer_load_dwordx2 v[136:137], v44, s[80:83], s27 offen
  s_add_u32 s27, s30, 82944
  buffer_load_dwordx2 v[138:139], v44, s[80:83], s27 offen
  s_add_u32 s27, s30, 83968
  buffer_load_dwordx2 v[140:141], v44, s[80:83], s27 offen
  s_add_u32 s27, s30, 84992
  buffer_load_dwordx2 v[142:143], v44, s[80:83], s27 offen
  s_add_u32 s27, s30, 73728
  buffer_load_dwordx2 v[144:145], v44, s[80:83], s27 offen
  s_add_u32 s27, s30, 74752
  buffer_load_dwordx2 v[146:147], v44, s[80:83], s27 offen
  s_add_u32 s27, s30, 75776
  buffer_load_dwordx2 v[148:149], v44, s[80:83], s27 offen
  s_add_u32 s27, s30, 76800
  buffer_load_dwordx2 v[150:151], v44, s[80:83], s27 offen
  s_add_u32 s27, s30, 90112
  buffer_load_dwordx2 v[152:153], v44, s[80:83], s27 offen
  s_add_u32 s27, s30, 91136
  buffer_load_dwordx2 v[154:155], v44, s[80:83], s27 offen
  s_add_u32 s27, s30, 92160
  buffer_load_dwordx2 v[156:157], v44, s[80:83], s27 offen
  s_add_u32 s27, s30, 93184
  buffer_load_dwordx2 v[158:159], v44, s[80:83], s27 offen
  s_add_u32 s27, s30, 98304
  buffer_load_dwordx2 v[160:161], v44, s[80:83], s27 offen
  s_add_u32 s27, s30, 99328
  buffer_load_dwordx2 v[162:163], v44, s[80:83], s27 offen
  s_add_u32 s27, s30, 100352
  buffer_load_dwordx2 v[164:165], v44, s[80:83], s27 offen
  s_add_u32 s27, s30, 101376
  buffer_load_dwordx2 v[166:167], v44, s[80:83], s27 offen
  s_add_u32 s27, s30, 114688
  buffer_load_dwordx2 v[168:169], v44, s[80:83], s27 offen
  s_add_u32 s27, s30, 115712
  buffer_load_dwordx2 v[170:171], v44, s[80:83], s27 offen
  s_add_u32 s27, s30, 116736
  buffer_load_dwordx2 v[172:173], v44, s[80:83], s27 offen
  s_add_u32 s27, s30, 117760
  buffer_load_dwordx2 v[174:175], v44, s[80:83], s27 offen
  s_add_u32 s27, s30, 106496
  buffer_load_dwordx2 v[64:65], v44, s[80:83], s27 offen
  s_add_u32 s27, s30, 107520
  buffer_load_dwordx2 v[66:67], v44, s[80:83], s27 offen
  s_add_u32 s27, s30, 108544
  buffer_load_dwordx2 v[68:69], v44, s[80:83], s27 offen
  s_add_u32 s27, s30, 109568
  buffer_load_dwordx2 v[70:71], v44, s[80:83], s27 offen
  s_add_u32 s27, s30, 122880
  buffer_load_dwordx2 v[72:73], v44, s[80:83], s27 offen
  s_add_u32 s27, s30, 123904
  buffer_load_dwordx2 v[74:75], v44, s[80:83], s27 offen
  s_add_u32 s27, s30, 124928
  buffer_load_dwordx2 v[76:77], v44, s[80:83], s27 offen
  s_add_u32 s27, s30, 125952
  buffer_load_dwordx2 v[78:79], v44, s[80:83], s27 offen
  s_add_u32 s27, s30, 131072
  buffer_load_dwordx2 v[80:81], v44, s[80:83], s27 offen
  s_add_u32 s27, s30, 132096
  buffer_load_dwordx2 v[82:83], v44, s[80:83], s27 offen
  s_add_u32 s27, s30, 133120
  buffer_load_dwordx2 v[84:85], v44, s[80:83], s27 offen
  s_add_u32 s27, s30, 134144
  buffer_load_dwordx2 v[86:87], v44, s[80:83], s27 offen
  s_add_u32 s27, s30, 147456
  buffer_load_dwordx2 v[88:89], v44, s[80:83], s27 offen
  s_add_u32 s27, s30, 148480
  buffer_load_dwordx2 v[90:91], v44, s[80:83], s27 offen
  s_add_u32 s27, s30, 149504
  buffer_load_dwordx2 v[92:93], v44, s[80:83], s27 offen
  s_add_u32 s27, s30, 150528
  buffer_load_dwordx2 v[94:95], v44, s[80:83], s27 offen
  s_add_u32 s27, s30, 139264
  buffer_load_dwordx2 v[96:97], v44, s[80:83], s27 offen
  s_add_u32 s27, s30, 140288
  buffer_load_dwordx2 v[98:99], v44, s[80:83], s27 offen
  s_add_u32 s27, s30, 141312
  buffer_load_dwordx2 v[100:101], v44, s[80:83], s27 offen
  s_add_u32 s27, s30, 142336
  buffer_load_dwordx2 v[102:103], v44, s[80:83], s27 offen
  s_add_u32 s27, s30, 155648
  buffer_load_dwordx2 v[104:105], v44, s[80:83], s27 offen
  s_add_u32 s27, s30, 156672
  buffer_load_dwordx2 v[106:107], v44, s[80:83], s27 offen
  s_add_u32 s27, s30, 157696
  buffer_load_dwordx2 v[108:109], v44, s[80:83], s27 offen
  s_add_u32 s27, s30, 158720
  buffer_load_dwordx2 v[110:111], v44, s[80:83], s27 offen
  s_add_u32 s27, s30, 163840
  buffer_load_dwordx2 v[112:113], v44, s[80:83], s27 offen
  s_add_u32 s27, s30, 164864
  buffer_load_dwordx2 v[114:115], v44, s[80:83], s27 offen
  s_add_u32 s27, s30, 165888
  buffer_load_dwordx2 v[116:117], v44, s[80:83], s27 offen
  s_add_u32 s27, s30, 166912
  buffer_load_dwordx2 v[118:119], v44, s[80:83], s27 offen
  s_add_u32 s27, s30, 180224
  buffer_load_dwordx2 v[120:121], v44, s[80:83], s27 offen
  s_add_u32 s27, s30, 181248
  buffer_load_dwordx2 v[122:123], v44, s[80:83], s27 offen
  s_add_u32 s27, s30, 182272
  buffer_load_dwordx2 v[124:125], v44, s[80:83], s27 offen
  s_add_u32 s27, s30, 183296
  buffer_load_dwordx2 v[126:127], v44, s[80:83], s27 offen
  v_lshlrev_b32 v8, 16, v56
  v_and_b32 v9, 0xffff0000, v56
  v_lshlrev_b32 v10, 16, v57
  v_and_b32 v11, 0xffff0000, v57
  v_lshlrev_b32 v12, 16, v58
  v_and_b32 v13, 0xffff0000, v58
  v_lshlrev_b32 v14, 16, v59
  v_and_b32 v15, 0xffff0000, v59
  v_mul_f32 v56, v8, v8
  v_fmac_f32 v56, v9, v9
  v_fmac_f32 v56, v10, v10
  v_fmac_f32 v56, v11, v11
  v_fmac_f32 v56, v12, v12
  v_fmac_f32 v56, v13, v13
  v_fmac_f32 v56, v14, v14
  v_fmac_f32 v56, v15, v15
  s_nop 0
  s_nop 0
  v_add_f32_dpp v56, v56, v56 row_ror:8 row_mask:0xf bank_mask:0xf
  s_nop 1
  v_add_f32_dpp v56, v56, v56 row_ror:4 row_mask:0xf bank_mask:0xf
  s_nop 1
  v_add_f32_dpp v56, v56, v56 row_ror:2 row_mask:0xf bank_mask:0xf
  s_nop 1
  v_add_f32_dpp v56, v56, v56 row_ror:1 row_mask:0xf bank_mask:0xf
  v_mov_b32 v57, v56
  s_nop 0
  s_nop 0
  v_permlane16_swap_b32 v56, v57
  v_add_f32 v56, v56, v57
  v_mov_b32 v57, v56
  s_nop 0
  s_nop 0
  v_permlane32_swap_b32 v56, v57
  v_add_f32 v56, v56, v57
  v_sqrt_f32 v56, v56
  s_mov_b32 s28, 0x404d8eb7
  v_writelane_b32 v247, s28, 0
  s_mov_b32 s28, 0x404d8eb7
  v_writelane_b32 v247, s28, 1
  s_mov_b32 s28, 0x404cc30f
  v_writelane_b32 v247, s28, 2
  s_mov_b32 s28, 0x404ba22b
  v_writelane_b32 v247, s28, 3
  s_mov_b32 s28, 0x404a6ab0
  v_writelane_b32 v247, s28, 4
  s_mov_b32 s28, 0x404918ea
  v_writelane_b32 v247, s28, 5
  s_mov_b32 s28, 0x4047a82a
  v_writelane_b32 v247, s28, 6
  s_mov_b32 s28, 0x40461267
  v_writelane_b32 v247, s28, 7
  s_mov_b32 s28, 0x40444faa
  v_writelane_b32 v247, s28, 8
  s_mov_b32 s28, 0x40425526
  v_writelane_b32 v247, s28, 9
  s_mov_b32 s28, 0x404013b2
  v_writelane_b32 v247, s28, 10
  s_mov_b32 s28, 0x403d751c
  v_writelane_b32 v247, s28, 11
  s_mov_b32 s28, 0x403a570a
  v_writelane_b32 v247, s28, 12
  s_mov_b32 s28, 0x4036803f
  v_writelane_b32 v247, s28, 13
  s_mov_b32 s28, 0x403186a2
  v_writelane_b32 v247, s28, 14
  s_mov_b32 s28, 0x402a8231
  v_writelane_b32 v247, s28, 15
  s_mov_b32 s28, 0x401ec2e6
  v_writelane_b32 v247, s28, 16
  s_mov_b32 s28, 0x3ff46943
  v_writelane_b32 v247, s28, 17
  s_mov_b32 s28, 0x3ff46943
  v_writelane_b32 v247, s28, 18
  v_mul_f32 v247, v247, v56
  v_or_b32 v247, 0x80000000, v247
  s_lshl_b32 s29, s61, 2
  s_add_u32 s29, s29, s17
  s_lshl_b32 s29, s29, 13
  s_add_u32 s29, s29, s41
  s_cmp_ge_u32 s60, 4
  s_cselect_b32 s29, 268435456, s29
  v_mov_b64 v[208:209], 0
  v_mov_b64 v[210:211], 0
  s_waitcnt vmcnt(48)
  v_perm_b32 v48, v130, v128, s44
  v_perm_b32 v49, v134, v132, s44
  v_perm_b32 v50, v138, v136, s44
  v_perm_b32 v51, v142, v140, s44
  v_accvgpr_write_b32 a64, v48
  v_accvgpr_write_b32 a65, v49
  v_accvgpr_write_b32 a66, v50
  v_accvgpr_write_b32 a67, v51
  v_perm_b32 v52, v130, v128, s45
  v_perm_b32 v53, v134, v132, s45
  v_perm_b32 v54, v138, v136, s45
  v_perm_b32 v55, v142, v140, s45
  v_accvgpr_write_b32 a68, v52
  v_accvgpr_write_b32 a69, v53
  v_accvgpr_write_b32 a70, v54
  v_accvgpr_write_b32 a71, v55
  v_perm_b32 v48, v131, v129, s44
  v_perm_b32 v49, v135, v133, s44
  v_perm_b32 v50, v139, v137, s44
  v_perm_b32 v51, v143, v141, s44
  v_accvgpr_write_b32 a72, v48
  v_accvgpr_write_b32 a73, v49
  v_accvgpr_write_b32 a74, v50
  v_accvgpr_write_b32 a75, v51
  v_perm_b32 v52, v131, v129, s45
  v_perm_b32 v53, v135, v133, s45
  v_perm_b32 v54, v139, v137, s45
  v_perm_b32 v55, v143, v141, s45
  v_accvgpr_write_b32 a76, v52
  v_accvgpr_write_b32 a77, v53
  v_accvgpr_write_b32 a78, v54
  v_accvgpr_write_b32 a79, v55
  s_add_u32 s27, s30, 172032
  buffer_load_dwordx2 v[128:129], v44, s[80:83], s27 offen
  s_add_u32 s27, s30, 173056
  buffer_load_dwordx2 v[130:131], v44, s[80:83], s27 offen
  s_add_u32 s27, s30, 174080
  buffer_load_dwordx2 v[132:133], v44, s[80:83], s27 offen
  s_add_u32 s27, s30, 175104
  buffer_load_dwordx2 v[134:135], v44, s[80:83], s27 offen
  s_add_u32 s27, s30, 188416
  buffer_load_dwordx2 v[136:137], v44, s[80:83], s27 offen
  s_add_u32 s27, s30, 189440
  buffer_load_dwordx2 v[138:139], v44, s[80:83], s27 offen
  s_add_u32 s27, s30, 190464
  buffer_load_dwordx2 v[140:141], v44, s[80:83], s27 offen
  s_add_u32 s27, s30, 191488
  buffer_load_dwordx2 v[142:143], v44, s[80:83], s27 offen
  s_waitcnt vmcnt(48)
  v_perm_b32 v48, v146, v144, s44
  v_perm_b32 v49, v150, v148, s44
  v_perm_b32 v50, v154, v152, s44
  v_perm_b32 v51, v158, v156, s44
  v_accvgpr_write_b32 a80, v48
  v_accvgpr_write_b32 a81, v49
  v_accvgpr_write_b32 a82, v50
  v_accvgpr_write_b32 a83, v51
  v_perm_b32 v52, v146, v144, s45
  v_perm_b32 v53, v150, v148, s45
  v_perm_b32 v54, v154, v152, s45
  v_perm_b32 v55, v158, v156, s45
  v_accvgpr_write_b32 a84, v52
  v_accvgpr_write_b32 a85, v53
  v_accvgpr_write_b32 a86, v54
  v_accvgpr_write_b32 a87, v55
  v_perm_b32 v48, v147, v145, s44
  v_perm_b32 v49, v151, v149, s44
  v_perm_b32 v50, v155, v153, s44
  v_perm_b32 v51, v159, v157, s44
  v_accvgpr_write_b32 a88, v48
  v_accvgpr_write_b32 a89, v49
  v_accvgpr_write_b32 a90, v50
  v_accvgpr_write_b32 a91, v51
  v_perm_b32 v52, v147, v145, s45
  v_perm_b32 v53, v151, v149, s45
  v_perm_b32 v54, v155, v153, s45
  v_perm_b32 v55, v159, v157, s45
  v_accvgpr_write_b32 a92, v52
  v_accvgpr_write_b32 a93, v53
  v_accvgpr_write_b32 a94, v54
  v_accvgpr_write_b32 a95, v55
  s_add_u32 s27, s30, 196608
  buffer_load_dwordx2 v[144:145], v44, s[80:83], s27 offen
  s_add_u32 s27, s30, 197632
  buffer_load_dwordx2 v[146:147], v44, s[80:83], s27 offen
  s_add_u32 s27, s30, 198656
  buffer_load_dwordx2 v[148:149], v44, s[80:83], s27 offen
  s_add_u32 s27, s30, 199680
  buffer_load_dwordx2 v[150:151], v44, s[80:83], s27 offen
  s_add_u32 s27, s30, 212992
  buffer_load_dwordx2 v[152:153], v44, s[80:83], s27 offen
  s_add_u32 s27, s30, 214016
  buffer_load_dwordx2 v[154:155], v44, s[80:83], s27 offen
  s_add_u32 s27, s30, 215040
  buffer_load_dwordx2 v[156:157], v44, s[80:83], s27 offen
  s_add_u32 s27, s30, 216064
  buffer_load_dwordx2 v[158:159], v44, s[80:83], s27 offen
  s_waitcnt vmcnt(48)
  v_perm_b32 v48, v162, v160, s44
  v_perm_b32 v49, v166, v164, s44
  v_perm_b32 v50, v170, v168, s44
  v_perm_b32 v51, v174, v172, s44
  v_accvgpr_write_b32 a96, v48
  v_accvgpr_write_b32 a97, v49
  v_accvgpr_write_b32 a98, v50
  v_accvgpr_write_b32 a99, v51
  v_perm_b32 v52, v162, v160, s45
  v_perm_b32 v53, v166, v164, s45
  v_perm_b32 v54, v170, v168, s45
  v_perm_b32 v55, v174, v172, s45
  v_accvgpr_write_b32 a100, v52
  v_accvgpr_write_b32 a101, v53
  v_accvgpr_write_b32 a102, v54
  v_accvgpr_write_b32 a103, v55
  v_perm_b32 v48, v163, v161, s44
  v_perm_b32 v49, v167, v165, s44
  v_perm_b32 v50, v171, v169, s44
  v_perm_b32 v51, v175, v173, s44
  v_accvgpr_write_b32 a104, v48
  v_accvgpr_write_b32 a105, v49
  v_accvgpr_write_b32 a106, v50
  v_accvgpr_write_b32 a107, v51
  v_perm_b32 v52, v163, v161, s45
  v_perm_b32 v53, v167, v165, s45
  v_perm_b32 v54, v171, v169, s45
  v_perm_b32 v55, v175, v173, s45
  v_accvgpr_write_b32 a108, v52
  v_accvgpr_write_b32 a109, v53
  v_accvgpr_write_b32 a110, v54
  v_accvgpr_write_b32 a111, v55
  s_add_u32 s27, s30, 204800
  buffer_load_dwordx2 v[160:161], v44, s[80:83], s27 offen
  s_add_u32 s27, s30, 205824
  buffer_load_dwordx2 v[162:163], v44, s[80:83], s27 offen
  s_add_u32 s27, s30, 206848
  buffer_load_dwordx2 v[164:165], v44, s[80:83], s27 offen
  s_add_u32 s27, s30, 207872
  buffer_load_dwordx2 v[166:167], v44, s[80:83], s27 offen
  s_add_u32 s27, s30, 221184
  buffer_load_dwordx2 v[168:169], v44, s[80:83], s27 offen
  s_add_u32 s27, s30, 222208
  buffer_load_dwordx2 v[170:171], v44, s[80:83], s27 offen
  s_add_u32 s27, s30, 223232
  buffer_load_dwordx2 v[172:173], v44, s[80:83], s27 offen
  s_add_u32 s27, s30, 224256
  buffer_load_dwordx2 v[174:175], v44, s[80:83], s27 offen
  s_waitcnt vmcnt(48)
  v_perm_b32 v48, v66, v64, s44
  v_perm_b32 v49, v70, v68, s44
  v_perm_b32 v50, v74, v72, s44
  v_perm_b32 v51, v78, v76, s44
  v_accvgpr_write_b32 a112, v48
  v_accvgpr_write_b32 a113, v49
  v_accvgpr_write_b32 a114, v50
  v_accvgpr_write_b32 a115, v51
  v_perm_b32 v52, v66, v64, s45
  v_perm_b32 v53, v70, v68, s45
  v_perm_b32 v54, v74, v72, s45
  v_perm_b32 v55, v78, v76, s45
  v_accvgpr_write_b32 a116, v52
  v_accvgpr_write_b32 a117, v53
  v_accvgpr_write_b32 a118, v54
  v_accvgpr_write_b32 a119, v55
  v_perm_b32 v48, v67, v65, s44
  v_perm_b32 v49, v71, v69, s44
  v_perm_b32 v50, v75, v73, s44
  v_perm_b32 v51, v79, v77, s44
  v_accvgpr_write_b32 a120, v48
  v_accvgpr_write_b32 a121, v49
  v_accvgpr_write_b32 a122, v50
  v_accvgpr_write_b32 a123, v51
  v_perm_b32 v52, v67, v65, s45
  v_perm_b32 v53, v71, v69, s45
  v_perm_b32 v54, v75, v73, s45
  v_perm_b32 v55, v79, v77, s45
  v_accvgpr_write_b32 a124, v52
  v_accvgpr_write_b32 a125, v53
  v_accvgpr_write_b32 a126, v54
  v_accvgpr_write_b32 a127, v55
  s_add_u32 s27, s30, 229376
  buffer_load_dwordx2 v[64:65], v44, s[80:83], s27 offen
  s_add_u32 s27, s30, 230400
  buffer_load_dwordx2 v[66:67], v44, s[80:83], s27 offen
  s_add_u32 s27, s30, 231424
  buffer_load_dwordx2 v[68:69], v44, s[80:83], s27 offen
  s_add_u32 s27, s30, 232448
  buffer_load_dwordx2 v[70:71], v44, s[80:83], s27 offen
  s_add_u32 s27, s30, 245760
  buffer_load_dwordx2 v[72:73], v44, s[80:83], s27 offen
  s_add_u32 s27, s30, 246784
  buffer_load_dwordx2 v[74:75], v44, s[80:83], s27 offen
  s_add_u32 s27, s30, 247808
  buffer_load_dwordx2 v[76:77], v44, s[80:83], s27 offen
  s_add_u32 s27, s30, 248832
  buffer_load_dwordx2 v[78:79], v44, s[80:83], s27 offen
  s_waitcnt vmcnt(48)
  v_perm_b32 v48, v82, v80, s44
  v_perm_b32 v49, v86, v84, s44
  v_perm_b32 v50, v90, v88, s44
  v_perm_b32 v51, v94, v92, s44
  v_accvgpr_write_b32 a128, v48
  v_accvgpr_write_b32 a129, v49
  v_accvgpr_write_b32 a130, v50
  v_accvgpr_write_b32 a131, v51
  v_perm_b32 v52, v82, v80, s45
  v_perm_b32 v53, v86, v84, s45
  v_perm_b32 v54, v90, v88, s45
  v_perm_b32 v55, v94, v92, s45
  v_accvgpr_write_b32 a132, v52
  v_accvgpr_write_b32 a133, v53
  v_accvgpr_write_b32 a134, v54
  v_accvgpr_write_b32 a135, v55
  v_perm_b32 v48, v83, v81, s44
  v_perm_b32 v49, v87, v85, s44
  v_perm_b32 v50, v91, v89, s44
  v_perm_b32 v51, v95, v93, s44
  v_accvgpr_write_b32 a136, v48
  v_accvgpr_write_b32 a137, v49
  v_accvgpr_write_b32 a138, v50
  v_accvgpr_write_b32 a139, v51
  v_perm_b32 v52, v83, v81, s45
  v_perm_b32 v53, v87, v85, s45
  v_perm_b32 v54, v91, v89, s45
  v_perm_b32 v55, v95, v93, s45
  v_accvgpr_write_b32 a140, v52
  v_accvgpr_write_b32 a141, v53
  v_accvgpr_write_b32 a142, v54
  v_accvgpr_write_b32 a143, v55
  s_add_u32 s27, s30, 237568
  buffer_load_dwordx2 v[80:81], v44, s[80:83], s27 offen
  s_add_u32 s27, s30, 238592
  buffer_load_dwordx2 v[82:83], v44, s[80:83], s27 offen
  s_add_u32 s27, s30, 239616
  buffer_load_dwordx2 v[84:85], v44, s[80:83], s27 offen
  s_add_u32 s27, s30, 240640
  buffer_load_dwordx2 v[86:87], v44, s[80:83], s27 offen
  s_add_u32 s27, s30, 253952
  buffer_load_dwordx2 v[88:89], v44, s[80:83], s27 offen
  s_add_u32 s27, s30, 254976
  buffer_load_dwordx2 v[90:91], v44, s[80:83], s27 offen
  s_add_u32 s27, s30, 256000
  buffer_load_dwordx2 v[92:93], v44, s[80:83], s27 offen
  s_add_u32 s27, s30, 257024
  buffer_load_dwordx2 v[94:95], v44, s[80:83], s27 offen
  s_waitcnt vmcnt(48)
  v_perm_b32 v48, v98, v96, s44
  v_perm_b32 v49, v102, v100, s44
  v_perm_b32 v50, v106, v104, s44
  v_perm_b32 v51, v110, v108, s44
  v_accvgpr_write_b32 a144, v48
  v_accvgpr_write_b32 a145, v49
  v_accvgpr_write_b32 a146, v50
  v_accvgpr_write_b32 a147, v51
  v_perm_b32 v52, v98, v96, s45
  v_perm_b32 v53, v102, v100, s45
  v_perm_b32 v54, v106, v104, s45
  v_perm_b32 v55, v110, v108, s45
  v_accvgpr_write_b32 a148, v52
  v_accvgpr_write_b32 a149, v53
  v_accvgpr_write_b32 a150, v54
  v_accvgpr_write_b32 a151, v55
  v_perm_b32 v48, v99, v97, s44
  v_perm_b32 v49, v103, v101, s44
  v_perm_b32 v50, v107, v105, s44
  v_perm_b32 v51, v111, v109, s44
  v_accvgpr_write_b32 a152, v48
  v_accvgpr_write_b32 a153, v49
  v_accvgpr_write_b32 a154, v50
  v_accvgpr_write_b32 a155, v51
  v_perm_b32 v52, v99, v97, s45
  v_perm_b32 v53, v103, v101, s45
  v_perm_b32 v54, v107, v105, s45
  v_perm_b32 v55, v111, v109, s45
  v_accvgpr_write_b32 a156, v52
  v_accvgpr_write_b32 a157, v53
  v_accvgpr_write_b32 a158, v54
  v_accvgpr_write_b32 a159, v55
  buffer_store_dwordx4 v[208:211], v0, s[4:7], s29 offen offset:0 sc1
  buffer_store_dwordx4 v[208:211], v0, s[4:7], s29 offen offset:1024 sc1
  buffer_store_dwordx4 v[208:211], v0, s[4:7], s29 offen offset:2048 sc1
  buffer_store_dwordx4 v[208:211], v0, s[4:7], s29 offen offset:3072 sc1
  s_add_u32 s29, s29, 4096
  s_waitcnt vmcnt(44)
  v_perm_b32 v48, v114, v112, s44
  v_perm_b32 v49, v118, v116, s44
  v_perm_b32 v50, v122, v120, s44
  v_perm_b32 v51, v126, v124, s44
  v_accvgpr_write_b32 a160, v48
  v_accvgpr_write_b32 a161, v49
  v_accvgpr_write_b32 a162, v50
  v_accvgpr_write_b32 a163, v51
  v_perm_b32 v52, v114, v112, s45
  v_perm_b32 v53, v118, v116, s45
  v_perm_b32 v54, v122, v120, s45
  v_perm_b32 v55, v126, v124, s45
  v_accvgpr_write_b32 a164, v52
  v_accvgpr_write_b32 a165, v53
  v_accvgpr_write_b32 a166, v54
  v_accvgpr_write_b32 a167, v55
  v_perm_b32 v48, v115, v113, s44
  v_perm_b32 v49, v119, v117, s44
  v_perm_b32 v50, v123, v121, s44
  v_perm_b32 v51, v127, v125, s44
  v_accvgpr_write_b32 a168, v48
  v_accvgpr_write_b32 a169, v49
  v_accvgpr_write_b32 a170, v50
  v_accvgpr_write_b32 a171, v51
  v_perm_b32 v52, v115, v113, s45
  v_perm_b32 v53, v119, v117, s45
  v_perm_b32 v54, v123, v121, s45
  v_perm_b32 v55, v127, v125, s45
  v_accvgpr_write_b32 a172, v52
  v_accvgpr_write_b32 a173, v53
  v_accvgpr_write_b32 a174, v54
  v_accvgpr_write_b32 a175, v55
  buffer_store_dwordx4 v[208:211], v0, s[4:7], s29 offen offset:0 sc1
  buffer_store_dwordx4 v[208:211], v0, s[4:7], s29 offen offset:1024 sc1
  buffer_store_dwordx4 v[208:211], v0, s[4:7], s29 offen offset:2048 sc1
  buffer_store_dwordx4 v[208:211], v0, s[4:7], s29 offen offset:3072 sc1
  s_add_u32 s29, s29, 520192
  s_waitcnt vmcnt(40)
  v_perm_b32 v48, v130, v128, s44
  v_perm_b32 v49, v134, v132, s44
  v_perm_b32 v50, v138, v136, s44
  v_perm_b32 v51, v142, v140, s44
  v_accvgpr_write_b32 a176, v48
  v_accvgpr_write_b32 a177, v49
  v_accvgpr_write_b32 a178, v50
  v_accvgpr_write_b32 a179, v51
  v_perm_b32 v52, v130, v128, s45
  v_perm_b32 v53, v134, v132, s45
  v_perm_b32 v54, v138, v136, s45
  v_perm_b32 v55, v142, v140, s45
  v_accvgpr_write_b32 a180, v52
  v_accvgpr_write_b32 a181, v53
  v_accvgpr_write_b32 a182, v54
  v_accvgpr_write_b32 a183, v55
  v_perm_b32 v48, v131, v129, s44
  v_perm_b32 v49, v135, v133, s44
  v_perm_b32 v50, v139, v137, s44
  v_perm_b32 v51, v143, v141, s44
  v_accvgpr_write_b32 a184, v48
  v_accvgpr_write_b32 a185, v49
  v_accvgpr_write_b32 a186, v50
  v_accvgpr_write_b32 a187, v51
  v_perm_b32 v52, v131, v129, s45
  v_perm_b32 v53, v135, v133, s45
  v_perm_b32 v54, v139, v137, s45
  v_perm_b32 v55, v143, v141, s45
  v_accvgpr_write_b32 a188, v52
  v_accvgpr_write_b32 a189, v53
  v_accvgpr_write_b32 a190, v54
  v_accvgpr_write_b32 a191, v55
  buffer_store_dwordx4 v[208:211], v0, s[4:7], s29 offen offset:0 sc1
  buffer_store_dwordx4 v[208:211], v0, s[4:7], s29 offen offset:1024 sc1
  buffer_store_dwordx4 v[208:211], v0, s[4:7], s29 offen offset:2048 sc1
  buffer_store_dwordx4 v[208:211], v0, s[4:7], s29 offen offset:3072 sc1
  s_add_u32 s29, s29, 4096
  s_waitcnt vmcnt(36)
  v_perm_b32 v48, v146, v144, s44
  v_perm_b32 v49, v150, v148, s44
  v_perm_b32 v50, v154, v152, s44
  v_perm_b32 v51, v158, v156, s44
  v_accvgpr_write_b32 a192, v48
  v_accvgpr_write_b32 a193, v49
  v_accvgpr_write_b32 a194, v50
  v_accvgpr_write_b32 a195, v51
  v_perm_b32 v52, v146, v144, s45
  v_perm_b32 v53, v150, v148, s45
  v_perm_b32 v54, v154, v152, s45
  v_perm_b32 v55, v158, v156, s45
  v_accvgpr_write_b32 a196, v52
  v_accvgpr_write_b32 a197, v53
  v_accvgpr_write_b32 a198, v54
  v_accvgpr_write_b32 a199, v55
  v_perm_b32 v48, v147, v145, s44
  v_perm_b32 v49, v151, v149, s44
  v_perm_b32 v50, v155, v153, s44
  v_perm_b32 v51, v159, v157, s44
  v_accvgpr_write_b32 a200, v48
  v_accvgpr_write_b32 a201, v49
  v_accvgpr_write_b32 a202, v50
  v_accvgpr_write_b32 a203, v51
  v_perm_b32 v52, v147, v145, s45
  v_perm_b32 v53, v151, v149, s45
  v_perm_b32 v54, v155, v153, s45
  v_perm_b32 v55, v159, v157, s45
  v_accvgpr_write_b32 a204, v52
  v_accvgpr_write_b32 a205, v53
  v_accvgpr_write_b32 a206, v54
  v_accvgpr_write_b32 a207, v55
  buffer_store_dwordx4 v[208:211], v0, s[4:7], s29 offen offset:0 sc1
  buffer_store_dwordx4 v[208:211], v0, s[4:7], s29 offen offset:1024 sc1
  buffer_store_dwordx4 v[208:211], v0, s[4:7], s29 offen offset:2048 sc1
  buffer_store_dwordx4 v[208:211], v0, s[4:7], s29 offen offset:3072 sc1
  s_add_u32 s29, s29, 4096
  s_waitcnt vmcnt(32)
  v_perm_b32 v48, v162, v160, s44
  v_perm_b32 v49, v166, v164, s44
  v_perm_b32 v50, v170, v168, s44
  v_perm_b32 v51, v174, v172, s44
  v_accvgpr_write_b32 a208, v48
  v_accvgpr_write_b32 a209, v49
  v_accvgpr_write_b32 a210, v50
  v_accvgpr_write_b32 a211, v51
  v_perm_b32 v52, v162, v160, s45
  v_perm_b32 v53, v166, v164, s45
  v_perm_b32 v54, v170, v168, s45
  v_perm_b32 v55, v174, v172, s45
  v_accvgpr_write_b32 a212, v52
  v_accvgpr_write_b32 a213, v53
  v_accvgpr_write_b32 a214, v54
  v_accvgpr_write_b32 a215, v55
  v_perm_b32 v48, v163, v161, s44
  v_perm_b32 v49, v167, v165, s44
  v_perm_b32 v50, v171, v169, s44
  v_perm_b32 v51, v175, v173, s44
  v_accvgpr_write_b32 a216, v48
  v_accvgpr_write_b32 a217, v49
  v_accvgpr_write_b32 a218, v50
  v_accvgpr_write_b32 a219, v51
  v_perm_b32 v52, v163, v161, s45
  v_perm_b32 v53, v167, v165, s45
  v_perm_b32 v54, v171, v169, s45
  v_perm_b32 v55, v175, v173, s45
  v_accvgpr_write_b32 a220, v52
  v_accvgpr_write_b32 a221, v53
  v_accvgpr_write_b32 a222, v54
  v_accvgpr_write_b32 a223, v55
  s_waitcnt vmcnt(24)
  v_perm_b32 v48, v66, v64, s44
  v_perm_b32 v49, v70, v68, s44
  v_perm_b32 v50, v74, v72, s44
  v_perm_b32 v51, v78, v76, s44
  v_accvgpr_write_b32 a224, v48
  v_accvgpr_write_b32 a225, v49
  v_accvgpr_write_b32 a226, v50
  v_accvgpr_write_b32 a227, v51
  v_perm_b32 v52, v66, v64, s45
  v_perm_b32 v53, v70, v68, s45
  v_perm_b32 v54, v74, v72, s45
  v_perm_b32 v55, v78, v76, s45
  v_accvgpr_write_b32 a228, v52
  v_accvgpr_write_b32 a229, v53
  v_accvgpr_write_b32 a230, v54
  v_accvgpr_write_b32 a231, v55
  v_perm_b32 v48, v67, v65, s44
  v_perm_b32 v49, v71, v69, s44
  v_perm_b32 v50, v75, v73, s44
  v_perm_b32 v51, v79, v77, s44
  v_accvgpr_write_b32 a232, v48
  v_accvgpr_write_b32 a233, v49
  v_accvgpr_write_b32 a234, v50
  v_accvgpr_write_b32 a235, v51
  v_perm_b32 v52, v67, v65, s45
  v_perm_b32 v53, v71, v69, s45
  v_perm_b32 v54, v75, v73, s45
  v_perm_b32 v55, v79, v77, s45
  v_accvgpr_write_b32 a236, v52
  v_accvgpr_write_b32 a237, v53
  v_accvgpr_write_b32 a238, v54
  v_accvgpr_write_b32 a239, v55
  s_waitcnt vmcnt(16)
  v_perm_b32 v48, v82, v80, s44
  v_perm_b32 v49, v86, v84, s44
  v_perm_b32 v50, v90, v88, s44
  v_perm_b32 v51, v94, v92, s44
  v_accvgpr_write_b32 a240, v48
  v_accvgpr_write_b32 a241, v49
  v_accvgpr_write_b32 a242, v50
  v_accvgpr_write_b32 a243, v51
  v_perm_b32 v52, v82, v80, s45
  v_perm_b32 v53, v86, v84, s45
  v_perm_b32 v54, v90, v88, s45
  v_perm_b32 v55, v94, v92, s45
  v_accvgpr_write_b32 a244, v52
  v_accvgpr_write_b32 a245, v53
  v_accvgpr_write_b32 a246, v54
  v_accvgpr_write_b32 a247, v55
  v_perm_b32 v48, v83, v81, s44
  v_perm_b32 v49, v87, v85, s44
  v_perm_b32 v50, v91, v89, s44
  v_perm_b32 v51, v95, v93, s44
  v_accvgpr_write_b32 a248, v48
  v_accvgpr_write_b32 a249, v49
  v_accvgpr_write_b32 a250, v50
  v_accvgpr_write_b32 a251, v51
  v_perm_b32 v52, v83, v81, s45
  v_perm_b32 v53, v87, v85, s45
  v_perm_b32 v54, v91, v89, s45
  v_perm_b32 v55, v95, v93, s45
  v_accvgpr_write_b32 a252, v52
  v_accvgpr_write_b32 a253, v53
  v_accvgpr_write_b32 a254, v54
  v_accvgpr_write_b32 a255, v55
  s_waitcnt vmcnt(0)
  s_barrier
  s_cmp_ge_u32 s60, 4
  s_cbranch_scc1 L_oh
  s_cmp_lg_u32 s17, 0
  s_cbranch_scc1 g_ar_121
  s_lshl_b32 s36, s89, 3
  s_lshl_b64 s[36:37], 1, s36
  v_lshlrev_b32 v52, 3, s91
  v_mov_b32 v48, s36
  v_mov_b32 v49, s37
  s_mov_b64 exec, 1
  global_atomic_add_x2 v[50:51], v52, v[48:49], s[12:13] sc0
  s_mov_b64 exec, -1
g_ar_121:
  s_waitcnt vmcnt(0)
  s_cmp_lg_u32 s17, 0
  s_cbranch_scc1 g_af_122
  v_readfirstlane_b32 s36, v50
  v_readfirstlane_b32 s37, v51
  s_add_u32 s38, s36, s37
  s_mul_i32 s38, s38, 0x01010101
  s_lshr_b32 s38, s38, 24
  s_cmp_lg_u32 s38, 15
  s_cbranch_scc1 g_af_122
  s_lshl_b32 s38, s89, 3
  s_lshr_b64 s[36:37], s[36:37], s38
  s_and_b32 s36, s36, 0xff
  s_cmp_eq_u32 s36, 15
  s_cselect_b32 s36, 1, 2
  v_mov_b32 v48, s36
  v_lshrrev_b32 v52, 1, v52
  s_mov_b64 exec, 1
  global_store_dword v52, v48, s[12:13] offset:128 sc1
  s_mov_b64 exec, -1
g_af_122:
  s_lshr_b32 s26, s60, 1
  s_cmp_lg_u32 s26, 1
  s_cbranch_scc1 L_ow
  s_and_b32 s28, s85, 28
  s_or_b32 s28, s28, 1
  s_lshl_b32 s27, s28, 6
  s_add_u32 s27, s27, 245104640
  s_mov_b32 s26, 0
g_h_123:
  buffer_load_dwordx2 v[60:61], off, s[4:7], s27 sc1
  s_add_u32 s26, s26, 1
  s_cmp_gt_u32 s26, 1048576
  s_cbranch_scc1 L_end
  s_waitcnt vmcnt(0)
  v_and_or_b32 v60, v61, -1, v60
  v_cmp_eq_u32 vcc, 0, v60
  s_cbranch_vccnz g_h_123
  s_mov_b32 s10, 1835008
  s_load_dwordx2 s[8:9], s[0:1], 72
  s_mul_i32 s26, s77, 14336
  s_sub_u32 s26, s26, 1835008
  s_waitcnt lgkmcnt(0)
  buffer_load_dwordx4 v[64:67], v0, s[8:11], s26 offen offset:0
  buffer_load_dwordx4 v[64:67], v0, s[8:11], s26 offen offset:1024
  buffer_load_dwordx4 v[64:67], v0, s[8:11], s26 offen offset:2048
  buffer_load_dwordx4 v[64:67], v0, s[8:11], s26 offen offset:3072
  s_add_u32 s26, s26, 4096
  buffer_load_dwordx4 v[64:67], v0, s[8:11], s26 offen offset:0
  buffer_load_dwordx4 v[64:67], v0, s[8:11], s26 offen offset:1024
  buffer_load_dwordx4 v[64:67], v0, s[8:11], s26 offen offset:2048
  buffer_load_dwordx4 v[64:67], v0, s[8:11], s26 offen offset:3072
  s_add_u32 s26, s26, 4096
  buffer_load_dwordx4 v[64:67], v0, s[8:11], s26 offen offset:0
  buffer_load_dwordx4 v[64:67], v0, s[8:11], s26 offen offset:1024
  buffer_load_dwordx4 v[64:67], v0, s[8:11], s26 offen offset:2048
  buffer_load_dwordx4 v[64:67], v0, s[8:11], s26 offen offset:3072
  s_add_u32 s26, s26, 4096
  buffer_load_dwordx4 v[64:67], v0, s[8:11], s26 offen offset:0
  buffer_load_dwordx4 v[64:67], v0, s[8:11], s26 offen offset:1024
  s_load_dwordx2 s[8:9], s[0:1], 80
  s_mul_i32 s26, s77, 14336
  s_sub_u32 s26, s26, 1835008
  s_waitcnt lgkmcnt(0)
  buffer_load_dwordx4 v[64:67], v0, s[8:11], s26 offen offset:0
  buffer_load_dwordx4 v[64:67], v0, s[8:11], s26 offen offset:1024
  buffer_load_dwordx4 v[64:67], v0, s[8:11], s26 offen offset:2048
  buffer_load_dwordx4 v[64:67], v0, s[8:11], s26 offen offset:3072
  s_add_u32 s26, s26, 4096
  buffer_load_dwordx4 v[64:67], v0, s[8:11], s26 offen offset:0
  buffer_load_dwordx4 v[64:67], v0, s[8:11], s26 offen offset:1024
  buffer_load_dwordx4 v[64:67], v0, s[8:11], s26 offen offset:2048
  buffer_load_dwordx4 v[64:67], v0, s[8:11], s26 offen offset:3072
  s_add_u32 s26, s26, 4096
  buffer_load_dwordx4 v[64:67], v0, s[8:11], s26 offen offset:0
  buffer_load_dwordx4 v[64:67], v0, s[8:11], s26 offen offset:1024
  buffer_load_dwordx4 v[64:67], v0, s[8:11], s26 offen offset:2048
  buffer_load_dwordx4 v[64:67], v0, s[8:11], s26 offen offset:3072
  s_add_u32 s26, s26, 4096
  buffer_load_dwordx4 v[64:67], v0, s[8:11], s26 offen offset:0
  buffer_load_dwordx4 v[64:67], v0, s[8:11], s26 offen offset:1024
  s_load_dwordx2 s[8:9], s[0:1], 88
  s_mul_i32 s26, s77, 14336
  s_sub_u32 s26, s26, 1835008
  s_waitcnt lgkmcnt(0)
  buffer_load_dwordx4 v[64:67], v0, s[8:11], s26 offen offset:0
  buffer_load_dwordx4 v[64:67], v0, s[8:11], s26 offen offset:1024
  buffer_load_dwordx4 v[64:67], v0, s[8:11], s26 offen offset:2048
  buffer_load_dwordx4 v[64:67], v0, s[8:11], s26 offen offset:3072
  s_add_u32 s26, s26, 4096
  buffer_load_dwordx4 v[64:67], v0, s[8:11], s26 offen offset:0
  buffer_load_dwordx4 v[64:67], v0, s[8:11], s26 offen offset:1024
  buffer_load_dwordx4 v[64:67], v0, s[8:11], s26 offen offset:2048
  buffer_load_dwordx4 v[64:67], v0, s[8:11], s26 offen offset:3072
  s_add_u32 s26, s26, 4096
  buffer_load_dwordx4 v[64:67], v0, s[8:11], s26 offen offset:0
  buffer_load_dwordx4 v[64:67], v0, s[8:11], s26 offen offset:1024
  buffer_load_dwordx4 v[64:67], v0, s[8:11], s26 offen offset:2048
  buffer_load_dwordx4 v[64:67], v0, s[8:11], s26 offen offset:3072
  s_add_u32 s26, s26, 4096
  buffer_load_dwordx4 v[64:67], v0, s[8:11], s26 offen offset:0
  buffer_load_dwordx4 v[64:67], v0, s[8:11], s26 offen offset:1024
L_ow:
  v_mbcnt_lo_u32_b32 v60, -1, 0
  v_and_b32 v60, 0, v60
  v_add_lshl_u32 v60, v60, s91, 2
  s_mov_b32 s26, 0
g_wt_124:
  global_load_dword v61, v60, s[12:13] offset:128 sc1
  s_add_u32 s26, s26, 1
  s_cmp_gt_u32 s26, 1048576
  s_cbranch_scc1 L_end
  s_waitcnt vmcnt(0)
  v_cmp_eq_u32 vcc, 0, v61
  v_readfirstlane_b32 s27, v61
  s_cbranch_vccnz g_wt_124
  s_mov_b32 s89, s27
L_oh:
  s_cmp_lg_u32 s89, 1
  s_cbranch_scc1 L_o_x
  s_mov_b32 s62, 1
  s_mov_b32 s42, 0
  s_mov_b32 s3, 0
  s_mov_b32 s46, 0
  s_mov_b32 s65, 0
  s_mov_b32 s66, 0
  s_mov_b32 s76, 0
  s_mov_b32 s55, 0
  s_mov_b32 s48, 0
  s_mov_b32 s56, 0
  s_mov_b32 s84, 268435456
  s_mov_b32 s86, s41
  s_mov_b32 s49, s60
  s_mul_i32 s63, s49, 257
  s_or_b32 s63, s63, 1179648
  s_lshr_b32 s57, s60, 2
  s_cbranch_scc1 o_help_136
o_round_125:
  s_max_u32 s46, s46, s3
  s_cmp_lg_u32 s3, 0
  s_mov_b32 s3, 0
  s_cbranch_scc1 d_g_141
  s_mov_b32 s67, 0
d_w_140:
  s_min_u32 s26, s49, 71
  s_lshl_b32 s26, s26, 12
  s_add_u32 s27, s26, 243494912
  s_add_u32 s26, s26, 243486720
  buffer_load_dword v248, v246, s[4:7], s26 offen sc1
  buffer_load_dword v249, v246, s[4:7], s27 offen sc1
  s_add_u32 s67, s67, 1
  s_cmp_gt_u32 s67, 1048576
  s_cbranch_scc1 L_end
  s_waitcnt vmcnt(0)
  s_mov_b64 exec, 1
  buffer_store_dword v38, off, s[4:7], s84 sc1
  s_mov_b64 exec, -1
  s_mov_b32 s84, 268435456
  v_min_u32 v162, v248, v249
  v_max_u32 v163, v248, v249
  v_cmp_eq_u32 vcc, 0, v162
  s_cbranch_vccnz d_w_140
  v_max_u32_dpp v163, v163, v163 row_ror:8 row_mask:0xf bank_mask:0xf
  s_nop 1
  v_max_u32_dpp v163, v163, v163 row_ror:4 row_mask:0xf bank_mask:0xf
  s_nop 1
  v_max_u32_dpp v163, v163, v163 row_ror:2 row_mask:0xf bank_mask:0xf
  s_nop 1
  v_max_u32_dpp v163, v163, v163 row_ror:1 row_mask:0xf bank_mask:0xf
  s_nop 0
  v_readlane_b32 s28, v163, 0
  v_readlane_b32 s29, v163, 16
  v_readlane_b32 s30, v163, 32
  v_readlane_b32 s31, v163, 48
  s_max_u32 s28, s28, s29
  s_max_u32 s30, s30, s31
  s_max_u32 s46, s46, s28
  s_max_u32 s46, s46, s30
d_g_141:
  s_lshr_b32 s27, s49, 2
  s_andn2_b32 s52, 0xfff, s46
  s_lshr_b32 s52, s52, 5
  s_min_u32 s52, s52, 64
  s_add_u32 s26, s52, 3
  v_readlane_b32 s89, v247, s27
  s_sub_u32 s26, s26, s60
  s_lshr_b32 s26, s26, 2
  s_bfm_b32 s54, s26, 0
  s_add_u32 s53, s63, 1028
  s_cmp_lt_u32 s49, 60
  s_cselect_b32 s53, s53, 0
  s_cmp_lt_u32 s49, 64
  s_cselect_b32 s26, 3, 1
  s_sub_i32 s26, s27, s26
  s_max_i32 s26, s26, 0
  s_min_u32 s26, s26, 16
  s_bfm_b32 s58, s26, 0
  s_cmp_eq_u32 s27, 16
  s_cselect_b32 s59, 2, 1
  s_cmp_eq_u32 s27, 17
  s_cselect_b32 s59, 0, s59
  s_cmp_eq_u32 s27, 18
  s_cselect_b32 s59, 64, s59
  s_cselect_b32 s50, 0, -1
  s_cselect_b32 s89, 0, s89
  s_cbranch_scc1 o_dl_137
  s_cmp_eq_u32 s27, 16
  s_cbranch_scc1 o_dl_137_a
o_pick_129:
  s_cmp_eq_u32 s59, 0
  s_cbranch_scc1 o_none_133
  s_sub_u32 s59, s59, 1
  s_andn2_b32 s26, s58, s55
  s_and_b32 s26, s26, s54
  s_cbranch_scc1 o_ga_130
  s_and_b32 s26, s55, s50
  s_or_b32 s26, s26, s56
  s_or_b32 s26, s26, s54
  s_andn2_b32 s26, s58, s26
  s_cbranch_scc0 o_none_133
  s_cmp_ge_u32 s46, s89
  s_cbranch_scc1 o_gb_131
o_ga_130:
  s_ff1_i32_b32 s26, s26
  s_bitset1_b32 s55, s26
  s_mov_b32 s64, 1327168
  s_mov_b32 s27, s64
  s_branch o_gd_132
o_none_133:
  s_cmp_lt_u32 s49, 60
  s_cbranch_scc1 o_nn_134
  s_cmp_eq_u32 s50, 0
  s_cbranch_scc1 o_nn_134
  s_and_b32 s26, s63, 1097728
  s_cmp_eq_u32 s26, 1048576
  s_cbranch_scc1 o_nn_134
  s_cmp_lt_u32 s49, 64
  s_cbranch_scc1 o_adv_135
  s_and_b32 s26, s65, 1097728
  s_cmp_lg_u32 s26, 1048576
  s_cbranch_scc1 o_adv_135
o_nn_134:
  s_mov_b32 s64, s53
  s_mov_b32 s51, 0
  s_branch o_task_126
o_gb_131:
  s_ff1_i32_b32 s26, s26
  s_bitset1_b32 s56, s26
  s_andn2_b32 s27, 31, s46
  s_or_b32 s27, s27, 32
  s_lshl_b32 s27, s27, 22
  s_or_b32 s27, s27, 1474688
  s_mov_b32 s64, 1474624
o_gd_132:
  s_lshl4_add_u32 s48, s48, s26
  s_and_b32 s28, s26, s57
  s_lshr_b32 s26, s26, s57
  s_lshl2_add_u32 s26, s26, s60
  s_add_u32 s26, s26, s28
  s_cmp_eq_u32 s26, s52
  s_cselect_b32 s64, s27, s64
  s_mul_i32 s26, s26, 257
  s_or_b32 s64, s64, s26
  s_mov_b32 s51, 1
o_task_126:
  s_cmp_eq_u32 s63, 0
  s_cbranch_scc1 o_nofl_127
  s_cmp_lg_u32 s66, 0
  s_cbranch_scc1 o_have_143
  s_mov_b32 s67, 0
o_w1_142:
  s_and_b32 s32, s63, 0xff
  s_lshl_b32 s32, s32, 12
  s_add_u32 s32, s32, s14
  buffer_load_dword v37, v36, s[4:7], s32 offen sc1
  s_add_u32 s67, s67, 1
  s_cmp_gt_u32 s67, 1048576
  s_cbranch_scc1 L_end
  s_waitcnt vmcnt(0)
  s_mov_b64 exec, 1
  buffer_store_dword v38, off, s[4:7], s84 sc1
  s_mov_b64 exec, -1
  s_mov_b32 s84, 268435456
  v_cmp_eq_u32 vcc, 0, v37
  s_cbranch_vccnz o_w1_142
  s_and_b32 s87, s63, 0xff
  s_lshl_b32 s33, s87, 18
  s_lshl_b32 s32, s87, 19
  s_add_u32 m0, s22, 0
  s_add_u32 s33, s33, s19
  buffer_load_dwordx4 v0, s[4:7], s33 offen offset:0 sc1 lds
  buffer_load_dwordx4 v0, s[4:7], s33 offen offset:1024 sc1 lds
  buffer_load_dwordx4 v0, s[4:7], s33 offen offset:2048 sc1 lds
  buffer_load_dwordx4 v0, s[4:7], s33 offen offset:3072 sc1 lds
  s_add_u32 m0, s23, 0
  s_add_u32 s32, s32, s18
  buffer_load_dwordx4 v0, s[4:7], s32 offen offset:0 sc1 lds
  buffer_load_dwordx4 v0, s[4:7], s32 offen offset:1024 sc1 lds
  buffer_load_dwordx4 v0, s[4:7], s32 offen offset:2048 sc1 lds
  buffer_load_dwordx4 v0, s[4:7], s32 offen offset:3072 sc1 lds
  s_add_u32 m0, m0, 4096
  s_add_u32 s32, s32, 4096
  buffer_load_dwordx4 v0, s[4:7], s32 offen offset:0 sc1 lds
  buffer_load_dwordx4 v0, s[4:7], s32 offen offset:1024 sc1 lds
  buffer_load_dwordx4 v0, s[4:7], s32 offen offset:2048 sc1 lds
  buffer_load_dwordx4 v0, s[4:7], s32 offen offset:3072 sc1 lds
  s_waitcnt vmcnt(0)
  s_barrier
o_have_143:
  ds_read_b128 v[120:123], v33 offset:0
  ds_read_b128 v[40:43], v32 offset:0
  ds_read_b128 v[56:59], v32 offset:1024
  ds_read_b128 v[124:127], v33 offset:2048
  ds_read_b128 v[44:47], v32 offset:4096
  ds_read_b128 v[60:63], v32 offset:5120
  ds_read_b128 v[128:131], v33 offset:4096
  ds_read_b128 v[48:51], v32 offset:8192
  ds_read_b128 v[64:67], v32 offset:9216
  ds_read_b128 v[132:135], v33 offset:6144
  ds_read_b128 v[52:55], v32 offset:12288
  ds_read_b128 v[68:71], v32 offset:13312
  s_cmp_lt_u32 s17, 2
  s_cselect_b32 s65, s65, 0
  s_cmp_lg_u32 s65, 0
  s_cselect_b64 s[44:45], -1, 0
  s_mov_b32 s95, s86
  s_mov_b32 s96, s42
  s_lshl_b32 s97, s43, 14
  s_add_u32 s97, s97, s95
  s_and_b32 s87, s64, 0xff
  s_lshl_b32 s87, s87, 12
  s_add_u32 s87, s87, s14
  s_and_b32 s88, s63, 0xff00
  s_lshl_b32 s88, s88, 3
  s_add_u32 s88, s88, s15
  s_and_b32 s91, s65, 63
  s_lshl_b32 s90, s91, 5
  s_add_u32 s94, s90, s85
  s_add_u32 s90, s90, s43
  s_lshl_b32 s94, s94, 10
  s_lshr_b32 s92, s65, 22
  s_xor_b32 s93, s43, 32
  s_lshl_b32 s91, s90, 10
  s_add_u32 s94, s94, 25165824
  s_cmp_eq_u32 s92, s93
  s_cselect_b32 s92, s94, s91
  s_add_u32 s92, s92, 10485760
  s_and_b32 s93, s65, 49152
  s_cselect_b32 s92, s92, s91
  s_cselect_b64 s[80:81], s[4:5], s[72:73]
  s_cselect_b32 s82, s6, s74
  s_waitcnt lgkmcnt(9)
  v_mfma_f32_16x16x32_bf16 v[104:107], v[40:43], v[120:123], v[24:27]
  v_mfma_f32_16x16x32_bf16 v[108:111], v[56:59], v[120:123], v[28:31]
  s_mov_b64 exec, s[44:45]
  buffer_load_dword v7, v255, s[4:7], s97 offen sc1
  buffer_load_dwordx4 v[184:187], v0, s[80:83], s92 offen sc1
  s_not_b64 exec, exec
  buffer_load_dword v37, v36, s[4:7], s87 offen sc1
  s_mov_b64 exec, -1
  buffer_load_dword v244, v252, s[4:7], s88 offen sc1
  s_waitcnt lgkmcnt(6)
  v_mfma_f32_16x16x32_bf16 v[104:107], v[44:47], v[124:127], v[104:107]
  v_mfma_f32_16x16x32_bf16 v[108:111], v[60:63], v[124:127], v[108:111]
  s_waitcnt lgkmcnt(3)
  v_mfma_f32_16x16x32_bf16 v[104:107], v[48:51], v[128:131], v[104:107]
  v_mfma_f32_16x16x32_bf16 v[108:111], v[64:67], v[128:131], v[108:111]
  s_waitcnt lgkmcnt(0)
  v_mfma_f32_16x16x32_bf16 v[104:107], v[52:55], v[132:135], v[104:107]
  v_mfma_f32_16x16x32_bf16 v[108:111], v[68:71], v[132:135], v[108:111]
  s_cmp_lg_u32 s76, 0
  s_cbranch_scc1 o_klds_146
  v_mov_b32 v196, 0
  v_mov_b32 v199, 0
  v_exp_f32 v56, v104
  v_exp_f32 v57, v105
  v_exp_f32 v58, v106
  v_exp_f32 v59, v107
  v_exp_f32 v60, v108
  v_exp_f32 v61, v109
  v_exp_f32 v62, v110
  v_exp_f32 v63, v111
  v_max3_f32 v116, v104, v105, v106
  v_max3_f32 v116, v107, v108, v116
  v_max3_f32 v116, v109, v110, v116
  v_add_f32 v117, v56, v57
  v_add_f32 v118, v58, v59
  v_add_f32 v117, v117, v60
  v_add_f32 v118, v118, v61
  v_add_f32 v117, v117, v62
  v_add_f32 v118, v118, v63
  s_mov_b32 s67, 0
  s_and_b32 s32, s63, 0xff00
  s_lshl_b32 s32, s32, 10
  s_add_u32 s32, s32, s20
  s_add_u32 s33, s32, 4096
o_w2_144:
  s_waitcnt vmcnt(0)
  v_cmp_eq_u32 vcc, 0, v244
  s_cbranch_vccz o_kgo_154
  s_mov_b64 exec, 1
  buffer_store_dword v38, off, s[4:7], s84 sc1
  s_mov_b64 exec, -1
  s_mov_b32 s84, 268435456
  buffer_load_dword v244, v252, s[4:7], s88 offen sc1
  s_add_u32 s67, s67, 1
  s_cmp_gt_u32 s67, 1048576
  s_cbranch_scc1 L_end
  s_branch o_w2_144
o_kgo_154:
  buffer_load_dwordx4 v[136:139], v0, s[4:7], s32 offen offset:0 sc1
  buffer_load_dwordx4 v[140:143], v0, s[4:7], s32 offen offset:1024 sc1
  buffer_load_dwordx4 v[144:147], v0, s[4:7], s32 offen offset:2048 sc1
  buffer_load_dwordx4 v[148:151], v0, s[4:7], s32 offen offset:3072 sc1
  buffer_load_dwordx2 v[200:201], v1, s[4:7], s33 offen offset:0 sc1
  buffer_load_dwordx2 v[202:203], v1, s[4:7], s33 offen offset:512 sc1
  buffer_load_dwordx2 v[204:205], v1, s[4:7], s33 offen offset:1024 sc1
  buffer_load_dwordx2 v[206:207], v1, s[4:7], s33 offen offset:1536 sc1
  buffer_load_dword v37, v36, s[4:7], s87 offen sc1
  buffer_load_dword v244, v252, s[4:7], s88 offen sc1
  s_barrier
  ds_read_b128 v[152:155], v32 offset:2048
  ds_read_b128 v[156:159], v32 offset:3072
  ds_read_b128 v[160:163], v32 offset:6144
  ds_read_b128 v[164:167], v32 offset:7168
  ds_read_b128 v[168:171], v32 offset:10240
  ds_read_b128 v[172:175], v32 offset:11264
  ds_read_b128 v[176:179], v32 offset:14336
  ds_read_b128 v[180:183], v32 offset:15360
  s_waitcnt vmcnt(9)
  v_mfma_f32_16x16x32_bf16 v[112:115], v[136:139], v[120:123], 0
  s_waitcnt vmcnt(8)
  v_mfma_f32_16x16x32_bf16 v[112:115], v[140:143], v[124:127], v[112:115]
  s_waitcnt vmcnt(7)
  v_mfma_f32_16x16x32_bf16 v[112:115], v[144:147], v[128:131], v[112:115]
  s_waitcnt vmcnt(6)
  v_mfma_f32_16x16x32_bf16 v[112:115], v[148:151], v[132:135], v[112:115]
  s_waitcnt vmcnt(2)
  s_branch o_havek_145
o_klds_146:
  s_waitcnt vmcnt(12)
  s_barrier
  ds_read_b128 v[136:139], v34 offset:0
  ds_read_b128 v[140:143], v34 offset:1024
  ds_read_b128 v[144:147], v34 offset:2048
  ds_read_b128 v[148:151], v34 offset:3072
  ds_read_b64 v[200:201], v35 offset:4096
  ds_read_b64 v[202:203], v35 offset:4608
  ds_read_b64 v[204:205], v35 offset:5120
  ds_read_b64 v[206:207], v35 offset:5632
  v_mov_b32 v196, 0
  v_mov_b32 v199, 0
  v_exp_f32 v56, v104
  v_exp_f32 v57, v105
  v_exp_f32 v58, v106
  v_exp_f32 v59, v107
  v_exp_f32 v60, v108
  v_exp_f32 v61, v109
  v_exp_f32 v62, v110
  v_exp_f32 v63, v111
  v_max3_f32 v116, v104, v105, v106
  v_max3_f32 v116, v107, v108, v116
  v_max3_f32 v116, v109, v110, v116
  s_waitcnt lgkmcnt(4)
  v_mfma_f32_16x16x32_bf16 v[112:115], v[136:139], v[120:123], 0
  ds_read_b128 v[152:155], v32 offset:2048
  ds_read_b128 v[156:159], v32 offset:3072
  v_mfma_f32_16x16x32_bf16 v[112:115], v[140:143], v[124:127], v[112:115]
  ds_read_b128 v[160:163], v32 offset:6144
  ds_read_b128 v[164:167], v32 offset:7168
  v_mfma_f32_16x16x32_bf16 v[112:115], v[144:147], v[128:131], v[112:115]
  ds_read_b128 v[168:171], v32 offset:10240
  ds_read_b128 v[172:175], v32 offset:11264
  v_mfma_f32_16x16x32_bf16 v[112:115], v[148:151], v[132:135], v[112:115]
  ds_read_b128 v[176:179], v32 offset:14336
  ds_read_b128 v[180:183], v32 offset:15360
  v_add_f32 v117, v56, v57
  v_add_f32 v118, v58, v59
  v_add_f32 v117, v117, v60
  v_add_f32 v118, v118, v61
  v_add_f32 v117, v117, v62
  v_add_f32 v118, v118, v63
o_havek_145:
  s_cmp_lg_u32 s65, 0
  s_cbranch_scc1 o_wr1_151
  s_nop 3
  v_mul_f32 v112, s24, v112
  v_mul_f32 v113, s24, v113
  v_exp_f32 v64, v112
  v_exp_f32 v65, v113
  v_max_f32 v116, v111, v116
  v_max3_f32 v116, v112, v113, v116
  v_add_f32 v117, v117, v64
  v_add_f32 v118, v118, v65
  v_add_f32 v117, v117, v118
  s_mov_b32 s28, 0x21800000
  v_mov_b32 v118, v117
  s_nop 1
  v_permlane16_swap_b32 v117, v118
  v_add_f32 v117, v117, v118
  v_mov_b32 v118, v117
  s_nop 0
  s_nop 0
  v_permlane32_swap_b32 v117, v118
  v_add_f32 v117, v117, v118
  v_cmp_lt_f32 vcc, 0x42700000, v116
  v_cmp_gt_f32 s[30:31], s28, v117
  v_rcp_f32 v117, v117
  s_or_b64 vcc, vcc, s[30:31]
  s_cbranch_vccnz o_fb_155
o_fbr_156:
  v_pk_mul_f32 v[56:57], v[56:57], v[116:117] op_sel:[0,1] op_sel_hi:[1,1]
  v_pk_mul_f32 v[58:59], v[58:59], v[116:117] op_sel:[0,1] op_sel_hi:[1,1]
  v_pk_mul_f32 v[60:61], v[60:61], v[116:117] op_sel:[0,1] op_sel_hi:[1,1]
  v_pk_mul_f32 v[62:63], v[62:63], v[116:117] op_sel:[0,1] op_sel_hi:[1,1]
  v_pk_mul_f32 v[64:65], v[64:65], v[116:117] op_sel:[0,1] op_sel_hi:[1,1]
  v_cvt_pk_bf16_f32 v116, v56, v57
  v_cvt_pk_bf16_f32 v117, v58, v59
  v_cvt_pk_bf16_f32 v118, v60, v61
  v_cvt_pk_bf16_f32 v119, v62, v63
  s_waitcnt lgkmcnt(0)
  s_nop 0
  v_mfma_f32_16x16x32_bf16 v[72:75], v[152:155], v[116:119], 0
  s_add_u32 s62, s62, 1
  v_cvt_pk_bf16_f32 v197, v64, v65
  v_cvt_pk_bf16_f32 v198, v64, v65
  v_mfma_f32_16x16x32_bf16 v[76:79], v[156:159], v[116:119], 0
  s_xor_b32 s86, s86, 524288
  v_mfma_f32_16x16x32_bf16 v[80:83], v[160:163], v[116:119], 0
  s_bfe_u32 s42, s62, 0x10001
  v_mfma_f32_16x16x32_bf16 v[84:87], v[164:167], v[116:119], 0
  s_bfe_u32 s26, s64, 65556
  v_mfma_f32_16x16x32_bf16 v[88:91], v[168:171], v[116:119], 0
  s_and_b32 s87, s64, 0xff
  v_mfma_f32_16x16x32_bf16 v[92:95], v[172:175], v[116:119], 0
  s_bfe_u32 s88, s64, 0x80008
  v_mfma_f32_16x16x32_bf16 v[96:99], v[176:179], v[116:119], 0
  s_nop 0
  v_mfma_f32_16x16x32_bf16 v[100:103], v[180:183], v[116:119], 0
  s_nop 0
  v_mfma_f32_16x16x16_bf16 v[72:75], v[200:201], v[198:199], v[72:75]
  s_nop 1
  v_mfma_f32_16x16x16_bf16 v[76:79], v[200:201], v[196:197], v[76:79]
  s_nop 1
  v_mfma_f32_16x16x16_bf16 v[80:83], v[202:203], v[198:199], v[80:83]
  s_nop 1
  v_mfma_f32_16x16x16_bf16 v[84:87], v[202:203], v[196:197], v[84:87]
  s_nop 1
  v_mfma_f32_16x16x16_bf16 v[88:91], v[204:205], v[198:199], v[88:91]
  s_nop 0
  v_cvt_pk_bf16_f32 v40, v72, v73
  v_cvt_pk_bf16_f32 v41, v74, v75
  v_mfma_f32_16x16x16_bf16 v[92:95], v[204:205], v[196:197], v[92:95]
  s_nop 0
  v_cvt_pk_bf16_f32 v42, v76, v77
  v_cvt_pk_bf16_f32 v43, v78, v79
  v_mfma_f32_16x16x16_bf16 v[96:99], v[206:207], v[198:199], v[96:99]
  s_nop 0
  ds_write_b128 v6, v[40:43] offset:0
  v_cvt_pk_bf16_f32 v44, v80, v81
  v_mfma_f32_16x16x16_bf16 v[100:103], v[206:207], v[196:197], v[100:103]
  s_nop 0
  v_cvt_pk_bf16_f32 v45, v82, v83
  v_cvt_pk_bf16_f32 v46, v84, v85
  v_cvt_pk_bf16_f32 v47, v86, v87
  ds_write_b128 v6, v[44:47] offset:1024
  v_cvt_pk_bf16_f32 v48, v88, v89
  v_cvt_pk_bf16_f32 v49, v90, v91
  v_cvt_pk_bf16_f32 v50, v92, v93
  v_cvt_pk_bf16_f32 v51, v94, v95
  ds_write_b128 v6, v[48:51] offset:2048
  v_cvt_pk_bf16_f32 v52, v96, v97
  v_cvt_pk_bf16_f32 v53, v98, v99
  v_cvt_pk_bf16_f32 v54, v100, v101
  v_cvt_pk_bf16_f32 v55, v102, v103
  ds_write_b128 v6, v[52:55] offset:3072
  s_cmp_lt_u32 s17, 2
  s_cbranch_scc1 o_wr0_150
  s_waitcnt lgkmcnt(0)
  s_barrier
  ds_read_b128 v[104:107], v3 offset:0
  ds_read_b128 v[108:111], v3 offset:512
  ds_read_b128 v[112:115], v3 offset:1024
  s_waitcnt lgkmcnt(2)
  v_mfma_f32_32x32x16_bf16 v[40:55], v[104:107], a[0:3], 0
  s_waitcnt vmcnt(0)
  v_cmp_eq_u32 vcc, 0, v37
  s_cmp_eq_u64 vcc, 0
  s_cselect_b32 s66, s26, 0
  s_cmp_eq_u32 s66, 1
  s_cselect_b32 s87, s87, 1024
  s_cselect_b32 s34, 0, 0x28000
  v_mfma_f32_32x32x16_bf16 v[56:71], v[104:107], a[4:7], 0
  ds_read_b128 v[116:119], v3 offset:1536
  s_lshl_b32 s33, s87, 18
  s_lshl_b32 s32, s87, 19
  s_add_u32 m0, s22, s34
  s_add_u32 s33, s33, s19
  s_min_u32 s28, s49, 67
  v_mfma_f32_32x32x16_bf16 v[72:87], v[104:107], a[8:11], 0
  s_lshl1_add_u32 s28, s17, s28
  s_lshl_b32 s28, s28, 12
  s_add_u32 s28, s28, 243486720
  v_mfma_f32_32x32x16_bf16 v[88:103], v[104:107], a[12:15], 0
  buffer_load_dword v249, v246, s[4:7], s28 offen sc1
  s_waitcnt lgkmcnt(2)
  v_mfma_f32_32x32x16_bf16 v[40:55], v[108:111], a[16:19], v[40:55]
  buffer_load_dwordx4 v0, s[4:7], s33 offen offset:0 sc1 lds
  v_mfma_f32_32x32x16_bf16 v[56:71], v[108:111], a[20:23], v[56:71]
  ds_read_b128 v[104:107], v3 offset:2048
  v_mfma_f32_32x32x16_bf16 v[72:87], v[108:111], a[24:27], v[72:87]
  buffer_load_dwordx4 v0, s[4:7], s33 offen offset:1024 sc1 lds
  v_mfma_f32_32x32x16_bf16 v[88:103], v[108:111], a[28:31], v[88:103]
  buffer_load_dwordx4 v0, s[4:7], s33 offen offset:2048 sc1 lds
  s_waitcnt lgkmcnt(2)
  v_mfma_f32_32x32x16_bf16 v[40:55], v[112:115], a[32:35], v[40:55]
  v_mfma_f32_32x32x16_bf16 v[56:71], v[112:115], a[36:39], v[56:71]
  ds_read_b128 v[108:111], v3 offset:2560
  buffer_load_dwordx4 v0, s[4:7], s33 offen offset:3072 sc1 lds
  s_sub_u32 m0, m0, 8192
  s_sub_u32 s33, s33, 8192
  v_mfma_f32_32x32x16_bf16 v[72:87], v[112:115], a[40:43], v[72:87]
  buffer_load_dwordx4 v0, s[4:7], s33 offen offset:0 sc1 lds
  v_mfma_f32_32x32x16_bf16 v[88:103], v[112:115], a[44:47], v[88:103]
  s_waitcnt lgkmcnt(2)
  v_mfma_f32_32x32x16_bf16 v[40:55], v[116:119], a[48:51], v[40:55]
  buffer_load_dwordx4 v0, s[4:7], s33 offen offset:1024 sc1 lds
  v_mfma_f32_32x32x16_bf16 v[56:71], v[116:119], a[52:55], v[56:71]
  ds_read_b128 v[112:115], v3 offset:3072
  buffer_load_dwordx4 v0, s[4:7], s33 offen offset:2048 sc1 lds
  v_mfma_f32_32x32x16_bf16 v[72:87], v[116:119], a[56:59], v[72:87]
  v_mfma_f32_32x32x16_bf16 v[88:103], v[116:119], a[60:63], v[88:103]
  buffer_load_dwordx4 v0, s[4:7], s33 offen offset:3072 sc1 lds
  s_add_u32 m0, s23, s34
  s_add_u32 s32, s32, s18
  s_waitcnt lgkmcnt(2)
  v_mfma_f32_32x32x16_bf16 v[40:55], v[104:107], a[64:67], v[40:55]
  buffer_load_dwordx4 v0, s[4:7], s32 offen offset:0 sc1 lds
  v_mfma_f32_32x32x16_bf16 v[56:71], v[104:107], a[68:71], v[56:71]
  ds_read_b128 v[116:119], v3 offset:3584
  v_mfma_f32_32x32x16_bf16 v[72:87], v[104:107], a[72:75], v[72:87]
  buffer_load_dwordx4 v0, s[4:7], s32 offen offset:1024 sc1 lds
  s_add_i32 m0, m0, 4096
  s_add_i32 s32, s32, 4096
  v_mfma_f32_32x32x16_bf16 v[88:103], v[104:107], a[76:79], v[88:103]
  buffer_load_dwordx4 v0, s[4:7], s32 offen offset:0 sc1 lds
  s_waitcnt lgkmcnt(2)
  v_mfma_f32_32x32x16_bf16 v[40:55], v[108:111], a[80:83], v[40:55]
  v_mfma_f32_32x32x16_bf16 v[56:71], v[108:111], a[84:87], v[56:71]
  ds_read_b128 v[104:107], v3 offset:8192
  buffer_load_dwordx4 v0, s[4:7], s32 offen offset:1024 sc1 lds
  s_add_i32 m0, m0, -16384
  s_add_i32 s32, s32, -16384
  v_mfma_f32_32x32x16_bf16 v[72:87], v[108:111], a[88:91], v[72:87]
  s_and_b32 s29, s64, 0xff00
  s_lshl_b32 s29, s29, 3
  s_add_u32 s29, s29, s15
  buffer_load_dword v245, v252, s[4:7], s29 offen sc1
  v_mfma_f32_32x32x16_bf16 v[88:103], v[108:111], a[92:95], v[88:103]
  s_waitcnt lgkmcnt(2)
  v_mfma_f32_32x32x16_bf16 v[40:55], v[112:115], a[96:99], v[40:55]
  buffer_load_dwordx4 v0, s[4:7], s32 offen offset:0 sc1 lds
  v_mfma_f32_32x32x16_bf16 v[56:71], v[112:115], a[100:103], v[56:71]
  ds_read_b128 v[108:111], v3 offset:8704
  buffer_load_dwordx4 v0, s[4:7], s32 offen offset:1024 sc1 lds
  s_add_i32 m0, m0, -4096
  s_add_i32 s32, s32, -4096
  v_mfma_f32_32x32x16_bf16 v[72:87], v[112:115], a[104:107], v[72:87]
  v_mfma_f32_32x32x16_bf16 v[88:103], v[112:115], a[108:111], v[88:103]
  buffer_load_dwordx4 v0, s[4:7], s32 offen offset:0 sc1 lds
  s_waitcnt lgkmcnt(2)
  v_mfma_f32_32x32x16_bf16 v[40:55], v[116:119], a[112:115], v[40:55]
  buffer_load_dwordx4 v0, s[4:7], s32 offen offset:1024 sc1 lds
  v_mfma_f32_32x32x16_bf16 v[56:71], v[116:119], a[116:119], v[56:71]
  ds_read_b128 v[112:115], v3 offset:9216
  v_mfma_f32_32x32x16_bf16 v[72:87], v[116:119], a[120:123], v[72:87]
  buffer_load_dwordx4 v0, s[4:7], s32 offen offset:2048 sc1 lds
  v_mfma_f32_32x32x16_bf16 v[88:103], v[116:119], a[124:127], v[88:103]
  buffer_load_dwordx4 v0, s[4:7], s32 offen offset:3072 sc1 lds
  s_add_i32 m0, m0, 4096
  s_add_i32 s32, s32, 4096
  s_waitcnt lgkmcnt(2)
  v_mfma_f32_32x32x16_bf16 v[40:55], v[104:107], a[128:131], v[40:55]
  v_mfma_f32_32x32x16_bf16 v[56:71], v[104:107], a[132:135], v[56:71]
  ds_read_b128 v[116:119], v3 offset:9728
  buffer_load_dwordx4 v0, s[4:7], s32 offen offset:2048 sc1 lds
  v_mfma_f32_32x32x16_bf16 v[72:87], v[104:107], a[136:139], v[72:87]
  buffer_load_dwordx4 v0, s[4:7], s32 offen offset:3072 sc1 lds
  s_add_i32 m0, m0, 16384
  s_add_i32 s32, s32, 16384
  v_mfma_f32_32x32x16_bf16 v[88:103], v[104:107], a[140:143], v[88:103]
  s_waitcnt lgkmcnt(2)
  v_mfma_f32_32x32x16_bf16 v[40:55], v[108:111], a[144:147], v[40:55]
  buffer_load_dwordx4 v0, s[4:7], s32 offen offset:2048 sc1 lds
  v_mfma_f32_32x32x16_bf16 v[56:71], v[108:111], a[148:151], v[56:71]
  ds_read_b128 v[104:107], v3 offset:10240
  buffer_load_dwordx4 v0, s[4:7], s32 offen offset:3072 sc1 lds
  s_add_i32 m0, m0, -4096
  s_add_i32 s32, s32, -4096
  v_mfma_f32_32x32x16_bf16 v[72:87], v[108:111], a[152:155], v[72:87]
  v_mfma_f32_32x32x16_bf16 v[88:103], v[108:111], a[156:159], v[88:103]
  buffer_load_dwordx4 v0, s[4:7], s32 offen offset:2048 sc1 lds
  s_waitcnt lgkmcnt(2)
  v_mfma_f32_32x32x16_bf16 v[40:55], v[112:115], a[160:163], v[40:55]
  buffer_load_dwordx4 v0, s[4:7], s32 offen offset:3072 sc1 lds
  v_mfma_f32_32x32x16_bf16 v[56:71], v[112:115], a[164:167], v[56:71]
  ds_read_b128 v[108:111], v3 offset:10752
  v_mfma_f32_32x32x16_bf16 v[72:87], v[112:115], a[168:171], v[72:87]
  v_mfma_f32_32x32x16_bf16 v[88:103], v[112:115], a[172:175], v[88:103]
  s_waitcnt lgkmcnt(2)
  v_mfma_f32_32x32x16_bf16 v[40:55], v[116:119], a[176:179], v[40:55]
  v_mfma_f32_32x32x16_bf16 v[56:71], v[116:119], a[180:183], v[56:71]
  ds_read_b128 v[112:115], v3 offset:11264
  v_mfma_f32_32x32x16_bf16 v[72:87], v[116:119], a[184:187], v[72:87]
  v_mfma_f32_32x32x16_bf16 v[88:103], v[116:119], a[188:191], v[88:103]
  s_waitcnt lgkmcnt(2)
  v_mfma_f32_32x32x16_bf16 v[40:55], v[104:107], a[192:195], v[40:55]
  v_mfma_f32_32x32x16_bf16 v[56:71], v[104:107], a[196:199], v[56:71]
  ds_read_b128 v[116:119], v3 offset:11776
  s_waitcnt vmcnt(12)
  v_cmp_eq_u32 vcc, 0, v245
  s_cmp_eq_u64 vcc, 0
  s_cselect_b32 s76, s26, 0
  s_and_b32 s76, s76, 1
  s_cselect_b32 s88, s88, 1024
  s_waitcnt lgkmcnt(2)
  v_mfma_f32_32x32x16_bf16 v[40:55], v[108:111], a[208:211], v[40:55]
  s_lshl_b32 s32, s88, 18
  s_mov_b32 m0, s40
  s_add_u32 s32, s32, s21
  buffer_load_dwordx4 v0, s[4:7], s32 offen offset:0 sc1 lds
  v_mfma_f32_32x32x16_bf16 v[56:71], v[108:111], a[212:215], v[56:71]
  buffer_load_dwordx4 v0, s[4:7], s32 offen offset:1024 sc1 lds
  s_waitcnt lgkmcnt(1)
  v_mfma_f32_32x32x16_bf16 v[40:55], v[112:115], a[224:227], v[40:55]
  buffer_load_dwordx4 v0, s[4:7], s32 offen offset:2048 sc1 lds
  s_sub_u32 m0, m0, 8192
  s_sub_u32 s32, s32, 8192
  v_mfma_f32_32x32x16_bf16 v[56:71], v[112:115], a[228:231], v[56:71]
  buffer_load_dwordx4 v0, s[4:7], s32 offen offset:0 sc1 lds
  s_waitcnt lgkmcnt(0)
  v_mfma_f32_32x32x16_bf16 v[40:55], v[116:119], a[240:243], v[40:55]
  buffer_load_dwordx4 v0, s[4:7], s32 offen offset:1024 sc1 lds
  v_mfma_f32_32x32x16_bf16 v[56:71], v[116:119], a[244:247], v[56:71]
  buffer_load_dwordx4 v0, s[4:7], s32 offen offset:2048 sc1 lds
  v_cmp_eq_u32 vcc, 0, v249
  v_max_u32_dpp v249, v249, v249 row_ror:8 row_mask:0xf bank_mask:0xf
  s_nop 0
  v_mfma_f32_32x32x16_bf16 v[72:87], v[104:107], a[200:203], v[72:87]
  v_max_u32_dpp v249, v249, v249 row_ror:4 row_mask:0xf bank_mask:0xf
  s_nop 0
  s_nop 0
  v_max_u32_dpp v249, v249, v249 row_ror:2 row_mask:0xf bank_mask:0xf
  s_nop 0
  s_nop 0
  v_max_u32_dpp v249, v249, v249 row_ror:1 row_mask:0xf bank_mask:0xf
  s_nop 0
  v_mfma_f32_32x32x16_bf16 v[88:103], v[104:107], a[204:207], v[88:103]
  v_mov_b32 v248, v249
  s_nop 0
  s_nop 0
  v_permlane16_swap_b32 v249, v248
  v_max_u32 v249, v249, v248
  v_mfma_f32_32x32x16_bf16 v[72:87], v[108:111], a[216:219], v[72:87]
  v_mov_b32 v248, v249
  s_nop 0
  s_nop 0
  v_permlane32_swap_b32 v249, v248
  v_max_u32 v249, v249, v248
  s_cmp_eq_u64 vcc, 0
  s_cselect_b32 s28, 4, 0
  v_mfma_f32_32x32x16_bf16 v[88:103], v[108:111], a[220:223], v[88:103]
  s_lshl_b32 s26, s76, 1
  s_or_b32 s26, s26, s66
  s_or_b32 s26, s26, s28
  v_mov_b32 v248, s26
  ds_write_b64 v39, v[248:249]
  v_mfma_f32_32x32x16_bf16 v[72:87], v[112:115], a[232:235], v[72:87]
  v_cvt_pk_bf16_f32 v212, v40, v56
  v_cvt_pk_bf16_f32 v214, v41, v57
  v_cvt_pk_bf16_f32 v216, v42, v58
  v_cvt_pk_bf16_f32 v218, v43, v59
  v_permlane16_swap_b32 v212, v214
  v_mfma_f32_32x32x16_bf16 v[88:103], v[112:115], a[236:239], v[88:103]
  v_cvt_pk_bf16_f32 v220, v44, v60
  v_cvt_pk_bf16_f32 v222, v45, v61
  v_permlane16_swap_b32 v216, v218
  v_bfi_b32 v212, v254, s42, v212
  v_mfma_f32_32x32x16_bf16 v[72:87], v[116:119], a[248:251], v[72:87]
  v_cvt_pk_bf16_f32 v224, v46, v62
  v_cvt_pk_bf16_f32 v226, v47, v63
  v_permlane16_swap_b32 v220, v222
  v_bfi_b32 v216, v254, s42, v216
  v_cvt_pk_bf16_f32 v228, v48, v64
  v_mfma_f32_32x32x16_bf16 v[88:103], v[116:119], a[252:255], v[88:103]
  v_cvt_pk_bf16_f32 v230, v49, v65
  v_permlane16_swap_b32 v224, v226
  v_bfi_b32 v220, v254, s42, v220
  v_cvt_pk_bf16_f32 v232, v50, v66
  v_cvt_pk_bf16_f32 v234, v51, v67
  v_permlane16_swap_b32 v228, v230
  v_bfi_b32 v224, v254, s42, v224
  v_cvt_pk_bf16_f32 v236, v52, v68
  v_cvt_pk_bf16_f32 v238, v53, v69
  v_permlane16_swap_b32 v232, v234
  v_bfi_b32 v228, v254, s42, v228
  v_cvt_pk_bf16_f32 v240, v54, v70
  v_cvt_pk_bf16_f32 v242, v55, v71
  v_permlane16_swap_b32 v236, v238
  v_bfi_b32 v232, v254, s42, v232
  v_permlane16_swap_b32 v240, v242
  v_bfi_b32 v236, v254, s42, v236
  v_bfi_b32 v240, v254, s42, v240
  v_cvt_pk_bf16_f32 v213, v72, v88
  v_cvt_pk_bf16_f32 v215, v73, v89
  v_cvt_pk_bf16_f32 v217, v74, v90
  v_cvt_pk_bf16_f32 v219, v75, v91
  s_add_u32 s78, s86, 0
  v_permlane16_swap_b32 v213, v215
  buffer_store_dwordx4 v[212:215], v4, s[4:7], s78 offen
  v_cvt_pk_bf16_f32 v221, v76, v92
  v_cvt_pk_bf16_f32 v223, v77, v93
  s_add_u32 s78, s86, 32768
  v_permlane16_swap_b32 v217, v219
  buffer_store_dwordx4 v[216:219], v4, s[4:7], s78 offen
  v_cvt_pk_bf16_f32 v225, v78, v94
  v_cvt_pk_bf16_f32 v227, v79, v95
  s_add_u32 s78, s86, 131072
  v_permlane16_swap_b32 v221, v223
  buffer_store_dwordx4 v[220:223], v4, s[4:7], s78 offen
  v_cvt_pk_bf16_f32 v229, v80, v96
  v_cvt_pk_bf16_f32 v231, v81, v97
  s_add_u32 s78, s86, 163840
  v_permlane16_swap_b32 v225, v227
  buffer_store_dwordx4 v[224:227], v4, s[4:7], s78 offen
  v_cvt_pk_bf16_f32 v233, v82, v98
  v_cvt_pk_bf16_f32 v235, v83, v99
  s_add_u32 s78, s86, 262144
  v_permlane16_swap_b32 v229, v231
  buffer_store_dwordx4 v[228:231], v4, s[4:7], s78 offen
  v_cvt_pk_bf16_f32 v237, v84, v100
  v_cvt_pk_bf16_f32 v239, v85, v101
  s_add_u32 s78, s86, 294912
  v_permlane16_swap_b32 v233, v235
  buffer_store_dwordx4 v[232:235], v4, s[4:7], s78 offen
  v_cvt_pk_bf16_f32 v241, v86, v102
  v_cvt_pk_bf16_f32 v243, v87, v103
  s_add_u32 s78, s86, 393216
  v_permlane16_swap_b32 v237, v239
  buffer_store_dwordx4 v[236:239], v4, s[4:7], s78 offen
  s_add_u32 s78, s86, 425984
  v_permlane16_swap_b32 v241, v243
  buffer_store_dwordx4 v[240:243], v4, s[4:7], s78 offen
  s_waitcnt vmcnt(22)
  s_branch o_we_153
o_wr0_150:
  s_waitcnt lgkmcnt(0)
  s_barrier
  ds_read_b128 v[104:107], v3 offset:0
  ds_read_b128 v[108:111], v3 offset:512
  ds_read_b128 v[112:115], v3 offset:1024
  s_waitcnt lgkmcnt(2)
  v_mfma_f32_32x32x16_bf16 v[40:55], v[104:107], a[0:3], 0
  v_mfma_f32_32x32x16_bf16 v[56:71], v[104:107], a[4:7], 0
  ds_read_b128 v[116:119], v3 offset:1536
  v_mfma_f32_32x32x16_bf16 v[72:87], v[104:107], a[8:11], 0
  v_mfma_f32_32x32x16_bf16 v[88:103], v[104:107], a[12:15], 0
  s_waitcnt lgkmcnt(2)
  v_mfma_f32_32x32x16_bf16 v[40:55], v[108:111], a[16:19], v[40:55]
  v_mfma_f32_32x32x16_bf16 v[56:71], v[108:111], a[20:23], v[56:71]
  ds_read_b128 v[104:107], v3 offset:2048
  v_mfma_f32_32x32x16_bf16 v[72:87], v[108:111], a[24:27], v[72:87]
  v_mfma_f32_32x32x16_bf16 v[88:103], v[108:111], a[28:31], v[88:103]
  s_waitcnt lgkmcnt(2)
  v_mfma_f32_32x32x16_bf16 v[40:55], v[112:115], a[32:35], v[40:55]
  v_mfma_f32_32x32x16_bf16 v[56:71], v[112:115], a[36:39], v[56:71]
  ds_read_b128 v[108:111], v3 offset:2560
  v_mfma_f32_32x32x16_bf16 v[72:87], v[112:115], a[40:43], v[72:87]
  v_mfma_f32_32x32x16_bf16 v[88:103], v[112:115], a[44:47], v[88:103]
  s_waitcnt lgkmcnt(2)
  v_mfma_f32_32x32x16_bf16 v[40:55], v[116:119], a[48:51], v[40:55]
  v_mfma_f32_32x32x16_bf16 v[56:71], v[116:119], a[52:55], v[56:71]
  ds_read_b128 v[112:115], v3 offset:3072
  v_mfma_f32_32x32x16_bf16 v[72:87], v[116:119], a[56:59], v[72:87]
  v_mfma_f32_32x32x16_bf16 v[88:103], v[116:119], a[60:63], v[88:103]
  s_waitcnt lgkmcnt(2)
  v_mfma_f32_32x32x16_bf16 v[40:55], v[104:107], a[64:67], v[40:55]
  v_mfma_f32_32x32x16_bf16 v[56:71], v[104:107], a[68:71], v[56:71]
  ds_read_b128 v[116:119], v3 offset:3584
  v_mfma_f32_32x32x16_bf16 v[72:87], v[104:107], a[72:75], v[72:87]
  v_mfma_f32_32x32x16_bf16 v[88:103], v[104:107], a[76:79], v[88:103]
  s_waitcnt lgkmcnt(2)
  v_mfma_f32_32x32x16_bf16 v[40:55], v[108:111], a[80:83], v[40:55]
  v_mfma_f32_32x32x16_bf16 v[56:71], v[108:111], a[84:87], v[56:71]
  ds_read_b128 v[104:107], v3 offset:8192
  v_mfma_f32_32x32x16_bf16 v[72:87], v[108:111], a[88:91], v[72:87]
  v_mfma_f32_32x32x16_bf16 v[88:103], v[108:111], a[92:95], v[88:103]
  s_waitcnt lgkmcnt(2)
  v_mfma_f32_32x32x16_bf16 v[40:55], v[112:115], a[96:99], v[40:55]
  v_mfma_f32_32x32x16_bf16 v[56:71], v[112:115], a[100:103], v[56:71]
  ds_read_b128 v[108:111], v3 offset:8704
  v_mfma_f32_32x32x16_bf16 v[72:87], v[112:115], a[104:107], v[72:87]
  v_mfma_f32_32x32x16_bf16 v[88:103], v[112:115], a[108:111], v[88:103]
  s_waitcnt lgkmcnt(2)
  v_mfma_f32_32x32x16_bf16 v[40:55], v[116:119], a[112:115], v[40:55]
  v_mfma_f32_32x32x16_bf16 v[56:71], v[116:119], a[116:119], v[56:71]
  ds_read_b128 v[112:115], v3 offset:9216
  v_mfma_f32_32x32x16_bf16 v[72:87], v[116:119], a[120:123], v[72:87]
  v_mfma_f32_32x32x16_bf16 v[88:103], v[116:119], a[124:127], v[88:103]
  s_waitcnt lgkmcnt(2)
  v_mfma_f32_32x32x16_bf16 v[40:55], v[104:107], a[128:131], v[40:55]
  v_mfma_f32_32x32x16_bf16 v[56:71], v[104:107], a[132:135], v[56:71]
  ds_read_b128 v[116:119], v3 offset:9728
  v_mfma_f32_32x32x16_bf16 v[72:87], v[104:107], a[136:139], v[72:87]
  v_mfma_f32_32x32x16_bf16 v[88:103], v[104:107], a[140:143], v[88:103]
  s_waitcnt lgkmcnt(2)
  v_mfma_f32_32x32x16_bf16 v[40:55], v[108:111], a[144:147], v[40:55]
  v_mfma_f32_32x32x16_bf16 v[56:71], v[108:111], a[148:151], v[56:71]
  ds_read_b128 v[104:107], v3 offset:10240
  v_mfma_f32_32x32x16_bf16 v[72:87], v[108:111], a[152:155], v[72:87]
  v_mfma_f32_32x32x16_bf16 v[88:103], v[108:111], a[156:159], v[88:103]
  s_waitcnt lgkmcnt(2)
  v_mfma_f32_32x32x16_bf16 v[40:55], v[112:115], a[160:163], v[40:55]
  v_mfma_f32_32x32x16_bf16 v[56:71], v[112:115], a[164:167], v[56:71]
  ds_read_b128 v[108:111], v3 offset:10752
  v_mfma_f32_32x32x16_bf16 v[72:87], v[112:115], a[168:171], v[72:87]
  v_mfma_f32_32x32x16_bf16 v[88:103], v[112:115], a[172:175], v[88:103]
  s_waitcnt lgkmcnt(2)
  v_mfma_f32_32x32x16_bf16 v[40:55], v[116:119], a[176:179], v[40:55]
  v_mfma_f32_32x32x16_bf16 v[56:71], v[116:119], a[180:183], v[56:71]
  ds_read_b128 v[112:115], v3 offset:11264
  v_mfma_f32_32x32x16_bf16 v[72:87], v[116:119], a[184:187], v[72:87]
  v_mfma_f32_32x32x16_bf16 v[88:103], v[116:119], a[188:191], v[88:103]
  s_waitcnt lgkmcnt(2)
  v_mfma_f32_32x32x16_bf16 v[40:55], v[104:107], a[192:195], v[40:55]
  v_mfma_f32_32x32x16_bf16 v[56:71], v[104:107], a[196:199], v[56:71]
  ds_read_b128 v[116:119], v3 offset:11776
  s_waitcnt lgkmcnt(2)
  v_mfma_f32_32x32x16_bf16 v[40:55], v[108:111], a[208:211], v[40:55]
  v_mfma_f32_32x32x16_bf16 v[56:71], v[108:111], a[212:215], v[56:71]
  s_waitcnt lgkmcnt(1)
  v_mfma_f32_32x32x16_bf16 v[40:55], v[112:115], a[224:227], v[40:55]
  v_mfma_f32_32x32x16_bf16 v[56:71], v[112:115], a[228:231], v[56:71]
  s_waitcnt lgkmcnt(0)
  v_mfma_f32_32x32x16_bf16 v[40:55], v[116:119], a[240:243], v[40:55]
  v_mfma_f32_32x32x16_bf16 v[56:71], v[116:119], a[244:247], v[56:71]
  v_mfma_f32_32x32x16_bf16 v[72:87], v[104:107], a[200:203], v[72:87]
  v_mfma_f32_32x32x16_bf16 v[88:103], v[104:107], a[204:207], v[88:103]
  v_cvt_pk_bf16_f32 v212, v40, v56
  v_cvt_pk_bf16_f32 v214, v41, v57
  v_cvt_pk_bf16_f32 v216, v42, v58
  v_cvt_pk_bf16_f32 v218, v43, v59
  v_permlane16_swap_b32 v212, v214
  v_mfma_f32_32x32x16_bf16 v[72:87], v[108:111], a[216:219], v[72:87]
  v_cvt_pk_bf16_f32 v220, v44, v60
  v_cvt_pk_bf16_f32 v222, v45, v61
  v_permlane16_swap_b32 v216, v218
  v_bfi_b32 v212, v254, s42, v212
  v_cvt_pk_bf16_f32 v224, v46, v62
  v_mfma_f32_32x32x16_bf16 v[88:103], v[108:111], a[220:223], v[88:103]
  v_cvt_pk_bf16_f32 v226, v47, v63
  v_permlane16_swap_b32 v220, v222
  v_bfi_b32 v216, v254, s42, v216
  v_cvt_pk_bf16_f32 v228, v48, v64
  v_mfma_f32_32x32x16_bf16 v[72:87], v[112:115], a[232:235], v[72:87]
  v_cvt_pk_bf16_f32 v230, v49, v65
  v_permlane16_swap_b32 v224, v226
  v_bfi_b32 v220, v254, s42, v220
  v_cvt_pk_bf16_f32 v232, v50, v66
  v_cvt_pk_bf16_f32 v234, v51, v67
  v_mfma_f32_32x32x16_bf16 v[88:103], v[112:115], a[236:239], v[88:103]
  v_permlane16_swap_b32 v228, v230
  v_bfi_b32 v224, v254, s42, v224
  v_cvt_pk_bf16_f32 v236, v52, v68
  v_cvt_pk_bf16_f32 v238, v53, v69
  v_mfma_f32_32x32x16_bf16 v[72:87], v[116:119], a[248:251], v[72:87]
  v_permlane16_swap_b32 v232, v234
  v_bfi_b32 v228, v254, s42, v228
  v_cvt_pk_bf16_f32 v240, v54, v70
  v_cvt_pk_bf16_f32 v242, v55, v71
  v_permlane16_swap_b32 v236, v238
  v_mfma_f32_32x32x16_bf16 v[88:103], v[116:119], a[252:255], v[88:103]
  v_bfi_b32 v232, v254, s42, v232
  v_permlane16_swap_b32 v240, v242
  v_bfi_b32 v236, v254, s42, v236
  v_bfi_b32 v240, v254, s42, v240
  s_nop 7
  v_cvt_pk_bf16_f32 v213, v72, v88
  v_cvt_pk_bf16_f32 v215, v73, v89
  v_cvt_pk_bf16_f32 v217, v74, v90
  v_cvt_pk_bf16_f32 v219, v75, v91
  s_add_u32 s78, s86, 0
  v_permlane16_swap_b32 v213, v215
  buffer_store_dwordx4 v[212:215], v4, s[4:7], s78 offen
  v_cvt_pk_bf16_f32 v221, v76, v92
  v_cvt_pk_bf16_f32 v223, v77, v93
  s_add_u32 s78, s86, 32768
  v_permlane16_swap_b32 v217, v219
  buffer_store_dwordx4 v[216:219], v4, s[4:7], s78 offen
  v_cvt_pk_bf16_f32 v225, v78, v94
  v_cvt_pk_bf16_f32 v227, v79, v95
  s_add_u32 s78, s86, 131072
  v_permlane16_swap_b32 v221, v223
  buffer_store_dwordx4 v[220:223], v4, s[4:7], s78 offen
  v_cvt_pk_bf16_f32 v229, v80, v96
  v_cvt_pk_bf16_f32 v231, v81, v97
  s_add_u32 s78, s86, 163840
  v_permlane16_swap_b32 v225, v227
  buffer_store_dwordx4 v[224:227], v4, s[4:7], s78 offen
  v_cvt_pk_bf16_f32 v233, v82, v98
  v_cvt_pk_bf16_f32 v235, v83, v99
  s_add_u32 s78, s86, 262144
  v_permlane16_swap_b32 v229, v231
  buffer_store_dwordx4 v[228:231], v4, s[4:7], s78 offen
  v_cvt_pk_bf16_f32 v237, v84, v100
  v_cvt_pk_bf16_f32 v239, v85, v101
  s_add_u32 s78, s86, 294912
  v_permlane16_swap_b32 v233, v235
  buffer_store_dwordx4 v[232:235], v4, s[4:7], s78 offen
  v_cvt_pk_bf16_f32 v241, v86, v102
  v_cvt_pk_bf16_f32 v243, v87, v103
  s_add_u32 s78, s86, 393216
  v_permlane16_swap_b32 v237, v239
  buffer_store_dwordx4 v[236:239], v4, s[4:7], s78 offen
  s_add_u32 s78, s86, 425984
  v_permlane16_swap_b32 v241, v243
  buffer_store_dwordx4 v[240:243], v4, s[4:7], s78 offen
  s_branch o_we_153
o_wr1_151:
  s_nop 3
  v_mul_f32 v112, s24, v112
  v_mul_f32 v113, s24, v113
  v_exp_f32 v64, v112
  v_exp_f32 v65, v113
  v_max_f32 v116, v111, v116
  v_max3_f32 v116, v112, v113, v116
  v_add_f32 v117, v117, v64
  v_add_f32 v118, v118, v65
  v_add_f32 v117, v117, v118
  s_mov_b32 s28, 0x21800000
  v_mov_b32 v118, v117
  s_nop 1
  v_permlane16_swap_b32 v117, v118
  v_add_f32 v117, v117, v118
  v_mov_b32 v118, v117
  s_nop 0
  s_nop 0
  v_permlane32_swap_b32 v117, v118
  v_add_f32 v117, v117, v118
  s_mov_b32 s67, 0
  s_mov_b64 vcc, 0
  s_waitcnt vmcnt(3)
o_pl_159:
  v_and_b32 v7, 1, v7
  v_cmp_ne_u32 vcc, s96, v7
  s_cbranch_vccz o_pk_160
  buffer_load_dword v7, v255, s[4:7], s97 offen sc1
  s_add_u32 s67, s67, 1
  s_cmp_gt_u32 s67, 1048576
  s_cbranch_scc1 L_end
  s_waitcnt vmcnt(0)
  s_branch o_pl_159
o_pk_160:
  s_lshl_b32 s94, s43, 14
  s_add_u32 s94, s94, s95
  buffer_load_dwordx4 v[120:123], v5, s[4:7], s94 offen offset:0 sc1
  v_cmp_lt_f32 vcc, 0x42700000, v116
  v_cmp_gt_f32 s[30:31], s28, v117
  v_rcp_f32 v117, v117
  buffer_load_dwordx4 v[124:127], v5, s[4:7], s94 offen offset:512 sc1
  s_or_b64 vcc, vcc, s[30:31]
  s_cbranch_vccnz o_fb_157
o_fbr_158:
  buffer_load_dwordx4 v[128:131], v5, s[4:7], s94 offen offset:256 sc1
  v_pk_mul_f32 v[56:57], v[56:57], v[116:117] op_sel:[0,1] op_sel_hi:[1,1]
  v_pk_mul_f32 v[58:59], v[58:59], v[116:117] op_sel:[0,1] op_sel_hi:[1,1]
  v_pk_mul_f32 v[60:61], v[60:61], v[116:117] op_sel:[0,1] op_sel_hi:[1,1]
  v_pk_mul_f32 v[62:63], v[62:63], v[116:117] op_sel:[0,1] op_sel_hi:[1,1]
  v_pk_mul_f32 v[64:65], v[64:65], v[116:117] op_sel:[0,1] op_sel_hi:[1,1]
  buffer_load_dwordx4 v[132:135], v5, s[4:7], s94 offen offset:768 sc1
  v_cvt_pk_bf16_f32 v116, v56, v57
  v_cvt_pk_bf16_f32 v117, v58, v59
  v_cvt_pk_bf16_f32 v118, v60, v61
  v_cvt_pk_bf16_f32 v119, v62, v63
  s_waitcnt lgkmcnt(0)
  s_nop 0
  v_mfma_f32_16x16x32_bf16 v[72:75], v[152:155], v[116:119], 0
  s_add_u32 s62, s62, 1
  v_cvt_pk_bf16_f32 v197, v64, v65
  v_cvt_pk_bf16_f32 v198, v64, v65
  v_mfma_f32_16x16x32_bf16 v[76:79], v[156:159], v[116:119], 0
  s_add_u32 s94, s94, 4096
  buffer_load_dwordx4 v[136:139], v5, s[4:7], s94 offen offset:0 sc1
  s_xor_b32 s86, s86, 524288
  v_mfma_f32_16x16x32_bf16 v[80:83], v[160:163], v[116:119], 0
  s_bfe_u32 s42, s62, 0x10001
  v_mfma_f32_16x16x32_bf16 v[84:87], v[164:167], v[116:119], 0
  buffer_load_dwordx4 v[140:143], v5, s[4:7], s94 offen offset:512 sc1
  v_mfma_f32_16x16x32_bf16 v[88:91], v[168:171], v[116:119], 0
  v_mfma_f32_16x16x32_bf16 v[92:95], v[172:175], v[116:119], 0
  buffer_load_dwordx4 v[144:147], v5, s[4:7], s94 offen offset:256 sc1
  v_mfma_f32_16x16x32_bf16 v[96:99], v[176:179], v[116:119], 0
  v_mfma_f32_16x16x32_bf16 v[100:103], v[180:183], v[116:119], 0
  buffer_load_dwordx4 v[148:151], v5, s[4:7], s94 offen offset:768 sc1
  v_mfma_f32_16x16x16_bf16 v[72:75], v[200:201], v[198:199], v[72:75]
  s_nop 1
  v_mfma_f32_16x16x16_bf16 v[76:79], v[200:201], v[196:197], v[76:79]
  s_add_u32 s94, s94, 4096
  buffer_load_dwordx4 v[152:155], v5, s[4:7], s94 offen offset:0 sc1
  v_mfma_f32_16x16x16_bf16 v[80:83], v[202:203], v[198:199], v[80:83]
  s_nop 1
  v_mfma_f32_16x16x16_bf16 v[84:87], v[202:203], v[196:197], v[84:87]
  buffer_load_dwordx4 v[156:159], v5, s[4:7], s94 offen offset:512 sc1
  v_mfma_f32_16x16x16_bf16 v[88:91], v[204:205], v[198:199], v[88:91]
  s_nop 0
  v_cvt_pk_bf16_f32 v40, v72, v73
  v_cvt_pk_bf16_f32 v41, v74, v75
  v_mfma_f32_16x16x16_bf16 v[92:95], v[204:205], v[196:197], v[92:95]
  buffer_load_dwordx4 v[160:163], v5, s[4:7], s94 offen offset:256 sc1
  v_cvt_pk_bf16_f32 v42, v76, v77
  v_cvt_pk_bf16_f32 v43, v78, v79
  v_mfma_f32_16x16x16_bf16 v[96:99], v[206:207], v[198:199], v[96:99]
  s_nop 0
  ds_write_b128 v6, v[40:43] offset:0
  v_cvt_pk_bf16_f32 v44, v80, v81
  v_mfma_f32_16x16x16_bf16 v[100:103], v[206:207], v[196:197], v[100:103]
  buffer_load_dwordx4 v[164:167], v5, s[4:7], s94 offen offset:768 sc1
  v_cvt_pk_bf16_f32 v45, v82, v83
  v_cvt_pk_bf16_f32 v46, v84, v85
  v_cvt_pk_bf16_f32 v47, v86, v87
  ds_write_b128 v6, v[44:47] offset:1024
  v_cvt_pk_bf16_f32 v48, v88, v89
  v_cvt_pk_bf16_f32 v49, v90, v91
  v_cvt_pk_bf16_f32 v50, v92, v93
  v_cvt_pk_bf16_f32 v51, v94, v95
  s_add_u32 s94, s94, 4096
  buffer_load_dwordx4 v[168:171], v5, s[4:7], s94 offen offset:0 sc1
  ds_write_b128 v6, v[48:51] offset:2048
  v_cvt_pk_bf16_f32 v52, v96, v97
  v_cvt_pk_bf16_f32 v53, v98, v99
  v_cvt_pk_bf16_f32 v54, v100, v101
  v_cvt_pk_bf16_f32 v55, v102, v103
  ds_write_b128 v6, v[52:55] offset:3072
  buffer_load_dwordx4 v[172:175], v5, s[4:7], s94 offen offset:512 sc1
  s_and_b32 s26, s65, 49152
  s_cbranch_scc1 o_wr2_152
  s_waitcnt lgkmcnt(0)
  s_barrier
  ds_read_b128 v[104:107], v3 offset:0
  ds_read_b128 v[108:111], v3 offset:512
  ds_read_b128 v[112:115], v3 offset:1024
  buffer_load_dwordx4 v[176:179], v5, s[4:7], s94 offen offset:256 sc1
  buffer_load_dwordx4 v[180:183], v5, s[4:7], s94 offen offset:768 sc1
  s_waitcnt lgkmcnt(2)
  v_mfma_f32_32x32x16_bf16 v[40:55], v[104:107], a[0:3], 0
  v_mov_b64 v[188:189], 0
  v_mov_b64 v[190:191], 0
  v_mov_b64 v[192:193], 0
  v_mov_b64 v[194:195], 0
  s_mov_b64 exec, 1
  buffer_store_dword v38, off, s[4:7], s84 sc1
  s_mov_b64 exec, -1
  s_mov_b32 s84, 268435456
  v_mfma_f32_32x32x16_bf16 v[56:71], v[104:107], a[4:7], 0
  ds_read_b128 v[116:119], v3 offset:1536
  v_mfma_f32_32x32x16_bf16 v[72:87], v[104:107], a[8:11], 0
  v_mfma_f32_32x32x16_bf16 v[88:103], v[104:107], a[12:15], 0
  s_waitcnt vmcnt(13)
  v_xor_b32 v7, s96, v120
  v_bitop3_b32 v7, v7, v124, s96 bitop3:0xf6
  v_bitop3_b32 v7, v7, v128, s96 bitop3:0xf6
  v_bitop3_b32 v7, v7, v132, s96 bitop3:0xf6
  s_waitcnt lgkmcnt(2)
  v_mfma_f32_32x32x16_bf16 v[40:55], v[108:111], a[16:19], v[40:55]
  s_waitcnt vmcnt(9)
  v_bitop3_b32 v7, v7, v136, s96 bitop3:0xf6
  v_bitop3_b32 v7, v7, v140, s96 bitop3:0xf6
  v_bitop3_b32 v7, v7, v144, s96 bitop3:0xf6
  v_bitop3_b32 v7, v7, v148, s96 bitop3:0xf6
  s_waitcnt vmcnt(5)
  v_mfma_f32_32x32x16_bf16 v[56:71], v[108:111], a[20:23], v[56:71]
  ds_read_b128 v[104:107], v3 offset:2048
  v_bitop3_b32 v7, v7, v152, s96 bitop3:0xf6
  v_bitop3_b32 v7, v7, v156, s96 bitop3:0xf6
  v_bitop3_b32 v7, v7, v160, s96 bitop3:0xf6
  v_bitop3_b32 v7, v7, v164, s96 bitop3:0xf6
  s_waitcnt vmcnt(1)
  v_mfma_f32_32x32x16_bf16 v[72:87], v[108:111], a[24:27], v[72:87]
  v_bitop3_b32 v7, v7, v168, s96 bitop3:0xf6
  v_bitop3_b32 v7, v7, v172, s96 bitop3:0xf6
  v_bitop3_b32 v7, v7, v176, s96 bitop3:0xf6
  v_bitop3_b32 v7, v7, v180, s96 bitop3:0xf6
  v_and_b32 v7, v254, v7
  v_cmp_ne_u32 vcc, 0, v7
  s_cbranch_vccnz o_rt_161
o_bk_162:
  v_mfma_f32_32x32x16_bf16 v[88:103], v[108:111], a[28:31], v[88:103]
  v_smfmac_f32_16x16x64_bf16 v[188:191], v[16:19], v[120:127], v20
  v_lshlrev_b32 v196, 16, v184
  v_smfmac_f32_16x16x64_bf16 v[192:195], v[16:19], v[128:135], v20
  v_and_b32 v197, 0xffff0000, v184
  v_smfmac_f32_16x16x64_bf16 v[188:191], v[16:19], v[136:143], v20
  v_lshlrev_b32 v198, 16, v185
  s_waitcnt lgkmcnt(2)
  v_mfma_f32_32x32x16_bf16 v[40:55], v[112:115], a[32:35], v[40:55]
  v_smfmac_f32_16x16x64_bf16 v[192:195], v[16:19], v[144:151], v20
  v_and_b32 v199, 0xffff0000, v185
  v_smfmac_f32_16x16x64_bf16 v[188:191], v[16:19], v[152:159], v20
  v_lshlrev_b32 v200, 16, v186
  v_smfmac_f32_16x16x64_bf16 v[192:195], v[16:19], v[160:167], v20
  v_and_b32 v201, 0xffff0000, v186
  v_mfma_f32_32x32x16_bf16 v[56:71], v[112:115], a[36:39], v[56:71]
  ds_read_b128 v[108:111], v3 offset:2560
  v_smfmac_f32_16x16x64_bf16 v[188:191], v[16:19], v[168:175], v20
  v_lshlrev_b32 v202, 16, v187
  v_smfmac_f32_16x16x64_bf16 v[192:195], v[16:19], v[176:183], v20
  v_and_b32 v203, 0xffff0000, v187
  s_bfe_u32 s92, s65, 131086
  v_mfma_f32_32x32x16_bf16 v[72:87], v[112:115], a[40:43], v[72:87]
  s_lshl_b32 s92, s92, 21
  s_add_u32 s92, s92, s91
  s_add_u32 s93, s92, 27262976
  s_add_u32 s92, s92, 20971520
  v_permlane16_swap_b32 v188, v192
  v_mfma_f32_32x32x16_bf16 v[88:103], v[112:115], a[44:47], v[88:103]
  v_permlane16_swap_b32 v189, v193
  v_permlane16_swap_b32 v190, v194
  v_permlane16_swap_b32 v191, v195
  s_waitcnt lgkmcnt(2)
  v_mfma_f32_32x32x16_bf16 v[40:55], v[116:119], a[48:51], v[40:55]
  v_cvt_pk_bf16_f32 v188, 0, v188
  v_cvt_pk_bf16_f32 v189, 0, v189
  v_cvt_pk_bf16_f32 v190, 0, v190
  v_cvt_pk_bf16_f32 v191, 0, v191
  v_cvt_pk_bf16_f32 v192, 0, v192
  v_cvt_pk_bf16_f32 v193, 0, v193
  v_mfma_f32_32x32x16_bf16 v[56:71], v[116:119], a[52:55], v[56:71]
  ds_read_b128 v[112:115], v3 offset:3072
  v_cvt_pk_bf16_f32 v194, 0, v194
  v_cvt_pk_bf16_f32 v195, 0, v195
  v_add_f32 v196, v196, v188
  v_add_f32 v197, v197, v189
  v_add_f32 v198, v198, v190
  v_mfma_f32_32x32x16_bf16 v[72:87], v[116:119], a[56:59], v[72:87]
  v_add_f32 v199, v199, v191
  v_add_f32 v200, v200, v192
  v_add_f32 v201, v201, v193
  v_add_f32 v202, v202, v194
  v_add_f32 v203, v203, v195
  v_cvt_pk_bf16_f32 v120, v196, v197
  v_mfma_f32_32x32x16_bf16 v[88:103], v[116:119], a[60:63], v[88:103]
  v_cvt_pk_bf16_f32 v121, v198, v199
  v_cvt_pk_bf16_f32 v122, v200, v201
  v_cvt_pk_bf16_f32 v123, v202, v203
  v_lshlrev_b32 v196, 16, v120
  v_and_b32 v197, 0xffff0000, v120
  s_waitcnt lgkmcnt(2)
  v_mfma_f32_32x32x16_bf16 v[40:55], v[104:107], a[64:67], v[40:55]
  v_lshlrev_b32 v198, 16, v121
  v_and_b32 v199, 0xffff0000, v121
  v_lshlrev_b32 v200, 16, v122
  v_and_b32 v201, 0xffff0000, v122
  v_lshlrev_b32 v202, 16, v123
  v_and_b32 v203, 0xffff0000, v123
  v_mfma_f32_32x32x16_bf16 v[56:71], v[104:107], a[68:71], v[56:71]
  ds_read_b128 v[116:119], v3 offset:3584
  buffer_store_dwordx4 v[120:123], v0, s[4:7], s92 offen sc1
  v_add_f32 v136, v196, v197
  v_mul_f32 v137, v196, v196
  v_mfma_f32_32x32x16_bf16 v[72:87], v[104:107], a[72:75], v[72:87]
  v_add_f32 v138, v198, v199
  v_mul_f32 v139, v197, v197
  v_fmac_f32 v137, v198, v198
  v_fmac_f32 v139, v199, v199
  v_add_f32 v136, v136, v200
  v_fmac_f32 v137, v200, v200
  v_mfma_f32_32x32x16_bf16 v[88:103], v[104:107], a[76:79], v[88:103]
  v_add_f32 v138, v138, v201
  v_fmac_f32 v139, v201, v201
  v_add_f32 v136, v136, v202
  v_fmac_f32 v137, v202, v202
  v_add_f32 v138, v138, v203
  s_waitcnt lgkmcnt(2)
  v_mfma_f32_32x32x16_bf16 v[40:55], v[108:111], a[80:83], v[40:55]
  v_fmac_f32 v139, v203, v203
  v_add_f32 v136, v136, v138
  v_add_f32 v137, v137, v139
  s_nop 0
  v_add_f32_dpp v136, v136, v136 row_ror:8 row_mask:0xf bank_mask:0xf
  v_add_f32_dpp v137, v137, v137 row_ror:8 row_mask:0xf bank_mask:0xf
  s_nop 0
  v_add_f32_dpp v136, v136, v136 row_ror:4 row_mask:0xf bank_mask:0xf
  v_mfma_f32_32x32x16_bf16 v[56:71], v[108:111], a[84:87], v[56:71]
  ds_read_b128 v[104:107], v3 offset:8192
  v_add_f32_dpp v137, v137, v137 row_ror:4 row_mask:0xf bank_mask:0xf
  v_add_f32_dpp v136, v136, v136 row_ror:2 row_mask:0xf bank_mask:0xf
  s_nop 0
  v_add_f32_dpp v137, v137, v137 row_ror:2 row_mask:0xf bank_mask:0xf
  v_add_f32_dpp v136, v136, v136 row_ror:1 row_mask:0xf bank_mask:0xf
  s_nop 0
  v_add_f32_dpp v137, v137, v137 row_ror:1 row_mask:0xf bank_mask:0xf
  v_mfma_f32_32x32x16_bf16 v[72:87], v[108:111], a[88:91], v[72:87]
  v_mov_b32 v140, v136
  v_mov_b32 v141, v137
  s_nop 0
  v_permlane16_swap_b32 v136, v140
  v_permlane16_swap_b32 v137, v141
  v_mfma_f32_32x32x16_bf16 v[88:103], v[108:111], a[92:95], v[88:103]
  v_add_f32 v136, v136, v140
  v_add_f32 v137, v137, v141
  v_mov_b32 v140, v136
  v_mov_b32 v141, v137
  s_nop 0
  v_permlane32_swap_b32 v136, v140
  s_waitcnt lgkmcnt(2)
  v_mfma_f32_32x32x16_bf16 v[40:55], v[112:115], a[96:99], v[40:55]
  v_permlane32_swap_b32 v137, v141
  v_add_f32 v136, v136, v140
  v_add_f32 v137, v137, v141
  v_mul_f32 v136, 0x3b000000, v136
  v_mul_f32 v137, 0x3b000000, v137
  v_mfma_f32_32x32x16_bf16 v[56:71], v[112:115], a[100:103], v[56:71]
  ds_read_b128 v[108:111], v3 offset:8704
  v_fma_f32 v137, -v136, v136, v137
  v_cvt_pk_bf16_f32 v136, 0, v136
  v_max_f32 v137, 0, v137
  v_sub_f32 v140, v196, v136
  v_sub_f32 v141, v197, v136
  v_mfma_f32_32x32x16_bf16 v[72:87], v[112:115], a[104:107], v[72:87]
  v_cvt_pk_bf16_f32 v137, 0, v137
  v_sub_f32 v142, v198, v136
  v_sub_f32 v143, v199, v136
  v_add_f32 v137, 0x3727c5ac, v137
  v_sub_f32 v144, v200, v136
  v_sub_f32 v145, v201, v136
  v_mfma_f32_32x32x16_bf16 v[88:103], v[112:115], a[108:111], v[88:103]
  v_cvt_pk_bf16_f32 v137, 0, v137
  v_sub_f32 v146, v202, v136
  v_sub_f32 v147, v203, v136
  v_sqrt_f32 v137, v137
  s_waitcnt lgkmcnt(2)
  v_mfma_f32_32x32x16_bf16 v[40:55], v[116:119], a[112:115], v[40:55]
  v_cvt_pk_bf16_f32 v140, 0, v140
  v_cvt_pk_bf16_f32 v141, 0, v141
  v_cvt_pk_bf16_f32 v137, 0, v137
  v_cvt_pk_bf16_f32 v142, 0, v142
  v_cvt_pk_bf16_f32 v143, 0, v143
  v_rcp_f32 v137, v137
  v_mfma_f32_32x32x16_bf16 v[56:71], v[116:119], a[116:119], v[56:71]
  ds_read_b128 v[112:115], v3 offset:9216
  v_cvt_pk_bf16_f32 v144, 0, v144
  v_cvt_pk_bf16_f32 v145, 0, v145
  v_cvt_pk_bf16_f32 v146, 0, v146
  v_cvt_pk_bf16_f32 v147, 0, v147
  v_mul_f32 v140, v140, v137
  v_mfma_f32_32x32x16_bf16 v[72:87], v[116:119], a[120:123], v[72:87]
  v_mul_f32 v141, v141, v137
  v_mul_f32 v142, v142, v137
  v_mul_f32 v143, v143, v137
  v_mul_f32 v144, v144, v137
  v_mul_f32 v145, v145, v137
  v_mul_f32 v146, v146, v137
  v_mfma_f32_32x32x16_bf16 v[88:103], v[116:119], a[124:127], v[88:103]
  v_mul_f32 v147, v147, v137
  v_cvt_pk_bf16_f32 v124, v140, v141
  v_cvt_pk_bf16_f32 v125, v142, v143
  v_cvt_pk_bf16_f32 v126, v144, v145
  v_cvt_pk_bf16_f32 v127, v146, v147
  s_waitcnt lgkmcnt(2)
  v_mfma_f32_32x32x16_bf16 v[40:55], v[104:107], a[128:131], v[40:55]
  v_lshlrev_b32 v204, 16, v124
  v_and_b32 v205, 0xffff0000, v124
  v_lshlrev_b32 v206, 16, v125
  v_and_b32 v207, 0xffff0000, v125
  v_lshlrev_b32 v208, 16, v126
  v_and_b32 v209, 0xffff0000, v126
  v_mfma_f32_32x32x16_bf16 v[56:71], v[104:107], a[132:135], v[56:71]
  ds_read_b128 v[116:119], v3 offset:9728
  v_lshlrev_b32 v210, 16, v127
  v_and_b32 v211, 0xffff0000, v127
  buffer_store_dwordx4 v[124:127], v0, s[4:7], s93 offen sc1
  v_mfma_f32_32x32x16_bf16 v[72:87], v[104:107], a[136:139], v[72:87]
  v_add_f32 v196, v196, v204
  v_add_f32 v197, v197, v205
  v_add_f32 v198, v198, v206
  v_add_f32 v199, v199, v207
  v_add_f32 v200, v200, v208
  v_add_f32 v201, v201, v209
  v_mfma_f32_32x32x16_bf16 v[88:103], v[104:107], a[140:143], v[88:103]
  v_add_f32 v202, v202, v210
  v_add_f32 v203, v203, v211
  v_cvt_pk_bf16_f32 v128, v196, v197
  v_cvt_pk_bf16_f32 v129, v198, v199
  v_cvt_pk_bf16_f32 v130, v200, v201
  s_waitcnt lgkmcnt(2)
  v_mfma_f32_32x32x16_bf16 v[40:55], v[108:111], a[144:147], v[40:55]
  v_cvt_pk_bf16_f32 v131, v202, v203
  v_mul_f32 v188, v204, v8
  v_mul_f32 v189, v205, v9
  v_fmac_f32 v188, v206, v10
  v_fmac_f32 v189, v207, v11
  v_fmac_f32 v188, v208, v12
  v_mfma_f32_32x32x16_bf16 v[56:71], v[108:111], a[148:151], v[56:71]
  ds_read_b128 v[104:107], v3 offset:10240
  v_fmac_f32 v189, v209, v13
  v_fmac_f32 v188, v210, v14
  v_fmac_f32 v189, v211, v15
  v_add_f32 v188, v188, v189
  s_add_u32 s92, s91, 10485760
  v_mfma_f32_32x32x16_bf16 v[72:87], v[108:111], a[152:155], v[72:87]
  s_add_u32 s93, s91, 8388608
  buffer_store_dwordx4 v[128:131], v0, s[4:7], s92 offen sc1
  v_lshlrev_b32 v196, 16, v128
  v_and_b32 v197, 0xffff0000, v128
  v_mfma_f32_32x32x16_bf16 v[88:103], v[108:111], a[156:159], v[88:103]
  v_lshlrev_b32 v198, 16, v129
  v_and_b32 v199, 0xffff0000, v129
  v_lshlrev_b32 v200, 16, v130
  v_and_b32 v201, 0xffff0000, v130
  v_lshlrev_b32 v202, 16, v131
  s_waitcnt lgkmcnt(2)
  v_mfma_f32_32x32x16_bf16 v[40:55], v[112:115], a[160:163], v[40:55]
  v_and_b32 v203, 0xffff0000, v131
  v_add_f32 v136, v196, v197
  v_mul_f32 v137, v196, v196
  v_add_f32 v138, v198, v199
  v_mul_f32 v139, v197, v197
  v_fmac_f32 v137, v198, v198
  v_mfma_f32_32x32x16_bf16 v[56:71], v[112:115], a[164:167], v[56:71]
  ds_read_b128 v[108:111], v3 offset:10752
  v_fmac_f32 v139, v199, v199
  v_add_f32 v136, v136, v200
  v_fmac_f32 v137, v200, v200
  v_add_f32 v138, v138, v201
  v_fmac_f32 v139, v201, v201
  v_mfma_f32_32x32x16_bf16 v[72:87], v[112:115], a[168:171], v[72:87]
  v_add_f32 v136, v136, v202
  v_fmac_f32 v137, v202, v202
  v_add_f32 v138, v138, v203
  v_fmac_f32 v139, v203, v203
  v_add_f32 v136, v136, v138
  v_add_f32 v137, v137, v139
  v_mfma_f32_32x32x16_bf16 v[88:103], v[112:115], a[172:175], v[88:103]
  v_add_f32_dpp v136, v136, v136 row_ror:8 row_mask:0xf bank_mask:0xf
  v_add_f32_dpp v137, v137, v137 row_ror:8 row_mask:0xf bank_mask:0xf
  v_add_f32_dpp v188, v188, v188 row_ror:8 row_mask:0xf bank_mask:0xf
  v_add_f32_dpp v136, v136, v136 row_ror:4 row_mask:0xf bank_mask:0xf
  v_add_f32_dpp v137, v137, v137 row_ror:4 row_mask:0xf bank_mask:0xf
  s_waitcnt lgkmcnt(2)
  v_mfma_f32_32x32x16_bf16 v[40:55], v[116:119], a[176:179], v[40:55]
  v_add_f32_dpp v188, v188, v188 row_ror:4 row_mask:0xf bank_mask:0xf
  v_add_f32_dpp v136, v136, v136 row_ror:2 row_mask:0xf bank_mask:0xf
  v_add_f32_dpp v137, v137, v137 row_ror:2 row_mask:0xf bank_mask:0xf
  v_add_f32_dpp v188, v188, v188 row_ror:2 row_mask:0xf bank_mask:0xf
  v_add_f32_dpp v136, v136, v136 row_ror:1 row_mask:0xf bank_mask:0xf
  v_add_f32_dpp v137, v137, v137 row_ror:1 row_mask:0xf bank_mask:0xf
  v_mfma_f32_32x32x16_bf16 v[56:71], v[116:119], a[180:183], v[56:71]
  ds_read_b128 v[112:115], v3 offset:11264
  v_add_f32_dpp v188, v188, v188 row_ror:1 row_mask:0xf bank_mask:0xf
  v_mov_b32 v140, v136
  v_mov_b32 v141, v137
  v_mov_b32 v142, v188
  v_permlane16_swap_b32 v136, v140
  v_mfma_f32_32x32x16_bf16 v[72:87], v[116:119], a[184:187], v[72:87]
  v_permlane16_swap_b32 v137, v141
  v_permlane16_swap_b32 v188, v142
  v_add_f32 v136, v136, v140
  v_add_f32 v137, v137, v141
  v_mfma_f32_32x32x16_bf16 v[88:103], v[116:119], a[188:191], v[88:103]
  v_add_f32 v188, v188, v142
  v_mov_b32 v140, v136
  v_mov_b32 v141, v137
  v_mov_b32 v142, v188
  v_permlane32_swap_b32 v136, v140
  s_waitcnt lgkmcnt(2)
  v_mfma_f32_32x32x16_bf16 v[40:55], v[104:107], a[192:195], v[40:55]
  v_permlane32_swap_b32 v137, v141
  v_permlane32_swap_b32 v188, v142
  v_add_f32 v136, v136, v140
  v_add_f32 v137, v137, v141
  v_mfma_f32_32x32x16_bf16 v[56:71], v[104:107], a[196:199], v[56:71]
  ds_read_b128 v[116:119], v3 offset:11776
  v_add_f32 v188, v188, v142
  v_mul_f32 v136, 0x3b000000, v136
  v_mul_f32 v137, 0x3b000000, v137
  v_fma_f32 v137, -v136, v136, v137
  v_cvt_pk_bf16_f32 v136, 0, v136
  s_waitcnt lgkmcnt(2)
  v_mfma_f32_32x32x16_bf16 v[40:55], v[108:111], a[208:211], v[40:55]
  v_max_f32 v137, 0, v137
  v_sub_f32 v140, v196, v136
  v_sub_f32 v141, v197, v136
  v_cvt_pk_bf16_f32 v137, 0, v137
  v_sub_f32 v142, v198, v136
  v_sub_f32 v143, v199, v136
  v_mfma_f32_32x32x16_bf16 v[56:71], v[108:111], a[212:215], v[56:71]
  v_add_f32 v137, 0x3727c5ac, v137
  v_sub_f32 v144, v200, v136
  v_sub_f32 v145, v201, v136
  v_cvt_pk_bf16_f32 v137, 0, v137
  v_sub_f32 v146, v202, v136
  v_sub_f32 v147, v203, v136
  s_waitcnt lgkmcnt(1)
  v_mfma_f32_32x32x16_bf16 v[40:55], v[112:115], a[224:227], v[40:55]
  v_sqrt_f32 v137, v137
  v_cvt_pk_bf16_f32 v140, 0, v140
  v_cvt_pk_bf16_f32 v141, 0, v141
  v_cvt_pk_bf16_f32 v137, 0, v137
  v_cvt_pk_bf16_f32 v142, 0, v142
  v_mfma_f32_32x32x16_bf16 v[56:71], v[112:115], a[228:231], v[56:71]
  v_cvt_pk_bf16_f32 v143, 0, v143
  v_rcp_f32 v137, v137
  v_cvt_pk_bf16_f32 v144, 0, v144
  v_cvt_pk_bf16_f32 v145, 0, v145
  v_cvt_pk_bf16_f32 v146, 0, v146
  s_waitcnt lgkmcnt(0)
  v_mfma_f32_32x32x16_bf16 v[40:55], v[116:119], a[240:243], v[40:55]
  v_cvt_pk_bf16_f32 v147, 0, v147
  v_mul_f32 v140, v140, v137
  v_mul_f32 v141, v141, v137
  v_mul_f32 v142, v142, v137
  v_mul_f32 v143, v143, v137
  v_mul_f32 v144, v144, v137
  v_mfma_f32_32x32x16_bf16 v[56:71], v[116:119], a[244:247], v[56:71]
  v_mul_f32 v145, v145, v137
  v_mul_f32 v146, v146, v137
  v_mul_f32 v147, v147, v137
  v_cvt_pk_bf16_f32 v132, v140, v141
  v_cvt_pk_bf16_f32 v133, v142, v143
  v_cvt_pk_bf16_f32 v134, v144, v145
  v_mfma_f32_32x32x16_bf16 v[72:87], v[104:107], a[200:203], v[72:87]
  v_cvt_pk_bf16_f32 v135, v146, v147
  buffer_store_dwordx4 v[132:135], v0, s[4:7], s93 offen sc1
  v_cvt_pk_bf16_f32 v188, 0, v188
  v_ashrrev_i32 v189, 31, v188
  v_mfma_f32_32x32x16_bf16 v[88:103], v[104:107], a[204:207], v[88:103]
  v_or_b32 v189, 0x80000000, v189
  v_xor_b32 v188, v188, v189
  s_sub_u32 s92, 4095, s90
  v_and_b32 v188, 0xffff0000, v188
  v_or_b32 v38, s92, v188
  v_mfma_f32_32x32x16_bf16 v[72:87], v[108:111], a[216:219], v[72:87]
  s_bfe_u32 s92, s65, 196625
  s_lshl_b32 s92, s92, 18
  s_lshl_b32 s93, s90, 7
  s_add_u32 s92, s92, s93
  s_add_u32 s84, s92, 243269632
  v_cvt_pk_bf16_f32 v212, v40, v56
  v_mfma_f32_32x32x16_bf16 v[88:103], v[108:111], a[220:223], v[88:103]
  v_cvt_pk_bf16_f32 v214, v41, v57
  v_cvt_pk_bf16_f32 v216, v42, v58
  v_cvt_pk_bf16_f32 v218, v43, v59
  v_permlane16_swap_b32 v212, v214
  v_mfma_f32_32x32x16_bf16 v[72:87], v[112:115], a[232:235], v[72:87]
  v_cvt_pk_bf16_f32 v220, v44, v60
  v_cvt_pk_bf16_f32 v222, v45, v61
  v_permlane16_swap_b32 v216, v218
  v_bfi_b32 v212, v254, s42, v212
  v_cvt_pk_bf16_f32 v224, v46, v62
  v_mfma_f32_32x32x16_bf16 v[88:103], v[112:115], a[236:239], v[88:103]
  v_cvt_pk_bf16_f32 v226, v47, v63
  v_permlane16_swap_b32 v220, v222
  v_bfi_b32 v216, v254, s42, v216
  v_cvt_pk_bf16_f32 v228, v48, v64
  v_mfma_f32_32x32x16_bf16 v[72:87], v[116:119], a[248:251], v[72:87]
  v_cvt_pk_bf16_f32 v230, v49, v65
  v_permlane16_swap_b32 v224, v226
  v_bfi_b32 v220, v254, s42, v220
  v_cvt_pk_bf16_f32 v232, v50, v66
  v_cvt_pk_bf16_f32 v234, v51, v67
  v_mfma_f32_32x32x16_bf16 v[88:103], v[116:119], a[252:255], v[88:103]
  v_permlane16_swap_b32 v228, v230
  v_bfi_b32 v224, v254, s42, v224
  v_cvt_pk_bf16_f32 v236, v52, v68
  v_cvt_pk_bf16_f32 v238, v53, v69
  v_permlane16_swap_b32 v232, v234
  v_bfi_b32 v228, v254, s42, v228
  v_cvt_pk_bf16_f32 v240, v54, v70
  v_cvt_pk_bf16_f32 v242, v55, v71
  v_permlane16_swap_b32 v236, v238
  v_bfi_b32 v232, v254, s42, v232
  v_permlane16_swap_b32 v240, v242
  v_bfi_b32 v236, v254, s42, v236
  v_bfi_b32 v240, v254, s42, v240
  v_cvt_pk_bf16_f32 v213, v72, v88
  v_cvt_pk_bf16_f32 v215, v73, v89
  v_cvt_pk_bf16_f32 v217, v74, v90
  v_cvt_pk_bf16_f32 v219, v75, v91
  s_add_u32 s78, s86, 0
  v_permlane16_swap_b32 v213, v215
  buffer_store_dwordx4 v[212:215], v4, s[4:7], s78 offen
  v_cvt_pk_bf16_f32 v221, v76, v92
  v_cvt_pk_bf16_f32 v223, v77, v93
  s_add_u32 s78, s86, 32768
  v_permlane16_swap_b32 v217, v219
  buffer_store_dwordx4 v[216:219], v4, s[4:7], s78 offen
  v_cvt_pk_bf16_f32 v225, v78, v94
  v_cvt_pk_bf16_f32 v227, v79, v95
  s_add_u32 s78, s86, 131072
  v_permlane16_swap_b32 v221, v223
  buffer_store_dwordx4 v[220:223], v4, s[4:7], s78 offen
  v_cvt_pk_bf16_f32 v229, v80, v96
  v_cvt_pk_bf16_f32 v231, v81, v97
  s_add_u32 s78, s86, 163840
  v_permlane16_swap_b32 v225, v227
  buffer_store_dwordx4 v[224:227], v4, s[4:7], s78 offen
  v_cvt_pk_bf16_f32 v233, v82, v98
  v_cvt_pk_bf16_f32 v235, v83, v99
  s_add_u32 s78, s86, 262144
  v_permlane16_swap_b32 v229, v231
  buffer_store_dwordx4 v[228:231], v4, s[4:7], s78 offen
  v_cvt_pk_bf16_f32 v237, v84, v100
  v_cvt_pk_bf16_f32 v239, v85, v101
  s_add_u32 s78, s86, 294912
  v_permlane16_swap_b32 v233, v235
  buffer_store_dwordx4 v[232:235], v4, s[4:7], s78 offen
  v_cvt_pk_bf16_f32 v241, v86, v102
  v_cvt_pk_bf16_f32 v243, v87, v103
  s_add_u32 s78, s86, 393216
  v_permlane16_swap_b32 v237, v239
  buffer_store_dwordx4 v[236:239], v4, s[4:7], s78 offen
  s_add_u32 s78, s86, 425984
  v_permlane16_swap_b32 v241, v243
  buffer_store_dwordx4 v[240:243], v4, s[4:7], s78 offen
  s_waitcnt vmcnt(8)
  s_mov_b64 exec, 1
  buffer_store_dword v38, off, s[4:7], s84 sc1
  s_mov_b64 exec, -1
  s_mov_b32 s84, 268435456
  s_branch o_we_153
o_rt_161:
  s_mov_b32 s67, 0
o_rl_165:
  s_lshl_b32 s94, s43, 14
  s_add_u32 s94, s94, s95
  buffer_load_dwordx4 v[120:123], v5, s[4:7], s94 offen offset:0 sc1
  buffer_load_dwordx4 v[124:127], v5, s[4:7], s94 offen offset:512 sc1
  buffer_load_dwordx4 v[128:131], v5, s[4:7], s94 offen offset:256 sc1
  buffer_load_dwordx4 v[132:135], v5, s[4:7], s94 offen offset:768 sc1
  s_add_u32 s94, s94, 4096
  buffer_load_dwordx4 v[136:139], v5, s[4:7], s94 offen offset:0 sc1
  buffer_load_dwordx4 v[140:143], v5, s[4:7], s94 offen offset:512 sc1
  buffer_load_dwordx4 v[144:147], v5, s[4:7], s94 offen offset:256 sc1
  buffer_load_dwordx4 v[148:151], v5, s[4:7], s94 offen offset:768 sc1
  s_add_u32 s94, s94, 4096
  buffer_load_dwordx4 v[152:155], v5, s[4:7], s94 offen offset:0 sc1
  buffer_load_dwordx4 v[156:159], v5, s[4:7], s94 offen offset:512 sc1
  buffer_load_dwordx4 v[160:163], v5, s[4:7], s94 offen offset:256 sc1
  buffer_load_dwordx4 v[164:167], v5, s[4:7], s94 offen offset:768 sc1
  s_add_u32 s94, s94, 4096
  buffer_load_dwordx4 v[168:171], v5, s[4:7], s94 offen offset:0 sc1
  buffer_load_dwordx4 v[172:175], v5, s[4:7], s94 offen offset:512 sc1
  buffer_load_dwordx4 v[176:179], v5, s[4:7], s94 offen offset:256 sc1
  buffer_load_dwordx4 v[180:183], v5, s[4:7], s94 offen offset:768 sc1
  s_add_u32 s67, s67, 1
  s_cmp_gt_u32 s67, 1048576
  s_cbranch_scc1 L_end
  s_waitcnt vmcnt(0)
  v_xor_b32 v7, s96, v120
  v_bitop3_b32 v7, v7, v124, s96 bitop3:0xf6
  v_bitop3_b32 v7, v7, v128, s96 bitop3:0xf6
  v_bitop3_b32 v7, v7, v132, s96 bitop3:0xf6
  v_bitop3_b32 v7, v7, v136, s96 bitop3:0xf6
  v_bitop3_b32 v7, v7, v140, s96 bitop3:0xf6
  v_bitop3_b32 v7, v7, v144, s96 bitop3:0xf6
  v_bitop3_b32 v7, v7, v148, s96 bitop3:0xf6
  v_bitop3_b32 v7, v7, v152, s96 bitop3:0xf6
  v_bitop3_b32 v7, v7, v156, s96 bitop3:0xf6
  v_bitop3_b32 v7, v7, v160, s96 bitop3:0xf6
  v_bitop3_b32 v7, v7, v164, s96 bitop3:0xf6
  v_bitop3_b32 v7, v7, v168, s96 bitop3:0xf6
  v_bitop3_b32 v7, v7, v172, s96 bitop3:0xf6
  v_bitop3_b32 v7, v7, v176, s96 bitop3:0xf6
  v_bitop3_b32 v7, v7, v180, s96 bitop3:0xf6
  v_and_b32 v7, v254, v7
  v_cmp_ne_u32 vcc, 0, v7
  s_cbranch_vccnz o_rl_165
  s_branch o_bk_162
o_rt_163:
  s_mov_b32 s67, 0
o_rl_166:
  s_lshl_b32 s94, s43, 14
  s_add_u32 s94, s94, s95
  buffer_load_dwordx4 v[120:123], v5, s[4:7], s94 offen offset:0 sc1
  buffer_load_dwordx4 v[124:127], v5, s[4:7], s94 offen offset:512 sc1
  buffer_load_dwordx4 v[128:131], v5, s[4:7], s94 offen offset:256 sc1
  buffer_load_dwordx4 v[132:135], v5, s[4:7], s94 offen offset:768 sc1
  s_add_u32 s94, s94, 4096
  buffer_load_dwordx4 v[136:139], v5, s[4:7], s94 offen offset:0 sc1
  buffer_load_dwordx4 v[140:143], v5, s[4:7], s94 offen offset:512 sc1
  buffer_load_dwordx4 v[144:147], v5, s[4:7], s94 offen offset:256 sc1
  buffer_load_dwordx4 v[148:151], v5, s[4:7], s94 offen offset:768 sc1
  s_add_u32 s94, s94, 4096
  buffer_load_dwordx4 v[152:155], v5, s[4:7], s94 offen offset:0 sc1
  buffer_load_dwordx4 v[156:159], v5, s[4:7], s94 offen offset:512 sc1
  buffer_load_dwordx4 v[160:163], v5, s[4:7], s94 offen offset:256 sc1
  buffer_load_dwordx4 v[164:167], v5, s[4:7], s94 offen offset:768 sc1
  s_add_u32 s94, s94, 4096
  buffer_load_dwordx4 v[168:171], v5, s[4:7], s94 offen offset:0 sc1
  buffer_load_dwordx4 v[172:175], v5, s[4:7], s94 offen offset:512 sc1
  buffer_load_dwordx4 v[176:179], v5, s[4:7], s94 offen offset:256 sc1
  buffer_load_dwordx4 v[180:183], v5, s[4:7], s94 offen offset:768 sc1
  s_add_u32 s67, s67, 1
  s_cmp_gt_u32 s67, 1048576
  s_cbranch_scc1 L_end
  s_waitcnt vmcnt(0)
  v_xor_b32 v7, s96, v120
  v_bitop3_b32 v7, v7, v124, s96 bitop3:0xf6
  v_bitop3_b32 v7, v7, v128, s96 bitop3:0xf6
  v_bitop3_b32 v7, v7, v132, s96 bitop3:0xf6
  v_bitop3_b32 v7, v7, v136, s96 bitop3:0xf6
  v_bitop3_b32 v7, v7, v140, s96 bitop3:0xf6
  v_bitop3_b32 v7, v7, v144, s96 bitop3:0xf6
  v_bitop3_b32 v7, v7, v148, s96 bitop3:0xf6
  v_bitop3_b32 v7, v7, v152, s96 bitop3:0xf6
  v_bitop3_b32 v7, v7, v156, s96 bitop3:0xf6
  v_bitop3_b32 v7, v7, v160, s96 bitop3:0xf6
  v_bitop3_b32 v7, v7, v164, s96 bitop3:0xf6
  v_bitop3_b32 v7, v7, v168, s96 bitop3:0xf6
  v_bitop3_b32 v7, v7, v172, s96 bitop3:0xf6
  v_bitop3_b32 v7, v7, v176, s96 bitop3:0xf6
  v_bitop3_b32 v7, v7, v180, s96 bitop3:0xf6
  v_and_b32 v7, v254, v7
  v_cmp_ne_u32 vcc, 0, v7
  s_cbranch_vccnz o_rl_166
  s_branch o_bk_164
o_fb_155:
  v_mov_b32 v118, v116
  s_nop 1
  v_permlane16_swap_b32 v116, v118
  v_max_f32 v116, v116, v118
  v_mov_b32 v118, v116
  s_nop 0
  s_nop 0
  v_permlane32_swap_b32 v116, v118
  v_max_f32 v116, v116, v118
  v_sub_f32 v56, v104, v116
  v_sub_f32 v57, v105, v116
  v_sub_f32 v58, v106, v116
  v_sub_f32 v59, v107, v116
  v_sub_f32 v60, v108, v116
  v_sub_f32 v61, v109, v116
  v_sub_f32 v62, v110, v116
  v_sub_f32 v63, v111, v116
  v_sub_f32 v64, v112, v116
  v_sub_f32 v65, v113, v116
  v_exp_f32 v56, v56
  v_exp_f32 v57, v57
  v_exp_f32 v58, v58
  v_exp_f32 v59, v59
  v_exp_f32 v60, v60
  v_exp_f32 v61, v61
  v_exp_f32 v62, v62
  v_exp_f32 v63, v63
  v_exp_f32 v64, v64
  v_exp_f32 v65, v65
  v_add_f32 v117, v56, v57
  v_add_f32 v117, v117, v58
  v_add_f32 v117, v117, v59
  v_add_f32 v117, v117, v60
  v_add_f32 v117, v117, v61
  v_add_f32 v117, v117, v62
  v_add_f32 v117, v117, v63
  v_add_f32 v117, v117, v64
  v_add_f32 v117, v117, v65
  v_mov_b32 v118, v117
  s_nop 0
  s_nop 0
  v_permlane16_swap_b32 v117, v118
  v_add_f32 v117, v117, v118
  v_mov_b32 v118, v117
  s_nop 0
  s_nop 0
  v_permlane32_swap_b32 v117, v118
  v_add_f32 v117, v117, v118
  v_rcp_f32 v117, v117
  s_branch o_fbr_156
o_fb_157:
  v_mov_b32 v118, v116
  s_nop 1
  v_permlane16_swap_b32 v116, v118
  v_max_f32 v116, v116, v118
  v_mov_b32 v118, v116
  s_nop 0
  s_nop 0
  v_permlane32_swap_b32 v116, v118
  v_max_f32 v116, v116, v118
  v_sub_f32 v56, v104, v116
  v_sub_f32 v57, v105, v116
  v_sub_f32 v58, v106, v116
  v_sub_f32 v59, v107, v116
  v_sub_f32 v60, v108, v116
  v_sub_f32 v61, v109, v116
  v_sub_f32 v62, v110, v116
  v_sub_f32 v63, v111, v116
  v_sub_f32 v64, v112, v116
  v_sub_f32 v65, v113, v116
  v_exp_f32 v56, v56
  v_exp_f32 v57, v57
  v_exp_f32 v58, v58
  v_exp_f32 v59, v59
  v_exp_f32 v60, v60
  v_exp_f32 v61, v61
  v_exp_f32 v62, v62
  v_exp_f32 v63, v63
  v_exp_f32 v64, v64
  v_exp_f32 v65, v65
  v_add_f32 v117, v56, v57
  v_add_f32 v117, v117, v58
  v_add_f32 v117, v117, v59
  v_add_f32 v117, v117, v60
  v_add_f32 v117, v117, v61
  v_add_f32 v117, v117, v62
  v_add_f32 v117, v117, v63
  v_add_f32 v117, v117, v64
  v_add_f32 v117, v117, v65
  v_mov_b32 v118, v117
  s_nop 0
  s_nop 0
  v_permlane16_swap_b32 v117, v118
  v_add_f32 v117, v117, v118
  v_mov_b32 v118, v117
  s_nop 0
  s_nop 0
  v_permlane32_swap_b32 v117, v118
  v_add_f32 v117, v117, v118
  v_rcp_f32 v117, v117
  s_branch o_fbr_158
o_wr2_152:
  s_waitcnt lgkmcnt(0)
  s_barrier
  ds_read_b128 v[104:107], v3 offset:0
  ds_read_b128 v[108:111], v3 offset:512
  ds_read_b128 v[112:115], v3 offset:1024
  buffer_load_dwordx4 v[176:179], v5, s[4:7], s94 offen offset:256 sc1
  buffer_load_dwordx4 v[180:183], v5, s[4:7], s94 offen offset:768 sc1
  s_waitcnt lgkmcnt(2)
  v_mfma_f32_32x32x16_bf16 v[40:55], v[104:107], a[0:3], 0
  v_mov_b64 v[188:189], 0
  v_mov_b64 v[190:191], 0
  v_mov_b64 v[192:193], 0
  v_mov_b64 v[194:195], 0
  s_mov_b64 exec, 1
  buffer_store_dword v38, off, s[4:7], s84 sc1
  s_mov_b64 exec, -1
  s_mov_b32 s84, 268435456
  v_mfma_f32_32x32x16_bf16 v[56:71], v[104:107], a[4:7], 0
  ds_read_b128 v[116:119], v3 offset:1536
  v_mfma_f32_32x32x16_bf16 v[72:87], v[104:107], a[8:11], 0
  v_mfma_f32_32x32x16_bf16 v[88:103], v[104:107], a[12:15], 0
  s_waitcnt vmcnt(13)
  v_xor_b32 v7, s96, v120
  v_bitop3_b32 v7, v7, v124, s96 bitop3:0xf6
  v_bitop3_b32 v7, v7, v128, s96 bitop3:0xf6
  v_bitop3_b32 v7, v7, v132, s96 bitop3:0xf6
  s_waitcnt lgkmcnt(2)
  v_mfma_f32_32x32x16_bf16 v[40:55], v[108:111], a[16:19], v[40:55]
  s_waitcnt vmcnt(9)
  v_bitop3_b32 v7, v7, v136, s96 bitop3:0xf6
  v_bitop3_b32 v7, v7, v140, s96 bitop3:0xf6
  v_bitop3_b32 v7, v7, v144, s96 bitop3:0xf6
  v_bitop3_b32 v7, v7, v148, s96 bitop3:0xf6
  s_waitcnt vmcnt(5)
  v_mfma_f32_32x32x16_bf16 v[56:71], v[108:111], a[20:23], v[56:71]
  ds_read_b128 v[104:107], v3 offset:2048
  v_bitop3_b32 v7, v7, v152, s96 bitop3:0xf6
  v_bitop3_b32 v7, v7, v156, s96 bitop3:0xf6
  v_bitop3_b32 v7, v7, v160, s96 bitop3:0xf6
  v_bitop3_b32 v7, v7, v164, s96 bitop3:0xf6
  s_waitcnt vmcnt(1)
  v_mfma_f32_32x32x16_bf16 v[72:87], v[108:111], a[24:27], v[72:87]
  v_bitop3_b32 v7, v7, v168, s96 bitop3:0xf6
  v_bitop3_b32 v7, v7, v172, s96 bitop3:0xf6
  v_bitop3_b32 v7, v7, v176, s96 bitop3:0xf6
  v_bitop3_b32 v7, v7, v180, s96 bitop3:0xf6
  v_and_b32 v7, v254, v7
  v_cmp_ne_u32 vcc, 0, v7
  s_cbranch_vccnz o_rt_163
o_bk_164:
  v_mfma_f32_32x32x16_bf16 v[88:103], v[108:111], a[28:31], v[88:103]
  v_smfmac_f32_16x16x64_bf16 v[188:191], v[16:19], v[120:127], v20
  v_lshlrev_b32 v196, 16, v184
  v_smfmac_f32_16x16x64_bf16 v[192:195], v[16:19], v[128:135], v20
  v_and_b32 v197, 0xffff0000, v184
  v_smfmac_f32_16x16x64_bf16 v[188:191], v[16:19], v[136:143], v20
  v_lshlrev_b32 v198, 16, v185
  s_waitcnt lgkmcnt(2)
  v_mfma_f32_32x32x16_bf16 v[40:55], v[112:115], a[32:35], v[40:55]
  v_smfmac_f32_16x16x64_bf16 v[192:195], v[16:19], v[144:151], v20
  v_and_b32 v199, 0xffff0000, v185
  v_smfmac_f32_16x16x64_bf16 v[188:191], v[16:19], v[152:159], v20
  v_lshlrev_b32 v200, 16, v186
  v_smfmac_f32_16x16x64_bf16 v[192:195], v[16:19], v[160:167], v20
  v_and_b32 v201, 0xffff0000, v186
  v_mfma_f32_32x32x16_bf16 v[56:71], v[112:115], a[36:39], v[56:71]
  ds_read_b128 v[108:111], v3 offset:2560
  v_smfmac_f32_16x16x64_bf16 v[188:191], v[16:19], v[168:175], v20
  v_lshlrev_b32 v202, 16, v187
  v_smfmac_f32_16x16x64_bf16 v[192:195], v[16:19], v[176:183], v20
  v_and_b32 v203, 0xffff0000, v187
  s_bfe_u32 s92, s65, 131086
  v_mfma_f32_32x32x16_bf16 v[72:87], v[112:115], a[40:43], v[72:87]
  s_lshl_b32 s92, s92, 21
  s_add_u32 s92, s92, s91
  s_add_u32 s93, s92, 27262976
  s_add_u32 s92, s92, 20971520
  v_permlane16_swap_b32 v188, v192
  v_mfma_f32_32x32x16_bf16 v[88:103], v[112:115], a[44:47], v[88:103]
  v_permlane16_swap_b32 v189, v193
  v_permlane16_swap_b32 v190, v194
  v_permlane16_swap_b32 v191, v195
  s_waitcnt lgkmcnt(2)
  v_mfma_f32_32x32x16_bf16 v[40:55], v[116:119], a[48:51], v[40:55]
  v_cvt_pk_bf16_f32 v188, 0, v188
  v_cvt_pk_bf16_f32 v189, 0, v189
  v_cvt_pk_bf16_f32 v190, 0, v190
  v_cvt_pk_bf16_f32 v191, 0, v191
  v_cvt_pk_bf16_f32 v192, 0, v192
  v_cvt_pk_bf16_f32 v193, 0, v193
  v_mfma_f32_32x32x16_bf16 v[56:71], v[116:119], a[52:55], v[56:71]
  ds_read_b128 v[112:115], v3 offset:3072
  v_cvt_pk_bf16_f32 v194, 0, v194
  v_cvt_pk_bf16_f32 v195, 0, v195
  v_add_f32 v196, v196, v188
  v_add_f32 v197, v197, v189
  v_add_f32 v198, v198, v190
  v_mfma_f32_32x32x16_bf16 v[72:87], v[116:119], a[56:59], v[72:87]
  v_add_f32 v199, v199, v191
  v_add_f32 v200, v200, v192
  v_add_f32 v201, v201, v193
  v_add_f32 v202, v202, v194
  v_add_f32 v203, v203, v195
  v_cvt_pk_bf16_f32 v120, v196, v197
  v_mfma_f32_32x32x16_bf16 v[88:103], v[116:119], a[60:63], v[88:103]
  v_cvt_pk_bf16_f32 v121, v198, v199
  v_cvt_pk_bf16_f32 v122, v200, v201
  v_cvt_pk_bf16_f32 v123, v202, v203
  v_lshlrev_b32 v196, 16, v120
  v_and_b32 v197, 0xffff0000, v120
  s_waitcnt lgkmcnt(2)
  v_mfma_f32_32x32x16_bf16 v[40:55], v[104:107], a[64:67], v[40:55]
  v_lshlrev_b32 v198, 16, v121
  v_and_b32 v199, 0xffff0000, v121
  v_lshlrev_b32 v200, 16, v122
  v_and_b32 v201, 0xffff0000, v122
  v_lshlrev_b32 v202, 16, v123
  v_and_b32 v203, 0xffff0000, v123
  v_mfma_f32_32x32x16_bf16 v[56:71], v[104:107], a[68:71], v[56:71]
  ds_read_b128 v[116:119], v3 offset:3584
  buffer_store_dwordx4 v[120:123], v0, s[4:7], s92 offen sc1
  v_add_f32 v136, v196, v197
  v_mul_f32 v137, v196, v196
  v_mfma_f32_32x32x16_bf16 v[72:87], v[104:107], a[72:75], v[72:87]
  v_add_f32 v138, v198, v199
  v_mul_f32 v139, v197, v197
  v_fmac_f32 v137, v198, v198
  v_fmac_f32 v139, v199, v199
  v_add_f32 v136, v136, v200
  v_fmac_f32 v137, v200, v200
  v_mfma_f32_32x32x16_bf16 v[88:103], v[104:107], a[76:79], v[88:103]
  v_add_f32 v138, v138, v201
  v_fmac_f32 v139, v201, v201
  v_add_f32 v136, v136, v202
  v_fmac_f32 v137, v202, v202
  v_add_f32 v138, v138, v203
  s_waitcnt lgkmcnt(2)
  v_mfma_f32_32x32x16_bf16 v[40:55], v[108:111], a[80:83], v[40:55]
  v_fmac_f32 v139, v203, v203
  v_add_f32 v136, v136, v138
  v_add_f32 v137, v137, v139
  s_nop 0
  v_add_f32_dpp v136, v136, v136 row_ror:8 row_mask:0xf bank_mask:0xf
  v_add_f32_dpp v137, v137, v137 row_ror:8 row_mask:0xf bank_mask:0xf
  s_nop 0
  v_add_f32_dpp v136, v136, v136 row_ror:4 row_mask:0xf bank_mask:0xf
  v_mfma_f32_32x32x16_bf16 v[56:71], v[108:111], a[84:87], v[56:71]
  ds_read_b128 v[104:107], v3 offset:8192
  v_add_f32_dpp v137, v137, v137 row_ror:4 row_mask:0xf bank_mask:0xf
  v_add_f32_dpp v136, v136, v136 row_ror:2 row_mask:0xf bank_mask:0xf
  s_nop 0
  v_add_f32_dpp v137, v137, v137 row_ror:2 row_mask:0xf bank_mask:0xf
  v_add_f32_dpp v136, v136, v136 row_ror:1 row_mask:0xf bank_mask:0xf
  s_nop 0
  v_add_f32_dpp v137, v137, v137 row_ror:1 row_mask:0xf bank_mask:0xf
  v_mfma_f32_32x32x16_bf16 v[72:87], v[108:111], a[88:91], v[72:87]
  v_mov_b32 v140, v136
  v_mov_b32 v141, v137
  s_nop 0
  v_permlane16_swap_b32 v136, v140
  v_permlane16_swap_b32 v137, v141
  v_mfma_f32_32x32x16_bf16 v[88:103], v[108:111], a[92:95], v[88:103]
  v_add_f32 v136, v136, v140
  v_add_f32 v137, v137, v141
  v_mov_b32 v140, v136
  v_mov_b32 v141, v137
  s_nop 0
  v_permlane32_swap_b32 v136, v140
  s_waitcnt lgkmcnt(2)
  v_mfma_f32_32x32x16_bf16 v[40:55], v[112:115], a[96:99], v[40:55]
  v_permlane32_swap_b32 v137, v141
  v_add_f32 v136, v136, v140
  v_add_f32 v137, v137, v141
  v_mul_f32 v136, 0x3b000000, v136
  v_mul_f32 v137, 0x3b000000, v137
  v_mfma_f32_32x32x16_bf16 v[56:71], v[112:115], a[100:103], v[56:71]
  ds_read_b128 v[108:111], v3 offset:8704
  v_fma_f32 v137, -v136, v136, v137
  v_cvt_pk_bf16_f32 v136, 0, v136
  v_max_f32 v137, 0, v137
  v_sub_f32 v140, v196, v136
  v_sub_f32 v141, v197, v136
  v_mfma_f32_32x32x16_bf16 v[72:87], v[112:115], a[104:107], v[72:87]
  v_cvt_pk_bf16_f32 v137, 0, v137
  v_sub_f32 v142, v198, v136
  v_sub_f32 v143, v199, v136
  v_add_f32 v137, 0x3727c5ac, v137
  v_sub_f32 v144, v200, v136
  v_sub_f32 v145, v201, v136
  v_mfma_f32_32x32x16_bf16 v[88:103], v[112:115], a[108:111], v[88:103]
  v_cvt_pk_bf16_f32 v137, 0, v137
  v_sub_f32 v146, v202, v136
  v_sub_f32 v147, v203, v136
  v_sqrt_f32 v137, v137
  s_waitcnt lgkmcnt(2)
  v_mfma_f32_32x32x16_bf16 v[40:55], v[116:119], a[112:115], v[40:55]
  v_cvt_pk_bf16_f32 v140, 0, v140
  v_cvt_pk_bf16_f32 v141, 0, v141
  v_cvt_pk_bf16_f32 v137, 0, v137
  v_cvt_pk_bf16_f32 v142, 0, v142
  v_cvt_pk_bf16_f32 v143, 0, v143
  v_rcp_f32 v137, v137
  v_mfma_f32_32x32x16_bf16 v[56:71], v[116:119], a[116:119], v[56:71]
  ds_read_b128 v[112:115], v3 offset:9216
  v_cvt_pk_bf16_f32 v144, 0, v144
  v_cvt_pk_bf16_f32 v145, 0, v145
  v_cvt_pk_bf16_f32 v146, 0, v146
  v_cvt_pk_bf16_f32 v147, 0, v147
  v_mul_f32 v140, v140, v137
  v_mfma_f32_32x32x16_bf16 v[72:87], v[116:119], a[120:123], v[72:87]
  v_mul_f32 v141, v141, v137
  v_mul_f32 v142, v142, v137
  v_mul_f32 v143, v143, v137
  v_mul_f32 v144, v144, v137
  v_mul_f32 v145, v145, v137
  v_mul_f32 v146, v146, v137
  v_mfma_f32_32x32x16_bf16 v[88:103], v[116:119], a[124:127], v[88:103]
  v_mul_f32 v147, v147, v137
  v_cvt_pk_bf16_f32 v124, v140, v141
  v_cvt_pk_bf16_f32 v125, v142, v143
  v_cvt_pk_bf16_f32 v126, v144, v145
  v_cvt_pk_bf16_f32 v127, v146, v147
  s_waitcnt lgkmcnt(2)
  v_mfma_f32_32x32x16_bf16 v[40:55], v[104:107], a[128:131], v[40:55]
  v_lshlrev_b32 v204, 16, v124
  v_and_b32 v205, 0xffff0000, v124
  v_lshlrev_b32 v206, 16, v125
  v_and_b32 v207, 0xffff0000, v125
  v_lshlrev_b32 v208, 16, v126
  v_and_b32 v209, 0xffff0000, v126
  v_mfma_f32_32x32x16_bf16 v[56:71], v[104:107], a[132:135], v[56:71]
  ds_read_b128 v[116:119], v3 offset:9728
  v_lshlrev_b32 v210, 16, v127
  v_and_b32 v211, 0xffff0000, v127
  buffer_store_dwordx4 v[124:127], v0, s[4:7], s93 offen sc1
  v_mfma_f32_32x32x16_bf16 v[72:87], v[104:107], a[136:139], v[72:87]
  v_add_f32 v196, v196, v204
  v_add_f32 v197, v197, v205
  v_add_f32 v198, v198, v206
  v_add_f32 v199, v199, v207
  v_add_f32 v200, v200, v208
  v_add_f32 v201, v201, v209
  v_mfma_f32_32x32x16_bf16 v[88:103], v[104:107], a[140:143], v[88:103]
  v_add_f32 v202, v202, v210
  v_add_f32 v203, v203, v211
  v_cvt_pk_bf16_f32 v128, v196, v197
  v_cvt_pk_bf16_f32 v129, v198, v199
  v_cvt_pk_bf16_f32 v130, v200, v201
  s_waitcnt lgkmcnt(2)
  v_mfma_f32_32x32x16_bf16 v[40:55], v[108:111], a[144:147], v[40:55]
  v_cvt_pk_bf16_f32 v131, v202, v203
  v_mul_f32 v188, v204, v8
  v_mul_f32 v189, v205, v9
  v_fmac_f32 v188, v206, v10
  v_fmac_f32 v189, v207, v11
  v_fmac_f32 v188, v208, v12
  v_mfma_f32_32x32x16_bf16 v[56:71], v[108:111], a[148:151], v[56:71]
  ds_read_b128 v[104:107], v3 offset:10240
  v_fmac_f32 v189, v209, v13
  v_fmac_f32 v188, v210, v14
  v_fmac_f32 v189, v211, v15
  v_add_f32 v188, v188, v189
  buffer_store_dwordx4 v[128:131], v0, s[68:71], s91 offen sc1
  v_mfma_f32_32x32x16_bf16 v[72:87], v[108:111], a[152:155], v[72:87]
  v_add_f32_dpp v188, v188, v188 row_ror:8 row_mask:0xf bank_mask:0xf
  s_nop 1
  v_add_f32_dpp v188, v188, v188 row_ror:4 row_mask:0xf bank_mask:0xf
  s_nop 1
  v_add_f32_dpp v188, v188, v188 row_ror:2 row_mask:0xf bank_mask:0xf
  s_nop 1
  v_add_f32_dpp v188, v188, v188 row_ror:1 row_mask:0xf bank_mask:0xf
  v_mov_b32 v189, v188
  s_nop 0
  s_nop 0
  v_permlane16_swap_b32 v188, v189
  v_mfma_f32_32x32x16_bf16 v[88:103], v[108:111], a[156:159], v[88:103]
  v_add_f32 v188, v188, v189
  v_mov_b32 v189, v188
  s_nop 0
  s_nop 0
  v_permlane32_swap_b32 v188, v189
  v_add_f32 v188, v188, v189
  s_waitcnt lgkmcnt(2)
  v_mfma_f32_32x32x16_bf16 v[40:55], v[112:115], a[160:163], v[40:55]
  v_cvt_pk_bf16_f32 v188, 0, v188
  v_ashrrev_i32 v189, 31, v188
  v_or_b32 v189, 0x80000000, v189
  v_xor_b32 v188, v188, v189
  s_sub_u32 s92, 4095, s90
  v_and_b32 v188, 0xffff0000, v188
  v_mfma_f32_32x32x16_bf16 v[56:71], v[112:115], a[164:167], v[56:71]
  ds_read_b128 v[108:111], v3 offset:10752
  v_or_b32 v38, s92, v188
  s_bfe_u32 s92, s65, 196625
  s_lshl_b32 s92, s92, 18
  s_lshl_b32 s93, s90, 7
  s_add_u32 s92, s92, s93
  v_mfma_f32_32x32x16_bf16 v[72:87], v[112:115], a[168:171], v[72:87]
  s_add_u32 s84, s92, 243269632
  v_mfma_f32_32x32x16_bf16 v[88:103], v[112:115], a[172:175], v[88:103]
  s_waitcnt lgkmcnt(2)
  v_mfma_f32_32x32x16_bf16 v[40:55], v[116:119], a[176:179], v[40:55]
  v_mfma_f32_32x32x16_bf16 v[56:71], v[116:119], a[180:183], v[56:71]
  ds_read_b128 v[112:115], v3 offset:11264
  v_mfma_f32_32x32x16_bf16 v[72:87], v[116:119], a[184:187], v[72:87]
  v_mfma_f32_32x32x16_bf16 v[88:103], v[116:119], a[188:191], v[88:103]
  s_waitcnt lgkmcnt(2)
  v_mfma_f32_32x32x16_bf16 v[40:55], v[104:107], a[192:195], v[40:55]
  v_mfma_f32_32x32x16_bf16 v[56:71], v[104:107], a[196:199], v[56:71]
  ds_read_b128 v[116:119], v3 offset:11776
  s_waitcnt lgkmcnt(2)
  v_mfma_f32_32x32x16_bf16 v[40:55], v[108:111], a[208:211], v[40:55]
  v_mfma_f32_32x32x16_bf16 v[56:71], v[108:111], a[212:215], v[56:71]
  s_waitcnt lgkmcnt(1)
  v_mfma_f32_32x32x16_bf16 v[40:55], v[112:115], a[224:227], v[40:55]
  v_mfma_f32_32x32x16_bf16 v[56:71], v[112:115], a[228:231], v[56:71]
  s_waitcnt lgkmcnt(0)
  v_mfma_f32_32x32x16_bf16 v[40:55], v[116:119], a[240:243], v[40:55]
  v_mfma_f32_32x32x16_bf16 v[56:71], v[116:119], a[244:247], v[56:71]
  v_mfma_f32_32x32x16_bf16 v[72:87], v[104:107], a[200:203], v[72:87]
  v_mfma_f32_32x32x16_bf16 v[88:103], v[104:107], a[204:207], v[88:103]
  v_cvt_pk_bf16_f32 v212, v40, v56
  v_cvt_pk_bf16_f32 v214, v41, v57
  v_cvt_pk_bf16_f32 v216, v42, v58
  v_cvt_pk_bf16_f32 v218, v43, v59
  v_permlane16_swap_b32 v212, v214
  v_mfma_f32_32x32x16_bf16 v[72:87], v[108:111], a[216:219], v[72:87]
  v_cvt_pk_bf16_f32 v220, v44, v60
  v_cvt_pk_bf16_f32 v222, v45, v61
  v_permlane16_swap_b32 v216, v218
  v_bfi_b32 v212, v254, s42, v212
  v_cvt_pk_bf16_f32 v224, v46, v62
  v_mfma_f32_32x32x16_bf16 v[88:103], v[108:111], a[220:223], v[88:103]
  v_cvt_pk_bf16_f32 v226, v47, v63
  v_permlane16_swap_b32 v220, v222
  v_bfi_b32 v216, v254, s42, v216
  v_cvt_pk_bf16_f32 v228, v48, v64
  v_mfma_f32_32x32x16_bf16 v[72:87], v[112:115], a[232:235], v[72:87]
  v_cvt_pk_bf16_f32 v230, v49, v65
  v_permlane16_swap_b32 v224, v226
  v_bfi_b32 v220, v254, s42, v220
  v_cvt_pk_bf16_f32 v232, v50, v66
  v_cvt_pk_bf16_f32 v234, v51, v67
  v_mfma_f32_32x32x16_bf16 v[88:103], v[112:115], a[236:239], v[88:103]
  v_permlane16_swap_b32 v228, v230
  v_bfi_b32 v224, v254, s42, v224
  v_cvt_pk_bf16_f32 v236, v52, v68
  v_cvt_pk_bf16_f32 v238, v53, v69
  v_mfma_f32_32x32x16_bf16 v[72:87], v[116:119], a[248:251], v[72:87]
  v_permlane16_swap_b32 v232, v234
  v_bfi_b32 v228, v254, s42, v228
  v_cvt_pk_bf16_f32 v240, v54, v70
  v_cvt_pk_bf16_f32 v242, v55, v71
  v_permlane16_swap_b32 v236, v238
  v_mfma_f32_32x32x16_bf16 v[88:103], v[116:119], a[252:255], v[88:103]
  v_bfi_b32 v232, v254, s42, v232
  v_permlane16_swap_b32 v240, v242
  v_bfi_b32 v236, v254, s42, v236
  v_bfi_b32 v240, v254, s42, v240
  s_nop 7
  v_cvt_pk_bf16_f32 v213, v72, v88
  v_cvt_pk_bf16_f32 v215, v73, v89
  v_cvt_pk_bf16_f32 v217, v74, v90
  v_cvt_pk_bf16_f32 v219, v75, v91
  s_add_u32 s78, s86, 0
  v_permlane16_swap_b32 v213, v215
  buffer_store_dwordx4 v[212:215], v4, s[4:7], s78 offen
  v_cvt_pk_bf16_f32 v221, v76, v92
  v_cvt_pk_bf16_f32 v223, v77, v93
  s_add_u32 s78, s86, 32768
  v_permlane16_swap_b32 v217, v219
  buffer_store_dwordx4 v[216:219], v4, s[4:7], s78 offen
  v_cvt_pk_bf16_f32 v225, v78, v94
  v_cvt_pk_bf16_f32 v227, v79, v95
  s_add_u32 s78, s86, 131072
  v_permlane16_swap_b32 v221, v223
  buffer_store_dwordx4 v[220:223], v4, s[4:7], s78 offen
  v_cvt_pk_bf16_f32 v229, v80, v96
  v_cvt_pk_bf16_f32 v231, v81, v97
  s_add_u32 s78, s86, 163840
  v_permlane16_swap_b32 v225, v227
  buffer_store_dwordx4 v[224:227], v4, s[4:7], s78 offen
  v_cvt_pk_bf16_f32 v233, v82, v98
  v_cvt_pk_bf16_f32 v235, v83, v99
  s_add_u32 s78, s86, 262144
  v_permlane16_swap_b32 v229, v231
  buffer_store_dwordx4 v[228:231], v4, s[4:7], s78 offen
  v_cvt_pk_bf16_f32 v237, v84, v100
  v_cvt_pk_bf16_f32 v239, v85, v101
  s_add_u32 s78, s86, 294912
  v_permlane16_swap_b32 v233, v235
  buffer_store_dwordx4 v[232:235], v4, s[4:7], s78 offen
  v_cvt_pk_bf16_f32 v241, v86, v102
  v_cvt_pk_bf16_f32 v243, v87, v103
  s_add_u32 s78, s86, 393216
  v_permlane16_swap_b32 v237, v239
  buffer_store_dwordx4 v[236:239], v4, s[4:7], s78 offen
  s_add_u32 s78, s86, 425984
  v_permlane16_swap_b32 v241, v243
  buffer_store_dwordx4 v[240:243], v4, s[4:7], s78 offen
o_we_153:
  v_and_b32 v37, -32, v39
  s_waitcnt lgkmcnt(0)
  s_barrier
  ds_read_b128 v[104:107], v37 offset:16
  s_mov_b32 s65, s63
  s_waitcnt lgkmcnt(0)
  v_and_b32 v104, v104, v106
  v_max_u32 v105, v105, v107
  v_readfirstlane_b32 s26, v104
  v_readfirstlane_b32 s3, v105
  s_and_b32 s66, s26, 1
  s_and_b32 s76, s26, 2
  s_bitcmp1_b32 s26, 2
  s_cselect_b32 s3, s3, 0
  s_cmp_lg_u32 s76, 0
  s_cbranch_scc1 o_nofl_127
  s_and_b32 s26, s63, 49152
  s_cbranch_scc0 o_fl_128
  s_and_b32 s26, s64, s50
  s_cbranch_scc1 o_nofl_127
o_fl_128:
  s_cmp_ge_u32 s17, 2
  s_cbranch_scc1 o_fd_167
  s_cmp_eq_u32 s65, 0
  s_cbranch_scc1 o_fd_167
  s_mov_b32 s96, s42
  s_lshl_b32 s97, s43, 14
  s_add_u32 s97, s97, s86
  buffer_load_dword v7, v255, s[4:7], s97 offen sc1
  s_and_b32 s91, s65, 63
  s_lshl_b32 s90, s91, 5
  s_add_u32 s94, s90, s85
  s_add_u32 s90, s90, s43
  s_lshl_b32 s94, s94, 10
  s_lshr_b32 s92, s65, 22
  s_xor_b32 s93, s43, 32
  s_lshl_b32 s91, s90, 10
  s_add_u32 s94, s94, 25165824
  s_cmp_eq_u32 s92, s93
  s_cselect_b32 s92, s94, s91
  s_add_u32 s92, s92, 10485760
  s_and_b32 s93, s65, 49152
  s_cselect_b32 s92, s92, s91
  s_cselect_b64 s[80:81], s[4:5], s[72:73]
  s_cselect_b32 s82, s6, s74
  buffer_load_dwordx4 v[184:187], v0, s[80:83], s92 offen sc1
  s_mov_b32 s67, 0
  s_mov_b64 vcc, 0
  s_waitcnt vmcnt(1)
o_pl_169:
  v_and_b32 v7, 1, v7
  v_cmp_ne_u32 vcc, s96, v7
  s_cbranch_vccz o_pk_170
  s_mov_b64 exec, 1
  buffer_store_dword v38, off, s[4:7], s84 sc1
  s_mov_b64 exec, -1
  s_mov_b32 s84, 268435456
  buffer_load_dword v7, v255, s[4:7], s97 offen sc1
  s_add_u32 s67, s67, 1
  s_cmp_gt_u32 s67, 1048576
  s_cbranch_scc1 L_end
  s_waitcnt vmcnt(0)
  s_branch o_pl_169
o_pk_170:
  s_and_b32 s26, s65, 49152
  s_cbranch_scc1 o_f2_168
  s_lshl_b32 s94, s43, 14
  s_add_u32 s94, s94, s86
  buffer_load_dwordx4 v[120:123], v5, s[4:7], s94 offen offset:0 sc1
  buffer_load_dwordx4 v[124:127], v5, s[4:7], s94 offen offset:512 sc1
  buffer_load_dwordx4 v[128:131], v5, s[4:7], s94 offen offset:256 sc1
  buffer_load_dwordx4 v[132:135], v5, s[4:7], s94 offen offset:768 sc1
  s_add_u32 s94, s94, 4096
  buffer_load_dwordx4 v[136:139], v5, s[4:7], s94 offen offset:0 sc1
  buffer_load_dwordx4 v[140:143], v5, s[4:7], s94 offen offset:512 sc1
  buffer_load_dwordx4 v[144:147], v5, s[4:7], s94 offen offset:256 sc1
  buffer_load_dwordx4 v[148:151], v5, s[4:7], s94 offen offset:768 sc1
  s_add_u32 s94, s94, 4096
  buffer_load_dwordx4 v[152:155], v5, s[4:7], s94 offen offset:0 sc1
  buffer_load_dwordx4 v[156:159], v5, s[4:7], s94 offen offset:512 sc1
  buffer_load_dwordx4 v[160:163], v5, s[4:7], s94 offen offset:256 sc1
  buffer_load_dwordx4 v[164:167], v5, s[4:7], s94 offen offset:768 sc1
  s_add_u32 s94, s94, 4096
  buffer_load_dwordx4 v[168:171], v5, s[4:7], s94 offen offset:0 sc1
  buffer_load_dwordx4 v[172:175], v5, s[4:7], s94 offen offset:512 sc1
  buffer_load_dwordx4 v[176:179], v5, s[4:7], s94 offen offset:256 sc1
  buffer_load_dwordx4 v[180:183], v5, s[4:7], s94 offen offset:768 sc1
  s_mov_b64 exec, 1
  buffer_store_dword v38, off, s[4:7], s84 sc1
  s_mov_b64 exec, -1
  s_mov_b32 s84, 268435456
  v_mov_b64 v[188:189], 0
  v_mov_b64 v[190:191], 0
  v_mov_b64 v[192:193], 0
  v_mov_b64 v[194:195], 0
  s_waitcnt vmcnt(13)
  v_xor_b32 v7, s96, v120
  v_bitop3_b32 v7, v7, v124, s96 bitop3:0xf6
  v_bitop3_b32 v7, v7, v128, s96 bitop3:0xf6
  v_bitop3_b32 v7, v7, v132, s96 bitop3:0xf6
  s_waitcnt vmcnt(9)
  v_bitop3_b32 v7, v7, v136, s96 bitop3:0xf6
  v_bitop3_b32 v7, v7, v140, s96 bitop3:0xf6
  v_bitop3_b32 v7, v7, v144, s96 bitop3:0xf6
  v_bitop3_b32 v7, v7, v148, s96 bitop3:0xf6
  s_waitcnt vmcnt(5)
  v_bitop3_b32 v7, v7, v152, s96 bitop3:0xf6
  v_bitop3_b32 v7, v7, v156, s96 bitop3:0xf6
  v_bitop3_b32 v7, v7, v160, s96 bitop3:0xf6
  v_bitop3_b32 v7, v7, v164, s96 bitop3:0xf6
  s_waitcnt vmcnt(1)
  v_bitop3_b32 v7, v7, v168, s96 bitop3:0xf6
  v_bitop3_b32 v7, v7, v172, s96 bitop3:0xf6
  v_bitop3_b32 v7, v7, v176, s96 bitop3:0xf6
  v_bitop3_b32 v7, v7, v180, s96 bitop3:0xf6
  v_and_b32 v7, v254, v7
  v_cmp_ne_u32 vcc, 0, v7
  s_cbranch_vccnz o_rt_171
o_bk_172:
  v_smfmac_f32_16x16x64_bf16 v[188:191], v[16:19], v[120:127], v20
  v_lshlrev_b32 v196, 16, v184
  v_smfmac_f32_16x16x64_bf16 v[192:195], v[16:19], v[128:135], v20
  v_and_b32 v197, 0xffff0000, v184
  v_smfmac_f32_16x16x64_bf16 v[188:191], v[16:19], v[136:143], v20
  v_lshlrev_b32 v198, 16, v185
  v_smfmac_f32_16x16x64_bf16 v[192:195], v[16:19], v[144:151], v20
  v_and_b32 v199, 0xffff0000, v185
  v_smfmac_f32_16x16x64_bf16 v[188:191], v[16:19], v[152:159], v20
  v_lshlrev_b32 v200, 16, v186
  v_smfmac_f32_16x16x64_bf16 v[192:195], v[16:19], v[160:167], v20
  v_and_b32 v201, 0xffff0000, v186
  v_smfmac_f32_16x16x64_bf16 v[188:191], v[16:19], v[168:175], v20
  v_lshlrev_b32 v202, 16, v187
  v_smfmac_f32_16x16x64_bf16 v[192:195], v[16:19], v[176:183], v20
  v_and_b32 v203, 0xffff0000, v187
  s_bfe_u32 s92, s65, 131086
  s_lshl_b32 s92, s92, 21
  s_add_u32 s92, s92, s91
  s_add_u32 s93, s92, 27262976
  s_add_u32 s92, s92, 20971520
  s_nop 1
  v_permlane16_swap_b32 v188, v192
  v_permlane16_swap_b32 v189, v193
  v_permlane16_swap_b32 v190, v194
  v_permlane16_swap_b32 v191, v195
  v_cvt_pk_bf16_f32 v188, 0, v188
  v_cvt_pk_bf16_f32 v189, 0, v189
  v_cvt_pk_bf16_f32 v190, 0, v190
  v_cvt_pk_bf16_f32 v191, 0, v191
  v_cvt_pk_bf16_f32 v192, 0, v192
  v_cvt_pk_bf16_f32 v193, 0, v193
  v_cvt_pk_bf16_f32 v194, 0, v194
  v_cvt_pk_bf16_f32 v195, 0, v195
  v_add_f32 v196, v196, v188
  v_add_f32 v197, v197, v189
  v_add_f32 v198, v198, v190
  v_add_f32 v199, v199, v191
  v_add_f32 v200, v200, v192
  v_add_f32 v201, v201, v193
  v_add_f32 v202, v202, v194
  v_add_f32 v203, v203, v195
  v_cvt_pk_bf16_f32 v120, v196, v197
  v_cvt_pk_bf16_f32 v121, v198, v199
  v_cvt_pk_bf16_f32 v122, v200, v201
  v_cvt_pk_bf16_f32 v123, v202, v203
  v_lshlrev_b32 v196, 16, v120
  v_and_b32 v197, 0xffff0000, v120
  v_lshlrev_b32 v198, 16, v121
  v_and_b32 v199, 0xffff0000, v121
  v_lshlrev_b32 v200, 16, v122
  v_and_b32 v201, 0xffff0000, v122
  v_lshlrev_b32 v202, 16, v123
  v_and_b32 v203, 0xffff0000, v123
  buffer_store_dwordx4 v[120:123], v0, s[4:7], s92 offen sc1
  v_add_f32 v136, v196, v197
  v_mul_f32 v137, v196, v196
  v_add_f32 v138, v198, v199
  v_mul_f32 v139, v197, v197
  v_fmac_f32 v137, v198, v198
  v_fmac_f32 v139, v199, v199
  v_add_f32 v136, v136, v200
  v_fmac_f32 v137, v200, v200
  v_add_f32 v138, v138, v201
  v_fmac_f32 v139, v201, v201
  v_add_f32 v136, v136, v202
  v_fmac_f32 v137, v202, v202
  v_add_f32 v138, v138, v203
  v_fmac_f32 v139, v203, v203
  v_add_f32 v136, v136, v138
  v_add_f32 v137, v137, v139
  s_nop 0
  v_add_f32_dpp v136, v136, v136 row_ror:8 row_mask:0xf bank_mask:0xf
  v_add_f32_dpp v137, v137, v137 row_ror:8 row_mask:0xf bank_mask:0xf
  s_nop 0
  v_add_f32_dpp v136, v136, v136 row_ror:4 row_mask:0xf bank_mask:0xf
  v_add_f32_dpp v137, v137, v137 row_ror:4 row_mask:0xf bank_mask:0xf
  s_nop 0
  v_add_f32_dpp v136, v136, v136 row_ror:2 row_mask:0xf bank_mask:0xf
  v_add_f32_dpp v137, v137, v137 row_ror:2 row_mask:0xf bank_mask:0xf
  s_nop 0
  v_add_f32_dpp v136, v136, v136 row_ror:1 row_mask:0xf bank_mask:0xf
  v_add_f32_dpp v137, v137, v137 row_ror:1 row_mask:0xf bank_mask:0xf
  v_mov_b32 v140, v136
  v_mov_b32 v141, v137
  s_nop 0
  v_permlane16_swap_b32 v136, v140
  v_permlane16_swap_b32 v137, v141
  v_add_f32 v136, v136, v140
  v_add_f32 v137, v137, v141
  v_mov_b32 v140, v136
  v_mov_b32 v141, v137
  s_nop 0
  v_permlane32_swap_b32 v136, v140
  v_permlane32_swap_b32 v137, v141
  v_add_f32 v136, v136, v140
  v_add_f32 v137, v137, v141
  v_mul_f32 v136, 0x3b000000, v136
  v_mul_f32 v137, 0x3b000000, v137
  v_fma_f32 v137, -v136, v136, v137
  v_cvt_pk_bf16_f32 v136, 0, v136
  v_max_f32 v137, 0, v137
  v_sub_f32 v140, v196, v136
  v_sub_f32 v141, v197, v136
  v_cvt_pk_bf16_f32 v137, 0, v137
  v_sub_f32 v142, v198, v136
  v_sub_f32 v143, v199, v136
  v_add_f32 v137, 0x3727c5ac, v137
  v_sub_f32 v144, v200, v136
  v_sub_f32 v145, v201, v136
  v_cvt_pk_bf16_f32 v137, 0, v137
  v_sub_f32 v146, v202, v136
  v_sub_f32 v147, v203, v136
  v_sqrt_f32 v137, v137
  v_cvt_pk_bf16_f32 v140, 0, v140
  v_cvt_pk_bf16_f32 v141, 0, v141
  v_cvt_pk_bf16_f32 v137, 0, v137
  v_cvt_pk_bf16_f32 v142, 0, v142
  v_cvt_pk_bf16_f32 v143, 0, v143
  v_rcp_f32 v137, v137
  v_cvt_pk_bf16_f32 v144, 0, v144
  v_cvt_pk_bf16_f32 v145, 0, v145
  v_cvt_pk_bf16_f32 v146, 0, v146
  v_cvt_pk_bf16_f32 v147, 0, v147
  v_mul_f32 v140, v140, v137
  v_mul_f32 v141, v141, v137
  v_mul_f32 v142, v142, v137
  v_mul_f32 v143, v143, v137
  v_mul_f32 v144, v144, v137
  v_mul_f32 v145, v145, v137
  v_mul_f32 v146, v146, v137
  v_mul_f32 v147, v147, v137
  v_cvt_pk_bf16_f32 v124, v140, v141
  v_cvt_pk_bf16_f32 v125, v142, v143
  v_cvt_pk_bf16_f32 v126, v144, v145
  v_cvt_pk_bf16_f32 v127, v146, v147
  v_lshlrev_b32 v204, 16, v124
  v_and_b32 v205, 0xffff0000, v124
  v_lshlrev_b32 v206, 16, v125
  v_and_b32 v207, 0xffff0000, v125
  v_lshlrev_b32 v208, 16, v126
  v_and_b32 v209, 0xffff0000, v126
  v_lshlrev_b32 v210, 16, v127
  v_and_b32 v211, 0xffff0000, v127
  buffer_store_dwordx4 v[124:127], v0, s[4:7], s93 offen sc1
  v_add_f32 v196, v196, v204
  v_add_f32 v197, v197, v205
  v_add_f32 v198, v198, v206
  v_add_f32 v199, v199, v207
  v_add_f32 v200, v200, v208
  v_add_f32 v201, v201, v209
  v_add_f32 v202, v202, v210
  v_add_f32 v203, v203, v211
  v_cvt_pk_bf16_f32 v128, v196, v197
  v_cvt_pk_bf16_f32 v129, v198, v199
  v_cvt_pk_bf16_f32 v130, v200, v201
  v_cvt_pk_bf16_f32 v131, v202, v203
  v_mul_f32 v188, v204, v8
  v_mul_f32 v189, v205, v9
  v_fmac_f32 v188, v206, v10
  v_fmac_f32 v189, v207, v11
  v_fmac_f32 v188, v208, v12
  v_fmac_f32 v189, v209, v13
  v_fmac_f32 v188, v210, v14
  v_fmac_f32 v189, v211, v15
  v_add_f32 v188, v188, v189
  s_add_u32 s92, s91, 10485760
  s_add_u32 s93, s91, 8388608
  buffer_store_dwordx4 v[128:131], v0, s[4:7], s92 offen sc1
  v_lshlrev_b32 v196, 16, v128
  v_and_b32 v197, 0xffff0000, v128
  v_lshlrev_b32 v198, 16, v129
  v_and_b32 v199, 0xffff0000, v129
  v_lshlrev_b32 v200, 16, v130
  v_and_b32 v201, 0xffff0000, v130
  v_lshlrev_b32 v202, 16, v131
  v_and_b32 v203, 0xffff0000, v131
  v_add_f32 v136, v196, v197
  v_mul_f32 v137, v196, v196
  v_add_f32 v138, v198, v199
  v_mul_f32 v139, v197, v197
  v_fmac_f32 v137, v198, v198
  v_fmac_f32 v139, v199, v199
  v_add_f32 v136, v136, v200
  v_fmac_f32 v137, v200, v200
  v_add_f32 v138, v138, v201
  v_fmac_f32 v139, v201, v201
  v_add_f32 v136, v136, v202
  v_fmac_f32 v137, v202, v202
  v_add_f32 v138, v138, v203
  v_fmac_f32 v139, v203, v203
  v_add_f32 v136, v136, v138
  v_add_f32 v137, v137, v139
  s_nop 0
  v_add_f32_dpp v136, v136, v136 row_ror:8 row_mask:0xf bank_mask:0xf
  v_add_f32_dpp v137, v137, v137 row_ror:8 row_mask:0xf bank_mask:0xf
  v_add_f32_dpp v188, v188, v188 row_ror:8 row_mask:0xf bank_mask:0xf
  v_add_f32_dpp v136, v136, v136 row_ror:4 row_mask:0xf bank_mask:0xf
  v_add_f32_dpp v137, v137, v137 row_ror:4 row_mask:0xf bank_mask:0xf
  v_add_f32_dpp v188, v188, v188 row_ror:4 row_mask:0xf bank_mask:0xf
  v_add_f32_dpp v136, v136, v136 row_ror:2 row_mask:0xf bank_mask:0xf
  v_add_f32_dpp v137, v137, v137 row_ror:2 row_mask:0xf bank_mask:0xf
  v_add_f32_dpp v188, v188, v188 row_ror:2 row_mask:0xf bank_mask:0xf
  v_add_f32_dpp v136, v136, v136 row_ror:1 row_mask:0xf bank_mask:0xf
  v_add_f32_dpp v137, v137, v137 row_ror:1 row_mask:0xf bank_mask:0xf
  v_add_f32_dpp v188, v188, v188 row_ror:1 row_mask:0xf bank_mask:0xf
  v_mov_b32 v140, v136
  v_mov_b32 v141, v137
  v_mov_b32 v142, v188
  v_permlane16_swap_b32 v136, v140
  v_permlane16_swap_b32 v137, v141
  v_permlane16_swap_b32 v188, v142
  v_add_f32 v136, v136, v140
  v_add_f32 v137, v137, v141
  v_add_f32 v188, v188, v142
  v_mov_b32 v140, v136
  v_mov_b32 v141, v137
  v_mov_b32 v142, v188
  v_permlane32_swap_b32 v136, v140
  v_permlane32_swap_b32 v137, v141
  v_permlane32_swap_b32 v188, v142
  v_add_f32 v136, v136, v140
  v_add_f32 v137, v137, v141
  v_add_f32 v188, v188, v142
  v_mul_f32 v136, 0x3b000000, v136
  v_mul_f32 v137, 0x3b000000, v137
  v_fma_f32 v137, -v136, v136, v137
  v_cvt_pk_bf16_f32 v136, 0, v136
  v_max_f32 v137, 0, v137
  v_sub_f32 v140, v196, v136
  v_sub_f32 v141, v197, v136
  v_cvt_pk_bf16_f32 v137, 0, v137
  v_sub_f32 v142, v198, v136
  v_sub_f32 v143, v199, v136
  v_add_f32 v137, 0x3727c5ac, v137
  v_sub_f32 v144, v200, v136
  v_sub_f32 v145, v201, v136
  v_cvt_pk_bf16_f32 v137, 0, v137
  v_sub_f32 v146, v202, v136
  v_sub_f32 v147, v203, v136
  v_sqrt_f32 v137, v137
  v_cvt_pk_bf16_f32 v140, 0, v140
  v_cvt_pk_bf16_f32 v141, 0, v141
  v_cvt_pk_bf16_f32 v137, 0, v137
  v_cvt_pk_bf16_f32 v142, 0, v142
  v_cvt_pk_bf16_f32 v143, 0, v143
  v_rcp_f32 v137, v137
  v_cvt_pk_bf16_f32 v144, 0, v144
  v_cvt_pk_bf16_f32 v145, 0, v145
  v_cvt_pk_bf16_f32 v146, 0, v146
  v_cvt_pk_bf16_f32 v147, 0, v147
  v_mul_f32 v140, v140, v137
  v_mul_f32 v141, v141, v137
  v_mul_f32 v142, v142, v137
  v_mul_f32 v143, v143, v137
  v_mul_f32 v144, v144, v137
  v_mul_f32 v145, v145, v137
  v_mul_f32 v146, v146, v137
  v_mul_f32 v147, v147, v137
  v_cvt_pk_bf16_f32 v132, v140, v141
  v_cvt_pk_bf16_f32 v133, v142, v143
  v_cvt_pk_bf16_f32 v134, v144, v145
  v_cvt_pk_bf16_f32 v135, v146, v147
  buffer_store_dwordx4 v[132:135], v0, s[4:7], s93 offen sc1
  v_cvt_pk_bf16_f32 v188, 0, v188
  v_ashrrev_i32 v189, 31, v188
  v_or_b32 v189, 0x80000000, v189
  v_xor_b32 v188, v188, v189
  s_sub_u32 s92, 4095, s90
  v_and_b32 v188, 0xffff0000, v188
  v_or_b32 v38, s92, v188
  s_bfe_u32 s92, s65, 196625
  s_lshl_b32 s92, s92, 18
  s_lshl_b32 s93, s90, 7
  s_add_u32 s92, s92, s93
  s_add_u32 s84, s92, 243269632
  s_waitcnt vmcnt(0)
  s_mov_b64 exec, 1
  buffer_store_dword v38, off, s[4:7], s84 sc1
  s_mov_b64 exec, -1
  s_mov_b32 s84, 268435456
  s_branch o_fd_167
o_rt_171:
  s_mov_b32 s67, 0
o_rl_173:
  s_lshl_b32 s94, s43, 14
  s_add_u32 s94, s94, s86
  buffer_load_dwordx4 v[120:123], v5, s[4:7], s94 offen offset:0 sc1
  buffer_load_dwordx4 v[124:127], v5, s[4:7], s94 offen offset:512 sc1
  buffer_load_dwordx4 v[128:131], v5, s[4:7], s94 offen offset:256 sc1
  buffer_load_dwordx4 v[132:135], v5, s[4:7], s94 offen offset:768 sc1
  s_add_u32 s94, s94, 4096
  buffer_load_dwordx4 v[136:139], v5, s[4:7], s94 offen offset:0 sc1
  buffer_load_dwordx4 v[140:143], v5, s[4:7], s94 offen offset:512 sc1
  buffer_load_dwordx4 v[144:147], v5, s[4:7], s94 offen offset:256 sc1
  buffer_load_dwordx4 v[148:151], v5, s[4:7], s94 offen offset:768 sc1
  s_add_u32 s94, s94, 4096
  buffer_load_dwordx4 v[152:155], v5, s[4:7], s94 offen offset:0 sc1
  buffer_load_dwordx4 v[156:159], v5, s[4:7], s94 offen offset:512 sc1
  buffer_load_dwordx4 v[160:163], v5, s[4:7], s94 offen offset:256 sc1
  buffer_load_dwordx4 v[164:167], v5, s[4:7], s94 offen offset:768 sc1
  s_add_u32 s94, s94, 4096
  buffer_load_dwordx4 v[168:171], v5, s[4:7], s94 offen offset:0 sc1
  buffer_load_dwordx4 v[172:175], v5, s[4:7], s94 offen offset:512 sc1
  buffer_load_dwordx4 v[176:179], v5, s[4:7], s94 offen offset:256 sc1
  buffer_load_dwordx4 v[180:183], v5, s[4:7], s94 offen offset:768 sc1
  s_add_u32 s67, s67, 1
  s_cmp_gt_u32 s67, 1048576
  s_cbranch_scc1 L_end
  s_waitcnt vmcnt(0)
  v_xor_b32 v7, s96, v120
  v_bitop3_b32 v7, v7, v124, s96 bitop3:0xf6
  v_bitop3_b32 v7, v7, v128, s96 bitop3:0xf6
  v_bitop3_b32 v7, v7, v132, s96 bitop3:0xf6
  v_bitop3_b32 v7, v7, v136, s96 bitop3:0xf6
  v_bitop3_b32 v7, v7, v140, s96 bitop3:0xf6
  v_bitop3_b32 v7, v7, v144, s96 bitop3:0xf6
  v_bitop3_b32 v7, v7, v148, s96 bitop3:0xf6
  v_bitop3_b32 v7, v7, v152, s96 bitop3:0xf6
  v_bitop3_b32 v7, v7, v156, s96 bitop3:0xf6
  v_bitop3_b32 v7, v7, v160, s96 bitop3:0xf6
  v_bitop3_b32 v7, v7, v164, s96 bitop3:0xf6
  v_bitop3_b32 v7, v7, v168, s96 bitop3:0xf6
  v_bitop3_b32 v7, v7, v172, s96 bitop3:0xf6
  v_bitop3_b32 v7, v7, v176, s96 bitop3:0xf6
  v_bitop3_b32 v7, v7, v180, s96 bitop3:0xf6
  v_and_b32 v7, v254, v7
  v_cmp_ne_u32 vcc, 0, v7
  s_cbranch_vccnz o_rl_173
  s_branch o_bk_172
o_f2_168:
  s_lshl_b32 s94, s43, 14
  s_add_u32 s94, s94, s86
  buffer_load_dwordx4 v[120:123], v5, s[4:7], s94 offen offset:0 sc1
  buffer_load_dwordx4 v[124:127], v5, s[4:7], s94 offen offset:512 sc1
  buffer_load_dwordx4 v[128:131], v5, s[4:7], s94 offen offset:256 sc1
  buffer_load_dwordx4 v[132:135], v5, s[4:7], s94 offen offset:768 sc1
  s_add_u32 s94, s94, 4096
  buffer_load_dwordx4 v[136:139], v5, s[4:7], s94 offen offset:0 sc1
  buffer_load_dwordx4 v[140:143], v5, s[4:7], s94 offen offset:512 sc1
  buffer_load_dwordx4 v[144:147], v5, s[4:7], s94 offen offset:256 sc1
  buffer_load_dwordx4 v[148:151], v5, s[4:7], s94 offen offset:768 sc1
  s_add_u32 s94, s94, 4096
  buffer_load_dwordx4 v[152:155], v5, s[4:7], s94 offen offset:0 sc1
  buffer_load_dwordx4 v[156:159], v5, s[4:7], s94 offen offset:512 sc1
  buffer_load_dwordx4 v[160:163], v5, s[4:7], s94 offen offset:256 sc1
  buffer_load_dwordx4 v[164:167], v5, s[4:7], s94 offen offset:768 sc1
  s_add_u32 s94, s94, 4096
  buffer_load_dwordx4 v[168:171], v5, s[4:7], s94 offen offset:0 sc1
  buffer_load_dwordx4 v[172:175], v5, s[4:7], s94 offen offset:512 sc1
  buffer_load_dwordx4 v[176:179], v5, s[4:7], s94 offen offset:256 sc1
  buffer_load_dwordx4 v[180:183], v5, s[4:7], s94 offen offset:768 sc1
  s_mov_b64 exec, 1
  buffer_store_dword v38, off, s[4:7], s84 sc1
  s_mov_b64 exec, -1
  s_mov_b32 s84, 268435456
  v_mov_b64 v[188:189], 0
  v_mov_b64 v[190:191], 0
  v_mov_b64 v[192:193], 0
  v_mov_b64 v[194:195], 0
  s_waitcnt vmcnt(13)
  v_xor_b32 v7, s96, v120
  v_bitop3_b32 v7, v7, v124, s96 bitop3:0xf6
  v_bitop3_b32 v7, v7, v128, s96 bitop3:0xf6
  v_bitop3_b32 v7, v7, v132, s96 bitop3:0xf6
  s_waitcnt vmcnt(9)
  v_bitop3_b32 v7, v7, v136, s96 bitop3:0xf6
  v_bitop3_b32 v7, v7, v140, s96 bitop3:0xf6
  v_bitop3_b32 v7, v7, v144, s96 bitop3:0xf6
  v_bitop3_b32 v7, v7, v148, s96 bitop3:0xf6
  s_waitcnt vmcnt(5)
  v_bitop3_b32 v7, v7, v152, s96 bitop3:0xf6
  v_bitop3_b32 v7, v7, v156, s96 bitop3:0xf6
  v_bitop3_b32 v7, v7, v160, s96 bitop3:0xf6
  v_bitop3_b32 v7, v7, v164, s96 bitop3:0xf6
  s_waitcnt vmcnt(1)
  v_bitop3_b32 v7, v7, v168, s96 bitop3:0xf6
  v_bitop3_b32 v7, v7, v172, s96 bitop3:0xf6
  v_bitop3_b32 v7, v7, v176, s96 bitop3:0xf6
  v_bitop3_b32 v7, v7, v180, s96 bitop3:0xf6
  v_and_b32 v7, v254, v7
  v_cmp_ne_u32 vcc, 0, v7
  s_cbranch_vccnz o_rt_174
o_bk_175:
  v_smfmac_f32_16x16x64_bf16 v[188:191], v[16:19], v[120:127], v20
  v_lshlrev_b32 v196, 16, v184
  v_smfmac_f32_16x16x64_bf16 v[192:195], v[16:19], v[128:135], v20
  v_and_b32 v197, 0xffff0000, v184
  v_smfmac_f32_16x16x64_bf16 v[188:191], v[16:19], v[136:143], v20
  v_lshlrev_b32 v198, 16, v185
  v_smfmac_f32_16x16x64_bf16 v[192:195], v[16:19], v[144:151], v20
  v_and_b32 v199, 0xffff0000, v185
  v_smfmac_f32_16x16x64_bf16 v[188:191], v[16:19], v[152:159], v20
  v_lshlrev_b32 v200, 16, v186
  v_smfmac_f32_16x16x64_bf16 v[192:195], v[16:19], v[160:167], v20
  v_and_b32 v201, 0xffff0000, v186
  v_smfmac_f32_16x16x64_bf16 v[188:191], v[16:19], v[168:175], v20
  v_lshlrev_b32 v202, 16, v187
  v_smfmac_f32_16x16x64_bf16 v[192:195], v[16:19], v[176:183], v20
  v_and_b32 v203, 0xffff0000, v187
  s_bfe_u32 s92, s65, 131086
  s_lshl_b32 s92, s92, 21
  s_add_u32 s92, s92, s91
  s_add_u32 s93, s92, 27262976
  s_add_u32 s92, s92, 20971520
  s_nop 1
  v_permlane16_swap_b32 v188, v192
  v_permlane16_swap_b32 v189, v193
  v_permlane16_swap_b32 v190, v194
  v_permlane16_swap_b32 v191, v195
  v_cvt_pk_bf16_f32 v188, 0, v188
  v_cvt_pk_bf16_f32 v189, 0, v189
  v_cvt_pk_bf16_f32 v190, 0, v190
  v_cvt_pk_bf16_f32 v191, 0, v191
  v_cvt_pk_bf16_f32 v192, 0, v192
  v_cvt_pk_bf16_f32 v193, 0, v193
  v_cvt_pk_bf16_f32 v194, 0, v194
  v_cvt_pk_bf16_f32 v195, 0, v195
  v_add_f32 v196, v196, v188
  v_add_f32 v197, v197, v189
  v_add_f32 v198, v198, v190
  v_add_f32 v199, v199, v191
  v_add_f32 v200, v200, v192
  v_add_f32 v201, v201, v193
  v_add_f32 v202, v202, v194
  v_add_f32 v203, v203, v195
  v_cvt_pk_bf16_f32 v120, v196, v197
  v_cvt_pk_bf16_f32 v121, v198, v199
  v_cvt_pk_bf16_f32 v122, v200, v201
  v_cvt_pk_bf16_f32 v123, v202, v203
  v_lshlrev_b32 v196, 16, v120
  v_and_b32 v197, 0xffff0000, v120
  v_lshlrev_b32 v198, 16, v121
  v_and_b32 v199, 0xffff0000, v121
  v_lshlrev_b32 v200, 16, v122
  v_and_b32 v201, 0xffff0000, v122
  v_lshlrev_b32 v202, 16, v123
  v_and_b32 v203, 0xffff0000, v123
  buffer_store_dwordx4 v[120:123], v0, s[4:7], s92 offen sc1
  v_add_f32 v136, v196, v197
  v_mul_f32 v137, v196, v196
  v_add_f32 v138, v198, v199
  v_mul_f32 v139, v197, v197
  v_fmac_f32 v137, v198, v198
  v_fmac_f32 v139, v199, v199
  v_add_f32 v136, v136, v200
  v_fmac_f32 v137, v200, v200
  v_add_f32 v138, v138, v201
  v_fmac_f32 v139, v201, v201
  v_add_f32 v136, v136, v202
  v_fmac_f32 v137, v202, v202
  v_add_f32 v138, v138, v203
  v_fmac_f32 v139, v203, v203
  v_add_f32 v136, v136, v138
  v_add_f32 v137, v137, v139
  s_nop 0
  v_add_f32_dpp v136, v136, v136 row_ror:8 row_mask:0xf bank_mask:0xf
  v_add_f32_dpp v137, v137, v137 row_ror:8 row_mask:0xf bank_mask:0xf
  s_nop 0
  v_add_f32_dpp v136, v136, v136 row_ror:4 row_mask:0xf bank_mask:0xf
  v_add_f32_dpp v137, v137, v137 row_ror:4 row_mask:0xf bank_mask:0xf
  s_nop 0
  v_add_f32_dpp v136, v136, v136 row_ror:2 row_mask:0xf bank_mask:0xf
  v_add_f32_dpp v137, v137, v137 row_ror:2 row_mask:0xf bank_mask:0xf
  s_nop 0
  v_add_f32_dpp v136, v136, v136 row_ror:1 row_mask:0xf bank_mask:0xf
  v_add_f32_dpp v137, v137, v137 row_ror:1 row_mask:0xf bank_mask:0xf
  v_mov_b32 v140, v136
  v_mov_b32 v141, v137
  s_nop 0
  v_permlane16_swap_b32 v136, v140
  v_permlane16_swap_b32 v137, v141
  v_add_f32 v136, v136, v140
  v_add_f32 v137, v137, v141
  v_mov_b32 v140, v136
  v_mov_b32 v141, v137
  s_nop 0
  v_permlane32_swap_b32 v136, v140
  v_permlane32_swap_b32 v137, v141
  v_add_f32 v136, v136, v140
  v_add_f32 v137, v137, v141
  v_mul_f32 v136, 0x3b000000, v136
  v_mul_f32 v137, 0x3b000000, v137
  v_fma_f32 v137, -v136, v136, v137
  v_cvt_pk_bf16_f32 v136, 0, v136
  v_max_f32 v137, 0, v137
  v_sub_f32 v140, v196, v136
  v_sub_f32 v141, v197, v136
  v_cvt_pk_bf16_f32 v137, 0, v137
  v_sub_f32 v142, v198, v136
  v_sub_f32 v143, v199, v136
  v_add_f32 v137, 0x3727c5ac, v137
  v_sub_f32 v144, v200, v136
  v_sub_f32 v145, v201, v136
  v_cvt_pk_bf16_f32 v137, 0, v137
  v_sub_f32 v146, v202, v136
  v_sub_f32 v147, v203, v136
  v_sqrt_f32 v137, v137
  v_cvt_pk_bf16_f32 v140, 0, v140
  v_cvt_pk_bf16_f32 v141, 0, v141
  v_cvt_pk_bf16_f32 v137, 0, v137
  v_cvt_pk_bf16_f32 v142, 0, v142
  v_cvt_pk_bf16_f32 v143, 0, v143
  v_rcp_f32 v137, v137
  v_cvt_pk_bf16_f32 v144, 0, v144
  v_cvt_pk_bf16_f32 v145, 0, v145
  v_cvt_pk_bf16_f32 v146, 0, v146
  v_cvt_pk_bf16_f32 v147, 0, v147
  v_mul_f32 v140, v140, v137
  v_mul_f32 v141, v141, v137
  v_mul_f32 v142, v142, v137
  v_mul_f32 v143, v143, v137
  v_mul_f32 v144, v144, v137
  v_mul_f32 v145, v145, v137
  v_mul_f32 v146, v146, v137
  v_mul_f32 v147, v147, v137
  v_cvt_pk_bf16_f32 v124, v140, v141
  v_cvt_pk_bf16_f32 v125, v142, v143
  v_cvt_pk_bf16_f32 v126, v144, v145
  v_cvt_pk_bf16_f32 v127, v146, v147
  v_lshlrev_b32 v204, 16, v124
  v_and_b32 v205, 0xffff0000, v124
  v_lshlrev_b32 v206, 16, v125
  v_and_b32 v207, 0xffff0000, v125
  v_lshlrev_b32 v208, 16, v126
  v_and_b32 v209, 0xffff0000, v126
  v_lshlrev_b32 v210, 16, v127
  v_and_b32 v211, 0xffff0000, v127
  buffer_store_dwordx4 v[124:127], v0, s[4:7], s93 offen sc1
  v_add_f32 v196, v196, v204
  v_add_f32 v197, v197, v205
  v_add_f32 v198, v198, v206
  v_add_f32 v199, v199, v207
  v_add_f32 v200, v200, v208
  v_add_f32 v201, v201, v209
  v_add_f32 v202, v202, v210
  v_add_f32 v203, v203, v211
  v_cvt_pk_bf16_f32 v128, v196, v197
  v_cvt_pk_bf16_f32 v129, v198, v199
  v_cvt_pk_bf16_f32 v130, v200, v201
  v_cvt_pk_bf16_f32 v131, v202, v203
  v_mul_f32 v188, v204, v8
  v_mul_f32 v189, v205, v9
  v_fmac_f32 v188, v206, v10
  v_fmac_f32 v189, v207, v11
  v_fmac_f32 v188, v208, v12
  v_fmac_f32 v189, v209, v13
  v_fmac_f32 v188, v210, v14
  v_fmac_f32 v189, v211, v15
  v_add_f32 v188, v188, v189
  buffer_store_dwordx4 v[128:131], v0, s[68:71], s91 offen sc1
  s_nop 0
  v_add_f32_dpp v188, v188, v188 row_ror:8 row_mask:0xf bank_mask:0xf
  s_nop 1
  v_add_f32_dpp v188, v188, v188 row_ror:4 row_mask:0xf bank_mask:0xf
  s_nop 1
  v_add_f32_dpp v188, v188, v188 row_ror:2 row_mask:0xf bank_mask:0xf
  s_nop 1
  v_add_f32_dpp v188, v188, v188 row_ror:1 row_mask:0xf bank_mask:0xf
  v_mov_b32 v189, v188
  s_nop 0
  s_nop 0
  v_permlane16_swap_b32 v188, v189
  v_add_f32 v188, v188, v189
  v_mov_b32 v189, v188
  s_nop 0
  s_nop 0
  v_permlane32_swap_b32 v188, v189
  v_add_f32 v188, v188, v189
  v_cvt_pk_bf16_f32 v188, 0, v188
  v_ashrrev_i32 v189, 31, v188
  v_or_b32 v189, 0x80000000, v189
  v_xor_b32 v188, v188, v189
  s_sub_u32 s92, 4095, s90
  v_and_b32 v188, 0xffff0000, v188
  v_or_b32 v38, s92, v188
  s_bfe_u32 s92, s65, 196625
  s_lshl_b32 s92, s92, 18
  s_lshl_b32 s93, s90, 7
  s_add_u32 s92, s92, s93
  s_add_u32 s84, s92, 243269632
  s_waitcnt vmcnt(0)
  s_mov_b64 exec, 1
  buffer_store_dword v38, off, s[4:7], s84 sc1
  s_mov_b64 exec, -1
  s_mov_b32 s84, 268435456
  s_branch o_fd_167
o_rt_174:
  s_mov_b32 s67, 0
o_rl_176:
  s_lshl_b32 s94, s43, 14
  s_add_u32 s94, s94, s86
  buffer_load_dwordx4 v[120:123], v5, s[4:7], s94 offen offset:0 sc1
  buffer_load_dwordx4 v[124:127], v5, s[4:7], s94 offen offset:512 sc1
  buffer_load_dwordx4 v[128:131], v5, s[4:7], s94 offen offset:256 sc1
  buffer_load_dwordx4 v[132:135], v5, s[4:7], s94 offen offset:768 sc1
  s_add_u32 s94, s94, 4096
  buffer_load_dwordx4 v[136:139], v5, s[4:7], s94 offen offset:0 sc1
  buffer_load_dwordx4 v[140:143], v5, s[4:7], s94 offen offset:512 sc1
  buffer_load_dwordx4 v[144:147], v5, s[4:7], s94 offen offset:256 sc1
  buffer_load_dwordx4 v[148:151], v5, s[4:7], s94 offen offset:768 sc1
  s_add_u32 s94, s94, 4096
  buffer_load_dwordx4 v[152:155], v5, s[4:7], s94 offen offset:0 sc1
  buffer_load_dwordx4 v[156:159], v5, s[4:7], s94 offen offset:512 sc1
  buffer_load_dwordx4 v[160:163], v5, s[4:7], s94 offen offset:256 sc1
  buffer_load_dwordx4 v[164:167], v5, s[4:7], s94 offen offset:768 sc1
  s_add_u32 s94, s94, 4096
  buffer_load_dwordx4 v[168:171], v5, s[4:7], s94 offen offset:0 sc1
  buffer_load_dwordx4 v[172:175], v5, s[4:7], s94 offen offset:512 sc1
  buffer_load_dwordx4 v[176:179], v5, s[4:7], s94 offen offset:256 sc1
  buffer_load_dwordx4 v[180:183], v5, s[4:7], s94 offen offset:768 sc1
  s_add_u32 s67, s67, 1
  s_cmp_gt_u32 s67, 1048576
  s_cbranch_scc1 L_end
  s_waitcnt vmcnt(0)
  v_xor_b32 v7, s96, v120
  v_bitop3_b32 v7, v7, v124, s96 bitop3:0xf6
  v_bitop3_b32 v7, v7, v128, s96 bitop3:0xf6
  v_bitop3_b32 v7, v7, v132, s96 bitop3:0xf6
  v_bitop3_b32 v7, v7, v136, s96 bitop3:0xf6
  v_bitop3_b32 v7, v7, v140, s96 bitop3:0xf6
  v_bitop3_b32 v7, v7, v144, s96 bitop3:0xf6
  v_bitop3_b32 v7, v7, v148, s96 bitop3:0xf6
  v_bitop3_b32 v7, v7, v152, s96 bitop3:0xf6
  v_bitop3_b32 v7, v7, v156, s96 bitop3:0xf6
  v_bitop3_b32 v7, v7, v160, s96 bitop3:0xf6
  v_bitop3_b32 v7, v7, v164, s96 bitop3:0xf6
  v_bitop3_b32 v7, v7, v168, s96 bitop3:0xf6
  v_bitop3_b32 v7, v7, v172, s96 bitop3:0xf6
  v_bitop3_b32 v7, v7, v176, s96 bitop3:0xf6
  v_bitop3_b32 v7, v7, v180, s96 bitop3:0xf6
  v_and_b32 v7, v254, v7
  v_cmp_ne_u32 vcc, 0, v7
  s_cbranch_vccnz o_rl_176
  s_branch o_bk_175
o_fd_167:
  s_mov_b32 s65, 0
o_nofl_127:
  s_mov_b32 s63, s64
  s_cmp_lg_u32 s51, 0
  s_cbranch_scc1 o_pick_129
  s_cmp_eq_u32 s50, 0
  s_cbranch_scc1 o_help_136_n
o_adv_135:
  s_add_u32 s49, s49, 4
  s_branch o_round_125
o_dl_137_a:
  s_andn2_b32 s26, s58, s55
  s_and_b32 s29, s26, s54
  s_bcnt1_i32_b32 s27, s29
  s_add_u32 s27, s27, 2
  s_max_u32 s27, s27, 4
  s_andn2_b32 s26, s26, s56
  s_and_b32 s26, s26, 0x3fff
  s_or_b32 s26, s26, s29
  s_cselect_b32 s27, s27, 0
  s_mul_i32 s27, s27, 0
  s_cmp_ge_u32 s46, s89
  s_cselect_b32 s30, s54, -1
  s_mov_b32 s31, 243269696
  s_branch o_dl_137_b
o_dl_137:
  s_and_b32 s26, s55, s54
  s_andn2_b32 s27, s56, s54
  s_or_b32 s26, s26, s27
  s_andn2_b32 s26, s58, s26
  s_bcnt1_i32_b32 s27, s26
  s_bcnt1_i32_b32 s28, s47
  s_mul_i32 s28, s28, -5
  s_lshl1_add_u32 s27, s27, s28
  s_add_i32 s27, s27, 1
  s_max_i32 s27, s27, 0
  s_mul_i32 s27, s27, 37
  s_mov_b32 s30, s54
  s_mov_b32 s31, 243269704
  s_and_b32 s29, s26, s47
  s_andn2_b32 s26, s26, s29
  s_branch o_dl_137_c
o_dl_137_b:
  s_mov_b32 s29, 0
o_dl_137_c:
  s_bfe_u32 s28, s48, 262144
  s_bitset0_b32 s26, s28
  s_bfe_u32 s28, s48, 262148
  s_bitset0_b32 s26, s28
  s_bfe_u32 s28, s48, 262152
  s_bitset0_b32 s26, s28
  s_bfe_u32 s28, s48, 262156
  s_bitset0_b32 s26, s28
  s_lshr_b32 s27, s27, 8
o_dl1_138:
  s_cbranch_scc0 o_dl2_139
  s_ff1_i32_b32 s28, s26
  s_bitset0_b32 s26, s28
  s_bitset1_b32 s29, s28
  s_sub_u32 s27, s27, 1
  s_cmp_lg_u32 s27, 0
  s_branch o_dl1_138
o_dl2_139:
  s_and_b32 s47, s29, 0xffff
  s_and_b32 s30, s30, s47
  s_or_b32 s55, s55, s30
  s_andn2_b32 s26, s47, s30
  s_or_b32 s56, s56, s26
  s_pack_ll_b32_b16 s26, s47, s30
  s_lshl_b32 s27, s60, 7
  s_add_u32 s27, s27, s31
  s_cmp_lg_u32 s43, 0
  s_cbranch_scc1 o_pick_129
  v_mov_b32 v162, s26
  v_mov_b32 v163, s46
  s_mov_b64 exec, 1
  buffer_store_dwordx2 v[162:163], off, s[4:7], s27 sc1
  s_mov_b64 exec, -1
  s_branch o_pick_129
o_help_136:
  s_lshl_b32 s60, s60, 1
  s_and_b32 s60, s60, 2
  s_lshl_b32 s47, s60, 7
  s_add_u32 s47, s47, 243269688
o_help_136_n:
  s_add_u32 s47, s47, 8
  s_lshr_b32 s26, s47, 4
  s_andn2_b32 s26, s57, s26
  s_cbranch_scc0 L_end
  s_mov_b32 s67, 0
o_help_136_w:
  buffer_load_dwordx2 v[162:163], off, s[4:7], s47 sc1
  buffer_load_dwordx2 v[164:165], off, s[4:7], s47 offset:128 sc1
  s_add_u32 s67, s67, 1
  s_cmp_gt_u32 s67, 1048576
  s_cbranch_scc1 L_end
  s_waitcnt vmcnt(0)
  v_readfirstlane_b32 s28, v162
  v_readfirstlane_b32 s30, v164
  v_readfirstlane_b32 s46, v163
  v_readfirstlane_b32 s27, v165
  s_min_u32 s26, s46, s27
  s_cmp_eq_u32 s26, 0
  s_cbranch_scc1 o_help_136_w
  s_max_u32 s46, s46, s27
  s_bitreplicate_b64_b32 s[28:29], s28
  s_bitreplicate_b64_b32 s[30:31], s30
  s_mov_b32 s26, 0x55555555
  s_mov_b32 s27, 0x55555555
  s_and_b64 s[28:29], s[28:29], s[26:27]
  s_andn2_b64 s[30:31], s[30:31], s[26:27]
  s_or_b32 s58, s28, s30
  s_or_b32 s54, s29, s31
  s_andn2_b32 s52, 0xfff, s46
  s_lshr_b32 s52, s52, 5
  s_mov_b32 s53, 0
  s_mov_b32 s63, 0
  s_mov_b32 s49, 72
  s_mov_b32 s59, 64
  s_mov_b32 s50, 0
  s_mov_b32 s89, 0
  s_branch o_pick_129
L_o_x:
  s_mov_b32 s62, 1
  s_mov_b32 s42, 0
  s_mov_b32 s3, 0
  s_mov_b32 s46, 0
  s_mov_b32 s65, 0
  s_mov_b32 s66, 0
  s_mov_b32 s76, 0
  s_mov_b32 s55, 0
  s_mov_b32 s48, 0
  s_mov_b32 s56, 0
  s_mov_b32 s84, 268435456
  s_mov_b32 s86, s41
  s_mov_b32 s49, s60
  s_mul_i32 s63, s49, 257
  s_or_b32 s63, s63, 1179648
  s_lshr_b32 s57, s60, 2
  s_cbranch_scc1 o_help_188
o_round_177:
  s_max_u32 s46, s46, s3
  s_cmp_lg_u32 s3, 0
  s_mov_b32 s3, 0
  s_cbranch_scc1 d_g_193
  s_mov_b32 s67, 0
d_w_192:
  s_min_u32 s26, s49, 71
  s_lshl_b32 s26, s26, 12
  s_add_u32 s27, s26, 243494912
  s_add_u32 s26, s26, 243486720
  buffer_load_dword v248, v246, s[4:7], s26 offen sc1
  buffer_load_dword v249, v246, s[4:7], s27 offen sc1
  s_add_u32 s67, s67, 1
  s_cmp_gt_u32 s67, 1048576
  s_cbranch_scc1 L_end
  s_waitcnt vmcnt(0)
  s_mov_b64 exec, 1
  buffer_store_dword v38, off, s[4:7], s84 sc1
  s_mov_b64 exec, -1
  s_mov_b32 s84, 268435456
  v_min_u32 v162, v248, v249
  v_max_u32 v163, v248, v249
  v_cmp_eq_u32 vcc, 0, v162
  s_cbranch_vccnz d_w_192
  v_max_u32_dpp v163, v163, v163 row_ror:8 row_mask:0xf bank_mask:0xf
  s_nop 1
  v_max_u32_dpp v163, v163, v163 row_ror:4 row_mask:0xf bank_mask:0xf
  s_nop 1
  v_max_u32_dpp v163, v163, v163 row_ror:2 row_mask:0xf bank_mask:0xf
  s_nop 1
  v_max_u32_dpp v163, v163, v163 row_ror:1 row_mask:0xf bank_mask:0xf
  s_nop 0
  v_readlane_b32 s28, v163, 0
  v_readlane_b32 s29, v163, 16
  v_readlane_b32 s30, v163, 32
  v_readlane_b32 s31, v163, 48
  s_max_u32 s28, s28, s29
  s_max_u32 s30, s30, s31
  s_max_u32 s46, s46, s28
  s_max_u32 s46, s46, s30
d_g_193:
  s_lshr_b32 s27, s49, 2
  s_andn2_b32 s52, 0xfff, s46
  s_lshr_b32 s52, s52, 5
  s_min_u32 s52, s52, 64
  s_add_u32 s26, s52, 3
  v_readlane_b32 s89, v247, s27
  s_sub_u32 s26, s26, s60
  s_lshr_b32 s26, s26, 2
  s_bfm_b32 s54, s26, 0
  s_add_u32 s53, s63, 1028
  s_cmp_lt_u32 s49, 60
  s_cselect_b32 s53, s53, 0
  s_cmp_lt_u32 s49, 64
  s_cselect_b32 s26, 3, 1
  s_sub_i32 s26, s27, s26
  s_max_i32 s26, s26, 0
  s_min_u32 s26, s26, 16
  s_bfm_b32 s58, s26, 0
  s_cmp_eq_u32 s27, 16
  s_cselect_b32 s59, 2, 1
  s_cmp_eq_u32 s27, 17
  s_cselect_b32 s59, 0, s59
  s_cmp_eq_u32 s27, 18
  s_cselect_b32 s59, 64, s59
  s_cselect_b32 s50, 0, -1
  s_cselect_b32 s89, 0, s89
  s_cbranch_scc1 o_dl_189
  s_cmp_eq_u32 s27, 16
  s_cbranch_scc1 o_dl_189_a
o_pick_181:
  s_cmp_eq_u32 s59, 0
  s_cbranch_scc1 o_none_185
  s_sub_u32 s59, s59, 1
  s_andn2_b32 s26, s58, s55
  s_and_b32 s26, s26, s54
  s_cbranch_scc1 o_ga_182
  s_and_b32 s26, s55, s50
  s_or_b32 s26, s26, s56
  s_or_b32 s26, s26, s54
  s_andn2_b32 s26, s58, s26
  s_cbranch_scc0 o_none_185
  s_cmp_ge_u32 s46, s89
  s_cbranch_scc1 o_gb_183
o_ga_182:
  s_ff1_i32_b32 s26, s26
  s_bitset1_b32 s55, s26
  s_mov_b32 s64, 1327168
  s_mov_b32 s27, s64
  s_branch o_gd_184
o_none_185:
  s_cmp_lt_u32 s49, 60
  s_cbranch_scc1 o_nn_186
  s_cmp_eq_u32 s50, 0
  s_cbranch_scc1 o_nn_186
  s_and_b32 s26, s63, 1097728
  s_cmp_eq_u32 s26, 1048576
  s_cbranch_scc1 o_nn_186
  s_cmp_lt_u32 s49, 64
  s_cbranch_scc1 o_adv_187
  s_and_b32 s26, s65, 1097728
  s_cmp_lg_u32 s26, 1048576
  s_cbranch_scc1 o_adv_187
o_nn_186:
  s_mov_b32 s64, s53
  s_mov_b32 s51, 0
  s_branch o_task_178
o_gb_183:
  s_ff1_i32_b32 s26, s26
  s_bitset1_b32 s56, s26
  s_andn2_b32 s27, 31, s46
  s_or_b32 s27, s27, 32
  s_lshl_b32 s27, s27, 22
  s_or_b32 s27, s27, 1474688
  s_mov_b32 s64, 1474624
o_gd_184:
  s_lshl4_add_u32 s48, s48, s26
  s_and_b32 s28, s26, s57
  s_lshr_b32 s26, s26, s57
  s_lshl2_add_u32 s26, s26, s60
  s_add_u32 s26, s26, s28
  s_cmp_eq_u32 s26, s52
  s_cselect_b32 s64, s27, s64
  s_mul_i32 s26, s26, 257
  s_or_b32 s64, s64, s26
  s_mov_b32 s51, 1
o_task_178:
  s_cmp_eq_u32 s63, 0
  s_cbranch_scc1 o_nofl_179
  s_cmp_lg_u32 s66, 0
  s_cbranch_scc1 o_have_195
  s_mov_b32 s67, 0
o_w1_194:
  s_and_b32 s32, s63, 0xff
  s_lshl_b32 s32, s32, 12
  s_add_u32 s32, s32, s14
  buffer_load_dword v37, v36, s[4:7], s32 offen sc1
  s_add_u32 s67, s67, 1
  s_cmp_gt_u32 s67, 1048576
  s_cbranch_scc1 L_end
  s_waitcnt vmcnt(0)
  s_mov_b64 exec, 1
  buffer_store_dword v38, off, s[4:7], s84 sc1
  s_mov_b64 exec, -1
  s_mov_b32 s84, 268435456
  v_cmp_eq_u32 vcc, 0, v37
  s_cbranch_vccnz o_w1_194
  s_and_b32 s87, s63, 0xff
  s_lshl_b32 s33, s87, 18
  s_lshl_b32 s32, s87, 19
  s_add_u32 m0, s22, 0
  s_add_u32 s33, s33, s19
  buffer_load_dwordx4 v0, s[4:7], s33 offen offset:0 sc1 lds
  buffer_load_dwordx4 v0, s[4:7], s33 offen offset:1024 sc1 lds
  buffer_load_dwordx4 v0, s[4:7], s33 offen offset:2048 sc1 lds
  buffer_load_dwordx4 v0, s[4:7], s33 offen offset:3072 sc1 lds
  s_add_u32 m0, s23, 0
  s_add_u32 s32, s32, s18
  buffer_load_dwordx4 v0, s[4:7], s32 offen offset:0 sc1 lds
  buffer_load_dwordx4 v0, s[4:7], s32 offen offset:1024 sc1 lds
  buffer_load_dwordx4 v0, s[4:7], s32 offen offset:2048 sc1 lds
  buffer_load_dwordx4 v0, s[4:7], s32 offen offset:3072 sc1 lds
  s_add_u32 m0, m0, 4096
  s_add_u32 s32, s32, 4096
  buffer_load_dwordx4 v0, s[4:7], s32 offen offset:0 sc1 lds
  buffer_load_dwordx4 v0, s[4:7], s32 offen offset:1024 sc1 lds
  buffer_load_dwordx4 v0, s[4:7], s32 offen offset:2048 sc1 lds
  buffer_load_dwordx4 v0, s[4:7], s32 offen offset:3072 sc1 lds
  s_waitcnt vmcnt(0)
  s_barrier
o_have_195:
  ds_read_b128 v[120:123], v33 offset:0
  ds_read_b128 v[40:43], v32 offset:0
  ds_read_b128 v[56:59], v32 offset:1024
  ds_read_b128 v[124:127], v33 offset:2048
  ds_read_b128 v[44:47], v32 offset:4096
  ds_read_b128 v[60:63], v32 offset:5120
  ds_read_b128 v[128:131], v33 offset:4096
  ds_read_b128 v[48:51], v32 offset:8192
  ds_read_b128 v[64:67], v32 offset:9216
  ds_read_b128 v[132:135], v33 offset:6144
  ds_read_b128 v[52:55], v32 offset:12288
  ds_read_b128 v[68:71], v32 offset:13312
  s_cmp_lt_u32 s17, 2
  s_cselect_b32 s65, s65, 0
  s_cmp_lg_u32 s65, 0
  s_cselect_b64 s[44:45], -1, 0
  s_mov_b32 s95, s86
  s_mov_b32 s96, s42
  s_lshl_b32 s97, s43, 14
  s_add_u32 s97, s97, s95
  s_and_b32 s87, s64, 0xff
  s_lshl_b32 s87, s87, 12
  s_add_u32 s87, s87, s14
  s_and_b32 s88, s63, 0xff00
  s_lshl_b32 s88, s88, 3
  s_add_u32 s88, s88, s15
  s_and_b32 s91, s65, 63
  s_lshl_b32 s90, s91, 5
  s_add_u32 s94, s90, s85
  s_add_u32 s90, s90, s43
  s_lshl_b32 s94, s94, 10
  s_lshr_b32 s92, s65, 22
  s_xor_b32 s93, s43, 32
  s_lshl_b32 s91, s90, 10
  s_add_u32 s94, s94, 25165824
  s_cmp_eq_u32 s92, s93
  s_cselect_b32 s92, s94, s91
  s_add_u32 s92, s92, 10485760
  s_and_b32 s93, s65, 49152
  s_cselect_b32 s92, s92, s91
  s_cselect_b64 s[80:81], s[4:5], s[72:73]
  s_cselect_b32 s82, s6, s74
  s_waitcnt lgkmcnt(9)
  v_mfma_f32_16x16x32_bf16 v[104:107], v[40:43], v[120:123], v[24:27]
  v_mfma_f32_16x16x32_bf16 v[108:111], v[56:59], v[120:123], v[28:31]
  s_mov_b64 exec, s[44:45]
  buffer_load_dword v7, v255, s[4:7], s97 offen sc1
  buffer_load_dwordx4 v[184:187], v0, s[80:83], s92 offen sc1
  s_not_b64 exec, exec
  buffer_load_dword v37, v36, s[4:7], s87 offen sc1
  s_mov_b64 exec, -1
  buffer_load_dword v244, v252, s[4:7], s88 offen sc1
  s_waitcnt lgkmcnt(6)
  v_mfma_f32_16x16x32_bf16 v[104:107], v[44:47], v[124:127], v[104:107]
  v_mfma_f32_16x16x32_bf16 v[108:111], v[60:63], v[124:127], v[108:111]
  s_waitcnt lgkmcnt(3)
  v_mfma_f32_16x16x32_bf16 v[104:107], v[48:51], v[128:131], v[104:107]
  v_mfma_f32_16x16x32_bf16 v[108:111], v[64:67], v[128:131], v[108:111]
  s_waitcnt lgkmcnt(0)
  v_mfma_f32_16x16x32_bf16 v[104:107], v[52:55], v[132:135], v[104:107]
  v_mfma_f32_16x16x32_bf16 v[108:111], v[68:71], v[132:135], v[108:111]
  s_cmp_lg_u32 s76, 0
  s_cbranch_scc1 o_klds_198
  v_mov_b32 v196, 0
  v_mov_b32 v199, 0
  v_exp_f32 v56, v104
  v_exp_f32 v57, v105
  v_exp_f32 v58, v106
  v_exp_f32 v59, v107
  v_exp_f32 v60, v108
  v_exp_f32 v61, v109
  v_exp_f32 v62, v110
  v_exp_f32 v63, v111
  v_max3_f32 v116, v104, v105, v106
  v_max3_f32 v116, v107, v108, v116
  v_max3_f32 v116, v109, v110, v116
  v_add_f32 v117, v56, v57
  v_add_f32 v118, v58, v59
  v_add_f32 v117, v117, v60
  v_add_f32 v118, v118, v61
  v_add_f32 v117, v117, v62
  v_add_f32 v118, v118, v63
  s_mov_b32 s67, 0
  s_and_b32 s32, s63, 0xff00
  s_lshl_b32 s32, s32, 10
  s_add_u32 s32, s32, s20
  s_add_u32 s33, s32, 4096
o_w2_196:
  s_waitcnt vmcnt(0)
  v_cmp_eq_u32 vcc, 0, v244
  s_cbranch_vccz o_kgo_206
  s_mov_b64 exec, 1
  buffer_store_dword v38, off, s[4:7], s84 sc1
  s_mov_b64 exec, -1
  s_mov_b32 s84, 268435456
  buffer_load_dword v244, v252, s[4:7], s88 offen sc1
  s_add_u32 s67, s67, 1
  s_cmp_gt_u32 s67, 1048576
  s_cbranch_scc1 L_end
  s_branch o_w2_196
o_kgo_206:
  buffer_load_dwordx4 v[136:139], v0, s[4:7], s32 offen offset:0 sc1
  buffer_load_dwordx4 v[140:143], v0, s[4:7], s32 offen offset:1024 sc1
  buffer_load_dwordx4 v[144:147], v0, s[4:7], s32 offen offset:2048 sc1
  buffer_load_dwordx4 v[148:151], v0, s[4:7], s32 offen offset:3072 sc1
  buffer_load_dwordx2 v[200:201], v1, s[4:7], s33 offen offset:0 sc1
  buffer_load_dwordx2 v[202:203], v1, s[4:7], s33 offen offset:512 sc1
  buffer_load_dwordx2 v[204:205], v1, s[4:7], s33 offen offset:1024 sc1
  buffer_load_dwordx2 v[206:207], v1, s[4:7], s33 offen offset:1536 sc1
  buffer_load_dword v37, v36, s[4:7], s87 offen sc1
  buffer_load_dword v244, v252, s[4:7], s88 offen sc1
  s_barrier
  ds_read_b128 v[152:155], v32 offset:2048
  ds_read_b128 v[156:159], v32 offset:3072
  ds_read_b128 v[160:163], v32 offset:6144
  ds_read_b128 v[164:167], v32 offset:7168
  ds_read_b128 v[168:171], v32 offset:10240
  ds_read_b128 v[172:175], v32 offset:11264
  ds_read_b128 v[176:179], v32 offset:14336
  ds_read_b128 v[180:183], v32 offset:15360
  s_waitcnt vmcnt(9)
  v_mfma_f32_16x16x32_bf16 v[112:115], v[136:139], v[120:123], 0
  s_waitcnt vmcnt(8)
  v_mfma_f32_16x16x32_bf16 v[112:115], v[140:143], v[124:127], v[112:115]
  s_waitcnt vmcnt(7)
  v_mfma_f32_16x16x32_bf16 v[112:115], v[144:147], v[128:131], v[112:115]
  s_waitcnt vmcnt(6)
  v_mfma_f32_16x16x32_bf16 v[112:115], v[148:151], v[132:135], v[112:115]
  s_waitcnt vmcnt(2)
  s_branch o_havek_197
o_klds_198:
  s_waitcnt vmcnt(12)
  s_barrier
  ds_read_b128 v[136:139], v34 offset:0
  ds_read_b128 v[140:143], v34 offset:1024
  ds_read_b128 v[144:147], v34 offset:2048
  ds_read_b128 v[148:151], v34 offset:3072
  ds_read_b64 v[200:201], v35 offset:4096
  ds_read_b64 v[202:203], v35 offset:4608
  ds_read_b64 v[204:205], v35 offset:5120
  ds_read_b64 v[206:207], v35 offset:5632
  v_mov_b32 v196, 0
  v_mov_b32 v199, 0
  v_exp_f32 v56, v104
  v_exp_f32 v57, v105
  v_exp_f32 v58, v106
  v_exp_f32 v59, v107
  v_exp_f32 v60, v108
  v_exp_f32 v61, v109
  v_exp_f32 v62, v110
  v_exp_f32 v63, v111
  v_max3_f32 v116, v104, v105, v106
  v_max3_f32 v116, v107, v108, v116
  v_max3_f32 v116, v109, v110, v116
  s_waitcnt lgkmcnt(4)
  v_mfma_f32_16x16x32_bf16 v[112:115], v[136:139], v[120:123], 0
  ds_read_b128 v[152:155], v32 offset:2048
  ds_read_b128 v[156:159], v32 offset:3072
  v_mfma_f32_16x16x32_bf16 v[112:115], v[140:143], v[124:127], v[112:115]
  ds_read_b128 v[160:163], v32 offset:6144
  ds_read_b128 v[164:167], v32 offset:7168
  v_mfma_f32_16x16x32_bf16 v[112:115], v[144:147], v[128:131], v[112:115]
  ds_read_b128 v[168:171], v32 offset:10240
  ds_read_b128 v[172:175], v32 offset:11264
  v_mfma_f32_16x16x32_bf16 v[112:115], v[148:151], v[132:135], v[112:115]
  ds_read_b128 v[176:179], v32 offset:14336
  ds_read_b128 v[180:183], v32 offset:15360
  v_add_f32 v117, v56, v57
  v_add_f32 v118, v58, v59
  v_add_f32 v117, v117, v60
  v_add_f32 v118, v118, v61
  v_add_f32 v117, v117, v62
  v_add_f32 v118, v118, v63
o_havek_197:
  s_cmp_lg_u32 s65, 0
  s_cbranch_scc1 o_wr1_203
  s_nop 3
  v_mul_f32 v112, s24, v112
  v_mul_f32 v113, s24, v113
  v_exp_f32 v64, v112
  v_exp_f32 v65, v113
  v_max_f32 v116, v111, v116
  v_max3_f32 v116, v112, v113, v116
  v_add_f32 v117, v117, v64
  v_add_f32 v118, v118, v65
  v_add_f32 v117, v117, v118
  s_mov_b32 s28, 0x21800000
  v_mov_b32 v118, v117
  s_nop 1
  v_permlane16_swap_b32 v117, v118
  v_add_f32 v117, v117, v118
  v_mov_b32 v118, v117
  s_nop 0
  s_nop 0
  v_permlane32_swap_b32 v117, v118
  v_add_f32 v117, v117, v118
  v_cmp_lt_f32 vcc, 0x42700000, v116
  v_cmp_gt_f32 s[30:31], s28, v117
  v_rcp_f32 v117, v117
  s_or_b64 vcc, vcc, s[30:31]
  s_cbranch_vccnz o_fb_207
o_fbr_208:
  v_pk_mul_f32 v[56:57], v[56:57], v[116:117] op_sel:[0,1] op_sel_hi:[1,1]
  v_pk_mul_f32 v[58:59], v[58:59], v[116:117] op_sel:[0,1] op_sel_hi:[1,1]
  v_pk_mul_f32 v[60:61], v[60:61], v[116:117] op_sel:[0,1] op_sel_hi:[1,1]
  v_pk_mul_f32 v[62:63], v[62:63], v[116:117] op_sel:[0,1] op_sel_hi:[1,1]
  v_pk_mul_f32 v[64:65], v[64:65], v[116:117] op_sel:[0,1] op_sel_hi:[1,1]
  v_cvt_pk_bf16_f32 v116, v56, v57
  v_cvt_pk_bf16_f32 v117, v58, v59
  v_cvt_pk_bf16_f32 v118, v60, v61
  v_cvt_pk_bf16_f32 v119, v62, v63
  s_waitcnt lgkmcnt(0)
  s_nop 0
  v_mfma_f32_16x16x32_bf16 v[72:75], v[152:155], v[116:119], 0
  s_add_u32 s62, s62, 1
  v_cvt_pk_bf16_f32 v197, v64, v65
  v_cvt_pk_bf16_f32 v198, v64, v65
  v_mfma_f32_16x16x32_bf16 v[76:79], v[156:159], v[116:119], 0
  s_xor_b32 s86, s86, 524288
  v_mfma_f32_16x16x32_bf16 v[80:83], v[160:163], v[116:119], 0
  s_bfe_u32 s42, s62, 0x10001
  v_mfma_f32_16x16x32_bf16 v[84:87], v[164:167], v[116:119], 0
  s_bfe_u32 s26, s64, 65556
  v_mfma_f32_16x16x32_bf16 v[88:91], v[168:171], v[116:119], 0
  s_and_b32 s87, s64, 0xff
  v_mfma_f32_16x16x32_bf16 v[92:95], v[172:175], v[116:119], 0
  s_bfe_u32 s88, s64, 0x80008
  v_mfma_f32_16x16x32_bf16 v[96:99], v[176:179], v[116:119], 0
  s_nop 0
  v_mfma_f32_16x16x32_bf16 v[100:103], v[180:183], v[116:119], 0
  s_nop 0
  v_mfma_f32_16x16x16_bf16 v[72:75], v[200:201], v[198:199], v[72:75]
  s_nop 1
  v_mfma_f32_16x16x16_bf16 v[76:79], v[200:201], v[196:197], v[76:79]
  s_nop 1
  v_mfma_f32_16x16x16_bf16 v[80:83], v[202:203], v[198:199], v[80:83]
  s_nop 1
  v_mfma_f32_16x16x16_bf16 v[84:87], v[202:203], v[196:197], v[84:87]
  s_nop 1
  v_mfma_f32_16x16x16_bf16 v[88:91], v[204:205], v[198:199], v[88:91]
  s_nop 0
  v_cvt_pk_bf16_f32 v40, v72, v73
  v_cvt_pk_bf16_f32 v41, v74, v75
  v_mfma_f32_16x16x16_bf16 v[92:95], v[204:205], v[196:197], v[92:95]
  s_nop 0
  v_cvt_pk_bf16_f32 v42, v76, v77
  v_cvt_pk_bf16_f32 v43, v78, v79
  v_mfma_f32_16x16x16_bf16 v[96:99], v[206:207], v[198:199], v[96:99]
  s_nop 0
  ds_write_b128 v6, v[40:43] offset:0
  v_cvt_pk_bf16_f32 v44, v80, v81
  v_mfma_f32_16x16x16_bf16 v[100:103], v[206:207], v[196:197], v[100:103]
  s_nop 0
  v_cvt_pk_bf16_f32 v45, v82, v83
  v_cvt_pk_bf16_f32 v46, v84, v85
  v_cvt_pk_bf16_f32 v47, v86, v87
  ds_write_b128 v6, v[44:47] offset:1024
  v_cvt_pk_bf16_f32 v48, v88, v89
  v_cvt_pk_bf16_f32 v49, v90, v91
  v_cvt_pk_bf16_f32 v50, v92, v93
  v_cvt_pk_bf16_f32 v51, v94, v95
  ds_write_b128 v6, v[48:51] offset:2048
  v_cvt_pk_bf16_f32 v52, v96, v97
  v_cvt_pk_bf16_f32 v53, v98, v99
  v_cvt_pk_bf16_f32 v54, v100, v101
  v_cvt_pk_bf16_f32 v55, v102, v103
  ds_write_b128 v6, v[52:55] offset:3072
  s_cmp_lt_u32 s17, 2
  s_cbranch_scc1 o_wr0_202
  s_waitcnt lgkmcnt(0)
  s_barrier
  ds_read_b128 v[104:107], v3 offset:0
  ds_read_b128 v[108:111], v3 offset:512
  ds_read_b128 v[112:115], v3 offset:1024
  s_waitcnt lgkmcnt(2)
  v_mfma_f32_32x32x16_bf16 v[40:55], v[104:107], a[0:3], 0
  s_waitcnt vmcnt(0)
  v_cmp_eq_u32 vcc, 0, v37
  s_cmp_eq_u64 vcc, 0
  s_cselect_b32 s66, s26, 0
  s_cmp_eq_u32 s66, 1
  s_cselect_b32 s87, s87, 1024
  s_cselect_b32 s34, 0, 0x28000
  v_mfma_f32_32x32x16_bf16 v[56:71], v[104:107], a[4:7], 0
  ds_read_b128 v[116:119], v3 offset:1536
  s_lshl_b32 s33, s87, 18
  s_lshl_b32 s32, s87, 19
  s_add_u32 m0, s22, s34
  s_add_u32 s33, s33, s19
  s_min_u32 s28, s49, 67
  v_mfma_f32_32x32x16_bf16 v[72:87], v[104:107], a[8:11], 0
  s_lshl1_add_u32 s28, s17, s28
  s_lshl_b32 s28, s28, 12
  s_add_u32 s28, s28, 243486720
  v_mfma_f32_32x32x16_bf16 v[88:103], v[104:107], a[12:15], 0
  buffer_load_dword v249, v246, s[4:7], s28 offen sc1
  s_waitcnt lgkmcnt(2)
  v_mfma_f32_32x32x16_bf16 v[40:55], v[108:111], a[16:19], v[40:55]
  buffer_load_dwordx4 v0, s[4:7], s33 offen offset:0 sc1 lds
  v_mfma_f32_32x32x16_bf16 v[56:71], v[108:111], a[20:23], v[56:71]
  ds_read_b128 v[104:107], v3 offset:2048
  v_mfma_f32_32x32x16_bf16 v[72:87], v[108:111], a[24:27], v[72:87]
  buffer_load_dwordx4 v0, s[4:7], s33 offen offset:1024 sc1 lds
  v_mfma_f32_32x32x16_bf16 v[88:103], v[108:111], a[28:31], v[88:103]
  buffer_load_dwordx4 v0, s[4:7], s33 offen offset:2048 sc1 lds
  s_waitcnt lgkmcnt(2)
  v_mfma_f32_32x32x16_bf16 v[40:55], v[112:115], a[32:35], v[40:55]
  v_mfma_f32_32x32x16_bf16 v[56:71], v[112:115], a[36:39], v[56:71]
  ds_read_b128 v[108:111], v3 offset:2560
  buffer_load_dwordx4 v0, s[4:7], s33 offen offset:3072 sc1 lds
  s_sub_u32 m0, m0, 8192
  s_sub_u32 s33, s33, 8192
  v_mfma_f32_32x32x16_bf16 v[72:87], v[112:115], a[40:43], v[72:87]
  buffer_load_dwordx4 v0, s[4:7], s33 offen offset:0 sc1 lds
  v_mfma_f32_32x32x16_bf16 v[88:103], v[112:115], a[44:47], v[88:103]
  s_waitcnt lgkmcnt(2)
  v_mfma_f32_32x32x16_bf16 v[40:55], v[116:119], a[48:51], v[40:55]
  buffer_load_dwordx4 v0, s[4:7], s33 offen offset:1024 sc1 lds
  v_mfma_f32_32x32x16_bf16 v[56:71], v[116:119], a[52:55], v[56:71]
  ds_read_b128 v[112:115], v3 offset:3072
  buffer_load_dwordx4 v0, s[4:7], s33 offen offset:2048 sc1 lds
  v_mfma_f32_32x32x16_bf16 v[72:87], v[116:119], a[56:59], v[72:87]
  v_mfma_f32_32x32x16_bf16 v[88:103], v[116:119], a[60:63], v[88:103]
  buffer_load_dwordx4 v0, s[4:7], s33 offen offset:3072 sc1 lds
  s_add_u32 m0, s23, s34
  s_add_u32 s32, s32, s18
  s_waitcnt lgkmcnt(2)
  v_mfma_f32_32x32x16_bf16 v[40:55], v[104:107], a[64:67], v[40:55]
  buffer_load_dwordx4 v0, s[4:7], s32 offen offset:0 sc1 lds
  v_mfma_f32_32x32x16_bf16 v[56:71], v[104:107], a[68:71], v[56:71]
  ds_read_b128 v[116:119], v3 offset:3584
  v_mfma_f32_32x32x16_bf16 v[72:87], v[104:107], a[72:75], v[72:87]
  buffer_load_dwordx4 v0, s[4:7], s32 offen offset:1024 sc1 lds
  s_add_i32 m0, m0, 4096
  s_add_i32 s32, s32, 4096
  v_mfma_f32_32x32x16_bf16 v[88:103], v[104:107], a[76:79], v[88:103]
  buffer_load_dwordx4 v0, s[4:7], s32 offen offset:0 sc1 lds
  s_waitcnt lgkmcnt(2)
  v_mfma_f32_32x32x16_bf16 v[40:55], v[108:111], a[80:83], v[40:55]
  v_mfma_f32_32x32x16_bf16 v[56:71], v[108:111], a[84:87], v[56:71]
  ds_read_b128 v[104:107], v3 offset:8192
  buffer_load_dwordx4 v0, s[4:7], s32 offen offset:1024 sc1 lds
  s_add_i32 m0, m0, -16384
  s_add_i32 s32, s32, -16384
  v_mfma_f32_32x32x16_bf16 v[72:87], v[108:111], a[88:91], v[72:87]
  s_and_b32 s29, s64, 0xff00
  s_lshl_b32 s29, s29, 3
  s_add_u32 s29, s29, s15
  buffer_load_dword v245, v252, s[4:7], s29 offen sc1
  v_mfma_f32_32x32x16_bf16 v[88:103], v[108:111], a[92:95], v[88:103]
  s_waitcnt lgkmcnt(2)
  v_mfma_f32_32x32x16_bf16 v[40:55], v[112:115], a[96:99], v[40:55]
  buffer_load_dwordx4 v0, s[4:7], s32 offen offset:0 sc1 lds
  v_mfma_f32_32x32x16_bf16 v[56:71], v[112:115], a[100:103], v[56:71]
  ds_read_b128 v[108:111], v3 offset:8704
  buffer_load_dwordx4 v0, s[4:7], s32 offen offset:1024 sc1 lds
  s_add_i32 m0, m0, -4096
  s_add_i32 s32, s32, -4096
  v_mfma_f32_32x32x16_bf16 v[72:87], v[112:115], a[104:107], v[72:87]
  v_mfma_f32_32x32x16_bf16 v[88:103], v[112:115], a[108:111], v[88:103]
  buffer_load_dwordx4 v0, s[4:7], s32 offen offset:0 sc1 lds
  s_waitcnt lgkmcnt(2)
  v_mfma_f32_32x32x16_bf16 v[40:55], v[116:119], a[112:115], v[40:55]
  buffer_load_dwordx4 v0, s[4:7], s32 offen offset:1024 sc1 lds
  v_mfma_f32_32x32x16_bf16 v[56:71], v[116:119], a[116:119], v[56:71]
  ds_read_b128 v[112:115], v3 offset:9216
  v_mfma_f32_32x32x16_bf16 v[72:87], v[116:119], a[120:123], v[72:87]
  buffer_load_dwordx4 v0, s[4:7], s32 offen offset:2048 sc1 lds
  v_mfma_f32_32x32x16_bf16 v[88:103], v[116:119], a[124:127], v[88:103]
  buffer_load_dwordx4 v0, s[4:7], s32 offen offset:3072 sc1 lds
  s_add_i32 m0, m0, 4096
  s_add_i32 s32, s32, 4096
  s_waitcnt lgkmcnt(2)
  v_mfma_f32_32x32x16_bf16 v[40:55], v[104:107], a[128:131], v[40:55]
  v_mfma_f32_32x32x16_bf16 v[56:71], v[104:107], a[132:135], v[56:71]
  ds_read_b128 v[116:119], v3 offset:9728
  buffer_load_dwordx4 v0, s[4:7], s32 offen offset:2048 sc1 lds
  v_mfma_f32_32x32x16_bf16 v[72:87], v[104:107], a[136:139], v[72:87]
  buffer_load_dwordx4 v0, s[4:7], s32 offen offset:3072 sc1 lds
  s_add_i32 m0, m0, 16384
  s_add_i32 s32, s32, 16384
  v_mfma_f32_32x32x16_bf16 v[88:103], v[104:107], a[140:143], v[88:103]
  s_waitcnt lgkmcnt(2)
  v_mfma_f32_32x32x16_bf16 v[40:55], v[108:111], a[144:147], v[40:55]
  buffer_load_dwordx4 v0, s[4:7], s32 offen offset:2048 sc1 lds
  v_mfma_f32_32x32x16_bf16 v[56:71], v[108:111], a[148:151], v[56:71]
  ds_read_b128 v[104:107], v3 offset:10240
  buffer_load_dwordx4 v0, s[4:7], s32 offen offset:3072 sc1 lds
  s_add_i32 m0, m0, -4096
  s_add_i32 s32, s32, -4096
  v_mfma_f32_32x32x16_bf16 v[72:87], v[108:111], a[152:155], v[72:87]
  v_mfma_f32_32x32x16_bf16 v[88:103], v[108:111], a[156:159], v[88:103]
  buffer_load_dwordx4 v0, s[4:7], s32 offen offset:2048 sc1 lds
  s_waitcnt lgkmcnt(2)
  v_mfma_f32_32x32x16_bf16 v[40:55], v[112:115], a[160:163], v[40:55]
  buffer_load_dwordx4 v0, s[4:7], s32 offen offset:3072 sc1 lds
  v_mfma_f32_32x32x16_bf16 v[56:71], v[112:115], a[164:167], v[56:71]
  ds_read_b128 v[108:111], v3 offset:10752
  v_mfma_f32_32x32x16_bf16 v[72:87], v[112:115], a[168:171], v[72:87]
  v_mfma_f32_32x32x16_bf16 v[88:103], v[112:115], a[172:175], v[88:103]
  s_waitcnt lgkmcnt(2)
  v_mfma_f32_32x32x16_bf16 v[40:55], v[116:119], a[176:179], v[40:55]
  v_mfma_f32_32x32x16_bf16 v[56:71], v[116:119], a[180:183], v[56:71]
  ds_read_b128 v[112:115], v3 offset:11264
  v_mfma_f32_32x32x16_bf16 v[72:87], v[116:119], a[184:187], v[72:87]
  v_mfma_f32_32x32x16_bf16 v[88:103], v[116:119], a[188:191], v[88:103]
  s_waitcnt lgkmcnt(2)
  v_mfma_f32_32x32x16_bf16 v[40:55], v[104:107], a[192:195], v[40:55]
  v_mfma_f32_32x32x16_bf16 v[56:71], v[104:107], a[196:199], v[56:71]
  ds_read_b128 v[116:119], v3 offset:11776
  s_waitcnt vmcnt(12)
  v_cmp_eq_u32 vcc, 0, v245
  s_cmp_eq_u64 vcc, 0
  s_cselect_b32 s76, s26, 0
  s_and_b32 s76, s76, 1
  s_cselect_b32 s88, s88, 1024
  s_waitcnt lgkmcnt(2)
  v_mfma_f32_32x32x16_bf16 v[40:55], v[108:111], a[208:211], v[40:55]
  s_lshl_b32 s32, s88, 18
  s_mov_b32 m0, s40
  s_add_u32 s32, s32, s21
  buffer_load_dwordx4 v0, s[4:7], s32 offen offset:0 sc1 lds
  v_mfma_f32_32x32x16_bf16 v[56:71], v[108:111], a[212:215], v[56:71]
  buffer_load_dwordx4 v0, s[4:7], s32 offen offset:1024 sc1 lds
  s_waitcnt lgkmcnt(1)
  v_mfma_f32_32x32x16_bf16 v[40:55], v[112:115], a[224:227], v[40:55]
  buffer_load_dwordx4 v0, s[4:7], s32 offen offset:2048 sc1 lds
  s_sub_u32 m0, m0, 8192
  s_sub_u32 s32, s32, 8192
  v_mfma_f32_32x32x16_bf16 v[56:71], v[112:115], a[228:231], v[56:71]
  buffer_load_dwordx4 v0, s[4:7], s32 offen offset:0 sc1 lds
  s_waitcnt lgkmcnt(0)
  v_mfma_f32_32x32x16_bf16 v[40:55], v[116:119], a[240:243], v[40:55]
  buffer_load_dwordx4 v0, s[4:7], s32 offen offset:1024 sc1 lds
  v_mfma_f32_32x32x16_bf16 v[56:71], v[116:119], a[244:247], v[56:71]
  buffer_load_dwordx4 v0, s[4:7], s32 offen offset:2048 sc1 lds
  v_cmp_eq_u32 vcc, 0, v249
  v_max_u32_dpp v249, v249, v249 row_ror:8 row_mask:0xf bank_mask:0xf
  s_nop 0
  v_mfma_f32_32x32x16_bf16 v[72:87], v[104:107], a[200:203], v[72:87]
  v_max_u32_dpp v249, v249, v249 row_ror:4 row_mask:0xf bank_mask:0xf
  s_nop 0
  s_nop 0
  v_max_u32_dpp v249, v249, v249 row_ror:2 row_mask:0xf bank_mask:0xf
  s_nop 0
  s_nop 0
  v_max_u32_dpp v249, v249, v249 row_ror:1 row_mask:0xf bank_mask:0xf
  s_nop 0
  v_mfma_f32_32x32x16_bf16 v[88:103], v[104:107], a[204:207], v[88:103]
  v_mov_b32 v248, v249
  s_nop 0
  s_nop 0
  v_permlane16_swap_b32 v249, v248
  v_max_u32 v249, v249, v248
  v_mfma_f32_32x32x16_bf16 v[72:87], v[108:111], a[216:219], v[72:87]
  v_mov_b32 v248, v249
  s_nop 0
  s_nop 0
  v_permlane32_swap_b32 v249, v248
  v_max_u32 v249, v249, v248
  s_cmp_eq_u64 vcc, 0
  s_cselect_b32 s28, 4, 0
  v_mfma_f32_32x32x16_bf16 v[88:103], v[108:111], a[220:223], v[88:103]
  s_lshl_b32 s26, s76, 1
  s_or_b32 s26, s26, s66
  s_or_b32 s26, s26, s28
  v_mov_b32 v248, s26
  ds_write_b64 v39, v[248:249]
  v_mfma_f32_32x32x16_bf16 v[72:87], v[112:115], a[232:235], v[72:87]
  v_cvt_pk_bf16_f32 v212, v40, v56
  v_cvt_pk_bf16_f32 v214, v41, v57
  v_cvt_pk_bf16_f32 v216, v42, v58
  v_cvt_pk_bf16_f32 v218, v43, v59
  v_permlane16_swap_b32 v212, v214
  v_mfma_f32_32x32x16_bf16 v[88:103], v[112:115], a[236:239], v[88:103]
  v_cvt_pk_bf16_f32 v220, v44, v60
  v_cvt_pk_bf16_f32 v222, v45, v61
  v_permlane16_swap_b32 v216, v218
  v_bfi_b32 v212, v254, s42, v212
  v_mfma_f32_32x32x16_bf16 v[72:87], v[116:119], a[248:251], v[72:87]
  v_cvt_pk_bf16_f32 v224, v46, v62
  v_cvt_pk_bf16_f32 v226, v47, v63
  v_permlane16_swap_b32 v220, v222
  v_bfi_b32 v216, v254, s42, v216
  v_cvt_pk_bf16_f32 v228, v48, v64
  v_mfma_f32_32x32x16_bf16 v[88:103], v[116:119], a[252:255], v[88:103]
  v_cvt_pk_bf16_f32 v230, v49, v65
  v_permlane16_swap_b32 v224, v226
  v_bfi_b32 v220, v254, s42, v220
  v_cvt_pk_bf16_f32 v232, v50, v66
  v_cvt_pk_bf16_f32 v234, v51, v67
  v_permlane16_swap_b32 v228, v230
  v_bfi_b32 v224, v254, s42, v224
  v_cvt_pk_bf16_f32 v236, v52, v68
  v_cvt_pk_bf16_f32 v238, v53, v69
  v_permlane16_swap_b32 v232, v234
  v_bfi_b32 v228, v254, s42, v228
  v_cvt_pk_bf16_f32 v240, v54, v70
  v_cvt_pk_bf16_f32 v242, v55, v71
  v_permlane16_swap_b32 v236, v238
  v_bfi_b32 v232, v254, s42, v232
  v_permlane16_swap_b32 v240, v242
  v_bfi_b32 v236, v254, s42, v236
  v_bfi_b32 v240, v254, s42, v240
  v_cvt_pk_bf16_f32 v213, v72, v88
  v_cvt_pk_bf16_f32 v215, v73, v89
  v_cvt_pk_bf16_f32 v217, v74, v90
  v_cvt_pk_bf16_f32 v219, v75, v91
  s_add_u32 s78, s86, 0
  v_permlane16_swap_b32 v213, v215
  buffer_store_dwordx4 v[212:215], v4, s[4:7], s78 offen sc1
  v_cvt_pk_bf16_f32 v221, v76, v92
  v_cvt_pk_bf16_f32 v223, v77, v93
  s_add_u32 s78, s86, 32768
  v_permlane16_swap_b32 v217, v219
  buffer_store_dwordx4 v[216:219], v4, s[4:7], s78 offen sc1
  v_cvt_pk_bf16_f32 v225, v78, v94
  v_cvt_pk_bf16_f32 v227, v79, v95
  s_add_u32 s78, s86, 131072
  v_permlane16_swap_b32 v221, v223
  buffer_store_dwordx4 v[220:223], v4, s[4:7], s78 offen sc1
  v_cvt_pk_bf16_f32 v229, v80, v96
  v_cvt_pk_bf16_f32 v231, v81, v97
  s_add_u32 s78, s86, 163840
  v_permlane16_swap_b32 v225, v227
  buffer_store_dwordx4 v[224:227], v4, s[4:7], s78 offen sc1
  v_cvt_pk_bf16_f32 v233, v82, v98
  v_cvt_pk_bf16_f32 v235, v83, v99
  s_add_u32 s78, s86, 262144
  v_permlane16_swap_b32 v229, v231
  buffer_store_dwordx4 v[228:231], v4, s[4:7], s78 offen sc1
  v_cvt_pk_bf16_f32 v237, v84, v100
  v_cvt_pk_bf16_f32 v239, v85, v101
  s_add_u32 s78, s86, 294912
  v_permlane16_swap_b32 v233, v235
  buffer_store_dwordx4 v[232:235], v4, s[4:7], s78 offen sc1
  v_cvt_pk_bf16_f32 v241, v86, v102
  v_cvt_pk_bf16_f32 v243, v87, v103
  s_add_u32 s78, s86, 393216
  v_permlane16_swap_b32 v237, v239
  buffer_store_dwordx4 v[236:239], v4, s[4:7], s78 offen sc1
  s_add_u32 s78, s86, 425984
  v_permlane16_swap_b32 v241, v243
  buffer_store_dwordx4 v[240:243], v4, s[4:7], s78 offen sc1
  s_waitcnt vmcnt(22)
  s_branch o_we_205
o_wr0_202:
  s_waitcnt lgkmcnt(0)
  s_barrier
  ds_read_b128 v[104:107], v3 offset:0
  ds_read_b128 v[108:111], v3 offset:512
  ds_read_b128 v[112:115], v3 offset:1024
  s_waitcnt lgkmcnt(2)
  v_mfma_f32_32x32x16_bf16 v[40:55], v[104:107], a[0:3], 0
  v_mfma_f32_32x32x16_bf16 v[56:71], v[104:107], a[4:7], 0
  ds_read_b128 v[116:119], v3 offset:1536
  v_mfma_f32_32x32x16_bf16 v[72:87], v[104:107], a[8:11], 0
  v_mfma_f32_32x32x16_bf16 v[88:103], v[104:107], a[12:15], 0
  s_waitcnt lgkmcnt(2)
  v_mfma_f32_32x32x16_bf16 v[40:55], v[108:111], a[16:19], v[40:55]
  v_mfma_f32_32x32x16_bf16 v[56:71], v[108:111], a[20:23], v[56:71]
  ds_read_b128 v[104:107], v3 offset:2048
  v_mfma_f32_32x32x16_bf16 v[72:87], v[108:111], a[24:27], v[72:87]
  v_mfma_f32_32x32x16_bf16 v[88:103], v[108:111], a[28:31], v[88:103]
  s_waitcnt lgkmcnt(2)
  v_mfma_f32_32x32x16_bf16 v[40:55], v[112:115], a[32:35], v[40:55]
  v_mfma_f32_32x32x16_bf16 v[56:71], v[112:115], a[36:39], v[56:71]
  ds_read_b128 v[108:111], v3 offset:2560
  v_mfma_f32_32x32x16_bf16 v[72:87], v[112:115], a[40:43], v[72:87]
  v_mfma_f32_32x32x16_bf16 v[88:103], v[112:115], a[44:47], v[88:103]
  s_waitcnt lgkmcnt(2)
  v_mfma_f32_32x32x16_bf16 v[40:55], v[116:119], a[48:51], v[40:55]
  v_mfma_f32_32x32x16_bf16 v[56:71], v[116:119], a[52:55], v[56:71]
  ds_read_b128 v[112:115], v3 offset:3072
  v_mfma_f32_32x32x16_bf16 v[72:87], v[116:119], a[56:59], v[72:87]
  v_mfma_f32_32x32x16_bf16 v[88:103], v[116:119], a[60:63], v[88:103]
  s_waitcnt lgkmcnt(2)
  v_mfma_f32_32x32x16_bf16 v[40:55], v[104:107], a[64:67], v[40:55]
  v_mfma_f32_32x32x16_bf16 v[56:71], v[104:107], a[68:71], v[56:71]
  ds_read_b128 v[116:119], v3 offset:3584
  v_mfma_f32_32x32x16_bf16 v[72:87], v[104:107], a[72:75], v[72:87]
  v_mfma_f32_32x32x16_bf16 v[88:103], v[104:107], a[76:79], v[88:103]
  s_waitcnt lgkmcnt(2)
  v_mfma_f32_32x32x16_bf16 v[40:55], v[108:111], a[80:83], v[40:55]
  v_mfma_f32_32x32x16_bf16 v[56:71], v[108:111], a[84:87], v[56:71]
  ds_read_b128 v[104:107], v3 offset:8192
  v_mfma_f32_32x32x16_bf16 v[72:87], v[108:111], a[88:91], v[72:87]
  v_mfma_f32_32x32x16_bf16 v[88:103], v[108:111], a[92:95], v[88:103]
  s_waitcnt lgkmcnt(2)
  v_mfma_f32_32x32x16_bf16 v[40:55], v[112:115], a[96:99], v[40:55]
  v_mfma_f32_32x32x16_bf16 v[56:71], v[112:115], a[100:103], v[56:71]
  ds_read_b128 v[108:111], v3 offset:8704
  v_mfma_f32_32x32x16_bf16 v[72:87], v[112:115], a[104:107], v[72:87]
  v_mfma_f32_32x32x16_bf16 v[88:103], v[112:115], a[108:111], v[88:103]
  s_waitcnt lgkmcnt(2)
  v_mfma_f32_32x32x16_bf16 v[40:55], v[116:119], a[112:115], v[40:55]
  v_mfma_f32_32x32x16_bf16 v[56:71], v[116:119], a[116:119], v[56:71]
  ds_read_b128 v[112:115], v3 offset:9216
  v_mfma_f32_32x32x16_bf16 v[72:87], v[116:119], a[120:123], v[72:87]
  v_mfma_f32_32x32x16_bf16 v[88:103], v[116:119], a[124:127], v[88:103]
  s_waitcnt lgkmcnt(2)
  v_mfma_f32_32x32x16_bf16 v[40:55], v[104:107], a[128:131], v[40:55]
  v_mfma_f32_32x32x16_bf16 v[56:71], v[104:107], a[132:135], v[56:71]
  ds_read_b128 v[116:119], v3 offset:9728
  v_mfma_f32_32x32x16_bf16 v[72:87], v[104:107], a[136:139], v[72:87]
  v_mfma_f32_32x32x16_bf16 v[88:103], v[104:107], a[140:143], v[88:103]
  s_waitcnt lgkmcnt(2)
  v_mfma_f32_32x32x16_bf16 v[40:55], v[108:111], a[144:147], v[40:55]
  v_mfma_f32_32x32x16_bf16 v[56:71], v[108:111], a[148:151], v[56:71]
  ds_read_b128 v[104:107], v3 offset:10240
  v_mfma_f32_32x32x16_bf16 v[72:87], v[108:111], a[152:155], v[72:87]
  v_mfma_f32_32x32x16_bf16 v[88:103], v[108:111], a[156:159], v[88:103]
  s_waitcnt lgkmcnt(2)
  v_mfma_f32_32x32x16_bf16 v[40:55], v[112:115], a[160:163], v[40:55]
  v_mfma_f32_32x32x16_bf16 v[56:71], v[112:115], a[164:167], v[56:71]
  ds_read_b128 v[108:111], v3 offset:10752
  v_mfma_f32_32x32x16_bf16 v[72:87], v[112:115], a[168:171], v[72:87]
  v_mfma_f32_32x32x16_bf16 v[88:103], v[112:115], a[172:175], v[88:103]
  s_waitcnt lgkmcnt(2)
  v_mfma_f32_32x32x16_bf16 v[40:55], v[116:119], a[176:179], v[40:55]
  v_mfma_f32_32x32x16_bf16 v[56:71], v[116:119], a[180:183], v[56:71]
  ds_read_b128 v[112:115], v3 offset:11264
  v_mfma_f32_32x32x16_bf16 v[72:87], v[116:119], a[184:187], v[72:87]
  v_mfma_f32_32x32x16_bf16 v[88:103], v[116:119], a[188:191], v[88:103]
  s_waitcnt lgkmcnt(2)
  v_mfma_f32_32x32x16_bf16 v[40:55], v[104:107], a[192:195], v[40:55]
  v_mfma_f32_32x32x16_bf16 v[56:71], v[104:107], a[196:199], v[56:71]
  ds_read_b128 v[116:119], v3 offset:11776
  s_waitcnt lgkmcnt(2)
  v_mfma_f32_32x32x16_bf16 v[40:55], v[108:111], a[208:211], v[40:55]
  v_mfma_f32_32x32x16_bf16 v[56:71], v[108:111], a[212:215], v[56:71]
  s_waitcnt lgkmcnt(1)
  v_mfma_f32_32x32x16_bf16 v[40:55], v[112:115], a[224:227], v[40:55]
  v_mfma_f32_32x32x16_bf16 v[56:71], v[112:115], a[228:231], v[56:71]
  s_waitcnt lgkmcnt(0)
  v_mfma_f32_32x32x16_bf16 v[40:55], v[116:119], a[240:243], v[40:55]
  v_mfma_f32_32x32x16_bf16 v[56:71], v[116:119], a[244:247], v[56:71]
  v_mfma_f32_32x32x16_bf16 v[72:87], v[104:107], a[200:203], v[72:87]
  v_mfma_f32_32x32x16_bf16 v[88:103], v[104:107], a[204:207], v[88:103]
  v_cvt_pk_bf16_f32 v212, v40, v56
  v_cvt_pk_bf16_f32 v214, v41, v57
  v_cvt_pk_bf16_f32 v216, v42, v58
  v_cvt_pk_bf16_f32 v218, v43, v59
  v_permlane16_swap_b32 v212, v214
  v_mfma_f32_32x32x16_bf16 v[72:87], v[108:111], a[216:219], v[72:87]
  v_cvt_pk_bf16_f32 v220, v44, v60
  v_cvt_pk_bf16_f32 v222, v45, v61
  v_permlane16_swap_b32 v216, v218
  v_bfi_b32 v212, v254, s42, v212
  v_cvt_pk_bf16_f32 v224, v46, v62
  v_mfma_f32_32x32x16_bf16 v[88:103], v[108:111], a[220:223], v[88:103]
  v_cvt_pk_bf16_f32 v226, v47, v63
  v_permlane16_swap_b32 v220, v222
  v_bfi_b32 v216, v254, s42, v216
  v_cvt_pk_bf16_f32 v228, v48, v64
  v_mfma_f32_32x32x16_bf16 v[72:87], v[112:115], a[232:235], v[72:87]
  v_cvt_pk_bf16_f32 v230, v49, v65
  v_permlane16_swap_b32 v224, v226
  v_bfi_b32 v220, v254, s42, v220
  v_cvt_pk_bf16_f32 v232, v50, v66
  v_cvt_pk_bf16_f32 v234, v51, v67
  v_mfma_f32_32x32x16_bf16 v[88:103], v[112:115], a[236:239], v[88:103]
  v_permlane16_swap_b32 v228, v230
  v_bfi_b32 v224, v254, s42, v224
  v_cvt_pk_bf16_f32 v236, v52, v68
  v_cvt_pk_bf16_f32 v238, v53, v69
  v_mfma_f32_32x32x16_bf16 v[72:87], v[116:119], a[248:251], v[72:87]
  v_permlane16_swap_b32 v232, v234
  v_bfi_b32 v228, v254, s42, v228
  v_cvt_pk_bf16_f32 v240, v54, v70
  v_cvt_pk_bf16_f32 v242, v55, v71
  v_permlane16_swap_b32 v236, v238
  v_mfma_f32_32x32x16_bf16 v[88:103], v[116:119], a[252:255], v[88:103]
  v_bfi_b32 v232, v254, s42, v232
  v_permlane16_swap_b32 v240, v242
  v_bfi_b32 v236, v254, s42, v236
  v_bfi_b32 v240, v254, s42, v240
  s_nop 7
  v_cvt_pk_bf16_f32 v213, v72, v88
  v_cvt_pk_bf16_f32 v215, v73, v89
  v_cvt_pk_bf16_f32 v217, v74, v90
  v_cvt_pk_bf16_f32 v219, v75, v91
  s_add_u32 s78, s86, 0
  v_permlane16_swap_b32 v213, v215
  buffer_store_dwordx4 v[212:215], v4, s[4:7], s78 offen sc1
  v_cvt_pk_bf16_f32 v221, v76, v92
  v_cvt_pk_bf16_f32 v223, v77, v93
  s_add_u32 s78, s86, 32768
  v_permlane16_swap_b32 v217, v219
  buffer_store_dwordx4 v[216:219], v4, s[4:7], s78 offen sc1
  v_cvt_pk_bf16_f32 v225, v78, v94
  v_cvt_pk_bf16_f32 v227, v79, v95
  s_add_u32 s78, s86, 131072
  v_permlane16_swap_b32 v221, v223
  buffer_store_dwordx4 v[220:223], v4, s[4:7], s78 offen sc1
  v_cvt_pk_bf16_f32 v229, v80, v96
  v_cvt_pk_bf16_f32 v231, v81, v97
  s_add_u32 s78, s86, 163840
  v_permlane16_swap_b32 v225, v227
  buffer_store_dwordx4 v[224:227], v4, s[4:7], s78 offen sc1
  v_cvt_pk_bf16_f32 v233, v82, v98
  v_cvt_pk_bf16_f32 v235, v83, v99
  s_add_u32 s78, s86, 262144
  v_permlane16_swap_b32 v229, v231
  buffer_store_dwordx4 v[228:231], v4, s[4:7], s78 offen sc1
  v_cvt_pk_bf16_f32 v237, v84, v100
  v_cvt_pk_bf16_f32 v239, v85, v101
  s_add_u32 s78, s86, 294912
  v_permlane16_swap_b32 v233, v235
  buffer_store_dwordx4 v[232:235], v4, s[4:7], s78 offen sc1
  v_cvt_pk_bf16_f32 v241, v86, v102
  v_cvt_pk_bf16_f32 v243, v87, v103
  s_add_u32 s78, s86, 393216
  v_permlane16_swap_b32 v237, v239
  buffer_store_dwordx4 v[236:239], v4, s[4:7], s78 offen sc1
  s_add_u32 s78, s86, 425984
  v_permlane16_swap_b32 v241, v243
  buffer_store_dwordx4 v[240:243], v4, s[4:7], s78 offen sc1
  s_branch o_we_205
o_wr1_203:
  s_nop 3
  v_mul_f32 v112, s24, v112
  v_mul_f32 v113, s24, v113
  v_exp_f32 v64, v112
  v_exp_f32 v65, v113
  v_max_f32 v116, v111, v116
  v_max3_f32 v116, v112, v113, v116
  v_add_f32 v117, v117, v64
  v_add_f32 v118, v118, v65
  v_add_f32 v117, v117, v118
  s_mov_b32 s28, 0x21800000
  v_mov_b32 v118, v117
  s_nop 1
  v_permlane16_swap_b32 v117, v118
  v_add_f32 v117, v117, v118
  v_mov_b32 v118, v117
  s_nop 0
  s_nop 0
  v_permlane32_swap_b32 v117, v118
  v_add_f32 v117, v117, v118
  s_mov_b32 s67, 0
  s_mov_b64 vcc, 0
  s_waitcnt vmcnt(3)
o_pl_211:
  v_and_b32 v7, 1, v7
  v_cmp_ne_u32 vcc, s96, v7
  s_cbranch_vccz o_pk_212
  buffer_load_dword v7, v255, s[4:7], s97 offen sc1
  s_add_u32 s67, s67, 1
  s_cmp_gt_u32 s67, 1048576
  s_cbranch_scc1 L_end
  s_waitcnt vmcnt(0)
  s_branch o_pl_211
o_pk_212:
  s_lshl_b32 s94, s43, 14
  s_add_u32 s94, s94, s95
  buffer_load_dwordx4 v[120:123], v5, s[4:7], s94 offen offset:0 sc1
  v_cmp_lt_f32 vcc, 0x42700000, v116
  v_cmp_gt_f32 s[30:31], s28, v117
  v_rcp_f32 v117, v117
  buffer_load_dwordx4 v[124:127], v5, s[4:7], s94 offen offset:512 sc1
  s_or_b64 vcc, vcc, s[30:31]
  s_cbranch_vccnz o_fb_209
o_fbr_210:
  buffer_load_dwordx4 v[128:131], v5, s[4:7], s94 offen offset:256 sc1
  v_pk_mul_f32 v[56:57], v[56:57], v[116:117] op_sel:[0,1] op_sel_hi:[1,1]
  v_pk_mul_f32 v[58:59], v[58:59], v[116:117] op_sel:[0,1] op_sel_hi:[1,1]
  v_pk_mul_f32 v[60:61], v[60:61], v[116:117] op_sel:[0,1] op_sel_hi:[1,1]
  v_pk_mul_f32 v[62:63], v[62:63], v[116:117] op_sel:[0,1] op_sel_hi:[1,1]
  v_pk_mul_f32 v[64:65], v[64:65], v[116:117] op_sel:[0,1] op_sel_hi:[1,1]
  buffer_load_dwordx4 v[132:135], v5, s[4:7], s94 offen offset:768 sc1
  v_cvt_pk_bf16_f32 v116, v56, v57
  v_cvt_pk_bf16_f32 v117, v58, v59
  v_cvt_pk_bf16_f32 v118, v60, v61
  v_cvt_pk_bf16_f32 v119, v62, v63
  s_waitcnt lgkmcnt(0)
  s_nop 0
  v_mfma_f32_16x16x32_bf16 v[72:75], v[152:155], v[116:119], 0
  s_add_u32 s62, s62, 1
  v_cvt_pk_bf16_f32 v197, v64, v65
  v_cvt_pk_bf16_f32 v198, v64, v65
  v_mfma_f32_16x16x32_bf16 v[76:79], v[156:159], v[116:119], 0
  s_add_u32 s94, s94, 4096
  buffer_load_dwordx4 v[136:139], v5, s[4:7], s94 offen offset:0 sc1
  s_xor_b32 s86, s86, 524288
  v_mfma_f32_16x16x32_bf16 v[80:83], v[160:163], v[116:119], 0
  s_bfe_u32 s42, s62, 0x10001
  v_mfma_f32_16x16x32_bf16 v[84:87], v[164:167], v[116:119], 0
  buffer_load_dwordx4 v[140:143], v5, s[4:7], s94 offen offset:512 sc1
  v_mfma_f32_16x16x32_bf16 v[88:91], v[168:171], v[116:119], 0
  v_mfma_f32_16x16x32_bf16 v[92:95], v[172:175], v[116:119], 0
  buffer_load_dwordx4 v[144:147], v5, s[4:7], s94 offen offset:256 sc1
  v_mfma_f32_16x16x32_bf16 v[96:99], v[176:179], v[116:119], 0
  v_mfma_f32_16x16x32_bf16 v[100:103], v[180:183], v[116:119], 0
  buffer_load_dwordx4 v[148:151], v5, s[4:7], s94 offen offset:768 sc1
  v_mfma_f32_16x16x16_bf16 v[72:75], v[200:201], v[198:199], v[72:75]
  s_nop 1
  v_mfma_f32_16x16x16_bf16 v[76:79], v[200:201], v[196:197], v[76:79]
  s_add_u32 s94, s94, 4096
  buffer_load_dwordx4 v[152:155], v5, s[4:7], s94 offen offset:0 sc1
  v_mfma_f32_16x16x16_bf16 v[80:83], v[202:203], v[198:199], v[80:83]
  s_nop 1
  v_mfma_f32_16x16x16_bf16 v[84:87], v[202:203], v[196:197], v[84:87]
  buffer_load_dwordx4 v[156:159], v5, s[4:7], s94 offen offset:512 sc1
  v_mfma_f32_16x16x16_bf16 v[88:91], v[204:205], v[198:199], v[88:91]
  s_nop 0
  v_cvt_pk_bf16_f32 v40, v72, v73
  v_cvt_pk_bf16_f32 v41, v74, v75
  v_mfma_f32_16x16x16_bf16 v[92:95], v[204:205], v[196:197], v[92:95]
  buffer_load_dwordx4 v[160:163], v5, s[4:7], s94 offen offset:256 sc1
  v_cvt_pk_bf16_f32 v42, v76, v77
  v_cvt_pk_bf16_f32 v43, v78, v79
  v_mfma_f32_16x16x16_bf16 v[96:99], v[206:207], v[198:199], v[96:99]
  s_nop 0
  ds_write_b128 v6, v[40:43] offset:0
  v_cvt_pk_bf16_f32 v44, v80, v81
  v_mfma_f32_16x16x16_bf16 v[100:103], v[206:207], v[196:197], v[100:103]
  buffer_load_dwordx4 v[164:167], v5, s[4:7], s94 offen offset:768 sc1
  v_cvt_pk_bf16_f32 v45, v82, v83
  v_cvt_pk_bf16_f32 v46, v84, v85
  v_cvt_pk_bf16_f32 v47, v86, v87
  ds_write_b128 v6, v[44:47] offset:1024
  v_cvt_pk_bf16_f32 v48, v88, v89
  v_cvt_pk_bf16_f32 v49, v90, v91
  v_cvt_pk_bf16_f32 v50, v92, v93
  v_cvt_pk_bf16_f32 v51, v94, v95
  s_add_u32 s94, s94, 4096
  buffer_load_dwordx4 v[168:171], v5, s[4:7], s94 offen offset:0 sc1
  ds_write_b128 v6, v[48:51] offset:2048
  v_cvt_pk_bf16_f32 v52, v96, v97
  v_cvt_pk_bf16_f32 v53, v98, v99
  v_cvt_pk_bf16_f32 v54, v100, v101
  v_cvt_pk_bf16_f32 v55, v102, v103
  ds_write_b128 v6, v[52:55] offset:3072
  buffer_load_dwordx4 v[172:175], v5, s[4:7], s94 offen offset:512 sc1
  s_and_b32 s26, s65, 49152
  s_cbranch_scc1 o_wr2_204
  s_waitcnt lgkmcnt(0)
  s_barrier
  ds_read_b128 v[104:107], v3 offset:0
  ds_read_b128 v[108:111], v3 offset:512
  ds_read_b128 v[112:115], v3 offset:1024
  buffer_load_dwordx4 v[176:179], v5, s[4:7], s94 offen offset:256 sc1
  buffer_load_dwordx4 v[180:183], v5, s[4:7], s94 offen offset:768 sc1
  s_waitcnt lgkmcnt(2)
  v_mfma_f32_32x32x16_bf16 v[40:55], v[104:107], a[0:3], 0
  v_mov_b64 v[188:189], 0
  v_mov_b64 v[190:191], 0
  v_mov_b64 v[192:193], 0
  v_mov_b64 v[194:195], 0
  s_mov_b64 exec, 1
  buffer_store_dword v38, off, s[4:7], s84 sc1
  s_mov_b64 exec, -1
  s_mov_b32 s84, 268435456
  v_mfma_f32_32x32x16_bf16 v[56:71], v[104:107], a[4:7], 0
  ds_read_b128 v[116:119], v3 offset:1536
  v_mfma_f32_32x32x16_bf16 v[72:87], v[104:107], a[8:11], 0
  v_mfma_f32_32x32x16_bf16 v[88:103], v[104:107], a[12:15], 0
  s_waitcnt vmcnt(13)
  v_xor_b32 v7, s96, v120
  v_bitop3_b32 v7, v7, v124, s96 bitop3:0xf6
  v_bitop3_b32 v7, v7, v128, s96 bitop3:0xf6
  v_bitop3_b32 v7, v7, v132, s96 bitop3:0xf6
  s_waitcnt lgkmcnt(2)
  v_mfma_f32_32x32x16_bf16 v[40:55], v[108:111], a[16:19], v[40:55]
  s_waitcnt vmcnt(9)
  v_bitop3_b32 v7, v7, v136, s96 bitop3:0xf6
  v_bitop3_b32 v7, v7, v140, s96 bitop3:0xf6
  v_bitop3_b32 v7, v7, v144, s96 bitop3:0xf6
  v_bitop3_b32 v7, v7, v148, s96 bitop3:0xf6
  s_waitcnt vmcnt(5)
  v_mfma_f32_32x32x16_bf16 v[56:71], v[108:111], a[20:23], v[56:71]
  ds_read_b128 v[104:107], v3 offset:2048
  v_bitop3_b32 v7, v7, v152, s96 bitop3:0xf6
  v_bitop3_b32 v7, v7, v156, s96 bitop3:0xf6
  v_bitop3_b32 v7, v7, v160, s96 bitop3:0xf6
  v_bitop3_b32 v7, v7, v164, s96 bitop3:0xf6
  s_waitcnt vmcnt(1)
  v_mfma_f32_32x32x16_bf16 v[72:87], v[108:111], a[24:27], v[72:87]
  v_bitop3_b32 v7, v7, v168, s96 bitop3:0xf6
  v_bitop3_b32 v7, v7, v172, s96 bitop3:0xf6
  v_bitop3_b32 v7, v7, v176, s96 bitop3:0xf6
  v_bitop3_b32 v7, v7, v180, s96 bitop3:0xf6
  v_and_b32 v7, v254, v7
  v_cmp_ne_u32 vcc, 0, v7
  s_cbranch_vccnz o_rt_213
o_bk_214:
  v_mfma_f32_32x32x16_bf16 v[88:103], v[108:111], a[28:31], v[88:103]
  v_smfmac_f32_16x16x64_bf16 v[188:191], v[16:19], v[120:127], v20
  v_lshlrev_b32 v196, 16, v184
  v_smfmac_f32_16x16x64_bf16 v[192:195], v[16:19], v[128:135], v20
  v_and_b32 v197, 0xffff0000, v184
  v_smfmac_f32_16x16x64_bf16 v[188:191], v[16:19], v[136:143], v20
  v_lshlrev_b32 v198, 16, v185
  s_waitcnt lgkmcnt(2)
  v_mfma_f32_32x32x16_bf16 v[40:55], v[112:115], a[32:35], v[40:55]
  v_smfmac_f32_16x16x64_bf16 v[192:195], v[16:19], v[144:151], v20
  v_and_b32 v199, 0xffff0000, v185
  v_smfmac_f32_16x16x64_bf16 v[188:191], v[16:19], v[152:159], v20
  v_lshlrev_b32 v200, 16, v186
  v_smfmac_f32_16x16x64_bf16 v[192:195], v[16:19], v[160:167], v20
  v_and_b32 v201, 0xffff0000, v186
  v_mfma_f32_32x32x16_bf16 v[56:71], v[112:115], a[36:39], v[56:71]
  ds_read_b128 v[108:111], v3 offset:2560
  v_smfmac_f32_16x16x64_bf16 v[188:191], v[16:19], v[168:175], v20
  v_lshlrev_b32 v202, 16, v187
  v_smfmac_f32_16x16x64_bf16 v[192:195], v[16:19], v[176:183], v20
  v_and_b32 v203, 0xffff0000, v187
  s_bfe_u32 s92, s65, 131086
  v_mfma_f32_32x32x16_bf16 v[72:87], v[112:115], a[40:43], v[72:87]
  s_lshl_b32 s92, s92, 21
  s_add_u32 s92, s92, s91
  s_add_u32 s93, s92, 27262976
  s_add_u32 s92, s92, 20971520
  v_permlane16_swap_b32 v188, v192
  v_mfma_f32_32x32x16_bf16 v[88:103], v[112:115], a[44:47], v[88:103]
  v_permlane16_swap_b32 v189, v193
  v_permlane16_swap_b32 v190, v194
  v_permlane16_swap_b32 v191, v195
  s_waitcnt lgkmcnt(2)
  v_mfma_f32_32x32x16_bf16 v[40:55], v[116:119], a[48:51], v[40:55]
  v_cvt_pk_bf16_f32 v188, 0, v188
  v_cvt_pk_bf16_f32 v189, 0, v189
  v_cvt_pk_bf16_f32 v190, 0, v190
  v_cvt_pk_bf16_f32 v191, 0, v191
  v_cvt_pk_bf16_f32 v192, 0, v192
  v_cvt_pk_bf16_f32 v193, 0, v193
  v_mfma_f32_32x32x16_bf16 v[56:71], v[116:119], a[52:55], v[56:71]
  ds_read_b128 v[112:115], v3 offset:3072
  v_cvt_pk_bf16_f32 v194, 0, v194
  v_cvt_pk_bf16_f32 v195, 0, v195
  v_add_f32 v196, v196, v188
  v_add_f32 v197, v197, v189
  v_add_f32 v198, v198, v190
  v_mfma_f32_32x32x16_bf16 v[72:87], v[116:119], a[56:59], v[72:87]
  v_add_f32 v199, v199, v191
  v_add_f32 v200, v200, v192
  v_add_f32 v201, v201, v193
  v_add_f32 v202, v202, v194
  v_add_f32 v203, v203, v195
  v_cvt_pk_bf16_f32 v120, v196, v197
  v_mfma_f32_32x32x16_bf16 v[88:103], v[116:119], a[60:63], v[88:103]
  v_cvt_pk_bf16_f32 v121, v198, v199
  v_cvt_pk_bf16_f32 v122, v200, v201
  v_cvt_pk_bf16_f32 v123, v202, v203
  v_lshlrev_b32 v196, 16, v120
  v_and_b32 v197, 0xffff0000, v120
  s_waitcnt lgkmcnt(2)
  v_mfma_f32_32x32x16_bf16 v[40:55], v[104:107], a[64:67], v[40:55]
  v_lshlrev_b32 v198, 16, v121
  v_and_b32 v199, 0xffff0000, v121
  v_lshlrev_b32 v200, 16, v122
  v_and_b32 v201, 0xffff0000, v122
  v_lshlrev_b32 v202, 16, v123
  v_and_b32 v203, 0xffff0000, v123
  v_mfma_f32_32x32x16_bf16 v[56:71], v[104:107], a[68:71], v[56:71]
  ds_read_b128 v[116:119], v3 offset:3584
  buffer_store_dwordx4 v[120:123], v0, s[4:7], s92 offen sc1
  v_add_f32 v136, v196, v197
  v_mul_f32 v137, v196, v196
  v_mfma_f32_32x32x16_bf16 v[72:87], v[104:107], a[72:75], v[72:87]
  v_add_f32 v138, v198, v199
  v_mul_f32 v139, v197, v197
  v_fmac_f32 v137, v198, v198
  v_fmac_f32 v139, v199, v199
  v_add_f32 v136, v136, v200
  v_fmac_f32 v137, v200, v200
  v_mfma_f32_32x32x16_bf16 v[88:103], v[104:107], a[76:79], v[88:103]
  v_add_f32 v138, v138, v201
  v_fmac_f32 v139, v201, v201
  v_add_f32 v136, v136, v202
  v_fmac_f32 v137, v202, v202
  v_add_f32 v138, v138, v203
  s_waitcnt lgkmcnt(2)
  v_mfma_f32_32x32x16_bf16 v[40:55], v[108:111], a[80:83], v[40:55]
  v_fmac_f32 v139, v203, v203
  v_add_f32 v136, v136, v138
  v_add_f32 v137, v137, v139
  s_nop 0
  v_add_f32_dpp v136, v136, v136 row_ror:8 row_mask:0xf bank_mask:0xf
  v_add_f32_dpp v137, v137, v137 row_ror:8 row_mask:0xf bank_mask:0xf
  s_nop 0
  v_add_f32_dpp v136, v136, v136 row_ror:4 row_mask:0xf bank_mask:0xf
  v_mfma_f32_32x32x16_bf16 v[56:71], v[108:111], a[84:87], v[56:71]
  ds_read_b128 v[104:107], v3 offset:8192
  v_add_f32_dpp v137, v137, v137 row_ror:4 row_mask:0xf bank_mask:0xf
  v_add_f32_dpp v136, v136, v136 row_ror:2 row_mask:0xf bank_mask:0xf
  s_nop 0
  v_add_f32_dpp v137, v137, v137 row_ror:2 row_mask:0xf bank_mask:0xf
  v_add_f32_dpp v136, v136, v136 row_ror:1 row_mask:0xf bank_mask:0xf
  s_nop 0
  v_add_f32_dpp v137, v137, v137 row_ror:1 row_mask:0xf bank_mask:0xf
  v_mfma_f32_32x32x16_bf16 v[72:87], v[108:111], a[88:91], v[72:87]
  v_mov_b32 v140, v136
  v_mov_b32 v141, v137
  s_nop 0
  v_permlane16_swap_b32 v136, v140
  v_permlane16_swap_b32 v137, v141
  v_mfma_f32_32x32x16_bf16 v[88:103], v[108:111], a[92:95], v[88:103]
  v_add_f32 v136, v136, v140
  v_add_f32 v137, v137, v141
  v_mov_b32 v140, v136
  v_mov_b32 v141, v137
  s_nop 0
  v_permlane32_swap_b32 v136, v140
  s_waitcnt lgkmcnt(2)
  v_mfma_f32_32x32x16_bf16 v[40:55], v[112:115], a[96:99], v[40:55]
  v_permlane32_swap_b32 v137, v141
  v_add_f32 v136, v136, v140
  v_add_f32 v137, v137, v141
  v_mul_f32 v136, 0x3b000000, v136
  v_mul_f32 v137, 0x3b000000, v137
  v_mfma_f32_32x32x16_bf16 v[56:71], v[112:115], a[100:103], v[56:71]
  ds_read_b128 v[108:111], v3 offset:8704
  v_fma_f32 v137, -v136, v136, v137
  v_cvt_pk_bf16_f32 v136, 0, v136
  v_max_f32 v137, 0, v137
  v_sub_f32 v140, v196, v136
  v_sub_f32 v141, v197, v136
  v_mfma_f32_32x32x16_bf16 v[72:87], v[112:115], a[104:107], v[72:87]
  v_cvt_pk_bf16_f32 v137, 0, v137
  v_sub_f32 v142, v198, v136
  v_sub_f32 v143, v199, v136
  v_add_f32 v137, 0x3727c5ac, v137
  v_sub_f32 v144, v200, v136
  v_sub_f32 v145, v201, v136
  v_mfma_f32_32x32x16_bf16 v[88:103], v[112:115], a[108:111], v[88:103]
  v_cvt_pk_bf16_f32 v137, 0, v137
  v_sub_f32 v146, v202, v136
  v_sub_f32 v147, v203, v136
  v_sqrt_f32 v137, v137
  s_waitcnt lgkmcnt(2)
  v_mfma_f32_32x32x16_bf16 v[40:55], v[116:119], a[112:115], v[40:55]
  v_cvt_pk_bf16_f32 v140, 0, v140
  v_cvt_pk_bf16_f32 v141, 0, v141
  v_cvt_pk_bf16_f32 v137, 0, v137
  v_cvt_pk_bf16_f32 v142, 0, v142
  v_cvt_pk_bf16_f32 v143, 0, v143
  v_rcp_f32 v137, v137
  v_mfma_f32_32x32x16_bf16 v[56:71], v[116:119], a[116:119], v[56:71]
  ds_read_b128 v[112:115], v3 offset:9216
  v_cvt_pk_bf16_f32 v144, 0, v144
  v_cvt_pk_bf16_f32 v145, 0, v145
  v_cvt_pk_bf16_f32 v146, 0, v146
  v_cvt_pk_bf16_f32 v147, 0, v147
  v_mul_f32 v140, v140, v137
  v_mfma_f32_32x32x16_bf16 v[72:87], v[116:119], a[120:123], v[72:87]
  v_mul_f32 v141, v141, v137
  v_mul_f32 v142, v142, v137
  v_mul_f32 v143, v143, v137
  v_mul_f32 v144, v144, v137
  v_mul_f32 v145, v145, v137
  v_mul_f32 v146, v146, v137
  v_mfma_f32_32x32x16_bf16 v[88:103], v[116:119], a[124:127], v[88:103]
  v_mul_f32 v147, v147, v137
  v_cvt_pk_bf16_f32 v124, v140, v141
  v_cvt_pk_bf16_f32 v125, v142, v143
  v_cvt_pk_bf16_f32 v126, v144, v145
  v_cvt_pk_bf16_f32 v127, v146, v147
  s_waitcnt lgkmcnt(2)
  v_mfma_f32_32x32x16_bf16 v[40:55], v[104:107], a[128:131], v[40:55]
  v_lshlrev_b32 v204, 16, v124
  v_and_b32 v205, 0xffff0000, v124
  v_lshlrev_b32 v206, 16, v125
  v_and_b32 v207, 0xffff0000, v125
  v_lshlrev_b32 v208, 16, v126
  v_and_b32 v209, 0xffff0000, v126
  v_mfma_f32_32x32x16_bf16 v[56:71], v[104:107], a[132:135], v[56:71]
  ds_read_b128 v[116:119], v3 offset:9728
  v_lshlrev_b32 v210, 16, v127
  v_and_b32 v211, 0xffff0000, v127
  buffer_store_dwordx4 v[124:127], v0, s[4:7], s93 offen sc1
  v_mfma_f32_32x32x16_bf16 v[72:87], v[104:107], a[136:139], v[72:87]
  v_add_f32 v196, v196, v204
  v_add_f32 v197, v197, v205
  v_add_f32 v198, v198, v206
  v_add_f32 v199, v199, v207
  v_add_f32 v200, v200, v208
  v_add_f32 v201, v201, v209
  v_mfma_f32_32x32x16_bf16 v[88:103], v[104:107], a[140:143], v[88:103]
  v_add_f32 v202, v202, v210
  v_add_f32 v203, v203, v211
  v_cvt_pk_bf16_f32 v128, v196, v197
  v_cvt_pk_bf16_f32 v129, v198, v199
  v_cvt_pk_bf16_f32 v130, v200, v201
  s_waitcnt lgkmcnt(2)
  v_mfma_f32_32x32x16_bf16 v[40:55], v[108:111], a[144:147], v[40:55]
  v_cvt_pk_bf16_f32 v131, v202, v203
  v_mul_f32 v188, v204, v8
  v_mul_f32 v189, v205, v9
  v_fmac_f32 v188, v206, v10
  v_fmac_f32 v189, v207, v11
  v_fmac_f32 v188, v208, v12
  v_mfma_f32_32x32x16_bf16 v[56:71], v[108:111], a[148:151], v[56:71]
  ds_read_b128 v[104:107], v3 offset:10240
  v_fmac_f32 v189, v209, v13
  v_fmac_f32 v188, v210, v14
  v_fmac_f32 v189, v211, v15
  v_add_f32 v188, v188, v189
  s_add_u32 s92, s91, 10485760
  v_mfma_f32_32x32x16_bf16 v[72:87], v[108:111], a[152:155], v[72:87]
  s_add_u32 s93, s91, 8388608
  buffer_store_dwordx4 v[128:131], v0, s[4:7], s92 offen sc1
  v_lshlrev_b32 v196, 16, v128
  v_and_b32 v197, 0xffff0000, v128
  v_mfma_f32_32x32x16_bf16 v[88:103], v[108:111], a[156:159], v[88:103]
  v_lshlrev_b32 v198, 16, v129
  v_and_b32 v199, 0xffff0000, v129
  v_lshlrev_b32 v200, 16, v130
  v_and_b32 v201, 0xffff0000, v130
  v_lshlrev_b32 v202, 16, v131
  s_waitcnt lgkmcnt(2)
  v_mfma_f32_32x32x16_bf16 v[40:55], v[112:115], a[160:163], v[40:55]
  v_and_b32 v203, 0xffff0000, v131
  v_add_f32 v136, v196, v197
  v_mul_f32 v137, v196, v196
  v_add_f32 v138, v198, v199
  v_mul_f32 v139, v197, v197
  v_fmac_f32 v137, v198, v198
  v_mfma_f32_32x32x16_bf16 v[56:71], v[112:115], a[164:167], v[56:71]
  ds_read_b128 v[108:111], v3 offset:10752
  v_fmac_f32 v139, v199, v199
  v_add_f32 v136, v136, v200
  v_fmac_f32 v137, v200, v200
  v_add_f32 v138, v138, v201
  v_fmac_f32 v139, v201, v201
  v_mfma_f32_32x32x16_bf16 v[72:87], v[112:115], a[168:171], v[72:87]
  v_add_f32 v136, v136, v202
  v_fmac_f32 v137, v202, v202
  v_add_f32 v138, v138, v203
  v_fmac_f32 v139, v203, v203
  v_add_f32 v136, v136, v138
  v_add_f32 v137, v137, v139
  v_mfma_f32_32x32x16_bf16 v[88:103], v[112:115], a[172:175], v[88:103]
  v_add_f32_dpp v136, v136, v136 row_ror:8 row_mask:0xf bank_mask:0xf
  v_add_f32_dpp v137, v137, v137 row_ror:8 row_mask:0xf bank_mask:0xf
  v_add_f32_dpp v188, v188, v188 row_ror:8 row_mask:0xf bank_mask:0xf
  v_add_f32_dpp v136, v136, v136 row_ror:4 row_mask:0xf bank_mask:0xf
  v_add_f32_dpp v137, v137, v137 row_ror:4 row_mask:0xf bank_mask:0xf
  s_waitcnt lgkmcnt(2)
  v_mfma_f32_32x32x16_bf16 v[40:55], v[116:119], a[176:179], v[40:55]
  v_add_f32_dpp v188, v188, v188 row_ror:4 row_mask:0xf bank_mask:0xf
  v_add_f32_dpp v136, v136, v136 row_ror:2 row_mask:0xf bank_mask:0xf
  v_add_f32_dpp v137, v137, v137 row_ror:2 row_mask:0xf bank_mask:0xf
  v_add_f32_dpp v188, v188, v188 row_ror:2 row_mask:0xf bank_mask:0xf
  v_add_f32_dpp v136, v136, v136 row_ror:1 row_mask:0xf bank_mask:0xf
  v_add_f32_dpp v137, v137, v137 row_ror:1 row_mask:0xf bank_mask:0xf
  v_mfma_f32_32x32x16_bf16 v[56:71], v[116:119], a[180:183], v[56:71]
  ds_read_b128 v[112:115], v3 offset:11264
  v_add_f32_dpp v188, v188, v188 row_ror:1 row_mask:0xf bank_mask:0xf
  v_mov_b32 v140, v136
  v_mov_b32 v141, v137
  v_mov_b32 v142, v188
  v_permlane16_swap_b32 v136, v140
  v_mfma_f32_32x32x16_bf16 v[72:87], v[116:119], a[184:187], v[72:87]
  v_permlane16_swap_b32 v137, v141
  v_permlane16_swap_b32 v188, v142
  v_add_f32 v136, v136, v140
  v_add_f32 v137, v137, v141
  v_mfma_f32_32x32x16_bf16 v[88:103], v[116:119], a[188:191], v[88:103]
  v_add_f32 v188, v188, v142
  v_mov_b32 v140, v136
  v_mov_b32 v141, v137
  v_mov_b32 v142, v188
  v_permlane32_swap_b32 v136, v140
  s_waitcnt lgkmcnt(2)
  v_mfma_f32_32x32x16_bf16 v[40:55], v[104:107], a[192:195], v[40:55]
  v_permlane32_swap_b32 v137, v141
  v_permlane32_swap_b32 v188, v142
  v_add_f32 v136, v136, v140
  v_add_f32 v137, v137, v141
  v_mfma_f32_32x32x16_bf16 v[56:71], v[104:107], a[196:199], v[56:71]
  ds_read_b128 v[116:119], v3 offset:11776
  v_add_f32 v188, v188, v142
  v_mul_f32 v136, 0x3b000000, v136
  v_mul_f32 v137, 0x3b000000, v137
  v_fma_f32 v137, -v136, v136, v137
  v_cvt_pk_bf16_f32 v136, 0, v136
  s_waitcnt lgkmcnt(2)
  v_mfma_f32_32x32x16_bf16 v[40:55], v[108:111], a[208:211], v[40:55]
  v_max_f32 v137, 0, v137
  v_sub_f32 v140, v196, v136
  v_sub_f32 v141, v197, v136
  v_cvt_pk_bf16_f32 v137, 0, v137
  v_sub_f32 v142, v198, v136
  v_sub_f32 v143, v199, v136
  v_mfma_f32_32x32x16_bf16 v[56:71], v[108:111], a[212:215], v[56:71]
  v_add_f32 v137, 0x3727c5ac, v137
  v_sub_f32 v144, v200, v136
  v_sub_f32 v145, v201, v136
  v_cvt_pk_bf16_f32 v137, 0, v137
  v_sub_f32 v146, v202, v136
  v_sub_f32 v147, v203, v136
  s_waitcnt lgkmcnt(1)
  v_mfma_f32_32x32x16_bf16 v[40:55], v[112:115], a[224:227], v[40:55]
  v_sqrt_f32 v137, v137
  v_cvt_pk_bf16_f32 v140, 0, v140
  v_cvt_pk_bf16_f32 v141, 0, v141
  v_cvt_pk_bf16_f32 v137, 0, v137
  v_cvt_pk_bf16_f32 v142, 0, v142
  v_mfma_f32_32x32x16_bf16 v[56:71], v[112:115], a[228:231], v[56:71]
  v_cvt_pk_bf16_f32 v143, 0, v143
  v_rcp_f32 v137, v137
  v_cvt_pk_bf16_f32 v144, 0, v144
  v_cvt_pk_bf16_f32 v145, 0, v145
  v_cvt_pk_bf16_f32 v146, 0, v146
  s_waitcnt lgkmcnt(0)
  v_mfma_f32_32x32x16_bf16 v[40:55], v[116:119], a[240:243], v[40:55]
  v_cvt_pk_bf16_f32 v147, 0, v147
  v_mul_f32 v140, v140, v137
  v_mul_f32 v141, v141, v137
  v_mul_f32 v142, v142, v137
  v_mul_f32 v143, v143, v137
  v_mul_f32 v144, v144, v137
  v_mfma_f32_32x32x16_bf16 v[56:71], v[116:119], a[244:247], v[56:71]
  v_mul_f32 v145, v145, v137
  v_mul_f32 v146, v146, v137
  v_mul_f32 v147, v147, v137
  v_cvt_pk_bf16_f32 v132, v140, v141
  v_cvt_pk_bf16_f32 v133, v142, v143
  v_cvt_pk_bf16_f32 v134, v144, v145
  v_mfma_f32_32x32x16_bf16 v[72:87], v[104:107], a[200:203], v[72:87]
  v_cvt_pk_bf16_f32 v135, v146, v147
  buffer_store_dwordx4 v[132:135], v0, s[4:7], s93 offen sc1
  v_cvt_pk_bf16_f32 v188, 0, v188
  v_ashrrev_i32 v189, 31, v188
  v_mfma_f32_32x32x16_bf16 v[88:103], v[104:107], a[204:207], v[88:103]
  v_or_b32 v189, 0x80000000, v189
  v_xor_b32 v188, v188, v189
  s_sub_u32 s92, 4095, s90
  v_and_b32 v188, 0xffff0000, v188
  v_or_b32 v38, s92, v188
  v_mfma_f32_32x32x16_bf16 v[72:87], v[108:111], a[216:219], v[72:87]
  s_bfe_u32 s92, s65, 196625
  s_lshl_b32 s92, s92, 18
  s_lshl_b32 s93, s90, 7
  s_add_u32 s92, s92, s93
  s_add_u32 s84, s92, 243269632
  v_cvt_pk_bf16_f32 v212, v40, v56
  v_mfma_f32_32x32x16_bf16 v[88:103], v[108:111], a[220:223], v[88:103]
  v_cvt_pk_bf16_f32 v214, v41, v57
  v_cvt_pk_bf16_f32 v216, v42, v58
  v_cvt_pk_bf16_f32 v218, v43, v59
  v_permlane16_swap_b32 v212, v214
  v_mfma_f32_32x32x16_bf16 v[72:87], v[112:115], a[232:235], v[72:87]
  v_cvt_pk_bf16_f32 v220, v44, v60
  v_cvt_pk_bf16_f32 v222, v45, v61
  v_permlane16_swap_b32 v216, v218
  v_bfi_b32 v212, v254, s42, v212
  v_cvt_pk_bf16_f32 v224, v46, v62
  v_mfma_f32_32x32x16_bf16 v[88:103], v[112:115], a[236:239], v[88:103]
  v_cvt_pk_bf16_f32 v226, v47, v63
  v_permlane16_swap_b32 v220, v222
  v_bfi_b32 v216, v254, s42, v216
  v_cvt_pk_bf16_f32 v228, v48, v64
  v_mfma_f32_32x32x16_bf16 v[72:87], v[116:119], a[248:251], v[72:87]
  v_cvt_pk_bf16_f32 v230, v49, v65
  v_permlane16_swap_b32 v224, v226
  v_bfi_b32 v220, v254, s42, v220
  v_cvt_pk_bf16_f32 v232, v50, v66
  v_cvt_pk_bf16_f32 v234, v51, v67
  v_mfma_f32_32x32x16_bf16 v[88:103], v[116:119], a[252:255], v[88:103]
  v_permlane16_swap_b32 v228, v230
  v_bfi_b32 v224, v254, s42, v224
  v_cvt_pk_bf16_f32 v236, v52, v68
  v_cvt_pk_bf16_f32 v238, v53, v69
  v_permlane16_swap_b32 v232, v234
  v_bfi_b32 v228, v254, s42, v228
  v_cvt_pk_bf16_f32 v240, v54, v70
  v_cvt_pk_bf16_f32 v242, v55, v71
  v_permlane16_swap_b32 v236, v238
  v_bfi_b32 v232, v254, s42, v232
  v_permlane16_swap_b32 v240, v242
  v_bfi_b32 v236, v254, s42, v236
  v_bfi_b32 v240, v254, s42, v240
  v_cvt_pk_bf16_f32 v213, v72, v88
  v_cvt_pk_bf16_f32 v215, v73, v89
  v_cvt_pk_bf16_f32 v217, v74, v90
  v_cvt_pk_bf16_f32 v219, v75, v91
  s_add_u32 s78, s86, 0
  v_permlane16_swap_b32 v213, v215
  buffer_store_dwordx4 v[212:215], v4, s[4:7], s78 offen sc1
  v_cvt_pk_bf16_f32 v221, v76, v92
  v_cvt_pk_bf16_f32 v223, v77, v93
  s_add_u32 s78, s86, 32768
  v_permlane16_swap_b32 v217, v219
  buffer_store_dwordx4 v[216:219], v4, s[4:7], s78 offen sc1
  v_cvt_pk_bf16_f32 v225, v78, v94
  v_cvt_pk_bf16_f32 v227, v79, v95
  s_add_u32 s78, s86, 131072
  v_permlane16_swap_b32 v221, v223
  buffer_store_dwordx4 v[220:223], v4, s[4:7], s78 offen sc1
  v_cvt_pk_bf16_f32 v229, v80, v96
  v_cvt_pk_bf16_f32 v231, v81, v97
  s_add_u32 s78, s86, 163840
  v_permlane16_swap_b32 v225, v227
  buffer_store_dwordx4 v[224:227], v4, s[4:7], s78 offen sc1
  v_cvt_pk_bf16_f32 v233, v82, v98
  v_cvt_pk_bf16_f32 v235, v83, v99
  s_add_u32 s78, s86, 262144
  v_permlane16_swap_b32 v229, v231
  buffer_store_dwordx4 v[228:231], v4, s[4:7], s78 offen sc1
  v_cvt_pk_bf16_f32 v237, v84, v100
  v_cvt_pk_bf16_f32 v239, v85, v101
  s_add_u32 s78, s86, 294912
  v_permlane16_swap_b32 v233, v235
  buffer_store_dwordx4 v[232:235], v4, s[4:7], s78 offen sc1
  v_cvt_pk_bf16_f32 v241, v86, v102
  v_cvt_pk_bf16_f32 v243, v87, v103
  s_add_u32 s78, s86, 393216
  v_permlane16_swap_b32 v237, v239
  buffer_store_dwordx4 v[236:239], v4, s[4:7], s78 offen sc1
  s_add_u32 s78, s86, 425984
  v_permlane16_swap_b32 v241, v243
  buffer_store_dwordx4 v[240:243], v4, s[4:7], s78 offen sc1
  s_waitcnt vmcnt(8)
  s_mov_b64 exec, 1
  buffer_store_dword v38, off, s[4:7], s84 sc1
  s_mov_b64 exec, -1
  s_mov_b32 s84, 268435456
  s_branch o_we_205
o_rt_213:
  s_mov_b32 s67, 0
o_rl_217:
  s_lshl_b32 s94, s43, 14
  s_add_u32 s94, s94, s95
  buffer_load_dwordx4 v[120:123], v5, s[4:7], s94 offen offset:0 sc1
  buffer_load_dwordx4 v[124:127], v5, s[4:7], s94 offen offset:512 sc1
  buffer_load_dwordx4 v[128:131], v5, s[4:7], s94 offen offset:256 sc1
  buffer_load_dwordx4 v[132:135], v5, s[4:7], s94 offen offset:768 sc1
  s_add_u32 s94, s94, 4096
  buffer_load_dwordx4 v[136:139], v5, s[4:7], s94 offen offset:0 sc1
  buffer_load_dwordx4 v[140:143], v5, s[4:7], s94 offen offset:512 sc1
  buffer_load_dwordx4 v[144:147], v5, s[4:7], s94 offen offset:256 sc1
  buffer_load_dwordx4 v[148:151], v5, s[4:7], s94 offen offset:768 sc1
  s_add_u32 s94, s94, 4096
  buffer_load_dwordx4 v[152:155], v5, s[4:7], s94 offen offset:0 sc1
  buffer_load_dwordx4 v[156:159], v5, s[4:7], s94 offen offset:512 sc1
  buffer_load_dwordx4 v[160:163], v5, s[4:7], s94 offen offset:256 sc1
  buffer_load_dwordx4 v[164:167], v5, s[4:7], s94 offen offset:768 sc1
  s_add_u32 s94, s94, 4096
  buffer_load_dwordx4 v[168:171], v5, s[4:7], s94 offen offset:0 sc1
  buffer_load_dwordx4 v[172:175], v5, s[4:7], s94 offen offset:512 sc1
  buffer_load_dwordx4 v[176:179], v5, s[4:7], s94 offen offset:256 sc1
  buffer_load_dwordx4 v[180:183], v5, s[4:7], s94 offen offset:768 sc1
  s_add_u32 s67, s67, 1
  s_cmp_gt_u32 s67, 1048576
  s_cbranch_scc1 L_end
  s_waitcnt vmcnt(0)
  v_xor_b32 v7, s96, v120
  v_bitop3_b32 v7, v7, v124, s96 bitop3:0xf6
  v_bitop3_b32 v7, v7, v128, s96 bitop3:0xf6
  v_bitop3_b32 v7, v7, v132, s96 bitop3:0xf6
  v_bitop3_b32 v7, v7, v136, s96 bitop3:0xf6
  v_bitop3_b32 v7, v7, v140, s96 bitop3:0xf6
  v_bitop3_b32 v7, v7, v144, s96 bitop3:0xf6
  v_bitop3_b32 v7, v7, v148, s96 bitop3:0xf6
  v_bitop3_b32 v7, v7, v152, s96 bitop3:0xf6
  v_bitop3_b32 v7, v7, v156, s96 bitop3:0xf6
  v_bitop3_b32 v7, v7, v160, s96 bitop3:0xf6
  v_bitop3_b32 v7, v7, v164, s96 bitop3:0xf6
  v_bitop3_b32 v7, v7, v168, s96 bitop3:0xf6
  v_bitop3_b32 v7, v7, v172, s96 bitop3:0xf6
  v_bitop3_b32 v7, v7, v176, s96 bitop3:0xf6
  v_bitop3_b32 v7, v7, v180, s96 bitop3:0xf6
  v_and_b32 v7, v254, v7
  v_cmp_ne_u32 vcc, 0, v7
  s_cbranch_vccnz o_rl_217
  s_branch o_bk_214
o_rt_215:
  s_mov_b32 s67, 0
o_rl_218:
  s_lshl_b32 s94, s43, 14
  s_add_u32 s94, s94, s95
  buffer_load_dwordx4 v[120:123], v5, s[4:7], s94 offen offset:0 sc1
  buffer_load_dwordx4 v[124:127], v5, s[4:7], s94 offen offset:512 sc1
  buffer_load_dwordx4 v[128:131], v5, s[4:7], s94 offen offset:256 sc1
  buffer_load_dwordx4 v[132:135], v5, s[4:7], s94 offen offset:768 sc1
  s_add_u32 s94, s94, 4096
  buffer_load_dwordx4 v[136:139], v5, s[4:7], s94 offen offset:0 sc1
  buffer_load_dwordx4 v[140:143], v5, s[4:7], s94 offen offset:512 sc1
  buffer_load_dwordx4 v[144:147], v5, s[4:7], s94 offen offset:256 sc1
  buffer_load_dwordx4 v[148:151], v5, s[4:7], s94 offen offset:768 sc1
  s_add_u32 s94, s94, 4096
  buffer_load_dwordx4 v[152:155], v5, s[4:7], s94 offen offset:0 sc1
  buffer_load_dwordx4 v[156:159], v5, s[4:7], s94 offen offset:512 sc1
  buffer_load_dwordx4 v[160:163], v5, s[4:7], s94 offen offset:256 sc1
  buffer_load_dwordx4 v[164:167], v5, s[4:7], s94 offen offset:768 sc1
  s_add_u32 s94, s94, 4096
  buffer_load_dwordx4 v[168:171], v5, s[4:7], s94 offen offset:0 sc1
  buffer_load_dwordx4 v[172:175], v5, s[4:7], s94 offen offset:512 sc1
  buffer_load_dwordx4 v[176:179], v5, s[4:7], s94 offen offset:256 sc1
  buffer_load_dwordx4 v[180:183], v5, s[4:7], s94 offen offset:768 sc1
  s_add_u32 s67, s67, 1
  s_cmp_gt_u32 s67, 1048576
  s_cbranch_scc1 L_end
  s_waitcnt vmcnt(0)
  v_xor_b32 v7, s96, v120
  v_bitop3_b32 v7, v7, v124, s96 bitop3:0xf6
  v_bitop3_b32 v7, v7, v128, s96 bitop3:0xf6
  v_bitop3_b32 v7, v7, v132, s96 bitop3:0xf6
  v_bitop3_b32 v7, v7, v136, s96 bitop3:0xf6
  v_bitop3_b32 v7, v7, v140, s96 bitop3:0xf6
  v_bitop3_b32 v7, v7, v144, s96 bitop3:0xf6
  v_bitop3_b32 v7, v7, v148, s96 bitop3:0xf6
  v_bitop3_b32 v7, v7, v152, s96 bitop3:0xf6
  v_bitop3_b32 v7, v7, v156, s96 bitop3:0xf6
  v_bitop3_b32 v7, v7, v160, s96 bitop3:0xf6
  v_bitop3_b32 v7, v7, v164, s96 bitop3:0xf6
  v_bitop3_b32 v7, v7, v168, s96 bitop3:0xf6
  v_bitop3_b32 v7, v7, v172, s96 bitop3:0xf6
  v_bitop3_b32 v7, v7, v176, s96 bitop3:0xf6
  v_bitop3_b32 v7, v7, v180, s96 bitop3:0xf6
  v_and_b32 v7, v254, v7
  v_cmp_ne_u32 vcc, 0, v7
  s_cbranch_vccnz o_rl_218
  s_branch o_bk_216
o_fb_207:
  v_mov_b32 v118, v116
  s_nop 1
  v_permlane16_swap_b32 v116, v118
  v_max_f32 v116, v116, v118
  v_mov_b32 v118, v116
  s_nop 0
  s_nop 0
  v_permlane32_swap_b32 v116, v118
  v_max_f32 v116, v116, v118
  v_sub_f32 v56, v104, v116
  v_sub_f32 v57, v105, v116
  v_sub_f32 v58, v106, v116
  v_sub_f32 v59, v107, v116
  v_sub_f32 v60, v108, v116
  v_sub_f32 v61, v109, v116
  v_sub_f32 v62, v110, v116
  v_sub_f32 v63, v111, v116
  v_sub_f32 v64, v112, v116
  v_sub_f32 v65, v113, v116
  v_exp_f32 v56, v56
  v_exp_f32 v57, v57
  v_exp_f32 v58, v58
  v_exp_f32 v59, v59
  v_exp_f32 v60, v60
  v_exp_f32 v61, v61
  v_exp_f32 v62, v62
  v_exp_f32 v63, v63
  v_exp_f32 v64, v64
  v_exp_f32 v65, v65
  v_add_f32 v117, v56, v57
  v_add_f32 v117, v117, v58
  v_add_f32 v117, v117, v59
  v_add_f32 v117, v117, v60
  v_add_f32 v117, v117, v61
  v_add_f32 v117, v117, v62
  v_add_f32 v117, v117, v63
  v_add_f32 v117, v117, v64
  v_add_f32 v117, v117, v65
  v_mov_b32 v118, v117
  s_nop 0
  s_nop 0
  v_permlane16_swap_b32 v117, v118
  v_add_f32 v117, v117, v118
  v_mov_b32 v118, v117
  s_nop 0
  s_nop 0
  v_permlane32_swap_b32 v117, v118
  v_add_f32 v117, v117, v118
  v_rcp_f32 v117, v117
  s_branch o_fbr_208
o_fb_209:
  v_mov_b32 v118, v116
  s_nop 1
  v_permlane16_swap_b32 v116, v118
  v_max_f32 v116, v116, v118
  v_mov_b32 v118, v116
  s_nop 0
  s_nop 0
  v_permlane32_swap_b32 v116, v118
  v_max_f32 v116, v116, v118
  v_sub_f32 v56, v104, v116
  v_sub_f32 v57, v105, v116
  v_sub_f32 v58, v106, v116
  v_sub_f32 v59, v107, v116
  v_sub_f32 v60, v108, v116
  v_sub_f32 v61, v109, v116
  v_sub_f32 v62, v110, v116
  v_sub_f32 v63, v111, v116
  v_sub_f32 v64, v112, v116
  v_sub_f32 v65, v113, v116
  v_exp_f32 v56, v56
  v_exp_f32 v57, v57
  v_exp_f32 v58, v58
  v_exp_f32 v59, v59
  v_exp_f32 v60, v60
  v_exp_f32 v61, v61
  v_exp_f32 v62, v62
  v_exp_f32 v63, v63
  v_exp_f32 v64, v64
  v_exp_f32 v65, v65
  v_add_f32 v117, v56, v57
  v_add_f32 v117, v117, v58
  v_add_f32 v117, v117, v59
  v_add_f32 v117, v117, v60
  v_add_f32 v117, v117, v61
  v_add_f32 v117, v117, v62
  v_add_f32 v117, v117, v63
  v_add_f32 v117, v117, v64
  v_add_f32 v117, v117, v65
  v_mov_b32 v118, v117
  s_nop 0
  s_nop 0
  v_permlane16_swap_b32 v117, v118
  v_add_f32 v117, v117, v118
  v_mov_b32 v118, v117
  s_nop 0
  s_nop 0
  v_permlane32_swap_b32 v117, v118
  v_add_f32 v117, v117, v118
  v_rcp_f32 v117, v117
  s_branch o_fbr_210
o_wr2_204:
  s_waitcnt lgkmcnt(0)
  s_barrier
  ds_read_b128 v[104:107], v3 offset:0
  ds_read_b128 v[108:111], v3 offset:512
  ds_read_b128 v[112:115], v3 offset:1024
  buffer_load_dwordx4 v[176:179], v5, s[4:7], s94 offen offset:256 sc1
  buffer_load_dwordx4 v[180:183], v5, s[4:7], s94 offen offset:768 sc1
  s_waitcnt lgkmcnt(2)
  v_mfma_f32_32x32x16_bf16 v[40:55], v[104:107], a[0:3], 0
  v_mov_b64 v[188:189], 0
  v_mov_b64 v[190:191], 0
  v_mov_b64 v[192:193], 0
  v_mov_b64 v[194:195], 0
  s_mov_b64 exec, 1
  buffer_store_dword v38, off, s[4:7], s84 sc1
  s_mov_b64 exec, -1
  s_mov_b32 s84, 268435456
  v_mfma_f32_32x32x16_bf16 v[56:71], v[104:107], a[4:7], 0
  ds_read_b128 v[116:119], v3 offset:1536
  v_mfma_f32_32x32x16_bf16 v[72:87], v[104:107], a[8:11], 0
  v_mfma_f32_32x32x16_bf16 v[88:103], v[104:107], a[12:15], 0
  s_waitcnt vmcnt(13)
  v_xor_b32 v7, s96, v120
  v_bitop3_b32 v7, v7, v124, s96 bitop3:0xf6
  v_bitop3_b32 v7, v7, v128, s96 bitop3:0xf6
  v_bitop3_b32 v7, v7, v132, s96 bitop3:0xf6
  s_waitcnt lgkmcnt(2)
  v_mfma_f32_32x32x16_bf16 v[40:55], v[108:111], a[16:19], v[40:55]
  s_waitcnt vmcnt(9)
  v_bitop3_b32 v7, v7, v136, s96 bitop3:0xf6
  v_bitop3_b32 v7, v7, v140, s96 bitop3:0xf6
  v_bitop3_b32 v7, v7, v144, s96 bitop3:0xf6
  v_bitop3_b32 v7, v7, v148, s96 bitop3:0xf6
  s_waitcnt vmcnt(5)
  v_mfma_f32_32x32x16_bf16 v[56:71], v[108:111], a[20:23], v[56:71]
  ds_read_b128 v[104:107], v3 offset:2048
  v_bitop3_b32 v7, v7, v152, s96 bitop3:0xf6
  v_bitop3_b32 v7, v7, v156, s96 bitop3:0xf6
  v_bitop3_b32 v7, v7, v160, s96 bitop3:0xf6
  v_bitop3_b32 v7, v7, v164, s96 bitop3:0xf6
  s_waitcnt vmcnt(1)
  v_mfma_f32_32x32x16_bf16 v[72:87], v[108:111], a[24:27], v[72:87]
  v_bitop3_b32 v7, v7, v168, s96 bitop3:0xf6
  v_bitop3_b32 v7, v7, v172, s96 bitop3:0xf6
  v_bitop3_b32 v7, v7, v176, s96 bitop3:0xf6
  v_bitop3_b32 v7, v7, v180, s96 bitop3:0xf6
  v_and_b32 v7, v254, v7
  v_cmp_ne_u32 vcc, 0, v7
  s_cbranch_vccnz o_rt_215
o_bk_216:
  v_mfma_f32_32x32x16_bf16 v[88:103], v[108:111], a[28:31], v[88:103]
  v_smfmac_f32_16x16x64_bf16 v[188:191], v[16:19], v[120:127], v20
  v_lshlrev_b32 v196, 16, v184
  v_smfmac_f32_16x16x64_bf16 v[192:195], v[16:19], v[128:135], v20
  v_and_b32 v197, 0xffff0000, v184
  v_smfmac_f32_16x16x64_bf16 v[188:191], v[16:19], v[136:143], v20
  v_lshlrev_b32 v198, 16, v185
  s_waitcnt lgkmcnt(2)
  v_mfma_f32_32x32x16_bf16 v[40:55], v[112:115], a[32:35], v[40:55]
  v_smfmac_f32_16x16x64_bf16 v[192:195], v[16:19], v[144:151], v20
  v_and_b32 v199, 0xffff0000, v185
  v_smfmac_f32_16x16x64_bf16 v[188:191], v[16:19], v[152:159], v20
  v_lshlrev_b32 v200, 16, v186
  v_smfmac_f32_16x16x64_bf16 v[192:195], v[16:19], v[160:167], v20
  v_and_b32 v201, 0xffff0000, v186
  v_mfma_f32_32x32x16_bf16 v[56:71], v[112:115], a[36:39], v[56:71]
  ds_read_b128 v[108:111], v3 offset:2560
  v_smfmac_f32_16x16x64_bf16 v[188:191], v[16:19], v[168:175], v20
  v_lshlrev_b32 v202, 16, v187
  v_smfmac_f32_16x16x64_bf16 v[192:195], v[16:19], v[176:183], v20
  v_and_b32 v203, 0xffff0000, v187
  s_bfe_u32 s92, s65, 131086
  v_mfma_f32_32x32x16_bf16 v[72:87], v[112:115], a[40:43], v[72:87]
  s_lshl_b32 s92, s92, 21
  s_add_u32 s92, s92, s91
  s_add_u32 s93, s92, 27262976
  s_add_u32 s92, s92, 20971520
  v_permlane16_swap_b32 v188, v192
  v_mfma_f32_32x32x16_bf16 v[88:103], v[112:115], a[44:47], v[88:103]
  v_permlane16_swap_b32 v189, v193
  v_permlane16_swap_b32 v190, v194
  v_permlane16_swap_b32 v191, v195
  s_waitcnt lgkmcnt(2)
  v_mfma_f32_32x32x16_bf16 v[40:55], v[116:119], a[48:51], v[40:55]
  v_cvt_pk_bf16_f32 v188, 0, v188
  v_cvt_pk_bf16_f32 v189, 0, v189
  v_cvt_pk_bf16_f32 v190, 0, v190
  v_cvt_pk_bf16_f32 v191, 0, v191
  v_cvt_pk_bf16_f32 v192, 0, v192
  v_cvt_pk_bf16_f32 v193, 0, v193
  v_mfma_f32_32x32x16_bf16 v[56:71], v[116:119], a[52:55], v[56:71]
  ds_read_b128 v[112:115], v3 offset:3072
  v_cvt_pk_bf16_f32 v194, 0, v194
  v_cvt_pk_bf16_f32 v195, 0, v195
  v_add_f32 v196, v196, v188
  v_add_f32 v197, v197, v189
  v_add_f32 v198, v198, v190
  v_mfma_f32_32x32x16_bf16 v[72:87], v[116:119], a[56:59], v[72:87]
  v_add_f32 v199, v199, v191
  v_add_f32 v200, v200, v192
  v_add_f32 v201, v201, v193
  v_add_f32 v202, v202, v194
  v_add_f32 v203, v203, v195
  v_cvt_pk_bf16_f32 v120, v196, v197
  v_mfma_f32_32x32x16_bf16 v[88:103], v[116:119], a[60:63], v[88:103]
  v_cvt_pk_bf16_f32 v121, v198, v199
  v_cvt_pk_bf16_f32 v122, v200, v201
  v_cvt_pk_bf16_f32 v123, v202, v203
  v_lshlrev_b32 v196, 16, v120
  v_and_b32 v197, 0xffff0000, v120
  s_waitcnt lgkmcnt(2)
  v_mfma_f32_32x32x16_bf16 v[40:55], v[104:107], a[64:67], v[40:55]
  v_lshlrev_b32 v198, 16, v121
  v_and_b32 v199, 0xffff0000, v121
  v_lshlrev_b32 v200, 16, v122
  v_and_b32 v201, 0xffff0000, v122
  v_lshlrev_b32 v202, 16, v123
  v_and_b32 v203, 0xffff0000, v123
  v_mfma_f32_32x32x16_bf16 v[56:71], v[104:107], a[68:71], v[56:71]
  ds_read_b128 v[116:119], v3 offset:3584
  buffer_store_dwordx4 v[120:123], v0, s[4:7], s92 offen sc1
  v_add_f32 v136, v196, v197
  v_mul_f32 v137, v196, v196
  v_mfma_f32_32x32x16_bf16 v[72:87], v[104:107], a[72:75], v[72:87]
  v_add_f32 v138, v198, v199
  v_mul_f32 v139, v197, v197
  v_fmac_f32 v137, v198, v198
  v_fmac_f32 v139, v199, v199
  v_add_f32 v136, v136, v200
  v_fmac_f32 v137, v200, v200
  v_mfma_f32_32x32x16_bf16 v[88:103], v[104:107], a[76:79], v[88:103]
  v_add_f32 v138, v138, v201
  v_fmac_f32 v139, v201, v201
  v_add_f32 v136, v136, v202
  v_fmac_f32 v137, v202, v202
  v_add_f32 v138, v138, v203
  s_waitcnt lgkmcnt(2)
  v_mfma_f32_32x32x16_bf16 v[40:55], v[108:111], a[80:83], v[40:55]
  v_fmac_f32 v139, v203, v203
  v_add_f32 v136, v136, v138
  v_add_f32 v137, v137, v139
  s_nop 0
  v_add_f32_dpp v136, v136, v136 row_ror:8 row_mask:0xf bank_mask:0xf
  v_add_f32_dpp v137, v137, v137 row_ror:8 row_mask:0xf bank_mask:0xf
  s_nop 0
  v_add_f32_dpp v136, v136, v136 row_ror:4 row_mask:0xf bank_mask:0xf
  v_mfma_f32_32x32x16_bf16 v[56:71], v[108:111], a[84:87], v[56:71]
  ds_read_b128 v[104:107], v3 offset:8192
  v_add_f32_dpp v137, v137, v137 row_ror:4 row_mask:0xf bank_mask:0xf
  v_add_f32_dpp v136, v136, v136 row_ror:2 row_mask:0xf bank_mask:0xf
  s_nop 0
  v_add_f32_dpp v137, v137, v137 row_ror:2 row_mask:0xf bank_mask:0xf
  v_add_f32_dpp v136, v136, v136 row_ror:1 row_mask:0xf bank_mask:0xf
  s_nop 0
  v_add_f32_dpp v137, v137, v137 row_ror:1 row_mask:0xf bank_mask:0xf
  v_mfma_f32_32x32x16_bf16 v[72:87], v[108:111], a[88:91], v[72:87]
  v_mov_b32 v140, v136
  v_mov_b32 v141, v137
  s_nop 0
  v_permlane16_swap_b32 v136, v140
  v_permlane16_swap_b32 v137, v141
  v_mfma_f32_32x32x16_bf16 v[88:103], v[108:111], a[92:95], v[88:103]
  v_add_f32 v136, v136, v140
  v_add_f32 v137, v137, v141
  v_mov_b32 v140, v136
  v_mov_b32 v141, v137
  s_nop 0
  v_permlane32_swap_b32 v136, v140
  s_waitcnt lgkmcnt(2)
  v_mfma_f32_32x32x16_bf16 v[40:55], v[112:115], a[96:99], v[40:55]
  v_permlane32_swap_b32 v137, v141
  v_add_f32 v136, v136, v140
  v_add_f32 v137, v137, v141
  v_mul_f32 v136, 0x3b000000, v136
  v_mul_f32 v137, 0x3b000000, v137
  v_mfma_f32_32x32x16_bf16 v[56:71], v[112:115], a[100:103], v[56:71]
  ds_read_b128 v[108:111], v3 offset:8704
  v_fma_f32 v137, -v136, v136, v137
  v_cvt_pk_bf16_f32 v136, 0, v136
  v_max_f32 v137, 0, v137
  v_sub_f32 v140, v196, v136
  v_sub_f32 v141, v197, v136
  v_mfma_f32_32x32x16_bf16 v[72:87], v[112:115], a[104:107], v[72:87]
  v_cvt_pk_bf16_f32 v137, 0, v137
  v_sub_f32 v142, v198, v136
  v_sub_f32 v143, v199, v136
  v_add_f32 v137, 0x3727c5ac, v137
  v_sub_f32 v144, v200, v136
  v_sub_f32 v145, v201, v136
  v_mfma_f32_32x32x16_bf16 v[88:103], v[112:115], a[108:111], v[88:103]
  v_cvt_pk_bf16_f32 v137, 0, v137
  v_sub_f32 v146, v202, v136
  v_sub_f32 v147, v203, v136
  v_sqrt_f32 v137, v137
  s_waitcnt lgkmcnt(2)
  v_mfma_f32_32x32x16_bf16 v[40:55], v[116:119], a[112:115], v[40:55]
  v_cvt_pk_bf16_f32 v140, 0, v140
  v_cvt_pk_bf16_f32 v141, 0, v141
  v_cvt_pk_bf16_f32 v137, 0, v137
  v_cvt_pk_bf16_f32 v142, 0, v142
  v_cvt_pk_bf16_f32 v143, 0, v143
  v_rcp_f32 v137, v137
  v_mfma_f32_32x32x16_bf16 v[56:71], v[116:119], a[116:119], v[56:71]
  ds_read_b128 v[112:115], v3 offset:9216
  v_cvt_pk_bf16_f32 v144, 0, v144
  v_cvt_pk_bf16_f32 v145, 0, v145
  v_cvt_pk_bf16_f32 v146, 0, v146
  v_cvt_pk_bf16_f32 v147, 0, v147
  v_mul_f32 v140, v140, v137
  v_mfma_f32_32x32x16_bf16 v[72:87], v[116:119], a[120:123], v[72:87]
  v_mul_f32 v141, v141, v137
  v_mul_f32 v142, v142, v137
  v_mul_f32 v143, v143, v137
  v_mul_f32 v144, v144, v137
  v_mul_f32 v145, v145, v137
  v_mul_f32 v146, v146, v137
  v_mfma_f32_32x32x16_bf16 v[88:103], v[116:119], a[124:127], v[88:103]
  v_mul_f32 v147, v147, v137
  v_cvt_pk_bf16_f32 v124, v140, v141
  v_cvt_pk_bf16_f32 v125, v142, v143
  v_cvt_pk_bf16_f32 v126, v144, v145
  v_cvt_pk_bf16_f32 v127, v146, v147
  s_waitcnt lgkmcnt(2)
  v_mfma_f32_32x32x16_bf16 v[40:55], v[104:107], a[128:131], v[40:55]
  v_lshlrev_b32 v204, 16, v124
  v_and_b32 v205, 0xffff0000, v124
  v_lshlrev_b32 v206, 16, v125
  v_and_b32 v207, 0xffff0000, v125
  v_lshlrev_b32 v208, 16, v126
  v_and_b32 v209, 0xffff0000, v126
  v_mfma_f32_32x32x16_bf16 v[56:71], v[104:107], a[132:135], v[56:71]
  ds_read_b128 v[116:119], v3 offset:9728
  v_lshlrev_b32 v210, 16, v127
  v_and_b32 v211, 0xffff0000, v127
  buffer_store_dwordx4 v[124:127], v0, s[4:7], s93 offen sc1
  v_mfma_f32_32x32x16_bf16 v[72:87], v[104:107], a[136:139], v[72:87]
  v_add_f32 v196, v196, v204
  v_add_f32 v197, v197, v205
  v_add_f32 v198, v198, v206
  v_add_f32 v199, v199, v207
  v_add_f32 v200, v200, v208
  v_add_f32 v201, v201, v209
  v_mfma_f32_32x32x16_bf16 v[88:103], v[104:107], a[140:143], v[88:103]
  v_add_f32 v202, v202, v210
  v_add_f32 v203, v203, v211
  v_cvt_pk_bf16_f32 v128, v196, v197
  v_cvt_pk_bf16_f32 v129, v198, v199
  v_cvt_pk_bf16_f32 v130, v200, v201
  s_waitcnt lgkmcnt(2)
  v_mfma_f32_32x32x16_bf16 v[40:55], v[108:111], a[144:147], v[40:55]
  v_cvt_pk_bf16_f32 v131, v202, v203
  v_mul_f32 v188, v204, v8
  v_mul_f32 v189, v205, v9
  v_fmac_f32 v188, v206, v10
  v_fmac_f32 v189, v207, v11
  v_fmac_f32 v188, v208, v12
  v_mfma_f32_32x32x16_bf16 v[56:71], v[108:111], a[148:151], v[56:71]
  ds_read_b128 v[104:107], v3 offset:10240
  v_fmac_f32 v189, v209, v13
  v_fmac_f32 v188, v210, v14
  v_fmac_f32 v189, v211, v15
  v_add_f32 v188, v188, v189
  buffer_store_dwordx4 v[128:131], v0, s[68:71], s91 offen sc1
  v_mfma_f32_32x32x16_bf16 v[72:87], v[108:111], a[152:155], v[72:87]
  v_add_f32_dpp v188, v188, v188 row_ror:8 row_mask:0xf bank_mask:0xf
  s_nop 1
  v_add_f32_dpp v188, v188, v188 row_ror:4 row_mask:0xf bank_mask:0xf
  s_nop 1
  v_add_f32_dpp v188, v188, v188 row_ror:2 row_mask:0xf bank_mask:0xf
  s_nop 1
  v_add_f32_dpp v188, v188, v188 row_ror:1 row_mask:0xf bank_mask:0xf
  v_mov_b32 v189, v188
  s_nop 0
  s_nop 0
  v_permlane16_swap_b32 v188, v189
  v_mfma_f32_32x32x16_bf16 v[88:103], v[108:111], a[156:159], v[88:103]
  v_add_f32 v188, v188, v189
  v_mov_b32 v189, v188
  s_nop 0
  s_nop 0
  v_permlane32_swap_b32 v188, v189
  v_add_f32 v188, v188, v189
  s_waitcnt lgkmcnt(2)
  v_mfma_f32_32x32x16_bf16 v[40:55], v[112:115], a[160:163], v[40:55]
  v_cvt_pk_bf16_f32 v188, 0, v188
  v_ashrrev_i32 v189, 31, v188
  v_or_b32 v189, 0x80000000, v189
  v_xor_b32 v188, v188, v189
  s_sub_u32 s92, 4095, s90
  v_and_b32 v188, 0xffff0000, v188
  v_mfma_f32_32x32x16_bf16 v[56:71], v[112:115], a[164:167], v[56:71]
  ds_read_b128 v[108:111], v3 offset:10752
  v_or_b32 v38, s92, v188
  s_bfe_u32 s92, s65, 196625
  s_lshl_b32 s92, s92, 18
  s_lshl_b32 s93, s90, 7
  s_add_u32 s92, s92, s93
  v_mfma_f32_32x32x16_bf16 v[72:87], v[112:115], a[168:171], v[72:87]
  s_add_u32 s84, s92, 243269632
  v_mfma_f32_32x32x16_bf16 v[88:103], v[112:115], a[172:175], v[88:103]
  s_waitcnt lgkmcnt(2)
  v_mfma_f32_32x32x16_bf16 v[40:55], v[116:119], a[176:179], v[40:55]
  v_mfma_f32_32x32x16_bf16 v[56:71], v[116:119], a[180:183], v[56:71]
  ds_read_b128 v[112:115], v3 offset:11264
  v_mfma_f32_32x32x16_bf16 v[72:87], v[116:119], a[184:187], v[72:87]
  v_mfma_f32_32x32x16_bf16 v[88:103], v[116:119], a[188:191], v[88:103]
  s_waitcnt lgkmcnt(2)
  v_mfma_f32_32x32x16_bf16 v[40:55], v[104:107], a[192:195], v[40:55]
  v_mfma_f32_32x32x16_bf16 v[56:71], v[104:107], a[196:199], v[56:71]
  ds_read_b128 v[116:119], v3 offset:11776
  s_waitcnt lgkmcnt(2)
  v_mfma_f32_32x32x16_bf16 v[40:55], v[108:111], a[208:211], v[40:55]
  v_mfma_f32_32x32x16_bf16 v[56:71], v[108:111], a[212:215], v[56:71]
  s_waitcnt lgkmcnt(1)
  v_mfma_f32_32x32x16_bf16 v[40:55], v[112:115], a[224:227], v[40:55]
  v_mfma_f32_32x32x16_bf16 v[56:71], v[112:115], a[228:231], v[56:71]
  s_waitcnt lgkmcnt(0)
  v_mfma_f32_32x32x16_bf16 v[40:55], v[116:119], a[240:243], v[40:55]
  v_mfma_f32_32x32x16_bf16 v[56:71], v[116:119], a[244:247], v[56:71]
  v_mfma_f32_32x32x16_bf16 v[72:87], v[104:107], a[200:203], v[72:87]
  v_mfma_f32_32x32x16_bf16 v[88:103], v[104:107], a[204:207], v[88:103]
  v_cvt_pk_bf16_f32 v212, v40, v56
  v_cvt_pk_bf16_f32 v214, v41, v57
  v_cvt_pk_bf16_f32 v216, v42, v58
  v_cvt_pk_bf16_f32 v218, v43, v59
  v_permlane16_swap_b32 v212, v214
  v_mfma_f32_32x32x16_bf16 v[72:87], v[108:111], a[216:219], v[72:87]
  v_cvt_pk_bf16_f32 v220, v44, v60
  v_cvt_pk_bf16_f32 v222, v45, v61
  v_permlane16_swap_b32 v216, v218
  v_bfi_b32 v212, v254, s42, v212
  v_cvt_pk_bf16_f32 v224, v46, v62
  v_mfma_f32_32x32x16_bf16 v[88:103], v[108:111], a[220:223], v[88:103]
  v_cvt_pk_bf16_f32 v226, v47, v63
  v_permlane16_swap_b32 v220, v222
  v_bfi_b32 v216, v254, s42, v216
  v_cvt_pk_bf16_f32 v228, v48, v64
  v_mfma_f32_32x32x16_bf16 v[72:87], v[112:115], a[232:235], v[72:87]
  v_cvt_pk_bf16_f32 v230, v49, v65
  v_permlane16_swap_b32 v224, v226
  v_bfi_b32 v220, v254, s42, v220
  v_cvt_pk_bf16_f32 v232, v50, v66
  v_cvt_pk_bf16_f32 v234, v51, v67
  v_mfma_f32_32x32x16_bf16 v[88:103], v[112:115], a[236:239], v[88:103]
  v_permlane16_swap_b32 v228, v230
  v_bfi_b32 v224, v254, s42, v224
  v_cvt_pk_bf16_f32 v236, v52, v68
  v_cvt_pk_bf16_f32 v238, v53, v69
  v_mfma_f32_32x32x16_bf16 v[72:87], v[116:119], a[248:251], v[72:87]
  v_permlane16_swap_b32 v232, v234
  v_bfi_b32 v228, v254, s42, v228
  v_cvt_pk_bf16_f32 v240, v54, v70
  v_cvt_pk_bf16_f32 v242, v55, v71
  v_permlane16_swap_b32 v236, v238
  v_mfma_f32_32x32x16_bf16 v[88:103], v[116:119], a[252:255], v[88:103]
  v_bfi_b32 v232, v254, s42, v232
  v_permlane16_swap_b32 v240, v242
  v_bfi_b32 v236, v254, s42, v236
  v_bfi_b32 v240, v254, s42, v240
  s_nop 7
  v_cvt_pk_bf16_f32 v213, v72, v88
  v_cvt_pk_bf16_f32 v215, v73, v89
  v_cvt_pk_bf16_f32 v217, v74, v90
  v_cvt_pk_bf16_f32 v219, v75, v91
  s_add_u32 s78, s86, 0
  v_permlane16_swap_b32 v213, v215
  buffer_store_dwordx4 v[212:215], v4, s[4:7], s78 offen sc1
  v_cvt_pk_bf16_f32 v221, v76, v92
  v_cvt_pk_bf16_f32 v223, v77, v93
  s_add_u32 s78, s86, 32768
  v_permlane16_swap_b32 v217, v219
  buffer_store_dwordx4 v[216:219], v4, s[4:7], s78 offen sc1
  v_cvt_pk_bf16_f32 v225, v78, v94
  v_cvt_pk_bf16_f32 v227, v79, v95
  s_add_u32 s78, s86, 131072
  v_permlane16_swap_b32 v221, v223
  buffer_store_dwordx4 v[220:223], v4, s[4:7], s78 offen sc1
  v_cvt_pk_bf16_f32 v229, v80, v96
  v_cvt_pk_bf16_f32 v231, v81, v97
  s_add_u32 s78, s86, 163840
  v_permlane16_swap_b32 v225, v227
  buffer_store_dwordx4 v[224:227], v4, s[4:7], s78 offen sc1
  v_cvt_pk_bf16_f32 v233, v82, v98
  v_cvt_pk_bf16_f32 v235, v83, v99
  s_add_u32 s78, s86, 262144
  v_permlane16_swap_b32 v229, v231
  buffer_store_dwordx4 v[228:231], v4, s[4:7], s78 offen sc1
  v_cvt_pk_bf16_f32 v237, v84, v100
  v_cvt_pk_bf16_f32 v239, v85, v101
  s_add_u32 s78, s86, 294912
  v_permlane16_swap_b32 v233, v235
  buffer_store_dwordx4 v[232:235], v4, s[4:7], s78 offen sc1
  v_cvt_pk_bf16_f32 v241, v86, v102
  v_cvt_pk_bf16_f32 v243, v87, v103
  s_add_u32 s78, s86, 393216
  v_permlane16_swap_b32 v237, v239
  buffer_store_dwordx4 v[236:239], v4, s[4:7], s78 offen sc1
  s_add_u32 s78, s86, 425984
  v_permlane16_swap_b32 v241, v243
  buffer_store_dwordx4 v[240:243], v4, s[4:7], s78 offen sc1
o_we_205:
  v_and_b32 v37, -32, v39
  s_waitcnt lgkmcnt(0)
  s_barrier
  ds_read_b128 v[104:107], v37 offset:16
  s_mov_b32 s65, s63
  s_waitcnt lgkmcnt(0)
  v_and_b32 v104, v104, v106
  v_max_u32 v105, v105, v107
  v_readfirstlane_b32 s26, v104
  v_readfirstlane_b32 s3, v105
  s_and_b32 s66, s26, 1
  s_and_b32 s76, s26, 2
  s_bitcmp1_b32 s26, 2
  s_cselect_b32 s3, s3, 0
  s_cmp_lg_u32 s76, 0
  s_cbranch_scc1 o_nofl_179
  s_and_b32 s26, s63, 49152
  s_cbranch_scc0 o_fl_180
  s_and_b32 s26, s64, s50
  s_cbranch_scc1 o_nofl_179
o_fl_180:
  s_cmp_ge_u32 s17, 2
  s_cbranch_scc1 o_fd_219
  s_cmp_eq_u32 s65, 0
  s_cbranch_scc1 o_fd_219
  s_mov_b32 s96, s42
  s_lshl_b32 s97, s43, 14
  s_add_u32 s97, s97, s86
  buffer_load_dword v7, v255, s[4:7], s97 offen sc1
  s_and_b32 s91, s65, 63
  s_lshl_b32 s90, s91, 5
  s_add_u32 s94, s90, s85
  s_add_u32 s90, s90, s43
  s_lshl_b32 s94, s94, 10
  s_lshr_b32 s92, s65, 22
  s_xor_b32 s93, s43, 32
  s_lshl_b32 s91, s90, 10
  s_add_u32 s94, s94, 25165824
  s_cmp_eq_u32 s92, s93
  s_cselect_b32 s92, s94, s91
  s_add_u32 s92, s92, 10485760
  s_and_b32 s93, s65, 49152
  s_cselect_b32 s92, s92, s91
  s_cselect_b64 s[80:81], s[4:5], s[72:73]
  s_cselect_b32 s82, s6, s74
  buffer_load_dwordx4 v[184:187], v0, s[80:83], s92 offen sc1
  s_mov_b32 s67, 0
  s_mov_b64 vcc, 0
  s_waitcnt vmcnt(1)
o_pl_221:
  v_and_b32 v7, 1, v7
  v_cmp_ne_u32 vcc, s96, v7
  s_cbranch_vccz o_pk_222
  s_mov_b64 exec, 1
  buffer_store_dword v38, off, s[4:7], s84 sc1
  s_mov_b64 exec, -1
  s_mov_b32 s84, 268435456
  buffer_load_dword v7, v255, s[4:7], s97 offen sc1
  s_add_u32 s67, s67, 1
  s_cmp_gt_u32 s67, 1048576
  s_cbranch_scc1 L_end
  s_waitcnt vmcnt(0)
  s_branch o_pl_221
o_pk_222:
  s_and_b32 s26, s65, 49152
  s_cbranch_scc1 o_f2_220
  s_lshl_b32 s94, s43, 14
  s_add_u32 s94, s94, s86
  buffer_load_dwordx4 v[120:123], v5, s[4:7], s94 offen offset:0 sc1
  buffer_load_dwordx4 v[124:127], v5, s[4:7], s94 offen offset:512 sc1
  buffer_load_dwordx4 v[128:131], v5, s[4:7], s94 offen offset:256 sc1
  buffer_load_dwordx4 v[132:135], v5, s[4:7], s94 offen offset:768 sc1
  s_add_u32 s94, s94, 4096
  buffer_load_dwordx4 v[136:139], v5, s[4:7], s94 offen offset:0 sc1
  buffer_load_dwordx4 v[140:143], v5, s[4:7], s94 offen offset:512 sc1
  buffer_load_dwordx4 v[144:147], v5, s[4:7], s94 offen offset:256 sc1
  buffer_load_dwordx4 v[148:151], v5, s[4:7], s94 offen offset:768 sc1
  s_add_u32 s94, s94, 4096
  buffer_load_dwordx4 v[152:155], v5, s[4:7], s94 offen offset:0 sc1
  buffer_load_dwordx4 v[156:159], v5, s[4:7], s94 offen offset:512 sc1
  buffer_load_dwordx4 v[160:163], v5, s[4:7], s94 offen offset:256 sc1
  buffer_load_dwordx4 v[164:167], v5, s[4:7], s94 offen offset:768 sc1
  s_add_u32 s94, s94, 4096
  buffer_load_dwordx4 v[168:171], v5, s[4:7], s94 offen offset:0 sc1
  buffer_load_dwordx4 v[172:175], v5, s[4:7], s94 offen offset:512 sc1
  buffer_load_dwordx4 v[176:179], v5, s[4:7], s94 offen offset:256 sc1
  buffer_load_dwordx4 v[180:183], v5, s[4:7], s94 offen offset:768 sc1
  s_mov_b64 exec, 1
  buffer_store_dword v38, off, s[4:7], s84 sc1
  s_mov_b64 exec, -1
  s_mov_b32 s84, 268435456
  v_mov_b64 v[188:189], 0
  v_mov_b64 v[190:191], 0
  v_mov_b64 v[192:193], 0
  v_mov_b64 v[194:195], 0
  s_waitcnt vmcnt(13)
  v_xor_b32 v7, s96, v120
  v_bitop3_b32 v7, v7, v124, s96 bitop3:0xf6
  v_bitop3_b32 v7, v7, v128, s96 bitop3:0xf6
  v_bitop3_b32 v7, v7, v132, s96 bitop3:0xf6
  s_waitcnt vmcnt(9)
  v_bitop3_b32 v7, v7, v136, s96 bitop3:0xf6
  v_bitop3_b32 v7, v7, v140, s96 bitop3:0xf6
  v_bitop3_b32 v7, v7, v144, s96 bitop3:0xf6
  v_bitop3_b32 v7, v7, v148, s96 bitop3:0xf6
  s_waitcnt vmcnt(5)
  v_bitop3_b32 v7, v7, v152, s96 bitop3:0xf6
  v_bitop3_b32 v7, v7, v156, s96 bitop3:0xf6
  v_bitop3_b32 v7, v7, v160, s96 bitop3:0xf6
  v_bitop3_b32 v7, v7, v164, s96 bitop3:0xf6
  s_waitcnt vmcnt(1)
  v_bitop3_b32 v7, v7, v168, s96 bitop3:0xf6
  v_bitop3_b32 v7, v7, v172, s96 bitop3:0xf6
  v_bitop3_b32 v7, v7, v176, s96 bitop3:0xf6
  v_bitop3_b32 v7, v7, v180, s96 bitop3:0xf6
  v_and_b32 v7, v254, v7
  v_cmp_ne_u32 vcc, 0, v7
  s_cbranch_vccnz o_rt_223
o_bk_224:
  v_smfmac_f32_16x16x64_bf16 v[188:191], v[16:19], v[120:127], v20
  v_lshlrev_b32 v196, 16, v184
  v_smfmac_f32_16x16x64_bf16 v[192:195], v[16:19], v[128:135], v20
  v_and_b32 v197, 0xffff0000, v184
  v_smfmac_f32_16x16x64_bf16 v[188:191], v[16:19], v[136:143], v20
  v_lshlrev_b32 v198, 16, v185
  v_smfmac_f32_16x16x64_bf16 v[192:195], v[16:19], v[144:151], v20
  v_and_b32 v199, 0xffff0000, v185
  v_smfmac_f32_16x16x64_bf16 v[188:191], v[16:19], v[152:159], v20
  v_lshlrev_b32 v200, 16, v186
  v_smfmac_f32_16x16x64_bf16 v[192:195], v[16:19], v[160:167], v20
  v_and_b32 v201, 0xffff0000, v186
  v_smfmac_f32_16x16x64_bf16 v[188:191], v[16:19], v[168:175], v20
  v_lshlrev_b32 v202, 16, v187
  v_smfmac_f32_16x16x64_bf16 v[192:195], v[16:19], v[176:183], v20
  v_and_b32 v203, 0xffff0000, v187
  s_bfe_u32 s92, s65, 131086
  s_lshl_b32 s92, s92, 21
  s_add_u32 s92, s92, s91
  s_add_u32 s93, s92, 27262976
  s_add_u32 s92, s92, 20971520
  s_nop 1
  v_permlane16_swap_b32 v188, v192
  v_permlane16_swap_b32 v189, v193
  v_permlane16_swap_b32 v190, v194
  v_permlane16_swap_b32 v191, v195
  v_cvt_pk_bf16_f32 v188, 0, v188
  v_cvt_pk_bf16_f32 v189, 0, v189
  v_cvt_pk_bf16_f32 v190, 0, v190
  v_cvt_pk_bf16_f32 v191, 0, v191
  v_cvt_pk_bf16_f32 v192, 0, v192
  v_cvt_pk_bf16_f32 v193, 0, v193
  v_cvt_pk_bf16_f32 v194, 0, v194
  v_cvt_pk_bf16_f32 v195, 0, v195
  v_add_f32 v196, v196, v188
  v_add_f32 v197, v197, v189
  v_add_f32 v198, v198, v190
  v_add_f32 v199, v199, v191
  v_add_f32 v200, v200, v192
  v_add_f32 v201, v201, v193
  v_add_f32 v202, v202, v194
  v_add_f32 v203, v203, v195
  v_cvt_pk_bf16_f32 v120, v196, v197
  v_cvt_pk_bf16_f32 v121, v198, v199
  v_cvt_pk_bf16_f32 v122, v200, v201
  v_cvt_pk_bf16_f32 v123, v202, v203
  v_lshlrev_b32 v196, 16, v120
  v_and_b32 v197, 0xffff0000, v120
  v_lshlrev_b32 v198, 16, v121
  v_and_b32 v199, 0xffff0000, v121
  v_lshlrev_b32 v200, 16, v122
  v_and_b32 v201, 0xffff0000, v122
  v_lshlrev_b32 v202, 16, v123
  v_and_b32 v203, 0xffff0000, v123
  buffer_store_dwordx4 v[120:123], v0, s[4:7], s92 offen sc1
  v_add_f32 v136, v196, v197
  v_mul_f32 v137, v196, v196
  v_add_f32 v138, v198, v199
  v_mul_f32 v139, v197, v197
  v_fmac_f32 v137, v198, v198
  v_fmac_f32 v139, v199, v199
  v_add_f32 v136, v136, v200
  v_fmac_f32 v137, v200, v200
  v_add_f32 v138, v138, v201
  v_fmac_f32 v139, v201, v201
  v_add_f32 v136, v136, v202
  v_fmac_f32 v137, v202, v202
  v_add_f32 v138, v138, v203
  v_fmac_f32 v139, v203, v203
  v_add_f32 v136, v136, v138
  v_add_f32 v137, v137, v139
  s_nop 0
  v_add_f32_dpp v136, v136, v136 row_ror:8 row_mask:0xf bank_mask:0xf
  v_add_f32_dpp v137, v137, v137 row_ror:8 row_mask:0xf bank_mask:0xf
  s_nop 0
  v_add_f32_dpp v136, v136, v136 row_ror:4 row_mask:0xf bank_mask:0xf
  v_add_f32_dpp v137, v137, v137 row_ror:4 row_mask:0xf bank_mask:0xf
  s_nop 0
  v_add_f32_dpp v136, v136, v136 row_ror:2 row_mask:0xf bank_mask:0xf
  v_add_f32_dpp v137, v137, v137 row_ror:2 row_mask:0xf bank_mask:0xf
  s_nop 0
  v_add_f32_dpp v136, v136, v136 row_ror:1 row_mask:0xf bank_mask:0xf
  v_add_f32_dpp v137, v137, v137 row_ror:1 row_mask:0xf bank_mask:0xf
  v_mov_b32 v140, v136
  v_mov_b32 v141, v137
  s_nop 0
  v_permlane16_swap_b32 v136, v140
  v_permlane16_swap_b32 v137, v141
  v_add_f32 v136, v136, v140
  v_add_f32 v137, v137, v141
  v_mov_b32 v140, v136
  v_mov_b32 v141, v137
  s_nop 0
  v_permlane32_swap_b32 v136, v140
  v_permlane32_swap_b32 v137, v141
  v_add_f32 v136, v136, v140
  v_add_f32 v137, v137, v141
  v_mul_f32 v136, 0x3b000000, v136
  v_mul_f32 v137, 0x3b000000, v137
  v_fma_f32 v137, -v136, v136, v137
  v_cvt_pk_bf16_f32 v136, 0, v136
  v_max_f32 v137, 0, v137
  v_sub_f32 v140, v196, v136
  v_sub_f32 v141, v197, v136
  v_cvt_pk_bf16_f32 v137, 0, v137
  v_sub_f32 v142, v198, v136
  v_sub_f32 v143, v199, v136
  v_add_f32 v137, 0x3727c5ac, v137
  v_sub_f32 v144, v200, v136
  v_sub_f32 v145, v201, v136
  v_cvt_pk_bf16_f32 v137, 0, v137
  v_sub_f32 v146, v202, v136
  v_sub_f32 v147, v203, v136
  v_sqrt_f32 v137, v137
  v_cvt_pk_bf16_f32 v140, 0, v140
  v_cvt_pk_bf16_f32 v141, 0, v141
  v_cvt_pk_bf16_f32 v137, 0, v137
  v_cvt_pk_bf16_f32 v142, 0, v142
  v_cvt_pk_bf16_f32 v143, 0, v143
  v_rcp_f32 v137, v137
  v_cvt_pk_bf16_f32 v144, 0, v144
  v_cvt_pk_bf16_f32 v145, 0, v145
  v_cvt_pk_bf16_f32 v146, 0, v146
  v_cvt_pk_bf16_f32 v147, 0, v147
  v_mul_f32 v140, v140, v137
  v_mul_f32 v141, v141, v137
  v_mul_f32 v142, v142, v137
  v_mul_f32 v143, v143, v137
  v_mul_f32 v144, v144, v137
  v_mul_f32 v145, v145, v137
  v_mul_f32 v146, v146, v137
  v_mul_f32 v147, v147, v137
  v_cvt_pk_bf16_f32 v124, v140, v141
  v_cvt_pk_bf16_f32 v125, v142, v143
  v_cvt_pk_bf16_f32 v126, v144, v145
  v_cvt_pk_bf16_f32 v127, v146, v147
  v_lshlrev_b32 v204, 16, v124
  v_and_b32 v205, 0xffff0000, v124
  v_lshlrev_b32 v206, 16, v125
  v_and_b32 v207, 0xffff0000, v125
  v_lshlrev_b32 v208, 16, v126
  v_and_b32 v209, 0xffff0000, v126
  v_lshlrev_b32 v210, 16, v127
  v_and_b32 v211, 0xffff0000, v127
  buffer_store_dwordx4 v[124:127], v0, s[4:7], s93 offen sc1
  v_add_f32 v196, v196, v204
  v_add_f32 v197, v197, v205
  v_add_f32 v198, v198, v206
  v_add_f32 v199, v199, v207
  v_add_f32 v200, v200, v208
  v_add_f32 v201, v201, v209
  v_add_f32 v202, v202, v210
  v_add_f32 v203, v203, v211
  v_cvt_pk_bf16_f32 v128, v196, v197
  v_cvt_pk_bf16_f32 v129, v198, v199
  v_cvt_pk_bf16_f32 v130, v200, v201
  v_cvt_pk_bf16_f32 v131, v202, v203
  v_mul_f32 v188, v204, v8
  v_mul_f32 v189, v205, v9
  v_fmac_f32 v188, v206, v10
  v_fmac_f32 v189, v207, v11
  v_fmac_f32 v188, v208, v12
  v_fmac_f32 v189, v209, v13
  v_fmac_f32 v188, v210, v14
  v_fmac_f32 v189, v211, v15
  v_add_f32 v188, v188, v189
  s_add_u32 s92, s91, 10485760
  s_add_u32 s93, s91, 8388608
  buffer_store_dwordx4 v[128:131], v0, s[4:7], s92 offen sc1
  v_lshlrev_b32 v196, 16, v128
  v_and_b32 v197, 0xffff0000, v128
  v_lshlrev_b32 v198, 16, v129
  v_and_b32 v199, 0xffff0000, v129
  v_lshlrev_b32 v200, 16, v130
  v_and_b32 v201, 0xffff0000, v130
  v_lshlrev_b32 v202, 16, v131
  v_and_b32 v203, 0xffff0000, v131
  v_add_f32 v136, v196, v197
  v_mul_f32 v137, v196, v196
  v_add_f32 v138, v198, v199
  v_mul_f32 v139, v197, v197
  v_fmac_f32 v137, v198, v198
  v_fmac_f32 v139, v199, v199
  v_add_f32 v136, v136, v200
  v_fmac_f32 v137, v200, v200
  v_add_f32 v138, v138, v201
  v_fmac_f32 v139, v201, v201
  v_add_f32 v136, v136, v202
  v_fmac_f32 v137, v202, v202
  v_add_f32 v138, v138, v203
  v_fmac_f32 v139, v203, v203
  v_add_f32 v136, v136, v138
  v_add_f32 v137, v137, v139
  s_nop 0
  v_add_f32_dpp v136, v136, v136 row_ror:8 row_mask:0xf bank_mask:0xf
  v_add_f32_dpp v137, v137, v137 row_ror:8 row_mask:0xf bank_mask:0xf
  v_add_f32_dpp v188, v188, v188 row_ror:8 row_mask:0xf bank_mask:0xf
  v_add_f32_dpp v136, v136, v136 row_ror:4 row_mask:0xf bank_mask:0xf
  v_add_f32_dpp v137, v137, v137 row_ror:4 row_mask:0xf bank_mask:0xf
  v_add_f32_dpp v188, v188, v188 row_ror:4 row_mask:0xf bank_mask:0xf
  v_add_f32_dpp v136, v136, v136 row_ror:2 row_mask:0xf bank_mask:0xf
  v_add_f32_dpp v137, v137, v137 row_ror:2 row_mask:0xf bank_mask:0xf
  v_add_f32_dpp v188, v188, v188 row_ror:2 row_mask:0xf bank_mask:0xf
  v_add_f32_dpp v136, v136, v136 row_ror:1 row_mask:0xf bank_mask:0xf
  v_add_f32_dpp v137, v137, v137 row_ror:1 row_mask:0xf bank_mask:0xf
  v_add_f32_dpp v188, v188, v188 row_ror:1 row_mask:0xf bank_mask:0xf
  v_mov_b32 v140, v136
  v_mov_b32 v141, v137
  v_mov_b32 v142, v188
  v_permlane16_swap_b32 v136, v140
  v_permlane16_swap_b32 v137, v141
  v_permlane16_swap_b32 v188, v142
  v_add_f32 v136, v136, v140
  v_add_f32 v137, v137, v141
  v_add_f32 v188, v188, v142
  v_mov_b32 v140, v136
  v_mov_b32 v141, v137
  v_mov_b32 v142, v188
  v_permlane32_swap_b32 v136, v140
  v_permlane32_swap_b32 v137, v141
  v_permlane32_swap_b32 v188, v142
  v_add_f32 v136, v136, v140
  v_add_f32 v137, v137, v141
  v_add_f32 v188, v188, v142
  v_mul_f32 v136, 0x3b000000, v136
  v_mul_f32 v137, 0x3b000000, v137
  v_fma_f32 v137, -v136, v136, v137
  v_cvt_pk_bf16_f32 v136, 0, v136
  v_max_f32 v137, 0, v137
  v_sub_f32 v140, v196, v136
  v_sub_f32 v141, v197, v136
  v_cvt_pk_bf16_f32 v137, 0, v137
  v_sub_f32 v142, v198, v136
  v_sub_f32 v143, v199, v136
  v_add_f32 v137, 0x3727c5ac, v137
  v_sub_f32 v144, v200, v136
  v_sub_f32 v145, v201, v136
  v_cvt_pk_bf16_f32 v137, 0, v137
  v_sub_f32 v146, v202, v136
  v_sub_f32 v147, v203, v136
  v_sqrt_f32 v137, v137
  v_cvt_pk_bf16_f32 v140, 0, v140
  v_cvt_pk_bf16_f32 v141, 0, v141
  v_cvt_pk_bf16_f32 v137, 0, v137
  v_cvt_pk_bf16_f32 v142, 0, v142
  v_cvt_pk_bf16_f32 v143, 0, v143
  v_rcp_f32 v137, v137
  v_cvt_pk_bf16_f32 v144, 0, v144
  v_cvt_pk_bf16_f32 v145, 0, v145
  v_cvt_pk_bf16_f32 v146, 0, v146
  v_cvt_pk_bf16_f32 v147, 0, v147
  v_mul_f32 v140, v140, v137
  v_mul_f32 v141, v141, v137
  v_mul_f32 v142, v142, v137
  v_mul_f32 v143, v143, v137
  v_mul_f32 v144, v144, v137
  v_mul_f32 v145, v145, v137
  v_mul_f32 v146, v146, v137
  v_mul_f32 v147, v147, v137
  v_cvt_pk_bf16_f32 v132, v140, v141
  v_cvt_pk_bf16_f32 v133, v142, v143
  v_cvt_pk_bf16_f32 v134, v144, v145
  v_cvt_pk_bf16_f32 v135, v146, v147
  buffer_store_dwordx4 v[132:135], v0, s[4:7], s93 offen sc1
  v_cvt_pk_bf16_f32 v188, 0, v188
  v_ashrrev_i32 v189, 31, v188
  v_or_b32 v189, 0x80000000, v189
  v_xor_b32 v188, v188, v189
  s_sub_u32 s92, 4095, s90
  v_and_b32 v188, 0xffff0000, v188
  v_or_b32 v38, s92, v188
  s_bfe_u32 s92, s65, 196625
  s_lshl_b32 s92, s92, 18
  s_lshl_b32 s93, s90, 7
  s_add_u32 s92, s92, s93
  s_add_u32 s84, s92, 243269632
  s_waitcnt vmcnt(0)
  s_mov_b64 exec, 1
  buffer_store_dword v38, off, s[4:7], s84 sc1
  s_mov_b64 exec, -1
  s_mov_b32 s84, 268435456
  s_branch o_fd_219
o_rt_223:
  s_mov_b32 s67, 0
o_rl_225:
  s_lshl_b32 s94, s43, 14
  s_add_u32 s94, s94, s86
  buffer_load_dwordx4 v[120:123], v5, s[4:7], s94 offen offset:0 sc1
  buffer_load_dwordx4 v[124:127], v5, s[4:7], s94 offen offset:512 sc1
  buffer_load_dwordx4 v[128:131], v5, s[4:7], s94 offen offset:256 sc1
  buffer_load_dwordx4 v[132:135], v5, s[4:7], s94 offen offset:768 sc1
  s_add_u32 s94, s94, 4096
  buffer_load_dwordx4 v[136:139], v5, s[4:7], s94 offen offset:0 sc1
  buffer_load_dwordx4 v[140:143], v5, s[4:7], s94 offen offset:512 sc1
  buffer_load_dwordx4 v[144:147], v5, s[4:7], s94 offen offset:256 sc1
  buffer_load_dwordx4 v[148:151], v5, s[4:7], s94 offen offset:768 sc1
  s_add_u32 s94, s94, 4096
  buffer_load_dwordx4 v[152:155], v5, s[4:7], s94 offen offset:0 sc1
  buffer_load_dwordx4 v[156:159], v5, s[4:7], s94 offen offset:512 sc1
  buffer_load_dwordx4 v[160:163], v5, s[4:7], s94 offen offset:256 sc1
  buffer_load_dwordx4 v[164:167], v5, s[4:7], s94 offen offset:768 sc1
  s_add_u32 s94, s94, 4096
  buffer_load_dwordx4 v[168:171], v5, s[4:7], s94 offen offset:0 sc1
  buffer_load_dwordx4 v[172:175], v5, s[4:7], s94 offen offset:512 sc1
  buffer_load_dwordx4 v[176:179], v5, s[4:7], s94 offen offset:256 sc1
  buffer_load_dwordx4 v[180:183], v5, s[4:7], s94 offen offset:768 sc1
  s_add_u32 s67, s67, 1
  s_cmp_gt_u32 s67, 1048576
  s_cbranch_scc1 L_end
  s_waitcnt vmcnt(0)
  v_xor_b32 v7, s96, v120
  v_bitop3_b32 v7, v7, v124, s96 bitop3:0xf6
  v_bitop3_b32 v7, v7, v128, s96 bitop3:0xf6
  v_bitop3_b32 v7, v7, v132, s96 bitop3:0xf6
  v_bitop3_b32 v7, v7, v136, s96 bitop3:0xf6
  v_bitop3_b32 v7, v7, v140, s96 bitop3:0xf6
  v_bitop3_b32 v7, v7, v144, s96 bitop3:0xf6
  v_bitop3_b32 v7, v7, v148, s96 bitop3:0xf6
  v_bitop3_b32 v7, v7, v152, s96 bitop3:0xf6
  v_bitop3_b32 v7, v7, v156, s96 bitop3:0xf6
  v_bitop3_b32 v7, v7, v160, s96 bitop3:0xf6
  v_bitop3_b32 v7, v7, v164, s96 bitop3:0xf6
  v_bitop3_b32 v7, v7, v168, s96 bitop3:0xf6
  v_bitop3_b32 v7, v7, v172, s96 bitop3:0xf6
  v_bitop3_b32 v7, v7, v176, s96 bitop3:0xf6
  v_bitop3_b32 v7, v7, v180, s96 bitop3:0xf6
  v_and_b32 v7, v254, v7
  v_cmp_ne_u32 vcc, 0, v7
  s_cbranch_vccnz o_rl_225
  s_branch o_bk_224
o_f2_220:
  s_lshl_b32 s94, s43, 14
  s_add_u32 s94, s94, s86
  buffer_load_dwordx4 v[120:123], v5, s[4:7], s94 offen offset:0 sc1
  buffer_load_dwordx4 v[124:127], v5, s[4:7], s94 offen offset:512 sc1
  buffer_load_dwordx4 v[128:131], v5, s[4:7], s94 offen offset:256 sc1
  buffer_load_dwordx4 v[132:135], v5, s[4:7], s94 offen offset:768 sc1
  s_add_u32 s94, s94, 4096
  buffer_load_dwordx4 v[136:139], v5, s[4:7], s94 offen offset:0 sc1
  buffer_load_dwordx4 v[140:143], v5, s[4:7], s94 offen offset:512 sc1
  buffer_load_dwordx4 v[144:147], v5, s[4:7], s94 offen offset:256 sc1
  buffer_load_dwordx4 v[148:151], v5, s[4:7], s94 offen offset:768 sc1
  s_add_u32 s94, s94, 4096
  buffer_load_dwordx4 v[152:155], v5, s[4:7], s94 offen offset:0 sc1
  buffer_load_dwordx4 v[156:159], v5, s[4:7], s94 offen offset:512 sc1
  buffer_load_dwordx4 v[160:163], v5, s[4:7], s94 offen offset:256 sc1
  buffer_load_dwordx4 v[164:167], v5, s[4:7], s94 offen offset:768 sc1
  s_add_u32 s94, s94, 4096
  buffer_load_dwordx4 v[168:171], v5, s[4:7], s94 offen offset:0 sc1
  buffer_load_dwordx4 v[172:175], v5, s[4:7], s94 offen offset:512 sc1
  buffer_load_dwordx4 v[176:179], v5, s[4:7], s94 offen offset:256 sc1
  buffer_load_dwordx4 v[180:183], v5, s[4:7], s94 offen offset:768 sc1
  s_mov_b64 exec, 1
  buffer_store_dword v38, off, s[4:7], s84 sc1
  s_mov_b64 exec, -1
  s_mov_b32 s84, 268435456
  v_mov_b64 v[188:189], 0
  v_mov_b64 v[190:191], 0
  v_mov_b64 v[192:193], 0
  v_mov_b64 v[194:195], 0
  s_waitcnt vmcnt(13)
  v_xor_b32 v7, s96, v120
  v_bitop3_b32 v7, v7, v124, s96 bitop3:0xf6
  v_bitop3_b32 v7, v7, v128, s96 bitop3:0xf6
  v_bitop3_b32 v7, v7, v132, s96 bitop3:0xf6
  s_waitcnt vmcnt(9)
  v_bitop3_b32 v7, v7, v136, s96 bitop3:0xf6
  v_bitop3_b32 v7, v7, v140, s96 bitop3:0xf6
  v_bitop3_b32 v7, v7, v144, s96 bitop3:0xf6
  v_bitop3_b32 v7, v7, v148, s96 bitop3:0xf6
  s_waitcnt vmcnt(5)
  v_bitop3_b32 v7, v7, v152, s96 bitop3:0xf6
  v_bitop3_b32 v7, v7, v156, s96 bitop3:0xf6
  v_bitop3_b32 v7, v7, v160, s96 bitop3:0xf6
  v_bitop3_b32 v7, v7, v164, s96 bitop3:0xf6
  s_waitcnt vmcnt(1)
  v_bitop3_b32 v7, v7, v168, s96 bitop3:0xf6
  v_bitop3_b32 v7, v7, v172, s96 bitop3:0xf6
  v_bitop3_b32 v7, v7, v176, s96 bitop3:0xf6
  v_bitop3_b32 v7, v7, v180, s96 bitop3:0xf6
  v_and_b32 v7, v254, v7
  v_cmp_ne_u32 vcc, 0, v7
  s_cbranch_vccnz o_rt_226
o_bk_227:
  v_smfmac_f32_16x16x64_bf16 v[188:191], v[16:19], v[120:127], v20
  v_lshlrev_b32 v196, 16, v184
  v_smfmac_f32_16x16x64_bf16 v[192:195], v[16:19], v[128:135], v20
  v_and_b32 v197, 0xffff0000, v184
  v_smfmac_f32_16x16x64_bf16 v[188:191], v[16:19], v[136:143], v20
  v_lshlrev_b32 v198, 16, v185
  v_smfmac_f32_16x16x64_bf16 v[192:195], v[16:19], v[144:151], v20
  v_and_b32 v199, 0xffff0000, v185
  v_smfmac_f32_16x16x64_bf16 v[188:191], v[16:19], v[152:159], v20
  v_lshlrev_b32 v200, 16, v186
  v_smfmac_f32_16x16x64_bf16 v[192:195], v[16:19], v[160:167], v20
  v_and_b32 v201, 0xffff0000, v186
  v_smfmac_f32_16x16x64_bf16 v[188:191], v[16:19], v[168:175], v20
  v_lshlrev_b32 v202, 16, v187
  v_smfmac_f32_16x16x64_bf16 v[192:195], v[16:19], v[176:183], v20
  v_and_b32 v203, 0xffff0000, v187
  s_bfe_u32 s92, s65, 131086
  s_lshl_b32 s92, s92, 21
  s_add_u32 s92, s92, s91
  s_add_u32 s93, s92, 27262976
  s_add_u32 s92, s92, 20971520
  s_nop 1
  v_permlane16_swap_b32 v188, v192
  v_permlane16_swap_b32 v189, v193
  v_permlane16_swap_b32 v190, v194
  v_permlane16_swap_b32 v191, v195
  v_cvt_pk_bf16_f32 v188, 0, v188
  v_cvt_pk_bf16_f32 v189, 0, v189
  v_cvt_pk_bf16_f32 v190, 0, v190
  v_cvt_pk_bf16_f32 v191, 0, v191
  v_cvt_pk_bf16_f32 v192, 0, v192
  v_cvt_pk_bf16_f32 v193, 0, v193
  v_cvt_pk_bf16_f32 v194, 0, v194
  v_cvt_pk_bf16_f32 v195, 0, v195
  v_add_f32 v196, v196, v188
  v_add_f32 v197, v197, v189
  v_add_f32 v198, v198, v190
  v_add_f32 v199, v199, v191
  v_add_f32 v200, v200, v192
  v_add_f32 v201, v201, v193
  v_add_f32 v202, v202, v194
  v_add_f32 v203, v203, v195
  v_cvt_pk_bf16_f32 v120, v196, v197
  v_cvt_pk_bf16_f32 v121, v198, v199
  v_cvt_pk_bf16_f32 v122, v200, v201
  v_cvt_pk_bf16_f32 v123, v202, v203
  v_lshlrev_b32 v196, 16, v120
  v_and_b32 v197, 0xffff0000, v120
  v_lshlrev_b32 v198, 16, v121
  v_and_b32 v199, 0xffff0000, v121
  v_lshlrev_b32 v200, 16, v122
  v_and_b32 v201, 0xffff0000, v122
  v_lshlrev_b32 v202, 16, v123
  v_and_b32 v203, 0xffff0000, v123
  buffer_store_dwordx4 v[120:123], v0, s[4:7], s92 offen sc1
  v_add_f32 v136, v196, v197
  v_mul_f32 v137, v196, v196
  v_add_f32 v138, v198, v199
  v_mul_f32 v139, v197, v197
  v_fmac_f32 v137, v198, v198
  v_fmac_f32 v139, v199, v199
  v_add_f32 v136, v136, v200
  v_fmac_f32 v137, v200, v200
  v_add_f32 v138, v138, v201
  v_fmac_f32 v139, v201, v201
  v_add_f32 v136, v136, v202
  v_fmac_f32 v137, v202, v202
  v_add_f32 v138, v138, v203
  v_fmac_f32 v139, v203, v203
  v_add_f32 v136, v136, v138
  v_add_f32 v137, v137, v139
  s_nop 0
  v_add_f32_dpp v136, v136, v136 row_ror:8 row_mask:0xf bank_mask:0xf
  v_add_f32_dpp v137, v137, v137 row_ror:8 row_mask:0xf bank_mask:0xf
  s_nop 0
  v_add_f32_dpp v136, v136, v136 row_ror:4 row_mask:0xf bank_mask:0xf
  v_add_f32_dpp v137, v137, v137 row_ror:4 row_mask:0xf bank_mask:0xf
  s_nop 0
  v_add_f32_dpp v136, v136, v136 row_ror:2 row_mask:0xf bank_mask:0xf
  v_add_f32_dpp v137, v137, v137 row_ror:2 row_mask:0xf bank_mask:0xf
  s_nop 0
  v_add_f32_dpp v136, v136, v136 row_ror:1 row_mask:0xf bank_mask:0xf
  v_add_f32_dpp v137, v137, v137 row_ror:1 row_mask:0xf bank_mask:0xf
  v_mov_b32 v140, v136
  v_mov_b32 v141, v137
  s_nop 0
  v_permlane16_swap_b32 v136, v140
  v_permlane16_swap_b32 v137, v141
  v_add_f32 v136, v136, v140
  v_add_f32 v137, v137, v141
  v_mov_b32 v140, v136
  v_mov_b32 v141, v137
  s_nop 0
  v_permlane32_swap_b32 v136, v140
  v_permlane32_swap_b32 v137, v141
  v_add_f32 v136, v136, v140
  v_add_f32 v137, v137, v141
  v_mul_f32 v136, 0x3b000000, v136
  v_mul_f32 v137, 0x3b000000, v137
  v_fma_f32 v137, -v136, v136, v137
  v_cvt_pk_bf16_f32 v136, 0, v136
  v_max_f32 v137, 0, v137
  v_sub_f32 v140, v196, v136
  v_sub_f32 v141, v197, v136
  v_cvt_pk_bf16_f32 v137, 0, v137
  v_sub_f32 v142, v198, v136
  v_sub_f32 v143, v199, v136
  v_add_f32 v137, 0x3727c5ac, v137
  v_sub_f32 v144, v200, v136
  v_sub_f32 v145, v201, v136
  v_cvt_pk_bf16_f32 v137, 0, v137
  v_sub_f32 v146, v202, v136
  v_sub_f32 v147, v203, v136
  v_sqrt_f32 v137, v137
  v_cvt_pk_bf16_f32 v140, 0, v140
  v_cvt_pk_bf16_f32 v141, 0, v141
  v_cvt_pk_bf16_f32 v137, 0, v137
  v_cvt_pk_bf16_f32 v142, 0, v142
  v_cvt_pk_bf16_f32 v143, 0, v143
  v_rcp_f32 v137, v137
  v_cvt_pk_bf16_f32 v144, 0, v144
  v_cvt_pk_bf16_f32 v145, 0, v145
  v_cvt_pk_bf16_f32 v146, 0, v146
  v_cvt_pk_bf16_f32 v147, 0, v147
  v_mul_f32 v140, v140, v137
  v_mul_f32 v141, v141, v137
  v_mul_f32 v142, v142, v137
  v_mul_f32 v143, v143, v137
  v_mul_f32 v144, v144, v137
  v_mul_f32 v145, v145, v137
  v_mul_f32 v146, v146, v137
  v_mul_f32 v147, v147, v137
  v_cvt_pk_bf16_f32 v124, v140, v141
  v_cvt_pk_bf16_f32 v125, v142, v143
  v_cvt_pk_bf16_f32 v126, v144, v145
  v_cvt_pk_bf16_f32 v127, v146, v147
  v_lshlrev_b32 v204, 16, v124
  v_and_b32 v205, 0xffff0000, v124
  v_lshlrev_b32 v206, 16, v125
  v_and_b32 v207, 0xffff0000, v125
  v_lshlrev_b32 v208, 16, v126
  v_and_b32 v209, 0xffff0000, v126
  v_lshlrev_b32 v210, 16, v127
  v_and_b32 v211, 0xffff0000, v127
  buffer_store_dwordx4 v[124:127], v0, s[4:7], s93 offen sc1
  v_add_f32 v196, v196, v204
  v_add_f32 v197, v197, v205
  v_add_f32 v198, v198, v206
  v_add_f32 v199, v199, v207
  v_add_f32 v200, v200, v208
  v_add_f32 v201, v201, v209
  v_add_f32 v202, v202, v210
  v_add_f32 v203, v203, v211
  v_cvt_pk_bf16_f32 v128, v196, v197
  v_cvt_pk_bf16_f32 v129, v198, v199
  v_cvt_pk_bf16_f32 v130, v200, v201
  v_cvt_pk_bf16_f32 v131, v202, v203
  v_mul_f32 v188, v204, v8
  v_mul_f32 v189, v205, v9
  v_fmac_f32 v188, v206, v10
  v_fmac_f32 v189, v207, v11
  v_fmac_f32 v188, v208, v12
  v_fmac_f32 v189, v209, v13
  v_fmac_f32 v188, v210, v14
  v_fmac_f32 v189, v211, v15
  v_add_f32 v188, v188, v189
  buffer_store_dwordx4 v[128:131], v0, s[68:71], s91 offen sc1
  s_nop 0
  v_add_f32_dpp v188, v188, v188 row_ror:8 row_mask:0xf bank_mask:0xf
  s_nop 1
  v_add_f32_dpp v188, v188, v188 row_ror:4 row_mask:0xf bank_mask:0xf
  s_nop 1
  v_add_f32_dpp v188, v188, v188 row_ror:2 row_mask:0xf bank_mask:0xf
  s_nop 1
  v_add_f32_dpp v188, v188, v188 row_ror:1 row_mask:0xf bank_mask:0xf
  v_mov_b32 v189, v188
  s_nop 0
  s_nop 0
  v_permlane16_swap_b32 v188, v189
  v_add_f32 v188, v188, v189
  v_mov_b32 v189, v188
  s_nop 0
  s_nop 0
  v_permlane32_swap_b32 v188, v189
  v_add_f32 v188, v188, v189
  v_cvt_pk_bf16_f32 v188, 0, v188
  v_ashrrev_i32 v189, 31, v188
  v_or_b32 v189, 0x80000000, v189
  v_xor_b32 v188, v188, v189
  s_sub_u32 s92, 4095, s90
  v_and_b32 v188, 0xffff0000, v188
  v_or_b32 v38, s92, v188
  s_bfe_u32 s92, s65, 196625
  s_lshl_b32 s92, s92, 18
  s_lshl_b32 s93, s90, 7
  s_add_u32 s92, s92, s93
  s_add_u32 s84, s92, 243269632
  s_waitcnt vmcnt(0)
  s_mov_b64 exec, 1
  buffer_store_dword v38, off, s[4:7], s84 sc1
  s_mov_b64 exec, -1
  s_mov_b32 s84, 268435456
  s_branch o_fd_219
o_rt_226:
  s_mov_b32 s67, 0
o_rl_228:
  s_lshl_b32 s94, s43, 14
  s_add_u32 s94, s94, s86
  buffer_load_dwordx4 v[120:123], v5, s[4:7], s94 offen offset:0 sc1
  buffer_load_dwordx4 v[124:127], v5, s[4:7], s94 offen offset:512 sc1
  buffer_load_dwordx4 v[128:131], v5, s[4:7], s94 offen offset:256 sc1
  buffer_load_dwordx4 v[132:135], v5, s[4:7], s94 offen offset:768 sc1
  s_add_u32 s94, s94, 4096
  buffer_load_dwordx4 v[136:139], v5, s[4:7], s94 offen offset:0 sc1
  buffer_load_dwordx4 v[140:143], v5, s[4:7], s94 offen offset:512 sc1
  buffer_load_dwordx4 v[144:147], v5, s[4:7], s94 offen offset:256 sc1
  buffer_load_dwordx4 v[148:151], v5, s[4:7], s94 offen offset:768 sc1
  s_add_u32 s94, s94, 4096
  buffer_load_dwordx4 v[152:155], v5, s[4:7], s94 offen offset:0 sc1
  buffer_load_dwordx4 v[156:159], v5, s[4:7], s94 offen offset:512 sc1
  buffer_load_dwordx4 v[160:163], v5, s[4:7], s94 offen offset:256 sc1
  buffer_load_dwordx4 v[164:167], v5, s[4:7], s94 offen offset:768 sc1
  s_add_u32 s94, s94, 4096
  buffer_load_dwordx4 v[168:171], v5, s[4:7], s94 offen offset:0 sc1
  buffer_load_dwordx4 v[172:175], v5, s[4:7], s94 offen offset:512 sc1
  buffer_load_dwordx4 v[176:179], v5, s[4:7], s94 offen offset:256 sc1
  buffer_load_dwordx4 v[180:183], v5, s[4:7], s94 offen offset:768 sc1
  s_add_u32 s67, s67, 1
  s_cmp_gt_u32 s67, 1048576
  s_cbranch_scc1 L_end
  s_waitcnt vmcnt(0)
  v_xor_b32 v7, s96, v120
  v_bitop3_b32 v7, v7, v124, s96 bitop3:0xf6
  v_bitop3_b32 v7, v7, v128, s96 bitop3:0xf6
  v_bitop3_b32 v7, v7, v132, s96 bitop3:0xf6
  v_bitop3_b32 v7, v7, v136, s96 bitop3:0xf6
  v_bitop3_b32 v7, v7, v140, s96 bitop3:0xf6
  v_bitop3_b32 v7, v7, v144, s96 bitop3:0xf6
  v_bitop3_b32 v7, v7, v148, s96 bitop3:0xf6
  v_bitop3_b32 v7, v7, v152, s96 bitop3:0xf6
  v_bitop3_b32 v7, v7, v156, s96 bitop3:0xf6
  v_bitop3_b32 v7, v7, v160, s96 bitop3:0xf6
  v_bitop3_b32 v7, v7, v164, s96 bitop3:0xf6
  v_bitop3_b32 v7, v7, v168, s96 bitop3:0xf6
  v_bitop3_b32 v7, v7, v172, s96 bitop3:0xf6
  v_bitop3_b32 v7, v7, v176, s96 bitop3:0xf6
  v_bitop3_b32 v7, v7, v180, s96 bitop3:0xf6
  v_and_b32 v7, v254, v7
  v_cmp_ne_u32 vcc, 0, v7
  s_cbranch_vccnz o_rl_228
  s_branch o_bk_227
o_fd_219:
  s_mov_b32 s65, 0
o_nofl_179:
  s_mov_b32 s63, s64
  s_cmp_lg_u32 s51, 0
  s_cbranch_scc1 o_pick_181
  s_cmp_eq_u32 s50, 0
  s_cbranch_scc1 o_help_188_n
o_adv_187:
  s_add_u32 s49, s49, 4
  s_branch o_round_177
o_dl_189_a:
  s_andn2_b32 s26, s58, s55
  s_and_b32 s29, s26, s54
  s_bcnt1_i32_b32 s27, s29
  s_add_u32 s27, s27, 2
  s_max_u32 s27, s27, 4
  s_andn2_b32 s26, s26, s56
  s_and_b32 s26, s26, 0x3fff
  s_or_b32 s26, s26, s29
  s_cselect_b32 s27, s27, 0
  s_mul_i32 s27, s27, 0
  s_cmp_ge_u32 s46, s89
  s_cselect_b32 s30, s54, -1
  s_mov_b32 s31, 243269696
  s_branch o_dl_189_b
o_dl_189:
  s_and_b32 s26, s55, s54
  s_andn2_b32 s27, s56, s54
  s_or_b32 s26, s26, s27
  s_andn2_b32 s26, s58, s26
  s_bcnt1_i32_b32 s27, s26
  s_bcnt1_i32_b32 s28, s47
  s_mul_i32 s28, s28, -5
  s_lshl1_add_u32 s27, s27, s28
  s_add_i32 s27, s27, 1
  s_max_i32 s27, s27, 0
  s_mul_i32 s27, s27, 37
  s_mov_b32 s30, s54
  s_mov_b32 s31, 243269704
  s_and_b32 s29, s26, s47
  s_andn2_b32 s26, s26, s29
  s_branch o_dl_189_c
o_dl_189_b:
  s_mov_b32 s29, 0
o_dl_189_c:
  s_bfe_u32 s28, s48, 262144
  s_bitset0_b32 s26, s28
  s_bfe_u32 s28, s48, 262148
  s_bitset0_b32 s26, s28
  s_bfe_u32 s28, s48, 262152
  s_bitset0_b32 s26, s28
  s_bfe_u32 s28, s48, 262156
  s_bitset0_b32 s26, s28
  s_lshr_b32 s27, s27, 8
o_dl1_190:
  s_cbranch_scc0 o_dl2_191
  s_ff1_i32_b32 s28, s26
  s_bitset0_b32 s26, s28
  s_bitset1_b32 s29, s28
  s_sub_u32 s27, s27, 1
  s_cmp_lg_u32 s27, 0
  s_branch o_dl1_190
o_dl2_191:
  s_and_b32 s47, s29, 0xffff
  s_and_b32 s30, s30, s47
  s_or_b32 s55, s55, s30
  s_andn2_b32 s26, s47, s30
  s_or_b32 s56, s56, s26
  s_pack_ll_b32_b16 s26, s47, s30
  s_lshl_b32 s27, s60, 7
  s_add_u32 s27, s27, s31
  s_cmp_lg_u32 s43, 0
  s_cbranch_scc1 o_pick_181
  v_mov_b32 v162, s26
  v_mov_b32 v163, s46
  s_mov_b64 exec, 1
  buffer_store_dwordx2 v[162:163], off, s[4:7], s27 sc1
  s_mov_b64 exec, -1
  s_branch o_pick_181
o_help_188:
  s_lshl_b32 s60, s60, 1
  s_and_b32 s60, s60, 2
  s_lshl_b32 s47, s60, 7
  s_add_u32 s47, s47, 243269688
o_help_188_n:
  s_add_u32 s47, s47, 8
  s_lshr_b32 s26, s47, 4
  s_andn2_b32 s26, s57, s26
  s_cbranch_scc0 L_end
  s_mov_b32 s67, 0
o_help_188_w:
  buffer_load_dwordx2 v[162:163], off, s[4:7], s47 sc1
  buffer_load_dwordx2 v[164:165], off, s[4:7], s47 offset:128 sc1
  s_add_u32 s67, s67, 1
  s_cmp_gt_u32 s67, 1048576
  s_cbranch_scc1 L_end
  s_waitcnt vmcnt(0)
  v_readfirstlane_b32 s28, v162
  v_readfirstlane_b32 s30, v164
  v_readfirstlane_b32 s46, v163
  v_readfirstlane_b32 s27, v165
  s_min_u32 s26, s46, s27
  s_cmp_eq_u32 s26, 0
  s_cbranch_scc1 o_help_188_w
  s_max_u32 s46, s46, s27
  s_bitreplicate_b64_b32 s[28:29], s28
  s_bitreplicate_b64_b32 s[30:31], s30
  s_mov_b32 s26, 0x55555555
  s_mov_b32 s27, 0x55555555
  s_and_b64 s[28:29], s[28:29], s[26:27]
  s_andn2_b64 s[30:31], s[30:31], s[26:27]
  s_or_b32 s58, s28, s30
  s_or_b32 s54, s29, s31
  s_andn2_b32 s52, 0xfff, s46
  s_lshr_b32 s52, s52, 5
  s_mov_b32 s53, 0
  s_mov_b32 s63, 0
  s_mov_b32 s49, 72
  s_mov_b32 s59, 64
  s_mov_b32 s50, 0
  s_mov_b32 s89, 0
  s_branch o_pick_181

.section .rodata,"a"
.p2align 6
.amdhsa_kernel interleave_layers__memory_aug_recurrent_mem_tr__moe_arch_mod__prompt_kernel
  .amdhsa_next_free_vgpr 512
  .amdhsa_next_free_sgpr 102
  .amdhsa_accum_offset 256
  .amdhsa_group_segment_fixed_size 0
  .amdhsa_kernarg_size 120
  .amdhsa_user_sgpr_count 2
  .amdhsa_user_sgpr_kernarg_segment_ptr 1
  .amdhsa_system_sgpr_workgroup_id_x 1
  .amdhsa_float_denorm_mode_32 3
.end_amdhsa_kernel
```
